```python
import torch

def _softmax(x, axis=-1):
    return torch.softmax(x, dim=axis)
def _gelu(x):
    return torch.nn.functional.gelu(x, approximate="tanh")
def _silu(x):
    return torch.nn.functional.silu(x)
def _sigmoid(x):
    return torch.sigmoid(x)
def _layernorm(x, axis=-1, eps=1e-5):
    m = x.mean(dim=axis, keepdim=True)
    v = x.var(dim=axis, keepdim=True, unbiased=False)
    return (x - m) / torch.sqrt(v + eps)
def _scatter_add(tgt, idx, src, axis=0):
    return tgt.clone().index_add_(axis, idx, src)
def _segment_sum(src, seg, n):
    out = torch.zeros((n,) + src.shape[1:], dtype=src.dtype)
    return out.index_add_(0, seg, src)
def _pad(x, pw):
    flat = tuple(v for pair in reversed(pw) for v in pair)
    return torch.nn.functional.pad(x, flat)

kernel_name = 'standalone__window_attn_swin_v2__vision'

def setup_inputs():

    _w = (lambda a: (lambda t: t.to(torch.bfloat16) if t.is_floating_point() else t)(torch.as_tensor(a)))
    win = 7
    H = W = (512 // win) * win
    C = 192
    nh = 4
    shift = win // 2
    coords = torch.stack(torch.meshgrid(torch.arange(win), torch.arange(win), indexing="ij"), -1).reshape(-1, 2)
    rel = coords[:, None, :] - coords[None, :, :]
    rel_idx = ((rel[..., 0] + win - 1) * (2 * win - 1) + (rel[..., 1] + win - 1)).to(torch.int64)
    tab = torch.stack(torch.meshgrid(torch.arange(1 - win, win), torch.arange(1 - win, win), indexing="ij"), -1).reshape(-1, 2).to(float)
    tab = (lambda _x: torch.sign(torch.as_tensor(_x)))(tab) * (lambda _x: torch.log1p(torch.as_tensor(_x)))(torch.abs(tab))
    img = torch.zeros((H, W), dtype=torch.int64)
    cnt = 0
    for hs in (slice(0, H - win), slice(H - win, H - shift), slice(H - shift, H)):
        for ws in (slice(0, W - win), slice(W - win, W - shift), slice(W - shift, W)):
            img[hs, ws] = cnt; cnt += 1
    mw = img.reshape(H // win, win, W // win, win).permute(0, 2, 1, 3).reshape(-1, win * win)
    mask = (mw[:, :, None] != mw[:, None, :]).to(float) * (-100.0)
    return {
        "x": _w((lambda *s: torch.randn(*s, dtype=torch.bfloat16) * 0.05)(1, H, W, C)),
        "wqkv": _w((lambda *s: torch.randn(*s, dtype=torch.bfloat16) * 1.6)(C, 3 * C)),
        "wo": _w((lambda *s: torch.randn(*s, dtype=torch.bfloat16) * 0.05)(C, C)),
        "logit_scale": _w((lambda *s: torch.randn(*s, dtype=torch.bfloat16) * 1.6)(nh)),
        "cpb_w1": _w((lambda *s: torch.randn(*s, dtype=torch.bfloat16) * 1.6)(2, 4 * nh)),
        "cpb_w2": _w((lambda *s: torch.randn(*s, dtype=torch.bfloat16) * 1.6)(4 * nh, nh)),
        "rel_coords": _w(tab),
        "rel_idx": _w(rel_idx),
        "attn_mask": _w(mask),
    }

def reference(x, wqkv, wo, logit_scale, cpb_w1, cpb_w2, rel_coords, rel_idx, attn_mask):
    B, H, W, C = x.shape
    win = 7
    nh = 4
    hd = C // nh
    shift = win // 2
    ww = win * win
    nH, nW = H // win, W // win
    xs = torch.roll(x, (-shift, -shift), (1, 2))
    xw = (lambda x, *d: x.permute(*d))(xs.reshape(B, nH, win, nW, win, C), 0, 1, 3, 2, 4, 5).reshape(B * nH * nW, ww, C)
    qkv = (lambda x, *d: x.permute(*d))((xw @ wqkv).reshape(B * nH * nW, ww, 3, nh, hd), 2, 0, 3, 1, 4)
    q, k, v = qkv[0], qkv[1], qkv[2]
    qn = q * (torch.einsum("bhqd,bhqd->bhq", q, q)[..., None] + 1e-12) ** -0.5
    kn = k * (torch.einsum("bhkd,bhkd->bhk", k, k)[..., None] + 1e-12) ** -0.5
    logits = torch.einsum("bhqd,bhkd->bhqk", qn, kn)
    tau = torch.exp(torch.clip(logit_scale, -100.0, 4.6052))
    logits = logits * tau[None, :, None, None]
    hcpb = rel_coords @ cpb_w1
    hcpb = torch.where(hcpb > 0, hcpb, hcpb * 0)
    bias_tab = 16.0 * _sigmoid(hcpb @ cpb_w2)
    bias = (lambda x, *d: x.permute(*d))(bias_tab[rel_idx], 2, 0, 1)
    logits = logits.reshape(B, nH * nW, nh, ww, ww) + bias[None, None, :, :, :] + attn_mask[None, :, None, :, :]
    p = _softmax(logits.reshape(B * nH * nW, nh, ww, ww), axis=-1)
    o = (lambda x, *d: x.permute(*d))(torch.einsum("bhqk,bhkd->bhqd", p, v), 0, 2, 1, 3).reshape(B * nH * nW, ww, C) @ wo
    o = (lambda x, *d: x.permute(*d))(o.reshape(B, nH, nW, win, win, C), 0, 1, 3, 2, 4, 5).reshape(B, H, W, C)
    o = torch.roll(o, (shift, shift), (1, 2))
    return _layernorm(o, axis=-1)
```

```asm
; @launch grid=(256,1,1) block=(256,1,1) lds=163840
.amdgcn_target "amdgcn-amd-amdhsa--gfx950"
.text
.globl standalone__window_attn_swin_v2__vision_kernel
.p2align 8
.type standalone__window_attn_swin_v2__vision_kernel,@function
standalone__window_attn_swin_v2__vision_kernel:
    s_cmp_ge_u32 s2, 256
    s_cbranch_scc1 L_end
    s_load_dwordx16 s[4:19], s[0:1], 0
    s_load_dwordx4 s[20:23], s[0:1], 64
    s_getpc_b64 s[78:79]
    v_lshlrev_b32 v10, 7, v0
    v_min_u32 v11, L_slow-standalone__window_attn_swin_v2__vision_kernel-64, v10
    global_load_dword v11, v11, s[78:79]
    v_lshrrev_b32 v4, 6, v0
    s_nop 0
    v_readfirstlane_b32 s68, v4
    v_mbcnt_lo_u32_b32 v1, -1, 0
    v_mbcnt_hi_u32_b32 v1, -1, v1
    v_and_b32 v2, 15, v1
    v_lshrrev_b32 v3, 4, v1
    s_mul_i32 s53, s68, 96
    v_add_u32 v4, 0, v1
    v_mul_u32_u24 v5, 10923, v4
    v_lshrrev_b32 v5, 16, v5
    v_mul_u32_u24 v6, 6, v5
    v_sub_u32 v6, v4, v6
    v_lshl_add_u32 v6, v6, 4, s53
    v_mul_u32_u24 v7, 384, v5
    v_add_u32 v12, v7, v6
    v_mul_u32_u24 v7, 1152, v5
    v_add_u32 v15, v7, v6
    v_add_u32 v4, 64, v1
    v_mul_u32_u24 v5, 10923, v4
    v_lshrrev_b32 v5, 16, v5
    v_mul_u32_u24 v6, 6, v5
    v_sub_u32 v6, v4, v6
    v_lshl_add_u32 v6, v6, 4, s53
    v_mul_u32_u24 v7, 384, v5
    v_add_u32 v13, v7, v6
    v_mul_u32_u24 v7, 1152, v5
    v_add_u32 v16, v7, v6
    v_add_u32 v4, 128, v1
    v_mul_u32_u24 v5, 10923, v4
    v_lshrrev_b32 v5, 16, v5
    v_mul_u32_u24 v6, 6, v5
    v_sub_u32 v6, v4, v6
    v_lshl_add_u32 v6, v6, 4, s53
    v_mul_u32_u24 v7, 384, v5
    v_add_u32 v14, v7, v6
    v_mul_u32_u24 v7, 1152, v5
    v_add_u32 v17, v7, v6
    s_lshr_b32 s75, s2, 3
    s_and_b32 s75, s75, 7
    s_mul_i32 s75, s75, 27648
    s_mul_i32 s80, s68, 6144
    s_add_u32 s80, s80, 61440
    s_waitcnt lgkmcnt(0)
    s_mov_b32 s24, s4
    s_mov_b32 s25, s5
    s_mov_b32 s26, 100270464
    s_mov_b32 s27, 0x20000
    s_mov_b32 s28, s22
    s_mov_b32 s29, s23
    s_mov_b32 s30, 0
    s_mov_b32 s31, 0x20000
    s_mov_b32 s32, s6
    s_mov_b32 s33, s7
    s_mov_b32 s34, 221184
    s_mov_b32 s35, 0x20000
    s_mov_b32 s36, s8
    s_mov_b32 s37, s9
    s_mov_b32 s38, 73728
    s_mov_b32 s39, 0x20000
    s_load_dwordx2 s[82:83], s[10:11], 0
    buffer_load_dword v18, v10, s[32:35], s75 offen
    v_add_u32 v4, 0, v1
    v_min_u32 v4, 168, v4
    v_lshlrev_b32 v4, 2, v4
    global_load_dword v20, v4, s[16:17]
    v_add_u32 v4, 64, v1
    v_min_u32 v4, 168, v4
    v_lshlrev_b32 v4, 2, v4
    global_load_dword v21, v4, s[16:17]
    v_add_u32 v4, 128, v1
    v_min_u32 v4, 168, v4
    v_lshlrev_b32 v4, 2, v4
    global_load_dword v22, v4, s[16:17]
    v_mov_b32 v4, 0
    global_load_dwordx4 v[24:27], v4, s[12:13] offset:0
    global_load_dwordx4 v[28:31], v4, s[12:13] offset:16
    global_load_dwordx4 v[32:35], v4, s[12:13] offset:32
    global_load_dwordx4 v[36:39], v4, s[12:13] offset:48
    v_lshlrev_b32 v4, 3, v2
    v_lshl_add_u32 v4, s68, 1, v4
    global_load_ushort v23, v4, s[14:15]
    v_lshrrev_b32 v4, 2, v2
    v_mul_u32_u24 v4, 12, v4
    v_and_b32 v5, 3, v2
    v_add_u32 v56, v4, v5
    v_add_u32 v57, 4, v56
    v_add_u32 v58, 8, v56
    v_mul_u32_u24 v59, 12, v3
    v_mul_u32_u24 v4, 49, v56
    v_add_u32 v100, v4, v59
    v_add_u32 v104, 48, v4
    v_lshlrev_b32 v5, 2, v100
    v_lshlrev_b32 v6, 2, v104
    global_load_dwordx4 v[60:63], v5, s[18:19] offset:0
    global_load_dwordx4 v[64:67], v5, s[18:19] offset:16
    global_load_dwordx4 v[68:71], v5, s[18:19] offset:32
    global_load_dword v96, v6, s[18:19]
    v_mul_u32_u24 v4, 49, v57
    v_add_u32 v101, v4, v59
    v_add_u32 v105, 48, v4
    v_lshlrev_b32 v5, 2, v101
    v_lshlrev_b32 v6, 2, v105
    global_load_dwordx4 v[72:75], v5, s[18:19] offset:0
    global_load_dwordx4 v[76:79], v5, s[18:19] offset:16
    global_load_dwordx4 v[80:83], v5, s[18:19] offset:32
    global_load_dword v97, v6, s[18:19]
    v_mul_u32_u24 v4, 49, v58
    v_add_u32 v102, v4, v59
    v_add_u32 v106, 48, v4
    v_lshlrev_b32 v5, 2, v102
    v_lshlrev_b32 v6, 2, v106
    global_load_dwordx4 v[84:87], v5, s[18:19] offset:0
    global_load_dwordx4 v[88:91], v5, s[18:19] offset:16
    global_load_dwordx4 v[92:95], v5, s[18:19] offset:32
    global_load_dword v98, v6, s[18:19]
    v_lshl_add_u32 v4, v3, 2, v56
    v_mov_b32 v5, 48
    v_cmp_gt_u32 vcc, 3, v3
    s_nop 1
    v_cndmask_b32 v4, v5, v4, vcc
    v_add_u32 v107, 2352, v4
    v_lshlrev_b32 v5, 2, v107
    global_load_dword v99, v5, s[18:19]
    s_add_u32 m0, s80, 0
    s_mov_b32 s53, 0
    buffer_load_dwordx4 v12, s[36:39], s53 offen lds
    s_add_u32 m0, s80, 1024
    s_mov_b32 s53, 0
    buffer_load_dwordx4 v13, s[36:39], s53 offen lds
    s_add_u32 m0, s80, 2048
    s_mov_b32 s53, 0
    buffer_load_dwordx4 v14, s[36:39], s53 offen lds
    s_add_u32 m0, s80, 3072
    s_mov_b32 s53, 12288
    buffer_load_dwordx4 v12, s[36:39], s53 offen lds
    s_add_u32 m0, s80, 4096
    s_mov_b32 s53, 12288
    buffer_load_dwordx4 v13, s[36:39], s53 offen lds
    s_add_u32 m0, s80, 5120
    s_mov_b32 s53, 12288
    buffer_load_dwordx4 v14, s[36:39], s53 offen lds
    s_add_u32 m0, s80, 24576
    s_mov_b32 s53, 24576
    buffer_load_dwordx4 v12, s[36:39], s53 offen lds
    s_add_u32 m0, s80, 25600
    s_mov_b32 s53, 24576
    buffer_load_dwordx4 v13, s[36:39], s53 offen lds
    s_add_u32 m0, s80, 26624
    s_mov_b32 s53, 24576
    buffer_load_dwordx4 v14, s[36:39], s53 offen lds
    s_add_u32 m0, s80, 27648
    s_mov_b32 s53, 36864
    buffer_load_dwordx4 v12, s[36:39], s53 offen lds
    s_add_u32 m0, s80, 28672
    s_mov_b32 s53, 36864
    buffer_load_dwordx4 v13, s[36:39], s53 offen lds
    s_add_u32 m0, s80, 29696
    s_mov_b32 s53, 36864
    buffer_load_dwordx4 v14, s[36:39], s53 offen lds
    s_add_u32 m0, s80, 49152
    s_mov_b32 s53, 49152
    buffer_load_dwordx4 v12, s[36:39], s53 offen lds
    s_add_u32 m0, s80, 50176
    s_mov_b32 s53, 49152
    buffer_load_dwordx4 v13, s[36:39], s53 offen lds
    s_add_u32 m0, s80, 51200
    s_mov_b32 s53, 49152
    buffer_load_dwordx4 v14, s[36:39], s53 offen lds
    s_add_u32 m0, s80, 52224
    s_mov_b32 s53, 61440
    buffer_load_dwordx4 v12, s[36:39], s53 offen lds
    s_add_u32 m0, s80, 53248
    s_mov_b32 s53, 61440
    buffer_load_dwordx4 v13, s[36:39], s53 offen lds
    s_add_u32 m0, s80, 54272
    s_mov_b32 s53, 61440
    buffer_load_dwordx4 v14, s[36:39], s53 offen lds
    s_add_u32 m0, s80, 73728
    s_mov_b32 s53, 0
    buffer_load_dwordx4 v15, s[32:35], s53 offen lds
    s_add_u32 m0, s80, 74752
    s_mov_b32 s53, 0
    buffer_load_dwordx4 v16, s[32:35], s53 offen lds
    s_add_u32 m0, s80, 75776
    s_mov_b32 s53, 0
    buffer_load_dwordx4 v17, s[32:35], s53 offen lds
    s_add_u32 m0, s80, 76800
    s_mov_b32 s53, 36864
    buffer_load_dwordx4 v15, s[32:35], s53 offen lds
    s_add_u32 m0, s80, 77824
    s_mov_b32 s53, 36864
    buffer_load_dwordx4 v16, s[32:35], s53 offen lds
    s_add_u32 m0, s80, 78848
    s_mov_b32 s53, 36864
    buffer_load_dwordx4 v17, s[32:35], s53 offen lds
    s_mul_i32 s75, s2, 21
    s_mul_i32 s76, s75, 58255
    s_lshr_b32 s76, s76, 22
    s_mul_i32 s77, s76, 72
    s_sub_u32 s70, s75, s77
    s_mul_i32 s76, s76, 1373568
    s_mul_i32 s77, s70, 2688
    s_add_u32 s69, s76, s77
    s_mov_b32 s62, 2688
    s_mov_b32 s63, 1180032
    s_mov_b32 s72, 3
    s_mov_b32 s73, 3
    s_mov_b32 s74, 0
    s_cmp_eq_u32 s2, 246
    s_cselect_b32 s71, 18, 21
    s_cmp_lt_u32 s2, 247
    s_cbranch_scc1 L_wdone
    s_mov_b32 s70, 0
    s_mov_b32 s71, 18
    s_sub_u32 s75, s2, 247
    s_mul_i32 s69, s75, 24724224
    s_mov_b32 s62, 1373568
    s_mov_b32 s73, 507
    s_mov_b32 s74, 345744
    s_cmp_lt_u32 s2, 251
    s_cbranch_scc1 L_wdone
    s_sub_u32 s75, s2, 251
    s_mul_i32 s69, s75, 48384
    s_mov_b32 s62, 2688
    s_mov_b32 s72, 507
    s_mov_b32 s73, 3
    s_mov_b32 s74, 25239312
    s_cmp_lt_u32 s2, 255
    s_cbranch_scc1 L_wdone
    s_mov_b32 s69, 0
    s_mov_b32 s62, 0
    s_mov_b32 s71, 1
    s_mov_b32 s73, 507
    s_mov_b32 s74, 25585056
L_wdone:
    s_mul_i32 s54, s68, 5120
    s_mul_i32 s81, s68, 12
    s_add_u32 s75, s72, 6
    s_sub_u32 s76, s75, 511
    s_min_u32 s75, s75, s76
    s_mul_i32 s75, s75, 196224
    s_add_u32 s76, s73, 6
    s_sub_u32 s77, s76, 511
    s_min_u32 s76, s76, s77
    s_mul_i32 s76, s76, 384
    s_add_u32 s75, s75, s76
    s_add_u32 s75, s75, s69
    s_sub_u32 s76, 72, s70
    v_add_u32 v4, 0, v1
    v_mul_u32_u24 v7, 2731, v4
    v_lshrrev_b32 v7, 16, v7
    v_mul_u32_u24 v5, 24, v7
    v_sub_u32 v5, v4, v5
    v_and_b32 v6, 3, v7
    v_lshl_add_u32 v6, s68, 2, v6
    v_and_b32 v8, 7, v6
    v_xor_b32 v8, v8, v5
    v_lshrrev_b32 v7, 2, v7
    v_lshl_add_u32 v7, v7, 4, v6
    v_mul_lo_u32 v108, v7, s62
    v_lshl_add_u32 v108, v8, 4, v108
    v_add_u32 v108, s75, v108
    v_add_u32 v9, s63, v108
    v_cmp_le_u32 vcc, s76, v7
    s_nop 1
    v_cndmask_b32 v108, v108, v9, vcc
    v_mov_b32 v9, 1073741824
    v_cmp_gt_u32 vcc, s71, v7
    s_nop 1
    v_cndmask_b32 v108, v9, v108, vcc
    v_add_u32 v4, 64, v1
    v_mul_u32_u24 v7, 2731, v4
    v_lshrrev_b32 v7, 16, v7
    v_mul_u32_u24 v5, 24, v7
    v_sub_u32 v5, v4, v5
    v_and_b32 v6, 3, v7
    v_lshl_add_u32 v6, s68, 2, v6
    v_and_b32 v8, 7, v6
    v_xor_b32 v8, v8, v5
    v_lshrrev_b32 v7, 2, v7
    v_lshl_add_u32 v7, v7, 4, v6
    v_mul_lo_u32 v109, v7, s62
    v_lshl_add_u32 v109, v8, 4, v109
    v_add_u32 v109, s75, v109
    v_add_u32 v9, s63, v109
    v_cmp_le_u32 vcc, s76, v7
    s_nop 1
    v_cndmask_b32 v109, v109, v9, vcc
    v_mov_b32 v9, 1073741824
    v_cmp_gt_u32 vcc, s71, v7
    s_nop 1
    v_cndmask_b32 v109, v9, v109, vcc
    v_add_u32 v4, 128, v1
    v_mul_u32_u24 v7, 2731, v4
    v_lshrrev_b32 v7, 16, v7
    v_mul_u32_u24 v5, 24, v7
    v_sub_u32 v5, v4, v5
    v_and_b32 v6, 3, v7
    v_lshl_add_u32 v6, s68, 2, v6
    v_and_b32 v8, 7, v6
    v_xor_b32 v8, v8, v5
    v_lshrrev_b32 v7, 2, v7
    v_lshl_add_u32 v7, v7, 4, v6
    v_mul_lo_u32 v110, v7, s62
    v_lshl_add_u32 v110, v8, 4, v110
    v_add_u32 v110, s75, v110
    v_add_u32 v9, s63, v110
    v_cmp_le_u32 vcc, s76, v7
    s_nop 1
    v_cndmask_b32 v110, v110, v9, vcc
    v_mov_b32 v9, 1073741824
    v_cmp_gt_u32 vcc, s71, v7
    s_nop 1
    v_cndmask_b32 v110, v9, v110, vcc
    s_add_u32 m0, s54, 40960
    s_nop 0
    buffer_load_dwordx4 v108, s[24:27], 0 offen nt lds
    s_add_u32 m0, s54, 41984
    s_nop 0
    buffer_load_dwordx4 v109, s[24:27], 0 offen nt lds
    s_add_u32 m0, s54, 43008
    s_nop 0
    buffer_load_dwordx4 v110, s[24:27], 0 offen nt lds
    v_add_u32 v4, 0, v1
    v_mul_u32_u24 v7, 2731, v4
    v_lshrrev_b32 v7, 16, v7
    v_mul_u32_u24 v5, 24, v7
    v_sub_u32 v5, v4, v5
    v_and_b32 v6, 3, v7
    v_lshl_add_u32 v6, s68, 2, v6
    v_and_b32 v8, 7, v6
    v_xor_b32 v8, v8, v5
    v_add_u32 v7, s81, v7
    v_mul_u32_u24 v4, 37, v7
    v_lshrrev_b32 v4, 8, v4
    v_mul_u32_u24 v5, 7, v4
    v_sub_u32 v5, v7, v5
    v_add_u32 v4, s72, v4
    v_subrev_u32 v9, 511, v4
    v_min_u32 v4, v4, v9
    s_mov_b32 s53, 196224
    v_mul_lo_u32 v4, v4, s53
    v_add_u32 v5, s73, v5
    v_subrev_u32 v9, 511, v5
    v_min_u32 v5, v5, v9
    s_mov_b32 s53, 384
    v_mul_lo_u32 v5, v5, s53
    v_add_u32 v4, v4, v5
    v_lshl_add_u32 v218, v8, 4, v4
    s_add_u32 m0, s54, 0
    s_nop 0
    buffer_load_dwordx4 v218, s[24:27], s69 offen nt lds
    v_add_u32 v4, 64, v1
    v_mul_u32_u24 v7, 2731, v4
    v_lshrrev_b32 v7, 16, v7
    v_mul_u32_u24 v5, 24, v7
    v_sub_u32 v5, v4, v5
    v_and_b32 v6, 3, v7
    v_lshl_add_u32 v6, s68, 2, v6
    v_and_b32 v8, 7, v6
    v_xor_b32 v8, v8, v5
    v_add_u32 v7, s81, v7
    v_mul_u32_u24 v4, 37, v7
    v_lshrrev_b32 v4, 8, v4
    v_mul_u32_u24 v5, 7, v4
    v_sub_u32 v5, v7, v5
    v_add_u32 v4, s72, v4
    v_subrev_u32 v9, 511, v4
    v_min_u32 v4, v4, v9
    s_mov_b32 s53, 196224
    v_mul_lo_u32 v4, v4, s53
    v_add_u32 v5, s73, v5
    v_subrev_u32 v9, 511, v5
    v_min_u32 v5, v5, v9
    s_mov_b32 s53, 384
    v_mul_lo_u32 v5, v5, s53
    v_add_u32 v4, v4, v5
    v_lshl_add_u32 v219, v8, 4, v4
    s_add_u32 m0, s54, 1024
    s_nop 0
    buffer_load_dwordx4 v219, s[24:27], s69 offen nt lds
    v_add_u32 v4, 128, v1
    v_mul_u32_u24 v7, 2731, v4
    v_lshrrev_b32 v7, 16, v7
    v_mul_u32_u24 v5, 24, v7
    v_sub_u32 v5, v4, v5
    v_and_b32 v6, 3, v7
    v_lshl_add_u32 v6, s68, 2, v6
    v_and_b32 v8, 7, v6
    v_xor_b32 v8, v8, v5
    v_add_u32 v7, s81, v7
    v_mul_u32_u24 v4, 37, v7
    v_lshrrev_b32 v4, 8, v4
    v_mul_u32_u24 v5, 7, v4
    v_sub_u32 v5, v7, v5
    v_add_u32 v4, s72, v4
    v_subrev_u32 v9, 511, v4
    v_min_u32 v4, v4, v9
    s_mov_b32 s53, 196224
    v_mul_lo_u32 v4, v4, s53
    v_add_u32 v5, s73, v5
    v_subrev_u32 v9, 511, v5
    v_min_u32 v5, v5, v9
    s_mov_b32 s53, 384
    v_mul_lo_u32 v5, v5, s53
    v_add_u32 v4, v4, v5
    v_lshl_add_u32 v220, v8, 4, v4
    s_add_u32 m0, s54, 2048
    s_nop 0
    buffer_load_dwordx4 v220, s[24:27], s69 offen nt lds
    v_add_u32 v4, 192, v1
    v_mul_u32_u24 v7, 2731, v4
    v_lshrrev_b32 v7, 16, v7
    v_mul_u32_u24 v5, 24, v7
    v_sub_u32 v5, v4, v5
    v_and_b32 v6, 3, v7
    v_lshl_add_u32 v6, s68, 2, v6
    v_and_b32 v8, 7, v6
    v_xor_b32 v8, v8, v5
    v_add_u32 v7, s81, v7
    v_mul_u32_u24 v4, 37, v7
    v_lshrrev_b32 v4, 8, v4
    v_mul_u32_u24 v5, 7, v4
    v_sub_u32 v5, v7, v5
    v_add_u32 v4, s72, v4
    v_subrev_u32 v9, 511, v4
    v_min_u32 v4, v4, v9
    s_mov_b32 s53, 196224
    v_mul_lo_u32 v4, v4, s53
    v_add_u32 v5, s73, v5
    v_subrev_u32 v9, 511, v5
    v_min_u32 v5, v5, v9
    s_mov_b32 s53, 384
    v_mul_lo_u32 v5, v5, s53
    v_add_u32 v4, v4, v5
    v_lshl_add_u32 v221, v8, 4, v4
    s_add_u32 m0, s54, 3072
    s_nop 0
    buffer_load_dwordx4 v221, s[24:27], s69 offen nt lds
    v_add_u32 v4, 256, v1
    v_mul_u32_u24 v7, 2731, v4
    v_lshrrev_b32 v7, 16, v7
    v_mul_u32_u24 v5, 24, v7
    v_sub_u32 v5, v4, v5
    v_and_b32 v6, 3, v7
    v_lshl_add_u32 v6, s68, 2, v6
    v_and_b32 v8, 7, v6
    v_xor_b32 v8, v8, v5
    v_add_u32 v7, s81, v7
    v_mul_u32_u24 v4, 37, v7
    v_lshrrev_b32 v4, 8, v4
    v_mul_u32_u24 v5, 7, v4
    v_sub_u32 v5, v7, v5
    v_add_u32 v4, s72, v4
    v_subrev_u32 v9, 511, v4
    v_min_u32 v4, v4, v9
    s_mov_b32 s53, 196224
    v_mul_lo_u32 v4, v4, s53
    v_add_u32 v5, s73, v5
    v_subrev_u32 v9, 511, v5
    v_min_u32 v5, v5, v9
    s_mov_b32 s53, 384
    v_mul_lo_u32 v5, v5, s53
    v_add_u32 v4, v4, v5
    v_lshl_add_u32 v222, v8, 4, v4
    v_mov_b32 v9, 1073741824
    v_cmp_gt_u32 vcc, 32, v1
    s_nop 1
    v_cndmask_b32 v222, v9, v222, vcc
    s_add_u32 m0, s54, 4096
    s_nop 0
    buffer_load_dwordx4 v222, s[24:27], s69 offen nt lds
    s_waitcnt vmcnt(45)
    v_lshlrev_b32 v23, 16, v23
    v_lshlrev_b32 v116, 16, v20
    v_and_b32 v120, 0xffff0000, v20
    v_mov_b32 v112, 0
    v_lshlrev_b32 v117, 16, v21
    v_and_b32 v121, 0xffff0000, v21
    v_mov_b32 v113, 0
    v_lshlrev_b32 v118, 16, v22
    v_and_b32 v122, 0xffff0000, v22
    v_mov_b32 v114, 0
    v_lshlrev_b32 v4, 16, v24
    v_and_b32 v5, 0xffff0000, v24
    v_lshlrev_b32 v6, 16, v32
    v_and_b32 v7, 0xffff0000, v32
    v_readlane_b32 s75, v23, 0
    v_readlane_b32 s76, v23, 1
    v_mul_f32 v8, v116, v4
    v_mul_f32 v9, v116, v5
    v_fmac_f32 v8, v120, v6
    v_fmac_f32 v9, v120, v7
    v_max_f32 v8, 0, v8
    v_max_f32 v9, 0, v9
    v_cvt_pk_bf16_f32 v8, v8, v9
    v_and_b32 v9, 0xffff0000, v8
    v_lshlrev_b32 v8, 16, v8
    v_fmac_f32 v112, s75, v8
    v_fmac_f32 v112, s76, v9
    v_mul_f32 v8, v117, v4
    v_mul_f32 v9, v117, v5
    v_fmac_f32 v8, v121, v6
    v_fmac_f32 v9, v121, v7
    v_max_f32 v8, 0, v8
    v_max_f32 v9, 0, v9
    v_cvt_pk_bf16_f32 v8, v8, v9
    v_and_b32 v9, 0xffff0000, v8
    v_lshlrev_b32 v8, 16, v8
    v_fmac_f32 v113, s75, v8
    v_fmac_f32 v113, s76, v9
    v_mul_f32 v8, v118, v4
    v_mul_f32 v9, v118, v5
    v_fmac_f32 v8, v122, v6
    v_fmac_f32 v9, v122, v7
    v_max_f32 v8, 0, v8
    v_max_f32 v9, 0, v9
    v_cvt_pk_bf16_f32 v8, v8, v9
    v_and_b32 v9, 0xffff0000, v8
    v_lshlrev_b32 v8, 16, v8
    v_fmac_f32 v114, s75, v8
    v_fmac_f32 v114, s76, v9
    v_lshlrev_b32 v4, 16, v25
    v_and_b32 v5, 0xffff0000, v25
    v_lshlrev_b32 v6, 16, v33
    v_and_b32 v7, 0xffff0000, v33
    v_readlane_b32 s75, v23, 2
    v_readlane_b32 s76, v23, 3
    v_mul_f32 v8, v116, v4
    v_mul_f32 v9, v116, v5
    v_fmac_f32 v8, v120, v6
    v_fmac_f32 v9, v120, v7
    v_max_f32 v8, 0, v8
    v_max_f32 v9, 0, v9
    v_cvt_pk_bf16_f32 v8, v8, v9
    v_and_b32 v9, 0xffff0000, v8
    v_lshlrev_b32 v8, 16, v8
    v_fmac_f32 v112, s75, v8
    v_fmac_f32 v112, s76, v9
    v_mul_f32 v8, v117, v4
    v_mul_f32 v9, v117, v5
    v_fmac_f32 v8, v121, v6
    v_fmac_f32 v9, v121, v7
    v_max_f32 v8, 0, v8
    v_max_f32 v9, 0, v9
    v_cvt_pk_bf16_f32 v8, v8, v9
    v_and_b32 v9, 0xffff0000, v8
    v_lshlrev_b32 v8, 16, v8
    v_fmac_f32 v113, s75, v8
    v_fmac_f32 v113, s76, v9
    v_mul_f32 v8, v118, v4
    v_mul_f32 v9, v118, v5
    v_fmac_f32 v8, v122, v6
    v_fmac_f32 v9, v122, v7
    v_max_f32 v8, 0, v8
    v_max_f32 v9, 0, v9
    v_cvt_pk_bf16_f32 v8, v8, v9
    v_and_b32 v9, 0xffff0000, v8
    v_lshlrev_b32 v8, 16, v8
    v_fmac_f32 v114, s75, v8
    v_fmac_f32 v114, s76, v9
    v_lshlrev_b32 v4, 16, v26
    v_and_b32 v5, 0xffff0000, v26
    v_lshlrev_b32 v6, 16, v34
    v_and_b32 v7, 0xffff0000, v34
    v_readlane_b32 s75, v23, 4
    v_readlane_b32 s76, v23, 5
    v_mul_f32 v8, v116, v4
    v_mul_f32 v9, v116, v5
    v_fmac_f32 v8, v120, v6
    v_fmac_f32 v9, v120, v7
    v_max_f32 v8, 0, v8
    v_max_f32 v9, 0, v9
    v_cvt_pk_bf16_f32 v8, v8, v9
    v_and_b32 v9, 0xffff0000, v8
    v_lshlrev_b32 v8, 16, v8
    v_fmac_f32 v112, s75, v8
    v_fmac_f32 v112, s76, v9
    v_mul_f32 v8, v117, v4
    v_mul_f32 v9, v117, v5
    v_fmac_f32 v8, v121, v6
    v_fmac_f32 v9, v121, v7
    v_max_f32 v8, 0, v8
    v_max_f32 v9, 0, v9
    v_cvt_pk_bf16_f32 v8, v8, v9
    v_and_b32 v9, 0xffff0000, v8
    v_lshlrev_b32 v8, 16, v8
    v_fmac_f32 v113, s75, v8
    v_fmac_f32 v113, s76, v9
    v_mul_f32 v8, v118, v4
    v_mul_f32 v9, v118, v5
    v_fmac_f32 v8, v122, v6
    v_fmac_f32 v9, v122, v7
    v_max_f32 v8, 0, v8
    v_max_f32 v9, 0, v9
    v_cvt_pk_bf16_f32 v8, v8, v9
    v_and_b32 v9, 0xffff0000, v8
    v_lshlrev_b32 v8, 16, v8
    v_fmac_f32 v114, s75, v8
    v_fmac_f32 v114, s76, v9
    v_lshlrev_b32 v4, 16, v27
    v_and_b32 v5, 0xffff0000, v27
    v_lshlrev_b32 v6, 16, v35
    v_and_b32 v7, 0xffff0000, v35
    v_readlane_b32 s75, v23, 6
    v_readlane_b32 s76, v23, 7
    v_mul_f32 v8, v116, v4
    v_mul_f32 v9, v116, v5
    v_fmac_f32 v8, v120, v6
    v_fmac_f32 v9, v120, v7
    v_max_f32 v8, 0, v8
    v_max_f32 v9, 0, v9
    v_cvt_pk_bf16_f32 v8, v8, v9
    v_and_b32 v9, 0xffff0000, v8
    v_lshlrev_b32 v8, 16, v8
    v_fmac_f32 v112, s75, v8
    v_fmac_f32 v112, s76, v9
    v_mul_f32 v8, v117, v4
    v_mul_f32 v9, v117, v5
    v_fmac_f32 v8, v121, v6
    v_fmac_f32 v9, v121, v7
    v_max_f32 v8, 0, v8
    v_max_f32 v9, 0, v9
    v_cvt_pk_bf16_f32 v8, v8, v9
    v_and_b32 v9, 0xffff0000, v8
    v_lshlrev_b32 v8, 16, v8
    v_fmac_f32 v113, s75, v8
    v_fmac_f32 v113, s76, v9
    v_mul_f32 v8, v118, v4
    v_mul_f32 v9, v118, v5
    v_fmac_f32 v8, v122, v6
    v_fmac_f32 v9, v122, v7
    v_max_f32 v8, 0, v8
    v_max_f32 v9, 0, v9
    v_cvt_pk_bf16_f32 v8, v8, v9
    v_and_b32 v9, 0xffff0000, v8
    v_lshlrev_b32 v8, 16, v8
    v_fmac_f32 v114, s75, v8
    v_fmac_f32 v114, s76, v9
    v_lshlrev_b32 v4, 16, v28
    v_and_b32 v5, 0xffff0000, v28
    v_lshlrev_b32 v6, 16, v36
    v_and_b32 v7, 0xffff0000, v36
    v_readlane_b32 s75, v23, 8
    v_readlane_b32 s76, v23, 9
    v_mul_f32 v8, v116, v4
    v_mul_f32 v9, v116, v5
    v_fmac_f32 v8, v120, v6
    v_fmac_f32 v9, v120, v7
    v_max_f32 v8, 0, v8
    v_max_f32 v9, 0, v9
    v_cvt_pk_bf16_f32 v8, v8, v9
    v_and_b32 v9, 0xffff0000, v8
    v_lshlrev_b32 v8, 16, v8
    v_fmac_f32 v112, s75, v8
    v_fmac_f32 v112, s76, v9
    v_mul_f32 v8, v117, v4
    v_mul_f32 v9, v117, v5
    v_fmac_f32 v8, v121, v6
    v_fmac_f32 v9, v121, v7
    v_max_f32 v8, 0, v8
    v_max_f32 v9, 0, v9
    v_cvt_pk_bf16_f32 v8, v8, v9
    v_and_b32 v9, 0xffff0000, v8
    v_lshlrev_b32 v8, 16, v8
    v_fmac_f32 v113, s75, v8
    v_fmac_f32 v113, s76, v9
    v_mul_f32 v8, v118, v4
    v_mul_f32 v9, v118, v5
    v_fmac_f32 v8, v122, v6
    v_fmac_f32 v9, v122, v7
    v_max_f32 v8, 0, v8
    v_max_f32 v9, 0, v9
    v_cvt_pk_bf16_f32 v8, v8, v9
    v_and_b32 v9, 0xffff0000, v8
    v_lshlrev_b32 v8, 16, v8
    v_fmac_f32 v114, s75, v8
    v_fmac_f32 v114, s76, v9
    v_lshlrev_b32 v4, 16, v29
    v_and_b32 v5, 0xffff0000, v29
    v_lshlrev_b32 v6, 16, v37
    v_and_b32 v7, 0xffff0000, v37
    v_readlane_b32 s75, v23, 10
    v_readlane_b32 s76, v23, 11
    v_mul_f32 v8, v116, v4
    v_mul_f32 v9, v116, v5
    v_fmac_f32 v8, v120, v6
    v_fmac_f32 v9, v120, v7
    v_max_f32 v8, 0, v8
    v_max_f32 v9, 0, v9
    v_cvt_pk_bf16_f32 v8, v8, v9
    v_and_b32 v9, 0xffff0000, v8
    v_lshlrev_b32 v8, 16, v8
    v_fmac_f32 v112, s75, v8
    v_fmac_f32 v112, s76, v9
    v_mul_f32 v8, v117, v4
    v_mul_f32 v9, v117, v5
    v_fmac_f32 v8, v121, v6
    v_fmac_f32 v9, v121, v7
    v_max_f32 v8, 0, v8
    v_max_f32 v9, 0, v9
    v_cvt_pk_bf16_f32 v8, v8, v9
    v_and_b32 v9, 0xffff0000, v8
    v_lshlrev_b32 v8, 16, v8
    v_fmac_f32 v113, s75, v8
    v_fmac_f32 v113, s76, v9
    v_mul_f32 v8, v118, v4
    v_mul_f32 v9, v118, v5
    v_fmac_f32 v8, v122, v6
    v_fmac_f32 v9, v122, v7
    v_max_f32 v8, 0, v8
    v_max_f32 v9, 0, v9
    v_cvt_pk_bf16_f32 v8, v8, v9
    v_and_b32 v9, 0xffff0000, v8
    v_lshlrev_b32 v8, 16, v8
    v_fmac_f32 v114, s75, v8
    v_fmac_f32 v114, s76, v9
    v_lshlrev_b32 v4, 16, v30
    v_and_b32 v5, 0xffff0000, v30
    v_lshlrev_b32 v6, 16, v38
    v_and_b32 v7, 0xffff0000, v38
    v_readlane_b32 s75, v23, 12
    v_readlane_b32 s76, v23, 13
    v_mul_f32 v8, v116, v4
    v_mul_f32 v9, v116, v5
    v_fmac_f32 v8, v120, v6
    v_fmac_f32 v9, v120, v7
    v_max_f32 v8, 0, v8
    v_max_f32 v9, 0, v9
    v_cvt_pk_bf16_f32 v8, v8, v9
    v_and_b32 v9, 0xffff0000, v8
    v_lshlrev_b32 v8, 16, v8
    v_fmac_f32 v112, s75, v8
    v_fmac_f32 v112, s76, v9
    v_mul_f32 v8, v117, v4
    v_mul_f32 v9, v117, v5
    v_fmac_f32 v8, v121, v6
    v_fmac_f32 v9, v121, v7
    v_max_f32 v8, 0, v8
    v_max_f32 v9, 0, v9
    v_cvt_pk_bf16_f32 v8, v8, v9
    v_and_b32 v9, 0xffff0000, v8
    v_lshlrev_b32 v8, 16, v8
    v_fmac_f32 v113, s75, v8
    v_fmac_f32 v113, s76, v9
    v_mul_f32 v8, v118, v4
    v_mul_f32 v9, v118, v5
    v_fmac_f32 v8, v122, v6
    v_fmac_f32 v9, v122, v7
    v_max_f32 v8, 0, v8
    v_max_f32 v9, 0, v9
    v_cvt_pk_bf16_f32 v8, v8, v9
    v_and_b32 v9, 0xffff0000, v8
    v_lshlrev_b32 v8, 16, v8
    v_fmac_f32 v114, s75, v8
    v_fmac_f32 v114, s76, v9
    v_lshlrev_b32 v4, 16, v31
    v_and_b32 v5, 0xffff0000, v31
    v_lshlrev_b32 v6, 16, v39
    v_and_b32 v7, 0xffff0000, v39
    v_readlane_b32 s75, v23, 14
    v_readlane_b32 s76, v23, 15
    v_mul_f32 v8, v116, v4
    v_mul_f32 v9, v116, v5
    v_fmac_f32 v8, v120, v6
    v_fmac_f32 v9, v120, v7
    v_max_f32 v8, 0, v8
    v_max_f32 v9, 0, v9
    v_cvt_pk_bf16_f32 v8, v8, v9
    v_and_b32 v9, 0xffff0000, v8
    v_lshlrev_b32 v8, 16, v8
    v_fmac_f32 v112, s75, v8
    v_fmac_f32 v112, s76, v9
    v_mul_f32 v8, v117, v4
    v_mul_f32 v9, v117, v5
    v_fmac_f32 v8, v121, v6
    v_fmac_f32 v9, v121, v7
    v_max_f32 v8, 0, v8
    v_max_f32 v9, 0, v9
    v_cvt_pk_bf16_f32 v8, v8, v9
    v_and_b32 v9, 0xffff0000, v8
    v_lshlrev_b32 v8, 16, v8
    v_fmac_f32 v113, s75, v8
    v_fmac_f32 v113, s76, v9
    v_mul_f32 v8, v118, v4
    v_mul_f32 v9, v118, v5
    v_fmac_f32 v8, v122, v6
    v_fmac_f32 v9, v122, v7
    v_max_f32 v8, 0, v8
    v_max_f32 v9, 0, v9
    v_cvt_pk_bf16_f32 v8, v8, v9
    v_and_b32 v9, 0xffff0000, v8
    v_lshlrev_b32 v8, 16, v8
    v_fmac_f32 v114, s75, v8
    v_fmac_f32 v114, s76, v9
    s_mul_i32 s75, s68, 768
    s_add_u32 s75, s75, 159744
    v_lshl_add_u32 v4, v1, 2, s75
    s_mov_b32 s76, 0x41b8aa3b
    v_mov_b32 v5, 0xc138aa3b
    v_cvt_pk_bf16_f32 v112, v112, v112
    v_lshlrev_b32 v112, 16, v112
    v_mul_f32 v112, 0xbfb8aa3b, v112
    v_exp_f32 v112, v112
    s_nop 0
    v_add_f32 v112, 1.0, v112
    v_rcp_f32 v112, v112
    s_nop 0
    v_cvt_pk_bf16_f32 v112, v112, v112
    v_lshlrev_b32 v112, 16, v112
    v_fma_f32 v112, v112, s76, v5
    ds_write_b32 v4, v112 offset:0
    v_cvt_pk_bf16_f32 v113, v113, v113
    v_lshlrev_b32 v113, 16, v113
    v_mul_f32 v113, 0xbfb8aa3b, v113
    v_exp_f32 v113, v113
    s_nop 0
    v_add_f32 v113, 1.0, v113
    v_rcp_f32 v113, v113
    s_nop 0
    v_cvt_pk_bf16_f32 v113, v113, v113
    v_lshlrev_b32 v113, 16, v113
    v_fma_f32 v113, v113, s76, v5
    ds_write_b32 v4, v113 offset:256
    v_cvt_pk_bf16_f32 v114, v114, v114
    v_lshlrev_b32 v114, 16, v114
    v_mul_f32 v114, 0xbfb8aa3b, v114
    v_exp_f32 v114, v114
    s_nop 0
    v_add_f32 v114, 1.0, v114
    v_rcp_f32 v114, v114
    s_nop 0
    v_cvt_pk_bf16_f32 v114, v114, v114
    v_lshlrev_b32 v114, 16, v114
    v_fma_f32 v114, v114, s76, v5
    ds_write_b32 v4, v114 offset:512
    s_waitcnt vmcnt(44)
    v_lshl_add_u32 v60, v60, 2, s75
    v_lshl_add_u32 v61, v61, 2, s75
    v_lshl_add_u32 v62, v62, 2, s75
    v_lshl_add_u32 v63, v63, 2, s75
    s_waitcnt vmcnt(43)
    v_lshl_add_u32 v64, v64, 2, s75
    v_lshl_add_u32 v65, v65, 2, s75
    v_lshl_add_u32 v66, v66, 2, s75
    v_lshl_add_u32 v67, v67, 2, s75
    s_waitcnt vmcnt(42)
    v_lshl_add_u32 v68, v68, 2, s75
    v_lshl_add_u32 v69, v69, 2, s75
    v_lshl_add_u32 v70, v70, 2, s75
    v_lshl_add_u32 v71, v71, 2, s75
    s_waitcnt vmcnt(40)
    v_lshl_add_u32 v72, v72, 2, s75
    v_lshl_add_u32 v73, v73, 2, s75
    v_lshl_add_u32 v74, v74, 2, s75
    v_lshl_add_u32 v75, v75, 2, s75
    s_waitcnt vmcnt(39)
    v_lshl_add_u32 v76, v76, 2, s75
    v_lshl_add_u32 v77, v77, 2, s75
    v_lshl_add_u32 v78, v78, 2, s75
    v_lshl_add_u32 v79, v79, 2, s75
    s_waitcnt vmcnt(38)
    v_lshl_add_u32 v80, v80, 2, s75
    v_lshl_add_u32 v81, v81, 2, s75
    v_lshl_add_u32 v82, v82, 2, s75
    v_lshl_add_u32 v83, v83, 2, s75
    s_waitcnt vmcnt(36)
    v_lshl_add_u32 v84, v84, 2, s75
    v_lshl_add_u32 v85, v85, 2, s75
    v_lshl_add_u32 v86, v86, 2, s75
    v_lshl_add_u32 v87, v87, 2, s75
    s_waitcnt vmcnt(35)
    v_lshl_add_u32 v88, v88, 2, s75
    v_lshl_add_u32 v89, v89, 2, s75
    v_lshl_add_u32 v90, v90, 2, s75
    v_lshl_add_u32 v91, v91, 2, s75
    s_waitcnt vmcnt(34)
    v_lshl_add_u32 v92, v92, 2, s75
    v_lshl_add_u32 v93, v93, 2, s75
    v_lshl_add_u32 v94, v94, 2, s75
    v_lshl_add_u32 v95, v95, 2, s75
    v_lshl_add_u32 v96, v96, 2, s75
    v_lshl_add_u32 v97, v97, 2, s75
    s_waitcnt vmcnt(33)
    v_lshl_add_u32 v98, v98, 2, s75
    s_waitcnt vmcnt(32)
    v_lshl_add_u32 v99, v99, 2, s75
    ds_read_b32 v60, v60
    ds_read_b32 v61, v61
    ds_read_b32 v62, v62
    ds_read_b32 v63, v63
    ds_read_b32 v64, v64
    ds_read_b32 v65, v65
    ds_read_b32 v66, v66
    ds_read_b32 v67, v67
    s_waitcnt lgkmcnt(4)
    ds_read_b32 v68, v68
    ds_read_b32 v69, v69
    ds_read_b32 v70, v70
    ds_read_b32 v71, v71
    ds_read_b32 v72, v72
    ds_read_b32 v73, v73
    ds_read_b32 v74, v74
    ds_read_b32 v75, v75
    s_waitcnt lgkmcnt(4)
    ds_read_b32 v76, v76
    ds_read_b32 v77, v77
    ds_read_b32 v78, v78
    ds_read_b32 v79, v79
    ds_read_b32 v80, v80
    ds_read_b32 v81, v81
    ds_read_b32 v82, v82
    ds_read_b32 v83, v83
    s_waitcnt lgkmcnt(4)
    ds_read_b32 v84, v84
    ds_read_b32 v85, v85
    ds_read_b32 v86, v86
    ds_read_b32 v87, v87
    ds_read_b32 v88, v88
    ds_read_b32 v89, v89
    ds_read_b32 v90, v90
    ds_read_b32 v91, v91
    s_waitcnt lgkmcnt(4)
    ds_read_b32 v92, v92
    ds_read_b32 v93, v93
    ds_read_b32 v94, v94
    ds_read_b32 v95, v95
    ds_read_b32 v96, v96
    ds_read_b32 v97, v97
    ds_read_b32 v98, v98
    ds_read_b32 v99, v99
    s_waitcnt lgkmcnt(4)
    s_waitcnt lgkmcnt(0)
    s_lshl_b32 s75, s68, 4
    s_lshr_b64 s[82:83], s[82:83], s75
    s_lshl_b32 s82, s82, 16
    v_mov_b32 v4, s82
    v_min_f32 v4, 0x40930000, v4
    v_max_f32 v4, 0xc2c80000, v4
    v_mul_f32 v4, 0x3fb8aa3b, v4
    v_exp_f32 v4, v4
    s_nop 0
    v_cvt_pk_bf16_f32 v4, v4, v4
    v_lshlrev_b32 v4, 16, v4
    v_mul_f32 v4, 0x3fb8aa3b, v4
    s_nop 0
    v_readfirstlane_b32 s40, v4
    s_mov_b32 s41, 0x2a8cbccc
    s_mov_b32 s42, 0x38fba882
    s_mov_b32 s43, 0x415db3d7
    s_cmp_lt_u32 s2, 247
    s_cbranch_scc1 L_nomask
    s_add_u32 s20, s20, s74
    s_addc_u32 s21, s21, 0
    s_mov_b32 s75, 0x3fb8aa3b
    s_waitcnt vmcnt(0)
    v_lshlrev_b32 v4, 1, v100
    global_load_ushort v124, v4, s[20:21] offset:0
    global_load_ushort v125, v4, s[20:21] offset:2
    global_load_ushort v126, v4, s[20:21] offset:4
    global_load_ushort v127, v4, s[20:21] offset:6
    global_load_ushort v128, v4, s[20:21] offset:8
    global_load_ushort v129, v4, s[20:21] offset:10
    global_load_ushort v130, v4, s[20:21] offset:12
    global_load_ushort v131, v4, s[20:21] offset:14
    global_load_ushort v132, v4, s[20:21] offset:16
    global_load_ushort v133, v4, s[20:21] offset:18
    global_load_ushort v134, v4, s[20:21] offset:20
    global_load_ushort v135, v4, s[20:21] offset:22
    v_lshlrev_b32 v4, 1, v101
    global_load_ushort v136, v4, s[20:21] offset:0
    global_load_ushort v137, v4, s[20:21] offset:2
    global_load_ushort v138, v4, s[20:21] offset:4
    global_load_ushort v139, v4, s[20:21] offset:6
    global_load_ushort v140, v4, s[20:21] offset:8
    global_load_ushort v141, v4, s[20:21] offset:10
    global_load_ushort v142, v4, s[20:21] offset:12
    global_load_ushort v143, v4, s[20:21] offset:14
    global_load_ushort v144, v4, s[20:21] offset:16
    global_load_ushort v145, v4, s[20:21] offset:18
    global_load_ushort v146, v4, s[20:21] offset:20
    global_load_ushort v147, v4, s[20:21] offset:22
    v_lshlrev_b32 v4, 1, v102
    global_load_ushort v148, v4, s[20:21] offset:0
    global_load_ushort v149, v4, s[20:21] offset:2
    global_load_ushort v150, v4, s[20:21] offset:4
    global_load_ushort v151, v4, s[20:21] offset:6
    global_load_ushort v152, v4, s[20:21] offset:8
    global_load_ushort v153, v4, s[20:21] offset:10
    global_load_ushort v154, v4, s[20:21] offset:12
    global_load_ushort v155, v4, s[20:21] offset:14
    global_load_ushort v156, v4, s[20:21] offset:16
    global_load_ushort v157, v4, s[20:21] offset:18
    global_load_ushort v158, v4, s[20:21] offset:20
    global_load_ushort v159, v4, s[20:21] offset:22
    v_lshlrev_b32 v4, 1, v104
    global_load_ushort v160, v4, s[20:21]
    v_lshlrev_b32 v4, 1, v105
    global_load_ushort v161, v4, s[20:21]
    v_lshlrev_b32 v4, 1, v106
    global_load_ushort v162, v4, s[20:21]
    v_lshlrev_b32 v4, 1, v107
    global_load_ushort v163, v4, s[20:21]
    s_waitcnt vmcnt(0)
    v_lshlrev_b32 v4, 16, v124
    v_fmac_f32 v60, s75, v4
    v_lshlrev_b32 v4, 16, v125
    v_fmac_f32 v61, s75, v4
    v_lshlrev_b32 v4, 16, v126
    v_fmac_f32 v62, s75, v4
    v_lshlrev_b32 v4, 16, v127
    v_fmac_f32 v63, s75, v4
    v_lshlrev_b32 v4, 16, v128
    v_fmac_f32 v64, s75, v4
    v_lshlrev_b32 v4, 16, v129
    v_fmac_f32 v65, s75, v4
    v_lshlrev_b32 v4, 16, v130
    v_fmac_f32 v66, s75, v4
    v_lshlrev_b32 v4, 16, v131
    v_fmac_f32 v67, s75, v4
    v_lshlrev_b32 v4, 16, v132
    v_fmac_f32 v68, s75, v4
    v_lshlrev_b32 v4, 16, v133
    v_fmac_f32 v69, s75, v4
    v_lshlrev_b32 v4, 16, v134
    v_fmac_f32 v70, s75, v4
    v_lshlrev_b32 v4, 16, v135
    v_fmac_f32 v71, s75, v4
    v_lshlrev_b32 v4, 16, v136
    v_fmac_f32 v72, s75, v4
    v_lshlrev_b32 v4, 16, v137
    v_fmac_f32 v73, s75, v4
    v_lshlrev_b32 v4, 16, v138
    v_fmac_f32 v74, s75, v4
    v_lshlrev_b32 v4, 16, v139
    v_fmac_f32 v75, s75, v4
    v_lshlrev_b32 v4, 16, v140
    v_fmac_f32 v76, s75, v4
    v_lshlrev_b32 v4, 16, v141
    v_fmac_f32 v77, s75, v4
    v_lshlrev_b32 v4, 16, v142
    v_fmac_f32 v78, s75, v4
    v_lshlrev_b32 v4, 16, v143
    v_fmac_f32 v79, s75, v4
    v_lshlrev_b32 v4, 16, v144
    v_fmac_f32 v80, s75, v4
    v_lshlrev_b32 v4, 16, v145
    v_fmac_f32 v81, s75, v4
    v_lshlrev_b32 v4, 16, v146
    v_fmac_f32 v82, s75, v4
    v_lshlrev_b32 v4, 16, v147
    v_fmac_f32 v83, s75, v4
    v_lshlrev_b32 v4, 16, v148
    v_fmac_f32 v84, s75, v4
    v_lshlrev_b32 v4, 16, v149
    v_fmac_f32 v85, s75, v4
    v_lshlrev_b32 v4, 16, v150
    v_fmac_f32 v86, s75, v4
    v_lshlrev_b32 v4, 16, v151
    v_fmac_f32 v87, s75, v4
    v_lshlrev_b32 v4, 16, v152
    v_fmac_f32 v88, s75, v4
    v_lshlrev_b32 v4, 16, v153
    v_fmac_f32 v89, s75, v4
    v_lshlrev_b32 v4, 16, v154
    v_fmac_f32 v90, s75, v4
    v_lshlrev_b32 v4, 16, v155
    v_fmac_f32 v91, s75, v4
    v_lshlrev_b32 v4, 16, v156
    v_fmac_f32 v92, s75, v4
    v_lshlrev_b32 v4, 16, v157
    v_fmac_f32 v93, s75, v4
    v_lshlrev_b32 v4, 16, v158
    v_fmac_f32 v94, s75, v4
    v_lshlrev_b32 v4, 16, v159
    v_fmac_f32 v95, s75, v4
    v_lshlrev_b32 v4, 16, v160
    v_fmac_f32 v96, s75, v4
    v_lshlrev_b32 v4, 16, v161
    v_fmac_f32 v97, s75, v4
    v_lshlrev_b32 v4, 16, v162
    v_fmac_f32 v98, s75, v4
    v_lshlrev_b32 v4, 16, v163
    v_fmac_f32 v99, s75, v4
L_nomask:
    v_mov_b32 v4, 0xf149f2ca
    v_cmp_gt_u32 vcc, 16, v1
    s_nop 1
    v_cndmask_b32 v204, v4, v96, vcc
    v_cndmask_b32 v205, v4, v97, vcc
    v_cndmask_b32 v206, v4, v98, vcc
    v_cmp_gt_u32 vcc, 49, v1
    s_nop 1
    v_cndmask_b32 v207, v4, v99, vcc
    v_mov_b32 v196, 0x3f803f80
    v_mov_b32 v197, 0x3f803f80
    v_mov_b32 v198, 0x3f803f80
    v_mov_b32 v199, 0x3f803f80
    v_and_b32 v4, 1, v1
    v_lshlrev_b32 v4, 4, v4
    v_mov_b32 v5, 0x3f80
    v_lshlrev_b32 v4, v4, v5
    v_and_b32 v5, 2, v1
    v_cmp_eq_u32 vcc, 0, v5
    s_nop 1
    v_cndmask_b32 v200, 0, v4, vcc
    v_cndmask_b32 v202, 0, v4, vcc
    v_cmp_ne_u32 vcc, 0, v5
    s_nop 1
    v_cndmask_b32 v201, 0, v4, vcc
    v_cndmask_b32 v203, 0, v4, vcc
    v_lshrrev_b32 v4, 2, v2
    v_lshl_add_u32 v4, v3, 3, v4
    v_mul_u32_u24 v4, 96, v4
    v_add_u32 v4, s80, v4
    v_and_b32 v5, 3, v2
    v_lshl_add_u32 v18, v5, 4, v4
    v_lshl_add_u32 v19, v5, 3, v4
    v_add_u32 v19, 64, v19
    v_lshrrev_b32 v4, 2, v2
    v_lshl_add_u32 v4, v4, 3, v5
    v_mul_u32_u24 v4, 96, v4
    v_lshl_add_u32 v20, v3, 4, v4
    v_lshl_add_u32 v21, v3, 3, v4
    v_add_u32 v21, 64, v21
    v_add_u32 v22, 49152, v18
    v_add_u32 v23, 49152, v19
    s_waitcnt vmcnt(14)
    s_barrier
    s_mul_i32 s75, s68, 3
    s_add_u32 s75, s75, 0
    s_lshr_b32 s76, s75, 2
    s_mul_i32 s76, s76, 24576
    s_bfe_u32 s77, s75, 0x10001
    s_mul_i32 s77, s77, 3072
    s_add_u32 s76, s76, s77
    s_and_b32 s77, s75, 1
    s_mul_i32 s77, s77, 384
    s_add_u32 s76, s76, s77
    s_add_u32 s76, s76, 61440
    v_add_u32 v4, s76, v20
    v_add_u32 v5, s76, v21
    ds_read_b128 v[24:27], v4 offset:0
    ds_read_b64 v[28:29], v5 offset:0
    ds_read_b128 v[30:33], v4 offset:6144
    ds_read_b64 v[34:35], v5 offset:6144
    ds_read_b128 v[36:39], v4 offset:12288
    ds_read_b64 v[40:41], v5 offset:12288
    ds_read_b128 v[42:45], v4 offset:18432
    ds_read_b64 v[46:47], v5 offset:18432
    s_waitcnt lgkmcnt(7)
    v_mfma_f32_16x16x32_bf16 v[48:51], v[24:27], v[196:199], 0
    s_waitcnt lgkmcnt(5)
    v_mfma_f32_16x16x32_bf16 v[48:51], v[30:33], v[196:199], v[48:51]
    s_waitcnt lgkmcnt(3)
    v_mfma_f32_16x16x32_bf16 v[48:51], v[36:39], v[196:199], v[48:51]
    s_waitcnt lgkmcnt(1)
    v_mfma_f32_16x16x32_bf16 v[48:51], v[42:45], v[196:199], v[48:51]
    s_nop 5
    v_mfma_f32_16x16x16_bf16 v[48:51], v[28:29], v[196:197], v[48:51]
    v_mfma_f32_16x16x16_bf16 v[48:51], v[34:35], v[196:197], v[48:51]
    v_mfma_f32_16x16x16_bf16 v[48:51], v[40:41], v[196:197], v[48:51]
    s_waitcnt lgkmcnt(0)
    v_mfma_f32_16x16x16_bf16 v[48:51], v[46:47], v[196:197], v[48:51]
    ds_read_b64_tr_b16 v[100:101], v18 offset:0
    ds_read_b64_tr_b16 v[102:103], v18 offset:384
    ds_read_b64_tr_b16 v[124:125], v18 offset:8
    ds_read_b64_tr_b16 v[126:127], v18 offset:392
    ds_read_b64_tr_b16 v[148:149], v19 offset:0
    ds_read_b64_tr_b16 v[150:151], v19 offset:384
    ds_read_b64_tr_b16 v[104:105], v18 offset:3072
    ds_read_b64_tr_b16 v[106:107], v18 offset:3456
    ds_read_b64_tr_b16 v[128:129], v18 offset:3080
    ds_read_b64_tr_b16 v[130:131], v18 offset:3464
    ds_read_b64_tr_b16 v[152:153], v19 offset:3072
    ds_read_b64_tr_b16 v[154:155], v19 offset:3456
    v_mul_f32 v48, 0xbbaaaaab, v48
    v_mul_f32 v49, 0xbbaaaaab, v49
    v_mul_f32 v50, 0xbbaaaaab, v50
    v_mul_f32 v51, 0xbbaaaaab, v51
    s_lshl_b32 s75, s75, 6
    s_add_u32 s75, s75, 162816
    v_lshl_add_u32 v4, v3, 4, s75
    ds_write_b128 v4, v[48:51]
    s_mul_i32 s75, s68, 3
    s_add_u32 s75, s75, 1
    s_lshr_b32 s76, s75, 2
    s_mul_i32 s76, s76, 24576
    s_bfe_u32 s77, s75, 0x10001
    s_mul_i32 s77, s77, 3072
    s_add_u32 s76, s76, s77
    s_and_b32 s77, s75, 1
    s_mul_i32 s77, s77, 384
    s_add_u32 s76, s76, s77
    s_add_u32 s76, s76, 61440
    v_add_u32 v4, s76, v20
    v_add_u32 v5, s76, v21
    ds_read_b128 v[24:27], v4 offset:0
    ds_read_b64 v[28:29], v5 offset:0
    ds_read_b128 v[30:33], v4 offset:6144
    ds_read_b64 v[34:35], v5 offset:6144
    ds_read_b128 v[36:39], v4 offset:12288
    ds_read_b64 v[40:41], v5 offset:12288
    ds_read_b128 v[42:45], v4 offset:18432
    ds_read_b64 v[46:47], v5 offset:18432
    s_waitcnt lgkmcnt(7)
    v_mfma_f32_16x16x32_bf16 v[48:51], v[24:27], v[196:199], 0
    s_waitcnt lgkmcnt(5)
    v_mfma_f32_16x16x32_bf16 v[48:51], v[30:33], v[196:199], v[48:51]
    s_waitcnt lgkmcnt(3)
    v_mfma_f32_16x16x32_bf16 v[48:51], v[36:39], v[196:199], v[48:51]
    s_waitcnt lgkmcnt(1)
    v_mfma_f32_16x16x32_bf16 v[48:51], v[42:45], v[196:199], v[48:51]
    s_nop 5
    v_mfma_f32_16x16x16_bf16 v[48:51], v[28:29], v[196:197], v[48:51]
    v_mfma_f32_16x16x16_bf16 v[48:51], v[34:35], v[196:197], v[48:51]
    v_mfma_f32_16x16x16_bf16 v[48:51], v[40:41], v[196:197], v[48:51]
    s_waitcnt lgkmcnt(0)
    v_mfma_f32_16x16x16_bf16 v[48:51], v[46:47], v[196:197], v[48:51]
    ds_read_b64_tr_b16 v[108:109], v18 offset:24576
    ds_read_b64_tr_b16 v[110:111], v18 offset:24960
    ds_read_b64_tr_b16 v[132:133], v18 offset:24584
    ds_read_b64_tr_b16 v[134:135], v18 offset:24968
    ds_read_b64_tr_b16 v[156:157], v19 offset:24576
    ds_read_b64_tr_b16 v[158:159], v19 offset:24960
    ds_read_b64_tr_b16 v[112:113], v18 offset:27648
    ds_read_b64_tr_b16 v[114:115], v18 offset:28032
    ds_read_b64_tr_b16 v[136:137], v18 offset:27656
    ds_read_b64_tr_b16 v[138:139], v18 offset:28040
    ds_read_b64_tr_b16 v[160:161], v19 offset:27648
    ds_read_b64_tr_b16 v[162:163], v19 offset:28032
    v_mul_f32 v48, 0xbbaaaaab, v48
    v_mul_f32 v49, 0xbbaaaaab, v49
    v_mul_f32 v50, 0xbbaaaaab, v50
    v_mul_f32 v51, 0xbbaaaaab, v51
    s_lshl_b32 s75, s75, 6
    s_add_u32 s75, s75, 162816
    v_lshl_add_u32 v4, v3, 4, s75
    ds_write_b128 v4, v[48:51]
    s_mul_i32 s75, s68, 3
    s_add_u32 s75, s75, 2
    s_lshr_b32 s76, s75, 2
    s_mul_i32 s76, s76, 24576
    s_bfe_u32 s77, s75, 0x10001
    s_mul_i32 s77, s77, 3072
    s_add_u32 s76, s76, s77
    s_and_b32 s77, s75, 1
    s_mul_i32 s77, s77, 384
    s_add_u32 s76, s76, s77
    s_add_u32 s76, s76, 61440
    v_add_u32 v4, s76, v20
    v_add_u32 v5, s76, v21
    ds_read_b128 v[24:27], v4 offset:0
    ds_read_b64 v[28:29], v5 offset:0
    ds_read_b128 v[30:33], v4 offset:6144
    ds_read_b64 v[34:35], v5 offset:6144
    ds_read_b128 v[36:39], v4 offset:12288
    ds_read_b64 v[40:41], v5 offset:12288
    ds_read_b128 v[42:45], v4 offset:18432
    ds_read_b64 v[46:47], v5 offset:18432
    s_waitcnt lgkmcnt(7)
    v_mfma_f32_16x16x32_bf16 v[48:51], v[24:27], v[196:199], 0
    s_waitcnt lgkmcnt(5)
    v_mfma_f32_16x16x32_bf16 v[48:51], v[30:33], v[196:199], v[48:51]
    s_waitcnt lgkmcnt(3)
    v_mfma_f32_16x16x32_bf16 v[48:51], v[36:39], v[196:199], v[48:51]
    s_waitcnt lgkmcnt(1)
    v_mfma_f32_16x16x32_bf16 v[48:51], v[42:45], v[196:199], v[48:51]
    s_nop 5
    v_mfma_f32_16x16x16_bf16 v[48:51], v[28:29], v[196:197], v[48:51]
    v_mfma_f32_16x16x16_bf16 v[48:51], v[34:35], v[196:197], v[48:51]
    v_mfma_f32_16x16x16_bf16 v[48:51], v[40:41], v[196:197], v[48:51]
    s_waitcnt lgkmcnt(0)
    v_mfma_f32_16x16x16_bf16 v[48:51], v[46:47], v[196:197], v[48:51]
    ds_read_b64_tr_b16 v[116:117], v22 offset:0
    ds_read_b64_tr_b16 v[118:119], v22 offset:384
    ds_read_b64_tr_b16 v[140:141], v22 offset:8
    ds_read_b64_tr_b16 v[142:143], v22 offset:392
    ds_read_b64_tr_b16 v[164:165], v23 offset:0
    ds_read_b64_tr_b16 v[166:167], v23 offset:384
    ds_read_b64_tr_b16 v[120:121], v22 offset:3072
    ds_read_b64_tr_b16 v[122:123], v22 offset:3456
    ds_read_b64_tr_b16 v[144:145], v22 offset:3080
    ds_read_b64_tr_b16 v[146:147], v22 offset:3464
    ds_read_b64_tr_b16 v[168:169], v23 offset:3072
    ds_read_b64_tr_b16 v[170:171], v23 offset:3456
    v_mul_f32 v48, 0xbbaaaaab, v48
    v_mul_f32 v49, 0xbbaaaaab, v49
    v_mul_f32 v50, 0xbbaaaaab, v50
    v_mul_f32 v51, 0xbbaaaaab, v51
    s_lshl_b32 s75, s75, 6
    s_add_u32 s75, s75, 162816
    v_lshl_add_u32 v4, v3, 4, s75
    ds_write_b128 v4, v[48:51]
    s_waitcnt lgkmcnt(0)
    s_barrier
    s_add_u32 m0, s80, 0
    s_mov_b32 s53, 73728
    buffer_load_dwordx4 v15, s[32:35], s53 offen lds
    s_add_u32 m0, s80, 1024
    s_mov_b32 s53, 73728
    buffer_load_dwordx4 v16, s[32:35], s53 offen lds
    s_add_u32 m0, s80, 2048
    s_mov_b32 s53, 73728
    buffer_load_dwordx4 v17, s[32:35], s53 offen lds
    s_add_u32 m0, s80, 3072
    s_mov_b32 s53, 110592
    buffer_load_dwordx4 v15, s[32:35], s53 offen lds
    s_add_u32 m0, s80, 4096
    s_mov_b32 s53, 110592
    buffer_load_dwordx4 v16, s[32:35], s53 offen lds
    s_add_u32 m0, s80, 5120
    s_mov_b32 s53, 110592
    buffer_load_dwordx4 v17, s[32:35], s53 offen lds
    s_add_u32 m0, s80, 24576
    s_mov_b32 s53, 147456
    buffer_load_dwordx4 v15, s[32:35], s53 offen lds
    s_add_u32 m0, s80, 25600
    s_mov_b32 s53, 147456
    buffer_load_dwordx4 v16, s[32:35], s53 offen lds
    s_add_u32 m0, s80, 26624
    s_mov_b32 s53, 147456
    buffer_load_dwordx4 v17, s[32:35], s53 offen lds
    s_add_u32 m0, s80, 27648
    s_mov_b32 s53, 184320
    buffer_load_dwordx4 v15, s[32:35], s53 offen lds
    s_add_u32 m0, s80, 28672
    s_mov_b32 s53, 184320
    buffer_load_dwordx4 v16, s[32:35], s53 offen lds
    s_add_u32 m0, s80, 29696
    s_mov_b32 s53, 184320
    buffer_load_dwordx4 v17, s[32:35], s53 offen lds
    s_add_u32 m0, s80, 49152
    s_mov_b32 s53, 384
    buffer_load_dwordx4 v15, s[32:35], s53 offen lds
    s_add_u32 m0, s80, 50176
    s_mov_b32 s53, 384
    buffer_load_dwordx4 v16, s[32:35], s53 offen lds
    s_add_u32 m0, s80, 51200
    s_mov_b32 s53, 384
    buffer_load_dwordx4 v17, s[32:35], s53 offen lds
    s_add_u32 m0, s80, 52224
    s_mov_b32 s53, 37248
    buffer_load_dwordx4 v15, s[32:35], s53 offen lds
    s_add_u32 m0, s80, 53248
    s_mov_b32 s53, 37248
    buffer_load_dwordx4 v16, s[32:35], s53 offen lds
    s_add_u32 m0, s80, 54272
    s_mov_b32 s53, 37248
    buffer_load_dwordx4 v17, s[32:35], s53 offen lds
    v_lshlrev_b32 v4, 4, v3
    v_add_u32 v59, 162816, v4
    s_waitcnt vmcnt(26)
    ds_read_b64_tr_b16 a[0:1], v22 offset:24576
    ds_read_b64_tr_b16 a[2:3], v22 offset:24960
    ds_read_b64_tr_b16 a[24:25], v22 offset:24584
    ds_read_b64_tr_b16 a[26:27], v22 offset:24968
    ds_read_b64_tr_b16 a[48:49], v23 offset:24576
    ds_read_b64_tr_b16 a[50:51], v23 offset:24960
    ds_read_b64_tr_b16 a[4:5], v22 offset:27648
    ds_read_b64_tr_b16 a[6:7], v22 offset:28032
    ds_read_b64_tr_b16 a[28:29], v22 offset:27656
    ds_read_b64_tr_b16 a[30:31], v22 offset:28040
    ds_read_b64_tr_b16 a[52:53], v23 offset:27648
    ds_read_b64_tr_b16 a[54:55], v23 offset:28032
    s_add_u32 m0, s80, 73728
    s_mov_b32 s53, 74112
    s_waitcnt lgkmcnt(0)
    buffer_load_dwordx4 v15, s[32:35], s53 offen lds
    s_add_u32 m0, s80, 74752
    s_mov_b32 s53, 74112
    buffer_load_dwordx4 v16, s[32:35], s53 offen lds
    s_add_u32 m0, s80, 75776
    s_mov_b32 s53, 74112
    buffer_load_dwordx4 v17, s[32:35], s53 offen lds
    s_add_u32 m0, s80, 76800
    s_mov_b32 s53, 110976
    buffer_load_dwordx4 v15, s[32:35], s53 offen lds
    s_add_u32 m0, s80, 77824
    s_mov_b32 s53, 110976
    buffer_load_dwordx4 v16, s[32:35], s53 offen lds
    s_add_u32 m0, s80, 78848
    s_mov_b32 s53, 110976
    buffer_load_dwordx4 v17, s[32:35], s53 offen lds
    ds_read_b128 v[24:27], v59 offset:0
    ds_read_b128 v[28:31], v59 offset:64
    v_lshlrev_b32 v4, 16, v100
    v_and_b32 v5, 0xffff0000, v100
    s_waitcnt lgkmcnt(1)
    v_add_f32 v4, v4, v24
    v_add_f32 v5, v5, v25
    v_cvt_pk_bf16_f32 v4, v4, v5
    v_accvgpr_write_b32 a216, v4
    v_lshlrev_b32 v4, 16, v101
    v_and_b32 v5, 0xffff0000, v101
    v_add_f32 v4, v4, v26
    v_add_f32 v5, v5, v27
    v_cvt_pk_bf16_f32 v4, v4, v5
    v_accvgpr_write_b32 a217, v4
    v_lshlrev_b32 v4, 16, v102
    v_and_b32 v5, 0xffff0000, v102
    s_waitcnt lgkmcnt(0)
    v_add_f32 v4, v4, v28
    v_add_f32 v5, v5, v29
    v_cvt_pk_bf16_f32 v4, v4, v5
    v_accvgpr_write_b32 a218, v4
    v_lshlrev_b32 v4, 16, v103
    v_and_b32 v5, 0xffff0000, v103
    v_add_f32 v4, v4, v30
    v_add_f32 v5, v5, v31
    v_cvt_pk_bf16_f32 v4, v4, v5
    v_accvgpr_write_b32 a219, v4
    v_lshlrev_b32 v4, 16, v124
    v_and_b32 v5, 0xffff0000, v124
    v_add_f32 v4, v4, v24
    v_add_f32 v5, v5, v25
    v_cvt_pk_bf16_f32 v4, v4, v5
    v_accvgpr_write_b32 a240, v4
    v_lshlrev_b32 v4, 16, v125
    v_and_b32 v5, 0xffff0000, v125
    v_add_f32 v4, v4, v26
    v_add_f32 v5, v5, v27
    v_cvt_pk_bf16_f32 v4, v4, v5
    v_accvgpr_write_b32 a241, v4
    v_lshlrev_b32 v4, 16, v126
    v_and_b32 v5, 0xffff0000, v126
    v_add_f32 v4, v4, v28
    v_add_f32 v5, v5, v29
    v_cvt_pk_bf16_f32 v4, v4, v5
    v_accvgpr_write_b32 a242, v4
    v_lshlrev_b32 v4, 16, v127
    v_and_b32 v5, 0xffff0000, v127
    v_add_f32 v4, v4, v30
    v_add_f32 v5, v5, v31
    v_cvt_pk_bf16_f32 v4, v4, v5
    v_accvgpr_write_b32 a243, v4
    v_lshlrev_b32 v4, 16, v148
    v_and_b32 v5, 0xffff0000, v148
    v_add_f32 v4, v4, v24
    v_add_f32 v5, v5, v25
    v_cvt_pk_bf16_f32 v232, v4, v5
    v_lshlrev_b32 v4, 16, v149
    v_and_b32 v5, 0xffff0000, v149
    v_add_f32 v4, v4, v26
    v_add_f32 v5, v5, v27
    v_cvt_pk_bf16_f32 v233, v4, v5
    v_lshlrev_b32 v4, 16, v150
    v_and_b32 v5, 0xffff0000, v150
    v_add_f32 v4, v4, v28
    v_add_f32 v5, v5, v29
    v_cvt_pk_bf16_f32 v234, v4, v5
    v_lshlrev_b32 v4, 16, v151
    v_and_b32 v5, 0xffff0000, v151
    v_add_f32 v4, v4, v30
    v_add_f32 v5, v5, v31
    v_cvt_pk_bf16_f32 v235, v4, v5
    s_waitcnt vmcnt(18)
    ds_read_b64_tr_b16 a[8:9], v18 offset:0
    ds_read_b64_tr_b16 a[10:11], v18 offset:384
    ds_read_b64_tr_b16 a[32:33], v18 offset:8
    ds_read_b64_tr_b16 a[34:35], v18 offset:392
    ds_read_b64_tr_b16 a[56:57], v19 offset:0
    ds_read_b64_tr_b16 a[58:59], v19 offset:384
    ds_read_b64_tr_b16 a[12:13], v18 offset:3072
    ds_read_b64_tr_b16 a[14:15], v18 offset:3456
    ds_read_b64_tr_b16 a[36:37], v18 offset:3080
    ds_read_b64_tr_b16 a[38:39], v18 offset:3464
    ds_read_b64_tr_b16 a[60:61], v19 offset:3072
    ds_read_b64_tr_b16 a[62:63], v19 offset:3456
    s_add_u32 m0, s80, 0
    s_mov_b32 s53, 147840
    s_waitcnt lgkmcnt(0)
    buffer_load_dwordx4 v15, s[32:35], s53 offen lds
    s_add_u32 m0, s80, 1024
    s_mov_b32 s53, 147840
    buffer_load_dwordx4 v16, s[32:35], s53 offen lds
    s_add_u32 m0, s80, 2048
    s_mov_b32 s53, 147840
    buffer_load_dwordx4 v17, s[32:35], s53 offen lds
    s_add_u32 m0, s80, 3072
    s_mov_b32 s53, 184704
    buffer_load_dwordx4 v15, s[32:35], s53 offen lds
    s_add_u32 m0, s80, 4096
    s_mov_b32 s53, 184704
    buffer_load_dwordx4 v16, s[32:35], s53 offen lds
    s_add_u32 m0, s80, 5120
    s_mov_b32 s53, 184704
    buffer_load_dwordx4 v17, s[32:35], s53 offen lds
    ds_read_b128 v[24:27], v59 offset:128
    ds_read_b128 v[28:31], v59 offset:192
    v_lshlrev_b32 v4, 16, v104
    v_and_b32 v5, 0xffff0000, v104
    s_waitcnt lgkmcnt(1)
    v_add_f32 v4, v4, v24
    v_add_f32 v5, v5, v25
    v_cvt_pk_bf16_f32 v4, v4, v5
    v_accvgpr_write_b32 a220, v4
    v_lshlrev_b32 v4, 16, v105
    v_and_b32 v5, 0xffff0000, v105
    v_add_f32 v4, v4, v26
    v_add_f32 v5, v5, v27
    v_cvt_pk_bf16_f32 v4, v4, v5
    v_accvgpr_write_b32 a221, v4
    v_lshlrev_b32 v4, 16, v106
    v_and_b32 v5, 0xffff0000, v106
    s_waitcnt lgkmcnt(0)
    v_add_f32 v4, v4, v28
    v_add_f32 v5, v5, v29
    v_cvt_pk_bf16_f32 v4, v4, v5
    v_accvgpr_write_b32 a222, v4
    v_lshlrev_b32 v4, 16, v107
    v_and_b32 v5, 0xffff0000, v107
    v_add_f32 v4, v4, v30
    v_add_f32 v5, v5, v31
    v_cvt_pk_bf16_f32 v4, v4, v5
    v_accvgpr_write_b32 a223, v4
    v_lshlrev_b32 v4, 16, v128
    v_and_b32 v5, 0xffff0000, v128
    v_add_f32 v4, v4, v24
    v_add_f32 v5, v5, v25
    v_cvt_pk_bf16_f32 v4, v4, v5
    v_accvgpr_write_b32 a244, v4
    v_lshlrev_b32 v4, 16, v129
    v_and_b32 v5, 0xffff0000, v129
    v_add_f32 v4, v4, v26
    v_add_f32 v5, v5, v27
    v_cvt_pk_bf16_f32 v4, v4, v5
    v_accvgpr_write_b32 a245, v4
    v_lshlrev_b32 v4, 16, v130
    v_and_b32 v5, 0xffff0000, v130
    v_add_f32 v4, v4, v28
    v_add_f32 v5, v5, v29
    v_cvt_pk_bf16_f32 v4, v4, v5
    v_accvgpr_write_b32 a246, v4
    v_lshlrev_b32 v4, 16, v131
    v_and_b32 v5, 0xffff0000, v131
    v_add_f32 v4, v4, v30
    v_add_f32 v5, v5, v31
    v_cvt_pk_bf16_f32 v4, v4, v5
    v_accvgpr_write_b32 a247, v4
    v_lshlrev_b32 v4, 16, v152
    v_and_b32 v5, 0xffff0000, v152
    v_add_f32 v4, v4, v24
    v_add_f32 v5, v5, v25
    v_cvt_pk_bf16_f32 v236, v4, v5
    v_lshlrev_b32 v4, 16, v153
    v_and_b32 v5, 0xffff0000, v153
    v_add_f32 v4, v4, v26
    v_add_f32 v5, v5, v27
    v_cvt_pk_bf16_f32 v237, v4, v5
    v_lshlrev_b32 v4, 16, v154
    v_and_b32 v5, 0xffff0000, v154
    v_add_f32 v4, v4, v28
    v_add_f32 v5, v5, v29
    v_cvt_pk_bf16_f32 v238, v4, v5
    v_lshlrev_b32 v4, 16, v155
    v_and_b32 v5, 0xffff0000, v155
    v_add_f32 v4, v4, v30
    v_add_f32 v5, v5, v31
    v_cvt_pk_bf16_f32 v239, v4, v5
    s_waitcnt vmcnt(18)
    ds_read_b64_tr_b16 a[16:17], v18 offset:24576
    ds_read_b64_tr_b16 a[18:19], v18 offset:24960
    ds_read_b64_tr_b16 a[40:41], v18 offset:24584
    ds_read_b64_tr_b16 a[42:43], v18 offset:24968
    ds_read_b64_tr_b16 a[64:65], v19 offset:24576
    ds_read_b64_tr_b16 a[66:67], v19 offset:24960
    ds_read_b64_tr_b16 a[20:21], v18 offset:27648
    ds_read_b64_tr_b16 a[22:23], v18 offset:28032
    ds_read_b64_tr_b16 a[44:45], v18 offset:27656
    ds_read_b64_tr_b16 a[46:47], v18 offset:28040
    ds_read_b64_tr_b16 a[68:69], v19 offset:27648
    ds_read_b64_tr_b16 a[70:71], v19 offset:28032
    s_add_u32 m0, s80, 24576
    s_mov_b32 s53, 768
    s_waitcnt lgkmcnt(0)
    buffer_load_dwordx4 v15, s[32:35], s53 offen lds
    s_add_u32 m0, s80, 25600
    s_mov_b32 s53, 768
    buffer_load_dwordx4 v16, s[32:35], s53 offen lds
    s_add_u32 m0, s80, 26624
    s_mov_b32 s53, 768
    buffer_load_dwordx4 v17, s[32:35], s53 offen lds
    s_add_u32 m0, s80, 27648
    s_mov_b32 s53, 37632
    buffer_load_dwordx4 v15, s[32:35], s53 offen lds
    s_add_u32 m0, s80, 28672
    s_mov_b32 s53, 37632
    buffer_load_dwordx4 v16, s[32:35], s53 offen lds
    s_add_u32 m0, s80, 29696
    s_mov_b32 s53, 37632
    buffer_load_dwordx4 v17, s[32:35], s53 offen lds
    ds_read_b128 v[24:27], v59 offset:256
    ds_read_b128 v[28:31], v59 offset:320
    v_lshlrev_b32 v4, 16, v108
    v_and_b32 v5, 0xffff0000, v108
    s_waitcnt lgkmcnt(1)
    v_add_f32 v4, v4, v24
    v_add_f32 v5, v5, v25
    v_cvt_pk_bf16_f32 v4, v4, v5
    v_accvgpr_write_b32 a224, v4
    v_lshlrev_b32 v4, 16, v109
    v_and_b32 v5, 0xffff0000, v109
    v_add_f32 v4, v4, v26
    v_add_f32 v5, v5, v27
    v_cvt_pk_bf16_f32 v4, v4, v5
    v_accvgpr_write_b32 a225, v4
    v_lshlrev_b32 v4, 16, v110
    v_and_b32 v5, 0xffff0000, v110
    s_waitcnt lgkmcnt(0)
    v_add_f32 v4, v4, v28
    v_add_f32 v5, v5, v29
    v_cvt_pk_bf16_f32 v4, v4, v5
    v_accvgpr_write_b32 a226, v4
    v_lshlrev_b32 v4, 16, v111
    v_and_b32 v5, 0xffff0000, v111
    v_add_f32 v4, v4, v30
    v_add_f32 v5, v5, v31
    v_cvt_pk_bf16_f32 v4, v4, v5
    v_accvgpr_write_b32 a227, v4
    v_lshlrev_b32 v4, 16, v132
    v_and_b32 v5, 0xffff0000, v132
    v_add_f32 v4, v4, v24
    v_add_f32 v5, v5, v25
    v_cvt_pk_bf16_f32 v4, v4, v5
    v_accvgpr_write_b32 a248, v4
    v_lshlrev_b32 v4, 16, v133
    v_and_b32 v5, 0xffff0000, v133
    v_add_f32 v4, v4, v26
    v_add_f32 v5, v5, v27
    v_cvt_pk_bf16_f32 v4, v4, v5
    v_accvgpr_write_b32 a249, v4
    v_lshlrev_b32 v4, 16, v134
    v_and_b32 v5, 0xffff0000, v134
    v_add_f32 v4, v4, v28
    v_add_f32 v5, v5, v29
    v_cvt_pk_bf16_f32 v4, v4, v5
    v_accvgpr_write_b32 a250, v4
    v_lshlrev_b32 v4, 16, v135
    v_and_b32 v5, 0xffff0000, v135
    v_add_f32 v4, v4, v30
    v_add_f32 v5, v5, v31
    v_cvt_pk_bf16_f32 v4, v4, v5
    v_accvgpr_write_b32 a251, v4
    v_lshlrev_b32 v4, 16, v156
    v_and_b32 v5, 0xffff0000, v156
    v_add_f32 v4, v4, v24
    v_add_f32 v5, v5, v25
    v_cvt_pk_bf16_f32 v240, v4, v5
    v_lshlrev_b32 v4, 16, v157
    v_and_b32 v5, 0xffff0000, v157
    v_add_f32 v4, v4, v26
    v_add_f32 v5, v5, v27
    v_cvt_pk_bf16_f32 v241, v4, v5
    v_lshlrev_b32 v4, 16, v158
    v_and_b32 v5, 0xffff0000, v158
    v_add_f32 v4, v4, v28
    v_add_f32 v5, v5, v29
    v_cvt_pk_bf16_f32 v242, v4, v5
    v_lshlrev_b32 v4, 16, v159
    v_and_b32 v5, 0xffff0000, v159
    v_add_f32 v4, v4, v30
    v_add_f32 v5, v5, v31
    v_cvt_pk_bf16_f32 v243, v4, v5
    s_waitcnt vmcnt(18)
    ds_read_b64_tr_b16 a[72:73], v22 offset:0
    ds_read_b64_tr_b16 a[74:75], v22 offset:384
    ds_read_b64_tr_b16 a[96:97], v22 offset:8
    ds_read_b64_tr_b16 a[98:99], v22 offset:392
    ds_read_b64_tr_b16 a[120:121], v23 offset:0
    ds_read_b64_tr_b16 a[122:123], v23 offset:384
    ds_read_b64_tr_b16 a[76:77], v22 offset:3072
    ds_read_b64_tr_b16 a[78:79], v22 offset:3456
    ds_read_b64_tr_b16 a[100:101], v22 offset:3080
    ds_read_b64_tr_b16 a[102:103], v22 offset:3464
    ds_read_b64_tr_b16 a[124:125], v23 offset:3072
    ds_read_b64_tr_b16 a[126:127], v23 offset:3456
    s_add_u32 m0, s80, 49152
    s_mov_b32 s53, 74496
    s_waitcnt lgkmcnt(0)
    buffer_load_dwordx4 v15, s[32:35], s53 offen lds
    s_add_u32 m0, s80, 50176
    s_mov_b32 s53, 74496
    buffer_load_dwordx4 v16, s[32:35], s53 offen lds
    s_add_u32 m0, s80, 51200
    s_mov_b32 s53, 74496
    buffer_load_dwordx4 v17, s[32:35], s53 offen lds
    s_add_u32 m0, s80, 52224
    s_mov_b32 s53, 111360
    buffer_load_dwordx4 v15, s[32:35], s53 offen lds
    s_add_u32 m0, s80, 53248
    s_mov_b32 s53, 111360
    buffer_load_dwordx4 v16, s[32:35], s53 offen lds
    s_add_u32 m0, s80, 54272
    s_mov_b32 s53, 111360
    buffer_load_dwordx4 v17, s[32:35], s53 offen lds
    ds_read_b128 v[24:27], v59 offset:384
    ds_read_b128 v[28:31], v59 offset:448
    v_lshlrev_b32 v4, 16, v112
    v_and_b32 v5, 0xffff0000, v112
    s_waitcnt lgkmcnt(1)
    v_add_f32 v4, v4, v24
    v_add_f32 v5, v5, v25
    v_cvt_pk_bf16_f32 v4, v4, v5
    v_accvgpr_write_b32 a228, v4
    v_lshlrev_b32 v4, 16, v113
    v_and_b32 v5, 0xffff0000, v113
    v_add_f32 v4, v4, v26
    v_add_f32 v5, v5, v27
    v_cvt_pk_bf16_f32 v4, v4, v5
    v_accvgpr_write_b32 a229, v4
    v_lshlrev_b32 v4, 16, v114
    v_and_b32 v5, 0xffff0000, v114
    s_waitcnt lgkmcnt(0)
    v_add_f32 v4, v4, v28
    v_add_f32 v5, v5, v29
    v_cvt_pk_bf16_f32 v4, v4, v5
    v_accvgpr_write_b32 a230, v4
    v_lshlrev_b32 v4, 16, v115
    v_and_b32 v5, 0xffff0000, v115
    v_add_f32 v4, v4, v30
    v_add_f32 v5, v5, v31
    v_cvt_pk_bf16_f32 v4, v4, v5
    v_accvgpr_write_b32 a231, v4
    v_lshlrev_b32 v4, 16, v136
    v_and_b32 v5, 0xffff0000, v136
    v_add_f32 v4, v4, v24
    v_add_f32 v5, v5, v25
    v_cvt_pk_bf16_f32 v4, v4, v5
    v_accvgpr_write_b32 a252, v4
    v_lshlrev_b32 v4, 16, v137
    v_and_b32 v5, 0xffff0000, v137
    v_add_f32 v4, v4, v26
    v_add_f32 v5, v5, v27
    v_cvt_pk_bf16_f32 v4, v4, v5
    v_accvgpr_write_b32 a253, v4
    v_lshlrev_b32 v4, 16, v138
    v_and_b32 v5, 0xffff0000, v138
    v_add_f32 v4, v4, v28
    v_add_f32 v5, v5, v29
    v_cvt_pk_bf16_f32 v4, v4, v5
    v_accvgpr_write_b32 a254, v4
    v_lshlrev_b32 v4, 16, v139
    v_and_b32 v5, 0xffff0000, v139
    v_add_f32 v4, v4, v30
    v_add_f32 v5, v5, v31
    v_cvt_pk_bf16_f32 v4, v4, v5
    v_accvgpr_write_b32 a255, v4
    v_lshlrev_b32 v4, 16, v160
    v_and_b32 v5, 0xffff0000, v160
    v_add_f32 v4, v4, v24
    v_add_f32 v5, v5, v25
    v_cvt_pk_bf16_f32 v244, v4, v5
    v_lshlrev_b32 v4, 16, v161
    v_and_b32 v5, 0xffff0000, v161
    v_add_f32 v4, v4, v26
    v_add_f32 v5, v5, v27
    v_cvt_pk_bf16_f32 v245, v4, v5
    v_lshlrev_b32 v4, 16, v162
    v_and_b32 v5, 0xffff0000, v162
    v_add_f32 v4, v4, v28
    v_add_f32 v5, v5, v29
    v_cvt_pk_bf16_f32 v246, v4, v5
    v_lshlrev_b32 v4, 16, v163
    v_and_b32 v5, 0xffff0000, v163
    v_add_f32 v4, v4, v30
    v_add_f32 v5, v5, v31
    v_cvt_pk_bf16_f32 v247, v4, v5
    s_waitcnt vmcnt(18)
    ds_read_b64_tr_b16 a[80:81], v22 offset:24576
    ds_read_b64_tr_b16 a[82:83], v22 offset:24960
    ds_read_b64_tr_b16 a[104:105], v22 offset:24584
    ds_read_b64_tr_b16 a[106:107], v22 offset:24968
    ds_read_b64_tr_b16 a[128:129], v23 offset:24576
    ds_read_b64_tr_b16 a[130:131], v23 offset:24960
    ds_read_b64_tr_b16 a[84:85], v22 offset:27648
    ds_read_b64_tr_b16 a[86:87], v22 offset:28032
    ds_read_b64_tr_b16 a[108:109], v22 offset:27656
    ds_read_b64_tr_b16 a[110:111], v22 offset:28040
    ds_read_b64_tr_b16 a[132:133], v23 offset:27648
    ds_read_b64_tr_b16 a[134:135], v23 offset:28032
    s_add_u32 m0, s80, 73728
    s_mov_b32 s53, 148224
    s_waitcnt lgkmcnt(0)
    buffer_load_dwordx4 v15, s[32:35], s53 offen lds
    s_add_u32 m0, s80, 74752
    s_mov_b32 s53, 148224
    buffer_load_dwordx4 v16, s[32:35], s53 offen lds
    s_add_u32 m0, s80, 75776
    s_mov_b32 s53, 148224
    buffer_load_dwordx4 v17, s[32:35], s53 offen lds
    s_add_u32 m0, s80, 76800
    s_mov_b32 s53, 185088
    buffer_load_dwordx4 v15, s[32:35], s53 offen lds
    s_add_u32 m0, s80, 77824
    s_mov_b32 s53, 185088
    buffer_load_dwordx4 v16, s[32:35], s53 offen lds
    s_add_u32 m0, s80, 78848
    s_mov_b32 s53, 185088
    buffer_load_dwordx4 v17, s[32:35], s53 offen lds
    s_add_u32 s56, s69, s62
    s_add_u32 s61, s70, 1
    s_cmp_eq_u32 s61, 72
    s_cselect_b32 s53, s63, 0
    s_cselect_b32 s61, 0, s61
    s_add_u32 s56, s56, s53
    s_add_u32 m0, s54, 20480
    s_nop 0
    buffer_load_dwordx4 v218, s[24:27], s56 offen nt lds
    s_add_u32 m0, s54, 21504
    s_nop 0
    buffer_load_dwordx4 v219, s[24:27], s56 offen nt lds
    s_add_u32 m0, s54, 22528
    s_nop 0
    buffer_load_dwordx4 v220, s[24:27], s56 offen nt lds
    s_add_u32 m0, s54, 23552
    s_nop 0
    buffer_load_dwordx4 v221, s[24:27], s56 offen nt lds
    s_add_u32 m0, s54, 24576
    s_nop 0
    buffer_load_dwordx4 v222, s[24:27], s56 offen nt lds
    ds_read_b128 v[24:27], v59 offset:512
    ds_read_b128 v[28:31], v59 offset:576
    v_lshlrev_b32 v4, 16, v116
    v_and_b32 v5, 0xffff0000, v116
    s_waitcnt lgkmcnt(1)
    v_add_f32 v4, v4, v24
    v_add_f32 v5, v5, v25
    v_cvt_pk_bf16_f32 v4, v4, v5
    v_accvgpr_write_b32 a232, v4
    v_lshlrev_b32 v4, 16, v117
    v_and_b32 v5, 0xffff0000, v117
    v_add_f32 v4, v4, v26
    v_add_f32 v5, v5, v27
    v_cvt_pk_bf16_f32 v4, v4, v5
    v_accvgpr_write_b32 a233, v4
    v_lshlrev_b32 v4, 16, v118
    v_and_b32 v5, 0xffff0000, v118
    s_waitcnt lgkmcnt(0)
    v_add_f32 v4, v4, v28
    v_add_f32 v5, v5, v29
    v_cvt_pk_bf16_f32 v4, v4, v5
    v_accvgpr_write_b32 a234, v4
    v_lshlrev_b32 v4, 16, v119
    v_and_b32 v5, 0xffff0000, v119
    v_add_f32 v4, v4, v30
    v_add_f32 v5, v5, v31
    v_cvt_pk_bf16_f32 v4, v4, v5
    v_accvgpr_write_b32 a235, v4
    v_lshlrev_b32 v4, 16, v140
    v_and_b32 v5, 0xffff0000, v140
    v_add_f32 v4, v4, v24
    v_add_f32 v5, v5, v25
    v_cvt_pk_bf16_f32 v224, v4, v5
    v_lshlrev_b32 v4, 16, v141
    v_and_b32 v5, 0xffff0000, v141
    v_add_f32 v4, v4, v26
    v_add_f32 v5, v5, v27
    v_cvt_pk_bf16_f32 v225, v4, v5
    v_lshlrev_b32 v4, 16, v142
    v_and_b32 v5, 0xffff0000, v142
    v_add_f32 v4, v4, v28
    v_add_f32 v5, v5, v29
    v_cvt_pk_bf16_f32 v226, v4, v5
    v_lshlrev_b32 v4, 16, v143
    v_and_b32 v5, 0xffff0000, v143
    v_add_f32 v4, v4, v30
    v_add_f32 v5, v5, v31
    v_cvt_pk_bf16_f32 v227, v4, v5
    v_lshlrev_b32 v4, 16, v164
    v_and_b32 v5, 0xffff0000, v164
    v_add_f32 v4, v4, v24
    v_add_f32 v5, v5, v25
    v_cvt_pk_bf16_f32 v248, v4, v5
    v_lshlrev_b32 v4, 16, v165
    v_and_b32 v5, 0xffff0000, v165
    v_add_f32 v4, v4, v26
    v_add_f32 v5, v5, v27
    v_cvt_pk_bf16_f32 v249, v4, v5
    v_lshlrev_b32 v4, 16, v166
    v_and_b32 v5, 0xffff0000, v166
    v_add_f32 v4, v4, v28
    v_add_f32 v5, v5, v29
    v_cvt_pk_bf16_f32 v250, v4, v5
    v_lshlrev_b32 v4, 16, v167
    v_and_b32 v5, 0xffff0000, v167
    v_add_f32 v4, v4, v30
    v_add_f32 v5, v5, v31
    v_cvt_pk_bf16_f32 v251, v4, v5
    s_waitcnt vmcnt(23)
    ds_read_b64_tr_b16 a[88:89], v18 offset:0
    ds_read_b64_tr_b16 a[90:91], v18 offset:384
    ds_read_b64_tr_b16 a[112:113], v18 offset:8
    ds_read_b64_tr_b16 a[114:115], v18 offset:392
    ds_read_b64_tr_b16 a[136:137], v19 offset:0
    ds_read_b64_tr_b16 a[138:139], v19 offset:384
    ds_read_b64_tr_b16 a[92:93], v18 offset:3072
    ds_read_b64_tr_b16 a[94:95], v18 offset:3456
    ds_read_b64_tr_b16 a[116:117], v18 offset:3080
    ds_read_b64_tr_b16 a[118:119], v18 offset:3464
    ds_read_b64_tr_b16 a[140:141], v19 offset:3072
    ds_read_b64_tr_b16 a[142:143], v19 offset:3456
    ds_read_b128 v[24:27], v59 offset:640
    ds_read_b128 v[28:31], v59 offset:704
    v_lshlrev_b32 v4, 16, v120
    v_and_b32 v5, 0xffff0000, v120
    s_waitcnt lgkmcnt(1)
    v_add_f32 v4, v4, v24
    v_add_f32 v5, v5, v25
    v_cvt_pk_bf16_f32 v4, v4, v5
    v_accvgpr_write_b32 a236, v4
    v_lshlrev_b32 v4, 16, v121
    v_and_b32 v5, 0xffff0000, v121
    v_add_f32 v4, v4, v26
    v_add_f32 v5, v5, v27
    v_cvt_pk_bf16_f32 v4, v4, v5
    v_accvgpr_write_b32 a237, v4
    v_lshlrev_b32 v4, 16, v122
    v_and_b32 v5, 0xffff0000, v122
    s_waitcnt lgkmcnt(0)
    v_add_f32 v4, v4, v28
    v_add_f32 v5, v5, v29
    v_cvt_pk_bf16_f32 v4, v4, v5
    v_accvgpr_write_b32 a238, v4
    v_lshlrev_b32 v4, 16, v123
    v_and_b32 v5, 0xffff0000, v123
    v_add_f32 v4, v4, v30
    v_add_f32 v5, v5, v31
    v_cvt_pk_bf16_f32 v4, v4, v5
    v_accvgpr_write_b32 a239, v4
    v_lshlrev_b32 v4, 16, v144
    v_and_b32 v5, 0xffff0000, v144
    v_add_f32 v4, v4, v24
    v_add_f32 v5, v5, v25
    v_cvt_pk_bf16_f32 v228, v4, v5
    v_lshlrev_b32 v4, 16, v145
    v_and_b32 v5, 0xffff0000, v145
    v_add_f32 v4, v4, v26
    v_add_f32 v5, v5, v27
    v_cvt_pk_bf16_f32 v229, v4, v5
    v_lshlrev_b32 v4, 16, v146
    v_and_b32 v5, 0xffff0000, v146
    v_add_f32 v4, v4, v28
    v_add_f32 v5, v5, v29
    v_cvt_pk_bf16_f32 v230, v4, v5
    v_lshlrev_b32 v4, 16, v147
    v_and_b32 v5, 0xffff0000, v147
    v_add_f32 v4, v4, v30
    v_add_f32 v5, v5, v31
    v_cvt_pk_bf16_f32 v231, v4, v5
    v_lshlrev_b32 v4, 16, v168
    v_and_b32 v5, 0xffff0000, v168
    v_add_f32 v4, v4, v24
    v_add_f32 v5, v5, v25
    v_cvt_pk_bf16_f32 v252, v4, v5
    v_lshlrev_b32 v4, 16, v169
    v_and_b32 v5, 0xffff0000, v169
    v_add_f32 v4, v4, v26
    v_add_f32 v5, v5, v27
    v_cvt_pk_bf16_f32 v253, v4, v5
    v_lshlrev_b32 v4, 16, v170
    v_and_b32 v5, 0xffff0000, v170
    v_add_f32 v4, v4, v28
    v_add_f32 v5, v5, v29
    v_cvt_pk_bf16_f32 v254, v4, v5
    v_lshlrev_b32 v4, 16, v171
    v_and_b32 v5, 0xffff0000, v171
    v_add_f32 v4, v4, v30
    v_add_f32 v5, v5, v31
    v_cvt_pk_bf16_f32 v255, v4, v5
    s_waitcnt vmcnt(17)
    ds_read_b64_tr_b16 a[144:145], v18 offset:24576
    ds_read_b64_tr_b16 a[146:147], v18 offset:24960
    ds_read_b64_tr_b16 a[168:169], v18 offset:24584
    ds_read_b64_tr_b16 a[170:171], v18 offset:24968
    ds_read_b64_tr_b16 a[192:193], v19 offset:24576
    ds_read_b64_tr_b16 a[194:195], v19 offset:24960
    ds_read_b64_tr_b16 a[148:149], v18 offset:27648
    ds_read_b64_tr_b16 a[150:151], v18 offset:28032
    ds_read_b64_tr_b16 a[172:173], v18 offset:27656
    ds_read_b64_tr_b16 a[174:175], v18 offset:28040
    ds_read_b64_tr_b16 a[196:197], v19 offset:27648
    ds_read_b64_tr_b16 a[198:199], v19 offset:28032
    s_waitcnt vmcnt(11)
    ds_read_b64_tr_b16 a[152:153], v22 offset:0
    ds_read_b64_tr_b16 a[154:155], v22 offset:384
    ds_read_b64_tr_b16 a[176:177], v22 offset:8
    ds_read_b64_tr_b16 a[178:179], v22 offset:392
    ds_read_b64_tr_b16 a[200:201], v23 offset:0
    ds_read_b64_tr_b16 a[202:203], v23 offset:384
    ds_read_b64_tr_b16 a[156:157], v22 offset:3072
    ds_read_b64_tr_b16 a[158:159], v22 offset:3456
    ds_read_b64_tr_b16 a[180:181], v22 offset:3080
    ds_read_b64_tr_b16 a[182:183], v22 offset:3464
    ds_read_b64_tr_b16 a[204:205], v23 offset:3072
    ds_read_b64_tr_b16 a[206:207], v23 offset:3456
    s_waitcnt vmcnt(5)
    ds_read_b64_tr_b16 a[160:161], v22 offset:24576
    ds_read_b64_tr_b16 a[162:163], v22 offset:24960
    ds_read_b64_tr_b16 a[184:185], v22 offset:24584
    ds_read_b64_tr_b16 a[186:187], v22 offset:24968
    ds_read_b64_tr_b16 a[208:209], v23 offset:24576
    ds_read_b64_tr_b16 a[210:211], v23 offset:24960
    ds_read_b64_tr_b16 a[164:165], v22 offset:27648
    ds_read_b64_tr_b16 a[166:167], v22 offset:28032
    ds_read_b64_tr_b16 a[188:189], v22 offset:27656
    ds_read_b64_tr_b16 a[190:191], v22 offset:28040
    ds_read_b64_tr_b16 a[212:213], v23 offset:27648
    ds_read_b64_tr_b16 a[214:215], v23 offset:28032
    v_lshrrev_b32 v4, 2, v2
    v_mul_u32_u24 v4, 5120, v4
    v_and_b32 v5, 3, v2
    v_mul_u32_u24 v6, 384, v5
    v_add_u32 v4, v4, v6
    v_and_b32 v6, 7, v2
    v_xor_b32 v7, v6, v3
    v_lshl_add_u32 v7, v7, 4, v4
    v_add_u32 v208, 40960, v7
    v_xor_b32 v209, 64, v208
    s_mul_i32 s75, s68, 6
    v_add_u32 v4, 61440, v4
    v_add_u32 v7, s75, v3
    v_xor_b32 v7, v6, v7
    v_lshl_add_u32 v210, v7, 4, v4
    v_lshrrev_b32 v7, 1, v3
    v_add3_u32 v7, v7, s75, 4
    v_xor_b32 v7, v6, v7
    v_lshl_add_u32 v7, v7, 4, v4
    v_and_b32 v8, 1, v3
    v_lshl_add_u32 v211, v8, 3, v7
    v_lshlrev_b32 v4, 4, v1
    s_add_u32 s75, s54, 20480
    v_add_u32 v212, s75, v4
    s_mul_i32 s75, s68, 9216
    s_add_u32 s75, s75, 81920
    v_add_u32 v213, s75, v4
    v_add_u32 v217, 159744, v4
    s_lshr_b32 s75, s68, 1
    s_lshl_b32 s75, s75, 10
    s_and_b32 s76, s68, 1
    s_lshl_b32 s76, s76, 3
    s_add_u32 s75, s75, s76
    v_add_u32 v216, s75, v217
    s_mul_i32 s75, s68, 10240
    s_add_u32 s75, s75, 118464
    v_mul_u32_u24 v4, 80, v3
    v_add_u32 v214, s75, v4
    v_mul_u32_u24 v6, 320, v2
    v_add_u32 v223, v6, v214
    v_lshrrev_b32 v4, 2, v2
    v_mul_u32_u24 v4, 80, v4
    v_lshl_add_u32 v4, v3, 3, v4
    v_lshl_add_u32 v4, v5, 1, v4
    v_add_u32 v215, s75, v4
    s_mov_b32 s44, 61440
    s_mov_b32 s45, 40960
    s_mov_b32 s46, 20480
    s_mov_b32 s47, 0
    s_mov_b32 s57, s69
    s_mov_b32 s58, 0
    s_mov_b32 s59, 0
    s_mov_b32 s60, 0
    s_sub_u32 s64, s71, 1
    s_mov_b32 s65, -1
    s_mov_b32 s66, s71
    v_mov_b32 v195, 0
    v_mov_b32 v191, 0
    v_mov_b32 v187, 0
    v_mov_b32 v183, 0
    s_waitcnt lgkmcnt(0)
    s_barrier
    ds_write_b128 v213, v[60:63] offset:0
    ds_write_b128 v213, v[64:67] offset:1024
    ds_write_b128 v213, v[68:71] offset:2048
    ds_write_b128 v213, v[72:75] offset:3072
    ds_write_b128 v213, v[76:79] offset:4096
    ds_write_b128 v213, v[80:83] offset:5120
    ds_write_b128 v213, v[84:87] offset:6144
    ds_write_b128 v213, v[88:91] offset:7168
    ds_write_b128 v213, v[92:95] offset:8192
    ds_read_b128 v[70:73], v208 offset:0
    ds_read_b128 v[54:57], v209 offset:0
    ds_read_b128 v[58:61], v208 offset:128
    ds_read_b128 v[62:65], v209 offset:128
    ds_read_b128 v[66:69], v208 offset:256
    ds_read_b128 v[24:27], v209 offset:256
    v_mov_b32 v74, 0
    v_mov_b32 v75, 0
    s_waitcnt lgkmcnt(5)
    v_mfma_f32_16x16x32_bf16 v[28:31], a[0:3], v[70:73], 0
    s_waitcnt lgkmcnt(4)
    v_mfma_f32_16x16x32_bf16 v[28:31], a[4:7], v[54:57], v[28:31]
    s_waitcnt lgkmcnt(3)
    v_mfma_f32_16x16x32_bf16 v[28:31], a[8:11], v[58:61], v[28:31]
    s_waitcnt lgkmcnt(2)
    v_mfma_f32_16x16x32_bf16 v[28:31], a[12:15], v[62:65], v[28:31]
    s_waitcnt lgkmcnt(1)
    v_mfma_f32_16x16x32_bf16 v[28:31], a[16:19], v[66:69], v[28:31]
    s_waitcnt lgkmcnt(0)
    v_mfma_f32_16x16x32_bf16 v[28:31], a[20:23], v[24:27], v[28:31]
    v_mfma_f32_16x16x32_bf16 v[48:51], a[24:27], v[70:73], 0
    v_mfma_f32_16x16x32_bf16 v[48:51], a[28:31], v[54:57], v[48:51]
    v_mfma_f32_16x16x32_bf16 v[48:51], a[32:35], v[58:61], v[48:51]
    v_mfma_f32_16x16x32_bf16 v[48:51], a[36:39], v[62:65], v[48:51]
    v_mfma_f32_16x16x32_bf16 v[48:51], a[40:43], v[66:69], v[48:51]
    v_mfma_f32_16x16x32_bf16 v[48:51], a[44:47], v[24:27], v[48:51]
    v_mfma_f32_16x16x32_bf16 v[32:35], a[48:51], v[70:73], 0
    v_mfma_f32_16x16x32_bf16 v[32:35], a[52:55], v[54:57], v[32:35]
    v_fma_f32 v52, v28, v28, s41
    v_fmac_f32 v52, v29, v29
    v_mfma_f32_16x16x32_bf16 v[32:35], a[56:59], v[58:61], v[32:35]
    v_fmac_f32 v52, v30, v30
    v_fmac_f32 v52, v31, v31
    v_mfma_f32_16x16x32_bf16 v[32:35], a[60:63], v[62:65], v[32:35]
    v_fmac_f32 v52, v48, v48
    v_fmac_f32 v52, v49, v49
    v_mfma_f32_16x16x32_bf16 v[32:35], a[64:67], v[66:69], v[32:35]
    v_fmac_f32 v52, v50, v50
    v_fmac_f32 v52, v51, v51
    v_mfma_f32_16x16x32_bf16 v[32:35], a[68:71], v[24:27], v[32:35]
    v_mfma_f32_16x16x32_bf16 v[40:43], a[72:75], v[70:73], 0
    v_mfma_f32_16x16x32_bf16 v[40:43], a[76:79], v[54:57], v[40:43]
    v_mfma_f32_16x16x32_bf16 v[40:43], a[80:83], v[58:61], v[40:43]
    v_mfma_f32_16x16x32_bf16 v[40:43], a[84:87], v[62:65], v[40:43]
    v_mfma_f32_16x16x32_bf16 v[40:43], a[88:91], v[66:69], v[40:43]
    v_mfma_f32_16x16x32_bf16 v[40:43], a[92:95], v[24:27], v[40:43]
    v_mfma_f32_16x16x32_bf16 v[36:39], a[96:99], v[70:73], 0
    v_mfma_f32_16x16x32_bf16 v[36:39], a[100:103], v[54:57], v[36:39]
    v_fmac_f32 v52, v32, v32
    v_fmac_f32 v52, v33, v33
    v_mfma_f32_16x16x32_bf16 v[36:39], a[104:107], v[58:61], v[36:39]
    v_fmac_f32 v52, v34, v34
    v_fmac_f32 v52, v35, v35
    v_mfma_f32_16x16x32_bf16 v[36:39], a[108:111], v[62:65], v[36:39]
    v_fma_f32 v53, v40, v40, s41
    v_fmac_f32 v53, v41, v41
    v_mfma_f32_16x16x32_bf16 v[36:39], a[112:115], v[66:69], v[36:39]
    v_fmac_f32 v53, v42, v42
    v_fmac_f32 v53, v43, v43
    v_mfma_f32_16x16x32_bf16 v[36:39], a[116:119], v[24:27], v[36:39]
    v_mfma_f32_16x16x32_bf16 v[44:47], a[120:123], v[70:73], 0
    v_mfma_f32_16x16x32_bf16 v[44:47], a[124:127], v[54:57], v[44:47]
    v_mfma_f32_16x16x32_bf16 v[44:47], a[128:131], v[58:61], v[44:47]
    v_mfma_f32_16x16x32_bf16 v[44:47], a[132:135], v[62:65], v[44:47]
    v_mfma_f32_16x16x32_bf16 v[44:47], a[136:139], v[66:69], v[44:47]
    v_mfma_f32_16x16x32_bf16 v[44:47], a[140:143], v[24:27], v[44:47]
    v_mfma_f32_16x16x32_bf16 v[76:79], a[144:147], v[70:73], 0
    v_mfma_f32_16x16x32_bf16 v[76:79], a[148:151], v[54:57], v[76:79]
    v_fmac_f32 v53, v36, v36
    v_fmac_f32 v53, v37, v37
    v_mfma_f32_16x16x32_bf16 v[76:79], a[152:155], v[58:61], v[76:79]
    v_fmac_f32 v53, v38, v38
    v_fmac_f32 v53, v39, v39
    v_mfma_f32_16x16x32_bf16 v[76:79], a[156:159], v[62:65], v[76:79]
    v_fmac_f32 v53, v44, v44
    v_fmac_f32 v53, v45, v45
    v_mfma_f32_16x16x32_bf16 v[76:79], a[160:163], v[66:69], v[76:79]
    ds_read_b128 v[0:3], v208 offset:1536
    ds_read_b128 v[4:7], v209 offset:1536
    v_mfma_f32_16x16x32_bf16 v[76:79], a[164:167], v[24:27], v[76:79]
    ds_read_b128 v[8:11], v208 offset:1664
    ds_read_b128 v[12:15], v209 offset:1664
    v_mfma_f32_16x16x32_bf16 v[84:87], a[168:171], v[70:73], 0
    ds_read_b128 v[16:19], v208 offset:1792
    ds_read_b128 v[20:23], v209 offset:1792
    v_mfma_f32_16x16x32_bf16 v[84:87], a[172:175], v[54:57], v[84:87]
    v_fmac_f32 v53, v46, v46
    v_fmac_f32 v53, v47, v47
    v_mfma_f32_16x16x32_bf16 v[84:87], a[176:179], v[58:61], v[84:87]
    v_cvt_pk_bf16_f32 v194, v52, v53
    v_cvt_pk_bf16_f32 v88, v76, v77
    v_mfma_f32_16x16x32_bf16 v[84:87], a[180:183], v[62:65], v[84:87]
    v_cvt_pk_bf16_f32 v89, v78, v79
    v_mfma_f32_16x16x32_bf16 v[84:87], a[184:187], v[66:69], v[84:87]
    v_mfma_f32_16x16x32_bf16 v[84:87], a[188:191], v[24:27], v[84:87]
    v_mfma_f32_16x16x16_bf16 v[80:83], v[200:201], v[194:195], 0
    v_mfma_f32_16x16x32_bf16 v[76:79], a[192:195], v[70:73], 0
    v_mov_b32 v52, 0
    v_mov_b32 v53, 0
    v_mfma_f32_16x16x32_bf16 v[76:79], a[196:199], v[54:57], v[76:79]
    v_mfma_f32_16x16x32_bf16 v[76:79], a[200:203], v[58:61], v[76:79]
    v_mfma_f32_16x16x32_bf16 v[76:79], a[204:207], v[62:65], v[76:79]
    v_mfma_f32_16x16x32_bf16 v[76:79], a[208:211], v[66:69], v[76:79]
    v_cvt_pk_bf16_f32 v90, v84, v85
    v_rsq_f32 v80, v80
    v_mfma_f32_16x16x32_bf16 v[76:79], a[212:215], v[24:27], v[76:79]
    s_waitcnt lgkmcnt(5)
    v_rsq_f32 v81, v81
    v_mfma_f32_16x16x32_bf16 v[24:27], a[0:3], v[0:3], 0
    s_waitcnt lgkmcnt(4)
    v_mul_f32 v80, s40, v80
    v_cvt_pk_bf16_f32 v91, v86, v87
    v_mfma_f32_16x16x32_bf16 v[24:27], a[4:7], v[4:7], v[24:27]
    s_waitcnt lgkmcnt(3)
    ds_write_b128 v223, v[88:91] offset:368
    v_mfma_f32_16x16x32_bf16 v[24:27], a[8:11], v[8:11], v[24:27]
    s_waitcnt lgkmcnt(3)
    v_mul_f32 v28, v28, v80
    v_mul_f32 v29, v29, v80
    v_mfma_f32_16x16x32_bf16 v[24:27], a[12:15], v[12:15], v[24:27]
    s_waitcnt lgkmcnt(2)
    v_cvt_pk_bf16_f32 v54, v28, v29
    v_mul_f32 v30, v30, v80
    v_mfma_f32_16x16x32_bf16 v[24:27], a[16:19], v[16:19], v[24:27]
    s_waitcnt lgkmcnt(1)
    v_mul_f32 v31, v31, v80
    v_cvt_pk_bf16_f32 v55, v30, v31
    v_mfma_f32_16x16x32_bf16 v[24:27], a[20:23], v[20:23], v[24:27]
    v_mul_f32 v48, v48, v80
    v_mul_f32 v49, v49, v80
    v_mfma_f32_16x16x32_bf16 v[28:31], a[24:27], v[0:3], 0
    v_cvt_pk_bf16_f32 v56, v48, v49
    v_mul_f32 v50, v50, v80
    v_mfma_f32_16x16x32_bf16 v[28:31], a[28:31], v[4:7], v[28:31]
    v_mul_f32 v51, v51, v80
    v_cvt_pk_bf16_f32 v57, v50, v51
    v_mfma_f32_16x16x32_bf16 v[28:31], a[32:35], v[8:11], v[28:31]
    ds_write_b128 v223, v[54:57] offset:320
    v_mfma_f32_16x16x32_bf16 v[28:31], a[36:39], v[12:15], v[28:31]
    v_mul_f32 v32, v32, v80
    v_mul_f32 v33, v33, v80
    v_mfma_f32_16x16x32_bf16 v[28:31], a[40:43], v[16:19], v[28:31]
    v_cvt_pk_bf16_f32 v48, v32, v33
    v_mul_f32 v34, v34, v80
    v_mfma_f32_16x16x32_bf16 v[28:31], a[44:47], v[20:23], v[28:31]
    v_mul_f32 v35, v35, v80
    v_cvt_pk_bf16_f32 v49, v34, v35
    v_mfma_f32_16x16x32_bf16 v[32:35], a[48:51], v[0:3], 0
    v_mul_f32 v40, v40, v81
    v_mul_f32 v41, v41, v81
    v_mfma_f32_16x16x32_bf16 v[32:35], a[52:55], v[4:7], v[32:35]
    v_cvt_pk_bf16_f32 v40, v40, v41
    v_mul_f32 v42, v42, v81
    v_mfma_f32_16x16x32_bf16 v[32:35], a[56:59], v[8:11], v[32:35]
    v_mul_f32 v43, v43, v81
    v_cvt_pk_bf16_f32 v41, v42, v43
    v_mfma_f32_16x16x32_bf16 v[32:35], a[60:63], v[12:15], v[32:35]
    v_mul_f32 v36, v36, v81
    v_mul_f32 v37, v37, v81
    v_mfma_f32_16x16x32_bf16 v[32:35], a[64:67], v[16:19], v[32:35]
    v_cvt_pk_bf16_f32 v42, v36, v37
    v_mul_f32 v38, v38, v81
    v_mfma_f32_16x16x32_bf16 v[32:35], a[68:71], v[20:23], v[32:35]
    v_mul_f32 v39, v39, v81
    v_cvt_pk_bf16_f32 v43, v38, v39
    v_mfma_f32_16x16x32_bf16 v[36:39], a[72:75], v[0:3], 0
    ds_write_b128 v223, v[40:43] offset:336
    v_mfma_f32_16x16x32_bf16 v[36:39], a[76:79], v[4:7], v[36:39]
    v_mul_f32 v44, v44, v81
    v_mul_f32 v45, v45, v81
    v_mfma_f32_16x16x32_bf16 v[36:39], a[80:83], v[8:11], v[36:39]
    v_cvt_pk_bf16_f32 v50, v44, v45
    v_mul_f32 v46, v46, v81
    v_mfma_f32_16x16x32_bf16 v[36:39], a[84:87], v[12:15], v[36:39]
    v_mul_f32 v47, v47, v81
    v_cvt_pk_bf16_f32 v51, v46, v47
    v_mfma_f32_16x16x32_bf16 v[36:39], a[88:91], v[16:19], v[36:39]
    ds_write_b128 v223, v[48:51] offset:352
    v_mfma_f32_16x16x32_bf16 v[36:39], a[92:95], v[20:23], v[36:39]
    v_cvt_pk_bf16_f32 v72, v76, v77
    v_cvt_pk_bf16_f32 v73, v78, v79
    v_mfma_f32_16x16x32_bf16 v[40:43], a[96:99], v[0:3], 0
    ds_write_b128 v223, v[72:75] offset:384
    v_mfma_f32_16x16x32_bf16 v[40:43], a[100:103], v[4:7], v[40:43]
    v_fma_f32 v54, v24, v24, s41
    v_fmac_f32 v54, v25, v25
    v_mfma_f32_16x16x32_bf16 v[40:43], a[104:107], v[8:11], v[40:43]
    v_fmac_f32 v54, v26, v26
    v_fmac_f32 v54, v27, v27
    v_mfma_f32_16x16x32_bf16 v[40:43], a[108:111], v[12:15], v[40:43]
    v_fmac_f32 v54, v28, v28
    v_fmac_f32 v54, v29, v29
    v_mfma_f32_16x16x32_bf16 v[40:43], a[112:115], v[16:19], v[40:43]
    v_fmac_f32 v54, v30, v30
    v_fmac_f32 v54, v31, v31
    v_mfma_f32_16x16x32_bf16 v[40:43], a[116:119], v[20:23], v[40:43]
    v_fmac_f32 v54, v32, v32
    v_fmac_f32 v54, v33, v33
    v_mfma_f32_16x16x32_bf16 v[44:47], a[120:123], v[0:3], 0
    v_fmac_f32 v54, v34, v34
    v_fmac_f32 v54, v35, v35
    v_mfma_f32_16x16x32_bf16 v[44:47], a[124:127], v[4:7], v[44:47]
    v_fma_f32 v55, v36, v36, s41
    v_fmac_f32 v55, v37, v37
    v_mfma_f32_16x16x32_bf16 v[44:47], a[128:131], v[8:11], v[44:47]
    v_fmac_f32 v55, v38, v38
    v_fmac_f32 v55, v39, v39
    v_mfma_f32_16x16x32_bf16 v[44:47], a[132:135], v[12:15], v[44:47]
    v_fmac_f32 v55, v40, v40
    v_fmac_f32 v55, v41, v41
    v_mfma_f32_16x16x32_bf16 v[44:47], a[136:139], v[16:19], v[44:47]
    v_fmac_f32 v55, v42, v42
    v_fmac_f32 v55, v43, v43
    v_mfma_f32_16x16x32_bf16 v[44:47], a[140:143], v[20:23], v[44:47]
    v_mfma_f32_16x16x32_bf16 v[48:51], a[144:147], v[0:3], 0
    v_mfma_f32_16x16x32_bf16 v[48:51], a[148:151], v[4:7], v[48:51]
    v_mfma_f32_16x16x32_bf16 v[48:51], a[152:155], v[8:11], v[48:51]
    v_mfma_f32_16x16x32_bf16 v[48:51], a[156:159], v[12:15], v[48:51]
    v_mfma_f32_16x16x32_bf16 v[48:51], a[160:163], v[16:19], v[48:51]
    v_mfma_f32_16x16x32_bf16 v[48:51], a[164:167], v[20:23], v[48:51]
    v_mfma_f32_16x16x32_bf16 v[62:65], a[168:171], v[0:3], 0
    v_mfma_f32_16x16x32_bf16 v[62:65], a[172:175], v[4:7], v[62:65]
    v_fmac_f32 v55, v44, v44
    v_fmac_f32 v55, v45, v45
    v_mfma_f32_16x16x32_bf16 v[62:65], a[176:179], v[8:11], v[62:65]
    v_fmac_f32 v55, v46, v46
    v_fmac_f32 v55, v47, v47
    v_mfma_f32_16x16x32_bf16 v[62:65], a[180:183], v[12:15], v[62:65]
    v_cvt_pk_bf16_f32 v194, v54, v55
    v_cvt_pk_bf16_f32 v54, v48, v49
    v_mfma_f32_16x16x32_bf16 v[62:65], a[184:187], v[16:19], v[62:65]
    v_cvt_pk_bf16_f32 v55, v50, v51
    v_mfma_f32_16x16x32_bf16 v[62:65], a[188:191], v[20:23], v[62:65]
    v_mfma_f32_16x16x16_bf16 v[48:51], v[200:201], v[194:195], 0
    v_mfma_f32_16x16x32_bf16 v[58:61], a[192:195], v[0:3], 0
    v_mfma_f32_16x16x32_bf16 v[58:61], a[196:199], v[4:7], v[58:61]
    v_mfma_f32_16x16x32_bf16 v[58:61], a[200:203], v[8:11], v[58:61]
    v_mfma_f32_16x16x32_bf16 v[58:61], a[204:207], v[12:15], v[58:61]
    v_mfma_f32_16x16x32_bf16 v[58:61], a[208:211], v[16:19], v[58:61]
    v_mfma_f32_16x16x32_bf16 v[58:61], a[212:215], v[20:23], v[58:61]
    s_nop 0
    v_cvt_pk_bf16_f32 v56, v62, v63
    v_rsq_f32 v48, v48
    v_rsq_f32 v49, v49
    v_mul_f32 v48, s40, v48
    v_cvt_pk_bf16_f32 v57, v64, v65
    v_mul_f32 v24, v24, v48
    v_mul_f32 v25, v25, v48
    v_cvt_pk_bf16_f32 v0, v24, v25
    v_mul_f32 v26, v26, v48
    v_mul_f32 v27, v27, v48
    v_cvt_pk_bf16_f32 v1, v26, v27
    v_mul_f32 v28, v28, v48
    v_mul_f32 v29, v29, v48
    v_cvt_pk_bf16_f32 v2, v28, v29
    v_mul_f32 v30, v30, v48
    v_mul_f32 v31, v31, v48
    v_cvt_pk_bf16_f32 v3, v30, v31
    v_mul_f32 v32, v32, v48
    v_mul_f32 v33, v33, v48
    v_cvt_pk_bf16_f32 v4, v32, v33
    v_mul_f32 v34, v34, v48
    v_mul_f32 v35, v35, v48
    v_cvt_pk_bf16_f32 v5, v34, v35
    v_mul_f32 v36, v36, v49
    v_mul_f32 v37, v37, v49
    v_cvt_pk_bf16_f32 v8, v36, v37
    v_mul_f32 v38, v38, v49
    v_mul_f32 v39, v39, v49
    v_cvt_pk_bf16_f32 v9, v38, v39
    v_mul_f32 v40, v40, v49
    v_mul_f32 v41, v41, v49
    v_cvt_pk_bf16_f32 v10, v40, v41
    v_mul_f32 v42, v42, v49
    v_mul_f32 v43, v43, v49
    v_cvt_pk_bf16_f32 v11, v42, v43
    v_mul_f32 v44, v44, v49
    v_mul_f32 v45, v45, v49
    v_cvt_pk_bf16_f32 v6, v44, v45
    v_mul_f32 v46, v46, v49
    v_mul_f32 v47, v47, v49
    v_cvt_pk_bf16_f32 v7, v46, v47
    v_cvt_pk_bf16_f32 v50, v58, v59
    v_cvt_pk_bf16_f32 v51, v60, v61
    ds_write_b128 v223, v[0:3] offset:5440
    ds_write_b128 v223, v[8:11] offset:5456
    ds_write_b128 v223, v[4:7] offset:5472
    ds_write_b128 v223, v[54:57] offset:5488
    ds_write_b128 v223, v[50:53] offset:5504
    s_cmp_gt_i32 s40, 0x4266d4ca
    s_cbranch_scc1 L_slow
    s_mov_b32 s53, s47
    s_mov_b32 s47, s46
    s_mov_b32 s46, s45
    s_mov_b32 s45, s44
    s_mov_b32 s44, s53
    v_fma_f32 v78, v28, v28, s42
    s_sub_u32 s48, s44, s46
    s_sub_u32 s49, s46, s45
    s_waitcnt vmcnt(10)
    s_barrier
    v_add_u32 v208, s48, v208
    v_add_u32 v209, s48, v209
    ds_read_b128 v[96:99], v208 offset:0
    ds_read_b128 v[92:95], v209 offset:0
    ds_read_b128 v[64:67], v208 offset:128
    ds_read_b128 v[4:7], v209 offset:128
    ds_read_b128 v[60:63], v208 offset:256
    ds_read_b128 v[52:55], v209 offset:256
    v_fmac_f32 v78, v29, v29
    v_fmac_f32 v78, v30, v30
    s_waitcnt lgkmcnt(5)
    v_mfma_f32_16x16x32_bf16 v[20:23], a[0:3], v[96:99], 0
    s_nop 7
.p2align 6
L_loopF:
    ds_write_b128 v210, v[8:11] offset:3072
    s_waitcnt lgkmcnt(5)
    v_mfma_f32_16x16x32_bf16 v[20:23], a[4:7], v[92:95], v[20:23]
    s_waitcnt lgkmcnt(4)
    v_mul_f32 v1, v1, v56
    v_cvt_pk_bf16_f32 v0, v0, v1
    v_mfma_f32_16x16x32_bf16 v[20:23], a[8:11], v[64:67], v[20:23]
    s_waitcnt lgkmcnt(3)
    v_mul_f32 v2, v2, v56
    v_mul_f32 v3, v3, v56
    v_mfma_f32_16x16x32_bf16 v[20:23], a[12:15], v[4:7], v[20:23]
    s_waitcnt lgkmcnt(2)
    v_cvt_pk_bf16_f32 v1, v2, v3
    v_fmac_f32 v78, v31, v31
    v_mfma_f32_16x16x32_bf16 v[20:23], a[16:19], v[60:63], v[20:23]
    s_waitcnt lgkmcnt(1)
    ds_write_b64 v211, v[0:1] offset:3072
    v_mfma_f32_16x16x32_bf16 v[20:23], a[20:23], v[52:55], v[20:23]
    v_fmac_f32 v78, v12, v12
    v_fmac_f32 v78, v13, v13
    v_mfma_f32_16x16x32_bf16 v[100:103], a[24:27], v[96:99], 0
    v_fmac_f32 v78, v14, v14
    v_fmac_f32 v78, v15, v15
    v_mfma_f32_16x16x32_bf16 v[100:103], a[28:31], v[92:95], v[100:103]
    v_fmac_f32 v78, v16, v16
    v_fmac_f32 v78, v17, v17
    v_mfma_f32_16x16x32_bf16 v[100:103], a[32:35], v[64:67], v[100:103]
    v_fmac_f32 v78, v18, v18
    v_fmac_f32 v78, v19, v19
    v_mfma_f32_16x16x32_bf16 v[100:103], a[36:39], v[4:7], v[100:103]
    v_fma_f32 v0, v24, v24, s42
    v_fmac_f32 v0, v25, v25
    v_mfma_f32_16x16x32_bf16 v[100:103], a[40:43], v[60:63], v[100:103]
    v_fmac_f32 v0, v26, v26
    v_fmac_f32 v0, v27, v27
    v_mfma_f32_16x16x32_bf16 v[100:103], a[44:47], v[52:55], v[100:103]
    v_fmac_f32 v0, v40, v40
    v_fmac_f32 v0, v41, v41
    v_mfma_f32_16x16x32_bf16 v[104:107], a[48:51], v[96:99], 0
    v_fmac_f32 v0, v42, v42
    v_fmac_f32 v0, v43, v43
    v_mfma_f32_16x16x32_bf16 v[104:107], a[52:55], v[92:95], v[104:107]
    v_fmac_f32 v0, v48, v48
    v_fmac_f32 v0, v49, v49
    v_mfma_f32_16x16x32_bf16 v[104:107], a[56:59], v[64:67], v[104:107]
    v_fmac_f32 v0, v50, v50
    v_fmac_f32 v0, v51, v51
    v_mfma_f32_16x16x32_bf16 v[104:107], a[60:63], v[4:7], v[104:107]
    v_fma_f32 v1, v32, v32, s42
    v_fmac_f32 v1, v33, v33
    v_mfma_f32_16x16x32_bf16 v[104:107], a[64:67], v[60:63], v[104:107]
    v_fmac_f32 v1, v34, v34
    v_fmac_f32 v1, v35, v35
    v_mfma_f32_16x16x32_bf16 v[104:107], a[68:71], v[52:55], v[104:107]
    v_fmac_f32 v1, v36, v36
    v_fmac_f32 v1, v37, v37
    v_mfma_f32_16x16x32_bf16 v[108:111], a[72:75], v[96:99], 0
    v_fmac_f32 v1, v38, v38
    v_fmac_f32 v1, v39, v39
    v_mfma_f32_16x16x32_bf16 v[108:111], a[76:79], v[92:95], v[108:111]
    v_fmac_f32 v1, v44, v44
    v_fmac_f32 v1, v45, v45
    v_mfma_f32_16x16x32_bf16 v[108:111], a[80:83], v[64:67], v[108:111]
    v_fmac_f32 v1, v46, v46
    v_fmac_f32 v1, v47, v47
    v_mfma_f32_16x16x32_bf16 v[108:111], a[84:87], v[4:7], v[108:111]
    v_cvt_pk_bf16_f32 v0, v78, v0
    v_cvt_pk_bf16_f32 v1, v1, v1
    v_mfma_f32_16x16x32_bf16 v[108:111], a[88:91], v[60:63], v[108:111]
    ds_write_b64 v216, v[0:1]
    v_mfma_f32_16x16x32_bf16 v[108:111], a[92:95], v[52:55], v[108:111]
    v_add_u32 v210, s49, v210
    v_add_u32 v211, s49, v211
    v_mfma_f32_16x16x32_bf16 v[116:119], a[96:99], v[96:99], 0
    v_fma_f32 v68, v20, v20, s41
    v_fmac_f32 v68, v21, v21
    v_mfma_f32_16x16x32_bf16 v[116:119], a[100:103], v[92:95], v[116:119]
    v_fmac_f32 v68, v22, v22
    v_fmac_f32 v68, v23, v23
    v_mfma_f32_16x16x32_bf16 v[116:119], a[104:107], v[64:67], v[116:119]
    v_fmac_f32 v68, v100, v100
    v_fmac_f32 v68, v101, v101
    v_mfma_f32_16x16x32_bf16 v[116:119], a[108:111], v[4:7], v[116:119]
    v_fmac_f32 v68, v102, v102
    v_fmac_f32 v68, v103, v103
    v_mfma_f32_16x16x32_bf16 v[116:119], a[112:115], v[60:63], v[116:119]
    v_fmac_f32 v68, v104, v104
    v_fmac_f32 v68, v105, v105
    v_mfma_f32_16x16x32_bf16 v[116:119], a[116:119], v[52:55], v[116:119]
    v_fmac_f32 v68, v106, v106
    v_fmac_f32 v68, v107, v107
    v_mfma_f32_16x16x32_bf16 v[120:123], a[120:123], v[96:99], 0
    s_waitcnt lgkmcnt(0)
    v_fma_f32 v69, v108, v108, s41
    v_fmac_f32 v69, v109, v109
    v_mfma_f32_16x16x32_bf16 v[120:123], a[124:127], v[92:95], v[120:123]
    s_barrier
    ds_read_b128 v[8:11], v217 offset:0
    ds_read_b128 v[56:59], v217 offset:1024
    v_mfma_f32_16x16x32_bf16 v[120:123], a[128:131], v[64:67], v[120:123]
    v_fmac_f32 v69, v110, v110
    v_fmac_f32 v69, v111, v111
    v_mfma_f32_16x16x32_bf16 v[120:123], a[132:135], v[4:7], v[120:123]
    v_fmac_f32 v69, v116, v116
    v_fmac_f32 v69, v117, v117
    v_mfma_f32_16x16x32_bf16 v[120:123], a[136:139], v[60:63], v[120:123]
    v_fmac_f32 v69, v118, v118
    v_fmac_f32 v69, v119, v119
    v_mfma_f32_16x16x32_bf16 v[120:123], a[140:143], v[52:55], v[120:123]
    v_mfma_f32_16x16x32_bf16 v[0:3], v[96:99], a[144:147], 0
    v_mfma_f32_16x16x32_bf16 v[0:3], v[92:95], a[148:151], v[0:3]
    v_mfma_f32_16x16x32_bf16 v[0:3], v[64:67], a[152:155], v[0:3]
    v_mfma_f32_16x16x32_bf16 v[0:3], v[4:7], a[156:159], v[0:3]
    v_mfma_f32_16x16x32_bf16 v[0:3], v[60:63], a[160:163], v[0:3]
    v_mfma_f32_16x16x32_bf16 v[0:3], v[52:55], a[164:167], v[0:3]
    s_waitcnt lgkmcnt(1)
    v_mfma_f32_16x16x32_bf16 v[112:115], v[200:203], v[8:11], 0
    s_waitcnt lgkmcnt(0)
    v_mfma_f32_16x16x32_bf16 v[112:115], v[200:203], v[56:59], v[112:115]
    ds_read_b128 v[88:91], v208 offset:1536
    ds_read_b128 v[82:85], v209 offset:1536
    v_mfma_f32_16x16x32_bf16 v[8:11], v[96:99], a[168:171], 0
    ds_read_b128 v[78:81], v208 offset:1664
    ds_read_b128 v[74:77], v209 offset:1664
    v_mfma_f32_16x16x32_bf16 v[8:11], v[92:95], a[172:175], v[8:11]
    ds_read_b128 v[70:73], v208 offset:1792
    ds_read_b128 v[56:59], v209 offset:1792
    v_mfma_f32_16x16x32_bf16 v[8:11], v[64:67], a[176:179], v[8:11]
    v_rsq_f32 v112, v112
    v_mfma_f32_16x16x32_bf16 v[8:11], v[4:7], a[180:183], v[8:11]
    v_rsq_f32 v113, v113
    v_mfma_f32_16x16x32_bf16 v[8:11], v[60:63], a[184:187], v[8:11]
    v_rsq_f32 v114, v114
    v_mfma_f32_16x16x32_bf16 v[8:11], v[52:55], a[188:191], v[8:11]
    v_mul_f32 v112, s43, v112
    v_mul_f32 v113, s43, v113
    v_mfma_f32_16x16x32_bf16 v[124:127], v[96:99], a[192:195], 0
    v_mul_f32 v114, s43, v114
    v_fmac_f32 v69, v120, v120
    v_mfma_f32_16x16x32_bf16 v[124:127], v[92:95], a[196:199], v[124:127]
    v_fmac_f32 v69, v121, v121
    v_fmac_f32 v69, v122, v122
    v_mfma_f32_16x16x32_bf16 v[124:127], v[64:67], a[200:203], v[124:127]
    v_fmac_f32 v69, v123, v123
    v_cvt_pk_bf16_f32 v194, v68, v69
    v_mfma_f32_16x16x32_bf16 v[124:127], v[4:7], a[204:207], v[124:127]
    v_cvt_pk_bf16_f32 v4, v0, v1
    v_cvt_pk_bf16_f32 v5, v2, v3
    v_mfma_f32_16x16x32_bf16 v[124:127], v[60:63], a[208:211], v[124:127]
    v_cvt_pk_bf16_f32 v0, v8, v9
    v_cvt_pk_bf16_f32 v1, v10, v11
    v_mfma_f32_16x16x32_bf16 v[124:127], v[52:55], a[212:215], v[124:127]
    v_mul_f32 v28, v28, v112
    v_mul_f32 v29, v29, v112
    v_mfma_f32_16x16x16_bf16 v[60:63], v[200:201], v[194:195], 0
    s_waitcnt lgkmcnt(5)
    v_cvt_pk_bf16_f32 v10, v28, v29
    v_mul_f32 v30, v30, v112
    v_mfma_f32_16x16x32_bf16 v[92:95], a[0:3], v[88:91], 0
    s_waitcnt lgkmcnt(4)
    v_mul_f32 v31, v31, v112
    v_cvt_pk_bf16_f32 v11, v30, v31
    v_mfma_f32_16x16x32_bf16 v[92:95], a[4:7], v[82:85], v[92:95]
    s_waitcnt lgkmcnt(3)
    v_cvt_pk_bf16_f32 v8, v124, v125
    v_cvt_pk_bf16_f32 v9, v126, v127
    v_mfma_f32_16x16x32_bf16 v[92:95], a[8:11], v[78:81], v[92:95]
    s_waitcnt lgkmcnt(2)
    v_rsq_f32 v60, v60
    v_mfma_f32_16x16x32_bf16 v[92:95], a[12:15], v[74:77], v[92:95]
    s_waitcnt lgkmcnt(1)
    v_rsq_f32 v61, v61
    v_mfma_f32_16x16x32_bf16 v[92:95], a[16:19], v[70:73], v[92:95]
    s_waitcnt lgkmcnt(0)
    v_mul_f32 v60, s40, v60
    v_mul_f32 v20, v20, v60
    v_mfma_f32_16x16x32_bf16 v[92:95], a[20:23], v[56:59], v[92:95]
    v_mul_f32 v21, v21, v60
    v_cvt_pk_bf16_f32 v52, v20, v21
    v_mfma_f32_16x16x32_bf16 v[96:99], a[24:27], v[88:91], 0
    v_mul_f32 v22, v22, v60
    v_mul_f32 v23, v23, v60
    v_mfma_f32_16x16x32_bf16 v[96:99], a[28:31], v[82:85], v[96:99]
    v_cvt_pk_bf16_f32 v53, v22, v23
    v_mul_f32 v100, v100, v60
    v_mfma_f32_16x16x32_bf16 v[96:99], a[32:35], v[78:81], v[96:99]
    v_mul_f32 v101, v101, v60
    v_cvt_pk_bf16_f32 v54, v100, v101
    v_mfma_f32_16x16x32_bf16 v[96:99], a[36:39], v[74:77], v[96:99]
    v_mul_f32 v102, v102, v60
    v_mul_f32 v103, v103, v60
    v_mfma_f32_16x16x32_bf16 v[96:99], a[40:43], v[70:73], v[96:99]
    v_cvt_pk_bf16_f32 v55, v102, v103
    v_mul_f32 v104, v104, v60
    v_mfma_f32_16x16x32_bf16 v[96:99], a[44:47], v[56:59], v[96:99]
    v_mul_f32 v105, v105, v60
    v_cvt_pk_bf16_f32 v86, v104, v105
    v_mfma_f32_16x16x32_bf16 v[100:103], a[48:51], v[88:91], 0
    v_mul_f32 v106, v106, v60
    v_mul_f32 v107, v107, v60
    v_mfma_f32_16x16x32_bf16 v[100:103], a[52:55], v[82:85], v[100:103]
    v_cvt_pk_bf16_f32 v87, v106, v107
    v_mul_f32 v108, v108, v61
    v_mfma_f32_16x16x32_bf16 v[100:103], a[56:59], v[78:81], v[100:103]
    v_mul_f32 v109, v109, v61
    v_cvt_pk_bf16_f32 v20, v108, v109
    v_mfma_f32_16x16x32_bf16 v[100:103], a[60:63], v[74:77], v[100:103]
    v_mul_f32 v110, v110, v61
    v_mul_f32 v111, v111, v61
    v_mfma_f32_16x16x32_bf16 v[100:103], a[64:67], v[70:73], v[100:103]
    v_cvt_pk_bf16_f32 v21, v110, v111
    v_mul_f32 v116, v116, v61
    v_mfma_f32_16x16x32_bf16 v[100:103], a[68:71], v[56:59], v[100:103]
    v_mul_f32 v117, v117, v61
    v_cvt_pk_bf16_f32 v22, v116, v117
    v_mfma_f32_16x16x32_bf16 v[104:107], a[72:75], v[88:91], 0
    v_mul_f32 v118, v118, v61
    v_mul_f32 v119, v119, v61
    v_mfma_f32_16x16x32_bf16 v[104:107], a[76:79], v[82:85], v[104:107]
    v_cvt_pk_bf16_f32 v23, v118, v119
    v_mul_f32 v120, v120, v61
    v_mfma_f32_16x16x32_bf16 v[104:107], a[80:83], v[78:81], v[104:107]
    v_mul_f32 v121, v121, v61
    v_cvt_pk_bf16_f32 v60, v120, v121
    v_mfma_f32_16x16x32_bf16 v[104:107], a[84:87], v[74:77], v[104:107]
    v_mul_f32 v122, v122, v61
    v_mul_f32 v123, v123, v61
    v_mfma_f32_16x16x32_bf16 v[104:107], a[88:91], v[70:73], v[104:107]
    v_cvt_pk_bf16_f32 v61, v122, v123
    v_mul_f32 v12, v12, v112
    v_mfma_f32_16x16x32_bf16 v[104:107], a[92:95], v[56:59], v[104:107]
    v_mul_f32 v13, v13, v112
    v_cvt_pk_bf16_f32 v12, v12, v13
    v_mfma_f32_16x16x32_bf16 v[108:111], a[96:99], v[88:91], 0
    v_mul_f32 v14, v14, v112
    v_mul_f32 v15, v15, v112
    v_mfma_f32_16x16x32_bf16 v[108:111], a[100:103], v[82:85], v[108:111]
    v_cvt_pk_bf16_f32 v13, v14, v15
    v_mul_f32 v16, v16, v112
    v_mfma_f32_16x16x32_bf16 v[108:111], a[104:107], v[78:81], v[108:111]
    ds_write_b128 v210, v[10:13] offset:0
    v_mfma_f32_16x16x32_bf16 v[108:111], a[108:111], v[74:77], v[108:111]
    v_mul_f32 v17, v17, v112
    v_cvt_pk_bf16_f32 v6, v16, v17
    v_mfma_f32_16x16x32_bf16 v[108:111], a[112:115], v[70:73], v[108:111]
    v_mul_f32 v18, v18, v112
    v_mul_f32 v19, v19, v112
    v_mfma_f32_16x16x32_bf16 v[108:111], a[116:119], v[56:59], v[108:111]
    v_cvt_pk_bf16_f32 v7, v18, v19
    v_fma_f32 v2, v92, v92, s41
    v_mfma_f32_16x16x32_bf16 v[116:119], a[120:123], v[88:91], 0
    ds_write_b64 v211, v[6:7] offset:0
    v_mfma_f32_16x16x32_bf16 v[116:119], a[124:127], v[82:85], v[116:119]
    v_fmac_f32 v2, v93, v93
    v_fmac_f32 v2, v94, v94
    v_mfma_f32_16x16x32_bf16 v[116:119], a[128:131], v[78:81], v[116:119]
    v_fmac_f32 v2, v95, v95
    v_fmac_f32 v2, v96, v96
    v_mfma_f32_16x16x32_bf16 v[116:119], a[132:135], v[74:77], v[116:119]
    v_fmac_f32 v2, v97, v97
    v_fmac_f32 v2, v98, v98
    v_mfma_f32_16x16x32_bf16 v[116:119], a[136:139], v[70:73], v[116:119]
    v_fmac_f32 v2, v99, v99
    v_fmac_f32 v2, v100, v100
    v_mfma_f32_16x16x32_bf16 v[116:119], a[140:143], v[56:59], v[116:119]
    v_fmac_f32 v2, v101, v101
    v_fmac_f32 v2, v102, v102
    v_mfma_f32_16x16x32_bf16 v[120:123], v[88:91], a[144:147], 0
    v_fmac_f32 v2, v103, v103
    v_mul_f32 v24, v24, v113
    v_mfma_f32_16x16x32_bf16 v[120:123], v[82:85], a[148:151], v[120:123]
    v_mul_f32 v25, v25, v113
    v_cvt_pk_bf16_f32 v128, v24, v25
    v_mfma_f32_16x16x32_bf16 v[120:123], v[78:81], a[152:155], v[120:123]
    v_mul_f32 v26, v26, v113
    v_mul_f32 v27, v27, v113
    v_mfma_f32_16x16x32_bf16 v[120:123], v[74:77], a[156:159], v[120:123]
    v_cvt_pk_bf16_f32 v129, v26, v27
    v_mul_f32 v40, v40, v113
    v_mfma_f32_16x16x32_bf16 v[120:123], v[70:73], a[160:163], v[120:123]
    ds_read_b128 v[16:19], v208 offset:3072
    ds_read_b128 v[24:27], v209 offset:3072
    v_mfma_f32_16x16x32_bf16 v[120:123], v[56:59], a[164:167], v[120:123]
    ds_read_b128 v[62:65], v208 offset:3200
    ds_read_b128 v[66:69], v209 offset:3200
    v_mfma_f32_16x16x32_bf16 v[124:127], v[88:91], a[168:171], 0
    ds_read_b128 v[28:31], v208 offset:3328
    ds_read_b128 v[12:15], v209 offset:3328
    v_mfma_f32_16x16x32_bf16 v[124:127], v[82:85], a[172:175], v[124:127]
    v_mul_f32 v41, v41, v113
    v_cvt_pk_bf16_f32 v130, v40, v41
    v_mfma_f32_16x16x32_bf16 v[124:127], v[78:81], a[176:179], v[124:127]
    v_mul_f32 v42, v42, v113
    v_mul_f32 v43, v43, v113
    v_mfma_f32_16x16x32_bf16 v[124:127], v[74:77], a[180:183], v[124:127]
    v_cvt_pk_bf16_f32 v131, v42, v43
    v_mul_f32 v48, v48, v113
    v_mfma_f32_16x16x32_bf16 v[124:127], v[70:73], a[184:187], v[124:127]
    ds_write_b128 v210, v[128:131] offset:1536
    v_mfma_f32_16x16x32_bf16 v[124:127], v[56:59], a[188:191], v[124:127]
    v_mul_f32 v49, v49, v113
    v_cvt_pk_bf16_f32 v10, v48, v49
    v_mul_f32 v50, v50, v113
    v_mul_f32 v51, v51, v113
    v_cvt_pk_bf16_f32 v11, v50, v51
    v_fma_f32 v3, v104, v104, s41
    v_fmac_f32 v3, v105, v105
    v_fmac_f32 v3, v106, v106
    v_fmac_f32 v3, v107, v107
    v_fmac_f32 v3, v108, v108
    v_fmac_f32 v3, v109, v109
    v_fmac_f32 v3, v110, v110
    v_fmac_f32 v3, v111, v111
    v_fmac_f32 v3, v116, v116
    v_fmac_f32 v3, v117, v117
    v_fmac_f32 v3, v118, v118
    v_fmac_f32 v3, v119, v119
    v_cvt_pk_bf16_f32 v194, v2, v3
    v_cvt_pk_bf16_f32 v6, v120, v121
    v_cvt_pk_bf16_f32 v7, v122, v123
    v_mfma_f32_16x16x16_bf16 v[128:131], v[200:201], v[194:195], 0
    ds_write_b64 v211, v[10:11] offset:1536
    v_mfma_f32_16x16x32_bf16 v[120:123], v[88:91], a[192:195], 0
    s_sub_u32 s50, s45, s44
    v_cvt_pk_bf16_f32 v2, v124, v125
    v_cvt_pk_bf16_f32 v3, v126, v127
    v_mfma_f32_16x16x32_bf16 v[120:123], v[82:85], a[196:199], v[120:123]
    s_sub_u32 s51, s46, s47
    v_mul_f32 v32, v32, v114
    v_mul_f32 v33, v33, v114
    v_mfma_f32_16x16x32_bf16 v[120:123], v[78:81], a[200:203], v[120:123]
    s_mov_b32 s60, s59
    v_rsq_f32 v128, v128
    v_mfma_f32_16x16x32_bf16 v[120:123], v[74:77], a[204:207], v[120:123]
    s_mov_b32 s59, s58
    v_rsq_f32 v129, v129
    v_mfma_f32_16x16x32_bf16 v[120:123], v[70:73], a[208:211], v[120:123]
    s_mov_b32 s58, s57
    v_mul_f32 v128, s40, v128
    v_mul_f32 v92, v92, v128
    v_mfma_f32_16x16x32_bf16 v[120:123], v[56:59], a[212:215], v[120:123]
    s_waitcnt lgkmcnt(7)
    s_mov_b32 s57, s56
    v_mul_f32 v93, v93, v128
    v_cvt_pk_bf16_f32 v40, v92, v93
    v_mfma_f32_16x16x32_bf16 v[48:51], a[0:3], v[16:19], 0
    s_waitcnt lgkmcnt(6)
    s_add_u32 s56, s56, s62
    v_mul_f32 v94, v94, v128
    v_mul_f32 v95, v95, v128
    v_mfma_f32_16x16x32_bf16 v[48:51], a[4:7], v[24:27], v[48:51]
    s_waitcnt lgkmcnt(5)
    s_add_u32 s61, s61, 1
    v_cvt_pk_bf16_f32 v41, v94, v95
    v_mul_f32 v96, v96, v128
    v_mfma_f32_16x16x32_bf16 v[48:51], a[8:11], v[62:65], v[48:51]
    s_waitcnt lgkmcnt(4)
    s_cmp_eq_u32 s61, 72
    v_mul_f32 v97, v97, v128
    v_cvt_pk_bf16_f32 v42, v96, v97
    v_mfma_f32_16x16x32_bf16 v[48:51], a[12:15], v[66:69], v[48:51]
    s_waitcnt lgkmcnt(3)
    s_cselect_b32 s53, s63, 0
    v_mul_f32 v98, v98, v128
    v_mul_f32 v99, v99, v128
    v_mfma_f32_16x16x32_bf16 v[48:51], a[16:19], v[28:31], v[48:51]
    s_waitcnt lgkmcnt(2)
    s_cselect_b32 s61, 0, s61
    v_cvt_pk_bf16_f32 v43, v98, v99
    v_mul_f32 v100, v100, v128
    v_mfma_f32_16x16x32_bf16 v[48:51], a[20:23], v[12:15], v[48:51]
    s_add_u32 s56, s56, s53
    v_mul_f32 v101, v101, v128
    v_cvt_pk_bf16_f32 v84, v100, v101
    v_mfma_f32_16x16x32_bf16 v[70:73], a[24:27], v[16:19], 0
    s_sub_u32 s64, s64, 1
    v_mul_f32 v102, v102, v128
    v_mul_f32 v103, v103, v128
    v_mfma_f32_16x16x32_bf16 v[70:73], a[28:31], v[24:27], v[70:73]
    s_cmp_gt_i32 s64, 0
    v_cvt_pk_bf16_f32 v85, v102, v103
    v_mul_f32 v104, v104, v129
    v_mfma_f32_16x16x32_bf16 v[70:73], a[32:35], v[62:65], v[70:73]
    s_cselect_b32 s26, 100270464, 0
    v_mul_f32 v105, v105, v129
    v_cvt_pk_bf16_f32 v56, v104, v105
    v_mfma_f32_16x16x32_bf16 v[70:73], a[36:39], v[66:69], v[70:73]
    s_cselect_b32 s56, s56, 0
    v_mul_f32 v106, v106, v129
    v_mul_f32 v107, v107, v129
    v_mfma_f32_16x16x32_bf16 v[70:73], a[40:43], v[28:31], v[70:73]
    s_add_u32 s65, s65, 1
    v_cvt_pk_bf16_f32 v57, v106, v107
    v_mul_f32 v108, v108, v129
    v_mfma_f32_16x16x32_bf16 v[70:73], a[44:47], v[12:15], v[70:73]
    s_cmp_ge_i32 s65, 2
    v_mul_f32 v109, v109, v129
    v_cvt_pk_bf16_f32 v58, v108, v109
    v_mfma_f32_16x16x32_bf16 v[74:77], a[48:51], v[16:19], 0
    s_cselect_b32 s30, 100270464, 0
    v_mul_f32 v110, v110, v129
    v_mul_f32 v111, v111, v129
    v_mfma_f32_16x16x32_bf16 v[74:77], a[52:55], v[24:27], v[74:77]
    s_add_u32 s67, s46, s54
    v_cvt_pk_bf16_f32 v59, v110, v111
    v_mul_f32 v116, v116, v129
    v_mfma_f32_16x16x32_bf16 v[74:77], a[56:59], v[62:65], v[74:77]
    s_add_u32 m0, s67, 0
    v_mul_f32 v117, v117, v129
    v_cvt_pk_bf16_f32 v78, v116, v117
    v_mfma_f32_16x16x32_bf16 v[74:77], a[60:63], v[66:69], v[74:77]
    v_mul_f32 v118, v118, v129
    v_mul_f32 v119, v119, v129
    v_mfma_f32_16x16x32_bf16 v[74:77], a[64:67], v[28:31], v[74:77]
    v_cvt_pk_bf16_f32 v79, v118, v119
    v_cvt_pk_bf16_f32 v10, v120, v121
    v_mfma_f32_16x16x32_bf16 v[74:77], a[68:71], v[12:15], v[74:77]
    v_cvt_pk_bf16_f32 v11, v122, v123
    v_cvt_pk_bf16_f32 v32, v32, v33
    v_mfma_f32_16x16x32_bf16 v[80:83], a[72:75], v[16:19], 0
    v_mul_f32 v34, v34, v114
    v_mul_f32 v35, v35, v114
    v_mfma_f32_16x16x32_bf16 v[80:83], a[76:79], v[24:27], v[80:83]
    v_cvt_pk_bf16_f32 v33, v34, v35
    v_mul_f32 v36, v36, v114
    v_mfma_f32_16x16x32_bf16 v[80:83], a[80:83], v[62:65], v[80:83]
    v_mul_f32 v37, v37, v114
    v_cvt_pk_bf16_f32 v34, v36, v37
    v_mfma_f32_16x16x32_bf16 v[80:83], a[84:87], v[66:69], v[80:83]
    v_mul_f32 v38, v38, v114
    v_mul_f32 v39, v39, v114
    v_mfma_f32_16x16x32_bf16 v[80:83], a[88:91], v[28:31], v[80:83]
    v_cvt_pk_bf16_f32 v35, v38, v39
    v_mul_f32 v44, v44, v114
    v_mfma_f32_16x16x32_bf16 v[80:83], a[92:95], v[12:15], v[80:83]
    ds_write_b128 v210, v[32:35] offset:3072
    v_mfma_f32_16x16x32_bf16 v[88:91], a[96:99], v[16:19], 0
    v_mul_f32 v45, v45, v114
    v_cvt_pk_bf16_f32 v32, v44, v45
    v_mfma_f32_16x16x32_bf16 v[88:91], a[100:103], v[24:27], v[88:91]
    v_mul_f32 v46, v46, v114
    v_mul_f32 v47, v47, v114
    v_mfma_f32_16x16x32_bf16 v[88:91], a[104:107], v[62:65], v[88:91]
    v_cvt_pk_bf16_f32 v33, v46, v47
    v_fma_f32 v36, v48, v48, s41
    v_mfma_f32_16x16x32_bf16 v[88:91], a[108:111], v[66:69], v[88:91]
    ds_write_b64 v211, v[32:33] offset:3072
    v_mfma_f32_16x16x32_bf16 v[88:91], a[112:115], v[28:31], v[88:91]
    v_fmac_f32 v36, v49, v49
    v_fmac_f32 v36, v50, v50
    v_mfma_f32_16x16x32_bf16 v[88:91], a[116:119], v[12:15], v[88:91]
    v_fmac_f32 v36, v51, v51
    v_fmac_f32 v36, v70, v70
    v_mfma_f32_16x16x32_bf16 v[92:95], a[120:123], v[16:19], 0
    v_fmac_f32 v36, v71, v71
    v_fmac_f32 v36, v72, v72
    v_mfma_f32_16x16x32_bf16 v[92:95], a[124:127], v[24:27], v[92:95]
    v_fmac_f32 v36, v73, v73
    v_fmac_f32 v36, v74, v74
    v_mfma_f32_16x16x32_bf16 v[92:95], a[128:131], v[62:65], v[92:95]
    v_fmac_f32 v36, v75, v75
    v_fmac_f32 v36, v76, v76
    v_mfma_f32_16x16x32_bf16 v[92:95], a[132:135], v[66:69], v[92:95]
    v_fmac_f32 v36, v77, v77
    v_fma_f32 v37, v80, v80, s41
    v_mfma_f32_16x16x32_bf16 v[92:95], a[136:139], v[28:31], v[92:95]
    v_fmac_f32 v37, v81, v81
    v_fmac_f32 v37, v82, v82
    v_mfma_f32_16x16x32_bf16 v[92:95], a[140:143], v[12:15], v[92:95]
    s_waitcnt lgkmcnt(0)
    v_fmac_f32 v37, v83, v83
    v_fmac_f32 v37, v88, v88
    v_mfma_f32_16x16x32_bf16 v[32:35], v[16:19], a[144:147], 0
    s_barrier
    v_fmac_f32 v37, v89, v89
    v_fmac_f32 v37, v90, v90
    v_mfma_f32_16x16x32_bf16 v[32:35], v[24:27], a[148:151], v[32:35]
    v_fmac_f32 v37, v91, v91
    v_add_u32 v208, s50, v208
    v_mfma_f32_16x16x32_bf16 v[32:35], v[62:65], a[152:155], v[32:35]
    v_fmac_f32 v37, v92, v92
    v_fmac_f32 v37, v93, v93
    v_mfma_f32_16x16x32_bf16 v[32:35], v[66:69], a[156:159], v[32:35]
    v_fmac_f32 v37, v94, v94
    v_fmac_f32 v37, v95, v95
    v_mfma_f32_16x16x32_bf16 v[32:35], v[28:31], a[160:163], v[32:35]
    ds_read_b128 v[126:129], v208 offset:0
    ds_read_b128 v[118:121], v208 offset:128
    v_mfma_f32_16x16x32_bf16 v[32:35], v[12:15], a[164:167], v[32:35]
    ds_read_b128 v[96:99], v208 offset:256
    v_cvt_pk_bf16_f32 v194, v36, v37
    v_mfma_f32_16x16x32_bf16 v[36:39], v[16:19], a[168:171], 0
    v_add_u32 v209, s50, v209
    v_add_u32 v210, s48, v210
    v_mfma_f32_16x16x32_bf16 v[36:39], v[24:27], a[172:175], v[36:39]
    ds_read_b128 v[134:137], v209 offset:0
    ds_read_b128 v[130:133], v209 offset:128
    v_mfma_f32_16x16x32_bf16 v[36:39], v[62:65], a[176:179], v[36:39]
    ds_read_b128 v[122:125], v209 offset:256
    v_cvt_pk_bf16_f32 v188, v32, v33
    v_mfma_f32_16x16x32_bf16 v[36:39], v[66:69], a[180:183], v[36:39]
    v_cvt_pk_bf16_f32 v189, v34, v35
    v_add_u32 v211, s48, v211
    v_mfma_f32_16x16x32_bf16 v[36:39], v[28:31], a[184:187], v[36:39]
    v_add_u32 v212, s51, v212
    v_add_u32 v214, 320, v214
    v_mfma_f32_16x16x32_bf16 v[36:39], v[12:15], a[188:191], v[36:39]
    v_add_u32 v215, 320, v215
    v_mfma_f32_16x16x16_bf16 v[138:141], v[200:201], v[194:195], 0
    v_mfma_f32_16x16x32_bf16 v[110:113], v[16:19], a[192:195], 0
    v_mfma_f32_16x16x32_bf16 v[110:113], v[24:27], a[196:199], v[110:113]
    v_mfma_f32_16x16x32_bf16 v[110:113], v[62:65], a[200:203], v[110:113]
    v_mfma_f32_16x16x32_bf16 v[110:113], v[66:69], a[204:207], v[110:113]
    ds_read_b128 v[32:35], v214 offset:16
    ds_read_b128 v[44:47], v214 offset:32
    v_mfma_f32_16x16x32_bf16 v[110:113], v[28:31], a[208:211], v[110:113]
    ds_read_b128 v[24:27], v214
    ds_read_b128 v[16:19], v212 offset:0
    v_mfma_f32_16x16x32_bf16 v[110:113], v[12:15], a[212:215], v[110:113]
    s_waitcnt lgkmcnt(9)
    v_rsq_f32 v138, v138
    v_mfma_f32_16x16x32_bf16 v[28:31], a[216:219], v[126:129], 0
    s_waitcnt lgkmcnt(6)
    v_rsq_f32 v139, v139
    v_mfma_f32_16x16x32_bf16 v[28:31], a[220:223], v[134:137], v[28:31]
    v_mul_f32 v138, s40, v138
    v_cvt_pk_bf16_f32 v184, v36, v37
    v_mfma_f32_16x16x32_bf16 v[28:31], a[224:227], v[118:121], v[28:31]
    s_waitcnt lgkmcnt(5)
    v_cvt_pk_bf16_f32 v185, v38, v39
    v_mul_f32 v80, v80, v139
    v_mfma_f32_16x16x32_bf16 v[28:31], a[228:231], v[130:133], v[28:31]
    ds_read_b128 v[114:117], v213 offset:0
    v_mul_f32 v81, v81, v139
    v_mfma_f32_16x16x32_bf16 v[28:31], a[232:235], v[96:99], v[28:31]
    s_waitcnt lgkmcnt(5)
    ds_read_b128 v[106:109], v213 offset:1024
    v_cvt_pk_bf16_f32 v36, v80, v81
    v_mfma_f32_16x16x32_bf16 v[28:31], a[236:239], v[122:125], v[28:31]
    ds_read_b128 v[100:103], v213 offset:2048
    v_mul_f32 v82, v82, v139
    v_mfma_f32_16x16x32_bf16 v[12:15], a[240:243], v[126:129], 0
    v_mul_f32 v83, v83, v139
    v_cvt_pk_bf16_f32 v37, v82, v83
    v_mfma_f32_16x16x32_bf16 v[12:15], a[244:247], v[134:137], v[12:15]
    s_waitcnt lgkmcnt(3)
    buffer_load_dwordx4 v218, s[24:27], s56 offen nt lds
    buffer_store_dwordx4 v[16:19], v218, s[28:31], s60 offen sc1
    v_mul_f32 v88, v88, v139
    v_mul_f32 v89, v89, v139
    v_cvt_pk_bf16_f32 v38, v88, v89
    v_mul_f32 v90, v90, v139
    v_mfma_f32_16x16x32_bf16 v[12:15], a[248:251], v[118:121], v[12:15]
    s_add_u32 m0, s67, 1024
    v_mul_f32 v91, v91, v139
    v_cvt_pk_bf16_f32 v39, v90, v91
    v_mfma_f32_16x16x32_bf16 v[12:15], a[252:255], v[130:133], v[12:15]
    v_mul_f32 v92, v92, v139
    v_mul_f32 v93, v93, v139
    v_mfma_f32_16x16x32_bf16 v[12:15], v[224:227], v[96:99], v[12:15]
    v_cvt_pk_bf16_f32 v104, v92, v93
    v_mul_f32 v94, v94, v139
    v_mfma_f32_16x16x32_bf16 v[12:15], v[228:231], v[122:125], v[12:15]
    ds_read_u16 v190, v215 offset:48
    ds_read_u16 v186, v215 offset:56
    v_mfma_f32_16x16x32_bf16 v[16:19], v[232:235], v[126:129], 0
    ds_read_u16 v182, v215 offset:64
    v_mul_f32 v95, v95, v139
    v_mfma_f32_16x16x32_bf16 v[16:19], v[236:239], v[134:137], v[16:19]
    v_cvt_pk_bf16_f32 v105, v94, v95
    v_mul_f32 v48, v48, v138
    v_mfma_f32_16x16x32_bf16 v[16:19], v[240:243], v[118:121], v[16:19]
    v_mul_f32 v49, v49, v138
    v_cvt_pk_bf16_f32 v62, v48, v49
    v_mfma_f32_16x16x32_bf16 v[16:19], v[244:247], v[130:133], v[16:19]
    v_mul_f32 v50, v50, v138
    v_mul_f32 v51, v51, v138
    v_mfma_f32_16x16x32_bf16 v[16:19], v[248:251], v[96:99], v[16:19]
    v_cvt_pk_bf16_f32 v63, v50, v51
    v_mul_f32 v70, v70, v138
    v_mfma_f32_16x16x32_bf16 v[16:19], v[252:255], v[122:125], v[16:19]
    s_waitcnt lgkmcnt(5)
    v_mul_f32 v71, v71, v138
    v_cvt_pk_bf16_f32 v64, v70, v71
    v_mfma_f32_16x16x32_bf16 v[114:117], v[20:23], v[52:55], v[114:117]
    s_waitcnt lgkmcnt(4)
    v_mul_f32 v72, v72, v138
    v_mul_f32 v73, v73, v138
    v_mfma_f32_16x16x32_bf16 v[106:109], v[56:59], v[52:55], v[106:109]
    s_waitcnt lgkmcnt(3)
    ds_read_b128 v[120:123], v212 offset:1024
    ds_read_b128 v[96:99], v208 offset:1536
    v_mfma_f32_16x16x32_bf16 v[100:103], v[36:39], v[52:55], v[100:103]
    ds_read_b128 v[92:95], v209 offset:1536
    ds_read_b128 v[88:91], v208 offset:1664
    v_mfma_f32_16x16x32_bf16 v[124:127], v[32:35], v[52:55], v[204:207]
    ds_read_b128 v[80:83], v209 offset:1664
    ds_read_b128 v[66:69], v208 offset:1792
    v_mfma_f32_16x16x16_bf16 v[114:117], v[60:61], v[86:87], v[114:117]
    ds_read_b128 v[52:55], v209 offset:1792
    v_cvt_pk_bf16_f32 v65, v72, v73
    v_mfma_f32_16x16x16_bf16 v[106:109], v[78:79], v[86:87], v[106:109]
    v_mul_f32 v74, v74, v138
    v_mul_f32 v75, v75, v138
    v_mfma_f32_16x16x16_bf16 v[100:103], v[104:105], v[86:87], v[100:103]
    v_cvt_pk_bf16_f32 v118, v74, v75
    v_mul_f32 v76, v76, v138
    v_mul_f32 v77, v77, v138
    v_cvt_pk_bf16_f32 v119, v76, v77
    v_cvt_pk_bf16_f32 v180, v110, v111
    v_cvt_pk_bf16_f32 v181, v112, v113
    v_mfma_f32_16x16x16_bf16 v[124:127], v[46:47], v[86:87], v[124:127]
    ds_read_b128 v[110:113], v213 offset:3072
    v_exp_f32 v114, v114
    v_mfma_f32_16x16x32_bf16 v[128:131], v[24:27], v[20:23], v[204:207]
    ds_read_b128 v[72:75], v213 offset:4096
    v_exp_f32 v115, v115
    v_mfma_f32_16x16x32_bf16 v[132:135], v[24:27], v[56:59], v[204:207]
    s_waitcnt lgkmcnt(8)
    buffer_load_dwordx4 v219, s[24:27], s56 offen nt lds
    buffer_store_dwordx4 v[120:123], v219, s[28:31], s60 offen sc1
    ds_read_b128 v[48:51], v213 offset:5120
    v_exp_f32 v116, v116
    v_exp_f32 v117, v117
    v_mfma_f32_16x16x32_bf16 v[136:139], v[24:27], v[36:39], v[204:207]
    s_add_u32 m0, s67, 2048
    v_cvt_pk_bf16_f32 v120, v114, v115
    v_cvt_pk_bf16_f32 v121, v116, v117
    v_mfma_f32_16x16x32_bf16 v[114:117], v[24:27], v[32:35], v[204:207]
    v_exp_f32 v106, v106
    v_mfma_f32_16x16x16_bf16 v[128:131], v[44:45], v[60:61], v[128:131]
    v_exp_f32 v107, v107
    v_mfma_f32_16x16x16_bf16 v[132:135], v[44:45], v[78:79], v[132:135]
    v_exp_f32 v108, v108
    v_mfma_f32_16x16x16_bf16 v[136:139], v[44:45], v[104:105], v[136:139]
    v_exp_f32 v109, v109
    v_mfma_f32_16x16x16_bf16 v[114:117], v[44:45], v[46:47], v[114:117]
    s_waitcnt lgkmcnt(8)
    v_cvt_pk_bf16_f32 v122, v106, v107
    v_cvt_pk_bf16_f32 v123, v108, v109
    v_mfma_f32_16x16x32_bf16 v[24:27], a[216:219], v[96:99], 0
    s_waitcnt lgkmcnt(7)
    v_exp_f32 v100, v100
    v_mfma_f32_16x16x32_bf16 v[24:27], a[220:223], v[92:95], v[24:27]
    s_waitcnt lgkmcnt(6)
    v_exp_f32 v101, v101
    v_mfma_f32_16x16x32_bf16 v[24:27], a[224:227], v[88:91], v[24:27]
    s_waitcnt lgkmcnt(5)
    v_exp_f32 v102, v102
    v_mfma_f32_16x16x32_bf16 v[24:27], a[228:231], v[80:83], v[24:27]
    s_waitcnt lgkmcnt(4)
    v_exp_f32 v103, v103
    v_mfma_f32_16x16x32_bf16 v[24:27], a[232:235], v[66:69], v[24:27]
    s_waitcnt lgkmcnt(3)
    v_cvt_pk_bf16_f32 v192, v100, v101
    v_cvt_pk_bf16_f32 v193, v102, v103
    v_mfma_f32_16x16x32_bf16 v[24:27], a[236:239], v[52:55], v[24:27]
    s_waitcnt lgkmcnt(2)
    v_exp_f32 v124, v124
    v_mfma_f32_16x16x32_bf16 v[110:113], v[20:23], v[40:43], v[110:113]
    s_waitcnt lgkmcnt(1)
    v_cvt_pk_bf16_f32 v194, v124, 0
    v_mov_b32_dpp v131, v135 quad_perm:[0,1,2,3] row_mask:0x2 bank_mask:0xf
    v_mfma_f32_16x16x32_bf16 v[72:75], v[56:59], v[40:43], v[72:75]
    s_waitcnt lgkmcnt(0)
    ds_read_b128 v[100:103], v212 offset:2048
    v_mov_b32_dpp v131, v139 quad_perm:[0,1,2,3] row_mask:0x4 bank_mask:0xf
    v_mfma_f32_16x16x32_bf16 v[48:51], v[36:39], v[40:43], v[48:51]
    v_mfma_f32_16x16x32_bf16 v[132:135], v[32:35], v[40:43], v[204:207]
    v_mov_b32_dpp v131, v117 quad_perm:[0,1,2,3] row_mask:0x8 bank_mask:0xf
    v_exp_f32 v131, v131
    v_mfma_f32_16x16x16_bf16 v[110:113], v[60:61], v[84:85], v[110:113]
    v_cvt_pk_bf16_f32 v131, v131, v131
    v_mfma_f32_16x16x16_bf16 v[72:75], v[78:79], v[84:85], v[72:75]
    ds_write_b16 v215, v131
    v_mfma_f32_16x16x16_bf16 v[48:51], v[104:105], v[84:85], v[48:51]
    ds_read_b128 v[114:117], v214
    ds_read_b128 v[106:109], v214 offset:16
    v_mfma_f32_16x16x16_bf16 v[132:135], v[46:47], v[84:85], v[132:135]
    v_mfma_f32_16x16x32_bf16 v[136:139], v[196:199], v[120:123], 0
    v_exp_f32 v110, v110
    v_mfma_f32_16x16x32_bf16 v[136:139], v[196:199], v[192:195], v[136:139]
    v_exp_f32 v111, v111
    v_mfma_f32_16x16x32_bf16 v[124:127], v[4:7], v[120:123], 0
    s_waitcnt lgkmcnt(3)
    buffer_load_dwordx4 v220, s[24:27], s56 offen nt lds
    buffer_store_dwordx4 v[100:103], v220, s[28:31], s60 offen sc1
    v_exp_f32 v112, v112
    v_exp_f32 v113, v113
    v_mfma_f32_16x16x32_bf16 v[124:127], v[188:191], v[192:195], v[124:127]
    s_add_u32 m0, s67, 3072
    v_cvt_pk_bf16_f32 v70, v110, v111
    v_cvt_pk_bf16_f32 v71, v112, v113
    v_mfma_f32_16x16x32_bf16 v[128:131], v[0:3], v[120:123], 0
    v_exp_f32 v72, v72
    v_mfma_f32_16x16x32_bf16 v[128:131], v[184:187], v[192:195], v[128:131]
    v_exp_f32 v73, v73
    v_mfma_f32_16x16x32_bf16 v[110:113], v[8:11], v[120:123], 0
    v_exp_f32 v74, v74
    v_mfma_f32_16x16x32_bf16 v[110:113], v[180:183], v[192:195], v[110:113]
    v_exp_f32 v75, v75
    v_mfma_f32_16x16x32_bf16 v[40:43], a[240:243], v[96:99], 0
    v_cvt_pk_bf16_f32 v72, v72, v73
    v_cvt_pk_bf16_f32 v73, v74, v75
    v_mfma_f32_16x16x32_bf16 v[40:43], a[244:247], v[92:95], v[40:43]
    s_mov_b32 s53, s47
    v_exp_f32 v48, v48
    v_mfma_f32_16x16x32_bf16 v[40:43], a[248:251], v[88:91], v[40:43]
    s_mov_b32 s47, s46
    v_exp_f32 v49, v49
    v_mfma_f32_16x16x32_bf16 v[40:43], a[252:255], v[80:83], v[40:43]
    s_mov_b32 s46, s45
    v_exp_f32 v50, v50
    v_mfma_f32_16x16x32_bf16 v[40:43], v[224:227], v[66:69], v[40:43]
    s_mov_b32 s45, s44
    v_exp_f32 v51, v51
    v_mfma_f32_16x16x32_bf16 v[40:43], v[228:231], v[52:55], v[40:43]
    s_waitcnt lgkmcnt(1)
    s_mov_b32 s44, s53
    ds_read_b128 v[100:103], v213 offset:6144
    v_cvt_pk_bf16_f32 v192, v48, v49
    v_mfma_f32_16x16x32_bf16 v[120:123], v[114:117], v[4:7], 0
    s_waitcnt lgkmcnt(1)
    ds_read_b128 v[84:87], v213 offset:7168
    v_cvt_pk_bf16_f32 v193, v50, v51
    v_mfma_f32_16x16x32_bf16 v[120:123], v[106:109], v[188:191], v[120:123]
    ds_read_b128 v[74:77], v213 offset:8192
    v_exp_f32 v133, v133
    v_mfma_f32_16x16x32_bf16 v[138:141], v[114:117], v[0:3], 0
    v_cvt_pk_bf16_f32 v194, v133, 0
    v_rcp_f32 v136, v136
    v_mfma_f32_16x16x32_bf16 v[138:141], v[106:109], v[184:187], v[138:141]
    v_mul_f32 v124, v124, v136
    v_mul_f32 v125, v125, v136
    v_mfma_f32_16x16x32_bf16 v[132:135], v[114:117], v[8:11], 0
    v_cvt_pk_bf16_f32 v142, v124, v125
    v_mul_f32 v126, v126, v136
    v_mfma_f32_16x16x32_bf16 v[132:135], v[106:109], v[180:183], v[132:135]
    v_mul_f32 v127, v127, v136
    v_cvt_pk_bf16_f32 v143, v126, v127
    v_mfma_f32_16x16x32_bf16 v[122:125], v[114:117], v[196:199], 0
    v_mul_f32 v128, v128, v136
    v_mul_f32 v129, v129, v136
    v_mfma_f32_16x16x32_bf16 v[122:125], v[106:109], v[196:199], v[122:125]
    v_cvt_pk_bf16_f32 v144, v128, v129
    v_mul_f32 v130, v130, v136
    v_mfma_f32_16x16x32_bf16 v[48:51], v[232:235], v[96:99], 0
    v_mul_f32 v131, v131, v136
    v_cvt_pk_bf16_f32 v145, v130, v131
    v_mfma_f32_16x16x32_bf16 v[48:51], v[236:239], v[92:95], v[48:51]
    ds_write_b128 v210, v[142:145] offset:0
    v_mfma_f32_16x16x32_bf16 v[48:51], v[240:243], v[88:91], v[48:51]
    v_mul_f32 v110, v110, v136
    v_mul_f32 v111, v111, v136
    v_mfma_f32_16x16x32_bf16 v[48:51], v[244:247], v[80:83], v[48:51]
    v_cvt_pk_bf16_f32 v44, v110, v111
    v_mul_f32 v112, v112, v136
    v_mfma_f32_16x16x32_bf16 v[48:51], v[248:251], v[66:69], v[48:51]
    v_mul_f32 v113, v113, v136
    v_cvt_pk_bf16_f32 v45, v112, v113
    v_mfma_f32_16x16x32_bf16 v[48:51], v[252:255], v[52:55], v[48:51]
    s_waitcnt lgkmcnt(3)
    ds_write_b64 v211, v[44:45] offset:0
    v_mfma_f32_16x16x32_bf16 v[100:103], v[20:23], v[62:65], v[100:103]
    s_waitcnt lgkmcnt(3)
    v_rcp_f32 v122, v122
    v_mfma_f32_16x16x32_bf16 v[84:87], v[56:59], v[62:65], v[84:87]
    s_waitcnt lgkmcnt(2)
    ds_read_b128 v[106:109], v212 offset:3072
    ds_read_b128 v[88:91], v208 offset:3072
    v_mfma_f32_16x16x32_bf16 v[74:77], v[36:39], v[62:65], v[74:77]
    ds_read_b128 v[80:83], v209 offset:3072
    ds_read_b128 v[66:69], v208 offset:3200
    v_mfma_f32_16x16x32_bf16 v[94:97], v[32:35], v[62:65], v[204:207]
    ds_read_b128 v[56:59], v209 offset:3200
    ds_read_b128 v[52:55], v208 offset:3328
    v_mfma_f32_16x16x16_bf16 v[100:103], v[60:61], v[118:119], v[100:103]
    ds_read_b128 v[20:23], v209 offset:3328
    v_mov_b32_dpp v120, v138 quad_perm:[0,1,2,3] row_mask:0x2 bank_mask:0xf
    v_mfma_f32_16x16x16_bf16 v[84:87], v[78:79], v[118:119], v[84:87]
    v_fma_f32 v78, v28, v28, s42
    v_mov_b32_dpp v120, v132 quad_perm:[0,1,2,3] row_mask:0x4 bank_mask:0xf
    v_mfma_f32_16x16x16_bf16 v[74:77], v[104:105], v[118:119], v[74:77]
    v_mul_f32 v120, v120, v122
    v_cvt_pk_bf16_f32 v120, v120, v120
    v_mfma_f32_16x16x16_bf16 v[94:97], v[46:47], v[118:119], v[94:97]
    ds_write_b16 v215, v120 offset:48
    v_mfma_f32_16x16x32_bf16 v[110:113], v[196:199], v[70:73], 0
    ds_read_b128 v[36:39], v212 offset:4096
    v_exp_f32 v100, v100
    v_mfma_f32_16x16x32_bf16 v[110:113], v[196:199], v[192:195], v[110:113]
    v_exp_f32 v101, v101
    v_mfma_f32_16x16x32_bf16 v[44:47], v[4:7], v[70:73], 0
    s_waitcnt lgkmcnt(8)
    buffer_load_dwordx4 v221, s[24:27], s56 offen nt lds
    buffer_store_dwordx4 v[106:109], v221, s[28:31], s60 offen sc1
    v_exp_f32 v102, v102
    v_exp_f32 v103, v103
    v_mfma_f32_16x16x32_bf16 v[44:47], v[188:191], v[192:195], v[44:47]
    s_add_u32 m0, s67, 4096
    v_cvt_pk_bf16_f32 v100, v100, v101
    v_cvt_pk_bf16_f32 v101, v102, v103
    v_mfma_f32_16x16x32_bf16 v[92:95], v[0:3], v[70:73], 0
    s_sub_u32 s48, s44, s46
    v_exp_f32 v84, v84
    v_mfma_f32_16x16x32_bf16 v[92:95], v[184:187], v[192:195], v[92:95]
    s_sub_u32 s49, s46, s45
    v_exp_f32 v85, v85
    v_mfma_f32_16x16x32_bf16 v[60:63], v[8:11], v[70:73], 0
    s_sub_u32 s66, s66, 1
    v_exp_f32 v86, v86
    v_mfma_f32_16x16x32_bf16 v[60:63], v[180:183], v[192:195], v[60:63]
    s_waitcnt lgkmcnt(7)
    s_cmp_lg_u32 s66, 0
    v_exp_f32 v87, v87
    v_mfma_f32_16x16x32_bf16 v[32:35], a[216:219], v[88:91], 0
    s_waitcnt lgkmcnt(0)
    buffer_load_dwordx4 v222, s[24:27], s56 offen nt lds
    buffer_store_dwordx4 v[36:39], v222, s[28:31], s60 offen sc1
    v_cvt_pk_bf16_f32 v102, v84, v85
    v_cvt_pk_bf16_f32 v103, v86, v87
    v_exp_f32 v74, v74
    v_mfma_f32_16x16x32_bf16 v[32:35], a[220:223], v[80:83], v[32:35]
    s_waitcnt vmcnt(10)
    v_exp_f32 v75, v75
    v_mfma_f32_16x16x32_bf16 v[32:35], a[224:227], v[66:69], v[32:35]
    s_barrier
    v_exp_f32 v76, v76
    v_mfma_f32_16x16x32_bf16 v[32:35], a[228:231], v[56:59], v[32:35]
    v_exp_f32 v77, v77
    v_mfma_f32_16x16x32_bf16 v[32:35], a[232:235], v[52:55], v[32:35]
    v_cvt_pk_bf16_f32 v192, v74, v75
    v_cvt_pk_bf16_f32 v193, v76, v77
    v_mfma_f32_16x16x32_bf16 v[32:35], a[236:239], v[20:23], v[32:35]
    v_exp_f32 v96, v96
    v_mfma_f32_16x16x32_bf16 v[36:39], a[240:243], v[88:91], 0
    v_cvt_pk_bf16_f32 v194, v96, 0
    v_rcp_f32 v110, v110
    v_mfma_f32_16x16x32_bf16 v[36:39], a[244:247], v[80:83], v[36:39]
    v_mul_f32 v44, v44, v110
    v_mul_f32 v45, v45, v110
    v_mfma_f32_16x16x32_bf16 v[36:39], a[248:251], v[66:69], v[36:39]
    v_cvt_pk_bf16_f32 v70, v44, v45
    v_mul_f32 v46, v46, v110
    v_mfma_f32_16x16x32_bf16 v[36:39], a[252:255], v[56:59], v[36:39]
    v_mul_f32 v47, v47, v110
    v_cvt_pk_bf16_f32 v71, v46, v47
    v_mfma_f32_16x16x32_bf16 v[36:39], v[224:227], v[52:55], v[36:39]
    v_mul_f32 v92, v92, v110
    v_mul_f32 v93, v93, v110
    v_mfma_f32_16x16x32_bf16 v[36:39], v[228:231], v[20:23], v[36:39]
    v_cvt_pk_bf16_f32 v72, v92, v93
    v_mul_f32 v94, v94, v110
    v_mfma_f32_16x16x32_bf16 v[44:47], v[232:235], v[88:91], 0
    v_mul_f32 v95, v95, v110
    v_cvt_pk_bf16_f32 v73, v94, v95
    v_mfma_f32_16x16x32_bf16 v[44:47], v[236:239], v[80:83], v[44:47]
    ds_write_b128 v210, v[70:73] offset:1536
    v_mfma_f32_16x16x32_bf16 v[44:47], v[240:243], v[66:69], v[44:47]
    v_mul_f32 v60, v60, v110
    v_mul_f32 v61, v61, v110
    v_mfma_f32_16x16x32_bf16 v[44:47], v[244:247], v[56:59], v[44:47]
    v_cvt_pk_bf16_f32 v56, v60, v61
    v_mul_f32 v62, v62, v110
    v_mfma_f32_16x16x32_bf16 v[44:47], v[248:251], v[52:55], v[44:47]
    v_mul_f32 v63, v63, v110
    v_cvt_pk_bf16_f32 v57, v62, v63
    v_mfma_f32_16x16x32_bf16 v[44:47], v[252:255], v[20:23], v[44:47]
    ds_write_b64 v211, v[56:57] offset:1536
    v_mfma_f32_16x16x32_bf16 v[56:59], v[196:199], v[100:103], 0
    v_add_u32 v208, s48, v208
    v_add_u32 v209, s48, v209
    v_mfma_f32_16x16x32_bf16 v[56:59], v[196:199], v[192:195], v[56:59]
    ds_read_b128 v[96:99], v208 offset:0
    ds_read_b128 v[92:95], v209 offset:0
    v_mfma_f32_16x16x32_bf16 v[20:23], v[4:7], v[100:103], 0
    ds_read_b128 v[64:67], v208 offset:128
    ds_read_b128 v[4:7], v209 offset:128
    v_mfma_f32_16x16x32_bf16 v[20:23], v[188:191], v[192:195], v[20:23]
    ds_read_b128 v[60:63], v208 offset:256
    ds_read_b128 v[52:55], v209 offset:256
    v_mfma_f32_16x16x32_bf16 v[68:71], v[0:3], v[100:103], 0
    v_rcp_f32 v56, v56
    v_mfma_f32_16x16x32_bf16 v[68:71], v[184:187], v[192:195], v[68:71]
    v_fmac_f32 v78, v29, v29
    v_fmac_f32 v78, v30, v30
    v_mfma_f32_16x16x32_bf16 v[0:3], v[8:11], v[100:103], 0
    v_mul_f32 v20, v20, v56
    v_mul_f32 v21, v21, v56
    v_mfma_f32_16x16x32_bf16 v[0:3], v[180:183], v[192:195], v[0:3]
    v_cvt_pk_bf16_f32 v8, v20, v21
    v_mul_f32 v22, v22, v56
    v_mul_f32 v23, v23, v56
    v_cvt_pk_bf16_f32 v9, v22, v23
    v_mul_f32 v68, v68, v56
    v_mul_f32 v69, v69, v56
    v_cvt_pk_bf16_f32 v10, v68, v69
    v_mul_f32 v70, v70, v56
    v_mul_f32 v71, v71, v56
    v_cvt_pk_bf16_f32 v11, v70, v71
    v_mul_f32 v0, v0, v56
    s_waitcnt lgkmcnt(5)
    v_mfma_f32_16x16x32_bf16 v[20:23], a[0:3], v[96:99], 0
    s_cbranch_scc1 L_loopF
    ds_write_b128 v210, v[8:11] offset:3072
    v_mul_f32 v1, v1, v56
    v_cvt_pk_bf16_f32 v0, v0, v1
    v_mul_f32 v2, v2, v56
    v_mul_f32 v3, v3, v56
    v_cvt_pk_bf16_f32 v1, v2, v3
    v_fmac_f32 v78, v31, v31
    ds_write_b64 v211, v[0:1] offset:3072
    v_fmac_f32 v78, v12, v12
    v_fmac_f32 v78, v13, v13
    v_fmac_f32 v78, v14, v14
    v_fmac_f32 v78, v15, v15
    v_fmac_f32 v78, v16, v16
    v_fmac_f32 v78, v17, v17
    v_fmac_f32 v78, v18, v18
    v_fmac_f32 v78, v19, v19
    v_fma_f32 v0, v24, v24, s42
    v_fmac_f32 v0, v25, v25
    v_fmac_f32 v0, v26, v26
    v_fmac_f32 v0, v27, v27
    v_fmac_f32 v0, v40, v40
    v_fmac_f32 v0, v41, v41
    v_fmac_f32 v0, v42, v42
    v_fmac_f32 v0, v43, v43
    v_fmac_f32 v0, v48, v48
    v_fmac_f32 v0, v49, v49
    v_fmac_f32 v0, v50, v50
    v_fmac_f32 v0, v51, v51
    v_fma_f32 v1, v32, v32, s42
    v_fmac_f32 v1, v33, v33
    v_fmac_f32 v1, v34, v34
    v_fmac_f32 v1, v35, v35
    v_fmac_f32 v1, v36, v36
    v_fmac_f32 v1, v37, v37
    v_fmac_f32 v1, v38, v38
    v_fmac_f32 v1, v39, v39
    v_fmac_f32 v1, v44, v44
    v_fmac_f32 v1, v45, v45
    v_fmac_f32 v1, v46, v46
    v_fmac_f32 v1, v47, v47
    v_cvt_pk_bf16_f32 v0, v78, v0
    v_cvt_pk_bf16_f32 v1, v1, v1
    ds_write_b64 v216, v[0:1]
    v_add_u32 v210, s49, v210
    v_add_u32 v211, s49, v211
    s_waitcnt lgkmcnt(0)
    s_barrier
    ds_read_b128 v[8:11], v217 offset:0
    ds_read_b128 v[56:59], v217 offset:1024
    s_waitcnt lgkmcnt(1)
    v_mfma_f32_16x16x32_bf16 v[112:115], v[200:203], v[8:11], 0
    s_waitcnt lgkmcnt(0)
    v_mfma_f32_16x16x32_bf16 v[112:115], v[200:203], v[56:59], v[112:115]
    s_nop 7
    v_rsq_f32 v112, v112
    v_rsq_f32 v113, v113
    v_rsq_f32 v114, v114
    v_mul_f32 v112, s43, v112
    v_mul_f32 v113, s43, v113
    v_mul_f32 v114, s43, v114
    v_mul_f32 v28, v28, v112
    v_mul_f32 v29, v29, v112
    v_cvt_pk_bf16_f32 v10, v28, v29
    v_mul_f32 v30, v30, v112
    v_mul_f32 v31, v31, v112
    v_cvt_pk_bf16_f32 v11, v30, v31
    v_mul_f32 v12, v12, v112
    v_mul_f32 v13, v13, v112
    v_cvt_pk_bf16_f32 v12, v12, v13
    v_mul_f32 v14, v14, v112
    v_mul_f32 v15, v15, v112
    v_cvt_pk_bf16_f32 v13, v14, v15
    v_mul_f32 v16, v16, v112
    ds_write_b128 v210, v[10:13] offset:0
    v_mul_f32 v17, v17, v112
    v_cvt_pk_bf16_f32 v6, v16, v17
    v_mul_f32 v18, v18, v112
    v_mul_f32 v19, v19, v112
    v_cvt_pk_bf16_f32 v7, v18, v19
    ds_write_b64 v211, v[6:7] offset:0
    v_mul_f32 v24, v24, v113
    v_mul_f32 v25, v25, v113
    v_cvt_pk_bf16_f32 v128, v24, v25
    v_mul_f32 v26, v26, v113
    v_mul_f32 v27, v27, v113
    v_cvt_pk_bf16_f32 v129, v26, v27
    v_mul_f32 v40, v40, v113
    v_mul_f32 v41, v41, v113
    v_cvt_pk_bf16_f32 v130, v40, v41
    v_mul_f32 v42, v42, v113
    v_mul_f32 v43, v43, v113
    v_cvt_pk_bf16_f32 v131, v42, v43
    v_mul_f32 v48, v48, v113
    ds_write_b128 v210, v[128:131] offset:1536
    v_mul_f32 v49, v49, v113
    v_cvt_pk_bf16_f32 v10, v48, v49
    v_mul_f32 v50, v50, v113
    v_mul_f32 v51, v51, v113
    v_cvt_pk_bf16_f32 v11, v50, v51
    ds_write_b64 v211, v[10:11] offset:1536
    s_sub_u32 s50, s45, s44
    s_sub_u32 s51, s46, s47
    v_mul_f32 v32, v32, v114
    v_mul_f32 v33, v33, v114
    s_mov_b32 s60, s59
    s_mov_b32 s59, s58
    s_mov_b32 s58, s57
    s_mov_b32 s57, s56
    s_add_u32 s56, s56, s62
    s_add_u32 s61, s61, 1
    s_cmp_eq_u32 s61, 72
    s_cselect_b32 s53, s63, 0
    s_cselect_b32 s61, 0, s61
    s_add_u32 s56, s56, s53
    s_sub_u32 s64, s64, 1
    s_cmp_gt_i32 s64, 0
    s_cselect_b32 s26, 100270464, 0
    s_cselect_b32 s56, s56, 0
    s_add_u32 s65, s65, 1
    s_cmp_ge_i32 s65, 2
    s_cselect_b32 s30, 100270464, 0
    s_add_u32 s67, s46, s54
    s_add_u32 m0, s67, 0
    v_cvt_pk_bf16_f32 v32, v32, v33
    v_mul_f32 v34, v34, v114
    v_mul_f32 v35, v35, v114
    v_cvt_pk_bf16_f32 v33, v34, v35
    v_mul_f32 v36, v36, v114
    v_mul_f32 v37, v37, v114
    v_cvt_pk_bf16_f32 v34, v36, v37
    v_mul_f32 v38, v38, v114
    v_mul_f32 v39, v39, v114
    v_cvt_pk_bf16_f32 v35, v38, v39
    v_mul_f32 v44, v44, v114
    ds_write_b128 v210, v[32:35] offset:3072
    v_mul_f32 v45, v45, v114
    v_cvt_pk_bf16_f32 v32, v44, v45
    v_mul_f32 v46, v46, v114
    v_mul_f32 v47, v47, v114
    v_cvt_pk_bf16_f32 v33, v46, v47
    ds_write_b64 v211, v[32:33] offset:3072
    s_waitcnt lgkmcnt(0)
    s_barrier
    v_add_u32 v208, s50, v208
    ds_read_b128 v[126:129], v208 offset:0
    ds_read_b128 v[118:121], v208 offset:128
    ds_read_b128 v[96:99], v208 offset:256
    v_add_u32 v209, s50, v209
    v_add_u32 v210, s48, v210
    ds_read_b128 v[134:137], v209 offset:0
    ds_read_b128 v[130:133], v209 offset:128
    ds_read_b128 v[122:125], v209 offset:256
    v_add_u32 v211, s48, v211
    v_add_u32 v212, s51, v212
    v_add_u32 v214, 320, v214
    v_add_u32 v215, 320, v215
    ds_read_b128 v[16:19], v212 offset:0
    s_waitcnt lgkmcnt(6)
    v_mfma_f32_16x16x32_bf16 v[28:31], a[216:219], v[126:129], 0
    s_waitcnt lgkmcnt(3)
    v_mfma_f32_16x16x32_bf16 v[28:31], a[220:223], v[134:137], v[28:31]
    v_mfma_f32_16x16x32_bf16 v[28:31], a[224:227], v[118:121], v[28:31]
    s_waitcnt lgkmcnt(2)
    v_mfma_f32_16x16x32_bf16 v[28:31], a[228:231], v[130:133], v[28:31]
    v_mfma_f32_16x16x32_bf16 v[28:31], a[232:235], v[96:99], v[28:31]
    s_waitcnt lgkmcnt(1)
    v_mfma_f32_16x16x32_bf16 v[28:31], a[236:239], v[122:125], v[28:31]
    v_mfma_f32_16x16x32_bf16 v[12:15], a[240:243], v[126:129], 0
    v_mfma_f32_16x16x32_bf16 v[12:15], a[244:247], v[134:137], v[12:15]
    s_waitcnt lgkmcnt(0)
    buffer_store_dwordx4 v[16:19], v218, s[28:31], s60 offen sc1
    v_mfma_f32_16x16x32_bf16 v[12:15], a[248:251], v[118:121], v[12:15]
    s_add_u32 m0, s67, 1024
    v_mfma_f32_16x16x32_bf16 v[12:15], a[252:255], v[130:133], v[12:15]
    v_mfma_f32_16x16x32_bf16 v[12:15], v[224:227], v[96:99], v[12:15]
    v_mfma_f32_16x16x32_bf16 v[12:15], v[228:231], v[122:125], v[12:15]
    v_mfma_f32_16x16x32_bf16 v[16:19], v[232:235], v[126:129], 0
    v_mfma_f32_16x16x32_bf16 v[16:19], v[236:239], v[134:137], v[16:19]
    v_mfma_f32_16x16x32_bf16 v[16:19], v[240:243], v[118:121], v[16:19]
    v_mfma_f32_16x16x32_bf16 v[16:19], v[244:247], v[130:133], v[16:19]
    v_mfma_f32_16x16x32_bf16 v[16:19], v[248:251], v[96:99], v[16:19]
    v_mfma_f32_16x16x32_bf16 v[16:19], v[252:255], v[122:125], v[16:19]
    ds_read_b128 v[120:123], v212 offset:1024
    ds_read_b128 v[96:99], v208 offset:1536
    ds_read_b128 v[92:95], v209 offset:1536
    ds_read_b128 v[88:91], v208 offset:1664
    ds_read_b128 v[80:83], v209 offset:1664
    ds_read_b128 v[66:69], v208 offset:1792
    ds_read_b128 v[52:55], v209 offset:1792
    s_waitcnt lgkmcnt(6)
    buffer_store_dwordx4 v[120:123], v219, s[28:31], s60 offen sc1
    s_add_u32 m0, s67, 2048
    s_waitcnt lgkmcnt(5)
    v_mfma_f32_16x16x32_bf16 v[24:27], a[216:219], v[96:99], 0
    s_waitcnt lgkmcnt(4)
    v_mfma_f32_16x16x32_bf16 v[24:27], a[220:223], v[92:95], v[24:27]
    s_waitcnt lgkmcnt(3)
    v_mfma_f32_16x16x32_bf16 v[24:27], a[224:227], v[88:91], v[24:27]
    s_waitcnt lgkmcnt(2)
    v_mfma_f32_16x16x32_bf16 v[24:27], a[228:231], v[80:83], v[24:27]
    s_waitcnt lgkmcnt(1)
    v_mfma_f32_16x16x32_bf16 v[24:27], a[232:235], v[66:69], v[24:27]
    s_waitcnt lgkmcnt(0)
    v_mfma_f32_16x16x32_bf16 v[24:27], a[236:239], v[52:55], v[24:27]
    ds_read_b128 v[100:103], v212 offset:2048
    s_waitcnt lgkmcnt(0)
    buffer_store_dwordx4 v[100:103], v220, s[28:31], s60 offen sc1
    s_add_u32 m0, s67, 3072
    v_mfma_f32_16x16x32_bf16 v[40:43], a[240:243], v[96:99], 0
    v_mfma_f32_16x16x32_bf16 v[40:43], a[244:247], v[92:95], v[40:43]
    s_mov_b32 s53, s47
    v_mfma_f32_16x16x32_bf16 v[40:43], a[248:251], v[88:91], v[40:43]
    s_mov_b32 s47, s46
    v_mfma_f32_16x16x32_bf16 v[40:43], a[252:255], v[80:83], v[40:43]
    s_mov_b32 s46, s45
    v_mfma_f32_16x16x32_bf16 v[40:43], v[224:227], v[66:69], v[40:43]
    s_mov_b32 s45, s44
    v_mfma_f32_16x16x32_bf16 v[40:43], v[228:231], v[52:55], v[40:43]
    s_mov_b32 s44, s53
    v_mfma_f32_16x16x32_bf16 v[48:51], v[232:235], v[96:99], 0
    v_mfma_f32_16x16x32_bf16 v[48:51], v[236:239], v[92:95], v[48:51]
    v_mfma_f32_16x16x32_bf16 v[48:51], v[240:243], v[88:91], v[48:51]
    v_mfma_f32_16x16x32_bf16 v[48:51], v[244:247], v[80:83], v[48:51]
    v_mfma_f32_16x16x32_bf16 v[48:51], v[248:251], v[66:69], v[48:51]
    v_mfma_f32_16x16x32_bf16 v[48:51], v[252:255], v[52:55], v[48:51]
    ds_read_b128 v[106:109], v212 offset:3072
    ds_read_b128 v[88:91], v208 offset:3072
    ds_read_b128 v[80:83], v209 offset:3072
    ds_read_b128 v[66:69], v208 offset:3200
    ds_read_b128 v[56:59], v209 offset:3200
    ds_read_b128 v[52:55], v208 offset:3328
    ds_read_b128 v[20:23], v209 offset:3328
    v_fma_f32 v78, v28, v28, s42
    ds_read_b128 v[36:39], v212 offset:4096
    s_waitcnt lgkmcnt(7)
    buffer_store_dwordx4 v[106:109], v221, s[28:31], s60 offen sc1
    s_add_u32 m0, s67, 4096
    s_sub_u32 s48, s44, s46
    s_sub_u32 s49, s46, s45
    s_waitcnt lgkmcnt(6)
    v_mfma_f32_16x16x32_bf16 v[32:35], a[216:219], v[88:91], 0
    s_waitcnt lgkmcnt(0)
    buffer_store_dwordx4 v[36:39], v222, s[28:31], s60 offen sc1
    v_mfma_f32_16x16x32_bf16 v[32:35], a[220:223], v[80:83], v[32:35]
    s_waitcnt vmcnt(10)
    v_mfma_f32_16x16x32_bf16 v[32:35], a[224:227], v[66:69], v[32:35]
    s_barrier
    v_mfma_f32_16x16x32_bf16 v[32:35], a[228:231], v[56:59], v[32:35]
    v_mfma_f32_16x16x32_bf16 v[32:35], a[232:235], v[52:55], v[32:35]
    v_mfma_f32_16x16x32_bf16 v[32:35], a[236:239], v[20:23], v[32:35]
    v_mfma_f32_16x16x32_bf16 v[36:39], a[240:243], v[88:91], 0
    v_mfma_f32_16x16x32_bf16 v[36:39], a[244:247], v[80:83], v[36:39]
    v_mfma_f32_16x16x32_bf16 v[36:39], a[248:251], v[66:69], v[36:39]
    v_mfma_f32_16x16x32_bf16 v[36:39], a[252:255], v[56:59], v[36:39]
    v_mfma_f32_16x16x32_bf16 v[36:39], v[224:227], v[52:55], v[36:39]
    v_mfma_f32_16x16x32_bf16 v[36:39], v[228:231], v[20:23], v[36:39]
    v_mfma_f32_16x16x32_bf16 v[44:47], v[232:235], v[88:91], 0
    v_mfma_f32_16x16x32_bf16 v[44:47], v[236:239], v[80:83], v[44:47]
    v_mfma_f32_16x16x32_bf16 v[44:47], v[240:243], v[66:69], v[44:47]
    v_mfma_f32_16x16x32_bf16 v[44:47], v[244:247], v[56:59], v[44:47]
    v_mfma_f32_16x16x32_bf16 v[44:47], v[248:251], v[52:55], v[44:47]
    v_mfma_f32_16x16x32_bf16 v[44:47], v[252:255], v[20:23], v[44:47]
    v_add_u32 v208, s48, v208
    v_add_u32 v209, s48, v209
    v_fmac_f32 v78, v29, v29
    v_fmac_f32 v78, v30, v30
    v_fmac_f32 v78, v31, v31
    v_fmac_f32 v78, v12, v12
    v_fmac_f32 v78, v13, v13
    v_fmac_f32 v78, v14, v14
    v_fmac_f32 v78, v15, v15
    v_fmac_f32 v78, v16, v16
    v_fmac_f32 v78, v17, v17
    v_fmac_f32 v78, v18, v18
    v_fmac_f32 v78, v19, v19
    v_fma_f32 v0, v24, v24, s42
    v_fmac_f32 v0, v25, v25
    v_fmac_f32 v0, v26, v26
    v_fmac_f32 v0, v27, v27
    v_fmac_f32 v0, v40, v40
    v_fmac_f32 v0, v41, v41
    v_fmac_f32 v0, v42, v42
    v_fmac_f32 v0, v43, v43
    v_fmac_f32 v0, v48, v48
    v_fmac_f32 v0, v49, v49
    v_fmac_f32 v0, v50, v50
    v_fmac_f32 v0, v51, v51
    v_fma_f32 v1, v32, v32, s42
    v_fmac_f32 v1, v33, v33
    v_fmac_f32 v1, v34, v34
    v_fmac_f32 v1, v35, v35
    v_fmac_f32 v1, v36, v36
    v_fmac_f32 v1, v37, v37
    v_fmac_f32 v1, v38, v38
    v_fmac_f32 v1, v39, v39
    v_fmac_f32 v1, v44, v44
    v_fmac_f32 v1, v45, v45
    v_fmac_f32 v1, v46, v46
    v_fmac_f32 v1, v47, v47
    v_cvt_pk_bf16_f32 v0, v78, v0
    v_cvt_pk_bf16_f32 v1, v1, v1
    ds_write_b64 v216, v[0:1]
    v_add_u32 v210, s49, v210
    v_add_u32 v211, s49, v211
    s_waitcnt lgkmcnt(0)
    s_barrier
    ds_read_b128 v[8:11], v217 offset:0
    ds_read_b128 v[56:59], v217 offset:1024
    s_waitcnt lgkmcnt(1)
    v_mfma_f32_16x16x32_bf16 v[112:115], v[200:203], v[8:11], 0
    s_waitcnt lgkmcnt(0)
    v_mfma_f32_16x16x32_bf16 v[112:115], v[200:203], v[56:59], v[112:115]
    s_nop 7
    v_rsq_f32 v112, v112
    v_rsq_f32 v113, v113
    v_rsq_f32 v114, v114
    v_mul_f32 v112, s43, v112
    v_mul_f32 v113, s43, v113
    v_mul_f32 v114, s43, v114
    v_mul_f32 v28, v28, v112
    v_mul_f32 v29, v29, v112
    v_cvt_pk_bf16_f32 v10, v28, v29
    v_mul_f32 v30, v30, v112
    v_mul_f32 v31, v31, v112
    v_cvt_pk_bf16_f32 v11, v30, v31
    v_mul_f32 v12, v12, v112
    v_mul_f32 v13, v13, v112
    v_cvt_pk_bf16_f32 v12, v12, v13
    v_mul_f32 v14, v14, v112
    v_mul_f32 v15, v15, v112
    v_cvt_pk_bf16_f32 v13, v14, v15
    v_mul_f32 v16, v16, v112
    ds_write_b128 v210, v[10:13] offset:0
    v_mul_f32 v17, v17, v112
    v_cvt_pk_bf16_f32 v6, v16, v17
    v_mul_f32 v18, v18, v112
    v_mul_f32 v19, v19, v112
    v_cvt_pk_bf16_f32 v7, v18, v19
    ds_write_b64 v211, v[6:7] offset:0
    v_mul_f32 v24, v24, v113
    v_mul_f32 v25, v25, v113
    v_cvt_pk_bf16_f32 v128, v24, v25
    v_mul_f32 v26, v26, v113
    v_mul_f32 v27, v27, v113
    v_cvt_pk_bf16_f32 v129, v26, v27
    v_mul_f32 v40, v40, v113
    v_mul_f32 v41, v41, v113
    v_cvt_pk_bf16_f32 v130, v40, v41
    v_mul_f32 v42, v42, v113
    v_mul_f32 v43, v43, v113
    v_cvt_pk_bf16_f32 v131, v42, v43
    v_mul_f32 v48, v48, v113
    ds_write_b128 v210, v[128:131] offset:1536
    v_mul_f32 v49, v49, v113
    v_cvt_pk_bf16_f32 v10, v48, v49
    v_mul_f32 v50, v50, v113
    v_mul_f32 v51, v51, v113
    v_cvt_pk_bf16_f32 v11, v50, v51
    ds_write_b64 v211, v[10:11] offset:1536
    s_sub_u32 s50, s45, s44
    s_sub_u32 s51, s46, s47
    v_mul_f32 v32, v32, v114
    v_mul_f32 v33, v33, v114
    s_mov_b32 s60, s59
    s_mov_b32 s59, s58
    s_mov_b32 s58, s57
    s_mov_b32 s57, s56
    s_add_u32 s56, s56, s62
    s_add_u32 s61, s61, 1
    s_cmp_eq_u32 s61, 72
    s_cselect_b32 s53, s63, 0
    s_cselect_b32 s61, 0, s61
    s_add_u32 s56, s56, s53
    s_sub_u32 s64, s64, 1
    s_cmp_gt_i32 s64, 0
    s_cselect_b32 s26, 100270464, 0
    s_cselect_b32 s56, s56, 0
    s_add_u32 s65, s65, 1
    s_cmp_ge_i32 s65, 2
    s_cselect_b32 s30, 100270464, 0
    s_add_u32 s67, s46, s54
    s_add_u32 m0, s67, 0
    v_cvt_pk_bf16_f32 v32, v32, v33
    v_mul_f32 v34, v34, v114
    v_mul_f32 v35, v35, v114
    v_cvt_pk_bf16_f32 v33, v34, v35
    v_mul_f32 v36, v36, v114
    v_mul_f32 v37, v37, v114
    v_cvt_pk_bf16_f32 v34, v36, v37
    v_mul_f32 v38, v38, v114
    v_mul_f32 v39, v39, v114
    v_cvt_pk_bf16_f32 v35, v38, v39
    v_mul_f32 v44, v44, v114
    ds_write_b128 v210, v[32:35] offset:3072
    v_mul_f32 v45, v45, v114
    v_cvt_pk_bf16_f32 v32, v44, v45
    v_mul_f32 v46, v46, v114
    v_mul_f32 v47, v47, v114
    v_cvt_pk_bf16_f32 v33, v46, v47
    ds_write_b64 v211, v[32:33] offset:3072
    s_waitcnt lgkmcnt(0)
    s_barrier
    v_add_u32 v208, s50, v208
    v_add_u32 v209, s50, v209
    v_add_u32 v210, s48, v210
    v_add_u32 v211, s48, v211
    v_add_u32 v212, s51, v212
    v_add_u32 v214, 320, v214
    v_add_u32 v215, 320, v215
    ds_read_b128 v[16:19], v212 offset:0
    s_waitcnt lgkmcnt(0)
    buffer_store_dwordx4 v[16:19], v218, s[28:31], s60 offen sc1
    s_add_u32 m0, s67, 1024
    ds_read_b128 v[120:123], v212 offset:1024
    s_waitcnt lgkmcnt(0)
    buffer_store_dwordx4 v[120:123], v219, s[28:31], s60 offen sc1
    s_add_u32 m0, s67, 2048
    ds_read_b128 v[100:103], v212 offset:2048
    s_waitcnt lgkmcnt(0)
    buffer_store_dwordx4 v[100:103], v220, s[28:31], s60 offen sc1
    s_add_u32 m0, s67, 3072
    ds_read_b128 v[106:109], v212 offset:3072
    ds_read_b128 v[36:39], v212 offset:4096
    s_waitcnt lgkmcnt(1)
    buffer_store_dwordx4 v[106:109], v221, s[28:31], s60 offen sc1
    s_add_u32 m0, s67, 4096
    s_waitcnt lgkmcnt(0)
    buffer_store_dwordx4 v[36:39], v222, s[28:31], s60 offen sc1
    s_nop 7
L_etail:
    s_waitcnt vmcnt(10) lgkmcnt(0)
    s_barrier
    v_mbcnt_lo_u32_b32 v1, -1, 0
    v_mbcnt_hi_u32_b32 v1, -1, v1
    v_and_b32 v2, 15, v1
    v_lshrrev_b32 v3, 4, v1
    s_add_u32 s75, s72, 6
    s_sub_u32 s76, s75, 511
    s_min_u32 s75, s75, s76
    s_mul_i32 s75, s75, 196224
    s_add_u32 s76, s73, 6
    s_sub_u32 s77, s76, 511
    s_min_u32 s76, s76, s77
    s_mul_i32 s76, s76, 384
    s_add_u32 s75, s75, s76
    s_add_u32 s75, s75, s69
    s_sub_u32 s76, 72, s70
    v_add_u32 v4, 0, v1
    v_mul_u32_u24 v7, 2731, v4
    v_lshrrev_b32 v7, 16, v7
    v_mul_u32_u24 v5, 24, v7
    v_sub_u32 v5, v4, v5
    v_and_b32 v6, 3, v7
    v_lshl_add_u32 v6, s68, 2, v6
    v_and_b32 v8, 7, v6
    v_xor_b32 v8, v8, v5
    v_lshrrev_b32 v7, 2, v7
    v_lshl_add_u32 v7, v7, 4, v6
    v_mul_lo_u32 v170, v7, s62
    v_lshl_add_u32 v170, v8, 4, v170
    v_add_u32 v170, s75, v170
    v_add_u32 v9, s63, v170
    v_cmp_le_u32 vcc, s76, v7
    s_nop 1
    v_cndmask_b32 v170, v170, v9, vcc
    v_mov_b32 v9, 1073741824
    v_cmp_gt_u32 vcc, s71, v7
    s_nop 1
    v_cndmask_b32 v170, v9, v170, vcc
    v_add_u32 v4, 64, v1
    v_mul_u32_u24 v7, 2731, v4
    v_lshrrev_b32 v7, 16, v7
    v_mul_u32_u24 v5, 24, v7
    v_sub_u32 v5, v4, v5
    v_and_b32 v6, 3, v7
    v_lshl_add_u32 v6, s68, 2, v6
    v_and_b32 v8, 7, v6
    v_xor_b32 v8, v8, v5
    v_lshrrev_b32 v7, 2, v7
    v_lshl_add_u32 v7, v7, 4, v6
    v_mul_lo_u32 v171, v7, s62
    v_lshl_add_u32 v171, v8, 4, v171
    v_add_u32 v171, s75, v171
    v_add_u32 v9, s63, v171
    v_cmp_le_u32 vcc, s76, v7
    s_nop 1
    v_cndmask_b32 v171, v171, v9, vcc
    v_mov_b32 v9, 1073741824
    v_cmp_gt_u32 vcc, s71, v7
    s_nop 1
    v_cndmask_b32 v171, v9, v171, vcc
    v_add_u32 v4, 128, v1
    v_mul_u32_u24 v7, 2731, v4
    v_lshrrev_b32 v7, 16, v7
    v_mul_u32_u24 v5, 24, v7
    v_sub_u32 v5, v4, v5
    v_and_b32 v6, 3, v7
    v_lshl_add_u32 v6, s68, 2, v6
    v_and_b32 v8, 7, v6
    v_xor_b32 v8, v8, v5
    v_lshrrev_b32 v7, 2, v7
    v_lshl_add_u32 v7, v7, 4, v6
    v_mul_lo_u32 v172, v7, s62
    v_lshl_add_u32 v172, v8, 4, v172
    v_add_u32 v172, s75, v172
    v_add_u32 v9, s63, v172
    v_cmp_le_u32 vcc, s76, v7
    s_nop 1
    v_cndmask_b32 v172, v172, v9, vcc
    v_mov_b32 v9, 1073741824
    v_cmp_gt_u32 vcc, s71, v7
    s_nop 1
    v_cndmask_b32 v172, v9, v172, vcc
    s_sub_u32 s75, s44, s46
    v_add_u32 v212, s75, v212
    v_mul_u32_u24 v10, 320, v2
    v_add_u32 v10, 118784, v10
    v_add_u32 v4, 0, v3
    v_cmp_le_u32 vcc, 6, v4
    v_subrev_u32 v5, 6, v4
    s_nop 0
    v_cndmask_b32 v4, v4, v5, vcc
    v_add_u32 v5, 10240, v10
    v_cndmask_b32 v5, v10, v5, vcc
    v_mul_u32_u24 v6, 80, v4
    v_add_u32 v7, 48, v6
    v_add_u32 v8, 56, v6
    v_lshlrev_b32 v6, 1, v6
    v_subrev_u32 v9, 576, v6
    v_subrev_u32 v6, 496, v6
    v_cmp_le_u32 vcc, 4, v4
    s_nop 1
    v_cndmask_b32 v7, v7, v9, vcc
    v_cndmask_b32 v8, v8, v6, vcc
    v_add_u32 v174, v5, v7
    v_add_u32 v175, v5, v8
    v_add_u32 v4, 4, v3
    v_cmp_le_u32 vcc, 6, v4
    v_subrev_u32 v5, 6, v4
    s_nop 0
    v_cndmask_b32 v4, v4, v5, vcc
    v_add_u32 v5, 10240, v10
    v_cndmask_b32 v5, v10, v5, vcc
    v_mul_u32_u24 v6, 80, v4
    v_add_u32 v7, 48, v6
    v_add_u32 v8, 56, v6
    v_lshlrev_b32 v6, 1, v6
    v_subrev_u32 v9, 576, v6
    v_subrev_u32 v6, 496, v6
    v_cmp_le_u32 vcc, 4, v4
    s_nop 1
    v_cndmask_b32 v7, v7, v9, vcc
    v_cndmask_b32 v8, v8, v6, vcc
    v_add_u32 v176, v5, v7
    v_add_u32 v177, v5, v8
    v_add_u32 v4, 8, v3
    v_cmp_le_u32 vcc, 6, v4
    v_subrev_u32 v5, 6, v4
    s_nop 0
    v_cndmask_b32 v4, v4, v5, vcc
    v_add_u32 v5, 10240, v10
    v_cndmask_b32 v5, v10, v5, vcc
    v_mul_u32_u24 v6, 80, v4
    v_add_u32 v7, 48, v6
    v_add_u32 v8, 56, v6
    v_lshlrev_b32 v6, 1, v6
    v_subrev_u32 v9, 576, v6
    v_subrev_u32 v6, 496, v6
    v_cmp_le_u32 vcc, 4, v4
    s_nop 1
    v_cndmask_b32 v7, v7, v9, vcc
    v_cndmask_b32 v8, v8, v6, vcc
    v_add_u32 v178, v5, v7
    v_add_u32 v179, v5, v8
    ds_read_b64 v[8:9], v174 offset:0
    ds_read_b64 v[10:11], v175 offset:0
    ds_read_b64 v[16:17], v176 offset:0
    ds_read_b64 v[18:19], v177 offset:0
    ds_read_b64 v[20:21], v178 offset:0
    ds_read_b64 v[22:23], v179 offset:0
    ds_read_b64 v[48:49], v174 offset:20480
    ds_read_b64 v[50:51], v175 offset:20480
    ds_read_b64 v[52:53], v176 offset:20480
    ds_read_b64 v[54:55], v177 offset:20480
    ds_read_b64 v[56:57], v178 offset:20480
    ds_read_b64 v[58:59], v179 offset:20480
    v_mov_b32 v61, 0
    s_waitcnt lgkmcnt(10)
    v_mfma_f32_16x16x32_bf16 v[0:3], a[216:219], v[8:11], 0
    s_waitcnt lgkmcnt(8)
    v_mfma_f32_16x16x32_bf16 v[0:3], a[220:223], v[16:19], v[0:3]
    s_waitcnt lgkmcnt(6)
    v_mfma_f32_16x16x32_bf16 v[0:3], a[224:227], v[20:23], v[0:3]
    s_waitcnt lgkmcnt(4)
    v_mfma_f32_16x16x32_bf16 v[0:3], a[228:231], v[48:51], v[0:3]
    s_waitcnt lgkmcnt(2)
    ds_read_b64 v[24:25], v174 offset:5120
    ds_read_b64 v[26:27], v175 offset:5120
    v_mfma_f32_16x16x32_bf16 v[0:3], a[232:235], v[52:55], v[0:3]
    s_waitcnt lgkmcnt(2)
    ds_read_b64 v[28:29], v176 offset:5120
    ds_read_b64 v[30:31], v177 offset:5120
    v_mfma_f32_16x16x32_bf16 v[0:3], a[236:239], v[56:59], v[0:3]
    ds_read_b64 v[32:33], v178 offset:5120
    ds_read_b64 v[34:35], v179 offset:5120
    v_mfma_f32_16x16x32_bf16 v[4:7], a[240:243], v[8:11], 0
    ds_read_b64 v[36:37], v174 offset:25600
    ds_read_b64 v[38:39], v175 offset:25600
    v_mfma_f32_16x16x32_bf16 v[4:7], a[244:247], v[16:19], v[4:7]
    ds_read_b64 v[40:41], v176 offset:25600
    ds_read_b64 v[42:43], v177 offset:25600
    v_mfma_f32_16x16x32_bf16 v[4:7], a[248:251], v[20:23], v[4:7]
    ds_read_b64 v[44:45], v178 offset:25600
    ds_read_b64 v[46:47], v179 offset:25600
    v_mfma_f32_16x16x32_bf16 v[4:7], a[252:255], v[48:51], v[4:7]
    v_fma_f32 v60, v0, v0, s42
    v_fmac_f32 v60, v1, v1
    v_mfma_f32_16x16x32_bf16 v[4:7], v[224:227], v[52:55], v[4:7]
    v_fmac_f32 v60, v2, v2
    v_fmac_f32 v60, v3, v3
    v_mfma_f32_16x16x32_bf16 v[4:7], v[228:231], v[56:59], v[4:7]
    v_mfma_f32_16x16x32_bf16 v[12:15], v[232:235], v[8:11], 0
    v_mfma_f32_16x16x32_bf16 v[12:15], v[236:239], v[16:19], v[12:15]
    v_mfma_f32_16x16x32_bf16 v[12:15], v[240:243], v[20:23], v[12:15]
    v_mfma_f32_16x16x32_bf16 v[12:15], v[244:247], v[48:51], v[12:15]
    v_mfma_f32_16x16x32_bf16 v[12:15], v[248:251], v[52:55], v[12:15]
    v_mfma_f32_16x16x32_bf16 v[12:15], v[252:255], v[56:59], v[12:15]
    s_waitcnt lgkmcnt(10)
    v_mfma_f32_16x16x32_bf16 v[8:11], a[216:219], v[24:27], 0
    s_waitcnt lgkmcnt(8)
    v_mfma_f32_16x16x32_bf16 v[8:11], a[220:223], v[28:31], v[8:11]
    s_waitcnt lgkmcnt(6)
    v_fmac_f32 v60, v4, v4
    v_fmac_f32 v60, v5, v5
    v_mfma_f32_16x16x32_bf16 v[8:11], a[224:227], v[32:35], v[8:11]
    s_waitcnt lgkmcnt(4)
    v_fmac_f32 v60, v6, v6
    v_fmac_f32 v60, v7, v7
    v_mfma_f32_16x16x32_bf16 v[8:11], a[228:231], v[36:39], v[8:11]
    s_waitcnt lgkmcnt(2)
    v_fmac_f32 v60, v12, v12
    v_fmac_f32 v60, v13, v13
    v_mfma_f32_16x16x32_bf16 v[8:11], a[232:235], v[40:43], v[8:11]
    s_waitcnt lgkmcnt(0)
    v_fmac_f32 v60, v14, v14
    v_fmac_f32 v60, v15, v15
    v_mfma_f32_16x16x32_bf16 v[8:11], a[236:239], v[44:47], v[8:11]
    v_mfma_f32_16x16x32_bf16 v[16:19], a[240:243], v[24:27], 0
    v_mfma_f32_16x16x32_bf16 v[16:19], a[244:247], v[28:31], v[16:19]
    v_mfma_f32_16x16x32_bf16 v[16:19], a[248:251], v[32:35], v[16:19]
    v_mfma_f32_16x16x32_bf16 v[16:19], a[252:255], v[36:39], v[16:19]
    v_mfma_f32_16x16x32_bf16 v[16:19], v[224:227], v[40:43], v[16:19]
    v_mfma_f32_16x16x32_bf16 v[16:19], v[228:231], v[44:47], v[16:19]
    v_mfma_f32_16x16x32_bf16 v[20:23], v[232:235], v[24:27], 0
    v_mfma_f32_16x16x32_bf16 v[20:23], v[236:239], v[28:31], v[20:23]
    v_fma_f32 v24, v8, v8, s42
    v_fmac_f32 v24, v9, v9
    v_mfma_f32_16x16x32_bf16 v[20:23], v[240:243], v[32:35], v[20:23]
    v_fmac_f32 v24, v10, v10
    v_fmac_f32 v24, v11, v11
    v_mfma_f32_16x16x32_bf16 v[20:23], v[244:247], v[36:39], v[20:23]
    v_fmac_f32 v24, v16, v16
    v_fmac_f32 v24, v17, v17
    v_mfma_f32_16x16x32_bf16 v[20:23], v[248:251], v[40:43], v[20:23]
    v_fmac_f32 v24, v18, v18
    v_fmac_f32 v24, v19, v19
    v_mfma_f32_16x16x32_bf16 v[20:23], v[252:255], v[44:47], v[20:23]
    s_nop 7
    v_fmac_f32 v24, v20, v20
    v_fmac_f32 v24, v21, v21
    v_fmac_f32 v24, v22, v22
    v_fmac_f32 v24, v23, v23
    v_cvt_pk_bf16_f32 v60, v60, v24
    ds_write_b64 v216, v[60:61]
    s_waitcnt lgkmcnt(0)
    s_barrier
    ds_read_b128 v[28:31], v217 offset:0
    ds_read_b128 v[32:35], v217 offset:1024
    s_waitcnt lgkmcnt(1)
    v_mfma_f32_16x16x32_bf16 v[24:27], v[200:203], v[28:31], 0
    s_waitcnt lgkmcnt(0)
    v_mfma_f32_16x16x32_bf16 v[24:27], v[200:203], v[32:35], v[24:27]
    s_nop 7
    v_rsq_f32 v24, v24
    v_rsq_f32 v25, v25
    v_mul_f32 v24, s43, v24
    v_mul_f32 v0, v0, v24
    v_mul_f32 v1, v1, v24
    v_cvt_pk_bf16_f32 v0, v0, v1
    v_mul_f32 v2, v2, v24
    v_mul_f32 v3, v3, v24
    v_cvt_pk_bf16_f32 v1, v2, v3
    v_mul_f32 v4, v4, v24
    v_mul_f32 v5, v5, v24
    v_cvt_pk_bf16_f32 v2, v4, v5
    v_mul_f32 v6, v6, v24
    v_mul_f32 v7, v7, v24
    v_cvt_pk_bf16_f32 v3, v6, v7
    v_mul_f32 v12, v12, v24
    v_mul_f32 v13, v13, v24
    v_cvt_pk_bf16_f32 v12, v12, v13
    v_mul_f32 v14, v14, v24
    v_mul_f32 v15, v15, v24
    v_cvt_pk_bf16_f32 v13, v14, v15
    v_mul_f32 v25, s43, v25
    v_mul_f32 v8, v8, v25
    v_mul_f32 v9, v9, v25
    v_cvt_pk_bf16_f32 v4, v8, v9
    v_mul_f32 v10, v10, v25
    v_mul_f32 v11, v11, v25
    v_cvt_pk_bf16_f32 v5, v10, v11
    v_mul_f32 v16, v16, v25
    v_mul_f32 v17, v17, v25
    v_cvt_pk_bf16_f32 v6, v16, v17
    v_mul_f32 v18, v18, v25
    v_mul_f32 v19, v19, v25
    v_cvt_pk_bf16_f32 v7, v18, v19
    v_mul_f32 v20, v20, v25
    v_mul_f32 v21, v21, v25
    v_cvt_pk_bf16_f32 v8, v20, v21
    v_mul_f32 v22, v22, v25
    v_mul_f32 v23, v23, v25
    v_cvt_pk_bf16_f32 v9, v22, v23
    ds_write_b128 v210, v[0:3] offset:0
    ds_write_b64 v211, v[12:13] offset:0
    ds_write_b128 v210, v[4:7] offset:1536
    ds_write_b64 v211, v[8:9] offset:1536
    s_waitcnt lgkmcnt(0)
    s_barrier
    ds_read_b128 v[0:3], v212 offset:0
    ds_read_b128 v[4:7], v212 offset:1024
    ds_read_b128 v[8:11], v212 offset:2048
    s_waitcnt lgkmcnt(2)
    buffer_store_dwordx4 v[0:3], v170, s[28:31], 0 offen sc1
    s_waitcnt lgkmcnt(1)
    buffer_store_dwordx4 v[4:7], v171, s[28:31], 0 offen sc1
    s_waitcnt lgkmcnt(0)
    buffer_store_dwordx4 v[8:11], v172, s[28:31], 0 offen sc1
L_end:
    s_endpgm
L_slow:
    s_mov_b32 s53, s47
    s_mov_b32 s47, s46
    s_mov_b32 s46, s45
    s_mov_b32 s45, s44
    s_mov_b32 s44, s53
    v_fma_f32 v45, v20, v20, s42
    v_fmac_f32 v45, v21, v21
    v_fmac_f32 v45, v22, v22
    v_fmac_f32 v45, v23, v23
    v_fmac_f32 v45, v12, v12
    v_fmac_f32 v45, v13, v13
    v_fmac_f32 v45, v14, v14
    v_fmac_f32 v45, v15, v15
    v_fmac_f32 v45, v16, v16
    v_fmac_f32 v45, v17, v17
    v_fmac_f32 v45, v18, v18
    v_fmac_f32 v45, v19, v19
    v_fma_f32 v60, v24, v24, s42
    v_fmac_f32 v60, v25, v25
    v_fmac_f32 v60, v26, v26
    v_fmac_f32 v60, v27, v27
    v_fmac_f32 v60, v32, v32
    v_fmac_f32 v60, v33, v33
    v_fmac_f32 v60, v34, v34
    v_fmac_f32 v60, v35, v35
    v_fmac_f32 v60, v36, v36
    v_fmac_f32 v60, v37, v37
    v_fmac_f32 v60, v38, v38
    v_fmac_f32 v60, v39, v39
    v_cvt_pk_bf16_f32 v60, v45, v60
    s_sub_u32 s48, s44, s46
    s_sub_u32 s49, s46, s45
    s_waitcnt vmcnt(10)
    s_barrier
    v_add_u32 v208, s48, v208
    v_add_u32 v209, s48, v209
    v_fma_f32 v6, v48, v48, s42
    v_fmac_f32 v6, v49, v49
    v_fmac_f32 v6, v50, v50
    v_fmac_f32 v6, v51, v51
    v_fmac_f32 v6, v40, v40
    v_fmac_f32 v6, v41, v41
    v_fmac_f32 v6, v42, v42
    v_fmac_f32 v6, v43, v43
    v_fmac_f32 v6, v44, v44
    v_fmac_f32 v6, v45, v45
    v_fmac_f32 v6, v46, v46
    v_fmac_f32 v6, v47, v47
    v_cvt_pk_bf16_f32 v61, v6, v6
    ds_read_b128 v[108:111], v208 offset:0
    ds_read_b128 v[2:5], v209 offset:0
    ds_read_b128 v[96:99], v208 offset:128
    ds_read_b128 v[80:83], v209 offset:128
    ds_read_b128 v[68:71], v208 offset:256
    ds_read_b128 v[28:31], v209 offset:256
    ds_write_b64 v216, v[60:61]
    v_add_u32 v210, s49, v210
    v_add_u32 v211, s49, v211
    s_waitcnt lgkmcnt(6)
    v_mfma_f32_16x16x32_bf16 v[52:55], a[0:3], v[108:111], 0
    s_nop 7
.p2align 6
L_loopS:
    s_waitcnt lgkmcnt(5)
    v_mfma_f32_16x16x32_bf16 v[52:55], a[4:7], v[2:5], v[52:55]
    s_waitcnt lgkmcnt(0)
    v_mfma_f32_16x16x32_bf16 v[52:55], a[8:11], v[96:99], v[52:55]
    s_barrier
    ds_read_b128 v[56:59], v217 offset:0
    ds_read_b128 v[72:75], v217 offset:1024
    v_mfma_f32_16x16x32_bf16 v[52:55], a[12:15], v[80:83], v[52:55]
    v_mfma_f32_16x16x32_bf16 v[52:55], a[16:19], v[68:71], v[52:55]
    v_mfma_f32_16x16x32_bf16 v[52:55], a[20:23], v[28:31], v[52:55]
    v_mfma_f32_16x16x32_bf16 v[64:67], a[24:27], v[108:111], 0
    v_mfma_f32_16x16x32_bf16 v[64:67], a[28:31], v[2:5], v[64:67]
    v_mfma_f32_16x16x32_bf16 v[64:67], a[32:35], v[96:99], v[64:67]
    v_mfma_f32_16x16x32_bf16 v[64:67], a[36:39], v[80:83], v[64:67]
    v_mfma_f32_16x16x32_bf16 v[64:67], a[40:43], v[68:71], v[64:67]
    v_mfma_f32_16x16x32_bf16 v[64:67], a[44:47], v[28:31], v[64:67]
    v_mfma_f32_16x16x32_bf16 v[6:9], a[48:51], v[108:111], 0
    v_mfma_f32_16x16x32_bf16 v[6:9], a[52:55], v[2:5], v[6:9]
    v_fma_f32 v0, v52, v52, s41
    v_fmac_f32 v0, v53, v53
    v_mfma_f32_16x16x32_bf16 v[6:9], a[56:59], v[96:99], v[6:9]
    v_fmac_f32 v0, v54, v54
    v_fmac_f32 v0, v55, v55
    v_mfma_f32_16x16x32_bf16 v[6:9], a[60:63], v[80:83], v[6:9]
    v_fmac_f32 v0, v64, v64
    v_fmac_f32 v0, v65, v65
    v_mfma_f32_16x16x32_bf16 v[6:9], a[64:67], v[68:71], v[6:9]
    v_fmac_f32 v0, v66, v66
    v_fmac_f32 v0, v67, v67
    v_mfma_f32_16x16x32_bf16 v[6:9], a[68:71], v[28:31], v[6:9]
    v_mfma_f32_16x16x32_bf16 v[100:103], a[72:75], v[108:111], 0
    v_mfma_f32_16x16x32_bf16 v[100:103], a[76:79], v[2:5], v[100:103]
    v_mfma_f32_16x16x32_bf16 v[100:103], a[80:83], v[96:99], v[100:103]
    v_mfma_f32_16x16x32_bf16 v[100:103], a[84:87], v[80:83], v[100:103]
    v_mfma_f32_16x16x32_bf16 v[100:103], a[88:91], v[68:71], v[100:103]
    v_mfma_f32_16x16x32_bf16 v[100:103], a[92:95], v[28:31], v[100:103]
    v_mfma_f32_16x16x32_bf16 v[60:63], a[96:99], v[108:111], 0
    v_mfma_f32_16x16x32_bf16 v[60:63], a[100:103], v[2:5], v[60:63]
    v_fmac_f32 v0, v6, v6
    v_fmac_f32 v0, v7, v7
    v_mfma_f32_16x16x32_bf16 v[60:63], a[104:107], v[96:99], v[60:63]
    v_fmac_f32 v0, v8, v8
    v_fmac_f32 v0, v9, v9
    v_mfma_f32_16x16x32_bf16 v[60:63], a[108:111], v[80:83], v[60:63]
    v_fma_f32 v1, v100, v100, s41
    v_fmac_f32 v1, v101, v101
    v_mfma_f32_16x16x32_bf16 v[60:63], a[112:115], v[68:71], v[60:63]
    v_fmac_f32 v1, v102, v102
    v_fmac_f32 v1, v103, v103
    v_mfma_f32_16x16x32_bf16 v[60:63], a[116:119], v[28:31], v[60:63]
    v_mfma_f32_16x16x32_bf16 v[104:107], a[120:123], v[108:111], 0
    v_mfma_f32_16x16x32_bf16 v[104:107], a[124:127], v[2:5], v[104:107]
    v_mfma_f32_16x16x32_bf16 v[104:107], a[128:131], v[96:99], v[104:107]
    v_mfma_f32_16x16x32_bf16 v[104:107], a[132:135], v[80:83], v[104:107]
    v_mfma_f32_16x16x32_bf16 v[104:107], a[136:139], v[68:71], v[104:107]
    v_mfma_f32_16x16x32_bf16 v[104:107], a[140:143], v[28:31], v[104:107]
    s_waitcnt lgkmcnt(1)
    v_mfma_f32_16x16x32_bf16 v[112:115], v[200:203], v[56:59], 0
    s_waitcnt lgkmcnt(0)
    v_mfma_f32_16x16x32_bf16 v[112:115], v[200:203], v[72:75], v[112:115]
    v_fmac_f32 v1, v60, v60
    v_fmac_f32 v1, v61, v61
    v_mfma_f32_16x16x32_bf16 v[116:119], v[108:111], a[144:147], 0
    v_fmac_f32 v1, v62, v62
    v_fmac_f32 v1, v63, v63
    v_mfma_f32_16x16x32_bf16 v[116:119], v[2:5], a[148:151], v[116:119]
    v_fmac_f32 v1, v104, v104
    v_fmac_f32 v1, v105, v105
    v_mfma_f32_16x16x32_bf16 v[116:119], v[96:99], a[152:155], v[116:119]
    v_rsq_f32 v112, v112
    v_mfma_f32_16x16x32_bf16 v[116:119], v[80:83], a[156:159], v[116:119]
    v_rsq_f32 v113, v113
    v_mfma_f32_16x16x32_bf16 v[116:119], v[68:71], a[160:163], v[116:119]
    ds_read_b128 v[92:95], v208 offset:1536
    ds_read_b128 v[88:91], v209 offset:1536
    v_mfma_f32_16x16x32_bf16 v[116:119], v[28:31], a[164:167], v[116:119]
    ds_read_b128 v[84:87], v208 offset:1664
    ds_read_b128 v[76:79], v209 offset:1664
    v_mfma_f32_16x16x32_bf16 v[124:127], v[108:111], a[168:171], 0
    ds_read_b128 v[72:75], v208 offset:1792
    ds_read_b128 v[56:59], v209 offset:1792
    v_mfma_f32_16x16x32_bf16 v[124:127], v[2:5], a[172:175], v[124:127]
    v_rsq_f32 v114, v114
    v_mfma_f32_16x16x32_bf16 v[124:127], v[96:99], a[176:179], v[124:127]
    v_mul_f32 v112, s43, v112
    v_mul_f32 v113, s43, v113
    v_mfma_f32_16x16x32_bf16 v[124:127], v[80:83], a[180:183], v[124:127]
    v_mul_f32 v114, s43, v114
    v_fmac_f32 v1, v106, v106
    v_mfma_f32_16x16x32_bf16 v[124:127], v[68:71], a[184:187], v[124:127]
    v_fmac_f32 v1, v107, v107
    v_cvt_pk_bf16_f32 v194, v0, v1
    v_mfma_f32_16x16x32_bf16 v[124:127], v[28:31], a[188:191], v[124:127]
    v_cvt_pk_bf16_f32 v0, v116, v117
    v_cvt_pk_bf16_f32 v1, v118, v119
    v_mfma_f32_16x16x16_bf16 v[120:123], v[200:201], v[194:195], 0
    v_mul_f32 v20, v20, v112
    v_mul_f32 v21, v21, v112
    v_mfma_f32_16x16x32_bf16 v[116:119], v[108:111], a[192:195], 0
    v_cvt_pk_bf16_f32 v10, v20, v21
    v_mul_f32 v22, v22, v112
    v_mfma_f32_16x16x32_bf16 v[116:119], v[2:5], a[196:199], v[116:119]
    v_cvt_pk_bf16_f32 v4, v124, v125
    v_cvt_pk_bf16_f32 v5, v126, v127
    v_mfma_f32_16x16x32_bf16 v[116:119], v[96:99], a[200:203], v[116:119]
    v_rsq_f32 v120, v120
    v_mfma_f32_16x16x32_bf16 v[116:119], v[80:83], a[204:207], v[116:119]
    v_rsq_f32 v121, v121
    v_mfma_f32_16x16x32_bf16 v[116:119], v[68:71], a[208:211], v[116:119]
    v_mul_f32 v120, s40, v120
    v_mul_f32 v52, v52, v120
    v_mfma_f32_16x16x32_bf16 v[116:119], v[28:31], a[212:215], v[116:119]
    s_waitcnt lgkmcnt(5)
    v_mul_f32 v53, v53, v120
    v_cvt_pk_bf16_f32 v52, v52, v53
    v_mfma_f32_16x16x32_bf16 v[80:83], a[0:3], v[92:95], 0
    s_waitcnt lgkmcnt(4)
    v_mul_f32 v54, v54, v120
    v_mul_f32 v55, v55, v120
    v_mfma_f32_16x16x32_bf16 v[80:83], a[4:7], v[88:91], v[80:83]
    s_waitcnt lgkmcnt(3)
    v_cvt_pk_bf16_f32 v53, v54, v55
    v_mul_f32 v64, v64, v120
    v_mfma_f32_16x16x32_bf16 v[80:83], a[8:11], v[84:87], v[80:83]
    s_waitcnt lgkmcnt(2)
    v_mul_f32 v65, v65, v120
    v_cvt_pk_bf16_f32 v54, v64, v65
    v_mfma_f32_16x16x32_bf16 v[80:83], a[12:15], v[76:79], v[80:83]
    s_waitcnt lgkmcnt(1)
    v_mul_f32 v66, v66, v120
    v_mul_f32 v67, v67, v120
    v_mfma_f32_16x16x32_bf16 v[80:83], a[16:19], v[72:75], v[80:83]
    s_waitcnt lgkmcnt(0)
    v_cvt_pk_bf16_f32 v55, v66, v67
    v_mul_f32 v6, v6, v120
    v_mfma_f32_16x16x32_bf16 v[80:83], a[20:23], v[56:59], v[80:83]
    v_mul_f32 v7, v7, v120
    v_cvt_pk_bf16_f32 v70, v6, v7
    v_mfma_f32_16x16x32_bf16 v[96:99], a[24:27], v[92:95], 0
    v_mul_f32 v8, v8, v120
    v_mul_f32 v9, v9, v120
    v_mfma_f32_16x16x32_bf16 v[96:99], a[28:31], v[88:91], v[96:99]
    v_cvt_pk_bf16_f32 v71, v8, v9
    v_mul_f32 v100, v100, v121
    v_mfma_f32_16x16x32_bf16 v[96:99], a[32:35], v[84:87], v[96:99]
    v_mul_f32 v101, v101, v121
    v_cvt_pk_bf16_f32 v28, v100, v101
    v_mfma_f32_16x16x32_bf16 v[96:99], a[36:39], v[76:79], v[96:99]
    v_mul_f32 v102, v102, v121
    v_mul_f32 v103, v103, v121
    v_mfma_f32_16x16x32_bf16 v[96:99], a[40:43], v[72:75], v[96:99]
    v_cvt_pk_bf16_f32 v29, v102, v103
    v_mul_f32 v60, v60, v121
    v_mfma_f32_16x16x32_bf16 v[96:99], a[44:47], v[56:59], v[96:99]
    v_mul_f32 v61, v61, v121
    v_cvt_pk_bf16_f32 v30, v60, v61
    v_mfma_f32_16x16x32_bf16 v[100:103], a[48:51], v[92:95], 0
    v_mul_f32 v62, v62, v121
    v_mul_f32 v63, v63, v121
    v_mfma_f32_16x16x32_bf16 v[100:103], a[52:55], v[88:91], v[100:103]
    v_cvt_pk_bf16_f32 v31, v62, v63
    v_mul_f32 v104, v104, v121
    v_mfma_f32_16x16x32_bf16 v[100:103], a[56:59], v[84:87], v[100:103]
    v_mul_f32 v105, v105, v121
    v_cvt_pk_bf16_f32 v60, v104, v105
    v_mfma_f32_16x16x32_bf16 v[100:103], a[60:63], v[76:79], v[100:103]
    v_mul_f32 v106, v106, v121
    v_mul_f32 v107, v107, v121
    v_mfma_f32_16x16x32_bf16 v[100:103], a[64:67], v[72:75], v[100:103]
    v_cvt_pk_bf16_f32 v61, v106, v107
    v_cvt_pk_bf16_f32 v8, v116, v117
    v_mfma_f32_16x16x32_bf16 v[100:103], a[68:71], v[56:59], v[100:103]
    v_cvt_pk_bf16_f32 v9, v118, v119
    v_mul_f32 v23, v23, v112
    v_mfma_f32_16x16x32_bf16 v[104:107], a[72:75], v[92:95], 0
    v_cvt_pk_bf16_f32 v11, v22, v23
    v_mul_f32 v12, v12, v112
    v_mfma_f32_16x16x32_bf16 v[104:107], a[76:79], v[88:91], v[104:107]
    v_mul_f32 v13, v13, v112
    v_cvt_pk_bf16_f32 v12, v12, v13
    v_mfma_f32_16x16x32_bf16 v[104:107], a[80:83], v[84:87], v[104:107]
    v_mul_f32 v14, v14, v112
    v_mul_f32 v15, v15, v112
    v_mfma_f32_16x16x32_bf16 v[104:107], a[84:87], v[76:79], v[104:107]
    v_cvt_pk_bf16_f32 v13, v14, v15
    v_mul_f32 v16, v16, v112
    v_mfma_f32_16x16x32_bf16 v[104:107], a[88:91], v[72:75], v[104:107]
    ds_write_b128 v210, v[10:13] offset:0
    v_mfma_f32_16x16x32_bf16 v[104:107], a[92:95], v[56:59], v[104:107]
    v_mul_f32 v17, v17, v112
    v_cvt_pk_bf16_f32 v6, v16, v17
    v_mfma_f32_16x16x32_bf16 v[108:111], a[96:99], v[92:95], 0
    v_mul_f32 v18, v18, v112
    v_mul_f32 v19, v19, v112
    v_mfma_f32_16x16x32_bf16 v[108:111], a[100:103], v[88:91], v[108:111]
    v_cvt_pk_bf16_f32 v7, v18, v19
    v_fma_f32 v2, v80, v80, s41
    v_mfma_f32_16x16x32_bf16 v[108:111], a[104:107], v[84:87], v[108:111]
    ds_write_b64 v211, v[6:7] offset:0
    v_mfma_f32_16x16x32_bf16 v[108:111], a[108:111], v[76:79], v[108:111]
    v_fmac_f32 v2, v81, v81
    v_fmac_f32 v2, v82, v82
    v_mfma_f32_16x16x32_bf16 v[108:111], a[112:115], v[72:75], v[108:111]
    v_fmac_f32 v2, v83, v83
    v_fmac_f32 v2, v96, v96
    v_mfma_f32_16x16x32_bf16 v[108:111], a[116:119], v[56:59], v[108:111]
    v_fmac_f32 v2, v97, v97
    v_fmac_f32 v2, v98, v98
    v_mfma_f32_16x16x32_bf16 v[116:119], a[120:123], v[92:95], 0
    v_fmac_f32 v2, v99, v99
    v_fmac_f32 v2, v100, v100
    v_mfma_f32_16x16x32_bf16 v[116:119], a[124:127], v[88:91], v[116:119]
    v_fmac_f32 v2, v101, v101
    v_fmac_f32 v2, v102, v102
    v_mfma_f32_16x16x32_bf16 v[116:119], a[128:131], v[84:87], v[116:119]
    v_fmac_f32 v2, v103, v103
    v_mul_f32 v24, v24, v113
    v_mfma_f32_16x16x32_bf16 v[116:119], a[132:135], v[76:79], v[116:119]
    v_mul_f32 v25, v25, v113
    v_cvt_pk_bf16_f32 v10, v24, v25
    v_mfma_f32_16x16x32_bf16 v[116:119], a[136:139], v[72:75], v[116:119]
    v_mul_f32 v26, v26, v113
    v_mul_f32 v27, v27, v113
    v_mfma_f32_16x16x32_bf16 v[116:119], a[140:143], v[56:59], v[116:119]
    v_cvt_pk_bf16_f32 v11, v26, v27
    v_mul_f32 v32, v32, v113
    v_mfma_f32_16x16x32_bf16 v[120:123], v[92:95], a[144:147], 0
    v_mul_f32 v33, v33, v113
    v_cvt_pk_bf16_f32 v12, v32, v33
    v_mfma_f32_16x16x32_bf16 v[120:123], v[88:91], a[148:151], v[120:123]
    v_mul_f32 v34, v34, v113
    v_mul_f32 v35, v35, v113
    v_mfma_f32_16x16x32_bf16 v[120:123], v[84:87], a[152:155], v[120:123]
    v_cvt_pk_bf16_f32 v13, v34, v35
    v_mul_f32 v36, v36, v113
    v_mfma_f32_16x16x32_bf16 v[120:123], v[76:79], a[156:159], v[120:123]
    ds_write_b128 v210, v[10:13] offset:1536
    v_mfma_f32_16x16x32_bf16 v[120:123], v[72:75], a[160:163], v[120:123]
    ds_read_b128 v[66:69], v208 offset:3072
    ds_read_b128 v[62:65], v209 offset:3072
    v_mfma_f32_16x16x32_bf16 v[120:123], v[56:59], a[164:167], v[120:123]
    ds_read_b128 v[24:27], v208 offset:3200
    ds_read_b128 v[16:19], v209 offset:3200
    v_mfma_f32_16x16x32_bf16 v[32:35], v[92:95], a[168:171], 0
    ds_read_b128 v[20:23], v208 offset:3328
    ds_read_b128 v[12:15], v209 offset:3328
    v_mfma_f32_16x16x32_bf16 v[32:35], v[88:91], a[172:175], v[32:35]
    v_mul_f32 v37, v37, v113
    v_cvt_pk_bf16_f32 v6, v36, v37
    v_mfma_f32_16x16x32_bf16 v[32:35], v[84:87], a[176:179], v[32:35]
    v_mul_f32 v38, v38, v113
    v_mul_f32 v39, v39, v113
    v_mfma_f32_16x16x32_bf16 v[32:35], v[76:79], a[180:183], v[32:35]
    v_cvt_pk_bf16_f32 v7, v38, v39
    v_fma_f32 v3, v104, v104, s41
    v_mfma_f32_16x16x32_bf16 v[32:35], v[72:75], a[184:187], v[32:35]
    ds_write_b64 v211, v[6:7] offset:1536
    v_mfma_f32_16x16x32_bf16 v[32:35], v[56:59], a[188:191], v[32:35]
    v_fmac_f32 v3, v105, v105
    v_fmac_f32 v3, v106, v106
    v_fmac_f32 v3, v107, v107
    v_mfma_f32_16x16x32_bf16 v[124:127], v[92:95], a[192:195], 0
    v_fmac_f32 v3, v108, v108
    v_fmac_f32 v3, v109, v109
    v_mfma_f32_16x16x32_bf16 v[124:127], v[88:91], a[196:199], v[124:127]
    v_fmac_f32 v3, v110, v110
    v_fmac_f32 v3, v111, v111
    v_mfma_f32_16x16x32_bf16 v[124:127], v[84:87], a[200:203], v[124:127]
    v_fmac_f32 v3, v116, v116
    v_fmac_f32 v3, v117, v117
    v_mfma_f32_16x16x32_bf16 v[124:127], v[76:79], a[204:207], v[124:127]
    v_fmac_f32 v3, v118, v118
    v_fmac_f32 v3, v119, v119
    v_mfma_f32_16x16x32_bf16 v[124:127], v[72:75], a[208:211], v[124:127]
    v_cvt_pk_bf16_f32 v194, v2, v3
    v_cvt_pk_bf16_f32 v2, v120, v121
    v_mfma_f32_16x16x32_bf16 v[124:127], v[56:59], a[212:215], v[124:127]
    v_cvt_pk_bf16_f32 v3, v122, v123
    v_cvt_pk_bf16_f32 v6, v32, v33
    v_mfma_f32_16x16x16_bf16 v[84:87], v[200:201], v[194:195], 0
    s_waitcnt lgkmcnt(6)
    s_sub_u32 s50, s45, s44
    v_cvt_pk_bf16_f32 v7, v34, v35
    v_mul_f32 v48, v48, v114
    v_mfma_f32_16x16x32_bf16 v[36:39], a[0:3], v[66:69], 0
    s_waitcnt lgkmcnt(5)
    s_sub_u32 s51, s46, s47
    v_mul_f32 v49, v49, v114
    v_cvt_pk_bf16_f32 v88, v48, v49
    v_mfma_f32_16x16x32_bf16 v[36:39], a[4:7], v[62:65], v[36:39]
    s_waitcnt lgkmcnt(4)
    s_mov_b32 s60, s59
    v_cvt_pk_bf16_f32 v10, v124, v125
    v_cvt_pk_bf16_f32 v11, v126, v127
    v_mfma_f32_16x16x32_bf16 v[36:39], a[8:11], v[24:27], v[36:39]
    s_waitcnt lgkmcnt(3)
    s_mov_b32 s59, s58
    v_rsq_f32 v84, v84
    v_mfma_f32_16x16x32_bf16 v[36:39], a[12:15], v[16:19], v[36:39]
    s_waitcnt lgkmcnt(2)
    s_mov_b32 s58, s57
    v_rsq_f32 v85, v85
    v_mfma_f32_16x16x32_bf16 v[36:39], a[16:19], v[20:23], v[36:39]
    s_waitcnt lgkmcnt(1)
    s_mov_b32 s57, s56
    v_mul_f32 v84, s40, v84
    v_mul_f32 v80, v80, v84
    v_mfma_f32_16x16x32_bf16 v[36:39], a[20:23], v[12:15], v[36:39]
    s_add_u32 s56, s56, s62
    v_mul_f32 v81, v81, v84
    v_cvt_pk_bf16_f32 v32, v80, v81
    v_mfma_f32_16x16x32_bf16 v[72:75], a[24:27], v[66:69], 0
    s_add_u32 s61, s61, 1
    v_mul_f32 v82, v82, v84
    v_mul_f32 v83, v83, v84
    v_mfma_f32_16x16x32_bf16 v[72:75], a[28:31], v[62:65], v[72:75]
    s_cmp_eq_u32 s61, 72
    v_cvt_pk_bf16_f32 v33, v82, v83
    v_mul_f32 v96, v96, v84
    v_mfma_f32_16x16x32_bf16 v[72:75], a[32:35], v[24:27], v[72:75]
    s_cselect_b32 s53, s63, 0
    v_mul_f32 v97, v97, v84
    v_cvt_pk_bf16_f32 v34, v96, v97
    v_mfma_f32_16x16x32_bf16 v[72:75], a[36:39], v[16:19], v[72:75]
    s_cselect_b32 s61, 0, s61
    v_mul_f32 v98, v98, v84
    v_mul_f32 v99, v99, v84
    v_mfma_f32_16x16x32_bf16 v[72:75], a[40:43], v[20:23], v[72:75]
    s_add_u32 s56, s56, s53
    v_cvt_pk_bf16_f32 v35, v98, v99
    v_mul_f32 v100, v100, v84
    v_mfma_f32_16x16x32_bf16 v[72:75], a[44:47], v[12:15], v[72:75]
    s_sub_u32 s64, s64, 1
    v_mul_f32 v101, v101, v84
    v_cvt_pk_bf16_f32 v112, v100, v101
    v_mfma_f32_16x16x32_bf16 v[76:79], a[48:51], v[66:69], 0
    s_cmp_gt_i32 s64, 0
    v_mul_f32 v102, v102, v84
    v_mul_f32 v103, v103, v84
    v_mfma_f32_16x16x32_bf16 v[76:79], a[52:55], v[62:65], v[76:79]
    s_cselect_b32 s26, 100270464, 0
    v_cvt_pk_bf16_f32 v113, v102, v103
    v_mul_f32 v104, v104, v85
    v_mfma_f32_16x16x32_bf16 v[76:79], a[56:59], v[24:27], v[76:79]
    s_cselect_b32 s56, s56, 0
    v_mul_f32 v105, v105, v85
    v_cvt_pk_bf16_f32 v56, v104, v105
    v_mfma_f32_16x16x32_bf16 v[76:79], a[60:63], v[16:19], v[76:79]
    s_add_u32 s65, s65, 1
    v_mul_f32 v106, v106, v85
    v_mul_f32 v107, v107, v85
    v_mfma_f32_16x16x32_bf16 v[76:79], a[64:67], v[20:23], v[76:79]
    s_cmp_ge_i32 s65, 2
    v_cvt_pk_bf16_f32 v57, v106, v107
    v_mul_f32 v108, v108, v85
    v_mfma_f32_16x16x32_bf16 v[76:79], a[68:71], v[12:15], v[76:79]
    s_cselect_b32 s30, 100270464, 0
    v_mul_f32 v109, v109, v85
    v_cvt_pk_bf16_f32 v58, v108, v109
    v_mfma_f32_16x16x32_bf16 v[80:83], a[72:75], v[66:69], 0
    s_add_u32 s67, s46, s54
    v_mul_f32 v110, v110, v85
    v_mul_f32 v111, v111, v85
    v_mfma_f32_16x16x32_bf16 v[80:83], a[76:79], v[62:65], v[80:83]
    s_add_u32 m0, s67, 0
    v_cvt_pk_bf16_f32 v59, v110, v111
    v_mul_f32 v116, v116, v85
    v_mfma_f32_16x16x32_bf16 v[80:83], a[80:83], v[24:27], v[80:83]
    v_mul_f32 v117, v117, v85
    v_cvt_pk_bf16_f32 v48, v116, v117
    v_mfma_f32_16x16x32_bf16 v[80:83], a[84:87], v[16:19], v[80:83]
    v_mul_f32 v118, v118, v85
    v_mul_f32 v119, v119, v85
    v_mfma_f32_16x16x32_bf16 v[80:83], a[88:91], v[20:23], v[80:83]
    v_cvt_pk_bf16_f32 v49, v118, v119
    v_mul_f32 v50, v50, v114
    v_mfma_f32_16x16x32_bf16 v[80:83], a[92:95], v[12:15], v[80:83]
    v_mul_f32 v51, v51, v114
    v_cvt_pk_bf16_f32 v89, v50, v51
    v_mfma_f32_16x16x32_bf16 v[84:87], a[96:99], v[66:69], 0
    v_mul_f32 v40, v40, v114
    v_mul_f32 v41, v41, v114
    v_mfma_f32_16x16x32_bf16 v[84:87], a[100:103], v[62:65], v[84:87]
    v_cvt_pk_bf16_f32 v90, v40, v41
    v_mul_f32 v42, v42, v114
    v_mfma_f32_16x16x32_bf16 v[84:87], a[104:107], v[24:27], v[84:87]
    v_mul_f32 v43, v43, v114
    v_cvt_pk_bf16_f32 v91, v42, v43
    v_mfma_f32_16x16x32_bf16 v[84:87], a[108:111], v[16:19], v[84:87]
    ds_write_b128 v210, v[88:91] offset:3072
    v_mfma_f32_16x16x32_bf16 v[84:87], a[112:115], v[20:23], v[84:87]
    v_mul_f32 v44, v44, v114
    v_mul_f32 v45, v45, v114
    v_mfma_f32_16x16x32_bf16 v[84:87], a[116:119], v[12:15], v[84:87]
    v_cvt_pk_bf16_f32 v40, v44, v45
    v_mul_f32 v46, v46, v114
    v_mfma_f32_16x16x32_bf16 v[88:91], a[120:123], v[66:69], 0
    v_mul_f32 v47, v47, v114
    v_cvt_pk_bf16_f32 v41, v46, v47
    v_mfma_f32_16x16x32_bf16 v[88:91], a[124:127], v[62:65], v[88:91]
    ds_write_b64 v211, v[40:41] offset:3072
    v_mfma_f32_16x16x32_bf16 v[88:91], a[128:131], v[24:27], v[88:91]
    v_fma_f32 v50, v36, v36, s41
    v_fmac_f32 v50, v37, v37
    v_mfma_f32_16x16x32_bf16 v[88:91], a[132:135], v[16:19], v[88:91]
    v_fmac_f32 v50, v38, v38
    v_fmac_f32 v50, v39, v39
    v_mfma_f32_16x16x32_bf16 v[88:91], a[136:139], v[20:23], v[88:91]
    v_fmac_f32 v50, v72, v72
    v_fmac_f32 v50, v73, v73
    v_mfma_f32_16x16x32_bf16 v[88:91], a[140:143], v[12:15], v[88:91]
    v_fmac_f32 v50, v74, v74
    v_fmac_f32 v50, v75, v75
    v_mfma_f32_16x16x32_bf16 v[40:43], v[66:69], a[144:147], 0
    v_fmac_f32 v50, v76, v76
    v_fmac_f32 v50, v77, v77
    v_mfma_f32_16x16x32_bf16 v[40:43], v[62:65], a[148:151], v[40:43]
    v_fmac_f32 v50, v78, v78
    v_fmac_f32 v50, v79, v79
    v_mfma_f32_16x16x32_bf16 v[40:43], v[24:27], a[152:155], v[40:43]
    v_fma_f32 v51, v80, v80, s41
    v_fmac_f32 v51, v81, v81
    v_mfma_f32_16x16x32_bf16 v[40:43], v[16:19], a[156:159], v[40:43]
    s_waitcnt lgkmcnt(0)
    v_fmac_f32 v51, v82, v82
    v_fmac_f32 v51, v83, v83
    v_mfma_f32_16x16x32_bf16 v[40:43], v[20:23], a[160:163], v[40:43]
    s_barrier
    v_fmac_f32 v51, v84, v84
    v_fmac_f32 v51, v85, v85
    v_mfma_f32_16x16x32_bf16 v[40:43], v[12:15], a[164:167], v[40:43]
    v_fmac_f32 v51, v86, v86
    v_fmac_f32 v51, v87, v87
    v_mfma_f32_16x16x32_bf16 v[44:47], v[66:69], a[168:171], 0
    v_fmac_f32 v51, v88, v88
    v_fmac_f32 v51, v89, v89
    v_mfma_f32_16x16x32_bf16 v[44:47], v[62:65], a[172:175], v[44:47]
    v_fmac_f32 v51, v90, v90
    v_fmac_f32 v51, v91, v91
    v_mfma_f32_16x16x32_bf16 v[44:47], v[24:27], a[176:179], v[44:47]
    v_cvt_pk_bf16_f32 v194, v50, v51
    v_cvt_pk_bf16_f32 v188, v40, v41
    v_mfma_f32_16x16x32_bf16 v[44:47], v[16:19], a[180:183], v[44:47]
    v_cvt_pk_bf16_f32 v189, v42, v43
    v_add_u32 v208, s50, v208
    v_mfma_f32_16x16x32_bf16 v[44:47], v[20:23], a[184:187], v[44:47]
    ds_read_b128 v[108:111], v208 offset:0
    ds_read_b128 v[96:99], v208 offset:128
    v_mfma_f32_16x16x32_bf16 v[44:47], v[12:15], a[188:191], v[44:47]
    ds_read_b128 v[92:95], v208 offset:256
    v_add_u32 v209, s50, v209
    v_mfma_f32_16x16x16_bf16 v[130:133], v[200:201], v[194:195], 0
    ds_read_b128 v[126:129], v209 offset:0
    ds_read_b128 v[104:107], v209 offset:128
    v_mfma_f32_16x16x32_bf16 v[100:103], v[66:69], a[192:195], 0
    ds_read_b128 v[66:69], v209 offset:256
    v_add_u32 v210, s48, v210
    v_mfma_f32_16x16x32_bf16 v[100:103], v[62:65], a[196:199], v[100:103]
    v_cvt_pk_bf16_f32 v184, v44, v45
    v_cvt_pk_bf16_f32 v185, v46, v47
    v_mfma_f32_16x16x32_bf16 v[100:103], v[24:27], a[200:203], v[100:103]
    v_rsq_f32 v130, v130
    v_mfma_f32_16x16x32_bf16 v[100:103], v[16:19], a[204:207], v[100:103]
    v_rsq_f32 v131, v131
    v_mfma_f32_16x16x32_bf16 v[100:103], v[20:23], a[208:211], v[100:103]
    v_mul_f32 v130, s40, v130
    v_mul_f32 v80, v80, v131
    v_mfma_f32_16x16x32_bf16 v[100:103], v[12:15], a[212:215], v[100:103]
    s_waitcnt lgkmcnt(5)
    v_mul_f32 v81, v81, v131
    v_cvt_pk_bf16_f32 v40, v80, v81
    v_mul_f32 v82, v82, v131
    v_mfma_f32_16x16x32_bf16 v[20:23], a[216:219], v[108:111], 0
    s_waitcnt lgkmcnt(2)
    v_mul_f32 v83, v83, v131
    v_cvt_pk_bf16_f32 v41, v82, v83
    v_mul_f32 v84, v84, v131
    v_mul_f32 v85, v85, v131
    v_cvt_pk_bf16_f32 v42, v84, v85
    v_mul_f32 v86, v86, v131
    v_mfma_f32_16x16x32_bf16 v[20:23], a[220:223], v[126:129], v[20:23]
    v_mul_f32 v87, v87, v131
    v_cvt_pk_bf16_f32 v43, v86, v87
    v_mfma_f32_16x16x32_bf16 v[20:23], a[224:227], v[96:99], v[20:23]
    s_waitcnt lgkmcnt(1)
    v_mul_f32 v88, v88, v131
    v_mul_f32 v89, v89, v131
    v_mfma_f32_16x16x32_bf16 v[20:23], a[228:231], v[104:107], v[20:23]
    ds_read_b128 v[122:125], v213 offset:0
    v_cvt_pk_bf16_f32 v50, v88, v89
    v_mfma_f32_16x16x32_bf16 v[20:23], a[232:235], v[92:95], v[20:23]
    s_waitcnt lgkmcnt(1)
    ds_read_b128 v[118:121], v213 offset:1024
    v_mul_f32 v90, v90, v131
    v_mfma_f32_16x16x32_bf16 v[20:23], a[236:239], v[66:69], v[20:23]
    ds_read_b128 v[114:117], v213 offset:2048
    v_mul_f32 v91, v91, v131
    v_mfma_f32_16x16x32_bf16 v[12:15], a[240:243], v[108:111], 0
    v_cvt_pk_bf16_f32 v51, v90, v91
    v_mul_f32 v36, v36, v130
    v_mfma_f32_16x16x32_bf16 v[12:15], a[244:247], v[126:129], v[12:15]
    v_mul_f32 v37, v37, v130
    v_cvt_pk_bf16_f32 v44, v36, v37
    v_mfma_f32_16x16x32_bf16 v[12:15], a[248:251], v[96:99], v[12:15]
    v_mul_f32 v38, v38, v130
    v_mul_f32 v39, v39, v130
    v_mfma_f32_16x16x32_bf16 v[12:15], a[252:255], v[104:107], v[12:15]
    v_cvt_pk_bf16_f32 v45, v38, v39
    v_mul_f32 v72, v72, v130
    v_mfma_f32_16x16x32_bf16 v[12:15], v[224:227], v[92:95], v[12:15]
    v_mul_f32 v73, v73, v130
    v_cvt_pk_bf16_f32 v46, v72, v73
    v_mfma_f32_16x16x32_bf16 v[12:15], v[228:231], v[66:69], v[12:15]
    v_mul_f32 v74, v74, v130
    v_mul_f32 v75, v75, v130
    v_mfma_f32_16x16x32_bf16 v[16:19], v[232:235], v[108:111], 0
    v_cvt_pk_bf16_f32 v47, v74, v75
    v_mul_f32 v76, v76, v130
    v_mfma_f32_16x16x32_bf16 v[16:19], v[236:239], v[126:129], v[16:19]
    v_mul_f32 v77, v77, v130
    v_cvt_pk_bf16_f32 v108, v76, v77
    v_mfma_f32_16x16x32_bf16 v[16:19], v[240:243], v[96:99], v[16:19]
    v_mul_f32 v78, v78, v130
    v_mul_f32 v79, v79, v130
    v_mfma_f32_16x16x32_bf16 v[16:19], v[244:247], v[104:107], v[16:19]
    v_cvt_pk_bf16_f32 v109, v78, v79
    v_cvt_pk_bf16_f32 v180, v100, v101
    v_mfma_f32_16x16x32_bf16 v[16:19], v[248:251], v[92:95], v[16:19]
    v_cvt_pk_bf16_f32 v181, v102, v103
    v_add_u32 v211, s48, v211
    v_mfma_f32_16x16x32_bf16 v[16:19], v[252:255], v[66:69], v[16:19]
    s_waitcnt lgkmcnt(2)
    v_add_u32 v212, s51, v212
    v_add_u32 v214, 320, v214
    v_mfma_f32_16x16x32_bf16 v[122:125], v[28:31], v[52:55], v[122:125]
    s_waitcnt lgkmcnt(1)
    ds_read_b128 v[62:65], v214 offset:16
    ds_read_b128 v[76:79], v214 offset:32
    v_mfma_f32_16x16x32_bf16 v[118:121], v[56:59], v[52:55], v[118:121]
    s_waitcnt lgkmcnt(2)
    ds_read_b128 v[24:27], v214
    ds_read_b128 v[72:75], v212 offset:0
    v_mfma_f32_16x16x32_bf16 v[114:117], v[40:43], v[52:55], v[114:117]
    ds_read_b128 v[66:69], v212 offset:1024
    ds_read_b128 v[104:107], v208 offset:1536
    v_mfma_f32_16x16x16_bf16 v[122:125], v[60:61], v[70:71], v[122:125]
    ds_read_b128 v[100:103], v209 offset:1536
    ds_read_b128 v[96:99], v208 offset:1664
    v_mfma_f32_16x16x16_bf16 v[118:121], v[48:49], v[70:71], v[118:121]
    ds_read_b128 v[92:95], v209 offset:1664
    ds_read_b128 v[88:91], v208 offset:1792
    v_mfma_f32_16x16x16_bf16 v[114:117], v[50:51], v[70:71], v[114:117]
    s_waitcnt lgkmcnt(9)
    ds_read_b128 v[84:87], v209 offset:1792
    v_add_u32 v215, 320, v215
    v_max3_f32 v110, v122, v123, v124
    ds_read_u16 v190, v215 offset:48
    ds_read_u16 v186, v215 offset:56
    ds_read_u16 v182, v215 offset:64
    v_max3_f32 v110, v110, v125, v118
    v_max3_f32 v110, v110, v119, v120
    v_max3_f32 v110, v110, v121, v114
    v_max3_f32 v110, v110, v115, v116
    v_mfma_f32_16x16x32_bf16 v[132:135], v[62:65], v[52:55], v[204:207]
    s_waitcnt lgkmcnt(11)
    v_mfma_f32_16x16x32_bf16 v[36:39], v[24:27], v[28:31], v[204:207]
    s_waitcnt lgkmcnt(10)
    buffer_load_dwordx4 v218, s[24:27], s56 offen nt lds
    buffer_store_dwordx4 v[72:75], v218, s[28:31], s60 offen sc1
    v_mfma_f32_16x16x32_bf16 v[52:55], v[24:27], v[56:59], v[204:207]
    s_add_u32 m0, s67, 1024
    v_mfma_f32_16x16x32_bf16 v[136:139], v[24:27], v[40:43], v[204:207]
    s_waitcnt lgkmcnt(9)
    buffer_load_dwordx4 v219, s[24:27], s56 offen nt lds
    buffer_store_dwordx4 v[66:69], v219, s[28:31], s60 offen sc1
    v_mfma_f32_16x16x16_bf16 v[132:135], v[78:79], v[70:71], v[132:135]
    s_add_u32 m0, s67, 2048
    ds_read_b128 v[80:83], v213 offset:3072
    ds_read_b128 v[70:73], v213 offset:4096
    v_mfma_f32_16x16x32_bf16 v[128:131], v[24:27], v[62:65], v[204:207]
    ds_read_b128 v[66:69], v213 offset:5120
    v_mfma_f32_16x16x16_bf16 v[36:39], v[76:77], v[60:61], v[36:39]
    v_mfma_f32_16x16x16_bf16 v[52:55], v[76:77], v[48:49], v[52:55]
    v_mfma_f32_16x16x16_bf16 v[136:139], v[76:77], v[50:51], v[136:139]
    s_waitcnt lgkmcnt(11)
    v_mfma_f32_16x16x32_bf16 v[24:27], a[216:219], v[104:107], 0
    s_waitcnt lgkmcnt(10)
    v_max3_f32 v110, v110, v117, v132
    v_mov_b32 v74, v110
    v_mfma_f32_16x16x32_bf16 v[24:27], a[220:223], v[100:103], v[24:27]
    s_waitcnt lgkmcnt(9)
    v_mfma_f32_16x16x32_bf16 v[24:27], a[224:227], v[96:99], v[24:27]
    s_waitcnt lgkmcnt(8)
    v_permlane32_swap_b32 v74, v110
    v_mfma_f32_16x16x32_bf16 v[24:27], a[228:231], v[92:95], v[24:27]
    s_waitcnt lgkmcnt(7)
    v_max_f32 v110, v74, v110
    v_mov_b32 v74, v110
    v_mfma_f32_16x16x32_bf16 v[24:27], a[232:235], v[88:91], v[24:27]
    s_waitcnt lgkmcnt(6)
    v_mov_b32_dpp v39, v55 quad_perm:[0,1,2,3] row_mask:0x2 bank_mask:0xf
    v_permlane16_swap_b32 v74, v110
    v_mfma_f32_16x16x32_bf16 v[24:27], a[236:239], v[84:87], v[24:27]
    v_max_f32 v110, v74, v110
    v_sub_f32 v122, v122, v110
    v_mfma_f32_16x16x16_bf16 v[128:131], v[76:77], v[78:79], v[128:131]
    s_waitcnt lgkmcnt(2)
    v_sub_f32 v123, v123, v110
    v_sub_f32 v124, v124, v110
    v_mfma_f32_16x16x32_bf16 v[80:83], v[28:31], v[32:35], v[80:83]
    s_waitcnt lgkmcnt(1)
    v_sub_f32 v125, v125, v110
    v_sub_f32 v118, v118, v110
    v_mfma_f32_16x16x32_bf16 v[70:73], v[56:59], v[32:35], v[70:73]
    s_waitcnt lgkmcnt(0)
    ds_read_b128 v[52:55], v212 offset:2048
    v_sub_f32 v119, v119, v110
    v_mfma_f32_16x16x32_bf16 v[66:69], v[40:43], v[32:35], v[66:69]
    v_sub_f32 v120, v120, v110
    v_sub_f32 v121, v121, v110
    v_mfma_f32_16x16x32_bf16 v[126:129], v[62:65], v[32:35], v[204:207]
    v_sub_f32 v114, v114, v110
    v_sub_f32 v115, v115, v110
    v_mfma_f32_16x16x16_bf16 v[80:83], v[60:61], v[112:113], v[80:83]
    v_sub_f32 v116, v116, v110
    v_sub_f32 v117, v117, v110
    v_mfma_f32_16x16x16_bf16 v[70:73], v[48:49], v[112:113], v[70:73]
    v_sub_f32 v132, v132, v110
    v_exp_f32 v122, v122
    v_mfma_f32_16x16x16_bf16 v[66:69], v[50:51], v[112:113], v[66:69]
    v_exp_f32 v123, v123
    v_mfma_f32_16x16x16_bf16 v[126:129], v[78:79], v[112:113], v[126:129]
    v_exp_f32 v124, v124
    v_exp_f32 v125, v125
    v_cvt_pk_bf16_f32 v32, v122, v123
    v_cvt_pk_bf16_f32 v33, v124, v125
    v_exp_f32 v118, v118
    v_exp_f32 v119, v119
    v_exp_f32 v120, v120
    v_exp_f32 v121, v121
    v_cvt_pk_bf16_f32 v34, v118, v119
    v_cvt_pk_bf16_f32 v35, v120, v121
    v_exp_f32 v114, v114
    v_exp_f32 v115, v115
    v_exp_f32 v116, v116
    v_exp_f32 v117, v117
    v_cvt_pk_bf16_f32 v192, v114, v115
    v_cvt_pk_bf16_f32 v193, v116, v117
    v_exp_f32 v132, v132
    v_mov_b32_dpp v39, v139 quad_perm:[0,1,2,3] row_mask:0x4 bank_mask:0xf
    v_cvt_pk_bf16_f32 v194, v132, 0
    v_mfma_f32_16x16x32_bf16 v[122:125], v[196:199], v[32:35], 0
    s_waitcnt lgkmcnt(0)
    buffer_load_dwordx4 v220, s[24:27], s56 offen nt lds
    buffer_store_dwordx4 v[52:55], v220, s[28:31], s60 offen sc1
    v_mov_b32_dpp v39, v131 quad_perm:[0,1,2,3] row_mask:0x8 bank_mask:0xf
    v_mov_b32 v36, v39
    v_max3_f32 v126, v80, v81, v82
    v_max3_f32 v126, v126, v83, v70
    v_mfma_f32_16x16x32_bf16 v[122:125], v[196:199], v[192:195], v[122:125]
    s_add_u32 m0, s67, 3072
    v_max_f32_dpp v36, v36, v36 row_ror:8 row_mask:0xf bank_mask:0xf
    v_max3_f32 v126, v126, v71, v72
    v_mfma_f32_16x16x32_bf16 v[110:113], v[0:3], v[32:35], 0
    v_max_f32_dpp v36, v36, v36 row_ror:4 row_mask:0xf bank_mask:0xf
    v_max3_f32 v126, v126, v73, v66
    v_mfma_f32_16x16x32_bf16 v[110:113], v[188:191], v[192:195], v[110:113]
    v_max_f32_dpp v36, v36, v36 row_ror:2 row_mask:0xf bank_mask:0xf
    v_max3_f32 v126, v126, v67, v68
    v_mfma_f32_16x16x32_bf16 v[114:117], v[4:7], v[32:35], 0
    v_max_f32_dpp v36, v36, v36 row_ror:1 row_mask:0xf bank_mask:0xf
    v_mov_b32 v37, v36
    v_mfma_f32_16x16x32_bf16 v[114:117], v[184:187], v[192:195], v[114:117]
    v_max3_f32 v126, v126, v69, v127
    v_permlane32_swap_b32 v37, v36
    v_mfma_f32_16x16x32_bf16 v[118:121], v[8:11], v[32:35], 0
    v_max_f32 v36, v37, v36
    v_mov_b32 v37, v36
    v_mfma_f32_16x16x32_bf16 v[118:121], v[180:183], v[192:195], v[118:121]
    v_mov_b32 v74, v126
    v_permlane16_swap_b32 v37, v36
    v_mfma_f32_16x16x32_bf16 v[32:35], a[240:243], v[104:107], 0
    v_max_f32 v36, v37, v36
    v_sub_f32 v39, v39, v36
    v_mfma_f32_16x16x32_bf16 v[32:35], a[244:247], v[100:103], v[32:35]
    s_mov_b32 s53, s47
    v_exp_f32 v39, v39
    v_mfma_f32_16x16x32_bf16 v[32:35], a[248:251], v[96:99], v[32:35]
    s_mov_b32 s47, s46
    v_cvt_pk_bf16_f32 v39, v39, v39
    v_permlane32_swap_b32 v74, v126
    v_mfma_f32_16x16x32_bf16 v[32:35], a[252:255], v[92:95], v[32:35]
    s_mov_b32 s46, s45
    ds_write_b16 v215, v39
    v_mfma_f32_16x16x32_bf16 v[32:35], v[224:227], v[88:91], v[32:35]
    s_mov_b32 s45, s44
    ds_read_b128 v[132:135], v214
    ds_read_b128 v[128:131], v214 offset:16
    v_mfma_f32_16x16x32_bf16 v[32:35], v[228:231], v[84:87], v[32:35]
    s_mov_b32 s44, s53
    ds_read_b128 v[52:55], v213 offset:6144
    v_max_f32 v126, v74, v126
    v_mfma_f32_16x16x32_bf16 v[36:39], v[232:235], v[104:107], 0
    v_mov_b32 v74, v126
    v_rcp_f32 v122, v122
    v_mfma_f32_16x16x32_bf16 v[36:39], v[236:239], v[100:103], v[36:39]
    v_permlane16_swap_b32 v74, v126
    v_mfma_f32_16x16x32_bf16 v[36:39], v[240:243], v[96:99], v[36:39]
    v_max_f32 v126, v74, v126
    v_sub_f32 v80, v80, v126
    v_mfma_f32_16x16x32_bf16 v[36:39], v[244:247], v[92:95], v[36:39]
    v_sub_f32 v81, v81, v126
    v_sub_f32 v82, v82, v126
    v_mfma_f32_16x16x32_bf16 v[36:39], v[248:251], v[88:91], v[36:39]
    v_sub_f32 v83, v83, v126
    v_sub_f32 v70, v70, v126
    v_mfma_f32_16x16x32_bf16 v[36:39], v[252:255], v[84:87], v[36:39]
    v_sub_f32 v71, v71, v126
    v_sub_f32 v72, v72, v126
    v_mfma_f32_16x16x32_bf16 v[96:99], v[62:65], v[44:47], v[204:207]
    s_waitcnt lgkmcnt(2)
    v_sub_f32 v73, v73, v126
    v_sub_f32 v66, v66, v126
    v_mfma_f32_16x16x32_bf16 v[136:139], v[132:135], v[0:3], 0
    s_waitcnt lgkmcnt(1)
    ds_read_b128 v[74:77], v213 offset:7168
    v_sub_f32 v67, v67, v126
    v_mfma_f32_16x16x32_bf16 v[136:139], v[128:131], v[188:191], v[136:139]
    ds_read_b128 v[62:65], v213 offset:8192
    v_sub_f32 v68, v68, v126
    v_mfma_f32_16x16x32_bf16 v[140:143], v[132:135], v[4:7], 0
    v_sub_f32 v69, v69, v126
    v_sub_f32 v127, v127, v126
    v_mfma_f32_16x16x32_bf16 v[140:143], v[128:131], v[184:187], v[140:143]
    v_exp_f32 v80, v80
    v_mfma_f32_16x16x32_bf16 v[144:147], v[132:135], v[8:11], 0
    v_exp_f32 v81, v81
    v_mfma_f32_16x16x32_bf16 v[144:147], v[128:131], v[180:183], v[144:147]
    v_exp_f32 v82, v82
    v_mfma_f32_16x16x32_bf16 v[148:151], v[132:135], v[196:199], 0
    v_exp_f32 v83, v83
    v_mfma_f32_16x16x32_bf16 v[148:151], v[128:131], v[196:199], v[148:151]
    s_waitcnt lgkmcnt(2)
    v_cvt_pk_bf16_f32 v100, v80, v81
    v_cvt_pk_bf16_f32 v101, v82, v83
    v_mfma_f32_16x16x32_bf16 v[52:55], v[28:31], v[44:47], v[52:55]
    s_waitcnt lgkmcnt(1)
    v_exp_f32 v70, v70
    v_exp_f32 v71, v71
    v_mfma_f32_16x16x32_bf16 v[74:77], v[56:59], v[44:47], v[74:77]
    s_waitcnt lgkmcnt(0)
    ds_read_b128 v[104:107], v212 offset:3072
    ds_read_b128 v[88:91], v208 offset:3072
    v_mfma_f32_16x16x32_bf16 v[62:65], v[40:43], v[44:47], v[62:65]
    ds_read_b128 v[92:95], v209 offset:3072
    ds_read_b128 v[80:83], v208 offset:3200
    v_mfma_f32_16x16x16_bf16 v[52:55], v[60:61], v[108:109], v[52:55]
    ds_read_b128 v[84:87], v209 offset:3200
    ds_read_b128 v[56:59], v208 offset:3328
    ds_read_b128 v[28:31], v209 offset:3328
    v_exp_f32 v72, v72
    v_exp_f32 v73, v73
    v_cvt_pk_bf16_f32 v102, v70, v71
    v_cvt_pk_bf16_f32 v103, v72, v73
    v_exp_f32 v66, v66
    v_exp_f32 v67, v67
    v_exp_f32 v68, v68
    v_exp_f32 v69, v69
    v_cvt_pk_bf16_f32 v192, v66, v67
    v_cvt_pk_bf16_f32 v193, v68, v69
    v_exp_f32 v127, v127
    v_mul_f32 v110, v110, v122
    v_cvt_pk_bf16_f32 v194, v127, 0
    v_mul_f32 v111, v111, v122
    v_cvt_pk_bf16_f32 v40, v110, v111
    v_mul_f32 v112, v112, v122
    v_mul_f32 v113, v113, v122
    v_cvt_pk_bf16_f32 v41, v112, v113
    v_mul_f32 v114, v114, v122
    v_mul_f32 v115, v115, v122
    v_cvt_pk_bf16_f32 v42, v114, v115
    v_mul_f32 v116, v116, v122
    v_mul_f32 v117, v117, v122
    v_cvt_pk_bf16_f32 v43, v116, v117
    v_mul_f32 v118, v118, v122
    v_mul_f32 v119, v119, v122
    v_cvt_pk_bf16_f32 v46, v118, v119
    v_mul_f32 v120, v120, v122
    v_mul_f32 v121, v121, v122
    v_cvt_pk_bf16_f32 v47, v120, v121
    v_rcp_f32 v148, v148
    v_mov_b32_dpp v136, v140 quad_perm:[0,1,2,3] row_mask:0x2 bank_mask:0xf
    v_max3_f32 v44, v52, v53, v54
    v_fma_f32 v45, v20, v20, s42
    v_mov_b32_dpp v136, v144 quad_perm:[0,1,2,3] row_mask:0x4 bank_mask:0xf
    v_mul_f32 v136, v136, v148
    v_cvt_pk_bf16_f32 v136, v136, v136
    v_fmac_f32 v45, v21, v21
    v_fmac_f32 v45, v22, v22
    v_fmac_f32 v45, v23, v23
    v_fmac_f32 v45, v12, v12
    v_fmac_f32 v45, v13, v13
    v_fmac_f32 v45, v14, v14
    v_fmac_f32 v45, v15, v15
    v_fmac_f32 v45, v16, v16
    v_fmac_f32 v45, v17, v17
    v_fmac_f32 v45, v18, v18
    v_fmac_f32 v45, v19, v19
    v_fma_f32 v60, v24, v24, s42
    v_fmac_f32 v60, v25, v25
    v_fmac_f32 v60, v26, v26
    v_fmac_f32 v60, v27, v27
    v_fmac_f32 v60, v32, v32
    v_fmac_f32 v60, v33, v33
    v_fmac_f32 v60, v34, v34
    v_fmac_f32 v60, v35, v35
    v_fmac_f32 v60, v36, v36
    v_fmac_f32 v60, v37, v37
    v_fmac_f32 v60, v38, v38
    v_fmac_f32 v60, v39, v39
    v_cvt_pk_bf16_f32 v60, v45, v60
    ds_write_b128 v210, v[40:43] offset:0
    ds_write_b64 v211, v[46:47] offset:0
    v_mfma_f32_16x16x16_bf16 v[74:77], v[48:49], v[108:109], v[74:77]
    ds_write_b16 v215, v136 offset:48
    v_mfma_f32_16x16x16_bf16 v[62:65], v[50:51], v[108:109], v[62:65]
    s_waitcnt lgkmcnt(9)
    buffer_load_dwordx4 v221, s[24:27], s56 offen nt lds
    buffer_store_dwordx4 v[104:107], v221, s[28:31], s60 offen sc1
    v_mfma_f32_16x16x16_bf16 v[96:99], v[78:79], v[108:109], v[96:99]
    s_add_u32 m0, s67, 4096
    ds_read_b128 v[40:43], v212 offset:4096
    v_mfma_f32_16x16x32_bf16 v[108:111], v[196:199], v[100:103], 0
    s_sub_u32 s48, s44, s46
    v_mfma_f32_16x16x32_bf16 v[108:111], v[196:199], v[192:195], v[108:111]
    s_sub_u32 s49, s46, s45
    v_max3_f32 v44, v44, v55, v74
    v_max3_f32 v44, v44, v75, v76
    v_mfma_f32_16x16x32_bf16 v[104:107], v[0:3], v[100:103], 0
    s_sub_u32 s66, s66, 1
    v_max3_f32 v44, v44, v77, v62
    v_max3_f32 v44, v44, v63, v64
    v_mfma_f32_16x16x32_bf16 v[104:107], v[188:191], v[192:195], v[104:107]
    s_cmp_lg_u32 s66, 0
    v_max3_f32 v44, v44, v65, v98
    v_mov_b32 v45, v44
    v_mfma_f32_16x16x32_bf16 v[70:73], v[4:7], v[100:103], 0
    v_rcp_f32 v108, v108
    v_mfma_f32_16x16x32_bf16 v[70:73], v[184:187], v[192:195], v[70:73]
    v_permlane32_swap_b32 v45, v44
    v_mfma_f32_16x16x32_bf16 v[66:69], v[8:11], v[100:103], 0
    v_max_f32 v44, v45, v44
    v_mov_b32 v45, v44
    v_mfma_f32_16x16x32_bf16 v[66:69], v[180:183], v[192:195], v[66:69]
    s_waitcnt lgkmcnt(9)
    v_mul_f32 v104, v104, v108
    v_permlane16_swap_b32 v45, v44
    v_mfma_f32_16x16x32_bf16 v[48:51], a[216:219], v[88:91], 0
    s_waitcnt lgkmcnt(0)
    buffer_load_dwordx4 v222, s[24:27], s56 offen nt lds
    buffer_store_dwordx4 v[40:43], v222, s[28:31], s60 offen sc1
    v_max_f32 v44, v45, v44
    v_sub_f32 v52, v52, v44
    v_sub_f32 v53, v53, v44
    v_sub_f32 v54, v54, v44
    v_mfma_f32_16x16x32_bf16 v[48:51], a[220:223], v[92:95], v[48:51]
    s_waitcnt vmcnt(10)
    v_sub_f32 v55, v55, v44
    v_sub_f32 v74, v74, v44
    v_mfma_f32_16x16x32_bf16 v[48:51], a[224:227], v[80:83], v[48:51]
    s_barrier
    v_sub_f32 v75, v75, v44
    v_sub_f32 v76, v76, v44
    v_mfma_f32_16x16x32_bf16 v[48:51], a[228:231], v[84:87], v[48:51]
    v_sub_f32 v77, v77, v44
    v_sub_f32 v62, v62, v44
    v_mfma_f32_16x16x32_bf16 v[48:51], a[232:235], v[56:59], v[48:51]
    v_sub_f32 v63, v63, v44
    v_sub_f32 v64, v64, v44
    v_mfma_f32_16x16x32_bf16 v[48:51], a[236:239], v[28:31], v[48:51]
    v_sub_f32 v65, v65, v44
    v_sub_f32 v98, v98, v44
    v_mfma_f32_16x16x32_bf16 v[40:43], a[240:243], v[88:91], 0
    v_exp_f32 v52, v52
    v_mfma_f32_16x16x32_bf16 v[40:43], a[244:247], v[92:95], v[40:43]
    v_exp_f32 v53, v53
    v_mfma_f32_16x16x32_bf16 v[40:43], a[248:251], v[80:83], v[40:43]
    v_exp_f32 v54, v54
    v_mfma_f32_16x16x32_bf16 v[40:43], a[252:255], v[84:87], v[40:43]
    v_exp_f32 v55, v55
    v_mfma_f32_16x16x32_bf16 v[40:43], v[224:227], v[56:59], v[40:43]
    v_cvt_pk_bf16_f32 v52, v52, v53
    v_cvt_pk_bf16_f32 v53, v54, v55
    v_mfma_f32_16x16x32_bf16 v[40:43], v[228:231], v[28:31], v[40:43]
    v_exp_f32 v74, v74
    v_mfma_f32_16x16x32_bf16 v[44:47], v[232:235], v[88:91], 0
    v_exp_f32 v75, v75
    v_mfma_f32_16x16x32_bf16 v[44:47], v[236:239], v[92:95], v[44:47]
    v_exp_f32 v76, v76
    v_mfma_f32_16x16x32_bf16 v[44:47], v[240:243], v[80:83], v[44:47]
    v_exp_f32 v77, v77
    v_mfma_f32_16x16x32_bf16 v[44:47], v[244:247], v[84:87], v[44:47]
    v_cvt_pk_bf16_f32 v54, v74, v75
    v_cvt_pk_bf16_f32 v55, v76, v77
    v_mfma_f32_16x16x32_bf16 v[44:47], v[248:251], v[56:59], v[44:47]
    v_exp_f32 v62, v62
    v_mfma_f32_16x16x32_bf16 v[44:47], v[252:255], v[28:31], v[44:47]
    v_exp_f32 v63, v63
    v_exp_f32 v64, v64
    v_exp_f32 v65, v65
    v_cvt_pk_bf16_f32 v192, v62, v63
    v_cvt_pk_bf16_f32 v193, v64, v65
    v_exp_f32 v98, v98
    v_mul_f32 v105, v105, v108
    v_cvt_pk_bf16_f32 v194, v98, 0
    v_mfma_f32_16x16x32_bf16 v[62:65], v[196:199], v[52:55], 0
    v_cvt_pk_bf16_f32 v74, v104, v105
    v_mul_f32 v106, v106, v108
    v_mfma_f32_16x16x32_bf16 v[62:65], v[196:199], v[192:195], v[62:65]
    v_mul_f32 v107, v107, v108
    v_cvt_pk_bf16_f32 v75, v106, v107
    v_mfma_f32_16x16x32_bf16 v[28:31], v[0:3], v[52:55], 0
    v_mul_f32 v70, v70, v108
    v_mul_f32 v71, v71, v108
    v_mfma_f32_16x16x32_bf16 v[28:31], v[188:191], v[192:195], v[28:31]
    v_cvt_pk_bf16_f32 v76, v70, v71
    v_mul_f32 v72, v72, v108
    v_mfma_f32_16x16x32_bf16 v[56:59], v[4:7], v[52:55], 0
    v_mul_f32 v73, v73, v108
    v_cvt_pk_bf16_f32 v77, v72, v73
    v_mfma_f32_16x16x32_bf16 v[56:59], v[184:187], v[192:195], v[56:59]
    ds_write_b128 v210, v[74:77] offset:1536
    v_mfma_f32_16x16x32_bf16 v[4:7], v[8:11], v[52:55], 0
    v_mul_f32 v66, v66, v108
    v_mul_f32 v67, v67, v108
    v_mfma_f32_16x16x32_bf16 v[4:7], v[180:183], v[192:195], v[4:7]
    v_cvt_pk_bf16_f32 v8, v66, v67
    v_mul_f32 v68, v68, v108
    v_mul_f32 v69, v69, v108
    v_cvt_pk_bf16_f32 v9, v68, v69
    v_rcp_f32 v62, v62
    v_add_u32 v208, s48, v208
    v_mul_f32 v28, v28, v62
    v_mul_f32 v29, v29, v62
    v_cvt_pk_bf16_f32 v0, v28, v29
    v_mul_f32 v30, v30, v62
    v_mul_f32 v31, v31, v62
    v_cvt_pk_bf16_f32 v1, v30, v31
    v_mul_f32 v56, v56, v62
    v_mul_f32 v57, v57, v62
    v_cvt_pk_bf16_f32 v2, v56, v57
    v_mul_f32 v58, v58, v62
    v_mul_f32 v59, v59, v62
    v_cvt_pk_bf16_f32 v3, v58, v59
    v_mul_f32 v4, v4, v62
    v_mul_f32 v5, v5, v62
    v_cvt_pk_bf16_f32 v4, v4, v5
    v_mul_f32 v6, v6, v62
    v_mul_f32 v7, v7, v62
    v_cvt_pk_bf16_f32 v5, v6, v7
    v_add_u32 v209, s48, v209
    v_fma_f32 v6, v48, v48, s42
    v_fmac_f32 v6, v49, v49
    v_fmac_f32 v6, v50, v50
    v_fmac_f32 v6, v51, v51
    v_fmac_f32 v6, v40, v40
    v_fmac_f32 v6, v41, v41
    v_fmac_f32 v6, v42, v42
    v_fmac_f32 v6, v43, v43
    v_fmac_f32 v6, v44, v44
    v_fmac_f32 v6, v45, v45
    v_fmac_f32 v6, v46, v46
    v_fmac_f32 v6, v47, v47
    v_cvt_pk_bf16_f32 v61, v6, v6
    ds_write_b64 v211, v[8:9] offset:1536
    ds_write_b128 v210, v[0:3] offset:3072
    ds_write_b64 v211, v[4:5] offset:3072
    ds_read_b128 v[108:111], v208 offset:0
    ds_read_b128 v[2:5], v209 offset:0
    ds_read_b128 v[96:99], v208 offset:128
    ds_read_b128 v[80:83], v209 offset:128
    ds_read_b128 v[68:71], v208 offset:256
    ds_read_b128 v[28:31], v209 offset:256
    ds_write_b64 v216, v[60:61]
    v_add_u32 v210, s49, v210
    v_add_u32 v211, s49, v211
    s_waitcnt lgkmcnt(6)
    v_mfma_f32_16x16x32_bf16 v[52:55], a[0:3], v[108:111], 0
    s_cbranch_scc1 L_loopS
    s_waitcnt lgkmcnt(0)
    s_barrier
    ds_read_b128 v[56:59], v217 offset:0
    ds_read_b128 v[72:75], v217 offset:1024
    s_waitcnt lgkmcnt(1)
    v_mfma_f32_16x16x32_bf16 v[112:115], v[200:203], v[56:59], 0
    s_waitcnt lgkmcnt(0)
    v_mfma_f32_16x16x32_bf16 v[112:115], v[200:203], v[72:75], v[112:115]
    s_nop 7
    v_rsq_f32 v112, v112
    v_rsq_f32 v113, v113
    v_rsq_f32 v114, v114
    v_mul_f32 v112, s43, v112
    v_mul_f32 v113, s43, v113
    v_mul_f32 v114, s43, v114
    v_mul_f32 v20, v20, v112
    v_mul_f32 v21, v21, v112
    v_cvt_pk_bf16_f32 v10, v20, v21
    v_mul_f32 v22, v22, v112
    v_mul_f32 v23, v23, v112
    v_cvt_pk_bf16_f32 v11, v22, v23
    v_mul_f32 v12, v12, v112
    v_mul_f32 v13, v13, v112
    v_cvt_pk_bf16_f32 v12, v12, v13
    v_mul_f32 v14, v14, v112
    v_mul_f32 v15, v15, v112
    v_cvt_pk_bf16_f32 v13, v14, v15
    v_mul_f32 v16, v16, v112
    ds_write_b128 v210, v[10:13] offset:0
    v_mul_f32 v17, v17, v112
    v_cvt_pk_bf16_f32 v6, v16, v17
    v_mul_f32 v18, v18, v112
    v_mul_f32 v19, v19, v112
    v_cvt_pk_bf16_f32 v7, v18, v19
    ds_write_b64 v211, v[6:7] offset:0
    v_mul_f32 v24, v24, v113
    v_mul_f32 v25, v25, v113
    v_cvt_pk_bf16_f32 v10, v24, v25
    v_mul_f32 v26, v26, v113
    v_mul_f32 v27, v27, v113
    v_cvt_pk_bf16_f32 v11, v26, v27
    v_mul_f32 v32, v32, v113
    v_mul_f32 v33, v33, v113
    v_cvt_pk_bf16_f32 v12, v32, v33
    v_mul_f32 v34, v34, v113
    v_mul_f32 v35, v35, v113
    v_cvt_pk_bf16_f32 v13, v34, v35
    v_mul_f32 v36, v36, v113
    ds_write_b128 v210, v[10:13] offset:1536
    v_mul_f32 v37, v37, v113
    v_cvt_pk_bf16_f32 v6, v36, v37
    v_mul_f32 v38, v38, v113
    v_mul_f32 v39, v39, v113
    v_cvt_pk_bf16_f32 v7, v38, v39
    ds_write_b64 v211, v[6:7] offset:1536
    s_sub_u32 s50, s45, s44
    v_mul_f32 v48, v48, v114
    s_sub_u32 s51, s46, s47
    v_mul_f32 v49, v49, v114
    v_cvt_pk_bf16_f32 v88, v48, v49
    s_mov_b32 s60, s59
    s_mov_b32 s59, s58
    s_mov_b32 s58, s57
    s_mov_b32 s57, s56
    s_add_u32 s56, s56, s62
    s_add_u32 s61, s61, 1
    s_cmp_eq_u32 s61, 72
    s_cselect_b32 s53, s63, 0
    s_cselect_b32 s61, 0, s61
    s_add_u32 s56, s56, s53
    s_sub_u32 s64, s64, 1
    s_cmp_gt_i32 s64, 0
    s_cselect_b32 s26, 100270464, 0
    s_cselect_b32 s56, s56, 0
    s_add_u32 s65, s65, 1
    s_cmp_ge_i32 s65, 2
    s_cselect_b32 s30, 100270464, 0
    s_add_u32 s67, s46, s54
    s_add_u32 m0, s67, 0
    v_mul_f32 v50, v50, v114
    v_mul_f32 v51, v51, v114
    v_cvt_pk_bf16_f32 v89, v50, v51
    v_mul_f32 v40, v40, v114
    v_mul_f32 v41, v41, v114
    v_cvt_pk_bf16_f32 v90, v40, v41
    v_mul_f32 v42, v42, v114
    v_mul_f32 v43, v43, v114
    v_cvt_pk_bf16_f32 v91, v42, v43
    ds_write_b128 v210, v[88:91] offset:3072
    v_mul_f32 v44, v44, v114
    v_mul_f32 v45, v45, v114
    v_cvt_pk_bf16_f32 v40, v44, v45
    v_mul_f32 v46, v46, v114
    v_mul_f32 v47, v47, v114
    v_cvt_pk_bf16_f32 v41, v46, v47
    ds_write_b64 v211, v[40:41] offset:3072
    s_waitcnt lgkmcnt(0)
    s_barrier
    v_add_u32 v208, s50, v208
    ds_read_b128 v[108:111], v208 offset:0
    ds_read_b128 v[96:99], v208 offset:128
    ds_read_b128 v[92:95], v208 offset:256
    v_add_u32 v209, s50, v209
    ds_read_b128 v[126:129], v209 offset:0
    ds_read_b128 v[104:107], v209 offset:128
    ds_read_b128 v[66:69], v209 offset:256
    v_add_u32 v210, s48, v210
    s_waitcnt lgkmcnt(5)
    v_mfma_f32_16x16x32_bf16 v[20:23], a[216:219], v[108:111], 0
    s_waitcnt lgkmcnt(2)
    v_mfma_f32_16x16x32_bf16 v[20:23], a[220:223], v[126:129], v[20:23]
    v_mfma_f32_16x16x32_bf16 v[20:23], a[224:227], v[96:99], v[20:23]
    s_waitcnt lgkmcnt(1)
    v_mfma_f32_16x16x32_bf16 v[20:23], a[228:231], v[104:107], v[20:23]
    v_mfma_f32_16x16x32_bf16 v[20:23], a[232:235], v[92:95], v[20:23]
    s_waitcnt lgkmcnt(0)
    v_mfma_f32_16x16x32_bf16 v[20:23], a[236:239], v[66:69], v[20:23]
    v_mfma_f32_16x16x32_bf16 v[12:15], a[240:243], v[108:111], 0
    v_mfma_f32_16x16x32_bf16 v[12:15], a[244:247], v[126:129], v[12:15]
    v_mfma_f32_16x16x32_bf16 v[12:15], a[248:251], v[96:99], v[12:15]
    v_mfma_f32_16x16x32_bf16 v[12:15], a[252:255], v[104:107], v[12:15]
    v_mfma_f32_16x16x32_bf16 v[12:15], v[224:227], v[92:95], v[12:15]
    v_mfma_f32_16x16x32_bf16 v[12:15], v[228:231], v[66:69], v[12:15]
    v_mfma_f32_16x16x32_bf16 v[16:19], v[232:235], v[108:111], 0
    v_mfma_f32_16x16x32_bf16 v[16:19], v[236:239], v[126:129], v[16:19]
    v_mfma_f32_16x16x32_bf16 v[16:19], v[240:243], v[96:99], v[16:19]
    v_mfma_f32_16x16x32_bf16 v[16:19], v[244:247], v[104:107], v[16:19]
    v_mfma_f32_16x16x32_bf16 v[16:19], v[248:251], v[92:95], v[16:19]
    v_add_u32 v211, s48, v211
    v_mfma_f32_16x16x32_bf16 v[16:19], v[252:255], v[66:69], v[16:19]
    v_add_u32 v212, s51, v212
    v_add_u32 v214, 320, v214
    ds_read_b128 v[72:75], v212 offset:0
    ds_read_b128 v[66:69], v212 offset:1024
    ds_read_b128 v[104:107], v208 offset:1536
    ds_read_b128 v[100:103], v209 offset:1536
    ds_read_b128 v[96:99], v208 offset:1664
    ds_read_b128 v[92:95], v209 offset:1664
    ds_read_b128 v[88:91], v208 offset:1792
    ds_read_b128 v[84:87], v209 offset:1792
    v_add_u32 v215, 320, v215
    s_waitcnt lgkmcnt(7)
    buffer_store_dwordx4 v[72:75], v218, s[28:31], s60 offen sc1
    s_add_u32 m0, s67, 1024
    s_waitcnt lgkmcnt(6)
    buffer_store_dwordx4 v[66:69], v219, s[28:31], s60 offen sc1
    s_add_u32 m0, s67, 2048
    s_waitcnt lgkmcnt(5)
    v_mfma_f32_16x16x32_bf16 v[24:27], a[216:219], v[104:107], 0
    s_waitcnt lgkmcnt(4)
    v_mfma_f32_16x16x32_bf16 v[24:27], a[220:223], v[100:103], v[24:27]
    s_waitcnt lgkmcnt(3)
    v_mfma_f32_16x16x32_bf16 v[24:27], a[224:227], v[96:99], v[24:27]
    s_waitcnt lgkmcnt(2)
    v_mfma_f32_16x16x32_bf16 v[24:27], a[228:231], v[92:95], v[24:27]
    s_waitcnt lgkmcnt(1)
    v_mfma_f32_16x16x32_bf16 v[24:27], a[232:235], v[88:91], v[24:27]
    s_waitcnt lgkmcnt(0)
    v_mfma_f32_16x16x32_bf16 v[24:27], a[236:239], v[84:87], v[24:27]
    ds_read_b128 v[52:55], v212 offset:2048
    s_waitcnt lgkmcnt(0)
    buffer_store_dwordx4 v[52:55], v220, s[28:31], s60 offen sc1
    s_add_u32 m0, s67, 3072
    v_mfma_f32_16x16x32_bf16 v[32:35], a[240:243], v[104:107], 0
    v_mfma_f32_16x16x32_bf16 v[32:35], a[244:247], v[100:103], v[32:35]
    s_mov_b32 s53, s47
    v_mfma_f32_16x16x32_bf16 v[32:35], a[248:251], v[96:99], v[32:35]
    s_mov_b32 s47, s46
    v_mfma_f32_16x16x32_bf16 v[32:35], a[252:255], v[92:95], v[32:35]
    s_mov_b32 s46, s45
    v_mfma_f32_16x16x32_bf16 v[32:35], v[224:227], v[88:91], v[32:35]
    s_mov_b32 s45, s44
    v_mfma_f32_16x16x32_bf16 v[32:35], v[228:231], v[84:87], v[32:35]
    s_mov_b32 s44, s53
    v_mfma_f32_16x16x32_bf16 v[36:39], v[232:235], v[104:107], 0
    v_mfma_f32_16x16x32_bf16 v[36:39], v[236:239], v[100:103], v[36:39]
    v_mfma_f32_16x16x32_bf16 v[36:39], v[240:243], v[96:99], v[36:39]
    v_mfma_f32_16x16x32_bf16 v[36:39], v[244:247], v[92:95], v[36:39]
    v_mfma_f32_16x16x32_bf16 v[36:39], v[248:251], v[88:91], v[36:39]
    v_mfma_f32_16x16x32_bf16 v[36:39], v[252:255], v[84:87], v[36:39]
    ds_read_b128 v[104:107], v212 offset:3072
    ds_read_b128 v[88:91], v208 offset:3072
    ds_read_b128 v[92:95], v209 offset:3072
    ds_read_b128 v[80:83], v208 offset:3200
    ds_read_b128 v[84:87], v209 offset:3200
    ds_read_b128 v[56:59], v208 offset:3328
    ds_read_b128 v[28:31], v209 offset:3328
    v_fma_f32 v45, v20, v20, s42
    v_fmac_f32 v45, v21, v21
    v_fmac_f32 v45, v22, v22
    v_fmac_f32 v45, v23, v23
    v_fmac_f32 v45, v12, v12
    v_fmac_f32 v45, v13, v13
    v_fmac_f32 v45, v14, v14
    v_fmac_f32 v45, v15, v15
    v_fmac_f32 v45, v16, v16
    v_fmac_f32 v45, v17, v17
    v_fmac_f32 v45, v18, v18
    v_fmac_f32 v45, v19, v19
    v_fma_f32 v60, v24, v24, s42
    v_fmac_f32 v60, v25, v25
    v_fmac_f32 v60, v26, v26
    v_fmac_f32 v60, v27, v27
    v_fmac_f32 v60, v32, v32
    v_fmac_f32 v60, v33, v33
    v_fmac_f32 v60, v34, v34
    v_fmac_f32 v60, v35, v35
    v_fmac_f32 v60, v36, v36
    v_fmac_f32 v60, v37, v37
    v_fmac_f32 v60, v38, v38
    v_fmac_f32 v60, v39, v39
    v_cvt_pk_bf16_f32 v60, v45, v60
    s_waitcnt lgkmcnt(6)
    buffer_store_dwordx4 v[104:107], v221, s[28:31], s60 offen sc1
    s_add_u32 m0, s67, 4096
    ds_read_b128 v[40:43], v212 offset:4096
    s_sub_u32 s48, s44, s46
    s_sub_u32 s49, s46, s45
    s_waitcnt lgkmcnt(6)
    v_mfma_f32_16x16x32_bf16 v[48:51], a[216:219], v[88:91], 0
    s_waitcnt lgkmcnt(0)
    buffer_store_dwordx4 v[40:43], v222, s[28:31], s60 offen sc1
    v_mfma_f32_16x16x32_bf16 v[48:51], a[220:223], v[92:95], v[48:51]
    s_waitcnt vmcnt(10)
    v_mfma_f32_16x16x32_bf16 v[48:51], a[224:227], v[80:83], v[48:51]
    s_barrier
    v_mfma_f32_16x16x32_bf16 v[48:51], a[228:231], v[84:87], v[48:51]
    v_mfma_f32_16x16x32_bf16 v[48:51], a[232:235], v[56:59], v[48:51]
    v_mfma_f32_16x16x32_bf16 v[48:51], a[236:239], v[28:31], v[48:51]
    v_mfma_f32_16x16x32_bf16 v[40:43], a[240:243], v[88:91], 0
    v_mfma_f32_16x16x32_bf16 v[40:43], a[244:247], v[92:95], v[40:43]
    v_mfma_f32_16x16x32_bf16 v[40:43], a[248:251], v[80:83], v[40:43]
    v_mfma_f32_16x16x32_bf16 v[40:43], a[252:255], v[84:87], v[40:43]
    v_mfma_f32_16x16x32_bf16 v[40:43], v[224:227], v[56:59], v[40:43]
    v_mfma_f32_16x16x32_bf16 v[40:43], v[228:231], v[28:31], v[40:43]
    v_mfma_f32_16x16x32_bf16 v[44:47], v[232:235], v[88:91], 0
    v_mfma_f32_16x16x32_bf16 v[44:47], v[236:239], v[92:95], v[44:47]
    v_mfma_f32_16x16x32_bf16 v[44:47], v[240:243], v[80:83], v[44:47]
    v_mfma_f32_16x16x32_bf16 v[44:47], v[244:247], v[84:87], v[44:47]
    v_mfma_f32_16x16x32_bf16 v[44:47], v[248:251], v[56:59], v[44:47]
    v_mfma_f32_16x16x32_bf16 v[44:47], v[252:255], v[28:31], v[44:47]
    v_add_u32 v208, s48, v208
    v_add_u32 v209, s48, v209
    v_fma_f32 v6, v48, v48, s42
    v_fmac_f32 v6, v49, v49
    v_fmac_f32 v6, v50, v50
    v_fmac_f32 v6, v51, v51
    v_fmac_f32 v6, v40, v40
    v_fmac_f32 v6, v41, v41
    v_fmac_f32 v6, v42, v42
    v_fmac_f32 v6, v43, v43
    v_fmac_f32 v6, v44, v44
    v_fmac_f32 v6, v45, v45
    v_fmac_f32 v6, v46, v46
    v_fmac_f32 v6, v47, v47
    v_cvt_pk_bf16_f32 v61, v6, v6
    ds_write_b64 v216, v[60:61]
    v_add_u32 v210, s49, v210
    v_add_u32 v211, s49, v211
    s_waitcnt lgkmcnt(0)
    s_barrier
    ds_read_b128 v[56:59], v217 offset:0
    ds_read_b128 v[72:75], v217 offset:1024
    s_waitcnt lgkmcnt(1)
    v_mfma_f32_16x16x32_bf16 v[112:115], v[200:203], v[56:59], 0
    s_waitcnt lgkmcnt(0)
    v_mfma_f32_16x16x32_bf16 v[112:115], v[200:203], v[72:75], v[112:115]
    s_nop 7
    v_rsq_f32 v112, v112
    v_rsq_f32 v113, v113
    v_rsq_f32 v114, v114
    v_mul_f32 v112, s43, v112
    v_mul_f32 v113, s43, v113
    v_mul_f32 v114, s43, v114
    v_mul_f32 v20, v20, v112
    v_mul_f32 v21, v21, v112
    v_cvt_pk_bf16_f32 v10, v20, v21
    v_mul_f32 v22, v22, v112
    v_mul_f32 v23, v23, v112
    v_cvt_pk_bf16_f32 v11, v22, v23
    v_mul_f32 v12, v12, v112
    v_mul_f32 v13, v13, v112
    v_cvt_pk_bf16_f32 v12, v12, v13
    v_mul_f32 v14, v14, v112
    v_mul_f32 v15, v15, v112
    v_cvt_pk_bf16_f32 v13, v14, v15
    v_mul_f32 v16, v16, v112
    ds_write_b128 v210, v[10:13] offset:0
    v_mul_f32 v17, v17, v112
    v_cvt_pk_bf16_f32 v6, v16, v17
    v_mul_f32 v18, v18, v112
    v_mul_f32 v19, v19, v112
    v_cvt_pk_bf16_f32 v7, v18, v19
    ds_write_b64 v211, v[6:7] offset:0
    v_mul_f32 v24, v24, v113
    v_mul_f32 v25, v25, v113
    v_cvt_pk_bf16_f32 v10, v24, v25
    v_mul_f32 v26, v26, v113
    v_mul_f32 v27, v27, v113
    v_cvt_pk_bf16_f32 v11, v26, v27
    v_mul_f32 v32, v32, v113
    v_mul_f32 v33, v33, v113
    v_cvt_pk_bf16_f32 v12, v32, v33
    v_mul_f32 v34, v34, v113
    v_mul_f32 v35, v35, v113
    v_cvt_pk_bf16_f32 v13, v34, v35
    v_mul_f32 v36, v36, v113
    ds_write_b128 v210, v[10:13] offset:1536
    v_mul_f32 v37, v37, v113
    v_cvt_pk_bf16_f32 v6, v36, v37
    v_mul_f32 v38, v38, v113
    v_mul_f32 v39, v39, v113
    v_cvt_pk_bf16_f32 v7, v38, v39
    ds_write_b64 v211, v[6:7] offset:1536
    s_sub_u32 s50, s45, s44
    v_mul_f32 v48, v48, v114
    s_sub_u32 s51, s46, s47
    v_mul_f32 v49, v49, v114
    v_cvt_pk_bf16_f32 v88, v48, v49
    s_mov_b32 s60, s59
    s_mov_b32 s59, s58
    s_mov_b32 s58, s57
    s_mov_b32 s57, s56
    s_add_u32 s56, s56, s62
    s_add_u32 s61, s61, 1
    s_cmp_eq_u32 s61, 72
    s_cselect_b32 s53, s63, 0
    s_cselect_b32 s61, 0, s61
    s_add_u32 s56, s56, s53
    s_sub_u32 s64, s64, 1
    s_cmp_gt_i32 s64, 0
    s_cselect_b32 s26, 100270464, 0
    s_cselect_b32 s56, s56, 0
    s_add_u32 s65, s65, 1
    s_cmp_ge_i32 s65, 2
    s_cselect_b32 s30, 100270464, 0
    s_add_u32 s67, s46, s54
    s_add_u32 m0, s67, 0
    v_mul_f32 v50, v50, v114
    v_mul_f32 v51, v51, v114
    v_cvt_pk_bf16_f32 v89, v50, v51
    v_mul_f32 v40, v40, v114
    v_mul_f32 v41, v41, v114
    v_cvt_pk_bf16_f32 v90, v40, v41
    v_mul_f32 v42, v42, v114
    v_mul_f32 v43, v43, v114
    v_cvt_pk_bf16_f32 v91, v42, v43
    ds_write_b128 v210, v[88:91] offset:3072
    v_mul_f32 v44, v44, v114
    v_mul_f32 v45, v45, v114
    v_cvt_pk_bf16_f32 v40, v44, v45
    v_mul_f32 v46, v46, v114
    v_mul_f32 v47, v47, v114
    v_cvt_pk_bf16_f32 v41, v46, v47
    ds_write_b64 v211, v[40:41] offset:3072
    s_waitcnt lgkmcnt(0)
    s_barrier
    v_add_u32 v208, s50, v208
    v_add_u32 v209, s50, v209
    v_add_u32 v210, s48, v210
    v_add_u32 v211, s48, v211
    v_add_u32 v212, s51, v212
    v_add_u32 v214, 320, v214
    ds_read_b128 v[72:75], v212 offset:0
    ds_read_b128 v[66:69], v212 offset:1024
    v_add_u32 v215, 320, v215
    s_waitcnt lgkmcnt(1)
    buffer_store_dwordx4 v[72:75], v218, s[28:31], s60 offen sc1
    s_add_u32 m0, s67, 1024
    s_waitcnt lgkmcnt(0)
    buffer_store_dwordx4 v[66:69], v219, s[28:31], s60 offen sc1
    s_add_u32 m0, s67, 2048
    ds_read_b128 v[52:55], v212 offset:2048
    s_waitcnt lgkmcnt(0)
    buffer_store_dwordx4 v[52:55], v220, s[28:31], s60 offen sc1
    s_add_u32 m0, s67, 3072
    ds_read_b128 v[104:107], v212 offset:3072
    s_waitcnt lgkmcnt(0)
    buffer_store_dwordx4 v[104:107], v221, s[28:31], s60 offen sc1
    s_add_u32 m0, s67, 4096
    ds_read_b128 v[40:43], v212 offset:4096
    s_waitcnt lgkmcnt(0)
    buffer_store_dwordx4 v[40:43], v222, s[28:31], s60 offen sc1
    s_nop 7
    s_branch L_etail
.section .rodata,"a"
.p2align 6
.amdhsa_kernel standalone__window_attn_swin_v2__vision_kernel
  .amdhsa_next_free_vgpr 512
  .amdhsa_next_free_sgpr 102
  .amdhsa_accum_offset 256
  .amdhsa_group_segment_fixed_size 0
  .amdhsa_kernarg_size 96
  .amdhsa_user_sgpr_count 2
  .amdhsa_user_sgpr_kernarg_segment_ptr 1
  .amdhsa_system_sgpr_workgroup_id_x 1
.end_amdhsa_kernel
```

```asm
; @launch grid=(256,1,1) block=(256,1,1) lds=163840
.amdgcn_target "amdgcn-amd-amdhsa--gfx950"
.text
.globl standalone__window_attn_swin_v2__vision_kernel
.p2align 8
.type standalone__window_attn_swin_v2__vision_kernel,@function
standalone__window_attn_swin_v2__vision_kernel:
    v_lshrrev_b32 v0, 6, v0
    s_cmp_ge_u32 s2, 256
    s_cbranch_scc1 L_end
    v_readfirstlane_b32 s68, v0
    s_nop 1
    v_mbcnt_lo_u32_b32 v162, -1, 0
    v_mbcnt_hi_u32_b32 v162, -1, v162
    s_load_dwordx16 s[4:19], s[0:1], 0
    s_load_dwordx4 s[20:23], s[0:1], 64
    s_lshr_b32 s88, s2, 3
    s_lshl2_add_u32 s88, s88, s68
    v_lshlrev_b32 v21, 7, v162
    s_getpc_b64 s[80:81]
    s_lshl_b32 s84, s88, 8
    v_and_b32 v20, 128, v21
    v_add_u32 v20, s84, v20
    v_min_u32 v20, L_slow-standalone__window_attn_swin_v2__vision_kernel-256, v20
    s_mul_i32 s89, s88, 576
    s_mul_i32 s88, s88, 1728
    global_load_dword a255, v20, s[80:81]
    v_min_u32 v20, 1664, v21
    v_min_u32 v159, 512, v21
    s_mov_b32 s34, 221184
    s_mov_b32 s35, 0x20000
    s_mov_b32 s78, 73728
    s_mov_b32 s79, 0x20000
    v_and_b32 v155, 15, v162
    v_lshrrev_b32 v156, 4, v162
    v_lshrrev_b32 v158, 2, v155
    v_and_b32 v51, 3, v155
    s_mul_i32 s87, s68, 192
    v_mad_u32_u24 v22, v155, 12, s87
    v_lshlrev_b32 v27, 1, v155
    v_lshlrev_b32 v157, 1, v158
    v_lshl_add_u32 v157, v156, 5, v157
    s_movk_i32 s86, 384
    s_mov_b32 s26, 100270464
    s_mov_b32 s27, 0x20000
    s_mov_b32 s30, 0
    s_mov_b32 s31, 0x20000
    s_waitcnt lgkmcnt(0)
    s_mov_b32 s32, s6
    s_mov_b32 s33, s7
    s_mov_b32 s76, s8
    s_mov_b32 s77, s9
    buffer_load_dword a254, v20, s[32:35], s88 offen
    buffer_load_dword a253, v159, s[76:79], s89 offen
    s_load_dwordx2 s[82:83], s[10:11], 0
    s_movk_i32 s18, 676
    s_mov_b32 s19, 0x20000
    s_mov_b32 s24, s4
    s_mov_b32 s25, s5
    buffer_load_dwordx3 v[24:26], v22, s[16:19], 0 offen
    s_mul_i32 s96, s68, 288
    s_and_b32 s97, s68, 1
    s_lshl_b32 s97, s97, 2
    s_mov_b32 s98, 193536
    s_mov_b32 s99, 589824
    global_load_ushort v12, v27, s[12:13]
    v_add_u32 v73, s96, v162
    v_mul_u32_u24 v49, 2731, v73
    v_mul_u32_u24 v152, 6242, v73
    v_lshrrev_b32 v49, 16, v49
    v_lshrrev_b32 v152, 20, v152
    s_mul_i32 s93, s2, 21
    s_mul_i32 s94, s93, 58255
    global_load_ushort v13, v27, s[12:13] offset:32
    v_and_or_b32 v124, v49, 3, s97
    v_xor_b32 v124, v73, v124
    v_lshl_add_u32 v130, v124, 4, s99
    v_mad_u32_u24 v130, v152, s98, v130
    v_add_u32 v14, 64, v73
    s_lshr_b32 s94, s94, 22
    s_mul_i32 s95, s94, 72
    global_load_ushort v74, v157, s[14:15] offset:0
    v_mul_u32_u24 v50, 2731, v14
    v_mul_u32_u24 v48, 6242, v14
    v_lshrrev_b32 v50, 16, v50
    v_lshrrev_b32 v48, 20, v48
    v_and_or_b32 v27, v50, 3, s97
    s_sub_u32 s70, s93, s95
    s_mul_i32 s94, s94, 1180032
    global_load_ushort v15, v157, s[14:15] offset:8
    v_xor_b32 v27, v14, v27
    v_lshl_add_u32 v129, v27, 4, s99
    v_mad_u32_u24 v129, v48, s98, v129
    v_add_u32 v128, 128, v73
    v_mul_u32_u24 v72, 2731, v128
    s_mul_i32 s95, s93, 2688
    s_add_u32 s69, s94, s95
    global_load_ushort v75, v157, s[14:15] offset:16
    v_mul_u32_u24 v159, 6242, v128
    v_lshrrev_b32 v72, 16, v72
    v_lshrrev_b32 v159, 20, v159
    v_and_or_b32 v14, v72, 3, s97
    v_xor_b32 v14, v128, v14
    s_movk_i32 s62, 2688
    s_movk_i32 s71, 21
    global_load_ushort v131, v157, s[14:15] offset:24
    v_lshl_add_u32 v128, v14, 4, s99
    v_mad_u32_u24 v128, v159, s98, v128
    v_add_u32 v127, 192, v73
    v_mul_u32_u24 v125, 2731, v127
    v_mul_u32_u24 v157, 6242, v127
    v_lshrrev_b32 v125, 16, v125
    v_lshrrev_b32 v157, 20, v157
    v_and_or_b32 v126, v125, 3, s97
    v_xor_b32 v126, v127, v126
    v_lshl_add_u32 v127, v126, 4, s99
    v_mad_u32_u24 v127, v157, s98, v127
    v_add_u32 v20, 256, v73
    v_mul_u32_u24 v73, 2731, v20
    v_mul_u32_u24 v23, 6242, v20
    v_lshrrev_b32 v73, 16, v73
    v_lshrrev_b32 v23, 20, v23
    v_and_or_b32 v126, v73, 3, s97
    v_xor_b32 v126, v20, v126
    v_lshl_add_u32 v126, v126, 4, s99
    v_mad_u32_u24 v126, v23, s98, v126
    s_mov_b32 s93, 1769472
    s_mul_i32 s54, s68, 5120
    s_cmp_ge_u32 s2, 246
    s_cbranch_scc1 L_bndF
L_bndrF:
    v_lshl_or_b32 v154, v162, 4, 2.0
    s_add_u32 m0, s54, 0
    v_cmp_gt_u32 vcc, 32, v162
    s_mov_b32 s63, 1180032
    s_sub_u32 s66, s71, 1
    buffer_load_dwordx4 v130, s[24:27], s69 offen nt lds
    s_add_u32 m0, s54, 1024
    v_cndmask_b32 v126, v154, v126, vcc
    s_add_u32 s93, s93, s69
    s_sub_u32 s94, 72, s70
    s_mul_i32 s95, s68, -44
    s_movk_i32 s99, -24
    v_and_b32 v73, -4, v49
    s_mul_i32 s85, s68, 96
    s_sub_u32 s100, s85, 1024
    buffer_load_dwordx4 v129, s[24:27], s69 offen nt lds
    s_add_u32 m0, s54, 2048
    v_mad_u32_u24 v48, v73, 3, v49
    v_add_u32 v48, s95, v48
    v_mad_i32_i24 v49, v49, s99, v124
    v_min_u32 v124, s66, v48
    v_lshl_add_u32 v49, v49, 4, s93
    v_mad_u32_u24 v49, v124, s62, v49
    s_sub_u32 s87, s85, 2048
    s_movk_i32 s91, 1152
    buffer_load_dwordx4 v128, s[24:27], s69 offen nt lds
    s_add_u32 m0, s54, 3072
    v_add_u32 v73, s63, v49
    v_cmp_le_u32 vcc, s94, v124
    v_and_b32 v125, -4, v50
    v_mad_u32_u24 v124, v125, 3, v50
    v_cndmask_b32 v49, v49, v73, vcc
    v_cmp_gt_u32 vcc, s71, v48
    s_mul_i32 s90, s68, 3072
    s_add_u32 s90, s90, 61440
    buffer_load_dwordx4 v127, s[24:27], s69 offen nt lds
    s_add_u32 m0, s54, 4096
    v_cndmask_b32 v48, v154, v49, vcc
    v_add_u32 v124, s95, v124
    v_mad_i32_i24 v73, v50, s99, v27
    v_min_u32 v27, s66, v124
    v_lshl_add_u32 v73, v73, 4, s93
    v_mad_u32_u24 v73, v27, s62, v73
    s_mov_b32 s92, 0
    s_mov_b32 s28, s22
    buffer_load_dwordx4 v126, s[24:27], s69 offen nt lds
    s_add_u32 m0, s54, 40960
    v_add_u32 v125, s63, v73
    v_cmp_le_u32 vcc, s94, v27
    v_and_b32 v50, -4, v72
    v_mad_u32_u24 v27, v50, 3, v72
    v_cndmask_b32 v73, v73, v125, vcc
    v_cmp_gt_u32 vcc, s71, v124
    s_mov_b32 s29, s23
    s_mov_b32 s41, 0x2a8cbccc
    buffer_load_dwordx4 v49, s[24:27], 0 offen nt lds
    s_add_u32 m0, s54, 41984
    v_cndmask_b32 v49, v154, v73, vcc
    v_add_u32 v27, s95, v27
    v_mad_i32_i24 v14, v72, s99, v14
    v_min_u32 v72, s66, v27
    v_lshl_add_u32 v14, v14, 4, s93
    v_mad_u32_u24 v14, v72, s62, v14
    s_mov_b32 s42, 0x38fba882
    s_mov_b32 s43, 0x415db3d7
    buffer_load_dwordx4 v73, s[24:27], 0 offen nt lds
    v_add_u32 v50, s63, v14
    v_cmp_le_u32 vcc, s94, v72
    s_add_u32 m0, s54, 43008
    v_mul_u32_u24 v72, 10923, v162
    v_cndmask_b32 v14, v14, v50, vcc
    v_cmp_gt_u32 vcc, s71, v27
    v_lshrrev_b32 v20, 17, v72
    s_mov_b32 s39, 0x00010001
    s_add_u32 s101, s54, 44032
    buffer_load_dwordx4 v14, s[24:27], 0 offen nt lds
    v_cndmask_b32 v50, v154, v14, vcc
    v_lshrrev_b32 v72, 16, v72
    v_mad_i32_i24 v73, v72, -6, v162
    v_bitop3_b32 v20, v20, v72, 4 bitop3:0x28
    v_lshl_add_u32 v73, v73, 4, s85
    v_mul_u32_u24 v20, 3, v20
    v_xor_b32 v72, v72, v20
    v_mad_u32_u24 v20, v72, s91, v73
    v_add_u32 v14, 64, v162
    v_mul_u32_u24 v124, 10923, v14
    v_lshrrev_b32 v34, 17, v124
    v_lshrrev_b32 v124, 16, v124
    v_mad_i32_i24 v14, v124, -6, v14
    v_bitop3_b32 v34, v34, v124, 4 bitop3:0x28
    v_lshl_add_u32 v14, v14, 4, s100
    v_mul_u32_u24 v34, 3, v34
    v_xor_b32 v124, v124, v34
    v_mad_u32_u24 v34, v124, s91, v14
    v_add_u32 v23, 128, v162
    v_mul_u32_u24 v27, 10923, v23
    v_lshrrev_b32 v21, 17, v27
    v_lshrrev_b32 v27, 16, v27
    v_mad_i32_i24 v23, v27, -6, v23
    v_bitop3_b32 v21, v21, v27, 4 bitop3:0x28
    v_lshl_add_u32 v23, v23, 4, s87
    v_mul_u32_u24 v21, 3, v21
    v_xor_b32 v27, v27, v21
    v_mad_u32_u24 v21, v27, s91, v23
    v_mad_u32_u24 v142, v72, s86, v73
    v_mad_u32_u24 v7, v124, s86, v14
    v_mad_u32_u24 v6, v27, s86, v23
    s_add_u32 m0, s90, 0
    v_mov_b32 v14, 0
    s_mul_i32 s93, s68, 6
    s_lshl_b32 s94, s97, 1
    buffer_load_dwordx4 v20, s[32:35], s92 offen offset:0 lds
    v_mov_b32 v27, 0
    v_mul_u32_u24 v23, 5120, v156
    v_add_u32 v23, v22, v23
    v_mov_b32 v125, 0xc138aa3b
    v_and_b32 v22, 8, v155
    v_add_u32 v22, v22, v155
    v_mul_u32_u24 v22, 96, v22
    v_add_u32 v22, s90, v22
    v_lshl_add_u32 v73, v156, 4, v22
    v_lshl_add_u32 v72, v156, 3, v22
    v_lshlrev_b32 v124, 4, v156
    v_add_u32 v124, 4608, v124
    v_lshrrev_b32 v5, 1, v156
    s_waitcnt lgkmcnt(0)
    s_sext_i32_i16 s84, s82
    s_ashr_i32 s85, s82, 16
    s_max_i32 s84, s84, s85
    s_sext_i32_i16 s85, s83
    s_max_i32 s84, s84, s85
    s_ashr_i32 s85, s83, 16
    s_max_i32 s84, s84, s85
    s_cmp_gt_i32 s84, 16492
    s_cbranch_scc1 L_slow
    s_lshl_b32 s84, s68, 4
    s_lshr_b64 s[82:83], s[82:83], s84
    s_lshl_b32 s82, s82, 16
    v_mov_b32 v4, s82
    v_min_f32 v4, 0x40930000, v4
    v_max_f32 v4, 0xc2c80000, v4
    v_mul_f32 v4, 0x3fb8aa3b, v4
    v_exp_f32 v4, v4
    s_mov_b32 s84, 0x41b8aa3b
    v_cvt_pk_bf16_f32 v4, v4, v4
    v_lshlrev_b32 v4, 16, v4
    v_mul_f32 v4, 0x4038aa3b, v4
    v_lshl_add_u32 v22, v156, 2, v158
    v_readfirstlane_b32 s55, v4
    v_add_f32 v4, v4, v4
    v_lshl_add_u32 v22, v5, 3, v22
    v_readfirstlane_b32 s52, v4
    v_mul_u32_u24 v22, 96, v22
    v_add_u32 v22, s90, v22
    v_lshl_add_u32 v157, v51, 4, v22
    v_lshl_add_u32 v143, v51, 3, v22
    v_mul_u32_u24 v45, 48, v158
    v_lshl_add_u32 v45, v51, 2, v45
    v_mul_u32_u24 v4, 48, v156
    v_add_u32 v199, 0, v45
    v_mul_u32_u24 v5, 37, v199
    v_lshrrev_b32 v5, 10, v5
    v_mad_u32_u24 v199, v5, 24, v199
    v_add_u32 v199, s101, v199
    v_add_u32 v187, 16, v45
    v_mul_u32_u24 v5, 37, v187
    v_lshrrev_b32 v5, 10, v5
    v_mad_u32_u24 v187, v5, 24, v187
    v_add_u32 v187, s101, v187
    v_add_u32 v175, 32, v45
    v_mul_u32_u24 v5, 37, v175
    v_lshrrev_b32 v5, 10, v5
    v_mad_u32_u24 v175, v5, 24, v175
    v_add_u32 v175, s101, v175
    v_add_u32 v204, 0, v4
    v_mul_u32_u24 v5, 37, v204
    v_lshrrev_b32 v5, 10, v5
    v_mad_u32_u24 v204, v5, 24, v204
    v_add_u32 v205, 4, v4
    v_mul_u32_u24 v5, 37, v205
    v_lshrrev_b32 v5, 10, v5
    v_mad_u32_u24 v205, v5, 24, v205
    v_add_u32 v206, 8, v4
    v_mul_u32_u24 v5, 37, v206
    v_lshrrev_b32 v5, 10, v5
    v_mad_u32_u24 v206, v5, 24, v206
    v_add_u32 v207, 12, v4
    v_mul_u32_u24 v5, 37, v207
    v_lshrrev_b32 v5, 10, v5
    v_mad_u32_u24 v207, v5, 24, v207
    v_add_u32 v151, 16, v4
    v_mul_u32_u24 v5, 37, v151
    v_lshrrev_b32 v5, 10, v5
    v_mad_u32_u24 v151, v5, 24, v151
    v_add_u32 v150, 20, v4
    v_mul_u32_u24 v5, 37, v150
    v_lshrrev_b32 v5, 10, v5
    v_mad_u32_u24 v150, v5, 24, v150
    v_add_u32 v147, 24, v4
    v_mul_u32_u24 v5, 37, v147
    v_lshrrev_b32 v5, 10, v5
    v_mad_u32_u24 v147, v5, 24, v147
    v_add_u32 v46, 28, v4
    v_mul_u32_u24 v5, 37, v46
    v_lshrrev_b32 v5, 10, v5
    v_mad_u32_u24 v46, v5, 24, v46
    v_add_u32 v146, 32, v4
    v_mul_u32_u24 v5, 37, v146
    v_lshrrev_b32 v5, 10, v5
    v_mad_u32_u24 v146, v5, 24, v146
    v_add_u32 v44, 36, v4
    v_mul_u32_u24 v5, 37, v44
    v_lshrrev_b32 v5, 10, v5
    v_mad_u32_u24 v44, v5, 24, v44
    v_add_u32 v5, 40, v4
    v_mul_u32_u24 v22, 37, v5
    v_lshrrev_b32 v22, 10, v22
    v_mad_u32_u24 v5, v22, 24, v5
    v_add_u32 v4, 44, v4
    v_mul_u32_u24 v22, 37, v4
    v_lshrrev_b32 v22, 10, v22
    s_mov_b32 s44, 61440
    s_mov_b32 s45, 40960
    buffer_load_dwordx4 v34, s[32:35], s92 offen offset:1024 lds
    v_mad_u32_u24 v4, v22, 24, v4
    v_lshl_add_u32 v22, v156, 4, v45
    v_mul_u32_u24 v47, 37, v22
    v_lshrrev_b32 v47, 10, v47
    v_mad_u32_u24 v22, v47, 24, v22
    v_mov_b32 v47, 336
    v_cmp_gt_u32 vcc, 3, v156
    s_mov_b32 s46, 20480
    s_mov_b32 s47, 0
    buffer_load_dwordx4 v21, s[32:35], s92 offen offset:2048 lds
    s_add_u32 m0, s90, 12288
    s_mov_b32 s92, 36864
    v_cndmask_b32 v22, v47, v22, vcc
    v_sub_u32 v22, s101, v22
    v_mov_b32 v47, 0x3f803f80
    v_cmp_eq_u32 vcc, 0, v51
    v_and_b32 v159, 1, v162
    s_mov_b32 s57, s69
    s_mov_b32 s58, 0
    buffer_load_dwordx4 v20, s[32:35], s92 offen offset:0 lds
    s_waitcnt vmcnt(16)
    v_lshl_or_b32 v12, v13, 16, v12
    v_mov_b32 v13, 0
    v_cndmask_b32 v220, 0, v47, vcc
    v_cndmask_b32 v221, 0, v47, vcc
    v_cndmask_b32 v222, 0, v47, vcc
    v_cndmask_b32 v223, 0, v47, vcc
    v_cmp_gt_u32 vcc, 16, v162
    s_waitcnt vmcnt(14)
    v_lshl_or_b32 v74, v15, 16, v74
    v_lshlrev_b32 v159, 4, v159
    v_cndmask_b32 v15, 0, v12, vcc
    v_cndmask_b32 v12, 0, v12, vcc
    v_mov_b32 v47, 0x3f80
    v_mfma_f32_16x16x16_bf16 v[0:3], v[14:15], v[24:25], 0
    s_waitcnt vmcnt(12)
    s_mov_b32 s59, 0
    v_lshlrev_b32 v47, v159, v47
    v_lshl_or_b32 v75, v131, 16, v75
    v_mfma_f32_16x16x16_bf16 v[8:11], v[12:13], v[24:25], 0
    s_mov_b32 s60, 0
    buffer_load_dwordx4 v34, s[32:35], s92 offen offset:1024 lds
    v_cmp_gt_u32 vcc, 2, v51
    v_mfma_f32_16x16x16_bf16 v[16:19], v[12:13], v[26:27], 0
    s_sub_u32 s64, s71, 1
    v_max_f32 v0, 0, v0
    v_max_f32 v1, 0, v1
    v_max_f32 v2, 0, v2
    v_max_f32 v8, 0, v8
    v_max_f32 v9, 0, v9
    v_max_f32 v10, 0, v10
    v_max_f32 v11, 0, v11
    v_cvt_pk_bf16_f32 v8, v8, v9
    v_cvt_pk_bf16_f32 v9, v10, v11
    v_max_f32 v3, 0, v3
    v_cvt_pk_bf16_f32 v0, v0, v1
    v_mfma_f32_16x16x16_bf16 v[12:15], v[74:75], v[8:9], 0
    s_mov_b32 s65, -1
    v_cvt_pk_bf16_f32 v1, v2, v3
    v_max_f32 v16, 0, v16
    v_max_f32 v17, 0, v17
    v_mfma_f32_16x16x16_bf16 v[8:11], v[74:75], v[0:1], 0
    s_add_u32 s56, s69, s62
    v_max_f32 v18, 0, v18
    v_max_f32 v19, 0, v19
    v_cvt_pk_bf16_f32 v16, v16, v17
    v_cvt_pk_bf16_f32 v17, v18, v19
    v_cvt_pk_bf16_f32 v12, v12, v12
    v_lshlrev_b32 v12, 16, v12
    v_mfma_f32_16x16x16_bf16 v[0:3], v[74:75], v[16:17], 0
    s_add_u32 s61, s70, 1
    v_mul_f32 v12, 0xbfb8aa3b, v12
    v_cvt_pk_bf16_f32 v8, v8, v8
    v_exp_f32 v12, v12
    v_lshlrev_b32 v8, 16, v8
    v_add_f32 v12, 1.0, v12
    v_rcp_f32 v12, v12
    v_mul_f32 v8, 0xbfb8aa3b, v8
    v_cvt_pk_bf16_f32 v12, v12, v12
    v_lshlrev_b32 v12, 16, v12
    v_fma_f32 v12, v12, s84, v125
    ds_write_b32 v23, v12 offset:44032
    v_exp_f32 v8, v8
    v_cvt_pk_bf16_f32 v0, v0, v0
    v_add_f32 v8, 1.0, v8
    v_rcp_f32 v8, v8
    v_lshlrev_b32 v0, 16, v0
    v_cvt_pk_bf16_f32 v8, v8, v8
    v_lshlrev_b32 v8, 16, v8
    v_fma_f32 v8, v8, s84, v125
    ds_write_b32 v23, v8 offset:44036
    v_mul_f32 v0, 0xbfb8aa3b, v0
    v_exp_f32 v0, v0
    v_cndmask_b32 v216, 0, v47, vcc
    v_add_f32 v0, 1.0, v0
    v_rcp_f32 v0, v0
    v_cndmask_b32 v218, 0, v47, vcc
    v_cvt_pk_bf16_f32 v0, v0, v0
    v_lshlrev_b32 v0, 16, v0
    v_fma_f32 v0, v0, s84, v125
    ds_write_b32 v23, v0 offset:44040
    v_cmp_le_u32 vcc, 2, v51
    v_mov_b32 v23, 0x44004400
    v_mov_b32 v171, 0
    v_cndmask_b32 v217, 0, v47, vcc
    v_cndmask_b32 v219, 0, v47, vcc
    v_cmp_eq_u32 vcc, v156, v158
    v_mov_b32 v167, 0
    v_mov_b32 v163, 0
    v_cndmask_b32 v74, 0, v216, vcc
    v_cndmask_b32 v75, 0, v217, vcc
    v_cmp_eq_u32 vcc, 0, v51
    v_mov_b32 v159, 0
    v_mov_b32 v152, 0
    v_cndmask_b32 v212, 0, v23, vcc
    v_cmp_eq_u32 vcc, 1, v51
    v_mov_b32 v153, 0
    v_mov_b32 v148, 0
    v_cndmask_b32 v213, 0, v23, vcc
    v_cmp_eq_u32 vcc, 2, v51
    v_mov_b32 v149, 0
    v_mov_b32 v144, 0
    v_cndmask_b32 v214, 0, v23, vcc
    v_cmp_eq_u32 vcc, 3, v51
    v_mov_b32 v145, 0
    v_mov_b32 v140, 0
    v_cndmask_b32 v215, 0, v23, vcc
    v_mov_b32 v141, 0
    v_mul_u32_u24 v23, 5120, v158
    v_mad_u32_u24 v23, v51, s86, v23
    v_and_b32 v131, 7, v155
    v_xor_b32 v125, v131, v156
    v_lshl_add_u32 v47, v125, 4, v23
    v_xor_b32 v166, 64, v47
    s_waitcnt lgkmcnt(0)
    s_barrier
    v_add_u32 v139, 40960, v47
    v_xor_b32 v138, 64, v139
    v_add_u32 v23, 61440, v23
    v_add_u32 v125, s93, v156
    v_xor_b32 v125, v131, v125
    v_lshl_add_u32 v137, v125, 4, v23
    v_lshrrev_b32 v125, 1, v156
    v_add3_u32 v125, v125, s93, 4
    v_xor_b32 v125, v131, v125
    v_lshl_add_u32 v125, v125, 4, v23
    v_and_b32 v23, 1, v156
    v_lshl_add_u32 v136, v23, 3, v125
    v_lshlrev_b32 v23, 4, v162
    s_add_u32 s93, s54, 20480
    v_add_u32 v135, s93, v23
    v_add_u32 v131, 81920, v23
    s_lshr_b32 s93, s68, 1
    s_lshl_b32 s93, s93, 10
    s_add_u32 s93, s93, s94
    s_and_b32 s94, s68, 1
    s_mul_i32 s94, s94, -2304
    ds_read_b32 v210, v175
    v_add_u32 v132, s93, v131
    s_mul_i32 s93, s68, 7056
    s_add_u32 s93, s93, 135280
    v_mul_u32_u24 v23, 80, v156
    v_add_u32 v125, s93, v23
    v_mul_u32_u24 v23, 336, v155
    v_add_u32 v27, v23, v125
    v_cmp_eq_u32 vcc, 0, v158
    v_mul_u32_u24 v23, 80, v158
    v_lshl_add_u32 v23, v156, 3, v23
    buffer_load_dwordx4 v21, s[32:35], s92 offen offset:2048 lds
    s_add_u32 m0, s90, 24576
    s_mov_b32 s92, 73728
    ds_write_b128 v27, v[216:219] offset:416
    v_cndmask_b32 v134, v154, v125, vcc
    v_cmp_eq_u32 vcc, 3, v51
    v_lshl_add_u32 v23, v51, 1, v23
    v_add_u32 v23, s93, v23
    v_cndmask_b32 v134, v134, v125, vcc
    v_cmp_gt_u32 vcc, 5, v155
    v_mov_b32 v125, 0
    s_cmp_eq_u32 s61, 72
    v_cndmask_b32 v51, v154, v27, vcc
    v_cmp_gt_u32 vcc, 3, v156
    s_cselect_b32 s93, s63, 0
    s_cselect_b32 s61, 0, s61
    ds_read_b32 v209, v187
    v_cndmask_b32 v133, v154, v23, vcc
    s_add_u32 s56, s56, s93
    s_lshr_b32 s93, s68, 1
    buffer_load_dwordx4 v20, s[32:35], s92 offen offset:0 lds
    s_mul_i32 s93, s93, 30720
    s_add_u32 s93, s93, s94
    ds_read_b32 v208, v199
    v_add_u32 v158, s93, v73
    v_add_u32 v23, s93, v72
    s_lshr_b32 s93, s68, 1
    s_mul_i32 s93, s93, 5120
    s_lshl_b32 s94, s97, 4
    s_add_u32 s93, s93, s94
    buffer_load_dwordx4 v34, s[32:35], s92 offen offset:1024 lds
    ds_read_b32 v211, v22 offset:672
    v_add_u32 v22, s93, v124
    v_cmp_eq_u32 vcc, 0, v155
    v_sub_u32 v180, v175, v204
    v_sub_u32 v181, v175, v205
    v_cndmask_b32 v22, v154, v22, vcc
    ds_read_b32 v180, v180 offset:336
    v_sub_u32 v182, v175, v206
    v_sub_u32 v183, v175, v207
    v_sub_u32 v176, v175, v151
    v_sub_u32 v177, v175, v150
    v_sub_u32 v178, v175, v147
    ds_read_b32 v181, v181 offset:336
    v_sub_u32 v179, v175, v46
    v_sub_u32 v172, v175, v146
    v_sub_u32 v173, v175, v44
    v_sub_u32 v174, v175, v5
    v_sub_u32 v175, v175, v4
    buffer_load_dwordx4 v21, s[32:35], s92 offen offset:2048 lds
    s_add_u32 m0, s90, 36864
    s_mov_b32 s92, 110592
    ds_read_b32 v182, v182 offset:336
    v_sub_u32 v192, v187, v204
    v_sub_u32 v193, v187, v205
    v_sub_u32 v194, v187, v206
    v_sub_u32 v195, v187, v207
    v_sub_u32 v188, v187, v151
    ds_read_b32 v183, v183 offset:336
    s_waitcnt vmcnt(9)
    s_barrier
    v_sub_u32 v189, v187, v150
    v_sub_u32 v190, v187, v147
    v_sub_u32 v191, v187, v46
    v_sub_u32 v184, v187, v146
    ds_read_b32 v176, v176 offset:336
    v_sub_u32 v185, v187, v44
    v_sub_u32 v186, v187, v5
    v_sub_u32 v187, v187, v4
    v_sub_u32 v204, v199, v204
    v_sub_u32 v205, v199, v205
    ds_read_b32 v177, v177 offset:336
    v_sub_u32 v206, v199, v206
    v_sub_u32 v207, v199, v207
    v_sub_u32 v200, v199, v151
    buffer_load_dwordx4 v20, s[32:35], s92 offen offset:0 lds
    ds_read_b32 v178, v178 offset:336
    v_sub_u32 v201, v199, v150
    v_sub_u32 v202, v199, v147
    v_sub_u32 v203, v199, v46
    v_sub_u32 v196, v199, v146
    v_sub_u32 v197, v199, v44
    ds_read_b32 v179, v179 offset:336
    v_sub_u32 v198, v199, v5
    v_sub_u32 v199, v199, v4
    ds_read_b32 v172, v172 offset:336
    buffer_load_dwordx4 v34, s[32:35], s92 offen offset:1024 lds
    ds_read_b32 v173, v173 offset:336
    ds_read_b32 v174, v174 offset:336
    ds_read_b32 v175, v175 offset:336
    buffer_load_dwordx4 v21, s[32:35], s92 offen offset:2048 lds
    s_add_u32 m0, s90, 49152
    s_mov_b32 s92, 147456
    s_waitcnt vmcnt(9)
    ds_read_b64_tr_b16 a[0:1], v143 offset:0
    ds_read_b64_tr_b16 a[2:3], v143 offset:768
    ds_read_b64_tr_b16 a[24:25], v143 offset:32
    ds_read_b64_tr_b16 a[26:27], v143 offset:800
    ds_read_b64_tr_b16 a[48:49], v143 offset:64
    ds_read_b64_tr_b16 a[50:51], v143 offset:832
    ds_read_b128 v[16:19], v47 offset:40960
    ds_read_b128 v[0:3], v47 offset:42496
    buffer_load_dwordx4 v20, s[32:35], s92 offen offset:0 lds
    ds_read_b128 v[12:15], v47 offset:0
    ds_read_b128 v[36:39], v47 offset:1536
    ds_read_b128 v[52:55], v47 offset:3072
    ds_read_b32 v192, v192 offset:336
    buffer_load_dwordx4 v34, s[32:35], s92 offen offset:1024 lds
    ds_read_b32 v193, v193 offset:336
    ds_read_b32 v194, v194 offset:336
    s_waitcnt lgkmcnt(7)
    v_mfma_f32_16x16x32_bf16 v[96:99], a[0:3], v[16:19], 0
    ds_read_b128 v[100:103], v166 offset:40960
    v_mfma_f32_16x16x32_bf16 v[8:11], a[24:27], v[16:19], 0
    ds_read_b32 v195, v195 offset:336
    v_mfma_f32_16x16x32_bf16 v[88:91], a[48:51], v[16:19], 0
    s_waitcnt lgkmcnt(6)
    buffer_load_dwordx4 v21, s[32:35], s92 offen offset:2048 lds
    v_mfma_f32_16x16x32_bf16 v[76:79], a[0:3], v[0:3], 0
    s_waitcnt vmcnt(9)
    s_add_u32 m0, s90, 61440
    ds_read_b64_tr_b16 a[4:5], v143 offset:12288
    v_mfma_f32_16x16x32_bf16 v[68:71], a[24:27], v[0:3], 0
    s_mov_b32 s92, 184320
    ds_read_b64_tr_b16 a[6:7], v143 offset:13056
    v_mfma_f32_16x16x32_bf16 v[60:63], a[48:51], v[0:3], 0
    ds_read_b64_tr_b16 a[28:29], v143 offset:12320
    v_mfma_f32_16x16x32_bf16 v[28:31], a[0:3], v[12:15], 0
    ds_read_b64_tr_b16 a[30:31], v143 offset:13088
    v_mfma_f32_16x16x32_bf16 v[2:5], a[24:27], v[12:15], 0
    buffer_load_dwordx4 v20, s[32:35], s92 offen offset:0 lds
    ds_read_b64_tr_b16 a[52:53], v143 offset:12352
    v_mfma_f32_16x16x32_bf16 v[56:59], a[48:51], v[12:15], 0
    ds_read_b64_tr_b16 a[54:55], v143 offset:13120
    v_mfma_f32_16x16x32_bf16 v[12:15], a[0:3], v[36:39], 0
    ds_read_b128 v[40:43], v166 offset:42496
    v_mfma_f32_16x16x32_bf16 v[64:67], a[24:27], v[36:39], 0
    ds_read_b128 v[16:19], v166 offset:0
    v_mfma_f32_16x16x32_bf16 v[84:87], a[48:51], v[36:39], 0
    s_waitcnt lgkmcnt(8)
    ds_read_b128 v[92:95], v166 offset:1536
    v_mfma_f32_16x16x32_bf16 v[36:39], a[0:3], v[52:55], 0
    buffer_load_dwordx4 v34, s[32:35], s92 offen offset:1024 lds
    ds_read_b128 v[80:83], v166 offset:3072
    v_mfma_f32_16x16x32_bf16 v[248:251], a[24:27], v[52:55], 0
    ds_read_b32 v188, v188 offset:336
    v_mfma_f32_16x16x32_bf16 v[240:243], a[48:51], v[52:55], 0
    s_waitcnt lgkmcnt(8)
    v_mfma_f32_16x16x32_bf16 v[96:99], a[4:7], v[100:103], v[96:99]
    s_waitcnt lgkmcnt(7)
    ds_read_b128 v[52:55], v47 offset:41088
    v_mfma_f32_16x16x32_bf16 v[8:11], a[28:31], v[100:103], v[8:11]
    s_waitcnt lgkmcnt(6)
    ds_read_b32 v189, v189 offset:336
    v_mfma_f32_16x16x32_bf16 v[88:91], a[52:55], v[100:103], v[88:91]
    s_waitcnt vmcnt(8) lgkmcnt(6)
    buffer_load_dwordx4 v21, s[32:35], s92 offen offset:2048 lds
    ds_read_b64_tr_b16 a[8:9], v143 offset:24576
    v_mfma_f32_16x16x32_bf16 v[76:79], a[4:7], v[40:43], v[76:79]
    s_add_u32 m0, s90, 0
    ds_read_b64_tr_b16 a[10:11], v143 offset:25344
    v_mfma_f32_16x16x32_bf16 v[68:71], a[28:31], v[40:43], v[68:71]
    s_mov_b32 s92, 384
    ds_read_b64_tr_b16 a[32:33], v143 offset:24608
    v_mfma_f32_16x16x32_bf16 v[60:63], a[52:55], v[40:43], v[60:63]
    s_waitcnt lgkmcnt(7)
    ds_read_b64_tr_b16 a[34:35], v143 offset:25376
    v_mfma_f32_16x16x32_bf16 v[28:31], a[4:7], v[16:19], v[28:31]
    ds_read_b64_tr_b16 a[56:57], v143 offset:24640
    v_mfma_f32_16x16x32_bf16 v[2:5], a[28:31], v[16:19], v[2:5]
    buffer_load_dwordx4 v20, s[32:35], s92 offen offset:0 lds
    ds_read_b64_tr_b16 a[58:59], v143 offset:25408
    v_mfma_f32_16x16x32_bf16 v[56:59], a[52:55], v[16:19], v[56:59]
    ds_read_b128 v[40:43], v47 offset:42624
    v_mfma_f32_16x16x32_bf16 v[12:15], a[4:7], v[92:95], v[12:15]
    ds_read_b128 v[16:19], v47 offset:128
    v_mfma_f32_16x16x32_bf16 v[64:67], a[28:31], v[92:95], v[64:67]
    ds_read_b128 v[100:103], v47 offset:1664
    v_mfma_f32_16x16x32_bf16 v[84:87], a[52:55], v[92:95], v[84:87]
    s_waitcnt lgkmcnt(8)
    ds_read_b32 v190, v190 offset:336
    v_mfma_f32_16x16x32_bf16 v[36:39], a[4:7], v[80:83], v[36:39]
    buffer_load_dwordx4 v34, s[32:35], s92 offen offset:1024 lds
    v_mfma_f32_16x16x32_bf16 v[248:251], a[28:31], v[80:83], v[248:251]
    ds_read_b128 v[92:95], v47 offset:3200
    v_mfma_f32_16x16x32_bf16 v[240:243], a[52:55], v[80:83], v[240:243]
    s_waitcnt lgkmcnt(7)
    ds_read_b32 v191, v191 offset:336
    v_mfma_f32_16x16x32_bf16 v[96:99], a[8:11], v[52:55], v[96:99]
    v_mfma_f32_16x16x32_bf16 v[8:11], a[32:35], v[52:55], v[8:11]
    s_waitcnt lgkmcnt(6)
    ds_read_b128 v[80:83], v166 offset:41088
    v_mfma_f32_16x16x32_bf16 v[88:91], a[56:59], v[52:55], v[88:91]
    s_waitcnt vmcnt(8) lgkmcnt(6)
    buffer_load_dwordx4 v21, s[32:35], s92 offen offset:2048 lds
    ds_read_b64_tr_b16 a[12:13], v143 offset:36864
    v_mfma_f32_16x16x32_bf16 v[76:79], a[8:11], v[40:43], v[76:79]
    s_add_u32 m0, s90, 12288
    ds_read_b64_tr_b16 a[14:15], v143 offset:37632
    v_mfma_f32_16x16x32_bf16 v[68:71], a[32:35], v[40:43], v[68:71]
    s_mov_b32 s92, 37248
    ds_read_b64_tr_b16 a[36:37], v143 offset:36896
    v_mfma_f32_16x16x32_bf16 v[60:63], a[56:59], v[40:43], v[60:63]
    s_waitcnt lgkmcnt(6)
    ds_read_b64_tr_b16 a[38:39], v143 offset:37664
    v_mfma_f32_16x16x32_bf16 v[28:31], a[8:11], v[16:19], v[28:31]
    ds_read_b64_tr_b16 a[60:61], v143 offset:36928
    v_mfma_f32_16x16x32_bf16 v[2:5], a[32:35], v[16:19], v[2:5]
    buffer_load_dwordx4 v20, s[32:35], s92 offen offset:0 lds
    ds_read_b64_tr_b16 a[62:63], v143 offset:37696
    v_mfma_f32_16x16x32_bf16 v[56:59], a[56:59], v[16:19], v[56:59]
    ds_read_b128 v[52:55], v166 offset:42624
    v_mfma_f32_16x16x32_bf16 v[12:15], a[8:11], v[100:103], v[12:15]
    ds_read_b128 v[40:43], v166 offset:128
    v_mfma_f32_16x16x32_bf16 v[64:67], a[32:35], v[100:103], v[64:67]
    ds_read_b128 v[16:19], v166 offset:1664
    v_mfma_f32_16x16x32_bf16 v[84:87], a[56:59], v[100:103], v[84:87]
    s_waitcnt lgkmcnt(8)
    ds_read_b32 v184, v184 offset:336
    v_mfma_f32_16x16x32_bf16 v[36:39], a[8:11], v[92:95], v[36:39]
    buffer_load_dwordx4 v34, s[32:35], s92 offen offset:1024 lds
    v_mfma_f32_16x16x32_bf16 v[248:251], a[32:35], v[92:95], v[248:251]
    ds_read_b128 v[100:103], v166 offset:3200
    v_mfma_f32_16x16x32_bf16 v[240:243], a[56:59], v[92:95], v[240:243]
    s_waitcnt lgkmcnt(7)
    ds_read_b32 v185, v185 offset:336
    v_mfma_f32_16x16x32_bf16 v[96:99], a[12:15], v[80:83], v[96:99]
    v_mfma_f32_16x16x32_bf16 v[8:11], a[36:39], v[80:83], v[8:11]
    s_waitcnt lgkmcnt(6)
    ds_read_b128 v[92:95], v47 offset:41216
    v_mfma_f32_16x16x32_bf16 v[88:91], a[60:63], v[80:83], v[88:91]
    s_waitcnt vmcnt(8) lgkmcnt(6)
    buffer_load_dwordx4 v21, s[32:35], s92 offen offset:2048 lds
    ds_read_b64_tr_b16 a[16:17], v143 offset:49152
    v_mfma_f32_16x16x32_bf16 v[76:79], a[12:15], v[52:55], v[76:79]
    s_add_u32 m0, s90, 24576
    ds_read_b64_tr_b16 a[18:19], v143 offset:49920
    v_mfma_f32_16x16x32_bf16 v[68:71], a[36:39], v[52:55], v[68:71]
    s_mov_b32 s92, 74112
    ds_read_b64_tr_b16 a[40:41], v143 offset:49184
    v_mfma_f32_16x16x32_bf16 v[60:63], a[60:63], v[52:55], v[60:63]
    s_waitcnt lgkmcnt(6)
    ds_read_b64_tr_b16 a[42:43], v143 offset:49952
    v_mfma_f32_16x16x32_bf16 v[28:31], a[12:15], v[40:43], v[28:31]
    ds_read_b64_tr_b16 a[64:65], v143 offset:49216
    v_mfma_f32_16x16x32_bf16 v[2:5], a[36:39], v[40:43], v[2:5]
    buffer_load_dwordx4 v20, s[32:35], s92 offen offset:0 lds
    ds_read_b64_tr_b16 a[66:67], v143 offset:49984
    v_mfma_f32_16x16x32_bf16 v[56:59], a[60:63], v[40:43], v[56:59]
    ds_read_b128 v[80:83], v47 offset:42752
    v_mfma_f32_16x16x32_bf16 v[12:15], a[12:15], v[16:19], v[12:15]
    ds_read_b128 v[52:55], v47 offset:256
    v_mov_b32 v35, 0
    v_mfma_f32_16x16x32_bf16 v[64:67], a[36:39], v[16:19], v[64:67]
    ds_read_b128 v[40:43], v47 offset:1792
    v_mfma_f32_16x16x32_bf16 v[84:87], a[60:63], v[16:19], v[84:87]
    s_waitcnt lgkmcnt(8)
    ds_read_b32 v186, v186 offset:336
    v_mfma_f32_16x16x32_bf16 v[36:39], a[12:15], v[100:103], v[36:39]
    buffer_load_dwordx4 v34, s[32:35], s92 offen offset:1024 lds
    v_mfma_f32_16x16x32_bf16 v[248:251], a[36:39], v[100:103], v[248:251]
    ds_read_b128 v[16:19], v47 offset:3328
    v_mfma_f32_16x16x32_bf16 v[240:243], a[60:63], v[100:103], v[240:243]
    s_waitcnt lgkmcnt(7)
    ds_read_b32 v187, v187 offset:336
    v_mfma_f32_16x16x32_bf16 v[96:99], a[16:19], v[92:95], v[96:99]
    v_mfma_f32_16x16x32_bf16 v[8:11], a[40:43], v[92:95], v[8:11]
    s_waitcnt lgkmcnt(6)
    ds_read_b128 v[100:103], v166 offset:41216
    v_mfma_f32_16x16x32_bf16 v[88:91], a[64:67], v[92:95], v[88:91]
    s_waitcnt vmcnt(8) lgkmcnt(6)
    buffer_load_dwordx4 v21, s[32:35], s92 offen offset:2048 lds
    ds_read_b64_tr_b16 a[20:21], v143 offset:61440
    v_mfma_f32_16x16x32_bf16 v[76:79], a[16:19], v[80:83], v[76:79]
    s_add_u32 m0, s90, 36864
    ds_read_b64_tr_b16 a[22:23], v143 offset:62208
    v_mfma_f32_16x16x32_bf16 v[68:71], a[40:43], v[80:83], v[68:71]
    s_mov_b32 s92, 110976
    ds_read_b64_tr_b16 a[44:45], v143 offset:61472
    v_mfma_f32_16x16x32_bf16 v[60:63], a[64:67], v[80:83], v[60:63]
    s_waitcnt lgkmcnt(6)
    ds_read_b64_tr_b16 a[46:47], v143 offset:62240
    v_mfma_f32_16x16x32_bf16 v[28:31], a[16:19], v[52:55], v[28:31]
    ds_read_b64_tr_b16 a[68:69], v143 offset:61504
    v_mfma_f32_16x16x32_bf16 v[2:5], a[40:43], v[52:55], v[2:5]
    buffer_load_dwordx4 v20, s[32:35], s92 offen offset:0 lds
    ds_read_b64_tr_b16 a[70:71], v143 offset:62272
    v_mfma_f32_16x16x32_bf16 v[56:59], a[64:67], v[52:55], v[56:59]
    ds_read_b128 v[80:83], v166 offset:42752
    v_mfma_f32_16x16x32_bf16 v[12:15], a[16:19], v[40:43], v[12:15]
    ds_read_b128 v[52:55], v166 offset:256
    v_mfma_f32_16x16x32_bf16 v[64:67], a[40:43], v[40:43], v[64:67]
    ds_read_b128 v[92:95], v166 offset:1792
    v_mfma_f32_16x16x32_bf16 v[84:87], a[64:67], v[40:43], v[84:87]
    s_waitcnt lgkmcnt(8)
    ds_read_b32 v204, v204 offset:336
    v_mfma_f32_16x16x32_bf16 v[36:39], a[16:19], v[16:19], v[36:39]
    buffer_load_dwordx4 v34, s[32:35], s92 offen offset:1024 lds
    v_mfma_f32_16x16x32_bf16 v[248:251], a[40:43], v[16:19], v[248:251]
    ds_read_b128 v[40:43], v166 offset:3328
    v_mfma_f32_16x16x32_bf16 v[240:243], a[64:67], v[16:19], v[240:243]
    s_waitcnt lgkmcnt(7)
    ds_read_b32 v205, v205 offset:336
    v_mfma_f32_16x16x32_bf16 v[96:99], a[20:23], v[100:103], v[96:99]
    v_mfma_f32_16x16x32_bf16 v[8:11], a[44:47], v[100:103], v[8:11]
    s_waitcnt lgkmcnt(6)
    ds_read_b128 v[16:19], v47 offset:40960
    v_mfma_f32_16x16x32_bf16 v[88:91], a[68:71], v[100:103], v[88:91]
    s_waitcnt vmcnt(8) lgkmcnt(6)
    buffer_load_dwordx4 v21, s[32:35], s92 offen offset:2048 lds
    ds_read_b64_tr_b16 a[72:73], v143 offset:0
    v_mfma_f32_16x16x32_bf16 v[76:79], a[20:23], v[80:83], v[76:79]
    s_add_u32 m0, s90, 49152
    ds_read_b64_tr_b16 a[74:75], v143 offset:768
    v_cvt_pk_f16_f32 v108, v96, v97
    v_mfma_f32_16x16x32_bf16 v[68:71], a[44:47], v[80:83], v[68:71]
    s_mov_b32 s92, 147840
    ds_read_b64_tr_b16 a[96:97], v143 offset:32
    v_cvt_pk_f16_f32 v109, v98, v99
    v_mfma_f32_16x16x32_bf16 v[60:63], a[68:71], v[80:83], v[60:63]
    s_waitcnt lgkmcnt(6)
    ds_read_b64_tr_b16 a[98:99], v143 offset:800
    v_pk_fma_f16 v232, v108, v108, s39
    v_mfma_f32_16x16x32_bf16 v[28:31], a[20:23], v[52:55], v[28:31]
    ds_read_b64_tr_b16 a[120:121], v143 offset:64
    v_pk_fmac_f16 v232, v109, v109
    v_mfma_f32_16x16x32_bf16 v[2:5], a[44:47], v[52:55], v[2:5]
    buffer_load_dwordx4 v20, s[32:35], s92 offen offset:0 lds
    ds_read_b64_tr_b16 a[122:123], v143 offset:832
    v_mfma_f32_16x16x32_bf16 v[56:59], a[68:71], v[52:55], v[56:59]
    ds_read_b128 v[80:83], v47 offset:42496
    v_cvt_pk_f16_f32 v110, v8, v9
    v_mfma_f32_16x16x32_bf16 v[12:15], a[20:23], v[92:95], v[12:15]
    ds_read_b128 v[52:55], v47 offset:0
    v_cvt_pk_f16_f32 v111, v10, v11
    v_mfma_f32_16x16x32_bf16 v[64:67], a[44:47], v[92:95], v[64:67]
    ds_read_b128 v[8:11], v47 offset:1536
    v_pk_fmac_f16 v232, v110, v110
    v_mfma_f32_16x16x32_bf16 v[84:87], a[68:71], v[92:95], v[84:87]
    s_waitcnt lgkmcnt(8)
    ds_read_b32 v206, v206 offset:336
    v_pk_fmac_f16 v232, v111, v111
    v_mfma_f32_16x16x32_bf16 v[36:39], a[20:23], v[40:43], v[36:39]
    buffer_load_dwordx4 v34, s[32:35], s92 offen offset:1024 lds
    v_cvt_pk_f16_f32 v32, v88, v89
    v_mfma_f32_16x16x32_bf16 v[248:251], a[44:47], v[40:43], v[248:251]
    ds_read_b128 v[112:115], v47 offset:3072
    v_cvt_pk_f16_f32 v33, v90, v91
    v_mfma_f32_16x16x32_bf16 v[240:243], a[68:71], v[40:43], v[240:243]
    s_waitcnt lgkmcnt(7)
    ds_read_b32 v207, v207 offset:336
    v_pk_fmac_f16 v232, v32, v32
    v_mfma_f32_16x16x32_bf16 v[104:107], a[72:75], v[16:19], 0
    v_pk_fmac_f16 v232, v33, v33
    v_cvt_pk_f16_f32 v120, v76, v77
    v_mfma_f32_16x16x32_bf16 v[244:247], a[96:99], v[16:19], 0
    s_waitcnt lgkmcnt(6)
    ds_read_b128 v[40:43], v166 offset:40960
    v_cvt_pk_f16_f32 v121, v78, v79
    v_mfma_f32_16x16x32_bf16 v[116:119], a[120:123], v[16:19], 0
    s_waitcnt vmcnt(8) lgkmcnt(6)
    buffer_load_dwordx4 v21, s[32:35], s92 offen offset:2048 lds
    ds_read_b64_tr_b16 a[76:77], v143 offset:12288
    v_mfma_f32_16x16x32_bf16 v[100:103], a[72:75], v[80:83], 0
    s_add_u32 m0, s90, 61440
    ds_read_b64_tr_b16 a[78:79], v143 offset:13056
    v_pk_fma_f16 v234, v120, v120, s39
    v_mfma_f32_16x16x32_bf16 v[76:79], a[96:99], v[80:83], 0
    s_mov_b32 s92, 184704
    ds_read_b64_tr_b16 a[100:101], v143 offset:12320
    v_pk_fmac_f16 v234, v121, v121
    v_mfma_f32_16x16x32_bf16 v[16:19], a[120:123], v[80:83], 0
    s_waitcnt lgkmcnt(6)
    ds_read_b64_tr_b16 a[102:103], v143 offset:13088
    v_cvt_pk_f16_f32 v122, v68, v69
    v_mfma_f32_16x16x32_bf16 v[236:239], a[72:75], v[52:55], 0
    ds_read_b64_tr_b16 a[124:125], v143 offset:12352
    v_cvt_pk_f16_f32 v123, v70, v71
    v_mfma_f32_16x16x32_bf16 v[228:231], a[96:99], v[52:55], 0
    buffer_load_dwordx4 v20, s[32:35], s92 offen offset:0 lds
    ds_read_b64_tr_b16 a[126:127], v143 offset:13120
    v_mfma_f32_16x16x32_bf16 v[92:95], a[120:123], v[52:55], 0
    ds_read_b128 v[224:227], v166 offset:42496
    v_pk_fmac_f16 v234, v122, v122
    v_mfma_f32_16x16x32_bf16 v[96:99], a[72:75], v[8:11], 0
    ds_read_b128 v[52:55], v166 offset:0
    v_pk_fmac_f16 v234, v123, v123
    v_cvt_pk_f16_f32 v24, v60, v61
    v_cvt_pk_f16_f32 v25, v62, v63
    v_pk_fmac_f16 v234, v24, v24
    v_pk_fmac_f16 v234, v25, v25
    v_mfma_f32_16x16x32_bf16 v[88:91], a[96:99], v[8:11], 0
    ds_read_b128 v[80:83], v166 offset:1536
    v_cvt_pk_f16_f32 v0, v28, v29
    v_mfma_f32_16x16x32_bf16 v[68:71], a[120:123], v[8:11], 0
    s_waitcnt lgkmcnt(7)
    buffer_load_dwordx4 v34, s[32:35], s92 offen offset:1024 lds
    ds_read_b32 v200, v200 offset:336
    v_mfma_f32_16x16x32_bf16 v[8:11], a[72:75], v[112:115], 0
    v_cvt_pk_f16_f32 v1, v30, v31
    v_pk_fma_f16 v60, v0, v0, s39
    v_mfma_f32_16x16x32_bf16 v[104:107], a[76:79], v[40:43], v[104:107]
    s_waitcnt lgkmcnt(6)
    ds_read_b128 v[252:255], v166 offset:3072
    v_pk_fmac_f16 v60, v1, v1
    v_mfma_f32_16x16x32_bf16 v[244:247], a[100:103], v[40:43], v[244:247]
    s_waitcnt lgkmcnt(5)
    ds_read_b32 v201, v201 offset:336
    v_cvt_pk_f16_f32 v2, v2, v3
    v_cvt_pk_f16_f32 v3, v4, v5
    v_pk_fmac_f16 v60, v2, v2
    v_mfma_f32_16x16x32_bf16 v[116:119], a[124:127], v[40:43], v[116:119]
    s_waitcnt lgkmcnt(5)
    ds_read_b128 v[40:43], v47 offset:41088
    buffer_load_dwordx4 v21, s[32:35], s92 offen offset:2048 lds
    v_mfma_f32_16x16x32_bf16 v[100:103], a[76:79], v[224:227], v[100:103]
    s_waitcnt vmcnt(9)
    s_add_u32 m0, s90, 0
    ds_read_b64_tr_b16 a[80:81], v143 offset:24576
    v_pk_fmac_f16 v60, v3, v3
    v_mfma_f32_16x16x32_bf16 v[76:79], a[100:103], v[224:227], v[76:79]
    s_mov_b32 s92, 768
    ds_read_b64_tr_b16 a[82:83], v143 offset:25344
    v_cvt_pk_f16_f32 v154, v56, v57
    v_mfma_f32_16x16x32_bf16 v[16:19], a[124:127], v[224:227], v[16:19]
    s_waitcnt lgkmcnt(6)
    ds_read_b64_tr_b16 a[104:105], v143 offset:24608
    v_cvt_pk_f16_f32 v155, v58, v59
    v_mfma_f32_16x16x32_bf16 v[236:239], a[76:79], v[52:55], v[236:239]
    ds_read_b64_tr_b16 a[106:107], v143 offset:25376
    v_pk_fmac_f16 v60, v154, v154
    v_mfma_f32_16x16x32_bf16 v[228:231], a[100:103], v[52:55], v[228:231]
    ds_read_b64_tr_b16 a[128:129], v143 offset:24640
    buffer_load_dwordx4 v20, s[32:35], s92 offen offset:0 lds
    v_mfma_f32_16x16x32_bf16 v[92:95], a[124:127], v[52:55], v[92:95]
    ds_read_b64_tr_b16 a[130:131], v143 offset:25408
    v_pk_fmac_f16 v60, v155, v155
    v_mfma_f32_16x16x32_bf16 v[56:59], a[96:99], v[112:115], 0
    ds_read_b128 v[28:31], v47 offset:42624
    v_cvt_pk_f16_f32 v12, v12, v13
    v_mfma_f32_16x16x32_bf16 v[52:55], a[120:123], v[112:115], 0
    ds_read_b128 v[224:227], v47 offset:128
    v_cvt_pk_f16_f32 v13, v14, v15
    v_mfma_f32_16x16x32_bf16 v[96:99], a[76:79], v[80:83], v[96:99]
    ds_read_b128 v[112:115], v47 offset:1664
    v_pk_fma_f16 v62, v12, v12, s39
    v_mfma_f32_16x16x32_bf16 v[88:91], a[100:103], v[80:83], v[88:91]
    ds_read_b32 v202, v202 offset:336
    buffer_load_dwordx4 v34, s[32:35], s92 offen offset:1024 lds
    v_mfma_f32_16x16x32_bf16 v[68:71], a[124:127], v[80:83], v[68:71]
    s_waitcnt lgkmcnt(8)
    v_pk_fmac_f16 v62, v13, v13
    v_cvt_pk_f16_f32 v14, v64, v65
    v_mfma_f32_16x16x32_bf16 v[8:11], a[76:79], v[252:255], v[8:11]
    ds_read_b128 v[80:83], v47 offset:3200
    v_cvt_pk_f16_f32 v15, v66, v67
    v_mfma_f32_16x16x32_bf16 v[56:59], a[100:103], v[252:255], v[56:59]
    ds_read_b32 v203, v203 offset:336
    v_pk_fmac_f16 v62, v14, v14
    v_mfma_f32_16x16x32_bf16 v[52:55], a[124:127], v[252:255], v[52:55]
    v_pk_fmac_f16 v62, v15, v15
    v_cvt_pk_f16_f32 v150, v84, v85
    v_mfma_f32_16x16x32_bf16 v[104:107], a[80:83], v[40:43], v[104:107]
    s_waitcnt lgkmcnt(6)
    ds_read_b128 v[64:67], v166 offset:41088
    buffer_load_dwordx4 v21, s[32:35], s92 offen offset:2048 lds
    v_mfma_f32_16x16x32_bf16 v[244:247], a[104:107], v[40:43], v[244:247]
    s_waitcnt vmcnt(9)
    s_add_u32 m0, s90, 12288
    ds_read_b64_tr_b16 a[84:85], v143 offset:36864
    v_cvt_pk_f16_f32 v151, v86, v87
    v_mfma_f32_16x16x32_bf16 v[116:119], a[128:131], v[40:43], v[116:119]
    s_waitcnt lgkmcnt(6)
    s_mov_b32 s92, 37632
    ds_read_b64_tr_b16 a[86:87], v143 offset:37632
    v_pk_fmac_f16 v62, v150, v150
    v_mfma_f32_16x16x32_bf16 v[100:103], a[80:83], v[28:31], v[100:103]
    ds_read_b64_tr_b16 a[108:109], v143 offset:36896
    v_pk_fmac_f16 v62, v151, v151
    v_mfma_f32_16x16x32_bf16 v[76:79], a[104:107], v[28:31], v[76:79]
    ds_read_b64_tr_b16 a[110:111], v143 offset:37664
    v_cvt_pk_f16_f32 v36, v36, v37
    v_mfma_f32_16x16x32_bf16 v[16:19], a[128:131], v[28:31], v[16:19]
    ds_read_b64_tr_b16 a[132:133], v143 offset:36928
    buffer_load_dwordx4 v20, s[32:35], s92 offen offset:0 lds
    v_mfma_f32_16x16x32_bf16 v[236:239], a[80:83], v[224:227], v[236:239]
    ds_read_b64_tr_b16 a[134:135], v143 offset:37696
    v_cvt_pk_f16_f32 v37, v38, v39
    v_pk_fma_f16 v40, v36, v36, s39
    v_pk_fmac_f16 v40, v37, v37
    v_cvt_pk_f16_f32 v38, v248, v249
    v_cvt_pk_f16_f32 v39, v250, v251
    v_pk_fmac_f16 v40, v38, v38
    v_pk_fmac_f16 v40, v39, v39
    v_cvt_pk_f16_f32 v146, v240, v241
    v_cvt_pk_f16_f32 v147, v242, v243
    v_pk_fmac_f16 v40, v146, v146
    v_pk_fmac_f16 v40, v147, v147
    v_mfma_f32_16x16x32_bf16 v[228:231], a[104:107], v[224:227], v[228:231]
    ds_read_b128 v[28:31], v166 offset:42624
    v_mfma_f32_16x16x32_bf16 v[92:95], a[128:131], v[224:227], v[92:95]
    s_waitcnt lgkmcnt(5)
    buffer_load_dwordx4 v34, s[32:35], s92 offen offset:1024 lds
    ds_read_b128 v[84:87], v166 offset:128
    v_mfma_f32_16x16x32_bf16 v[96:99], a[80:83], v[112:115], v[96:99]
    ds_read_b128 v[248:251], v166 offset:1664
    v_mfma_f32_16x16x32_bf16 v[88:91], a[104:107], v[112:115], v[88:91]
    ds_read_b32 v196, v196 offset:336
    v_mfma_f32_16x16x32_bf16 v[68:71], a[128:131], v[112:115], v[68:71]
    v_mfma_f32_16x16x32_bf16 v[8:11], a[80:83], v[80:83], v[8:11]
    ds_read_b128 v[224:227], v166 offset:3200
    v_mfma_f32_16x16x32_bf16 v[56:59], a[104:107], v[80:83], v[56:59]
    s_waitcnt vmcnt(8)
    buffer_load_dwordx4 v21, s[32:35], s92 offen offset:2048 lds
    ds_read_b64_tr_b16 a[88:89], v143 offset:49152
    v_mfma_f32_16x16x32_bf16 v[52:55], a[128:131], v[80:83], v[52:55]
    s_add_u32 m0, s90, 24576
    ds_read_b64_tr_b16 a[90:91], v143 offset:49920
    v_mfma_f32_16x16x32_bf16 v[104:107], a[84:87], v[64:67], v[104:107]
    s_waitcnt lgkmcnt(7)
    s_mov_b32 s92, 74496
    ds_read_b64_tr_b16 a[112:113], v143 offset:49184
    v_mfma_f32_16x16x32_bf16 v[244:247], a[108:111], v[64:67], v[244:247]
    ds_read_b64_tr_b16 a[114:115], v143 offset:49952
    v_mfma_f32_16x16x32_bf16 v[116:119], a[132:135], v[64:67], v[116:119]
    s_waitcnt lgkmcnt(7)
    ds_read_b64_tr_b16 a[136:137], v143 offset:49216
    v_mov_b32 v42, 0
    v_mfma_f32_16x16x32_bf16 v[100:103], a[84:87], v[28:31], v[100:103]
    buffer_load_dwordx4 v20, s[32:35], s92 offen offset:0 lds
    ds_read_b64_tr_b16 a[138:139], v143 offset:49984
    v_mfma_f32_16x16x32_bf16 v[76:79], a[108:111], v[28:31], v[76:79]
    ds_read_b128 v[64:67], v166 offset:41216
    v_mov_b32 v43, 0
    v_mfma_f32_16x16x32_bf16 v[16:19], a[132:135], v[28:31], v[16:19]
    ds_read_b128 v[28:31], v166 offset:42752
    v_mov_b32 v26, 0xf149f2ca
    v_mfma_f32_16x16x32_bf16 v[236:239], a[84:87], v[84:87], v[236:239]
    ds_read_b128 v[112:115], v166 offset:256
    v_mfma_f32_16x16x32_bf16 v[228:231], a[108:111], v[84:87], v[228:231]
    ds_read_b128 v[80:83], v166 offset:1792
    v_mfma_f32_16x16x32_bf16 v[92:95], a[132:135], v[84:87], v[92:95]
    s_waitcnt lgkmcnt(8)
    buffer_load_dwordx4 v34, s[32:35], s92 offen offset:1024 lds
    ds_read_b128 v[240:243], v166 offset:3328
    v_mfma_f32_16x16x32_bf16 v[96:99], a[84:87], v[248:251], v[96:99]
    s_mov_b32 s53, s47
    v_add_u32 v134, 336, v134
    v_mfma_f32_16x16x32_bf16 v[88:91], a[108:111], v[248:251], v[88:91]
    s_mov_b32 s47, s46
    ds_read_b128 v[84:87], v47 offset:41216
    v_mfma_f32_16x16x32_bf16 v[68:71], a[132:135], v[248:251], v[68:71]
    s_mov_b32 s46, s45
    ds_read_b128 v[248:251], v47 offset:42752
    v_add_u32 v133, 336, v133
    v_mfma_f32_16x16x32_bf16 v[8:11], a[84:87], v[224:227], v[8:11]
    s_mov_b32 s45, s44
    ds_read_b32 v197, v197 offset:336
    v_mfma_f32_16x16x32_bf16 v[56:59], a[108:111], v[224:227], v[56:59]
    s_mov_b32 s44, s53
    buffer_load_dwordx4 v21, s[32:35], s92 offen offset:2048 lds
    v_mfma_f32_16x16x32_bf16 v[52:55], a[132:135], v[224:227], v[52:55]
    s_waitcnt vmcnt(9)
    s_add_u32 m0, s90, 36864
    ds_read_b64_tr_b16 a[92:93], v143 offset:61440
    ds_read_b64_tr_b16 a[94:95], v143 offset:62208
    s_mov_b32 s92, 111360
    ds_read_b64_tr_b16 a[116:117], v143 offset:61472
    s_sub_u32 s48, s44, s46
    ds_read_b64_tr_b16 a[118:119], v143 offset:62240
    v_add_u32 v139, s48, v139
    s_sub_u32 s49, s46, s45
    s_sub_u32 s50, s45, s44
    ds_read_b64_tr_b16 a[140:141], v143 offset:61504
    v_add_u32 v138, s48, v138
    s_sub_u32 s51, s46, s47
    s_mov_b32 s60, s59
    ds_read_b64_tr_b16 a[142:143], v143 offset:62272
    buffer_load_dwordx4 v20, s[32:35], s92 offen offset:0 lds
    ds_read_b128 v[224:227], v47 offset:256
    v_add_u32 v137, s49, v137
    v_add_u32 v136, s49, v136
    s_waitcnt lgkmcnt(9)
    v_mfma_f32_16x16x32_bf16 v[104:107], a[88:91], v[84:87], v[104:107]
    s_mov_b32 s59, s58
    ds_read_b32 v198, v198 offset:336
    v_add_u32 v139, s50, v139
    v_mfma_f32_16x16x32_bf16 v[244:247], a[112:115], v[84:87], v[244:247]
    s_mov_b32 s58, s57
    v_add_u32 v138, s50, v138
    v_add_u32 v137, s48, v137
    v_mfma_f32_16x16x32_bf16 v[116:119], a[136:139], v[84:87], v[116:119]
    s_waitcnt lgkmcnt(8)
    s_mov_b32 s57, s56
    ds_read_b32 v199, v199 offset:336
    v_add_u32 v136, s48, v136
    v_mfma_f32_16x16x32_bf16 v[100:103], a[88:91], v[248:251], v[100:103]
    s_add_u32 s61, s61, 1
    v_add_u32 v135, s51, v135
    v_mfma_f32_16x16x32_bf16 v[76:79], a[112:115], v[248:251], v[76:79]
    s_waitcnt lgkmcnt(6)
    s_cmp_eq_u32 s61, 72
    buffer_load_dwordx4 v34, s[32:35], s92 offen offset:1024 lds
    ds_read_b128 v[84:87], v47 offset:1792
    v_mfma_f32_16x16x32_bf16 v[104:107], a[92:95], v[64:67], v[104:107]
    s_waitcnt lgkmcnt(6)
    s_cselect_b32 s53, s63, 0
    v_mfma_f32_16x16x32_bf16 v[244:247], a[116:119], v[64:67], v[244:247]
    s_waitcnt lgkmcnt(4)
    s_cselect_b32 s61, 0, s61
    ds_write_b128 v51, v[216:219] offset:5792
    v_mfma_f32_16x16x32_bf16 v[116:119], a[140:143], v[64:67], v[116:119]
    s_sub_u32 s64, s64, 1
    v_cvt_pk_f16_f32 v64, v104, v105
    v_cvt_pk_f16_f32 v65, v106, v107
    v_mfma_f32_16x16x32_bf16 v[100:103], a[92:95], v[28:31], v[100:103]
    s_add_u32 s65, s65, 1
    buffer_load_dwordx4 v21, s[32:35], s92 offen offset:2048 lds
    v_pk_fma_f16 v233, v64, v64, s39
    v_mfma_f32_16x16x32_bf16 v[76:79], a[116:119], v[28:31], v[76:79]
    s_waitcnt vmcnt(9)
    s_add_u32 m0, s90, 49152
    ds_read_b64_tr_b16 a[144:145], v157 offset:0
    v_pk_fmac_f16 v233, v65, v65
    v_mfma_f32_16x16x32_bf16 v[16:19], a[136:139], v[248:251], v[16:19]
    s_mov_b32 s92, 148224
    ds_read_b64_tr_b16 a[146:147], v157 offset:768
    v_cvt_pk_f16_f32 v66, v244, v245
    v_mfma_f32_16x16x32_bf16 v[16:19], a[140:143], v[28:31], v[16:19]
    s_waitcnt lgkmcnt(4)
    s_cmp_ge_i32 s65, 2
    ds_read_b64_tr_b16 a[168:169], v157 offset:8
    v_cvt_pk_f16_f32 v67, v246, v247
    v_mfma_f32_16x16x32_bf16 v[236:239], a[88:91], v[224:227], v[236:239]
    s_cselect_b32 s30, 100270464, 0
    ds_read_b64_tr_b16 a[170:171], v157 offset:776
    v_pk_fmac_f16 v233, v66, v66
    v_mfma_f32_16x16x32_bf16 v[236:239], a[92:95], v[112:115], v[236:239]
    s_add_u32 s67, s46, s54
    buffer_load_dwordx4 v20, s[32:35], s92 offen offset:0 lds
    ds_read_b64_tr_b16 a[192:193], v143 offset:64
    v_mfma_f32_16x16x32_bf16 v[228:231], a[112:115], v[224:227], v[228:231]
    ds_read_b64_tr_b16 a[194:195], v143 offset:832
    v_pk_fmac_f16 v233, v67, v67
    v_mfma_f32_16x16x32_bf16 v[228:231], a[116:119], v[112:115], v[228:231]
    ds_read_b128 v[244:247], v47 offset:3328
    v_cvt_pk_f16_f32 v28, v116, v117
    v_mfma_f32_16x16x32_bf16 v[92:95], a[136:139], v[224:227], v[92:95]
    v_cvt_pk_f16_f32 v29, v118, v119
    v_pk_fmac_f16 v233, v28, v28
    v_mfma_f32_16x16x32_bf16 v[92:95], a[140:143], v[112:115], v[92:95]
    s_waitcnt lgkmcnt(7)
    ds_read_b128 v[224:227], v47 offset:3072
    v_pk_fmac_f16 v233, v29, v29
    v_mfma_f32_16x16x32_bf16 v[96:99], a[88:91], v[84:87], v[96:99]
    buffer_load_dwordx4 v34, s[32:35], s92 offen offset:1024 lds
    ds_read_b128 v[116:119], v166 offset:3072
    v_mfma_f32_16x16x32_bf16 v[96:99], a[92:95], v[80:83], v[96:99]
    v_cvt_pk_f16_f32 v100, v100, v101
    v_cvt_pk_f16_f32 v101, v102, v103
    v_mfma_f32_16x16x32_bf16 v[88:91], a[112:115], v[84:87], v[88:91]
    ds_read_b128 v[112:115], v47 offset:3200
    v_pk_fma_f16 v235, v100, v100, s39
    v_mfma_f32_16x16x32_bf16 v[88:91], a[116:119], v[80:83], v[88:91]
    ds_read_b128 v[104:107], v166 offset:3200
    v_pk_fmac_f16 v235, v101, v101
    v_mfma_f32_16x16x32_bf16 v[68:71], a[136:139], v[84:87], v[68:71]
    ds_read_b128 v[84:87], v47 offset:3328
    v_cvt_pk_f16_f32 v102, v76, v77
    v_mfma_f32_16x16x32_bf16 v[68:71], a[140:143], v[80:83], v[68:71]
    s_waitcnt vmcnt(8) lgkmcnt(5)
    buffer_load_dwordx4 v21, s[32:35], s92 offen offset:2048 lds
    ds_read_b64_tr_b16 a[148:149], v157 offset:12288
    v_cvt_pk_f16_f32 v103, v78, v79
    v_mfma_f32_16x16x32_bf16 v[8:11], a[88:91], v[244:247], v[8:11]
    s_add_u32 m0, s90, 61440
    ds_read_b64_tr_b16 a[150:151], v157 offset:13056
    v_pk_fmac_f16 v235, v102, v102
    v_mfma_f32_16x16x32_bf16 v[8:11], a[92:95], v[240:243], v[8:11]
    s_mov_b32 s92, 185088
    ds_read_b64_tr_b16 a[172:173], v157 offset:12296
    v_pk_fmac_f16 v235, v103, v103
    v_mfma_f32_16x16x32_bf16 v[56:59], a[112:115], v[244:247], v[56:59]
    ds_read_b64_tr_b16 a[174:175], v157 offset:13064
    v_cvt_pk_f16_f32 v4, v16, v17
    v_mfma_f32_16x16x32_bf16 v[56:59], a[116:119], v[240:243], v[56:59]
    ds_read_b64_tr_b16 a[196:197], v143 offset:12352
    v_cvt_pk_f16_f32 v5, v18, v19
    v_mfma_f32_16x16x32_bf16 v[52:55], a[136:139], v[244:247], v[52:55]
    buffer_load_dwordx4 v20, s[32:35], s92 offen offset:0 lds
    ds_read_b64_tr_b16 a[198:199], v143 offset:13120
    v_mfma_f32_16x16x32_bf16 v[52:55], a[140:143], v[240:243], v[52:55]
    ds_read_b128 v[76:79], v166 offset:3328
    v_pk_fmac_f16 v235, v4, v4
    v_pk_fmac_f16 v235, v5, v5
    v_cvt_pk_f16_f32 v16, v236, v237
    v_cvt_pk_f16_f32 v17, v238, v239
    v_mfma_f32_16x16x32_f16 v[80:83], v[212:215], v[232:235], 0
    v_pk_fma_f16 v61, v16, v16, s39
    v_pk_fmac_f16 v61, v17, v17
    v_cvt_pk_f16_f32 v18, v228, v229
    v_cvt_pk_f16_f32 v19, v230, v231
    v_pk_fmac_f16 v61, v18, v18
    v_pk_fmac_f16 v61, v19, v19
    v_cvt_pk_f16_f32 v20, v92, v93
    buffer_load_dwordx4 v34, s[32:35], s92 offen offset:1024 lds
    v_or3_b32 v125, v125, v80, v81
    v_rsq_f32 v80, v80
    v_rsq_f32 v81, v81
    v_mul_f32 v80, s52, v80
    v_cvt_pk_f16_f32 v80, v80, v81
    v_or3_b32 v125, v125, v82, v83
    v_rsq_f32 v82, v82
    v_rsq_f32 v83, v83
    v_mul_f32 v82, s52, v82
    v_cvt_pk_f16_f32 v82, v82, v83
    v_pk_mul_f16 v108, v108, v80 op_sel:[0,0] op_sel_hi:[1,0]
    v_pk_mul_f16 v109, v109, v80 op_sel:[0,0] op_sel_hi:[1,0]
    v_pk_mul_f16 v110, v110, v80 op_sel:[0,0] op_sel_hi:[1,0]
    buffer_load_dwordx4 v21, s[32:35], s92 offen offset:2048 lds
    s_add_u32 m0, s90, 0
    s_mov_b32 s92, 0
    s_waitcnt vmcnt(9)
    ds_read_b64_tr_b16 a[152:153], v157 offset:24576
    v_pk_mul_f16 v111, v111, v80 op_sel:[0,0] op_sel_hi:[1,0]
    v_pk_mul_f16 v32, v32, v80 op_sel:[0,0] op_sel_hi:[1,0]
    v_pk_mul_f16 v33, v33, v80 op_sel:[0,0] op_sel_hi:[1,0]
    ds_read_b64_tr_b16 a[154:155], v157 offset:25344
    v_pk_mul_f16 v64, v64, v80 op_sel:[0,1] op_sel_hi:[1,1]
    v_pk_mul_f16 v65, v65, v80 op_sel:[0,1] op_sel_hi:[1,1]
    v_pk_mul_f16 v66, v66, v80 op_sel:[0,1] op_sel_hi:[1,1]
    ds_read_b64_tr_b16 a[176:177], v157 offset:24584
    v_pk_mul_f16 v67, v67, v80 op_sel:[0,1] op_sel_hi:[1,1]
    v_pk_mul_f16 v28, v28, v80 op_sel:[0,1] op_sel_hi:[1,1]
    buffer_load_dwordx4 v142, s[76:79], s92 offen offset:0 lds
    ds_read_b64_tr_b16 a[178:179], v157 offset:25352
    v_pk_mul_f16 v29, v29, v80 op_sel:[0,1] op_sel_hi:[1,1]
    v_fma_mix_f32 v34, v108, v64, 0 op_sel:[0,0,0] op_sel_hi:[1,1,0]
    v_fma_mix_f32 v34, v108, v64, v34 op_sel:[1,1,0] op_sel_hi:[1,1,0]
    ds_read_b64_tr_b16 a[200:201], v143 offset:24640
    v_fma_mix_f32 v34, v109, v65, v34 op_sel:[0,0,0] op_sel_hi:[1,1,0]
    ds_read_b64_tr_b16 a[202:203], v143 offset:25408
    v_fma_mix_f32 v34, v109, v65, v34 op_sel:[1,1,0] op_sel_hi:[1,1,0]
    v_fma_mix_f32 v34, v110, v66, v34 op_sel:[0,0,0] op_sel_hi:[1,1,0]
    v_fma_mix_f32 v34, v110, v66, v34 op_sel:[1,1,0] op_sel_hi:[1,1,0]
    v_fma_mix_f32 v34, v111, v67, v34 op_sel:[0,0,0] op_sel_hi:[1,1,0]
    v_fma_mix_f32 v34, v111, v67, v34 op_sel:[1,1,0] op_sel_hi:[1,1,0]
    v_fma_mix_f32 v34, v32, v28, v34 op_sel:[0,0,0] op_sel_hi:[1,1,0]
    buffer_load_dwordx4 v7, s[76:79], s92 offen offset:1024 lds
    ds_write_b128 v27, v[108:111] offset:336
    v_fma_mix_f32 v34, v32, v28, v34 op_sel:[1,1,0] op_sel_hi:[1,1,0]
    v_fma_mix_f32 v34, v33, v29, v34 op_sel:[0,0,0] op_sel_hi:[1,1,0]
    v_fma_mix_f32 v34, v33, v29, v34 op_sel:[1,1,0] op_sel_hi:[1,1,0]
    v_mov_b32 v41, v34
    v_cvt_pk_f16_f32 v21, v94, v95
    v_pk_fmac_f16 v61, v20, v20
    v_permlane32_swap_b32 v41, v34
    v_add_f32 v34, v41, v34
    v_mov_b32 v41, v34
    buffer_load_dwordx4 v6, s[76:79], s92 offen offset:2048 lds
    s_add_u32 m0, s90, 12288
    s_mov_b32 s92, 12288
    s_waitcnt vmcnt(9)
    ds_read_b64_tr_b16 a[156:157], v157 offset:36864
    v_permlane16_swap_b32 v41, v34
    v_add_f32 v34, v41, v34
    ds_read_b64_tr_b16 a[158:159], v157 offset:37632
    v_pk_fmac_f16 v61, v21, v21
    v_cvt_pk_f16_f32 v94, v96, v97
    v_cvt_pk_f16_f32 v95, v98, v99
    ds_read_b64_tr_b16 a[180:181], v157 offset:36872
    v_pk_fma_f16 v63, v94, v94, s39
    v_pk_fmac_f16 v63, v95, v95
    v_cvt_pk_f16_f32 v96, v88, v89
    s_waitcnt lgkmcnt(3)
    buffer_load_dwordx4 v142, s[76:79], s92 offen offset:0 lds
    ds_read_b64_tr_b16 a[182:183], v157 offset:37640
    v_cvt_pk_f16_f32 v97, v90, v91
    v_pk_fmac_f16 v63, v96, v96
    v_pk_fmac_f16 v63, v97, v97
    ds_read_b64_tr_b16 a[204:205], v143 offset:36928
    v_cvt_pk_f16_f32 v98, v68, v69
    ds_read_b64_tr_b16 a[206:207], v143 offset:37696
    v_cvt_pk_f16_f32 v99, v70, v71
    ds_write_b128 v27, v[64:67] offset:368
    buffer_load_dwordx4 v7, s[76:79], s92 offen offset:1024 lds
    v_pk_fmac_f16 v63, v98, v98
    v_pk_fmac_f16 v63, v99, v99
    v_cvt_pk_f16_f32 v88, v8, v9
    v_cvt_pk_f16_f32 v89, v10, v11
    v_mfma_f32_16x16x32_f16 v[8:11], v[212:215], v[60:63], 0
    s_nop 0
    v_pk_fma_f16 v41, v88, v88, s39
    v_pk_fmac_f16 v41, v89, v89
    v_cvt_pk_f16_f32 v90, v56, v57
    v_cvt_pk_f16_f32 v91, v58, v59
    ds_write_b64 v27, v[28:29] offset:384
    v_pk_fmac_f16 v41, v90, v90
    v_pk_fmac_f16 v41, v91, v91
    v_or3_b32 v125, v125, v8, v9
    buffer_load_dwordx4 v6, s[76:79], s92 offen offset:2048 lds
    s_add_u32 m0, s90, 24576
    s_mov_b32 s92, 24576
    s_waitcnt vmcnt(9)
    ds_read_b64_tr_b16 a[160:161], v157 offset:49152
    v_rsq_f32 v8, v8
    v_rsq_f32 v9, v9
    ds_read_b64_tr_b16 a[162:163], v157 offset:49920
    v_mul_f32 v8, s52, v8
    v_cvt_pk_f16_f32 v8, v8, v9
    v_or3_b32 v125, v125, v10, v11
    ds_read_b64_tr_b16 a[184:185], v157 offset:49160
    v_rsq_f32 v10, v10
    buffer_load_dwordx4 v142, s[76:79], s92 offen offset:0 lds
    ds_read_b64_tr_b16 a[186:187], v157 offset:49928
    v_rsq_f32 v11, v11
    v_mul_f32 v10, s52, v10
    ds_read_b64_tr_b16 a[208:209], v143 offset:49216
    v_cvt_pk_f16_f32 v10, v10, v11
    ds_read_b64_tr_b16 a[210:211], v143 offset:49984
    v_pk_mul_f16 v16, v16, v8 op_sel:[0,1] op_sel_hi:[1,1]
    v_pk_mul_f16 v17, v17, v8 op_sel:[0,1] op_sel_hi:[1,1]
    v_pk_mul_f16 v18, v18, v8 op_sel:[0,1] op_sel_hi:[1,1]
    v_pk_mul_f16 v19, v19, v8 op_sel:[0,1] op_sel_hi:[1,1]
    v_pk_mul_f16 v20, v20, v8 op_sel:[0,1] op_sel_hi:[1,1]
    buffer_load_dwordx4 v7, s[76:79], s92 offen offset:1024 lds
    v_pk_mul_f16 v21, v21, v8 op_sel:[0,1] op_sel_hi:[1,1]
    v_pk_mul_f16 v0, v0, v8 op_sel:[0,0] op_sel_hi:[1,0]
    v_pk_mul_f16 v1, v1, v8 op_sel:[0,0] op_sel_hi:[1,0]
    v_pk_mul_f16 v2, v2, v8 op_sel:[0,0] op_sel_hi:[1,0]
    v_pk_mul_f16 v3, v3, v8 op_sel:[0,0] op_sel_hi:[1,0]
    v_pk_mul_f16 v154, v154, v8 op_sel:[0,0] op_sel_hi:[1,0]
    v_pk_mul_f16 v155, v155, v8 op_sel:[0,0] op_sel_hi:[1,0]
    v_pk_mul_f16 v94, v94, v10 op_sel:[0,1] op_sel_hi:[1,1]
    v_pk_mul_f16 v95, v95, v10 op_sel:[0,1] op_sel_hi:[1,1]
    v_pk_mul_f16 v96, v96, v10 op_sel:[0,1] op_sel_hi:[1,1]
    v_pk_mul_f16 v97, v97, v10 op_sel:[0,1] op_sel_hi:[1,1]
    v_pk_mul_f16 v98, v98, v10 op_sel:[0,1] op_sel_hi:[1,1]
    v_pk_mul_f16 v99, v99, v10 op_sel:[0,1] op_sel_hi:[1,1]
    v_pk_mul_f16 v12, v12, v10 op_sel:[0,0] op_sel_hi:[1,0]
    v_pk_mul_f16 v13, v13, v10 op_sel:[0,0] op_sel_hi:[1,0]
    v_pk_mul_f16 v14, v14, v10 op_sel:[0,0] op_sel_hi:[1,0]
    v_pk_mul_f16 v15, v15, v10 op_sel:[0,0] op_sel_hi:[1,0]
    buffer_load_dwordx4 v6, s[76:79], s92 offen offset:2048 lds
    s_add_u32 m0, s90, 36864
    s_mov_b32 s92, 36864
    s_waitcnt vmcnt(9)
    ds_read_b64_tr_b16 a[164:165], v157 offset:61440
    v_pk_mul_f16 v150, v150, v10 op_sel:[0,0] op_sel_hi:[1,0]
    v_pk_mul_f16 v151, v151, v10 op_sel:[0,0] op_sel_hi:[1,0]
    v_cvt_pk_f16_f32 v92, v52, v53
    ds_read_b64_tr_b16 a[166:167], v157 offset:62208
    v_mfma_f32_16x16x32_bf16 v[8:11], v[224:227], a[144:147], 0
    v_cvt_pk_f16_f32 v93, v54, v55
    v_pk_fmac_f16 v41, v92, v92
    v_mfma_f32_16x16x32_bf16 v[8:11], v[116:119], a[148:151], v[8:11]
    ds_read_b64_tr_b16 a[188:189], v157 offset:61448
    v_pk_fmac_f16 v41, v93, v93
    v_mfma_f32_16x16x32_bf16 v[8:11], v[112:115], a[152:155], v[8:11]
    s_waitcnt lgkmcnt(3)
    buffer_load_dwordx4 v142, s[76:79], s92 offen offset:0 lds
    ds_read_b64_tr_b16 a[190:191], v157 offset:62216
    v_mfma_f32_16x16x32_bf16 v[8:11], v[104:107], a[156:159], v[8:11]
    s_cmp_ge_u32 s2, 247
    s_cbranch_scc1 L_maskF
L_nomaskF:
    v_mfma_f32_16x16x32_bf16 v[8:11], v[84:87], a[160:163], v[8:11]
    ds_read_b64_tr_b16 a[212:213], v143 offset:61504
    v_readlane_b32 s84, v211, 48
    v_cmp_gt_u32 vcc, 16, v162
    ds_read_b64_tr_b16 a[214:215], v143 offset:62272
    v_add_f32 v34, s84, v34
    ds_read_b128 v[68:71], v47 offset:40960
    buffer_load_dwordx4 v7, s[76:79], s92 offen offset:1024 lds
    v_exp_f32 v34, v34
    ds_read_b128 v[64:67], v166 offset:40960
    s_waitcnt lgkmcnt(6)
    v_mfma_f32_16x16x32_bf16 v[8:11], v[76:79], a[164:167], v[8:11]
    v_cvt_pk_bf16_f32 v34, v34, 0
    v_cndmask_b32 v208, v26, v208, vcc
    v_mfma_f32_16x16x32_bf16 v[108:111], v[224:227], a[168:171], 0
    ds_read_b128 v[60:63], v47 offset:41088
    v_cndmask_b32 v209, v26, v209, vcc
    v_mfma_f32_16x16x32_bf16 v[108:111], v[116:119], a[172:175], v[108:111]
    s_nop 0
    ds_read_b128 v[56:59], v166 offset:41088
    v_cvt_pk_bf16_f32 v164, v8, v9
    v_mfma_f32_16x16x32_bf16 v[108:111], v[112:115], a[176:179], v[108:111]
    buffer_load_dwordx4 v6, s[76:79], s92 offen offset:2048 lds
    ds_read_b128 v[52:55], v47 offset:41216
    v_mfma_f32_16x16x32_bf16 v[108:111], v[104:107], a[180:183], v[108:111]
    s_add_u32 m0, s90, 49152
    v_cvt_pk_bf16_f32 v165, v10, v11
    v_cndmask_b32 v210, v26, v210, vcc
    v_mfma_f32_16x16x32_bf16 v[108:111], v[84:87], a[184:187], v[108:111]
    s_waitcnt lgkmcnt(5)
    s_mov_b32 s92, 49152
    ds_read_b128 v[8:11], v166 offset:41216
    v_cmp_gt_u32 vcc, 16, v162
    v_mfma_f32_16x16x32_bf16 v[108:111], v[76:79], a[188:191], v[108:111]
    s_nop 0
    v_cndmask_b32 v34, 0, v34, vcc
    v_cmp_gt_u32 vcc, 49, v162
    v_mfma_f32_16x16x32_bf16 v[28:31], v[224:227], a[192:195], 0
    s_nop 0
    v_cndmask_b32 v211, v26, v211, vcc
    v_pk_mul_f16 v120, v120, v82 op_sel:[0,0] op_sel_hi:[1,0]
    v_mfma_f32_16x16x32_bf16 v[28:31], v[116:119], a[196:199], v[28:31]
    buffer_load_dwordx4 v142, s[76:79], s92 offen offset:0 lds
    v_cvt_pk_bf16_f32 v160, v108, v109
    v_mfma_f32_16x16x32_bf16 v[28:31], v[112:115], a[200:203], v[28:31]
    v_cvt_pk_bf16_f32 v161, v110, v111
    v_pk_mul_f16 v121, v121, v82 op_sel:[0,0] op_sel_hi:[1,0]
    v_mfma_f32_16x16x32_bf16 v[28:31], v[104:107], a[204:207], v[28:31]
    v_pk_mul_f16 v122, v122, v82 op_sel:[0,0] op_sel_hi:[1,0]
    v_pk_mul_f16 v123, v123, v82 op_sel:[0,0] op_sel_hi:[1,0]
    v_mfma_f32_16x16x32_bf16 v[28:31], v[84:87], a[208:211], v[28:31]
    v_pk_mul_f16 v24, v24, v82 op_sel:[0,0] op_sel_hi:[1,0]
    v_pk_mul_f16 v25, v25, v82 op_sel:[0,0] op_sel_hi:[1,0]
    v_mfma_f32_16x16x32_bf16 v[28:31], v[76:79], a[212:215], v[28:31]
    s_waitcnt lgkmcnt(1)
    v_pk_mul_f16 v100, v100, v82 op_sel:[0,1] op_sel_hi:[1,1]
    v_pk_mul_f16 v101, v101, v82 op_sel:[0,1] op_sel_hi:[1,1]
    v_mfma_f32_16x16x32_bf16 v[76:79], a[144:147], v[68:71], 0
    buffer_load_dwordx4 v7, s[76:79], s92 offen offset:1024 lds
    v_pk_mul_f16 v102, v102, v82 op_sel:[0,1] op_sel_hi:[1,1]
    v_mfma_f32_16x16x32_bf16 v[76:79], a[148:151], v[64:67], v[76:79]
    s_nop 0
    v_cvt_pk_bf16_f32 v156, v28, v29
    v_cvt_pk_bf16_f32 v157, v30, v31
    v_mfma_f32_16x16x32_bf16 v[76:79], a[152:155], v[60:63], v[76:79]
    v_pk_mul_f16 v103, v103, v82 op_sel:[0,1] op_sel_hi:[1,1]
    v_pk_mul_f16 v4, v4, v82 op_sel:[0,1] op_sel_hi:[1,1]
    v_mfma_f32_16x16x32_bf16 v[76:79], a[156:159], v[56:59], v[76:79]
    v_pk_mul_f16 v5, v5, v82 op_sel:[0,1] op_sel_hi:[1,1]
    v_fma_mix_f32 v26, v120, v100, 0 op_sel:[0,0,0] op_sel_hi:[1,1,0]
    v_mfma_f32_16x16x32_bf16 v[76:79], a[160:163], v[52:55], v[76:79]
    s_waitcnt lgkmcnt(0)
    ds_write_b128 v27, v[32:35] offset:352
    v_mfma_f32_16x16x32_bf16 v[76:79], a[164:167], v[8:11], v[76:79]
    buffer_load_dwordx4 v6, s[76:79], s92 offen offset:2048 lds
    v_fma_mix_f32 v26, v120, v100, v26 op_sel:[1,1,0] op_sel_hi:[1,1,0]
    v_mfma_f32_16x16x32_bf16 v[32:35], a[168:171], v[68:71], 0
    s_add_u32 m0, s90, 61440
    v_fma_mix_f32 v26, v121, v101, v26 op_sel:[0,0,0] op_sel_hi:[1,1,0]
    v_fma_mix_f32 v26, v121, v101, v26 op_sel:[1,1,0] op_sel_hi:[1,1,0]
    v_mfma_f32_16x16x32_bf16 v[32:35], a[172:175], v[64:67], v[32:35]
    s_mov_b32 s92, 61440
    v_cvt_pk_bf16_f32 v30, v76, v77
    v_cvt_pk_bf16_f32 v31, v78, v79
    v_mfma_f32_16x16x32_bf16 v[32:35], a[176:179], v[60:63], v[32:35]
    ds_write_b64 v27, v[30:31] offset:392
    v_mfma_f32_16x16x32_bf16 v[32:35], a[180:183], v[56:59], v[32:35]
    buffer_load_dwordx4 v142, s[76:79], s92 offen offset:0 lds
    v_fma_mix_f32 v26, v122, v102, v26 op_sel:[0,0,0] op_sel_hi:[1,1,0]
    v_mfma_f32_16x16x32_bf16 v[32:35], a[184:187], v[52:55], v[32:35]
    ds_read_b128 v[76:79], v134 offset:32
    v_fma_mix_f32 v26, v122, v102, v26 op_sel:[1,1,0] op_sel_hi:[1,1,0]
    v_mfma_f32_16x16x32_bf16 v[32:35], a[188:191], v[8:11], v[32:35]
    ds_read_b64 v[80:81], v134 offset:48
    v_fma_mix_f32 v26, v123, v103, v26 op_sel:[0,0,0] op_sel_hi:[1,1,0]
    v_mfma_f32_16x16x32_bf16 v[28:31], a[192:195], v[68:71], 0
    ds_read_b128 v[236:239], v47 offset:0
    v_fma_mix_f32 v26, v123, v103, v26 op_sel:[1,1,0] op_sel_hi:[1,1,0]
    v_mfma_f32_16x16x32_bf16 v[28:31], a[196:199], v[64:67], v[28:31]
    s_nop 0
    ds_read_b128 v[232:235], v166 offset:0
    v_cvt_pk_bf16_f32 v32, v32, v33
    v_mfma_f32_16x16x32_bf16 v[28:31], a[200:203], v[60:63], v[28:31]
    buffer_load_dwordx4 v7, s[76:79], s92 offen offset:1024 lds
    ds_read_b128 v[228:231], v47 offset:128
    v_mfma_f32_16x16x32_bf16 v[28:31], a[204:207], v[56:59], v[28:31]
    v_cvt_pk_bf16_f32 v33, v34, v35
    v_fma_mix_f32 v26, v24, v4, v26 op_sel:[0,0,0] op_sel_hi:[1,1,0]
    v_mfma_f32_16x16x32_bf16 v[28:31], a[208:211], v[52:55], v[28:31]
    ds_read_b128 v[224:227], v166 offset:128
    v_fma_mix_f32 v26, v24, v4, v26 op_sel:[1,1,0] op_sel_hi:[1,1,0]
    v_mfma_f32_16x16x32_bf16 v[28:31], a[212:215], v[8:11], v[28:31]
    ds_read_b128 v[104:107], v47 offset:256
    v_fma_mix_f32 v26, v25, v5, v26 op_sel:[0,0,0] op_sel_hi:[1,1,0]
    v_mfma_f32_16x16x32_f16 v[8:11], v[212:215], v[40:43], 0
    ds_read_b128 v[84:87], v166 offset:256
    v_fma_mix_f32 v26, v25, v5, v26 op_sel:[1,1,0] op_sel_hi:[1,1,0]
    v_mfma_f32_16x16x32_f16 v[40:43], v[16:19], v[0:3], v[204:207]
    s_nop 0
    buffer_load_dwordx4 v6, s[76:79], s92 offen offset:2048 lds
    v_cvt_pk_bf16_f32 v34, v28, v29
    v_mfma_f32_16x16x32_f16 v[40:43], v[18:21], v[152:155], v[40:43]
    s_add_u32 m0, s54, 20480
    v_cvt_pk_bf16_f32 v35, v30, v31
    v_or3_b32 v125, v125, v8, v9
    v_mfma_f32_16x16x32_f16 v[28:31], v[94:97], v[0:3], v[200:203]
    ds_write_b128 v27, v[32:35] offset:400
    v_mfma_f32_16x16x32_f16 v[28:31], v[96:99], v[152:155], v[28:31]
    s_waitcnt lgkmcnt(4)
    v_rsq_f32 v8, v8
    v_mfma_f32_16x16x32_f16 v[32:35], v[76:79], v[0:3], v[208:211]
    v_rsq_f32 v9, v9
    v_mfma_f32_16x16x32_f16 v[32:35], v[78:81], v[152:155], v[32:35]
    buffer_load_dwordx4 v130, s[24:27], s56 offen nt lds
    v_mul_f32 v8, s52, v8
    v_mfma_f32_16x16x32_bf16 v[60:63], v[236:239], a[144:147], 0
    s_add_u32 m0, s54, 21504
    v_cvt_pk_f16_f32 v8, v8, v9
    v_pk_mul_f16 v88, v88, v8 op_sel:[0,1] op_sel_hi:[1,1]
    v_mfma_f32_16x16x32_bf16 v[60:63], v[232:235], a[148:151], v[60:63]
    v_pk_mul_f16 v89, v89, v8 op_sel:[0,1] op_sel_hi:[1,1]
    v_pk_mul_f16 v90, v90, v8 op_sel:[0,1] op_sel_hi:[1,1]
    v_mfma_f32_16x16x32_bf16 v[60:63], v[228:231], a[152:155], v[60:63]
    s_waitcnt lgkmcnt(1)
    v_pk_mul_f16 v91, v91, v8 op_sel:[0,1] op_sel_hi:[1,1]
    v_pk_mul_f16 v92, v92, v8 op_sel:[0,1] op_sel_hi:[1,1]
    v_mfma_f32_16x16x32_bf16 v[60:63], v[224:227], a[156:159], v[60:63]
    v_pk_mul_f16 v93, v93, v8 op_sel:[0,1] op_sel_hi:[1,1]
    v_pk_mul_f16 v36, v36, v8 op_sel:[0,0] op_sel_hi:[1,0]
    v_mfma_f32_16x16x32_bf16 v[60:63], v[104:107], a[160:163], v[60:63]
    buffer_load_dwordx4 v129, s[24:27], s56 offen nt lds
    v_pk_mul_f16 v37, v37, v8 op_sel:[0,0] op_sel_hi:[1,0]
    v_mfma_f32_16x16x32_bf16 v[60:63], v[84:87], a[164:167], v[60:63]
    s_add_u32 m0, s54, 22528
    ds_read_b128 v[108:111], v47 offset:42496
    v_pk_mul_f16 v38, v38, v8 op_sel:[0,0] op_sel_hi:[1,0]
    v_mfma_f32_16x16x32_f16 v[116:119], v[88:91], v[0:3], v[196:199]
    ds_read_b128 v[68:71], v166 offset:42496
    v_pk_mul_f16 v39, v39, v8 op_sel:[0,0] op_sel_hi:[1,0]
    v_mfma_f32_16x16x32_f16 v[116:119], v[90:93], v[152:155], v[116:119]
    ds_read_b128 v[64:67], v47 offset:42624
    v_pk_mul_f16 v146, v146, v8 op_sel:[0,0] op_sel_hi:[1,0]
    v_mfma_f32_16x16x32_bf16 v[0:3], v[236:239], a[168:171], 0
    ds_read_b128 v[56:59], v166 offset:42624
    buffer_load_dwordx4 v128, s[24:27], s56 offen nt lds
    v_mfma_f32_16x16x32_bf16 v[0:3], v[232:235], a[172:175], v[0:3]
    s_add_u32 m0, s54, 23552
    ds_read_b128 v[52:55], v47 offset:42752
    v_pk_mul_f16 v147, v147, v8 op_sel:[0,0] op_sel_hi:[1,0]
    v_mfma_f32_16x16x32_bf16 v[0:3], v[228:231], a[176:179], v[0:3]
    ds_read_b128 v[8:11], v166 offset:42752
    v_cvt_pk_bf16_f32 v60, v60, v61
    v_mfma_f32_16x16x32_bf16 v[0:3], v[224:227], a[180:183], v[0:3]
    v_exp_f32 v40, v40
    v_mfma_f32_16x16x32_bf16 v[0:3], v[104:107], a[184:187], v[0:3]
    v_exp_f32 v41, v41
    v_mfma_f32_16x16x32_bf16 v[0:3], v[84:87], a[188:191], v[0:3]
    v_exp_f32 v42, v42
    v_mfma_f32_16x16x32_bf16 v[112:115], v[236:239], a[192:195], 0
    buffer_load_dwordx4 v127, s[24:27], s56 offen nt lds
    v_cvt_pk_bf16_f32 v40, v40, v41
    v_mfma_f32_16x16x32_bf16 v[112:115], v[232:235], a[196:199], v[112:115]
    s_add_u32 m0, s54, 24576
    v_exp_f32 v43, v43
    v_mfma_f32_16x16x32_bf16 v[112:115], v[228:231], a[200:203], v[112:115]
    v_cvt_pk_bf16_f32 v41, v42, v43
    v_cvt_pk_bf16_f32 v61, v62, v63
    v_mfma_f32_16x16x32_bf16 v[112:115], v[224:227], a[204:207], v[112:115]
    v_exp_f32 v28, v28
    v_mfma_f32_16x16x32_bf16 v[112:115], v[104:107], a[208:211], v[112:115]
    v_exp_f32 v29, v29
    v_mfma_f32_16x16x32_bf16 v[112:115], v[84:87], a[212:215], v[112:115]
    s_waitcnt lgkmcnt(0)
    buffer_load_dwordx4 v126, s[24:27], s56 offen nt lds
    v_cvt_pk_bf16_f32 v42, v28, v29
    v_mfma_f32_16x16x32_bf16 v[84:87], a[144:147], v[108:111], 0
    s_add_u32 s56, s56, s62
    v_exp_f32 v30, v30
    v_mfma_f32_16x16x32_bf16 v[84:87], a[148:151], v[68:71], v[84:87]
    s_add_u32 s56, s56, s53
    v_exp_f32 v31, v31
    v_mfma_f32_16x16x32_bf16 v[84:87], a[152:155], v[64:67], v[84:87]
    s_cmp_gt_i32 s64, 0
    v_cvt_pk_bf16_f32 v43, v30, v31
    v_cvt_pk_bf16_f32 v104, v0, v1
    v_mfma_f32_16x16x32_bf16 v[84:87], a[156:159], v[56:59], v[84:87]
    s_cselect_b32 s26, 100270464, 0
    ds_read_b128 v[28:31], v134 offset:0
    v_cvt_pk_bf16_f32 v105, v2, v3
    v_mfma_f32_16x16x32_bf16 v[84:87], a[160:163], v[52:55], v[84:87]
    s_cselect_b32 s56, s56, 0
    ds_read_b64 v[142:143], v134 offset:16
    v_cvt_pk_bf16_f32 v44, v112, v113
    v_mfma_f32_16x16x32_bf16 v[84:87], a[164:167], v[8:11], v[84:87]
    v_exp_f32 v116, v116
    v_mfma_f32_16x16x32_bf16 v[0:3], a[168:171], v[108:111], 0
    v_exp_f32 v117, v117
    v_mfma_f32_16x16x32_bf16 v[0:3], a[172:175], v[68:71], v[0:3]
    v_exp_f32 v118, v118
    v_mfma_f32_16x16x32_bf16 v[0:3], a[176:179], v[64:67], v[0:3]
    v_exp_f32 v119, v119
    v_mfma_f32_16x16x32_bf16 v[0:3], a[180:183], v[56:59], v[0:3]
    ds_write_b128 v51, v[120:123] offset:5712
    v_mfma_f32_16x16x32_bf16 v[0:3], a[184:187], v[52:55], v[0:3]
    v_cvt_pk_bf16_f32 v168, v116, v117
    v_cvt_pk_bf16_f32 v169, v118, v119
    v_mfma_f32_16x16x32_bf16 v[0:3], a[188:191], v[8:11], v[0:3]
    v_exp_f32 v32, v32
    v_cvt_pk_bf16_f32 v45, v114, v115
    v_cvt_pk_bf16_f32 v170, v32, 0
    v_mfma_f32_16x16x32_bf16 v[32:35], a[192:195], v[108:111], 0
    ds_write_b128 v51, v[100:103] offset:5744
    v_mfma_f32_16x16x32_bf16 v[32:35], a[196:199], v[68:71], v[32:35]
    v_cvt_pk_bf16_f32 v6, v84, v85
    v_cvt_pk_bf16_f32 v7, v86, v87
    v_mfma_f32_16x16x32_bf16 v[32:35], a[200:203], v[64:67], v[32:35]
    v_cvt_pk_bf16_f32 v0, v0, v1
    v_cvt_pk_bf16_f32 v1, v2, v3
    v_mfma_f32_16x16x32_bf16 v[32:35], a[204:207], v[56:59], v[32:35]
    s_add_u32 m0, s67, 0
    ds_write_b64 v51, v[6:7] offset:5768
    v_mfma_f32_16x16x32_bf16 v[32:35], a[208:211], v[52:55], v[32:35]
    s_waitcnt vmcnt(5)
    v_mov_b32 v46, v26
    v_mov_b32 v27, 0
    v_mfma_f32_16x16x32_bf16 v[32:35], a[212:215], v[8:11], v[32:35]
    s_waitcnt lgkmcnt(2)
    s_barrier
    ds_write_b64 v51, v[4:5] offset:5760
    v_mfma_f32_16x16x32_f16 v[8:11], v[28:31], v[16:19], v[208:211]
    v_permlane32_swap_b32 v46, v26
    v_mfma_f32_16x16x32_f16 v[8:11], v[140:143], v[18:21], v[8:11]
    s_nop 0
    ds_read_b128 v[232:235], v47 offset:1536
    v_cvt_pk_bf16_f32 v2, v32, v33
    v_mfma_f32_16x16x32_f16 v[4:7], v[28:31], v[94:97], v[208:211]
    ds_read_b128 v[120:123], v166 offset:1536
    v_cvt_pk_bf16_f32 v3, v34, v35
    v_mfma_f32_16x16x32_f16 v[4:7], v[140:143], v[96:99], v[4:7]
    ds_write_b128 v51, v[0:3] offset:5776
    v_mfma_f32_16x16x32_f16 v[0:3], v[28:31], v[88:91], v[208:211]
    v_add_f32 v26, v46, v26
    v_mov_b32 v46, v26
    v_mfma_f32_16x16x32_f16 v[0:3], v[140:143], v[90:93], v[0:3]
    s_nop 0
    v_permlane16_swap_b32 v46, v26
    v_mfma_f32_16x16x32_f16 v[84:87], v[16:19], v[12:15], v[192:195]
    ds_read_b128 v[228:231], v47 offset:1664
    v_mov_b32_dpp v11, v7 quad_perm:[0,1,2,3] row_mask:0x2 bank_mask:0xf
    v_mfma_f32_16x16x32_f16 v[84:87], v[18:21], v[148:151], v[84:87]
    s_nop 0
    ds_read_b128 v[100:103], v166 offset:1664
    v_mov_b32_dpp v11, v3 quad_perm:[0,1,2,3] row_mask:0x4 bank_mask:0xf
    v_mfma_f32_16x16x32_f16 v[64:67], v[94:97], v[12:15], v[188:191]
    ds_read_b128 v[108:111], v47 offset:1792
    v_add_f32 v26, v46, v26
    v_mfma_f32_16x16x32_f16 v[64:67], v[96:99], v[148:151], v[64:67]
    ds_read_b128 v[0:3], v166 offset:1792
    v_add_f32 v26, s84, v26
    v_mfma_f32_16x16x32_f16 v[4:7], v[88:91], v[12:15], v[184:187]
    v_exp_f32 v11, v11
    v_mfma_f32_16x16x32_f16 v[4:7], v[90:93], v[148:151], v[4:7]
    v_exp_f32 v26, v26
    v_mfma_f32_16x16x32_f16 v[52:55], v[76:79], v[12:15], v[208:211]
    v_cvt_pk_bf16_f32 v11, v11, v11
    v_cvt_pk_bf16_f32 v26, v26, 0
    v_mfma_f32_16x16x32_f16 v[52:55], v[78:81], v[148:151], v[52:55]
    s_waitcnt lgkmcnt(4)
    ds_write_b16 v133, v11
    v_mfma_f32_16x16x32_bf16 v[28:31], v[232:235], a[144:147], 0
    ds_read_b128 v[12:15], v134
    v_cmp_gt_u32 vcc, 16, v162
    v_mfma_f32_16x16x32_bf16 v[28:31], v[120:123], a[148:151], v[28:31]
    s_waitcnt lgkmcnt(5)
    ds_read_b128 v[8:11], v134 offset:16
    v_cndmask_b32 v26, 0, v26, vcc
    v_mfma_f32_16x16x32_bf16 v[28:31], v[228:231], a[152:155], v[28:31]
    s_waitcnt lgkmcnt(5)
    ds_write_b128 v51, v[24:27] offset:5728
    v_mfma_f32_16x16x32_bf16 v[28:31], v[100:103], a[156:159], v[28:31]
    s_waitcnt lgkmcnt(4)
    v_exp_f32 v84, v84
    v_mfma_f32_16x16x32_bf16 v[28:31], v[108:111], a[160:163], v[28:31]
    s_barrier
    buffer_load_dwordx4 v130, s[24:27], s56 offen nt lds
    v_mfma_f32_16x16x32_bf16 v[28:31], v[0:3], a[164:167], v[28:31]
    s_add_u32 m0, s67, 1024
    ds_read_b128 v[56:59], v158 offset:0
    v_mfma_f32_16x16x32_bf16 v[116:119], v[232:235], a[168:171], 0
    ds_read_b64 v[24:25], v23 offset:64
    buffer_load_dwordx4 v129, s[24:27], s56 offen nt lds
    v_mfma_f32_16x16x32_bf16 v[116:119], v[120:123], a[172:175], v[116:119]
    s_add_u32 m0, s67, 2048
    ds_read_b128 v[32:35], v158 offset:3072
    v_cvt_pk_bf16_f32 v62, v28, v29
    v_mfma_f32_16x16x32_bf16 v[116:119], v[228:231], a[176:179], v[116:119]
    ds_read_b64 v[26:27], v23 offset:3136
    buffer_load_dwordx4 v128, s[24:27], s56 offen nt lds
    v_mfma_f32_16x16x32_bf16 v[116:119], v[100:103], a[180:183], v[116:119]
    s_add_u32 m0, s67, 3072
    ds_read_b128 v[224:227], v158 offset:6144
    v_cvt_pk_bf16_f32 v63, v30, v31
    v_mfma_f32_16x16x32_bf16 v[116:119], v[108:111], a[184:187], v[116:119]
    s_lshl_b32 s93, s68, 10
    ds_read_b64 v[28:29], v23 offset:6208
    buffer_load_dwordx4 v127, s[24:27], s56 offen nt lds
    v_mfma_f32_16x16x32_bf16 v[116:119], v[0:3], a[188:191], v[116:119]
    s_add_u32 m0, s67, 4096
    ds_read_b128 v[68:71], v158 offset:9216
    v_add_u32 v51, s93, v131
    v_mfma_f32_16x16x32_bf16 v[112:115], v[232:235], a[192:195], 0
    s_mov_b32 s53, s47
    ds_read_b64 v[30:31], v23 offset:9280
    buffer_load_dwordx4 v126, s[24:27], s56 offen nt lds
    v_mfma_f32_16x16x32_bf16 v[112:115], v[120:123], a[196:199], v[112:115]
    s_mov_b32 s47, s46
    ds_read_b128 v[120:123], v158 offset:12288
    v_cvt_pk_bf16_f32 v106, v116, v117
    v_mfma_f32_16x16x32_bf16 v[112:115], v[228:231], a[200:203], v[112:115]
    s_mov_b32 s46, s45
    ds_read_b64 v[116:117], v23 offset:12352
    v_cvt_pk_bf16_f32 v107, v118, v119
    v_mfma_f32_16x16x32_bf16 v[112:115], v[100:103], a[204:207], v[112:115]
    s_mov_b32 s45, s44
    ds_read_b128 v[100:103], v158 offset:15360
    v_mfma_f32_16x16x32_bf16 v[112:115], v[108:111], a[208:211], v[112:115]
    s_mov_b32 s44, s53
    ds_read_b64 v[118:119], v23 offset:15424
    v_mfma_f32_16x16x32_bf16 v[112:115], v[0:3], a[212:215], v[112:115]
    s_waitcnt lgkmcnt(8)
    s_sub_u32 s48, s44, s46
    ds_read_b128 v[0:3], v158 offset:18432
    v_add_u32 v139, s48, v139
    v_mfma_f32_16x16x32_bf16 v[108:111], v[56:59], v[220:223], 0
    s_sub_u32 s49, s46, s45
    ds_read_b64 v[56:57], v23 offset:18496
    v_add_u32 v138, s48, v138
    v_mfma_f32_16x16x32_bf16 v[108:111], v[32:35], v[220:223], v[108:111]
    s_waitcnt lgkmcnt(8)
    ds_read_b128 v[32:35], v158 offset:21504
    v_cvt_pk_bf16_f32 v46, v112, v113
    v_mfma_f32_16x16x32_bf16 v[108:111], v[224:227], v[220:223], v[108:111]
    s_waitcnt lgkmcnt(8)
    ds_read_b64 v[58:59], v23 offset:21568
    v_cvt_pk_bf16_f32 v47, v114, v115
    v_mfma_f32_16x16x32_bf16 v[108:111], v[68:71], v[220:223], v[108:111]
    ds_read_b128 v[112:115], v158 offset:24576
    v_mfma_f32_16x16x32_bf16 v[108:111], v[24:27], v[220:223], v[108:111]
    s_waitcnt lgkmcnt(8)
    ds_read_b64 v[24:25], v23 offset:24640
    v_mfma_f32_16x16x32_bf16 v[108:111], v[28:31], v[220:223], v[108:111]
    ds_read_b128 v[68:71], v158 offset:27648
    v_mfma_f32_16x16x32_bf16 v[28:31], v[120:123], v[220:223], 0
    s_waitcnt lgkmcnt(8)
    ds_read_b64 v[26:27], v23 offset:27712
    v_mfma_f32_16x16x32_bf16 v[28:31], v[100:103], v[220:223], v[28:31]
    s_waitcnt lgkmcnt(7)
    s_nop 0
    ds_read_b128 v[100:103], v158 offset:30720
    v_mul_f32 v108, 0xbbaaaaab, v108
    v_exp_f32 v85, v85
    v_mfma_f32_16x16x32_bf16 v[28:31], v[0:3], v[220:223], v[28:31]
    s_waitcnt lgkmcnt(6)
    ds_read_b64 v[0:1], v23 offset:30784
    v_cvt_pk_bf16_f32 v84, v84, v85
    v_exp_f32 v86, v86
    v_exp_f32 v87, v87
    v_mfma_f32_16x16x32_bf16 v[28:31], v[32:35], v[220:223], v[28:31]
    ds_read_b128 v[32:35], v158 offset:33792
    v_cvt_pk_bf16_f32 v85, v86, v87
    v_mfma_f32_16x16x32_bf16 v[28:31], v[116:119], v[220:223], v[28:31]
    s_waitcnt lgkmcnt(6)
    ds_read_b64 v[2:3], v23 offset:33856
    v_mul_f32 v109, 0xbbaaaaab, v109
    v_mfma_f32_16x16x32_bf16 v[28:31], v[56:59], v[220:223], v[28:31]
    ds_read_u16 v166, v133 offset:56
    v_mul_f32 v110, 0xbbaaaaab, v110
    v_mfma_f32_16x16x32_bf16 v[56:59], v[112:115], v[220:223], 0
    s_waitcnt lgkmcnt(6)
    ds_read_u16 v162, v133 offset:64
    v_mul_f32 v111, 0xbbaaaaab, v111
    v_mfma_f32_16x16x32_bf16 v[56:59], v[68:71], v[220:223], v[56:59]
    s_waitcnt lgkmcnt(5)
    ds_write_b128 v22, v[108:111] offset:0
    v_mfma_f32_16x16x32_bf16 v[56:59], v[100:103], v[220:223], v[56:59]
    s_waitcnt lgkmcnt(4)
    v_exp_f32 v64, v64
    v_exp_f32 v65, v65
    v_exp_f32 v66, v66
    v_exp_f32 v67, v67
    v_cvt_pk_bf16_f32 v86, v64, v65
    v_cvt_pk_bf16_f32 v87, v66, v67
    v_exp_f32 v4, v4
    v_mfma_f32_16x16x32_bf16 v[56:59], v[32:35], v[220:223], v[56:59]
    ds_read_u16 v158, v133 offset:72
    v_mul_f32 v28, 0xbbaaaaab, v28
    v_mfma_f32_16x16x32_bf16 v[56:59], v[24:27], v[220:223], v[56:59]
    s_waitcnt lgkmcnt(3)
    v_exp_f32 v5, v5
    v_mfma_f32_16x16x32_bf16 v[56:59], v[0:3], v[220:223], v[56:59]
    v_exp_f32 v6, v6
    v_mfma_f32_16x16x32_bf16 v[32:35], v[220:223], v[40:43], 0
    v_exp_f32 v7, v7
    v_mfma_f32_16x16x32_bf16 v[32:35], v[220:223], v[168:171], v[32:35]
    v_exp_f32 v53, v53
    v_mfma_f32_16x16x32_bf16 v[0:3], v[60:63], v[40:43], 0
    v_mul_f32 v29, 0xbbaaaaab, v29
    v_mul_f32 v30, 0xbbaaaaab, v30
    v_mfma_f32_16x16x32_bf16 v[0:3], v[164:167], v[168:171], v[0:3]
    v_mul_f32 v31, 0xbbaaaaab, v31
    v_mul_f32 v56, 0xbbaaaaab, v56
    v_mfma_f32_16x16x32_bf16 v[24:27], v[104:107], v[40:43], 0
    s_waitcnt lgkmcnt(1)
    ds_write_b128 v22, v[28:31] offset:128
    v_mfma_f32_16x16x32_bf16 v[24:27], v[160:163], v[168:171], v[24:27]
    v_mul_f32 v57, 0xbbaaaaab, v57
    v_mul_f32 v58, 0xbbaaaaab, v58
    v_mfma_f32_16x16x32_bf16 v[28:31], v[44:47], v[40:43], 0
    s_waitcnt lgkmcnt(1)
    v_rcp_f32 v32, v32
    v_mfma_f32_16x16x32_bf16 v[28:31], v[156:159], v[168:171], v[28:31]
    v_mul_f32 v59, 0xbbaaaaab, v59
    v_cvt_pk_bf16_f32 v168, v4, v5
    v_mfma_f32_16x16x32_bf16 v[40:43], v[12:15], v[60:63], 0
    ds_write_b128 v22, v[56:59] offset:256
    v_mfma_f32_16x16x32_bf16 v[40:43], v[8:11], v[164:167], v[40:43]
    v_cvt_pk_bf16_f32 v169, v6, v7
    v_cvt_pk_bf16_f32 v170, v53, 0
    v_mfma_f32_16x16x32_bf16 v[4:7], v[12:15], v[104:107], 0
    v_mul_f32 v0, v0, v32
    v_mul_f32 v1, v1, v32
    v_mfma_f32_16x16x32_bf16 v[4:7], v[8:11], v[160:163], v[4:7]
    v_cvt_pk_bf16_f32 v68, v0, v1
    v_mul_f32 v2, v2, v32
    v_mfma_f32_16x16x32_bf16 v[64:67], v[12:15], v[44:47], 0
    ds_read_b128 v[52:55], v73 offset:0
    v_mul_f32 v3, v3, v32
    v_mfma_f32_16x16x32_bf16 v[64:67], v[8:11], v[156:159], v[64:67]
    ds_read_b64 v[56:57], v72 offset:64
    v_cvt_pk_bf16_f32 v69, v2, v3
    v_mfma_f32_16x16x32_f16 v[12:15], v[16:19], v[36:39], v[180:183]
    ds_write_b64 v137, v[68:69] offset:0
    v_mfma_f32_16x16x32_f16 v[12:15], v[18:21], v[144:147], v[12:15]
    s_waitcnt lgkmcnt(3)
    v_mul_f32 v24, v24, v32
    v_mul_f32 v25, v25, v32
    v_mfma_f32_16x16x32_f16 v[8:11], v[94:97], v[36:39], v[176:179]
    s_barrier
    ds_read_b128 v[20:23], v124 offset:0
    v_cvt_pk_bf16_f32 v70, v24, v25
    v_mfma_f32_16x16x32_f16 v[8:11], v[96:99], v[144:147], v[8:11]
    ds_read_b128 v[108:111], v73 offset:768
    v_mul_f32 v26, v26, v32
    v_mfma_f32_16x16x32_f16 v[0:3], v[88:91], v[36:39], v[172:175]
    ds_read_b64 v[112:113], v72 offset:832
    v_mul_f32 v27, v27, v32
    v_mfma_f32_16x16x32_f16 v[0:3], v[90:93], v[144:147], v[0:3]
    ds_read_b128 v[16:19], v124 offset:64
    v_cvt_pk_bf16_f32 v71, v26, v27
    v_mfma_f32_16x16x32_f16 v[24:27], v[76:79], v[36:39], v[208:211]
    ds_write_b64 v137, v[70:71] offset:8
    v_mfma_f32_16x16x32_f16 v[24:27], v[78:81], v[144:147], v[24:27]
    v_mul_f32 v28, v28, v32
    v_mul_f32 v29, v29, v32
    v_mfma_f32_16x16x32_bf16 v[76:79], v[220:223], v[84:87], 0
    v_cvt_pk_bf16_f32 v58, v28, v29
    v_mul_f32 v30, v30, v32
    v_mfma_f32_16x16x32_bf16 v[76:79], v[220:223], v[168:171], v[76:79]
    v_mul_f32 v31, v31, v32
    v_cvt_pk_bf16_f32 v59, v30, v31
    v_mfma_f32_16x16x32_bf16 v[28:31], v[60:63], v[84:87], 0
    ds_write_b64 v136, v[58:59] offset:0
    v_mfma_f32_16x16x32_bf16 v[28:31], v[164:167], v[168:171], v[28:31]
    s_waitcnt lgkmcnt(4)
    v_exp_f32 v12, v12
    v_mfma_f32_16x16x16_bf16 v[68:71], v[52:53], v[74:75], v[20:23]
    ds_read_b128 v[36:39], v73 offset:24576
    v_exp_f32 v13, v13
    v_mfma_f32_16x16x16_bf16 v[96:99], v[54:55], v[74:75], v[20:23]
    ds_read_b64 v[40:41], v72 offset:24640
    v_mov_b32_dpp v43, v7 quad_perm:[0,1,2,3] row_mask:0x2 bank_mask:0xf
    v_mfma_f32_16x16x16_bf16 v[4:7], v[56:57], v[74:75], v[20:23]
    s_waitcnt lgkmcnt(3)
    ds_read_b128 v[32:35], v124 offset:256
    v_mov_b32_dpp v43, v67 quad_perm:[0,1,2,3] row_mask:0x4 bank_mask:0xf
    v_mfma_f32_16x16x16_bf16 v[92:95], v[108:109], v[74:75], v[16:19]
    ds_read_b128 v[20:23], v73 offset:25344
    v_cvt_pk_bf16_f32 v43, v43, v43
    v_mfma_f32_16x16x16_bf16 v[56:59], v[110:111], v[74:75], v[16:19]
    ds_write_b16 v133, v43 offset:56
    v_mfma_f32_16x16x16_bf16 v[52:55], v[112:113], v[74:75], v[16:19]
    ds_read_b64 v[24:25], v72 offset:25408
    v_cvt_pk_bf16_f32 v68, v68, v69
    v_accvgpr_write_b32 a216, v68
    v_mfma_f32_16x16x32_bf16 v[88:91], v[104:107], v[84:87], 0
    ds_read_b128 v[16:19], v124 offset:320
    v_cvt_pk_bf16_f32 v70, v70, v71
    v_mfma_f32_16x16x32_bf16 v[88:91], v[160:163], v[168:171], v[88:91]
    ds_read_b128 v[66:69], v73 offset:12288
    v_accvgpr_write_b32 a217, v70
    v_mfma_f32_16x16x32_bf16 v[80:83], v[44:47], v[84:87], 0
    ds_read_b64 v[70:71], v72 offset:12352
    v_cvt_pk_bf16_f32 v96, v96, v97
    v_mfma_f32_16x16x32_bf16 v[80:83], v[156:159], v[168:171], v[80:83]
    s_waitcnt lgkmcnt(6)
    ds_read_b128 v[84:87], v124 offset:128
    v_accvgpr_write_b32 a240, v96
    v_cvt_pk_bf16_f32 v98, v98, v99
    v_accvgpr_write_b32 a241, v98
    v_cvt_pk_bf16_f32 v232, v4, v5
    v_cvt_pk_bf16_f32 v233, v6, v7
    v_mfma_f32_16x16x16_bf16 v[4:7], v[36:37], v[74:75], v[32:35]
    ds_read_b128 v[96:99], v73 offset:13056
    v_cvt_pk_bf16_f32 v92, v92, v93
    v_accvgpr_write_b32 a218, v92
    v_cvt_pk_bf16_f32 v94, v94, v95
    v_accvgpr_write_b32 a219, v94
    v_cvt_pk_bf16_f32 v56, v56, v57
    v_accvgpr_write_b32 a242, v56
    v_cvt_pk_bf16_f32 v58, v58, v59
    v_accvgpr_write_b32 a243, v58
    v_cvt_pk_bf16_f32 v234, v52, v53
    v_cvt_pk_bf16_f32 v235, v54, v55
    v_exp_f32 v14, v14
    v_exp_f32 v15, v15
    v_cvt_pk_bf16_f32 v12, v12, v13
    v_cvt_pk_bf16_f32 v13, v14, v15
    v_exp_f32 v8, v8
    v_exp_f32 v9, v9
    v_exp_f32 v10, v10
    v_exp_f32 v11, v11
    v_cvt_pk_bf16_f32 v14, v8, v9
    v_cvt_pk_bf16_f32 v15, v10, v11
    v_exp_f32 v0, v0
    v_exp_f32 v1, v1
    v_exp_f32 v2, v2
    v_exp_f32 v3, v3
    v_exp_f32 v26, v26
    v_mfma_f32_16x16x16_bf16 v[52:55], v[38:39], v[74:75], v[32:35]
    ds_read_b64 v[100:101], v72 offset:13120
    v_cvt_pk_bf16_f32 v168, v0, v1
    v_mfma_f32_16x16x16_bf16 v[8:11], v[40:41], v[74:75], v[32:35]
    s_waitcnt lgkmcnt(1)
    ds_read_b128 v[56:59], v124 offset:192
    v_cvt_pk_bf16_f32 v169, v2, v3
    v_mfma_f32_16x16x16_bf16 v[0:3], v[20:21], v[74:75], v[16:19]
    ds_read_b128 v[32:35], v73 offset:36864
    v_cvt_pk_bf16_f32 v170, v26, 0
    v_mfma_f32_16x16x16_bf16 v[40:43], v[22:23], v[74:75], v[16:19]
    ds_read_b64 v[36:37], v72 offset:36928
    v_cvt_pk_bf16_f32 v4, v4, v5
    v_mfma_f32_16x16x16_bf16 v[108:111], v[24:25], v[74:75], v[16:19]
    ds_read_b128 v[92:95], v124 offset:5120
    v_accvgpr_write_b32 a224, v4
    v_mfma_f32_16x16x16_bf16 v[16:19], v[66:67], v[74:75], v[84:87]
    ds_read_b128 v[64:67], v73 offset:37632
    v_cvt_pk_bf16_f32 v6, v6, v7
    v_mfma_f32_16x16x16_bf16 v[24:27], v[68:69], v[74:75], v[84:87]
    ds_read_b64 v[68:69], v72 offset:37696
    v_accvgpr_write_b32 a225, v6
    v_mfma_f32_16x16x16_bf16 v[20:23], v[70:71], v[74:75], v[84:87]
    ds_read_b128 v[4:7], v124 offset:5184
    v_cvt_pk_bf16_f32 v52, v52, v53
    v_accvgpr_write_b32 a248, v52
    v_cvt_pk_bf16_f32 v54, v54, v55
    v_accvgpr_write_b32 a249, v54
    v_cvt_pk_bf16_f32 v240, v8, v9
    v_cvt_pk_bf16_f32 v241, v10, v11
    v_cvt_pk_bf16_f32 v0, v0, v1
    v_accvgpr_write_b32 a226, v0
    v_cvt_pk_bf16_f32 v2, v2, v3
    v_accvgpr_write_b32 a227, v2
    s_waitcnt lgkmcnt(6)
    v_mfma_f32_16x16x16_bf16 v[8:11], v[96:97], v[74:75], v[56:59]
    ds_read_b128 v[224:227], v73 offset:49152
    v_cvt_pk_bf16_f32 v40, v40, v41
    v_mfma_f32_16x16x16_bf16 v[84:87], v[98:99], v[74:75], v[56:59]
    ds_read_b64 v[228:229], v72 offset:49216
    v_accvgpr_write_b32 a250, v40
    v_mfma_f32_16x16x16_bf16 v[52:55], v[100:101], v[74:75], v[56:59]
    s_waitcnt lgkmcnt(5)
    ds_read_b128 v[0:3], v124 offset:5248
    v_cvt_pk_bf16_f32 v42, v42, v43
    v_mfma_f32_16x16x16_bf16 v[56:59], v[32:33], v[74:75], v[92:95]
    ds_read_b128 v[96:99], v73 offset:49920
    v_accvgpr_write_b32 a251, v42
    v_mfma_f32_16x16x16_bf16 v[40:43], v[34:35], v[74:75], v[92:95]
    ds_read_b64 v[100:101], v72 offset:49984
    v_cvt_pk_bf16_f32 v242, v108, v109
    v_mfma_f32_16x16x16_bf16 v[32:35], v[36:37], v[74:75], v[92:95]
    s_waitcnt lgkmcnt(5)
    ds_read_b128 v[36:39], v124 offset:5312
    v_cvt_pk_bf16_f32 v243, v110, v111
    v_mfma_f32_16x16x16_bf16 v[112:115], v[64:65], v[74:75], v[4:7]
    ds_read_b128 v[116:119], v73 offset:61440
    v_cvt_pk_bf16_f32 v16, v16, v17
    v_mfma_f32_16x16x16_bf16 v[92:95], v[66:67], v[74:75], v[4:7]
    ds_read_b64 v[120:121], v72 offset:61504
    v_accvgpr_write_b32 a220, v16
    v_mfma_f32_16x16x16_bf16 v[64:67], v[68:69], v[74:75], v[4:7]
    ds_read_b128 v[108:111], v124 offset:5376
    v_cvt_pk_bf16_f32 v18, v18, v19
    v_accvgpr_write_b32 a221, v18
    v_mfma_f32_16x16x32_bf16 v[4:7], v[220:223], v[12:15], 0
    ds_read_b128 v[68:71], v73 offset:62208
    v_cvt_pk_bf16_f32 v24, v24, v25
    v_mfma_f32_16x16x32_bf16 v[4:7], v[220:223], v[168:171], v[4:7]
    ds_read_b64 v[72:73], v72 offset:62272
    v_accvgpr_write_b32 a244, v24
    v_mfma_f32_16x16x32_bf16 v[16:19], v[60:63], v[12:15], 0
    ds_read_b128 v[60:63], v124 offset:5440
    v_cvt_pk_bf16_f32 v26, v26, v27
    v_mfma_f32_16x16x32_bf16 v[16:19], v[164:167], v[168:171], v[16:19]
    s_waitcnt lgkmcnt(7)
    v_accvgpr_write_b32 a245, v26
    v_cvt_pk_bf16_f32 v236, v20, v21
    v_cvt_pk_bf16_f32 v237, v22, v23
    v_mfma_f32_16x16x16_bf16 v[24:27], v[224:225], v[74:75], v[0:3]
    v_cvt_pk_bf16_f32 v8, v8, v9
    v_accvgpr_write_b32 a222, v8
    v_mfma_f32_16x16x16_bf16 v[20:23], v[226:227], v[74:75], v[0:3]
    v_cvt_pk_bf16_f32 v10, v10, v11
    v_accvgpr_write_b32 a223, v10
    v_mfma_f32_16x16x16_bf16 v[8:11], v[228:229], v[74:75], v[0:3]
    v_cvt_pk_bf16_f32 v84, v84, v85
    v_accvgpr_write_b32 a246, v84
    v_cvt_pk_bf16_f32 v86, v86, v87
    v_mfma_f32_16x16x32_bf16 v[0:3], v[104:107], v[12:15], 0
    v_accvgpr_write_b32 a247, v86
    v_cvt_pk_bf16_f32 v238, v52, v53
    v_mfma_f32_16x16x32_bf16 v[0:3], v[160:163], v[168:171], v[0:3]
    s_waitcnt lgkmcnt(2)
    v_cvt_pk_bf16_f32 v239, v54, v55
    v_cvt_pk_bf16_f32 v56, v56, v57
    v_mfma_f32_16x16x16_bf16 v[52:55], v[96:97], v[74:75], v[36:39]
    s_waitcnt vmcnt(5) lgkmcnt(1)
    v_accvgpr_write_b32 a228, v56
    v_cvt_pk_bf16_f32 v58, v58, v59
    v_accvgpr_write_b32 a229, v58
    v_mfma_f32_16x16x16_bf16 v[56:59], v[98:99], v[74:75], v[36:39]
    s_barrier
    ds_write_b96 v51, v[48:50] offset:4096
    v_mfma_f32_16x16x16_bf16 v[48:51], v[100:101], v[74:75], v[36:39]
    v_cvt_pk_bf16_f32 v40, v40, v41
    v_accvgpr_write_b32 a252, v40
    v_cvt_pk_bf16_f32 v42, v42, v43
    v_mfma_f32_16x16x32_bf16 v[36:39], v[44:47], v[12:15], 0
    ds_read_b128 v[12:15], v139 offset:0
    v_accvgpr_write_b32 a253, v42
    v_mfma_f32_16x16x32_bf16 v[36:39], v[156:159], v[168:171], v[36:39]
    ds_read_b128 v[104:107], v138 offset:0
    v_cvt_pk_bf16_f32 v244, v32, v33
    v_cvt_pk_bf16_f32 v245, v34, v35
    v_mfma_f32_16x16x16_bf16 v[44:47], v[116:117], v[74:75], v[108:111]
    ds_read_b128 v[84:87], v139 offset:128
    v_cvt_pk_bf16_f32 v112, v112, v113
    v_mfma_f32_16x16x16_bf16 v[32:35], v[118:119], v[74:75], v[108:111]
    ds_read_b128 v[100:103], v138 offset:128
    v_accvgpr_write_b32 a230, v112
    v_mfma_f32_16x16x16_bf16 v[40:43], v[120:121], v[74:75], v[108:111]
    ds_read_b128 v[96:99], v139 offset:256
    v_cvt_pk_bf16_f32 v114, v114, v115
    v_accvgpr_write_b32 a231, v114
    v_cvt_pk_bf16_f32 v92, v92, v93
    v_accvgpr_write_b32 a254, v92
    v_cvt_pk_bf16_f32 v94, v94, v95
    v_accvgpr_write_b32 a255, v94
    v_cvt_pk_bf16_f32 v246, v64, v65
    v_cvt_pk_bf16_f32 v247, v66, v67
    v_rcp_f32 v76, v76
    v_cvt_pk_bf16_f32 v24, v24, v25
    v_mul_f32 v28, v28, v76
    v_mul_f32 v29, v29, v76
    v_cvt_pk_bf16_f32 v64, v28, v29
    v_mul_f32 v30, v30, v76
    v_mul_f32 v31, v31, v76
    v_cvt_pk_bf16_f32 v65, v30, v31
    s_waitcnt lgkmcnt(4)
    v_mfma_f32_16x16x32_bf16 v[28:31], a[0:3], v[12:15], 0
    ds_write_b64 v137, v[64:65] offset:1536
    v_mul_f32 v88, v88, v76
    v_mul_f32 v89, v89, v76
    v_cvt_pk_bf16_f32 v66, v88, v89
    v_mul_f32 v90, v90, v76
    v_mul_f32 v91, v91, v76
    v_cvt_pk_bf16_f32 v67, v90, v91
    v_mul_f32 v80, v80, v76
    v_mul_f32 v81, v81, v76
    v_cvt_pk_bf16_f32 v142, v80, v81
    v_mul_f32 v82, v82, v76
    v_mul_f32 v83, v83, v76
    v_cvt_pk_bf16_f32 v143, v82, v83
    ds_write_b64 v137, v[66:67] offset:1544
    v_accvgpr_write_b32 a232, v24
    v_cvt_pk_bf16_f32 v26, v26, v27
    v_accvgpr_write_b32 a233, v26
    v_cvt_pk_bf16_f32 v224, v20, v21
    v_cvt_pk_bf16_f32 v225, v22, v23
    ds_write_b64 v136, v[142:143] offset:1536
    v_mfma_f32_16x16x16_bf16 v[24:27], v[68:69], v[74:75], v[60:63]
    v_cvt_pk_bf16_f32 v248, v8, v9
    v_cvt_pk_bf16_f32 v249, v10, v11
    v_mfma_f32_16x16x16_bf16 v[20:23], v[70:71], v[74:75], v[60:63]
    ds_read_b128 v[68:71], v138 offset:256
    v_cvt_pk_bf16_f32 v52, v52, v53
    v_mfma_f32_16x16x16_bf16 v[8:11], v[72:73], v[74:75], v[60:63]
    v_accvgpr_write_b32 a234, v52
    v_cvt_pk_bf16_f32 v54, v54, v55
    v_accvgpr_write_b32 a235, v54
    v_cvt_pk_bf16_f32 v226, v56, v57
    v_cvt_pk_bf16_f32 v227, v58, v59
    v_cvt_pk_bf16_f32 v250, v48, v49
    v_cvt_pk_bf16_f32 v251, v50, v51
    v_cvt_pk_bf16_f32 v44, v44, v45
    v_accvgpr_write_b32 a236, v44
    v_cvt_pk_bf16_f32 v46, v46, v47
    v_accvgpr_write_b32 a237, v46
    v_cvt_pk_bf16_f32 v228, v32, v33
    v_cvt_pk_bf16_f32 v229, v34, v35
    v_cvt_pk_bf16_f32 v252, v40, v41
    v_cvt_pk_bf16_f32 v253, v42, v43
    v_cvt_pk_bf16_f32 v24, v24, v25
    v_accvgpr_write_b32 a238, v24
    v_cvt_pk_bf16_f32 v26, v26, v27
    v_accvgpr_write_b32 a239, v26
    v_cvt_pk_bf16_f32 v230, v20, v21
    v_cvt_pk_bf16_f32 v231, v22, v23
    v_cvt_pk_bf16_f32 v254, v8, v9
    v_cvt_pk_bf16_f32 v255, v10, v11
.p2align 6
L_loopF0:
    v_rcp_f32 v4, v4
    s_waitcnt lgkmcnt(1)
    v_mfma_f32_16x16x32_bf16 v[28:31], a[4:7], v[104:107], v[28:31]
    v_mul_f32 v16, v16, v4
    v_mul_f32 v17, v17, v4
    v_mfma_f32_16x16x32_bf16 v[28:31], a[8:11], v[84:87], v[28:31]
    v_cvt_pk_bf16_f32 v24, v16, v17
    v_mul_f32 v18, v18, v4
    v_mfma_f32_16x16x32_bf16 v[28:31], a[12:15], v[100:103], v[28:31]
    v_mul_f32 v19, v19, v4
    v_cvt_pk_bf16_f32 v25, v18, v19
    v_mfma_f32_16x16x32_bf16 v[28:31], a[16:19], v[96:99], v[28:31]
    s_waitcnt lgkmcnt(0)
    ds_write_b64 v137, v[24:25] offset:3072
    v_mfma_f32_16x16x32_bf16 v[28:31], a[20:23], v[68:71], v[28:31]
    v_mul_f32 v0, v0, v4
    v_mul_f32 v1, v1, v4
    v_mfma_f32_16x16x32_bf16 v[154:157], a[24:27], v[12:15], 0
    v_cvt_pk_bf16_f32 v26, v0, v1
    v_mul_f32 v2, v2, v4
    v_mfma_f32_16x16x32_bf16 v[154:157], a[28:31], v[104:107], v[154:157]
    v_mul_f32 v3, v3, v4
    v_cvt_pk_bf16_f32 v27, v2, v3
    v_mfma_f32_16x16x32_bf16 v[154:157], a[32:35], v[84:87], v[154:157]
    ds_write_b64 v137, v[26:27] offset:3080
    v_mfma_f32_16x16x32_bf16 v[154:157], a[36:39], v[100:103], v[154:157]
    v_mul_f32 v36, v36, v4
    v_mul_f32 v37, v37, v4
    v_mfma_f32_16x16x32_bf16 v[154:157], a[40:43], v[96:99], v[154:157]
    v_cvt_pk_bf16_f32 v36, v36, v37
    v_mul_f32 v38, v38, v4
    v_mfma_f32_16x16x32_bf16 v[154:157], a[44:47], v[68:71], v[154:157]
    v_mul_f32 v39, v39, v4
    v_cvt_pk_bf16_f32 v37, v38, v39
    v_mfma_f32_16x16x32_bf16 v[0:3], a[48:51], v[12:15], 0
    ds_write_b64 v136, v[36:37] offset:3072
    v_mfma_f32_16x16x32_bf16 v[0:3], a[52:55], v[104:107], v[0:3]
    v_fmac_f32 v124, v46, v46
    v_fmac_f32 v124, v47, v47
    v_mfma_f32_16x16x32_bf16 v[0:3], a[56:59], v[84:87], v[0:3]
    v_fma_f32 v150, v52, v52, s42
    v_fmac_f32 v150, v53, v53
    v_mfma_f32_16x16x32_bf16 v[0:3], a[60:63], v[100:103], v[0:3]
    v_fmac_f32 v150, v54, v54
    v_fmac_f32 v150, v55, v55
    v_mfma_f32_16x16x32_bf16 v[0:3], a[64:67], v[96:99], v[0:3]
    v_fmac_f32 v150, v48, v48
    v_fmac_f32 v150, v49, v49
    v_mfma_f32_16x16x32_bf16 v[0:3], a[68:71], v[68:71], v[0:3]
    v_fmac_f32 v150, v50, v50
    v_fmac_f32 v150, v51, v51
    v_mfma_f32_16x16x32_bf16 v[4:7], a[72:75], v[12:15], 0
    v_fmac_f32 v150, v92, v92
    v_fmac_f32 v150, v93, v93
    v_mfma_f32_16x16x32_bf16 v[4:7], a[76:79], v[104:107], v[4:7]
    v_fmac_f32 v150, v94, v94
    v_fmac_f32 v150, v95, v95
    v_mfma_f32_16x16x32_bf16 v[4:7], a[80:83], v[84:87], v[4:7]
    v_fma_f32 v151, v108, v108, s42
    v_fmac_f32 v151, v109, v109
    v_mfma_f32_16x16x32_bf16 v[4:7], a[84:87], v[100:103], v[4:7]
    v_fmac_f32 v151, v110, v110
    v_fmac_f32 v151, v111, v111
    v_mfma_f32_16x16x32_bf16 v[4:7], a[88:91], v[96:99], v[4:7]
    v_fmac_f32 v151, v8, v8
    v_fmac_f32 v151, v9, v9
    v_mfma_f32_16x16x32_bf16 v[4:7], a[92:95], v[68:71], v[4:7]
    v_fmac_f32 v151, v10, v10
    v_fmac_f32 v151, v11, v11
    v_mfma_f32_16x16x32_bf16 v[36:39], a[96:99], v[12:15], 0
    v_fmac_f32 v151, v112, v112
    v_fmac_f32 v151, v113, v113
    v_mfma_f32_16x16x32_bf16 v[36:39], a[100:103], v[104:107], v[36:39]
    v_fmac_f32 v151, v114, v114
    v_fmac_f32 v151, v115, v115
    v_mfma_f32_16x16x32_bf16 v[36:39], a[104:107], v[84:87], v[36:39]
    v_cvt_pk_bf16_f32 v150, v124, v150
    v_cvt_pk_bf16_f32 v151, v151, v151
    v_mfma_f32_16x16x32_bf16 v[36:39], a[108:111], v[100:103], v[36:39]
    ds_write_b64 v132, v[150:151]
    v_mfma_f32_16x16x32_bf16 v[36:39], a[112:115], v[96:99], v[36:39]
    v_add_u32 v137, s49, v137
    v_add_u32 v136, s49, v136
    v_mfma_f32_16x16x32_bf16 v[36:39], a[116:119], v[68:71], v[36:39]
    v_cvt_pk_f16_f32 v88, v28, v29
    v_cvt_pk_f16_f32 v89, v30, v31
    v_mfma_f32_16x16x32_bf16 v[28:31], a[120:123], v[12:15], 0
    v_pk_fma_f16 v20, v88, v88, s39
    v_pk_fmac_f16 v20, v89, v89
    v_mfma_f32_16x16x32_bf16 v[28:31], a[124:127], v[104:107], v[28:31]
    v_cvt_pk_f16_f32 v90, v154, v155
    v_cvt_pk_f16_f32 v91, v156, v157
    v_mfma_f32_16x16x32_bf16 v[28:31], a[128:131], v[84:87], v[28:31]
    v_pk_fmac_f16 v20, v90, v90
    v_pk_fmac_f16 v20, v91, v91
    v_mfma_f32_16x16x32_bf16 v[28:31], a[132:135], v[100:103], v[28:31]
    v_cvt_pk_f16_f32 v154, v0, v1
    v_cvt_pk_f16_f32 v155, v2, v3
    v_mfma_f32_16x16x32_bf16 v[28:31], a[136:139], v[96:99], v[28:31]
    v_pk_fmac_f16 v20, v154, v154
    v_pk_fmac_f16 v20, v155, v155
    v_mfma_f32_16x16x32_bf16 v[28:31], a[140:143], v[68:71], v[28:31]
    s_waitcnt lgkmcnt(0)
    v_cvt_pk_f16_f32 v0, v4, v5
    v_cvt_pk_f16_f32 v1, v6, v7
    v_mfma_f32_16x16x32_bf16 v[16:19], v[12:15], a[144:147], 0
    s_barrier
    ds_read_b128 v[60:63], v131 offset:0
    v_pk_fma_f16 v21, v0, v0, s39
    v_mfma_f32_16x16x32_bf16 v[16:19], v[104:107], a[148:151], v[16:19]
    ds_read_b128 v[72:75], v131 offset:1024
    v_pk_fmac_f16 v21, v1, v1
    v_mfma_f32_16x16x32_bf16 v[16:19], v[84:87], a[152:155], v[16:19]
    ds_read_b128 v[80:83], v139 offset:1536
    v_cvt_pk_f16_f32 v2, v36, v37
    v_mfma_f32_16x16x32_bf16 v[16:19], v[100:103], a[156:159], v[16:19]
    ds_read_b128 v[64:67], v138 offset:1536
    v_cvt_pk_f16_f32 v3, v38, v39
    v_mfma_f32_16x16x32_bf16 v[16:19], v[96:99], a[160:163], v[16:19]
    ds_read_b128 v[76:79], v139 offset:1664
    v_pk_fmac_f16 v21, v2, v2
    v_mfma_f32_16x16x32_bf16 v[16:19], v[68:71], a[164:167], v[16:19]
    ds_read_b128 v[116:119], v138 offset:1664
    v_pk_fmac_f16 v21, v3, v3
    v_mfma_f32_16x16x32_bf16 v[22:25], v[12:15], a[168:171], 0
    ds_read_b128 v[120:123], v139 offset:1792
    v_cvt_pk_f16_f32 v4, v28, v29
    v_mfma_f32_16x16x32_bf16 v[22:25], v[104:107], a[172:175], v[22:25]
    ds_read_b128 v[56:59], v138 offset:1792
    v_cvt_pk_f16_f32 v5, v30, v31
    v_mfma_f32_16x16x32_bf16 v[22:25], v[84:87], a[176:179], v[22:25]
    v_pk_fmac_f16 v21, v4, v4
    v_pk_fmac_f16 v21, v5, v5
    v_mfma_f32_16x16x32_bf16 v[22:25], v[100:103], a[180:183], v[22:25]
    v_cvt_pk_bf16_f32 v36, v16, v17
    v_cvt_pk_bf16_f32 v37, v18, v19
    v_mfma_f32_16x16x32_bf16 v[22:25], v[96:99], a[184:187], v[22:25]
    v_mfma_f32_16x16x32_bf16 v[22:25], v[68:71], a[188:191], v[22:25]
    s_waitcnt lgkmcnt(5)
    s_nop 0
    v_mfma_f32_16x16x32_bf16 v[16:19], v[216:219], v[60:63], 0
    s_nop 2
    v_mfma_f32_16x16x32_bf16 v[16:19], v[216:219], v[72:75], v[16:19]
    s_nop 0
    v_cvt_pk_bf16_f32 v28, v22, v23
    v_cvt_pk_bf16_f32 v29, v24, v25
    v_mfma_f32_16x16x32_bf16 v[24:27], v[12:15], a[192:195], 0
    s_nop 1
    v_mfma_f32_16x16x32_bf16 v[24:27], v[104:107], a[196:199], v[24:27]
    s_nop 0
    v_rsq_f32 v16, v16
    v_mfma_f32_16x16x32_bf16 v[24:27], v[84:87], a[200:203], v[24:27]
    v_rsq_f32 v17, v17
    v_mfma_f32_16x16x32_bf16 v[24:27], v[100:103], a[204:207], v[24:27]
    v_rsq_f32 v18, v18
    v_mfma_f32_16x16x32_bf16 v[24:27], v[96:99], a[208:211], v[24:27]
    v_mul_f32 v16, s43, v16
    v_mul_f32 v17, s43, v17
    v_mfma_f32_16x16x32_bf16 v[24:27], v[68:71], a[212:215], v[24:27]
    v_mul_f32 v18, s43, v18
    v_mul_f32 v32, v32, v16
    v_mfma_f32_16x16x32_bf16 v[12:15], a[0:3], v[80:83], 0
    s_waitcnt lgkmcnt(0)
    v_mul_f32 v33, v33, v16
    v_cvt_pk_bf16_f32 v30, v32, v33
    v_mfma_f32_16x16x32_bf16 v[12:15], a[4:7], v[64:67], v[12:15]
    v_mul_f32 v34, v34, v16
    v_mul_f32 v35, v35, v16
    v_mfma_f32_16x16x32_bf16 v[12:15], a[8:11], v[76:79], v[12:15]
    v_cvt_pk_bf16_f32 v31, v34, v35
    v_mul_f32 v40, v40, v16
    v_mfma_f32_16x16x32_bf16 v[12:15], a[12:15], v[116:119], v[12:15]
    ds_write_b64 v137, v[30:31] offset:0
    v_mfma_f32_16x16x32_bf16 v[12:15], a[16:19], v[120:123], v[12:15]
    v_mul_f32 v41, v41, v16
    v_cvt_pk_bf16_f32 v32, v40, v41
    v_mfma_f32_16x16x32_bf16 v[12:15], a[20:23], v[56:59], v[12:15]
    v_mul_f32 v42, v42, v16
    v_mul_f32 v43, v43, v16
    v_mfma_f32_16x16x32_bf16 v[38:41], a[24:27], v[80:83], 0
    v_cvt_pk_bf16_f32 v33, v42, v43
    v_mul_f32 v44, v44, v16
    v_mfma_f32_16x16x32_bf16 v[38:41], a[28:31], v[64:67], v[38:41]
    ds_write_b64 v137, v[32:33] offset:8
    v_mfma_f32_16x16x32_bf16 v[38:41], a[32:35], v[76:79], v[38:41]
    v_mul_f32 v45, v45, v16
    v_cvt_pk_bf16_f32 v22, v44, v45
    v_mfma_f32_16x16x32_bf16 v[38:41], a[36:39], v[116:119], v[38:41]
    v_mul_f32 v46, v46, v16
    v_mul_f32 v47, v47, v16
    v_mfma_f32_16x16x32_bf16 v[38:41], a[40:43], v[120:123], v[38:41]
    v_cvt_pk_bf16_f32 v23, v46, v47
    v_cvt_pk_bf16_f32 v24, v24, v25
    v_mfma_f32_16x16x32_bf16 v[38:41], a[44:47], v[56:59], v[38:41]
    ds_write_b64 v136, v[22:23] offset:0
    v_mfma_f32_16x16x32_bf16 v[30:33], a[48:51], v[80:83], 0
    v_cvt_pk_bf16_f32 v25, v26, v27
    v_cvt_pk_f16_f32 v104, v12, v13
    v_mfma_f32_16x16x32_bf16 v[30:33], a[52:55], v[64:67], v[30:33]
    v_cvt_pk_f16_f32 v105, v14, v15
    v_pk_fma_f16 v22, v104, v104, s39
    v_mfma_f32_16x16x32_bf16 v[30:33], a[56:59], v[76:79], v[30:33]
    v_pk_fmac_f16 v22, v105, v105
    v_mul_f32 v52, v52, v17
    v_mfma_f32_16x16x32_bf16 v[30:33], a[60:63], v[116:119], v[30:33]
    v_mul_f32 v53, v53, v17
    v_cvt_pk_bf16_f32 v12, v52, v53
    v_mfma_f32_16x16x32_bf16 v[30:33], a[64:67], v[120:123], v[30:33]
    v_mul_f32 v54, v54, v17
    v_mul_f32 v55, v55, v17
    v_mfma_f32_16x16x32_bf16 v[30:33], a[68:71], v[56:59], v[30:33]
    v_cvt_pk_bf16_f32 v13, v54, v55
    v_mul_f32 v48, v48, v17
    v_mfma_f32_16x16x32_bf16 v[44:47], a[72:75], v[80:83], 0
    ds_write_b64 v137, v[12:13] offset:1536
    v_mfma_f32_16x16x32_bf16 v[44:47], a[76:79], v[64:67], v[44:47]
    v_mul_f32 v49, v49, v17
    v_cvt_pk_bf16_f32 v14, v48, v49
    v_mfma_f32_16x16x32_bf16 v[44:47], a[80:83], v[76:79], v[44:47]
    v_mul_f32 v50, v50, v17
    v_mul_f32 v51, v51, v17
    v_mfma_f32_16x16x32_bf16 v[44:47], a[84:87], v[116:119], v[44:47]
    v_cvt_pk_bf16_f32 v15, v50, v51
    v_mul_f32 v92, v92, v17
    v_mfma_f32_16x16x32_bf16 v[44:47], a[88:91], v[120:123], v[44:47]
    ds_write_b64 v137, v[14:15] offset:1544
    v_mfma_f32_16x16x32_bf16 v[44:47], a[92:95], v[56:59], v[44:47]
    v_mul_f32 v93, v93, v17
    v_cvt_pk_bf16_f32 v150, v92, v93
    v_mfma_f32_16x16x32_bf16 v[12:15], a[96:99], v[80:83], 0
    v_mul_f32 v94, v94, v17
    v_mul_f32 v95, v95, v17
    v_mfma_f32_16x16x32_bf16 v[12:15], a[100:103], v[64:67], v[12:15]
    v_cvt_pk_bf16_f32 v151, v94, v95
    v_cvt_pk_f16_f32 v106, v38, v39
    v_mfma_f32_16x16x32_bf16 v[12:15], a[104:107], v[76:79], v[12:15]
    ds_write_b64 v136, v[150:151] offset:1536
    v_mfma_f32_16x16x32_bf16 v[12:15], a[108:111], v[116:119], v[12:15]
    v_cvt_pk_f16_f32 v107, v40, v41
    v_pk_fmac_f16 v22, v106, v106
    v_mfma_f32_16x16x32_bf16 v[12:15], a[112:115], v[120:123], v[12:15]
    v_pk_fmac_f16 v22, v107, v107
    v_cvt_pk_f16_f32 v150, v30, v31
    v_mfma_f32_16x16x32_bf16 v[12:15], a[116:119], v[56:59], v[12:15]
    s_sub_u32 s50, s45, s44
    v_cvt_pk_f16_f32 v151, v32, v33
    v_pk_fmac_f16 v22, v150, v150
    v_mfma_f32_16x16x32_bf16 v[30:33], a[120:123], v[80:83], 0
    s_sub_u32 s51, s46, s47
    v_pk_fmac_f16 v22, v151, v151
    v_cvt_pk_f16_f32 v6, v44, v45
    v_mfma_f32_16x16x32_bf16 v[30:33], a[124:127], v[64:67], v[30:33]
    s_mov_b32 s60, s59
    v_cvt_pk_f16_f32 v7, v46, v47
    v_pk_fma_f16 v23, v6, v6, s39
    v_mfma_f32_16x16x32_bf16 v[30:33], a[128:131], v[76:79], v[30:33]
    s_mov_b32 s59, s58
    v_pk_fmac_f16 v23, v7, v7
    v_mul_f32 v108, v108, v18
    v_mfma_f32_16x16x32_bf16 v[30:33], a[132:135], v[116:119], v[30:33]
    s_mov_b32 s58, s57
    v_mul_f32 v109, v109, v18
    v_cvt_pk_bf16_f32 v38, v108, v109
    v_mfma_f32_16x16x32_bf16 v[30:33], a[136:139], v[120:123], v[30:33]
    s_mov_b32 s57, s56
    v_mul_f32 v110, v110, v18
    v_mul_f32 v111, v111, v18
    v_mfma_f32_16x16x32_bf16 v[30:33], a[140:143], v[56:59], v[30:33]
    s_add_u32 s56, s56, s62
    v_cvt_pk_bf16_f32 v39, v110, v111
    v_mul_f32 v8, v8, v18
    v_mfma_f32_16x16x32_bf16 v[44:47], v[80:83], a[144:147], 0
    s_add_u32 s61, s61, 1
    ds_write_b64 v137, v[38:39] offset:3072
    v_mfma_f32_16x16x32_bf16 v[44:47], v[64:67], a[148:151], v[44:47]
    s_cmp_eq_u32 s61, 72
    v_mul_f32 v9, v9, v18
    v_cvt_pk_bf16_f32 v40, v8, v9
    v_mfma_f32_16x16x32_bf16 v[44:47], v[76:79], a[152:155], v[44:47]
    s_cselect_b32 s53, s63, 0
    ds_read_b128 v[68:71], v139 offset:3072
    v_mul_f32 v10, v10, v18
    v_mfma_f32_16x16x32_bf16 v[44:47], v[116:119], a[156:159], v[44:47]
    s_cselect_b32 s61, 0, s61
    ds_read_b128 v[60:63], v138 offset:3072
    v_mul_f32 v11, v11, v18
    v_mfma_f32_16x16x32_bf16 v[44:47], v[120:123], a[160:163], v[44:47]
    s_add_u32 s56, s56, s53
    ds_read_b128 v[72:75], v139 offset:3200
    v_cvt_pk_bf16_f32 v41, v10, v11
    v_mfma_f32_16x16x32_bf16 v[44:47], v[56:59], a[164:167], v[44:47]
    s_sub_u32 s64, s64, 1
    ds_write_b64 v137, v[40:41] offset:3080
    v_mfma_f32_16x16x32_bf16 v[40:43], v[80:83], a[168:171], 0
    s_cmp_gt_i32 s64, 0
    v_mul_f32 v112, v112, v18
    v_mul_f32 v113, v113, v18
    v_mfma_f32_16x16x32_bf16 v[40:43], v[64:67], a[172:175], v[40:43]
    s_cselect_b32 s26, 100270464, 0
    ds_read_b128 v[52:55], v138 offset:3200
    v_cvt_pk_bf16_f32 v38, v112, v113
    v_mfma_f32_16x16x32_bf16 v[40:43], v[76:79], a[176:179], v[40:43]
    s_cselect_b32 s56, s56, 0
    ds_read_b128 v[92:95], v139 offset:3328
    v_mul_f32 v114, v114, v18
    v_mfma_f32_16x16x32_bf16 v[40:43], v[116:119], a[180:183], v[40:43]
    s_add_u32 s65, s65, 1
    ds_read_b128 v[108:111], v138 offset:3328
    v_mul_f32 v115, v115, v18
    v_mfma_f32_16x16x32_bf16 v[40:43], v[120:123], a[184:187], v[40:43]
    s_cmp_ge_i32 s65, 2
    v_cvt_pk_bf16_f32 v39, v114, v115
    v_cvt_pk_f16_f32 v8, v12, v13
    v_mfma_f32_16x16x32_bf16 v[40:43], v[56:59], a[188:191], v[40:43]
    s_cselect_b32 s30, 100270464, 0
    ds_write_b64 v136, v[38:39] offset:3072
    v_mfma_f32_16x16x32_bf16 v[16:19], v[80:83], a[192:195], 0
    s_waitcnt vmcnt(0)
    v_cvt_pk_f16_f32 v9, v14, v15
    v_pk_fmac_f16 v23, v8, v8
    v_mfma_f32_16x16x32_bf16 v[16:19], v[64:67], a[196:199], v[16:19]
    s_add_u32 s67, s46, s54
    v_pk_fmac_f16 v23, v9, v9
    v_cvt_pk_f16_f32 v10, v30, v31
    v_mfma_f32_16x16x32_bf16 v[16:19], v[76:79], a[200:203], v[16:19]
    s_add_u32 m0, s67, 0
    v_cvt_pk_f16_f32 v11, v32, v33
    v_pk_fmac_f16 v23, v10, v10
    v_mfma_f32_16x16x32_bf16 v[16:19], v[116:119], a[204:207], v[16:19]
    v_pk_fmac_f16 v23, v11, v11
    v_cvt_pk_bf16_f32 v38, v44, v45
    v_mfma_f32_16x16x32_bf16 v[16:19], v[120:123], a[208:211], v[16:19]
    v_cvt_pk_bf16_f32 v39, v46, v47
    v_cvt_pk_bf16_f32 v30, v40, v41
    v_mfma_f32_16x16x32_bf16 v[16:19], v[56:59], a[212:215], v[16:19]
    v_cvt_pk_bf16_f32 v31, v42, v43
    v_add_u32 v139, s50, v139
    v_mfma_f32_16x16x32_f16 v[56:59], v[212:215], v[20:23], 0
    s_waitcnt lgkmcnt(1)
    v_add_u32 v138, s50, v138
    v_add_u32 v137, s48, v137
    v_mfma_f32_16x16x32_bf16 v[12:15], a[0:3], v[68:71], 0
    s_waitcnt lgkmcnt(0)
    v_cvt_pk_bf16_f32 v26, v16, v17
    v_cvt_pk_bf16_f32 v27, v18, v19
    v_mfma_f32_16x16x32_bf16 v[12:15], a[4:7], v[60:63], v[12:15]
    s_barrier
    v_or3_b32 v125, v125, v56, v57
    v_or3_b32 v125, v125, v58, v59
    v_mfma_f32_16x16x32_bf16 v[12:15], a[8:11], v[72:75], v[12:15]
    v_rsq_f32 v56, v56
    v_mfma_f32_16x16x32_bf16 v[12:15], a[12:15], v[52:55], v[12:15]
    v_rsq_f32 v57, v57
    v_mfma_f32_16x16x32_bf16 v[12:15], a[16:19], v[92:95], v[12:15]
    v_mul_f32 v56, s52, v56
    v_cvt_pk_f16_f32 v56, v56, v57
    v_mfma_f32_16x16x32_bf16 v[12:15], a[20:23], v[108:111], v[12:15]
    v_rsq_f32 v58, v58
    v_mfma_f32_16x16x32_bf16 v[16:19], a[24:27], v[68:71], 0
    v_rsq_f32 v59, v59
    v_mfma_f32_16x16x32_bf16 v[16:19], a[28:31], v[60:63], v[16:19]
    v_mul_f32 v58, s52, v58
    v_cvt_pk_f16_f32 v58, v58, v59
    v_mfma_f32_16x16x32_bf16 v[16:19], a[32:35], v[72:75], v[16:19]
    v_pk_mul_f16 v0, v0, v56 op_sel:[0,1] op_sel_hi:[1,1]
    v_pk_mul_f16 v1, v1, v56 op_sel:[0,1] op_sel_hi:[1,1]
    v_mfma_f32_16x16x32_bf16 v[16:19], a[36:39], v[52:55], v[16:19]
    v_pk_mul_f16 v2, v2, v56 op_sel:[0,1] op_sel_hi:[1,1]
    v_pk_mul_f16 v3, v3, v56 op_sel:[0,1] op_sel_hi:[1,1]
    v_mfma_f32_16x16x32_bf16 v[16:19], a[40:43], v[92:95], v[16:19]
    v_pk_mul_f16 v4, v4, v56 op_sel:[0,1] op_sel_hi:[1,1]
    v_pk_mul_f16 v5, v5, v56 op_sel:[0,1] op_sel_hi:[1,1]
    v_mfma_f32_16x16x32_bf16 v[16:19], a[44:47], v[108:111], v[16:19]
    v_pk_mul_f16 v88, v88, v56 op_sel:[0,0] op_sel_hi:[1,0]
    v_pk_mul_f16 v89, v89, v56 op_sel:[0,0] op_sel_hi:[1,0]
    v_mfma_f32_16x16x32_bf16 v[32:35], a[48:51], v[68:71], 0
    v_pk_mul_f16 v90, v90, v56 op_sel:[0,0] op_sel_hi:[1,0]
    v_pk_mul_f16 v91, v91, v56 op_sel:[0,0] op_sel_hi:[1,0]
    v_mfma_f32_16x16x32_bf16 v[32:35], a[52:55], v[60:63], v[32:35]
    v_pk_mul_f16 v154, v154, v56 op_sel:[0,0] op_sel_hi:[1,0]
    v_pk_mul_f16 v155, v155, v56 op_sel:[0,0] op_sel_hi:[1,0]
    v_mfma_f32_16x16x32_bf16 v[32:35], a[56:59], v[72:75], v[32:35]
    v_cvt_pk_f16_f32 v56, v12, v13
    v_cvt_pk_f16_f32 v57, v14, v15
    v_mfma_f32_16x16x32_bf16 v[32:35], a[60:63], v[52:55], v[32:35]
    v_pk_fma_f16 v20, v56, v56, s39
    v_pk_fmac_f16 v20, v57, v57
    v_mfma_f32_16x16x32_bf16 v[32:35], a[64:67], v[92:95], v[32:35]
    v_pk_mul_f16 v6, v6, v58 op_sel:[0,1] op_sel_hi:[1,1]
    v_pk_mul_f16 v7, v7, v58 op_sel:[0,1] op_sel_hi:[1,1]
    v_mfma_f32_16x16x32_bf16 v[32:35], a[68:71], v[108:111], v[32:35]
    v_pk_mul_f16 v8, v8, v58 op_sel:[0,1] op_sel_hi:[1,1]
    v_pk_mul_f16 v9, v9, v58 op_sel:[0,1] op_sel_hi:[1,1]
    v_mfma_f32_16x16x32_bf16 v[12:15], a[72:75], v[68:71], 0
    v_pk_mul_f16 v10, v10, v58 op_sel:[0,1] op_sel_hi:[1,1]
    v_pk_mul_f16 v11, v11, v58 op_sel:[0,1] op_sel_hi:[1,1]
    v_mfma_f32_16x16x32_bf16 v[12:15], a[76:79], v[60:63], v[12:15]
    v_pk_mul_f16 v104, v104, v58 op_sel:[0,0] op_sel_hi:[1,0]
    v_pk_mul_f16 v105, v105, v58 op_sel:[0,0] op_sel_hi:[1,0]
    v_mfma_f32_16x16x32_bf16 v[12:15], a[80:83], v[72:75], v[12:15]
    v_pk_mul_f16 v106, v106, v58 op_sel:[0,0] op_sel_hi:[1,0]
    v_pk_mul_f16 v107, v107, v58 op_sel:[0,0] op_sel_hi:[1,0]
    v_mfma_f32_16x16x32_bf16 v[12:15], a[84:87], v[52:55], v[12:15]
    v_pk_mul_f16 v150, v150, v58 op_sel:[0,0] op_sel_hi:[1,0]
    v_pk_mul_f16 v151, v151, v58 op_sel:[0,0] op_sel_hi:[1,0]
    v_mfma_f32_16x16x32_bf16 v[12:15], a[88:91], v[92:95], v[12:15]
    v_cvt_pk_f16_f32 v58, v16, v17
    v_cvt_pk_f16_f32 v59, v18, v19
    v_mfma_f32_16x16x32_bf16 v[12:15], a[92:95], v[108:111], v[12:15]
    v_pk_fmac_f16 v20, v58, v58
    v_pk_fmac_f16 v20, v59, v59
    v_mfma_f32_16x16x32_bf16 v[16:19], a[96:99], v[68:71], 0
    v_cvt_pk_f16_f32 v146, v32, v33
    v_cvt_pk_f16_f32 v147, v34, v35
    v_mfma_f32_16x16x32_bf16 v[16:19], a[100:103], v[60:63], v[16:19]
    v_pk_fmac_f16 v20, v146, v146
    v_pk_fmac_f16 v20, v147, v147
    v_mfma_f32_16x16x32_bf16 v[16:19], a[104:107], v[72:75], v[16:19]
    v_cvt_pk_f16_f32 v12, v12, v13
    v_cvt_pk_f16_f32 v13, v14, v15
    v_mfma_f32_16x16x32_bf16 v[16:19], a[108:111], v[52:55], v[16:19]
    v_pk_fma_f16 v21, v12, v12, s39
    v_pk_fmac_f16 v21, v13, v13
    v_mfma_f32_16x16x32_bf16 v[16:19], a[112:115], v[92:95], v[16:19]
    v_add_u32 v136, s48, v136
    v_add_u32 v135, s51, v135
    v_mfma_f32_16x16x32_bf16 v[16:19], a[116:119], v[108:111], v[16:19]
    v_add_u32 v134, 336, v134
    v_add_u32 v133, 336, v133
    v_mfma_f32_16x16x32_bf16 v[32:35], a[120:123], v[68:71], 0
    s_nop 2
    v_mfma_f32_16x16x32_bf16 v[32:35], a[124:127], v[60:63], v[32:35]
    s_nop 0
    v_cvt_pk_f16_f32 v14, v16, v17
    v_cvt_pk_f16_f32 v15, v18, v19
    v_mfma_f32_16x16x32_bf16 v[32:35], a[128:131], v[72:75], v[32:35]
    v_pk_fmac_f16 v21, v14, v14
    v_pk_fmac_f16 v21, v15, v15
    v_mfma_f32_16x16x32_bf16 v[32:35], a[132:135], v[52:55], v[32:35]
    v_mfma_f32_16x16x32_bf16 v[32:35], a[136:139], v[92:95], v[32:35]
    v_mfma_f32_16x16x32_bf16 v[32:35], a[140:143], v[108:111], v[32:35]
    s_nop 0
    v_mfma_f32_16x16x32_bf16 v[40:43], v[68:71], a[144:147], 0
    s_nop 0
    ds_read_b128 v[44:47], v135 offset:0
    s_nop 0
    v_mfma_f32_16x16x32_bf16 v[40:43], v[60:63], a[148:151], v[40:43]
    s_nop 0
    ds_read_b128 v[80:83], v135 offset:1024
    v_cvt_pk_f16_f32 v16, v32, v33
    v_mfma_f32_16x16x32_bf16 v[40:43], v[72:75], a[152:155], v[40:43]
    ds_read_b128 v[64:67], v139 offset:0
    v_cvt_pk_f16_f32 v17, v34, v35
    v_mfma_f32_16x16x32_bf16 v[40:43], v[52:55], a[156:159], v[40:43]
    ds_read_b128 v[76:79], v138 offset:0
    v_pk_fmac_f16 v21, v16, v16
    v_mfma_f32_16x16x32_bf16 v[40:43], v[92:95], a[160:163], v[40:43]
    ds_read_b128 v[84:87], v139 offset:128
    v_pk_fmac_f16 v21, v17, v17
    v_mfma_f32_16x16x32_bf16 v[40:43], v[108:111], a[164:167], v[40:43]
    ds_read_b128 v[100:103], v138 offset:128
    v_mfma_f32_16x16x32_f16 v[96:99], v[212:215], v[20:23], 0
    s_nop 0
    ds_read_b128 v[48:51], v139 offset:256
    s_nop 0
    v_mfma_f32_16x16x32_bf16 v[32:35], v[68:71], a[168:171], 0
    s_nop 0
    ds_read_b128 v[112:115], v138 offset:256
    v_cvt_pk_bf16_f32 v164, v40, v41
    v_mfma_f32_16x16x32_bf16 v[32:35], v[60:63], a[172:175], v[32:35]
    ds_read_b128 v[116:119], v135 offset:2048
    v_or3_b32 v125, v125, v96, v97
    v_mfma_f32_16x16x32_bf16 v[32:35], v[72:75], a[176:179], v[32:35]
    s_waitcnt lgkmcnt(8)
    buffer_load_dwordx4 v130, s[24:27], s56 offen nt lds
    v_cvt_pk_bf16_f32 v165, v42, v43
    v_mfma_f32_16x16x32_bf16 v[32:35], v[52:55], a[180:183], v[32:35]
    v_rsq_f32 v96, v96
    v_mfma_f32_16x16x32_bf16 v[32:35], v[92:95], a[184:187], v[32:35]
    v_rsq_f32 v97, v97
    v_mfma_f32_16x16x32_bf16 v[32:35], v[108:111], a[188:191], v[32:35]
    ds_read_b128 v[18:21], v134 offset:32
    v_mul_f32 v96, s52, v96
    v_mfma_f32_16x16x32_bf16 v[40:43], v[68:71], a[192:195], 0
    ds_read_b64 v[22:23], v134 offset:48
    v_cvt_pk_f16_f32 v96, v96, v97
    v_mfma_f32_16x16x32_bf16 v[40:43], v[60:63], a[196:199], v[40:43]
    s_nop 0
    ds_read_b128 v[120:123], v135 offset:3072
    v_cvt_pk_bf16_f32 v160, v32, v33
    v_mfma_f32_16x16x32_bf16 v[40:43], v[72:75], a[200:203], v[40:43]
    v_cvt_pk_bf16_f32 v161, v34, v35
    v_pk_mul_f16 v12, v12, v96 op_sel:[0,1] op_sel_hi:[1,1]
    v_mfma_f32_16x16x32_bf16 v[40:43], v[52:55], a[204:207], v[40:43]
    buffer_store_dwordx4 v[44:47], v130, s[28:31], s60 offen sc1
    v_pk_mul_f16 v13, v13, v96 op_sel:[0,1] op_sel_hi:[1,1]
    v_pk_mul_f16 v14, v14, v96 op_sel:[0,1] op_sel_hi:[1,1]
    v_pk_mul_f16 v15, v15, v96 op_sel:[0,1] op_sel_hi:[1,1]
    v_pk_mul_f16 v16, v16, v96 op_sel:[0,1] op_sel_hi:[1,1]
    v_mfma_f32_16x16x32_bf16 v[40:43], v[92:95], a[208:211], v[40:43]
    s_add_u32 m0, s67, 1024
    v_pk_mul_f16 v17, v17, v96 op_sel:[0,1] op_sel_hi:[1,1]
    v_pk_mul_f16 v56, v56, v96 op_sel:[0,0] op_sel_hi:[1,0]
    v_mfma_f32_16x16x32_bf16 v[40:43], v[108:111], a[212:215], v[40:43]
    s_waitcnt lgkmcnt(3)
    v_pk_mul_f16 v57, v57, v96 op_sel:[0,0] op_sel_hi:[1,0]
    v_pk_mul_f16 v58, v58, v96 op_sel:[0,0] op_sel_hi:[1,0]
    v_mfma_f32_16x16x32_bf16 v[32:35], a[216:219], v[64:67], 0
    v_pk_mul_f16 v59, v59, v96 op_sel:[0,0] op_sel_hi:[1,0]
    v_pk_mul_f16 v146, v146, v96 op_sel:[0,0] op_sel_hi:[1,0]
    v_mfma_f32_16x16x32_bf16 v[32:35], a[220:223], v[76:79], v[32:35]
    buffer_load_dwordx4 v129, s[24:27], s56 offen nt lds
    v_pk_mul_f16 v147, v147, v96 op_sel:[0,0] op_sel_hi:[1,0]
    v_mfma_f32_16x16x32_bf16 v[32:35], a[224:227], v[84:87], v[32:35]
    v_cvt_pk_bf16_f32 v156, v40, v41
    v_cvt_pk_bf16_f32 v157, v42, v43
    v_mfma_f32_16x16x32_bf16 v[32:35], a[228:231], v[100:103], v[32:35]
    v_mfma_f32_16x16x32_bf16 v[32:35], a[232:235], v[48:51], v[32:35]
    v_mfma_f32_16x16x32_bf16 v[32:35], a[236:239], v[112:115], v[32:35]
    v_mfma_f32_16x16x32_bf16 v[40:43], a[240:243], v[64:67], 0
    v_mfma_f32_16x16x32_bf16 v[40:43], a[244:247], v[76:79], v[40:43]
    ds_read_u16 v166, v133 offset:56
    v_mfma_f32_16x16x32_bf16 v[40:43], a[248:251], v[84:87], v[40:43]
    buffer_store_dwordx4 v[80:83], v129, s[28:31], s60 offen sc1
    ds_read_u16 v162, v133 offset:64
    ds_read_u16 v158, v133 offset:72
    v_mfma_f32_16x16x32_bf16 v[40:43], a[252:255], v[100:103], v[40:43]
    s_add_u32 m0, s67, 2048
    ds_read_b128 v[108:111], v135 offset:4096
    v_mfma_f32_16x16x32_bf16 v[40:43], v[224:227], v[48:51], v[40:43]
    ds_read_b128 v[52:55], v134 offset:0
    v_mfma_f32_16x16x32_bf16 v[40:43], v[228:231], v[112:115], v[40:43]
    ds_read_b64 v[142:143], v134 offset:16
    buffer_load_dwordx4 v128, s[24:27], s56 offen nt lds
    v_mfma_f32_16x16x32_bf16 v[44:47], v[232:235], v[64:67], 0
    v_mfma_f32_16x16x32_bf16 v[44:47], v[236:239], v[76:79], v[44:47]
    ds_read_b128 v[68:71], v139 offset:1536
    v_mfma_f32_16x16x32_bf16 v[44:47], v[240:243], v[84:87], v[44:47]
    ds_read_b128 v[60:63], v138 offset:1536
    v_mfma_f32_16x16x32_bf16 v[44:47], v[244:247], v[100:103], v[44:47]
    ds_read_b128 v[72:75], v139 offset:1664
    v_mfma_f32_16x16x32_bf16 v[44:47], v[248:251], v[48:51], v[44:47]
    ds_read_b128 v[80:83], v138 offset:1664
    v_mfma_f32_16x16x32_bf16 v[44:47], v[252:255], v[112:115], v[44:47]
    ds_read_b128 v[64:67], v139 offset:1792
    v_mfma_f32_16x16x32_f16 v[92:95], v[0:3], v[88:91], v[204:207]
    ds_read_b128 v[76:79], v138 offset:1792
    v_mfma_f32_16x16x32_f16 v[92:95], v[2:5], v[152:155], v[92:95]
    s_add_u32 m0, s67, 3072
    buffer_store_dwordx4 v[116:119], v128, s[28:31], s60 offen sc1
    s_nop 3
    v_mfma_f32_16x16x32_f16 v[84:87], v[6:9], v[88:91], v[200:203]
    s_nop 0
    v_exp_f32 v92, v92
    v_mfma_f32_16x16x32_f16 v[84:87], v[8:11], v[152:155], v[84:87]
    v_exp_f32 v93, v93
    v_mfma_f32_16x16x32_f16 v[100:103], v[12:15], v[88:91], v[196:199]
    v_exp_f32 v94, v94
    v_mfma_f32_16x16x32_f16 v[100:103], v[14:17], v[152:155], v[100:103]
    s_waitcnt lgkmcnt(3)
    buffer_load_dwordx4 v127, s[24:27], s56 offen nt lds
    v_cvt_pk_bf16_f32 v48, v92, v93
    v_mfma_f32_16x16x32_f16 v[96:99], v[18:21], v[88:91], v[208:211]
    v_exp_f32 v95, v95
    v_mfma_f32_16x16x32_f16 v[96:99], v[20:23], v[152:155], v[96:99]
    v_exp_f32 v84, v84
    v_mfma_f32_16x16x32_f16 v[88:91], v[52:55], v[0:3], v[208:211]
    v_exp_f32 v85, v85
    v_mfma_f32_16x16x32_f16 v[88:91], v[140:143], v[2:5], v[88:91]
    v_cvt_pk_bf16_f32 v49, v94, v95
    v_cvt_pk_bf16_f32 v50, v84, v85
    v_mfma_f32_16x16x32_f16 v[92:95], v[52:55], v[6:9], v[208:211]
    v_exp_f32 v86, v86
    v_mfma_f32_16x16x32_f16 v[92:95], v[140:143], v[8:11], v[92:95]
    v_exp_f32 v87, v87
    v_mfma_f32_16x16x32_f16 v[112:115], v[52:55], v[12:15], v[208:211]
    buffer_store_dwordx4 v[120:123], v127, s[28:31], s60 offen sc1
    v_cvt_pk_bf16_f32 v51, v86, v87
    v_exp_f32 v100, v100
    v_mfma_f32_16x16x32_f16 v[112:115], v[140:143], v[14:17], v[112:115]
    s_add_u32 m0, s67, 4096
    v_exp_f32 v101, v101
    v_mfma_f32_16x16x32_bf16 v[52:55], a[216:219], v[68:71], 0
    v_exp_f32 v102, v102
    v_mfma_f32_16x16x32_bf16 v[52:55], a[220:223], v[60:63], v[52:55]
    s_mov_b32 s53, s47
    v_exp_f32 v103, v103
    v_mfma_f32_16x16x32_bf16 v[52:55], a[224:227], v[72:75], v[52:55]
    s_waitcnt lgkmcnt(0)
    s_mov_b32 s47, s46
    buffer_load_dwordx4 v126, s[24:27], s56 offen nt lds
    v_cvt_pk_bf16_f32 v168, v100, v101
    v_mfma_f32_16x16x32_bf16 v[52:55], a[228:231], v[80:83], v[52:55]
    s_mov_b32 s46, s45
    v_cvt_pk_bf16_f32 v169, v102, v103
    v_mov_b32_dpp v91, v95 quad_perm:[0,1,2,3] row_mask:0x2 bank_mask:0xf
    v_mfma_f32_16x16x32_bf16 v[52:55], a[232:235], v[64:67], v[52:55]
    s_mov_b32 s45, s44
    v_exp_f32 v96, v96
    v_mfma_f32_16x16x32_bf16 v[52:55], a[236:239], v[76:79], v[52:55]
    s_mov_b32 s44, s53
    v_cvt_pk_bf16_f32 v170, v96, 0
    v_mov_b32_dpp v91, v115 quad_perm:[0,1,2,3] row_mask:0x4 bank_mask:0xf
    v_mfma_f32_16x16x32_f16 v[84:87], v[0:3], v[104:107], v[192:195]
    s_sub_u32 s48, s44, s46
    v_exp_f32 v91, v91
    v_mfma_f32_16x16x32_f16 v[84:87], v[2:5], v[148:151], v[84:87]
    s_sub_u32 s49, s46, s45
    v_cvt_pk_bf16_f32 v91, v91, v91
    v_fma_f32 v124, v32, v32, s42
    v_mfma_f32_16x16x32_f16 v[96:99], v[6:9], v[104:107], v[188:191]
    s_sub_u32 s66, s66, 1
    ds_write_b16 v133, v91
    v_mfma_f32_16x16x32_f16 v[96:99], v[8:11], v[148:151], v[96:99]
    s_cmp_lg_u32 s66, 0
    buffer_store_dwordx4 v[108:111], v126, s[28:31], s60 offen sc1
    ds_read_b128 v[92:95], v134
    v_exp_f32 v84, v84
    v_fmac_f32 v124, v33, v33
    v_mfma_f32_16x16x32_f16 v[112:115], v[12:15], v[104:107], v[184:187]
    ds_read_b128 v[88:91], v134 offset:16
    v_fmac_f32 v124, v34, v34
    v_mfma_f32_16x16x32_f16 v[112:115], v[14:17], v[148:151], v[112:115]
    v_exp_f32 v85, v85
    v_mfma_f32_16x16x32_f16 v[116:119], v[18:21], v[104:107], v[208:211]
    v_exp_f32 v86, v86
    v_mfma_f32_16x16x32_f16 v[116:119], v[20:23], v[148:151], v[116:119]
    v_exp_f32 v87, v87
    v_mfma_f32_16x16x32_bf16 v[108:111], v[220:223], v[48:51], 0
    v_cvt_pk_bf16_f32 v84, v84, v85
    v_cvt_pk_bf16_f32 v85, v86, v87
    v_mfma_f32_16x16x32_bf16 v[108:111], v[220:223], v[168:171], v[108:111]
    v_exp_f32 v96, v96
    v_mfma_f32_16x16x32_bf16 v[104:107], v[36:39], v[48:51], 0
    v_exp_f32 v97, v97
    v_mfma_f32_16x16x32_bf16 v[104:107], v[164:167], v[168:171], v[104:107]
    v_exp_f32 v98, v98
    v_mfma_f32_16x16x32_bf16 v[100:103], v[28:31], v[48:51], 0
    v_exp_f32 v99, v99
    v_mfma_f32_16x16x32_bf16 v[100:103], v[160:163], v[168:171], v[100:103]
    v_cvt_pk_bf16_f32 v86, v96, v97
    v_cvt_pk_bf16_f32 v87, v98, v99
    v_mfma_f32_16x16x32_bf16 v[96:99], v[24:27], v[48:51], 0
    v_exp_f32 v112, v112
    v_mfma_f32_16x16x32_bf16 v[96:99], v[156:159], v[168:171], v[96:99]
    v_exp_f32 v113, v113
    v_mfma_f32_16x16x32_bf16 v[48:51], a[240:243], v[68:71], 0
    v_exp_f32 v114, v114
    v_mfma_f32_16x16x32_bf16 v[48:51], a[244:247], v[60:63], v[48:51]
    v_exp_f32 v115, v115
    v_mfma_f32_16x16x32_bf16 v[48:51], a[248:251], v[72:75], v[48:51]
    v_cvt_pk_bf16_f32 v168, v112, v113
    v_cvt_pk_bf16_f32 v169, v114, v115
    v_mfma_f32_16x16x32_bf16 v[48:51], a[252:255], v[80:83], v[48:51]
    v_exp_f32 v117, v117
    v_mfma_f32_16x16x32_bf16 v[48:51], v[224:227], v[64:67], v[48:51]
    v_cvt_pk_bf16_f32 v170, v117, 0
    v_fmac_f32 v124, v35, v35
    v_mfma_f32_16x16x32_bf16 v[48:51], v[228:231], v[76:79], v[48:51]
    s_waitcnt lgkmcnt(0)
    v_rcp_f32 v108, v108
    v_mfma_f32_16x16x32_bf16 v[112:115], v[92:95], v[36:39], 0
    v_mul_f32 v104, v104, v108
    v_mul_f32 v105, v105, v108
    v_mfma_f32_16x16x32_bf16 v[112:115], v[88:91], v[164:167], v[112:115]
    v_cvt_pk_bf16_f32 v104, v104, v105
    v_mul_f32 v106, v106, v108
    v_mfma_f32_16x16x32_bf16 v[116:119], v[92:95], v[28:31], 0
    v_mul_f32 v107, v107, v108
    v_cvt_pk_bf16_f32 v105, v106, v107
    v_mfma_f32_16x16x32_bf16 v[116:119], v[88:91], v[160:163], v[116:119]
    ds_write_b64 v137, v[104:105] offset:0
    v_mfma_f32_16x16x32_bf16 v[110:113], v[92:95], v[24:27], 0
    v_mul_f32 v100, v100, v108
    v_mul_f32 v101, v101, v108
    v_mfma_f32_16x16x32_bf16 v[110:113], v[88:91], v[156:159], v[110:113]
    v_cvt_pk_bf16_f32 v106, v100, v101
    v_mul_f32 v102, v102, v108
    v_mfma_f32_16x16x32_bf16 v[92:95], v[232:235], v[68:71], 0
    v_mul_f32 v103, v103, v108
    v_cvt_pk_bf16_f32 v107, v102, v103
    v_mfma_f32_16x16x32_bf16 v[92:95], v[236:239], v[60:63], v[92:95]
    ds_write_b64 v137, v[106:107] offset:8
    v_mfma_f32_16x16x32_bf16 v[92:95], v[240:243], v[72:75], v[92:95]
    v_mul_f32 v96, v96, v108
    v_mul_f32 v97, v97, v108
    v_mfma_f32_16x16x32_bf16 v[92:95], v[244:247], v[80:83], v[92:95]
    ds_read_b128 v[68:71], v139 offset:3072
    v_cvt_pk_bf16_f32 v154, v96, v97
    v_mfma_f32_16x16x32_bf16 v[92:95], v[248:251], v[64:67], v[92:95]
    ds_read_b128 v[60:63], v138 offset:3072
    v_mul_f32 v98, v98, v108
    v_mfma_f32_16x16x32_bf16 v[92:95], v[252:255], v[76:79], v[92:95]
    ds_read_b128 v[72:75], v139 offset:3200
    v_mul_f32 v99, v99, v108
    v_mfma_f32_16x16x32_f16 v[80:83], v[0:3], v[56:59], v[180:183]
    ds_read_b128 v[64:67], v138 offset:3200
    v_cvt_pk_bf16_f32 v155, v98, v99
    v_mfma_f32_16x16x32_f16 v[80:83], v[2:5], v[144:147], v[80:83]
    ds_write_b64 v136, v[154:155] offset:0
    v_mfma_f32_16x16x32_f16 v[0:3], v[6:9], v[56:59], v[176:179]
    v_mov_b32_dpp v115, v119 quad_perm:[0,1,2,3] row_mask:0x2 bank_mask:0xf
    v_fmac_f32 v124, v40, v40
    v_mfma_f32_16x16x32_f16 v[0:3], v[8:11], v[144:147], v[0:3]
    ds_read_b128 v[4:7], v139 offset:3328
    v_mov_b32_dpp v115, v113 quad_perm:[0,1,2,3] row_mask:0x4 bank_mask:0xf
    v_mfma_f32_16x16x32_f16 v[8:11], v[12:15], v[56:59], v[172:175]
    ds_read_b128 v[76:79], v138 offset:3328
    v_cvt_pk_bf16_f32 v115, v115, v115
    v_mfma_f32_16x16x32_f16 v[8:11], v[14:17], v[144:147], v[8:11]
    ds_write_b16 v133, v115 offset:56
    v_mfma_f32_16x16x32_f16 v[12:15], v[18:21], v[56:59], v[208:211]
    v_exp_f32 v80, v80
    v_mfma_f32_16x16x32_f16 v[12:15], v[20:23], v[144:147], v[12:15]
    v_exp_f32 v81, v81
    v_mfma_f32_16x16x32_bf16 v[56:59], v[220:223], v[84:87], 0
    v_exp_f32 v82, v82
    v_mfma_f32_16x16x32_bf16 v[56:59], v[220:223], v[168:171], v[56:59]
    v_exp_f32 v83, v83
    v_mfma_f32_16x16x32_bf16 v[16:19], v[36:39], v[84:87], 0
    v_cvt_pk_bf16_f32 v20, v80, v81
    v_cvt_pk_bf16_f32 v21, v82, v83
    v_mfma_f32_16x16x32_bf16 v[16:19], v[164:167], v[168:171], v[16:19]
    v_exp_f32 v0, v0
    v_mfma_f32_16x16x32_bf16 v[80:83], v[28:31], v[84:87], 0
    v_exp_f32 v1, v1
    v_mfma_f32_16x16x32_bf16 v[80:83], v[160:163], v[168:171], v[80:83]
    v_exp_f32 v2, v2
    v_mfma_f32_16x16x32_bf16 v[88:91], v[24:27], v[84:87], 0
    v_exp_f32 v3, v3
    v_mfma_f32_16x16x32_bf16 v[88:91], v[156:159], v[168:171], v[88:91]
    s_waitcnt lgkmcnt(0)
    v_cvt_pk_bf16_f32 v22, v0, v1
    v_cvt_pk_bf16_f32 v23, v2, v3
    v_mfma_f32_16x16x32_bf16 v[108:111], a[216:219], v[68:71], 0
    v_exp_f32 v8, v8
    v_mfma_f32_16x16x32_bf16 v[108:111], a[220:223], v[60:63], v[108:111]
    v_exp_f32 v9, v9
    v_mfma_f32_16x16x32_bf16 v[108:111], a[224:227], v[72:75], v[108:111]
    v_exp_f32 v10, v10
    v_mfma_f32_16x16x32_bf16 v[108:111], a[228:231], v[64:67], v[108:111]
    v_exp_f32 v11, v11
    v_mfma_f32_16x16x32_bf16 v[108:111], a[232:235], v[4:7], v[108:111]
    v_cvt_pk_bf16_f32 v168, v8, v9
    v_cvt_pk_bf16_f32 v169, v10, v11
    v_mfma_f32_16x16x32_bf16 v[108:111], a[236:239], v[76:79], v[108:111]
    v_exp_f32 v14, v14
    v_mfma_f32_16x16x32_bf16 v[8:11], a[240:243], v[68:71], 0
    v_cvt_pk_bf16_f32 v170, v14, 0
    v_add_u32 v139, s48, v139
    v_mfma_f32_16x16x32_bf16 v[8:11], a[244:247], v[60:63], v[8:11]
    ds_read_b128 v[12:15], v139 offset:0
    v_add_u32 v138, s48, v138
    v_mfma_f32_16x16x32_bf16 v[8:11], a[248:251], v[72:75], v[8:11]
    ds_read_b128 v[104:107], v138 offset:0
    v_fmac_f32 v124, v41, v41
    v_mfma_f32_16x16x32_bf16 v[8:11], a[252:255], v[64:67], v[8:11]
    ds_read_b128 v[84:87], v139 offset:128
    v_fmac_f32 v124, v42, v42
    v_mfma_f32_16x16x32_bf16 v[8:11], v[224:227], v[4:7], v[8:11]
    ds_read_b128 v[100:103], v138 offset:128
    v_fmac_f32 v124, v43, v43
    v_mfma_f32_16x16x32_bf16 v[8:11], v[228:231], v[76:79], v[8:11]
    ds_read_b128 v[96:99], v139 offset:256
    v_fmac_f32 v124, v44, v44
    v_mfma_f32_16x16x32_bf16 v[112:115], v[232:235], v[68:71], 0
    ds_read_b128 v[68:71], v138 offset:256
    v_fmac_f32 v124, v45, v45
    v_mfma_f32_16x16x32_bf16 v[112:115], v[236:239], v[60:63], v[112:115]
    v_rcp_f32 v56, v56
    v_mfma_f32_16x16x32_bf16 v[112:115], v[240:243], v[72:75], v[112:115]
    v_mul_f32 v16, v16, v56
    v_mul_f32 v17, v17, v56
    v_mfma_f32_16x16x32_bf16 v[112:115], v[244:247], v[64:67], v[112:115]
    v_cvt_pk_bf16_f32 v0, v16, v17
    v_mul_f32 v18, v18, v56
    v_mfma_f32_16x16x32_bf16 v[112:115], v[248:251], v[4:7], v[112:115]
    v_mul_f32 v19, v19, v56
    v_cvt_pk_bf16_f32 v1, v18, v19
    v_mfma_f32_16x16x32_bf16 v[112:115], v[252:255], v[76:79], v[112:115]
    ds_write_b64 v137, v[0:1] offset:1536
    v_mfma_f32_16x16x32_bf16 v[4:7], v[220:223], v[20:23], 0
    v_mul_f32 v80, v80, v56
    v_mul_f32 v81, v81, v56
    v_mfma_f32_16x16x32_bf16 v[4:7], v[220:223], v[168:171], v[4:7]
    v_cvt_pk_bf16_f32 v2, v80, v81
    v_mul_f32 v82, v82, v56
    v_mfma_f32_16x16x32_bf16 v[16:19], v[36:39], v[20:23], 0
    v_mul_f32 v83, v83, v56
    v_cvt_pk_bf16_f32 v3, v82, v83
    v_mfma_f32_16x16x32_bf16 v[16:19], v[164:167], v[168:171], v[16:19]
    ds_write_b64 v137, v[2:3] offset:1544
    v_mfma_f32_16x16x32_bf16 v[0:3], v[28:31], v[20:23], 0
    v_mul_f32 v88, v88, v56
    v_mul_f32 v89, v89, v56
    v_mfma_f32_16x16x32_bf16 v[0:3], v[160:163], v[168:171], v[0:3]
    v_cvt_pk_bf16_f32 v154, v88, v89
    v_mul_f32 v90, v90, v56
    v_mfma_f32_16x16x32_bf16 v[36:39], v[24:27], v[20:23], 0
    v_mul_f32 v91, v91, v56
    v_cvt_pk_bf16_f32 v155, v90, v91
    v_mfma_f32_16x16x32_bf16 v[36:39], v[156:159], v[168:171], v[36:39]
    s_waitcnt lgkmcnt(1)
    ds_write_b64 v136, v[154:155] offset:1536
    v_mfma_f32_16x16x32_bf16 v[28:31], a[0:3], v[12:15], 0
    s_cbranch_scc1 L_loopF0
L_tailF:
    v_rcp_f32 v4, v4
    v_fmac_f32 v124, v46, v46
    v_mul_f32 v16, v16, v4
    v_mul_f32 v17, v17, v4
    v_cvt_pk_bf16_f32 v12, v16, v17
    v_mul_f32 v18, v18, v4
    v_mul_f32 v19, v19, v4
    v_cvt_pk_bf16_f32 v13, v18, v19
    v_mul_f32 v0, v0, v4
    v_mul_f32 v1, v1, v4
    v_cvt_pk_bf16_f32 v14, v0, v1
    v_mul_f32 v2, v2, v4
    v_mul_f32 v3, v3, v4
    v_cvt_pk_bf16_f32 v15, v2, v3
    v_mul_f32 v36, v36, v4
    v_mul_f32 v37, v37, v4
    v_cvt_pk_bf16_f32 v36, v36, v37
    v_mul_f32 v38, v38, v4
    v_mul_f32 v39, v39, v4
    v_cvt_pk_bf16_f32 v37, v38, v39
    s_sub_u32 s84, s45, s44
    s_mov_b32 s30, 100270464
    ds_write_b64 v137, v[12:13] offset:3072
    v_fmac_f32 v124, v47, v47
    s_sub_u32 s85, s71, 1
    ds_write_b64 v137, v[14:15] offset:3080
    v_fma_f32 v134, v52, v52, s42
    v_fmac_f32 v134, v53, v53
    v_fmac_f32 v134, v54, v54
    ds_write_b64 v136, v[36:37] offset:3072
    v_fmac_f32 v134, v55, v55
    v_fmac_f32 v134, v48, v48
    v_fmac_f32 v134, v49, v49
    v_fmac_f32 v134, v50, v50
    v_fmac_f32 v134, v51, v51
    v_fmac_f32 v134, v92, v92
    v_fmac_f32 v134, v93, v93
    v_fmac_f32 v134, v94, v94
    v_fmac_f32 v134, v95, v95
    v_fma_f32 v133, v108, v108, s42
    v_fmac_f32 v133, v109, v109
    v_fmac_f32 v133, v110, v110
    v_fmac_f32 v133, v111, v111
    v_fmac_f32 v133, v8, v8
    v_fmac_f32 v133, v9, v9
    v_fmac_f32 v133, v10, v10
    v_fmac_f32 v133, v11, v11
    v_fmac_f32 v133, v112, v112
    v_fmac_f32 v133, v113, v113
    v_fmac_f32 v133, v114, v114
    v_fmac_f32 v133, v115, v115
    v_cvt_pk_bf16_f32 v0, v124, v134
    v_cvt_pk_bf16_f32 v1, v133, v133
    ds_write_b64 v132, v[0:1]
    v_mbcnt_lo_u32_b32 v124, -1, 0
    v_mbcnt_hi_u32_b32 v124, -1, v124
    v_and_b32 v103, 15, v124
    v_lshrrev_b32 v102, 4, v124
    v_add_u32 v101, s84, v139
    v_add_u32 v1, s84, v138
    s_sub_u32 s84, s46, s45
    v_add_u32 v100, s84, v137
    v_add_u32 v133, s84, v136
    s_sub_u32 s84, s44, s45
    v_add_u32 v3, s84, v137
    v_add_u32 v2, s84, v136
    s_sub_u32 s84, s44, s47
    v_add_u32 v7, s84, v135
    s_sub_u32 s84, s45, s47
    v_add_u32 v124, s84, v135
    s_sub_u32 s84, s46, s47
    v_add_u32 v0, s84, v135
    s_mul_i32 s84, s68, 7056
    s_add_u32 s84, s84, 135616
    v_mul_u32_u24 v102, 80, v102
    v_add_u32 v102, s84, v102
    s_movk_i32 s84, 336
    v_min_u32 v26, s85, v103
    v_mad_u32_u24 v26, v26, s84, v102
    v_add_u32 v14, 16, v103
    v_min_u32 v14, s85, v14
    v_mad_u32_u24 v14, v14, s84, v102
    s_lshl_b32 s84, s68, 10
    v_add_u32 v102, s84, v131
    ds_read_b96 v[4:6], v102 offset:4096
    ds_read_b128 v[64:67], v26 offset:0
    ds_read_b128 v[20:23], v26 offset:16
    ds_read_b64 v[24:25], v26 offset:56
    ds_read_b128 v[26:29], v26 offset:64
    ds_read_b128 v[60:63], v14 offset:0
    ds_read_b128 v[56:59], v14 offset:16
    ds_read_b64 v[12:13], v14 offset:56
    ds_read_b128 v[14:17], v14 offset:64
    s_waitcnt lgkmcnt(6)
    v_mfma_f32_16x16x32_bf16 v[36:39], v[220:223], v[64:67], 0
    v_mfma_f32_16x16x32_bf16 v[36:39], v[220:223], v[20:23], v[36:39]
    s_waitcnt lgkmcnt(3)
    v_lshlrev_b32 v30, 16, v24
    v_and_b32 v24, 0xffff0000, v24
    v_lshlrev_b32 v19, 16, v25
    v_and_b32 v25, 0xffff0000, v25
    v_lshlrev_b32 v18, 16, v26
    v_and_b32 v26, 0xffff0000, v26
    v_mfma_f32_16x16x32_bf16 v[20:23], v[220:223], v[60:63], 0
    s_waitcnt lgkmcnt(2)
    v_rcp_f32 v36, v36
    v_mfma_f32_16x16x32_bf16 v[20:23], v[220:223], v[56:59], v[20:23]
    v_mul_f32 v30, v30, v36
    v_mul_f32 v24, v24, v36
    v_cvt_pk_bf16_f32 v24, v30, v24
    v_mul_f32 v19, v19, v36
    v_mul_f32 v25, v25, v36
    v_cvt_pk_bf16_f32 v25, v19, v25
    v_mul_f32 v18, v18, v36
    v_mul_f32 v26, v26, v36
    v_cvt_pk_bf16_f32 v26, v18, v26
    v_lshlrev_b32 v18, 16, v27
    v_and_b32 v27, 0xffff0000, v27
    v_mul_f32 v18, v18, v36
    v_mul_f32 v27, v27, v36
    v_cvt_pk_bf16_f32 v27, v18, v27
    v_lshlrev_b32 v18, 16, v28
    v_and_b32 v28, 0xffff0000, v28
    v_mul_f32 v18, v18, v36
    v_mul_f32 v28, v28, v36
    v_cvt_pk_bf16_f32 v102, v18, v28
    v_lshlrev_b32 v103, 16, v29
    v_and_b32 v29, 0xffff0000, v29
    v_mul_f32 v103, v103, v36
    v_mul_f32 v29, v29, v36
    v_cvt_pk_bf16_f32 v103, v103, v29
    ds_write_b64 v3, v[24:25] offset:0
    v_rcp_f32 v20, v20
    ds_write_b64 v3, v[26:27] offset:8
    s_waitcnt lgkmcnt(2)
    v_lshlrev_b32 v18, 16, v12
    v_and_b32 v12, 0xffff0000, v12
    ds_write_b64 v2, v[102:103] offset:0
    v_mul_f32 v18, v18, v20
    v_mul_f32 v12, v12, v20
    v_cvt_pk_bf16_f32 v12, v18, v12
    v_lshlrev_b32 v18, 16, v13
    v_and_b32 v13, 0xffff0000, v13
    v_mul_f32 v18, v18, v20
    v_mul_f32 v13, v13, v20
    v_cvt_pk_bf16_f32 v13, v18, v13
    v_lshlrev_b32 v18, 16, v14
    v_and_b32 v14, 0xffff0000, v14
    v_mul_f32 v18, v18, v20
    v_mul_f32 v14, v14, v20
    v_cvt_pk_bf16_f32 v14, v18, v14
    v_lshlrev_b32 v18, 16, v15
    v_and_b32 v15, 0xffff0000, v15
    v_mul_f32 v18, v18, v20
    v_mul_f32 v15, v15, v20
    v_cvt_pk_bf16_f32 v15, v18, v15
    v_lshlrev_b32 v18, 16, v16
    v_and_b32 v16, 0xffff0000, v16
    v_mul_f32 v18, v18, v20
    v_mul_f32 v16, v16, v20
    v_cvt_pk_bf16_f32 v102, v18, v16
    v_lshlrev_b32 v103, 16, v17
    v_and_b32 v17, 0xffff0000, v17
    v_mul_f32 v103, v103, v20
    v_mul_f32 v17, v17, v20
    v_cvt_pk_bf16_f32 v103, v103, v17
    ds_write_b64 v3, v[12:13] offset:1536
    ds_write_b64 v3, v[14:15] offset:1544
    ds_write_b64 v2, v[102:103] offset:1536
    s_waitcnt lgkmcnt(0)
    s_barrier
    ds_read_b128 v[88:91], v101 offset:0
    ds_read_b128 v[80:83], v1 offset:0
    ds_read_b128 v[68:71], v101 offset:128
    ds_read_b128 v[64:67], v1 offset:128
    ds_read_b128 v[60:63], v101 offset:256
    ds_read_b128 v[16:19], v1 offset:256
    ds_read_b128 v[28:31], v131 offset:0
    ds_read_b128 v[24:27], v131 offset:1024
    s_waitcnt lgkmcnt(6)
    v_mfma_f32_16x16x32_bf16 v[76:79], a[216:219], v[88:91], 0
    v_mfma_f32_16x16x32_bf16 v[76:79], a[220:223], v[80:83], v[76:79]
    s_waitcnt lgkmcnt(4)
    v_mfma_f32_16x16x32_bf16 v[76:79], a[224:227], v[68:71], v[76:79]
    v_mfma_f32_16x16x32_bf16 v[76:79], a[228:231], v[64:67], v[76:79]
    s_waitcnt lgkmcnt(2)
    ds_read_b128 v[116:119], v101 offset:1536
    ds_read_b128 v[104:107], v1 offset:1536
    v_mfma_f32_16x16x32_bf16 v[76:79], a[232:235], v[60:63], v[76:79]
    ds_read_b128 v[56:59], v101 offset:1664
    v_mfma_f32_16x16x32_bf16 v[76:79], a[236:239], v[16:19], v[76:79]
    ds_read_b128 v[36:39], v1 offset:1664
    v_mfma_f32_16x16x32_bf16 v[84:87], a[240:243], v[88:91], 0
    s_nop 0
    ds_read_b128 v[20:23], v101 offset:1792
    s_nop 0
    v_mfma_f32_16x16x32_bf16 v[84:87], a[244:247], v[80:83], v[84:87]
    s_nop 0
    ds_read_b128 v[12:15], v1 offset:1792
    v_fma_f32 v134, v76, v76, s42
    v_mfma_f32_16x16x32_bf16 v[84:87], a[248:251], v[68:71], v[84:87]
    v_fmac_f32 v134, v77, v77
    v_fmac_f32 v134, v78, v78
    v_mfma_f32_16x16x32_bf16 v[84:87], a[252:255], v[64:67], v[84:87]
    v_fmac_f32 v134, v79, v79
    v_mfma_f32_16x16x32_bf16 v[84:87], v[224:227], v[60:63], v[84:87]
    v_mfma_f32_16x16x32_bf16 v[84:87], v[228:231], v[16:19], v[84:87]
    s_nop 1
    v_mfma_f32_16x16x32_bf16 v[72:75], v[232:235], v[88:91], 0
    s_nop 2
    v_mfma_f32_16x16x32_bf16 v[72:75], v[236:239], v[80:83], v[72:75]
    s_nop 0
    v_fmac_f32 v134, v84, v84
    v_fmac_f32 v134, v85, v85
    v_mfma_f32_16x16x32_bf16 v[72:75], v[240:243], v[68:71], v[72:75]
    v_fmac_f32 v134, v86, v86
    v_fmac_f32 v134, v87, v87
    v_mfma_f32_16x16x32_bf16 v[72:75], v[244:247], v[64:67], v[72:75]
    v_and_b32 v125, 0xb8000000, v125
    v_mov_b32 v135, 0x3f803f80
    v_mfma_f32_16x16x32_bf16 v[72:75], v[248:251], v[60:63], v[72:75]
    v_cmp_ne_u32 vcc, 0, v125
    v_mfma_f32_16x16x32_bf16 v[72:75], v[252:255], v[16:19], v[72:75]
    s_waitcnt lgkmcnt(0)
    v_cndmask_b32 v135, 0, v135, vcc
    v_mfma_f32_16x16x32_bf16 v[16:19], v[216:219], v[28:31], 0
    s_nop 2
    v_mfma_f32_16x16x32_bf16 v[16:19], v[216:219], v[24:27], v[16:19]
    s_nop 0
    v_fmac_f32 v134, v72, v72
    v_fmac_f32 v134, v73, v73
    v_mfma_f32_16x16x32_bf16 v[68:71], a[216:219], v[116:119], 0
    v_fmac_f32 v134, v74, v74
    v_fmac_f32 v134, v75, v75
    v_mfma_f32_16x16x32_bf16 v[68:71], a[220:223], v[104:107], v[68:71]
    ds_read_b128 v[144:147], v101 offset:3072
    ds_read_b128 v[96:99], v1 offset:3072
    v_mfma_f32_16x16x32_bf16 v[68:71], a[224:227], v[56:59], v[68:71]
    ds_read_b128 v[28:31], v101 offset:3200
    v_mfma_f32_16x16x32_bf16 v[68:71], a[228:231], v[36:39], v[68:71]
    ds_read_b128 v[88:91], v1 offset:3200
    v_mfma_f32_16x16x32_bf16 v[68:71], a[232:235], v[20:23], v[68:71]
    ds_read_b128 v[80:83], v101 offset:3328
    v_mfma_f32_16x16x32_bf16 v[68:71], a[236:239], v[12:15], v[68:71]
    ds_read_b128 v[24:27], v1 offset:3328
    s_nop 0
    v_mfma_f32_16x16x32_bf16 v[64:67], a[240:243], v[116:119], 0
    s_nop 0
    v_rsq_f32 v16, v16
    v_mfma_f32_16x16x32_bf16 v[64:67], a[244:247], v[104:107], v[64:67]
    s_nop 0
    v_mul_f32 v16, s43, v16
    v_fma_f32 v125, v68, v68, s42
    v_mfma_f32_16x16x32_bf16 v[64:67], a[248:251], v[56:59], v[64:67]
    v_rsq_f32 v17, v17
    v_mfma_f32_16x16x32_bf16 v[64:67], a[252:255], v[36:39], v[64:67]
    v_mul_f32 v17, s43, v17
    v_fmac_f32 v125, v69, v69
    v_mfma_f32_16x16x32_bf16 v[64:67], v[224:227], v[20:23], v[64:67]
    v_rsq_f32 v18, v18
    v_mfma_f32_16x16x32_bf16 v[64:67], v[228:231], v[12:15], v[64:67]
    v_mul_f32 v18, s43, v18
    v_fmac_f32 v125, v70, v70
    v_mfma_f32_16x16x32_bf16 v[60:63], v[232:235], v[116:119], 0
    s_nop 0
    v_fmac_f32 v125, v71, v71
    v_mul_f32 v32, v32, v16
    v_mfma_f32_16x16x32_bf16 v[60:63], v[236:239], v[104:107], v[60:63]
    s_nop 0
    v_fmac_f32 v125, v64, v64
    v_fmac_f32 v125, v65, v65
    v_mfma_f32_16x16x32_bf16 v[60:63], v[240:243], v[56:59], v[60:63]
    v_fmac_f32 v125, v66, v66
    v_fmac_f32 v125, v67, v67
    v_mfma_f32_16x16x32_bf16 v[60:63], v[244:247], v[36:39], v[60:63]
    v_mul_f32 v33, v33, v16
    v_cvt_pk_bf16_f32 v32, v32, v33
    v_mfma_f32_16x16x32_bf16 v[60:63], v[248:251], v[20:23], v[60:63]
    v_mul_f32 v34, v34, v16
    v_mul_f32 v35, v35, v16
    v_mfma_f32_16x16x32_bf16 v[60:63], v[252:255], v[12:15], v[60:63]
    s_waitcnt lgkmcnt(0)
    v_cvt_pk_bf16_f32 v33, v34, v35
    v_mul_f32 v40, v40, v16
    v_mfma_f32_16x16x32_bf16 v[36:39], a[216:219], v[144:147], 0
    ds_write_b64 v100, v[32:33] offset:0
    v_mfma_f32_16x16x32_bf16 v[36:39], a[220:223], v[96:99], v[36:39]
    s_nop 0
    ds_read_b128 v[140:143], v139 offset:0
    v_fmac_f32 v125, v60, v60
    v_mfma_f32_16x16x32_bf16 v[36:39], a[224:227], v[28:31], v[36:39]
    ds_read_b128 v[120:123], v138 offset:0
    v_fmac_f32 v125, v61, v61
    v_mfma_f32_16x16x32_bf16 v[36:39], a[228:231], v[88:91], v[36:39]
    ds_read_b128 v[116:119], v139 offset:128
    v_fmac_f32 v125, v62, v62
    v_mfma_f32_16x16x32_bf16 v[36:39], a[232:235], v[80:83], v[36:39]
    ds_read_b128 v[104:107], v138 offset:128
    v_fmac_f32 v125, v63, v63
    v_mfma_f32_16x16x32_bf16 v[36:39], a[236:239], v[24:27], v[36:39]
    ds_read_b128 v[20:23], v139 offset:256
    v_mul_f32 v41, v41, v16
    v_mfma_f32_16x16x32_bf16 v[56:59], a[240:243], v[144:147], 0
    ds_read_b128 v[12:15], v138 offset:256
    v_cvt_pk_bf16_f32 v34, v40, v41
    v_mfma_f32_16x16x32_bf16 v[56:59], a[244:247], v[96:99], v[56:59]
    v_mul_f32 v42, v42, v16
    v_mul_f32 v43, v43, v16
    v_mfma_f32_16x16x32_bf16 v[56:59], a[248:251], v[28:31], v[56:59]
    v_cvt_pk_bf16_f32 v35, v42, v43
    v_mul_f32 v44, v44, v16
    v_mfma_f32_16x16x32_bf16 v[56:59], a[252:255], v[88:91], v[56:59]
    ds_write_b64 v100, v[34:35] offset:8
    v_mfma_f32_16x16x32_bf16 v[56:59], v[224:227], v[80:83], v[56:59]
    v_mul_f32 v45, v45, v16
    v_cvt_pk_bf16_f32 v44, v44, v45
    v_mfma_f32_16x16x32_bf16 v[56:59], v[228:231], v[24:27], v[56:59]
    v_mul_f32 v46, v46, v16
    v_mul_f32 v47, v47, v16
    v_mfma_f32_16x16x32_bf16 v[40:43], v[232:235], v[144:147], 0
    v_cvt_pk_bf16_f32 v45, v46, v47
    v_mul_f32 v52, v52, v17
    v_mfma_f32_16x16x32_bf16 v[40:43], v[236:239], v[96:99], v[40:43]
    ds_write_b64 v133, v[44:45] offset:0
    v_mfma_f32_16x16x32_bf16 v[40:43], v[240:243], v[28:31], v[40:43]
    v_mul_f32 v53, v53, v17
    v_cvt_pk_bf16_f32 v28, v52, v53
    v_mfma_f32_16x16x32_bf16 v[40:43], v[244:247], v[88:91], v[40:43]
    v_mul_f32 v54, v54, v17
    v_mul_f32 v55, v55, v17
    v_mfma_f32_16x16x32_bf16 v[40:43], v[248:251], v[80:83], v[40:43]
    v_cvt_pk_bf16_f32 v29, v54, v55
    v_mul_f32 v48, v48, v17
    v_mfma_f32_16x16x32_bf16 v[40:43], v[252:255], v[24:27], v[40:43]
    s_waitcnt lgkmcnt(1)
    ds_write_b64 v100, v[28:29] offset:1536
    v_mfma_f32_16x16x32_bf16 v[24:27], a[216:219], v[140:143], 0
    v_mul_f32 v49, v49, v17
    v_cvt_pk_bf16_f32 v30, v48, v49
    v_mfma_f32_16x16x32_bf16 v[24:27], a[220:223], v[120:123], v[24:27]
    v_mul_f32 v50, v50, v17
    v_mul_f32 v51, v51, v17
    v_mfma_f32_16x16x32_bf16 v[24:27], a[224:227], v[116:119], v[24:27]
    v_cvt_pk_bf16_f32 v31, v50, v51
    v_mul_f32 v92, v92, v17
    v_mfma_f32_16x16x32_bf16 v[24:27], a[228:231], v[104:107], v[24:27]
    ds_write_b64 v100, v[30:31] offset:1544
    v_mfma_f32_16x16x32_bf16 v[24:27], a[232:235], v[20:23], v[24:27]
    ds_read_b128 v[96:99], v139 offset:1536
    v_mul_f32 v93, v93, v17
    v_mfma_f32_16x16x32_bf16 v[24:27], a[236:239], v[12:15], v[24:27]
    ds_read_b128 v[88:91], v138 offset:1536
    v_cvt_pk_bf16_f32 v92, v92, v93
    v_mfma_f32_16x16x32_bf16 v[32:35], a[240:243], v[140:143], 0
    ds_read_b128 v[80:83], v139 offset:1664
    v_mul_f32 v94, v94, v17
    v_mfma_f32_16x16x32_bf16 v[32:35], a[244:247], v[120:123], v[32:35]
    ds_read_b128 v[52:55], v138 offset:1664
    v_mul_f32 v95, v95, v17
    v_mfma_f32_16x16x32_bf16 v[32:35], a[248:251], v[116:119], v[32:35]
    ds_read_b128 v[48:51], v139 offset:1792
    v_cvt_pk_bf16_f32 v93, v94, v95
    v_mfma_f32_16x16x32_bf16 v[32:35], a[252:255], v[104:107], v[32:35]
    ds_write_b64 v133, v[92:93] offset:1536
    v_mfma_f32_16x16x32_bf16 v[32:35], v[224:227], v[20:23], v[32:35]
    v_fma_f32 v1, v36, v36, s42
    v_fmac_f32 v1, v37, v37
    v_mfma_f32_16x16x32_bf16 v[32:35], v[228:231], v[12:15], v[32:35]
    ds_read_b128 v[44:47], v138 offset:1792
    v_fmac_f32 v1, v38, v38
    v_mfma_f32_16x16x32_bf16 v[28:31], v[232:235], v[140:143], 0
    v_fmac_f32 v1, v39, v39
    v_fmac_f32 v1, v56, v56
    v_mfma_f32_16x16x32_bf16 v[28:31], v[236:239], v[120:123], v[28:31]
    v_fmac_f32 v1, v57, v57
    v_fmac_f32 v1, v58, v58
    v_mfma_f32_16x16x32_bf16 v[28:31], v[240:243], v[116:119], v[28:31]
    v_fmac_f32 v1, v59, v59
    v_fmac_f32 v1, v40, v40
    v_mfma_f32_16x16x32_bf16 v[28:31], v[244:247], v[104:107], v[28:31]
    v_fmac_f32 v1, v41, v41
    v_fmac_f32 v1, v42, v42
    v_mfma_f32_16x16x32_bf16 v[28:31], v[248:251], v[20:23], v[28:31]
    v_fmac_f32 v1, v43, v43
    v_mul_f32 v108, v108, v18
    v_mfma_f32_16x16x32_bf16 v[28:31], v[252:255], v[12:15], v[28:31]
    s_waitcnt lgkmcnt(1)
    v_mul_f32 v109, v109, v18
    v_cvt_pk_bf16_f32 v92, v108, v109
    v_mfma_f32_16x16x32_bf16 v[12:15], a[216:219], v[96:99], 0
    v_mul_f32 v110, v110, v18
    v_mul_f32 v111, v111, v18
    v_mfma_f32_16x16x32_bf16 v[12:15], a[220:223], v[88:91], v[12:15]
    v_cvt_pk_bf16_f32 v93, v110, v111
    v_mul_f32 v8, v8, v18
    v_mfma_f32_16x16x32_bf16 v[12:15], a[224:227], v[80:83], v[12:15]
    ds_write_b64 v100, v[92:93] offset:3072
    v_mfma_f32_16x16x32_bf16 v[12:15], a[228:231], v[52:55], v[12:15]
    v_mul_f32 v9, v9, v18
    v_cvt_pk_bf16_f32 v94, v8, v9
    v_mfma_f32_16x16x32_bf16 v[12:15], a[232:235], v[48:51], v[12:15]
    s_waitcnt lgkmcnt(1)
    v_mul_f32 v10, v10, v18
    v_mul_f32 v11, v11, v18
    v_mfma_f32_16x16x32_bf16 v[12:15], a[236:239], v[44:47], v[12:15]
    v_cvt_pk_bf16_f32 v95, v10, v11
    v_mul_f32 v112, v112, v18
    v_mfma_f32_16x16x32_bf16 v[20:23], a[240:243], v[96:99], 0
    ds_write_b64 v100, v[94:95] offset:3080
    v_mfma_f32_16x16x32_bf16 v[20:23], a[244:247], v[88:91], v[20:23]
    v_mul_f32 v113, v113, v18
    v_cvt_pk_bf16_f32 v112, v112, v113
    v_mfma_f32_16x16x32_bf16 v[20:23], a[248:251], v[80:83], v[20:23]
    v_mul_f32 v114, v114, v18
    v_mul_f32 v115, v115, v18
    v_mfma_f32_16x16x32_bf16 v[20:23], a[252:255], v[52:55], v[20:23]
    v_cvt_pk_bf16_f32 v113, v114, v115
    v_cvt_pk_bf16_f32 v138, v134, v125
    v_mfma_f32_16x16x32_bf16 v[20:23], v[224:227], v[48:51], v[20:23]
    ds_write_b64 v133, v[112:113] offset:3072
    v_mfma_f32_16x16x32_bf16 v[20:23], v[228:231], v[44:47], v[20:23]
    v_cvt_pk_bf16_f32 v139, v1, v1
    v_fma_f32 v125, v24, v24, s42
    v_mfma_f32_16x16x32_bf16 v[16:19], v[232:235], v[96:99], 0
    ds_write_b64 v132, v[138:139] offset:2048
    v_mfma_f32_16x16x32_bf16 v[16:19], v[236:239], v[88:91], v[16:19]
    v_fmac_f32 v125, v25, v25
    v_fmac_f32 v125, v26, v26
    v_mfma_f32_16x16x32_bf16 v[16:19], v[240:243], v[80:83], v[16:19]
    v_fmac_f32 v125, v27, v27
    v_fmac_f32 v125, v32, v32
    v_mfma_f32_16x16x32_bf16 v[16:19], v[244:247], v[52:55], v[16:19]
    v_fmac_f32 v125, v33, v33
    v_fmac_f32 v125, v34, v34
    v_mfma_f32_16x16x32_bf16 v[16:19], v[248:251], v[48:51], v[16:19]
    v_fmac_f32 v125, v35, v35
    v_fmac_f32 v125, v28, v28
    v_mfma_f32_16x16x32_bf16 v[16:19], v[252:255], v[44:47], v[16:19]
    v_fmac_f32 v125, v29, v29
    v_fmac_f32 v125, v30, v30
    v_fmac_f32 v125, v31, v31
    v_fma_f32 v1, v12, v12, s42
    v_fmac_f32 v1, v13, v13
    v_fmac_f32 v1, v14, v14
    v_fmac_f32 v1, v15, v15
    v_fmac_f32 v1, v20, v20
    v_fmac_f32 v1, v21, v21
    v_fmac_f32 v1, v22, v22
    v_fmac_f32 v1, v23, v23
    v_fmac_f32 v1, v16, v16
    v_fmac_f32 v1, v17, v17
    v_fmac_f32 v1, v18, v18
    s_waitcnt lgkmcnt(0)
    s_barrier
    ds_read_b128 v[80:83], v131 offset:2048
    ds_read_b128 v[52:55], v131 offset:3072
    v_fmac_f32 v1, v19, v19
    v_cvt_pk_bf16_f32 v134, v125, v1
    ds_write_b64 v132, v[134:135]
    ds_read_b128 v[96:99], v0 offset:0
    ds_read_b128 v[92:95], v0 offset:1024
    ds_read_b128 v[88:91], v0 offset:2048
    ds_read_b128 v[8:11], v0 offset:3072
    ds_read_b128 v[48:51], v0 offset:4096
    s_waitcnt lgkmcnt(6)
    v_mfma_f32_16x16x32_bf16 v[44:47], v[216:219], v[80:83], 0
    v_mfma_f32_16x16x32_bf16 v[44:47], v[216:219], v[52:55], v[44:47]
    s_waitcnt lgkmcnt(4)
    s_nop 1
    s_barrier
    ds_read_b128 v[80:83], v131 offset:0
    ds_read_b128 v[52:55], v131 offset:1024
    s_nop 0
    buffer_store_dwordx4 v[96:99], v130, s[28:31], s59 offen sc1
    v_rsq_f32 v44, v44
    v_rsq_f32 v45, v45
    v_mul_f32 v44, s43, v44
    v_mul_f32 v45, s43, v45
    v_rsq_f32 v46, v46
    s_waitcnt lgkmcnt(3)
    buffer_store_dwordx4 v[92:95], v129, s[28:31], s59 offen sc1
    v_mul_f32 v46, s43, v46
    v_mul_f32 v76, v76, v44
    v_mul_f32 v77, v77, v44
    v_cvt_pk_bf16_f32 v76, v76, v77
    v_mul_f32 v78, v78, v44
    v_mul_f32 v79, v79, v44
    buffer_store_dwordx4 v[88:91], v128, s[28:31], s59 offen sc1
    v_cvt_pk_bf16_f32 v77, v78, v79
    v_mul_f32 v84, v84, v44
    v_mul_f32 v85, v85, v44
    v_cvt_pk_bf16_f32 v78, v84, v85
    v_mul_f32 v86, v86, v44
    v_mul_f32 v87, v87, v44
    buffer_store_dwordx4 v[8:11], v127, s[28:31], s59 offen sc1
    ds_write_b64 v137, v[76:77] offset:0
    v_cvt_pk_bf16_f32 v79, v86, v87
    s_waitcnt lgkmcnt(1)
    v_mfma_f32_16x16x32_bf16 v[8:11], v[216:219], v[80:83], 0
    buffer_store_dwordx4 v[48:51], v126, s[28:31], s59 offen sc1
    ds_write_b64 v137, v[78:79] offset:8
    v_mul_f32 v72, v72, v44
    v_mfma_f32_16x16x32_bf16 v[8:11], v[216:219], v[52:55], v[8:11]
    v_mul_f32 v73, v73, v44
    v_cvt_pk_bf16_f32 v0, v72, v73
    v_mul_f32 v74, v74, v44
    v_mul_f32 v75, v75, v44
    v_cvt_pk_bf16_f32 v1, v74, v75
    ds_write_b64 v136, v[0:1] offset:0
    v_mul_f32 v68, v68, v45
    v_mul_f32 v69, v69, v45
    v_cvt_pk_bf16_f32 v48, v68, v69
    v_mul_f32 v70, v70, v45
    v_mul_f32 v71, v71, v45
    v_cvt_pk_bf16_f32 v49, v70, v71
    v_mul_f32 v64, v64, v45
    v_mul_f32 v65, v65, v45
    v_cvt_pk_bf16_f32 v50, v64, v65
    v_mul_f32 v66, v66, v45
    v_mul_f32 v67, v67, v45
    v_cvt_pk_bf16_f32 v51, v66, v67
    v_mul_f32 v60, v60, v45
    v_mul_f32 v61, v61, v45
    v_cvt_pk_bf16_f32 v0, v60, v61
    v_mul_f32 v62, v62, v45
    v_mul_f32 v63, v63, v45
    v_cvt_pk_bf16_f32 v1, v62, v63
    ds_write_b64 v137, v[48:49] offset:1536
    v_mul_f32 v36, v36, v46
    ds_write_b64 v137, v[50:51] offset:1544
    v_mul_f32 v37, v37, v46
    v_cvt_pk_bf16_f32 v36, v36, v37
    v_mul_f32 v38, v38, v46
    ds_write_b64 v136, v[0:1] offset:1536
    v_mul_f32 v39, v39, v46
    v_cvt_pk_bf16_f32 v37, v38, v39
    v_mul_f32 v56, v56, v46
    v_mul_f32 v57, v57, v46
    v_cvt_pk_bf16_f32 v38, v56, v57
    v_mul_f32 v58, v58, v46
    v_mul_f32 v59, v59, v46
    v_cvt_pk_bf16_f32 v39, v58, v59
    v_mul_f32 v40, v40, v46
    v_mul_f32 v41, v41, v46
    v_cvt_pk_bf16_f32 v0, v40, v41
    v_mul_f32 v42, v42, v46
    v_mul_f32 v43, v43, v46
    v_cvt_pk_bf16_f32 v1, v42, v43
    ds_write_b64 v137, v[36:37] offset:3072
    v_rsq_f32 v8, v8
    ds_write_b64 v137, v[38:39] offset:3080
    v_mul_f32 v8, s43, v8
    v_rsq_f32 v9, v9
    ds_write_b64 v136, v[0:1] offset:3072
    v_mul_f32 v9, s43, v9
    v_mul_f32 v24, v24, v8
    v_mul_f32 v25, v25, v8
    v_cvt_pk_bf16_f32 v24, v24, v25
    v_mul_f32 v26, v26, v8
    v_mul_f32 v27, v27, v8
    v_cvt_pk_bf16_f32 v25, v26, v27
    v_mul_f32 v32, v32, v8
    v_mul_f32 v33, v33, v8
    v_cvt_pk_bf16_f32 v26, v32, v33
    v_mul_f32 v34, v34, v8
    v_mul_f32 v35, v35, v8
    v_cvt_pk_bf16_f32 v27, v34, v35
    v_mul_f32 v28, v28, v8
    v_mul_f32 v29, v29, v8
    v_cvt_pk_bf16_f32 v0, v28, v29
    v_mul_f32 v30, v30, v8
    v_mul_f32 v31, v31, v8
    v_cvt_pk_bf16_f32 v1, v30, v31
    ds_write_b64 v3, v[24:25] offset:0
    v_mul_f32 v12, v12, v9
    ds_write_b64 v3, v[26:27] offset:8
    v_mul_f32 v13, v13, v9
    v_cvt_pk_bf16_f32 v12, v12, v13
    v_mul_f32 v14, v14, v9
    ds_write_b64 v2, v[0:1] offset:0
    v_mul_f32 v15, v15, v9
    v_cvt_pk_bf16_f32 v13, v14, v15
    v_mul_f32 v20, v20, v9
    v_mul_f32 v21, v21, v9
    v_cvt_pk_bf16_f32 v14, v20, v21
    v_mul_f32 v22, v22, v9
    v_mul_f32 v23, v23, v9
    v_cvt_pk_bf16_f32 v15, v22, v23
    v_mul_f32 v16, v16, v9
    v_mul_f32 v17, v17, v9
    v_cvt_pk_bf16_f32 v0, v16, v17
    v_mul_f32 v18, v18, v9
    v_mul_f32 v19, v19, v9
    v_cvt_pk_bf16_f32 v1, v18, v19
    ds_write_b64 v3, v[12:13] offset:1536
    v_cmp_neq_f32 vcc, 0, v10
    ds_write_b64 v3, v[14:15] offset:1544
    ds_write_b64 v2, v[0:1] offset:1536
    s_waitcnt lgkmcnt(0)
    s_barrier
    ds_read_b128 v[32:35], v124 offset:0
    ds_read_b128 v[28:31], v124 offset:1024
    ds_read_b128 v[24:27], v124 offset:2048
    ds_read_b128 v[20:23], v124 offset:3072
    ds_read_b128 v[16:19], v124 offset:4096
    ds_read_b128 v[12:15], v7 offset:0
    ds_read_b128 v[8:11], v7 offset:1024
    ds_read_b128 v[0:3], v7 offset:2048
    s_waitcnt lgkmcnt(6)
    buffer_store_dwordx4 v[32:35], v130, s[28:31], s58 offen sc1
    buffer_store_dwordx4 v[28:31], v129, s[28:31], s58 offen sc1
    s_waitcnt lgkmcnt(3)
    buffer_store_dwordx4 v[24:27], v128, s[28:31], s58 offen sc1
    buffer_store_dwordx4 v[20:23], v127, s[28:31], s58 offen sc1
    buffer_store_dwordx4 v[16:19], v126, s[28:31], s58 offen sc1
    s_waitcnt lgkmcnt(0)
    buffer_store_dwordx4 v[12:15], v4, s[28:31], 0 offen sc1
    buffer_store_dwordx4 v[8:11], v5, s[28:31], 0 offen sc1
    buffer_store_dwordx4 v[0:3], v6, s[28:31], 0 offen sc1
    s_nop 4
    s_cbranch_vccnz L_slow
L_end:
    s_endpgm
L_slow:
    s_waitcnt vmcnt(0) lgkmcnt(0)
    s_nop 15
    s_barrier
    v_mbcnt_lo_u32_b32 v8, -1, 0
    v_mbcnt_hi_u32_b32 v8, -1, v8
    s_load_dwordx16 s[4:19], s[0:1], 0
    s_load_dwordx4 s[20:23], s[0:1], 64
    s_lshr_b32 s88, s2, 3
    s_lshl2_add_u32 s88, s88, s68
    v_lshlrev_b32 v9, 7, v8
    s_mul_i32 s89, s88, 576
    s_mul_i32 s88, s88, 1728
    v_min_u32 v20, 1664, v9
    v_min_u32 v10, 512, v9
    s_mov_b32 s34, 221184
    s_mov_b32 s35, 0x20000
    s_mov_b32 s78, 73728
    s_mov_b32 s79, 0x20000
    v_and_b32 v93, 15, v8
    v_lshrrev_b32 v142, 4, v8
    v_lshrrev_b32 v47, 2, v93
    v_and_b32 v9, 3, v93
    s_mul_i32 s87, s68, 192
    v_mad_u32_u24 v53, v93, 12, s87
    v_lshlrev_b32 v23, 1, v93
    v_lshlrev_b32 v11, 1, v47
    v_lshl_add_u32 v11, v142, 5, v11
    s_movk_i32 s86, 384
    s_mov_b32 s26, 100270464
    s_mov_b32 s27, 0x20000
    s_mov_b32 s30, 0
    s_mov_b32 s31, 0x20000
    s_mul_i32 s96, s68, 288
    s_and_b32 s97, s68, 1
    s_lshl_b32 s97, s97, 2
    s_mov_b32 s98, 193536
    s_waitcnt lgkmcnt(0)
    s_mov_b32 s32, s6
    s_mov_b32 s33, s7
    s_mov_b32 s76, s8
    s_mov_b32 s77, s9
    buffer_load_dword a254, v20, s[32:35], s88 offen
    buffer_load_dword a253, v10, s[76:79], s89 offen
    s_load_dwordx2 s[82:83], s[10:11], 0
    s_movk_i32 s18, 676
    s_mov_b32 s19, 0x20000
    s_mov_b32 s24, s4
    s_mov_b32 s25, s5
    buffer_load_dwordx3 v[20:22], v53, s[16:19], 0 offen
    s_mov_b32 s99, 589824
    v_add_u32 v92, s96, v8
    v_mul_u32_u24 v10, 2731, v92
    v_mul_u32_u24 v44, 6242, v92
    v_lshrrev_b32 v10, 16, v10
    s_mul_i32 s93, s2, 21
    s_mul_i32 s94, s93, 58255
    global_load_ushort v28, v23, s[12:13]
    v_lshrrev_b32 v44, 20, v44
    v_and_or_b32 v45, v10, 3, s97
    v_xor_b32 v45, v92, v45
    v_lshl_add_u32 v130, v45, 4, s99
    v_mad_u32_u24 v130, v44, s98, v130
    s_lshr_b32 s94, s94, 22
    s_mul_i32 s95, s94, 72
    global_load_ushort v29, v23, s[12:13] offset:32
    v_add_u32 v23, 64, v92
    v_mul_u32_u24 v46, 2731, v23
    v_mul_u32_u24 v131, 6242, v23
    v_lshrrev_b32 v46, 16, v46
    v_lshrrev_b32 v131, 20, v131
    s_sub_u32 s70, s93, s95
    s_mul_i32 s94, s94, 1180032
    global_load_ushort v42, v11, s[14:15] offset:0
    v_and_or_b32 v30, v46, 3, s97
    v_xor_b32 v30, v23, v30
    v_lshl_add_u32 v129, v30, 4, s99
    v_mad_u32_u24 v129, v131, s98, v129
    v_add_u32 v95, 128, v92
    s_mul_i32 s95, s93, 2688
    s_add_u32 s69, s94, s95
    global_load_ushort v31, v11, s[14:15] offset:8
    v_mul_u32_u24 v94, 2731, v95
    v_mul_u32_u24 v124, 6242, v95
    v_lshrrev_b32 v94, 16, v94
    v_lshrrev_b32 v124, 20, v124
    v_and_or_b32 v23, v94, 3, s97
    s_movk_i32 s62, 2688
    s_movk_i32 s71, 21
    global_load_ushort v43, v11, s[14:15] offset:16
    v_xor_b32 v23, v95, v23
    v_lshl_add_u32 v128, v23, 4, s99
    v_mad_u32_u24 v128, v124, s98, v128
    v_add_u32 v41, 192, v92
    v_mul_u32_u24 v52, 2731, v41
    s_mov_b32 s93, 1769472
    s_mul_i32 s54, s68, 5120
    global_load_ushort v95, v11, s[14:15] offset:24
    v_mul_u32_u24 v11, 6242, v41
    v_lshrrev_b32 v52, 16, v52
    v_lshrrev_b32 v11, 20, v11
    v_and_or_b32 v40, v52, 3, s97
    v_xor_b32 v40, v41, v40
    v_lshl_add_u32 v127, v40, 4, s99
    v_mad_u32_u24 v127, v11, s98, v127
    v_add_u32 v40, 256, v92
    v_mul_u32_u24 v125, 2731, v40
    v_mul_u32_u24 v92, 6242, v40
    v_lshrrev_b32 v125, 16, v125
    v_lshrrev_b32 v92, 20, v92
    v_and_or_b32 v126, v125, 3, s97
    v_xor_b32 v126, v40, v126
    v_lshl_add_u32 v126, v126, 4, s99
    v_mad_u32_u24 v126, v92, s98, v126
    s_cmp_ge_u32 s2, 246
    s_cbranch_scc1 L_bndS
L_bndrS:
    v_lshl_or_b32 v92, v8, 4, 2.0
    s_add_u32 m0, s54, 0
    v_cmp_gt_u32 vcc, 32, v8
    s_mov_b32 s63, 1180032
    s_sub_u32 s66, s71, 1
    buffer_load_dwordx4 v130, s[24:27], s69 offen nt lds
    s_add_u32 m0, s54, 1024
    v_cndmask_b32 v126, v92, v126, vcc
    s_add_u32 s93, s93, s69
    s_sub_u32 s94, 72, s70
    s_mul_i32 s95, s68, -44
    s_movk_i32 s99, -24
    v_and_b32 v44, -4, v10
    s_mul_i32 s85, s68, 96
    s_sub_u32 s100, s85, 1024
    buffer_load_dwordx4 v129, s[24:27], s69 offen nt lds
    s_add_u32 m0, s54, 2048
    v_mad_u32_u24 v131, v44, 3, v10
    v_add_u32 v131, s95, v131
    v_mad_i32_i24 v45, v10, s99, v45
    v_min_u32 v10, s66, v131
    v_lshl_add_u32 v45, v45, 4, s93
    v_mad_u32_u24 v45, v10, s62, v45
    s_sub_u32 s87, s85, 2048
    s_movk_i32 s91, 1152
    buffer_load_dwordx4 v128, s[24:27], s69 offen nt lds
    s_add_u32 m0, s54, 3072
    v_add_u32 v44, s63, v45
    v_cmp_le_u32 vcc, s94, v10
    v_and_b32 v11, -4, v46
    v_mad_u32_u24 v10, v11, 3, v46
    v_cndmask_b32 v45, v45, v44, vcc
    v_cmp_gt_u32 vcc, s71, v131
    s_mul_i32 s90, s68, 3072
    s_add_u32 s90, s90, 61440
    buffer_load_dwordx4 v127, s[24:27], s69 offen nt lds
    s_add_u32 m0, s54, 4096
    v_cndmask_b32 v44, v92, v45, vcc
    v_add_u32 v10, s95, v10
    v_mad_i32_i24 v131, v46, s99, v30
    v_min_u32 v30, s66, v10
    v_lshl_add_u32 v131, v131, 4, s93
    v_mad_u32_u24 v131, v30, s62, v131
    s_mov_b32 s92, 0
    s_mov_b32 s28, s22
    buffer_load_dwordx4 v126, s[24:27], s69 offen nt lds
    s_add_u32 m0, s54, 40960
    v_add_u32 v11, s63, v131
    v_cmp_le_u32 vcc, s94, v30
    v_and_b32 v46, -4, v94
    v_mad_u32_u24 v30, v46, 3, v94
    v_cndmask_b32 v131, v131, v11, vcc
    v_cmp_gt_u32 vcc, s71, v10
    s_mov_b32 s29, s23
    s_mov_b32 s41, 0x2a8cbccc
    buffer_load_dwordx4 v45, s[24:27], 0 offen nt lds
    s_add_u32 m0, s54, 41984
    v_cndmask_b32 v45, v92, v131, vcc
    v_add_u32 v30, s95, v30
    v_mad_i32_i24 v23, v94, s99, v23
    v_min_u32 v94, s66, v30
    v_lshl_add_u32 v23, v23, 4, s93
    v_mad_u32_u24 v23, v94, s62, v23
    s_mov_b32 s42, 0x38fba882
    s_mov_b32 s43, 0x415db3d7
    buffer_load_dwordx4 v131, s[24:27], 0 offen nt lds
    v_add_u32 v46, s63, v23
    v_cmp_le_u32 vcc, s94, v94
    s_add_u32 m0, s54, 43008
    v_mul_u32_u24 v131, 10923, v8
    v_cndmask_b32 v23, v23, v46, vcc
    v_cmp_gt_u32 vcc, s71, v30
    v_lshrrev_b32 v52, 17, v131
    s_mov_b32 s39, 0x00010001
    s_mul_i32 s93, s68, 6
    buffer_load_dwordx4 v23, s[24:27], 0 offen nt lds
    v_cndmask_b32 v46, v92, v23, vcc
    v_lshrrev_b32 v131, 16, v131
    v_mad_i32_i24 v11, v131, -6, v8
    v_bitop3_b32 v52, v52, v131, 4 bitop3:0x28
    v_lshl_add_u32 v11, v11, 4, s85
    v_mul_u32_u24 v52, 3, v52
    v_xor_b32 v131, v131, v52
    v_mad_u32_u24 v52, v131, s91, v11
    v_add_u32 v10, 64, v8
    v_mul_u32_u24 v94, 10923, v10
    v_lshrrev_b32 v41, 17, v94
    v_lshrrev_b32 v94, 16, v94
    v_mad_i32_i24 v10, v94, -6, v10
    v_bitop3_b32 v41, v41, v94, 4 bitop3:0x28
    v_lshl_add_u32 v10, v10, 4, s100
    v_mul_u32_u24 v41, 3, v41
    v_xor_b32 v94, v94, v41
    v_mad_u32_u24 v41, v94, s91, v10
    v_add_u32 v30, 128, v8
    v_mul_u32_u24 v23, 10923, v30
    v_lshrrev_b32 v40, 17, v23
    v_lshrrev_b32 v23, 16, v23
    v_mad_i32_i24 v30, v23, -6, v30
    v_bitop3_b32 v40, v40, v23, 4 bitop3:0x28
    v_lshl_add_u32 v30, v30, 4, s87
    v_mul_u32_u24 v40, 3, v40
    v_xor_b32 v23, v23, v40
    v_mad_u32_u24 v40, v23, s91, v30
    v_mad_u32_u24 v37, v131, s86, v11
    v_mad_u32_u24 v36, v94, s86, v10
    v_mad_u32_u24 v5, v23, s86, v30
    s_add_u32 m0, s90, 0
    v_mov_b32 v23, 0x3f803f80
    s_lshl_b32 s94, s97, 1
    s_mov_b32 s44, 61440
    buffer_load_dwordx4 v52, s[32:35], s92 offen offset:0 lds
    v_cmp_eq_u32 vcc, 0, v9
    v_and_b32 v30, 1, v8
    v_lshlrev_b32 v30, 4, v30
    v_cndmask_b32 v220, 0, v23, vcc
    v_cndmask_b32 v221, 0, v23, vcc
    v_cndmask_b32 v222, 0, v23, vcc
    v_cndmask_b32 v223, 0, v23, vcc
    v_mov_b32 v23, 0x3f80
    v_lshlrev_b32 v23, v30, v23
    v_cmp_gt_u32 vcc, 2, v9
    v_mov_b32 v171, 0
    v_mov_b32 v167, 0
    v_cndmask_b32 v216, 0, v23, vcc
    v_cndmask_b32 v218, 0, v23, vcc
    v_cmp_le_u32 vcc, 2, v9
    v_mov_b32 v163, 0
    v_mov_b32 v159, 0
    v_cndmask_b32 v217, 0, v23, vcc
    v_cndmask_b32 v219, 0, v23, vcc
    v_cmp_eq_u32 vcc, v142, v47
    v_mov_b32 v152, 0
    v_mov_b32 v153, 0
    v_cndmask_b32 v38, 0, v216, vcc
    v_cndmask_b32 v39, 0, v217, vcc
    v_mov_b32 v148, 0
    v_mov_b32 v149, 0
    v_mov_b32 v144, 0
    v_mov_b32 v145, 0
    v_mov_b32 v140, 0
    v_mov_b32 v141, 0
    v_lshrrev_b32 v30, 1, v142
    v_lshl_add_u32 v23, v142, 2, v47
    v_lshl_add_u32 v23, v30, 3, v23
    v_mul_u32_u24 v23, 96, v23
    v_add_u32 v23, s90, v23
    v_lshl_add_u32 v55, v9, 4, v23
    v_lshl_add_u32 v54, v9, 3, v23
    s_waitcnt lgkmcnt(0)
    s_lshl_b32 s84, s68, 4
    s_lshr_b64 s[82:83], s[82:83], s84
    s_lshl_b32 s82, s82, 16
    v_mov_b32 v94, s82
    v_min_f32 v94, 0x40930000, v94
    v_max_f32 v94, 0xc2c80000, v94
    v_mul_f32 v94, 0x3fb8aa3b, v94
    v_exp_f32 v94, v94
    v_mov_b32 v30, 0
    v_cvt_pk_bf16_f32 v94, v94, v94
    v_lshlrev_b32 v94, 16, v94
    v_mul_f32 v94, 0x4038aa3b, v94
    v_mov_b32 v23, 0
    v_readfirstlane_b32 s55, v94
    v_add_f32 v94, v94, v94
    v_mul_u32_u24 v133, 5120, v142
    v_readfirstlane_b32 s52, v94
    v_add_u32 v133, v53, v133
    s_mov_b32 s84, 0x41b8aa3b
    v_mov_b32 v143, 0xc138aa3b
    v_mul_u32_u24 v53, 5120, v47
    v_mad_u32_u24 v53, v9, s86, v53
    v_and_b32 v10, 7, v93
    v_xor_b32 v94, v10, v142
    v_lshl_add_u32 v2, v94, 4, v53
    v_xor_b32 v11, 64, v2
    v_add_u32 v139, 40960, v2
    v_xor_b32 v138, 64, v139
    v_add_u32 v53, 61440, v53
    v_add_u32 v94, s93, v142
    v_xor_b32 v94, v10, v94
    v_lshl_add_u32 v137, v94, 4, v53
    v_lshrrev_b32 v94, 1, v142
    v_add3_u32 v94, v94, s93, 4
    v_xor_b32 v94, v10, v94
    v_lshl_add_u32 v94, v94, 4, v53
    v_and_b32 v53, 1, v142
    v_lshl_add_u32 v136, v53, 3, v94
    s_add_u32 s93, s54, 20480
    s_mov_b32 s45, 40960
    buffer_load_dwordx4 v41, s[32:35], s92 offen offset:1024 lds
    v_lshlrev_b32 v10, 4, v8
    v_add_u32 v135, s93, v10
    v_add_u32 v131, 81920, v10
    s_lshr_b32 s93, s68, 1
    s_lshl_b32 s93, s93, 10
    s_add_u32 s93, s93, s94
    v_add_u32 v132, s93, v131
    s_mul_i32 s93, s68, 7056
    s_add_u32 s93, s93, 135280
    buffer_load_dwordx4 v40, s[32:35], s92 offen offset:2048 lds
    s_add_u32 m0, s90, 12288
    s_mov_b32 s92, 36864
    v_mul_u32_u24 v53, 80, v142
    v_add_u32 v94, s93, v53
    v_mul_u32_u24 v53, 336, v93
    v_add_u32 v10, v53, v94
    v_cmp_eq_u32 vcc, 0, v47
    s_mov_b32 s46, 20480
    s_mov_b32 s47, 0
    buffer_load_dwordx4 v52, s[32:35], s92 offen offset:0 lds
    ds_write_b128 v10, v[216:219] offset:416
    s_waitcnt vmcnt(16)
    v_lshl_or_b32 v28, v29, 16, v28
    v_mov_b32 v29, 0
    s_waitcnt vmcnt(14)
    v_lshl_or_b32 v42, v31, 16, v42
    v_cndmask_b32 v134, v92, v94, vcc
    v_cmp_gt_u32 vcc, 16, v8
    v_mul_u32_u24 v53, 80, v47
    v_lshl_add_u32 v53, v142, 3, v53
    v_cndmask_b32 v31, 0, v28, vcc
    v_cndmask_b32 v28, 0, v28, vcc
    v_cmp_eq_u32 vcc, 3, v9
    v_mfma_f32_16x16x16_bf16 v[12:15], v[30:31], v[20:21], 0
    s_waitcnt vmcnt(12)
    s_mov_b32 s57, s69
    buffer_load_dwordx4 v41, s[32:35], s92 offen offset:1024 lds
    v_lshl_or_b32 v43, v95, 16, v43
    v_mfma_f32_16x16x16_bf16 v[16:19], v[28:29], v[20:21], 0
    s_mov_b32 s58, 0
    v_cndmask_b32 v134, v134, v94, vcc
    v_cmp_gt_u32 vcc, 5, v93
    v_mfma_f32_16x16x16_bf16 v[24:27], v[28:29], v[22:23], 0
    s_mov_b32 s59, 0
    v_max_f32 v12, 0, v12
    v_max_f32 v13, 0, v13
    v_max_f32 v14, 0, v14
    v_max_f32 v16, 0, v16
    v_max_f32 v17, 0, v17
    v_max_f32 v18, 0, v18
    v_max_f32 v19, 0, v19
    v_cvt_pk_bf16_f32 v16, v16, v17
    v_cvt_pk_bf16_f32 v17, v18, v19
    v_max_f32 v15, 0, v15
    v_cvt_pk_bf16_f32 v12, v12, v13
    v_mfma_f32_16x16x16_bf16 v[20:23], v[42:43], v[16:17], 0
    s_mov_b32 s60, 0
    v_cvt_pk_bf16_f32 v13, v14, v15
    v_max_f32 v24, 0, v24
    v_max_f32 v25, 0, v25
    v_mfma_f32_16x16x16_bf16 v[16:19], v[42:43], v[12:13], 0
    s_sub_u32 s64, s71, 1
    v_max_f32 v26, 0, v26
    v_max_f32 v27, 0, v27
    v_cvt_pk_bf16_f32 v24, v24, v25
    v_cvt_pk_bf16_f32 v25, v26, v27
    v_cvt_pk_bf16_f32 v20, v20, v20
    v_lshlrev_b32 v20, 16, v20
    v_mfma_f32_16x16x16_bf16 v[12:15], v[42:43], v[24:25], 0
    s_mov_b32 s65, -1
    v_mul_f32 v20, 0xbfb8aa3b, v20
    v_cvt_pk_bf16_f32 v16, v16, v16
    v_exp_f32 v20, v20
    v_lshlrev_b32 v16, 16, v16
    v_add_f32 v20, 1.0, v20
    v_rcp_f32 v20, v20
    v_mul_f32 v16, 0xbfb8aa3b, v16
    v_cvt_pk_bf16_f32 v20, v20, v20
    v_lshlrev_b32 v20, 16, v20
    v_fma_f32 v20, v20, s84, v143
    s_add_u32 s56, s69, s62
    s_add_u32 s61, s70, 1
    ds_write_b32 v133, v20 offset:44032
    v_exp_f32 v16, v16
    v_cvt_pk_bf16_f32 v12, v12, v12
    v_add_f32 v16, 1.0, v16
    v_rcp_f32 v16, v16
    v_lshlrev_b32 v12, 16, v12
    v_cvt_pk_bf16_f32 v16, v16, v16
    v_lshlrev_b32 v16, 16, v16
    v_fma_f32 v16, v16, s84, v143
    s_add_u32 s101, s54, 44032
    s_and_b32 s94, s68, 1
    ds_write_b32 v133, v16 offset:44036
    v_mul_f32 v12, 0xbfb8aa3b, v12
    v_exp_f32 v12, v12
    v_cndmask_b32 v4, v92, v10, vcc
    v_add_f32 v12, 1.0, v12
    v_rcp_f32 v12, v12
    v_lshl_add_u32 v53, v9, 1, v53
    v_cvt_pk_bf16_f32 v12, v12, v12
    v_lshlrev_b32 v12, 16, v12
    v_fma_f32 v12, v12, s84, v143
    s_mul_i32 s94, s94, -2304
    ds_write_b32 v133, v12 offset:44040
    v_add_u32 v53, s93, v53
    v_cmp_gt_u32 vcc, 3, v142
    v_mov_b32 v125, v53
    s_cmp_eq_u32 s61, 72
    v_cndmask_b32 v133, v92, v53, vcc
    s_cselect_b32 s93, s63, 0
    s_cselect_b32 s61, 0, s61
    s_add_u32 s56, s56, s93
    ds_write_b128 v4, v[216:219] offset:5792
    v_mul_u32_u24 v147, 48, v47
    v_lshl_add_u32 v147, v9, 2, v147
    v_mul_u32_u24 v47, 48, v142
    v_add_u32 v150, 0, v147
    v_mul_u32_u24 v9, 37, v150
    v_lshrrev_b32 v9, 10, v9
    v_mad_u32_u24 v150, v9, 24, v150
    v_add_u32 v150, s101, v150
    v_add_u32 v143, 16, v147
    v_mul_u32_u24 v9, 37, v143
    v_lshrrev_b32 v9, 10, v9
    v_mad_u32_u24 v143, v9, 24, v143
    v_add_u32 v143, s101, v143
    v_add_u32 v9, 32, v147
    v_mul_u32_u24 v53, 37, v9
    v_lshrrev_b32 v53, 10, v53
    v_mad_u32_u24 v9, v53, 24, v9
    v_add_u32 v9, s101, v9
    v_add_u32 v155, 0, v47
    v_mul_u32_u24 v53, 37, v155
    s_waitcnt lgkmcnt(1)
    s_barrier
    v_lshrrev_b32 v53, 10, v53
    v_mad_u32_u24 v155, v53, 24, v155
    v_add_u32 v154, 4, v47
    v_mul_u32_u24 v53, 37, v154
    v_lshrrev_b32 v53, 10, v53
    v_mad_u32_u24 v154, v53, 24, v154
    v_add_u32 v95, 8, v47
    v_mul_u32_u24 v53, 37, v95
    v_lshrrev_b32 v53, 10, v53
    v_mad_u32_u24 v95, v53, 24, v95
    v_add_u32 v43, 12, v47
    v_mul_u32_u24 v42, 37, v43
    v_lshrrev_b32 v42, 10, v42
    v_mad_u32_u24 v43, v42, 24, v43
    v_add_u32 v94, 16, v47
    v_mul_u32_u24 v42, 37, v94
    v_lshrrev_b32 v42, 10, v42
    v_mad_u32_u24 v94, v42, 24, v94
    v_add_u32 v42, 20, v47
    v_mul_u32_u24 v53, 37, v42
    v_lshrrev_b32 v53, 10, v53
    v_mad_u32_u24 v42, v53, 24, v42
    v_add_u32 v6, 24, v47
    v_mul_u32_u24 v7, 37, v6
    v_lshrrev_b32 v7, 10, v7
    v_mad_u32_u24 v6, v7, 24, v6
    v_add_u32 v7, 28, v47
    v_mul_u32_u24 v53, 37, v7
    v_lshrrev_b32 v53, 10, v53
    v_mad_u32_u24 v7, v53, 24, v7
    v_add_u32 v151, 32, v47
    v_mul_u32_u24 v53, 37, v151
    v_lshrrev_b32 v53, 10, v53
    v_mad_u32_u24 v151, v53, 24, v151
    v_add_u32 v53, 36, v47
    v_mul_u32_u24 v124, 37, v53
    v_lshrrev_b32 v124, 10, v124
    v_mad_u32_u24 v53, v124, 24, v53
    v_add_u32 v124, 40, v47
    v_mul_u32_u24 v146, 37, v124
    v_lshrrev_b32 v146, 10, v146
    v_mad_u32_u24 v124, v146, 24, v124
    v_add_u32 v47, 44, v47
    v_mul_u32_u24 v146, 37, v47
    v_lshrrev_b32 v146, 10, v146
    v_mad_u32_u24 v47, v146, 24, v47
    v_lshl_add_u32 v146, v142, 4, v147
    v_mul_u32_u24 v0, 37, v146
    v_lshrrev_b32 v0, 10, v0
    v_mad_u32_u24 v146, v0, 24, v146
    v_mov_b32 v0, 336
    v_cmp_gt_u32 vcc, 3, v142
    v_sub_u32 v204, v150, v155
    s_lshr_b32 s93, s68, 1
    v_cndmask_b32 v146, v0, v146, vcc
    v_sub_u32 v146, s101, v146
    s_mul_i32 s93, s93, 30720
    s_add_u32 s93, s93, s94
    ds_read_b32 v204, v204 offset:336
    buffer_load_dwordx4 v40, s[32:35], s92 offen offset:2048 lds
    s_add_u32 m0, s90, 24576
    s_mov_b32 s92, 73728
    v_sub_u32 v205, v150, v154
    v_sub_u32 v206, v150, v95
    s_lshl_b32 s94, s97, 4
    ds_read_b32 v205, v205 offset:336
    v_sub_u32 v207, v150, v43
    v_sub_u32 v200, v150, v94
    v_sub_u32 v201, v150, v42
    v_sub_u32 v202, v150, v6
    v_sub_u32 v203, v150, v7
    ds_read_b32 v206, v206 offset:336
    v_sub_u32 v196, v150, v151
    v_sub_u32 v197, v150, v53
    v_sub_u32 v198, v150, v124
    v_sub_u32 v199, v150, v47
    v_sub_u32 v192, v143, v155
    ds_read_b32 v207, v207 offset:336
    buffer_load_dwordx4 v52, s[32:35], s92 offen offset:0 lds
    v_sub_u32 v193, v143, v154
    v_sub_u32 v194, v143, v95
    v_sub_u32 v195, v143, v43
    v_sub_u32 v188, v143, v94
    ds_read_b32 v200, v200 offset:336
    v_sub_u32 v189, v143, v42
    v_sub_u32 v190, v143, v6
    v_sub_u32 v191, v143, v7
    v_sub_u32 v184, v143, v151
    buffer_load_dwordx4 v41, s[32:35], s92 offen offset:1024 lds
    ds_read_b32 v201, v201 offset:336
    v_sub_u32 v185, v143, v53
    v_sub_u32 v186, v143, v124
    v_sub_u32 v187, v143, v47
    v_sub_u32 v180, v9, v155
    v_sub_u32 v181, v9, v154
    ds_read_b32 v202, v202 offset:336
    v_sub_u32 v182, v9, v95
    v_sub_u32 v183, v9, v43
    v_sub_u32 v176, v9, v94
    v_sub_u32 v177, v9, v42
    v_sub_u32 v178, v9, v6
    ds_read_b32 v203, v203 offset:336
    v_sub_u32 v179, v9, v7
    v_sub_u32 v172, v9, v151
    v_sub_u32 v173, v9, v53
    v_sub_u32 v174, v9, v124
    buffer_load_dwordx4 v40, s[32:35], s92 offen offset:2048 lds
    s_add_u32 m0, s90, 36864
    s_mov_b32 s92, 110592
    ds_read_b32 v196, v196 offset:336
    v_sub_u32 v175, v9, v47
    v_mov_b32 v53, 0xf149f2ca
    v_mov_b32 v94, 0x3f80
    v_mov_b32 v95, 0
    v_mov_b32 v42, 0x3f80
    s_waitcnt vmcnt(9)
    s_barrier
    ds_read_b32 v197, v197 offset:336
    v_mov_b32 v43, 0
    v_and_b32 v47, 8, v93
    v_add_u32 v47, v47, v93
    v_mul_u32_u24 v47, 96, v47
    v_add_u32 v47, s90, v47
    ds_read_b32 v198, v198 offset:336
    v_lshl_add_u32 v78, v142, 4, v47
    v_lshl_add_u32 v124, v142, 3, v47
    v_add_u32 v7, s93, v78
    v_add_u32 v6, s93, v124
    v_lshlrev_b32 v47, 4, v142
    s_lshr_b32 s93, s68, 1
    s_mul_i32 s93, s93, 5120
    ds_read_b32 v199, v199 offset:336
    v_add_u32 v47, 4608, v47
    s_add_u32 s93, s93, s94
    buffer_load_dwordx4 v52, s[32:35], s92 offen offset:0 lds
    v_add_u32 v14, s93, v47
    ds_read_b32 v208, v150
    v_cmp_eq_u32 vcc, 0, v93
    s_nop 1
    v_cndmask_b32 v14, v92, v14, vcc
    ds_read_b32 v211, v146 offset:672
    ds_read_b32 v192, v192 offset:336
    buffer_load_dwordx4 v41, s[32:35], s92 offen offset:1024 lds
    ds_read_b32 v193, v193 offset:336
    ds_read_b32 v194, v194 offset:336
    ds_read_b32 v195, v195 offset:336
    buffer_load_dwordx4 v40, s[32:35], s92 offen offset:2048 lds
    s_add_u32 m0, s90, 49152
    s_mov_b32 s92, 147456
    ds_read_b32 v188, v188 offset:336
    ds_read_b32 v189, v189 offset:336
    ds_read_b32 v190, v190 offset:336
    buffer_load_dwordx4 v52, s[32:35], s92 offen offset:0 lds
    ds_read_b32 v191, v191 offset:336
    ds_read_b32 v184, v184 offset:336
    ds_read_b32 v185, v185 offset:336
    ds_read_b32 v186, v186 offset:336
    buffer_load_dwordx4 v41, s[32:35], s92 offen offset:1024 lds
    ds_read_b32 v187, v187 offset:336
    ds_read_b32 v209, v143
    ds_read_b32 v180, v180 offset:336
    buffer_load_dwordx4 v40, s[32:35], s92 offen offset:2048 lds
    s_add_u32 m0, s90, 61440
    s_mov_b32 s92, 184320
    ds_read_b32 v181, v181 offset:336
    ds_read_b32 v182, v182 offset:336
    ds_read_b32 v183, v183 offset:336
    buffer_load_dwordx4 v52, s[32:35], s92 offen offset:0 lds
    ds_read_b32 v176, v176 offset:336
    ds_read_b32 v177, v177 offset:336
    ds_read_b32 v178, v178 offset:336
    ds_read_b32 v179, v179 offset:336
    buffer_load_dwordx4 v41, s[32:35], s92 offen offset:1024 lds
    ds_read_b32 v172, v172 offset:336
    ds_read_b32 v173, v173 offset:336
    ds_read_b32 v174, v174 offset:336
    buffer_load_dwordx4 v40, s[32:35], s92 offen offset:2048 lds
    ds_read_b32 v175, v175 offset:336
    ds_read_b32 v210, v9
    s_waitcnt vmcnt(15)
    ds_read_b64_tr_b16 a[0:1], v54 offset:0
    ds_read_b64_tr_b16 a[2:3], v54 offset:768
    ds_read_b64_tr_b16 a[24:25], v54 offset:32
    ds_read_b64_tr_b16 a[26:27], v54 offset:800
    ds_read_b64_tr_b16 a[48:49], v54 offset:64
    ds_read_b64_tr_b16 a[50:51], v54 offset:832
    s_add_u32 m0, s90, 0
    s_mov_b32 s92, 384
    s_waitcnt vmcnt(12)
    ds_read_b64_tr_b16 a[4:5], v54 offset:12288
    ds_read_b64_tr_b16 a[6:7], v54 offset:13056
    ds_read_b64_tr_b16 a[28:29], v54 offset:12320
    ds_read_b64_tr_b16 a[30:31], v54 offset:13088
    ds_read_b64_tr_b16 a[52:53], v54 offset:12352
    ds_read_b64_tr_b16 a[54:55], v54 offset:13120
    s_waitcnt vmcnt(9)
    ds_read_b64_tr_b16 a[8:9], v54 offset:24576
    ds_read_b64_tr_b16 a[10:11], v54 offset:25344
    ds_read_b64_tr_b16 a[32:33], v54 offset:24608
    s_waitcnt lgkmcnt(15)
    s_cmp_ge_u32 s2, 247
    s_cbranch_scc1 L_maskS
L_nomaskS:
    v_cmp_gt_u32 vcc, 16, v8
    v_readlane_b32 s84, v211, 48
    ds_read_b64_tr_b16 a[34:35], v54 offset:25376
    v_cndmask_b32 v208, v53, v208, vcc
    v_cndmask_b32 v209, v53, v209, vcc
    v_cndmask_b32 v210, v53, v210, vcc
    v_cmp_gt_u32 vcc, 49, v8
    ds_read_b64_tr_b16 a[56:57], v54 offset:24640
    s_waitcnt lgkmcnt(10)
    buffer_load_dwordx4 v52, s[32:35], s92 offen offset:0 lds
    ds_read_b64_tr_b16 a[58:59], v54 offset:25408
    v_cndmask_b32 v211, v53, v211, vcc
    s_waitcnt vmcnt(7)
    ds_read_b64_tr_b16 a[12:13], v54 offset:36864
    ds_read_b64_tr_b16 a[14:15], v54 offset:37632
    buffer_load_dwordx4 v41, s[32:35], s92 offen offset:1024 lds
    ds_read_b64_tr_b16 a[36:37], v54 offset:36896
    ds_read_b64_tr_b16 a[38:39], v54 offset:37664
    ds_read_b64_tr_b16 a[60:61], v54 offset:36928
    ds_read_b64_tr_b16 a[62:63], v54 offset:37696
    buffer_load_dwordx4 v40, s[32:35], s92 offen offset:2048 lds
    s_add_u32 m0, s90, 12288
    s_mov_b32 s92, 37248
    ds_read_b128 v[80:83], v2 offset:40960
    ds_read_b128 v[72:75], v11 offset:40960
    s_waitcnt lgkmcnt(10)
    buffer_load_dwordx4 v52, s[32:35], s92 offen offset:0 lds
    ds_read_b128 v[68:71], v2 offset:41088
    ds_read_b128 v[60:63], v11 offset:41088
    ds_read_b128 v[56:59], v2 offset:41216
    ds_read_b128 v[32:35], v11 offset:41216
    buffer_load_dwordx4 v41, s[32:35], s92 offen offset:1024 lds
    buffer_load_dwordx4 v40, s[32:35], s92 offen offset:2048 lds
    s_add_u32 m0, s90, 24576
    s_mov_b32 s92, 74112
    s_waitcnt vmcnt(9)
    ds_read_b64_tr_b16 a[16:17], v54 offset:49152
    ds_read_b64_tr_b16 a[18:19], v54 offset:49920
    ds_read_b64_tr_b16 a[40:41], v54 offset:49184
    ds_read_b64_tr_b16 a[42:43], v54 offset:49952
    ds_read_b64_tr_b16 a[64:65], v54 offset:49216
    ds_read_b64_tr_b16 a[66:67], v54 offset:49984
    s_waitcnt lgkmcnt(6)
    buffer_load_dwordx4 v52, s[32:35], s92 offen offset:0 lds
    buffer_load_dwordx4 v41, s[32:35], s92 offen offset:1024 lds
    buffer_load_dwordx4 v40, s[32:35], s92 offen offset:2048 lds
    s_add_u32 m0, s90, 36864
    s_mov_b32 s92, 110976
    s_waitcnt vmcnt(9)
    ds_read_b64_tr_b16 a[20:21], v54 offset:61440
    ds_read_b64_tr_b16 a[22:23], v54 offset:62208
    v_mfma_f32_16x16x32_bf16 v[104:107], a[0:3], v[80:83], 0
    ds_read_b64_tr_b16 a[44:45], v54 offset:61472
    v_mfma_f32_16x16x32_bf16 v[104:107], a[4:7], v[72:75], v[104:107]
    ds_read_b64_tr_b16 a[46:47], v54 offset:62240
    v_mfma_f32_16x16x32_bf16 v[104:107], a[8:11], v[68:71], v[104:107]
    ds_read_b64_tr_b16 a[68:69], v54 offset:61504
    v_mfma_f32_16x16x32_bf16 v[104:107], a[12:15], v[60:63], v[104:107]
    s_waitcnt lgkmcnt(5)
    ds_read_b64_tr_b16 a[70:71], v54 offset:62272
    v_mfma_f32_16x16x32_bf16 v[104:107], a[16:19], v[56:59], v[104:107]
    ds_read_b128 v[24:27], v2 offset:42496
    ds_read_b128 v[64:67], v11 offset:42496
    ds_read_b128 v[48:51], v2 offset:42624
    ds_read_b128 v[28:31], v11 offset:42624
    s_waitcnt lgkmcnt(7)
    v_mfma_f32_16x16x32_bf16 v[104:107], a[20:23], v[32:35], v[104:107]
    ds_read_b128 v[20:23], v2 offset:42752
    s_nop 0
    v_mfma_f32_16x16x32_bf16 v[112:115], a[24:27], v[80:83], 0
    s_nop 0
    ds_read_b128 v[16:19], v11 offset:42752
    s_nop 0
    v_mfma_f32_16x16x32_bf16 v[112:115], a[28:31], v[72:75], v[112:115]
    s_nop 0
    v_fma_f32 v9, v104, v104, s41
    v_fmac_f32 v9, v105, v105
    v_mfma_f32_16x16x32_bf16 v[112:115], a[32:35], v[68:71], v[112:115]
    v_fmac_f32 v9, v106, v106
    v_fmac_f32 v9, v107, v107
    v_mfma_f32_16x16x32_bf16 v[112:115], a[36:39], v[60:63], v[112:115]
    buffer_load_dwordx4 v52, s[32:35], s92 offen offset:0 lds
    v_mfma_f32_16x16x32_bf16 v[112:115], a[40:43], v[56:59], v[112:115]
    s_waitcnt lgkmcnt(4)
    v_mfma_f32_16x16x32_bf16 v[112:115], a[44:47], v[32:35], v[112:115]
    s_nop 1
    v_mfma_f32_16x16x32_bf16 v[108:111], a[48:51], v[80:83], 0
    s_nop 2
    v_mfma_f32_16x16x32_bf16 v[108:111], a[52:55], v[72:75], v[108:111]
    s_nop 0
    v_fmac_f32 v9, v112, v112
    v_fmac_f32 v9, v113, v113
    v_mfma_f32_16x16x32_bf16 v[108:111], a[56:59], v[68:71], v[108:111]
    buffer_load_dwordx4 v41, s[32:35], s92 offen offset:1024 lds
    v_fmac_f32 v9, v114, v114
    v_mfma_f32_16x16x32_bf16 v[108:111], a[60:63], v[60:63], v[108:111]
    v_fmac_f32 v9, v115, v115
    v_mfma_f32_16x16x32_bf16 v[108:111], a[64:67], v[56:59], v[108:111]
    v_mfma_f32_16x16x32_bf16 v[108:111], a[68:71], v[32:35], v[108:111]
    v_mfma_f32_16x16x32_bf16 v[60:63], a[0:3], v[24:27], 0
    s_nop 1
    buffer_load_dwordx4 v40, s[32:35], s92 offen offset:2048 lds
    v_mfma_f32_16x16x32_bf16 v[60:63], a[4:7], v[64:67], v[60:63]
    s_waitcnt vmcnt(9) lgkmcnt(0)
    s_add_u32 m0, s90, 49152
    ds_read_b64_tr_b16 a[72:73], v54 offset:0
    v_fmac_f32 v9, v108, v108
    v_mfma_f32_16x16x32_bf16 v[60:63], a[8:11], v[48:51], v[60:63]
    s_mov_b32 s92, 147840
    ds_read_b64_tr_b16 a[74:75], v54 offset:768
    v_fmac_f32 v9, v109, v109
    v_mfma_f32_16x16x32_bf16 v[60:63], a[12:15], v[28:31], v[60:63]
    ds_read_b64_tr_b16 a[96:97], v54 offset:32
    v_fmac_f32 v9, v110, v110
    v_mfma_f32_16x16x32_bf16 v[60:63], a[16:19], v[20:23], v[60:63]
    ds_read_b64_tr_b16 a[98:99], v54 offset:800
    v_fmac_f32 v9, v111, v111
    v_mfma_f32_16x16x32_bf16 v[60:63], a[20:23], v[16:19], v[60:63]
    ds_read_b64_tr_b16 a[120:121], v54 offset:64
    buffer_load_dwordx4 v52, s[32:35], s92 offen offset:0 lds
    v_mfma_f32_16x16x32_bf16 v[84:87], a[24:27], v[24:27], 0
    ds_read_b64_tr_b16 a[122:123], v54 offset:832
    s_nop 0
    v_mfma_f32_16x16x32_bf16 v[84:87], a[28:31], v[64:67], v[84:87]
    s_nop 0
    ds_read_b128 v[120:123], v2 offset:40960
    v_fma_f32 v8, v60, v60, s41
    v_mfma_f32_16x16x32_bf16 v[84:87], a[32:35], v[48:51], v[84:87]
    ds_read_b128 v[72:75], v11 offset:40960
    v_fmac_f32 v8, v61, v61
    v_mfma_f32_16x16x32_bf16 v[84:87], a[36:39], v[28:31], v[84:87]
    ds_read_b128 v[68:71], v2 offset:41088
    v_fmac_f32 v8, v62, v62
    v_mfma_f32_16x16x32_bf16 v[84:87], a[40:43], v[20:23], v[84:87]
    ds_read_b128 v[56:59], v11 offset:41088
    buffer_load_dwordx4 v41, s[32:35], s92 offen offset:1024 lds
    v_mfma_f32_16x16x32_bf16 v[84:87], a[44:47], v[16:19], v[84:87]
    ds_read_b128 v[32:35], v2 offset:41216
    v_fmac_f32 v8, v63, v63
    v_mfma_f32_16x16x32_bf16 v[80:83], a[48:51], v[24:27], 0
    s_nop 0
    ds_read_b128 v[24:27], v11 offset:41216
    s_nop 0
    v_mfma_f32_16x16x32_bf16 v[80:83], a[52:55], v[64:67], v[80:83]
    s_nop 0
    v_fmac_f32 v8, v84, v84
    v_fmac_f32 v8, v85, v85
    v_mfma_f32_16x16x32_bf16 v[80:83], a[56:59], v[48:51], v[80:83]
    v_fmac_f32 v8, v86, v86
    v_fmac_f32 v8, v87, v87
    v_mfma_f32_16x16x32_bf16 v[80:83], a[60:63], v[28:31], v[80:83]
    buffer_load_dwordx4 v40, s[32:35], s92 offen offset:2048 lds
    v_mfma_f32_16x16x32_bf16 v[80:83], a[64:67], v[20:23], v[80:83]
    s_waitcnt vmcnt(9)
    s_add_u32 m0, s90, 61440
    ds_read_b64_tr_b16 a[76:77], v54 offset:12288
    v_mfma_f32_16x16x32_bf16 v[80:83], a[68:71], v[16:19], v[80:83]
    s_mov_b32 s92, 184704
    ds_read_b64_tr_b16 a[78:79], v54 offset:13056
    s_nop 0
    ds_read_b64_tr_b16 a[100:101], v54 offset:12320
    s_nop 0
    ds_read_b64_tr_b16 a[102:103], v54 offset:13088
    s_nop 0
    ds_read_b64_tr_b16 a[124:125], v54 offset:12352
    v_fmac_f32 v8, v80, v80
    ds_read_b64_tr_b16 a[126:127], v54 offset:13120
    v_fmac_f32 v8, v81, v81
    v_fmac_f32 v8, v82, v82
    buffer_load_dwordx4 v52, s[32:35], s92 offen offset:0 lds
    v_fmac_f32 v8, v83, v83
    buffer_load_dwordx4 v41, s[32:35], s92 offen offset:1024 lds
    buffer_load_dwordx4 v40, s[32:35], s92 offen offset:2048 lds
    s_add_u32 m0, s90, 0
    s_mov_b32 s92, 768
    s_waitcnt vmcnt(9)
    ds_read_b64_tr_b16 a[80:81], v54 offset:24576
    ds_read_b64_tr_b16 a[82:83], v54 offset:25344
    ds_read_b64_tr_b16 a[104:105], v54 offset:24608
    ds_read_b64_tr_b16 a[106:107], v54 offset:25376
    ds_read_b64_tr_b16 a[128:129], v54 offset:24640
    ds_read_b64_tr_b16 a[130:131], v54 offset:25408
    s_waitcnt lgkmcnt(6)
    buffer_load_dwordx4 v52, s[32:35], s92 offen offset:0 lds
    buffer_load_dwordx4 v41, s[32:35], s92 offen offset:1024 lds
    buffer_load_dwordx4 v40, s[32:35], s92 offen offset:2048 lds
    s_add_u32 m0, s90, 12288
    s_mov_b32 s92, 37632
    s_waitcnt vmcnt(9)
    ds_read_b64_tr_b16 a[84:85], v54 offset:36864
    ds_read_b64_tr_b16 a[86:87], v54 offset:37632
    ds_read_b64_tr_b16 a[108:109], v54 offset:36896
    ds_read_b64_tr_b16 a[110:111], v54 offset:37664
    ds_read_b64_tr_b16 a[132:133], v54 offset:36928
    ds_read_b64_tr_b16 a[134:135], v54 offset:37696
    buffer_load_dwordx4 v52, s[32:35], s92 offen offset:0 lds
    buffer_load_dwordx4 v41, s[32:35], s92 offen offset:1024 lds
    buffer_load_dwordx4 v40, s[32:35], s92 offen offset:2048 lds
    s_add_u32 m0, s90, 24576
    s_mov_b32 s92, 74496
    s_waitcnt vmcnt(9)
    ds_read_b64_tr_b16 a[88:89], v54 offset:49152
    ds_read_b64_tr_b16 a[90:91], v54 offset:49920
    ds_read_b64_tr_b16 a[112:113], v54 offset:49184
    ds_read_b64_tr_b16 a[114:115], v54 offset:49952
    ds_read_b64_tr_b16 a[136:137], v54 offset:49216
    ds_read_b64_tr_b16 a[138:139], v54 offset:49984
    s_waitcnt lgkmcnt(6)
    buffer_load_dwordx4 v52, s[32:35], s92 offen offset:0 lds
    buffer_load_dwordx4 v41, s[32:35], s92 offen offset:1024 lds
    buffer_load_dwordx4 v40, s[32:35], s92 offen offset:2048 lds
    s_add_u32 m0, s90, 36864
    s_mov_b32 s92, 111360
    s_waitcnt vmcnt(9)
    ds_read_b64_tr_b16 a[92:93], v54 offset:61440
    ds_read_b64_tr_b16 a[94:95], v54 offset:62208
    v_mfma_f32_16x16x32_bf16 v[88:91], a[72:75], v[120:123], 0
    ds_read_b64_tr_b16 a[116:117], v54 offset:61472
    v_mfma_f32_16x16x32_bf16 v[88:91], a[76:79], v[72:75], v[88:91]
    ds_read_b64_tr_b16 a[118:119], v54 offset:62240
    v_mfma_f32_16x16x32_bf16 v[88:91], a[80:83], v[68:71], v[88:91]
    ds_read_b64_tr_b16 a[140:141], v54 offset:61504
    v_mfma_f32_16x16x32_bf16 v[88:91], a[84:87], v[56:59], v[88:91]
    s_waitcnt lgkmcnt(5)
    buffer_load_dwordx4 v52, s[32:35], s92 offen offset:0 lds
    ds_read_b64_tr_b16 a[142:143], v54 offset:62272
    v_mfma_f32_16x16x32_bf16 v[88:91], a[88:91], v[32:35], v[88:91]
    ds_read_b128 v[116:119], v2 offset:42496
    ds_read_b128 v[96:99], v11 offset:42496
    ds_read_b128 v[28:31], v2 offset:42624
    ds_read_b128 v[48:51], v11 offset:42624
    s_waitcnt lgkmcnt(7)
    v_mfma_f32_16x16x32_bf16 v[88:91], a[92:95], v[24:27], v[88:91]
    buffer_load_dwordx4 v41, s[32:35], s92 offen offset:1024 lds
    ds_read_b128 v[20:23], v2 offset:42752
    v_mfma_f32_16x16x32_bf16 v[100:103], a[96:99], v[120:123], 0
    s_nop 1
    ds_read_b128 v[16:19], v11 offset:42752
    v_mfma_f32_16x16x32_bf16 v[100:103], a[100:103], v[72:75], v[100:103]
    s_nop 0
    v_fma_f32 v53, v88, v88, s41
    v_fmac_f32 v53, v89, v89
    v_mfma_f32_16x16x32_bf16 v[100:103], a[104:107], v[68:71], v[100:103]
    v_fmac_f32 v53, v90, v90
    v_fmac_f32 v53, v91, v91
    v_mfma_f32_16x16x32_bf16 v[100:103], a[108:111], v[56:59], v[100:103]
    v_mfma_f32_16x16x32_bf16 v[100:103], a[112:115], v[32:35], v[100:103]
    s_waitcnt vmcnt(8) lgkmcnt(4)
    buffer_load_dwordx4 v40, s[32:35], s92 offen offset:2048 lds
    ds_read_b64_tr_b16 a[144:145], v55 offset:0
    v_mfma_f32_16x16x32_bf16 v[100:103], a[116:119], v[24:27], v[100:103]
    s_add_u32 m0, s90, 49152
    ds_read_b64_tr_b16 a[146:147], v55 offset:768
    v_mfma_f32_16x16x32_bf16 v[64:67], a[120:123], v[120:123], 0
    s_mov_b32 s92, 148224
    s_nop 0
    ds_read_b64_tr_b16 a[168:169], v55 offset:8
    v_mfma_f32_16x16x32_bf16 v[64:67], a[124:127], v[72:75], v[64:67]
    s_nop 0
    v_fmac_f32 v53, v100, v100
    v_fmac_f32 v53, v101, v101
    v_mfma_f32_16x16x32_bf16 v[64:67], a[128:131], v[68:71], v[64:67]
    ds_read_b64_tr_b16 a[170:171], v55 offset:776
    v_fmac_f32 v53, v102, v102
    v_mfma_f32_16x16x32_bf16 v[64:67], a[132:135], v[56:59], v[64:67]
    buffer_load_dwordx4 v52, s[32:35], s92 offen offset:0 lds
    ds_read_b64_tr_b16 a[192:193], v54 offset:64
    v_mfma_f32_16x16x32_bf16 v[64:67], a[136:139], v[32:35], v[64:67]
    ds_read_b64_tr_b16 a[194:195], v54 offset:832
    v_fmac_f32 v53, v103, v103
    v_mfma_f32_16x16x32_bf16 v[64:67], a[140:143], v[24:27], v[64:67]
    s_nop 0
    v_mfma_f32_16x16x32_bf16 v[24:27], a[72:75], v[116:119], 0
    s_nop 2
    v_mfma_f32_16x16x32_bf16 v[24:27], a[76:79], v[96:99], v[24:27]
    s_waitcnt lgkmcnt(5)
    s_nop 0
    v_fmac_f32 v53, v64, v64
    v_fmac_f32 v53, v65, v65
    v_mfma_f32_16x16x32_bf16 v[24:27], a[80:83], v[28:31], v[24:27]
    buffer_load_dwordx4 v41, s[32:35], s92 offen offset:1024 lds
    v_fmac_f32 v53, v66, v66
    v_mfma_f32_16x16x32_bf16 v[24:27], a[84:87], v[48:51], v[24:27]
    v_fmac_f32 v53, v67, v67
    v_cvt_pk_bf16_f32 v170, v9, v53
    v_mfma_f32_16x16x32_bf16 v[24:27], a[88:91], v[20:23], v[24:27]
    v_mfma_f32_16x16x32_bf16 v[24:27], a[92:95], v[16:19], v[24:27]
    ds_read_b128 v[56:59], v2 offset:40960
    v_mfma_f32_16x16x32_bf16 v[72:75], a[96:99], v[116:119], 0
    ds_read_b128 v[32:35], v11 offset:40960
    v_mfma_f32_16x16x32_bf16 v[72:75], a[100:103], v[96:99], v[72:75]
    s_waitcnt vmcnt(8)
    buffer_load_dwordx4 v40, s[32:35], s92 offen offset:2048 lds
    ds_read_b64_tr_b16 a[148:149], v55 offset:12288
    v_mfma_f32_16x16x32_bf16 v[72:75], a[104:107], v[28:31], v[72:75]
    s_add_u32 m0, s90, 61440
    v_fma_f32 v9, v24, v24, s41
    v_fmac_f32 v9, v25, v25
    v_mfma_f32_16x16x32_bf16 v[72:75], a[108:111], v[48:51], v[72:75]
    s_mov_b32 s92, 185088
    ds_read_b64_tr_b16 a[150:151], v55 offset:13056
    v_fmac_f32 v9, v26, v26
    v_mfma_f32_16x16x32_bf16 v[72:75], a[112:115], v[20:23], v[72:75]
    ds_read_b64_tr_b16 a[172:173], v55 offset:12296
    v_fmac_f32 v9, v27, v27
    v_mfma_f32_16x16x32_bf16 v[72:75], a[116:119], v[16:19], v[72:75]
    ds_read_b64_tr_b16 a[174:175], v55 offset:13064
    v_mfma_f32_16x16x32_bf16 v[68:71], a[120:123], v[116:119], 0
    s_nop 0
    buffer_load_dwordx4 v52, s[32:35], s92 offen offset:0 lds
    ds_read_b64_tr_b16 a[196:197], v54 offset:12352
    v_mfma_f32_16x16x32_bf16 v[68:71], a[124:127], v[96:99], v[68:71]
    s_nop 0
    ds_read_b64_tr_b16 a[198:199], v54 offset:13120
    v_fmac_f32 v9, v72, v72
    v_mfma_f32_16x16x32_bf16 v[68:71], a[128:131], v[28:31], v[68:71]
    ds_read_b128 v[28:31], v2 offset:41088
    v_fmac_f32 v9, v73, v73
    v_mfma_f32_16x16x32_bf16 v[68:71], a[132:135], v[48:51], v[68:71]
    ds_read_b128 v[48:51], v11 offset:41088
    v_fmac_f32 v9, v74, v74
    v_mfma_f32_16x16x32_bf16 v[68:71], a[136:139], v[20:23], v[68:71]
    ds_read_b128 v[20:23], v2 offset:41216
    v_fmac_f32 v9, v75, v75
    v_mfma_f32_16x16x32_bf16 v[68:71], a[140:143], v[16:19], v[68:71]
    s_nop 0
    buffer_load_dwordx4 v41, s[32:35], s92 offen offset:1024 lds
    ds_read_b128 v[16:19], v11 offset:41216
    v_mfma_f32_16x16x16_bf16 v[96:99], v[216:217], v[170:171], 0
    s_nop 3
    v_fmac_f32 v9, v68, v68
    v_fmac_f32 v9, v69, v69
    v_fmac_f32 v9, v70, v70
    v_fmac_f32 v9, v71, v71
    v_rsq_f32 v96, v96
    v_rsq_f32 v97, v97
    v_mul_f32 v96, s55, v96
    v_mul_f32 v97, 0.5, v97
    v_mul_f32 v104, v104, v96
    buffer_load_dwordx4 v40, s[32:35], s92 offen offset:2048 lds
    s_add_u32 m0, s90, 0
    s_mov_b32 s92, 0
    s_waitcnt vmcnt(9)
    ds_read_b64_tr_b16 a[152:153], v55 offset:24576
    v_mul_f32 v105, v105, v96
    v_cvt_pk_f16_f32 v104, v104, v105
    v_mul_f32 v106, v106, v96
    ds_read_b64_tr_b16 a[154:155], v55 offset:25344
    v_mul_f32 v107, v107, v96
    v_cvt_pk_f16_f32 v105, v106, v107
    v_mul_f32 v112, v112, v96
    ds_read_b64_tr_b16 a[176:177], v55 offset:24584
    v_mul_f32 v113, v113, v96
    v_cvt_pk_f16_f32 v106, v112, v113
    s_waitcnt lgkmcnt(3)
    buffer_load_dwordx4 v37, s[76:79], s92 offen offset:0 lds
    ds_read_b64_tr_b16 a[178:179], v55 offset:25352
    v_mul_f32 v114, v114, v96
    v_mul_f32 v115, v115, v96
    v_cvt_pk_f16_f32 v107, v114, v115
    ds_read_b64_tr_b16 a[200:201], v54 offset:24640
    v_mul_f32 v108, v108, v96
    ds_read_b64_tr_b16 a[202:203], v54 offset:25408
    v_mul_f32 v109, v109, v96
    v_cvt_pk_f16_f32 v92, v108, v109
    v_mul_f32 v110, v110, v96
    v_mul_f32 v111, v111, v96
    v_cvt_pk_f16_f32 v93, v110, v111
    v_mul_f32 v88, v88, v97
    buffer_load_dwordx4 v36, s[76:79], s92 offen offset:1024 lds
    ds_write_b128 v10, v[104:107] offset:336
    v_mul_f32 v89, v89, v97
    v_cvt_pk_f16_f32 v88, v88, v89
    v_mul_f32 v90, v90, v97
    v_mul_f32 v91, v91, v97
    v_cvt_pk_f16_f32 v89, v90, v91
    v_mul_f32 v100, v100, v97
    v_mul_f32 v101, v101, v97
    v_cvt_pk_f16_f32 v90, v100, v101
    v_mul_f32 v102, v102, v97
    v_mul_f32 v103, v103, v97
    v_cvt_pk_f16_f32 v91, v102, v103
    v_mul_f32 v64, v64, v97
    buffer_load_dwordx4 v5, s[76:79], s92 offen offset:2048 lds
    s_add_u32 m0, s90, 12288
    s_mov_b32 s92, 12288
    s_waitcnt vmcnt(9)
    ds_read_b64_tr_b16 a[156:157], v55 offset:36864
    v_mul_f32 v65, v65, v97
    v_cvt_pk_f16_f32 v52, v64, v65
    v_mul_f32 v66, v66, v97
    ds_read_b64_tr_b16 a[158:159], v55 offset:37632
    v_mul_f32 v67, v67, v97
    v_cvt_pk_f16_f32 v53, v66, v67
    v_cvt_pk_bf16_f32 v170, v8, v9
    ds_read_b64_tr_b16 a[180:181], v55 offset:36872
    s_nop 0
    v_mfma_f32_16x16x16_bf16 v[64:67], v[216:217], v[170:171], 0
    buffer_load_dwordx4 v37, s[76:79], s92 offen offset:0 lds
    ds_read_b64_tr_b16 a[182:183], v55 offset:37640
    s_nop 2
    ds_read_b64_tr_b16 a[204:205], v54 offset:36928
    s_nop 0
    ds_read_b64_tr_b16 a[206:207], v54 offset:37696
    v_rsq_f32 v64, v64
    ds_write_b128 v10, v[92:95] offset:352
    v_rsq_f32 v65, v65
    buffer_load_dwordx4 v36, s[76:79], s92 offen offset:1024 lds
    v_mul_f32 v64, s55, v64
    v_mul_f32 v65, 0.5, v65
    v_mul_f32 v60, v60, v64
    ds_write_b128 v10, v[88:91] offset:368
    v_mul_f32 v61, v61, v64
    v_cvt_pk_f16_f32 v60, v60, v61
    v_mul_f32 v62, v62, v64
    v_mul_f32 v63, v63, v64
    v_cvt_pk_f16_f32 v61, v62, v63
    v_mul_f32 v84, v84, v64
    v_mul_f32 v85, v85, v64
    buffer_load_dwordx4 v5, s[76:79], s92 offen offset:2048 lds
    s_add_u32 m0, s90, 24576
    s_mov_b32 s92, 24576
    s_waitcnt vmcnt(9)
    ds_read_b64_tr_b16 a[160:161], v55 offset:49152
    v_cvt_pk_f16_f32 v62, v84, v85
    v_mul_f32 v86, v86, v64
    v_mul_f32 v87, v87, v64
    ds_read_b64_tr_b16 a[162:163], v55 offset:49920
    v_cvt_pk_f16_f32 v63, v86, v87
    v_mul_f32 v80, v80, v64
    v_mul_f32 v81, v81, v64
    ds_read_b64_tr_b16 a[184:185], v55 offset:49160
    v_cvt_pk_f16_f32 v40, v80, v81
    v_mul_f32 v82, v82, v64
    s_waitcnt lgkmcnt(3)
    buffer_load_dwordx4 v37, s[76:79], s92 offen offset:0 lds
    ds_read_b64_tr_b16 a[186:187], v55 offset:49928
    v_mul_f32 v83, v83, v64
    v_cvt_pk_f16_f32 v41, v82, v83
    v_mul_f32 v24, v24, v65
    ds_read_b64_tr_b16 a[208:209], v54 offset:49216
    v_mul_f32 v25, v25, v65
    ds_read_b64_tr_b16 a[210:211], v54 offset:49984
    v_cvt_pk_f16_f32 v24, v24, v25
    ds_write_b64 v10, v[52:53] offset:384
    buffer_load_dwordx4 v36, s[76:79], s92 offen offset:1024 lds
    v_mul_f32 v26, v26, v65
    v_mul_f32 v27, v27, v65
    v_cvt_pk_f16_f32 v25, v26, v27
    v_mul_f32 v72, v72, v65
    v_mul_f32 v73, v73, v65
    v_cvt_pk_f16_f32 v26, v72, v73
    v_mul_f32 v74, v74, v65
    v_mul_f32 v75, v75, v65
    v_cvt_pk_f16_f32 v27, v74, v75
    v_mul_f32 v68, v68, v65
    v_mul_f32 v69, v69, v65
    v_cvt_pk_f16_f32 v8, v68, v69
    v_mul_f32 v70, v70, v65
    v_mul_f32 v71, v71, v65
    v_cvt_pk_f16_f32 v9, v70, v71
    ds_write_b128 v4, v[60:63] offset:5712
    buffer_load_dwordx4 v5, s[76:79], s92 offen offset:2048 lds
    s_add_u32 m0, s90, 36864
    s_mov_b32 s92, 36864
    s_waitcnt vmcnt(9)
    ds_read_b64_tr_b16 a[164:165], v55 offset:61440
    ds_read_b64_tr_b16 a[166:167], v55 offset:62208
    v_mfma_f32_16x16x32_bf16 v[60:63], a[144:147], v[56:59], 0
    ds_read_b64_tr_b16 a[188:189], v55 offset:61448
    v_mfma_f32_16x16x32_bf16 v[60:63], a[148:151], v[32:35], v[60:63]
    buffer_load_dwordx4 v37, s[76:79], s92 offen offset:0 lds
    ds_read_b64_tr_b16 a[190:191], v55 offset:62216
    v_mfma_f32_16x16x32_bf16 v[60:63], a[152:155], v[28:31], v[60:63]
    ds_read_b64_tr_b16 a[212:213], v54 offset:61504
    v_mfma_f32_16x16x32_bf16 v[60:63], a[156:159], v[48:51], v[60:63]
    s_waitcnt lgkmcnt(5)
    ds_read_b64_tr_b16 a[214:215], v54 offset:62272
    v_mfma_f32_16x16x32_bf16 v[60:63], a[160:163], v[20:23], v[60:63]
    ds_write_b128 v4, v[40:43] offset:5728
    buffer_load_dwordx4 v36, s[76:79], s92 offen offset:1024 lds
    ds_write_b128 v4, v[24:27] offset:5744
    s_waitcnt lgkmcnt(5)
    v_mfma_f32_16x16x32_bf16 v[60:63], a[164:167], v[16:19], v[60:63]
    v_mfma_f32_16x16x32_bf16 v[24:27], a[168:171], v[56:59], 0
    s_nop 0
    v_mfma_f32_16x16x32_bf16 v[24:27], a[172:175], v[32:35], v[24:27]
    s_nop 0
    buffer_load_dwordx4 v5, s[76:79], s92 offen offset:2048 lds
    ds_read_b128 v[40:43], v2 offset:42496
    v_mfma_f32_16x16x32_bf16 v[24:27], a[176:179], v[28:31], v[24:27]
    s_add_u32 m0, s90, 49152
    v_cvt_pk_bf16_f32 v54, v60, v61
    v_cvt_pk_bf16_f32 v55, v62, v63
    v_mfma_f32_16x16x32_bf16 v[24:27], a[180:183], v[48:51], v[24:27]
    s_mov_b32 s92, 49152
    ds_write_b64 v4, v[8:9] offset:5760
    v_mfma_f32_16x16x32_bf16 v[24:27], a[184:187], v[20:23], v[24:27]
    s_waitcnt lgkmcnt(3)
    s_mov_b32 s53, s47
    v_mfma_f32_16x16x32_bf16 v[24:27], a[188:191], v[16:19], v[24:27]
    s_mov_b32 s47, s46
    ds_write_b64 v10, v[54:55] offset:392
    v_mfma_f32_16x16x32_bf16 v[52:55], a[192:195], v[56:59], 0
    s_mov_b32 s46, s45
    buffer_load_dwordx4 v37, s[76:79], s92 offen offset:0 lds
    v_mfma_f32_16x16x32_bf16 v[52:55], a[196:199], v[32:35], v[52:55]
    s_mov_b32 s45, s44
    ds_read_b128 v[32:35], v11 offset:42496
    v_cvt_pk_bf16_f32 v0, v24, v25
    v_mfma_f32_16x16x32_bf16 v[52:55], a[200:203], v[28:31], v[52:55]
    s_mov_b32 s44, s53
    ds_read_b128 v[28:31], v2 offset:42624
    v_cvt_pk_bf16_f32 v1, v26, v27
    v_mfma_f32_16x16x32_bf16 v[52:55], a[204:207], v[48:51], v[52:55]
    s_sub_u32 s48, s44, s46
    ds_read_b128 v[24:27], v11 offset:42624
    v_add_u32 v139, s48, v139
    v_mfma_f32_16x16x32_bf16 v[52:55], a[208:211], v[20:23], v[52:55]
    s_sub_u32 s49, s46, s45
    buffer_load_dwordx4 v36, s[76:79], s92 offen offset:1024 lds
    ds_read_b128 v[20:23], v2 offset:42752
    v_mfma_f32_16x16x32_bf16 v[52:55], a[212:215], v[16:19], v[52:55]
    s_waitcnt lgkmcnt(5)
    v_add_u32 v138, s48, v138
    v_mfma_f32_16x16x32_bf16 v[48:51], a[144:147], v[40:43], 0
    s_waitcnt lgkmcnt(3)
    s_nop 0
    ds_read_b128 v[16:19], v11 offset:42752
    s_nop 1
    v_cvt_pk_bf16_f32 v2, v52, v53
    v_cvt_pk_bf16_f32 v3, v54, v55
    ds_write_b128 v10, v[0:3] offset:400
    buffer_load_dwordx4 v5, s[76:79], s92 offen offset:2048 lds
    s_add_u32 m0, s90, 61440
    s_mov_b32 s92, 61440
    v_mfma_f32_16x16x32_bf16 v[48:51], a[148:151], v[32:35], v[48:51]
    s_waitcnt lgkmcnt(4)
    v_mfma_f32_16x16x32_bf16 v[48:51], a[152:155], v[28:31], v[48:51]
    s_waitcnt lgkmcnt(3)
    v_mfma_f32_16x16x32_bf16 v[48:51], a[156:159], v[24:27], v[48:51]
    s_waitcnt lgkmcnt(2)
    v_mfma_f32_16x16x32_bf16 v[48:51], a[160:163], v[20:23], v[48:51]
    s_waitcnt lgkmcnt(1)
    buffer_load_dwordx4 v37, s[76:79], s92 offen offset:0 lds
    v_mfma_f32_16x16x32_bf16 v[48:51], a[164:167], v[16:19], v[48:51]
    s_nop 1
    v_mfma_f32_16x16x32_bf16 v[0:3], a[168:171], v[40:43], 0
    s_nop 2
    v_mfma_f32_16x16x32_bf16 v[0:3], a[172:175], v[32:35], v[0:3]
    s_nop 0
    v_cvt_pk_bf16_f32 v10, v48, v49
    v_cvt_pk_bf16_f32 v11, v50, v51
    v_mfma_f32_16x16x32_bf16 v[0:3], a[176:179], v[28:31], v[0:3]
    ds_write_b64 v4, v[10:11] offset:5768
    v_mfma_f32_16x16x32_bf16 v[0:3], a[180:183], v[24:27], v[0:3]
    buffer_load_dwordx4 v36, s[76:79], s92 offen offset:1024 lds
    v_mfma_f32_16x16x32_bf16 v[0:3], a[184:187], v[20:23], v[0:3]
    v_mfma_f32_16x16x32_bf16 v[0:3], a[188:191], v[16:19], v[0:3]
    s_nop 1
    v_mfma_f32_16x16x32_bf16 v[8:11], a[192:195], v[40:43], 0
    s_nop 2
    v_mfma_f32_16x16x32_bf16 v[8:11], a[196:199], v[32:35], v[8:11]
    s_nop 0
    v_cvt_pk_bf16_f32 v0, v0, v1
    v_cvt_pk_bf16_f32 v1, v2, v3
    v_mfma_f32_16x16x32_bf16 v[8:11], a[200:203], v[28:31], v[8:11]
    buffer_load_dwordx4 v5, s[76:79], s92 offen offset:2048 lds
    v_mfma_f32_16x16x32_bf16 v[8:11], a[204:207], v[24:27], v[8:11]
    s_add_u32 m0, s54, 20480
    v_mfma_f32_16x16x32_bf16 v[8:11], a[208:211], v[20:23], v[8:11]
    v_mfma_f32_16x16x32_bf16 v[8:11], a[212:215], v[16:19], v[8:11]
    s_nop 5
    buffer_load_dwordx4 v130, s[24:27], s56 offen nt lds
    s_add_u32 m0, s54, 21504
    v_cvt_pk_bf16_f32 v2, v8, v9
    v_cvt_pk_bf16_f32 v3, v10, v11
    ds_write_b128 v4, v[0:3] offset:5776
    buffer_load_dwordx4 v129, s[24:27], s56 offen nt lds
    s_add_u32 m0, s54, 22528
    s_nop 0
    buffer_load_dwordx4 v128, s[24:27], s56 offen nt lds
    s_add_u32 m0, s54, 23552
    s_nop 0
    buffer_load_dwordx4 v127, s[24:27], s56 offen nt lds
    s_add_u32 m0, s54, 24576
    s_nop 0
    buffer_load_dwordx4 v126, s[24:27], s56 offen nt lds
    s_waitcnt vmcnt(5)
    s_barrier
    ds_read_b128 v[20:23], v7 offset:0
    ds_read_b64 v[8:9], v6 offset:64
    ds_read_b128 v[0:3], v7 offset:3072
    ds_read_b64 v[10:11], v6 offset:3136
    ds_read_b128 v[32:35], v7 offset:6144
    ds_read_b64 v[24:25], v6 offset:6208
    ds_read_b128 v[16:19], v7 offset:9216
    ds_read_b64 v[26:27], v6 offset:9280
    ds_read_b128 v[28:31], v7 offset:12288
    ds_read_b64 v[40:41], v6 offset:12352
    ds_read_b128 v[56:59], v7 offset:15360
    ds_read_b64 v[42:43], v6 offset:15424
    s_waitcnt lgkmcnt(11)
    v_mfma_f32_16x16x32_bf16 v[48:51], v[20:23], v[220:223], 0
    s_waitcnt lgkmcnt(9)
    ds_read_b128 v[20:23], v7 offset:18432
    v_mfma_f32_16x16x32_bf16 v[48:51], v[0:3], v[220:223], v[48:51]
    s_waitcnt lgkmcnt(8)
    ds_read_b64 v[0:1], v6 offset:18496
    ds_read_b128 v[52:55], v7 offset:21504
    v_mfma_f32_16x16x32_bf16 v[48:51], v[32:35], v[220:223], v[48:51]
    s_waitcnt lgkmcnt(8)
    ds_read_b64 v[2:3], v6 offset:21568
    ds_read_b128 v[32:35], v7 offset:24576
    v_mfma_f32_16x16x32_bf16 v[48:51], v[16:19], v[220:223], v[48:51]
    ds_read_b64 v[16:17], v6 offset:24640
    v_mfma_f32_16x16x32_bf16 v[48:51], v[8:11], v[220:223], v[48:51]
    s_waitcnt lgkmcnt(9)
    ds_read_b128 v[8:11], v7 offset:27648
    v_mfma_f32_16x16x32_bf16 v[48:51], v[24:27], v[220:223], v[48:51]
    ds_read_b64 v[18:19], v6 offset:27712
    v_mfma_f32_16x16x32_bf16 v[24:27], v[28:31], v[220:223], 0
    s_waitcnt lgkmcnt(8)
    ds_read_b128 v[28:31], v7 offset:30720
    v_mfma_f32_16x16x32_bf16 v[24:27], v[56:59], v[220:223], v[24:27]
    s_waitcnt lgkmcnt(8)
    s_nop 0
    ds_read_b64 v[4:5], v6 offset:30784
    v_mul_f32 v48, 0xbbaaaaab, v48
    v_mfma_f32_16x16x32_bf16 v[24:27], v[20:23], v[220:223], v[24:27]
    s_waitcnt lgkmcnt(7)
    ds_read_b128 v[20:23], v7 offset:33792
    v_mul_f32 v49, 0xbbaaaaab, v49
    v_mul_f32 v50, 0xbbaaaaab, v50
    v_mul_f32 v51, 0xbbaaaaab, v51
    v_mfma_f32_16x16x32_bf16 v[24:27], v[52:55], v[220:223], v[24:27]
    ds_write_b128 v14, v[48:51] offset:0
    v_mfma_f32_16x16x32_bf16 v[24:27], v[40:43], v[220:223], v[24:27]
    s_waitcnt lgkmcnt(6)
    v_mfma_f32_16x16x32_bf16 v[24:27], v[0:3], v[220:223], v[24:27]
    v_mfma_f32_16x16x32_bf16 v[0:3], v[32:35], v[220:223], 0
    s_waitcnt lgkmcnt(4)
    ds_read_b64 v[6:7], v6 offset:33856
    s_nop 0
    v_mfma_f32_16x16x32_bf16 v[0:3], v[8:11], v[220:223], v[0:3]
    s_waitcnt lgkmcnt(4)
    s_nop 0
    ds_read_b128 v[8:11], v78 offset:0
    v_mul_f32 v24, 0xbbaaaaab, v24
    v_mfma_f32_16x16x32_bf16 v[0:3], v[28:31], v[220:223], v[0:3]
    s_waitcnt lgkmcnt(3)
    ds_read_b64 v[12:13], v124 offset:64
    v_mul_f32 v25, 0xbbaaaaab, v25
    v_mul_f32 v26, 0xbbaaaaab, v26
    v_mul_f32 v27, 0xbbaaaaab, v27
    v_mfma_f32_16x16x32_bf16 v[0:3], v[20:23], v[220:223], v[0:3]
    ds_write_b128 v14, v[24:27] offset:128
    v_mfma_f32_16x16x32_bf16 v[0:3], v[16:19], v[220:223], v[0:3]
    ds_read_b128 v[62:65], v78 offset:768
    ds_read_b64 v[66:67], v124 offset:832
    ds_read_b128 v[56:59], v78 offset:12288
    s_waitcnt lgkmcnt(6)
    v_mfma_f32_16x16x32_bf16 v[0:3], v[4:7], v[220:223], v[0:3]
    s_nop 0
    ds_read_b64 v[60:61], v124 offset:12352
    s_nop 0
    ds_read_b128 v[32:35], v78 offset:13056
    s_nop 2
    ds_read_b64 v[36:37], v124 offset:13120
    v_mul_f32 v0, 0xbbaaaaab, v0
    v_mul_f32 v1, 0xbbaaaaab, v1
    v_mul_f32 v2, 0xbbaaaaab, v2
    v_mul_f32 v3, 0xbbaaaaab, v3
    ds_write_b128 v14, v[0:3] offset:256
    s_waitcnt lgkmcnt(0)
    s_barrier
    ds_read_b128 v[0:3], v47 offset:0
    ds_read_b128 v[4:7], v47 offset:64
    ds_read_b128 v[52:55], v47 offset:128
    ds_read_b128 v[28:31], v47 offset:192
    s_waitcnt lgkmcnt(3)
    v_mfma_f32_16x16x16_bf16 v[20:23], v[8:9], v[38:39], v[0:3]
    v_mfma_f32_16x16x16_bf16 v[24:27], v[10:11], v[38:39], v[0:3]
    s_nop 2
    v_mfma_f32_16x16x16_bf16 v[48:51], v[12:13], v[38:39], v[0:3]
    s_waitcnt lgkmcnt(0)
    s_nop 0
    ds_read_b128 v[86:89], v78 offset:24576
    v_cvt_pk_bf16_f32 v20, v20, v21
    v_mfma_f32_16x16x16_bf16 v[8:11], v[62:63], v[38:39], v[4:7]
    ds_read_b64 v[90:91], v124 offset:24640
    v_accvgpr_write_b32 a216, v20
    v_mfma_f32_16x16x16_bf16 v[16:19], v[64:65], v[38:39], v[4:7]
    ds_read_b128 v[12:15], v47 offset:256
    v_cvt_pk_bf16_f32 v22, v22, v23
    v_mfma_f32_16x16x16_bf16 v[0:3], v[66:67], v[38:39], v[4:7]
    ds_read_b128 v[72:75], v78 offset:25344
    v_accvgpr_write_b32 a217, v22
    v_mfma_f32_16x16x16_bf16 v[40:43], v[56:57], v[38:39], v[52:55]
    ds_read_b64 v[76:77], v124 offset:25408
    v_cvt_pk_bf16_f32 v24, v24, v25
    v_mfma_f32_16x16x16_bf16 v[20:23], v[58:59], v[38:39], v[52:55]
    ds_read_b128 v[68:71], v47 offset:320
    v_accvgpr_write_b32 a240, v24
    v_mfma_f32_16x16x16_bf16 v[4:7], v[60:61], v[38:39], v[52:55]
    ds_read_b128 v[80:83], v78 offset:36864
    v_cvt_pk_bf16_f32 v26, v26, v27
    v_mfma_f32_16x16x16_bf16 v[64:67], v[32:33], v[38:39], v[28:31]
    ds_read_b64 v[84:85], v124 offset:36928
    v_accvgpr_write_b32 a241, v26
    v_mfma_f32_16x16x16_bf16 v[60:63], v[34:35], v[38:39], v[28:31]
    ds_read_b128 v[92:95], v47 offset:5120
    v_cvt_pk_bf16_f32 v232, v48, v49
    v_mfma_f32_16x16x16_bf16 v[24:27], v[36:37], v[38:39], v[28:31]
    s_waitcnt lgkmcnt(6)
    ds_read_b128 v[32:35], v78 offset:37632
    v_cvt_pk_bf16_f32 v233, v50, v51
    v_cvt_pk_bf16_f32 v8, v8, v9
    v_accvgpr_write_b32 a218, v8
    v_cvt_pk_bf16_f32 v10, v10, v11
    v_accvgpr_write_b32 a219, v10
    v_cvt_pk_bf16_f32 v16, v16, v17
    v_mfma_f32_16x16x16_bf16 v[56:59], v[86:87], v[38:39], v[12:15]
    ds_read_b64 v[36:37], v124 offset:37696
    v_accvgpr_write_b32 a242, v16
    v_mfma_f32_16x16x16_bf16 v[8:11], v[88:89], v[38:39], v[12:15]
    ds_read_b128 v[52:55], v47 offset:5184
    v_cvt_pk_bf16_f32 v18, v18, v19
    v_mfma_f32_16x16x16_bf16 v[28:31], v[90:91], v[38:39], v[12:15]
    s_waitcnt lgkmcnt(6)
    ds_read_b128 v[100:103], v78 offset:49152
    v_accvgpr_write_b32 a243, v18
    v_cvt_pk_bf16_f32 v234, v0, v1
    v_cvt_pk_bf16_f32 v235, v2, v3
    v_mfma_f32_16x16x16_bf16 v[16:19], v[72:73], v[38:39], v[68:71]
    ds_read_b64 v[104:105], v124 offset:49216
    v_cvt_pk_bf16_f32 v40, v40, v41
    v_mfma_f32_16x16x16_bf16 v[12:15], v[74:75], v[38:39], v[68:71]
    ds_read_b128 v[48:51], v47 offset:5248
    v_accvgpr_write_b32 a220, v40
    v_mfma_f32_16x16x16_bf16 v[0:3], v[76:77], v[38:39], v[68:71]
    s_waitcnt lgkmcnt(6)
    ds_read_b128 v[72:75], v78 offset:49920
    v_cvt_pk_bf16_f32 v42, v42, v43
    v_accvgpr_write_b32 a221, v42
    v_cvt_pk_bf16_f32 v20, v20, v21
    v_accvgpr_write_b32 a244, v20
    v_cvt_pk_bf16_f32 v22, v22, v23
    v_accvgpr_write_b32 a245, v22
    v_cvt_pk_bf16_f32 v236, v4, v5
    v_cvt_pk_bf16_f32 v237, v6, v7
    v_mfma_f32_16x16x16_bf16 v[40:43], v[80:81], v[38:39], v[92:95]
    ds_read_b64 v[76:77], v124 offset:49984
    v_cvt_pk_bf16_f32 v64, v64, v65
    v_mfma_f32_16x16x16_bf16 v[20:23], v[82:83], v[38:39], v[92:95]
    ds_read_b128 v[68:71], v47 offset:5312
    v_accvgpr_write_b32 a222, v64
    v_mfma_f32_16x16x16_bf16 v[4:7], v[84:85], v[38:39], v[92:95]
    s_waitcnt lgkmcnt(5)
    ds_read_b128 v[88:91], v78 offset:61440
    v_cvt_pk_bf16_f32 v66, v66, v67
    v_accvgpr_write_b32 a223, v66
    v_cvt_pk_bf16_f32 v60, v60, v61
    v_accvgpr_write_b32 a246, v60
    v_cvt_pk_bf16_f32 v62, v62, v63
    v_accvgpr_write_b32 a247, v62
    v_cvt_pk_bf16_f32 v238, v24, v25
    v_cvt_pk_bf16_f32 v239, v26, v27
    v_mfma_f32_16x16x16_bf16 v[96:99], v[32:33], v[38:39], v[52:55]
    ds_read_b64 v[92:93], v124 offset:61504
    v_cvt_pk_bf16_f32 v56, v56, v57
    v_mfma_f32_16x16x16_bf16 v[84:87], v[34:35], v[38:39], v[52:55]
    ds_read_b128 v[24:27], v47 offset:5376
    v_accvgpr_write_b32 a224, v56
    v_mfma_f32_16x16x16_bf16 v[80:83], v[36:37], v[38:39], v[52:55]
    s_waitcnt lgkmcnt(5)
    ds_read_b128 v[32:35], v78 offset:62208
    v_cvt_pk_bf16_f32 v58, v58, v59
    v_accvgpr_write_b32 a225, v58
    v_cvt_pk_bf16_f32 v8, v8, v9
    v_accvgpr_write_b32 a248, v8
    v_cvt_pk_bf16_f32 v10, v10, v11
    v_accvgpr_write_b32 a249, v10
    v_cvt_pk_bf16_f32 v240, v28, v29
    v_cvt_pk_bf16_f32 v241, v30, v31
    v_mfma_f32_16x16x16_bf16 v[60:63], v[100:101], v[38:39], v[48:51]
    ds_read_b64 v[36:37], v124 offset:62272
    v_cvt_pk_bf16_f32 v16, v16, v17
    v_mfma_f32_16x16x16_bf16 v[56:59], v[102:103], v[38:39], v[48:51]
    ds_read_b128 v[28:31], v47 offset:5440
    v_accvgpr_write_b32 a226, v16
    v_mfma_f32_16x16x16_bf16 v[52:55], v[104:105], v[38:39], v[48:51]
    s_waitcnt lgkmcnt(5)
    ds_read_b128 v[8:11], v139 offset:0
    v_cvt_pk_bf16_f32 v18, v18, v19
    v_accvgpr_write_b32 a227, v18
    v_cvt_pk_bf16_f32 v12, v12, v13
    v_accvgpr_write_b32 a250, v12
    v_cvt_pk_bf16_f32 v14, v14, v15
    v_accvgpr_write_b32 a251, v14
    v_cvt_pk_bf16_f32 v242, v0, v1
    v_cvt_pk_bf16_f32 v243, v2, v3
    v_mfma_f32_16x16x16_bf16 v[48:51], v[72:73], v[38:39], v[68:71]
    ds_read_b128 v[64:67], v138 offset:0
    v_cvt_pk_bf16_f32 v40, v40, v41
    v_mfma_f32_16x16x16_bf16 v[16:19], v[74:75], v[38:39], v[68:71]
    ds_read_b128 v[0:3], v139 offset:128
    v_accvgpr_write_b32 a228, v40
    v_mfma_f32_16x16x16_bf16 v[12:15], v[76:77], v[38:39], v[68:71]
    s_waitcnt lgkmcnt(5)
    ds_read_b128 v[72:75], v138 offset:128
    v_cvt_pk_bf16_f32 v42, v42, v43
    v_accvgpr_write_b32 a229, v42
    v_cvt_pk_bf16_f32 v20, v20, v21
    v_accvgpr_write_b32 a252, v20
    v_cvt_pk_bf16_f32 v22, v22, v23
    v_accvgpr_write_b32 a253, v22
    v_cvt_pk_bf16_f32 v244, v4, v5
    v_cvt_pk_bf16_f32 v245, v6, v7
    v_mfma_f32_16x16x16_bf16 v[4:7], v[88:89], v[38:39], v[24:27]
    ds_read_b128 v[68:71], v139 offset:256
    v_cvt_pk_bf16_f32 v96, v96, v97
    v_mfma_f32_16x16x16_bf16 v[40:43], v[90:91], v[38:39], v[24:27]
    ds_read_b128 v[76:79], v138 offset:256
    v_accvgpr_write_b32 a230, v96
    v_mfma_f32_16x16x16_bf16 v[20:23], v[92:93], v[38:39], v[24:27]
    s_waitcnt lgkmcnt(5)
    v_cvt_pk_bf16_f32 v98, v98, v99
    v_accvgpr_write_b32 a231, v98
    v_cvt_pk_bf16_f32 v84, v84, v85
    v_mfma_f32_16x16x32_bf16 v[24:27], a[0:3], v[8:11], 0
    s_waitcnt lgkmcnt(4)
    v_accvgpr_write_b32 a254, v84
    v_cvt_pk_bf16_f32 v86, v86, v87
    v_accvgpr_write_b32 a255, v86
    v_mfma_f32_16x16x32_bf16 v[24:27], a[4:7], v[64:67], v[24:27]
    s_waitcnt lgkmcnt(3)
    v_cvt_pk_bf16_f32 v246, v80, v81
    v_cvt_pk_bf16_f32 v247, v82, v83
    v_mfma_f32_16x16x32_bf16 v[24:27], a[8:11], v[0:3], v[24:27]
    s_waitcnt lgkmcnt(2)
    v_cvt_pk_bf16_f32 v60, v60, v61
    v_accvgpr_write_b32 a232, v60
    v_mfma_f32_16x16x32_bf16 v[24:27], a[12:15], v[72:75], v[24:27]
    s_waitcnt lgkmcnt(1)
    v_cvt_pk_bf16_f32 v62, v62, v63
    v_accvgpr_write_b32 a233, v62
    v_cvt_pk_bf16_f32 v224, v56, v57
    v_cvt_pk_bf16_f32 v225, v58, v59
    v_cvt_pk_bf16_f32 v248, v52, v53
    v_cvt_pk_bf16_f32 v249, v54, v55
    v_cvt_pk_bf16_f32 v48, v48, v49
    v_accvgpr_write_b32 a234, v48
    v_cvt_pk_bf16_f32 v50, v50, v51
    v_mfma_f32_16x16x32_bf16 v[24:27], a[16:19], v[68:71], v[24:27]
    s_waitcnt lgkmcnt(0)
    v_accvgpr_write_b32 a235, v50
    v_cvt_pk_bf16_f32 v226, v16, v17
    v_mfma_f32_16x16x32_bf16 v[24:27], a[20:23], v[76:79], v[24:27]
    v_cvt_pk_bf16_f32 v227, v18, v19
    v_cvt_pk_bf16_f32 v250, v12, v13
    v_mfma_f32_16x16x16_bf16 v[16:19], v[32:33], v[38:39], v[28:31]
    v_cvt_pk_bf16_f32 v251, v14, v15
    v_cvt_pk_bf16_f32 v4, v4, v5
    v_accvgpr_write_b32 a236, v4
    v_mfma_f32_16x16x16_bf16 v[12:15], v[34:35], v[38:39], v[28:31]
    v_cvt_pk_bf16_f32 v6, v6, v7
    v_accvgpr_write_b32 a237, v6
    v_mfma_f32_16x16x16_bf16 v[4:7], v[36:37], v[38:39], v[28:31]
    v_cvt_pk_bf16_f32 v228, v40, v41
    v_cvt_pk_bf16_f32 v229, v42, v43
    v_cvt_pk_bf16_f32 v252, v20, v21
    v_mfma_f32_16x16x32_bf16 v[56:59], a[24:27], v[8:11], 0
    v_cvt_pk_bf16_f32 v253, v22, v23
    v_cvt_pk_bf16_f32 v16, v16, v17
    v_mfma_f32_16x16x32_bf16 v[56:59], a[28:31], v[64:67], v[56:59]
    v_accvgpr_write_b32 a238, v16
    v_cvt_pk_bf16_f32 v18, v18, v19
    v_mfma_f32_16x16x32_bf16 v[56:59], a[32:35], v[0:3], v[56:59]
    v_accvgpr_write_b32 a239, v18
    v_cvt_pk_bf16_f32 v230, v12, v13
    v_mfma_f32_16x16x32_bf16 v[56:59], a[36:39], v[72:75], v[56:59]
    v_cvt_pk_bf16_f32 v231, v14, v15
    v_cvt_pk_bf16_f32 v254, v4, v5
    v_mfma_f32_16x16x32_bf16 v[56:59], a[40:43], v[68:71], v[56:59]
    v_cvt_pk_bf16_f32 v255, v6, v7
    v_add_u32 v137, s49, v137
    v_mfma_f32_16x16x32_bf16 v[56:59], a[44:47], v[76:79], v[56:59]
    v_add_u32 v136, s49, v136
    v_fma_f32 v124, v24, v24, s41
    v_mfma_f32_16x16x32_bf16 v[52:55], a[48:51], v[8:11], 0
    v_fmac_f32 v124, v25, v25
    v_fmac_f32 v124, v26, v26
    v_mfma_f32_16x16x32_bf16 v[52:55], a[52:55], v[64:67], v[52:55]
    s_nop 0
    v_fmac_f32 v124, v27, v27
    v_fmac_f32 v124, v56, v56
    v_mfma_f32_16x16x32_bf16 v[52:55], a[56:59], v[0:3], v[52:55]
    v_fmac_f32 v124, v57, v57
    v_fmac_f32 v124, v58, v58
    v_mfma_f32_16x16x32_bf16 v[52:55], a[60:63], v[72:75], v[52:55]
    v_fmac_f32 v124, v59, v59
    v_mfma_f32_16x16x32_bf16 v[52:55], a[64:67], v[68:71], v[52:55]
    v_mfma_f32_16x16x32_bf16 v[52:55], a[68:71], v[76:79], v[52:55]
    s_nop 1
    v_mfma_f32_16x16x32_bf16 v[48:51], a[72:75], v[8:11], 0
    s_nop 2
    v_mfma_f32_16x16x32_bf16 v[48:51], a[76:79], v[64:67], v[48:51]
    s_nop 0
    v_fmac_f32 v124, v52, v52
    v_fmac_f32 v124, v53, v53
    v_mfma_f32_16x16x32_bf16 v[48:51], a[80:83], v[0:3], v[48:51]
    v_fmac_f32 v124, v54, v54
    v_fmac_f32 v124, v55, v55
    v_mfma_f32_16x16x32_bf16 v[48:51], a[84:87], v[72:75], v[48:51]
    v_mfma_f32_16x16x32_bf16 v[48:51], a[88:91], v[68:71], v[48:51]
    v_mfma_f32_16x16x32_bf16 v[48:51], a[92:95], v[76:79], v[48:51]
    s_nop 1
    v_mfma_f32_16x16x32_bf16 v[4:7], a[96:99], v[8:11], 0
    s_nop 2
    v_mfma_f32_16x16x32_bf16 v[4:7], a[100:103], v[64:67], v[4:7]
    s_nop 0
    v_fma_f32 v47, v48, v48, s41
    v_fmac_f32 v47, v49, v49
    v_mfma_f32_16x16x32_bf16 v[4:7], a[104:107], v[0:3], v[4:7]
    v_fmac_f32 v47, v50, v50
    v_fmac_f32 v47, v51, v51
    v_mfma_f32_16x16x32_bf16 v[4:7], a[108:111], v[72:75], v[4:7]
    v_mfma_f32_16x16x32_bf16 v[4:7], a[112:115], v[68:71], v[4:7]
    v_mfma_f32_16x16x32_bf16 v[4:7], a[116:119], v[76:79], v[4:7]
    s_nop 1
    v_mfma_f32_16x16x32_bf16 v[36:39], a[120:123], v[8:11], 0
    s_nop 2
    v_mfma_f32_16x16x32_bf16 v[36:39], a[124:127], v[64:67], v[36:39]
    s_nop 0
    v_fmac_f32 v47, v4, v4
    v_fmac_f32 v47, v5, v5
    v_mfma_f32_16x16x32_bf16 v[36:39], a[128:131], v[0:3], v[36:39]
    v_fmac_f32 v47, v6, v6
    v_fmac_f32 v47, v7, v7
    v_mfma_f32_16x16x32_bf16 v[36:39], a[132:135], v[72:75], v[36:39]
    v_mfma_f32_16x16x32_bf16 v[36:39], a[136:139], v[68:71], v[36:39]
    v_mfma_f32_16x16x32_bf16 v[36:39], a[140:143], v[76:79], v[36:39]
    s_nop 1
    v_mfma_f32_16x16x32_bf16 v[12:15], v[8:11], a[144:147], 0
    s_nop 2
    v_mfma_f32_16x16x32_bf16 v[12:15], v[64:67], a[148:151], v[12:15]
    s_nop 0
    v_fmac_f32 v47, v36, v36
    v_fmac_f32 v47, v37, v37
    v_mfma_f32_16x16x32_bf16 v[12:15], v[0:3], a[152:155], v[12:15]
    v_fmac_f32 v47, v38, v38
    v_fmac_f32 v47, v39, v39
    v_mfma_f32_16x16x32_bf16 v[12:15], v[72:75], a[156:159], v[12:15]
    v_cvt_pk_bf16_f32 v170, v124, v47
    v_mfma_f32_16x16x32_bf16 v[12:15], v[68:71], a[160:163], v[12:15]
    ds_read_b128 v[112:115], v139 offset:1536
    v_mfma_f32_16x16x32_bf16 v[12:15], v[76:79], a[164:167], v[12:15]
    s_nop 0
    ds_read_b128 v[108:111], v138 offset:1536
    s_nop 0
    v_mfma_f32_16x16x16_bf16 v[40:43], v[216:217], v[170:171], 0
    s_nop 0
    ds_read_b128 v[92:95], v139 offset:1664
    s_nop 1
    v_cvt_pk_bf16_f32 v32, v12, v13
    v_mfma_f32_16x16x32_bf16 v[16:19], v[8:11], a[168:171], 0
    ds_read_b128 v[104:107], v138 offset:1664
    v_cvt_pk_bf16_f32 v33, v14, v15
    v_mfma_f32_16x16x32_bf16 v[16:19], v[64:67], a[172:175], v[16:19]
    ds_read_b128 v[80:83], v139 offset:1792
    v_mfma_f32_16x16x32_bf16 v[16:19], v[0:3], a[176:179], v[16:19]
    ds_read_b128 v[12:15], v138 offset:1792
    v_mfma_f32_16x16x32_bf16 v[16:19], v[72:75], a[180:183], v[16:19]
    v_rsq_f32 v40, v40
    v_mfma_f32_16x16x32_bf16 v[16:19], v[68:71], a[184:187], v[16:19]
    v_rsq_f32 v41, v41
    v_mfma_f32_16x16x32_bf16 v[16:19], v[76:79], a[188:191], v[16:19]
    v_mul_f32 v40, s55, v40
    v_mul_f32 v41, 0.5, v41
    v_mfma_f32_16x16x32_bf16 v[20:23], v[8:11], a[192:195], 0
    s_nop 0
    v_mul_f32 v24, v24, v40
    v_mul_f32 v25, v25, v40
    v_mfma_f32_16x16x32_bf16 v[20:23], v[64:67], a[196:199], v[20:23]
    s_nop 0
    v_cvt_pk_bf16_f32 v28, v16, v17
    v_cvt_pk_bf16_f32 v29, v18, v19
    v_mfma_f32_16x16x32_bf16 v[20:23], v[0:3], a[200:203], v[20:23]
    v_cvt_pk_f16_f32 v16, v24, v25
    v_mul_f32 v26, v26, v40
    v_mfma_f32_16x16x32_bf16 v[20:23], v[72:75], a[204:207], v[20:23]
    v_mul_f32 v27, v27, v40
    v_cvt_pk_f16_f32 v17, v26, v27
    v_mfma_f32_16x16x32_bf16 v[20:23], v[68:71], a[208:211], v[20:23]
    v_mul_f32 v56, v56, v40
    v_mul_f32 v57, v57, v40
    v_mfma_f32_16x16x32_bf16 v[20:23], v[76:79], a[212:215], v[20:23]
    s_waitcnt lgkmcnt(0)
    v_cvt_pk_f16_f32 v18, v56, v57
    v_mul_f32 v58, v58, v40
    v_mfma_f32_16x16x32_bf16 v[64:67], a[0:3], v[112:115], 0
    v_mul_f32 v59, v59, v40
    v_cvt_pk_f16_f32 v19, v58, v59
    v_mfma_f32_16x16x32_bf16 v[64:67], a[4:7], v[108:111], v[64:67]
    v_mul_f32 v52, v52, v40
    v_mul_f32 v53, v53, v40
    v_mfma_f32_16x16x32_bf16 v[64:67], a[8:11], v[92:95], v[64:67]
    v_cvt_pk_f16_f32 v154, v52, v53
    v_mul_f32 v54, v54, v40
    v_mfma_f32_16x16x32_bf16 v[64:67], a[12:15], v[104:107], v[64:67]
    v_mul_f32 v55, v55, v40
    v_cvt_pk_f16_f32 v155, v54, v55
    v_mfma_f32_16x16x32_bf16 v[64:67], a[16:19], v[80:83], v[64:67]
    v_mul_f32 v48, v48, v41
    v_mul_f32 v49, v49, v41
    v_mfma_f32_16x16x32_bf16 v[64:67], a[20:23], v[12:15], v[64:67]
    v_cvt_pk_f16_f32 v86, v48, v49
    v_mul_f32 v50, v50, v41
    v_mfma_f32_16x16x32_bf16 v[56:59], a[24:27], v[112:115], 0
    v_mul_f32 v51, v51, v41
    v_cvt_pk_f16_f32 v87, v50, v51
    v_mfma_f32_16x16x32_bf16 v[56:59], a[28:31], v[108:111], v[56:59]
    v_mul_f32 v4, v4, v41
    v_mul_f32 v5, v5, v41
    v_mfma_f32_16x16x32_bf16 v[56:59], a[32:35], v[92:95], v[56:59]
    v_cvt_pk_f16_f32 v88, v4, v5
    v_mul_f32 v6, v6, v41
    v_mfma_f32_16x16x32_bf16 v[56:59], a[36:39], v[104:107], v[56:59]
    v_mul_f32 v7, v7, v41
    v_cvt_pk_f16_f32 v89, v6, v7
    v_mfma_f32_16x16x32_bf16 v[56:59], a[40:43], v[80:83], v[56:59]
    v_mul_f32 v36, v36, v41
    v_mul_f32 v37, v37, v41
    v_mfma_f32_16x16x32_bf16 v[56:59], a[44:47], v[12:15], v[56:59]
    v_cvt_pk_f16_f32 v90, v36, v37
    v_mul_f32 v38, v38, v41
    v_mfma_f32_16x16x32_bf16 v[4:7], a[48:51], v[112:115], 0
    v_mul_f32 v39, v39, v41
    v_cvt_pk_f16_f32 v91, v38, v39
    v_mfma_f32_16x16x32_bf16 v[4:7], a[52:55], v[108:111], v[4:7]
    v_cvt_pk_bf16_f32 v20, v20, v21
    v_cvt_pk_bf16_f32 v21, v22, v23
    v_mfma_f32_16x16x32_bf16 v[4:7], a[56:59], v[92:95], v[4:7]
    v_fma_f32 v47, v64, v64, s41
    v_fmac_f32 v47, v65, v65
    v_mfma_f32_16x16x32_bf16 v[4:7], a[60:63], v[104:107], v[4:7]
    v_fmac_f32 v47, v66, v66
    v_fmac_f32 v47, v67, v67
    v_mfma_f32_16x16x32_bf16 v[4:7], a[64:67], v[80:83], v[4:7]
    v_fmac_f32 v47, v56, v56
    v_fmac_f32 v47, v57, v57
    v_mfma_f32_16x16x32_bf16 v[4:7], a[68:71], v[12:15], v[4:7]
    v_fmac_f32 v47, v58, v58
    v_fmac_f32 v47, v59, v59
    v_mfma_f32_16x16x32_bf16 v[52:55], a[72:75], v[112:115], 0
    s_nop 2
    v_mfma_f32_16x16x32_bf16 v[52:55], a[76:79], v[108:111], v[52:55]
    s_nop 0
    v_fmac_f32 v47, v4, v4
    v_fmac_f32 v47, v5, v5
    v_mfma_f32_16x16x32_bf16 v[52:55], a[80:83], v[92:95], v[52:55]
    v_fmac_f32 v47, v6, v6
    v_fmac_f32 v47, v7, v7
    v_mfma_f32_16x16x32_bf16 v[52:55], a[84:87], v[104:107], v[52:55]
    v_mfma_f32_16x16x32_bf16 v[52:55], a[88:91], v[80:83], v[52:55]
    v_mfma_f32_16x16x32_bf16 v[52:55], a[92:95], v[12:15], v[52:55]
    s_nop 1
    v_mfma_f32_16x16x32_bf16 v[0:3], a[96:99], v[112:115], 0
    s_nop 2
    v_mfma_f32_16x16x32_bf16 v[0:3], a[100:103], v[108:111], v[0:3]
    s_nop 0
    v_fma_f32 v124, v52, v52, s41
    v_fmac_f32 v124, v53, v53
    v_mfma_f32_16x16x32_bf16 v[0:3], a[104:107], v[92:95], v[0:3]
    v_fmac_f32 v124, v54, v54
    v_fmac_f32 v124, v55, v55
    v_mfma_f32_16x16x32_bf16 v[0:3], a[108:111], v[104:107], v[0:3]
    v_mfma_f32_16x16x32_bf16 v[0:3], a[112:115], v[80:83], v[0:3]
    v_mfma_f32_16x16x32_bf16 v[0:3], a[116:119], v[12:15], v[0:3]
    s_sub_u32 s50, s45, s44
    v_add_u32 v137, s48, v137
    v_add_u32 v136, s48, v136
    v_mfma_f32_16x16x32_bf16 v[24:27], a[120:123], v[112:115], 0
    s_sub_u32 s51, s46, s47
    v_add_u32 v135, s51, v135
    v_add_u32 v134, 336, v134
    v_mfma_f32_16x16x32_bf16 v[24:27], a[124:127], v[108:111], v[24:27]
    s_mov_b32 s60, s59
    v_fmac_f32 v124, v0, v0
    v_fmac_f32 v124, v1, v1
    v_mfma_f32_16x16x32_bf16 v[24:27], a[128:131], v[92:95], v[24:27]
    s_mov_b32 s59, s58
    v_fmac_f32 v124, v2, v2
    v_fmac_f32 v124, v3, v3
    v_mfma_f32_16x16x32_bf16 v[24:27], a[132:135], v[104:107], v[24:27]
    s_mov_b32 s58, s57
    v_add_u32 v133, 336, v133
    v_add_u32 v125, 336, v125
    v_mfma_f32_16x16x32_bf16 v[24:27], a[136:139], v[80:83], v[24:27]
    s_mov_b32 s57, s56
    v_mfma_f32_16x16x32_bf16 v[24:27], a[140:143], v[12:15], v[24:27]
    s_add_u32 s56, s56, s62
    s_nop 0
    v_mfma_f32_16x16x32_bf16 v[8:11], v[112:115], a[144:147], 0
    s_add_u32 s61, s61, 1
    s_nop 1
    v_mfma_f32_16x16x32_bf16 v[8:11], v[108:111], a[148:151], v[8:11]
    s_cmp_eq_u32 s61, 72
    v_fmac_f32 v124, v24, v24
    v_fmac_f32 v124, v25, v25
    v_mfma_f32_16x16x32_bf16 v[8:11], v[92:95], a[152:155], v[8:11]
    s_cselect_b32 s53, s63, 0
    v_fmac_f32 v124, v26, v26
    v_fmac_f32 v124, v27, v27
    v_mfma_f32_16x16x32_bf16 v[8:11], v[104:107], a[156:159], v[8:11]
    s_cselect_b32 s61, 0, s61
    v_cvt_pk_bf16_f32 v170, v47, v124
    v_mfma_f32_16x16x32_bf16 v[8:11], v[80:83], a[160:163], v[8:11]
    s_add_u32 s56, s56, s53
    ds_read_b128 v[100:103], v139 offset:3072
    v_mfma_f32_16x16x32_bf16 v[8:11], v[12:15], a[164:167], v[8:11]
    s_sub_u32 s64, s64, 1
    ds_read_b128 v[96:99], v138 offset:3072
    s_nop 0
    v_mfma_f32_16x16x16_bf16 v[40:43], v[216:217], v[170:171], 0
    s_cmp_gt_i32 s64, 0
    ds_read_b128 v[48:51], v139 offset:3200
    s_nop 1
    v_cvt_pk_bf16_f32 v34, v8, v9
    v_mfma_f32_16x16x32_bf16 v[68:71], v[112:115], a[168:171], 0
    s_cselect_b32 s26, 100270464, 0
    ds_read_b128 v[76:79], v138 offset:3200
    v_cvt_pk_bf16_f32 v35, v10, v11
    v_mfma_f32_16x16x32_bf16 v[68:71], v[108:111], a[172:175], v[68:71]
    s_cselect_b32 s56, s56, 0
    ds_read_b128 v[60:63], v139 offset:3328
    v_add_u32 v139, s50, v139
    v_mfma_f32_16x16x32_bf16 v[68:71], v[92:95], a[176:179], v[68:71]
    s_add_u32 s65, s65, 1
    ds_read_b128 v[36:39], v138 offset:3328
    v_add_u32 v138, s50, v138
    v_mfma_f32_16x16x32_bf16 v[68:71], v[104:107], a[180:183], v[68:71]
    s_cmp_ge_i32 s65, 2
    v_rsq_f32 v40, v40
    v_mfma_f32_16x16x32_bf16 v[68:71], v[80:83], a[184:187], v[68:71]
    s_cselect_b32 s30, 100270464, 0
    v_rsq_f32 v41, v41
    v_mfma_f32_16x16x32_bf16 v[68:71], v[12:15], a[188:191], v[68:71]
    s_add_u32 s67, s46, s54
    v_mul_f32 v40, s55, v40
    v_mul_f32 v41, 0.5, v41
    v_mfma_f32_16x16x32_bf16 v[8:11], v[112:115], a[192:195], 0
    s_add_u32 m0, s67, 0
    v_mul_f32 v64, v64, v40
    v_mul_f32 v65, v65, v40
    v_mfma_f32_16x16x32_bf16 v[8:11], v[108:111], a[196:199], v[8:11]
    v_cvt_pk_bf16_f32 v30, v68, v69
    v_cvt_pk_bf16_f32 v31, v70, v71
    v_mfma_f32_16x16x32_bf16 v[8:11], v[92:95], a[200:203], v[8:11]
    v_cvt_pk_f16_f32 v92, v64, v65
    v_mul_f32 v66, v66, v40
    v_mfma_f32_16x16x32_bf16 v[8:11], v[104:107], a[204:207], v[8:11]
    v_mul_f32 v67, v67, v40
    v_cvt_pk_f16_f32 v93, v66, v67
    v_mfma_f32_16x16x32_bf16 v[8:11], v[80:83], a[208:211], v[8:11]
    s_waitcnt lgkmcnt(0)
    v_mul_f32 v56, v56, v40
    v_mul_f32 v57, v57, v40
    v_mfma_f32_16x16x32_bf16 v[8:11], v[12:15], a[212:215], v[8:11]
    s_barrier
    buffer_load_dwordx4 v130, s[24:27], s56 offen nt lds
    v_cvt_pk_f16_f32 v94, v56, v57
    v_mfma_f32_16x16x32_bf16 v[12:15], a[0:3], v[100:103], 0
    s_add_u32 m0, s67, 1024
    v_mul_f32 v58, v58, v40
    v_mul_f32 v59, v59, v40
    v_mfma_f32_16x16x32_bf16 v[12:15], a[4:7], v[96:99], v[12:15]
    buffer_load_dwordx4 v129, s[24:27], s56 offen nt lds
    v_cvt_pk_f16_f32 v95, v58, v59
    v_mfma_f32_16x16x32_bf16 v[12:15], a[8:11], v[48:51], v[12:15]
    v_mul_f32 v4, v4, v40
    v_mul_f32 v5, v5, v40
    v_mfma_f32_16x16x32_bf16 v[12:15], a[12:15], v[76:79], v[12:15]
    v_cvt_pk_f16_f32 v150, v4, v5
    v_mul_f32 v6, v6, v40
    v_mfma_f32_16x16x32_bf16 v[12:15], a[16:19], v[60:63], v[12:15]
    v_mul_f32 v7, v7, v40
    v_cvt_pk_f16_f32 v151, v6, v7
    v_mfma_f32_16x16x32_bf16 v[12:15], a[20:23], v[36:39], v[12:15]
    v_mul_f32 v52, v52, v41
    v_mul_f32 v53, v53, v41
    v_mfma_f32_16x16x32_bf16 v[4:7], a[24:27], v[100:103], 0
    s_add_u32 m0, s67, 2048
    v_cvt_pk_f16_f32 v80, v52, v53
    v_mul_f32 v54, v54, v41
    v_mfma_f32_16x16x32_bf16 v[4:7], a[28:31], v[96:99], v[4:7]
    buffer_load_dwordx4 v128, s[24:27], s56 offen nt lds
    v_mul_f32 v55, v55, v41
    v_mfma_f32_16x16x32_bf16 v[4:7], a[32:35], v[48:51], v[4:7]
    v_cvt_pk_f16_f32 v81, v54, v55
    v_mul_f32 v0, v0, v41
    v_mfma_f32_16x16x32_bf16 v[4:7], a[36:39], v[76:79], v[4:7]
    v_mul_f32 v1, v1, v41
    v_cvt_pk_f16_f32 v82, v0, v1
    v_mfma_f32_16x16x32_bf16 v[4:7], a[40:43], v[60:63], v[4:7]
    v_mul_f32 v2, v2, v41
    v_mul_f32 v3, v3, v41
    v_mfma_f32_16x16x32_bf16 v[4:7], a[44:47], v[36:39], v[4:7]
    v_cvt_pk_f16_f32 v83, v2, v3
    v_mul_f32 v24, v24, v41
    v_mfma_f32_16x16x32_bf16 v[0:3], a[48:51], v[100:103], 0
    v_mul_f32 v25, v25, v41
    v_cvt_pk_f16_f32 v84, v24, v25
    v_mfma_f32_16x16x32_bf16 v[0:3], a[52:55], v[96:99], v[0:3]
    v_mul_f32 v26, v26, v41
    v_mul_f32 v27, v27, v41
    v_mfma_f32_16x16x32_bf16 v[0:3], a[56:59], v[48:51], v[0:3]
    v_cvt_pk_f16_f32 v85, v26, v27
    v_cvt_pk_bf16_f32 v22, v8, v9
    v_mfma_f32_16x16x32_bf16 v[0:3], a[60:63], v[76:79], v[0:3]
    v_cvt_pk_bf16_f32 v23, v10, v11
    v_fma_f32 v124, v12, v12, s41
    v_mfma_f32_16x16x32_bf16 v[0:3], a[64:67], v[60:63], v[0:3]
    v_fmac_f32 v124, v13, v13
    v_fmac_f32 v124, v14, v14
    v_mfma_f32_16x16x32_bf16 v[0:3], a[68:71], v[36:39], v[0:3]
    v_fmac_f32 v124, v15, v15
    v_fmac_f32 v124, v4, v4
    v_mfma_f32_16x16x32_bf16 v[56:59], a[72:75], v[100:103], 0
    v_fmac_f32 v124, v5, v5
    v_fmac_f32 v124, v6, v6
    v_mfma_f32_16x16x32_bf16 v[56:59], a[76:79], v[96:99], v[56:59]
    s_nop 0
    v_fmac_f32 v124, v7, v7
    v_fmac_f32 v124, v0, v0
    v_mfma_f32_16x16x32_bf16 v[56:59], a[80:83], v[48:51], v[56:59]
    v_fmac_f32 v124, v1, v1
    v_fmac_f32 v124, v2, v2
    v_mfma_f32_16x16x32_bf16 v[56:59], a[84:87], v[76:79], v[56:59]
    v_fmac_f32 v124, v3, v3
    v_mfma_f32_16x16x32_bf16 v[56:59], a[88:91], v[60:63], v[56:59]
    v_mfma_f32_16x16x32_bf16 v[56:59], a[92:95], v[36:39], v[56:59]
    s_nop 1
    v_mfma_f32_16x16x32_bf16 v[8:11], a[96:99], v[100:103], 0
    s_nop 2
    v_mfma_f32_16x16x32_bf16 v[8:11], a[100:103], v[96:99], v[8:11]
    s_nop 0
    v_fma_f32 v47, v56, v56, s41
    v_fmac_f32 v47, v57, v57
    v_mfma_f32_16x16x32_bf16 v[8:11], a[104:107], v[48:51], v[8:11]
    v_fmac_f32 v47, v58, v58
    v_fmac_f32 v47, v59, v59
    v_mfma_f32_16x16x32_bf16 v[8:11], a[108:111], v[76:79], v[8:11]
    v_mfma_f32_16x16x32_bf16 v[8:11], a[112:115], v[60:63], v[8:11]
    s_add_u32 m0, s67, 3072
    s_nop 0
    buffer_load_dwordx4 v127, s[24:27], s56 offen nt lds
    v_mfma_f32_16x16x32_bf16 v[8:11], a[116:119], v[36:39], v[8:11]
    s_add_u32 m0, s67, 4096
    s_nop 0
    v_mfma_f32_16x16x32_bf16 v[40:43], a[120:123], v[100:103], 0
    s_nop 1
    buffer_load_dwordx4 v126, s[24:27], s56 offen nt lds
    v_mfma_f32_16x16x32_bf16 v[40:43], a[124:127], v[96:99], v[40:43]
    s_nop 0
    v_fmac_f32 v47, v8, v8
    v_fmac_f32 v47, v9, v9
    v_mfma_f32_16x16x32_bf16 v[40:43], a[128:131], v[48:51], v[40:43]
    v_fmac_f32 v47, v10, v10
    v_fmac_f32 v47, v11, v11
    v_mfma_f32_16x16x32_bf16 v[40:43], a[132:135], v[76:79], v[40:43]
    v_mfma_f32_16x16x32_bf16 v[40:43], a[136:139], v[60:63], v[40:43]
    v_mfma_f32_16x16x32_bf16 v[40:43], a[140:143], v[36:39], v[40:43]
    s_waitcnt vmcnt(5)
    s_nop 0
    v_mfma_f32_16x16x32_bf16 v[24:27], v[100:103], a[144:147], 0
    s_barrier
    s_nop 1
    v_mfma_f32_16x16x32_bf16 v[24:27], v[96:99], a[148:151], v[24:27]
    s_lshl_b32 s93, s68, 10
    v_fmac_f32 v47, v40, v40
    v_fmac_f32 v47, v41, v41
    v_mfma_f32_16x16x32_bf16 v[24:27], v[48:51], a[152:155], v[24:27]
    s_mov_b32 s53, s47
    v_fmac_f32 v47, v42, v42
    v_fmac_f32 v47, v43, v43
    v_mfma_f32_16x16x32_bf16 v[24:27], v[76:79], a[156:159], v[24:27]
    s_mov_b32 s47, s46
    v_cvt_pk_bf16_f32 v170, v124, v47
    v_add_u32 v47, s93, v131
    v_mfma_f32_16x16x32_bf16 v[24:27], v[60:63], a[160:163], v[24:27]
    s_mov_b32 s46, s45
    ds_read_b128 v[68:71], v134 offset:32
    v_mfma_f32_16x16x32_bf16 v[24:27], v[36:39], a[164:167], v[24:27]
    s_mov_b32 s45, s44
    ds_read_b64 v[72:73], v134 offset:48
    s_nop 0
    v_mfma_f32_16x16x16_bf16 v[52:55], v[216:217], v[170:171], 0
    s_mov_b32 s44, s53
    s_nop 2
    v_cvt_pk_bf16_f32 v164, v24, v25
    v_mfma_f32_16x16x32_bf16 v[64:67], v[100:103], a[168:171], 0
    s_sub_u32 s48, s44, s46
    v_cvt_pk_bf16_f32 v165, v26, v27
    v_add_u32 v139, s48, v139
    v_mfma_f32_16x16x32_bf16 v[64:67], v[96:99], a[172:175], v[64:67]
    s_sub_u32 s49, s46, s45
    v_rsq_f32 v52, v52
    v_mfma_f32_16x16x32_bf16 v[64:67], v[48:51], a[176:179], v[64:67]
    v_rsq_f32 v53, v53
    v_mfma_f32_16x16x32_bf16 v[64:67], v[76:79], a[180:183], v[64:67]
    v_mul_f32 v52, s55, v52
    v_mul_f32 v53, 0.5, v53
    v_mfma_f32_16x16x32_bf16 v[64:67], v[60:63], a[184:187], v[64:67]
    v_mul_f32 v56, v56, v53
    v_mul_f32 v57, v57, v53
    v_mfma_f32_16x16x32_bf16 v[64:67], v[36:39], a[188:191], v[64:67]
    ds_read_u16 v166, v133 offset:56
    v_cvt_pk_f16_f32 v74, v56, v57
    v_mfma_f32_16x16x32_bf16 v[24:27], v[100:103], a[192:195], 0
    ds_read_u16 v162, v133 offset:64
    v_mul_f32 v58, v58, v53
    v_mfma_f32_16x16x32_bf16 v[24:27], v[96:99], a[196:199], v[24:27]
    s_nop 0
    ds_read_u16 v158, v133 offset:72
    v_cvt_pk_bf16_f32 v160, v64, v65
    v_mfma_f32_16x16x32_bf16 v[24:27], v[48:51], a[200:203], v[24:27]
    ds_read_b128 v[48:51], v134 offset:0
    v_cvt_pk_bf16_f32 v161, v66, v67
    v_mfma_f32_16x16x32_bf16 v[24:27], v[76:79], a[204:207], v[24:27]
    ds_read_b64 v[142:143], v134 offset:16
    v_mul_f32 v59, v59, v53
    v_mfma_f32_16x16x32_bf16 v[24:27], v[60:63], a[208:211], v[24:27]
    v_cvt_pk_f16_f32 v75, v58, v59
    v_mul_f32 v8, v8, v53
    v_mfma_f32_16x16x32_bf16 v[24:27], v[36:39], a[212:215], v[24:27]
    v_mul_f32 v9, v9, v53
    v_cvt_pk_f16_f32 v76, v8, v9
    v_mfma_f32_16x16x32_f16 v[36:39], v[86:89], v[16:19], v[204:207]
    v_mul_f32 v10, v10, v53
    v_mul_f32 v11, v11, v53
    v_mfma_f32_16x16x32_f16 v[36:39], v[88:91], v[152:155], v[36:39]
    v_cvt_pk_f16_f32 v77, v10, v11
    v_mul_f32 v40, v40, v53
    v_mfma_f32_16x16x32_f16 v[64:67], v[80:83], v[16:19], v[200:203]
    v_mul_f32 v41, v41, v53
    v_cvt_pk_f16_f32 v78, v40, v41
    v_mfma_f32_16x16x32_f16 v[64:67], v[82:85], v[152:155], v[64:67]
    s_waitcnt lgkmcnt(3)
    v_mul_f32 v42, v42, v53
    v_mul_f32 v43, v43, v53
    v_mfma_f32_16x16x32_f16 v[8:11], v[68:71], v[16:19], v[208:211]
    v_cvt_pk_f16_f32 v79, v42, v43
    v_mul_f32 v12, v12, v52
    v_mfma_f32_16x16x32_f16 v[8:11], v[70:73], v[152:155], v[8:11]
    v_mul_f32 v13, v13, v52
    v_cvt_pk_f16_f32 v40, v12, v13
    v_mfma_f32_16x16x32_f16 v[60:63], v[74:77], v[16:19], v[196:199]
    v_mul_f32 v14, v14, v52
    v_mul_f32 v15, v15, v52
    v_mfma_f32_16x16x32_f16 v[60:63], v[76:79], v[152:155], v[60:63]
    s_waitcnt lgkmcnt(0)
    v_cvt_pk_f16_f32 v41, v14, v15
    v_mul_f32 v4, v4, v52
    v_mfma_f32_16x16x32_f16 v[16:19], v[48:51], v[86:89], v[208:211]
    v_mul_f32 v5, v5, v52
    v_cvt_pk_f16_f32 v42, v4, v5
    v_mfma_f32_16x16x32_f16 v[16:19], v[140:143], v[88:91], v[16:19]
    v_mul_f32 v6, v6, v52
    v_mul_f32 v7, v7, v52
    v_mfma_f32_16x16x32_f16 v[12:15], v[48:51], v[80:83], v[208:211]
    v_cvt_pk_f16_f32 v43, v6, v7
    v_mul_f32 v0, v0, v52
    v_mfma_f32_16x16x32_f16 v[12:15], v[140:143], v[82:85], v[12:15]
    v_mul_f32 v1, v1, v52
    v_cvt_pk_f16_f32 v146, v0, v1
    v_mfma_f32_16x16x32_f16 v[4:7], v[48:51], v[74:77], v[208:211]
    v_mul_f32 v2, v2, v52
    v_mul_f32 v3, v3, v52
    v_mfma_f32_16x16x32_f16 v[4:7], v[140:143], v[76:79], v[4:7]
    v_cvt_pk_f16_f32 v147, v2, v3
    v_cvt_pk_bf16_f32 v156, v24, v25
    v_mfma_f32_16x16x32_f16 v[0:3], v[48:51], v[68:71], v[208:211]
    v_cvt_pk_bf16_f32 v157, v26, v27
    v_max3_f32 v124, v36, v37, v38
    v_mfma_f32_16x16x32_f16 v[0:3], v[140:143], v[70:73], v[0:3]
    v_max3_f32 v124, v124, v39, v64
    v_max3_f32 v124, v124, v65, v66
    v_mfma_f32_16x16x32_f16 v[52:55], v[86:89], v[92:95], v[192:195]
    v_max3_f32 v124, v124, v67, v60
    v_max3_f32 v124, v124, v61, v62
    v_mfma_f32_16x16x32_f16 v[52:55], v[88:91], v[148:151], v[52:55]
    v_max3_f32 v124, v124, v63, v8
    v_mov_b32 v142, v124
    v_mfma_f32_16x16x32_f16 v[56:59], v[80:83], v[92:95], v[188:191]
    s_nop 0
    v_permlane32_swap_b32 v142, v124
    v_mfma_f32_16x16x32_f16 v[56:59], v[82:85], v[148:151], v[56:59]
    v_max_f32 v124, v142, v124
    v_mov_b32 v142, v124
    v_mfma_f32_16x16x32_f16 v[48:51], v[74:77], v[92:95], v[184:187]
    s_nop 0
    v_permlane16_swap_b32 v142, v124
    v_mfma_f32_16x16x32_f16 v[48:51], v[76:79], v[148:151], v[48:51]
    v_max_f32 v124, v142, v124
    v_sub_f32 v36, v36, v124
    v_mfma_f32_16x16x32_f16 v[24:27], v[68:71], v[92:95], v[208:211]
    v_sub_f32 v37, v37, v124
    v_sub_f32 v38, v38, v124
    v_mfma_f32_16x16x32_f16 v[24:27], v[70:73], v[148:151], v[24:27]
    v_sub_f32 v39, v39, v124
    v_sub_f32 v64, v64, v124
    v_sub_f32 v65, v65, v124
    v_sub_f32 v66, v66, v124
    v_sub_f32 v67, v67, v124
    v_sub_f32 v60, v60, v124
    v_sub_f32 v61, v61, v124
    v_sub_f32 v62, v62, v124
    v_sub_f32 v63, v63, v124
    v_sub_f32 v8, v8, v124
    v_exp_f32 v36, v36
    v_exp_f32 v37, v37
    v_exp_f32 v38, v38
    v_exp_f32 v39, v39
    v_cvt_pk_bf16_f32 v36, v36, v37
    v_cvt_pk_bf16_f32 v37, v38, v39
    v_exp_f32 v64, v64
    v_exp_f32 v65, v65
    v_exp_f32 v66, v66
    v_exp_f32 v67, v67
    v_cvt_pk_bf16_f32 v38, v64, v65
    v_cvt_pk_bf16_f32 v39, v66, v67
    v_exp_f32 v60, v60
    v_exp_f32 v61, v61
    v_exp_f32 v62, v62
    v_exp_f32 v63, v63
    v_cvt_pk_bf16_f32 v168, v60, v61
    v_cvt_pk_bf16_f32 v169, v62, v63
    v_exp_f32 v8, v8
    v_mov_b32_dpp v19, v15 quad_perm:[0,1,2,3] row_mask:0x2 bank_mask:0xf
    v_cvt_pk_bf16_f32 v170, v8, 0
    v_mfma_f32_16x16x32_bf16 v[8:11], v[220:223], v[36:39], 0
    v_mov_b32_dpp v19, v7 quad_perm:[0,1,2,3] row_mask:0x4 bank_mask:0xf
    v_max3_f32 v124, v52, v53, v54
    v_mfma_f32_16x16x32_bf16 v[8:11], v[220:223], v[168:171], v[8:11]
    v_mov_b32_dpp v19, v3 quad_perm:[0,1,2,3] row_mask:0x8 bank_mask:0xf
    v_mov_b32 v143, v19
    v_mfma_f32_16x16x32_bf16 v[4:7], v[32:35], v[36:39], 0
    s_nop 0
    v_max_f32_dpp v143, v143, v143 row_ror:8 row_mask:0xf bank_mask:0xf
    v_max3_f32 v124, v124, v55, v56
    v_mfma_f32_16x16x32_bf16 v[4:7], v[164:167], v[168:171], v[4:7]
    v_max_f32_dpp v143, v143, v143 row_ror:4 row_mask:0xf bank_mask:0xf
    v_max3_f32 v124, v124, v57, v58
    v_mfma_f32_16x16x32_bf16 v[12:15], v[28:31], v[36:39], 0
    v_max_f32_dpp v143, v143, v143 row_ror:2 row_mask:0xf bank_mask:0xf
    v_max3_f32 v124, v124, v59, v48
    v_mfma_f32_16x16x32_bf16 v[12:15], v[160:163], v[168:171], v[12:15]
    v_max_f32_dpp v143, v143, v143 row_ror:1 row_mask:0xf bank_mask:0xf
    v_mov_b32 v142, v143
    v_mfma_f32_16x16x32_bf16 v[0:3], v[20:23], v[36:39], 0
    s_nop 0
    v_permlane32_swap_b32 v142, v143
    v_mfma_f32_16x16x32_bf16 v[0:3], v[156:159], v[168:171], v[0:3]
    v_max_f32 v143, v142, v143
    v_mov_b32 v142, v143
    v_rcp_f32 v8, v8
    v_max3_f32 v124, v124, v49, v50
    v_permlane16_swap_b32 v142, v143
    v_max_f32 v143, v142, v143
    v_sub_f32 v19, v19, v143
    v_exp_f32 v19, v19
    v_mul_f32 v4, v4, v8
    v_cvt_pk_bf16_f32 v19, v19, v19
    ds_write_b16 v125, v19
    v_mul_f32 v5, v5, v8
    v_cvt_pk_bf16_f32 v4, v4, v5
    ds_read_b128 v[64:67], v134
    v_mul_f32 v6, v6, v8
    v_mul_f32 v7, v7, v8
    v_cvt_pk_bf16_f32 v5, v6, v7
    ds_read_b128 v[60:63], v134 offset:16
    v_mfma_f32_16x16x32_f16 v[16:19], v[86:89], v[40:43], v[180:183]
    v_mul_f32 v12, v12, v8
    v_mul_f32 v13, v13, v8
    v_mfma_f32_16x16x32_f16 v[16:19], v[88:91], v[144:147], v[16:19]
    ds_write_b64 v137, v[4:5] offset:0
    v_mfma_f32_16x16x32_f16 v[36:39], v[80:83], v[40:43], v[176:179]
    v_cvt_pk_bf16_f32 v6, v12, v13
    v_mul_f32 v14, v14, v8
    v_mfma_f32_16x16x32_f16 v[36:39], v[82:85], v[144:147], v[36:39]
    v_mul_f32 v15, v15, v8
    v_cvt_pk_bf16_f32 v7, v14, v15
    v_mfma_f32_16x16x32_f16 v[12:15], v[74:77], v[40:43], v[172:175]
    ds_write_b64 v137, v[6:7] offset:8
    v_mfma_f32_16x16x32_f16 v[12:15], v[76:79], v[144:147], v[12:15]
    v_mul_f32 v0, v0, v8
    v_mul_f32 v1, v1, v8
    v_mfma_f32_16x16x32_f16 v[4:7], v[68:71], v[40:43], v[208:211]
    v_cvt_pk_bf16_f32 v142, v0, v1
    v_mul_f32 v2, v2, v8
    v_mfma_f32_16x16x32_f16 v[4:7], v[70:73], v[144:147], v[4:7]
    s_waitcnt lgkmcnt(2)
    v_mul_f32 v3, v3, v8
    v_cvt_pk_bf16_f32 v143, v2, v3
    v_mfma_f32_16x16x32_bf16 v[0:3], v[64:67], v[32:35], 0
    ds_write_b64 v136, v[142:143] offset:0
    v_mfma_f32_16x16x32_bf16 v[0:3], v[60:63], v[164:167], v[0:3]
    v_max3_f32 v124, v124, v51, v25
    v_mov_b32 v142, v124
    v_mfma_f32_16x16x32_bf16 v[40:43], v[64:67], v[28:31], 0
    s_nop 0
    v_permlane32_swap_b32 v142, v124
    v_mfma_f32_16x16x32_bf16 v[40:43], v[60:63], v[160:163], v[40:43]
    v_max_f32 v124, v142, v124
    v_mov_b32 v142, v124
    v_mfma_f32_16x16x32_bf16 v[8:11], v[64:67], v[20:23], 0
    s_nop 0
    v_permlane16_swap_b32 v142, v124
    v_mfma_f32_16x16x32_bf16 v[8:11], v[60:63], v[156:159], v[8:11]
    v_max_f32 v124, v142, v124
    v_sub_f32 v52, v52, v124
    v_sub_f32 v53, v53, v124
    v_sub_f32 v54, v54, v124
    v_sub_f32 v55, v55, v124
    v_sub_f32 v56, v56, v124
    v_sub_f32 v57, v57, v124
    v_sub_f32 v58, v58, v124
    v_sub_f32 v59, v59, v124
    v_sub_f32 v48, v48, v124
    v_sub_f32 v49, v49, v124
    v_sub_f32 v50, v50, v124
    v_sub_f32 v51, v51, v124
    v_sub_f32 v25, v25, v124
    v_exp_f32 v52, v52
    v_exp_f32 v53, v53
    v_exp_f32 v54, v54
    v_exp_f32 v55, v55
    v_cvt_pk_bf16_f32 v52, v52, v53
    v_cvt_pk_bf16_f32 v53, v54, v55
    v_exp_f32 v56, v56
    v_exp_f32 v57, v57
    v_exp_f32 v58, v58
    v_exp_f32 v59, v59
    v_cvt_pk_bf16_f32 v54, v56, v57
    v_cvt_pk_bf16_f32 v55, v58, v59
    v_exp_f32 v48, v48
    v_exp_f32 v49, v49
    v_exp_f32 v50, v50
    v_exp_f32 v51, v51
    v_cvt_pk_bf16_f32 v168, v48, v49
    v_cvt_pk_bf16_f32 v169, v50, v51
    v_exp_f32 v25, v25
    v_mov_b32_dpp v3, v43 quad_perm:[0,1,2,3] row_mask:0x2 bank_mask:0xf
    v_cvt_pk_bf16_f32 v170, v25, 0
    v_mfma_f32_16x16x32_bf16 v[24:27], v[220:223], v[52:55], 0
    v_mov_b32_dpp v3, v11 quad_perm:[0,1,2,3] row_mask:0x4 bank_mask:0xf
    v_cvt_pk_bf16_f32 v3, v3, v3
    v_mfma_f32_16x16x32_bf16 v[24:27], v[220:223], v[168:171], v[24:27]
    ds_write_b16 v133, v3 offset:56
    v_mfma_f32_16x16x32_bf16 v[40:43], v[32:35], v[52:55], 0
    ds_write_b96 v47, v[44:46] offset:4096
    v_mfma_f32_16x16x32_bf16 v[40:43], v[164:167], v[168:171], v[40:43]
    v_max3_f32 v124, v16, v17, v18
    v_max3_f32 v124, v124, v19, v36
    v_mfma_f32_16x16x32_bf16 v[48:51], v[28:31], v[52:55], 0
    ds_read_b128 v[8:11], v139 offset:0
    v_max3_f32 v124, v124, v37, v38
    v_mfma_f32_16x16x32_bf16 v[48:51], v[160:163], v[168:171], v[48:51]
    ds_read_b128 v[0:3], v139 offset:128
    v_max3_f32 v124, v124, v39, v12
    v_mfma_f32_16x16x32_bf16 v[44:47], v[20:23], v[52:55], 0
    ds_read_b128 v[68:71], v139 offset:256
    v_max3_f32 v124, v124, v13, v14
    v_mfma_f32_16x16x32_bf16 v[44:47], v[156:159], v[168:171], v[44:47]
    v_rcp_f32 v24, v24
    v_max3_f32 v124, v124, v15, v6
    v_mul_f32 v40, v40, v24
    v_mul_f32 v41, v41, v24
    v_cvt_pk_bf16_f32 v40, v40, v41
    v_mul_f32 v42, v42, v24
    v_mul_f32 v43, v43, v24
    v_cvt_pk_bf16_f32 v41, v42, v43
    v_mul_f32 v48, v48, v24
    v_mul_f32 v49, v49, v24
    v_cvt_pk_bf16_f32 v42, v48, v49
    v_mul_f32 v50, v50, v24
    v_mul_f32 v51, v51, v24
    v_cvt_pk_bf16_f32 v43, v50, v51
    v_mul_f32 v44, v44, v24
    v_mul_f32 v45, v45, v24
    v_cvt_pk_bf16_f32 v146, v44, v45
    v_mul_f32 v46, v46, v24
    v_mul_f32 v47, v47, v24
    v_cvt_pk_bf16_f32 v147, v46, v47
    s_waitcnt lgkmcnt(2)
    v_mfma_f32_16x16x32_bf16 v[24:27], a[0:3], v[8:11], 0
    ds_write_b64 v137, v[40:41] offset:1536
    v_mov_b32 v142, v124
    v_add_u32 v138, s48, v138
    s_nop 0
    v_permlane32_swap_b32 v142, v124
    ds_write_b64 v137, v[42:43] offset:1544
    v_max_f32 v124, v142, v124
    v_mov_b32 v142, v124
    s_nop 1
    v_permlane16_swap_b32 v142, v124
    ds_write_b64 v136, v[146:147] offset:1536
    v_max_f32 v124, v142, v124
    v_sub_f32 v16, v16, v124
    v_sub_f32 v17, v17, v124
    v_sub_f32 v18, v18, v124
    v_sub_f32 v19, v19, v124
    v_sub_f32 v36, v36, v124
    v_sub_f32 v37, v37, v124
    v_sub_f32 v38, v38, v124
    v_sub_f32 v39, v39, v124
    v_sub_f32 v12, v12, v124
    v_sub_f32 v13, v13, v124
    v_sub_f32 v14, v14, v124
    v_sub_f32 v15, v15, v124
    v_sub_f32 v6, v6, v124
    v_exp_f32 v16, v16
    v_exp_f32 v17, v17
    v_exp_f32 v18, v18
    v_exp_f32 v19, v19
    v_cvt_pk_bf16_f32 v16, v16, v17
    v_cvt_pk_bf16_f32 v17, v18, v19
    v_exp_f32 v36, v36
    v_exp_f32 v37, v37
    v_exp_f32 v38, v38
    v_exp_f32 v39, v39
    v_cvt_pk_bf16_f32 v18, v36, v37
    v_cvt_pk_bf16_f32 v19, v38, v39
    v_exp_f32 v12, v12
    v_exp_f32 v13, v13
    v_exp_f32 v14, v14
    v_exp_f32 v15, v15
    v_cvt_pk_bf16_f32 v168, v12, v13
    v_cvt_pk_bf16_f32 v169, v14, v15
    v_exp_f32 v6, v6
    ds_read_b128 v[64:67], v138 offset:0
    v_cvt_pk_bf16_f32 v170, v6, 0
    v_mfma_f32_16x16x32_bf16 v[4:7], v[220:223], v[16:19], 0
    ds_read_b128 v[72:75], v138 offset:128
    v_mfma_f32_16x16x32_bf16 v[4:7], v[220:223], v[168:171], v[4:7]
    ds_read_b128 v[76:79], v138 offset:256
    s_nop 0
    v_mfma_f32_16x16x32_bf16 v[12:15], v[32:35], v[16:19], 0
    s_nop 2
    v_mfma_f32_16x16x32_bf16 v[12:15], v[164:167], v[168:171], v[12:15]
    s_nop 0
    v_rcp_f32 v4, v4
    v_mfma_f32_16x16x32_bf16 v[36:39], v[28:31], v[16:19], 0
    s_nop 2
    v_mfma_f32_16x16x32_bf16 v[36:39], v[160:163], v[168:171], v[36:39]
    s_nop 0
    v_mul_f32 v12, v12, v4
    v_mul_f32 v13, v13, v4
    v_mfma_f32_16x16x32_bf16 v[60:63], v[20:23], v[16:19], 0
    v_cvt_pk_bf16_f32 v40, v12, v13
    v_mul_f32 v14, v14, v4
    v_mfma_f32_16x16x32_bf16 v[60:63], v[156:159], v[168:171], v[60:63]
    v_mul_f32 v15, v15, v4
    v_cvt_pk_bf16_f32 v41, v14, v15
.p2align 6
L_loopS0:
    ds_write_b64 v137, v[40:41] offset:3072
    s_waitcnt lgkmcnt(2)
    v_mfma_f32_16x16x32_bf16 v[24:27], a[4:7], v[64:67], v[24:27]
    v_mul_f32 v36, v36, v4
    v_mul_f32 v37, v37, v4
    v_mfma_f32_16x16x32_bf16 v[24:27], a[8:11], v[0:3], v[24:27]
    v_cvt_pk_bf16_f32 v42, v36, v37
    v_mul_f32 v38, v38, v4
    v_mfma_f32_16x16x32_bf16 v[24:27], a[12:15], v[72:75], v[24:27]
    v_mul_f32 v39, v39, v4
    v_cvt_pk_bf16_f32 v43, v38, v39
    v_mfma_f32_16x16x32_bf16 v[24:27], a[16:19], v[68:71], v[24:27]
    s_waitcnt lgkmcnt(1)
    ds_write_b64 v137, v[42:43] offset:3080
    v_mfma_f32_16x16x32_bf16 v[24:27], a[20:23], v[76:79], v[24:27]
    v_mul_f32 v60, v60, v4
    v_mul_f32 v61, v61, v4
    v_mfma_f32_16x16x32_bf16 v[20:23], a[24:27], v[8:11], 0
    v_cvt_pk_bf16_f32 v36, v60, v61
    v_mul_f32 v62, v62, v4
    v_mfma_f32_16x16x32_bf16 v[20:23], a[28:31], v[64:67], v[20:23]
    v_mul_f32 v63, v63, v4
    v_cvt_pk_bf16_f32 v37, v62, v63
    v_mfma_f32_16x16x32_bf16 v[20:23], a[32:35], v[0:3], v[20:23]
    ds_write_b64 v136, v[36:37] offset:3072
    v_mfma_f32_16x16x32_bf16 v[20:23], a[36:39], v[72:75], v[20:23]
    v_fmac_f32 v155, v52, v52
    v_fmac_f32 v155, v53, v53
    v_mfma_f32_16x16x32_bf16 v[20:23], a[40:43], v[68:71], v[20:23]
    v_fmac_f32 v155, v54, v54
    v_fmac_f32 v155, v55, v55
    v_mfma_f32_16x16x32_bf16 v[20:23], a[44:47], v[76:79], v[20:23]
    v_fma_f32 v170, v12, v12, s42
    v_fmac_f32 v170, v13, v13
    v_mfma_f32_16x16x32_bf16 v[4:7], a[48:51], v[8:11], 0
    v_fmac_f32 v170, v14, v14
    v_fmac_f32 v170, v15, v15
    v_mfma_f32_16x16x32_bf16 v[4:7], a[52:55], v[64:67], v[4:7]
    v_fmac_f32 v170, v16, v16
    v_fmac_f32 v170, v17, v17
    v_mfma_f32_16x16x32_bf16 v[4:7], a[56:59], v[0:3], v[4:7]
    v_fmac_f32 v170, v18, v18
    v_fmac_f32 v170, v19, v19
    v_mfma_f32_16x16x32_bf16 v[4:7], a[60:63], v[72:75], v[4:7]
    v_fmac_f32 v170, v56, v56
    v_fmac_f32 v170, v57, v57
    v_mfma_f32_16x16x32_bf16 v[4:7], a[64:67], v[68:71], v[4:7]
    v_fmac_f32 v170, v58, v58
    v_fmac_f32 v170, v59, v59
    v_mfma_f32_16x16x32_bf16 v[4:7], a[68:71], v[76:79], v[4:7]
    v_cvt_pk_bf16_f32 v154, v154, v155
    v_cvt_pk_bf16_f32 v155, v170, v170
    v_mfma_f32_16x16x32_bf16 v[80:83], a[72:75], v[8:11], 0
    ds_write_b64 v132, v[154:155]
    v_mfma_f32_16x16x32_bf16 v[80:83], a[76:79], v[64:67], v[80:83]
    v_add_u32 v137, s49, v137
    v_add_u32 v136, s49, v136
    v_mfma_f32_16x16x32_bf16 v[80:83], a[80:83], v[0:3], v[80:83]
    v_fma_f32 v154, v24, v24, s41
    v_fmac_f32 v154, v25, v25
    v_mfma_f32_16x16x32_bf16 v[80:83], a[84:87], v[72:75], v[80:83]
    v_fmac_f32 v154, v26, v26
    v_fmac_f32 v154, v27, v27
    v_mfma_f32_16x16x32_bf16 v[80:83], a[88:91], v[68:71], v[80:83]
    v_fmac_f32 v154, v20, v20
    v_fmac_f32 v154, v21, v21
    v_mfma_f32_16x16x32_bf16 v[80:83], a[92:95], v[76:79], v[80:83]
    v_fmac_f32 v154, v22, v22
    v_fmac_f32 v154, v23, v23
    v_mfma_f32_16x16x32_bf16 v[60:63], a[96:99], v[8:11], 0
    v_fmac_f32 v154, v4, v4
    v_fmac_f32 v154, v5, v5
    v_mfma_f32_16x16x32_bf16 v[60:63], a[100:103], v[64:67], v[60:63]
    v_fmac_f32 v154, v6, v6
    v_fmac_f32 v154, v7, v7
    v_mfma_f32_16x16x32_bf16 v[60:63], a[104:107], v[0:3], v[60:63]
    s_waitcnt lgkmcnt(0)
    v_fma_f32 v155, v80, v80, s41
    v_fmac_f32 v155, v81, v81
    v_mfma_f32_16x16x32_bf16 v[60:63], a[108:111], v[72:75], v[60:63]
    s_barrier
    ds_read_b128 v[36:39], v131 offset:0
    v_fmac_f32 v155, v82, v82
    v_mfma_f32_16x16x32_bf16 v[60:63], a[112:115], v[68:71], v[60:63]
    ds_read_b128 v[40:43], v131 offset:1024
    v_fmac_f32 v155, v83, v83
    v_mfma_f32_16x16x32_bf16 v[60:63], a[116:119], v[76:79], v[60:63]
    s_nop 1
    v_mfma_f32_16x16x32_bf16 v[104:107], a[120:123], v[8:11], 0
    s_nop 2
    v_mfma_f32_16x16x32_bf16 v[104:107], a[124:127], v[64:67], v[104:107]
    s_nop 0
    v_fmac_f32 v155, v60, v60
    v_fmac_f32 v155, v61, v61
    v_mfma_f32_16x16x32_bf16 v[104:107], a[128:131], v[0:3], v[104:107]
    v_fmac_f32 v155, v62, v62
    v_fmac_f32 v155, v63, v63
    v_mfma_f32_16x16x32_bf16 v[104:107], a[132:135], v[72:75], v[104:107]
    v_mfma_f32_16x16x32_bf16 v[104:107], a[136:139], v[68:71], v[104:107]
    v_mfma_f32_16x16x32_bf16 v[104:107], a[140:143], v[76:79], v[104:107]
    s_nop 1
    v_mfma_f32_16x16x32_bf16 v[120:123], v[8:11], a[144:147], 0
    s_nop 2
    v_mfma_f32_16x16x32_bf16 v[120:123], v[64:67], a[148:151], v[120:123]
    s_nop 0
    v_fmac_f32 v155, v104, v104
    v_fmac_f32 v155, v105, v105
    v_mfma_f32_16x16x32_bf16 v[120:123], v[0:3], a[152:155], v[120:123]
    v_fmac_f32 v155, v106, v106
    v_fmac_f32 v155, v107, v107
    v_mfma_f32_16x16x32_bf16 v[120:123], v[72:75], a[156:159], v[120:123]
    v_cvt_pk_bf16_f32 v170, v154, v155
    v_mfma_f32_16x16x32_bf16 v[120:123], v[68:71], a[160:163], v[120:123]
    v_mfma_f32_16x16x32_bf16 v[120:123], v[76:79], a[164:167], v[120:123]
    s_waitcnt lgkmcnt(0)
    v_mfma_f32_16x16x32_bf16 v[96:99], v[216:219], v[36:39], 0
    s_nop 0
    ds_read_b128 v[116:119], v139 offset:1536
    s_nop 0
    v_mfma_f32_16x16x32_bf16 v[96:99], v[216:219], v[40:43], v[96:99]
    s_nop 0
    ds_read_b128 v[100:103], v138 offset:1536
    v_cvt_pk_bf16_f32 v36, v120, v121
    v_mfma_f32_16x16x16_bf16 v[38:41], v[216:217], v[170:171], 0
    s_nop 0
    ds_read_b128 v[84:87], v139 offset:1664
    v_cvt_pk_bf16_f32 v37, v122, v123
    s_nop 0
    v_rsq_f32 v96, v96
    v_mfma_f32_16x16x32_bf16 v[154:157], v[8:11], a[168:171], 0
    ds_read_b128 v[120:123], v138 offset:1664
    v_mul_f32 v96, s43, v96
    v_mfma_f32_16x16x32_bf16 v[154:157], v[64:67], a[172:175], v[154:157]
    ds_read_b128 v[92:95], v139 offset:1792
    v_mul_f32 v48, v48, v96
    v_mfma_f32_16x16x32_bf16 v[154:157], v[0:3], a[176:179], v[154:157]
    ds_read_b128 v[88:91], v138 offset:1792
    v_mul_f32 v49, v49, v96
    v_mfma_f32_16x16x32_bf16 v[154:157], v[72:75], a[180:183], v[154:157]
    v_rsq_f32 v97, v97
    v_mfma_f32_16x16x32_bf16 v[154:157], v[68:71], a[184:187], v[154:157]
    v_rsq_f32 v98, v98
    v_mfma_f32_16x16x32_bf16 v[154:157], v[76:79], a[188:191], v[154:157]
    v_mul_f32 v97, s43, v97
    v_mul_f32 v98, s43, v98
    v_mfma_f32_16x16x32_bf16 v[112:115], v[8:11], a[192:195], 0
    v_rsq_f32 v38, v38
    v_mfma_f32_16x16x32_bf16 v[112:115], v[64:67], a[196:199], v[112:115]
    v_rsq_f32 v39, v39
    v_mfma_f32_16x16x32_bf16 v[112:115], v[0:3], a[200:203], v[112:115]
    v_mul_f32 v38, s55, v38
    v_mul_f32 v39, 0.5, v39
    v_mfma_f32_16x16x32_bf16 v[112:115], v[72:75], a[204:207], v[112:115]
    v_cvt_pk_bf16_f32 v40, v154, v155
    v_cvt_pk_bf16_f32 v41, v156, v157
    v_mfma_f32_16x16x32_bf16 v[112:115], v[68:71], a[208:211], v[112:115]
    v_mul_f32 v24, v24, v38
    v_mul_f32 v25, v25, v38
    v_mfma_f32_16x16x32_bf16 v[112:115], v[76:79], a[212:215], v[112:115]
    s_waitcnt lgkmcnt(0)
    v_cvt_pk_f16_f32 v212, v24, v25
    v_mul_f32 v26, v26, v38
    v_mfma_f32_16x16x32_bf16 v[8:11], a[0:3], v[116:119], 0
    v_mul_f32 v27, v27, v38
    v_cvt_pk_f16_f32 v213, v26, v27
    v_mfma_f32_16x16x32_bf16 v[8:11], a[4:7], v[100:103], v[8:11]
    v_mul_f32 v20, v20, v38
    v_mul_f32 v21, v21, v38
    v_mfma_f32_16x16x32_bf16 v[8:11], a[8:11], v[84:87], v[8:11]
    v_cvt_pk_f16_f32 v214, v20, v21
    v_mul_f32 v22, v22, v38
    v_mfma_f32_16x16x32_bf16 v[8:11], a[12:15], v[120:123], v[8:11]
    v_mul_f32 v23, v23, v38
    v_cvt_pk_f16_f32 v215, v22, v23
    v_mfma_f32_16x16x32_bf16 v[8:11], a[16:19], v[92:95], v[8:11]
    v_mul_f32 v4, v4, v38
    v_mul_f32 v5, v5, v38
    v_mfma_f32_16x16x32_bf16 v[8:11], a[20:23], v[88:91], v[8:11]
    v_cvt_pk_f16_f32 v154, v4, v5
    v_mul_f32 v6, v6, v38
    v_mfma_f32_16x16x32_bf16 v[20:23], a[24:27], v[116:119], 0
    v_mul_f32 v7, v7, v38
    v_cvt_pk_f16_f32 v155, v6, v7
    v_mfma_f32_16x16x32_bf16 v[20:23], a[28:31], v[100:103], v[20:23]
    v_mul_f32 v80, v80, v39
    v_mul_f32 v81, v81, v39
    v_mfma_f32_16x16x32_bf16 v[20:23], a[32:35], v[84:87], v[20:23]
    v_cvt_pk_f16_f32 v0, v80, v81
    v_mul_f32 v82, v82, v39
    v_mfma_f32_16x16x32_bf16 v[20:23], a[36:39], v[120:123], v[20:23]
    v_mul_f32 v83, v83, v39
    v_cvt_pk_f16_f32 v1, v82, v83
    v_mfma_f32_16x16x32_bf16 v[20:23], a[40:43], v[92:95], v[20:23]
    v_mul_f32 v60, v60, v39
    v_mul_f32 v61, v61, v39
    v_mfma_f32_16x16x32_bf16 v[20:23], a[44:47], v[88:91], v[20:23]
    v_cvt_pk_f16_f32 v2, v60, v61
    v_mul_f32 v62, v62, v39
    v_mfma_f32_16x16x32_bf16 v[68:71], a[48:51], v[116:119], 0
    v_mul_f32 v63, v63, v39
    v_cvt_pk_f16_f32 v3, v62, v63
    v_mfma_f32_16x16x32_bf16 v[68:71], a[52:55], v[100:103], v[68:71]
    v_mul_f32 v104, v104, v39
    v_mul_f32 v105, v105, v39
    v_mfma_f32_16x16x32_bf16 v[68:71], a[56:59], v[84:87], v[68:71]
    v_cvt_pk_f16_f32 v4, v104, v105
    v_mul_f32 v106, v106, v39
    v_mfma_f32_16x16x32_bf16 v[68:71], a[60:63], v[120:123], v[68:71]
    v_mul_f32 v107, v107, v39
    v_cvt_pk_f16_f32 v5, v106, v107
    v_mfma_f32_16x16x32_bf16 v[68:71], a[64:67], v[92:95], v[68:71]
    v_cvt_pk_bf16_f32 v24, v112, v113
    v_cvt_pk_bf16_f32 v25, v114, v115
    v_mfma_f32_16x16x32_bf16 v[68:71], a[68:71], v[88:91], v[68:71]
    v_cvt_pk_bf16_f32 v48, v48, v49
    v_mul_f32 v50, v50, v96
    v_mfma_f32_16x16x32_bf16 v[64:67], a[72:75], v[116:119], 0
    v_mul_f32 v51, v51, v96
    v_cvt_pk_bf16_f32 v49, v50, v51
    v_mfma_f32_16x16x32_bf16 v[64:67], a[76:79], v[100:103], v[64:67]
    ds_write_b64 v137, v[48:49] offset:0
    v_mfma_f32_16x16x32_bf16 v[64:67], a[80:83], v[84:87], v[64:67]
    v_mul_f32 v32, v32, v96
    v_mul_f32 v33, v33, v96
    v_mfma_f32_16x16x32_bf16 v[64:67], a[84:87], v[120:123], v[64:67]
    v_cvt_pk_bf16_f32 v50, v32, v33
    v_mul_f32 v34, v34, v96
    v_mfma_f32_16x16x32_bf16 v[64:67], a[88:91], v[92:95], v[64:67]
    v_mul_f32 v35, v35, v96
    v_cvt_pk_bf16_f32 v51, v34, v35
    v_mfma_f32_16x16x32_bf16 v[64:67], a[92:95], v[88:91], v[64:67]
    ds_write_b64 v137, v[50:51] offset:8
    v_mfma_f32_16x16x32_bf16 v[48:51], a[96:99], v[116:119], 0
    v_mul_f32 v28, v28, v96
    v_mul_f32 v29, v29, v96
    v_mfma_f32_16x16x32_bf16 v[48:51], a[100:103], v[100:103], v[48:51]
    v_cvt_pk_bf16_f32 v38, v28, v29
    v_mul_f32 v30, v30, v96
    v_mfma_f32_16x16x32_bf16 v[48:51], a[104:107], v[84:87], v[48:51]
    v_mul_f32 v31, v31, v96
    v_cvt_pk_bf16_f32 v39, v30, v31
    v_mfma_f32_16x16x32_bf16 v[48:51], a[108:111], v[120:123], v[48:51]
    ds_write_b64 v136, v[38:39] offset:0
    v_mfma_f32_16x16x32_bf16 v[48:51], a[112:115], v[92:95], v[48:51]
    v_fma_f32 v38, v8, v8, s41
    v_fmac_f32 v38, v9, v9
    v_mfma_f32_16x16x32_bf16 v[48:51], a[116:119], v[88:91], v[48:51]
    v_fmac_f32 v38, v10, v10
    v_fmac_f32 v38, v11, v11
    v_mfma_f32_16x16x32_bf16 v[32:35], a[120:123], v[116:119], 0
    v_fmac_f32 v38, v20, v20
    v_fmac_f32 v38, v21, v21
    v_mfma_f32_16x16x32_bf16 v[32:35], a[124:127], v[100:103], v[32:35]
    v_fmac_f32 v38, v22, v22
    v_fmac_f32 v38, v23, v23
    v_mfma_f32_16x16x32_bf16 v[32:35], a[128:131], v[84:87], v[32:35]
    v_fmac_f32 v38, v68, v68
    v_fmac_f32 v38, v69, v69
    v_mfma_f32_16x16x32_bf16 v[32:35], a[132:135], v[120:123], v[32:35]
    v_fmac_f32 v38, v70, v70
    v_fmac_f32 v38, v71, v71
    v_mfma_f32_16x16x32_bf16 v[32:35], a[136:139], v[92:95], v[32:35]
    v_mul_f32 v44, v44, v97
    v_mul_f32 v45, v45, v97
    v_mfma_f32_16x16x32_bf16 v[32:35], a[140:143], v[88:91], v[32:35]
    v_cvt_pk_bf16_f32 v26, v44, v45
    v_mul_f32 v46, v46, v97
    v_mfma_f32_16x16x32_bf16 v[42:45], v[116:119], a[144:147], 0
    v_mul_f32 v47, v47, v97
    v_cvt_pk_bf16_f32 v27, v46, v47
    v_mfma_f32_16x16x32_bf16 v[42:45], v[100:103], a[148:151], v[42:45]
    ds_write_b64 v137, v[26:27] offset:1536
    v_mfma_f32_16x16x32_bf16 v[42:45], v[84:87], a[152:155], v[42:45]
    v_mul_f32 v108, v108, v97
    v_mul_f32 v109, v109, v97
    v_mfma_f32_16x16x32_bf16 v[42:45], v[120:123], a[156:159], v[42:45]
    v_cvt_pk_bf16_f32 v28, v108, v109
    v_mul_f32 v110, v110, v97
    v_mfma_f32_16x16x32_bf16 v[42:45], v[92:95], a[160:163], v[42:45]
    ds_read_b128 v[72:75], v139 offset:3072
    v_mul_f32 v111, v111, v97
    v_mfma_f32_16x16x32_bf16 v[42:45], v[88:91], a[164:167], v[42:45]
    ds_read_b128 v[76:79], v138 offset:3072
    v_cvt_pk_bf16_f32 v29, v110, v111
    v_mfma_f32_16x16x32_bf16 v[80:83], v[116:119], a[168:171], 0
    ds_write_b64 v137, v[28:29] offset:1544
    v_mfma_f32_16x16x32_bf16 v[80:83], v[100:103], a[172:175], v[80:83]
    v_mul_f32 v52, v52, v97
    v_mul_f32 v53, v53, v97
    v_mfma_f32_16x16x32_bf16 v[80:83], v[84:87], a[176:179], v[80:83]
    ds_read_b128 v[28:31], v139 offset:3200
    v_cvt_pk_bf16_f32 v26, v52, v53
    v_mfma_f32_16x16x32_bf16 v[80:83], v[120:123], a[180:183], v[80:83]
    ds_read_b128 v[60:63], v138 offset:3200
    v_mul_f32 v54, v54, v97
    v_mfma_f32_16x16x32_bf16 v[80:83], v[92:95], a[184:187], v[80:83]
    ds_read_b128 v[106:109], v139 offset:3328
    v_mul_f32 v55, v55, v97
    v_mfma_f32_16x16x32_bf16 v[80:83], v[88:91], a[188:191], v[80:83]
    ds_read_b128 v[112:115], v138 offset:3328
    v_cvt_pk_bf16_f32 v27, v54, v55
    v_fma_f32 v39, v64, v64, s41
    v_fmac_f32 v39, v65, v65
    ds_write_b64 v136, v[26:27] offset:1536
    v_fmac_f32 v39, v66, v66
    v_fmac_f32 v39, v67, v67
    v_mfma_f32_16x16x32_bf16 v[52:55], v[116:119], a[192:195], 0
    v_fmac_f32 v39, v48, v48
    v_fmac_f32 v39, v49, v49
    v_mfma_f32_16x16x32_bf16 v[52:55], v[100:103], a[196:199], v[52:55]
    s_sub_u32 s50, s45, s44
    v_fmac_f32 v39, v50, v50
    v_fmac_f32 v39, v51, v51
    v_mfma_f32_16x16x32_bf16 v[52:55], v[84:87], a[200:203], v[52:55]
    s_sub_u32 s51, s46, s47
    v_fmac_f32 v39, v32, v32
    v_fmac_f32 v39, v33, v33
    v_mfma_f32_16x16x32_bf16 v[52:55], v[120:123], a[204:207], v[52:55]
    s_mov_b32 s60, s59
    v_fmac_f32 v39, v34, v34
    v_fmac_f32 v39, v35, v35
    v_mfma_f32_16x16x32_bf16 v[52:55], v[92:95], a[208:211], v[52:55]
    s_mov_b32 s59, s58
    v_cvt_pk_bf16_f32 v170, v38, v39
    v_cvt_pk_bf16_f32 v38, v42, v43
    v_mfma_f32_16x16x32_bf16 v[52:55], v[88:91], a[212:215], v[52:55]
    s_mov_b32 s58, s57
    v_cvt_pk_bf16_f32 v39, v44, v45
    v_cvt_pk_bf16_f32 v42, v80, v81
    v_mfma_f32_16x16x16_bf16 v[44:47], v[216:217], v[170:171], 0
    s_waitcnt lgkmcnt(0)
    s_mov_b32 s57, s56
    v_cvt_pk_bf16_f32 v43, v82, v83
    v_mul_f32 v12, v12, v98
    v_mul_f32 v13, v13, v98
    v_cvt_pk_bf16_f32 v26, v52, v53
    v_mfma_f32_16x16x32_bf16 v[80:83], a[0:3], v[72:75], 0
    s_add_u32 s56, s56, s62
    v_cvt_pk_bf16_f32 v27, v54, v55
    v_cvt_pk_bf16_f32 v12, v12, v13
    v_mfma_f32_16x16x32_bf16 v[80:83], a[4:7], v[76:79], v[80:83]
    s_add_u32 s61, s61, 1
    v_rsq_f32 v44, v44
    v_mfma_f32_16x16x32_bf16 v[80:83], a[8:11], v[28:31], v[80:83]
    s_cmp_eq_u32 s61, 72
    v_rsq_f32 v45, v45
    v_mfma_f32_16x16x32_bf16 v[80:83], a[12:15], v[60:63], v[80:83]
    s_cselect_b32 s53, s63, 0
    v_mul_f32 v44, s55, v44
    v_mul_f32 v45, 0.5, v45
    v_mfma_f32_16x16x32_bf16 v[80:83], a[16:19], v[106:109], v[80:83]
    s_cselect_b32 s61, 0, s61
    v_mul_f32 v8, v8, v44
    v_mul_f32 v9, v9, v44
    v_mfma_f32_16x16x32_bf16 v[80:83], a[20:23], v[112:115], v[80:83]
    s_add_u32 s56, s56, s53
    v_cvt_pk_f16_f32 v52, v8, v9
    v_mul_f32 v10, v10, v44
    v_mfma_f32_16x16x32_bf16 v[120:123], a[24:27], v[72:75], 0
    s_sub_u32 s64, s64, 1
    v_mul_f32 v11, v11, v44
    v_cvt_pk_f16_f32 v53, v10, v11
    v_mfma_f32_16x16x32_bf16 v[120:123], a[28:31], v[76:79], v[120:123]
    s_cmp_gt_i32 s64, 0
    v_mul_f32 v20, v20, v44
    v_mul_f32 v21, v21, v44
    v_mfma_f32_16x16x32_bf16 v[120:123], a[32:35], v[28:31], v[120:123]
    s_cselect_b32 s26, 100270464, 0
    v_cvt_pk_f16_f32 v54, v20, v21
    v_mul_f32 v22, v22, v44
    v_mfma_f32_16x16x32_bf16 v[120:123], a[36:39], v[60:63], v[120:123]
    s_cselect_b32 s56, s56, 0
    v_mul_f32 v23, v23, v44
    v_cvt_pk_f16_f32 v55, v22, v23
    v_mfma_f32_16x16x32_bf16 v[120:123], a[40:43], v[106:109], v[120:123]
    s_add_u32 s65, s65, 1
    v_mul_f32 v68, v68, v44
    v_mul_f32 v69, v69, v44
    v_mfma_f32_16x16x32_bf16 v[120:123], a[44:47], v[112:115], v[120:123]
    s_cmp_ge_i32 s65, 2
    v_cvt_pk_f16_f32 v150, v68, v69
    v_mul_f32 v70, v70, v44
    v_mfma_f32_16x16x32_bf16 v[116:119], a[48:51], v[72:75], 0
    s_cselect_b32 s30, 100270464, 0
    v_mul_f32 v71, v71, v44
    v_cvt_pk_f16_f32 v151, v70, v71
    v_mfma_f32_16x16x32_bf16 v[116:119], a[52:55], v[76:79], v[116:119]
    s_add_u32 s67, s46, s54
    v_mul_f32 v64, v64, v45
    v_mul_f32 v65, v65, v45
    v_mfma_f32_16x16x32_bf16 v[116:119], a[56:59], v[28:31], v[116:119]
    s_add_u32 m0, s67, 0
    v_cvt_pk_f16_f32 v6, v64, v65
    v_mul_f32 v66, v66, v45
    v_mfma_f32_16x16x32_bf16 v[116:119], a[60:63], v[60:63], v[116:119]
    v_mul_f32 v67, v67, v45
    v_cvt_pk_f16_f32 v7, v66, v67
    v_mfma_f32_16x16x32_bf16 v[116:119], a[64:67], v[106:109], v[116:119]
    v_mul_f32 v48, v48, v45
    v_mul_f32 v49, v49, v45
    v_mfma_f32_16x16x32_bf16 v[116:119], a[68:71], v[112:115], v[116:119]
    v_cvt_pk_f16_f32 v8, v48, v49
    v_mul_f32 v50, v50, v45
    v_mfma_f32_16x16x32_bf16 v[20:23], a[72:75], v[72:75], 0
    v_mul_f32 v51, v51, v45
    v_cvt_pk_f16_f32 v9, v50, v51
    v_mfma_f32_16x16x32_bf16 v[20:23], a[76:79], v[76:79], v[20:23]
    v_mul_f32 v32, v32, v45
    v_mul_f32 v33, v33, v45
    v_mfma_f32_16x16x32_bf16 v[20:23], a[80:83], v[28:31], v[20:23]
    v_cvt_pk_f16_f32 v10, v32, v33
    v_mul_f32 v34, v34, v45
    v_mfma_f32_16x16x32_bf16 v[20:23], a[84:87], v[60:63], v[20:23]
    v_mul_f32 v35, v35, v45
    v_cvt_pk_f16_f32 v11, v34, v35
    v_mfma_f32_16x16x32_bf16 v[20:23], a[88:91], v[106:109], v[20:23]
    v_mul_f32 v14, v14, v98
    v_mul_f32 v15, v15, v98
    v_mfma_f32_16x16x32_bf16 v[20:23], a[92:95], v[112:115], v[20:23]
    v_cvt_pk_bf16_f32 v13, v14, v15
    v_mul_f32 v16, v16, v98
    v_mfma_f32_16x16x32_bf16 v[32:35], a[96:99], v[72:75], 0
    ds_write_b64 v137, v[12:13] offset:3072
    v_mfma_f32_16x16x32_bf16 v[32:35], a[100:103], v[76:79], v[32:35]
    v_mul_f32 v17, v17, v98
    v_cvt_pk_bf16_f32 v14, v16, v17
    v_mfma_f32_16x16x32_bf16 v[32:35], a[104:107], v[28:31], v[32:35]
    v_mul_f32 v18, v18, v98
    v_mul_f32 v19, v19, v98
    v_mfma_f32_16x16x32_bf16 v[32:35], a[108:111], v[60:63], v[32:35]
    v_cvt_pk_bf16_f32 v15, v18, v19
    v_mul_f32 v56, v56, v98
    v_mfma_f32_16x16x32_bf16 v[32:35], a[112:115], v[106:109], v[32:35]
    ds_write_b64 v137, v[14:15] offset:3080
    v_mfma_f32_16x16x32_bf16 v[32:35], a[116:119], v[112:115], v[32:35]
    v_mul_f32 v57, v57, v98
    v_cvt_pk_bf16_f32 v56, v56, v57
    v_mul_f32 v58, v58, v98
    v_mul_f32 v59, v59, v98
    v_cvt_pk_bf16_f32 v57, v58, v59
    ds_write_b64 v136, v[56:57] offset:3072
    v_fma_f32 v142, v80, v80, s41
    v_fmac_f32 v142, v81, v81
    v_fmac_f32 v142, v82, v82
    v_fmac_f32 v142, v83, v83
    v_mfma_f32_16x16x32_bf16 v[56:59], a[120:123], v[72:75], 0
    s_waitcnt vmcnt(0)
    v_fmac_f32 v142, v120, v120
    v_fmac_f32 v142, v121, v121
    v_mfma_f32_16x16x32_bf16 v[56:59], a[124:127], v[76:79], v[56:59]
    v_fmac_f32 v142, v122, v122
    v_fmac_f32 v142, v123, v123
    v_mfma_f32_16x16x32_bf16 v[56:59], a[128:131], v[28:31], v[56:59]
    v_fmac_f32 v142, v116, v116
    v_fmac_f32 v142, v117, v117
    v_mfma_f32_16x16x32_bf16 v[56:59], a[132:135], v[60:63], v[56:59]
    v_fmac_f32 v142, v118, v118
    v_fmac_f32 v142, v119, v119
    v_mfma_f32_16x16x32_bf16 v[56:59], a[136:139], v[106:109], v[56:59]
    v_fma_f32 v143, v20, v20, s41
    v_fmac_f32 v143, v21, v21
    v_mfma_f32_16x16x32_bf16 v[56:59], a[140:143], v[112:115], v[56:59]
    v_fmac_f32 v143, v22, v22
    v_fmac_f32 v143, v23, v23
    v_mfma_f32_16x16x32_bf16 v[12:15], v[72:75], a[144:147], 0
    s_waitcnt lgkmcnt(0)
    v_fmac_f32 v143, v32, v32
    v_fmac_f32 v143, v33, v33
    v_mfma_f32_16x16x32_bf16 v[12:15], v[76:79], a[148:151], v[12:15]
    s_barrier
    v_fmac_f32 v143, v34, v34
    v_fmac_f32 v143, v35, v35
    v_mfma_f32_16x16x32_bf16 v[12:15], v[28:31], a[152:155], v[12:15]
    v_fmac_f32 v143, v56, v56
    v_fmac_f32 v143, v57, v57
    v_mfma_f32_16x16x32_bf16 v[12:15], v[60:63], a[156:159], v[12:15]
    v_fmac_f32 v143, v58, v58
    v_fmac_f32 v143, v59, v59
    v_mfma_f32_16x16x32_bf16 v[12:15], v[106:109], a[160:163], v[12:15]
    v_cvt_pk_bf16_f32 v170, v142, v143
    v_add_u32 v139, s50, v139
    v_mfma_f32_16x16x32_bf16 v[12:15], v[112:115], a[164:167], v[12:15]
    s_nop 0
    ds_read_b128 v[68:71], v139 offset:0
    v_add_u32 v138, s50, v138
    v_mfma_f32_16x16x16_bf16 v[64:67], v[216:217], v[170:171], 0
    s_nop 0
    ds_read_b128 v[44:47], v138 offset:0
    v_add_u32 v137, s48, v137
    v_add_u32 v136, s48, v136
    v_cvt_pk_bf16_f32 v164, v12, v13
    v_mfma_f32_16x16x32_bf16 v[16:19], v[72:75], a[168:171], 0
    ds_read_b128 v[96:99], v139 offset:128
    v_cvt_pk_bf16_f32 v165, v14, v15
    v_mfma_f32_16x16x32_bf16 v[16:19], v[76:79], a[172:175], v[16:19]
    ds_read_b128 v[100:103], v138 offset:128
    v_add_u32 v135, s51, v135
    v_mfma_f32_16x16x32_bf16 v[16:19], v[28:31], a[176:179], v[16:19]
    ds_read_b128 v[84:87], v139 offset:256
    v_add_u32 v134, 336, v134
    v_mfma_f32_16x16x32_bf16 v[16:19], v[60:63], a[180:183], v[16:19]
    ds_read_b128 v[92:95], v138 offset:256
    v_add_u32 v133, 336, v133
    v_mfma_f32_16x16x32_bf16 v[16:19], v[106:109], a[184:187], v[16:19]
    v_rsq_f32 v64, v64
    v_mfma_f32_16x16x32_bf16 v[16:19], v[112:115], a[188:191], v[16:19]
    s_nop 0
    v_rsq_f32 v65, v65
    v_mfma_f32_16x16x32_bf16 v[88:91], v[72:75], a[192:195], 0
    s_nop 0
    v_mul_f32 v64, s55, v64
    v_mul_f32 v65, 0.5, v65
    v_mfma_f32_16x16x32_bf16 v[88:91], v[76:79], a[196:199], v[88:91]
    s_nop 0
    v_cvt_pk_bf16_f32 v160, v16, v17
    v_cvt_pk_bf16_f32 v161, v18, v19
    v_mfma_f32_16x16x32_bf16 v[88:91], v[28:31], a[200:203], v[88:91]
    v_mul_f32 v20, v20, v65
    v_mul_f32 v21, v21, v65
    v_mfma_f32_16x16x32_bf16 v[88:91], v[60:63], a[204:207], v[88:91]
    ds_read_b128 v[12:15], v134 offset:32
    v_cvt_pk_f16_f32 v18, v20, v21
    v_mfma_f32_16x16x32_bf16 v[88:91], v[106:109], a[208:211], v[88:91]
    ds_read_b64 v[16:17], v134 offset:48
    v_mul_f32 v22, v22, v65
    v_mfma_f32_16x16x32_bf16 v[88:91], v[112:115], a[212:215], v[88:91]
    s_waitcnt lgkmcnt(3)
    ds_read_b128 v[72:75], v135 offset:0
    v_mul_f32 v23, v23, v65
    v_mfma_f32_16x16x32_bf16 v[48:51], a[216:219], v[68:71], 0
    v_cvt_pk_f16_f32 v19, v22, v23
    v_mul_f32 v32, v32, v65
    v_mfma_f32_16x16x32_bf16 v[48:51], a[220:223], v[44:47], v[48:51]
    v_mul_f32 v33, v33, v65
    v_cvt_pk_f16_f32 v20, v32, v33
    v_mfma_f32_16x16x32_bf16 v[48:51], a[224:227], v[96:99], v[48:51]
    v_mul_f32 v34, v34, v65
    v_mul_f32 v35, v35, v65
    v_mfma_f32_16x16x32_bf16 v[48:51], a[228:231], v[100:103], v[48:51]
    v_cvt_pk_f16_f32 v21, v34, v35
    v_mul_f32 v56, v56, v65
    v_mfma_f32_16x16x32_bf16 v[48:51], a[232:235], v[84:87], v[48:51]
    s_waitcnt lgkmcnt(3)
    v_mul_f32 v57, v57, v65
    v_cvt_pk_f16_f32 v22, v56, v57
    v_mfma_f32_16x16x32_bf16 v[48:51], a[236:239], v[92:95], v[48:51]
    v_mul_f32 v58, v58, v65
    v_mul_f32 v59, v59, v65
    v_mfma_f32_16x16x32_bf16 v[32:35], a[240:243], v[68:71], 0
    v_cvt_pk_f16_f32 v23, v58, v59
    v_mul_f32 v80, v80, v64
    v_mfma_f32_16x16x32_bf16 v[32:35], a[244:247], v[44:47], v[32:35]
    v_mul_f32 v81, v81, v64
    v_cvt_pk_f16_f32 v56, v80, v81
    v_mfma_f32_16x16x32_bf16 v[32:35], a[248:251], v[96:99], v[32:35]
    s_waitcnt lgkmcnt(0)
    buffer_load_dwordx4 v130, s[24:27], s56 offen nt lds
    v_mul_f32 v82, v82, v64
    v_mfma_f32_16x16x32_bf16 v[32:35], a[252:255], v[100:103], v[32:35]
    v_mul_f32 v83, v83, v64
    v_cvt_pk_f16_f32 v57, v82, v83
    v_mfma_f32_16x16x32_bf16 v[32:35], v[224:227], v[84:87], v[32:35]
    v_mul_f32 v120, v120, v64
    v_mul_f32 v121, v121, v64
    v_mfma_f32_16x16x32_bf16 v[32:35], v[228:231], v[92:95], v[32:35]
    ds_read_u16 v166, v133 offset:56
    v_cvt_pk_f16_f32 v58, v120, v121
    v_mfma_f32_16x16x32_bf16 v[28:31], v[232:235], v[68:71], 0
    ds_read_u16 v162, v133 offset:64
    v_mul_f32 v122, v122, v64
    v_mfma_f32_16x16x32_bf16 v[28:31], v[236:239], v[44:47], v[28:31]
    ds_read_u16 v158, v133 offset:72
    v_mul_f32 v123, v123, v64
    v_mfma_f32_16x16x32_bf16 v[28:31], v[240:243], v[96:99], v[28:31]
    ds_read_b128 v[44:47], v134 offset:0
    v_cvt_pk_f16_f32 v59, v122, v123
    v_mfma_f32_16x16x32_bf16 v[28:31], v[244:247], v[100:103], v[28:31]
    buffer_store_dwordx4 v[72:75], v130, s[28:31], s60 offen sc1
    ds_read_b64 v[142:143], v134 offset:16
    v_mul_f32 v116, v116, v64
    v_mul_f32 v117, v117, v64
    v_cvt_pk_f16_f32 v146, v116, v117
    v_mfma_f32_16x16x32_bf16 v[28:31], v[248:251], v[84:87], v[28:31]
    s_add_u32 m0, s67, 1024
    v_mul_f32 v118, v118, v64
    v_mul_f32 v119, v119, v64
    v_mfma_f32_16x16x32_bf16 v[28:31], v[252:255], v[92:95], v[28:31]
    v_cvt_pk_f16_f32 v147, v118, v119
    v_cvt_pk_bf16_f32 v156, v88, v89
    v_mfma_f32_16x16x32_f16 v[120:123], v[0:3], v[212:215], v[204:207]
    v_cvt_pk_bf16_f32 v157, v90, v91
    v_add_u32 v125, 336, v125
    v_mfma_f32_16x16x32_f16 v[120:123], v[2:5], v[152:155], v[120:123]
    ds_read_b128 v[96:99], v135 offset:1024
    v_mfma_f32_16x16x32_f16 v[116:119], v[6:9], v[212:215], v[200:203]
    s_nop 0
    ds_read_b128 v[68:71], v139 offset:1536
    s_nop 0
    v_mfma_f32_16x16x32_f16 v[116:119], v[8:11], v[152:155], v[116:119]
    s_nop 0
    ds_read_b128 v[64:67], v138 offset:1536
    v_max3_f32 v104, v120, v121, v122
    v_mfma_f32_16x16x32_f16 v[100:103], v[18:21], v[212:215], v[196:199]
    ds_read_b128 v[72:75], v139 offset:1664
    v_mfma_f32_16x16x32_f16 v[100:103], v[20:23], v[152:155], v[100:103]
    s_nop 0
    ds_read_b128 v[76:79], v138 offset:1664
    v_max3_f32 v104, v104, v123, v116
    v_mfma_f32_16x16x32_f16 v[84:87], v[12:15], v[212:215], v[208:211]
    ds_read_b128 v[80:83], v139 offset:1792
    v_max3_f32 v104, v104, v117, v118
    v_mfma_f32_16x16x32_f16 v[84:87], v[14:17], v[152:155], v[84:87]
    s_waitcnt lgkmcnt(6)
    ds_read_b128 v[60:63], v138 offset:1792
    v_max3_f32 v104, v104, v119, v100
    v_mfma_f32_16x16x32_f16 v[106:109], v[44:47], v[0:3], v[208:211]
    v_max3_f32 v104, v104, v101, v102
    s_nop 0
    v_mfma_f32_16x16x32_f16 v[106:109], v[140:143], v[2:5], v[106:109]
    s_nop 0
    v_max3_f32 v104, v104, v103, v84
    v_mov_b32 v105, v104
    v_mfma_f32_16x16x32_f16 v[92:95], v[44:47], v[6:9], v[208:211]
    s_waitcnt lgkmcnt(6)
    buffer_load_dwordx4 v129, s[24:27], s56 offen nt lds
    v_mfma_f32_16x16x32_f16 v[92:95], v[140:143], v[8:11], v[92:95]
    v_permlane32_swap_b32 v105, v104
    v_mfma_f32_16x16x32_f16 v[88:91], v[44:47], v[18:21], v[208:211]
    v_max_f32 v104, v105, v104
    v_mov_b32 v105, v104
    v_mfma_f32_16x16x32_f16 v[88:91], v[140:143], v[20:23], v[88:91]
    s_nop 0
    v_permlane16_swap_b32 v105, v104
    v_mfma_f32_16x16x32_f16 v[112:115], v[44:47], v[12:15], v[208:211]
    v_max_f32 v104, v105, v104
    v_sub_f32 v120, v120, v104
    v_mfma_f32_16x16x32_f16 v[112:115], v[140:143], v[14:17], v[112:115]
    s_waitcnt lgkmcnt(1)
    v_sub_f32 v121, v121, v104
    v_sub_f32 v122, v122, v104
    v_mfma_f32_16x16x32_bf16 v[44:47], a[216:219], v[68:71], 0
    v_sub_f32 v123, v123, v104
    v_sub_f32 v116, v116, v104
    v_mfma_f32_16x16x32_bf16 v[44:47], a[220:223], v[64:67], v[44:47]
    buffer_store_dwordx4 v[96:99], v129, s[28:31], s60 offen sc1
    v_sub_f32 v117, v117, v104
    v_sub_f32 v118, v118, v104
    v_sub_f32 v119, v119, v104
    v_sub_f32 v100, v100, v104
    v_mfma_f32_16x16x32_bf16 v[44:47], a[224:227], v[72:75], v[44:47]
    s_add_u32 m0, s67, 2048
    v_sub_f32 v101, v101, v104
    v_sub_f32 v102, v102, v104
    v_mfma_f32_16x16x32_bf16 v[44:47], a[228:231], v[76:79], v[44:47]
    v_sub_f32 v103, v103, v104
    v_sub_f32 v84, v84, v104
    v_mfma_f32_16x16x32_bf16 v[44:47], a[232:235], v[80:83], v[44:47]
    s_waitcnt lgkmcnt(0)
    v_exp_f32 v120, v120
    v_mfma_f32_16x16x32_bf16 v[44:47], a[236:239], v[60:63], v[44:47]
    v_exp_f32 v121, v121
    v_exp_f32 v122, v122
    v_exp_f32 v123, v123
    v_cvt_pk_bf16_f32 v86, v120, v121
    v_cvt_pk_bf16_f32 v87, v122, v123
    v_exp_f32 v116, v116
    v_exp_f32 v117, v117
    v_exp_f32 v118, v118
    v_exp_f32 v119, v119
    v_cvt_pk_bf16_f32 v88, v116, v117
    v_cvt_pk_bf16_f32 v89, v118, v119
    v_exp_f32 v100, v100
    v_exp_f32 v101, v101
    v_exp_f32 v102, v102
    v_exp_f32 v103, v103
    v_cvt_pk_bf16_f32 v168, v100, v101
    v_cvt_pk_bf16_f32 v169, v102, v103
    v_exp_f32 v84, v84
    v_mov_b32_dpp v109, v95 quad_perm:[0,1,2,3] row_mask:0x2 bank_mask:0xf
    v_cvt_pk_bf16_f32 v170, v84, 0
    v_mfma_f32_16x16x32_bf16 v[120:123], v[220:223], v[86:89], 0
    v_mov_b32_dpp v109, v91 quad_perm:[0,1,2,3] row_mask:0x4 bank_mask:0xf
    v_mfma_f32_16x16x32_bf16 v[120:123], v[220:223], v[168:171], v[120:123]
    ds_read_b128 v[96:99], v135 offset:2048
    v_mov_b32_dpp v109, v115 quad_perm:[0,1,2,3] row_mask:0x8 bank_mask:0xf
    v_mfma_f32_16x16x32_bf16 v[116:119], v[36:39], v[86:89], 0
    s_nop 0
    v_mov_b32 v124, v109
    s_nop 0
    v_mfma_f32_16x16x32_bf16 v[116:119], v[164:167], v[168:171], v[116:119]
    s_nop 0
    v_rcp_f32 v120, v120
    v_mfma_f32_16x16x32_bf16 v[104:107], v[40:43], v[86:89], 0
    v_max_f32_dpp v124, v124, v124 row_ror:8 row_mask:0xf bank_mask:0xf
    s_nop 0
    v_mfma_f32_16x16x32_bf16 v[104:107], v[160:163], v[168:171], v[104:107]
    s_nop 0
    v_max_f32_dpp v124, v124, v124 row_ror:4 row_mask:0xf bank_mask:0xf
    v_mul_f32 v116, v116, v120
    v_mfma_f32_16x16x32_bf16 v[100:103], v[24:27], v[86:89], 0
    v_max_f32_dpp v124, v124, v124 row_ror:2 row_mask:0xf bank_mask:0xf
    v_mul_f32 v117, v117, v120
    v_mfma_f32_16x16x32_bf16 v[100:103], v[156:159], v[168:171], v[100:103]
    v_max_f32_dpp v124, v124, v124 row_ror:1 row_mask:0xf bank_mask:0xf
    v_mov_b32 v142, v124
    v_mfma_f32_16x16x32_f16 v[84:87], v[0:3], v[52:55], v[192:195]
    s_nop 0
    v_permlane32_swap_b32 v142, v124
    v_mfma_f32_16x16x32_f16 v[84:87], v[2:5], v[148:151], v[84:87]
    v_max_f32 v124, v142, v124
    v_mov_b32 v142, v124
    v_mfma_f32_16x16x32_f16 v[92:95], v[6:9], v[52:55], v[188:191]
    s_waitcnt lgkmcnt(0)
    buffer_load_dwordx4 v128, s[24:27], s56 offen nt lds
    v_cvt_pk_bf16_f32 v116, v116, v117
    v_mfma_f32_16x16x32_f16 v[92:95], v[8:11], v[148:151], v[92:95]
    v_permlane16_swap_b32 v142, v124
    v_mfma_f32_16x16x32_f16 v[88:91], v[18:21], v[52:55], v[184:187]
    v_max_f32 v124, v142, v124
    v_sub_f32 v109, v109, v124
    v_mfma_f32_16x16x32_f16 v[88:91], v[20:23], v[148:151], v[88:91]
    v_exp_f32 v109, v109
    v_mfma_f32_16x16x32_f16 v[112:115], v[12:15], v[52:55], v[208:211]
    v_cvt_pk_bf16_f32 v109, v109, v109
    v_mul_f32 v118, v118, v120
    v_mfma_f32_16x16x32_f16 v[112:115], v[14:17], v[148:151], v[112:115]
    s_mov_b32 s53, s47
    ds_write_b16 v125, v109
    v_mul_f32 v119, v119, v120
    v_cvt_pk_bf16_f32 v117, v118, v119
    s_mov_b32 s47, s46
    s_mov_b32 s46, s45
    ds_read_b128 v[52:55], v134
    v_mul_f32 v104, v104, v120
    v_mul_f32 v105, v105, v120
    v_cvt_pk_bf16_f32 v118, v104, v105
    s_add_u32 m0, s67, 3072
    s_mov_b32 s45, s44
    ds_read_b128 v[212:215], v134 offset:16
    v_mfma_f32_16x16x32_bf16 v[108:111], a[240:243], v[68:71], 0
    s_mov_b32 s44, s53
    buffer_store_dwordx4 v[96:99], v128, s[28:31], s60 offen sc1
    ds_write_b64 v137, v[116:117] offset:0
    v_mul_f32 v106, v106, v120
    v_mfma_f32_16x16x32_bf16 v[108:111], a[244:247], v[64:67], v[108:111]
    s_sub_u32 s48, s44, s46
    v_mul_f32 v107, v107, v120
    v_cvt_pk_bf16_f32 v119, v106, v107
    v_mfma_f32_16x16x32_bf16 v[108:111], a[248:251], v[72:75], v[108:111]
    ds_write_b64 v137, v[118:119] offset:8
    v_mfma_f32_16x16x32_bf16 v[108:111], a[252:255], v[76:79], v[108:111]
    v_mul_f32 v100, v100, v120
    v_mul_f32 v101, v101, v120
    v_mfma_f32_16x16x32_bf16 v[108:111], v[224:227], v[80:83], v[108:111]
    v_cvt_pk_bf16_f32 v168, v100, v101
    v_mul_f32 v102, v102, v120
    v_mfma_f32_16x16x32_bf16 v[108:111], v[228:231], v[60:63], v[108:111]
    s_waitcnt lgkmcnt(3)
    s_sub_u32 s49, s46, s45
    v_mul_f32 v103, v103, v120
    v_cvt_pk_bf16_f32 v169, v102, v103
    v_mfma_f32_16x16x32_bf16 v[104:107], v[52:55], v[36:39], 0
    s_waitcnt lgkmcnt(2)
    ds_write_b64 v136, v[168:169] offset:0
    v_max3_f32 v168, v84, v85, v86
    v_mfma_f32_16x16x32_bf16 v[104:107], v[212:215], v[164:167], v[104:107]
    v_max3_f32 v168, v168, v87, v92
    v_max3_f32 v168, v168, v93, v94
    v_mfma_f32_16x16x32_bf16 v[120:123], v[52:55], v[40:43], 0
    v_max3_f32 v168, v168, v95, v88
    v_max3_f32 v168, v168, v89, v90
    v_mfma_f32_16x16x32_bf16 v[120:123], v[212:215], v[160:163], v[120:123]
    v_max3_f32 v168, v168, v91, v113
    v_mov_b32 v169, v168
    v_mfma_f32_16x16x32_bf16 v[96:99], v[52:55], v[24:27], 0
    s_nop 0
    v_permlane32_swap_b32 v169, v168
    v_mfma_f32_16x16x32_bf16 v[96:99], v[212:215], v[156:159], v[96:99]
    v_max_f32 v168, v169, v168
    v_mov_b32 v169, v168
    v_mfma_f32_16x16x32_bf16 v[52:55], v[232:235], v[68:71], 0
    s_nop 0
    v_permlane16_swap_b32 v169, v168
    v_mfma_f32_16x16x32_bf16 v[52:55], v[236:239], v[64:67], v[52:55]
    v_max_f32 v168, v169, v168
    v_sub_f32 v84, v84, v168
    v_mfma_f32_16x16x32_bf16 v[52:55], v[240:243], v[72:75], v[52:55]
    v_sub_f32 v85, v85, v168
    v_sub_f32 v86, v86, v168
    v_mfma_f32_16x16x32_bf16 v[52:55], v[244:247], v[76:79], v[52:55]
    v_sub_f32 v87, v87, v168
    v_sub_f32 v92, v92, v168
    v_mfma_f32_16x16x32_bf16 v[52:55], v[248:251], v[80:83], v[52:55]
    v_sub_f32 v93, v93, v168
    v_sub_f32 v94, v94, v168
    v_mfma_f32_16x16x32_bf16 v[52:55], v[252:255], v[60:63], v[52:55]
    v_sub_f32 v95, v95, v168
    v_sub_f32 v88, v88, v168
    v_sub_f32 v89, v89, v168
    v_sub_f32 v90, v90, v168
    v_sub_f32 v91, v91, v168
    v_sub_f32 v113, v113, v168
    v_exp_f32 v84, v84
    v_exp_f32 v85, v85
    v_exp_f32 v86, v86
    v_exp_f32 v87, v87
    v_cvt_pk_bf16_f32 v68, v84, v85
    v_cvt_pk_bf16_f32 v69, v86, v87
    v_exp_f32 v92, v92
    v_exp_f32 v93, v93
    v_exp_f32 v94, v94
    v_exp_f32 v95, v95
    v_cvt_pk_bf16_f32 v70, v92, v93
    v_cvt_pk_bf16_f32 v71, v94, v95
    v_exp_f32 v88, v88
    v_exp_f32 v89, v89
    v_exp_f32 v90, v90
    v_exp_f32 v91, v91
    v_cvt_pk_bf16_f32 v168, v88, v89
    v_cvt_pk_bf16_f32 v169, v90, v91
    v_exp_f32 v113, v113
    v_mov_b32_dpp v107, v123 quad_perm:[0,1,2,3] row_mask:0x2 bank_mask:0xf
    v_cvt_pk_bf16_f32 v170, v113, 0
    v_mfma_f32_16x16x32_bf16 v[64:67], v[220:223], v[68:71], 0
    v_mov_b32_dpp v107, v99 quad_perm:[0,1,2,3] row_mask:0x4 bank_mask:0xf
    v_cvt_pk_bf16_f32 v107, v107, v107
    v_mfma_f32_16x16x32_bf16 v[64:67], v[220:223], v[168:171], v[64:67]
    ds_write_b16 v133, v107 offset:56
    v_mfma_f32_16x16x32_bf16 v[72:75], v[36:39], v[68:71], 0
    ds_read_b128 v[76:79], v135 offset:3072
    v_fma_f32 v154, v48, v48, s42
    v_mfma_f32_16x16x32_bf16 v[72:75], v[164:167], v[168:171], v[72:75]
    ds_read_b128 v[60:63], v139 offset:3072
    v_fmac_f32 v154, v49, v49
    v_mfma_f32_16x16x32_bf16 v[80:83], v[40:43], v[68:71], 0
    ds_read_b128 v[104:107], v138 offset:3072
    v_fmac_f32 v154, v50, v50
    v_mfma_f32_16x16x32_bf16 v[80:83], v[160:163], v[168:171], v[80:83]
    ds_read_b128 v[120:123], v139 offset:3200
    v_fmac_f32 v154, v51, v51
    v_mfma_f32_16x16x32_bf16 v[96:99], v[24:27], v[68:71], 0
    ds_read_b128 v[68:71], v138 offset:3200
    v_fmac_f32 v154, v32, v32
    v_mfma_f32_16x16x32_bf16 v[96:99], v[156:159], v[168:171], v[96:99]
    ds_read_b128 v[100:103], v139 offset:3328
    v_add_u32 v139, s48, v139
    v_mfma_f32_16x16x32_f16 v[116:119], v[0:3], v[56:59], v[180:183]
    ds_read_b128 v[84:87], v138 offset:3328
    v_add_u32 v138, s48, v138
    v_mfma_f32_16x16x32_f16 v[116:119], v[2:5], v[144:147], v[116:119]
    ds_read_b128 v[0:3], v135 offset:4096
    v_fmac_f32 v154, v33, v33
    v_mfma_f32_16x16x32_f16 v[92:95], v[6:9], v[56:59], v[176:179]
    v_rcp_f32 v64, v64
    v_mfma_f32_16x16x32_f16 v[92:95], v[8:11], v[144:147], v[92:95]
    s_waitcnt lgkmcnt(7)
    buffer_load_dwordx4 v127, s[24:27], s56 offen nt lds
    v_mul_f32 v72, v72, v64
    v_mfma_f32_16x16x32_f16 v[4:7], v[18:21], v[56:59], v[172:175]
    v_mul_f32 v73, v73, v64
    v_cvt_pk_bf16_f32 v8, v72, v73
    v_mfma_f32_16x16x32_f16 v[4:7], v[20:23], v[144:147], v[4:7]
    v_mul_f32 v74, v74, v64
    v_mul_f32 v75, v75, v64
    v_mfma_f32_16x16x32_f16 v[20:23], v[12:15], v[56:59], v[208:211]
    v_cvt_pk_bf16_f32 v9, v74, v75
    v_mul_f32 v80, v80, v64
    v_mfma_f32_16x16x32_f16 v[20:23], v[14:17], v[144:147], v[20:23]
    s_waitcnt lgkmcnt(3)
    ds_write_b64 v137, v[8:9] offset:1536
    v_mfma_f32_16x16x32_bf16 v[12:15], a[216:219], v[60:63], 0
    v_mul_f32 v81, v81, v64
    v_cvt_pk_bf16_f32 v10, v80, v81
    v_mfma_f32_16x16x32_bf16 v[12:15], a[220:223], v[104:107], v[12:15]
    v_mul_f32 v82, v82, v64
    v_mul_f32 v83, v83, v64
    v_mfma_f32_16x16x32_bf16 v[12:15], a[224:227], v[120:123], v[12:15]
    s_add_u32 m0, s67, 4096
    buffer_store_dwordx4 v[76:79], v127, s[28:31], s60 offen sc1
    v_cvt_pk_bf16_f32 v11, v82, v83
    v_mul_f32 v96, v96, v64
    v_mul_f32 v97, v97, v64
    v_cvt_pk_bf16_f32 v168, v96, v97
    v_mfma_f32_16x16x32_bf16 v[12:15], a[228:231], v[68:71], v[12:15]
    s_waitcnt lgkmcnt(1)
    s_sub_u32 s66, s66, 1
    ds_write_b64 v137, v[10:11] offset:1544
    v_mfma_f32_16x16x32_bf16 v[12:15], a[232:235], v[100:103], v[12:15]
    s_cmp_lg_u32 s66, 0
    v_mul_f32 v98, v98, v64
    v_mul_f32 v99, v99, v64
    v_mfma_f32_16x16x32_bf16 v[12:15], a[236:239], v[84:87], v[12:15]
    buffer_load_dwordx4 v126, s[24:27], s56 offen nt lds
    v_cvt_pk_bf16_f32 v169, v98, v99
    v_mfma_f32_16x16x32_bf16 v[16:19], a[240:243], v[60:63], 0
    ds_write_b64 v136, v[168:169] offset:1536
    v_mfma_f32_16x16x32_bf16 v[16:19], a[244:247], v[104:107], v[16:19]
    v_max3_f32 v155, v116, v117, v118
    v_max3_f32 v155, v155, v119, v92
    v_mfma_f32_16x16x32_bf16 v[16:19], a[248:251], v[120:123], v[16:19]
    v_max3_f32 v155, v155, v93, v94
    v_max3_f32 v155, v155, v95, v4
    v_mfma_f32_16x16x32_bf16 v[16:19], a[252:255], v[68:71], v[16:19]
    v_max3_f32 v155, v155, v5, v6
    v_max3_f32 v155, v155, v7, v22
    v_mfma_f32_16x16x32_bf16 v[16:19], v[224:227], v[100:103], v[16:19]
    v_mov_b32 v168, v155
    v_fmac_f32 v154, v34, v34
    v_mfma_f32_16x16x32_bf16 v[16:19], v[228:231], v[84:87], v[16:19]
    ds_read_b128 v[8:11], v139 offset:0
    v_fmac_f32 v154, v35, v35
    v_mfma_f32_16x16x32_bf16 v[56:59], v[232:235], v[60:63], 0
    buffer_store_dwordx4 v[0:3], v126, s[28:31], s60 offen sc1
    ds_read_b128 v[64:67], v138 offset:0
    v_permlane32_swap_b32 v168, v155
    v_max_f32 v155, v168, v155
    v_mfma_f32_16x16x32_bf16 v[56:59], v[236:239], v[104:107], v[56:59]
    ds_read_b128 v[0:3], v139 offset:128
    v_mov_b32 v168, v155
    v_mfma_f32_16x16x32_bf16 v[56:59], v[240:243], v[120:123], v[56:59]
    ds_read_b128 v[72:75], v138 offset:128
    v_fmac_f32 v154, v28, v28
    v_mfma_f32_16x16x32_bf16 v[56:59], v[244:247], v[68:71], v[56:59]
    ds_read_b128 v[68:71], v139 offset:256
    v_fmac_f32 v154, v29, v29
    v_mfma_f32_16x16x32_bf16 v[56:59], v[248:251], v[100:103], v[56:59]
    ds_read_b128 v[76:79], v138 offset:256
    v_fmac_f32 v154, v30, v30
    v_mfma_f32_16x16x32_bf16 v[56:59], v[252:255], v[84:87], v[56:59]
    v_permlane16_swap_b32 v168, v155
    v_max_f32 v155, v168, v155
    v_sub_f32 v116, v116, v155
    v_sub_f32 v117, v117, v155
    v_sub_f32 v118, v118, v155
    v_sub_f32 v119, v119, v155
    v_sub_f32 v92, v92, v155
    v_sub_f32 v93, v93, v155
    v_sub_f32 v94, v94, v155
    v_sub_f32 v95, v95, v155
    v_sub_f32 v4, v4, v155
    v_sub_f32 v5, v5, v155
    v_sub_f32 v6, v6, v155
    v_sub_f32 v7, v7, v155
    v_sub_f32 v22, v22, v155
    v_exp_f32 v116, v116
    v_exp_f32 v117, v117
    v_exp_f32 v118, v118
    v_exp_f32 v119, v119
    v_cvt_pk_bf16_f32 v80, v116, v117
    v_cvt_pk_bf16_f32 v81, v118, v119
    v_exp_f32 v92, v92
    v_exp_f32 v93, v93
    v_exp_f32 v94, v94
    v_exp_f32 v95, v95
    v_cvt_pk_bf16_f32 v82, v92, v93
    v_cvt_pk_bf16_f32 v83, v94, v95
    v_exp_f32 v4, v4
    v_exp_f32 v5, v5
    v_exp_f32 v6, v6
    v_exp_f32 v7, v7
    v_cvt_pk_bf16_f32 v168, v4, v5
    v_cvt_pk_bf16_f32 v169, v6, v7
    v_exp_f32 v22, v22
    v_fmac_f32 v154, v31, v31
    v_cvt_pk_bf16_f32 v170, v22, 0
    v_mfma_f32_16x16x32_bf16 v[4:7], v[220:223], v[80:83], 0
    v_fma_f32 v155, v44, v44, s42
    v_fmac_f32 v155, v45, v45
    v_mfma_f32_16x16x32_bf16 v[4:7], v[220:223], v[168:171], v[4:7]
    v_fmac_f32 v155, v46, v46
    v_fmac_f32 v155, v47, v47
    v_mfma_f32_16x16x32_bf16 v[20:23], v[36:39], v[80:83], 0
    s_nop 0
    v_fmac_f32 v155, v108, v108
    v_fmac_f32 v155, v109, v109
    v_mfma_f32_16x16x32_bf16 v[20:23], v[164:167], v[168:171], v[20:23]
    s_nop 0
    v_rcp_f32 v4, v4
    v_mfma_f32_16x16x32_bf16 v[36:39], v[40:43], v[80:83], 0
    s_nop 0
    v_fmac_f32 v155, v110, v110
    v_fmac_f32 v155, v111, v111
    v_mfma_f32_16x16x32_bf16 v[36:39], v[160:163], v[168:171], v[36:39]
    s_nop 0
    v_mul_f32 v20, v20, v4
    v_mul_f32 v21, v21, v4
    v_mfma_f32_16x16x32_bf16 v[60:63], v[24:27], v[80:83], 0
    v_cvt_pk_bf16_f32 v40, v20, v21
    v_mul_f32 v22, v22, v4
    v_mfma_f32_16x16x32_bf16 v[60:63], v[156:159], v[168:171], v[60:63]
    s_waitcnt lgkmcnt(0)
    v_mul_f32 v23, v23, v4
    v_cvt_pk_bf16_f32 v41, v22, v23
    v_mfma_f32_16x16x32_bf16 v[24:27], a[0:3], v[8:11], 0
    s_cbranch_scc1 L_loopS0
    ds_write_b64 v137, v[40:41] offset:3072
    v_mul_f32 v36, v36, v4
    v_mul_f32 v37, v37, v4
    v_cvt_pk_bf16_f32 v42, v36, v37
    v_mul_f32 v38, v38, v4
    v_mul_f32 v39, v39, v4
    v_cvt_pk_bf16_f32 v43, v38, v39
    v_mul_f32 v60, v60, v4
    v_mul_f32 v61, v61, v4
    v_cvt_pk_bf16_f32 v40, v60, v61
    v_mul_f32 v62, v62, v4
    v_mul_f32 v63, v63, v4
    v_cvt_pk_bf16_f32 v41, v62, v63
    s_sub_u32 s84, s45, s44
    s_mov_b32 s30, 100270464
    ds_write_b64 v137, v[42:43] offset:3080
    v_fmac_f32 v155, v52, v52
    s_sub_u32 s85, s71, 1
    ds_write_b64 v136, v[40:41] offset:3072
    v_fmac_f32 v155, v53, v53
    v_fmac_f32 v155, v54, v54
    v_fmac_f32 v155, v55, v55
    v_fma_f32 v125, v12, v12, s42
    v_fmac_f32 v125, v13, v13
    v_fmac_f32 v125, v14, v14
    v_fmac_f32 v125, v15, v15
    v_fmac_f32 v125, v16, v16
    v_fmac_f32 v125, v17, v17
    v_fmac_f32 v125, v18, v18
    v_fmac_f32 v125, v19, v19
    v_fmac_f32 v125, v56, v56
    v_fmac_f32 v125, v57, v57
    v_fmac_f32 v125, v58, v58
    v_fmac_f32 v125, v59, v59
    v_cvt_pk_bf16_f32 v124, v154, v155
    v_cvt_pk_bf16_f32 v125, v125, v125
    ds_write_b64 v132, v[124:125]
    v_mbcnt_lo_u32_b32 v124, -1, 0
    v_mbcnt_hi_u32_b32 v124, -1, v124
    v_and_b32 v0, 15, v124
    v_lshrrev_b32 v133, 4, v124
    v_add_u32 v24, s84, v139
    v_add_u32 v7, s84, v138
    s_sub_u32 s84, s46, s45
    v_add_u32 v134, s84, v137
    v_add_u32 v5, s84, v136
    s_sub_u32 s84, s44, s45
    v_add_u32 v6, s84, v137
    v_add_u32 v125, s84, v136
    s_sub_u32 s84, s44, s47
    v_add_u32 v3, s84, v135
    s_sub_u32 s84, s45, s47
    v_add_u32 v124, s84, v135
    s_sub_u32 s84, s46, s47
    v_add_u32 v4, s84, v135
    s_mul_i32 s84, s68, 7056
    s_add_u32 s84, s84, 135616
    v_mul_u32_u24 v133, 80, v133
    v_add_u32 v133, s84, v133
    s_movk_i32 s84, 336
    v_min_u32 v62, s85, v0
    v_mad_u32_u24 v62, v62, s84, v133
    v_add_u32 v38, 16, v0
    v_min_u32 v38, s85, v38
    v_mad_u32_u24 v38, v38, s84, v133
    s_lshl_b32 s84, s68, 10
    v_add_u32 v133, s84, v131
    ds_read_b96 v[0:2], v133 offset:4096
    ds_read_b128 v[20:23], v62 offset:0
    ds_read_b128 v[8:11], v62 offset:16
    ds_read_b64 v[60:61], v62 offset:56
    ds_read_b128 v[62:65], v62 offset:64
    ds_read_b128 v[76:79], v38 offset:0
    ds_read_b128 v[72:75], v38 offset:16
    ds_read_b64 v[36:37], v38 offset:56
    ds_read_b128 v[38:41], v38 offset:64
    s_waitcnt lgkmcnt(6)
    v_mfma_f32_16x16x32_bf16 v[68:71], v[220:223], v[20:23], 0
    v_mfma_f32_16x16x32_bf16 v[68:71], v[220:223], v[8:11], v[68:71]
    s_waitcnt lgkmcnt(3)
    v_lshlrev_b32 v8, 16, v60
    v_and_b32 v60, 0xffff0000, v60
    v_lshlrev_b32 v9, 16, v61
    v_and_b32 v61, 0xffff0000, v61
    v_lshlrev_b32 v10, 16, v62
    v_and_b32 v62, 0xffff0000, v62
    v_mfma_f32_16x16x32_bf16 v[20:23], v[220:223], v[76:79], 0
    s_waitcnt lgkmcnt(2)
    v_rcp_f32 v68, v68
    v_mfma_f32_16x16x32_bf16 v[20:23], v[220:223], v[72:75], v[20:23]
    v_mul_f32 v8, v8, v68
    v_mul_f32 v60, v60, v68
    v_cvt_pk_bf16_f32 v8, v8, v60
    v_mul_f32 v9, v9, v68
    v_mul_f32 v61, v61, v68
    v_cvt_pk_bf16_f32 v9, v9, v61
    v_mul_f32 v10, v10, v68
    v_mul_f32 v62, v62, v68
    v_cvt_pk_bf16_f32 v10, v10, v62
    v_lshlrev_b32 v11, 16, v63
    v_and_b32 v63, 0xffff0000, v63
    v_mul_f32 v11, v11, v68
    v_mul_f32 v63, v63, v68
    v_cvt_pk_bf16_f32 v11, v11, v63
    v_lshlrev_b32 v42, 16, v64
    v_and_b32 v64, 0xffff0000, v64
    v_mul_f32 v42, v42, v68
    v_mul_f32 v64, v64, v68
    v_cvt_pk_bf16_f32 v22, v42, v64
    v_lshlrev_b32 v21, 16, v65
    v_and_b32 v65, 0xffff0000, v65
    v_mul_f32 v21, v21, v68
    v_mul_f32 v65, v65, v68
    v_cvt_pk_bf16_f32 v23, v21, v65
    ds_write_b64 v6, v[8:9] offset:0
    v_rcp_f32 v20, v20
    ds_write_b64 v6, v[10:11] offset:8
    s_waitcnt lgkmcnt(2)
    v_lshlrev_b32 v42, 16, v36
    v_and_b32 v36, 0xffff0000, v36
    ds_write_b64 v125, v[22:23] offset:0
    v_mul_f32 v42, v42, v20
    v_mul_f32 v36, v36, v20
    v_cvt_pk_bf16_f32 v8, v42, v36
    v_lshlrev_b32 v36, 16, v37
    v_and_b32 v37, 0xffff0000, v37
    v_mul_f32 v36, v36, v20
    v_mul_f32 v37, v37, v20
    v_cvt_pk_bf16_f32 v9, v36, v37
    v_lshlrev_b32 v10, 16, v38
    v_and_b32 v38, 0xffff0000, v38
    v_mul_f32 v10, v10, v20
    v_mul_f32 v38, v38, v20
    v_cvt_pk_bf16_f32 v10, v10, v38
    v_lshlrev_b32 v11, 16, v39
    v_and_b32 v39, 0xffff0000, v39
    v_mul_f32 v11, v11, v20
    v_mul_f32 v39, v39, v20
    v_cvt_pk_bf16_f32 v11, v11, v39
    v_lshlrev_b32 v42, 16, v40
    v_and_b32 v40, 0xffff0000, v40
    v_mul_f32 v42, v42, v20
    v_mul_f32 v40, v40, v20
    v_cvt_pk_bf16_f32 v26, v42, v40
    v_lshlrev_b32 v25, 16, v41
    v_and_b32 v41, 0xffff0000, v41
    v_mul_f32 v25, v25, v20
    v_mul_f32 v41, v41, v20
    v_cvt_pk_bf16_f32 v27, v25, v41
    ds_write_b64 v6, v[8:9] offset:1536
    ds_write_b64 v6, v[10:11] offset:1544
    ds_write_b64 v125, v[26:27] offset:1536
    s_waitcnt lgkmcnt(0)
    s_barrier
    ds_read_b128 v[100:103], v24 offset:0
    ds_read_b128 v[96:99], v7 offset:0
    ds_read_b128 v[92:95], v24 offset:128
    ds_read_b128 v[88:91], v7 offset:128
    ds_read_b128 v[80:83], v24 offset:256
    ds_read_b128 v[68:71], v7 offset:256
    ds_read_b128 v[64:67], v131 offset:0
    ds_read_b128 v[60:63], v131 offset:1024
    s_waitcnt lgkmcnt(6)
    v_mfma_f32_16x16x32_bf16 v[76:79], a[216:219], v[100:103], 0
    v_mfma_f32_16x16x32_bf16 v[76:79], a[220:223], v[96:99], v[76:79]
    s_waitcnt lgkmcnt(4)
    v_mfma_f32_16x16x32_bf16 v[76:79], a[224:227], v[92:95], v[76:79]
    v_mfma_f32_16x16x32_bf16 v[76:79], a[228:231], v[88:91], v[76:79]
    s_waitcnt lgkmcnt(2)
    ds_read_b128 v[116:119], v24 offset:1536
    ds_read_b128 v[112:115], v7 offset:1536
    v_mfma_f32_16x16x32_bf16 v[76:79], a[232:235], v[80:83], v[76:79]
    ds_read_b128 v[40:43], v24 offset:1664
    v_mfma_f32_16x16x32_bf16 v[76:79], a[236:239], v[68:71], v[76:79]
    ds_read_b128 v[36:39], v7 offset:1664
    v_mfma_f32_16x16x32_bf16 v[84:87], a[240:243], v[100:103], 0
    s_nop 0
    ds_read_b128 v[20:23], v24 offset:1792
    s_nop 0
    v_mfma_f32_16x16x32_bf16 v[84:87], a[244:247], v[96:99], v[84:87]
    s_nop 0
    ds_read_b128 v[8:11], v7 offset:1792
    v_fma_f32 v133, v76, v76, s42
    v_mfma_f32_16x16x32_bf16 v[84:87], a[248:251], v[92:95], v[84:87]
    v_fmac_f32 v133, v77, v77
    v_fmac_f32 v133, v78, v78
    v_mfma_f32_16x16x32_bf16 v[84:87], a[252:255], v[88:91], v[84:87]
    v_fmac_f32 v133, v79, v79
    v_mfma_f32_16x16x32_bf16 v[84:87], v[224:227], v[80:83], v[84:87]
    v_mfma_f32_16x16x32_bf16 v[84:87], v[228:231], v[68:71], v[84:87]
    s_nop 1
    v_mfma_f32_16x16x32_bf16 v[72:75], v[232:235], v[100:103], 0
    s_nop 2
    v_mfma_f32_16x16x32_bf16 v[72:75], v[236:239], v[96:99], v[72:75]
    s_nop 0
    v_fmac_f32 v133, v84, v84
    v_fmac_f32 v133, v85, v85
    v_mfma_f32_16x16x32_bf16 v[72:75], v[240:243], v[92:95], v[72:75]
    v_fmac_f32 v133, v86, v86
    v_fmac_f32 v133, v87, v87
    v_mfma_f32_16x16x32_bf16 v[72:75], v[244:247], v[88:91], v[72:75]
    v_mov_b32 v135, 0
    v_mfma_f32_16x16x32_bf16 v[72:75], v[248:251], v[80:83], v[72:75]
    v_mfma_f32_16x16x32_bf16 v[72:75], v[252:255], v[68:71], v[72:75]
    s_waitcnt lgkmcnt(0)
    s_nop 0
    v_mfma_f32_16x16x32_bf16 v[104:107], v[216:219], v[64:67], 0
    s_nop 2
    v_mfma_f32_16x16x32_bf16 v[104:107], v[216:219], v[60:63], v[104:107]
    s_nop 0
    v_fmac_f32 v133, v72, v72
    v_fmac_f32 v133, v73, v73
    v_mfma_f32_16x16x32_bf16 v[68:71], a[216:219], v[116:119], 0
    v_fmac_f32 v133, v74, v74
    v_fmac_f32 v133, v75, v75
    v_mfma_f32_16x16x32_bf16 v[68:71], a[220:223], v[112:115], v[68:71]
    ds_read_b128 v[100:103], v24 offset:3072
    ds_read_b128 v[96:99], v7 offset:3072
    v_mfma_f32_16x16x32_bf16 v[68:71], a[224:227], v[40:43], v[68:71]
    ds_read_b128 v[92:95], v24 offset:3200
    v_mfma_f32_16x16x32_bf16 v[68:71], a[228:231], v[36:39], v[68:71]
    ds_read_b128 v[88:91], v7 offset:3200
    v_mfma_f32_16x16x32_bf16 v[68:71], a[232:235], v[20:23], v[68:71]
    ds_read_b128 v[80:83], v24 offset:3328
    v_mfma_f32_16x16x32_bf16 v[68:71], a[236:239], v[8:11], v[68:71]
    ds_read_b128 v[24:27], v7 offset:3328
    s_nop 0
    v_mfma_f32_16x16x32_bf16 v[64:67], a[240:243], v[116:119], 0
    s_nop 0
    v_rsq_f32 v104, v104
    v_mfma_f32_16x16x32_bf16 v[64:67], a[244:247], v[112:115], v[64:67]
    s_nop 0
    v_mul_f32 v104, s43, v104
    v_fma_f32 v7, v68, v68, s42
    v_mfma_f32_16x16x32_bf16 v[64:67], a[248:251], v[40:43], v[64:67]
    v_rsq_f32 v105, v105
    v_mfma_f32_16x16x32_bf16 v[64:67], a[252:255], v[36:39], v[64:67]
    v_mul_f32 v105, s43, v105
    v_fmac_f32 v7, v69, v69
    v_mfma_f32_16x16x32_bf16 v[64:67], v[224:227], v[20:23], v[64:67]
    v_rsq_f32 v106, v106
    v_mfma_f32_16x16x32_bf16 v[64:67], v[228:231], v[8:11], v[64:67]
    v_mul_f32 v106, s43, v106
    v_fmac_f32 v7, v70, v70
    v_mfma_f32_16x16x32_bf16 v[60:63], v[232:235], v[116:119], 0
    s_nop 0
    v_fmac_f32 v7, v71, v71
    v_mul_f32 v48, v48, v104
    v_mfma_f32_16x16x32_bf16 v[60:63], v[236:239], v[112:115], v[60:63]
    s_nop 0
    v_fmac_f32 v7, v64, v64
    v_fmac_f32 v7, v65, v65
    v_mfma_f32_16x16x32_bf16 v[60:63], v[240:243], v[40:43], v[60:63]
    v_fmac_f32 v7, v66, v66
    v_fmac_f32 v7, v67, v67
    v_mfma_f32_16x16x32_bf16 v[60:63], v[244:247], v[36:39], v[60:63]
    v_mul_f32 v49, v49, v104
    v_cvt_pk_bf16_f32 v40, v48, v49
    v_mfma_f32_16x16x32_bf16 v[60:63], v[248:251], v[20:23], v[60:63]
    v_mul_f32 v50, v50, v104
    v_mul_f32 v51, v51, v104
    v_mfma_f32_16x16x32_bf16 v[60:63], v[252:255], v[8:11], v[60:63]
    s_waitcnt lgkmcnt(0)
    v_cvt_pk_bf16_f32 v41, v50, v51
    v_mul_f32 v32, v32, v104
    v_mfma_f32_16x16x32_bf16 v[36:39], a[216:219], v[100:103], 0
    ds_write_b64 v134, v[40:41] offset:0
    v_mfma_f32_16x16x32_bf16 v[36:39], a[220:223], v[96:99], v[36:39]
    s_nop 0
    ds_read_b128 v[140:143], v139 offset:0
    v_fmac_f32 v7, v60, v60
    v_mfma_f32_16x16x32_bf16 v[36:39], a[224:227], v[92:95], v[36:39]
    ds_read_b128 v[120:123], v138 offset:0
    v_fmac_f32 v7, v61, v61
    v_mfma_f32_16x16x32_bf16 v[36:39], a[228:231], v[88:91], v[36:39]
    ds_read_b128 v[116:119], v139 offset:128
    v_fmac_f32 v7, v62, v62
    v_mfma_f32_16x16x32_bf16 v[36:39], a[232:235], v[80:83], v[36:39]
    ds_read_b128 v[112:115], v138 offset:128
    v_fmac_f32 v7, v63, v63
    v_mfma_f32_16x16x32_bf16 v[36:39], a[236:239], v[24:27], v[36:39]
    ds_read_b128 v[20:23], v139 offset:256
    v_mul_f32 v33, v33, v104
    v_mfma_f32_16x16x32_bf16 v[48:51], a[240:243], v[100:103], 0
    ds_read_b128 v[8:11], v138 offset:256
    v_cvt_pk_bf16_f32 v42, v32, v33
    v_mfma_f32_16x16x32_bf16 v[48:51], a[244:247], v[96:99], v[48:51]
    v_mul_f32 v34, v34, v104
    v_mul_f32 v35, v35, v104
    v_mfma_f32_16x16x32_bf16 v[48:51], a[248:251], v[92:95], v[48:51]
    v_cvt_pk_bf16_f32 v43, v34, v35
    v_mul_f32 v28, v28, v104
    v_mfma_f32_16x16x32_bf16 v[48:51], a[252:255], v[88:91], v[48:51]
    ds_write_b64 v134, v[42:43] offset:8
    v_mfma_f32_16x16x32_bf16 v[48:51], v[224:227], v[80:83], v[48:51]
    v_mul_f32 v29, v29, v104
    v_cvt_pk_bf16_f32 v28, v28, v29
    v_mfma_f32_16x16x32_bf16 v[48:51], v[228:231], v[24:27], v[48:51]
    v_mul_f32 v30, v30, v104
    v_mul_f32 v31, v31, v104
    v_mfma_f32_16x16x32_bf16 v[40:43], v[232:235], v[100:103], 0
    v_cvt_pk_bf16_f32 v29, v30, v31
    v_mul_f32 v44, v44, v105
    v_mfma_f32_16x16x32_bf16 v[40:43], v[236:239], v[96:99], v[40:43]
    ds_write_b64 v5, v[28:29] offset:0
    v_mfma_f32_16x16x32_bf16 v[40:43], v[240:243], v[92:95], v[40:43]
    v_mul_f32 v45, v45, v105
    v_cvt_pk_bf16_f32 v28, v44, v45
    v_mfma_f32_16x16x32_bf16 v[40:43], v[244:247], v[88:91], v[40:43]
    v_mul_f32 v46, v46, v105
    v_mul_f32 v47, v47, v105
    v_mfma_f32_16x16x32_bf16 v[40:43], v[248:251], v[80:83], v[40:43]
    v_cvt_pk_bf16_f32 v29, v46, v47
    v_mul_f32 v108, v108, v105
    v_mfma_f32_16x16x32_bf16 v[40:43], v[252:255], v[24:27], v[40:43]
    s_waitcnt lgkmcnt(1)
    ds_write_b64 v134, v[28:29] offset:1536
    v_mfma_f32_16x16x32_bf16 v[24:27], a[216:219], v[140:143], 0
    v_mul_f32 v109, v109, v105
    v_cvt_pk_bf16_f32 v30, v108, v109
    v_mfma_f32_16x16x32_bf16 v[24:27], a[220:223], v[120:123], v[24:27]
    v_mul_f32 v110, v110, v105
    v_mul_f32 v111, v111, v105
    v_mfma_f32_16x16x32_bf16 v[24:27], a[224:227], v[116:119], v[24:27]
    v_cvt_pk_bf16_f32 v31, v110, v111
    v_mul_f32 v52, v52, v105
    v_mfma_f32_16x16x32_bf16 v[24:27], a[228:231], v[112:115], v[24:27]
    ds_write_b64 v134, v[30:31] offset:1544
    v_mfma_f32_16x16x32_bf16 v[24:27], a[232:235], v[20:23], v[24:27]
    ds_read_b128 v[100:103], v139 offset:1536
    v_mul_f32 v53, v53, v105
    v_mfma_f32_16x16x32_bf16 v[24:27], a[236:239], v[8:11], v[24:27]
    ds_read_b128 v[96:99], v138 offset:1536
    v_cvt_pk_bf16_f32 v52, v52, v53
    v_mfma_f32_16x16x32_bf16 v[32:35], a[240:243], v[140:143], 0
    ds_read_b128 v[92:95], v139 offset:1664
    v_mul_f32 v54, v54, v105
    v_mfma_f32_16x16x32_bf16 v[32:35], a[244:247], v[120:123], v[32:35]
    ds_read_b128 v[88:91], v138 offset:1664
    v_mul_f32 v55, v55, v105
    v_mfma_f32_16x16x32_bf16 v[32:35], a[248:251], v[116:119], v[32:35]
    ds_read_b128 v[80:83], v139 offset:1792
    v_cvt_pk_bf16_f32 v53, v54, v55
    v_mfma_f32_16x16x32_bf16 v[32:35], a[252:255], v[112:115], v[32:35]
    ds_write_b64 v5, v[52:53] offset:1536
    v_mfma_f32_16x16x32_bf16 v[32:35], v[224:227], v[20:23], v[32:35]
    v_fma_f32 v139, v36, v36, s42
    v_fmac_f32 v139, v37, v37
    v_mfma_f32_16x16x32_bf16 v[32:35], v[228:231], v[8:11], v[32:35]
    ds_read_b128 v[44:47], v138 offset:1792
    v_fmac_f32 v139, v38, v38
    v_mfma_f32_16x16x32_bf16 v[28:31], v[232:235], v[140:143], 0
    v_fmac_f32 v139, v39, v39
    v_fmac_f32 v139, v48, v48
    v_mfma_f32_16x16x32_bf16 v[28:31], v[236:239], v[120:123], v[28:31]
    v_fmac_f32 v139, v49, v49
    v_fmac_f32 v139, v50, v50
    v_mfma_f32_16x16x32_bf16 v[28:31], v[240:243], v[116:119], v[28:31]
    v_fmac_f32 v139, v51, v51
    v_fmac_f32 v139, v40, v40
    v_mfma_f32_16x16x32_bf16 v[28:31], v[244:247], v[112:115], v[28:31]
    v_fmac_f32 v139, v41, v41
    v_fmac_f32 v139, v42, v42
    v_mfma_f32_16x16x32_bf16 v[28:31], v[248:251], v[20:23], v[28:31]
    v_fmac_f32 v139, v43, v43
    v_mul_f32 v12, v12, v106
    v_mfma_f32_16x16x32_bf16 v[28:31], v[252:255], v[8:11], v[28:31]
    s_waitcnt lgkmcnt(1)
    v_mul_f32 v13, v13, v106
    v_cvt_pk_bf16_f32 v12, v12, v13
    v_mfma_f32_16x16x32_bf16 v[8:11], a[216:219], v[100:103], 0
    v_mul_f32 v14, v14, v106
    v_mul_f32 v15, v15, v106
    v_mfma_f32_16x16x32_bf16 v[8:11], a[220:223], v[96:99], v[8:11]
    v_cvt_pk_bf16_f32 v13, v14, v15
    v_mul_f32 v16, v16, v106
    v_mfma_f32_16x16x32_bf16 v[8:11], a[224:227], v[92:95], v[8:11]
    ds_write_b64 v134, v[12:13] offset:3072
    v_mfma_f32_16x16x32_bf16 v[8:11], a[228:231], v[88:91], v[8:11]
    v_mul_f32 v17, v17, v106
    v_cvt_pk_bf16_f32 v14, v16, v17
    v_mfma_f32_16x16x32_bf16 v[8:11], a[232:235], v[80:83], v[8:11]
    s_waitcnt lgkmcnt(1)
    v_mul_f32 v18, v18, v106
    v_mul_f32 v19, v19, v106
    v_mfma_f32_16x16x32_bf16 v[8:11], a[236:239], v[44:47], v[8:11]
    v_cvt_pk_bf16_f32 v15, v18, v19
    v_mul_f32 v56, v56, v106
    v_mfma_f32_16x16x32_bf16 v[20:23], a[240:243], v[100:103], 0
    ds_write_b64 v134, v[14:15] offset:3080
    v_mfma_f32_16x16x32_bf16 v[20:23], a[244:247], v[96:99], v[20:23]
    v_mul_f32 v57, v57, v106
    v_cvt_pk_bf16_f32 v56, v56, v57
    v_mfma_f32_16x16x32_bf16 v[20:23], a[248:251], v[92:95], v[20:23]
    v_mul_f32 v58, v58, v106
    v_mul_f32 v59, v59, v106
    v_mfma_f32_16x16x32_bf16 v[20:23], a[252:255], v[88:91], v[20:23]
    v_cvt_pk_bf16_f32 v57, v58, v59
    v_cvt_pk_bf16_f32 v138, v133, v7
    v_mfma_f32_16x16x32_bf16 v[20:23], v[224:227], v[80:83], v[20:23]
    ds_write_b64 v5, v[56:57] offset:3072
    v_mfma_f32_16x16x32_bf16 v[20:23], v[228:231], v[44:47], v[20:23]
    v_cvt_pk_bf16_f32 v139, v139, v139
    v_fma_f32 v5, v24, v24, s42
    v_mfma_f32_16x16x32_bf16 v[12:15], v[232:235], v[100:103], 0
    ds_write_b64 v132, v[138:139] offset:2048
    v_mfma_f32_16x16x32_bf16 v[12:15], v[236:239], v[96:99], v[12:15]
    v_fmac_f32 v5, v25, v25
    v_fmac_f32 v5, v26, v26
    v_mfma_f32_16x16x32_bf16 v[12:15], v[240:243], v[92:95], v[12:15]
    v_fmac_f32 v5, v27, v27
    v_fmac_f32 v5, v32, v32
    v_mfma_f32_16x16x32_bf16 v[12:15], v[244:247], v[88:91], v[12:15]
    v_fmac_f32 v5, v33, v33
    v_fmac_f32 v5, v34, v34
    v_mfma_f32_16x16x32_bf16 v[12:15], v[248:251], v[80:83], v[12:15]
    v_fmac_f32 v5, v35, v35
    v_fmac_f32 v5, v28, v28
    v_mfma_f32_16x16x32_bf16 v[12:15], v[252:255], v[44:47], v[12:15]
    v_fmac_f32 v5, v29, v29
    v_fmac_f32 v5, v30, v30
    v_fmac_f32 v5, v31, v31
    v_fma_f32 v7, v8, v8, s42
    v_fmac_f32 v7, v9, v9
    v_fmac_f32 v7, v10, v10
    v_fmac_f32 v7, v11, v11
    v_fmac_f32 v7, v20, v20
    v_fmac_f32 v7, v21, v21
    v_fmac_f32 v7, v22, v22
    v_fmac_f32 v7, v23, v23
    v_fmac_f32 v7, v12, v12
    v_fmac_f32 v7, v13, v13
    v_fmac_f32 v7, v14, v14
    s_waitcnt lgkmcnt(0)
    s_barrier
    ds_read_b128 v[80:83], v131 offset:2048
    ds_read_b128 v[52:55], v131 offset:3072
    v_fmac_f32 v7, v15, v15
    v_cvt_pk_bf16_f32 v134, v5, v7
    ds_write_b64 v132, v[134:135]
    ds_read_b128 v[96:99], v4 offset:0
    ds_read_b128 v[92:95], v4 offset:1024
    ds_read_b128 v[88:91], v4 offset:2048
    ds_read_b128 v[16:19], v4 offset:3072
    ds_read_b128 v[56:59], v4 offset:4096
    s_waitcnt lgkmcnt(6)
    v_mfma_f32_16x16x32_bf16 v[44:47], v[216:219], v[80:83], 0
    v_mfma_f32_16x16x32_bf16 v[44:47], v[216:219], v[52:55], v[44:47]
    s_waitcnt lgkmcnt(4)
    s_nop 1
    s_barrier
    ds_read_b128 v[80:83], v131 offset:0
    ds_read_b128 v[52:55], v131 offset:1024
    s_nop 0
    buffer_store_dwordx4 v[96:99], v130, s[28:31], s59 offen sc1
    v_rsq_f32 v44, v44
    v_rsq_f32 v45, v45
    v_mul_f32 v44, s43, v44
    v_mul_f32 v45, s43, v45
    v_rsq_f32 v46, v46
    s_waitcnt lgkmcnt(3)
    buffer_store_dwordx4 v[92:95], v129, s[28:31], s59 offen sc1
    v_mul_f32 v46, s43, v46
    v_mul_f32 v76, v76, v44
    v_mul_f32 v77, v77, v44
    v_cvt_pk_bf16_f32 v76, v76, v77
    v_mul_f32 v78, v78, v44
    v_mul_f32 v79, v79, v44
    buffer_store_dwordx4 v[88:91], v128, s[28:31], s59 offen sc1
    v_cvt_pk_bf16_f32 v77, v78, v79
    v_mul_f32 v84, v84, v44
    v_mul_f32 v85, v85, v44
    v_cvt_pk_bf16_f32 v78, v84, v85
    v_mul_f32 v86, v86, v44
    v_mul_f32 v87, v87, v44
    buffer_store_dwordx4 v[16:19], v127, s[28:31], s59 offen sc1
    ds_write_b64 v137, v[76:77] offset:0
    v_cvt_pk_bf16_f32 v79, v86, v87
    s_waitcnt lgkmcnt(1)
    v_mfma_f32_16x16x32_bf16 v[16:19], v[216:219], v[80:83], 0
    buffer_store_dwordx4 v[56:59], v126, s[28:31], s59 offen sc1
    ds_write_b64 v137, v[78:79] offset:8
    v_mul_f32 v72, v72, v44
    v_mfma_f32_16x16x32_bf16 v[16:19], v[216:219], v[52:55], v[16:19]
    v_mul_f32 v73, v73, v44
    v_cvt_pk_bf16_f32 v138, v72, v73
    v_mul_f32 v74, v74, v44
    v_mul_f32 v75, v75, v44
    v_cvt_pk_bf16_f32 v139, v74, v75
    ds_write_b64 v136, v[138:139] offset:0
    v_mul_f32 v68, v68, v45
    v_mul_f32 v69, v69, v45
    v_cvt_pk_bf16_f32 v52, v68, v69
    v_mul_f32 v70, v70, v45
    v_mul_f32 v71, v71, v45
    v_cvt_pk_bf16_f32 v53, v70, v71
    v_mul_f32 v64, v64, v45
    v_mul_f32 v65, v65, v45
    v_cvt_pk_bf16_f32 v54, v64, v65
    v_mul_f32 v66, v66, v45
    v_mul_f32 v67, v67, v45
    v_cvt_pk_bf16_f32 v55, v66, v67
    v_mul_f32 v60, v60, v45
    v_mul_f32 v61, v61, v45
    v_cvt_pk_bf16_f32 v18, v60, v61
    v_mul_f32 v62, v62, v45
    v_mul_f32 v63, v63, v45
    v_cvt_pk_bf16_f32 v19, v62, v63
    ds_write_b64 v137, v[52:53] offset:1536
    v_mul_f32 v36, v36, v46
    ds_write_b64 v137, v[54:55] offset:1544
    v_mul_f32 v37, v37, v46
    v_cvt_pk_bf16_f32 v36, v36, v37
    v_mul_f32 v38, v38, v46
    ds_write_b64 v136, v[18:19] offset:1536
    v_mul_f32 v39, v39, v46
    v_cvt_pk_bf16_f32 v37, v38, v39
    v_mul_f32 v48, v48, v46
    v_mul_f32 v49, v49, v46
    v_cvt_pk_bf16_f32 v38, v48, v49
    v_mul_f32 v50, v50, v46
    v_mul_f32 v51, v51, v46
    v_cvt_pk_bf16_f32 v39, v50, v51
    v_mul_f32 v40, v40, v46
    v_mul_f32 v41, v41, v46
    v_cvt_pk_bf16_f32 v18, v40, v41
    v_mul_f32 v42, v42, v46
    v_mul_f32 v43, v43, v46
    v_cvt_pk_bf16_f32 v19, v42, v43
    ds_write_b64 v137, v[36:37] offset:3072
    v_rsq_f32 v16, v16
    ds_write_b64 v137, v[38:39] offset:3080
    v_mul_f32 v16, s43, v16
    v_rsq_f32 v17, v17
    ds_write_b64 v136, v[18:19] offset:3072
    v_mul_f32 v17, s43, v17
    v_mul_f32 v24, v24, v16
    v_mul_f32 v25, v25, v16
    v_cvt_pk_bf16_f32 v24, v24, v25
    v_mul_f32 v26, v26, v16
    v_mul_f32 v27, v27, v16
    v_cvt_pk_bf16_f32 v25, v26, v27
    v_mul_f32 v32, v32, v16
    v_mul_f32 v33, v33, v16
    v_cvt_pk_bf16_f32 v26, v32, v33
    v_mul_f32 v34, v34, v16
    v_mul_f32 v35, v35, v16
    v_cvt_pk_bf16_f32 v27, v34, v35
    v_mul_f32 v28, v28, v16
    v_mul_f32 v29, v29, v16
    v_cvt_pk_bf16_f32 v18, v28, v29
    v_mul_f32 v30, v30, v16
    v_mul_f32 v31, v31, v16
    v_cvt_pk_bf16_f32 v19, v30, v31
    ds_write_b64 v6, v[24:25] offset:0
    v_mul_f32 v8, v8, v17
    ds_write_b64 v6, v[26:27] offset:8
    v_mul_f32 v9, v9, v17
    v_cvt_pk_bf16_f32 v8, v8, v9
    v_mul_f32 v10, v10, v17
    ds_write_b64 v125, v[18:19] offset:0
    v_mul_f32 v11, v11, v17
    v_cvt_pk_bf16_f32 v9, v10, v11
    v_mul_f32 v20, v20, v17
    v_mul_f32 v21, v21, v17
    v_cvt_pk_bf16_f32 v10, v20, v21
    v_mul_f32 v22, v22, v17
    v_mul_f32 v23, v23, v17
    v_cvt_pk_bf16_f32 v11, v22, v23
    v_mul_f32 v12, v12, v17
    v_mul_f32 v13, v13, v17
    v_cvt_pk_bf16_f32 v4, v12, v13
    v_mul_f32 v14, v14, v17
    v_mul_f32 v15, v15, v17
    v_cvt_pk_bf16_f32 v5, v14, v15
    ds_write_b64 v6, v[8:9] offset:1536
    ds_write_b64 v6, v[10:11] offset:1544
    ds_write_b64 v125, v[4:5] offset:1536
    s_waitcnt lgkmcnt(0)
    s_barrier
    ds_read_b128 v[32:35], v124 offset:0
    ds_read_b128 v[28:31], v124 offset:1024
    ds_read_b128 v[24:27], v124 offset:2048
    ds_read_b128 v[20:23], v124 offset:3072
    ds_read_b128 v[16:19], v124 offset:4096
    ds_read_b128 v[12:15], v3 offset:0
    ds_read_b128 v[8:11], v3 offset:1024
    ds_read_b128 v[4:7], v3 offset:2048
    s_waitcnt lgkmcnt(6)
    buffer_store_dwordx4 v[32:35], v130, s[28:31], s58 offen sc1
    buffer_store_dwordx4 v[28:31], v129, s[28:31], s58 offen sc1
    s_waitcnt lgkmcnt(3)
    buffer_store_dwordx4 v[24:27], v128, s[28:31], s58 offen sc1
    buffer_store_dwordx4 v[20:23], v127, s[28:31], s58 offen sc1
    buffer_store_dwordx4 v[16:19], v126, s[28:31], s58 offen sc1
    s_waitcnt lgkmcnt(0)
    buffer_store_dwordx4 v[12:15], v0, s[28:31], 0 offen sc1
    buffer_store_dwordx4 v[8:11], v1, s[28:31], 0 offen sc1
    buffer_store_dwordx4 v[4:7], v2, s[28:31], 0 offen sc1
    s_endpgm
L_bndF:
    s_movk_i32 s71, 18
    s_cmp_eq_u32 s2, 246
    s_cbranch_scc1 L_bndrF
    s_mov_b32 s70, 0
    s_mov_b32 s74, 0
    s_cmp_lt_u32 s2, 251
    s_cbranch_scc1 L_bndcF
    s_sub_u32 s94, s2, 251
    s_mul_i32 s69, s94, 48384
    s_mov_b32 s74, 25239312
    s_sub_u32 s93, s93, 1373568
    v_cmp_le_u32 vcc, 4, v152
    v_add_u32 v20, 98896896, v130
    v_subrev_u32 v21, 1373568, v130
    v_cndmask_b32 v130, v20, v21, vcc
    v_cmp_le_u32 vcc, 4, v48
    v_add_u32 v20, 98896896, v129
    v_subrev_u32 v21, 1373568, v129
    v_cndmask_b32 v129, v20, v21, vcc
    v_cmp_le_u32 vcc, 4, v159
    v_add_u32 v20, 98896896, v128
    v_subrev_u32 v21, 1373568, v128
    v_cndmask_b32 v128, v20, v21, vcc
    v_cmp_le_u32 vcc, 4, v157
    v_add_u32 v20, 98896896, v127
    v_subrev_u32 v21, 1373568, v127
    v_cndmask_b32 v127, v20, v21, vcc
    v_cmp_le_u32 vcc, 4, v23
    v_add_u32 v20, 98896896, v126
    v_subrev_u32 v21, 1373568, v126
    v_cndmask_b32 v126, v20, v21, vcc
    s_cmp_lt_u32 s2, 255
    s_cbranch_scc1 L_bndrF
L_bndcF:
    s_sub_u32 s94, s2, 247
    s_mul_i32 s69, s94, 24724224
    s_mov_b32 s62, 1373568
    s_add_u32 s74, s74, 345744
    s_sub_u32 s93, s93, 2688
    v_mad_i32_i24 v20, v152, -7, v49
    v_cmp_le_u32 vcc, 4, v20
    v_add_u32 v20, 193536, v130
    v_subrev_u32 v21, 2688, v130
    v_cndmask_b32 v130, v20, v21, vcc
    v_mad_i32_i24 v20, v48, -7, v50
    v_cmp_le_u32 vcc, 4, v20
    v_add_u32 v20, 193536, v129
    v_subrev_u32 v21, 2688, v129
    v_cndmask_b32 v129, v20, v21, vcc
    v_mad_i32_i24 v20, v159, -7, v72
    v_cmp_le_u32 vcc, 4, v20
    v_add_u32 v20, 193536, v128
    v_subrev_u32 v21, 2688, v128
    v_cndmask_b32 v128, v20, v21, vcc
    v_mad_i32_i24 v20, v157, -7, v125
    v_cmp_le_u32 vcc, 4, v20
    v_add_u32 v20, 193536, v127
    v_subrev_u32 v21, 2688, v127
    v_cndmask_b32 v127, v20, v21, vcc
    v_mad_i32_i24 v20, v23, -7, v73
    v_cmp_le_u32 vcc, 4, v20
    v_add_u32 v20, 193536, v126
    v_subrev_u32 v21, 2688, v126
    v_cndmask_b32 v126, v20, v21, vcc
    s_cmp_eq_u32 s2, 255
    s_cselect_b32 s62, 0, s62
    s_cselect_b32 s69, 0, s69
    s_cselect_b32 s71, 2, s71
    s_branch L_bndrF
L_maskF:
    s_add_u32 s20, s20, s74
    s_addc_u32 s21, s21, 0
    s_mov_b32 s22, 4802
    s_mov_b32 s23, 0x20000
    s_mov_b32 s85, 0x3fb8aa3b
    s_waitcnt vmcnt(0)
    v_lshrrev_b32 v160, 2, v45
    v_add_u32 v160, 0, v160
    v_mul_u32_u24 v160, 98, v160
    v_mad_u32_u24 v161, v156, 24, v160
    buffer_load_ushort v81, v161, s[20:23], 0 offen offset:0
    buffer_load_ushort v28, v161, s[20:23], 0 offen offset:2
    buffer_load_ushort v83, v161, s[20:23], 0 offen offset:4
    buffer_load_ushort v80, v161, s[20:23], 0 offen offset:6
    buffer_load_ushort v165, v161, s[20:23], 0 offen offset:8
    buffer_load_ushort v168, v161, s[20:23], 0 offen offset:10
    buffer_load_ushort v164, v161, s[20:23], 0 offen offset:12
    buffer_load_ushort v29, v161, s[20:23], 0 offen offset:14
    buffer_load_ushort v169, v161, s[20:23], 0 offen offset:16
    buffer_load_ushort v157, v161, s[20:23], 0 offen offset:18
    buffer_load_ushort v44, v161, s[20:23], 0 offen offset:20
    buffer_load_ushort v46, v161, s[20:23], 0 offen offset:22
    buffer_load_ushort v170, v160, s[20:23], 0 offen offset:96
    s_waitcnt vmcnt(0)
    v_lshlrev_b32 v81, 16, v81
    v_fmac_f32 v204, s85, v81
    v_lshlrev_b32 v28, 16, v28
    v_fmac_f32 v205, s85, v28
    v_lshlrev_b32 v83, 16, v83
    v_fmac_f32 v206, s85, v83
    v_lshlrev_b32 v80, 16, v80
    v_fmac_f32 v207, s85, v80
    v_lshlrev_b32 v165, 16, v165
    v_fmac_f32 v200, s85, v165
    v_lshlrev_b32 v168, 16, v168
    v_fmac_f32 v201, s85, v168
    v_lshlrev_b32 v164, 16, v164
    v_fmac_f32 v202, s85, v164
    v_lshlrev_b32 v29, 16, v29
    v_fmac_f32 v203, s85, v29
    v_lshlrev_b32 v169, 16, v169
    v_fmac_f32 v196, s85, v169
    v_lshlrev_b32 v157, 16, v157
    v_fmac_f32 v197, s85, v157
    v_lshlrev_b32 v44, 16, v44
    v_fmac_f32 v198, s85, v44
    v_lshlrev_b32 v46, 16, v46
    v_fmac_f32 v199, s85, v46
    v_lshlrev_b32 v170, 16, v170
    v_fmac_f32 v208, s85, v170
    v_lshrrev_b32 v160, 2, v45
    v_add_u32 v160, 4, v160
    v_mul_u32_u24 v160, 98, v160
    v_mad_u32_u24 v161, v156, 24, v160
    buffer_load_ushort v81, v161, s[20:23], 0 offen offset:0
    buffer_load_ushort v28, v161, s[20:23], 0 offen offset:2
    buffer_load_ushort v83, v161, s[20:23], 0 offen offset:4
    buffer_load_ushort v80, v161, s[20:23], 0 offen offset:6
    buffer_load_ushort v165, v161, s[20:23], 0 offen offset:8
    buffer_load_ushort v168, v161, s[20:23], 0 offen offset:10
    buffer_load_ushort v164, v161, s[20:23], 0 offen offset:12
    buffer_load_ushort v29, v161, s[20:23], 0 offen offset:14
    buffer_load_ushort v169, v161, s[20:23], 0 offen offset:16
    buffer_load_ushort v157, v161, s[20:23], 0 offen offset:18
    buffer_load_ushort v44, v161, s[20:23], 0 offen offset:20
    buffer_load_ushort v46, v161, s[20:23], 0 offen offset:22
    buffer_load_ushort v170, v160, s[20:23], 0 offen offset:96
    s_waitcnt vmcnt(0)
    v_lshlrev_b32 v81, 16, v81
    v_fmac_f32 v192, s85, v81
    v_lshlrev_b32 v28, 16, v28
    v_fmac_f32 v193, s85, v28
    v_lshlrev_b32 v83, 16, v83
    v_fmac_f32 v194, s85, v83
    v_lshlrev_b32 v80, 16, v80
    v_fmac_f32 v195, s85, v80
    v_lshlrev_b32 v165, 16, v165
    v_fmac_f32 v188, s85, v165
    v_lshlrev_b32 v168, 16, v168
    v_fmac_f32 v189, s85, v168
    v_lshlrev_b32 v164, 16, v164
    v_fmac_f32 v190, s85, v164
    v_lshlrev_b32 v29, 16, v29
    v_fmac_f32 v191, s85, v29
    v_lshlrev_b32 v169, 16, v169
    v_fmac_f32 v184, s85, v169
    v_lshlrev_b32 v157, 16, v157
    v_fmac_f32 v185, s85, v157
    v_lshlrev_b32 v44, 16, v44
    v_fmac_f32 v186, s85, v44
    v_lshlrev_b32 v46, 16, v46
    v_fmac_f32 v187, s85, v46
    v_lshlrev_b32 v170, 16, v170
    v_fmac_f32 v209, s85, v170
    v_lshrrev_b32 v160, 2, v45
    v_add_u32 v160, 8, v160
    v_mul_u32_u24 v160, 98, v160
    v_mad_u32_u24 v161, v156, 24, v160
    buffer_load_ushort v81, v161, s[20:23], 0 offen offset:0
    buffer_load_ushort v28, v161, s[20:23], 0 offen offset:2
    buffer_load_ushort v83, v161, s[20:23], 0 offen offset:4
    buffer_load_ushort v80, v161, s[20:23], 0 offen offset:6
    buffer_load_ushort v165, v161, s[20:23], 0 offen offset:8
    buffer_load_ushort v168, v161, s[20:23], 0 offen offset:10
    buffer_load_ushort v164, v161, s[20:23], 0 offen offset:12
    buffer_load_ushort v29, v161, s[20:23], 0 offen offset:14
    buffer_load_ushort v169, v161, s[20:23], 0 offen offset:16
    buffer_load_ushort v157, v161, s[20:23], 0 offen offset:18
    buffer_load_ushort v44, v161, s[20:23], 0 offen offset:20
    buffer_load_ushort v46, v161, s[20:23], 0 offen offset:22
    buffer_load_ushort v170, v160, s[20:23], 0 offen offset:96
    s_waitcnt vmcnt(0)
    v_lshlrev_b32 v81, 16, v81
    v_fmac_f32 v180, s85, v81
    v_lshlrev_b32 v28, 16, v28
    v_fmac_f32 v181, s85, v28
    v_lshlrev_b32 v83, 16, v83
    v_fmac_f32 v182, s85, v83
    v_lshlrev_b32 v80, 16, v80
    v_fmac_f32 v183, s85, v80
    v_lshlrev_b32 v165, 16, v165
    v_fmac_f32 v176, s85, v165
    v_lshlrev_b32 v168, 16, v168
    v_fmac_f32 v177, s85, v168
    v_lshlrev_b32 v164, 16, v164
    v_fmac_f32 v178, s85, v164
    v_lshlrev_b32 v29, 16, v29
    v_fmac_f32 v179, s85, v29
    v_lshlrev_b32 v169, 16, v169
    v_fmac_f32 v172, s85, v169
    v_lshlrev_b32 v157, 16, v157
    v_fmac_f32 v173, s85, v157
    v_lshlrev_b32 v44, 16, v44
    v_fmac_f32 v174, s85, v44
    v_lshlrev_b32 v46, 16, v46
    v_fmac_f32 v175, s85, v46
    v_lshlrev_b32 v170, 16, v170
    v_fmac_f32 v210, s85, v170
    v_lshrrev_b32 v160, 2, v45
    v_lshl_add_u32 v160, v156, 2, v160
    v_cmp_gt_u32 vcc, 3, v156
    v_mov_b32 v161, 48
    s_nop 1
    v_cndmask_b32 v160, v161, v160, vcc
    v_add_u32 v160, 2352, v160
    v_lshlrev_b32 v160, 1, v160
    buffer_load_ushort v81, v160, s[20:23], 0 offen
    s_waitcnt vmcnt(0)
    v_lshlrev_b32 v81, 16, v81
    v_fmac_f32 v211, s85, v81
    s_branch L_nomaskF
L_bndS:
    s_movk_i32 s71, 18
    s_cmp_eq_u32 s2, 246
    s_cbranch_scc1 L_bndrS
    s_mov_b32 s70, 0
    s_mov_b32 s74, 0
    s_cmp_lt_u32 s2, 251
    s_cbranch_scc1 L_bndcS
    s_sub_u32 s94, s2, 251
    s_mul_i32 s69, s94, 48384
    s_mov_b32 s74, 25239312
    s_sub_u32 s93, s93, 1373568
    v_cmp_le_u32 vcc, 4, v44
    v_add_u32 v40, 98896896, v130
    v_subrev_u32 v41, 1373568, v130
    v_cndmask_b32 v130, v40, v41, vcc
    v_cmp_le_u32 vcc, 4, v131
    v_add_u32 v40, 98896896, v129
    v_subrev_u32 v41, 1373568, v129
    v_cndmask_b32 v129, v40, v41, vcc
    v_cmp_le_u32 vcc, 4, v124
    v_add_u32 v40, 98896896, v128
    v_subrev_u32 v41, 1373568, v128
    v_cndmask_b32 v128, v40, v41, vcc
    v_cmp_le_u32 vcc, 4, v11
    v_add_u32 v40, 98896896, v127
    v_subrev_u32 v41, 1373568, v127
    v_cndmask_b32 v127, v40, v41, vcc
    v_cmp_le_u32 vcc, 4, v92
    v_add_u32 v40, 98896896, v126
    v_subrev_u32 v41, 1373568, v126
    v_cndmask_b32 v126, v40, v41, vcc
    s_cmp_lt_u32 s2, 255
    s_cbranch_scc1 L_bndrS
L_bndcS:
    s_sub_u32 s94, s2, 247
    s_mul_i32 s69, s94, 24724224
    s_mov_b32 s62, 1373568
    s_add_u32 s74, s74, 345744
    s_sub_u32 s93, s93, 2688
    v_mad_i32_i24 v40, v44, -7, v10
    v_cmp_le_u32 vcc, 4, v40
    v_add_u32 v40, 193536, v130
    v_subrev_u32 v41, 2688, v130
    v_cndmask_b32 v130, v40, v41, vcc
    v_mad_i32_i24 v40, v131, -7, v46
    v_cmp_le_u32 vcc, 4, v40
    v_add_u32 v40, 193536, v129
    v_subrev_u32 v41, 2688, v129
    v_cndmask_b32 v129, v40, v41, vcc
    v_mad_i32_i24 v40, v124, -7, v94
    v_cmp_le_u32 vcc, 4, v40
    v_add_u32 v40, 193536, v128
    v_subrev_u32 v41, 2688, v128
    v_cndmask_b32 v128, v40, v41, vcc
    v_mad_i32_i24 v40, v11, -7, v52
    v_cmp_le_u32 vcc, 4, v40
    v_add_u32 v40, 193536, v127
    v_subrev_u32 v41, 2688, v127
    v_cndmask_b32 v127, v40, v41, vcc
    v_mad_i32_i24 v40, v92, -7, v125
    v_cmp_le_u32 vcc, 4, v40
    v_add_u32 v40, 193536, v126
    v_subrev_u32 v41, 2688, v126
    v_cndmask_b32 v126, v40, v41, vcc
    s_cmp_eq_u32 s2, 255
    s_cselect_b32 s62, 0, s62
    s_cselect_b32 s69, 0, s69
    s_cselect_b32 s71, 2, s71
    s_branch L_bndrS
L_maskS:
    s_add_u32 s20, s20, s74
    s_addc_u32 s21, s21, 0
    s_mov_b32 s22, 4802
    s_mov_b32 s23, 0x20000
    s_mov_b32 s85, 0x3fb8aa3b
    s_waitcnt vmcnt(0)
    v_lshrrev_b32 v92, 2, v147
    v_add_u32 v92, 0, v92
    v_mul_u32_u24 v92, 98, v92
    v_mad_u32_u24 v93, v142, 24, v92
    buffer_load_ushort v150, v93, s[20:23], 0 offen offset:0
    buffer_load_ushort v15, v93, s[20:23], 0 offen offset:2
    buffer_load_ushort v13, v93, s[20:23], 0 offen offset:4
    buffer_load_ushort v9, v93, s[20:23], 0 offen offset:6
    buffer_load_ushort v3, v93, s[20:23], 0 offen offset:8
    buffer_load_ushort v0, v93, s[20:23], 0 offen offset:10
    buffer_load_ushort v155, v93, s[20:23], 0 offen offset:12
    buffer_load_ushort v1, v93, s[20:23], 0 offen offset:14
    buffer_load_ushort v12, v93, s[20:23], 0 offen offset:16
    buffer_load_ushort v154, v93, s[20:23], 0 offen offset:18
    buffer_load_ushort v146, v93, s[20:23], 0 offen offset:20
    buffer_load_ushort v143, v93, s[20:23], 0 offen offset:22
    buffer_load_ushort v151, v92, s[20:23], 0 offen offset:96
    s_waitcnt vmcnt(0)
    v_lshlrev_b32 v150, 16, v150
    v_fmac_f32 v204, s85, v150
    v_lshlrev_b32 v15, 16, v15
    v_fmac_f32 v205, s85, v15
    v_lshlrev_b32 v13, 16, v13
    v_fmac_f32 v206, s85, v13
    v_lshlrev_b32 v9, 16, v9
    v_fmac_f32 v207, s85, v9
    v_lshlrev_b32 v3, 16, v3
    v_fmac_f32 v200, s85, v3
    v_lshlrev_b32 v0, 16, v0
    v_fmac_f32 v201, s85, v0
    v_lshlrev_b32 v155, 16, v155
    v_fmac_f32 v202, s85, v155
    v_lshlrev_b32 v1, 16, v1
    v_fmac_f32 v203, s85, v1
    v_lshlrev_b32 v12, 16, v12
    v_fmac_f32 v196, s85, v12
    v_lshlrev_b32 v154, 16, v154
    v_fmac_f32 v197, s85, v154
    v_lshlrev_b32 v146, 16, v146
    v_fmac_f32 v198, s85, v146
    v_lshlrev_b32 v143, 16, v143
    v_fmac_f32 v199, s85, v143
    v_lshlrev_b32 v151, 16, v151
    v_fmac_f32 v208, s85, v151
    v_lshrrev_b32 v92, 2, v147
    v_add_u32 v92, 4, v92
    v_mul_u32_u24 v92, 98, v92
    v_mad_u32_u24 v93, v142, 24, v92
    buffer_load_ushort v150, v93, s[20:23], 0 offen offset:0
    buffer_load_ushort v15, v93, s[20:23], 0 offen offset:2
    buffer_load_ushort v13, v93, s[20:23], 0 offen offset:4
    buffer_load_ushort v9, v93, s[20:23], 0 offen offset:6
    buffer_load_ushort v3, v93, s[20:23], 0 offen offset:8
    buffer_load_ushort v0, v93, s[20:23], 0 offen offset:10
    buffer_load_ushort v155, v93, s[20:23], 0 offen offset:12
    buffer_load_ushort v1, v93, s[20:23], 0 offen offset:14
    buffer_load_ushort v12, v93, s[20:23], 0 offen offset:16
    buffer_load_ushort v154, v93, s[20:23], 0 offen offset:18
    buffer_load_ushort v146, v93, s[20:23], 0 offen offset:20
    buffer_load_ushort v143, v93, s[20:23], 0 offen offset:22
    buffer_load_ushort v151, v92, s[20:23], 0 offen offset:96
    s_waitcnt vmcnt(0)
    v_lshlrev_b32 v150, 16, v150
    v_fmac_f32 v192, s85, v150
    v_lshlrev_b32 v15, 16, v15
    v_fmac_f32 v193, s85, v15
    v_lshlrev_b32 v13, 16, v13
    v_fmac_f32 v194, s85, v13
    v_lshlrev_b32 v9, 16, v9
    v_fmac_f32 v195, s85, v9
    v_lshlrev_b32 v3, 16, v3
    v_fmac_f32 v188, s85, v3
    v_lshlrev_b32 v0, 16, v0
    v_fmac_f32 v189, s85, v0
    v_lshlrev_b32 v155, 16, v155
    v_fmac_f32 v190, s85, v155
    v_lshlrev_b32 v1, 16, v1
    v_fmac_f32 v191, s85, v1
    v_lshlrev_b32 v12, 16, v12
    v_fmac_f32 v184, s85, v12
    v_lshlrev_b32 v154, 16, v154
    v_fmac_f32 v185, s85, v154
    v_lshlrev_b32 v146, 16, v146
    v_fmac_f32 v186, s85, v146
    v_lshlrev_b32 v143, 16, v143
    v_fmac_f32 v187, s85, v143
    v_lshlrev_b32 v151, 16, v151
    v_fmac_f32 v209, s85, v151
    v_lshrrev_b32 v92, 2, v147
    v_add_u32 v92, 8, v92
    v_mul_u32_u24 v92, 98, v92
    v_mad_u32_u24 v93, v142, 24, v92
    buffer_load_ushort v150, v93, s[20:23], 0 offen offset:0
    buffer_load_ushort v15, v93, s[20:23], 0 offen offset:2
    buffer_load_ushort v13, v93, s[20:23], 0 offen offset:4
    buffer_load_ushort v9, v93, s[20:23], 0 offen offset:6
    buffer_load_ushort v3, v93, s[20:23], 0 offen offset:8
    buffer_load_ushort v0, v93, s[20:23], 0 offen offset:10
    buffer_load_ushort v155, v93, s[20:23], 0 offen offset:12
    buffer_load_ushort v1, v93, s[20:23], 0 offen offset:14
    buffer_load_ushort v12, v93, s[20:23], 0 offen offset:16
    buffer_load_ushort v154, v93, s[20:23], 0 offen offset:18
    buffer_load_ushort v146, v93, s[20:23], 0 offen offset:20
    buffer_load_ushort v143, v93, s[20:23], 0 offen offset:22
    buffer_load_ushort v151, v92, s[20:23], 0 offen offset:96
    s_waitcnt vmcnt(0)
    v_lshlrev_b32 v150, 16, v150
    v_fmac_f32 v180, s85, v150
    v_lshlrev_b32 v15, 16, v15
    v_fmac_f32 v181, s85, v15
    v_lshlrev_b32 v13, 16, v13
    v_fmac_f32 v182, s85, v13
    v_lshlrev_b32 v9, 16, v9
    v_fmac_f32 v183, s85, v9
    v_lshlrev_b32 v3, 16, v3
    v_fmac_f32 v176, s85, v3
    v_lshlrev_b32 v0, 16, v0
    v_fmac_f32 v177, s85, v0
    v_lshlrev_b32 v155, 16, v155
    v_fmac_f32 v178, s85, v155
    v_lshlrev_b32 v1, 16, v1
    v_fmac_f32 v179, s85, v1
    v_lshlrev_b32 v12, 16, v12
    v_fmac_f32 v172, s85, v12
    v_lshlrev_b32 v154, 16, v154
    v_fmac_f32 v173, s85, v154
    v_lshlrev_b32 v146, 16, v146
    v_fmac_f32 v174, s85, v146
    v_lshlrev_b32 v143, 16, v143
    v_fmac_f32 v175, s85, v143
    v_lshlrev_b32 v151, 16, v151
    v_fmac_f32 v210, s85, v151
    v_lshrrev_b32 v92, 2, v147
    v_lshl_add_u32 v92, v142, 2, v92
    v_cmp_gt_u32 vcc, 3, v142
    v_mov_b32 v93, 48
    s_nop 1
    v_cndmask_b32 v92, v93, v92, vcc
    v_add_u32 v92, 2352, v92
    v_lshlrev_b32 v92, 1, v92
    buffer_load_ushort v150, v92, s[20:23], 0 offen
    s_waitcnt vmcnt(0)
    v_lshlrev_b32 v150, 16, v150
    v_fmac_f32 v211, s85, v150
    s_branch L_nomaskS
.section .rodata,"a"
.p2align 6
.amdhsa_kernel standalone__window_attn_swin_v2__vision_kernel
  .amdhsa_next_free_vgpr 512
  .amdhsa_next_free_sgpr 102
  .amdhsa_accum_offset 256
  .amdhsa_group_segment_fixed_size 0
  .amdhsa_kernarg_size 96
  .amdhsa_user_sgpr_count 2
  .amdhsa_user_sgpr_kernarg_segment_ptr 1
  .amdhsa_system_sgpr_workgroup_id_x 1
.end_amdhsa_kernel
```

```asm
; @launch grid=(256,1,1) block=(256,1,1) lds=163840
.amdgcn_target "amdgcn-amd-amdhsa--gfx950"
.text
.globl standalone__window_attn_swin_v2__vision_kernel
.p2align 8
.type standalone__window_attn_swin_v2__vision_kernel,@function
standalone__window_attn_swin_v2__vision_kernel:
    v_lshrrev_b32 v0, 6, v0
    s_cmp_ge_u32 s2, 256
    s_cbranch_scc1 L_end
    v_readfirstlane_b32 s68, v0
    s_mov_b32 s64, 0
    s_nop 0
    v_mbcnt_lo_u32_b32 v0, -1, 0
    v_mbcnt_hi_u32_b32 v0, -1, v0
    s_load_dwordx16 s[4:19], s[0:1], 0
    s_load_dwordx4 s[20:23], s[0:1], 64
    s_load_dwordx2 s[38:39], s[0:1], 80
    s_lshr_b32 s88, s2, 3
    s_lshl2_add_u32 s88, s88, s68
    v_lshlrev_b32 v1, 7, v0
    s_getpc_b64 s[80:81]
    s_lshl_b32 s84, s88, 8
    v_and_b32 v2, 128, v1
    v_add_u32 v2, s84, v2
    v_min_u32 v2, L_slow-standalone__window_attn_swin_v2__vision_kernel-256, v2
    s_mul_i32 s89, s88, 576
    s_mul_i32 s88, s88, 1728
    global_load_dword a255, v2, s[80:81]
    v_min_u32 v3, 1664, v1
    v_min_u32 v1, 512, v1
    s_mov_b32 s34, 221184
    s_mov_b32 s35, 0x20000
    s_mov_b32 s78, 73728
    s_mov_b32 s79, 0x20000
    v_and_b32 v9, 15, v0
    v_lshrrev_b32 v97, 4, v0
    v_lshrrev_b32 v134, 2, v9
    v_and_b32 v133, 3, v9
    s_mul_i32 s87, s68, 192
    v_mad_u32_u24 v2, v9, 12, s87
    v_lshlrev_b32 v35, 1, v9
    v_lshlrev_b32 v127, 1, v134
    v_lshl_add_u32 v127, v97, 5, v127
    s_movk_i32 s86, 384
    s_mov_b32 s26, 100270464
    s_mov_b32 s27, 0x20000
    s_mov_b32 s30, 0
    s_mov_b32 s31, 0x20000
    s_waitcnt lgkmcnt(0)
    s_mov_b32 s32, s6
    s_mov_b32 s33, s7
    s_mov_b32 s76, s8
    s_mov_b32 s77, s9
    buffer_load_dword a254, v3, s[32:35], s88 offen
    buffer_load_dword a253, v1, s[76:79], s89 offen
    s_load_dwordx2 s[82:83], s[10:11], 0
    s_movk_i32 s18, 676
    s_mov_b32 s19, 0x20000
    s_mov_b32 s24, s4
    s_mov_b32 s25, s5
    buffer_load_dwordx3 v[32:34], v2, s[16:19], 0 offen
    s_mul_i32 s96, s68, 288
    s_and_b32 s97, s68, 1
    s_lshl_b32 s97, s97, 2
    s_mov_b32 s98, 193536
    s_mov_b32 s99, 589824
    global_load_ushort v24, v35, s[12:13]
    v_add_u32 v126, s96, v0
    v_mul_u32_u24 v112, 2731, v126
    v_mul_u32_u24 v132, 6242, v126
    v_lshrrev_b32 v112, 16, v112
    v_lshrrev_b32 v132, 20, v132
    s_lshr_b32 s94, s2, 3
    s_mul_i32 s70, s94, 168
    global_load_ushort v25, v35, s[12:13] offset:32
    v_and_or_b32 v35, v112, 3, s97
    v_xor_b32 v35, v126, v35
    v_lshl_add_u32 v130, v35, 4, s99
    v_mad_u32_u24 v130, v132, s98, v130
    v_add_u32 v11, 64, v126
    s_mul_i32 s69, s2, 20
    s_lshl3_add_u32 s69, s94, s69
    global_load_ushort v10, v127, s[14:15] offset:0
    v_mul_u32_u24 v8, 2731, v11
    v_mul_u32_u24 v26, 6242, v11
    v_lshrrev_b32 v8, 16, v8
    v_lshrrev_b32 v26, 20, v26
    v_and_or_b32 v27, v8, 3, s97
    s_add_u32 s70, s70, 140
    s_movk_i32 s62, 2688
    global_load_ushort v131, v127, s[14:15] offset:8
    v_xor_b32 v27, v11, v27
    v_lshl_add_u32 v129, v27, 4, s99
    v_mad_u32_u24 v129, v26, s98, v129
    v_add_u32 v128, 128, v126
    v_mul_u32_u24 v125, 2731, v128
    s_movk_i32 s71, 20
    s_movk_i32 s73, 28
    global_load_ushort v11, v127, s[14:15] offset:16
    v_mul_u32_u24 v114, 6242, v128
    v_lshrrev_b32 v125, 16, v125
    v_lshrrev_b32 v114, 20, v114
    v_and_or_b32 v124, v125, 3, s97
    v_xor_b32 v124, v128, v124
    s_mov_b32 s93, 1769472
    s_mul_i32 s54, s68, 5120
    global_load_ushort v3, v127, s[14:15] offset:24
    v_lshl_add_u32 v128, v124, 4, s99
    v_mad_u32_u24 v128, v114, s98, v128
    v_add_u32 v115, 192, v126
    v_mul_u32_u24 v135, 2731, v115
    v_mul_u32_u24 v1, 6242, v115
    v_lshrrev_b32 v135, 16, v135
    v_lshrrev_b32 v1, 20, v1
    v_and_or_b32 v113, v135, 3, s97
    v_xor_b32 v113, v115, v113
    v_lshl_add_u32 v127, v113, 4, s99
    v_mad_u32_u24 v127, v1, s98, v127
    v_add_u32 v126, 256, v126
    v_mul_u32_u24 v113, 2731, v126
    v_mul_u32_u24 v96, 6242, v126
    v_lshrrev_b32 v113, 16, v113
    v_lshrrev_b32 v96, 20, v96
    v_and_or_b32 v115, v113, 3, s97
    v_xor_b32 v115, v126, v115
    v_lshl_add_u32 v126, v115, 4, s99
    v_mad_u32_u24 v126, v96, s98, v126
    s_cmp_ge_u32 s2, 240
    s_cbranch_scc1 L_bndF
L_bndrF:
    s_mov_b32 s63, 1180032
    s_mul_i32 s94, s69, 58255
    s_lshr_b32 s94, s94, 22
    s_mul_i32 s94, s94, s63
    s_mul_i32 s72, s69, s62
    s_add_u32 s72, s72, s94
    v_lshl_or_b32 v237, v0, 4, 2.0
    s_sub_u32 s94, s73, 1
    s_max_u32 s94, s94, 20
    s_mul_i32 s95, s68, -44
    s_movk_i32 s99, -24
    s_add_u32 m0, s54, 0
    v_and_b32 v26, -4, v125
    s_mul_i32 s85, s68, 96
    s_sub_u32 s100, s85, 1024
    buffer_load_dwordx4 v130, s[24:27], s72 offen nt lds
    s_add_u32 m0, s54, 1024
    v_mad_u32_u24 v1, v26, 3, v125
    v_add_u32 v1, s95, v1
    v_mad_i32_i24 v114, v125, s99, v124
    v_med3_u32 v26, v1, 20, s94
    v_add_u32 v26, s70, v26
    v_add_u32 v113, s69, v1
    s_sub_u32 s87, s85, 2048
    s_movk_i32 s91, 1152
    buffer_load_dwordx4 v129, s[24:27], s72 offen nt lds
    v_cmp_gt_u32 vcc, s71, v1
    v_lshl_add_u32 v114, v114, 4, s93
    s_add_u32 m0, s54, 43008
    v_cndmask_b32 v113, v26, v113, vcc
    v_mul_u32_u24 v26, 58255, v113
    v_mad_u32_u24 v114, v113, s62, v114
    v_lshrrev_b32 v26, 22, v26
    v_mad_u32_u24 v114, v26, s63, v114
    s_mul_i32 s90, s68, 3072
    s_add_u32 s90, s90, 61440
    buffer_load_dwordx4 v114, s[24:27], 0 offen  lds
    v_lshlrev_b32 v115, 16, v1
    s_add_u32 m0, s54, 2048
    v_and_b32 v26, -4, v8
    v_mad_u32_u24 v1, v26, 3, v8
    v_add_u32 v1, s95, v1
    v_mad_i32_i24 v113, v8, s99, v27
    v_med3_u32 v26, v1, 20, s94
    s_mov_b32 s92, 0
    s_add_u32 s101, s54, 44032
    buffer_load_dwordx4 v128, s[24:27], s72 offen nt lds
    v_add_u32 v26, s70, v26
    v_add_u32 v8, s69, v1
    v_cmp_gt_u32 vcc, s71, v1
    v_lshl_add_u32 v113, v113, 4, s93
    s_add_u32 m0, s54, 41984
    v_cndmask_b32 v8, v26, v8, vcc
    v_mul_u32_u24 v26, 58255, v8
    v_mad_u32_u24 v113, v8, s62, v113
    v_lshrrev_b32 v26, 22, v26
    v_mad_u32_u24 v113, v26, s63, v113
    s_mov_b32 s28, s22
    s_mov_b32 s29, s23
    buffer_load_dwordx4 v113, s[24:27], 0 offen  lds
    v_lshl_or_b32 v115, v1, 8, v115
    s_add_u32 m0, s54, 3072
    v_cmp_gt_u32 vcc, 32, v0
    v_and_b32 v8, -4, v112
    v_mad_u32_u24 v1, v8, 3, v112
    v_cndmask_b32 v126, v237, v126, vcc
    v_add_u32 v1, s95, v1
    s_mov_b32 s41, 0x2a8cbccc
    s_mov_b32 s42, 0x38fba882
    buffer_load_dwordx4 v127, s[24:27], s72 offen nt lds
    s_add_u32 m0, s54, 4096
    v_mad_i32_i24 v112, v112, s99, v35
    v_med3_u32 v8, v1, 20, s94
    v_add_u32 v8, s70, v8
    v_add_u32 v35, s69, v1
    v_cmp_gt_u32 vcc, s71, v1
    v_lshl_add_u32 v112, v112, 4, s93
    s_mov_b32 s43, 0x415db3d7
    s_mul_i32 s93, s68, 6
    buffer_load_dwordx4 v126, s[24:27], s72 offen nt lds
    v_cndmask_b32 v35, v8, v35, vcc
    v_mul_u32_u24 v8, 58255, v35
    v_mad_u32_u24 v112, v35, s62, v112
    v_lshrrev_b32 v8, 22, v8
    v_mad_u32_u24 v112, v8, s63, v112
    s_add_u32 m0, s54, 40960
    v_lshl_or_b32 v115, v1, 0, v115
    s_lshl_b32 s94, s97, 1
    s_mov_b32 s44, 61440
    buffer_load_dwordx4 v112, s[24:27], 0 offen nt lds
    v_mul_u32_u24 v35, 10923, v0
    v_lshrrev_b32 v96, 17, v35
    v_lshrrev_b32 v35, 16, v35
    v_mad_i32_i24 v98, v35, -6, v0
    v_bitop3_b32 v96, v96, v35, 4 bitop3:0x28
    v_lshl_add_u32 v98, v98, 4, s85
    v_mul_u32_u24 v96, 3, v96
    v_xor_b32 v35, v35, v96
    v_mad_u32_u24 v96, v35, s91, v98
    v_add_u32 v8, 64, v0
    v_mul_u32_u24 v1, 10923, v8
    v_lshrrev_b32 v15, 17, v1
    v_lshrrev_b32 v1, 16, v1
    v_mad_i32_i24 v27, v1, -6, v8
    v_bitop3_b32 v15, v15, v1, 4 bitop3:0x28
    v_lshl_add_u32 v27, v27, 4, s100
    v_mul_u32_u24 v15, 3, v15
    v_xor_b32 v1, v1, v15
    v_mad_u32_u24 v15, v1, s91, v27
    v_add_u32 v8, 128, v0
    v_mul_u32_u24 v26, 10923, v8
    v_lshrrev_b32 v38, 17, v26
    v_lshrrev_b32 v26, 16, v26
    v_mad_i32_i24 v8, v26, -6, v8
    v_bitop3_b32 v38, v38, v26, 4 bitop3:0x28
    v_lshl_add_u32 v8, v8, 4, s87
    v_mul_u32_u24 v38, 3, v38
    v_xor_b32 v26, v26, v38
    v_mad_u32_u24 v38, v26, s91, v8
    v_mad_u32_u24 v158, v35, s86, v98
    v_mad_u32_u24 v63, v1, s86, v27
    v_mad_u32_u24 v1, v26, s86, v8
    s_add_u32 m0, s90, 0
    v_lshrrev_b32 v8, 1, v97
    s_mov_b32 s45, 40960
    s_mov_b32 s46, 20480
    buffer_load_dwordx4 v96, s[32:35], s92 offen offset:0 lds
    v_lshl_add_u32 v35, v97, 2, v134
    v_lshl_add_u32 v35, v8, 3, v35
    v_mul_u32_u24 v35, 96, v35
    v_add_u32 v35, s90, v35
    v_lshl_add_u32 v8, v133, 4, v35
    v_lshl_add_u32 v62, v133, 3, v35
    v_mov_b32 v27, 0x3f803f80
    v_cmp_eq_u32 vcc, 0, v133
    v_and_b32 v26, 1, v0
    v_lshlrev_b32 v26, 4, v26
    v_cndmask_b32 v220, 0, v27, vcc
    v_cndmask_b32 v221, 0, v27, vcc
    v_cndmask_b32 v222, 0, v27, vcc
    v_cndmask_b32 v223, 0, v27, vcc
    v_mov_b32 v35, 0x3f80
    v_lshlrev_b32 v35, v26, v35
    v_cmp_gt_u32 vcc, 2, v133
    v_mov_b32 v20, 0x44004400
    v_mul_u32_u24 v79, 48, v134
    v_cndmask_b32 v216, 0, v35, vcc
    v_cndmask_b32 v218, 0, v35, vcc
    v_cmp_le_u32 vcc, 2, v133
    v_lshl_add_u32 v79, v133, 2, v79
    v_mul_u32_u24 v21, 48, v97
    v_cndmask_b32 v217, 0, v35, vcc
    v_cndmask_b32 v219, 0, v35, vcc
    v_cmp_eq_u32 vcc, v97, v134
    v_add_u32 v208, 0, v79
    v_mul_u32_u24 v35, 37, v208
    v_cndmask_b32 v22, 0, v216, vcc
    v_cndmask_b32 v23, 0, v217, vcc
    v_cmp_eq_u32 vcc, 0, v133
    v_lshrrev_b32 v35, 10, v35
    v_mad_u32_u24 v208, v35, 24, v208
    v_cndmask_b32 v212, 0, v20, vcc
    v_cmp_eq_u32 vcc, 1, v133
    v_add_u32 v208, s101, v208
    v_add_u32 v187, 16, v79
    v_cndmask_b32 v213, 0, v20, vcc
    v_cmp_eq_u32 vcc, 2, v133
    v_mul_u32_u24 v35, 37, v187
    v_lshrrev_b32 v35, 10, v35
    v_cndmask_b32 v214, 0, v20, vcc
    v_cmp_eq_u32 vcc, 3, v133
    v_mad_u32_u24 v187, v35, 24, v187
    v_add_u32 v187, s101, v187
    v_cndmask_b32 v215, 0, v20, vcc
    v_add_u32 v175, 32, v79
    v_mul_u32_u24 v20, 37, v175
    v_lshrrev_b32 v20, 10, v20
    v_mad_u32_u24 v175, v20, 24, v175
    v_add_u32 v175, s101, v175
    v_add_u32 v204, 0, v21
    v_mul_u32_u24 v20, 37, v204
    v_lshrrev_b32 v20, 10, v20
    v_mad_u32_u24 v204, v20, 24, v204
    v_add_u32 v205, 4, v21
    v_mul_u32_u24 v20, 37, v205
    v_lshrrev_b32 v20, 10, v20
    v_mad_u32_u24 v205, v20, 24, v205
    v_add_u32 v206, 8, v21
    v_mul_u32_u24 v20, 37, v206
    v_lshrrev_b32 v20, 10, v20
    v_mad_u32_u24 v206, v20, 24, v206
    v_add_u32 v207, 12, v21
    v_mul_u32_u24 v20, 37, v207
    v_lshrrev_b32 v20, 10, v20
    v_mad_u32_u24 v207, v20, 24, v207
    v_add_u32 v236, 16, v21
    v_mul_u32_u24 v20, 37, v236
    v_lshrrev_b32 v20, 10, v20
    v_mad_u32_u24 v236, v20, 24, v236
    v_add_u32 v100, 20, v21
    v_mul_u32_u24 v20, 37, v100
    v_lshrrev_b32 v20, 10, v20
    v_mad_u32_u24 v100, v20, 24, v100
    v_add_u32 v202, 24, v21
    v_mul_u32_u24 v20, 37, v202
    v_lshrrev_b32 v20, 10, v20
    v_mad_u32_u24 v202, v20, 24, v202
    v_add_u32 v101, 28, v21
    v_mul_u32_u24 v20, 37, v101
    v_lshrrev_b32 v20, 10, v20
    v_mad_u32_u24 v101, v20, 24, v101
    v_add_u32 v61, 32, v21
    v_mul_u32_u24 v20, 37, v61
    v_lshrrev_b32 v20, 10, v20
    s_waitcnt lgkmcnt(0)
    s_sext_i32_i16 s84, s82
    s_ashr_i32 s85, s82, 16
    s_max_i32 s84, s84, s85
    s_sext_i32_i16 s85, s83
    s_max_i32 s84, s84, s85
    s_ashr_i32 s85, s83, 16
    s_max_i32 s84, s84, s85
    s_cmp_gt_i32 s84, 16492
    s_cbranch_scc1 L_slow
    s_lshl_b32 s84, s68, 4
    buffer_load_dwordx4 v15, s[32:35], s92 offen offset:1024 lds
    v_mad_u32_u24 v61, v20, 24, v61
    v_add_u32 v60, 36, v21
    v_mul_u32_u24 v20, 37, v60
    v_lshrrev_b32 v20, 10, v20
    v_mad_u32_u24 v60, v20, 24, v60
    v_add_u32 v20, 40, v21
    v_mul_u32_u24 v35, 37, v20
    s_lshr_b64 s[82:83], s[82:83], s84
    s_lshl_b32 s82, s82, 16
    buffer_load_dwordx4 v38, s[32:35], s92 offen offset:2048 lds
    s_add_u32 m0, s90, 12288
    s_mov_b32 s92, 36864
    v_lshrrev_b32 v35, 10, v35
    v_mad_u32_u24 v20, v35, 24, v20
    v_add_u32 v21, 44, v21
    v_mul_u32_u24 v35, 37, v21
    v_lshrrev_b32 v35, 10, v35
    s_mov_b32 s84, 0x41b8aa3b
    s_mov_b32 s47, 0
    buffer_load_dwordx4 v96, s[32:35], s92 offen offset:0 lds
    v_mad_u32_u24 v21, v35, 24, v21
    v_lshl_add_u32 v211, v97, 4, v79
    v_mul_u32_u24 v35, 37, v211
    v_lshrrev_b32 v35, 10, v35
    v_mad_u32_u24 v211, v35, 24, v211
    v_mov_b32 v26, 336
    v_cmp_gt_u32 vcc, 3, v97
    v_and_b32 v35, 8, v9
    v_add_u32 v35, v35, v9
    v_cndmask_b32 v211, v26, v211, vcc
    v_sub_u32 v211, s101, v211
    v_mul_u32_u24 v35, 96, v35
    v_add_u32 v35, s90, v35
    v_lshl_add_u32 v99, v97, 4, v35
    v_lshl_add_u32 v239, v97, 3, v35
    s_mov_b32 s57, s72
    s_mov_b32 s58, 0
    buffer_load_dwordx4 v15, s[32:35], s92 offen offset:1024 lds
    v_lshlrev_b32 v98, 4, v97
    v_add_u32 v98, 4608, v98
    v_mov_b32 v35, s82
    v_min_f32 v35, 0x40930000, v35
    v_max_f32 v35, 0xc2c80000, v35
    v_mul_f32 v35, 0x3fb8aa3b, v35
    v_exp_f32 v35, v35
    s_waitcnt vmcnt(17)
    v_lshl_or_b32 v24, v25, 16, v24
    v_cvt_pk_bf16_f32 v35, v35, v35
    v_lshlrev_b32 v35, 16, v35
    v_mul_f32 v35, 0x4038aa3b, v35
    s_waitcnt vmcnt(15)
    v_lshl_or_b32 v10, v131, 16, v10
    v_readfirstlane_b32 s55, v35
    v_add_f32 v35, v35, v35
    s_waitcnt vmcnt(13)
    v_lshl_or_b32 v11, v3, 16, v11
    v_readfirstlane_b32 s52, v35
    v_cmp_gt_u32 vcc, 16, v0
    v_mov_b32 v25, 0
    v_mov_b32 v26, 0
    v_cndmask_b32 v27, 0, v24, vcc
    v_cndmask_b32 v24, 0, v24, vcc
    v_mov_b32 v35, 0
    v_mfma_f32_16x16x16_bf16 v[4:7], v[26:27], v[32:33], 0
    s_mov_b32 s59, 0
    v_mul_u32_u24 v3, 5120, v97
    v_add_u32 v3, v2, v3
    v_mfma_f32_16x16x16_bf16 v[16:19], v[24:25], v[32:33], 0
    s_mov_b32 s60, 0
    v_mov_b32 v238, 0xc138aa3b
    v_mul_u32_u24 v2, 5120, v134
    v_mfma_f32_16x16x16_bf16 v[28:31], v[24:25], v[34:35], 0
    s_mov_b32 s65, -1
    v_max_f32 v4, 0, v4
    v_max_f32 v5, 0, v5
    v_max_f32 v6, 0, v6
    v_max_f32 v16, 0, v16
    v_max_f32 v17, 0, v17
    v_max_f32 v18, 0, v18
    v_max_f32 v19, 0, v19
    v_cvt_pk_bf16_f32 v16, v16, v17
    v_cvt_pk_bf16_f32 v17, v18, v19
    v_max_f32 v7, 0, v7
    v_cvt_pk_bf16_f32 v4, v4, v5
    v_mfma_f32_16x16x16_bf16 v[24:27], v[10:11], v[16:17], 0
    s_mov_b32 s61, 1
    v_cvt_pk_bf16_f32 v5, v6, v7
    v_max_f32 v28, 0, v28
    v_max_f32 v29, 0, v29
    v_mfma_f32_16x16x16_bf16 v[16:19], v[10:11], v[4:5], 0
    s_movk_i32 s4, 336
    v_max_f32 v30, 0, v30
    v_max_f32 v31, 0, v31
    v_cvt_pk_bf16_f32 v28, v28, v29
    v_cvt_pk_bf16_f32 v29, v30, v31
    v_cvt_pk_bf16_f32 v24, v24, v24
    v_lshlrev_b32 v24, 16, v24
    v_mfma_f32_16x16x16_bf16 v[4:7], v[10:11], v[28:29], 0
    s_mov_b32 s5, 0
    v_mul_f32 v24, 0xbfb8aa3b, v24
    v_cvt_pk_bf16_f32 v16, v16, v16
    v_exp_f32 v24, v24
    v_lshlrev_b32 v16, 16, v16
    v_add_f32 v24, 1.0, v24
    v_rcp_f32 v24, v24
    v_mul_f32 v16, 0xbfb8aa3b, v16
    v_cvt_pk_bf16_f32 v24, v24, v24
    v_lshlrev_b32 v24, 16, v24
    v_fma_f32 v24, v24, s84, v238
    s_mov_b32 s6, 0
    s_mov_b32 s12, 0
    ds_write_b32 v3, v24 offset:44032
    v_exp_f32 v16, v16
    v_cvt_pk_bf16_f32 v4, v4, v4
    v_add_f32 v16, 1.0, v16
    v_rcp_f32 v16, v16
    v_lshlrev_b32 v4, 16, v4
    v_cvt_pk_bf16_f32 v16, v16, v16
    v_lshlrev_b32 v16, 16, v16
    v_fma_f32 v16, v16, s84, v238
    s_mov_b32 s64, 3
    s_mov_b32 s10, 81924
    ds_write_b32 v3, v16 offset:44036
    v_mul_f32 v4, 0xbfb8aa3b, v4
    v_exp_f32 v4, v4
    v_mad_u32_u24 v2, v133, s86, v2
    v_add_f32 v4, 1.0, v4
    v_rcp_f32 v4, v4
    v_and_b32 v131, 7, v9
    v_cvt_pk_bf16_f32 v4, v4, v4
    v_lshlrev_b32 v4, 16, v4
    v_fma_f32 v4, v4, s84, v238
    s_mov_b32 s11, 0x20000
    ds_write_b32 v3, v4 offset:44040
    v_xor_b32 v102, v131, v97
    v_lshl_add_u32 v103, v102, 4, v2
    v_xor_b32 v3, 64, v103
    v_add_u32 v139, 40960, v103
    v_xor_b32 v138, 64, v139
    v_add_u32 v2, 61440, v2
    v_add_u32 v102, s93, v97
    v_xor_b32 v102, v131, v102
    v_lshl_add_u32 v137, v102, 4, v2
    v_lshrrev_b32 v102, 1, v97
    v_add3_u32 v102, v102, s93, 4
    v_xor_b32 v102, v131, v102
    v_lshl_add_u32 v102, v102, 4, v2
    v_and_b32 v2, 1, v97
    v_lshl_add_u32 v136, v2, 3, v102
    v_lshlrev_b32 v2, 4, v0
    s_add_u32 s93, s54, 20480
    v_add_u32 v135, s93, v2
    v_add_u32 v131, 81920, v2
    s_lshr_b32 s93, s68, 1
    s_lshl_b32 s93, s93, 10
    s_add_u32 s93, s93, s94
    v_add_u32 v132, s93, v131
    s_mul_i32 s93, s68, 5376
    s_add_u32 s93, s93, 142336
    v_mul_u32_u24 v2, 80, v97
    v_add_u32 v102, s93, v2
    v_mul_u32_u24 v2, 336, v9
    v_add_u32 v16, v2, v102
    v_subrev_u32 v16, 21504, v16
    v_cmp_eq_u32 vcc, 0, v134
    v_mul_u32_u24 v2, 80, v134
    v_lshl_add_u32 v2, v97, 3, v2
    s_waitcnt lgkmcnt(0)
    s_barrier
    v_cndmask_b32 v134, v237, v102, vcc
    v_cmp_eq_u32 vcc, 3, v133
    v_lshl_add_u32 v2, v133, 1, v2
    buffer_load_dwordx4 v38, s[32:35], s92 offen offset:2048 lds
    s_add_u32 m0, s90, 24576
    s_mov_b32 s92, 73728
    ds_read_b32 v209, v187
    v_cndmask_b32 v134, v134, v102, vcc
    v_add_u32 v2, s93, v2
    v_cmp_gt_u32 vcc, 3, v97
    v_mov_b32 v125, 0
    s_add_u32 s93, s69, 1
    v_cndmask_b32 v133, v237, v2, vcc
    s_mul_i32 s94, s93, 58255
    s_lshr_b32 s94, s94, 22
    s_mul_i32 s94, s94, s63
    s_mul_i32 s56, s93, s62
    s_add_u32 s56, s56, s94
    s_and_b32 s94, s68, 1
    s_mul_i32 s94, s94, -2304
    ds_read_b32 v210, v175
    v_mov_b32 v124, 0
    s_sub_u32 s93, s71, 1
    s_cmp_eq_u32 s68, 0
    s_cselect_b32 s13, s93, -1
    buffer_load_dwordx4 v96, s[32:35], s92 offen offset:0 lds
    s_cmp_gt_u32 s73, 20
    s_cselect_b32 s13, s13, -1
    s_and_b32 s93, s2, -8
    s_sub_u32 s93, 81920, s93
    s_sub_u32 s8, s38, s93
    s_subb_u32 s9, s39, 0
    s_lshr_b32 s93, s68, 1
    s_mul_i32 s93, s93, 30720
    s_add_u32 s93, s93, s94
    ds_write_b128 v16, v[216:219] offset:21584
    buffer_load_dwordx4 v15, s[32:35], s92 offen offset:1024 lds
    v_add_u32 v238, s93, v99
    v_add_u32 v102, s93, v239
    s_lshr_b32 s93, s68, 1
    s_mul_i32 s93, s93, 5120
    s_lshl_b32 s94, s97, 4
    s_add_u32 s93, s93, s94
    v_add_u32 v2, s93, v98
    v_cmp_eq_u32 vcc, 0, v9
    s_mov_b32 s39, 0x00010001
    v_sub_u32 v192, v187, v204
    v_cndmask_b32 v2, v237, v2, vcc
    ds_read_b32 v192, v192 offset:336
    v_sub_u32 v193, v187, v205
    v_sub_u32 v194, v187, v206
    v_sub_u32 v195, v187, v207
    v_sub_u32 v188, v187, v236
    v_sub_u32 v189, v187, v100
    buffer_load_dwordx4 v38, s[32:35], s92 offen offset:2048 lds
    s_add_u32 m0, s90, 36864
    s_mov_b32 s92, 110592
    ds_read_b32 v193, v193 offset:336
    v_sub_u32 v190, v187, v202
    v_sub_u32 v191, v187, v101
    v_sub_u32 v184, v187, v61
    v_sub_u32 v185, v187, v60
    v_sub_u32 v186, v187, v20
    ds_read_b32 v194, v194 offset:336
    v_sub_u32 v187, v187, v21
    s_waitcnt vmcnt(9)
    s_barrier
    v_sub_u32 v180, v175, v204
    v_sub_u32 v181, v175, v205
    v_sub_u32 v182, v175, v206
    ds_read_b32 v195, v195 offset:336
    v_sub_u32 v183, v175, v207
    v_sub_u32 v176, v175, v236
    v_sub_u32 v177, v175, v100
    v_sub_u32 v178, v175, v202
    v_sub_u32 v179, v175, v101
    ds_read_b32 v188, v188 offset:336
    v_sub_u32 v172, v175, v61
    v_sub_u32 v173, v175, v60
    v_sub_u32 v174, v175, v20
    buffer_load_dwordx4 v96, s[32:35], s92 offen offset:0 lds
    ds_read_b32 v189, v189 offset:336
    v_sub_u32 v175, v175, v21
    v_sub_u32 v204, v208, v204
    v_sub_u32 v205, v208, v205
    v_sub_u32 v206, v208, v206
    v_sub_u32 v207, v208, v207
    ds_read_b32 v190, v190 offset:336
    v_sub_u32 v200, v208, v236
    v_sub_u32 v201, v208, v100
    v_sub_u32 v202, v208, v202
    v_sub_u32 v203, v208, v101
    v_sub_u32 v196, v208, v61
    ds_read_b32 v191, v191 offset:336
    buffer_load_dwordx4 v15, s[32:35], s92 offen offset:1024 lds
    v_sub_u32 v197, v208, v60
    v_sub_u32 v198, v208, v20
    v_sub_u32 v199, v208, v21
    ds_read_b32 v184, v184 offset:336
    ds_read_b32 v185, v185 offset:336
    ds_read_b32 v186, v186 offset:336
    buffer_load_dwordx4 v38, s[32:35], s92 offen offset:2048 lds
    s_add_u32 m0, s90, 49152
    s_mov_b32 s92, 147456
    s_waitcnt vmcnt(9)
    ds_read_b64_tr_b16 a[0:1], v62 offset:0
    ds_read_b64_tr_b16 a[2:3], v62 offset:768
    ds_read_b64_tr_b16 a[24:25], v62 offset:32
    ds_read_b64_tr_b16 a[26:27], v62 offset:800
    ds_read_b64_tr_b16 a[48:49], v62 offset:64
    ds_read_b64_tr_b16 a[50:51], v62 offset:832
    ds_read_b32 v187, v187 offset:336
    buffer_load_dwordx4 v96, s[32:35], s92 offen offset:0 lds
    ds_read_b128 v[32:35], v103 offset:40960
    ds_read_b128 v[24:27], v103 offset:42496
    ds_read_b128 v[28:31], v103 offset:0
    ds_read_b128 v[4:7], v103 offset:1536
    ds_read_b128 v[84:87], v103 offset:3072
    buffer_load_dwordx4 v15, s[32:35], s92 offen offset:1024 lds
    ds_read_b32 v180, v180 offset:336
    ds_read_b32 v181, v181 offset:336
    ds_read_b32 v182, v182 offset:336
    s_waitcnt lgkmcnt(7)
    v_mfma_f32_16x16x32_bf16 v[56:59], a[0:3], v[32:35], 0
    buffer_load_dwordx4 v38, s[32:35], s92 offen offset:2048 lds
    v_mfma_f32_16x16x32_bf16 v[52:55], a[24:27], v[32:35], 0
    s_waitcnt vmcnt(9)
    s_add_u32 m0, s90, 61440
    ds_read_b64_tr_b16 a[4:5], v62 offset:12288
    v_mfma_f32_16x16x32_bf16 v[108:111], a[48:51], v[32:35], 0
    s_waitcnt lgkmcnt(5)
    s_mov_b32 s92, 184320
    ds_read_b64_tr_b16 a[6:7], v62 offset:13056
    v_mfma_f32_16x16x32_bf16 v[68:71], a[0:3], v[24:27], 0
    ds_read_b64_tr_b16 a[28:29], v62 offset:12320
    v_mfma_f32_16x16x32_bf16 v[64:67], a[24:27], v[24:27], 0
    ds_read_b64_tr_b16 a[30:31], v62 offset:13088
    v_mfma_f32_16x16x32_bf16 v[44:47], a[48:51], v[24:27], 0
    ds_read_b64_tr_b16 a[52:53], v62 offset:12352
    buffer_load_dwordx4 v96, s[32:35], s92 offen offset:0 lds
    v_mfma_f32_16x16x32_bf16 v[24:27], a[0:3], v[28:31], 0
    ds_read_b64_tr_b16 a[54:55], v62 offset:13120
    v_mfma_f32_16x16x32_bf16 v[104:107], a[24:27], v[28:31], 0
    ds_read_b128 v[116:119], v3 offset:41088
    v_mfma_f32_16x16x32_bf16 v[92:95], a[48:51], v[28:31], 0
    ds_read_b128 v[88:91], v3 offset:42624
    v_mfma_f32_16x16x32_bf16 v[28:31], a[0:3], v[4:7], 0
    ds_read_b128 v[40:43], v3 offset:128
    v_mfma_f32_16x16x32_bf16 v[72:75], a[24:27], v[4:7], 0
    ds_read_b128 v[160:163], v3 offset:1664
    buffer_load_dwordx4 v15, s[32:35], s92 offen offset:1024 lds
    v_mfma_f32_16x16x32_bf16 v[48:51], a[48:51], v[4:7], 0
    s_waitcnt lgkmcnt(8)
    ds_read_b128 v[4:7], v3 offset:3200
    v_mfma_f32_16x16x32_bf16 v[144:147], a[0:3], v[84:87], 0
    ds_read_b128 v[164:167], v3 offset:40960
    v_mfma_f32_16x16x32_bf16 v[32:35], a[24:27], v[84:87], 0
    ds_read_b128 v[120:123], v3 offset:42496
    v_mfma_f32_16x16x32_bf16 v[80:83], a[48:51], v[84:87], 0
    s_waitcnt vmcnt(8)
    ds_read_b128 v[152:155], v3 offset:0
    ds_read_b128 v[148:151], v3 offset:1536
    buffer_load_dwordx4 v38, s[32:35], s92 offen offset:2048 lds
    s_add_u32 m0, s90, 0
    s_mov_b32 s92, 384
    ds_read_b64_tr_b16 a[8:9], v62 offset:24576
    ds_read_b64_tr_b16 a[10:11], v62 offset:25344
    ds_read_b64_tr_b16 a[32:33], v62 offset:24608
    ds_read_b64_tr_b16 a[34:35], v62 offset:25376
    ds_read_b64_tr_b16 a[56:57], v62 offset:24640
    ds_read_b64_tr_b16 a[58:59], v62 offset:25408
    ds_read_b128 v[84:87], v3 offset:3072
    ds_read_b32 v183, v183 offset:336
    buffer_load_dwordx4 v96, s[32:35], s92 offen offset:0 lds
    s_waitcnt lgkmcnt(11)
    v_mfma_f32_16x16x32_bf16 v[56:59], a[4:7], v[164:167], v[56:59]
    ds_read_b128 v[140:143], v103 offset:41088
    v_mfma_f32_16x16x32_bf16 v[52:55], a[28:31], v[164:167], v[52:55]
    ds_read_b32 v176, v176 offset:336
    v_mfma_f32_16x16x32_bf16 v[108:111], a[52:55], v[164:167], v[108:111]
    s_waitcnt lgkmcnt(10)
    v_mfma_f32_16x16x32_bf16 v[68:71], a[4:7], v[120:123], v[68:71]
    ds_read_b32 v177, v177 offset:336
    v_mfma_f32_16x16x32_bf16 v[64:67], a[28:31], v[120:123], v[64:67]
    buffer_load_dwordx4 v15, s[32:35], s92 offen offset:1024 lds
    v_mfma_f32_16x16x32_bf16 v[44:47], a[52:55], v[120:123], v[44:47]
    ds_read_b32 v178, v178 offset:336
    v_mfma_f32_16x16x32_bf16 v[24:27], a[4:7], v[152:155], v[24:27]
    v_mfma_f32_16x16x32_bf16 v[104:107], a[28:31], v[152:155], v[104:107]
    ds_read_b128 v[120:123], v103 offset:42624
    v_mfma_f32_16x16x32_bf16 v[92:95], a[52:55], v[152:155], v[92:95]
    ds_read_b32 v179, v179 offset:336
    v_mfma_f32_16x16x32_bf16 v[28:31], a[4:7], v[148:151], v[28:31]
    buffer_load_dwordx4 v38, s[32:35], s92 offen offset:2048 lds
    v_mfma_f32_16x16x32_bf16 v[72:75], a[28:31], v[148:151], v[72:75]
    s_waitcnt vmcnt(9)
    s_add_u32 m0, s90, 12288
    ds_read_b64_tr_b16 a[12:13], v62 offset:36864
    v_mfma_f32_16x16x32_bf16 v[48:51], a[52:55], v[148:151], v[48:51]
    s_waitcnt lgkmcnt(5)
    s_mov_b32 s92, 37248
    ds_read_b64_tr_b16 a[14:15], v62 offset:37632
    v_mfma_f32_16x16x32_bf16 v[144:147], a[4:7], v[84:87], v[144:147]
    ds_read_b64_tr_b16 a[36:37], v62 offset:36896
    v_mfma_f32_16x16x32_bf16 v[32:35], a[28:31], v[84:87], v[32:35]
    ds_read_b64_tr_b16 a[38:39], v62 offset:37664
    v_mfma_f32_16x16x32_bf16 v[80:83], a[52:55], v[84:87], v[80:83]
    buffer_load_dwordx4 v96, s[32:35], s92 offen offset:0 lds
    ds_read_b64_tr_b16 a[60:61], v62 offset:36928
    v_mfma_f32_16x16x32_bf16 v[56:59], a[8:11], v[140:143], v[56:59]
    ds_read_b64_tr_b16 a[62:63], v62 offset:37696
    v_mfma_f32_16x16x32_bf16 v[52:55], a[32:35], v[140:143], v[52:55]
    ds_read_b128 v[84:87], v103 offset:128
    v_mfma_f32_16x16x32_bf16 v[108:111], a[56:59], v[140:143], v[108:111]
    s_waitcnt lgkmcnt(7)
    ds_read_b32 v172, v172 offset:336
    v_mfma_f32_16x16x32_bf16 v[68:71], a[8:11], v[120:123], v[68:71]
    v_mfma_f32_16x16x32_bf16 v[64:67], a[32:35], v[120:123], v[64:67]
    buffer_load_dwordx4 v15, s[32:35], s92 offen offset:1024 lds
    ds_read_b128 v[152:155], v103 offset:1664
    v_mfma_f32_16x16x32_bf16 v[44:47], a[56:59], v[120:123], v[44:47]
    s_waitcnt lgkmcnt(7)
    ds_read_b32 v173, v173 offset:336
    v_mfma_f32_16x16x32_bf16 v[56:59], a[12:15], v[116:119], v[56:59]
    v_mfma_f32_16x16x32_bf16 v[68:71], a[12:15], v[88:91], v[68:71]
    s_waitcnt lgkmcnt(6)
    ds_read_b32 v174, v174 offset:336
    v_mfma_f32_16x16x32_bf16 v[52:55], a[36:39], v[116:119], v[52:55]
    v_mfma_f32_16x16x32_bf16 v[64:67], a[36:39], v[88:91], v[64:67]
    s_waitcnt vmcnt(8) lgkmcnt(5)
    buffer_load_dwordx4 v38, s[32:35], s92 offen offset:2048 lds
    ds_read_b64_tr_b16 a[16:17], v62 offset:49152
    v_mfma_f32_16x16x32_bf16 v[108:111], a[60:63], v[116:119], v[108:111]
    s_add_u32 m0, s90, 24576
    ds_read_b64_tr_b16 a[18:19], v62 offset:49920
    v_mfma_f32_16x16x32_bf16 v[44:47], a[60:63], v[88:91], v[44:47]
    s_waitcnt lgkmcnt(5)
    s_mov_b32 s92, 74112
    ds_read_b64_tr_b16 a[40:41], v62 offset:49184
    v_mfma_f32_16x16x32_bf16 v[24:27], a[8:11], v[84:87], v[24:27]
    ds_read_b64_tr_b16 a[42:43], v62 offset:49952
    v_mfma_f32_16x16x32_bf16 v[24:27], a[12:15], v[40:43], v[24:27]
    ds_read_b64_tr_b16 a[64:65], v62 offset:49216
    v_mfma_f32_16x16x32_bf16 v[104:107], a[32:35], v[84:87], v[104:107]
    buffer_load_dwordx4 v96, s[32:35], s92 offen offset:0 lds
    ds_read_b64_tr_b16 a[66:67], v62 offset:49984
    v_mfma_f32_16x16x32_bf16 v[104:107], a[36:39], v[40:43], v[104:107]
    ds_read_b128 v[116:119], v103 offset:3200
    v_mfma_f32_16x16x32_bf16 v[92:95], a[56:59], v[84:87], v[92:95]
    ds_read_b128 v[148:151], v3 offset:41216
    v_mfma_f32_16x16x32_bf16 v[92:95], a[60:63], v[40:43], v[92:95]
    s_waitcnt lgkmcnt(8)
    ds_read_b128 v[140:143], v3 offset:42752
    v_mfma_f32_16x16x32_bf16 v[28:31], a[8:11], v[152:155], v[28:31]
    ds_read_b128 v[120:123], v3 offset:256
    v_mfma_f32_16x16x32_bf16 v[28:31], a[12:15], v[160:163], v[28:31]
    buffer_load_dwordx4 v15, s[32:35], s92 offen offset:1024 lds
    ds_read_b128 v[84:87], v3 offset:1792
    v_mfma_f32_16x16x32_bf16 v[72:75], a[32:35], v[152:155], v[72:75]
    ds_read_b128 v[40:43], v3 offset:3328
    v_mfma_f32_16x16x32_bf16 v[72:75], a[36:39], v[160:163], v[72:75]
    ds_read_b128 v[88:91], v103 offset:41216
    v_mfma_f32_16x16x32_bf16 v[48:51], a[56:59], v[152:155], v[48:51]
    ds_read_b128 v[152:155], v103 offset:42752
    v_mfma_f32_16x16x32_bf16 v[48:51], a[60:63], v[160:163], v[48:51]
    s_waitcnt lgkmcnt(7)
    ds_read_b32 v175, v175 offset:336
    v_mfma_f32_16x16x32_bf16 v[144:147], a[8:11], v[116:119], v[144:147]
    buffer_load_dwordx4 v38, s[32:35], s92 offen offset:2048 lds
    v_mov_b32 v39, 0
    v_mfma_f32_16x16x32_bf16 v[144:147], a[12:15], v[4:7], v[144:147]
    s_waitcnt vmcnt(9)
    s_add_u32 m0, s90, 36864
    ds_read_b64_tr_b16 a[20:21], v62 offset:61440
    v_mfma_f32_16x16x32_bf16 v[32:35], a[32:35], v[116:119], v[32:35]
    s_mov_b32 s92, 110976
    ds_read_b64_tr_b16 a[22:23], v62 offset:62208
    v_mfma_f32_16x16x32_bf16 v[32:35], a[36:39], v[4:7], v[32:35]
    ds_read_b64_tr_b16 a[44:45], v62 offset:61472
    v_mfma_f32_16x16x32_bf16 v[80:83], a[56:59], v[116:119], v[80:83]
    ds_read_b64_tr_b16 a[46:47], v62 offset:62240
    v_mfma_f32_16x16x32_bf16 v[80:83], a[60:63], v[4:7], v[80:83]
    s_waitcnt lgkmcnt(6)
    buffer_load_dwordx4 v96, s[32:35], s92 offen offset:0 lds
    ds_read_b64_tr_b16 a[68:69], v62 offset:61504
    v_mfma_f32_16x16x32_bf16 v[56:59], a[16:19], v[88:91], v[56:59]
    ds_read_b64_tr_b16 a[70:71], v62 offset:62272
    v_mfma_f32_16x16x32_bf16 v[52:55], a[40:43], v[88:91], v[52:55]
    ds_read_b128 v[4:7], v103 offset:256
    v_mfma_f32_16x16x32_bf16 v[108:111], a[64:67], v[88:91], v[108:111]
    s_waitcnt lgkmcnt(7)
    ds_read_b32 v204, v204 offset:336
    v_mfma_f32_16x16x32_bf16 v[68:71], a[16:19], v[152:155], v[68:71]
    v_mfma_f32_16x16x32_bf16 v[64:67], a[40:43], v[152:155], v[64:67]
    s_waitcnt lgkmcnt(6)
    buffer_load_dwordx4 v15, s[32:35], s92 offen offset:1024 lds
    ds_read_b128 v[88:91], v103 offset:1792
    v_mfma_f32_16x16x32_bf16 v[56:59], a[20:23], v[148:151], v[56:59]
    ds_read_b32 v205, v205 offset:336
    v_mfma_f32_16x16x32_bf16 v[68:71], a[20:23], v[140:143], v[68:71]
    s_waitcnt lgkmcnt(6)
    s_nop 1
    v_mfma_f32_16x16x32_bf16 v[52:55], a[44:47], v[148:151], v[52:55]
    s_nop 0
    ds_read_b32 v206, v206 offset:336
    v_cvt_pk_f16_f32 v56, v56, v57
    v_mfma_f32_16x16x32_bf16 v[64:67], a[44:47], v[140:143], v[64:67]
    v_cvt_pk_f16_f32 v57, v58, v59
    v_pk_fma_f16 v116, v56, v56, s39
    v_mfma_f32_16x16x32_bf16 v[44:47], a[64:67], v[152:155], v[44:47]
    s_waitcnt vmcnt(8) lgkmcnt(5)
    buffer_load_dwordx4 v38, s[32:35], s92 offen offset:2048 lds
    ds_read_b64_tr_b16 a[72:73], v62 offset:0
    v_mfma_f32_16x16x32_bf16 v[108:111], a[68:71], v[148:151], v[108:111]
    s_add_u32 m0, s90, 49152
    ds_read_b64_tr_b16 a[74:75], v62 offset:768
    v_pk_fmac_f16 v116, v57, v57
    v_mfma_f32_16x16x32_bf16 v[44:47], a[68:71], v[140:143], v[44:47]
    s_waitcnt lgkmcnt(5)
    s_mov_b32 s92, 147840
    ds_read_b64_tr_b16 a[96:97], v62 offset:32
    v_cvt_pk_f16_f32 v58, v52, v53
    v_mfma_f32_16x16x32_bf16 v[24:27], a[16:19], v[4:7], v[24:27]
    ds_read_b64_tr_b16 a[98:99], v62 offset:800
    v_cvt_pk_f16_f32 v59, v54, v55
    v_mfma_f32_16x16x32_bf16 v[24:27], a[20:23], v[120:123], v[24:27]
    ds_read_b64_tr_b16 a[120:121], v62 offset:64
    v_pk_fmac_f16 v116, v58, v58
    v_mfma_f32_16x16x32_bf16 v[104:107], a[40:43], v[4:7], v[104:107]
    buffer_load_dwordx4 v96, s[32:35], s92 offen offset:0 lds
    ds_read_b64_tr_b16 a[122:123], v62 offset:832
    v_mfma_f32_16x16x32_bf16 v[104:107], a[44:47], v[120:123], v[104:107]
    ds_read_b128 v[52:55], v103 offset:3328
    v_pk_fmac_f16 v116, v59, v59
    v_mfma_f32_16x16x32_bf16 v[92:95], a[64:67], v[4:7], v[92:95]
    ds_read_b128 v[4:7], v103 offset:40960
    v_cvt_pk_f16_f32 v36, v108, v109
    v_mfma_f32_16x16x32_bf16 v[92:95], a[68:71], v[120:123], v[92:95]
    s_waitcnt lgkmcnt(8)
    ds_read_b32 v207, v207 offset:336
    v_cvt_pk_f16_f32 v37, v110, v111
    v_mfma_f32_16x16x32_bf16 v[28:31], a[16:19], v[88:91], v[28:31]
    v_pk_fmac_f16 v116, v36, v36
    v_pk_fmac_f16 v116, v37, v37
    v_mfma_f32_16x16x32_bf16 v[28:31], a[20:23], v[84:87], v[28:31]
    buffer_load_dwordx4 v15, s[32:35], s92 offen offset:1024 lds
    ds_read_b128 v[148:151], v103 offset:42496
    v_mfma_f32_16x16x32_bf16 v[72:75], a[40:43], v[88:91], v[72:75]
    v_cvt_pk_f16_f32 v68, v68, v69
    v_cvt_pk_f16_f32 v69, v70, v71
    v_mfma_f32_16x16x32_bf16 v[72:75], a[44:47], v[84:87], v[72:75]
    ds_read_b128 v[120:123], v103 offset:0
    v_pk_fma_f16 v118, v68, v68, s39
    v_mfma_f32_16x16x32_bf16 v[48:51], a[64:67], v[88:91], v[48:51]
    ds_read_b32 v200, v200 offset:336
    v_pk_fmac_f16 v118, v69, v69
    v_mfma_f32_16x16x32_bf16 v[48:51], a[68:71], v[84:87], v[48:51]
    s_waitcnt lgkmcnt(5)
    v_cvt_pk_f16_f32 v70, v64, v65
    v_cvt_pk_f16_f32 v71, v66, v67
    v_pk_fmac_f16 v118, v70, v70
    v_mfma_f32_16x16x32_bf16 v[144:147], a[16:19], v[52:55], v[144:147]
    s_waitcnt vmcnt(8)
    buffer_load_dwordx4 v38, s[32:35], s92 offen offset:2048 lds
    ds_read_b64_tr_b16 a[76:77], v62 offset:12288
    v_mfma_f32_16x16x32_bf16 v[144:147], a[20:23], v[40:43], v[144:147]
    s_add_u32 m0, s90, 61440
    ds_read_b64_tr_b16 a[78:79], v62 offset:13056
    v_pk_fmac_f16 v118, v71, v71
    v_mfma_f32_16x16x32_bf16 v[32:35], a[40:43], v[52:55], v[32:35]
    s_mov_b32 s92, 184704
    ds_read_b64_tr_b16 a[100:101], v62 offset:12320
    v_cvt_pk_f16_f32 v60, v44, v45
    v_mfma_f32_16x16x32_bf16 v[32:35], a[44:47], v[40:43], v[32:35]
    ds_read_b64_tr_b16 a[102:103], v62 offset:13088
    v_cvt_pk_f16_f32 v61, v46, v47
    v_mfma_f32_16x16x32_bf16 v[80:83], a[64:67], v[52:55], v[80:83]
    ds_read_b64_tr_b16 a[124:125], v62 offset:12352
    buffer_load_dwordx4 v96, s[32:35], s92 offen offset:0 lds
    v_mfma_f32_16x16x32_bf16 v[80:83], a[68:71], v[40:43], v[80:83]
    s_waitcnt lgkmcnt(6)
    ds_read_b64_tr_b16 a[126:127], v62 offset:13120
    v_pk_fmac_f16 v118, v60, v60
    v_mfma_f32_16x16x32_bf16 v[44:47], a[72:75], v[4:7], 0
    ds_read_b128 v[84:87], v103 offset:1536
    v_pk_fmac_f16 v118, v61, v61
    v_mfma_f32_16x16x32_bf16 v[140:143], a[96:99], v[4:7], 0
    ds_read_b128 v[248:251], v103 offset:3072
    v_cvt_pk_f16_f32 v108, v24, v25
    v_mfma_f32_16x16x32_bf16 v[88:91], a[120:123], v[4:7], 0
    ds_read_b128 v[4:7], v3 offset:40960
    v_cvt_pk_f16_f32 v109, v26, v27
    v_mfma_f32_16x16x32_bf16 v[52:55], a[72:75], v[148:151], 0
    ds_read_b128 v[64:67], v3 offset:42496
    buffer_load_dwordx4 v15, s[32:35], s92 offen offset:1024 lds
    v_mfma_f32_16x16x32_bf16 v[252:255], a[96:99], v[148:151], 0
    ds_read_b32 v201, v201 offset:336
    v_pk_fma_f16 v160, v108, v108, s39
    v_mfma_f32_16x16x32_bf16 v[40:43], a[120:123], v[148:151], 0
    v_pk_fmac_f16 v160, v109, v109
    v_cvt_pk_f16_f32 v110, v104, v105
    v_mfma_f32_16x16x32_bf16 v[168:171], a[72:75], v[120:123], 0
    ds_read_b128 v[24:27], v3 offset:0
    v_cvt_pk_f16_f32 v111, v106, v107
    v_mfma_f32_16x16x32_bf16 v[164:167], a[96:99], v[120:123], 0
    ds_read_b32 v202, v202 offset:336
    v_pk_fmac_f16 v160, v110, v110
    v_mfma_f32_16x16x32_bf16 v[104:107], a[120:123], v[120:123], 0
    s_waitcnt lgkmcnt(6)
    v_pk_fmac_f16 v160, v111, v111
    v_cvt_pk_f16_f32 v154, v92, v93
    v_cvt_pk_f16_f32 v155, v94, v95
    v_mfma_f32_16x16x32_bf16 v[232:235], a[72:75], v[84:87], 0
    s_waitcnt vmcnt(8)
    buffer_load_dwordx4 v38, s[32:35], s92 offen offset:2048 lds
    ds_read_b64_tr_b16 a[80:81], v62 offset:24576
    v_pk_fmac_f16 v160, v154, v154
    v_pk_fmac_f16 v160, v155, v155
    v_mfma_f32_16x16x32_bf16 v[228:231], a[96:99], v[84:87], 0
    s_add_u32 m0, s90, 0
    ds_read_b64_tr_b16 a[82:83], v62 offset:25344
    v_cvt_pk_f16_f32 v28, v28, v29
    v_mfma_f32_16x16x32_bf16 v[224:227], a[120:123], v[84:87], 0
    s_waitcnt lgkmcnt(5)
    s_mov_b32 s92, 768
    ds_read_b64_tr_b16 a[104:105], v62 offset:24608
    v_cvt_pk_f16_f32 v29, v30, v31
    v_mfma_f32_16x16x32_bf16 v[120:123], a[72:75], v[248:251], 0
    ds_read_b64_tr_b16 a[106:107], v62 offset:25376
    v_pk_fma_f16 v162, v28, v28, s39
    v_mfma_f32_16x16x32_bf16 v[44:47], a[76:79], v[4:7], v[44:47]
    buffer_load_dwordx4 v96, s[32:35], s92 offen offset:0 lds
    ds_read_b64_tr_b16 a[128:129], v62 offset:24640
    v_mfma_f32_16x16x32_bf16 v[140:143], a[100:103], v[4:7], v[140:143]
    ds_read_b64_tr_b16 a[130:131], v62 offset:25408
    v_pk_fmac_f16 v162, v29, v29
    v_mfma_f32_16x16x32_bf16 v[88:91], a[124:127], v[4:7], v[88:91]
    ds_read_b128 v[84:87], v3 offset:1536
    v_cvt_pk_f16_f32 v30, v72, v73
    v_mfma_f32_16x16x32_bf16 v[52:55], a[76:79], v[64:67], v[52:55]
    ds_read_b128 v[4:7], v3 offset:3072
    v_cvt_pk_f16_f32 v31, v74, v75
    v_mfma_f32_16x16x32_bf16 v[252:255], a[100:103], v[64:67], v[252:255]
    ds_read_b128 v[244:247], v103 offset:41088
    v_pk_fmac_f16 v162, v30, v30
    v_mfma_f32_16x16x32_bf16 v[40:43], a[124:127], v[64:67], v[40:43]
    s_waitcnt lgkmcnt(8)
    buffer_load_dwordx4 v15, s[32:35], s92 offen offset:1024 lds
    ds_read_b128 v[64:67], v103 offset:42624
    v_mfma_f32_16x16x32_bf16 v[168:171], a[76:79], v[24:27], v[168:171]
    v_pk_fmac_f16 v162, v31, v31
    v_cvt_pk_f16_f32 v150, v48, v49
    v_mfma_f32_16x16x32_bf16 v[164:167], a[100:103], v[24:27], v[164:167]
    ds_read_b32 v203, v203 offset:336
    v_cvt_pk_f16_f32 v151, v50, v51
    v_mfma_f32_16x16x32_bf16 v[104:107], a[124:127], v[24:27], v[104:107]
    v_pk_fmac_f16 v162, v150, v150
    v_pk_fmac_f16 v162, v151, v151
    v_mfma_f32_16x16x32_bf16 v[92:95], a[96:99], v[248:251], 0
    ds_read_b128 v[48:51], v103 offset:128
    v_cvt_pk_f16_f32 v240, v144, v145
    v_mfma_f32_16x16x32_bf16 v[72:75], a[120:123], v[248:251], 0
    s_waitcnt vmcnt(8) lgkmcnt(5)
    buffer_load_dwordx4 v38, s[32:35], s92 offen offset:2048 lds
    ds_read_b64_tr_b16 a[84:85], v62 offset:36864
    v_cvt_pk_f16_f32 v241, v146, v147
    v_mfma_f32_16x16x32_bf16 v[232:235], a[76:79], v[84:87], v[232:235]
    s_add_u32 m0, s90, 12288
    ds_read_b64_tr_b16 a[86:87], v62 offset:37632
    v_pk_fma_f16 v24, v240, v240, s39
    v_mfma_f32_16x16x32_bf16 v[228:231], a[100:103], v[84:87], v[228:231]
    s_mov_b32 s92, 37632
    ds_read_b64_tr_b16 a[108:109], v62 offset:36896
    v_pk_fmac_f16 v24, v241, v241
    v_mfma_f32_16x16x32_bf16 v[224:227], a[124:127], v[84:87], v[224:227]
    s_waitcnt lgkmcnt(6)
    ds_read_b64_tr_b16 a[110:111], v62 offset:37664
    v_cvt_pk_f16_f32 v242, v32, v33
    v_mfma_f32_16x16x32_bf16 v[120:123], a[76:79], v[4:7], v[120:123]
    ds_read_b64_tr_b16 a[132:133], v62 offset:36928
    buffer_load_dwordx4 v96, s[32:35], s92 offen offset:0 lds
    v_mfma_f32_16x16x32_bf16 v[92:95], a[100:103], v[4:7], v[92:95]
    ds_read_b64_tr_b16 a[134:135], v62 offset:37696
    v_cvt_pk_f16_f32 v243, v34, v35
    v_mfma_f32_16x16x32_bf16 v[72:75], a[124:127], v[4:7], v[72:75]
    ds_read_b128 v[32:35], v103 offset:1664
    v_pk_fmac_f16 v24, v242, v242
    v_mfma_f32_16x16x32_bf16 v[44:47], a[80:83], v[244:247], v[44:47]
    ds_read_b128 v[4:7], v103 offset:3200
    v_pk_fmac_f16 v24, v243, v243
    v_mfma_f32_16x16x32_bf16 v[140:143], a[104:107], v[244:247], v[140:143]
    ds_read_b128 v[84:87], v3 offset:41088
    v_cvt_pk_f16_f32 v146, v80, v81
    v_mfma_f32_16x16x32_bf16 v[88:91], a[128:131], v[244:247], v[88:91]
    s_waitcnt lgkmcnt(8)
    ds_read_b32 v196, v196 offset:336
    buffer_load_dwordx4 v15, s[32:35], s92 offen offset:1024 lds
    v_mfma_f32_16x16x32_bf16 v[52:55], a[80:83], v[64:67], v[52:55]
    v_cvt_pk_f16_f32 v147, v82, v83
    v_pk_fmac_f16 v24, v146, v146
    v_mfma_f32_16x16x32_bf16 v[252:255], a[104:107], v[64:67], v[252:255]
    ds_read_b128 v[80:83], v3 offset:42624
    v_pk_fmac_f16 v24, v147, v147
    v_mfma_f32_16x16x32_bf16 v[40:43], a[128:131], v[64:67], v[40:43]
    ds_read_b32 v197, v197 offset:336
    v_mfma_f32_16x16x32_bf16 v[168:171], a[80:83], v[48:51], v[168:171]
    v_mfma_f32_16x16x32_bf16 v[164:167], a[104:107], v[48:51], v[164:167]
    ds_read_b128 v[64:67], v3 offset:128
    buffer_load_dwordx4 v38, s[32:35], s92 offen offset:2048 lds
    v_mfma_f32_16x16x32_bf16 v[104:107], a[128:131], v[48:51], v[104:107]
    s_waitcnt vmcnt(9) lgkmcnt(6)
    s_add_u32 m0, s90, 24576
    ds_read_b64_tr_b16 a[88:89], v62 offset:49152
    v_mfma_f32_16x16x32_bf16 v[232:235], a[80:83], v[32:35], v[232:235]
    s_mov_b32 s92, 74496
    ds_read_b64_tr_b16 a[90:91], v62 offset:49920
    v_mfma_f32_16x16x32_bf16 v[228:231], a[104:107], v[32:35], v[228:231]
    ds_read_b64_tr_b16 a[112:113], v62 offset:49184
    v_mfma_f32_16x16x32_bf16 v[224:227], a[128:131], v[32:35], v[224:227]
    s_waitcnt lgkmcnt(6)
    ds_read_b64_tr_b16 a[114:115], v62 offset:49952
    v_mfma_f32_16x16x32_bf16 v[120:123], a[80:83], v[4:7], v[120:123]
    ds_read_b64_tr_b16 a[136:137], v62 offset:49216
    buffer_load_dwordx4 v96, s[32:35], s92 offen offset:0 lds
    v_mfma_f32_16x16x32_bf16 v[92:95], a[104:107], v[4:7], v[92:95]
    ds_read_b64_tr_b16 a[138:139], v62 offset:49984
    v_mfma_f32_16x16x32_bf16 v[72:75], a[128:131], v[4:7], v[72:75]
    ds_read_b128 v[48:51], v3 offset:1664
    v_mfma_f32_16x16x32_bf16 v[44:47], a[84:87], v[84:87], v[44:47]
    ds_read_b128 v[32:35], v3 offset:3200
    v_mfma_f32_16x16x32_bf16 v[140:143], a[108:111], v[84:87], v[140:143]
    ds_read_b128 v[4:7], v103 offset:41216
    v_mfma_f32_16x16x32_bf16 v[88:91], a[132:135], v[84:87], v[88:91]
    s_waitcnt lgkmcnt(8)
    ds_read_b32 v198, v198 offset:336
    buffer_load_dwordx4 v15, s[32:35], s92 offen offset:1024 lds
    v_mfma_f32_16x16x32_bf16 v[52:55], a[84:87], v[80:83], v[52:55]
    v_mfma_f32_16x16x32_bf16 v[252:255], a[108:111], v[80:83], v[252:255]
    ds_read_b128 v[84:87], v103 offset:42752
    v_mfma_f32_16x16x32_bf16 v[40:43], a[132:135], v[80:83], v[40:43]
    ds_read_b32 v199, v199 offset:336
    v_mfma_f32_16x16x32_bf16 v[168:171], a[84:87], v[64:67], v[168:171]
    s_mov_b32 s53, s47
    v_mov_b32 v9, 0xf149f2ca
    v_mfma_f32_16x16x32_bf16 v[164:167], a[108:111], v[64:67], v[164:167]
    s_mov_b32 s47, s46
    ds_read_b128 v[80:83], v103 offset:256
    buffer_load_dwordx4 v38, s[32:35], s92 offen offset:2048 lds
    v_mfma_f32_16x16x32_bf16 v[104:107], a[132:135], v[64:67], v[104:107]
    s_waitcnt vmcnt(9) lgkmcnt(6)
    s_add_u32 m0, s90, 36864
    ds_read_b64_tr_b16 a[92:93], v62 offset:61440
    v_mfma_f32_16x16x32_bf16 v[232:235], a[84:87], v[48:51], v[232:235]
    s_mov_b32 s92, 111360
    ds_read_b64_tr_b16 a[94:95], v62 offset:62208
    v_mfma_f32_16x16x32_bf16 v[228:231], a[108:111], v[48:51], v[228:231]
    s_mov_b32 s46, s45
    ds_read_b64_tr_b16 a[116:117], v62 offset:61472
    v_mfma_f32_16x16x32_bf16 v[224:227], a[132:135], v[48:51], v[224:227]
    s_waitcnt lgkmcnt(6)
    s_mov_b32 s45, s44
    ds_read_b64_tr_b16 a[118:119], v62 offset:62240
    v_mfma_f32_16x16x32_bf16 v[120:123], a[84:87], v[32:35], v[120:123]
    s_mov_b32 s44, s53
    ds_read_b64_tr_b16 a[140:141], v62 offset:61504
    buffer_load_dwordx4 v96, s[32:35], s92 offen offset:0 lds
    v_mfma_f32_16x16x32_bf16 v[92:95], a[108:111], v[32:35], v[92:95]
    s_sub_u32 s48, s44, s46
    ds_read_b64_tr_b16 a[142:143], v62 offset:62272
    v_add_u32 v139, s48, v139
    v_mfma_f32_16x16x32_bf16 v[72:75], a[132:135], v[32:35], v[72:75]
    s_sub_u32 s49, s46, s45
    ds_read_b128 v[64:67], v103 offset:1792
    v_add_u32 v138, s48, v138
    v_mfma_f32_16x16x32_bf16 v[44:47], a[88:91], v[4:7], v[44:47]
    s_sub_u32 s50, s45, s44
    ds_read_b128 v[48:51], v103 offset:3328
    v_add_u32 v137, s49, v137
    v_mfma_f32_16x16x32_bf16 v[140:143], a[112:115], v[4:7], v[140:143]
    s_sub_u32 s51, s46, s47
    ds_read_b128 v[32:35], v3 offset:41216
    v_add_u32 v136, s49, v136
    v_mfma_f32_16x16x32_bf16 v[88:91], a[136:139], v[4:7], v[88:91]
    s_waitcnt lgkmcnt(8)
    s_mov_b32 s60, s59
    ds_read_b32 v208, v208
    buffer_load_dwordx4 v15, s[32:35], s92 offen offset:1024 lds
    v_mfma_f32_16x16x32_bf16 v[52:55], a[88:91], v[84:87], v[52:55]
    s_mov_b32 s59, s58
    v_add_u32 v139, s50, v139
    v_add_u32 v138, s50, v138
    v_mfma_f32_16x16x32_bf16 v[252:255], a[112:115], v[84:87], v[252:255]
    s_mov_b32 s58, s57
    ds_read_b128 v[4:7], v3 offset:42752
    v_add_u32 v137, s48, v137
    v_mfma_f32_16x16x32_bf16 v[40:43], a[136:139], v[84:87], v[40:43]
    s_mov_b32 s57, s56
    ds_read_b32 v211, v211 offset:672
    v_add_u32 v136, s48, v136
    v_mfma_f32_16x16x32_bf16 v[168:171], a[88:91], v[80:83], v[168:171]
    s_mov_b32 s7, s6
    v_add_u32 v135, s51, v135
    v_mfma_f32_16x16x32_bf16 v[164:167], a[112:115], v[80:83], v[164:167]
    s_mov_b32 s6, s5
    ds_read_b128 v[10:13], v3 offset:256
    buffer_load_dwordx4 v38, s[32:35], s92 offen offset:2048 lds
    v_mfma_f32_16x16x32_bf16 v[104:107], a[136:139], v[80:83], v[104:107]
    s_waitcnt vmcnt(9) lgkmcnt(6)
    s_add_u32 m0, s90, 49152
    ds_read_b64_tr_b16 a[144:145], v8 offset:0
    v_mfma_f32_16x16x32_bf16 v[232:235], a[88:91], v[64:67], v[232:235]
    s_mov_b32 s92, 148224
    ds_read_b64_tr_b16 a[146:147], v8 offset:768
    v_mfma_f32_16x16x32_bf16 v[228:231], a[112:115], v[64:67], v[228:231]
    s_mov_b32 s5, s4
    ds_read_b64_tr_b16 a[168:169], v8 offset:8
    v_mfma_f32_16x16x32_bf16 v[224:227], a[136:139], v[64:67], v[224:227]
    s_waitcnt lgkmcnt(6)
    s_sub_u32 s14, s6, s7
    ds_read_b64_tr_b16 a[170:171], v8 offset:776
    v_add_u32 v134, s14, v134
    v_mfma_f32_16x16x32_bf16 v[120:123], a[88:91], v[48:51], v[120:123]
    s_add_u32 s61, s61, 1
    ds_read_b64_tr_b16 a[192:193], v62 offset:64
    buffer_load_dwordx4 v96, s[32:35], s92 offen offset:0 lds
    v_mfma_f32_16x16x32_bf16 v[92:95], a[112:115], v[48:51], v[92:95]
    s_add_u32 s12, s12, 20
    ds_read_b64_tr_b16 a[194:195], v62 offset:832
    v_add_u32 v133, s14, v133
    v_mfma_f32_16x16x32_bf16 v[72:75], a[136:139], v[48:51], v[72:75]
    s_max_u32 s12, s12, s61
    ds_read_b128 v[248:251], v3 offset:1792
    v_mfma_f32_16x16x32_bf16 v[44:47], a[92:95], v[32:35], v[44:47]
    s_add_u32 s65, s65, 1
    ds_read_b128 v[244:247], v3 offset:3328
    v_mov_b32 v26, 0
    v_mfma_f32_16x16x32_bf16 v[140:143], a[116:119], v[32:35], v[140:143]
    s_cmp_ge_i32 s65, 2
    ds_read_b128 v[80:83], v103 offset:3072
    v_mov_b32 v27, 0
    v_mfma_f32_16x16x32_bf16 v[88:91], a[140:143], v[32:35], v[88:91]
    s_waitcnt lgkmcnt(8)
    s_cselect_b32 s30, 100270464, 0
    ds_read_b128 v[64:67], v3 offset:3072
    buffer_load_dwordx4 v15, s[32:35], s92 offen offset:1024 lds
    v_mfma_f32_16x16x32_bf16 v[52:55], a[92:95], v[4:7], v[52:55]
    s_add_u32 s67, s46, s54
    ds_read_b128 v[32:35], v103 offset:3200
    v_cvt_pk_f16_f32 v84, v44, v45
    v_mfma_f32_16x16x32_bf16 v[252:255], a[116:119], v[4:7], v[252:255]
    ds_read_b128 v[48:51], v3 offset:3200
    v_cvt_pk_f16_f32 v85, v46, v47
    v_mfma_f32_16x16x32_bf16 v[40:43], a[140:143], v[4:7], v[40:43]
    ds_read_b128 v[44:47], v103 offset:3328
    v_cvt_pk_f16_f32 v52, v52, v53
    v_mfma_f32_16x16x32_bf16 v[168:171], a[92:95], v[10:13], v[168:171]
    ds_read_b128 v[4:7], v3 offset:3328
    v_cvt_pk_f16_f32 v53, v54, v55
    v_mfma_f32_16x16x32_bf16 v[164:167], a[116:119], v[10:13], v[164:167]
    v_pk_fma_f16 v119, v52, v52, s39
    v_pk_fmac_f16 v119, v53, v53
    v_mfma_f32_16x16x32_bf16 v[104:107], a[140:143], v[10:13], v[104:107]
    s_waitcnt vmcnt(8) lgkmcnt(7)
    ds_read_b64_tr_b16 a[148:149], v8 offset:12288
    buffer_load_dwordx4 v38, s[32:35], s92 offen offset:2048 lds
    v_mfma_f32_16x16x32_bf16 v[232:235], a[92:95], v[248:251], v[232:235]
    s_add_u32 m0, s90, 61440
    ds_read_b64_tr_b16 a[150:151], v8 offset:13056
    v_cvt_pk_f16_f32 v54, v252, v253
    v_mfma_f32_16x16x32_bf16 v[228:231], a[116:119], v[248:251], v[228:231]
    s_mov_b32 s92, 185088
    ds_read_b64_tr_b16 a[172:173], v8 offset:12296
    v_cvt_pk_f16_f32 v55, v254, v255
    v_mfma_f32_16x16x32_bf16 v[224:227], a[140:143], v[248:251], v[224:227]
    s_waitcnt lgkmcnt(7)
    ds_read_b64_tr_b16 a[174:175], v8 offset:13064
    v_pk_fmac_f16 v119, v54, v54
    v_mfma_f32_16x16x32_bf16 v[120:123], a[92:95], v[244:247], v[120:123]
    ds_read_b64_tr_b16 a[196:197], v62 offset:12352
    buffer_load_dwordx4 v96, s[32:35], s92 offen offset:0 lds
    v_mfma_f32_16x16x32_bf16 v[92:95], a[116:119], v[244:247], v[92:95]
    ds_read_b64_tr_b16 a[198:199], v62 offset:13120
    v_pk_fmac_f16 v119, v55, v55
    v_mfma_f32_16x16x32_bf16 v[72:75], a[140:143], v[244:247], v[72:75]
    v_cvt_pk_f16_f32 v40, v40, v41
    v_cvt_pk_f16_f32 v41, v42, v43
    v_pk_fmac_f16 v119, v40, v40
    v_pk_fmac_f16 v119, v41, v41
    v_cvt_pk_f16_f32 v10, v232, v233
    v_cvt_pk_f16_f32 v11, v234, v235
    v_pk_fma_f16 v163, v10, v10, s39
    v_pk_fmac_f16 v163, v11, v11
    v_cvt_pk_f16_f32 v12, v228, v229
    v_cvt_pk_f16_f32 v13, v230, v231
    v_pk_fmac_f16 v163, v12, v12
    v_pk_fmac_f16 v163, v13, v13
    v_cvt_pk_f16_f32 v14, v224, v225
    buffer_load_dwordx4 v15, s[32:35], s92 offen offset:1024 lds
    v_cvt_pk_f16_f32 v15, v226, v227
    v_pk_fmac_f16 v163, v14, v14
    v_pk_fmac_f16 v163, v15, v15
    v_cvt_pk_f16_f32 v248, v168, v169
    v_cvt_pk_f16_f32 v249, v170, v171
    v_pk_fma_f16 v161, v248, v248, s39
    v_pk_fmac_f16 v161, v249, v249
    v_cvt_pk_f16_f32 v250, v164, v165
    v_cvt_pk_f16_f32 v251, v166, v167
    v_pk_fmac_f16 v161, v250, v250
    v_pk_fmac_f16 v161, v251, v251
    v_cvt_pk_f16_f32 v252, v104, v105
    v_cvt_pk_f16_f32 v253, v106, v107
    v_pk_fmac_f16 v161, v252, v252
    v_pk_fmac_f16 v161, v253, v253
    v_pk_fma_f16 v117, v84, v84, s39
    v_pk_fmac_f16 v117, v85, v85
    v_mfma_f32_16x16x32_f16 v[104:107], v[212:215], v[160:163], 0
    s_waitcnt vmcnt(8)
    ds_read_b64_tr_b16 a[152:153], v8 offset:24576
    buffer_load_dwordx4 v38, s[32:35], s92 offen offset:2048 lds
    v_cvt_pk_f16_f32 v86, v140, v141
    v_cvt_pk_f16_f32 v87, v142, v143
    s_add_u32 m0, s90, 0
    s_mov_b32 s92, 0
    ds_read_b64_tr_b16 a[154:155], v8 offset:25344
    v_pk_fmac_f16 v117, v86, v86
    v_pk_fmac_f16 v117, v87, v87
    v_cvt_pk_f16_f32 v76, v88, v89
    ds_read_b64_tr_b16 a[176:177], v8 offset:24584
    v_cvt_pk_f16_f32 v77, v90, v91
    v_pk_fmac_f16 v117, v76, v76
    v_pk_fmac_f16 v117, v77, v77
    ds_read_b64_tr_b16 a[178:179], v8 offset:25352
    buffer_load_dwordx4 v158, s[76:79], s92 offen offset:0 lds
    v_mfma_f32_16x16x32_f16 v[88:91], v[212:215], v[116:119], 0
    s_nop 0
    ds_read_b64_tr_b16 a[200:201], v62 offset:24640
    v_cvt_pk_f16_f32 v118, v120, v121
    s_cmp_ge_u32 s2, 247
    s_cbranch_scc1 L_maskF
L_nomaskF:
    ds_read_b64_tr_b16 a[202:203], v62 offset:25408
    v_readlane_b32 s84, v211, 48
    v_cmp_gt_u32 vcc, 16, v0
    v_cvt_pk_f16_f32 v119, v122, v123
    v_or3_b32 v125, v125, v88, v89
    v_rsq_f32 v88, v88
    v_rsq_f32 v89, v89
    v_mul_f32 v88, s52, v88
    buffer_load_dwordx4 v63, s[76:79], s92 offen offset:1024 lds
    v_cvt_pk_f16_f32 v88, v88, v89
    v_or3_b32 v125, v125, v90, v91
    v_rsq_f32 v90, v90
    v_rsq_f32 v91, v91
    v_mul_f32 v90, s52, v90
    v_cvt_pk_f16_f32 v90, v90, v91
    v_pk_mul_f16 v56, v56, v88 op_sel:[0,0] op_sel_hi:[1,0]
    v_pk_mul_f16 v57, v57, v88 op_sel:[0,0] op_sel_hi:[1,0]
    v_pk_mul_f16 v58, v58, v88 op_sel:[0,0] op_sel_hi:[1,0]
    v_pk_mul_f16 v59, v59, v88 op_sel:[0,0] op_sel_hi:[1,0]
    v_pk_mul_f16 v36, v36, v88 op_sel:[0,0] op_sel_hi:[1,0]
    v_pk_mul_f16 v37, v37, v88 op_sel:[0,0] op_sel_hi:[1,0]
    v_pk_mul_f16 v84, v84, v88 op_sel:[0,1] op_sel_hi:[1,1]
    v_pk_mul_f16 v85, v85, v88 op_sel:[0,1] op_sel_hi:[1,1]
    v_pk_mul_f16 v86, v86, v88 op_sel:[0,1] op_sel_hi:[1,1]
    s_waitcnt vmcnt(8)
    ds_read_b64_tr_b16 a[156:157], v8 offset:36864
    buffer_load_dwordx4 v1, s[76:79], s92 offen offset:2048 lds
    s_add_u32 m0, s90, 12288
    s_mov_b32 s92, 12288
    ds_read_b64_tr_b16 a[158:159], v8 offset:37632
    v_pk_mul_f16 v87, v87, v88 op_sel:[0,1] op_sel_hi:[1,1]
    v_pk_mul_f16 v76, v76, v88 op_sel:[0,1] op_sel_hi:[1,1]
    v_pk_mul_f16 v77, v77, v88 op_sel:[0,1] op_sel_hi:[1,1]
    ds_read_b64_tr_b16 a[180:181], v8 offset:36872
    v_fma_mix_f32 v38, v56, v84, 0 op_sel:[0,0,0] op_sel_hi:[1,1,0]
    v_fma_mix_f32 v38, v56, v84, v38 op_sel:[1,1,0] op_sel_hi:[1,1,0]
    v_fma_mix_f32 v38, v57, v85, v38 op_sel:[0,0,0] op_sel_hi:[1,1,0]
    ds_read_b64_tr_b16 a[182:183], v8 offset:37640
    v_fma_mix_f32 v38, v57, v85, v38 op_sel:[1,1,0] op_sel_hi:[1,1,0]
    ds_read_b64_tr_b16 a[204:205], v62 offset:36928
    s_waitcnt lgkmcnt(5)
    buffer_load_dwordx4 v158, s[76:79], s92 offen offset:0 lds
    ds_read_b64_tr_b16 a[206:207], v62 offset:37696
    v_fma_mix_f32 v38, v58, v86, v38 op_sel:[0,0,0] op_sel_hi:[1,1,0]
    v_fma_mix_f32 v38, v58, v86, v38 op_sel:[1,1,0] op_sel_hi:[1,1,0]
    v_fma_mix_f32 v38, v59, v87, v38 op_sel:[0,0,0] op_sel_hi:[1,1,0]
    v_fma_mix_f32 v38, v59, v87, v38 op_sel:[1,1,0] op_sel_hi:[1,1,0]
    v_fma_mix_f32 v38, v36, v76, v38 op_sel:[0,0,0] op_sel_hi:[1,1,0]
    v_fma_mix_f32 v38, v36, v76, v38 op_sel:[1,1,0] op_sel_hi:[1,1,0]
    v_fma_mix_f32 v38, v37, v77, v38 op_sel:[0,0,0] op_sel_hi:[1,1,0]
    v_fma_mix_f32 v38, v37, v77, v38 op_sel:[1,1,0] op_sel_hi:[1,1,0]
    v_mov_b32 v25, v38
    v_or3_b32 v125, v125, v104, v105
    v_rsq_f32 v104, v104
    v_permlane32_swap_b32 v25, v38
    v_add_f32 v38, v25, v38
    buffer_load_dwordx4 v63, s[76:79], s92 offen offset:1024 lds
    v_mov_b32 v25, v38
    v_rsq_f32 v105, v105
    v_mul_f32 v104, s52, v104
    v_permlane16_swap_b32 v25, v38
    v_add_f32 v38, v25, v38
    v_cvt_pk_f16_f32 v104, v104, v105
    v_or3_b32 v125, v125, v106, v107
    v_rsq_f32 v106, v106
    v_rsq_f32 v107, v107
    v_mul_f32 v106, s52, v106
    v_cvt_pk_f16_f32 v106, v106, v107
    v_pk_mul_f16 v248, v248, v104 op_sel:[0,1] op_sel_hi:[1,1]
    v_pk_mul_f16 v249, v249, v104 op_sel:[0,1] op_sel_hi:[1,1]
    s_waitcnt vmcnt(8)
    ds_read_b64_tr_b16 a[160:161], v8 offset:49152
    buffer_load_dwordx4 v1, s[76:79], s92 offen offset:2048 lds
    s_add_u32 m0, s90, 24576
    s_mov_b32 s92, 24576
    ds_read_b64_tr_b16 a[162:163], v8 offset:49920
    v_pk_mul_f16 v250, v250, v104 op_sel:[0,1] op_sel_hi:[1,1]
    v_pk_mul_f16 v251, v251, v104 op_sel:[0,1] op_sel_hi:[1,1]
    v_pk_mul_f16 v252, v252, v104 op_sel:[0,1] op_sel_hi:[1,1]
    ds_read_b64_tr_b16 a[184:185], v8 offset:49160
    v_pk_mul_f16 v253, v253, v104 op_sel:[0,1] op_sel_hi:[1,1]
    v_pk_mul_f16 v108, v108, v104 op_sel:[0,0] op_sel_hi:[1,0]
    v_pk_mul_f16 v109, v109, v104 op_sel:[0,0] op_sel_hi:[1,0]
    ds_read_b64_tr_b16 a[186:187], v8 offset:49928
    v_pk_mul_f16 v110, v110, v104 op_sel:[0,0] op_sel_hi:[1,0]
    ds_read_b64_tr_b16 a[208:209], v62 offset:49216
    buffer_load_dwordx4 v158, s[76:79], s92 offen offset:0 lds
    ds_read_b64_tr_b16 a[210:211], v62 offset:49984
    v_pk_mul_f16 v111, v111, v104 op_sel:[0,0] op_sel_hi:[1,0]
    v_pk_mul_f16 v154, v154, v104 op_sel:[0,0] op_sel_hi:[1,0]
    v_pk_mul_f16 v155, v155, v104 op_sel:[0,0] op_sel_hi:[1,0]
    v_pk_mul_f16 v10, v10, v106 op_sel:[0,1] op_sel_hi:[1,1]
    v_pk_mul_f16 v11, v11, v106 op_sel:[0,1] op_sel_hi:[1,1]
    v_pk_mul_f16 v12, v12, v106 op_sel:[0,1] op_sel_hi:[1,1]
    v_pk_mul_f16 v13, v13, v106 op_sel:[0,1] op_sel_hi:[1,1]
    v_pk_mul_f16 v14, v14, v106 op_sel:[0,1] op_sel_hi:[1,1]
    v_pk_mul_f16 v15, v15, v106 op_sel:[0,1] op_sel_hi:[1,1]
    v_pk_mul_f16 v28, v28, v106 op_sel:[0,0] op_sel_hi:[1,0]
    v_pk_mul_f16 v29, v29, v106 op_sel:[0,0] op_sel_hi:[1,0]
    v_pk_mul_f16 v30, v30, v106 op_sel:[0,0] op_sel_hi:[1,0]
    v_pk_mul_f16 v31, v31, v106 op_sel:[0,0] op_sel_hi:[1,0]
    v_pk_mul_f16 v150, v150, v106 op_sel:[0,0] op_sel_hi:[1,0]
    v_pk_mul_f16 v151, v151, v106 op_sel:[0,0] op_sel_hi:[1,0]
    buffer_load_dwordx4 v63, s[76:79], s92 offen offset:1024 lds
    v_add_f32 v38, s84, v38
    v_exp_f32 v38, v38
    v_cndmask_b32 v208, v9, v208, vcc
    v_cvt_pk_bf16_f32 v38, v38, 0
    v_cndmask_b32 v209, v9, v209, vcc
    v_cndmask_b32 v210, v9, v210, vcc
    v_cmp_gt_u32 vcc, 16, v0
    v_pk_fma_f16 v25, v118, v118, s39
    v_pk_fmac_f16 v25, v119, v119
    v_cndmask_b32 v38, 0, v38, vcc
    v_cmp_gt_u32 vcc, 49, v0
    v_cvt_pk_f16_f32 v120, v92, v93
    v_cvt_pk_f16_f32 v121, v94, v95
    v_cndmask_b32 v211, v9, v211, vcc
    v_pk_fmac_f16 v25, v120, v120
    v_pk_fmac_f16 v25, v121, v121
    buffer_load_dwordx4 v1, s[76:79], s92 offen offset:2048 lds
    s_add_u32 m0, s90, 36864
    s_mov_b32 s92, 36864
    s_waitcnt vmcnt(9)
    ds_read_b64_tr_b16 a[164:165], v8 offset:61440
    v_cvt_pk_f16_f32 v122, v72, v73
    v_cvt_pk_f16_f32 v123, v74, v75
    v_pk_fmac_f16 v25, v122, v122
    ds_read_b64_tr_b16 a[166:167], v8 offset:62208
    v_mfma_f32_16x16x32_bf16 v[72:75], v[80:83], a[144:147], 0
    v_pk_fmac_f16 v25, v123, v123
    v_pk_mul_f16 v68, v68, v90 op_sel:[0,0] op_sel_hi:[1,0]
    v_mfma_f32_16x16x32_bf16 v[72:75], v[64:67], a[148:151], v[72:75]
    ds_read_b64_tr_b16 a[188:189], v8 offset:61448
    v_pk_mul_f16 v69, v69, v90 op_sel:[0,0] op_sel_hi:[1,0]
    v_mfma_f32_16x16x32_bf16 v[72:75], v[32:35], a[152:155], v[72:75]
    s_waitcnt lgkmcnt(3)
    buffer_load_dwordx4 v158, s[76:79], s92 offen offset:0 lds
    ds_read_b64_tr_b16 a[190:191], v8 offset:62216
    v_mfma_f32_16x16x32_bf16 v[72:75], v[48:51], a[156:159], v[72:75]
    v_pk_mul_f16 v70, v70, v90 op_sel:[0,0] op_sel_hi:[1,0]
    v_pk_mul_f16 v71, v71, v90 op_sel:[0,0] op_sel_hi:[1,0]
    v_mfma_f32_16x16x32_bf16 v[72:75], v[44:47], a[160:163], v[72:75]
    s_waitcnt lgkmcnt(2)
    ds_read_b64_tr_b16 a[212:213], v62 offset:61504
    v_pk_mul_f16 v60, v60, v90 op_sel:[0,0] op_sel_hi:[1,0]
    v_pk_mul_f16 v61, v61, v90 op_sel:[0,0] op_sel_hi:[1,0]
    v_pk_mul_f16 v52, v52, v90 op_sel:[0,1] op_sel_hi:[1,1]
    ds_read_b64_tr_b16 a[214:215], v62 offset:62272
    v_pk_mul_f16 v53, v53, v90 op_sel:[0,1] op_sel_hi:[1,1]
    buffer_load_dwordx4 v63, s[76:79], s92 offen offset:1024 lds
    ds_write_b128 v16, v[56:59] offset:21504
    v_mfma_f32_16x16x32_bf16 v[72:75], v[4:7], a[164:167], v[72:75]
    v_pk_mul_f16 v54, v54, v90 op_sel:[0,1] op_sel_hi:[1,1]
    v_pk_mul_f16 v55, v55, v90 op_sel:[0,1] op_sel_hi:[1,1]
    v_mfma_f32_16x16x32_bf16 v[56:59], v[80:83], a[168:171], 0
    v_pk_mul_f16 v40, v40, v90 op_sel:[0,1] op_sel_hi:[1,1]
    v_pk_mul_f16 v41, v41, v90 op_sel:[0,1] op_sel_hi:[1,1]
    v_mfma_f32_16x16x32_bf16 v[56:59], v[64:67], a[172:175], v[56:59]
    ds_write_b128 v16, v[84:87] offset:21536
    v_mfma_f32_16x16x32_bf16 v[56:59], v[32:35], a[176:179], v[56:59]
    buffer_load_dwordx4 v1, s[76:79], s92 offen offset:2048 lds
    v_cvt_pk_bf16_f32 v164, v72, v73
    v_mfma_f32_16x16x32_bf16 v[56:59], v[48:51], a[180:183], v[56:59]
    s_add_u32 m0, s90, 49152
    v_cvt_pk_bf16_f32 v165, v74, v75
    v_fma_mix_f32 v62, v68, v52, 0 op_sel:[0,0,0] op_sel_hi:[1,1,0]
    v_mfma_f32_16x16x32_bf16 v[56:59], v[44:47], a[184:187], v[56:59]
    s_waitcnt lgkmcnt(2)
    s_mov_b32 s92, 49152
    ds_write_b64 v16, v[76:77] offset:21552
    v_mfma_f32_16x16x32_bf16 v[56:59], v[4:7], a[188:191], v[56:59]
    v_fma_mix_f32 v62, v68, v52, v62 op_sel:[1,1,0] op_sel_hi:[1,1,0]
    v_fma_mix_f32 v62, v69, v53, v62 op_sel:[0,0,0] op_sel_hi:[1,1,0]
    v_mfma_f32_16x16x32_bf16 v[72:75], v[80:83], a[192:195], 0
    s_nop 0
    buffer_load_dwordx4 v158, s[76:79], s92 offen offset:0 lds
    ds_read_b128 v[80:83], v103 offset:40960
    v_mfma_f32_16x16x32_bf16 v[72:75], v[64:67], a[196:199], v[72:75]
    s_nop 0
    v_cvt_pk_bf16_f32 v160, v56, v57
    v_cvt_pk_bf16_f32 v161, v58, v59
    v_mfma_f32_16x16x32_bf16 v[72:75], v[32:35], a[200:203], v[72:75]
    ds_read_b128 v[32:35], v3 offset:40960
    v_mov_b32 v171, 0
    v_mfma_f32_16x16x32_bf16 v[72:75], v[48:51], a[204:207], v[72:75]
    ds_read_b128 v[56:59], v103 offset:41088
    v_mov_b32 v167, 0
    v_mfma_f32_16x16x32_bf16 v[72:75], v[44:47], a[208:211], v[72:75]
    ds_read_b128 v[48:51], v3 offset:41088
    v_mov_b32 v163, 0
    v_mfma_f32_16x16x32_bf16 v[72:75], v[4:7], a[212:215], v[72:75]
    buffer_load_dwordx4 v63, s[76:79], s92 offen offset:1024 lds
    ds_read_b128 v[44:47], v103 offset:41216
    v_mov_b32 v159, 0
    v_mov_b32 v152, 0
    v_mov_b32 v153, 0
    v_mfma_f32_16x16x32_f16 v[64:67], v[248:251], v[108:111], v[204:207]
    s_nop 0
    ds_read_b128 v[4:7], v3 offset:41216
    v_cvt_pk_bf16_f32 v156, v72, v73
    v_mfma_f32_16x16x32_f16 v[64:67], v[250:253], v[152:155], v[64:67]
    v_cvt_pk_bf16_f32 v157, v74, v75
    v_mov_b32 v148, 0
    v_mfma_f32_16x16x32_f16 v[88:91], v[10:13], v[108:111], v[200:203]
    v_mov_b32 v149, 0
    v_mov_b32 v144, 0
    v_mfma_f32_16x16x32_f16 v[88:91], v[12:15], v[152:155], v[88:91]
    s_waitcnt lgkmcnt(5)
    v_mov_b32 v145, 0
    v_mov_b32 v140, 0
    v_mfma_f32_16x16x32_bf16 v[84:87], a[144:147], v[80:83], 0
    s_waitcnt lgkmcnt(4)
    buffer_load_dwordx4 v1, s[76:79], s92 offen offset:2048 lds
    v_mov_b32 v141, 0
    v_mfma_f32_16x16x32_bf16 v[84:87], a[148:151], v[32:35], v[84:87]
    s_waitcnt lgkmcnt(3)
    s_add_u32 m0, s90, 61440
    v_exp_f32 v64, v64
    v_mfma_f32_16x16x32_bf16 v[84:87], a[152:155], v[56:59], v[84:87]
    s_waitcnt lgkmcnt(2)
    s_mov_b32 s92, 61440
    v_exp_f32 v65, v65
    v_mfma_f32_16x16x32_bf16 v[84:87], a[156:159], v[48:51], v[84:87]
    s_waitcnt lgkmcnt(1)
    ds_write_b128 v16, v[36:39] offset:21520
    v_mfma_f32_16x16x32_bf16 v[84:87], a[160:163], v[44:47], v[84:87]
    s_waitcnt lgkmcnt(1)
    buffer_load_dwordx4 v158, s[76:79], s92 offen offset:0 lds
    v_cvt_pk_bf16_f32 v92, v64, v65
    v_mfma_f32_16x16x32_bf16 v[84:87], a[164:167], v[4:7], v[84:87]
    v_exp_f32 v66, v66
    v_mfma_f32_16x16x32_bf16 v[36:39], a[168:171], v[80:83], 0
    s_nop 0
    ds_read_b128 v[232:235], v134 offset:32
    v_fma_mix_f32 v62, v69, v53, v62 op_sel:[1,1,0] op_sel_hi:[1,1,0]
    v_mfma_f32_16x16x32_bf16 v[36:39], a[172:175], v[32:35], v[36:39]
    s_nop 0
    ds_read_b64 v[236:237], v134 offset:48
    v_cvt_pk_bf16_f32 v78, v84, v85
    v_mfma_f32_16x16x32_bf16 v[36:39], a[176:179], v[56:59], v[36:39]
    ds_read_b128 v[72:75], v134 offset:0
    v_cvt_pk_bf16_f32 v79, v86, v87
    v_mfma_f32_16x16x32_bf16 v[36:39], a[180:183], v[48:51], v[36:39]
    buffer_load_dwordx4 v63, s[76:79], s92 offen offset:1024 lds
    ds_read_b64 v[142:143], v134 offset:16
    v_mfma_f32_16x16x32_bf16 v[36:39], a[184:187], v[44:47], v[36:39]
    ds_write_b64 v16, v[78:79] offset:21560
    v_mfma_f32_16x16x32_bf16 v[36:39], a[188:191], v[4:7], v[36:39]
    v_exp_f32 v67, v67
    v_mfma_f32_16x16x32_bf16 v[76:79], a[192:195], v[80:83], 0
    ds_read_b128 v[80:83], v103 offset:42496
    v_cvt_pk_bf16_f32 v93, v66, v67
    v_mfma_f32_16x16x32_bf16 v[76:79], a[196:199], v[32:35], v[76:79]
    ds_read_b128 v[32:35], v3 offset:42496
    buffer_load_dwordx4 v1, s[76:79], s92 offen offset:2048 lds
    v_mfma_f32_16x16x32_bf16 v[76:79], a[200:203], v[56:59], v[76:79]
    s_add_u32 m0, s54, 20480
    ds_read_b128 v[64:67], v103 offset:42624
    v_cvt_pk_bf16_f32 v36, v36, v37
    v_mfma_f32_16x16x32_bf16 v[76:79], a[204:207], v[48:51], v[76:79]
    ds_read_b128 v[56:59], v3 offset:42624
    v_cvt_pk_bf16_f32 v37, v38, v39
    v_mfma_f32_16x16x32_bf16 v[76:79], a[208:211], v[44:47], v[76:79]
    ds_read_b128 v[48:51], v103 offset:42752
    v_fma_mix_f32 v62, v70, v54, v62 op_sel:[0,0,0] op_sel_hi:[1,1,0]
    v_mfma_f32_16x16x32_bf16 v[76:79], a[212:215], v[4:7], v[76:79]
    s_waitcnt lgkmcnt(7)
    ds_read_b128 v[44:47], v3 offset:42752
    v_fma_mix_f32 v62, v70, v54, v62 op_sel:[1,1,0] op_sel_hi:[1,1,0]
    v_mfma_f32_16x16x32_f16 v[84:87], v[232:235], v[108:111], v[208:211]
    v_exp_f32 v88, v88
    v_mfma_f32_16x16x32_f16 v[84:87], v[234:237], v[152:155], v[84:87]
    s_nop 0
    buffer_load_dwordx4 v130, s[24:27], s56 offen nt lds
    v_cvt_pk_bf16_f32 v38, v76, v77
    v_mfma_f32_16x16x32_f16 v[4:7], v[72:75], v[248:251], v[208:211]
    s_waitcnt lgkmcnt(6)
    s_add_u32 m0, s54, 21504
    v_cvt_pk_bf16_f32 v39, v78, v79
    v_fma_mix_f32 v62, v71, v55, v62 op_sel:[0,0,0] op_sel_hi:[1,1,0]
    v_mfma_f32_16x16x32_f16 v[4:7], v[140:143], v[250:253], v[4:7]
    ds_write_b128 v16, v[36:39] offset:21568
    v_mfma_f32_16x16x32_f16 v[76:79], v[72:75], v[10:13], v[208:211]
    v_exp_f32 v89, v89
    v_mfma_f32_16x16x32_f16 v[76:79], v[140:143], v[12:15], v[76:79]
    s_waitcnt lgkmcnt(3)
    buffer_load_dwordx4 v129, s[24:27], s56 offen nt lds
    v_cvt_pk_bf16_f32 v94, v88, v89
    v_mfma_f32_16x16x32_bf16 v[36:39], a[144:147], v[80:83], 0
    s_add_u32 m0, s54, 22528
    ds_read_u16 v166, v133 offset:56
    v_fma_mix_f32 v62, v71, v55, v62 op_sel:[1,1,0] op_sel_hi:[1,1,0]
    v_mfma_f32_16x16x32_bf16 v[36:39], a[148:151], v[32:35], v[36:39]
    ds_read_u16 v162, v133 offset:64
    v_mov_b32_dpp v7, v79 quad_perm:[0,1,2,3] row_mask:0x2 bank_mask:0xf
    v_mfma_f32_16x16x32_bf16 v[36:39], a[152:155], v[64:67], v[36:39]
    ds_read_u16 v158, v133 offset:72
    v_fma_mix_f32 v62, v60, v40, v62 op_sel:[0,0,0] op_sel_hi:[1,1,0]
    v_mfma_f32_16x16x32_bf16 v[36:39], a[156:159], v[56:59], v[36:39]
    s_waitcnt lgkmcnt(4)
    v_exp_f32 v90, v90
    v_mfma_f32_16x16x32_bf16 v[36:39], a[160:163], v[48:51], v[36:39]
    buffer_load_dwordx4 v128, s[24:27], s56 offen nt lds
    v_fma_mix_f32 v62, v60, v40, v62 op_sel:[1,1,0] op_sel_hi:[1,1,0]
    v_mfma_f32_16x16x32_bf16 v[36:39], a[164:167], v[44:47], v[36:39]
    s_add_u32 m0, s54, 23552
    v_exp_f32 v91, v91
    v_mfma_f32_16x16x32_bf16 v[76:79], a[168:171], v[80:83], 0
    v_cvt_pk_bf16_f32 v95, v90, v91
    v_fma_mix_f32 v62, v61, v41, v62 op_sel:[0,0,0] op_sel_hi:[1,1,0]
    v_mfma_f32_16x16x32_bf16 v[76:79], a[172:175], v[32:35], v[76:79]
    v_exp_f32 v84, v84
    v_mfma_f32_16x16x32_bf16 v[76:79], a[176:179], v[64:67], v[76:79]
    v_cvt_pk_bf16_f32 v170, v84, 0
    v_cvt_pk_bf16_f32 v42, v36, v37
    v_mfma_f32_16x16x32_bf16 v[76:79], a[180:183], v[56:59], v[76:79]
    buffer_load_dwordx4 v127, s[24:27], s56 offen nt lds
    v_cvt_pk_bf16_f32 v43, v38, v39
    v_mfma_f32_16x16x32_bf16 v[76:79], a[184:187], v[48:51], v[76:79]
    s_add_u32 m0, s54, 24576
    v_fma_mix_f32 v62, v61, v41, v62 op_sel:[1,1,0] op_sel_hi:[1,1,0]
    v_mov_b32 v1, v62
    v_mfma_f32_16x16x32_bf16 v[76:79], a[188:191], v[44:47], v[76:79]
    s_nop 0
    v_permlane32_swap_b32 v1, v62
    v_mfma_f32_16x16x32_bf16 v[36:39], a[192:195], v[80:83], 0
    s_nop 0
    v_add_f32 v62, v1, v62
    v_mov_b32 v1, v62
    v_mfma_f32_16x16x32_bf16 v[36:39], a[196:199], v[32:35], v[36:39]
    s_nop 0
    v_cvt_pk_bf16_f32 v32, v76, v77
    v_cvt_pk_bf16_f32 v33, v78, v79
    v_mfma_f32_16x16x32_bf16 v[36:39], a[200:203], v[64:67], v[36:39]
    buffer_load_dwordx4 v126, s[24:27], s56 offen nt lds
    v_mov_b32 v63, 0
    v_mfma_f32_16x16x32_bf16 v[36:39], a[204:207], v[56:59], v[36:39]
    s_cmp_lt_u32 s61, s71
    v_permlane16_swap_b32 v1, v62
    v_mfma_f32_16x16x32_bf16 v[36:39], a[208:211], v[48:51], v[36:39]
    s_cselect_b32 s15, s61, s12
    v_add_f32 v62, v1, v62
    v_add_f32 v62, s84, v62
    v_mfma_f32_16x16x32_bf16 v[36:39], a[212:215], v[44:47], v[36:39]
    s_cselect_b32 s56, s69, s70
    v_exp_f32 v62, v62
    v_mfma_f32_16x16x32_f16 v[64:67], v[248:251], v[28:31], v[192:195]
    s_add_u32 s56, s56, s15
    ds_read_b128 v[88:91], v103 offset:0
    v_cvt_pk_bf16_f32 v62, v62, 0
    v_mfma_f32_16x16x32_f16 v[64:67], v[250:253], v[148:151], v[64:67]
    s_mul_i32 s53, s56, 58255
    ds_read_b128 v[84:87], v3 offset:0
    v_cvt_pk_bf16_f32 v34, v36, v37
    v_mfma_f32_16x16x32_f16 v[228:231], v[10:13], v[28:31], v[188:191]
    s_lshr_b32 s53, s53, 22
    ds_read_b128 v[80:83], v103 offset:128
    v_cvt_pk_bf16_f32 v35, v38, v39
    v_mfma_f32_16x16x32_f16 v[228:231], v[12:15], v[148:151], v[228:231]
    s_mul_i32 s53, s53, s63
    ds_read_b128 v[76:79], v3 offset:128
    v_cmp_gt_u32 vcc, 16, v0
    v_exp_f32 v64, v64
    s_mul_i32 s56, s56, s62
    s_add_u32 s56, s56, s53
    s_mul_i32 s4, s15, 336
    s_cmp_ge_u32 s15, 16
    s_cselect_b32 s53, -26880, 0
    s_add_u32 s4, s4, s53
    s_cmp_lt_u32 s15, s73
    s_cselect_b32 s26, 100270464, 0
    s_cselect_b32 s56, s56, 0
    s_cselect_b32 s4, s4, -1
    s_cselect_b32 s15, s15, 0
    s_cselect_b32 s13, s13, -1
    s_bitset1_b32 s64, s15
    v_mfma_f32_16x16x32_f16 v[48:51], v[232:235], v[28:31], v[208:211]
    s_add_u32 m0, s67, 0
    ds_read_b128 v[44:47], v103 offset:256
    v_cndmask_b32 v62, 0, v62, vcc
    v_mfma_f32_16x16x32_f16 v[48:51], v[234:237], v[148:151], v[48:51]
    ds_read_b128 v[36:39], v3 offset:256
    v_mfma_f32_16x16x32_f16 v[56:59], v[212:215], v[24:27], 0
    s_waitcnt lgkmcnt(4)
    v_exp_f32 v65, v65
    v_mfma_f32_16x16x32_bf16 v[104:107], v[88:91], a[144:147], 0
    v_exp_f32 v66, v66
    v_mfma_f32_16x16x32_bf16 v[104:107], v[84:87], a[148:151], v[104:107]
    s_waitcnt lgkmcnt(2)
    v_exp_f32 v67, v67
    v_mfma_f32_16x16x32_bf16 v[104:107], v[80:83], a[152:155], v[104:107]
    v_or3_b32 v125, v125, v56, v57
    v_cvt_pk_bf16_f32 v100, v64, v65
    v_mfma_f32_16x16x32_bf16 v[104:107], v[76:79], a[156:159], v[104:107]
    s_waitcnt lgkmcnt(1)
    v_rsq_f32 v56, v56
    v_rsq_f32 v57, v57
    v_mul_f32 v56, s52, v56
    v_cvt_pk_f16_f32 v56, v56, v57
    v_pk_mul_f16 v118, v118, v56 op_sel:[0,1] op_sel_hi:[1,1]
    v_pk_mul_f16 v119, v119, v56 op_sel:[0,1] op_sel_hi:[1,1]
    v_pk_mul_f16 v120, v120, v56 op_sel:[0,1] op_sel_hi:[1,1]
    v_pk_mul_f16 v121, v121, v56 op_sel:[0,1] op_sel_hi:[1,1]
    v_pk_mul_f16 v122, v122, v56 op_sel:[0,1] op_sel_hi:[1,1]
    v_mfma_f32_16x16x32_bf16 v[104:107], v[44:47], a[160:163], v[104:107]
    s_waitcnt vmcnt(5) lgkmcnt(0)
    s_barrier
    v_pk_mul_f16 v123, v123, v56 op_sel:[0,1] op_sel_hi:[1,1]
    v_pk_mul_f16 v240, v240, v56 op_sel:[0,0] op_sel_hi:[1,0]
    v_mfma_f32_16x16x32_bf16 v[104:107], v[36:39], a[164:167], v[104:107]
    v_pk_mul_f16 v241, v241, v56 op_sel:[0,0] op_sel_hi:[1,0]
    v_pk_mul_f16 v242, v242, v56 op_sel:[0,0] op_sel_hi:[1,0]
    v_mfma_f32_16x16x32_f16 v[24:27], v[118:121], v[108:111], v[196:199]
    v_pk_mul_f16 v243, v243, v56 op_sel:[0,0] op_sel_hi:[1,0]
    v_pk_mul_f16 v146, v146, v56 op_sel:[0,0] op_sel_hi:[1,0]
    v_mfma_f32_16x16x32_f16 v[24:27], v[120:123], v[152:155], v[24:27]
    s_nop 0
    v_pk_mul_f16 v147, v147, v56 op_sel:[0,0] op_sel_hi:[1,0]
    v_cvt_pk_bf16_f32 v0, v104, v105
    v_mfma_f32_16x16x32_f16 v[56:59], v[72:75], v[118:121], v[208:211]
    v_cvt_pk_bf16_f32 v1, v106, v107
    v_cvt_pk_bf16_f32 v101, v66, v67
    v_mfma_f32_16x16x32_f16 v[56:59], v[140:143], v[120:123], v[56:59]
    s_nop 0
    v_exp_f32 v24, v24
    v_mfma_f32_16x16x32_f16 v[72:75], v[118:121], v[28:31], v[184:187]
    v_exp_f32 v25, v25
    v_mfma_f32_16x16x32_f16 v[72:75], v[120:123], v[148:151], v[72:75]
    v_exp_f32 v26, v26
    v_mfma_f32_16x16x32_bf16 v[28:31], v[88:91], a[168:171], 0
    s_nop 0
    v_mov_b32_dpp v7, v59 quad_perm:[0,1,2,3] row_mask:0x4 bank_mask:0xf
    v_cvt_pk_bf16_f32 v168, v24, v25
    v_mfma_f32_16x16x32_bf16 v[28:31], v[84:87], a[172:175], v[28:31]
    v_exp_f32 v7, v7
    v_mfma_f32_16x16x32_bf16 v[28:31], v[80:83], a[176:179], v[28:31]
    v_exp_f32 v27, v27
    v_mfma_f32_16x16x32_bf16 v[28:31], v[76:79], a[180:183], v[28:31]
    s_lshl_b32 s93, s68, 10
    v_cvt_pk_bf16_f32 v7, v7, v7
    v_cvt_pk_bf16_f32 v169, v26, v27
    v_mfma_f32_16x16x32_bf16 v[28:31], v[44:47], a[184:187], v[28:31]
    s_mov_b32 s53, s47
    ds_write_b16 v133, v7
    v_mfma_f32_16x16x32_bf16 v[28:31], v[36:39], a[188:191], v[28:31]
    s_mov_b32 s47, s46
    ds_read_b128 v[64:67], v134
    v_add_u32 v247, s93, v131
    v_mfma_f32_16x16x32_bf16 v[56:59], v[220:223], v[92:95], 0
    s_mov_b32 s46, s45
    ds_read_b128 v[24:27], v134 offset:16
    v_mfma_f32_16x16x32_bf16 v[56:59], v[220:223], v[168:171], v[56:59]
    s_mov_b32 s45, s44
    ds_read_b128 v[108:111], v238 offset:0
    v_cvt_pk_bf16_f32 v28, v28, v29
    v_mfma_f32_16x16x32_bf16 v[4:7], v[88:91], a[192:195], 0
    s_mov_b32 s44, s53
    ds_read_b64 v[104:105], v102 offset:64
    v_cvt_pk_bf16_f32 v29, v30, v31
    v_mfma_f32_16x16x32_bf16 v[4:7], v[84:87], a[196:199], v[4:7]
    s_sub_u32 s48, s44, s46
    ds_read_b128 v[18:21], v238 offset:3072
    v_add_u32 v139, s48, v139
    v_mfma_f32_16x16x32_bf16 v[4:7], v[80:83], a[200:203], v[4:7]
    s_sub_u32 s49, s46, s45
    ds_read_b64 v[106:107], v102 offset:3136
    v_add_u32 v138, s48, v138
    v_mfma_f32_16x16x32_bf16 v[4:7], v[76:79], a[204:207], v[4:7]
    ds_read_b128 v[88:91], v238 offset:6144
    v_mfma_f32_16x16x32_bf16 v[4:7], v[44:47], a[208:211], v[4:7]
    ds_read_b64 v[80:81], v102 offset:6208
    v_mfma_f32_16x16x32_bf16 v[4:7], v[36:39], a[212:215], v[4:7]
    ds_read_b128 v[224:227], v238 offset:9216
    v_mfma_f32_16x16x32_f16 v[84:87], v[248:251], v[240:243], v[180:183]
    s_nop 0
    ds_read_b64 v[82:83], v102 offset:9280
    s_nop 0
    v_mfma_f32_16x16x32_f16 v[84:87], v[250:253], v[144:147], v[84:87]
    s_nop 0
    ds_read_b128 v[76:79], v238 offset:12288
    v_cvt_pk_bf16_f32 v8, v4, v5
    v_mfma_f32_16x16x32_f16 v[36:39], v[10:13], v[240:243], v[176:179]
    ds_read_b64 v[116:117], v102 offset:12352
    v_cvt_pk_bf16_f32 v9, v6, v7
    v_mfma_f32_16x16x32_f16 v[36:39], v[12:15], v[144:147], v[36:39]
    ds_read_b128 v[44:47], v238 offset:15360
    v_mfma_f32_16x16x32_f16 v[12:15], v[118:121], v[240:243], v[172:175]
    ds_read_b64 v[118:119], v102 offset:15424
    v_mfma_f32_16x16x32_f16 v[12:15], v[120:123], v[144:147], v[12:15]
    ds_read_b128 v[252:255], v238 offset:18432
    v_mfma_f32_16x16x32_f16 v[4:7], v[232:235], v[240:243], v[208:211]
    ds_read_b64 v[240:241], v102 offset:18496
    v_mfma_f32_16x16x32_f16 v[4:7], v[234:237], v[144:147], v[4:7]
    s_waitcnt lgkmcnt(8)
    ds_read_b128 v[120:123], v238 offset:21504
    v_mfma_f32_16x16x32_bf16 v[248:251], v[108:111], v[220:223], 0
    ds_read_b64 v[242:243], v102 offset:21568
    v_mfma_f32_16x16x32_bf16 v[248:251], v[18:21], v[220:223], v[248:251]
    ds_read_b128 v[232:235], v238 offset:24576
    v_mfma_f32_16x16x32_bf16 v[248:251], v[88:91], v[220:223], v[248:251]
    s_waitcnt lgkmcnt(8)
    ds_read_b64 v[88:89], v102 offset:24640
    v_mfma_f32_16x16x32_bf16 v[248:251], v[224:227], v[220:223], v[248:251]
    ds_read_b128 v[108:111], v238 offset:27648
    v_mfma_f32_16x16x32_bf16 v[248:251], v[104:107], v[220:223], v[248:251]
    ds_read_b64 v[90:91], v102 offset:27712
    v_mfma_f32_16x16x32_bf16 v[248:251], v[80:83], v[220:223], v[248:251]
    ds_read_b128 v[80:83], v238 offset:30720
    v_mfma_f32_16x16x32_bf16 v[224:227], v[76:79], v[220:223], 0
    s_waitcnt lgkmcnt(8)
    ds_read_b64 v[76:77], v102 offset:30784
    s_nop 0
    v_mfma_f32_16x16x32_bf16 v[224:227], v[44:47], v[220:223], v[224:227]
    s_nop 0
    ds_read_b128 v[104:107], v238 offset:33792
    v_mul_f32 v248, 0xbbaaaaab, v248
    v_mfma_f32_16x16x32_bf16 v[224:227], v[252:255], v[220:223], v[224:227]
    s_waitcnt lgkmcnt(8)
    ds_read_b64 v[78:79], v102 offset:33856
    v_mul_f32 v249, 0xbbaaaaab, v249
    v_mfma_f32_16x16x32_bf16 v[224:227], v[120:123], v[220:223], v[224:227]
    ds_read_b128 v[120:123], v103 offset:1536
    v_mul_f32 v250, 0xbbaaaaab, v250
    v_mfma_f32_16x16x32_bf16 v[224:227], v[116:119], v[220:223], v[224:227]
    s_waitcnt lgkmcnt(8)
    ds_read_b128 v[116:119], v3 offset:1536
    v_mul_f32 v251, 0xbbaaaaab, v251
    v_mfma_f32_16x16x32_bf16 v[224:227], v[240:243], v[220:223], v[224:227]
    ds_write_b128 v2, v[248:251] offset:0
    v_mfma_f32_16x16x32_bf16 v[44:47], v[232:235], v[220:223], 0
    s_waitcnt lgkmcnt(7)
    v_exp_f32 v228, v228
    v_mfma_f32_16x16x32_bf16 v[44:47], v[108:111], v[220:223], v[44:47]
    s_waitcnt lgkmcnt(6)
    v_exp_f32 v229, v229
    v_mfma_f32_16x16x32_bf16 v[44:47], v[80:83], v[220:223], v[44:47]
    s_waitcnt lgkmcnt(4)
    ds_read_b128 v[80:83], v103 offset:1664
    v_cvt_pk_bf16_f32 v102, v228, v229
    v_exp_f32 v230, v230
    v_mfma_f32_16x16x32_bf16 v[44:47], v[104:107], v[220:223], v[44:47]
    ds_read_b128 v[108:111], v3 offset:1664
    v_mul_f32 v224, 0xbbaaaaab, v224
    v_mfma_f32_16x16x32_bf16 v[44:47], v[88:91], v[220:223], v[44:47]
    s_waitcnt lgkmcnt(4)
    ds_read_b128 v[104:107], v103 offset:1792
    v_mul_f32 v225, 0xbbaaaaab, v225
    v_mfma_f32_16x16x32_bf16 v[44:47], v[76:79], v[220:223], v[44:47]
    ds_read_b128 v[88:91], v3 offset:1792
    v_mul_f32 v226, 0xbbaaaaab, v226
    v_mfma_f32_16x16x32_bf16 v[76:79], v[120:123], a[144:147], 0
    s_waitcnt lgkmcnt(4)
    v_exp_f32 v231, v231
    v_mfma_f32_16x16x32_bf16 v[76:79], v[116:119], a[148:151], v[76:79]
    s_waitcnt lgkmcnt(3)
    v_cvt_pk_bf16_f32 v103, v230, v231
    v_mul_f32 v227, 0xbbaaaaab, v227
    v_exp_f32 v72, v72
    v_exp_f32 v73, v73
    v_exp_f32 v74, v74
    v_exp_f32 v75, v75
    v_exp_f32 v49, v49
    v_rcp_f32 v56, v56
    v_mfma_f32_16x16x32_bf16 v[76:79], v[80:83], a[152:155], v[76:79]
    s_waitcnt lgkmcnt(2)
    ds_write_b128 v2, v[224:227] offset:128
    v_mfma_f32_16x16x32_bf16 v[76:79], v[108:111], a[156:159], v[76:79]
    s_waitcnt lgkmcnt(2)
    v_mul_f32 v44, 0xbbaaaaab, v44
    v_mul_f32 v45, 0xbbaaaaab, v45
    v_mfma_f32_16x16x32_bf16 v[76:79], v[104:107], a[160:163], v[76:79]
    s_waitcnt lgkmcnt(1)
    v_mul_f32 v46, 0xbbaaaaab, v46
    v_mul_f32 v47, 0xbbaaaaab, v47
    v_mfma_f32_16x16x32_bf16 v[76:79], v[88:91], a[164:167], v[76:79]
    s_barrier
    ds_write_b128 v2, v[44:47] offset:256
    v_mfma_f32_16x16x32_bf16 v[44:47], v[120:123], a[168:171], 0
    s_nop 0
    buffer_load_dwordx4 v130, s[24:27], s56 offen nt lds
    s_nop 0
    v_mfma_f32_16x16x32_bf16 v[44:47], v[116:119], a[172:175], v[44:47]
    s_add_u32 m0, s67, 1024
    v_cvt_pk_bf16_f32 v2, v76, v77
    v_cvt_pk_bf16_f32 v3, v78, v79
    v_mfma_f32_16x16x32_bf16 v[44:47], v[80:83], a[176:179], v[44:47]
    buffer_load_dwordx4 v129, s[24:27], s56 offen nt lds
    v_mfma_f32_16x16x32_bf16 v[44:47], v[108:111], a[180:183], v[44:47]
    s_add_u32 m0, s67, 2048
    v_exp_f32 v84, v84
    v_mfma_f32_16x16x32_bf16 v[44:47], v[104:107], a[184:187], v[44:47]
    buffer_load_dwordx4 v128, s[24:27], s56 offen nt lds
    v_mfma_f32_16x16x32_bf16 v[44:47], v[88:91], a[188:191], v[44:47]
    s_add_u32 m0, s67, 3072
    v_exp_f32 v85, v85
    v_mfma_f32_16x16x32_bf16 v[76:79], v[0:3], v[92:95], 0
    buffer_load_dwordx4 v127, s[24:27], s56 offen nt lds
    v_cvt_pk_bf16_f32 v20, v84, v85
    v_mfma_f32_16x16x32_bf16 v[76:79], v[164:167], v[168:171], v[76:79]
    s_waitcnt lgkmcnt(0)
    s_add_u32 m0, s67, 4096
    v_cvt_pk_bf16_f32 v30, v44, v45
    v_cvt_pk_bf16_f32 v31, v46, v47
    v_mfma_f32_16x16x32_bf16 v[44:47], v[120:123], a[192:195], 0
    s_barrier
    buffer_load_dwordx4 v126, s[24:27], s56 offen nt lds
    v_mfma_f32_16x16x32_bf16 v[44:47], v[116:119], a[196:199], v[44:47]
    v_mul_f32 v76, v76, v56
    v_mul_f32 v77, v77, v56
    v_mfma_f32_16x16x32_bf16 v[44:47], v[80:83], a[200:203], v[44:47]
    v_cvt_pk_bf16_f32 v80, v76, v77
    v_mul_f32 v78, v78, v56
    v_mfma_f32_16x16x32_bf16 v[44:47], v[108:111], a[204:207], v[44:47]
    v_exp_f32 v86, v86
    v_mfma_f32_16x16x32_bf16 v[44:47], v[104:107], a[208:211], v[44:47]
    v_exp_f32 v87, v87
    v_mfma_f32_16x16x32_bf16 v[44:47], v[88:91], a[212:215], v[44:47]
    s_nop 0
    v_mul_f32 v79, v79, v56
    v_cvt_pk_bf16_f32 v81, v78, v79
    v_mfma_f32_16x16x32_bf16 v[88:91], v[28:31], v[92:95], 0
    s_nop 0
    ds_write_b64 v137, v[80:81] offset:0
    v_mfma_f32_16x16x32_bf16 v[88:91], v[160:163], v[168:171], v[88:91]
    s_nop 0
    v_cvt_pk_bf16_f32 v10, v44, v45
    v_cvt_pk_bf16_f32 v11, v46, v47
    v_mfma_f32_16x16x32_bf16 v[76:79], v[64:67], v[0:3], 0
    s_nop 0
    v_exp_f32 v36, v36
    v_mfma_f32_16x16x32_bf16 v[76:79], v[24:27], v[164:167], v[76:79]
    s_nop 0
    v_mul_f32 v88, v88, v56
    v_mul_f32 v89, v89, v56
    v_mfma_f32_16x16x32_bf16 v[44:47], v[8:11], v[92:95], 0
    v_cvt_pk_bf16_f32 v82, v88, v89
    v_mul_f32 v90, v90, v56
    v_mfma_f32_16x16x32_bf16 v[44:47], v[156:159], v[168:171], v[44:47]
    v_mul_f32 v91, v91, v56
    v_cvt_pk_bf16_f32 v83, v90, v91
    v_mfma_f32_16x16x32_bf16 v[88:91], v[64:67], v[28:31], 0
    ds_write_b64 v137, v[82:83] offset:8
    v_mfma_f32_16x16x32_bf16 v[88:91], v[24:27], v[160:163], v[88:91]
    v_cvt_pk_bf16_f32 v168, v72, v73
    v_cvt_pk_bf16_f32 v169, v74, v75
    v_mfma_f32_16x16x32_bf16 v[80:83], v[64:67], v[8:11], 0
    ds_read_b128 v[72:75], v99 offset:49152
    v_cvt_pk_bf16_f32 v170, v49, 0
    v_mfma_f32_16x16x32_bf16 v[80:83], v[24:27], v[156:159], v[80:83]
    ds_read_b64 v[76:77], v239 offset:49216
    v_mul_f32 v44, v44, v56
    v_mfma_f32_16x16x32_bf16 v[48:51], v[220:223], v[100:103], 0
    ds_read_b128 v[64:67], v98 offset:5248
    v_mul_f32 v45, v45, v56
    v_mfma_f32_16x16x32_bf16 v[48:51], v[220:223], v[168:171], v[48:51]
    ds_read_b128 v[224:227], v99 offset:49920
    v_cvt_pk_bf16_f32 v84, v44, v45
    v_mfma_f32_16x16x32_bf16 v[24:27], v[0:3], v[100:103], 0
    ds_read_b64 v[228:229], v239 offset:49984
    v_mul_f32 v46, v46, v56
    v_mfma_f32_16x16x32_bf16 v[24:27], v[164:167], v[168:171], v[24:27]
    ds_read_b128 v[108:111], v98 offset:5312
    v_mul_f32 v47, v47, v56
    v_mfma_f32_16x16x32_bf16 v[56:59], v[28:31], v[100:103], 0
    ds_read_b128 v[92:95], v99 offset:24576
    v_cvt_pk_bf16_f32 v85, v46, v47
    v_mfma_f32_16x16x32_bf16 v[56:59], v[160:163], v[168:171], v[56:59]
    ds_write_b64 v136, v[84:85] offset:0
    v_mfma_f32_16x16x32_bf16 v[44:47], v[8:11], v[100:103], 0
    v_mov_b32_dpp v79, v91 quad_perm:[0,1,2,3] row_mask:0x2 bank_mask:0xf
    v_cvt_pk_bf16_f32 v21, v86, v87
    v_mfma_f32_16x16x32_bf16 v[44:47], v[156:159], v[168:171], v[44:47]
    s_waitcnt lgkmcnt(5)
    ds_read_b64 v[96:97], v239 offset:24640
    v_mov_b32_dpp v79, v83 quad_perm:[0,1,2,3] row_mask:0x4 bank_mask:0xf
    v_cvt_pk_bf16_f32 v79, v79, v79
    v_rcp_f32 v48, v48
    v_mfma_f32_16x16x16_bf16 v[80:83], v[72:73], v[22:23], v[64:67]
    ds_write_b16 v133, v79 offset:56
    v_mfma_f32_16x16x16_bf16 v[120:123], v[74:75], v[22:23], v[64:67]
    ds_read_b128 v[84:87], v98 offset:256
    v_mul_f32 v24, v24, v48
    v_mfma_f32_16x16x16_bf16 v[104:107], v[76:77], v[22:23], v[64:67]
    s_waitcnt lgkmcnt(5)
    s_nop 0
    ds_read_b128 v[72:75], v99 offset:25344
    v_cvt_pk_bf16_f32 v80, v80, v81
    v_mfma_f32_16x16x16_bf16 v[100:103], v[224:225], v[22:23], v[108:111]
    ds_read_b64 v[76:77], v239 offset:25408
    v_accvgpr_write_b32 a232, v80
    v_mfma_f32_16x16x16_bf16 v[88:91], v[226:227], v[22:23], v[108:111]
    ds_read_b128 v[116:119], v98 offset:320
    v_cvt_pk_bf16_f32 v82, v82, v83
    v_mfma_f32_16x16x16_bf16 v[64:67], v[228:229], v[22:23], v[108:111]
    ds_read_b128 v[78:81], v99 offset:61440
    v_accvgpr_write_b32 a233, v82
    v_cvt_pk_bf16_f32 v224, v120, v121
    v_cvt_pk_bf16_f32 v225, v122, v123
    v_cvt_pk_bf16_f32 v248, v104, v105
    v_cvt_pk_bf16_f32 v249, v106, v107
    v_cvt_pk_bf16_f32 v100, v100, v101
    v_accvgpr_write_b32 a234, v100
    v_cvt_pk_bf16_f32 v102, v102, v103
    v_accvgpr_write_b32 a235, v102
    v_cvt_pk_bf16_f32 v226, v88, v89
    v_cvt_pk_bf16_f32 v227, v90, v91
    v_cvt_pk_bf16_f32 v250, v64, v65
    v_cvt_pk_bf16_f32 v251, v66, v67
    ds_read_b64 v[82:83], v239 offset:61504
    v_mul_f32 v25, v25, v48
    s_waitcnt lgkmcnt(5)
    v_mfma_f32_16x16x16_bf16 v[228:231], v[92:93], v[22:23], v[84:87]
    ds_read_b128 v[64:67], v98 offset:5376
    v_cvt_pk_bf16_f32 v24, v24, v25
    v_mfma_f32_16x16x16_bf16 v[104:107], v[94:95], v[22:23], v[84:87]
    ds_read_b128 v[92:95], v99 offset:62208
    v_mul_f32 v26, v26, v48
    v_mfma_f32_16x16x16_bf16 v[108:111], v[96:97], v[22:23], v[84:87]
    s_waitcnt lgkmcnt(4)
    ds_read_b64 v[96:97], v239 offset:62272
    v_cvt_pk_bf16_f32 v228, v228, v229
    v_mfma_f32_16x16x16_bf16 v[88:91], v[72:73], v[22:23], v[116:119]
    ds_read_b128 v[120:123], v98 offset:5440
    v_accvgpr_write_b32 a224, v228
    v_mfma_f32_16x16x16_bf16 v[100:103], v[74:75], v[22:23], v[116:119]
    ds_read_b128 v[72:75], v99 offset:12288
    v_cvt_pk_bf16_f32 v230, v230, v231
    v_mfma_f32_16x16x16_bf16 v[84:87], v[76:77], v[22:23], v[116:119]
    ds_read_b64 v[76:77], v239 offset:12352
    v_accvgpr_write_b32 a225, v230
    v_cvt_pk_bf16_f32 v104, v104, v105
    v_accvgpr_write_b32 a248, v104
    v_cvt_pk_bf16_f32 v106, v106, v107
    v_accvgpr_write_b32 a249, v106
    v_cvt_pk_bf16_f32 v240, v108, v109
    v_cvt_pk_bf16_f32 v241, v110, v111
    v_cvt_pk_bf16_f32 v88, v88, v89
    v_accvgpr_write_b32 a226, v88
    v_cvt_pk_bf16_f32 v90, v90, v91
    v_accvgpr_write_b32 a227, v90
    v_cvt_pk_bf16_f32 v100, v100, v101
    v_accvgpr_write_b32 a250, v100
    v_cvt_pk_bf16_f32 v102, v102, v103
    s_waitcnt lgkmcnt(5)
    v_mfma_f32_16x16x16_bf16 v[228:231], v[78:79], v[22:23], v[64:67]
    ds_read_b128 v[88:91], v98 offset:128
    v_accvgpr_write_b32 a251, v102
    v_mfma_f32_16x16x16_bf16 v[116:119], v[80:81], v[22:23], v[64:67]
    ds_read_b128 v[78:81], v99 offset:13056
    v_cvt_pk_bf16_f32 v242, v84, v85
    v_mfma_f32_16x16x16_bf16 v[108:111], v[82:83], v[22:23], v[64:67]
    s_waitcnt lgkmcnt(4)
    ds_read_b64 v[82:83], v239 offset:13120
    v_cvt_pk_bf16_f32 v243, v86, v87
    v_mfma_f32_16x16x16_bf16 v[104:107], v[92:93], v[22:23], v[120:123]
    ds_read_b128 v[84:87], v98 offset:192
    v_cvt_pk_bf16_f32 v228, v228, v229
    v_mfma_f32_16x16x16_bf16 v[100:103], v[94:95], v[22:23], v[120:123]
    ds_read_b128 v[92:95], v99 offset:36864
    v_accvgpr_write_b32 a236, v228
    v_mfma_f32_16x16x16_bf16 v[64:67], v[96:97], v[22:23], v[120:123]
    ds_read_b64 v[96:97], v239 offset:36928
    v_cvt_pk_bf16_f32 v230, v230, v231
    v_accvgpr_write_b32 a237, v230
    v_cvt_pk_bf16_f32 v228, v116, v117
    v_cvt_pk_bf16_f32 v229, v118, v119
    v_cvt_pk_bf16_f32 v252, v108, v109
    v_cvt_pk_bf16_f32 v253, v110, v111
    v_cvt_pk_bf16_f32 v104, v104, v105
    v_accvgpr_write_b32 a238, v104
    v_cvt_pk_bf16_f32 v106, v106, v107
    v_accvgpr_write_b32 a239, v106
    v_cvt_pk_bf16_f32 v230, v100, v101
    v_cvt_pk_bf16_f32 v231, v102, v103
    v_cvt_pk_bf16_f32 v254, v64, v65
    v_cvt_pk_bf16_f32 v255, v66, v67
    s_waitcnt lgkmcnt(5)
    v_mfma_f32_16x16x16_bf16 v[108:111], v[72:73], v[22:23], v[88:91]
    ds_read_b128 v[64:67], v98 offset:5120
    v_mul_f32 v27, v27, v48
    v_mfma_f32_16x16x16_bf16 v[120:123], v[74:75], v[22:23], v[88:91]
    ds_read_b128 v[72:75], v99 offset:37632
    v_cvt_pk_bf16_f32 v25, v26, v27
    v_mfma_f32_16x16x16_bf16 v[116:119], v[76:77], v[22:23], v[88:91]
    s_waitcnt lgkmcnt(4)
    ds_read_b64 v[76:77], v239 offset:37696
    v_cvt_pk_bf16_f32 v108, v108, v109
    v_mfma_f32_16x16x16_bf16 v[100:103], v[78:79], v[22:23], v[84:87]
    ds_read_b128 v[232:235], v98 offset:5184
    v_accvgpr_write_b32 a220, v108
    v_mfma_f32_16x16x16_bf16 v[88:91], v[80:81], v[22:23], v[84:87]
    ds_read_b128 v[104:107], v99 offset:0
    v_cvt_pk_bf16_f32 v110, v110, v111
    v_mfma_f32_16x16x16_bf16 v[78:81], v[82:83], v[22:23], v[84:87]
    ds_read_b64 v[108:109], v239 offset:64
    v_accvgpr_write_b32 a221, v110
    v_cvt_pk_bf16_f32 v120, v120, v121
    v_accvgpr_write_b32 a244, v120
    v_cvt_pk_bf16_f32 v122, v122, v123
    v_accvgpr_write_b32 a245, v122
    v_cvt_pk_bf16_f32 v236, v116, v117
    v_cvt_pk_bf16_f32 v237, v118, v119
    v_cvt_pk_bf16_f32 v100, v100, v101
    v_accvgpr_write_b32 a222, v100
    v_cvt_pk_bf16_f32 v102, v102, v103
    v_accvgpr_write_b32 a223, v102
    v_cvt_pk_bf16_f32 v88, v88, v89
    v_accvgpr_write_b32 a246, v88
    v_cvt_pk_bf16_f32 v90, v90, v91
    s_waitcnt lgkmcnt(5)
    v_mfma_f32_16x16x16_bf16 v[120:123], v[92:93], v[22:23], v[64:67]
    ds_read_b128 v[100:103], v98 offset:0
    v_accvgpr_write_b32 a247, v90
    v_mfma_f32_16x16x16_bf16 v[116:119], v[94:95], v[22:23], v[64:67]
    ds_read_b128 v[92:95], v99 offset:768
    v_cvt_pk_bf16_f32 v238, v78, v79
    v_mfma_f32_16x16x16_bf16 v[88:91], v[96:97], v[22:23], v[64:67]
    s_waitcnt lgkmcnt(4)
    ds_read_b64 v[96:97], v239 offset:832
    v_cvt_pk_bf16_f32 v239, v80, v81
    v_mfma_f32_16x16x16_bf16 v[80:83], v[72:73], v[22:23], v[232:235]
    ds_read_b128 v[84:87], v98 offset:64
    v_cvt_pk_bf16_f32 v120, v120, v121
    v_mfma_f32_16x16x16_bf16 v[64:67], v[74:75], v[22:23], v[232:235]
    ds_write_b64 v137, v[24:25] offset:1536
    v_mfma_f32_16x16x16_bf16 v[24:27], v[76:77], v[22:23], v[232:235]
    v_accvgpr_write_b32 a228, v120
    v_cvt_pk_bf16_f32 v122, v122, v123
    v_accvgpr_write_b32 a229, v122
    v_cvt_pk_bf16_f32 v116, v116, v117
    v_accvgpr_write_b32 a252, v116
    v_cvt_pk_bf16_f32 v118, v118, v119
    v_accvgpr_write_b32 a253, v118
    v_cvt_pk_bf16_f32 v244, v88, v89
    v_cvt_pk_bf16_f32 v245, v90, v91
    v_cvt_pk_bf16_f32 v80, v80, v81
    v_accvgpr_write_b32 a230, v80
    v_cvt_pk_bf16_f32 v82, v82, v83
    v_accvgpr_write_b32 a231, v82
    v_cvt_pk_bf16_f32 v64, v64, v65
    s_waitcnt lgkmcnt(4)
    v_mfma_f32_16x16x16_bf16 v[88:91], v[104:105], v[22:23], v[100:103]
    v_accvgpr_write_b32 a254, v64
    v_cvt_pk_bf16_f32 v66, v66, v67
    v_mfma_f32_16x16x16_bf16 v[80:83], v[106:107], v[22:23], v[100:103]
    s_waitcnt vmcnt(5) lgkmcnt(2)
    v_accvgpr_write_b32 a255, v66
    v_cvt_pk_bf16_f32 v246, v24, v25
    v_mfma_f32_16x16x16_bf16 v[76:79], v[108:109], v[22:23], v[100:103]
    s_waitcnt lgkmcnt(1)
    s_barrier
    ds_write_b128 v247, v[112:115] offset:6144
    v_mfma_f32_16x16x16_bf16 v[72:75], v[92:93], v[22:23], v[84:87]
    v_cvt_pk_bf16_f32 v247, v26, v27
    v_cvt_pk_bf16_f32 v88, v88, v89
    v_mfma_f32_16x16x16_bf16 v[64:67], v[94:95], v[22:23], v[84:87]
    v_accvgpr_write_b32 a216, v88
    v_cvt_pk_bf16_f32 v90, v90, v91
    v_mfma_f32_16x16x16_bf16 v[24:27], v[96:97], v[22:23], v[84:87]
    ds_write_b128 v16, v[216:219] offset:80
    v_accvgpr_write_b32 a217, v90
    v_cvt_pk_bf16_f32 v80, v80, v81
    v_accvgpr_write_b32 a240, v80
    v_cvt_pk_bf16_f32 v82, v82, v83
    v_accvgpr_write_b32 a241, v82
    v_cvt_pk_bf16_f32 v232, v76, v77
    v_cvt_pk_bf16_f32 v233, v78, v79
    v_cvt_pk_bf16_f32 v72, v72, v73
    ds_write_b128 v16, v[68:71] offset:0
    v_accvgpr_write_b32 a218, v72
    v_cvt_pk_bf16_f32 v74, v74, v75
    v_accvgpr_write_b32 a219, v74
    v_cvt_pk_bf16_f32 v64, v64, v65
    v_accvgpr_write_b32 a242, v64
    v_cvt_pk_bf16_f32 v66, v66, v67
    v_accvgpr_write_b32 a243, v66
    v_cvt_pk_bf16_f32 v234, v24, v25
    ds_write_b128 v16, v[60:63] offset:16
    v_cvt_pk_bf16_f32 v235, v26, v27
    v_mul_f32 v56, v56, v48
    v_mul_f32 v57, v57, v48
    v_cvt_pk_bf16_f32 v26, v56, v57
    v_mul_f32 v58, v58, v48
    v_mul_f32 v59, v59, v48
    v_cvt_pk_bf16_f32 v27, v58, v59
    v_mul_f32 v44, v44, v48
    ds_write_b128 v16, v[52:55] offset:32
    v_mul_f32 v45, v45, v48
    v_cvt_pk_bf16_f32 v142, v44, v45
    v_mul_f32 v46, v46, v48
    v_mul_f32 v47, v47, v48
    v_cvt_pk_bf16_f32 v143, v46, v47
    v_exp_f32 v37, v37
    v_exp_f32 v38, v38
    ds_write_b128 v16, v[40:43] offset:48
    v_exp_f32 v39, v39
    v_cvt_pk_bf16_f32 v22, v36, v37
    v_cvt_pk_bf16_f32 v23, v38, v39
    v_exp_f32 v12, v12
    v_exp_f32 v13, v13
    ds_write_b128 v16, v[32:35] offset:64
    v_exp_f32 v14, v14
    v_exp_f32 v15, v15
    v_cvt_pk_bf16_f32 v168, v12, v13
    v_cvt_pk_bf16_f32 v169, v14, v15
    v_exp_f32 v6, v6
    ds_read_b128 v[12:15], v139 offset:0
    v_cvt_pk_bf16_f32 v170, v6, 0
    v_mfma_f32_16x16x32_bf16 v[4:7], v[220:223], v[20:23], 0
    ds_read_b128 v[104:107], v138 offset:0
    v_mfma_f32_16x16x32_bf16 v[4:7], v[220:223], v[168:171], v[4:7]
    ds_read_b128 v[84:87], v139 offset:128
    v_mfma_f32_16x16x32_bf16 v[16:19], v[0:3], v[20:23], 0
    ds_read_b128 v[100:103], v138 offset:128
    v_mfma_f32_16x16x32_bf16 v[16:19], v[164:167], v[168:171], v[16:19]
    ds_read_b128 v[96:99], v139 offset:256
    v_mfma_f32_16x16x32_bf16 v[0:3], v[28:31], v[20:23], 0
    ds_read_b128 v[72:75], v138 offset:256
    v_mfma_f32_16x16x32_bf16 v[0:3], v[160:163], v[168:171], v[0:3]
    ds_write_b64 v137, v[26:27] offset:1544
    v_mfma_f32_16x16x32_bf16 v[28:31], v[8:11], v[20:23], 0
    v_mfma_f32_16x16x32_bf16 v[28:31], v[156:159], v[168:171], v[28:31]
    s_waitcnt lgkmcnt(6)
    ds_write_b64 v136, v[142:143] offset:1536
    v_mfma_f32_16x16x32_bf16 v[24:27], a[0:3], v[12:15], 0
    s_waitcnt lgkmcnt(0)
.p2align 6
L_loopF0:
    v_mfma_f32_16x16x32_bf16 v[24:27], a[4:7], v[104:107], v[24:27]
    v_rcp_f32 v4, v4
    v_mfma_f32_16x16x32_bf16 v[24:27], a[8:11], v[84:87], v[24:27]
    v_mul_f32 v16, v16, v4
    v_mul_f32 v17, v17, v4
    v_mfma_f32_16x16x32_bf16 v[24:27], a[12:15], v[100:103], v[24:27]
    v_cvt_pk_bf16_f32 v32, v16, v17
    v_mul_f32 v18, v18, v4
    v_mfma_f32_16x16x32_bf16 v[24:27], a[16:19], v[96:99], v[24:27]
    v_mul_f32 v19, v19, v4
    v_cvt_pk_bf16_f32 v33, v18, v19
    v_mfma_f32_16x16x32_bf16 v[24:27], a[20:23], v[72:75], v[24:27]
    ds_write_b64 v137, v[32:33] offset:3072
    v_mfma_f32_16x16x32_bf16 v[154:157], a[24:27], v[12:15], 0
    v_mul_f32 v0, v0, v4
    v_mul_f32 v1, v1, v4
    v_mfma_f32_16x16x32_bf16 v[154:157], a[28:31], v[104:107], v[154:157]
    v_cvt_pk_bf16_f32 v34, v0, v1
    v_mul_f32 v2, v2, v4
    v_mfma_f32_16x16x32_bf16 v[154:157], a[32:35], v[84:87], v[154:157]
    v_mul_f32 v3, v3, v4
    v_cvt_pk_bf16_f32 v35, v2, v3
    v_mfma_f32_16x16x32_bf16 v[154:157], a[36:39], v[100:103], v[154:157]
    ds_write_b64 v137, v[34:35] offset:3080
    v_mfma_f32_16x16x32_bf16 v[154:157], a[40:43], v[96:99], v[154:157]
    v_mul_f32 v28, v28, v4
    v_mul_f32 v29, v29, v4
    v_mfma_f32_16x16x32_bf16 v[154:157], a[44:47], v[72:75], v[154:157]
    v_cvt_pk_bf16_f32 v28, v28, v29
    v_mul_f32 v30, v30, v4
    v_mfma_f32_16x16x32_bf16 v[0:3], a[48:51], v[12:15], 0
    v_mul_f32 v31, v31, v4
    v_cvt_pk_bf16_f32 v29, v30, v31
    v_mfma_f32_16x16x32_bf16 v[0:3], a[52:55], v[104:107], v[0:3]
    ds_write_b64 v136, v[28:29] offset:3072
    v_mfma_f32_16x16x32_bf16 v[0:3], a[56:59], v[84:87], v[0:3]
    v_fmac_f32 v142, v46, v46
    v_fmac_f32 v142, v47, v47
    v_mfma_f32_16x16x32_bf16 v[0:3], a[60:63], v[100:103], v[0:3]
    v_fma_f32 v150, v48, v48, s42
    v_fmac_f32 v150, v49, v49
    v_mfma_f32_16x16x32_bf16 v[0:3], a[64:67], v[96:99], v[0:3]
    v_fmac_f32 v150, v50, v50
    v_fmac_f32 v150, v51, v51
    v_mfma_f32_16x16x32_bf16 v[0:3], a[68:71], v[72:75], v[0:3]
    v_fmac_f32 v150, v52, v52
    v_fmac_f32 v150, v53, v53
    v_mfma_f32_16x16x32_bf16 v[4:7], a[72:75], v[12:15], 0
    v_fmac_f32 v150, v54, v54
    v_fmac_f32 v150, v55, v55
    v_mfma_f32_16x16x32_bf16 v[4:7], a[76:79], v[104:107], v[4:7]
    v_fmac_f32 v150, v88, v88
    v_fmac_f32 v150, v89, v89
    v_mfma_f32_16x16x32_bf16 v[4:7], a[80:83], v[84:87], v[4:7]
    v_fmac_f32 v150, v90, v90
    v_fmac_f32 v150, v91, v91
    v_mfma_f32_16x16x32_bf16 v[4:7], a[84:87], v[100:103], v[4:7]
    v_fma_f32 v151, v108, v108, s42
    v_fmac_f32 v151, v109, v109
    v_mfma_f32_16x16x32_bf16 v[4:7], a[88:91], v[96:99], v[4:7]
    v_fmac_f32 v151, v110, v110
    v_fmac_f32 v151, v111, v111
    v_mfma_f32_16x16x32_bf16 v[4:7], a[92:95], v[72:75], v[4:7]
    v_fmac_f32 v151, v8, v8
    v_fmac_f32 v151, v9, v9
    v_mfma_f32_16x16x32_bf16 v[28:31], a[96:99], v[12:15], 0
    v_fmac_f32 v151, v10, v10
    v_fmac_f32 v151, v11, v11
    v_mfma_f32_16x16x32_bf16 v[28:31], a[100:103], v[104:107], v[28:31]
    s_waitcnt vmcnt(10)
    v_fmac_f32 v151, v112, v112
    v_fmac_f32 v151, v113, v113
    v_mfma_f32_16x16x32_bf16 v[28:31], a[104:107], v[84:87], v[28:31]
    v_fmac_f32 v151, v114, v114
    v_fmac_f32 v151, v115, v115
    v_mfma_f32_16x16x32_bf16 v[28:31], a[108:111], v[100:103], v[28:31]
    v_cvt_pk_bf16_f32 v150, v142, v150
    v_cvt_pk_bf16_f32 v151, v151, v124
    v_mfma_f32_16x16x32_bf16 v[28:31], a[112:115], v[96:99], v[28:31]
    ds_write_b64 v132, v[150:151]
    v_mfma_f32_16x16x32_bf16 v[28:31], a[116:119], v[72:75], v[28:31]
    v_add_u32 v137, s49, v137
    v_add_u32 v136, s49, v136
    v_mfma_f32_16x16x32_bf16 v[32:35], a[120:123], v[12:15], 0
    v_cvt_pk_f16_f32 v92, v24, v25
    v_cvt_pk_f16_f32 v93, v26, v27
    v_mfma_f32_16x16x32_bf16 v[32:35], a[124:127], v[104:107], v[32:35]
    v_pk_fma_f16 v20, v92, v92, s39
    v_pk_fmac_f16 v20, v93, v93
    v_mfma_f32_16x16x32_bf16 v[32:35], a[128:131], v[84:87], v[32:35]
    v_cvt_pk_f16_f32 v94, v154, v155
    v_cvt_pk_f16_f32 v95, v156, v157
    v_mfma_f32_16x16x32_bf16 v[32:35], a[132:135], v[100:103], v[32:35]
    v_pk_fmac_f16 v20, v94, v94
    v_pk_fmac_f16 v20, v95, v95
    v_mfma_f32_16x16x32_bf16 v[32:35], a[136:139], v[96:99], v[32:35]
    v_cvt_pk_f16_f32 v154, v0, v1
    v_cvt_pk_f16_f32 v155, v2, v3
    v_mfma_f32_16x16x32_bf16 v[32:35], a[140:143], v[72:75], v[32:35]
    v_pk_fmac_f16 v20, v154, v154
    v_pk_fmac_f16 v20, v155, v155
    v_mfma_f32_16x16x32_bf16 v[60:63], v[12:15], a[144:147], 0
    s_waitcnt lgkmcnt(0)
    v_cvt_pk_f16_f32 v0, v4, v5
    v_cvt_pk_f16_f32 v1, v6, v7
    v_mfma_f32_16x16x32_bf16 v[60:63], v[104:107], a[148:151], v[60:63]
    s_barrier
    ds_read_b128 v[64:67], v131 offset:0
    v_pk_fma_f16 v21, v0, v0, s39
    v_mfma_f32_16x16x32_bf16 v[60:63], v[84:87], a[152:155], v[60:63]
    ds_read_b128 v[80:83], v131 offset:1024
    v_pk_fmac_f16 v21, v1, v1
    v_mfma_f32_16x16x32_bf16 v[60:63], v[100:103], a[156:159], v[60:63]
    ds_read_b128 v[68:71], v139 offset:1536
    v_cvt_pk_f16_f32 v2, v28, v29
    v_mfma_f32_16x16x32_bf16 v[60:63], v[96:99], a[160:163], v[60:63]
    ds_read_b128 v[116:119], v138 offset:1536
    v_cvt_pk_f16_f32 v3, v30, v31
    v_mfma_f32_16x16x32_bf16 v[60:63], v[72:75], a[164:167], v[60:63]
    ds_read_b128 v[120:123], v139 offset:1664
    v_pk_fmac_f16 v21, v2, v2
    v_mfma_f32_16x16x32_bf16 v[24:27], v[12:15], a[168:171], 0
    ds_read_b128 v[56:59], v138 offset:1664
    v_pk_fmac_f16 v21, v3, v3
    v_mfma_f32_16x16x32_bf16 v[24:27], v[104:107], a[172:175], v[24:27]
    ds_read_b128 v[16:19], v139 offset:1792
    v_cvt_pk_f16_f32 v4, v32, v33
    v_mfma_f32_16x16x32_bf16 v[24:27], v[84:87], a[176:179], v[24:27]
    ds_read_b128 v[76:79], v138 offset:1792
    v_cvt_pk_f16_f32 v5, v34, v35
    v_mfma_f32_16x16x32_bf16 v[24:27], v[100:103], a[180:183], v[24:27]
    v_pk_fmac_f16 v21, v4, v4
    v_pk_fmac_f16 v21, v5, v5
    v_mfma_f32_16x16x32_bf16 v[24:27], v[96:99], a[184:187], v[24:27]
    s_waitcnt lgkmcnt(7)
    v_readfirstlane_b32 s12, v65
    v_cvt_pk_bf16_f32 v28, v60, v61
    v_mfma_f32_16x16x32_bf16 v[24:27], v[72:75], a[188:191], v[24:27]
    s_lshr_b32 s12, s12, 23
    v_cvt_pk_bf16_f32 v29, v62, v63
    v_mfma_f32_16x16x32_bf16 v[60:63], v[216:219], v[64:67], 0
    s_waitcnt lgkmcnt(5)
    s_nop 1
    v_mfma_f32_16x16x32_bf16 v[60:63], v[216:219], v[80:83], v[60:63]
    s_nop 0
    v_cvt_pk_bf16_f32 v24, v24, v25
    v_cvt_pk_bf16_f32 v25, v26, v27
    v_mfma_f32_16x16x32_bf16 v[32:35], v[12:15], a[192:195], 0
    s_nop 1
    v_mfma_f32_16x16x32_bf16 v[32:35], v[104:107], a[196:199], v[32:35]
    s_nop 0
    v_rsq_f32 v60, v60
    v_mfma_f32_16x16x32_bf16 v[32:35], v[84:87], a[200:203], v[32:35]
    v_rsq_f32 v61, v61
    v_mfma_f32_16x16x32_bf16 v[32:35], v[100:103], a[204:207], v[32:35]
    v_rsq_f32 v62, v62
    v_mfma_f32_16x16x32_bf16 v[32:35], v[96:99], a[208:211], v[32:35]
    v_mul_f32 v60, s43, v60
    v_mul_f32 v61, s43, v61
    v_mfma_f32_16x16x32_bf16 v[32:35], v[72:75], a[212:215], v[32:35]
    v_mul_f32 v62, s43, v62
    v_mul_f32 v40, v40, v60
    v_mfma_f32_16x16x32_bf16 v[12:15], a[0:3], v[68:71], 0
    s_waitcnt lgkmcnt(0)
    v_mul_f32 v41, v41, v60
    v_cvt_pk_bf16_f32 v40, v40, v41
    v_mfma_f32_16x16x32_bf16 v[12:15], a[4:7], v[116:119], v[12:15]
    v_mul_f32 v42, v42, v60
    v_mul_f32 v43, v43, v60
    v_mfma_f32_16x16x32_bf16 v[12:15], a[8:11], v[120:123], v[12:15]
    v_cvt_pk_bf16_f32 v41, v42, v43
    v_mul_f32 v36, v36, v60
    v_mfma_f32_16x16x32_bf16 v[12:15], a[12:15], v[56:59], v[12:15]
    ds_write_b64 v137, v[40:41] offset:0
    v_mfma_f32_16x16x32_bf16 v[12:15], a[16:19], v[16:19], v[12:15]
    v_mul_f32 v37, v37, v60
    v_cvt_pk_bf16_f32 v42, v36, v37
    v_mfma_f32_16x16x32_bf16 v[12:15], a[20:23], v[76:79], v[12:15]
    v_mul_f32 v38, v38, v60
    v_mul_f32 v39, v39, v60
    v_mfma_f32_16x16x32_bf16 v[72:75], a[24:27], v[68:71], 0
    v_cvt_pk_bf16_f32 v43, v38, v39
    v_mul_f32 v44, v44, v60
    v_mfma_f32_16x16x32_bf16 v[72:75], a[28:31], v[116:119], v[72:75]
    ds_write_b64 v137, v[42:43] offset:8
    v_mfma_f32_16x16x32_bf16 v[72:75], a[32:35], v[120:123], v[72:75]
    v_mul_f32 v45, v45, v60
    v_cvt_pk_bf16_f32 v22, v44, v45
    v_mfma_f32_16x16x32_bf16 v[72:75], a[36:39], v[56:59], v[72:75]
    v_mul_f32 v46, v46, v60
    v_mul_f32 v47, v47, v60
    v_mfma_f32_16x16x32_bf16 v[72:75], a[40:43], v[16:19], v[72:75]
    v_cvt_pk_bf16_f32 v23, v46, v47
    v_cvt_pk_bf16_f32 v32, v32, v33
    v_mfma_f32_16x16x32_bf16 v[72:75], a[44:47], v[76:79], v[72:75]
    ds_write_b64 v136, v[22:23] offset:0
    v_mfma_f32_16x16x32_bf16 v[40:43], a[48:51], v[68:71], 0
    v_cvt_pk_bf16_f32 v33, v34, v35
    v_cvt_pk_f16_f32 v104, v12, v13
    v_mfma_f32_16x16x32_bf16 v[40:43], a[52:55], v[116:119], v[40:43]
    v_cvt_pk_f16_f32 v105, v14, v15
    v_pk_fma_f16 v22, v104, v104, s39
    v_mfma_f32_16x16x32_bf16 v[40:43], a[56:59], v[120:123], v[40:43]
    v_pk_fmac_f16 v22, v105, v105
    v_mul_f32 v48, v48, v61
    v_mfma_f32_16x16x32_bf16 v[40:43], a[60:63], v[56:59], v[40:43]
    v_mul_f32 v49, v49, v61
    v_cvt_pk_bf16_f32 v12, v48, v49
    v_mfma_f32_16x16x32_bf16 v[40:43], a[64:67], v[16:19], v[40:43]
    v_mul_f32 v50, v50, v61
    v_mul_f32 v51, v51, v61
    v_mfma_f32_16x16x32_bf16 v[40:43], a[68:71], v[76:79], v[40:43]
    v_cvt_pk_bf16_f32 v13, v50, v51
    v_mul_f32 v52, v52, v61
    v_mfma_f32_16x16x32_bf16 v[34:37], a[72:75], v[68:71], 0
    ds_write_b64 v137, v[12:13] offset:1536
    v_mfma_f32_16x16x32_bf16 v[34:37], a[76:79], v[116:119], v[34:37]
    v_mul_f32 v53, v53, v61
    v_cvt_pk_bf16_f32 v14, v52, v53
    v_mfma_f32_16x16x32_bf16 v[34:37], a[80:83], v[120:123], v[34:37]
    v_mul_f32 v54, v54, v61
    v_mul_f32 v55, v55, v61
    v_mfma_f32_16x16x32_bf16 v[34:37], a[84:87], v[56:59], v[34:37]
    v_cvt_pk_bf16_f32 v15, v54, v55
    v_mul_f32 v88, v88, v61
    v_mfma_f32_16x16x32_bf16 v[34:37], a[88:91], v[16:19], v[34:37]
    ds_write_b64 v137, v[14:15] offset:1544
    v_mfma_f32_16x16x32_bf16 v[34:37], a[92:95], v[76:79], v[34:37]
    v_mul_f32 v89, v89, v61
    v_cvt_pk_bf16_f32 v150, v88, v89
    v_mfma_f32_16x16x32_bf16 v[12:15], a[96:99], v[68:71], 0
    v_mul_f32 v90, v90, v61
    v_mul_f32 v91, v91, v61
    v_mfma_f32_16x16x32_bf16 v[12:15], a[100:103], v[116:119], v[12:15]
    v_cvt_pk_bf16_f32 v151, v90, v91
    v_cvt_pk_f16_f32 v106, v72, v73
    v_mfma_f32_16x16x32_bf16 v[12:15], a[104:107], v[120:123], v[12:15]
    ds_write_b64 v136, v[150:151] offset:1536
    v_mfma_f32_16x16x32_bf16 v[12:15], a[108:111], v[56:59], v[12:15]
    v_cvt_pk_f16_f32 v107, v74, v75
    v_pk_fmac_f16 v22, v106, v106
    v_mfma_f32_16x16x32_bf16 v[12:15], a[112:115], v[16:19], v[12:15]
    v_pk_fmac_f16 v22, v107, v107
    v_cvt_pk_f16_f32 v150, v40, v41
    v_mfma_f32_16x16x32_bf16 v[12:15], a[116:119], v[76:79], v[12:15]
    s_sub_u32 s50, s45, s44
    v_cvt_pk_f16_f32 v151, v42, v43
    v_pk_fmac_f16 v22, v150, v150
    v_mfma_f32_16x16x32_bf16 v[40:43], a[120:123], v[68:71], 0
    s_sub_u32 s51, s46, s47
    v_pk_fmac_f16 v22, v151, v151
    v_cvt_pk_f16_f32 v6, v34, v35
    v_mfma_f32_16x16x32_bf16 v[40:43], a[124:127], v[116:119], v[40:43]
    s_mov_b32 s60, s59
    v_cvt_pk_f16_f32 v7, v36, v37
    v_pk_fma_f16 v23, v6, v6, s39
    v_mfma_f32_16x16x32_bf16 v[40:43], a[128:131], v[120:123], v[40:43]
    s_mov_b32 s59, s58
    v_pk_fmac_f16 v23, v7, v7
    v_mul_f32 v108, v108, v62
    v_mfma_f32_16x16x32_bf16 v[40:43], a[132:135], v[56:59], v[40:43]
    s_mov_b32 s58, s57
    v_mul_f32 v109, v109, v62
    v_cvt_pk_bf16_f32 v34, v108, v109
    v_mfma_f32_16x16x32_bf16 v[40:43], a[136:139], v[16:19], v[40:43]
    s_mov_b32 s57, s56
    v_mul_f32 v110, v110, v62
    v_mul_f32 v111, v111, v62
    v_mfma_f32_16x16x32_bf16 v[40:43], a[140:143], v[76:79], v[40:43]
    s_mov_b32 s7, s6
    v_cvt_pk_bf16_f32 v35, v110, v111
    v_mul_f32 v8, v8, v62
    v_mfma_f32_16x16x32_bf16 v[44:47], v[68:71], a[144:147], 0
    s_mov_b32 s6, s5
    ds_write_b64 v137, v[34:35] offset:3072
    v_mfma_f32_16x16x32_bf16 v[44:47], v[116:119], a[148:151], v[44:47]
    s_mov_b32 s5, s4
    v_mul_f32 v9, v9, v62
    v_cvt_pk_bf16_f32 v36, v8, v9
    v_mfma_f32_16x16x32_bf16 v[44:47], v[120:123], a[152:155], v[44:47]
    s_sub_u32 s14, s6, s7
    ds_read_b128 v[72:75], v139 offset:3072
    v_mul_f32 v10, v10, v62
    v_mfma_f32_16x16x32_bf16 v[44:47], v[56:59], a[156:159], v[44:47]
    s_add_u32 s61, s61, 1
    ds_read_b128 v[64:67], v138 offset:3072
    v_mul_f32 v11, v11, v62
    v_mfma_f32_16x16x32_bf16 v[44:47], v[16:19], a[160:163], v[44:47]
    s_add_u32 s12, s12, 20
    ds_read_b128 v[80:83], v139 offset:3200
    v_cvt_pk_bf16_f32 v37, v10, v11
    v_mfma_f32_16x16x32_bf16 v[44:47], v[76:79], a[164:167], v[44:47]
    s_max_u32 s12, s12, s61
    ds_write_b64 v137, v[36:37] offset:3080
    v_mfma_f32_16x16x32_bf16 v[34:37], v[68:71], a[168:171], 0
    s_cmp_lt_u32 s61, s71
    v_mul_f32 v112, v112, v62
    v_mul_f32 v113, v113, v62
    v_mfma_f32_16x16x32_bf16 v[34:37], v[116:119], a[172:175], v[34:37]
    s_cselect_b32 s15, s61, s12
    ds_read_b128 v[48:51], v138 offset:3200
    v_cvt_pk_bf16_f32 v30, v112, v113
    v_mfma_f32_16x16x32_bf16 v[34:37], v[120:123], a[176:179], v[34:37]
    s_cselect_b32 s56, s69, s70
    ds_read_b128 v[88:91], v139 offset:3328
    v_mul_f32 v114, v114, v62
    v_mfma_f32_16x16x32_bf16 v[34:37], v[56:59], a[180:183], v[34:37]
    s_add_u32 s56, s56, s15
    ds_read_b128 v[108:111], v138 offset:3328
    v_mul_f32 v115, v115, v62
    v_mfma_f32_16x16x32_bf16 v[34:37], v[16:19], a[184:187], v[34:37]
    s_mul_i32 s53, s56, 58255
    v_cvt_pk_bf16_f32 v31, v114, v115
    v_cvt_pk_f16_f32 v8, v12, v13
    v_mfma_f32_16x16x32_bf16 v[34:37], v[76:79], a[188:191], v[34:37]
    s_lshr_b32 s53, s53, 22
    ds_write_b64 v136, v[30:31] offset:3072
    v_mfma_f32_16x16x32_bf16 v[60:63], v[68:71], a[192:195], 0
    s_waitcnt vmcnt(0)
    v_cvt_pk_f16_f32 v9, v14, v15
    v_pk_fmac_f16 v23, v8, v8
    v_mfma_f32_16x16x32_bf16 v[60:63], v[116:119], a[196:199], v[60:63]
    s_mul_i32 s53, s53, s63
    v_pk_fmac_f16 v23, v9, v9
    v_cvt_pk_f16_f32 v10, v40, v41
    v_mfma_f32_16x16x32_bf16 v[60:63], v[120:123], a[200:203], v[60:63]
    s_mul_i32 s56, s56, s62
    v_cvt_pk_f16_f32 v11, v42, v43
    v_pk_fmac_f16 v23, v10, v10
    v_mfma_f32_16x16x32_bf16 v[60:63], v[56:59], a[204:207], v[60:63]
    s_add_u32 s56, s56, s53
    v_pk_fmac_f16 v23, v11, v11
    v_cvt_pk_bf16_f32 v30, v44, v45
    v_mfma_f32_16x16x32_bf16 v[60:63], v[16:19], a[208:211], v[60:63]
    s_mul_i32 s4, s15, 336
    v_cvt_pk_bf16_f32 v31, v46, v47
    v_cvt_pk_bf16_f32 v26, v34, v35
    v_mfma_f32_16x16x32_bf16 v[60:63], v[76:79], a[212:215], v[60:63]
    s_cmp_ge_u32 s15, 16
    v_cvt_pk_bf16_f32 v27, v36, v37
    v_add_u32 v139, s50, v139
    v_mfma_f32_16x16x32_f16 v[56:59], v[212:215], v[20:23], 0
    s_waitcnt lgkmcnt(1)
    s_cselect_b32 s53, -26880, 0
    v_add_u32 v138, s50, v138
    v_add_u32 v137, s48, v137
    v_mfma_f32_16x16x32_bf16 v[12:15], a[0:3], v[72:75], 0
    s_waitcnt lgkmcnt(0)
    s_add_u32 s4, s4, s53
    v_cvt_pk_bf16_f32 v34, v60, v61
    v_cvt_pk_bf16_f32 v35, v62, v63
    v_mfma_f32_16x16x32_bf16 v[12:15], a[4:7], v[64:67], v[12:15]
    s_barrier
    v_or3_b32 v125, v125, v56, v57
    v_or3_b32 v125, v125, v58, v59
    v_mfma_f32_16x16x32_bf16 v[12:15], a[8:11], v[80:83], v[12:15]
    s_cmp_lt_u32 s15, s73
    v_rsq_f32 v56, v56
    v_mfma_f32_16x16x32_bf16 v[12:15], a[12:15], v[48:51], v[12:15]
    s_cselect_b32 s26, 100270464, 0
    v_rsq_f32 v57, v57
    v_mfma_f32_16x16x32_bf16 v[12:15], a[16:19], v[88:91], v[12:15]
    s_cselect_b32 s56, s56, 0
    v_mul_f32 v56, s52, v56
    v_cvt_pk_f16_f32 v56, v56, v57
    v_mfma_f32_16x16x32_bf16 v[12:15], a[20:23], v[108:111], v[12:15]
    s_cselect_b32 s4, s4, -1
    v_rsq_f32 v58, v58
    v_mfma_f32_16x16x32_bf16 v[16:19], a[24:27], v[72:75], 0
    s_cselect_b32 s15, s15, 0
    v_rsq_f32 v59, v59
    v_mfma_f32_16x16x32_bf16 v[16:19], a[28:31], v[64:67], v[16:19]
    s_cselect_b32 s13, s13, -1
    v_mul_f32 v58, s52, v58
    v_cvt_pk_f16_f32 v58, v58, v59
    v_mfma_f32_16x16x32_bf16 v[16:19], a[32:35], v[80:83], v[16:19]
    s_bitset1_b32 s64, s15
    v_pk_mul_f16 v0, v0, v56 op_sel:[0,1] op_sel_hi:[1,1]
    v_pk_mul_f16 v1, v1, v56 op_sel:[0,1] op_sel_hi:[1,1]
    v_mfma_f32_16x16x32_bf16 v[16:19], a[36:39], v[48:51], v[16:19]
    s_cmp_ge_u32 s61, s13
    v_pk_mul_f16 v2, v2, v56 op_sel:[0,1] op_sel_hi:[1,1]
    v_pk_mul_f16 v3, v3, v56 op_sel:[0,1] op_sel_hi:[1,1]
    v_mfma_f32_16x16x32_bf16 v[16:19], a[40:43], v[88:91], v[16:19]
    s_cbranch_scc1 L_atomF0
L_atomrF0:
    v_mfma_f32_16x16x32_bf16 v[16:19], a[44:47], v[108:111], v[16:19]
    s_add_u32 s65, s65, 1
    v_pk_mul_f16 v4, v4, v56 op_sel:[0,1] op_sel_hi:[1,1]
    v_pk_mul_f16 v5, v5, v56 op_sel:[0,1] op_sel_hi:[1,1]
    v_mfma_f32_16x16x32_bf16 v[40:43], a[48:51], v[72:75], 0
    s_cmp_ge_i32 s65, 2
    v_pk_mul_f16 v92, v92, v56 op_sel:[0,0] op_sel_hi:[1,0]
    v_pk_mul_f16 v93, v93, v56 op_sel:[0,0] op_sel_hi:[1,0]
    v_mfma_f32_16x16x32_bf16 v[40:43], a[52:55], v[64:67], v[40:43]
    s_cselect_b32 s30, 100270464, 0
    v_pk_mul_f16 v94, v94, v56 op_sel:[0,0] op_sel_hi:[1,0]
    v_pk_mul_f16 v95, v95, v56 op_sel:[0,0] op_sel_hi:[1,0]
    v_mfma_f32_16x16x32_bf16 v[40:43], a[56:59], v[80:83], v[40:43]
    s_add_u32 s67, s46, s54
    v_pk_mul_f16 v154, v154, v56 op_sel:[0,0] op_sel_hi:[1,0]
    v_pk_mul_f16 v155, v155, v56 op_sel:[0,0] op_sel_hi:[1,0]
    v_mfma_f32_16x16x32_bf16 v[40:43], a[60:63], v[48:51], v[40:43]
    s_add_u32 m0, s67, 0
    v_cvt_pk_f16_f32 v56, v12, v13
    v_cvt_pk_f16_f32 v57, v14, v15
    v_mfma_f32_16x16x32_bf16 v[40:43], a[64:67], v[88:91], v[40:43]
    v_pk_fma_f16 v20, v56, v56, s39
    v_pk_fmac_f16 v20, v57, v57
    v_mfma_f32_16x16x32_bf16 v[40:43], a[68:71], v[108:111], v[40:43]
    v_pk_mul_f16 v6, v6, v58 op_sel:[0,1] op_sel_hi:[1,1]
    v_pk_mul_f16 v7, v7, v58 op_sel:[0,1] op_sel_hi:[1,1]
    v_mfma_f32_16x16x32_bf16 v[12:15], a[72:75], v[72:75], 0
    v_pk_mul_f16 v8, v8, v58 op_sel:[0,1] op_sel_hi:[1,1]
    v_pk_mul_f16 v9, v9, v58 op_sel:[0,1] op_sel_hi:[1,1]
    v_mfma_f32_16x16x32_bf16 v[12:15], a[76:79], v[64:67], v[12:15]
    v_pk_mul_f16 v10, v10, v58 op_sel:[0,1] op_sel_hi:[1,1]
    v_pk_mul_f16 v11, v11, v58 op_sel:[0,1] op_sel_hi:[1,1]
    v_mfma_f32_16x16x32_bf16 v[12:15], a[80:83], v[80:83], v[12:15]
    v_pk_mul_f16 v104, v104, v58 op_sel:[0,0] op_sel_hi:[1,0]
    v_pk_mul_f16 v105, v105, v58 op_sel:[0,0] op_sel_hi:[1,0]
    v_mfma_f32_16x16x32_bf16 v[12:15], a[84:87], v[48:51], v[12:15]
    v_pk_mul_f16 v106, v106, v58 op_sel:[0,0] op_sel_hi:[1,0]
    v_pk_mul_f16 v107, v107, v58 op_sel:[0,0] op_sel_hi:[1,0]
    v_mfma_f32_16x16x32_bf16 v[12:15], a[88:91], v[88:91], v[12:15]
    v_pk_mul_f16 v150, v150, v58 op_sel:[0,0] op_sel_hi:[1,0]
    v_pk_mul_f16 v151, v151, v58 op_sel:[0,0] op_sel_hi:[1,0]
    v_mfma_f32_16x16x32_bf16 v[12:15], a[92:95], v[108:111], v[12:15]
    v_cvt_pk_f16_f32 v58, v16, v17
    v_cvt_pk_f16_f32 v59, v18, v19
    v_mfma_f32_16x16x32_bf16 v[16:19], a[96:99], v[72:75], 0
    v_pk_fmac_f16 v20, v58, v58
    v_pk_fmac_f16 v20, v59, v59
    v_mfma_f32_16x16x32_bf16 v[16:19], a[100:103], v[64:67], v[16:19]
    v_cvt_pk_f16_f32 v146, v40, v41
    v_cvt_pk_f16_f32 v147, v42, v43
    v_mfma_f32_16x16x32_bf16 v[16:19], a[104:107], v[80:83], v[16:19]
    v_pk_fmac_f16 v20, v146, v146
    v_pk_fmac_f16 v20, v147, v147
    v_mfma_f32_16x16x32_bf16 v[16:19], a[108:111], v[48:51], v[16:19]
    v_cvt_pk_f16_f32 v12, v12, v13
    v_cvt_pk_f16_f32 v13, v14, v15
    v_mfma_f32_16x16x32_bf16 v[16:19], a[112:115], v[88:91], v[16:19]
    v_pk_fma_f16 v21, v12, v12, s39
    v_pk_fmac_f16 v21, v13, v13
    v_mfma_f32_16x16x32_bf16 v[16:19], a[116:119], v[108:111], v[16:19]
    v_add_u32 v136, s48, v136
    v_add_u32 v135, s51, v135
    v_mfma_f32_16x16x32_bf16 v[40:43], a[120:123], v[72:75], 0
    s_nop 0
    v_add_u32 v134, s14, v134
    v_add_u32 v133, s14, v133
    v_mfma_f32_16x16x32_bf16 v[40:43], a[124:127], v[64:67], v[40:43]
    s_nop 0
    v_cvt_pk_f16_f32 v14, v16, v17
    v_cvt_pk_f16_f32 v15, v18, v19
    v_mfma_f32_16x16x32_bf16 v[40:43], a[128:131], v[80:83], v[40:43]
    v_pk_fmac_f16 v21, v14, v14
    v_pk_fmac_f16 v21, v15, v15
    v_mfma_f32_16x16x32_bf16 v[40:43], a[132:135], v[48:51], v[40:43]
    v_mfma_f32_16x16x32_bf16 v[40:43], a[136:139], v[88:91], v[40:43]
    v_mfma_f32_16x16x32_bf16 v[40:43], a[140:143], v[108:111], v[40:43]
    s_nop 0
    v_mfma_f32_16x16x32_bf16 v[36:39], v[72:75], a[144:147], 0
    s_nop 0
    ds_read_b128 v[44:47], v135 offset:0
    s_nop 0
    v_mfma_f32_16x16x32_bf16 v[36:39], v[64:67], a[148:151], v[36:39]
    s_nop 0
    ds_read_b128 v[76:79], v135 offset:1024
    v_cvt_pk_f16_f32 v16, v40, v41
    v_mfma_f32_16x16x32_bf16 v[36:39], v[80:83], a[152:155], v[36:39]
    ds_read_b128 v[60:63], v139 offset:0
    v_cvt_pk_f16_f32 v17, v42, v43
    v_mfma_f32_16x16x32_bf16 v[36:39], v[48:51], a[156:159], v[36:39]
    ds_read_b128 v[68:71], v138 offset:0
    v_pk_fmac_f16 v21, v16, v16
    v_mfma_f32_16x16x32_bf16 v[36:39], v[88:91], a[160:163], v[36:39]
    ds_read_b128 v[84:87], v139 offset:128
    v_pk_fmac_f16 v21, v17, v17
    v_mfma_f32_16x16x32_bf16 v[36:39], v[108:111], a[164:167], v[36:39]
    ds_read_b128 v[100:103], v138 offset:128
    v_mfma_f32_16x16x32_f16 v[96:99], v[212:215], v[20:23], 0
    s_nop 0
    ds_read_b128 v[52:55], v139 offset:256
    s_nop 0
    v_mfma_f32_16x16x32_bf16 v[40:43], v[72:75], a[168:171], 0
    s_nop 0
    ds_read_b128 v[112:115], v138 offset:256
    v_cvt_pk_bf16_f32 v164, v36, v37
    v_mfma_f32_16x16x32_bf16 v[40:43], v[64:67], a[172:175], v[40:43]
    ds_read_b128 v[116:119], v135 offset:2048
    v_or3_b32 v125, v125, v96, v97
    v_mfma_f32_16x16x32_bf16 v[40:43], v[80:83], a[176:179], v[40:43]
    s_waitcnt lgkmcnt(8)
    buffer_load_dwordx4 v130, s[24:27], s56 offen nt lds
    v_cvt_pk_bf16_f32 v165, v38, v39
    v_mfma_f32_16x16x32_bf16 v[40:43], v[48:51], a[180:183], v[40:43]
    v_rsq_f32 v96, v96
    v_mfma_f32_16x16x32_bf16 v[40:43], v[88:91], a[184:187], v[40:43]
    v_rsq_f32 v97, v97
    v_mfma_f32_16x16x32_bf16 v[40:43], v[108:111], a[188:191], v[40:43]
    ds_read_b128 v[18:21], v134 offset:32
    v_mul_f32 v96, s52, v96
    v_mfma_f32_16x16x32_bf16 v[36:39], v[72:75], a[192:195], 0
    ds_read_b64 v[22:23], v134 offset:48
    v_cvt_pk_f16_f32 v96, v96, v97
    v_mfma_f32_16x16x32_bf16 v[36:39], v[64:67], a[196:199], v[36:39]
    s_nop 0
    ds_read_b128 v[120:123], v135 offset:3072
    v_cvt_pk_bf16_f32 v160, v40, v41
    v_mfma_f32_16x16x32_bf16 v[36:39], v[80:83], a[200:203], v[36:39]
    v_cvt_pk_bf16_f32 v161, v42, v43
    v_pk_mul_f16 v12, v12, v96 op_sel:[0,1] op_sel_hi:[1,1]
    v_mfma_f32_16x16x32_bf16 v[36:39], v[48:51], a[204:207], v[36:39]
    buffer_store_dwordx4 v[44:47], v130, s[28:31], s60 offen sc1
    v_pk_mul_f16 v13, v13, v96 op_sel:[0,1] op_sel_hi:[1,1]
    v_pk_mul_f16 v14, v14, v96 op_sel:[0,1] op_sel_hi:[1,1]
    v_pk_mul_f16 v15, v15, v96 op_sel:[0,1] op_sel_hi:[1,1]
    v_pk_mul_f16 v16, v16, v96 op_sel:[0,1] op_sel_hi:[1,1]
    v_mfma_f32_16x16x32_bf16 v[36:39], v[88:91], a[208:211], v[36:39]
    s_add_u32 m0, s67, 1024
    v_pk_mul_f16 v17, v17, v96 op_sel:[0,1] op_sel_hi:[1,1]
    v_pk_mul_f16 v56, v56, v96 op_sel:[0,0] op_sel_hi:[1,0]
    v_mfma_f32_16x16x32_bf16 v[36:39], v[108:111], a[212:215], v[36:39]
    s_waitcnt lgkmcnt(3)
    v_pk_mul_f16 v57, v57, v96 op_sel:[0,0] op_sel_hi:[1,0]
    v_pk_mul_f16 v58, v58, v96 op_sel:[0,0] op_sel_hi:[1,0]
    v_mfma_f32_16x16x32_bf16 v[40:43], a[216:219], v[60:63], 0
    v_pk_mul_f16 v59, v59, v96 op_sel:[0,0] op_sel_hi:[1,0]
    v_pk_mul_f16 v146, v146, v96 op_sel:[0,0] op_sel_hi:[1,0]
    v_mfma_f32_16x16x32_bf16 v[40:43], a[220:223], v[68:71], v[40:43]
    buffer_load_dwordx4 v129, s[24:27], s56 offen nt lds
    v_pk_mul_f16 v147, v147, v96 op_sel:[0,0] op_sel_hi:[1,0]
    v_mfma_f32_16x16x32_bf16 v[40:43], a[224:227], v[84:87], v[40:43]
    v_cvt_pk_bf16_f32 v156, v36, v37
    v_cvt_pk_bf16_f32 v157, v38, v39
    v_mfma_f32_16x16x32_bf16 v[40:43], a[228:231], v[100:103], v[40:43]
    v_mfma_f32_16x16x32_bf16 v[40:43], a[232:235], v[52:55], v[40:43]
    v_mfma_f32_16x16x32_bf16 v[40:43], a[236:239], v[112:115], v[40:43]
    v_mfma_f32_16x16x32_bf16 v[36:39], a[240:243], v[60:63], 0
    v_mfma_f32_16x16x32_bf16 v[36:39], a[244:247], v[68:71], v[36:39]
    ds_read_u16 v166, v133 offset:56
    v_mfma_f32_16x16x32_bf16 v[36:39], a[248:251], v[84:87], v[36:39]
    buffer_store_dwordx4 v[76:79], v129, s[28:31], s60 offen sc1
    ds_read_u16 v162, v133 offset:64
    ds_read_u16 v158, v133 offset:72
    v_mfma_f32_16x16x32_bf16 v[36:39], a[252:255], v[100:103], v[36:39]
    s_add_u32 m0, s67, 2048
    ds_read_b128 v[108:111], v135 offset:4096
    v_mfma_f32_16x16x32_bf16 v[36:39], v[224:227], v[52:55], v[36:39]
    ds_read_b128 v[48:51], v134 offset:0
    v_mfma_f32_16x16x32_bf16 v[36:39], v[228:231], v[112:115], v[36:39]
    ds_read_b64 v[142:143], v134 offset:16
    buffer_load_dwordx4 v128, s[24:27], s56 offen nt lds
    v_mfma_f32_16x16x32_bf16 v[44:47], v[232:235], v[60:63], 0
    v_mfma_f32_16x16x32_bf16 v[44:47], v[236:239], v[68:71], v[44:47]
    ds_read_b128 v[72:75], v139 offset:1536
    v_mfma_f32_16x16x32_bf16 v[44:47], v[240:243], v[84:87], v[44:47]
    ds_read_b128 v[76:79], v138 offset:1536
    v_mfma_f32_16x16x32_bf16 v[44:47], v[244:247], v[100:103], v[44:47]
    ds_read_b128 v[60:63], v139 offset:1664
    v_mfma_f32_16x16x32_bf16 v[44:47], v[248:251], v[52:55], v[44:47]
    ds_read_b128 v[64:67], v138 offset:1664
    v_mfma_f32_16x16x32_bf16 v[44:47], v[252:255], v[112:115], v[44:47]
    ds_read_b128 v[80:83], v139 offset:1792
    v_mfma_f32_16x16x32_f16 v[88:91], v[0:3], v[92:95], v[204:207]
    ds_read_b128 v[68:71], v138 offset:1792
    v_mfma_f32_16x16x32_f16 v[88:91], v[2:5], v[152:155], v[88:91]
    s_add_u32 m0, s67, 3072
    buffer_store_dwordx4 v[116:119], v128, s[28:31], s60 offen sc1
    s_nop 3
    v_mfma_f32_16x16x32_f16 v[84:87], v[6:9], v[92:95], v[200:203]
    s_nop 0
    v_exp_f32 v88, v88
    v_mfma_f32_16x16x32_f16 v[84:87], v[8:11], v[152:155], v[84:87]
    v_exp_f32 v89, v89
    v_mfma_f32_16x16x32_f16 v[100:103], v[12:15], v[92:95], v[196:199]
    v_exp_f32 v90, v90
    v_mfma_f32_16x16x32_f16 v[100:103], v[14:17], v[152:155], v[100:103]
    s_waitcnt lgkmcnt(3)
    buffer_load_dwordx4 v127, s[24:27], s56 offen nt lds
    v_cvt_pk_bf16_f32 v52, v88, v89
    v_mfma_f32_16x16x32_f16 v[96:99], v[18:21], v[92:95], v[208:211]
    v_exp_f32 v91, v91
    v_mfma_f32_16x16x32_f16 v[96:99], v[20:23], v[152:155], v[96:99]
    v_exp_f32 v84, v84
    v_mfma_f32_16x16x32_f16 v[92:95], v[48:51], v[0:3], v[208:211]
    v_exp_f32 v85, v85
    v_mfma_f32_16x16x32_f16 v[92:95], v[140:143], v[2:5], v[92:95]
    v_cvt_pk_bf16_f32 v53, v90, v91
    v_cvt_pk_bf16_f32 v54, v84, v85
    v_mfma_f32_16x16x32_f16 v[88:91], v[48:51], v[6:9], v[208:211]
    v_exp_f32 v86, v86
    v_mfma_f32_16x16x32_f16 v[88:91], v[140:143], v[8:11], v[88:91]
    v_exp_f32 v87, v87
    v_mfma_f32_16x16x32_f16 v[112:115], v[48:51], v[12:15], v[208:211]
    buffer_store_dwordx4 v[120:123], v127, s[28:31], s60 offen sc1
    v_cvt_pk_bf16_f32 v55, v86, v87
    v_exp_f32 v100, v100
    v_mfma_f32_16x16x32_f16 v[112:115], v[140:143], v[14:17], v[112:115]
    s_add_u32 m0, s67, 4096
    v_exp_f32 v101, v101
    v_mfma_f32_16x16x32_bf16 v[48:51], a[216:219], v[72:75], 0
    v_exp_f32 v102, v102
    v_mfma_f32_16x16x32_bf16 v[48:51], a[220:223], v[76:79], v[48:51]
    s_mov_b32 s53, s47
    v_exp_f32 v103, v103
    v_mfma_f32_16x16x32_bf16 v[48:51], a[224:227], v[60:63], v[48:51]
    s_waitcnt lgkmcnt(0)
    s_mov_b32 s47, s46
    buffer_load_dwordx4 v126, s[24:27], s56 offen nt lds
    v_cvt_pk_bf16_f32 v168, v100, v101
    v_mfma_f32_16x16x32_bf16 v[48:51], a[228:231], v[64:67], v[48:51]
    s_mov_b32 s46, s45
    v_cvt_pk_bf16_f32 v169, v102, v103
    v_mov_b32_dpp v95, v91 quad_perm:[0,1,2,3] row_mask:0x2 bank_mask:0xf
    v_mfma_f32_16x16x32_bf16 v[48:51], a[232:235], v[80:83], v[48:51]
    s_mov_b32 s45, s44
    v_exp_f32 v96, v96
    v_mfma_f32_16x16x32_bf16 v[48:51], a[236:239], v[68:71], v[48:51]
    s_mov_b32 s44, s53
    v_cvt_pk_bf16_f32 v170, v96, 0
    v_mov_b32_dpp v95, v115 quad_perm:[0,1,2,3] row_mask:0x4 bank_mask:0xf
    v_mfma_f32_16x16x32_f16 v[84:87], v[0:3], v[104:107], v[192:195]
    s_sub_u32 s48, s44, s46
    v_exp_f32 v95, v95
    v_mfma_f32_16x16x32_f16 v[84:87], v[2:5], v[148:151], v[84:87]
    s_sub_u32 s49, s46, s45
    v_cvt_pk_bf16_f32 v95, v95, v95
    v_fma_f32 v142, v40, v40, s42
    v_mfma_f32_16x16x32_f16 v[96:99], v[6:9], v[104:107], v[188:191]
    s_cmp_lg_u32 s5, -1
    ds_write_b16 v133, v95
    v_mfma_f32_16x16x32_f16 v[96:99], v[8:11], v[148:151], v[96:99]
    buffer_store_dwordx4 v[108:111], v126, s[28:31], s60 offen sc1
    ds_read_b128 v[88:91], v134
    v_exp_f32 v84, v84
    v_fmac_f32 v142, v41, v41
    v_mfma_f32_16x16x32_f16 v[112:115], v[12:15], v[104:107], v[184:187]
    ds_read_b128 v[92:95], v134 offset:16
    v_fmac_f32 v142, v42, v42
    v_mfma_f32_16x16x32_f16 v[112:115], v[14:17], v[148:151], v[112:115]
    v_exp_f32 v85, v85
    v_mfma_f32_16x16x32_f16 v[116:119], v[18:21], v[104:107], v[208:211]
    v_exp_f32 v86, v86
    v_mfma_f32_16x16x32_f16 v[116:119], v[20:23], v[148:151], v[116:119]
    v_exp_f32 v87, v87
    v_mfma_f32_16x16x32_bf16 v[108:111], v[220:223], v[52:55], 0
    v_cvt_pk_bf16_f32 v84, v84, v85
    v_cvt_pk_bf16_f32 v85, v86, v87
    v_mfma_f32_16x16x32_bf16 v[108:111], v[220:223], v[168:171], v[108:111]
    v_exp_f32 v96, v96
    v_mfma_f32_16x16x32_bf16 v[104:107], v[28:31], v[52:55], 0
    v_exp_f32 v97, v97
    v_mfma_f32_16x16x32_bf16 v[104:107], v[164:167], v[168:171], v[104:107]
    v_exp_f32 v98, v98
    v_mfma_f32_16x16x32_bf16 v[100:103], v[24:27], v[52:55], 0
    v_exp_f32 v99, v99
    v_mfma_f32_16x16x32_bf16 v[100:103], v[160:163], v[168:171], v[100:103]
    v_cvt_pk_bf16_f32 v86, v96, v97
    v_cvt_pk_bf16_f32 v87, v98, v99
    v_mfma_f32_16x16x32_bf16 v[96:99], v[32:35], v[52:55], 0
    v_exp_f32 v112, v112
    v_mfma_f32_16x16x32_bf16 v[96:99], v[156:159], v[168:171], v[96:99]
    v_exp_f32 v113, v113
    v_mfma_f32_16x16x32_bf16 v[52:55], a[240:243], v[72:75], 0
    v_exp_f32 v114, v114
    v_mfma_f32_16x16x32_bf16 v[52:55], a[244:247], v[76:79], v[52:55]
    v_exp_f32 v115, v115
    v_mfma_f32_16x16x32_bf16 v[52:55], a[248:251], v[60:63], v[52:55]
    v_cvt_pk_bf16_f32 v168, v112, v113
    v_cvt_pk_bf16_f32 v169, v114, v115
    v_mfma_f32_16x16x32_bf16 v[52:55], a[252:255], v[64:67], v[52:55]
    v_exp_f32 v117, v117
    v_mfma_f32_16x16x32_bf16 v[52:55], v[224:227], v[80:83], v[52:55]
    v_cvt_pk_bf16_f32 v170, v117, 0
    v_fmac_f32 v142, v43, v43
    v_mfma_f32_16x16x32_bf16 v[52:55], v[228:231], v[68:71], v[52:55]
    s_waitcnt lgkmcnt(0)
    v_rcp_f32 v108, v108
    v_mfma_f32_16x16x32_bf16 v[112:115], v[88:91], v[28:31], 0
    v_mul_f32 v104, v104, v108
    v_mul_f32 v105, v105, v108
    v_mfma_f32_16x16x32_bf16 v[112:115], v[92:95], v[164:167], v[112:115]
    v_cvt_pk_bf16_f32 v104, v104, v105
    v_mul_f32 v106, v106, v108
    v_mfma_f32_16x16x32_bf16 v[116:119], v[88:91], v[24:27], 0
    v_mul_f32 v107, v107, v108
    v_cvt_pk_bf16_f32 v105, v106, v107
    v_mfma_f32_16x16x32_bf16 v[116:119], v[92:95], v[160:163], v[116:119]
    ds_write_b64 v137, v[104:105] offset:0
    v_mfma_f32_16x16x32_bf16 v[110:113], v[88:91], v[32:35], 0
    v_mul_f32 v100, v100, v108
    v_mul_f32 v101, v101, v108
    v_mfma_f32_16x16x32_bf16 v[110:113], v[92:95], v[156:159], v[110:113]
    v_cvt_pk_bf16_f32 v106, v100, v101
    v_mul_f32 v102, v102, v108
    v_mfma_f32_16x16x32_bf16 v[88:91], v[232:235], v[72:75], 0
    v_mul_f32 v103, v103, v108
    v_cvt_pk_bf16_f32 v107, v102, v103
    v_mfma_f32_16x16x32_bf16 v[88:91], v[236:239], v[76:79], v[88:91]
    ds_write_b64 v137, v[106:107] offset:8
    v_mfma_f32_16x16x32_bf16 v[88:91], v[240:243], v[60:63], v[88:91]
    v_mul_f32 v96, v96, v108
    v_mul_f32 v97, v97, v108
    v_mfma_f32_16x16x32_bf16 v[88:91], v[244:247], v[64:67], v[88:91]
    ds_read_b128 v[72:75], v139 offset:3072
    v_cvt_pk_bf16_f32 v154, v96, v97
    v_mfma_f32_16x16x32_bf16 v[88:91], v[248:251], v[80:83], v[88:91]
    ds_read_b128 v[76:79], v138 offset:3072
    v_mul_f32 v98, v98, v108
    v_mfma_f32_16x16x32_bf16 v[88:91], v[252:255], v[68:71], v[88:91]
    ds_read_b128 v[60:63], v139 offset:3200
    v_mul_f32 v99, v99, v108
    v_mfma_f32_16x16x32_f16 v[64:67], v[0:3], v[56:59], v[180:183]
    ds_read_b128 v[80:83], v138 offset:3200
    v_cvt_pk_bf16_f32 v155, v98, v99
    v_mfma_f32_16x16x32_f16 v[64:67], v[2:5], v[144:147], v[64:67]
    ds_write_b64 v136, v[154:155] offset:0
    v_mfma_f32_16x16x32_f16 v[0:3], v[6:9], v[56:59], v[176:179]
    v_mov_b32_dpp v115, v119 quad_perm:[0,1,2,3] row_mask:0x2 bank_mask:0xf
    v_fmac_f32 v142, v36, v36
    v_mfma_f32_16x16x32_f16 v[0:3], v[8:11], v[144:147], v[0:3]
    ds_read_b128 v[4:7], v139 offset:3328
    v_mov_b32_dpp v115, v113 quad_perm:[0,1,2,3] row_mask:0x4 bank_mask:0xf
    v_mfma_f32_16x16x32_f16 v[8:11], v[12:15], v[56:59], v[172:175]
    ds_read_b128 v[68:71], v138 offset:3328
    v_cvt_pk_bf16_f32 v115, v115, v115
    v_mfma_f32_16x16x32_f16 v[8:11], v[14:17], v[144:147], v[8:11]
    ds_write_b16 v133, v115 offset:56
    v_mfma_f32_16x16x32_f16 v[12:15], v[18:21], v[56:59], v[208:211]
    v_exp_f32 v64, v64
    v_mfma_f32_16x16x32_f16 v[12:15], v[20:23], v[144:147], v[12:15]
    v_exp_f32 v65, v65
    v_mfma_f32_16x16x32_bf16 v[56:59], v[220:223], v[84:87], 0
    v_exp_f32 v66, v66
    v_mfma_f32_16x16x32_bf16 v[56:59], v[220:223], v[168:171], v[56:59]
    v_exp_f32 v67, v67
    v_mfma_f32_16x16x32_bf16 v[16:19], v[28:31], v[84:87], 0
    v_cvt_pk_bf16_f32 v20, v64, v65
    v_cvt_pk_bf16_f32 v21, v66, v67
    v_mfma_f32_16x16x32_bf16 v[16:19], v[164:167], v[168:171], v[16:19]
    v_exp_f32 v0, v0
    v_mfma_f32_16x16x32_bf16 v[64:67], v[24:27], v[84:87], 0
    v_exp_f32 v1, v1
    v_mfma_f32_16x16x32_bf16 v[64:67], v[160:163], v[168:171], v[64:67]
    v_exp_f32 v2, v2
    v_mfma_f32_16x16x32_bf16 v[92:95], v[32:35], v[84:87], 0
    v_exp_f32 v3, v3
    v_mfma_f32_16x16x32_bf16 v[92:95], v[156:159], v[168:171], v[92:95]
    s_waitcnt lgkmcnt(0)
    v_cvt_pk_bf16_f32 v22, v0, v1
    v_cvt_pk_bf16_f32 v23, v2, v3
    v_mfma_f32_16x16x32_bf16 v[108:111], a[216:219], v[72:75], 0
    v_exp_f32 v8, v8
    v_mfma_f32_16x16x32_bf16 v[108:111], a[220:223], v[76:79], v[108:111]
    v_exp_f32 v9, v9
    v_mfma_f32_16x16x32_bf16 v[108:111], a[224:227], v[60:63], v[108:111]
    v_exp_f32 v10, v10
    v_mfma_f32_16x16x32_bf16 v[108:111], a[228:231], v[80:83], v[108:111]
    v_exp_f32 v11, v11
    v_mfma_f32_16x16x32_bf16 v[108:111], a[232:235], v[4:7], v[108:111]
    v_cvt_pk_bf16_f32 v168, v8, v9
    v_cvt_pk_bf16_f32 v169, v10, v11
    v_mfma_f32_16x16x32_bf16 v[108:111], a[236:239], v[68:71], v[108:111]
    v_exp_f32 v14, v14
    v_mfma_f32_16x16x32_bf16 v[8:11], a[240:243], v[72:75], 0
    v_cvt_pk_bf16_f32 v170, v14, 0
    v_add_u32 v139, s48, v139
    v_mfma_f32_16x16x32_bf16 v[8:11], a[244:247], v[76:79], v[8:11]
    ds_read_b128 v[12:15], v139 offset:0
    v_add_u32 v138, s48, v138
    v_mfma_f32_16x16x32_bf16 v[8:11], a[248:251], v[60:63], v[8:11]
    ds_read_b128 v[104:107], v138 offset:0
    v_fmac_f32 v142, v37, v37
    v_mfma_f32_16x16x32_bf16 v[8:11], a[252:255], v[80:83], v[8:11]
    ds_read_b128 v[84:87], v139 offset:128
    v_fmac_f32 v142, v38, v38
    v_mfma_f32_16x16x32_bf16 v[8:11], v[224:227], v[4:7], v[8:11]
    ds_read_b128 v[100:103], v138 offset:128
    v_fmac_f32 v142, v39, v39
    v_mfma_f32_16x16x32_bf16 v[8:11], v[228:231], v[68:71], v[8:11]
    ds_read_b128 v[96:99], v139 offset:256
    v_fmac_f32 v142, v44, v44
    v_mfma_f32_16x16x32_bf16 v[112:115], v[232:235], v[72:75], 0
    ds_read_b128 v[72:75], v138 offset:256
    v_fmac_f32 v142, v45, v45
    v_mfma_f32_16x16x32_bf16 v[112:115], v[236:239], v[76:79], v[112:115]
    v_rcp_f32 v56, v56
    v_mfma_f32_16x16x32_bf16 v[112:115], v[240:243], v[60:63], v[112:115]
    v_mul_f32 v16, v16, v56
    v_mul_f32 v17, v17, v56
    v_mfma_f32_16x16x32_bf16 v[112:115], v[244:247], v[80:83], v[112:115]
    v_cvt_pk_bf16_f32 v0, v16, v17
    v_mul_f32 v18, v18, v56
    v_mfma_f32_16x16x32_bf16 v[112:115], v[248:251], v[4:7], v[112:115]
    v_mul_f32 v19, v19, v56
    v_cvt_pk_bf16_f32 v1, v18, v19
    v_mfma_f32_16x16x32_bf16 v[112:115], v[252:255], v[68:71], v[112:115]
    ds_write_b64 v137, v[0:1] offset:1536
    v_mfma_f32_16x16x32_bf16 v[4:7], v[220:223], v[20:23], 0
    v_mul_f32 v64, v64, v56
    v_mul_f32 v65, v65, v56
    v_mfma_f32_16x16x32_bf16 v[4:7], v[220:223], v[168:171], v[4:7]
    v_cvt_pk_bf16_f32 v2, v64, v65
    v_mul_f32 v66, v66, v56
    v_mfma_f32_16x16x32_bf16 v[16:19], v[28:31], v[20:23], 0
    v_mul_f32 v67, v67, v56
    v_cvt_pk_bf16_f32 v3, v66, v67
    v_mfma_f32_16x16x32_bf16 v[16:19], v[164:167], v[168:171], v[16:19]
    ds_write_b64 v137, v[2:3] offset:1544
    v_mfma_f32_16x16x32_bf16 v[0:3], v[24:27], v[20:23], 0
    v_mul_f32 v92, v92, v56
    v_mul_f32 v93, v93, v56
    v_mfma_f32_16x16x32_bf16 v[0:3], v[160:163], v[168:171], v[0:3]
    v_cvt_pk_bf16_f32 v154, v92, v93
    v_mul_f32 v94, v94, v56
    v_mfma_f32_16x16x32_bf16 v[28:31], v[32:35], v[20:23], 0
    v_mul_f32 v95, v95, v56
    v_cvt_pk_bf16_f32 v155, v94, v95
    v_mfma_f32_16x16x32_bf16 v[28:31], v[156:159], v[168:171], v[28:31]
    s_waitcnt lgkmcnt(1)
    ds_write_b64 v136, v[154:155] offset:1536
    v_mfma_f32_16x16x32_bf16 v[24:27], a[0:3], v[12:15], 0
    s_cbranch_scc1 L_loopF0
L_tailF:
    v_rcp_f32 v4, v4
    v_fmac_f32 v142, v46, v46
    v_mul_f32 v16, v16, v4
    v_mul_f32 v17, v17, v4
    v_cvt_pk_bf16_f32 v12, v16, v17
    v_mul_f32 v18, v18, v4
    v_mul_f32 v19, v19, v4
    v_cvt_pk_bf16_f32 v13, v18, v19
    v_mul_f32 v0, v0, v4
    v_mul_f32 v1, v1, v4
    v_cvt_pk_bf16_f32 v14, v0, v1
    v_mul_f32 v2, v2, v4
    v_mul_f32 v3, v3, v4
    v_cvt_pk_bf16_f32 v15, v2, v3
    v_mul_f32 v28, v28, v4
    v_mul_f32 v29, v29, v4
    v_cvt_pk_bf16_f32 v28, v28, v29
    v_mul_f32 v30, v30, v4
    v_mul_f32 v31, v31, v4
    v_cvt_pk_bf16_f32 v29, v30, v31
    s_mov_b32 s30, 100270464
    s_mul_i32 s89, s68, 5376
    ds_write_b64 v137, v[12:13] offset:3072
    v_fmac_f32 v142, v47, v47
    s_add_u32 s89, s89, 142336
    s_movk_i32 s90, 336
    ds_write_b64 v137, v[14:15] offset:3080
    v_fma_f32 v134, v48, v48, s42
    v_fmac_f32 v134, v49, v49
    v_fmac_f32 v134, v50, v50
    s_lshr_b32 s91, s64, 16
    s_sub_u32 s84, s45, s44
    ds_write_b64 v136, v[28:29] offset:3072
    v_fmac_f32 v134, v51, v51
    v_fmac_f32 v134, v52, v52
    v_fmac_f32 v134, v53, v53
    v_fmac_f32 v134, v54, v54
    v_fmac_f32 v134, v55, v55
    v_fmac_f32 v134, v88, v88
    v_fmac_f32 v134, v89, v89
    v_fmac_f32 v134, v90, v90
    v_fmac_f32 v134, v91, v91
    v_fma_f32 v133, v108, v108, s42
    v_fmac_f32 v133, v109, v109
    v_fmac_f32 v133, v110, v110
    v_fmac_f32 v133, v111, v111
    v_fmac_f32 v133, v8, v8
    v_fmac_f32 v133, v9, v9
    v_fmac_f32 v133, v10, v10
    v_fmac_f32 v133, v11, v11
    v_fmac_f32 v133, v112, v112
    v_fmac_f32 v133, v113, v113
    v_fmac_f32 v133, v114, v114
    v_fmac_f32 v133, v115, v115
    v_cvt_pk_bf16_f32 v0, v142, v134
    v_cvt_pk_bf16_f32 v1, v133, v124
    s_sub_u32 s85, s46, s45
    s_sub_u32 s86, s44, s45
    ds_write_b64 v132, v[0:1]
    v_mbcnt_lo_u32_b32 v124, -1, 0
    v_mbcnt_hi_u32_b32 v124, -1, v124
    v_and_b32 v133, 15, v124
    v_lshrrev_b32 v124, 4, v124
    v_mul_u32_u24 v124, 80, v124
    v_add_u32 v124, s89, v124
    v_mad_u32_u24 v77, v133, s90, v124
    v_lshrrev_b32 v134, v133, s64
    v_and_b32 v134, 1, v134
    v_cmp_eq_u32 vcc, 1, v134
    v_mad_u32_u24 v30, v133, s90, v124
    v_lshrrev_b32 v76, v133, s91
    v_cndmask_b32 v77, v124, v77, vcc
    s_sub_u32 s93, s44, s47
    s_sub_u32 s94, s45, s47
    ds_read_b128 v[12:15], v77
    ds_read_b128 v[64:67], v77 offset:16
    v_and_b32 v76, 1, v76
    v_subrev_u32 v30, 21504, v30
    s_sub_u32 s95, s46, s47
    ds_read_b64 v[78:79], v77 offset:56
    ds_read_b128 v[80:83], v77 offset:64
    v_cmp_eq_u32 vcc, 1, v76
    v_add_u32 v18, s84, v139
    v_add_u32 v19, s84, v138
    v_cndmask_b32 v30, v124, v30, vcc
    v_add_u32 v32, s85, v137
    v_add_u32 v35, s85, v136
    v_add_u32 v134, s86, v137
    v_add_u32 v133, s86, v136
    v_add_u32 v124, s93, v135
    s_waitcnt lgkmcnt(4)
    s_barrier
    ds_read_b128 v[24:27], v131 offset:0
    ds_read_b128 v[4:7], v131 offset:1024
    v_add_u32 v20, s94, v135
    v_add_u32 v135, s95, v135
    ds_read_b128 v[60:63], v18 offset:1536
    v_and_b32 v125, 0xb8000000, v125
    s_waitcnt lgkmcnt(6)
    v_mfma_f32_16x16x32_bf16 v[0:3], v[220:223], v[12:15], 0
    s_waitcnt lgkmcnt(5)
    s_lshl_b32 s92, s68, 10
    ds_read_b128 v[12:15], v18 offset:1664
    ds_read_b128 v[56:59], v18 offset:1792
    v_mfma_f32_16x16x32_bf16 v[0:3], v[220:223], v[64:67], v[0:3]
    s_waitcnt lgkmcnt(5)
    v_lshlrev_b32 v72, 16, v78
    v_and_b32 v78, 0xffff0000, v78
    v_lshlrev_b32 v73, 16, v79
    v_and_b32 v79, 0xffff0000, v79
    v_lshlrev_b32 v74, 16, v80
    v_and_b32 v80, 0xffff0000, v80
    v_lshlrev_b32 v75, 16, v81
    v_rcp_f32 v0, v0
    v_and_b32 v81, 0xffff0000, v81
    v_mul_f32 v72, v72, v0
    v_mul_f32 v78, v78, v0
    v_cvt_pk_bf16_f32 v72, v72, v78
    v_mul_f32 v73, v73, v0
    v_mul_f32 v79, v79, v0
    v_cvt_pk_bf16_f32 v73, v73, v79
    v_mul_f32 v74, v74, v0
    v_mul_f32 v80, v80, v0
    v_cvt_pk_bf16_f32 v74, v74, v80
    v_mul_f32 v75, v75, v0
    s_waitcnt lgkmcnt(3)
    v_mfma_f32_16x16x32_bf16 v[76:79], v[216:219], v[24:27], 0
    ds_read_b128 v[68:71], v19 offset:1536
    ds_read_b128 v[64:67], v19 offset:1664
    v_mfma_f32_16x16x32_bf16 v[76:79], v[216:219], v[4:7], v[76:79]
    s_waitcnt lgkmcnt(4)
    ds_read_b128 v[24:27], v19 offset:1792
    v_mul_f32 v81, v81, v0
    v_mfma_f32_16x16x32_bf16 v[4:7], a[216:219], v[60:63], 0
    v_cvt_pk_bf16_f32 v75, v75, v81
    v_lshlrev_b32 v16, 16, v82
    v_and_b32 v82, 0xffff0000, v82
    v_mul_f32 v16, v16, v0
    v_mul_f32 v82, v82, v0
    v_cvt_pk_bf16_f32 v22, v16, v82
    v_lshlrev_b32 v79, 16, v83
    v_and_b32 v83, 0xffff0000, v83
    v_mul_f32 v79, v79, v0
    v_mul_f32 v83, v83, v0
    v_cvt_pk_bf16_f32 v23, v79, v83
    v_rsq_f32 v76, v76
    v_rsq_f32 v77, v77
    v_mul_f32 v76, s43, v76
    v_mul_f32 v40, v40, v76
    v_mul_f32 v41, v41, v76
    v_cvt_pk_bf16_f32 v0, v40, v41
    v_mul_f32 v42, v42, v76
    v_mul_f32 v43, v43, v76
    v_cvt_pk_bf16_f32 v1, v42, v43
    v_mul_f32 v36, v36, v76
    v_mul_f32 v37, v37, v76
    v_cvt_pk_bf16_f32 v2, v36, v37
    v_mul_f32 v38, v38, v76
    v_mul_f32 v39, v39, v76
    s_waitcnt lgkmcnt(1)
    v_mfma_f32_16x16x32_bf16 v[4:7], a[220:223], v[68:71], v[4:7]
    ds_write_b128 v134, v[72:75] offset:0
    v_mfma_f32_16x16x32_bf16 v[4:7], a[224:227], v[12:15], v[4:7]
    v_cvt_pk_bf16_f32 v3, v38, v39
    v_mul_f32 v44, v44, v76
    v_mfma_f32_16x16x32_bf16 v[4:7], a[228:231], v[64:67], v[4:7]
    ds_write_b128 v32, v[0:3] offset:0
    v_mfma_f32_16x16x32_bf16 v[4:7], a[232:235], v[56:59], v[4:7]
    s_waitcnt lgkmcnt(2)
    v_mul_f32 v45, v45, v76
    v_cvt_pk_bf16_f32 v16, v44, v45
    v_mfma_f32_16x16x32_bf16 v[4:7], a[236:239], v[24:27], v[4:7]
    ds_write_b64 v133, v[22:23] offset:0
    v_mfma_f32_16x16x32_bf16 v[96:99], a[240:243], v[60:63], 0
    v_mul_f32 v46, v46, v76
    v_mul_f32 v47, v47, v76
    v_mfma_f32_16x16x32_bf16 v[96:99], a[244:247], v[68:71], v[96:99]
    ds_read_b128 v[92:95], v18 offset:0
    v_cvt_pk_bf16_f32 v17, v46, v47
    v_mfma_f32_16x16x32_bf16 v[96:99], a[248:251], v[12:15], v[96:99]
    ds_write_b64 v35, v[16:17] offset:0
    v_mfma_f32_16x16x32_bf16 v[96:99], a[252:255], v[64:67], v[96:99]
    v_mul_f32 v77, s43, v77
    v_mul_f32 v48, v48, v77
    v_mfma_f32_16x16x32_bf16 v[96:99], v[224:227], v[56:59], v[96:99]
    ds_read_b128 v[84:87], v19 offset:0
    v_mul_f32 v49, v49, v77
    v_mfma_f32_16x16x32_bf16 v[96:99], v[228:231], v[24:27], v[96:99]
    ds_read_b128 v[80:83], v18 offset:128
    v_cvt_pk_bf16_f32 v0, v48, v49
    v_mfma_f32_16x16x32_bf16 v[72:75], v[232:235], v[60:63], 0
    ds_read_b128 v[60:63], v19 offset:128
    v_mul_f32 v50, v50, v77
    v_mfma_f32_16x16x32_bf16 v[72:75], v[236:239], v[68:71], v[72:75]
    ds_read_b128 v[40:43], v18 offset:256
    v_mul_f32 v51, v51, v77
    v_mfma_f32_16x16x32_bf16 v[72:75], v[240:243], v[12:15], v[72:75]
    ds_read_b128 v[12:15], v19 offset:256
    v_cvt_pk_bf16_f32 v1, v50, v51
    v_mfma_f32_16x16x32_bf16 v[72:75], v[244:247], v[64:67], v[72:75]
    v_rsq_f32 v78, v78
    v_mfma_f32_16x16x32_bf16 v[72:75], v[248:251], v[56:59], v[72:75]
    v_mul_f32 v78, s43, v78
    v_mul_f32 v108, v108, v78
    v_mfma_f32_16x16x32_bf16 v[72:75], v[252:255], v[24:27], v[72:75]
    s_waitcnt lgkmcnt(5)
    v_mul_f32 v109, v109, v78
    v_cvt_pk_bf16_f32 v16, v108, v109
    v_mfma_f32_16x16x32_bf16 v[24:27], a[216:219], v[92:95], 0
    s_waitcnt lgkmcnt(4)
    v_mul_f32 v110, v110, v78
    v_mul_f32 v111, v111, v78
    v_cvt_pk_bf16_f32 v17, v110, v111
    v_mfma_f32_16x16x32_bf16 v[24:27], a[220:223], v[84:87], v[24:27]
    s_waitcnt lgkmcnt(3)
    ds_read_b128 v[68:71], v18 offset:3072
    ds_read_b128 v[64:67], v19 offset:3072
    v_mfma_f32_16x16x32_bf16 v[24:27], a[224:227], v[80:83], v[24:27]
    s_waitcnt lgkmcnt(4)
    ds_read_b128 v[56:59], v18 offset:3200
    v_mul_f32 v8, v8, v78
    v_mfma_f32_16x16x32_bf16 v[24:27], a[228:231], v[60:63], v[24:27]
    s_waitcnt lgkmcnt(4)
    ds_read_b128 v[48:51], v19 offset:3200
    v_mul_f32 v9, v9, v78
    v_mfma_f32_16x16x32_bf16 v[24:27], a[232:235], v[40:43], v[24:27]
    s_waitcnt lgkmcnt(4)
    ds_read_b128 v[44:47], v18 offset:3328
    v_cvt_pk_bf16_f32 v18, v8, v9
    v_mfma_f32_16x16x32_bf16 v[24:27], a[236:239], v[12:15], v[24:27]
    ds_read_b128 v[36:39], v19 offset:3328
    v_mul_f32 v10, v10, v78
    v_mfma_f32_16x16x32_bf16 v[104:107], a[240:243], v[92:95], 0
    v_mul_f32 v11, v11, v78
    v_cvt_pk_bf16_f32 v19, v10, v11
    v_mfma_f32_16x16x32_bf16 v[104:107], a[244:247], v[84:87], v[104:107]
    ds_write_b128 v32, v[16:19] offset:3072
    v_mfma_f32_16x16x32_bf16 v[104:107], a[248:251], v[80:83], v[104:107]
    v_mul_f32 v112, v112, v78
    v_mul_f32 v113, v113, v78
    v_mfma_f32_16x16x32_bf16 v[104:107], a[252:255], v[60:63], v[104:107]
    v_cvt_pk_bf16_f32 v2, v112, v113
    v_mul_f32 v114, v114, v78
    v_mfma_f32_16x16x32_bf16 v[104:107], v[224:227], v[40:43], v[104:107]
    v_mul_f32 v115, v115, v78
    v_cvt_pk_bf16_f32 v3, v114, v115
    v_mfma_f32_16x16x32_bf16 v[104:107], v[228:231], v[12:15], v[104:107]
    ds_write_b64 v35, v[2:3] offset:3072
    v_mfma_f32_16x16x32_bf16 v[16:19], v[232:235], v[92:95], 0
    v_fma_f32 v34, v24, v24, s42
    v_fmac_f32 v34, v25, v25
    v_mfma_f32_16x16x32_bf16 v[16:19], v[236:239], v[84:87], v[16:19]
    v_fmac_f32 v34, v26, v26
    v_fmac_f32 v34, v27, v27
    v_mfma_f32_16x16x32_bf16 v[16:19], v[240:243], v[80:83], v[16:19]
    v_fmac_f32 v34, v104, v104
    v_fmac_f32 v34, v105, v105
    v_mfma_f32_16x16x32_bf16 v[16:19], v[244:247], v[60:63], v[16:19]
    v_fmac_f32 v34, v106, v106
    v_fmac_f32 v34, v107, v107
    v_mfma_f32_16x16x32_bf16 v[16:19], v[248:251], v[40:43], v[16:19]
    v_mul_f32 v52, v52, v77
    v_mul_f32 v53, v53, v77
    v_mfma_f32_16x16x32_bf16 v[16:19], v[252:255], v[12:15], v[16:19]
    s_waitcnt lgkmcnt(1)
    v_cvt_pk_bf16_f32 v2, v52, v53
    v_mul_f32 v54, v54, v77
    v_mfma_f32_16x16x32_bf16 v[12:15], a[216:219], v[68:71], 0
    v_mul_f32 v55, v55, v77
    v_cvt_pk_bf16_f32 v3, v54, v55
    v_mfma_f32_16x16x32_bf16 v[12:15], a[220:223], v[64:67], v[12:15]
    ds_write_b128 v32, v[0:3] offset:1536
    v_mfma_f32_16x16x32_bf16 v[12:15], a[224:227], v[56:59], v[12:15]
    v_fmac_f32 v34, v16, v16
    v_fmac_f32 v34, v17, v17
    v_mfma_f32_16x16x32_bf16 v[12:15], a[228:231], v[48:51], v[12:15]
    ds_read_b128 v[40:43], v30
    v_fmac_f32 v34, v18, v18
    v_mfma_f32_16x16x32_bf16 v[12:15], a[232:235], v[44:47], v[12:15]
    ds_read_b128 v[0:3], v30 offset:16
    v_fmac_f32 v34, v19, v19
    v_mfma_f32_16x16x32_bf16 v[12:15], a[236:239], v[36:39], v[12:15]
    ds_read_b64 v[28:29], v30 offset:56
    ds_read_b128 v[30:33], v30 offset:64
    v_mfma_f32_16x16x32_bf16 v[60:63], a[240:243], v[68:71], 0
    v_mul_f32 v88, v88, v77
    v_mul_f32 v89, v89, v77
    v_mfma_f32_16x16x32_bf16 v[60:63], a[244:247], v[64:67], v[60:63]
    v_cvt_pk_bf16_f32 v88, v88, v89
    v_mul_f32 v90, v90, v77
    v_mfma_f32_16x16x32_bf16 v[60:63], a[248:251], v[56:59], v[60:63]
    v_mul_f32 v91, v91, v77
    v_cvt_pk_bf16_f32 v89, v90, v91
    v_mfma_f32_16x16x32_bf16 v[60:63], a[252:255], v[48:51], v[60:63]
    ds_write_b64 v35, v[88:89] offset:1536
    v_mfma_f32_16x16x32_bf16 v[60:63], v[224:227], v[44:47], v[60:63]
    v_fma_f32 v35, v12, v12, s42
    v_fmac_f32 v35, v13, v13
    v_mfma_f32_16x16x32_bf16 v[60:63], v[228:231], v[36:39], v[60:63]
    v_fmac_f32 v35, v14, v14
    v_fmac_f32 v35, v15, v15
    v_mfma_f32_16x16x32_bf16 v[8:11], v[232:235], v[68:71], 0
    s_nop 0
    v_fma_f32 v21, v4, v4, s42
    v_fmac_f32 v21, v5, v5
    v_mfma_f32_16x16x32_bf16 v[8:11], v[236:239], v[64:67], v[8:11]
    s_nop 0
    v_fmac_f32 v35, v60, v60
    v_fmac_f32 v35, v61, v61
    v_mfma_f32_16x16x32_bf16 v[8:11], v[240:243], v[56:59], v[8:11]
    v_fmac_f32 v35, v62, v62
    v_fmac_f32 v35, v63, v63
    v_mfma_f32_16x16x32_bf16 v[8:11], v[244:247], v[48:51], v[8:11]
    v_fmac_f32 v21, v6, v6
    v_fmac_f32 v21, v7, v7
    v_mfma_f32_16x16x32_bf16 v[8:11], v[248:251], v[44:47], v[8:11]
    v_fmac_f32 v21, v96, v96
    v_fmac_f32 v21, v97, v97
    v_mfma_f32_16x16x32_bf16 v[8:11], v[252:255], v[36:39], v[8:11]
    s_waitcnt lgkmcnt(0)
    v_fmac_f32 v21, v98, v98
    v_fmac_f32 v21, v99, v99
    v_mfma_f32_16x16x32_bf16 v[36:39], v[220:223], v[40:43], 0
    v_fmac_f32 v21, v72, v72
    v_fmac_f32 v21, v73, v73
    v_mfma_f32_16x16x32_bf16 v[36:39], v[220:223], v[0:3], v[36:39]
    s_nop 0
    v_fmac_f32 v35, v8, v8
    v_fmac_f32 v35, v9, v9
    v_fmac_f32 v35, v10, v10
    v_fmac_f32 v35, v11, v11
    v_cvt_pk_bf16_f32 v35, v35, v35
    v_fmac_f32 v21, v74, v74
    v_fmac_f32 v21, v75, v75
    v_cvt_pk_bf16_f32 v34, v34, v21
    ds_write_b64 v132, v[34:35] offset:2048
    v_rcp_f32 v36, v36
    v_lshlrev_b32 v34, 16, v28
    v_and_b32 v28, 0xffff0000, v28
    v_mul_f32 v34, v34, v36
    v_mul_f32 v28, v28, v36
    v_cvt_pk_bf16_f32 v28, v34, v28
    v_lshlrev_b32 v34, 16, v29
    v_and_b32 v29, 0xffff0000, v29
    v_mul_f32 v34, v34, v36
    v_mul_f32 v29, v29, v36
    v_cvt_pk_bf16_f32 v29, v34, v29
    v_lshlrev_b32 v34, 16, v30
    v_and_b32 v30, 0xffff0000, v30
    v_mul_f32 v34, v34, v36
    v_mul_f32 v30, v30, v36
    v_cvt_pk_bf16_f32 v30, v34, v30
    v_lshlrev_b32 v34, 16, v31
    v_and_b32 v31, 0xffff0000, v31
    v_mul_f32 v34, v34, v36
    v_mul_f32 v31, v31, v36
    v_cvt_pk_bf16_f32 v31, v34, v31
    v_lshlrev_b32 v34, 16, v32
    v_and_b32 v32, 0xffff0000, v32
    v_mul_f32 v34, v34, v36
    v_mul_f32 v32, v32, v36
    v_cvt_pk_bf16_f32 v0, v34, v32
    v_lshlrev_b32 v1, 16, v33
    v_and_b32 v33, 0xffff0000, v33
    v_mul_f32 v1, v1, v36
    v_mul_f32 v33, v33, v36
    v_cvt_pk_bf16_f32 v1, v1, v33
    s_waitcnt lgkmcnt(0)
    s_barrier
    ds_write_b128 v134, v[28:31] offset:1536
    v_mov_b32 v23, 0x3f803f80
    v_cmp_ne_u32 vcc, 0, v125
    v_add_u32 v125, s92, v131
    ds_write_b64 v133, v[0:1] offset:1536
    v_cndmask_b32 v23, 0, v23, vcc
    ds_read_b128 v[48:51], v131 offset:2048
    ds_read_b128 v[44:47], v131 offset:3072
    ds_read_b128 v[0:3], v135 offset:0
    ds_read_b128 v[32:35], v135 offset:1024
    ds_read_b128 v[36:39], v135 offset:2048
    ds_read_b128 v[100:103], v135 offset:3072
    ds_read_b128 v[28:31], v135 offset:4096
    s_waitcnt lgkmcnt(7)
    s_barrier
    s_waitcnt lgkmcnt(6)
    v_mfma_f32_16x16x32_bf16 v[40:43], v[216:219], v[48:51], 0
    s_waitcnt lgkmcnt(5)
    ds_read_b128 v[92:95], v139 offset:0
    ds_read_b128 v[88:91], v138 offset:0
    v_mfma_f32_16x16x32_bf16 v[40:43], v[216:219], v[44:47], v[40:43]
    s_waitcnt lgkmcnt(6)
    ds_read_b128 v[84:87], v139 offset:128
    s_nop 0
    buffer_store_dwordx4 v[0:3], v130, s[28:31], s59 offen sc1
    s_nop 0
    ds_read_b128 v[80:83], v138 offset:128
    s_nop 1
    v_rsq_f32 v40, v40
    ds_read_b128 v[76:79], v139 offset:256
    ds_read_b128 v[0:3], v138 offset:256
    v_mul_f32 v40, s43, v40
    v_mul_f32 v24, v24, v40
    v_mul_f32 v25, v25, v40
    ds_read_b128 v[68:71], v139 offset:1536
    s_waitcnt lgkmcnt(8)
    buffer_store_dwordx4 v[32:35], v129, s[28:31], s59 offen sc1
    ds_read_b128 v[64:67], v138 offset:1536
    v_cvt_pk_bf16_f32 v52, v24, v25
    v_mul_f32 v26, v26, v40
    v_mul_f32 v27, v27, v40
    v_cvt_pk_bf16_f32 v53, v26, v27
    v_mul_f32 v104, v104, v40
    ds_read_b128 v[56:59], v139 offset:1664
    ds_read_b128 v[48:51], v138 offset:1664
    v_mul_f32 v105, v105, v40
    s_waitcnt lgkmcnt(8)
    v_mfma_f32_16x16x32_bf16 v[24:27], a[216:219], v[92:95], 0
    ds_read_b128 v[44:47], v139 offset:1792
    v_cvt_pk_bf16_f32 v54, v104, v105
    v_mfma_f32_16x16x32_bf16 v[24:27], a[220:223], v[88:91], v[24:27]
    s_waitcnt lgkmcnt(7)
    ds_read_b128 v[32:35], v138 offset:1792
    v_mul_f32 v106, v106, v40
    v_mfma_f32_16x16x32_bf16 v[24:27], a[224:227], v[84:87], v[24:27]
    buffer_store_dwordx4 v[36:39], v128, s[28:31], s59 offen sc1
    v_mul_f32 v107, v107, v40
    v_cvt_pk_bf16_f32 v55, v106, v107
    v_mul_f32 v16, v16, v40
    v_mul_f32 v17, v17, v40
    v_mfma_f32_16x16x32_bf16 v[24:27], a[228:231], v[80:83], v[24:27]
    s_waitcnt lgkmcnt(6)
    v_cvt_pk_bf16_f32 v16, v16, v17
    v_mul_f32 v18, v18, v40
    v_mfma_f32_16x16x32_bf16 v[24:27], a[232:235], v[76:79], v[24:27]
    v_rsq_f32 v41, v41
    v_mfma_f32_16x16x32_bf16 v[24:27], a[236:239], v[0:3], v[24:27]
    s_nop 0
    v_mul_f32 v19, v19, v40
    v_cvt_pk_bf16_f32 v17, v18, v19
    v_mfma_f32_16x16x32_bf16 v[36:39], a[240:243], v[92:95], 0
    s_nop 0
    buffer_store_dwordx4 v[100:103], v127, s[28:31], s59 offen sc1
    v_mul_f32 v41, s43, v41
    v_mul_f32 v4, v4, v41
    v_fma_f32 v135, v24, v24, s42
    v_fmac_f32 v135, v25, v25
    v_mfma_f32_16x16x32_bf16 v[36:39], a[244:247], v[88:91], v[36:39]
    v_fmac_f32 v135, v26, v26
    v_fmac_f32 v135, v27, v27
    v_mfma_f32_16x16x32_bf16 v[36:39], a[248:251], v[84:87], v[36:39]
    v_mul_f32 v5, v5, v41
    v_cvt_pk_bf16_f32 v4, v4, v5
    v_mfma_f32_16x16x32_bf16 v[36:39], a[252:255], v[80:83], v[36:39]
    v_mul_f32 v6, v6, v41
    v_mul_f32 v7, v7, v41
    v_mfma_f32_16x16x32_bf16 v[36:39], v[224:227], v[76:79], v[36:39]
    buffer_store_dwordx4 v[28:31], v126, s[28:31], s59 offen sc1
    v_cvt_pk_bf16_f32 v5, v6, v7
    v_mul_f32 v96, v96, v41
    v_mul_f32 v97, v97, v41
    v_cvt_pk_bf16_f32 v6, v96, v97
    v_mfma_f32_16x16x32_bf16 v[36:39], v[228:231], v[0:3], v[36:39]
    v_mul_f32 v98, v98, v41
    v_mul_f32 v99, v99, v41
    v_mfma_f32_16x16x32_bf16 v[28:31], v[232:235], v[92:95], 0
    s_nop 0
    v_cvt_pk_bf16_f32 v7, v98, v99
    v_mul_f32 v72, v72, v41
    v_mfma_f32_16x16x32_bf16 v[28:31], v[236:239], v[88:91], v[28:31]
    s_nop 0
    v_fmac_f32 v135, v36, v36
    v_fmac_f32 v135, v37, v37
    v_mfma_f32_16x16x32_bf16 v[28:31], v[240:243], v[84:87], v[28:31]
    v_fmac_f32 v135, v38, v38
    v_fmac_f32 v135, v39, v39
    v_mfma_f32_16x16x32_bf16 v[28:31], v[244:247], v[80:83], v[28:31]
    v_mul_f32 v73, v73, v41
    v_cvt_pk_bf16_f32 v138, v72, v73
    v_mfma_f32_16x16x32_bf16 v[28:31], v[248:251], v[76:79], v[28:31]
    v_mul_f32 v74, v74, v41
    v_mul_f32 v75, v75, v41
    v_mfma_f32_16x16x32_bf16 v[28:31], v[252:255], v[0:3], v[28:31]
    s_waitcnt lgkmcnt(0)
    v_rsq_f32 v42, v42
    v_mfma_f32_16x16x32_bf16 v[0:3], a[216:219], v[68:71], 0
    v_cvt_pk_bf16_f32 v139, v74, v75
    v_mul_f32 v42, s43, v42
    v_mfma_f32_16x16x32_bf16 v[0:3], a[220:223], v[64:67], v[0:3]
    ds_write_b128 v137, v[52:55] offset:0
    v_mfma_f32_16x16x32_bf16 v[0:3], a[224:227], v[56:59], v[0:3]
    v_fmac_f32 v135, v28, v28
    v_fmac_f32 v135, v29, v29
    v_mfma_f32_16x16x32_bf16 v[0:3], a[228:231], v[48:51], v[0:3]
    ds_write_b64 v136, v[16:17] offset:0
    v_mfma_f32_16x16x32_bf16 v[0:3], a[232:235], v[44:47], v[0:3]
    v_fmac_f32 v135, v30, v30
    v_fmac_f32 v135, v31, v31
    v_mfma_f32_16x16x32_bf16 v[0:3], a[236:239], v[32:35], v[0:3]
    ds_write_b128 v137, v[4:7] offset:1536
    v_mfma_f32_16x16x32_bf16 v[16:19], a[240:243], v[68:71], 0
    v_mul_f32 v12, v12, v42
    v_mul_f32 v13, v13, v42
    v_mfma_f32_16x16x32_bf16 v[16:19], a[244:247], v[64:67], v[16:19]
    ds_write_b64 v136, v[138:139] offset:1536
    v_mfma_f32_16x16x32_bf16 v[16:19], a[248:251], v[56:59], v[16:19]
    v_cvt_pk_bf16_f32 v52, v12, v13
    v_mul_f32 v14, v14, v42
    v_mfma_f32_16x16x32_bf16 v[16:19], a[252:255], v[48:51], v[16:19]
    ds_read_b128 v[4:7], v125 offset:6144
    v_mul_f32 v15, v15, v42
    v_mfma_f32_16x16x32_bf16 v[16:19], v[224:227], v[44:47], v[16:19]
    v_cvt_pk_bf16_f32 v53, v14, v15
    v_mul_f32 v60, v60, v42
    v_mfma_f32_16x16x32_bf16 v[16:19], v[228:231], v[32:35], v[16:19]
    v_mul_f32 v61, v61, v42
    v_cvt_pk_bf16_f32 v54, v60, v61
    v_mfma_f32_16x16x32_bf16 v[12:15], v[232:235], v[68:71], 0
    v_mul_f32 v62, v62, v42
    v_mul_f32 v63, v63, v42
    v_mfma_f32_16x16x32_bf16 v[12:15], v[236:239], v[64:67], v[12:15]
    v_cvt_pk_bf16_f32 v55, v62, v63
    v_mul_f32 v8, v8, v42
    v_mfma_f32_16x16x32_bf16 v[12:15], v[240:243], v[56:59], v[12:15]
    ds_write_b128 v137, v[52:55] offset:3072
    v_mfma_f32_16x16x32_bf16 v[12:15], v[244:247], v[48:51], v[12:15]
    v_mul_f32 v9, v9, v42
    v_cvt_pk_bf16_f32 v138, v8, v9
    v_mfma_f32_16x16x32_bf16 v[12:15], v[248:251], v[44:47], v[12:15]
    v_mul_f32 v10, v10, v42
    v_mul_f32 v11, v11, v42
    v_mfma_f32_16x16x32_bf16 v[12:15], v[252:255], v[32:35], v[12:15]
    v_cvt_pk_bf16_f32 v139, v10, v11
    v_fma_f32 v125, v0, v0, s42
    v_fmac_f32 v125, v1, v1
    v_fmac_f32 v125, v2, v2
    ds_write_b64 v136, v[138:139] offset:3072
    v_fmac_f32 v125, v3, v3
    v_fmac_f32 v125, v16, v16
    v_fmac_f32 v125, v17, v17
    v_fmac_f32 v125, v18, v18
    v_fmac_f32 v125, v19, v19
    v_fmac_f32 v125, v12, v12
    v_fmac_f32 v125, v13, v13
    v_fmac_f32 v125, v14, v14
    v_fmac_f32 v125, v15, v15
    v_cvt_pk_bf16_f32 v22, v135, v125
    ds_write_b64 v132, v[22:23] offset:4096
    s_waitcnt lgkmcnt(2)
    v_lshrrev_b32 v125, 0, v7
    v_lshrrev_b32 v125, v125, s64
    v_and_b32 v125, 1, v125
    v_cmp_eq_u32 vcc, 1, v125
    v_lshrrev_b32 v125, 8, v7
    v_lshrrev_b32 v125, v125, s64
    v_cndmask_b32 v4, 2.0, v4, vcc
    v_and_b32 v125, 1, v125
    v_cmp_eq_u32 vcc, 1, v125
    v_lshrrev_b32 v7, 16, v7
    v_lshrrev_b32 v7, v7, s64
    v_cndmask_b32 v5, 2.0, v5, vcc
    v_and_b32 v7, 1, v7
    v_cmp_eq_u32 vcc, 1, v7
    s_nop 1
    v_cndmask_b32 v6, 2.0, v6, vcc
    s_waitcnt lgkmcnt(1)
    s_barrier
    ds_read_b128 v[52:55], v20 offset:0
    ds_read_b128 v[8:11], v20 offset:1024
    ds_read_b128 v[40:43], v20 offset:2048
    s_waitcnt lgkmcnt(3)
    s_barrier
    ds_read_b128 v[32:35], v20 offset:3072
    ds_read_b128 v[20:23], v20 offset:4096
    ds_read_b128 v[48:51], v131 offset:4096
    ds_read_b128 v[44:47], v131 offset:5120
    s_waitcnt lgkmcnt(6)
    buffer_store_dwordx4 v[52:55], v130, s[28:31], s58 offen sc1
    s_waitcnt lgkmcnt(1)
    buffer_store_dwordx4 v[8:11], v129, s[28:31], s58 offen sc1
    s_nop 1
    v_mfma_f32_16x16x32_bf16 v[8:11], v[216:219], v[48:51], 0
    s_waitcnt lgkmcnt(0)
    v_mfma_f32_16x16x32_bf16 v[8:11], v[216:219], v[44:47], v[8:11]
    s_nop 5
    buffer_store_dwordx4 v[40:43], v128, s[28:31], s58 offen sc1
    s_nop 0
    v_rsq_f32 v8, v8
    v_cmp_neq_f32 vcc, 0, v10
    v_mul_f32 v8, s43, v8
    v_mul_f32 v24, v24, v8
    v_mul_f32 v25, v25, v8
    v_cvt_pk_bf16_f32 v24, v24, v25
    v_mul_f32 v26, v26, v8
    v_mul_f32 v27, v27, v8
    v_cvt_pk_bf16_f32 v25, v26, v27
    v_mul_f32 v36, v36, v8
    v_mul_f32 v37, v37, v8
    v_cvt_pk_bf16_f32 v26, v36, v37
    v_mul_f32 v38, v38, v8
    buffer_store_dwordx4 v[32:35], v127, s[28:31], s58 offen sc1
    v_mul_f32 v39, v39, v8
    v_cvt_pk_bf16_f32 v27, v38, v39
    v_mul_f32 v28, v28, v8
    v_mul_f32 v29, v29, v8
    v_cvt_pk_bf16_f32 v10, v28, v29
    v_mul_f32 v30, v30, v8
    v_mul_f32 v31, v31, v8
    v_cvt_pk_bf16_f32 v11, v30, v31
    ds_write_b128 v134, v[24:27] offset:0
    buffer_store_dwordx4 v[20:23], v126, s[28:31], s58 offen sc1
    v_rsq_f32 v9, v9
    s_nop 0
    v_mul_f32 v9, s43, v9
    v_mul_f32 v0, v0, v9
    v_mul_f32 v1, v1, v9
    ds_write_b64 v133, v[10:11] offset:0
    v_cvt_pk_bf16_f32 v0, v0, v1
    v_mul_f32 v2, v2, v9
    v_mul_f32 v3, v3, v9
    v_cvt_pk_bf16_f32 v1, v2, v3
    v_mul_f32 v16, v16, v9
    v_mul_f32 v17, v17, v9
    v_cvt_pk_bf16_f32 v2, v16, v17
    v_mul_f32 v18, v18, v9
    v_mul_f32 v19, v19, v9
    v_cvt_pk_bf16_f32 v3, v18, v19
    v_mul_f32 v12, v12, v9
    v_mul_f32 v13, v13, v9
    v_cvt_pk_bf16_f32 v126, v12, v13
    v_mul_f32 v14, v14, v9
    v_mul_f32 v15, v15, v9
    v_cvt_pk_bf16_f32 v127, v14, v15
    ds_write_b128 v134, v[0:3] offset:1536
    ds_write_b64 v133, v[126:127] offset:1536
    s_waitcnt lgkmcnt(0)
    s_barrier
    ds_read_b128 v[12:15], v124 offset:0
    ds_read_b128 v[8:11], v124 offset:1024
    ds_read_b128 v[0:3], v124 offset:2048
    s_waitcnt lgkmcnt(1)
    buffer_store_dwordx4 v[12:15], v4, s[28:31], 0 offen sc1
    buffer_store_dwordx4 v[8:11], v5, s[28:31], 0 offen sc1
    s_waitcnt lgkmcnt(0)
    buffer_store_dwordx4 v[0:3], v6, s[28:31], 0 offen sc1
    s_nop 4
    s_cbranch_vccnz L_slow
L_end:
    s_endpgm
L_slow:
    s_waitcnt vmcnt(0) lgkmcnt(0)
    s_nop 15
    s_barrier
    s_lshr_b32 s66, s64, 20
    v_mbcnt_lo_u32_b32 v40, -1, 0
    v_mbcnt_hi_u32_b32 v40, -1, v40
    s_load_dwordx16 s[4:19], s[0:1], 0
    s_load_dwordx4 s[20:23], s[0:1], 64
    s_load_dwordx2 s[38:39], s[0:1], 80
    s_lshr_b32 s88, s2, 3
    s_lshl2_add_u32 s88, s88, s68
    v_lshlrev_b32 v8, 7, v40
    s_mul_i32 s89, s88, 576
    s_mul_i32 s88, s88, 1728
    v_min_u32 v9, 1664, v8
    v_min_u32 v8, 512, v8
    s_mov_b32 s34, 221184
    s_mov_b32 s35, 0x20000
    s_mov_b32 s78, 73728
    s_mov_b32 s79, 0x20000
    v_and_b32 v154, 15, v40
    v_lshrrev_b32 v151, 4, v40
    v_lshrrev_b32 v150, 2, v154
    v_and_b32 v142, 3, v154
    s_mul_i32 s87, s68, 192
    v_mad_u32_u24 v10, v154, 12, s87
    v_lshlrev_b32 v19, 1, v154
    v_lshlrev_b32 v11, 1, v150
    v_lshl_add_u32 v11, v151, 5, v11
    s_movk_i32 s86, 384
    s_mov_b32 s26, 100270464
    s_mov_b32 s27, 0x20000
    s_mov_b32 s30, 0
    s_mov_b32 s31, 0x20000
    s_mul_i32 s96, s68, 288
    s_and_b32 s97, s68, 1
    s_lshl_b32 s97, s97, 2
    s_mov_b32 s98, 193536
    s_waitcnt lgkmcnt(0)
    s_mov_b32 s32, s6
    s_mov_b32 s33, s7
    s_mov_b32 s76, s8
    s_mov_b32 s77, s9
    buffer_load_dword a254, v9, s[32:35], s88 offen
    buffer_load_dword a253, v8, s[76:79], s89 offen
    s_load_dwordx2 s[82:83], s[10:11], 0
    s_movk_i32 s18, 676
    s_mov_b32 s19, 0x20000
    s_mov_b32 s24, s4
    s_mov_b32 s25, s5
    buffer_load_dwordx3 v[16:18], v10, s[16:19], 0 offen
    s_mov_b32 s99, 589824
    v_add_u32 v8, s96, v40
    v_mul_u32_u24 v36, 2731, v8
    v_mul_u32_u24 v39, 6242, v8
    v_lshrrev_b32 v36, 16, v36
    s_lshr_b32 s94, s2, 3
    s_mul_i32 s70, s94, 168
    global_load_ushort v24, v19, s[12:13]
    v_lshrrev_b32 v39, 20, v39
    v_and_or_b32 v9, v36, 3, s97
    v_xor_b32 v9, v8, v9
    v_lshl_add_u32 v130, v9, 4, s99
    v_mad_u32_u24 v130, v39, s98, v130
    s_mul_i32 s69, s2, 20
    s_lshl3_add_u32 s69, s94, s69
    global_load_ushort v25, v19, s[12:13] offset:32
    v_add_u32 v19, 64, v8
    v_mul_u32_u24 v26, 2731, v19
    v_mul_u32_u24 v73, 6242, v19
    v_lshrrev_b32 v26, 16, v26
    v_lshrrev_b32 v73, 20, v73
    s_add_u32 s70, s70, 140
    s_movk_i32 s62, 2688
    global_load_ushort v74, v11, s[14:15] offset:0
    v_and_or_b32 v37, v26, 3, s97
    v_xor_b32 v37, v19, v37
    v_lshl_add_u32 v129, v37, 4, s99
    v_mad_u32_u24 v129, v73, s98, v129
    v_add_u32 v19, 128, v8
    s_movk_i32 s71, 20
    s_movk_i32 s73, 28
    global_load_ushort v131, v11, s[14:15] offset:8
    v_mul_u32_u24 v27, 2731, v19
    v_mul_u32_u24 v124, 6242, v19
    v_lshrrev_b32 v27, 16, v27
    v_lshrrev_b32 v124, 20, v124
    v_and_or_b32 v38, v27, 3, s97
    s_mov_b32 s93, 1769472
    s_mul_i32 s54, s68, 5120
    global_load_ushort v75, v11, s[14:15] offset:16
    v_xor_b32 v38, v19, v38
    v_lshl_add_u32 v128, v38, 4, s99
    v_mad_u32_u24 v128, v124, s98, v128
    v_add_u32 v148, 192, v8
    v_mul_u32_u24 v149, 2731, v148
    s_mov_b32 s63, 1180032
    s_mul_i32 s95, s68, -44
    global_load_ushort v11, v11, s[14:15] offset:24
    v_mul_u32_u24 v19, 6242, v148
    v_lshrrev_b32 v149, 16, v149
    v_lshrrev_b32 v19, 20, v19
    v_and_or_b32 v72, v149, 3, s97
    v_xor_b32 v72, v148, v72
    v_lshl_add_u32 v127, v72, 4, s99
    v_mad_u32_u24 v127, v19, s98, v127
    v_add_u32 v125, 256, v8
    v_mul_u32_u24 v72, 2731, v125
    v_mul_u32_u24 v8, 6242, v125
    v_lshrrev_b32 v72, 16, v72
    v_lshrrev_b32 v8, 20, v8
    v_and_or_b32 v148, v72, 3, s97
    v_xor_b32 v148, v125, v148
    v_lshl_add_u32 v126, v148, 4, s99
    v_mad_u32_u24 v126, v8, s98, v126
    s_cmp_ge_u32 s2, 240
    s_cbranch_scc1 L_bndS
L_bndrS:
    s_mul_i32 s94, s69, 58255
    s_lshr_b32 s94, s94, 22
    s_mul_i32 s94, s94, s63
    s_mul_i32 s72, s69, s62
    s_add_u32 s72, s72, s94
    v_lshl_or_b32 v143, v40, 4, 2.0
    s_sub_u32 s94, s73, 1
    s_max_u32 s94, s94, 20
    s_movk_i32 s99, -24
    s_add_u32 m0, s54, 0
    v_and_b32 v19, -4, v27
    s_mul_i32 s85, s68, 96
    s_sub_u32 s100, s85, 1024
    buffer_load_dwordx4 v130, s[24:27], s72 offen nt lds
    s_add_u32 m0, s54, 1024
    v_mad_u32_u24 v8, v19, 3, v27
    v_add_u32 v8, s95, v8
    v_mad_i32_i24 v38, v27, s99, v38
    v_med3_u32 v19, v8, 20, s94
    v_add_u32 v19, s70, v19
    v_add_u32 v27, s69, v8
    s_sub_u32 s87, s85, 2048
    s_movk_i32 s91, 1152
    buffer_load_dwordx4 v129, s[24:27], s72 offen nt lds
    v_cmp_gt_u32 vcc, s71, v8
    v_lshl_add_u32 v38, v38, 4, s93
    s_add_u32 m0, s54, 43008
    v_cndmask_b32 v27, v19, v27, vcc
    v_mul_u32_u24 v19, 58255, v27
    v_mad_u32_u24 v38, v27, s62, v38
    v_lshrrev_b32 v19, 22, v19
    v_mad_u32_u24 v38, v19, s63, v38
    s_mul_i32 s90, s68, 3072
    s_add_u32 s90, s90, 61440
    buffer_load_dwordx4 v38, s[24:27], 0 offen  lds
    v_lshlrev_b32 v39, 16, v8
    s_add_u32 m0, s54, 2048
    v_and_b32 v19, -4, v26
    v_mad_u32_u24 v8, v19, 3, v26
    v_add_u32 v8, s95, v8
    v_mad_i32_i24 v37, v26, s99, v37
    v_med3_u32 v19, v8, 20, s94
    s_mov_b32 s92, 0
    s_mov_b32 s28, s22
    buffer_load_dwordx4 v128, s[24:27], s72 offen nt lds
    v_add_u32 v19, s70, v19
    v_add_u32 v26, s69, v8
    v_cmp_gt_u32 vcc, s71, v8
    v_lshl_add_u32 v37, v37, 4, s93
    s_add_u32 m0, s54, 41984
    v_cndmask_b32 v26, v19, v26, vcc
    v_mul_u32_u24 v19, 58255, v26
    v_mad_u32_u24 v37, v26, s62, v37
    v_lshrrev_b32 v19, 22, v19
    v_mad_u32_u24 v37, v19, s63, v37
    s_mov_b32 s29, s23
    s_mov_b32 s41, 0x2a8cbccc
    buffer_load_dwordx4 v37, s[24:27], 0 offen  lds
    v_lshl_or_b32 v39, v8, 8, v39
    s_add_u32 m0, s54, 3072
    v_cmp_gt_u32 vcc, 32, v40
    v_and_b32 v8, -4, v36
    v_mad_u32_u24 v19, v8, 3, v36
    v_cndmask_b32 v126, v143, v126, vcc
    v_add_u32 v19, s95, v19
    s_mov_b32 s42, 0x38fba882
    s_mov_b32 s43, 0x415db3d7
    buffer_load_dwordx4 v127, s[24:27], s72 offen nt lds
    s_add_u32 m0, s54, 4096
    v_mad_i32_i24 v36, v36, s99, v9
    v_med3_u32 v8, v19, 20, s94
    v_add_u32 v8, s70, v8
    v_add_u32 v9, s69, v19
    v_cmp_gt_u32 vcc, s71, v19
    v_lshl_add_u32 v36, v36, 4, s93
    s_mul_i32 s93, s68, 6
    s_lshl_b32 s94, s97, 1
    buffer_load_dwordx4 v126, s[24:27], s72 offen nt lds
    v_cndmask_b32 v9, v8, v9, vcc
    v_mul_u32_u24 v8, 58255, v9
    v_mad_u32_u24 v36, v9, s62, v36
    v_lshrrev_b32 v8, 22, v8
    v_mad_u32_u24 v36, v8, s63, v36
    s_add_u32 m0, s54, 40960
    v_lshl_or_b32 v39, v19, 0, v39
    s_mov_b32 s44, 61440
    s_mov_b32 s45, 40960
    buffer_load_dwordx4 v36, s[24:27], 0 offen nt lds
    v_mul_u32_u24 v72, 10923, v40
    v_lshrrev_b32 v56, 17, v72
    v_lshrrev_b32 v72, 16, v72
    v_mad_i32_i24 v14, v72, -6, v40
    v_bitop3_b32 v56, v56, v72, 4 bitop3:0x28
    v_lshl_add_u32 v14, v14, 4, s85
    v_mul_u32_u24 v56, 3, v56
    v_xor_b32 v72, v72, v56
    v_mad_u32_u24 v56, v72, s91, v14
    v_add_u32 v8, 64, v40
    v_mul_u32_u24 v9, 10923, v8
    v_lshrrev_b32 v13, 17, v9
    v_lshrrev_b32 v9, 16, v9
    v_mad_i32_i24 v73, v9, -6, v8
    v_bitop3_b32 v13, v13, v9, 4 bitop3:0x28
    v_lshl_add_u32 v73, v73, 4, s100
    v_mul_u32_u24 v13, 3, v13
    v_xor_b32 v9, v9, v13
    v_mad_u32_u24 v13, v9, s91, v73
    v_add_u32 v8, 128, v40
    v_mul_u32_u24 v19, 10923, v8
    v_lshrrev_b32 v12, 17, v19
    v_lshrrev_b32 v19, 16, v19
    v_mad_i32_i24 v8, v19, -6, v8
    v_bitop3_b32 v12, v12, v19, 4 bitop3:0x28
    v_lshl_add_u32 v8, v8, 4, s87
    v_mul_u32_u24 v12, 3, v12
    v_xor_b32 v19, v19, v12
    v_mad_u32_u24 v12, v19, s91, v8
    v_mad_u32_u24 v72, v72, s86, v14
    v_mad_u32_u24 v9, v9, s86, v73
    v_mad_u32_u24 v8, v19, s86, v8
    s_add_u32 m0, s90, 0
    v_mov_b32 v19, 0x3f803f80
    s_mov_b32 s46, 20480
    s_mov_b32 s47, 0
    buffer_load_dwordx4 v56, s[32:35], s92 offen offset:0 lds
    v_cmp_eq_u32 vcc, 0, v142
    v_and_b32 v73, 1, v40
    v_lshlrev_b32 v73, 4, v73
    v_cndmask_b32 v220, 0, v19, vcc
    v_cndmask_b32 v221, 0, v19, vcc
    v_cndmask_b32 v222, 0, v19, vcc
    v_cndmask_b32 v223, 0, v19, vcc
    v_mov_b32 v19, 0x3f80
    v_lshlrev_b32 v19, v73, v19
    v_cmp_gt_u32 vcc, 2, v142
    v_mov_b32 v171, 0
    v_mov_b32 v167, 0
    v_cndmask_b32 v216, 0, v19, vcc
    v_cndmask_b32 v218, 0, v19, vcc
    v_cmp_le_u32 vcc, 2, v142
    v_mov_b32 v163, 0
    v_mov_b32 v159, 0
    v_cndmask_b32 v217, 0, v19, vcc
    v_cndmask_b32 v219, 0, v19, vcc
    v_cmp_eq_u32 vcc, v151, v150
    v_mov_b32 v152, 0
    v_mov_b32 v153, 0
    v_cndmask_b32 v146, 0, v216, vcc
    v_cndmask_b32 v147, 0, v217, vcc
    v_mov_b32 v148, 0
    v_mov_b32 v149, 0
    v_mov_b32 v144, 0
    v_mov_b32 v145, 0
    v_mov_b32 v140, 0
    v_mov_b32 v141, 0
    v_lshrrev_b32 v15, 1, v151
    v_lshl_add_u32 v14, v151, 2, v150
    v_lshl_add_u32 v14, v15, 3, v14
    v_mul_u32_u24 v14, 96, v14
    v_add_u32 v14, s90, v14
    v_lshl_add_u32 v15, v142, 4, v14
    v_lshl_add_u32 v14, v142, 3, v14
    s_waitcnt lgkmcnt(0)
    s_lshl_b32 s84, s68, 4
    s_lshr_b64 s[82:83], s[82:83], s84
    s_lshl_b32 s82, s82, 16
    v_mov_b32 v27, s82
    v_min_f32 v27, 0x40930000, v27
    v_max_f32 v27, 0xc2c80000, v27
    v_mul_f32 v27, 0x3fb8aa3b, v27
    v_exp_f32 v27, v27
    v_mov_b32 v26, 0
    v_cvt_pk_bf16_f32 v27, v27, v27
    v_lshlrev_b32 v27, 16, v27
    v_mul_f32 v27, 0x4038aa3b, v27
    v_mov_b32 v19, 0
    v_readfirstlane_b32 s55, v27
    v_add_f32 v27, v27, v27
    v_mul_u32_u24 v155, 5120, v151
    v_readfirstlane_b32 s52, v27
    v_add_u32 v155, v10, v155
    s_mov_b32 s84, 0x41b8aa3b
    v_mov_b32 v10, 0xc138aa3b
    v_mul_u32_u24 v124, 5120, v150
    v_mad_u32_u24 v124, v142, s86, v124
    v_and_b32 v27, 7, v154
    v_xor_b32 v125, v27, v151
    s_mov_b32 s57, s72
    s_mov_b32 s58, 0
    buffer_load_dwordx4 v13, s[32:35], s92 offen offset:1024 lds
    v_lshl_add_u32 v73, v125, 4, v124
    v_xor_b32 v35, 64, v73
    v_add_u32 v139, 40960, v73
    v_xor_b32 v138, 64, v139
    v_add_u32 v124, 61440, v124
    v_add_u32 v125, s93, v151
    v_xor_b32 v125, v27, v125
    s_mov_b32 s59, 0
    s_mov_b32 s60, 0
    buffer_load_dwordx4 v12, s[32:35], s92 offen offset:2048 lds
    s_add_u32 m0, s90, 12288
    s_mov_b32 s92, 36864
    v_lshl_add_u32 v137, v125, 4, v124
    v_lshrrev_b32 v125, 1, v151
    v_add3_u32 v125, v125, s93, 4
    v_xor_b32 v125, v27, v125
    v_lshl_add_u32 v125, v125, 4, v124
    s_add_u32 s93, s54, 20480
    s_mov_b32 s65, -1
    buffer_load_dwordx4 v56, s[32:35], s92 offen offset:0 lds
    s_waitcnt vmcnt(16)
    v_lshl_or_b32 v24, v25, 16, v24
    v_cmp_gt_u32 vcc, 16, v40
    v_mov_b32 v25, 0
    v_and_b32 v124, 1, v151
    v_cndmask_b32 v27, 0, v24, vcc
    v_cndmask_b32 v24, 0, v24, vcc
    v_lshl_add_u32 v136, v124, 3, v125
    v_mfma_f32_16x16x16_bf16 v[0:3], v[26:27], v[16:17], 0
    s_waitcnt vmcnt(14)
    s_mov_b32 s61, 1
    v_lshl_or_b32 v74, v131, 16, v74
    v_lshlrev_b32 v131, 4, v40
    v_mfma_f32_16x16x16_bf16 v[4:7], v[24:25], v[16:17], 0
    s_movk_i32 s4, 336
    v_add_u32 v135, s93, v131
    v_add_u32 v131, 81920, v131
    v_mfma_f32_16x16x16_bf16 v[20:23], v[24:25], v[18:19], 0
    s_waitcnt vmcnt(12)
    s_lshr_b32 s93, s68, 1
    buffer_load_dwordx4 v13, s[32:35], s92 offen offset:1024 lds
    v_lshl_or_b32 v75, v11, 16, v75
    v_max_f32 v0, 0, v0
    v_max_f32 v4, 0, v4
    v_max_f32 v5, 0, v5
    v_max_f32 v6, 0, v6
    v_max_f32 v7, 0, v7
    v_cvt_pk_bf16_f32 v4, v4, v5
    v_cvt_pk_bf16_f32 v5, v6, v7
    v_max_f32 v1, 0, v1
    v_max_f32 v2, 0, v2
    v_mfma_f32_16x16x16_bf16 v[16:19], v[74:75], v[4:5], 0
    s_lshl_b32 s93, s93, 10
    v_max_f32 v3, 0, v3
    v_cvt_pk_bf16_f32 v0, v0, v1
    v_cvt_pk_bf16_f32 v1, v2, v3
    v_max_f32 v20, 0, v20
    v_max_f32 v21, 0, v21
    v_mfma_f32_16x16x16_bf16 v[4:7], v[74:75], v[0:1], 0
    s_add_u32 s93, s93, s94
    v_max_f32 v22, 0, v22
    v_max_f32 v23, 0, v23
    v_cvt_pk_bf16_f32 v20, v20, v21
    v_cvt_pk_bf16_f32 v21, v22, v23
    v_cvt_pk_bf16_f32 v16, v16, v16
    v_lshlrev_b32 v16, 16, v16
    v_mfma_f32_16x16x16_bf16 v[0:3], v[74:75], v[20:21], 0
    s_mov_b32 s5, 0
    v_mul_f32 v16, 0xbfb8aa3b, v16
    v_cvt_pk_bf16_f32 v4, v4, v4
    v_exp_f32 v16, v16
    v_lshlrev_b32 v4, 16, v4
    v_add_f32 v16, 1.0, v16
    v_rcp_f32 v16, v16
    v_mul_f32 v4, 0xbfb8aa3b, v4
    v_cvt_pk_bf16_f32 v16, v16, v16
    v_lshlrev_b32 v16, 16, v16
    v_fma_f32 v16, v16, s84, v10
    s_mov_b32 s6, 0
    s_mov_b32 s12, 0
    ds_write_b32 v155, v16 offset:44032
    v_exp_f32 v4, v4
    v_cvt_pk_bf16_f32 v0, v0, v0
    v_add_f32 v4, 1.0, v4
    v_rcp_f32 v4, v4
    v_lshlrev_b32 v0, 16, v0
    v_cvt_pk_bf16_f32 v4, v4, v4
    v_lshlrev_b32 v4, 16, v4
    v_fma_f32 v4, v4, s84, v10
    s_mov_b32 s64, 3
    s_mov_b32 s10, 81924
    ds_write_b32 v155, v4 offset:44036
    v_mul_f32 v0, 0xbfb8aa3b, v0
    v_exp_f32 v0, v0
    v_add_u32 v132, s93, v131
    v_add_f32 v0, 1.0, v0
    v_rcp_f32 v0, v0
    s_mul_i32 s93, s68, 5376
    v_cvt_pk_bf16_f32 v0, v0, v0
    v_lshlrev_b32 v0, 16, v0
    v_fma_f32 v0, v0, s84, v10
    s_add_u32 s93, s93, 142336
    s_mov_b32 s11, 0x20000
    ds_write_b32 v155, v0 offset:44040
    v_mul_u32_u24 v124, 80, v151
    v_add_u32 v125, s93, v124
    v_mul_u32_u24 v124, 336, v154
    v_add_u32 v34, v124, v125
    v_subrev_u32 v34, 21504, v34
    v_cmp_eq_u32 vcc, 0, v150
    v_mul_u32_u24 v124, 80, v150
    v_lshl_add_u32 v124, v151, 3, v124
    v_cndmask_b32 v134, v143, v125, vcc
    v_cmp_eq_u32 vcc, 3, v142
    v_lshl_add_u32 v124, v142, 1, v124
    v_add_u32 v124, s93, v124
    v_cndmask_b32 v134, v134, v125, vcc
    v_cmp_gt_u32 vcc, 3, v151
    v_mov_b32 v125, v124
    s_add_u32 s93, s69, 1
    v_cndmask_b32 v133, v143, v124, vcc
    s_mul_i32 s94, s93, 58255
    s_lshr_b32 s94, s94, 22
    s_mul_i32 s94, s94, s63
    s_mul_i32 s56, s93, s62
    s_add_u32 s56, s56, s94
    ds_write_b128 v34, v[216:219] offset:21584
    v_mov_b32 v124, 0
    s_sub_u32 s93, s71, 1
    s_cmp_eq_u32 s68, 0
    s_cselect_b32 s13, s93, -1
    s_cmp_gt_u32 s73, 20
    s_cselect_b32 s13, s13, -1
    s_waitcnt lgkmcnt(1)
    s_barrier
    s_and_b32 s93, s2, -8
    s_sub_u32 s93, 81920, s93
    s_sub_u32 s8, s38, s93
    s_subb_u32 s9, s39, 0
    s_mov_b32 s39, 0x00010001
    s_add_u32 s101, s54, 44032
    v_mul_u32_u24 v150, 48, v150
    v_lshl_add_u32 v150, v142, 2, v150
    v_mul_u32_u24 v32, 48, v151
    v_add_u32 v199, 0, v150
    v_mul_u32_u24 v33, 37, v199
    v_lshrrev_b32 v33, 10, v33
    v_mad_u32_u24 v199, v33, 24, v199
    v_add_u32 v199, s101, v199
    v_add_u32 v142, 16, v150
    v_mul_u32_u24 v33, 37, v142
    v_lshrrev_b32 v33, 10, v33
    v_mad_u32_u24 v142, v33, 24, v142
    v_add_u32 v142, s101, v142
    v_add_u32 v41, 32, v150
    v_mul_u32_u24 v33, 37, v41
    v_lshrrev_b32 v33, 10, v33
    v_mad_u32_u24 v41, v33, 24, v41
    v_add_u32 v41, s101, v41
    v_add_u32 v59, 0, v32
    v_mul_u32_u24 v33, 37, v59
    v_lshrrev_b32 v33, 10, v33
    v_mad_u32_u24 v59, v33, 24, v59
    v_add_u32 v57, 4, v32
    v_mul_u32_u24 v33, 37, v57
    v_lshrrev_b32 v33, 10, v33
    v_mad_u32_u24 v57, v33, 24, v57
    v_add_u32 v58, 8, v32
    v_mul_u32_u24 v33, 37, v58
    v_lshrrev_b32 v33, 10, v33
    v_mad_u32_u24 v58, v33, 24, v58
    v_add_u32 v75, 12, v32
    v_mul_u32_u24 v33, 37, v75
    v_lshrrev_b32 v33, 10, v33
    v_mad_u32_u24 v75, v33, 24, v75
    v_add_u32 v74, 16, v32
    v_mul_u32_u24 v33, 37, v74
    v_lshrrev_b32 v33, 10, v33
    v_mad_u32_u24 v74, v33, 24, v74
    v_add_u32 v42, 20, v32
    v_mul_u32_u24 v33, 37, v42
    v_lshrrev_b32 v33, 10, v33
    v_mad_u32_u24 v42, v33, 24, v42
    v_add_u32 v43, 24, v32
    v_mul_u32_u24 v33, 37, v43
    v_lshrrev_b32 v33, 10, v33
    v_mad_u32_u24 v43, v33, 24, v43
    v_add_u32 v179, 28, v32
    v_mul_u32_u24 v33, 37, v179
    v_lshrrev_b32 v33, 10, v33
    v_mad_u32_u24 v179, v33, 24, v179
    v_add_u32 v11, 32, v32
    v_mul_u32_u24 v10, 37, v11
    v_lshrrev_b32 v10, 10, v10
    v_mad_u32_u24 v11, v10, 24, v11
    v_add_u32 v10, 36, v32
    v_mul_u32_u24 v33, 37, v10
    v_lshrrev_b32 v33, 10, v33
    v_mad_u32_u24 v10, v33, 24, v10
    v_add_u32 v155, 40, v32
    s_lshr_b32 s93, s68, 1
    s_mul_i32 s93, s93, 30720
    buffer_load_dwordx4 v12, s[32:35], s92 offen offset:2048 lds
    s_add_u32 m0, s90, 24576
    s_mov_b32 s92, 73728
    ds_read_b32 v208, v199
    v_mul_u32_u24 v33, 37, v155
    v_lshrrev_b32 v33, 10, v33
    v_mad_u32_u24 v155, v33, 24, v155
    v_add_u32 v32, 44, v32
    v_mul_u32_u24 v33, 37, v32
    v_lshrrev_b32 v33, 10, v33
    v_mad_u32_u24 v32, v33, 24, v32
    v_lshl_add_u32 v33, v151, 4, v150
    v_mul_u32_u24 v156, 37, v33
    v_lshrrev_b32 v156, 10, v156
    v_mad_u32_u24 v33, v156, 24, v33
    v_mov_b32 v156, 336
    v_cmp_gt_u32 vcc, 3, v151
    v_sub_u32 v204, v199, v59
    s_and_b32 s94, s68, 1
    v_cndmask_b32 v33, v156, v33, vcc
    v_sub_u32 v33, s101, v33
    s_mul_i32 s94, s94, -2304
    s_add_u32 s93, s93, s94
    buffer_load_dwordx4 v56, s[32:35], s92 offen offset:0 lds
    ds_read_b32 v204, v204 offset:336
    v_sub_u32 v205, v199, v57
    v_sub_u32 v206, v199, v58
    v_sub_u32 v207, v199, v75
    v_sub_u32 v200, v199, v74
    v_sub_u32 v201, v199, v42
    s_lshl_b32 s94, s97, 4
    ds_read_b32 v205, v205 offset:336
    v_sub_u32 v202, v199, v43
    buffer_load_dwordx4 v13, s[32:35], s92 offen offset:1024 lds
    v_sub_u32 v203, v199, v179
    ds_read_b32 v206, v206 offset:336
    v_sub_u32 v196, v199, v11
    v_sub_u32 v197, v199, v10
    v_sub_u32 v198, v199, v155
    v_sub_u32 v199, v199, v32
    v_sub_u32 v192, v142, v59
    ds_read_b32 v207, v207 offset:336
    v_sub_u32 v193, v142, v57
    v_sub_u32 v194, v142, v58
    v_sub_u32 v195, v142, v75
    v_sub_u32 v188, v142, v74
    v_sub_u32 v189, v142, v42
    ds_read_b32 v200, v200 offset:336
    v_sub_u32 v190, v142, v43
    buffer_load_dwordx4 v12, s[32:35], s92 offen offset:2048 lds
    s_add_u32 m0, s90, 36864
    s_mov_b32 s92, 110592
    ds_read_b32 v201, v201 offset:336
    v_sub_u32 v191, v142, v179
    v_sub_u32 v184, v142, v11
    v_sub_u32 v185, v142, v10
    v_sub_u32 v186, v142, v155
    v_sub_u32 v187, v142, v32
    s_waitcnt vmcnt(9)
    s_barrier
    ds_read_b32 v202, v202 offset:336
    v_sub_u32 v180, v41, v59
    v_sub_u32 v181, v41, v57
    v_sub_u32 v182, v41, v58
    v_sub_u32 v183, v41, v75
    v_sub_u32 v176, v41, v74
    ds_read_b32 v203, v203 offset:336
    v_sub_u32 v177, v41, v42
    v_sub_u32 v178, v41, v43
    v_sub_u32 v179, v41, v179
    v_sub_u32 v172, v41, v11
    v_sub_u32 v173, v41, v10
    ds_read_b32 v196, v196 offset:336
    v_sub_u32 v174, v41, v155
    v_sub_u32 v175, v41, v32
    buffer_load_dwordx4 v56, s[32:35], s92 offen offset:0 lds
    ds_read_b32 v197, v197 offset:336
    v_mov_b32 v57, 0xf149f2ca
    v_mov_b32 v58, 0x3f80
    v_mov_b32 v59, 0
    v_mov_b32 v42, 0x3f80
    v_mov_b32 v43, 0
    ds_read_b32 v198, v198 offset:336
    v_and_b32 v155, 8, v154
    v_add_u32 v155, v155, v154
    v_mul_u32_u24 v155, 96, v155
    v_add_u32 v155, s90, v155
    v_lshl_add_u32 v32, v151, 4, v155
    ds_read_b32 v199, v199 offset:336
    buffer_load_dwordx4 v13, s[32:35], s92 offen offset:1024 lds
    v_lshl_add_u32 v75, v151, 3, v155
    v_add_u32 v11, s93, v32
    v_add_u32 v10, s93, v75
    v_lshlrev_b32 v74, 4, v151
    s_lshr_b32 s93, s68, 1
    s_mul_i32 s93, s93, 5120
    ds_read_b32 v211, v33 offset:672
    v_add_u32 v74, 4608, v74
    s_add_u32 s93, s93, s94
    v_add_u32 v33, s93, v74
    v_cmp_eq_u32 vcc, 0, v154
    s_nop 0
    ds_read_b32 v192, v192 offset:336
    v_cndmask_b32 v33, v143, v33, vcc
    buffer_load_dwordx4 v12, s[32:35], s92 offen offset:2048 lds
    s_add_u32 m0, s90, 49152
    s_mov_b32 s92, 147456
    ds_read_b32 v193, v193 offset:336
    ds_read_b32 v194, v194 offset:336
    ds_read_b32 v195, v195 offset:336
    buffer_load_dwordx4 v56, s[32:35], s92 offen offset:0 lds
    ds_read_b32 v188, v188 offset:336
    ds_read_b32 v189, v189 offset:336
    ds_read_b32 v190, v190 offset:336
    ds_read_b32 v191, v191 offset:336
    buffer_load_dwordx4 v13, s[32:35], s92 offen offset:1024 lds
    ds_read_b32 v184, v184 offset:336
    ds_read_b32 v185, v185 offset:336
    ds_read_b32 v186, v186 offset:336
    buffer_load_dwordx4 v12, s[32:35], s92 offen offset:2048 lds
    s_add_u32 m0, s90, 61440
    s_mov_b32 s92, 184320
    ds_read_b32 v187, v187 offset:336
    ds_read_b32 v209, v142
    ds_read_b32 v180, v180 offset:336
    buffer_load_dwordx4 v56, s[32:35], s92 offen offset:0 lds
    ds_read_b32 v181, v181 offset:336
    ds_read_b32 v182, v182 offset:336
    ds_read_b32 v183, v183 offset:336
    ds_read_b32 v176, v176 offset:336
    buffer_load_dwordx4 v13, s[32:35], s92 offen offset:1024 lds
    ds_read_b32 v177, v177 offset:336
    ds_read_b32 v178, v178 offset:336
    ds_read_b32 v179, v179 offset:336
    buffer_load_dwordx4 v12, s[32:35], s92 offen offset:2048 lds
    ds_read_b32 v172, v172 offset:336
    ds_read_b32 v173, v173 offset:336
    ds_read_b32 v174, v174 offset:336
    ds_read_b32 v175, v175 offset:336
    ds_read_b32 v210, v41
    s_waitcnt vmcnt(15)
    ds_read_b64_tr_b16 a[0:1], v14 offset:0
    ds_read_b64_tr_b16 a[2:3], v14 offset:768
    ds_read_b64_tr_b16 a[24:25], v14 offset:32
    ds_read_b64_tr_b16 a[26:27], v14 offset:800
    ds_read_b64_tr_b16 a[48:49], v14 offset:64
    ds_read_b64_tr_b16 a[50:51], v14 offset:832
    s_add_u32 m0, s90, 0
    s_mov_b32 s92, 384
    s_waitcnt vmcnt(12)
    ds_read_b64_tr_b16 a[4:5], v14 offset:12288
    ds_read_b64_tr_b16 a[6:7], v14 offset:13056
    ds_read_b64_tr_b16 a[28:29], v14 offset:12320
    ds_read_b64_tr_b16 a[30:31], v14 offset:13088
    ds_read_b64_tr_b16 a[52:53], v14 offset:12352
    ds_read_b64_tr_b16 a[54:55], v14 offset:13120
    s_waitcnt vmcnt(9)
    ds_read_b64_tr_b16 a[8:9], v14 offset:24576
    ds_read_b64_tr_b16 a[10:11], v14 offset:25344
    ds_read_b64_tr_b16 a[32:33], v14 offset:24608
    s_waitcnt lgkmcnt(15)
    s_cmp_ge_u32 s2, 247
    s_cbranch_scc1 L_maskS
L_nomaskS:
    v_cmp_gt_u32 vcc, 16, v40
    v_readlane_b32 s84, v211, 48
    ds_read_b64_tr_b16 a[34:35], v14 offset:25376
    v_cndmask_b32 v208, v57, v208, vcc
    v_cndmask_b32 v209, v57, v209, vcc
    v_cndmask_b32 v210, v57, v210, vcc
    v_cmp_gt_u32 vcc, 49, v40
    ds_read_b64_tr_b16 a[56:57], v14 offset:24640
    s_waitcnt lgkmcnt(10)
    buffer_load_dwordx4 v56, s[32:35], s92 offen offset:0 lds
    ds_read_b64_tr_b16 a[58:59], v14 offset:25408
    v_cndmask_b32 v211, v57, v211, vcc
    s_waitcnt vmcnt(7)
    ds_read_b64_tr_b16 a[12:13], v14 offset:36864
    ds_read_b64_tr_b16 a[14:15], v14 offset:37632
    buffer_load_dwordx4 v13, s[32:35], s92 offen offset:1024 lds
    ds_read_b64_tr_b16 a[36:37], v14 offset:36896
    ds_read_b64_tr_b16 a[38:39], v14 offset:37664
    ds_read_b64_tr_b16 a[60:61], v14 offset:36928
    ds_read_b64_tr_b16 a[62:63], v14 offset:37696
    buffer_load_dwordx4 v12, s[32:35], s92 offen offset:2048 lds
    s_add_u32 m0, s90, 12288
    s_mov_b32 s92, 37248
    ds_read_b128 v[68:71], v73 offset:40960
    ds_read_b128 v[64:67], v35 offset:40960
    s_waitcnt lgkmcnt(10)
    buffer_load_dwordx4 v56, s[32:35], s92 offen offset:0 lds
    ds_read_b128 v[60:63], v73 offset:41088
    ds_read_b128 v[48:51], v35 offset:41088
    buffer_load_dwordx4 v13, s[32:35], s92 offen offset:1024 lds
    ds_read_b128 v[44:47], v73 offset:41216
    ds_read_b128 v[28:31], v35 offset:41216
    buffer_load_dwordx4 v12, s[32:35], s92 offen offset:2048 lds
    s_add_u32 m0, s90, 24576
    s_mov_b32 s92, 74112
    s_waitcnt vmcnt(9)
    ds_read_b64_tr_b16 a[16:17], v14 offset:49152
    ds_read_b64_tr_b16 a[18:19], v14 offset:49920
    ds_read_b64_tr_b16 a[40:41], v14 offset:49184
    ds_read_b64_tr_b16 a[42:43], v14 offset:49952
    ds_read_b64_tr_b16 a[64:65], v14 offset:49216
    ds_read_b64_tr_b16 a[66:67], v14 offset:49984
    s_waitcnt lgkmcnt(9)
    buffer_load_dwordx4 v56, s[32:35], s92 offen offset:0 lds
    buffer_load_dwordx4 v13, s[32:35], s92 offen offset:1024 lds
    buffer_load_dwordx4 v12, s[32:35], s92 offen offset:2048 lds
    s_add_u32 m0, s90, 36864
    s_mov_b32 s92, 110976
    s_waitcnt vmcnt(9)
    ds_read_b64_tr_b16 a[20:21], v14 offset:61440
    ds_read_b64_tr_b16 a[22:23], v14 offset:62208
    v_mfma_f32_16x16x32_bf16 v[92:95], a[0:3], v[68:71], 0
    ds_read_b64_tr_b16 a[44:45], v14 offset:61472
    v_mfma_f32_16x16x32_bf16 v[92:95], a[4:7], v[64:67], v[92:95]
    ds_read_b64_tr_b16 a[46:47], v14 offset:62240
    v_mfma_f32_16x16x32_bf16 v[92:95], a[8:11], v[60:63], v[92:95]
    s_waitcnt lgkmcnt(4)
    ds_read_b64_tr_b16 a[68:69], v14 offset:61504
    v_mfma_f32_16x16x32_bf16 v[92:95], a[12:15], v[48:51], v[92:95]
    ds_read_b64_tr_b16 a[70:71], v14 offset:62272
    v_mfma_f32_16x16x32_bf16 v[92:95], a[16:19], v[44:47], v[92:95]
    ds_read_b128 v[24:27], v73 offset:42496
    ds_read_b128 v[20:23], v35 offset:42496
    ds_read_b128 v[16:19], v73 offset:42624
    ds_read_b128 v[52:55], v35 offset:42624
    s_waitcnt lgkmcnt(7)
    v_mfma_f32_16x16x32_bf16 v[92:95], a[20:23], v[28:31], v[92:95]
    ds_read_b128 v[4:7], v73 offset:42752
    s_nop 0
    v_mfma_f32_16x16x32_bf16 v[100:103], a[24:27], v[68:71], 0
    s_nop 0
    ds_read_b128 v[0:3], v35 offset:42752
    s_nop 0
    v_mfma_f32_16x16x32_bf16 v[100:103], a[28:31], v[64:67], v[100:103]
    s_nop 0
    v_fma_f32 v41, v92, v92, s41
    v_fmac_f32 v41, v93, v93
    v_mfma_f32_16x16x32_bf16 v[100:103], a[32:35], v[60:63], v[100:103]
    v_fmac_f32 v41, v94, v94
    v_fmac_f32 v41, v95, v95
    v_mfma_f32_16x16x32_bf16 v[100:103], a[36:39], v[48:51], v[100:103]
    v_mfma_f32_16x16x32_bf16 v[100:103], a[40:43], v[44:47], v[100:103]
    s_waitcnt lgkmcnt(4)
    v_mfma_f32_16x16x32_bf16 v[100:103], a[44:47], v[28:31], v[100:103]
    s_nop 0
    v_mfma_f32_16x16x32_bf16 v[96:99], a[48:51], v[68:71], 0
    s_nop 2
    v_mfma_f32_16x16x32_bf16 v[96:99], a[52:55], v[64:67], v[96:99]
    s_nop 0
    buffer_load_dwordx4 v56, s[32:35], s92 offen offset:0 lds
    v_fmac_f32 v41, v100, v100
    v_mfma_f32_16x16x32_bf16 v[96:99], a[56:59], v[60:63], v[96:99]
    v_fmac_f32 v41, v101, v101
    v_fmac_f32 v41, v102, v102
    v_mfma_f32_16x16x32_bf16 v[96:99], a[60:63], v[48:51], v[96:99]
    v_fmac_f32 v41, v103, v103
    v_mfma_f32_16x16x32_bf16 v[96:99], a[64:67], v[44:47], v[96:99]
    v_mfma_f32_16x16x32_bf16 v[96:99], a[68:71], v[28:31], v[96:99]
    s_nop 0
    v_mfma_f32_16x16x32_bf16 v[48:51], a[0:3], v[24:27], 0
    s_nop 0
    buffer_load_dwordx4 v13, s[32:35], s92 offen offset:1024 lds
    s_nop 0
    v_mfma_f32_16x16x32_bf16 v[48:51], a[4:7], v[20:23], v[48:51]
    s_waitcnt lgkmcnt(0)
    s_nop 0
    v_fmac_f32 v41, v96, v96
    v_fmac_f32 v41, v97, v97
    v_mfma_f32_16x16x32_bf16 v[48:51], a[8:11], v[16:19], v[48:51]
    v_fmac_f32 v41, v98, v98
    v_fmac_f32 v41, v99, v99
    v_mfma_f32_16x16x32_bf16 v[48:51], a[12:15], v[52:55], v[48:51]
    ds_read_b128 v[108:111], v73 offset:40960
    v_mfma_f32_16x16x32_bf16 v[48:51], a[16:19], v[4:7], v[48:51]
    ds_read_b128 v[80:83], v35 offset:40960
    v_mfma_f32_16x16x32_bf16 v[48:51], a[20:23], v[0:3], v[48:51]
    s_waitcnt vmcnt(8)
    buffer_load_dwordx4 v12, s[32:35], s92 offen offset:2048 lds
    ds_read_b64_tr_b16 a[72:73], v14 offset:0
    v_mfma_f32_16x16x32_bf16 v[44:47], a[24:27], v[24:27], 0
    s_add_u32 m0, s90, 49152
    ds_read_b64_tr_b16 a[74:75], v14 offset:768
    v_mfma_f32_16x16x32_bf16 v[44:47], a[28:31], v[20:23], v[44:47]
    s_mov_b32 s92, 147840
    ds_read_b64_tr_b16 a[96:97], v14 offset:32
    v_fma_f32 v40, v48, v48, s41
    v_mfma_f32_16x16x32_bf16 v[44:47], a[32:35], v[16:19], v[44:47]
    ds_read_b64_tr_b16 a[98:99], v14 offset:800
    v_fmac_f32 v40, v49, v49
    v_mfma_f32_16x16x32_bf16 v[44:47], a[36:39], v[52:55], v[44:47]
    ds_read_b64_tr_b16 a[120:121], v14 offset:64
    v_fmac_f32 v40, v50, v50
    v_mfma_f32_16x16x32_bf16 v[44:47], a[40:43], v[4:7], v[44:47]
    buffer_load_dwordx4 v56, s[32:35], s92 offen offset:0 lds
    ds_read_b64_tr_b16 a[122:123], v14 offset:832
    v_mfma_f32_16x16x32_bf16 v[44:47], a[44:47], v[0:3], v[44:47]
    ds_read_b128 v[76:79], v73 offset:41088
    v_fmac_f32 v40, v51, v51
    v_mfma_f32_16x16x32_bf16 v[28:31], a[48:51], v[24:27], 0
    ds_read_b128 v[24:27], v35 offset:41088
    s_nop 0
    v_mfma_f32_16x16x32_bf16 v[28:31], a[52:55], v[20:23], v[28:31]
    s_nop 0
    ds_read_b128 v[20:23], v73 offset:41216
    v_fmac_f32 v40, v44, v44
    v_mfma_f32_16x16x32_bf16 v[28:31], a[56:59], v[16:19], v[28:31]
    ds_read_b128 v[16:19], v35 offset:41216
    v_fmac_f32 v40, v45, v45
    v_mfma_f32_16x16x32_bf16 v[28:31], a[60:63], v[52:55], v[28:31]
    buffer_load_dwordx4 v13, s[32:35], s92 offen offset:1024 lds
    v_fmac_f32 v40, v46, v46
    v_mfma_f32_16x16x32_bf16 v[28:31], a[64:67], v[4:7], v[28:31]
    v_fmac_f32 v40, v47, v47
    v_mfma_f32_16x16x32_bf16 v[28:31], a[68:71], v[0:3], v[28:31]
    s_nop 7
    v_fmac_f32 v40, v28, v28
    v_fmac_f32 v40, v29, v29
    v_fmac_f32 v40, v30, v30
    v_fmac_f32 v40, v31, v31
    buffer_load_dwordx4 v12, s[32:35], s92 offen offset:2048 lds
    s_add_u32 m0, s90, 61440
    s_mov_b32 s92, 184704
    s_waitcnt vmcnt(9)
    ds_read_b64_tr_b16 a[76:77], v14 offset:12288
    ds_read_b64_tr_b16 a[78:79], v14 offset:13056
    ds_read_b64_tr_b16 a[100:101], v14 offset:12320
    ds_read_b64_tr_b16 a[102:103], v14 offset:13088
    ds_read_b64_tr_b16 a[124:125], v14 offset:12352
    ds_read_b64_tr_b16 a[126:127], v14 offset:13120
    buffer_load_dwordx4 v56, s[32:35], s92 offen offset:0 lds
    buffer_load_dwordx4 v13, s[32:35], s92 offen offset:1024 lds
    buffer_load_dwordx4 v12, s[32:35], s92 offen offset:2048 lds
    s_add_u32 m0, s90, 0
    s_mov_b32 s92, 768
    s_waitcnt vmcnt(9)
    ds_read_b64_tr_b16 a[80:81], v14 offset:24576
    ds_read_b64_tr_b16 a[82:83], v14 offset:25344
    ds_read_b64_tr_b16 a[104:105], v14 offset:24608
    ds_read_b64_tr_b16 a[106:107], v14 offset:25376
    ds_read_b64_tr_b16 a[128:129], v14 offset:24640
    ds_read_b64_tr_b16 a[130:131], v14 offset:25408
    s_waitcnt lgkmcnt(6)
    buffer_load_dwordx4 v56, s[32:35], s92 offen offset:0 lds
    buffer_load_dwordx4 v13, s[32:35], s92 offen offset:1024 lds
    buffer_load_dwordx4 v12, s[32:35], s92 offen offset:2048 lds
    s_add_u32 m0, s90, 12288
    s_mov_b32 s92, 37632
    s_waitcnt vmcnt(9)
    ds_read_b64_tr_b16 a[84:85], v14 offset:36864
    ds_read_b64_tr_b16 a[86:87], v14 offset:37632
    ds_read_b64_tr_b16 a[108:109], v14 offset:36896
    ds_read_b64_tr_b16 a[110:111], v14 offset:37664
    ds_read_b64_tr_b16 a[132:133], v14 offset:36928
    ds_read_b64_tr_b16 a[134:135], v14 offset:37696
    buffer_load_dwordx4 v56, s[32:35], s92 offen offset:0 lds
    buffer_load_dwordx4 v13, s[32:35], s92 offen offset:1024 lds
    buffer_load_dwordx4 v12, s[32:35], s92 offen offset:2048 lds
    s_add_u32 m0, s90, 24576
    s_mov_b32 s92, 74496
    s_waitcnt vmcnt(9)
    ds_read_b64_tr_b16 a[88:89], v14 offset:49152
    ds_read_b64_tr_b16 a[90:91], v14 offset:49920
    ds_read_b64_tr_b16 a[112:113], v14 offset:49184
    ds_read_b64_tr_b16 a[114:115], v14 offset:49952
    ds_read_b64_tr_b16 a[136:137], v14 offset:49216
    ds_read_b64_tr_b16 a[138:139], v14 offset:49984
    s_waitcnt lgkmcnt(6)
    buffer_load_dwordx4 v56, s[32:35], s92 offen offset:0 lds
    buffer_load_dwordx4 v13, s[32:35], s92 offen offset:1024 lds
    buffer_load_dwordx4 v12, s[32:35], s92 offen offset:2048 lds
    s_add_u32 m0, s90, 36864
    s_mov_b32 s92, 111360
    s_waitcnt vmcnt(9)
    ds_read_b64_tr_b16 a[92:93], v14 offset:61440
    ds_read_b64_tr_b16 a[94:95], v14 offset:62208
    v_mfma_f32_16x16x32_bf16 v[52:55], a[72:75], v[108:111], 0
    ds_read_b64_tr_b16 a[116:117], v14 offset:61472
    v_mfma_f32_16x16x32_bf16 v[52:55], a[76:79], v[80:83], v[52:55]
    ds_read_b64_tr_b16 a[118:119], v14 offset:62240
    v_mfma_f32_16x16x32_bf16 v[52:55], a[80:83], v[76:79], v[52:55]
    ds_read_b64_tr_b16 a[140:141], v14 offset:61504
    v_mfma_f32_16x16x32_bf16 v[52:55], a[84:87], v[24:27], v[52:55]
    s_waitcnt lgkmcnt(5)
    buffer_load_dwordx4 v56, s[32:35], s92 offen offset:0 lds
    ds_read_b64_tr_b16 a[142:143], v14 offset:62272
    v_mfma_f32_16x16x32_bf16 v[52:55], a[88:91], v[20:23], v[52:55]
    ds_read_b128 v[104:107], v73 offset:42496
    ds_read_b128 v[84:87], v35 offset:42496
    ds_read_b128 v[68:71], v73 offset:42624
    ds_read_b128 v[64:67], v35 offset:42624
    s_waitcnt lgkmcnt(7)
    v_mfma_f32_16x16x32_bf16 v[52:55], a[92:95], v[16:19], v[52:55]
    buffer_load_dwordx4 v13, s[32:35], s92 offen offset:1024 lds
    ds_read_b128 v[60:63], v73 offset:42752
    v_mfma_f32_16x16x32_bf16 v[88:91], a[96:99], v[108:111], 0
    s_nop 1
    ds_read_b128 v[0:3], v35 offset:42752
    v_mfma_f32_16x16x32_bf16 v[88:91], a[100:103], v[80:83], v[88:91]
    s_nop 0
    v_fma_f32 v57, v52, v52, s41
    v_fmac_f32 v57, v53, v53
    v_mfma_f32_16x16x32_bf16 v[88:91], a[104:107], v[76:79], v[88:91]
    v_fmac_f32 v57, v54, v54
    v_fmac_f32 v57, v55, v55
    v_mfma_f32_16x16x32_bf16 v[88:91], a[108:111], v[24:27], v[88:91]
    v_mfma_f32_16x16x32_bf16 v[88:91], a[112:115], v[20:23], v[88:91]
    s_waitcnt vmcnt(8) lgkmcnt(4)
    buffer_load_dwordx4 v12, s[32:35], s92 offen offset:2048 lds
    ds_read_b64_tr_b16 a[144:145], v15 offset:0
    v_mfma_f32_16x16x32_bf16 v[88:91], a[116:119], v[16:19], v[88:91]
    s_add_u32 m0, s90, 49152
    ds_read_b64_tr_b16 a[146:147], v15 offset:768
    v_mfma_f32_16x16x32_bf16 v[4:7], a[120:123], v[108:111], 0
    s_mov_b32 s92, 148224
    s_nop 0
    ds_read_b64_tr_b16 a[168:169], v15 offset:8
    v_mfma_f32_16x16x32_bf16 v[4:7], a[124:127], v[80:83], v[4:7]
    s_nop 0
    v_fmac_f32 v57, v88, v88
    v_fmac_f32 v57, v89, v89
    v_mfma_f32_16x16x32_bf16 v[4:7], a[128:131], v[76:79], v[4:7]
    ds_read_b64_tr_b16 a[170:171], v15 offset:776
    v_fmac_f32 v57, v90, v90
    v_mfma_f32_16x16x32_bf16 v[4:7], a[132:135], v[24:27], v[4:7]
    buffer_load_dwordx4 v56, s[32:35], s92 offen offset:0 lds
    ds_read_b64_tr_b16 a[192:193], v14 offset:64
    v_mfma_f32_16x16x32_bf16 v[4:7], a[136:139], v[20:23], v[4:7]
    ds_read_b64_tr_b16 a[194:195], v14 offset:832
    v_fmac_f32 v57, v91, v91
    v_mfma_f32_16x16x32_bf16 v[4:7], a[140:143], v[16:19], v[4:7]
    s_nop 0
    v_mfma_f32_16x16x32_bf16 v[16:19], a[72:75], v[104:107], 0
    s_nop 2
    v_mfma_f32_16x16x32_bf16 v[16:19], a[76:79], v[84:87], v[16:19]
    s_waitcnt lgkmcnt(5)
    s_nop 0
    v_fmac_f32 v57, v4, v4
    v_fmac_f32 v57, v5, v5
    v_mfma_f32_16x16x32_bf16 v[16:19], a[80:83], v[68:71], v[16:19]
    buffer_load_dwordx4 v13, s[32:35], s92 offen offset:1024 lds
    v_fmac_f32 v57, v6, v6
    v_mfma_f32_16x16x32_bf16 v[16:19], a[84:87], v[64:67], v[16:19]
    v_fmac_f32 v57, v7, v7
    v_cvt_pk_bf16_f32 v170, v41, v57
    v_mfma_f32_16x16x32_bf16 v[16:19], a[88:91], v[60:63], v[16:19]
    v_mfma_f32_16x16x32_bf16 v[16:19], a[92:95], v[0:3], v[16:19]
    ds_read_b128 v[80:83], v73 offset:40960
    v_mfma_f32_16x16x32_bf16 v[24:27], a[96:99], v[104:107], 0
    ds_read_b128 v[76:79], v35 offset:40960
    v_mfma_f32_16x16x32_bf16 v[24:27], a[100:103], v[84:87], v[24:27]
    s_waitcnt vmcnt(8)
    buffer_load_dwordx4 v12, s[32:35], s92 offen offset:2048 lds
    ds_read_b64_tr_b16 a[148:149], v15 offset:12288
    v_mfma_f32_16x16x32_bf16 v[24:27], a[104:107], v[68:71], v[24:27]
    s_add_u32 m0, s90, 61440
    v_fma_f32 v41, v16, v16, s41
    v_fmac_f32 v41, v17, v17
    v_mfma_f32_16x16x32_bf16 v[24:27], a[108:111], v[64:67], v[24:27]
    s_mov_b32 s92, 185088
    ds_read_b64_tr_b16 a[150:151], v15 offset:13056
    v_fmac_f32 v41, v18, v18
    v_mfma_f32_16x16x32_bf16 v[24:27], a[112:115], v[60:63], v[24:27]
    ds_read_b64_tr_b16 a[172:173], v15 offset:12296
    v_fmac_f32 v41, v19, v19
    v_mfma_f32_16x16x32_bf16 v[24:27], a[116:119], v[0:3], v[24:27]
    ds_read_b64_tr_b16 a[174:175], v15 offset:13064
    v_mfma_f32_16x16x32_bf16 v[20:23], a[120:123], v[104:107], 0
    s_nop 0
    buffer_load_dwordx4 v56, s[32:35], s92 offen offset:0 lds
    ds_read_b64_tr_b16 a[196:197], v14 offset:12352
    v_mfma_f32_16x16x32_bf16 v[20:23], a[124:127], v[84:87], v[20:23]
    s_nop 0
    ds_read_b64_tr_b16 a[198:199], v14 offset:13120
    v_fmac_f32 v41, v24, v24
    v_mfma_f32_16x16x32_bf16 v[20:23], a[128:131], v[68:71], v[20:23]
    ds_read_b128 v[68:71], v73 offset:41088
    v_fmac_f32 v41, v25, v25
    v_mfma_f32_16x16x32_bf16 v[20:23], a[132:135], v[64:67], v[20:23]
    ds_read_b128 v[64:67], v35 offset:41088
    v_fmac_f32 v41, v26, v26
    v_mfma_f32_16x16x32_bf16 v[20:23], a[136:139], v[60:63], v[20:23]
    ds_read_b128 v[60:63], v73 offset:41216
    v_fmac_f32 v41, v27, v27
    v_mfma_f32_16x16x32_bf16 v[20:23], a[140:143], v[0:3], v[20:23]
    s_nop 0
    buffer_load_dwordx4 v13, s[32:35], s92 offen offset:1024 lds
    ds_read_b128 v[0:3], v35 offset:41216
    v_mfma_f32_16x16x16_bf16 v[84:87], v[216:217], v[170:171], 0
    s_nop 3
    v_fmac_f32 v41, v20, v20
    v_fmac_f32 v41, v21, v21
    v_fmac_f32 v41, v22, v22
    v_fmac_f32 v41, v23, v23
    v_rsq_f32 v84, v84
    v_rsq_f32 v85, v85
    v_mul_f32 v84, s55, v84
    v_mul_f32 v85, 0.5, v85
    v_mul_f32 v92, v92, v84
    buffer_load_dwordx4 v12, s[32:35], s92 offen offset:2048 lds
    s_add_u32 m0, s90, 0
    s_mov_b32 s92, 0
    s_waitcnt vmcnt(9)
    ds_read_b64_tr_b16 a[152:153], v15 offset:24576
    v_mul_f32 v93, v93, v84
    v_cvt_pk_f16_f32 v92, v92, v93
    v_mul_f32 v94, v94, v84
    ds_read_b64_tr_b16 a[154:155], v15 offset:25344
    v_mul_f32 v95, v95, v84
    v_cvt_pk_f16_f32 v93, v94, v95
    v_mul_f32 v100, v100, v84
    ds_read_b64_tr_b16 a[176:177], v15 offset:24584
    v_mul_f32 v101, v101, v84
    v_cvt_pk_f16_f32 v94, v100, v101
    s_waitcnt lgkmcnt(3)
    buffer_load_dwordx4 v72, s[76:79], s92 offen offset:0 lds
    ds_read_b64_tr_b16 a[178:179], v15 offset:25352
    v_mul_f32 v102, v102, v84
    v_mul_f32 v103, v103, v84
    v_cvt_pk_f16_f32 v95, v102, v103
    ds_read_b64_tr_b16 a[200:201], v14 offset:24640
    v_mul_f32 v96, v96, v84
    ds_read_b64_tr_b16 a[202:203], v14 offset:25408
    v_mul_f32 v97, v97, v84
    v_cvt_pk_f16_f32 v56, v96, v97
    v_mul_f32 v98, v98, v84
    v_mul_f32 v99, v99, v84
    v_cvt_pk_f16_f32 v57, v98, v99
    v_mul_f32 v52, v52, v85
    buffer_load_dwordx4 v9, s[76:79], s92 offen offset:1024 lds
    ds_write_b128 v34, v[92:95] offset:21504
    v_mul_f32 v53, v53, v85
    v_cvt_pk_f16_f32 v52, v52, v53
    v_mul_f32 v54, v54, v85
    v_mul_f32 v55, v55, v85
    v_cvt_pk_f16_f32 v53, v54, v55
    v_mul_f32 v88, v88, v85
    v_mul_f32 v89, v89, v85
    v_cvt_pk_f16_f32 v54, v88, v89
    v_mul_f32 v90, v90, v85
    v_mul_f32 v91, v91, v85
    v_cvt_pk_f16_f32 v55, v90, v91
    v_mul_f32 v4, v4, v85
    buffer_load_dwordx4 v8, s[76:79], s92 offen offset:2048 lds
    s_add_u32 m0, s90, 12288
    s_mov_b32 s92, 12288
    s_waitcnt vmcnt(9)
    ds_read_b64_tr_b16 a[156:157], v15 offset:36864
    v_mul_f32 v5, v5, v85
    v_cvt_pk_f16_f32 v12, v4, v5
    v_mul_f32 v6, v6, v85
    ds_read_b64_tr_b16 a[158:159], v15 offset:37632
    v_mul_f32 v7, v7, v85
    v_cvt_pk_f16_f32 v13, v6, v7
    v_cvt_pk_bf16_f32 v170, v40, v41
    ds_read_b64_tr_b16 a[180:181], v15 offset:36872
    s_nop 0
    v_mfma_f32_16x16x16_bf16 v[4:7], v[216:217], v[170:171], 0
    buffer_load_dwordx4 v72, s[76:79], s92 offen offset:0 lds
    ds_read_b64_tr_b16 a[182:183], v15 offset:37640
    s_nop 2
    ds_read_b64_tr_b16 a[204:205], v14 offset:36928
    s_nop 0
    ds_read_b64_tr_b16 a[206:207], v14 offset:37696
    v_rsq_f32 v4, v4
    ds_write_b128 v34, v[56:59] offset:21520
    v_rsq_f32 v5, v5
    buffer_load_dwordx4 v9, s[76:79], s92 offen offset:1024 lds
    v_mul_f32 v4, s55, v4
    v_mul_f32 v5, 0.5, v5
    v_mul_f32 v48, v48, v4
    ds_write_b128 v34, v[52:55] offset:21536
    v_mul_f32 v49, v49, v4
    v_cvt_pk_f16_f32 v88, v48, v49
    v_mul_f32 v50, v50, v4
    v_mul_f32 v51, v51, v4
    v_cvt_pk_f16_f32 v89, v50, v51
    v_mul_f32 v44, v44, v4
    v_mul_f32 v45, v45, v4
    buffer_load_dwordx4 v8, s[76:79], s92 offen offset:2048 lds
    s_add_u32 m0, s90, 24576
    s_mov_b32 s92, 24576
    s_waitcnt vmcnt(9)
    ds_read_b64_tr_b16 a[160:161], v15 offset:49152
    v_cvt_pk_f16_f32 v90, v44, v45
    v_mul_f32 v46, v46, v4
    v_mul_f32 v47, v47, v4
    ds_read_b64_tr_b16 a[162:163], v15 offset:49920
    v_cvt_pk_f16_f32 v91, v46, v47
    v_mul_f32 v28, v28, v4
    v_mul_f32 v29, v29, v4
    ds_read_b64_tr_b16 a[184:185], v15 offset:49160
    v_cvt_pk_f16_f32 v40, v28, v29
    v_mul_f32 v30, v30, v4
    s_waitcnt lgkmcnt(3)
    buffer_load_dwordx4 v72, s[76:79], s92 offen offset:0 lds
    ds_read_b64_tr_b16 a[186:187], v15 offset:49928
    v_mul_f32 v31, v31, v4
    v_cvt_pk_f16_f32 v41, v30, v31
    v_mul_f32 v16, v16, v5
    ds_read_b64_tr_b16 a[208:209], v14 offset:49216
    v_mul_f32 v17, v17, v5
    ds_read_b64_tr_b16 a[210:211], v14 offset:49984
    v_cvt_pk_f16_f32 v16, v16, v17
    ds_write_b64 v34, v[12:13] offset:21552
    buffer_load_dwordx4 v9, s[76:79], s92 offen offset:1024 lds
    v_mul_f32 v18, v18, v5
    v_mul_f32 v19, v19, v5
    v_cvt_pk_f16_f32 v17, v18, v19
    v_mul_f32 v24, v24, v5
    v_mul_f32 v25, v25, v5
    v_cvt_pk_f16_f32 v18, v24, v25
    v_mul_f32 v26, v26, v5
    v_mul_f32 v27, v27, v5
    v_cvt_pk_f16_f32 v19, v26, v27
    v_mul_f32 v20, v20, v5
    v_mul_f32 v21, v21, v5
    v_cvt_pk_f16_f32 v12, v20, v21
    v_mul_f32 v22, v22, v5
    v_mul_f32 v23, v23, v5
    v_cvt_pk_f16_f32 v13, v22, v23
    buffer_load_dwordx4 v8, s[76:79], s92 offen offset:2048 lds
    s_add_u32 m0, s90, 36864
    s_mov_b32 s92, 36864
    s_waitcnt vmcnt(9)
    ds_read_b64_tr_b16 a[164:165], v15 offset:61440
    ds_read_b64_tr_b16 a[166:167], v15 offset:62208
    v_mfma_f32_16x16x32_bf16 v[56:59], a[144:147], v[80:83], 0
    ds_read_b64_tr_b16 a[188:189], v15 offset:61448
    v_mfma_f32_16x16x32_bf16 v[56:59], a[148:151], v[76:79], v[56:59]
    ds_read_b64_tr_b16 a[190:191], v15 offset:62216
    v_mfma_f32_16x16x32_bf16 v[56:59], a[152:155], v[68:71], v[56:59]
    ds_read_b64_tr_b16 a[212:213], v14 offset:61504
    v_mfma_f32_16x16x32_bf16 v[56:59], a[156:159], v[64:67], v[56:59]
    s_waitcnt lgkmcnt(5)
    buffer_load_dwordx4 v72, s[76:79], s92 offen offset:0 lds
    ds_read_b64_tr_b16 a[214:215], v14 offset:62272
    v_mfma_f32_16x16x32_bf16 v[56:59], a[160:163], v[60:63], v[56:59]
    ds_read_b128 v[52:55], v73 offset:42496
    ds_read_b128 v[48:51], v35 offset:42496
    ds_read_b128 v[44:47], v73 offset:42624
    ds_read_b128 v[28:31], v35 offset:42624
    buffer_load_dwordx4 v9, s[76:79], s92 offen offset:1024 lds
    s_waitcnt lgkmcnt(8)
    v_mfma_f32_16x16x32_bf16 v[56:59], a[164:167], v[0:3], v[56:59]
    ds_read_b128 v[24:27], v73 offset:42752
    s_nop 0
    v_mfma_f32_16x16x32_bf16 v[4:7], a[168:171], v[80:83], 0
    s_nop 0
    ds_read_b128 v[20:23], v35 offset:42752
    s_nop 0
    v_mfma_f32_16x16x32_bf16 v[4:7], a[172:175], v[76:79], v[4:7]
    s_nop 0
    v_cvt_pk_bf16_f32 v14, v56, v57
    v_cvt_pk_bf16_f32 v15, v58, v59
    v_mfma_f32_16x16x32_bf16 v[4:7], a[176:179], v[68:71], v[4:7]
    ds_write_b64 v34, v[14:15] offset:21560
    v_mfma_f32_16x16x32_bf16 v[4:7], a[180:183], v[64:67], v[4:7]
    s_lshl_b32 s93, s68, 10
    buffer_load_dwordx4 v8, s[76:79], s92 offen offset:2048 lds
    v_add_u32 v35, s93, v131
    v_mfma_f32_16x16x32_bf16 v[4:7], a[184:187], v[60:63], v[4:7]
    s_waitcnt lgkmcnt(5)
    s_add_u32 m0, s90, 49152
    v_mfma_f32_16x16x32_bf16 v[4:7], a[188:191], v[0:3], v[4:7]
    s_mov_b32 s92, 49152
    s_nop 0
    v_mfma_f32_16x16x32_bf16 v[56:59], a[192:195], v[80:83], 0
    s_mov_b32 s53, s47
    s_nop 1
    v_mfma_f32_16x16x32_bf16 v[56:59], a[196:199], v[76:79], v[56:59]
    s_mov_b32 s47, s46
    v_cvt_pk_bf16_f32 v4, v4, v5
    v_cvt_pk_bf16_f32 v5, v6, v7
    v_mfma_f32_16x16x32_bf16 v[56:59], a[200:203], v[68:71], v[56:59]
    s_mov_b32 s46, s45
    buffer_load_dwordx4 v72, s[76:79], s92 offen offset:0 lds
    v_mfma_f32_16x16x32_bf16 v[56:59], a[204:207], v[64:67], v[56:59]
    s_mov_b32 s45, s44
    v_mfma_f32_16x16x32_bf16 v[56:59], a[208:211], v[60:63], v[56:59]
    s_mov_b32 s44, s53
    v_mfma_f32_16x16x32_bf16 v[56:59], a[212:215], v[0:3], v[56:59]
    s_sub_u32 s48, s44, s46
    v_add_u32 v139, s48, v139
    v_add_u32 v138, s48, v138
    v_mfma_f32_16x16x32_bf16 v[0:3], a[144:147], v[52:55], 0
    s_sub_u32 s49, s46, s45
    v_mfma_f32_16x16x32_bf16 v[0:3], a[148:151], v[48:51], v[0:3]
    s_waitcnt lgkmcnt(0)
    buffer_load_dwordx4 v9, s[76:79], s92 offen offset:1024 lds
    v_cvt_pk_bf16_f32 v6, v56, v57
    v_mfma_f32_16x16x32_bf16 v[0:3], a[152:155], v[44:47], v[0:3]
    v_cvt_pk_bf16_f32 v7, v58, v59
    v_mfma_f32_16x16x32_bf16 v[0:3], a[156:159], v[28:31], v[0:3]
    ds_write_b128 v34, v[4:7] offset:21568
    v_mfma_f32_16x16x32_bf16 v[0:3], a[160:163], v[24:27], v[0:3]
    v_mfma_f32_16x16x32_bf16 v[0:3], a[164:167], v[20:23], v[0:3]
    buffer_load_dwordx4 v8, s[76:79], s92 offen offset:2048 lds
    s_nop 0
    v_mfma_f32_16x16x32_bf16 v[4:7], a[168:171], v[52:55], 0
    s_add_u32 m0, s90, 61440
    s_nop 1
    v_mfma_f32_16x16x32_bf16 v[4:7], a[172:175], v[48:51], v[4:7]
    s_mov_b32 s92, 61440
    v_cvt_pk_bf16_f32 v14, v0, v1
    v_cvt_pk_bf16_f32 v15, v2, v3
    v_mfma_f32_16x16x32_bf16 v[4:7], a[176:179], v[44:47], v[4:7]
    v_mfma_f32_16x16x32_bf16 v[4:7], a[180:183], v[28:31], v[4:7]
    v_mfma_f32_16x16x32_bf16 v[4:7], a[184:187], v[24:27], v[4:7]
    buffer_load_dwordx4 v72, s[76:79], s92 offen offset:0 lds
    v_mfma_f32_16x16x32_bf16 v[4:7], a[188:191], v[20:23], v[4:7]
    s_nop 1
    v_mfma_f32_16x16x32_bf16 v[0:3], a[192:195], v[52:55], 0
    s_nop 2
    v_mfma_f32_16x16x32_bf16 v[0:3], a[196:199], v[48:51], v[0:3]
    s_nop 0
    v_cvt_pk_bf16_f32 v4, v4, v5
    v_cvt_pk_bf16_f32 v5, v6, v7
    v_mfma_f32_16x16x32_bf16 v[0:3], a[200:203], v[44:47], v[0:3]
    v_mfma_f32_16x16x32_bf16 v[0:3], a[204:207], v[28:31], v[0:3]
    buffer_load_dwordx4 v9, s[76:79], s92 offen offset:1024 lds
    v_mfma_f32_16x16x32_bf16 v[0:3], a[208:211], v[24:27], v[0:3]
    v_mfma_f32_16x16x32_bf16 v[0:3], a[212:215], v[20:23], v[0:3]
    s_nop 7
    v_cvt_pk_bf16_f32 v6, v0, v1
    v_cvt_pk_bf16_f32 v7, v2, v3
    buffer_load_dwordx4 v8, s[76:79], s92 offen offset:2048 lds
    s_add_u32 m0, s54, 20480
    s_nop 0
    buffer_load_dwordx4 v130, s[24:27], s56 offen nt lds
    s_add_u32 m0, s54, 21504
    s_nop 0
    buffer_load_dwordx4 v129, s[24:27], s56 offen nt lds
    s_add_u32 m0, s54, 22528
    s_nop 0
    buffer_load_dwordx4 v128, s[24:27], s56 offen nt lds
    s_add_u32 m0, s54, 23552
    s_nop 0
    buffer_load_dwordx4 v127, s[24:27], s56 offen nt lds
    s_add_u32 m0, s54, 24576
    s_nop 0
    buffer_load_dwordx4 v126, s[24:27], s56 offen nt lds
    s_waitcnt vmcnt(5)
    s_barrier
    ds_read_b128 v[28:31], v11 offset:0
    ds_read_b64 v[48:49], v10 offset:64
    ds_read_b128 v[0:3], v11 offset:3072
    ds_read_b64 v[50:51], v10 offset:3136
    ds_read_b128 v[52:55], v11 offset:6144
    ds_read_b64 v[20:21], v10 offset:6208
    ds_read_b128 v[24:27], v11 offset:9216
    ds_read_b64 v[22:23], v10 offset:9280
    ds_read_b128 v[44:47], v11 offset:12288
    ds_read_b64 v[56:57], v10 offset:12352
    ds_read_b128 v[68:71], v11 offset:15360
    ds_read_b64 v[58:59], v10 offset:15424
    s_waitcnt lgkmcnt(11)
    v_mfma_f32_16x16x32_bf16 v[60:63], v[28:31], v[220:223], 0
    s_waitcnt lgkmcnt(9)
    ds_read_b128 v[28:31], v11 offset:18432
    v_mfma_f32_16x16x32_bf16 v[60:63], v[0:3], v[220:223], v[60:63]
    s_waitcnt lgkmcnt(8)
    ds_read_b64 v[0:1], v10 offset:18496
    ds_read_b128 v[64:67], v11 offset:21504
    v_mfma_f32_16x16x32_bf16 v[60:63], v[52:55], v[220:223], v[60:63]
    s_waitcnt lgkmcnt(8)
    ds_read_b64 v[2:3], v10 offset:21568
    ds_read_b128 v[52:55], v11 offset:24576
    v_mfma_f32_16x16x32_bf16 v[60:63], v[24:27], v[220:223], v[60:63]
    ds_read_b64 v[24:25], v10 offset:24640
    v_mfma_f32_16x16x32_bf16 v[60:63], v[48:51], v[220:223], v[60:63]
    s_waitcnt lgkmcnt(9)
    ds_read_b128 v[48:51], v11 offset:27648
    v_mfma_f32_16x16x32_bf16 v[60:63], v[20:23], v[220:223], v[60:63]
    ds_read_b64 v[26:27], v10 offset:27712
    v_mfma_f32_16x16x32_bf16 v[20:23], v[44:47], v[220:223], 0
    s_waitcnt lgkmcnt(8)
    ds_read_b128 v[44:47], v11 offset:30720
    v_mfma_f32_16x16x32_bf16 v[20:23], v[68:71], v[220:223], v[20:23]
    s_waitcnt lgkmcnt(8)
    s_nop 0
    ds_read_b64 v[8:9], v10 offset:30784
    v_mul_f32 v60, 0xbbaaaaab, v60
    v_mfma_f32_16x16x32_bf16 v[20:23], v[28:31], v[220:223], v[20:23]
    s_waitcnt lgkmcnt(7)
    ds_read_b128 v[28:31], v11 offset:33792
    v_mul_f32 v61, 0xbbaaaaab, v61
    v_mul_f32 v62, 0xbbaaaaab, v62
    v_mul_f32 v63, 0xbbaaaaab, v63
    v_mfma_f32_16x16x32_bf16 v[20:23], v[64:67], v[220:223], v[20:23]
    ds_write_b128 v33, v[60:63] offset:0
    v_mfma_f32_16x16x32_bf16 v[20:23], v[56:59], v[220:223], v[20:23]
    s_waitcnt lgkmcnt(6)
    v_mfma_f32_16x16x32_bf16 v[20:23], v[0:3], v[220:223], v[20:23]
    v_mfma_f32_16x16x32_bf16 v[0:3], v[52:55], v[220:223], 0
    s_waitcnt lgkmcnt(4)
    ds_read_b64 v[10:11], v10 offset:33856
    s_nop 0
    v_mfma_f32_16x16x32_bf16 v[0:3], v[48:51], v[220:223], v[0:3]
    s_waitcnt lgkmcnt(4)
    s_nop 0
    ds_read_b128 v[52:55], v32 offset:0
    v_mul_f32 v20, 0xbbaaaaab, v20
    v_mfma_f32_16x16x32_bf16 v[0:3], v[44:47], v[220:223], v[0:3]
    s_waitcnt lgkmcnt(3)
    ds_read_b64 v[56:57], v75 offset:64
    v_mul_f32 v21, 0xbbaaaaab, v21
    v_mul_f32 v22, 0xbbaaaaab, v22
    v_mul_f32 v23, 0xbbaaaaab, v23
    v_mfma_f32_16x16x32_bf16 v[0:3], v[28:31], v[220:223], v[0:3]
    ds_write_b128 v33, v[20:23] offset:128
    v_mfma_f32_16x16x32_bf16 v[0:3], v[24:27], v[220:223], v[0:3]
    ds_read_b128 v[82:85], v32 offset:768
    ds_read_b64 v[86:87], v75 offset:832
    ds_read_b128 v[76:79], v32 offset:12288
    s_waitcnt lgkmcnt(6)
    v_mfma_f32_16x16x32_bf16 v[0:3], v[8:11], v[220:223], v[0:3]
    s_nop 0
    ds_read_b64 v[80:81], v75 offset:12352
    s_nop 0
    ds_read_b128 v[68:71], v32 offset:13056
    s_nop 2
    ds_read_b64 v[72:73], v75 offset:13120
    v_mul_f32 v0, 0xbbaaaaab, v0
    v_mul_f32 v1, 0xbbaaaaab, v1
    v_mul_f32 v2, 0xbbaaaaab, v2
    v_mul_f32 v3, 0xbbaaaaab, v3
    ds_write_b128 v33, v[0:3] offset:256
    s_waitcnt lgkmcnt(0)
    s_barrier
    ds_read_b128 v[0:3], v74 offset:0
    ds_read_b128 v[48:51], v74 offset:64
    ds_read_b128 v[28:31], v74 offset:128
    ds_read_b128 v[24:27], v74 offset:192
    s_waitcnt lgkmcnt(3)
    v_mfma_f32_16x16x16_bf16 v[44:47], v[52:53], v[146:147], v[0:3]
    v_mfma_f32_16x16x16_bf16 v[20:23], v[54:55], v[146:147], v[0:3]
    s_nop 2
    v_mfma_f32_16x16x16_bf16 v[64:67], v[56:57], v[146:147], v[0:3]
    s_waitcnt lgkmcnt(0)
    s_nop 0
    ds_read_b128 v[56:59], v32 offset:24576
    v_cvt_pk_bf16_f32 v44, v44, v45
    v_mfma_f32_16x16x16_bf16 v[8:11], v[82:83], v[146:147], v[48:51]
    ds_read_b64 v[60:61], v75 offset:24640
    v_accvgpr_write_b32 a216, v44
    v_mfma_f32_16x16x16_bf16 v[116:119], v[84:85], v[146:147], v[48:51]
    ds_read_b128 v[52:55], v74 offset:256
    v_cvt_pk_bf16_f32 v46, v46, v47
    v_mfma_f32_16x16x16_bf16 v[0:3], v[86:87], v[146:147], v[48:51]
    ds_read_b128 v[108:111], v32 offset:25344
    v_accvgpr_write_b32 a217, v46
    v_mfma_f32_16x16x16_bf16 v[100:103], v[76:77], v[146:147], v[28:31]
    ds_read_b64 v[112:113], v75 offset:25408
    v_cvt_pk_bf16_f32 v20, v20, v21
    v_mfma_f32_16x16x16_bf16 v[48:51], v[78:79], v[146:147], v[28:31]
    ds_read_b128 v[104:107], v74 offset:320
    v_accvgpr_write_b32 a240, v20
    v_mfma_f32_16x16x16_bf16 v[44:47], v[80:81], v[146:147], v[28:31]
    ds_read_b128 v[92:95], v32 offset:36864
    v_cvt_pk_bf16_f32 v22, v22, v23
    v_mfma_f32_16x16x16_bf16 v[84:87], v[68:69], v[146:147], v[24:27]
    ds_read_b64 v[96:97], v75 offset:36928
    v_accvgpr_write_b32 a241, v22
    v_mfma_f32_16x16x16_bf16 v[28:31], v[70:71], v[146:147], v[24:27]
    ds_read_b128 v[80:83], v74 offset:5120
    v_cvt_pk_bf16_f32 v232, v64, v65
    v_mfma_f32_16x16x16_bf16 v[20:23], v[72:73], v[146:147], v[24:27]
    s_waitcnt lgkmcnt(6)
    ds_read_b128 v[224:227], v32 offset:37632
    v_cvt_pk_bf16_f32 v233, v66, v67
    v_cvt_pk_bf16_f32 v8, v8, v9
    v_accvgpr_write_b32 a218, v8
    v_cvt_pk_bf16_f32 v10, v10, v11
    v_accvgpr_write_b32 a219, v10
    v_cvt_pk_bf16_f32 v116, v116, v117
    v_mfma_f32_16x16x16_bf16 v[76:79], v[56:57], v[146:147], v[52:55]
    ds_read_b64 v[228:229], v75 offset:37696
    v_accvgpr_write_b32 a242, v116
    v_mfma_f32_16x16x16_bf16 v[24:27], v[58:59], v[146:147], v[52:55]
    ds_read_b128 v[64:67], v74 offset:5184
    v_cvt_pk_bf16_f32 v118, v118, v119
    v_mfma_f32_16x16x16_bf16 v[8:11], v[60:61], v[146:147], v[52:55]
    s_waitcnt lgkmcnt(6)
    ds_read_b128 v[68:71], v32 offset:49152
    v_accvgpr_write_b32 a243, v118
    v_cvt_pk_bf16_f32 v234, v0, v1
    v_cvt_pk_bf16_f32 v235, v2, v3
    v_mfma_f32_16x16x16_bf16 v[56:59], v[108:109], v[146:147], v[104:107]
    ds_read_b64 v[72:73], v75 offset:49216
    v_cvt_pk_bf16_f32 v100, v100, v101
    v_mfma_f32_16x16x16_bf16 v[52:55], v[110:111], v[146:147], v[104:107]
    ds_read_b128 v[60:63], v74 offset:5248
    v_accvgpr_write_b32 a220, v100
    v_mfma_f32_16x16x16_bf16 v[0:3], v[112:113], v[146:147], v[104:107]
    s_waitcnt lgkmcnt(6)
    ds_read_b128 v[116:119], v32 offset:49920
    v_cvt_pk_bf16_f32 v102, v102, v103
    v_accvgpr_write_b32 a221, v102
    v_cvt_pk_bf16_f32 v48, v48, v49
    v_accvgpr_write_b32 a244, v48
    v_cvt_pk_bf16_f32 v50, v50, v51
    v_accvgpr_write_b32 a245, v50
    v_cvt_pk_bf16_f32 v236, v44, v45
    v_cvt_pk_bf16_f32 v237, v46, v47
    v_mfma_f32_16x16x16_bf16 v[108:111], v[92:93], v[146:147], v[80:83]
    ds_read_b64 v[120:121], v75 offset:49984
    v_cvt_pk_bf16_f32 v84, v84, v85
    v_mfma_f32_16x16x16_bf16 v[44:47], v[94:95], v[146:147], v[80:83]
    ds_read_b128 v[112:115], v74 offset:5312
    v_accvgpr_write_b32 a222, v84
    v_mfma_f32_16x16x16_bf16 v[48:51], v[96:97], v[146:147], v[80:83]
    s_waitcnt lgkmcnt(5)
    ds_read_b128 v[100:103], v32 offset:61440
    v_cvt_pk_bf16_f32 v86, v86, v87
    v_accvgpr_write_b32 a223, v86
    v_cvt_pk_bf16_f32 v28, v28, v29
    v_accvgpr_write_b32 a246, v28
    v_cvt_pk_bf16_f32 v30, v30, v31
    v_accvgpr_write_b32 a247, v30
    v_cvt_pk_bf16_f32 v238, v20, v21
    v_cvt_pk_bf16_f32 v239, v22, v23
    v_mfma_f32_16x16x16_bf16 v[96:99], v[224:225], v[146:147], v[64:67]
    ds_read_b64 v[104:105], v75 offset:61504
    v_cvt_pk_bf16_f32 v76, v76, v77
    v_mfma_f32_16x16x16_bf16 v[92:95], v[226:227], v[146:147], v[64:67]
    ds_read_b128 v[20:23], v74 offset:5376
    v_accvgpr_write_b32 a224, v76
    v_mfma_f32_16x16x16_bf16 v[84:87], v[228:229], v[146:147], v[64:67]
    s_waitcnt lgkmcnt(5)
    ds_read_b128 v[28:31], v32 offset:62208
    v_cvt_pk_bf16_f32 v78, v78, v79
    v_accvgpr_write_b32 a225, v78
    v_cvt_pk_bf16_f32 v24, v24, v25
    v_accvgpr_write_b32 a248, v24
    v_cvt_pk_bf16_f32 v26, v26, v27
    v_accvgpr_write_b32 a249, v26
    v_cvt_pk_bf16_f32 v240, v8, v9
    v_cvt_pk_bf16_f32 v241, v10, v11
    v_mfma_f32_16x16x16_bf16 v[80:83], v[68:69], v[146:147], v[60:63]
    ds_read_b64 v[32:33], v75 offset:62272
    v_cvt_pk_bf16_f32 v56, v56, v57
    v_mfma_f32_16x16x16_bf16 v[76:79], v[70:71], v[146:147], v[60:63]
    ds_read_b128 v[24:27], v74 offset:5440
    v_accvgpr_write_b32 a226, v56
    v_mfma_f32_16x16x16_bf16 v[68:71], v[72:73], v[146:147], v[60:63]
    s_waitcnt lgkmcnt(5)
    ds_read_b128 v[8:11], v139 offset:0
    v_cvt_pk_bf16_f32 v58, v58, v59
    v_accvgpr_write_b32 a227, v58
    v_cvt_pk_bf16_f32 v52, v52, v53
    v_accvgpr_write_b32 a250, v52
    v_cvt_pk_bf16_f32 v54, v54, v55
    v_accvgpr_write_b32 a251, v54
    v_cvt_pk_bf16_f32 v242, v0, v1
    v_cvt_pk_bf16_f32 v243, v2, v3
    v_mfma_f32_16x16x16_bf16 v[64:67], v[116:117], v[146:147], v[112:115]
    ds_read_b128 v[60:63], v138 offset:0
    v_cvt_pk_bf16_f32 v108, v108, v109
    v_mfma_f32_16x16x16_bf16 v[56:59], v[118:119], v[146:147], v[112:115]
    ds_read_b128 v[0:3], v139 offset:128
    v_accvgpr_write_b32 a228, v108
    v_mfma_f32_16x16x16_bf16 v[52:55], v[120:121], v[146:147], v[112:115]
    s_waitcnt lgkmcnt(5)
    ds_read_b128 v[72:75], v138 offset:128
    v_cvt_pk_bf16_f32 v110, v110, v111
    v_accvgpr_write_b32 a229, v110
    v_cvt_pk_bf16_f32 v44, v44, v45
    v_accvgpr_write_b32 a252, v44
    v_cvt_pk_bf16_f32 v46, v46, v47
    v_accvgpr_write_b32 a253, v46
    v_cvt_pk_bf16_f32 v244, v48, v49
    v_cvt_pk_bf16_f32 v245, v50, v51
    v_mfma_f32_16x16x16_bf16 v[48:51], v[100:101], v[146:147], v[20:23]
    s_waitcnt vmcnt(0) lgkmcnt(4)
    s_barrier
    ds_write_b128 v35, v[36:39] offset:6144
    v_mfma_f32_16x16x16_bf16 v[44:47], v[102:103], v[146:147], v[20:23]
    v_cvt_pk_bf16_f32 v96, v96, v97
    v_accvgpr_write_b32 a230, v96
    v_mfma_f32_16x16x16_bf16 v[36:39], v[104:105], v[146:147], v[20:23]
    s_waitcnt lgkmcnt(4)
    v_cvt_pk_bf16_f32 v98, v98, v99
    v_accvgpr_write_b32 a231, v98
    v_cvt_pk_bf16_f32 v92, v92, v93
    v_mfma_f32_16x16x32_bf16 v[20:23], a[0:3], v[8:11], 0
    s_waitcnt lgkmcnt(3)
    ds_write_b128 v34, v[216:219] offset:80
    v_mfma_f32_16x16x32_bf16 v[20:23], a[4:7], v[60:63], v[20:23]
    s_waitcnt lgkmcnt(2)
    v_accvgpr_write_b32 a254, v92
    v_cvt_pk_bf16_f32 v94, v94, v95
    v_mfma_f32_16x16x32_bf16 v[20:23], a[8:11], v[0:3], v[20:23]
    v_accvgpr_write_b32 a255, v94
    v_cvt_pk_bf16_f32 v246, v84, v85
    v_mfma_f32_16x16x32_bf16 v[20:23], a[12:15], v[72:75], v[20:23]
    ds_write_b128 v34, v[88:91] offset:0
    v_cvt_pk_bf16_f32 v247, v86, v87
    v_cvt_pk_bf16_f32 v80, v80, v81
    v_accvgpr_write_b32 a232, v80
    v_cvt_pk_bf16_f32 v82, v82, v83
    v_accvgpr_write_b32 a233, v82
    v_cvt_pk_bf16_f32 v224, v76, v77
    v_cvt_pk_bf16_f32 v225, v78, v79
    v_cvt_pk_bf16_f32 v248, v68, v69
    v_cvt_pk_bf16_f32 v249, v70, v71
    v_cvt_pk_bf16_f32 v64, v64, v65
    v_accvgpr_write_b32 a234, v64
    v_cvt_pk_bf16_f32 v66, v66, v67
    v_accvgpr_write_b32 a235, v66
    v_cvt_pk_bf16_f32 v226, v56, v57
    v_cvt_pk_bf16_f32 v227, v58, v59
    v_cvt_pk_bf16_f32 v250, v52, v53
    v_cvt_pk_bf16_f32 v251, v54, v55
    v_cvt_pk_bf16_f32 v48, v48, v49
    v_accvgpr_write_b32 a236, v48
    v_cvt_pk_bf16_f32 v50, v50, v51
    v_accvgpr_write_b32 a237, v50
    v_cvt_pk_bf16_f32 v228, v44, v45
    v_cvt_pk_bf16_f32 v229, v46, v47
    v_cvt_pk_bf16_f32 v252, v36, v37
    v_cvt_pk_bf16_f32 v253, v38, v39
    ds_write_b128 v34, v[40:43] offset:16
    v_add_u32 v137, s49, v137
    v_add_u32 v136, s49, v136
    ds_write_b128 v34, v[16:19] offset:32
    ds_write_b128 v34, v[12:15] offset:48
    ds_write_b128 v34, v[4:7] offset:64
    ds_read_b128 v[76:79], v139 offset:256
    ds_read_b128 v[64:67], v138 offset:256
    s_waitcnt lgkmcnt(1)
    v_mfma_f32_16x16x32_bf16 v[20:23], a[16:19], v[76:79], v[20:23]
    s_waitcnt lgkmcnt(0)
    v_mfma_f32_16x16x32_bf16 v[20:23], a[20:23], v[64:67], v[20:23]
    s_nop 0
    v_mfma_f32_16x16x16_bf16 v[16:19], v[28:29], v[146:147], v[24:27]
    s_nop 3
    v_mfma_f32_16x16x16_bf16 v[12:15], v[30:31], v[146:147], v[24:27]
    s_nop 0
    v_fma_f32 v143, v20, v20, s41
    v_fmac_f32 v143, v21, v21
    v_mfma_f32_16x16x16_bf16 v[4:7], v[32:33], v[146:147], v[24:27]
    v_cvt_pk_bf16_f32 v16, v16, v17
    v_accvgpr_write_b32 a238, v16
    v_cvt_pk_bf16_f32 v18, v18, v19
    v_mfma_f32_16x16x32_bf16 v[52:55], a[24:27], v[8:11], 0
    v_accvgpr_write_b32 a239, v18
    v_cvt_pk_bf16_f32 v230, v12, v13
    v_mfma_f32_16x16x32_bf16 v[52:55], a[28:31], v[60:63], v[52:55]
    v_cvt_pk_bf16_f32 v231, v14, v15
    v_cvt_pk_bf16_f32 v254, v4, v5
    v_mfma_f32_16x16x32_bf16 v[52:55], a[32:35], v[0:3], v[52:55]
    v_cvt_pk_bf16_f32 v255, v6, v7
    v_fmac_f32 v143, v22, v22
    v_mfma_f32_16x16x32_bf16 v[52:55], a[36:39], v[72:75], v[52:55]
    v_fmac_f32 v143, v23, v23
    v_mfma_f32_16x16x32_bf16 v[52:55], a[40:43], v[76:79], v[52:55]
    v_mfma_f32_16x16x32_bf16 v[52:55], a[44:47], v[64:67], v[52:55]
    s_nop 1
    v_mfma_f32_16x16x32_bf16 v[48:51], a[48:51], v[8:11], 0
    s_nop 2
    v_mfma_f32_16x16x32_bf16 v[48:51], a[52:55], v[60:63], v[48:51]
    s_nop 0
    v_fmac_f32 v143, v52, v52
    v_fmac_f32 v143, v53, v53
    v_mfma_f32_16x16x32_bf16 v[48:51], a[56:59], v[0:3], v[48:51]
    v_fmac_f32 v143, v54, v54
    v_fmac_f32 v143, v55, v55
    v_mfma_f32_16x16x32_bf16 v[48:51], a[60:63], v[72:75], v[48:51]
    v_mfma_f32_16x16x32_bf16 v[48:51], a[64:67], v[76:79], v[48:51]
    v_mfma_f32_16x16x32_bf16 v[48:51], a[68:71], v[64:67], v[48:51]
    s_nop 1
    v_mfma_f32_16x16x32_bf16 v[44:47], a[72:75], v[8:11], 0
    s_nop 2
    v_mfma_f32_16x16x32_bf16 v[44:47], a[76:79], v[60:63], v[44:47]
    s_nop 0
    v_fmac_f32 v143, v48, v48
    v_fmac_f32 v143, v49, v49
    v_mfma_f32_16x16x32_bf16 v[44:47], a[80:83], v[0:3], v[44:47]
    v_fmac_f32 v143, v50, v50
    v_fmac_f32 v143, v51, v51
    v_mfma_f32_16x16x32_bf16 v[44:47], a[84:87], v[72:75], v[44:47]
    v_mfma_f32_16x16x32_bf16 v[44:47], a[88:91], v[76:79], v[44:47]
    v_mfma_f32_16x16x32_bf16 v[44:47], a[92:95], v[64:67], v[44:47]
    s_nop 1
    v_mfma_f32_16x16x32_bf16 v[4:7], a[96:99], v[8:11], 0
    s_nop 2
    v_mfma_f32_16x16x32_bf16 v[4:7], a[100:103], v[60:63], v[4:7]
    s_nop 0
    v_fma_f32 v142, v44, v44, s41
    v_fmac_f32 v142, v45, v45
    v_mfma_f32_16x16x32_bf16 v[4:7], a[104:107], v[0:3], v[4:7]
    v_fmac_f32 v142, v46, v46
    v_fmac_f32 v142, v47, v47
    v_mfma_f32_16x16x32_bf16 v[4:7], a[108:111], v[72:75], v[4:7]
    v_mfma_f32_16x16x32_bf16 v[4:7], a[112:115], v[76:79], v[4:7]
    v_mfma_f32_16x16x32_bf16 v[4:7], a[116:119], v[64:67], v[4:7]
    s_nop 1
    v_mfma_f32_16x16x32_bf16 v[36:39], a[120:123], v[8:11], 0
    s_nop 2
    v_mfma_f32_16x16x32_bf16 v[36:39], a[124:127], v[60:63], v[36:39]
    s_nop 0
    v_fmac_f32 v142, v4, v4
    v_fmac_f32 v142, v5, v5
    v_mfma_f32_16x16x32_bf16 v[36:39], a[128:131], v[0:3], v[36:39]
    v_fmac_f32 v142, v6, v6
    v_fmac_f32 v142, v7, v7
    v_mfma_f32_16x16x32_bf16 v[36:39], a[132:135], v[72:75], v[36:39]
    v_mfma_f32_16x16x32_bf16 v[36:39], a[136:139], v[76:79], v[36:39]
    v_mfma_f32_16x16x32_bf16 v[36:39], a[140:143], v[64:67], v[36:39]
    s_nop 1
    v_mfma_f32_16x16x32_bf16 v[12:15], v[8:11], a[144:147], 0
    s_nop 2
    v_mfma_f32_16x16x32_bf16 v[12:15], v[60:63], a[148:151], v[12:15]
    s_nop 0
    v_fmac_f32 v142, v36, v36
    v_fmac_f32 v142, v37, v37
    v_mfma_f32_16x16x32_bf16 v[12:15], v[0:3], a[152:155], v[12:15]
    v_fmac_f32 v142, v38, v38
    v_fmac_f32 v142, v39, v39
    v_mfma_f32_16x16x32_bf16 v[12:15], v[72:75], a[156:159], v[12:15]
    v_cvt_pk_bf16_f32 v170, v143, v142
    v_mfma_f32_16x16x32_bf16 v[12:15], v[76:79], a[160:163], v[12:15]
    ds_read_b128 v[108:111], v139 offset:1536
    v_mfma_f32_16x16x32_bf16 v[12:15], v[64:67], a[164:167], v[12:15]
    s_nop 0
    ds_read_b128 v[104:107], v138 offset:1536
    s_nop 0
    v_mfma_f32_16x16x16_bf16 v[40:43], v[216:217], v[170:171], 0
    s_nop 0
    ds_read_b128 v[88:91], v139 offset:1664
    s_nop 1
    v_cvt_pk_bf16_f32 v24, v12, v13
    v_mfma_f32_16x16x32_bf16 v[16:19], v[8:11], a[168:171], 0
    ds_read_b128 v[100:103], v138 offset:1664
    v_cvt_pk_bf16_f32 v25, v14, v15
    v_mfma_f32_16x16x32_bf16 v[16:19], v[60:63], a[172:175], v[16:19]
    ds_read_b128 v[68:71], v139 offset:1792
    v_mfma_f32_16x16x32_bf16 v[16:19], v[0:3], a[176:179], v[16:19]
    ds_read_b128 v[12:15], v138 offset:1792
    v_mfma_f32_16x16x32_bf16 v[16:19], v[72:75], a[180:183], v[16:19]
    v_rsq_f32 v40, v40
    v_mfma_f32_16x16x32_bf16 v[16:19], v[76:79], a[184:187], v[16:19]
    v_rsq_f32 v41, v41
    v_mfma_f32_16x16x32_bf16 v[16:19], v[64:67], a[188:191], v[16:19]
    v_mul_f32 v40, s55, v40
    v_mul_f32 v41, 0.5, v41
    v_mfma_f32_16x16x32_bf16 v[32:35], v[8:11], a[192:195], 0
    s_nop 0
    v_mul_f32 v20, v20, v40
    v_mul_f32 v21, v21, v40
    v_mfma_f32_16x16x32_bf16 v[32:35], v[60:63], a[196:199], v[32:35]
    s_nop 0
    v_cvt_pk_bf16_f32 v28, v16, v17
    v_cvt_pk_bf16_f32 v29, v18, v19
    v_mfma_f32_16x16x32_bf16 v[32:35], v[0:3], a[200:203], v[32:35]
    v_cvt_pk_f16_f32 v16, v20, v21
    v_mul_f32 v22, v22, v40
    v_mfma_f32_16x16x32_bf16 v[32:35], v[72:75], a[204:207], v[32:35]
    v_mul_f32 v23, v23, v40
    v_cvt_pk_f16_f32 v17, v22, v23
    v_mfma_f32_16x16x32_bf16 v[32:35], v[76:79], a[208:211], v[32:35]
    v_mul_f32 v52, v52, v40
    v_mul_f32 v53, v53, v40
    v_mfma_f32_16x16x32_bf16 v[32:35], v[64:67], a[212:215], v[32:35]
    s_waitcnt lgkmcnt(0)
    v_cvt_pk_f16_f32 v18, v52, v53
    v_mul_f32 v54, v54, v40
    v_mfma_f32_16x16x32_bf16 v[64:67], a[0:3], v[108:111], 0
    v_mul_f32 v55, v55, v40
    v_cvt_pk_f16_f32 v19, v54, v55
    v_mfma_f32_16x16x32_bf16 v[64:67], a[4:7], v[104:107], v[64:67]
    v_mul_f32 v48, v48, v40
    v_mul_f32 v49, v49, v40
    v_mfma_f32_16x16x32_bf16 v[64:67], a[8:11], v[88:91], v[64:67]
    v_cvt_pk_f16_f32 v154, v48, v49
    v_mul_f32 v50, v50, v40
    v_mfma_f32_16x16x32_bf16 v[64:67], a[12:15], v[100:103], v[64:67]
    v_mul_f32 v51, v51, v40
    v_cvt_pk_f16_f32 v155, v50, v51
    v_mfma_f32_16x16x32_bf16 v[64:67], a[16:19], v[68:71], v[64:67]
    v_mul_f32 v44, v44, v41
    v_mul_f32 v45, v45, v41
    v_mfma_f32_16x16x32_bf16 v[64:67], a[20:23], v[12:15], v[64:67]
    v_cvt_pk_f16_f32 v82, v44, v45
    v_mul_f32 v46, v46, v41
    v_mfma_f32_16x16x32_bf16 v[52:55], a[24:27], v[108:111], 0
    v_mul_f32 v47, v47, v41
    v_cvt_pk_f16_f32 v83, v46, v47
    v_mfma_f32_16x16x32_bf16 v[52:55], a[28:31], v[104:107], v[52:55]
    v_mul_f32 v4, v4, v41
    v_mul_f32 v5, v5, v41
    v_mfma_f32_16x16x32_bf16 v[52:55], a[32:35], v[88:91], v[52:55]
    v_cvt_pk_f16_f32 v84, v4, v5
    v_mul_f32 v6, v6, v41
    v_mfma_f32_16x16x32_bf16 v[52:55], a[36:39], v[100:103], v[52:55]
    v_mul_f32 v7, v7, v41
    v_cvt_pk_f16_f32 v85, v6, v7
    v_mfma_f32_16x16x32_bf16 v[52:55], a[40:43], v[68:71], v[52:55]
    v_mul_f32 v36, v36, v41
    v_mul_f32 v37, v37, v41
    v_mfma_f32_16x16x32_bf16 v[52:55], a[44:47], v[12:15], v[52:55]
    v_cvt_pk_f16_f32 v86, v36, v37
    v_mul_f32 v38, v38, v41
    v_mfma_f32_16x16x32_bf16 v[4:7], a[48:51], v[108:111], 0
    v_mul_f32 v39, v39, v41
    v_cvt_pk_f16_f32 v87, v38, v39
    v_mfma_f32_16x16x32_bf16 v[4:7], a[52:55], v[104:107], v[4:7]
    v_cvt_pk_bf16_f32 v32, v32, v33
    v_cvt_pk_bf16_f32 v33, v34, v35
    v_mfma_f32_16x16x32_bf16 v[4:7], a[56:59], v[88:91], v[4:7]
    v_fma_f32 v26, v64, v64, s41
    v_fmac_f32 v26, v65, v65
    v_mfma_f32_16x16x32_bf16 v[4:7], a[60:63], v[100:103], v[4:7]
    v_fmac_f32 v26, v66, v66
    v_fmac_f32 v26, v67, v67
    v_mfma_f32_16x16x32_bf16 v[4:7], a[64:67], v[68:71], v[4:7]
    v_fmac_f32 v26, v52, v52
    v_fmac_f32 v26, v53, v53
    v_mfma_f32_16x16x32_bf16 v[4:7], a[68:71], v[12:15], v[4:7]
    v_fmac_f32 v26, v54, v54
    v_fmac_f32 v26, v55, v55
    v_mfma_f32_16x16x32_bf16 v[48:51], a[72:75], v[108:111], 0
    s_nop 2
    v_mfma_f32_16x16x32_bf16 v[48:51], a[76:79], v[104:107], v[48:51]
    s_nop 0
    v_fmac_f32 v26, v4, v4
    v_fmac_f32 v26, v5, v5
    v_mfma_f32_16x16x32_bf16 v[48:51], a[80:83], v[88:91], v[48:51]
    v_fmac_f32 v26, v6, v6
    v_fmac_f32 v26, v7, v7
    v_mfma_f32_16x16x32_bf16 v[48:51], a[84:87], v[100:103], v[48:51]
    v_mfma_f32_16x16x32_bf16 v[48:51], a[88:91], v[68:71], v[48:51]
    v_mfma_f32_16x16x32_bf16 v[48:51], a[92:95], v[12:15], v[48:51]
    s_nop 1
    v_mfma_f32_16x16x32_bf16 v[0:3], a[96:99], v[108:111], 0
    s_nop 2
    v_mfma_f32_16x16x32_bf16 v[0:3], a[100:103], v[104:107], v[0:3]
    s_nop 0
    v_fma_f32 v27, v48, v48, s41
    v_fmac_f32 v27, v49, v49
    v_mfma_f32_16x16x32_bf16 v[0:3], a[104:107], v[88:91], v[0:3]
    v_fmac_f32 v27, v50, v50
    v_fmac_f32 v27, v51, v51
    v_mfma_f32_16x16x32_bf16 v[0:3], a[108:111], v[100:103], v[0:3]
    v_mfma_f32_16x16x32_bf16 v[0:3], a[112:115], v[68:71], v[0:3]
    v_mfma_f32_16x16x32_bf16 v[0:3], a[116:119], v[12:15], v[0:3]
    s_sub_u32 s50, s45, s44
    v_add_u32 v137, s48, v137
    v_add_u32 v136, s48, v136
    v_mfma_f32_16x16x32_bf16 v[44:47], a[120:123], v[108:111], 0
    s_sub_u32 s51, s46, s47
    v_add_u32 v135, s51, v135
    v_mfma_f32_16x16x32_bf16 v[44:47], a[124:127], v[104:107], v[44:47]
    s_mov_b32 s60, s59
    v_fmac_f32 v27, v0, v0
    v_fmac_f32 v27, v1, v1
    v_mfma_f32_16x16x32_bf16 v[44:47], a[128:131], v[88:91], v[44:47]
    s_mov_b32 s59, s58
    v_fmac_f32 v27, v2, v2
    v_fmac_f32 v27, v3, v3
    v_mfma_f32_16x16x32_bf16 v[44:47], a[132:135], v[100:103], v[44:47]
    s_mov_b32 s58, s57
    v_mfma_f32_16x16x32_bf16 v[44:47], a[136:139], v[68:71], v[44:47]
    s_mov_b32 s57, s56
    v_mfma_f32_16x16x32_bf16 v[44:47], a[140:143], v[12:15], v[44:47]
    s_mov_b32 s7, s6
    s_nop 0
    v_mfma_f32_16x16x32_bf16 v[8:11], v[108:111], a[144:147], 0
    s_mov_b32 s6, s5
    s_nop 1
    v_mfma_f32_16x16x32_bf16 v[8:11], v[104:107], a[148:151], v[8:11]
    s_mov_b32 s5, s4
    v_fmac_f32 v27, v44, v44
    v_fmac_f32 v27, v45, v45
    v_mfma_f32_16x16x32_bf16 v[8:11], v[88:91], a[152:155], v[8:11]
    s_sub_u32 s14, s6, s7
    v_fmac_f32 v27, v46, v46
    v_fmac_f32 v27, v47, v47
    v_mfma_f32_16x16x32_bf16 v[8:11], v[100:103], a[156:159], v[8:11]
    s_add_u32 s61, s61, 1
    v_cvt_pk_bf16_f32 v170, v26, v27
    v_add_u32 v134, s14, v134
    v_mfma_f32_16x16x32_bf16 v[8:11], v[68:71], a[160:163], v[8:11]
    s_ff1_i32_b32 s15, s66
    ds_read_b128 v[96:99], v139 offset:3072
    v_add_u32 v133, s14, v133
    v_mfma_f32_16x16x32_bf16 v[8:11], v[12:15], a[164:167], v[8:11]
    s_cmp_lg_u32 s66, 0
    ds_read_b128 v[92:95], v138 offset:3072
    v_add_u32 v125, s14, v125
    v_mfma_f32_16x16x16_bf16 v[20:23], v[216:217], v[170:171], 0
    s_cselect_b32 s12, s15, s12
    ds_read_b128 v[40:43], v139 offset:3200
    s_nop 1
    v_cvt_pk_bf16_f32 v26, v8, v9
    v_mfma_f32_16x16x32_bf16 v[72:75], v[108:111], a[168:171], 0
    s_cmp_lt_u32 s61, s71
    ds_read_b128 v[60:63], v138 offset:3200
    v_cvt_pk_bf16_f32 v27, v10, v11
    v_mfma_f32_16x16x32_bf16 v[72:75], v[104:107], a[172:175], v[72:75]
    s_cselect_b32 s15, 31, s15
    ds_read_b128 v[56:59], v139 offset:3328
    v_add_u32 v139, s50, v139
    v_mfma_f32_16x16x32_bf16 v[72:75], v[88:91], a[176:179], v[72:75]
    s_bitset0_b32 s66, s15
    ds_read_b128 v[36:39], v138 offset:3328
    v_add_u32 v138, s50, v138
    v_mfma_f32_16x16x32_bf16 v[72:75], v[100:103], a[180:183], v[72:75]
    s_add_u32 s12, s12, 20
    v_rsq_f32 v20, v20
    v_mfma_f32_16x16x32_bf16 v[72:75], v[68:71], a[184:187], v[72:75]
    s_max_u32 s12, s12, s61
    v_rsq_f32 v21, v21
    v_mfma_f32_16x16x32_bf16 v[72:75], v[12:15], a[188:191], v[72:75]
    s_cmp_lt_u32 s61, s71
    v_mul_f32 v20, s55, v20
    v_mul_f32 v21, 0.5, v21
    v_mfma_f32_16x16x32_bf16 v[8:11], v[108:111], a[192:195], 0
    s_cselect_b32 s15, s61, s12
    v_mul_f32 v64, v64, v20
    v_mul_f32 v65, v65, v20
    v_mfma_f32_16x16x32_bf16 v[8:11], v[104:107], a[196:199], v[8:11]
    s_cselect_b32 s56, s69, s70
    v_cvt_pk_bf16_f32 v30, v72, v73
    v_cvt_pk_bf16_f32 v31, v74, v75
    v_mfma_f32_16x16x32_bf16 v[8:11], v[88:91], a[200:203], v[8:11]
    s_add_u32 s56, s56, s15
    v_cvt_pk_f16_f32 v88, v64, v65
    v_mul_f32 v66, v66, v20
    v_mfma_f32_16x16x32_bf16 v[8:11], v[100:103], a[204:207], v[8:11]
    s_mul_i32 s53, s56, 58255
    v_mul_f32 v67, v67, v20
    v_cvt_pk_f16_f32 v89, v66, v67
    v_mfma_f32_16x16x32_bf16 v[8:11], v[68:71], a[208:211], v[8:11]
    s_waitcnt lgkmcnt(0)
    s_lshr_b32 s53, s53, 22
    v_mul_f32 v52, v52, v20
    v_mul_f32 v53, v53, v20
    v_mfma_f32_16x16x32_bf16 v[8:11], v[12:15], a[212:215], v[8:11]
    s_barrier
    v_cvt_pk_f16_f32 v90, v52, v53
    v_mul_f32 v54, v54, v20
    v_mfma_f32_16x16x32_bf16 v[12:15], a[0:3], v[96:99], 0
    s_mul_i32 s53, s53, s63
    v_mul_f32 v55, v55, v20
    v_cvt_pk_f16_f32 v91, v54, v55
    v_mfma_f32_16x16x32_bf16 v[12:15], a[4:7], v[92:95], v[12:15]
    s_mul_i32 s56, s56, s62
    v_mul_f32 v4, v4, v20
    v_mul_f32 v5, v5, v20
    v_mfma_f32_16x16x32_bf16 v[12:15], a[8:11], v[40:43], v[12:15]
    s_add_u32 s56, s56, s53
    v_cvt_pk_f16_f32 v150, v4, v5
    v_mul_f32 v6, v6, v20
    v_mfma_f32_16x16x32_bf16 v[12:15], a[12:15], v[60:63], v[12:15]
    s_mul_i32 s4, s15, 336
    v_mul_f32 v7, v7, v20
    v_cvt_pk_f16_f32 v151, v6, v7
    v_mfma_f32_16x16x32_bf16 v[12:15], a[16:19], v[56:59], v[12:15]
    s_cmp_ge_u32 s15, 16
    v_mul_f32 v48, v48, v21
    v_mul_f32 v49, v49, v21
    v_mfma_f32_16x16x32_bf16 v[12:15], a[20:23], v[36:39], v[12:15]
    s_cselect_b32 s53, -26880, 0
    v_cvt_pk_f16_f32 v76, v48, v49
    v_mul_f32 v50, v50, v21
    v_mfma_f32_16x16x32_bf16 v[4:7], a[24:27], v[96:99], 0
    s_add_u32 s4, s4, s53
    v_mul_f32 v51, v51, v21
    v_cvt_pk_f16_f32 v77, v50, v51
    v_mfma_f32_16x16x32_bf16 v[4:7], a[28:31], v[92:95], v[4:7]
    s_cmp_lt_u32 s15, s73
    v_mul_f32 v0, v0, v21
    v_mul_f32 v1, v1, v21
    v_mfma_f32_16x16x32_bf16 v[4:7], a[32:35], v[40:43], v[4:7]
    s_cselect_b32 s26, 100270464, 0
    v_cvt_pk_f16_f32 v78, v0, v1
    v_mul_f32 v2, v2, v21
    v_mfma_f32_16x16x32_bf16 v[4:7], a[36:39], v[60:63], v[4:7]
    s_cselect_b32 s56, s56, 0
    v_mul_f32 v3, v3, v21
    v_cvt_pk_f16_f32 v79, v2, v3
    v_mfma_f32_16x16x32_bf16 v[4:7], a[40:43], v[56:59], v[4:7]
    s_cselect_b32 s4, s4, -1
    v_mul_f32 v44, v44, v21
    v_mul_f32 v45, v45, v21
    v_mfma_f32_16x16x32_bf16 v[4:7], a[44:47], v[36:39], v[4:7]
    s_cselect_b32 s15, s15, 0
    v_cvt_pk_f16_f32 v80, v44, v45
    v_mul_f32 v46, v46, v21
    v_mfma_f32_16x16x32_bf16 v[0:3], a[48:51], v[96:99], 0
    s_cselect_b32 s13, s13, -1
    v_mul_f32 v47, v47, v21
    v_cvt_pk_f16_f32 v81, v46, v47
    v_mfma_f32_16x16x32_bf16 v[0:3], a[52:55], v[92:95], v[0:3]
    s_bitset1_b32 s64, s15
    v_cvt_pk_bf16_f32 v34, v8, v9
    v_cvt_pk_bf16_f32 v35, v10, v11
    v_mfma_f32_16x16x32_bf16 v[0:3], a[56:59], v[40:43], v[0:3]
    s_add_u32 s65, s65, 1
    v_fma_f32 v143, v12, v12, s41
    v_fmac_f32 v143, v13, v13
    v_mfma_f32_16x16x32_bf16 v[0:3], a[60:63], v[60:63], v[0:3]
    s_cmp_ge_i32 s65, 2
    v_fmac_f32 v143, v14, v14
    v_fmac_f32 v143, v15, v15
    v_mfma_f32_16x16x32_bf16 v[0:3], a[64:67], v[56:59], v[0:3]
    s_cselect_b32 s30, 100270464, 0
    v_fmac_f32 v143, v4, v4
    v_fmac_f32 v143, v5, v5
    v_mfma_f32_16x16x32_bf16 v[0:3], a[68:71], v[36:39], v[0:3]
    s_add_u32 s67, s46, s54
    v_fmac_f32 v143, v6, v6
    v_fmac_f32 v143, v7, v7
    v_mfma_f32_16x16x32_bf16 v[52:55], a[72:75], v[96:99], 0
    s_add_u32 m0, s67, 0
    s_nop 0
    buffer_load_dwordx4 v130, s[24:27], s56 offen nt lds
    v_mfma_f32_16x16x32_bf16 v[52:55], a[76:79], v[92:95], v[52:55]
    s_add_u32 m0, s67, 1024
    v_fmac_f32 v143, v0, v0
    v_fmac_f32 v143, v1, v1
    v_mfma_f32_16x16x32_bf16 v[52:55], a[80:83], v[40:43], v[52:55]
    v_fmac_f32 v143, v2, v2
    v_fmac_f32 v143, v3, v3
    v_mfma_f32_16x16x32_bf16 v[52:55], a[84:87], v[60:63], v[52:55]
    buffer_load_dwordx4 v129, s[24:27], s56 offen nt lds
    v_mfma_f32_16x16x32_bf16 v[52:55], a[88:91], v[56:59], v[52:55]
    s_add_u32 m0, s67, 2048
    v_mfma_f32_16x16x32_bf16 v[52:55], a[92:95], v[36:39], v[52:55]
    buffer_load_dwordx4 v128, s[24:27], s56 offen nt lds
    s_nop 0
    v_mfma_f32_16x16x32_bf16 v[8:11], a[96:99], v[96:99], 0
    s_nop 2
    v_mfma_f32_16x16x32_bf16 v[8:11], a[100:103], v[92:95], v[8:11]
    s_nop 0
    v_fma_f32 v142, v52, v52, s41
    v_fmac_f32 v142, v53, v53
    v_mfma_f32_16x16x32_bf16 v[8:11], a[104:107], v[40:43], v[8:11]
    v_fmac_f32 v142, v54, v54
    v_fmac_f32 v142, v55, v55
    v_mfma_f32_16x16x32_bf16 v[8:11], a[108:111], v[60:63], v[8:11]
    v_mfma_f32_16x16x32_bf16 v[8:11], a[112:115], v[56:59], v[8:11]
    s_add_u32 m0, s67, 3072
    s_nop 0
    buffer_load_dwordx4 v127, s[24:27], s56 offen nt lds
    v_mfma_f32_16x16x32_bf16 v[8:11], a[116:119], v[36:39], v[8:11]
    s_add_u32 m0, s67, 4096
    s_nop 0
    v_mfma_f32_16x16x32_bf16 v[44:47], a[120:123], v[96:99], 0
    s_nop 1
    buffer_load_dwordx4 v126, s[24:27], s56 offen nt lds
    v_mfma_f32_16x16x32_bf16 v[44:47], a[124:127], v[92:95], v[44:47]
    s_nop 0
    v_fmac_f32 v142, v8, v8
    v_fmac_f32 v142, v9, v9
    v_mfma_f32_16x16x32_bf16 v[44:47], a[128:131], v[40:43], v[44:47]
    v_fmac_f32 v142, v10, v10
    v_fmac_f32 v142, v11, v11
    v_mfma_f32_16x16x32_bf16 v[44:47], a[132:135], v[60:63], v[44:47]
    v_mfma_f32_16x16x32_bf16 v[44:47], a[136:139], v[56:59], v[44:47]
    v_mfma_f32_16x16x32_bf16 v[44:47], a[140:143], v[36:39], v[44:47]
    s_nop 1
    v_mfma_f32_16x16x32_bf16 v[20:23], v[96:99], a[144:147], 0
    s_mov_b32 s53, s47
    s_nop 1
    v_mfma_f32_16x16x32_bf16 v[20:23], v[92:95], a[148:151], v[20:23]
    s_mov_b32 s47, s46
    v_fmac_f32 v142, v44, v44
    v_fmac_f32 v142, v45, v45
    v_mfma_f32_16x16x32_bf16 v[20:23], v[40:43], a[152:155], v[20:23]
    s_mov_b32 s46, s45
    v_fmac_f32 v142, v46, v46
    v_fmac_f32 v142, v47, v47
    v_mfma_f32_16x16x32_bf16 v[20:23], v[60:63], a[156:159], v[20:23]
    s_mov_b32 s45, s44
    v_cvt_pk_bf16_f32 v170, v143, v142
    v_mfma_f32_16x16x32_bf16 v[20:23], v[56:59], a[160:163], v[20:23]
    s_mov_b32 s44, s53
    ds_read_b128 v[64:67], v134 offset:32
    v_mfma_f32_16x16x32_bf16 v[20:23], v[36:39], a[164:167], v[20:23]
    s_sub_u32 s48, s44, s46
    ds_read_b64 v[68:69], v134 offset:48
    v_add_u32 v139, s48, v139
    v_mfma_f32_16x16x16_bf16 v[48:51], v[216:217], v[170:171], 0
    s_sub_u32 s49, s46, s45
    v_add_u32 v138, s48, v138
    s_nop 1
    v_cvt_pk_bf16_f32 v164, v20, v21
    v_mfma_f32_16x16x32_bf16 v[72:75], v[96:99], a[168:171], 0
    v_cvt_pk_bf16_f32 v165, v22, v23
    v_mfma_f32_16x16x32_bf16 v[72:75], v[92:95], a[172:175], v[72:75]
    v_rsq_f32 v48, v48
    v_mfma_f32_16x16x32_bf16 v[72:75], v[40:43], a[176:179], v[72:75]
    v_rsq_f32 v49, v49
    v_mfma_f32_16x16x32_bf16 v[72:75], v[60:63], a[180:183], v[72:75]
    v_mul_f32 v48, s55, v48
    v_mul_f32 v49, 0.5, v49
    v_mfma_f32_16x16x32_bf16 v[72:75], v[56:59], a[184:187], v[72:75]
    v_mul_f32 v52, v52, v49
    v_mul_f32 v53, v53, v49
    v_mfma_f32_16x16x32_bf16 v[72:75], v[36:39], a[188:191], v[72:75]
    ds_read_u16 v166, v133 offset:56
    v_cvt_pk_f16_f32 v70, v52, v53
    v_mfma_f32_16x16x32_bf16 v[20:23], v[96:99], a[192:195], 0
    ds_read_u16 v162, v133 offset:64
    v_mul_f32 v54, v54, v49
    v_mfma_f32_16x16x32_bf16 v[20:23], v[92:95], a[196:199], v[20:23]
    s_nop 0
    ds_read_u16 v158, v133 offset:72
    v_cvt_pk_bf16_f32 v160, v72, v73
    v_mfma_f32_16x16x32_bf16 v[20:23], v[40:43], a[200:203], v[20:23]
    ds_read_b128 v[40:43], v134 offset:0
    v_cvt_pk_bf16_f32 v161, v74, v75
    v_mfma_f32_16x16x32_bf16 v[20:23], v[60:63], a[204:207], v[20:23]
    ds_read_b64 v[142:143], v134 offset:16
    v_mul_f32 v55, v55, v49
    v_mfma_f32_16x16x32_bf16 v[20:23], v[56:59], a[208:211], v[20:23]
    v_cvt_pk_f16_f32 v71, v54, v55
    v_mul_f32 v8, v8, v49
    v_mfma_f32_16x16x32_bf16 v[20:23], v[36:39], a[212:215], v[20:23]
    v_mul_f32 v9, v9, v49
    v_cvt_pk_f16_f32 v72, v8, v9
    v_mfma_f32_16x16x32_f16 v[36:39], v[82:85], v[16:19], v[204:207]
    v_mul_f32 v10, v10, v49
    v_mul_f32 v11, v11, v49
    v_mfma_f32_16x16x32_f16 v[36:39], v[84:87], v[152:155], v[36:39]
    v_cvt_pk_f16_f32 v73, v10, v11
    v_mul_f32 v44, v44, v49
    v_mfma_f32_16x16x32_f16 v[60:63], v[76:79], v[16:19], v[200:203]
    v_mul_f32 v45, v45, v49
    v_cvt_pk_f16_f32 v74, v44, v45
    v_mfma_f32_16x16x32_f16 v[60:63], v[78:81], v[152:155], v[60:63]
    s_waitcnt lgkmcnt(3)
    v_mul_f32 v46, v46, v49
    v_mul_f32 v47, v47, v49
    v_mfma_f32_16x16x32_f16 v[8:11], v[64:67], v[16:19], v[208:211]
    v_cvt_pk_f16_f32 v75, v46, v47
    v_mul_f32 v12, v12, v48
    v_mfma_f32_16x16x32_f16 v[8:11], v[66:69], v[152:155], v[8:11]
    v_mul_f32 v13, v13, v48
    v_cvt_pk_f16_f32 v44, v12, v13
    v_mfma_f32_16x16x32_f16 v[56:59], v[70:73], v[16:19], v[196:199]
    v_mul_f32 v14, v14, v48
    v_mul_f32 v15, v15, v48
    v_mfma_f32_16x16x32_f16 v[56:59], v[72:75], v[152:155], v[56:59]
    s_waitcnt lgkmcnt(0)
    v_cvt_pk_f16_f32 v45, v14, v15
    v_mul_f32 v4, v4, v48
    v_mfma_f32_16x16x32_f16 v[16:19], v[40:43], v[82:85], v[208:211]
    v_mul_f32 v5, v5, v48
    v_cvt_pk_f16_f32 v46, v4, v5
    v_mfma_f32_16x16x32_f16 v[16:19], v[140:143], v[84:87], v[16:19]
    v_mul_f32 v6, v6, v48
    v_mul_f32 v7, v7, v48
    v_mfma_f32_16x16x32_f16 v[12:15], v[40:43], v[76:79], v[208:211]
    v_cvt_pk_f16_f32 v47, v6, v7
    v_mul_f32 v0, v0, v48
    v_mfma_f32_16x16x32_f16 v[12:15], v[140:143], v[78:81], v[12:15]
    v_mul_f32 v1, v1, v48
    v_cvt_pk_f16_f32 v146, v0, v1
    v_mfma_f32_16x16x32_f16 v[4:7], v[40:43], v[70:73], v[208:211]
    v_mul_f32 v2, v2, v48
    v_mul_f32 v3, v3, v48
    v_mfma_f32_16x16x32_f16 v[4:7], v[140:143], v[72:75], v[4:7]
    v_cvt_pk_f16_f32 v147, v2, v3
    v_cvt_pk_bf16_f32 v156, v20, v21
    v_mfma_f32_16x16x32_f16 v[0:3], v[40:43], v[64:67], v[208:211]
    v_cvt_pk_bf16_f32 v157, v22, v23
    v_max3_f32 v154, v36, v37, v38
    v_mfma_f32_16x16x32_f16 v[0:3], v[140:143], v[66:69], v[0:3]
    v_max3_f32 v154, v154, v39, v60
    v_max3_f32 v154, v154, v61, v62
    v_mfma_f32_16x16x32_f16 v[40:43], v[82:85], v[88:91], v[192:195]
    v_max3_f32 v154, v154, v63, v56
    v_max3_f32 v154, v154, v57, v58
    v_mfma_f32_16x16x32_f16 v[40:43], v[84:87], v[148:151], v[40:43]
    v_max3_f32 v154, v154, v59, v8
    v_mov_b32 v155, v154
    v_mfma_f32_16x16x32_f16 v[52:55], v[76:79], v[88:91], v[188:191]
    s_nop 0
    v_permlane32_swap_b32 v155, v154
    v_mfma_f32_16x16x32_f16 v[52:55], v[78:81], v[148:151], v[52:55]
    v_max_f32 v154, v155, v154
    v_mov_b32 v155, v154
    v_mfma_f32_16x16x32_f16 v[48:51], v[70:73], v[88:91], v[184:187]
    s_nop 0
    v_permlane16_swap_b32 v155, v154
    v_mfma_f32_16x16x32_f16 v[48:51], v[72:75], v[148:151], v[48:51]
    v_max_f32 v154, v155, v154
    v_sub_f32 v36, v36, v154
    v_mfma_f32_16x16x32_f16 v[20:23], v[64:67], v[88:91], v[208:211]
    v_sub_f32 v37, v37, v154
    v_sub_f32 v38, v38, v154
    v_mfma_f32_16x16x32_f16 v[20:23], v[66:69], v[148:151], v[20:23]
    v_sub_f32 v39, v39, v154
    v_sub_f32 v60, v60, v154
    v_sub_f32 v61, v61, v154
    v_sub_f32 v62, v62, v154
    v_sub_f32 v63, v63, v154
    v_sub_f32 v56, v56, v154
    v_sub_f32 v57, v57, v154
    v_sub_f32 v58, v58, v154
    v_sub_f32 v59, v59, v154
    v_sub_f32 v8, v8, v154
    v_exp_f32 v36, v36
    v_exp_f32 v37, v37
    v_exp_f32 v38, v38
    v_exp_f32 v39, v39
    v_cvt_pk_bf16_f32 v36, v36, v37
    v_cvt_pk_bf16_f32 v37, v38, v39
    v_exp_f32 v60, v60
    v_exp_f32 v61, v61
    v_exp_f32 v62, v62
    v_exp_f32 v63, v63
    v_cvt_pk_bf16_f32 v38, v60, v61
    v_cvt_pk_bf16_f32 v39, v62, v63
    v_exp_f32 v56, v56
    v_exp_f32 v57, v57
    v_exp_f32 v58, v58
    v_exp_f32 v59, v59
    v_cvt_pk_bf16_f32 v168, v56, v57
    v_cvt_pk_bf16_f32 v169, v58, v59
    v_exp_f32 v8, v8
    v_mov_b32_dpp v19, v15 quad_perm:[0,1,2,3] row_mask:0x2 bank_mask:0xf
    v_cvt_pk_bf16_f32 v170, v8, 0
    v_mfma_f32_16x16x32_bf16 v[8:11], v[220:223], v[36:39], 0
    v_mov_b32_dpp v19, v7 quad_perm:[0,1,2,3] row_mask:0x4 bank_mask:0xf
    v_max3_f32 v142, v40, v41, v42
    v_mfma_f32_16x16x32_bf16 v[8:11], v[220:223], v[168:171], v[8:11]
    v_mov_b32_dpp v19, v3 quad_perm:[0,1,2,3] row_mask:0x8 bank_mask:0xf
    v_mov_b32 v150, v19
    v_mfma_f32_16x16x32_bf16 v[4:7], v[24:27], v[36:39], 0
    s_nop 0
    v_max_f32_dpp v150, v150, v150 row_ror:8 row_mask:0xf bank_mask:0xf
    v_max3_f32 v142, v142, v43, v52
    v_mfma_f32_16x16x32_bf16 v[4:7], v[164:167], v[168:171], v[4:7]
    v_max_f32_dpp v150, v150, v150 row_ror:4 row_mask:0xf bank_mask:0xf
    v_max3_f32 v142, v142, v53, v54
    v_mfma_f32_16x16x32_bf16 v[12:15], v[28:31], v[36:39], 0
    v_max_f32_dpp v150, v150, v150 row_ror:2 row_mask:0xf bank_mask:0xf
    v_max3_f32 v142, v142, v55, v48
    v_mfma_f32_16x16x32_bf16 v[12:15], v[160:163], v[168:171], v[12:15]
    v_max_f32_dpp v150, v150, v150 row_ror:1 row_mask:0xf bank_mask:0xf
    v_mov_b32 v143, v150
    v_mfma_f32_16x16x32_bf16 v[0:3], v[32:35], v[36:39], 0
    s_nop 0
    v_permlane32_swap_b32 v143, v150
    v_mfma_f32_16x16x32_bf16 v[0:3], v[156:159], v[168:171], v[0:3]
    v_max_f32 v150, v143, v150
    v_mov_b32 v143, v150
    v_rcp_f32 v8, v8
    v_max3_f32 v142, v142, v49, v50
    v_permlane16_swap_b32 v143, v150
    v_max_f32 v150, v143, v150
    v_sub_f32 v19, v19, v150
    v_exp_f32 v19, v19
    v_mul_f32 v4, v4, v8
    v_cvt_pk_bf16_f32 v19, v19, v19
    ds_write_b16 v125, v19
    v_mul_f32 v5, v5, v8
    v_cvt_pk_bf16_f32 v4, v4, v5
    ds_read_b128 v[60:63], v134
    v_mul_f32 v6, v6, v8
    v_mul_f32 v7, v7, v8
    v_cvt_pk_bf16_f32 v5, v6, v7
    ds_read_b128 v[56:59], v134 offset:16
    v_mfma_f32_16x16x32_f16 v[16:19], v[82:85], v[44:47], v[180:183]
    v_mul_f32 v12, v12, v8
    v_mul_f32 v13, v13, v8
    v_mfma_f32_16x16x32_f16 v[16:19], v[84:87], v[144:147], v[16:19]
    ds_write_b64 v137, v[4:5] offset:0
    v_mfma_f32_16x16x32_f16 v[36:39], v[76:79], v[44:47], v[176:179]
    v_cvt_pk_bf16_f32 v6, v12, v13
    v_mul_f32 v14, v14, v8
    v_mfma_f32_16x16x32_f16 v[36:39], v[78:81], v[144:147], v[36:39]
    v_mul_f32 v15, v15, v8
    v_cvt_pk_bf16_f32 v7, v14, v15
    v_mfma_f32_16x16x32_f16 v[12:15], v[70:73], v[44:47], v[172:175]
    ds_write_b64 v137, v[6:7] offset:8
    v_mfma_f32_16x16x32_f16 v[12:15], v[72:75], v[144:147], v[12:15]
    v_mul_f32 v0, v0, v8
    v_mul_f32 v1, v1, v8
    v_mfma_f32_16x16x32_f16 v[4:7], v[64:67], v[44:47], v[208:211]
    v_cvt_pk_bf16_f32 v150, v0, v1
    v_mul_f32 v2, v2, v8
    v_mfma_f32_16x16x32_f16 v[4:7], v[66:69], v[144:147], v[4:7]
    s_waitcnt lgkmcnt(2)
    v_mul_f32 v3, v3, v8
    v_cvt_pk_bf16_f32 v151, v2, v3
    v_mfma_f32_16x16x32_bf16 v[0:3], v[60:63], v[24:27], 0
    ds_write_b64 v136, v[150:151] offset:0
    v_mfma_f32_16x16x32_bf16 v[0:3], v[56:59], v[164:167], v[0:3]
    v_max3_f32 v142, v142, v51, v21
    v_mov_b32 v143, v142
    v_mfma_f32_16x16x32_bf16 v[44:47], v[60:63], v[28:31], 0
    s_nop 0
    v_permlane32_swap_b32 v143, v142
    v_mfma_f32_16x16x32_bf16 v[44:47], v[56:59], v[160:163], v[44:47]
    v_max_f32 v142, v143, v142
    v_mov_b32 v143, v142
    v_mfma_f32_16x16x32_bf16 v[8:11], v[60:63], v[32:35], 0
    s_nop 0
    v_permlane16_swap_b32 v143, v142
    v_mfma_f32_16x16x32_bf16 v[8:11], v[56:59], v[156:159], v[8:11]
    v_max_f32 v142, v143, v142
    v_sub_f32 v40, v40, v142
    v_sub_f32 v41, v41, v142
    v_sub_f32 v42, v42, v142
    v_sub_f32 v43, v43, v142
    v_sub_f32 v52, v52, v142
    v_sub_f32 v53, v53, v142
    v_sub_f32 v54, v54, v142
    v_sub_f32 v55, v55, v142
    v_sub_f32 v48, v48, v142
    v_sub_f32 v49, v49, v142
    v_sub_f32 v50, v50, v142
    v_sub_f32 v51, v51, v142
    v_sub_f32 v21, v21, v142
    v_exp_f32 v40, v40
    v_exp_f32 v41, v41
    v_exp_f32 v42, v42
    v_exp_f32 v43, v43
    v_cvt_pk_bf16_f32 v40, v40, v41
    v_cvt_pk_bf16_f32 v41, v42, v43
    v_exp_f32 v52, v52
    v_exp_f32 v53, v53
    v_exp_f32 v54, v54
    v_exp_f32 v55, v55
    v_cvt_pk_bf16_f32 v42, v52, v53
    v_cvt_pk_bf16_f32 v43, v54, v55
    v_exp_f32 v48, v48
    v_exp_f32 v49, v49
    v_exp_f32 v50, v50
    v_exp_f32 v51, v51
    v_cvt_pk_bf16_f32 v168, v48, v49
    v_cvt_pk_bf16_f32 v169, v50, v51
    v_exp_f32 v21, v21
    v_mov_b32_dpp v3, v47 quad_perm:[0,1,2,3] row_mask:0x2 bank_mask:0xf
    v_cvt_pk_bf16_f32 v170, v21, 0
    v_mfma_f32_16x16x32_bf16 v[44:47], v[220:223], v[40:43], 0
    v_mov_b32_dpp v3, v11 quad_perm:[0,1,2,3] row_mask:0x4 bank_mask:0xf
    v_cvt_pk_bf16_f32 v3, v3, v3
    v_mfma_f32_16x16x32_bf16 v[44:47], v[220:223], v[168:171], v[44:47]
    ds_write_b16 v133, v3 offset:56
    v_mfma_f32_16x16x32_bf16 v[20:23], v[24:27], v[40:43], 0
    ds_read_b128 v[8:11], v139 offset:0
    v_max3_f32 v142, v16, v17, v18
    v_mfma_f32_16x16x32_bf16 v[20:23], v[164:167], v[168:171], v[20:23]
    ds_read_b128 v[60:63], v138 offset:0
    v_max3_f32 v142, v142, v19, v36
    v_mfma_f32_16x16x32_bf16 v[52:55], v[28:31], v[40:43], 0
    ds_read_b128 v[0:3], v139 offset:128
    v_max3_f32 v142, v142, v37, v38
    v_mfma_f32_16x16x32_bf16 v[52:55], v[160:163], v[168:171], v[52:55]
    ds_read_b128 v[72:75], v138 offset:128
    v_max3_f32 v142, v142, v39, v12
    v_mfma_f32_16x16x32_bf16 v[48:51], v[32:35], v[40:43], 0
    ds_read_b128 v[76:79], v139 offset:256
    v_max3_f32 v142, v142, v13, v14
    v_mfma_f32_16x16x32_bf16 v[48:51], v[156:159], v[168:171], v[48:51]
    ds_read_b128 v[64:67], v138 offset:256
    v_max3_f32 v142, v142, v15, v6
    v_rcp_f32 v44, v44
    v_mov_b32 v143, v142
    v_mul_f32 v20, v20, v44
    v_mul_f32 v21, v21, v44
    v_cvt_pk_bf16_f32 v40, v20, v21
    v_mul_f32 v22, v22, v44
    v_mul_f32 v23, v23, v44
    v_cvt_pk_bf16_f32 v41, v22, v23
    v_mul_f32 v52, v52, v44
    v_mul_f32 v53, v53, v44
    v_cvt_pk_bf16_f32 v42, v52, v53
    v_mul_f32 v54, v54, v44
    s_waitcnt lgkmcnt(5)
    v_mfma_f32_16x16x32_bf16 v[20:23], a[0:3], v[8:11], 0
    ds_write_b64 v137, v[40:41] offset:1536
    v_mul_f32 v55, v55, v44
    v_cvt_pk_bf16_f32 v43, v54, v55
    v_mul_f32 v48, v48, v44
    v_mul_f32 v49, v49, v44
    v_cvt_pk_bf16_f32 v146, v48, v49
    v_mul_f32 v50, v50, v44
    v_mul_f32 v51, v51, v44
    v_cvt_pk_bf16_f32 v147, v50, v51
    ds_write_b64 v137, v[42:43] offset:1544
    v_permlane32_swap_b32 v143, v142
    v_max_f32 v142, v143, v142
    v_mov_b32 v143, v142
    s_nop 0
    ds_write_b64 v136, v[146:147] offset:1536
    v_permlane16_swap_b32 v143, v142
    v_max_f32 v142, v143, v142
    v_sub_f32 v16, v16, v142
    v_sub_f32 v17, v17, v142
    v_sub_f32 v18, v18, v142
    v_sub_f32 v19, v19, v142
    v_sub_f32 v36, v36, v142
    v_sub_f32 v37, v37, v142
    v_sub_f32 v38, v38, v142
    v_sub_f32 v39, v39, v142
    v_sub_f32 v12, v12, v142
    v_sub_f32 v13, v13, v142
    v_sub_f32 v14, v14, v142
    v_sub_f32 v15, v15, v142
    v_sub_f32 v6, v6, v142
    v_exp_f32 v16, v16
    v_exp_f32 v17, v17
    v_exp_f32 v18, v18
    v_exp_f32 v19, v19
    v_cvt_pk_bf16_f32 v16, v16, v17
    v_cvt_pk_bf16_f32 v17, v18, v19
    v_exp_f32 v36, v36
    v_exp_f32 v37, v37
    v_exp_f32 v38, v38
    v_exp_f32 v39, v39
    v_cvt_pk_bf16_f32 v18, v36, v37
    v_cvt_pk_bf16_f32 v19, v38, v39
    v_exp_f32 v12, v12
    v_exp_f32 v13, v13
    v_exp_f32 v14, v14
    v_exp_f32 v15, v15
    v_cvt_pk_bf16_f32 v168, v12, v13
    v_cvt_pk_bf16_f32 v169, v14, v15
    v_exp_f32 v6, v6
    s_nop 0
    v_cvt_pk_bf16_f32 v170, v6, 0
    v_mfma_f32_16x16x32_bf16 v[4:7], v[220:223], v[16:19], 0
    s_nop 0
    v_mfma_f32_16x16x32_bf16 v[4:7], v[220:223], v[168:171], v[4:7]
    s_nop 1
    v_mfma_f32_16x16x32_bf16 v[12:15], v[24:27], v[16:19], 0
    s_nop 2
    v_mfma_f32_16x16x32_bf16 v[12:15], v[164:167], v[168:171], v[12:15]
    s_nop 0
    v_rcp_f32 v4, v4
    v_mfma_f32_16x16x32_bf16 v[24:27], v[28:31], v[16:19], 0
    s_nop 2
    v_mfma_f32_16x16x32_bf16 v[24:27], v[160:163], v[168:171], v[24:27]
    s_nop 0
    v_mul_f32 v12, v12, v4
    v_mul_f32 v13, v13, v4
    v_mfma_f32_16x16x32_bf16 v[28:31], v[32:35], v[16:19], 0
    v_cvt_pk_bf16_f32 v44, v12, v13
    v_mul_f32 v14, v14, v4
    v_mfma_f32_16x16x32_bf16 v[28:31], v[156:159], v[168:171], v[28:31]
    v_mul_f32 v15, v15, v4
    v_cvt_pk_bf16_f32 v45, v14, v15
    s_waitcnt lgkmcnt(0)
.p2align 6
L_loopS0:
    v_mfma_f32_16x16x32_bf16 v[20:23], a[4:7], v[60:63], v[20:23]
    ds_write_b64 v137, v[44:45] offset:3072
    v_mfma_f32_16x16x32_bf16 v[20:23], a[8:11], v[0:3], v[20:23]
    v_mul_f32 v24, v24, v4
    v_mul_f32 v25, v25, v4
    v_mfma_f32_16x16x32_bf16 v[20:23], a[12:15], v[72:75], v[20:23]
    v_cvt_pk_bf16_f32 v46, v24, v25
    v_mul_f32 v26, v26, v4
    v_mfma_f32_16x16x32_bf16 v[20:23], a[16:19], v[76:79], v[20:23]
    v_mul_f32 v27, v27, v4
    v_cvt_pk_bf16_f32 v47, v26, v27
    v_mfma_f32_16x16x32_bf16 v[20:23], a[20:23], v[64:67], v[20:23]
    ds_write_b64 v137, v[46:47] offset:3080
    v_mfma_f32_16x16x32_bf16 v[44:47], a[24:27], v[8:11], 0
    v_mul_f32 v28, v28, v4
    v_mul_f32 v29, v29, v4
    v_mfma_f32_16x16x32_bf16 v[44:47], a[28:31], v[60:63], v[44:47]
    v_cvt_pk_bf16_f32 v28, v28, v29
    v_mul_f32 v30, v30, v4
    v_mfma_f32_16x16x32_bf16 v[44:47], a[32:35], v[0:3], v[44:47]
    v_mul_f32 v31, v31, v4
    v_cvt_pk_bf16_f32 v29, v30, v31
    v_mfma_f32_16x16x32_bf16 v[44:47], a[36:39], v[72:75], v[44:47]
    ds_write_b64 v136, v[28:29] offset:3072
    v_mfma_f32_16x16x32_bf16 v[44:47], a[40:43], v[76:79], v[44:47]
    v_fmac_f32 v155, v52, v52
    v_fmac_f32 v155, v53, v53
    v_mfma_f32_16x16x32_bf16 v[44:47], a[44:47], v[64:67], v[44:47]
    v_fmac_f32 v155, v54, v54
    v_fmac_f32 v155, v55, v55
    v_mfma_f32_16x16x32_bf16 v[4:7], a[48:51], v[8:11], 0
    v_fma_f32 v170, v12, v12, s42
    v_fmac_f32 v170, v13, v13
    v_mfma_f32_16x16x32_bf16 v[4:7], a[52:55], v[60:63], v[4:7]
    v_fmac_f32 v170, v14, v14
    v_fmac_f32 v170, v15, v15
    v_mfma_f32_16x16x32_bf16 v[4:7], a[56:59], v[0:3], v[4:7]
    v_fmac_f32 v170, v16, v16
    v_fmac_f32 v170, v17, v17
    v_mfma_f32_16x16x32_bf16 v[4:7], a[60:63], v[72:75], v[4:7]
    v_fmac_f32 v170, v18, v18
    v_fmac_f32 v170, v19, v19
    v_mfma_f32_16x16x32_bf16 v[4:7], a[64:67], v[76:79], v[4:7]
    s_waitcnt vmcnt(10)
    v_fmac_f32 v170, v56, v56
    v_fmac_f32 v170, v57, v57
    v_mfma_f32_16x16x32_bf16 v[4:7], a[68:71], v[64:67], v[4:7]
    v_fmac_f32 v170, v58, v58
    v_fmac_f32 v170, v59, v59
    v_mfma_f32_16x16x32_bf16 v[88:91], a[72:75], v[8:11], 0
    v_cvt_pk_bf16_f32 v154, v154, v155
    v_cvt_pk_bf16_f32 v155, v170, v124
    v_mfma_f32_16x16x32_bf16 v[88:91], a[76:79], v[60:63], v[88:91]
    ds_write_b64 v132, v[154:155]
    v_mfma_f32_16x16x32_bf16 v[88:91], a[80:83], v[0:3], v[88:91]
    v_add_u32 v137, s49, v137
    v_add_u32 v136, s49, v136
    v_mfma_f32_16x16x32_bf16 v[88:91], a[84:87], v[72:75], v[88:91]
    v_fma_f32 v154, v20, v20, s41
    v_fmac_f32 v154, v21, v21
    v_mfma_f32_16x16x32_bf16 v[88:91], a[88:91], v[76:79], v[88:91]
    v_fmac_f32 v154, v22, v22
    v_fmac_f32 v154, v23, v23
    v_mfma_f32_16x16x32_bf16 v[88:91], a[92:95], v[64:67], v[88:91]
    v_fmac_f32 v154, v44, v44
    v_fmac_f32 v154, v45, v45
    v_mfma_f32_16x16x32_bf16 v[104:107], a[96:99], v[8:11], 0
    v_fmac_f32 v154, v46, v46
    v_fmac_f32 v154, v47, v47
    v_mfma_f32_16x16x32_bf16 v[104:107], a[100:103], v[60:63], v[104:107]
    v_fmac_f32 v154, v4, v4
    v_fmac_f32 v154, v5, v5
    v_mfma_f32_16x16x32_bf16 v[104:107], a[104:107], v[0:3], v[104:107]
    v_fmac_f32 v154, v6, v6
    v_fmac_f32 v154, v7, v7
    v_mfma_f32_16x16x32_bf16 v[104:107], a[108:111], v[72:75], v[104:107]
    s_waitcnt lgkmcnt(0)
    v_fma_f32 v155, v88, v88, s41
    v_fmac_f32 v155, v89, v89
    v_mfma_f32_16x16x32_bf16 v[104:107], a[112:115], v[76:79], v[104:107]
    s_barrier
    ds_read_b128 v[68:71], v131 offset:0
    v_fmac_f32 v155, v90, v90
    v_mfma_f32_16x16x32_bf16 v[104:107], a[116:119], v[64:67], v[104:107]
    ds_read_b128 v[120:123], v131 offset:1024
    v_fmac_f32 v155, v91, v91
    v_mfma_f32_16x16x32_bf16 v[84:87], a[120:123], v[8:11], 0
    s_nop 2
    v_mfma_f32_16x16x32_bf16 v[84:87], a[124:127], v[60:63], v[84:87]
    s_nop 0
    v_fmac_f32 v155, v104, v104
    v_fmac_f32 v155, v105, v105
    v_mfma_f32_16x16x32_bf16 v[84:87], a[128:131], v[0:3], v[84:87]
    v_fmac_f32 v155, v106, v106
    v_fmac_f32 v155, v107, v107
    v_mfma_f32_16x16x32_bf16 v[84:87], a[132:135], v[72:75], v[84:87]
    v_mfma_f32_16x16x32_bf16 v[84:87], a[136:139], v[76:79], v[84:87]
    v_mfma_f32_16x16x32_bf16 v[84:87], a[140:143], v[64:67], v[84:87]
    v_mfma_f32_16x16x32_bf16 v[112:115], v[8:11], a[144:147], 0
    s_nop 2
    v_mfma_f32_16x16x32_bf16 v[112:115], v[60:63], a[148:151], v[112:115]
    s_waitcnt lgkmcnt(1)
    s_nop 0
    v_readfirstlane_b32 s12, v69
    v_fmac_f32 v155, v84, v84
    v_mfma_f32_16x16x32_bf16 v[112:115], v[0:3], a[152:155], v[112:115]
    s_lshr_b32 s12, s12, 23
    v_fmac_f32 v155, v85, v85
    v_fmac_f32 v155, v86, v86
    v_mfma_f32_16x16x32_bf16 v[112:115], v[72:75], a[156:159], v[112:115]
    v_fmac_f32 v155, v87, v87
    v_cvt_pk_bf16_f32 v170, v154, v155
    v_mfma_f32_16x16x32_bf16 v[112:115], v[76:79], a[160:163], v[112:115]
    v_mfma_f32_16x16x32_bf16 v[112:115], v[64:67], a[164:167], v[112:115]
    v_mfma_f32_16x16x32_bf16 v[80:83], v[216:219], v[68:71], 0
    s_waitcnt lgkmcnt(0)
    s_nop 0
    ds_read_b128 v[68:71], v139 offset:1536
    s_nop 0
    v_mfma_f32_16x16x32_bf16 v[80:83], v[216:219], v[120:123], v[80:83]
    s_nop 0
    ds_read_b128 v[120:123], v138 offset:1536
    v_cvt_pk_bf16_f32 v24, v112, v113
    v_mfma_f32_16x16x16_bf16 v[26:29], v[216:217], v[170:171], 0
    s_nop 0
    ds_read_b128 v[100:103], v139 offset:1664
    v_cvt_pk_bf16_f32 v25, v114, v115
    s_nop 0
    v_rsq_f32 v80, v80
    v_mfma_f32_16x16x32_bf16 v[154:157], v[8:11], a[168:171], 0
    ds_read_b128 v[112:115], v138 offset:1664
    v_mul_f32 v80, s43, v80
    v_mfma_f32_16x16x32_bf16 v[154:157], v[60:63], a[172:175], v[154:157]
    ds_read_b128 v[96:99], v139 offset:1792
    v_mul_f32 v40, v40, v80
    v_mfma_f32_16x16x32_bf16 v[154:157], v[0:3], a[176:179], v[154:157]
    ds_read_b128 v[92:95], v138 offset:1792
    v_mul_f32 v41, v41, v80
    v_mfma_f32_16x16x32_bf16 v[154:157], v[72:75], a[180:183], v[154:157]
    v_rsq_f32 v81, v81
    v_mfma_f32_16x16x32_bf16 v[154:157], v[76:79], a[184:187], v[154:157]
    v_rsq_f32 v82, v82
    v_mfma_f32_16x16x32_bf16 v[154:157], v[64:67], a[188:191], v[154:157]
    v_mul_f32 v81, s43, v81
    v_mul_f32 v82, s43, v82
    v_mfma_f32_16x16x32_bf16 v[116:119], v[8:11], a[192:195], 0
    v_rsq_f32 v26, v26
    v_mfma_f32_16x16x32_bf16 v[116:119], v[60:63], a[196:199], v[116:119]
    v_rsq_f32 v27, v27
    v_mfma_f32_16x16x32_bf16 v[116:119], v[0:3], a[200:203], v[116:119]
    v_mul_f32 v26, s55, v26
    v_mul_f32 v27, 0.5, v27
    v_mfma_f32_16x16x32_bf16 v[116:119], v[72:75], a[204:207], v[116:119]
    v_cvt_pk_bf16_f32 v28, v154, v155
    v_cvt_pk_bf16_f32 v29, v156, v157
    v_mfma_f32_16x16x32_bf16 v[116:119], v[76:79], a[208:211], v[116:119]
    v_mul_f32 v20, v20, v26
    v_mul_f32 v21, v21, v26
    v_mfma_f32_16x16x32_bf16 v[116:119], v[64:67], a[212:215], v[116:119]
    s_waitcnt lgkmcnt(0)
    v_cvt_pk_f16_f32 v64, v20, v21
    v_mul_f32 v22, v22, v26
    v_mfma_f32_16x16x32_bf16 v[8:11], a[0:3], v[68:71], 0
    v_mul_f32 v23, v23, v26
    v_cvt_pk_f16_f32 v65, v22, v23
    v_mfma_f32_16x16x32_bf16 v[8:11], a[4:7], v[120:123], v[8:11]
    v_mul_f32 v44, v44, v26
    v_mul_f32 v45, v45, v26
    v_mfma_f32_16x16x32_bf16 v[8:11], a[8:11], v[100:103], v[8:11]
    v_cvt_pk_f16_f32 v66, v44, v45
    v_mul_f32 v46, v46, v26
    v_mfma_f32_16x16x32_bf16 v[8:11], a[12:15], v[112:115], v[8:11]
    v_mul_f32 v47, v47, v26
    v_cvt_pk_f16_f32 v67, v46, v47
    v_mfma_f32_16x16x32_bf16 v[8:11], a[16:19], v[96:99], v[8:11]
    v_mul_f32 v4, v4, v26
    v_mul_f32 v5, v5, v26
    v_mfma_f32_16x16x32_bf16 v[8:11], a[20:23], v[92:95], v[8:11]
    v_cvt_pk_f16_f32 v154, v4, v5
    v_mul_f32 v6, v6, v26
    v_mfma_f32_16x16x32_bf16 v[20:23], a[24:27], v[68:71], 0
    v_mul_f32 v7, v7, v26
    v_cvt_pk_f16_f32 v155, v6, v7
    v_mfma_f32_16x16x32_bf16 v[20:23], a[28:31], v[120:123], v[20:23]
    v_mul_f32 v88, v88, v27
    v_mul_f32 v89, v89, v27
    v_mfma_f32_16x16x32_bf16 v[20:23], a[32:35], v[100:103], v[20:23]
    v_cvt_pk_f16_f32 v0, v88, v89
    v_mul_f32 v90, v90, v27
    v_mfma_f32_16x16x32_bf16 v[20:23], a[36:39], v[112:115], v[20:23]
    v_mul_f32 v91, v91, v27
    v_cvt_pk_f16_f32 v1, v90, v91
    v_mfma_f32_16x16x32_bf16 v[20:23], a[40:43], v[96:99], v[20:23]
    v_mul_f32 v104, v104, v27
    v_mul_f32 v105, v105, v27
    v_mfma_f32_16x16x32_bf16 v[20:23], a[44:47], v[92:95], v[20:23]
    v_cvt_pk_f16_f32 v2, v104, v105
    v_mul_f32 v106, v106, v27
    v_mfma_f32_16x16x32_bf16 v[76:79], a[48:51], v[68:71], 0
    v_mul_f32 v107, v107, v27
    v_cvt_pk_f16_f32 v3, v106, v107
    v_mfma_f32_16x16x32_bf16 v[76:79], a[52:55], v[120:123], v[76:79]
    v_mul_f32 v84, v84, v27
    v_mul_f32 v85, v85, v27
    v_mfma_f32_16x16x32_bf16 v[76:79], a[56:59], v[100:103], v[76:79]
    v_cvt_pk_f16_f32 v4, v84, v85
    v_mul_f32 v86, v86, v27
    v_mfma_f32_16x16x32_bf16 v[76:79], a[60:63], v[112:115], v[76:79]
    v_mul_f32 v87, v87, v27
    v_cvt_pk_f16_f32 v5, v86, v87
    v_mfma_f32_16x16x32_bf16 v[76:79], a[64:67], v[96:99], v[76:79]
    v_cvt_pk_bf16_f32 v44, v116, v117
    v_cvt_pk_bf16_f32 v45, v118, v119
    v_mfma_f32_16x16x32_bf16 v[76:79], a[68:71], v[92:95], v[76:79]
    v_cvt_pk_bf16_f32 v40, v40, v41
    v_mul_f32 v42, v42, v80
    v_mfma_f32_16x16x32_bf16 v[60:63], a[72:75], v[68:71], 0
    v_mul_f32 v43, v43, v80
    v_cvt_pk_bf16_f32 v41, v42, v43
    v_mfma_f32_16x16x32_bf16 v[60:63], a[76:79], v[120:123], v[60:63]
    ds_write_b64 v137, v[40:41] offset:0
    v_mfma_f32_16x16x32_bf16 v[60:63], a[80:83], v[100:103], v[60:63]
    v_mul_f32 v36, v36, v80
    v_mul_f32 v37, v37, v80
    v_mfma_f32_16x16x32_bf16 v[60:63], a[84:87], v[112:115], v[60:63]
    v_cvt_pk_bf16_f32 v42, v36, v37
    v_mul_f32 v38, v38, v80
    v_mfma_f32_16x16x32_bf16 v[60:63], a[88:91], v[96:99], v[60:63]
    v_mul_f32 v39, v39, v80
    v_cvt_pk_bf16_f32 v43, v38, v39
    v_mfma_f32_16x16x32_bf16 v[60:63], a[92:95], v[92:95], v[60:63]
    ds_write_b64 v137, v[42:43] offset:8
    v_mfma_f32_16x16x32_bf16 v[40:43], a[96:99], v[68:71], 0
    v_mul_f32 v32, v32, v80
    v_mul_f32 v33, v33, v80
    v_mfma_f32_16x16x32_bf16 v[40:43], a[100:103], v[120:123], v[40:43]
    v_cvt_pk_bf16_f32 v26, v32, v33
    v_mul_f32 v34, v34, v80
    v_mfma_f32_16x16x32_bf16 v[40:43], a[104:107], v[100:103], v[40:43]
    v_mul_f32 v35, v35, v80
    v_cvt_pk_bf16_f32 v27, v34, v35
    v_mfma_f32_16x16x32_bf16 v[40:43], a[108:111], v[112:115], v[40:43]
    ds_write_b64 v136, v[26:27] offset:0
    v_mfma_f32_16x16x32_bf16 v[40:43], a[112:115], v[96:99], v[40:43]
    v_fma_f32 v26, v8, v8, s41
    v_fmac_f32 v26, v9, v9
    v_mfma_f32_16x16x32_bf16 v[40:43], a[116:119], v[92:95], v[40:43]
    v_fmac_f32 v26, v10, v10
    v_fmac_f32 v26, v11, v11
    v_mfma_f32_16x16x32_bf16 v[36:39], a[120:123], v[68:71], 0
    v_fmac_f32 v26, v20, v20
    v_fmac_f32 v26, v21, v21
    v_mfma_f32_16x16x32_bf16 v[36:39], a[124:127], v[120:123], v[36:39]
    v_fmac_f32 v26, v22, v22
    v_fmac_f32 v26, v23, v23
    v_mfma_f32_16x16x32_bf16 v[36:39], a[128:131], v[100:103], v[36:39]
    v_fmac_f32 v26, v76, v76
    v_fmac_f32 v26, v77, v77
    v_mfma_f32_16x16x32_bf16 v[36:39], a[132:135], v[112:115], v[36:39]
    v_fmac_f32 v26, v78, v78
    v_fmac_f32 v26, v79, v79
    v_mfma_f32_16x16x32_bf16 v[36:39], a[136:139], v[96:99], v[36:39]
    v_mul_f32 v48, v48, v81
    v_mul_f32 v49, v49, v81
    v_mfma_f32_16x16x32_bf16 v[36:39], a[140:143], v[92:95], v[36:39]
    v_cvt_pk_bf16_f32 v30, v48, v49
    v_mul_f32 v50, v50, v81
    v_mfma_f32_16x16x32_bf16 v[46:49], v[68:71], a[144:147], 0
    v_mul_f32 v51, v51, v81
    v_cvt_pk_bf16_f32 v31, v50, v51
    v_mfma_f32_16x16x32_bf16 v[46:49], v[120:123], a[148:151], v[46:49]
    ds_write_b64 v137, v[30:31] offset:1536
    v_mfma_f32_16x16x32_bf16 v[46:49], v[100:103], a[152:155], v[46:49]
    v_mul_f32 v108, v108, v81
    v_mul_f32 v109, v109, v81
    v_mfma_f32_16x16x32_bf16 v[46:49], v[112:115], a[156:159], v[46:49]
    v_cvt_pk_bf16_f32 v32, v108, v109
    v_mul_f32 v110, v110, v81
    v_mfma_f32_16x16x32_bf16 v[46:49], v[96:99], a[160:163], v[46:49]
    ds_read_b128 v[72:75], v139 offset:3072
    v_mul_f32 v111, v111, v81
    v_mfma_f32_16x16x32_bf16 v[46:49], v[92:95], a[164:167], v[46:49]
    ds_read_b128 v[88:91], v138 offset:3072
    v_cvt_pk_bf16_f32 v33, v110, v111
    v_mfma_f32_16x16x32_bf16 v[106:109], v[68:71], a[168:171], 0
    ds_write_b64 v137, v[32:33] offset:1544
    v_mfma_f32_16x16x32_bf16 v[106:109], v[120:123], a[172:175], v[106:109]
    v_mul_f32 v52, v52, v81
    v_mul_f32 v53, v53, v81
    v_mfma_f32_16x16x32_bf16 v[106:109], v[100:103], a[176:179], v[106:109]
    ds_read_b128 v[32:35], v139 offset:3200
    v_cvt_pk_bf16_f32 v30, v52, v53
    v_mfma_f32_16x16x32_bf16 v[106:109], v[112:115], a[180:183], v[106:109]
    ds_read_b128 v[84:87], v138 offset:3200
    v_mul_f32 v54, v54, v81
    v_mfma_f32_16x16x32_bf16 v[106:109], v[96:99], a[184:187], v[106:109]
    ds_read_b128 v[116:119], v139 offset:3328
    v_mul_f32 v55, v55, v81
    v_mfma_f32_16x16x32_bf16 v[106:109], v[92:95], a[188:191], v[106:109]
    ds_read_b128 v[212:215], v138 offset:3328
    v_cvt_pk_bf16_f32 v31, v54, v55
    v_fma_f32 v27, v60, v60, s41
    v_fmac_f32 v27, v61, v61
    ds_write_b64 v136, v[30:31] offset:1536
    v_fmac_f32 v27, v62, v62
    v_fmac_f32 v27, v63, v63
    v_mfma_f32_16x16x32_bf16 v[52:55], v[68:71], a[192:195], 0
    v_fmac_f32 v27, v40, v40
    v_fmac_f32 v27, v41, v41
    v_mfma_f32_16x16x32_bf16 v[52:55], v[120:123], a[196:199], v[52:55]
    s_sub_u32 s50, s45, s44
    v_fmac_f32 v27, v42, v42
    v_fmac_f32 v27, v43, v43
    v_mfma_f32_16x16x32_bf16 v[52:55], v[100:103], a[200:203], v[52:55]
    s_sub_u32 s51, s46, s47
    v_fmac_f32 v27, v36, v36
    v_fmac_f32 v27, v37, v37
    v_mfma_f32_16x16x32_bf16 v[52:55], v[112:115], a[204:207], v[52:55]
    s_mov_b32 s60, s59
    v_fmac_f32 v27, v38, v38
    v_fmac_f32 v27, v39, v39
    v_mfma_f32_16x16x32_bf16 v[52:55], v[96:99], a[208:211], v[52:55]
    s_mov_b32 s59, s58
    v_cvt_pk_bf16_f32 v170, v26, v27
    v_cvt_pk_bf16_f32 v26, v46, v47
    v_mfma_f32_16x16x32_bf16 v[52:55], v[92:95], a[212:215], v[52:55]
    s_mov_b32 s58, s57
    v_cvt_pk_bf16_f32 v27, v48, v49
    v_cvt_pk_bf16_f32 v30, v106, v107
    v_mfma_f32_16x16x16_bf16 v[68:71], v[216:217], v[170:171], 0
    s_waitcnt lgkmcnt(0)
    s_mov_b32 s57, s56
    v_cvt_pk_bf16_f32 v31, v108, v109
    v_mul_f32 v12, v12, v82
    v_mul_f32 v13, v13, v82
    v_cvt_pk_bf16_f32 v46, v52, v53
    v_mfma_f32_16x16x32_bf16 v[48:51], a[0:3], v[72:75], 0
    s_mov_b32 s7, s6
    v_cvt_pk_bf16_f32 v47, v54, v55
    v_cvt_pk_bf16_f32 v12, v12, v13
    v_mfma_f32_16x16x32_bf16 v[48:51], a[4:7], v[88:91], v[48:51]
    s_mov_b32 s6, s5
    v_rsq_f32 v68, v68
    v_mfma_f32_16x16x32_bf16 v[48:51], a[8:11], v[32:35], v[48:51]
    s_mov_b32 s5, s4
    v_rsq_f32 v69, v69
    v_mfma_f32_16x16x32_bf16 v[48:51], a[12:15], v[84:87], v[48:51]
    s_sub_u32 s14, s6, s7
    v_mul_f32 v68, s55, v68
    v_mul_f32 v69, 0.5, v69
    v_mfma_f32_16x16x32_bf16 v[48:51], a[16:19], v[116:119], v[48:51]
    s_add_u32 s61, s61, 1
    v_mul_f32 v8, v8, v68
    v_mul_f32 v9, v9, v68
    v_mfma_f32_16x16x32_bf16 v[48:51], a[20:23], v[212:215], v[48:51]
    s_ff1_i32_b32 s15, s66
    v_cvt_pk_f16_f32 v52, v8, v9
    v_mul_f32 v10, v10, v68
    v_mfma_f32_16x16x32_bf16 v[106:109], a[24:27], v[72:75], 0
    s_cmp_lg_u32 s66, 0
    v_mul_f32 v11, v11, v68
    v_cvt_pk_f16_f32 v53, v10, v11
    v_mfma_f32_16x16x32_bf16 v[106:109], a[28:31], v[88:91], v[106:109]
    s_cselect_b32 s12, s15, s12
    v_mul_f32 v20, v20, v68
    v_mul_f32 v21, v21, v68
    v_mfma_f32_16x16x32_bf16 v[106:109], a[32:35], v[32:35], v[106:109]
    s_cmp_lt_u32 s61, s71
    v_cvt_pk_f16_f32 v54, v20, v21
    v_mul_f32 v22, v22, v68
    v_mfma_f32_16x16x32_bf16 v[106:109], a[36:39], v[84:87], v[106:109]
    s_cselect_b32 s15, 31, s15
    v_mul_f32 v23, v23, v68
    v_cvt_pk_f16_f32 v55, v22, v23
    v_mfma_f32_16x16x32_bf16 v[106:109], a[40:43], v[116:119], v[106:109]
    s_bitset0_b32 s66, s15
    v_mul_f32 v76, v76, v68
    v_mul_f32 v77, v77, v68
    v_mfma_f32_16x16x32_bf16 v[106:109], a[44:47], v[212:215], v[106:109]
    s_add_u32 s12, s12, 20
    v_cvt_pk_f16_f32 v150, v76, v77
    v_mul_f32 v78, v78, v68
    v_mfma_f32_16x16x32_bf16 v[120:123], a[48:51], v[72:75], 0
    s_max_u32 s12, s12, s61
    v_mul_f32 v79, v79, v68
    v_cvt_pk_f16_f32 v151, v78, v79
    v_mfma_f32_16x16x32_bf16 v[120:123], a[52:55], v[88:91], v[120:123]
    s_cmp_lt_u32 s61, s71
    v_mul_f32 v60, v60, v69
    v_mul_f32 v61, v61, v69
    v_mfma_f32_16x16x32_bf16 v[120:123], a[56:59], v[32:35], v[120:123]
    s_cselect_b32 s15, s61, s12
    v_cvt_pk_f16_f32 v6, v60, v61
    v_mul_f32 v62, v62, v69
    v_mfma_f32_16x16x32_bf16 v[120:123], a[60:63], v[84:87], v[120:123]
    s_cselect_b32 s56, s69, s70
    v_mul_f32 v63, v63, v69
    v_cvt_pk_f16_f32 v7, v62, v63
    v_mfma_f32_16x16x32_bf16 v[120:123], a[64:67], v[116:119], v[120:123]
    s_add_u32 s56, s56, s15
    v_mul_f32 v40, v40, v69
    v_mul_f32 v41, v41, v69
    v_mfma_f32_16x16x32_bf16 v[120:123], a[68:71], v[212:215], v[120:123]
    s_mul_i32 s53, s56, 58255
    v_cvt_pk_f16_f32 v8, v40, v41
    v_mul_f32 v42, v42, v69
    v_mfma_f32_16x16x32_bf16 v[20:23], a[72:75], v[72:75], 0
    s_lshr_b32 s53, s53, 22
    v_mul_f32 v43, v43, v69
    v_cvt_pk_f16_f32 v9, v42, v43
    v_mfma_f32_16x16x32_bf16 v[20:23], a[76:79], v[88:91], v[20:23]
    s_mul_i32 s53, s53, s63
    v_mul_f32 v36, v36, v69
    v_mul_f32 v37, v37, v69
    v_mfma_f32_16x16x32_bf16 v[20:23], a[80:83], v[32:35], v[20:23]
    s_mul_i32 s56, s56, s62
    v_cvt_pk_f16_f32 v10, v36, v37
    v_mul_f32 v38, v38, v69
    v_mfma_f32_16x16x32_bf16 v[20:23], a[84:87], v[84:87], v[20:23]
    s_add_u32 s56, s56, s53
    v_mul_f32 v39, v39, v69
    v_cvt_pk_f16_f32 v11, v38, v39
    v_mfma_f32_16x16x32_bf16 v[20:23], a[88:91], v[116:119], v[20:23]
    s_mul_i32 s4, s15, 336
    v_mul_f32 v14, v14, v82
    v_mul_f32 v15, v15, v82
    v_mfma_f32_16x16x32_bf16 v[20:23], a[92:95], v[212:215], v[20:23]
    s_cmp_ge_u32 s15, 16
    v_cvt_pk_bf16_f32 v13, v14, v15
    v_mul_f32 v16, v16, v82
    v_mfma_f32_16x16x32_bf16 v[36:39], a[96:99], v[72:75], 0
    s_cselect_b32 s53, -26880, 0
    ds_write_b64 v137, v[12:13] offset:3072
    v_mfma_f32_16x16x32_bf16 v[36:39], a[100:103], v[88:91], v[36:39]
    s_add_u32 s4, s4, s53
    v_mul_f32 v17, v17, v82
    v_cvt_pk_bf16_f32 v14, v16, v17
    v_mfma_f32_16x16x32_bf16 v[36:39], a[104:107], v[32:35], v[36:39]
    s_cmp_lt_u32 s15, s73
    v_mul_f32 v18, v18, v82
    v_mul_f32 v19, v19, v82
    v_mfma_f32_16x16x32_bf16 v[36:39], a[108:111], v[84:87], v[36:39]
    s_cselect_b32 s26, 100270464, 0
    v_cvt_pk_bf16_f32 v15, v18, v19
    v_mul_f32 v56, v56, v82
    v_mfma_f32_16x16x32_bf16 v[36:39], a[112:115], v[116:119], v[36:39]
    s_cselect_b32 s56, s56, 0
    ds_write_b64 v137, v[14:15] offset:3080
    v_mfma_f32_16x16x32_bf16 v[36:39], a[116:119], v[212:215], v[36:39]
    s_cselect_b32 s4, s4, -1
    v_mul_f32 v57, v57, v82
    v_cvt_pk_bf16_f32 v56, v56, v57
    v_mul_f32 v58, v58, v82
    v_mul_f32 v59, v59, v82
    v_cvt_pk_bf16_f32 v57, v58, v59
    s_cselect_b32 s15, s15, 0
    s_cselect_b32 s13, s13, -1
    ds_write_b64 v136, v[56:57] offset:3072
    v_fma_f32 v142, v48, v48, s41
    v_fmac_f32 v142, v49, v49
    v_fmac_f32 v142, v50, v50
    v_fmac_f32 v142, v51, v51
    v_mfma_f32_16x16x32_bf16 v[56:59], a[120:123], v[72:75], 0
    s_waitcnt vmcnt(0)
    v_fmac_f32 v142, v106, v106
    v_fmac_f32 v142, v107, v107
    v_mfma_f32_16x16x32_bf16 v[56:59], a[124:127], v[88:91], v[56:59]
    s_bitset1_b32 s64, s15
    v_fmac_f32 v142, v108, v108
    v_fmac_f32 v142, v109, v109
    v_mfma_f32_16x16x32_bf16 v[56:59], a[128:131], v[32:35], v[56:59]
    s_add_u32 s65, s65, 1
    v_fmac_f32 v142, v120, v120
    v_fmac_f32 v142, v121, v121
    v_mfma_f32_16x16x32_bf16 v[56:59], a[132:135], v[84:87], v[56:59]
    s_cmp_ge_i32 s65, 2
    v_fmac_f32 v142, v122, v122
    v_fmac_f32 v142, v123, v123
    v_mfma_f32_16x16x32_bf16 v[56:59], a[136:139], v[116:119], v[56:59]
    s_cselect_b32 s30, 100270464, 0
    v_fma_f32 v143, v20, v20, s41
    v_fmac_f32 v143, v21, v21
    v_mfma_f32_16x16x32_bf16 v[56:59], a[140:143], v[212:215], v[56:59]
    s_add_u32 s67, s46, s54
    v_fmac_f32 v143, v22, v22
    v_fmac_f32 v143, v23, v23
    v_mfma_f32_16x16x32_bf16 v[12:15], v[72:75], a[144:147], 0
    s_waitcnt lgkmcnt(0)
    s_add_u32 m0, s67, 0
    v_fmac_f32 v143, v36, v36
    v_fmac_f32 v143, v37, v37
    v_mfma_f32_16x16x32_bf16 v[12:15], v[88:91], a[148:151], v[12:15]
    s_barrier
    v_fmac_f32 v143, v38, v38
    v_fmac_f32 v143, v39, v39
    v_mfma_f32_16x16x32_bf16 v[12:15], v[32:35], a[152:155], v[12:15]
    s_cmp_ge_u32 s61, s13
    v_fmac_f32 v143, v56, v56
    v_fmac_f32 v143, v57, v57
    v_mfma_f32_16x16x32_bf16 v[12:15], v[84:87], a[156:159], v[12:15]
    s_cbranch_scc1 L_atomS0
L_atomrS0:
    v_mfma_f32_16x16x32_bf16 v[12:15], v[116:119], a[160:163], v[12:15]
    v_fmac_f32 v143, v58, v58
    v_fmac_f32 v143, v59, v59
    v_mfma_f32_16x16x32_bf16 v[12:15], v[212:215], a[164:167], v[12:15]
    v_cvt_pk_bf16_f32 v170, v142, v143
    v_add_u32 v139, s50, v139
    v_mfma_f32_16x16x32_bf16 v[40:43], v[72:75], a[168:171], 0
    ds_read_b128 v[76:79], v139 offset:0
    v_add_u32 v138, s50, v138
    v_mfma_f32_16x16x32_bf16 v[40:43], v[88:91], a[172:175], v[40:43]
    s_nop 0
    ds_read_b128 v[80:83], v138 offset:0
    v_cvt_pk_bf16_f32 v164, v12, v13
    v_mfma_f32_16x16x32_bf16 v[40:43], v[32:35], a[176:179], v[40:43]
    ds_read_b128 v[68:71], v139 offset:128
    v_cvt_pk_bf16_f32 v165, v14, v15
    v_mfma_f32_16x16x32_bf16 v[40:43], v[84:87], a[180:183], v[40:43]
    ds_read_b128 v[100:103], v138 offset:128
    v_add_u32 v137, s48, v137
    v_mfma_f32_16x16x32_bf16 v[40:43], v[116:119], a[184:187], v[40:43]
    ds_read_b128 v[112:115], v139 offset:256
    v_add_u32 v136, s48, v136
    v_mfma_f32_16x16x32_bf16 v[40:43], v[212:215], a[188:191], v[40:43]
    s_nop 0
    ds_read_b128 v[96:99], v138 offset:256
    v_add_u32 v135, s51, v135
    v_mfma_f32_16x16x16_bf16 v[92:95], v[216:217], v[170:171], 0
    s_nop 0
    v_add_u32 v134, s14, v134
    v_add_u32 v133, s14, v133
    v_add_u32 v125, s14, v125
    v_cvt_pk_bf16_f32 v160, v40, v41
    v_mfma_f32_16x16x32_bf16 v[60:63], v[72:75], a[192:195], 0
    v_cvt_pk_bf16_f32 v161, v42, v43
    v_mfma_f32_16x16x32_bf16 v[60:63], v[88:91], a[196:199], v[60:63]
    v_rsq_f32 v92, v92
    v_mfma_f32_16x16x32_bf16 v[60:63], v[32:35], a[200:203], v[60:63]
    v_rsq_f32 v93, v93
    v_mfma_f32_16x16x32_bf16 v[60:63], v[84:87], a[204:207], v[60:63]
    ds_read_b128 v[12:15], v134 offset:32
    v_mul_f32 v92, s55, v92
    v_mfma_f32_16x16x32_bf16 v[60:63], v[116:119], a[208:211], v[60:63]
    ds_read_b64 v[16:17], v134 offset:48
    v_mul_f32 v93, 0.5, v93
    v_mfma_f32_16x16x32_bf16 v[60:63], v[212:215], a[212:215], v[60:63]
    s_waitcnt lgkmcnt(3)
    ds_read_b128 v[72:75], v135 offset:0
    v_mul_f32 v20, v20, v93
    v_mfma_f32_16x16x32_bf16 v[40:43], a[216:219], v[76:79], 0
    v_mul_f32 v21, v21, v93
    v_cvt_pk_f16_f32 v18, v20, v21
    v_mfma_f32_16x16x32_bf16 v[40:43], a[220:223], v[80:83], v[40:43]
    v_mul_f32 v22, v22, v93
    v_mul_f32 v23, v23, v93
    v_mfma_f32_16x16x32_bf16 v[40:43], a[224:227], v[68:71], v[40:43]
    v_cvt_pk_f16_f32 v19, v22, v23
    v_mul_f32 v36, v36, v93
    v_mfma_f32_16x16x32_bf16 v[40:43], a[228:231], v[100:103], v[40:43]
    v_mul_f32 v37, v37, v93
    v_cvt_pk_f16_f32 v20, v36, v37
    v_mfma_f32_16x16x32_bf16 v[40:43], a[232:235], v[112:115], v[40:43]
    s_waitcnt lgkmcnt(3)
    v_mul_f32 v38, v38, v93
    v_mul_f32 v39, v39, v93
    v_mfma_f32_16x16x32_bf16 v[40:43], a[236:239], v[96:99], v[40:43]
    v_cvt_pk_f16_f32 v21, v38, v39
    v_mul_f32 v56, v56, v93
    v_mfma_f32_16x16x32_bf16 v[36:39], a[240:243], v[76:79], 0
    v_mul_f32 v57, v57, v93
    v_cvt_pk_f16_f32 v22, v56, v57
    v_mfma_f32_16x16x32_bf16 v[36:39], a[244:247], v[80:83], v[36:39]
    v_mul_f32 v58, v58, v93
    v_mul_f32 v59, v59, v93
    v_mfma_f32_16x16x32_bf16 v[36:39], a[248:251], v[68:71], v[36:39]
    s_waitcnt lgkmcnt(0)
    buffer_load_dwordx4 v130, s[24:27], s56 offen nt lds
    v_cvt_pk_f16_f32 v23, v58, v59
    v_mfma_f32_16x16x32_bf16 v[36:39], a[252:255], v[100:103], v[36:39]
    v_mul_f32 v48, v48, v92
    v_mul_f32 v49, v49, v92
    v_mfma_f32_16x16x32_bf16 v[36:39], v[224:227], v[112:115], v[36:39]
    v_cvt_pk_f16_f32 v56, v48, v49
    v_mul_f32 v50, v50, v92
    v_mfma_f32_16x16x32_bf16 v[36:39], v[228:231], v[96:99], v[36:39]
    ds_read_u16 v166, v133 offset:56
    v_mul_f32 v51, v51, v92
    v_mfma_f32_16x16x32_bf16 v[32:35], v[232:235], v[76:79], 0
    ds_read_u16 v162, v133 offset:64
    v_cvt_pk_f16_f32 v57, v50, v51
    v_mfma_f32_16x16x32_bf16 v[32:35], v[236:239], v[80:83], v[32:35]
    ds_read_u16 v158, v133 offset:72
    v_mul_f32 v106, v106, v92
    v_mfma_f32_16x16x32_bf16 v[32:35], v[240:243], v[68:71], v[32:35]
    ds_read_b128 v[48:51], v134 offset:0
    v_mul_f32 v107, v107, v92
    v_mfma_f32_16x16x32_bf16 v[32:35], v[244:247], v[100:103], v[32:35]
    buffer_store_dwordx4 v[72:75], v130, s[28:31], s60 offen sc1
    ds_read_b64 v[142:143], v134 offset:16
    v_cvt_pk_f16_f32 v58, v106, v107
    v_mul_f32 v108, v108, v92
    v_mul_f32 v109, v109, v92
    v_mfma_f32_16x16x32_bf16 v[32:35], v[248:251], v[112:115], v[32:35]
    s_add_u32 m0, s67, 1024
    v_cvt_pk_f16_f32 v59, v108, v109
    v_mul_f32 v120, v120, v92
    v_mfma_f32_16x16x32_bf16 v[32:35], v[252:255], v[96:99], v[32:35]
    v_mul_f32 v121, v121, v92
    v_cvt_pk_f16_f32 v146, v120, v121
    v_mfma_f32_16x16x32_f16 v[100:103], v[0:3], v[64:67], v[204:207]
    v_mul_f32 v122, v122, v92
    v_mul_f32 v123, v123, v92
    v_mfma_f32_16x16x32_f16 v[100:103], v[2:5], v[152:155], v[100:103]
    ds_read_b128 v[112:115], v135 offset:1024
    v_cvt_pk_f16_f32 v147, v122, v123
    v_mfma_f32_16x16x32_f16 v[120:123], v[6:9], v[64:67], v[200:203]
    ds_read_b128 v[76:79], v139 offset:1536
    v_cvt_pk_bf16_f32 v156, v60, v61
    v_mfma_f32_16x16x32_f16 v[120:123], v[8:11], v[152:155], v[120:123]
    ds_read_b128 v[80:83], v138 offset:1536
    v_cvt_pk_bf16_f32 v157, v62, v63
    v_mfma_f32_16x16x32_f16 v[96:99], v[18:21], v[64:67], v[196:199]
    ds_read_b128 v[60:63], v139 offset:1664
    v_max3_f32 v104, v100, v101, v102
    v_mfma_f32_16x16x32_f16 v[96:99], v[20:23], v[152:155], v[96:99]
    s_nop 0
    ds_read_b128 v[72:75], v138 offset:1664
    v_max3_f32 v104, v104, v103, v120
    v_mfma_f32_16x16x32_f16 v[88:91], v[12:15], v[64:67], v[208:211]
    ds_read_b128 v[64:67], v139 offset:1792
    v_max3_f32 v104, v104, v121, v122
    v_mfma_f32_16x16x32_f16 v[88:91], v[14:17], v[152:155], v[88:91]
    s_waitcnt lgkmcnt(6)
    ds_read_b128 v[68:71], v138 offset:1792
    v_max3_f32 v104, v104, v123, v96
    v_mfma_f32_16x16x32_f16 v[106:109], v[48:51], v[0:3], v[208:211]
    v_max3_f32 v104, v104, v97, v98
    s_nop 0
    v_mfma_f32_16x16x32_f16 v[106:109], v[140:143], v[2:5], v[106:109]
    s_nop 0
    v_max3_f32 v104, v104, v99, v88
    v_mov_b32 v105, v104
    v_mfma_f32_16x16x32_f16 v[92:95], v[48:51], v[6:9], v[208:211]
    s_waitcnt lgkmcnt(6)
    buffer_load_dwordx4 v129, s[24:27], s56 offen nt lds
    v_mfma_f32_16x16x32_f16 v[92:95], v[140:143], v[8:11], v[92:95]
    v_permlane32_swap_b32 v105, v104
    v_mfma_f32_16x16x32_f16 v[84:87], v[48:51], v[18:21], v[208:211]
    v_max_f32 v104, v105, v104
    v_mov_b32 v105, v104
    v_mfma_f32_16x16x32_f16 v[84:87], v[140:143], v[20:23], v[84:87]
    s_nop 0
    v_permlane16_swap_b32 v105, v104
    v_mfma_f32_16x16x32_f16 v[90:93], v[48:51], v[12:15], v[208:211]
    v_max_f32 v104, v105, v104
    v_sub_f32 v100, v100, v104
    v_mfma_f32_16x16x32_f16 v[90:93], v[140:143], v[14:17], v[90:93]
    s_waitcnt lgkmcnt(1)
    v_sub_f32 v101, v101, v104
    v_sub_f32 v102, v102, v104
    v_mfma_f32_16x16x32_bf16 v[48:51], a[216:219], v[76:79], 0
    v_sub_f32 v103, v103, v104
    v_sub_f32 v120, v120, v104
    v_mfma_f32_16x16x32_bf16 v[48:51], a[220:223], v[80:83], v[48:51]
    buffer_store_dwordx4 v[112:115], v129, s[28:31], s60 offen sc1
    v_sub_f32 v121, v121, v104
    v_sub_f32 v122, v122, v104
    v_sub_f32 v123, v123, v104
    v_sub_f32 v96, v96, v104
    v_mfma_f32_16x16x32_bf16 v[48:51], a[224:227], v[60:63], v[48:51]
    s_add_u32 m0, s67, 2048
    v_sub_f32 v97, v97, v104
    v_sub_f32 v98, v98, v104
    v_mfma_f32_16x16x32_bf16 v[48:51], a[228:231], v[72:75], v[48:51]
    v_sub_f32 v99, v99, v104
    v_sub_f32 v88, v88, v104
    v_mfma_f32_16x16x32_bf16 v[48:51], a[232:235], v[64:67], v[48:51]
    s_waitcnt lgkmcnt(0)
    v_exp_f32 v100, v100
    v_mfma_f32_16x16x32_bf16 v[48:51], a[236:239], v[68:71], v[48:51]
    v_exp_f32 v101, v101
    v_exp_f32 v102, v102
    v_exp_f32 v103, v103
    v_cvt_pk_bf16_f32 v116, v100, v101
    v_cvt_pk_bf16_f32 v117, v102, v103
    v_exp_f32 v120, v120
    v_exp_f32 v121, v121
    v_exp_f32 v122, v122
    v_exp_f32 v123, v123
    v_cvt_pk_bf16_f32 v118, v120, v121
    v_cvt_pk_bf16_f32 v119, v122, v123
    v_exp_f32 v96, v96
    v_exp_f32 v97, v97
    v_exp_f32 v98, v98
    v_exp_f32 v99, v99
    v_cvt_pk_bf16_f32 v168, v96, v97
    v_cvt_pk_bf16_f32 v169, v98, v99
    v_exp_f32 v88, v88
    v_mov_b32_dpp v109, v95 quad_perm:[0,1,2,3] row_mask:0x2 bank_mask:0xf
    v_cvt_pk_bf16_f32 v170, v88, 0
    v_mfma_f32_16x16x32_bf16 v[120:123], v[220:223], v[116:119], 0
    v_mov_b32_dpp v109, v87 quad_perm:[0,1,2,3] row_mask:0x4 bank_mask:0xf
    v_mfma_f32_16x16x32_bf16 v[120:123], v[220:223], v[168:171], v[120:123]
    ds_read_b128 v[100:103], v135 offset:2048
    v_mov_b32_dpp v109, v93 quad_perm:[0,1,2,3] row_mask:0x8 bank_mask:0xf
    v_mfma_f32_16x16x32_bf16 v[112:115], v[24:27], v[116:119], 0
    s_nop 0
    v_mov_b32 v142, v109
    s_nop 0
    v_mfma_f32_16x16x32_bf16 v[112:115], v[164:167], v[168:171], v[112:115]
    s_nop 0
    v_rcp_f32 v120, v120
    v_mfma_f32_16x16x32_bf16 v[104:107], v[28:31], v[116:119], 0
    v_max_f32_dpp v142, v142, v142 row_ror:8 row_mask:0xf bank_mask:0xf
    s_nop 0
    v_mfma_f32_16x16x32_bf16 v[104:107], v[160:163], v[168:171], v[104:107]
    s_nop 0
    v_max_f32_dpp v142, v142, v142 row_ror:4 row_mask:0xf bank_mask:0xf
    v_mul_f32 v112, v112, v120
    v_mfma_f32_16x16x32_bf16 v[96:99], v[44:47], v[116:119], 0
    v_max_f32_dpp v142, v142, v142 row_ror:2 row_mask:0xf bank_mask:0xf
    v_mul_f32 v113, v113, v120
    v_mfma_f32_16x16x32_bf16 v[96:99], v[156:159], v[168:171], v[96:99]
    v_max_f32_dpp v142, v142, v142 row_ror:1 row_mask:0xf bank_mask:0xf
    v_mov_b32 v143, v142
    v_mfma_f32_16x16x32_f16 v[88:91], v[0:3], v[52:55], v[192:195]
    s_nop 0
    v_permlane32_swap_b32 v143, v142
    v_mfma_f32_16x16x32_f16 v[88:91], v[2:5], v[148:151], v[88:91]
    v_max_f32 v142, v143, v142
    v_mov_b32 v143, v142
    v_mfma_f32_16x16x32_f16 v[92:95], v[6:9], v[52:55], v[188:191]
    s_waitcnt lgkmcnt(0)
    buffer_load_dwordx4 v128, s[24:27], s56 offen nt lds
    v_cvt_pk_bf16_f32 v112, v112, v113
    v_mfma_f32_16x16x32_f16 v[92:95], v[8:11], v[148:151], v[92:95]
    v_permlane16_swap_b32 v143, v142
    v_mfma_f32_16x16x32_f16 v[84:87], v[18:21], v[52:55], v[184:187]
    v_max_f32 v142, v143, v142
    v_sub_f32 v109, v109, v142
    v_mfma_f32_16x16x32_f16 v[84:87], v[20:23], v[148:151], v[84:87]
    v_exp_f32 v109, v109
    v_mfma_f32_16x16x32_f16 v[116:119], v[12:15], v[52:55], v[208:211]
    v_cvt_pk_bf16_f32 v109, v109, v109
    v_mul_f32 v114, v114, v120
    v_mfma_f32_16x16x32_f16 v[116:119], v[14:17], v[148:151], v[116:119]
    s_mov_b32 s53, s47
    ds_write_b16 v125, v109
    v_mul_f32 v115, v115, v120
    v_cvt_pk_bf16_f32 v113, v114, v115
    s_mov_b32 s47, s46
    s_mov_b32 s46, s45
    ds_read_b128 v[52:55], v134
    v_mul_f32 v104, v104, v120
    v_mul_f32 v105, v105, v120
    v_cvt_pk_bf16_f32 v114, v104, v105
    s_add_u32 m0, s67, 3072
    s_mov_b32 s45, s44
    ds_read_b128 v[212:215], v134 offset:16
    v_mfma_f32_16x16x32_bf16 v[108:111], a[240:243], v[76:79], 0
    s_mov_b32 s44, s53
    buffer_store_dwordx4 v[100:103], v128, s[28:31], s60 offen sc1
    ds_write_b64 v137, v[112:113] offset:0
    v_mul_f32 v106, v106, v120
    v_mfma_f32_16x16x32_bf16 v[108:111], a[244:247], v[80:83], v[108:111]
    s_sub_u32 s48, s44, s46
    v_mul_f32 v107, v107, v120
    v_cvt_pk_bf16_f32 v115, v106, v107
    v_mfma_f32_16x16x32_bf16 v[108:111], a[248:251], v[60:63], v[108:111]
    ds_write_b64 v137, v[114:115] offset:8
    v_mfma_f32_16x16x32_bf16 v[108:111], a[252:255], v[72:75], v[108:111]
    v_mul_f32 v96, v96, v120
    v_mul_f32 v97, v97, v120
    v_mfma_f32_16x16x32_bf16 v[108:111], v[224:227], v[64:67], v[108:111]
    v_cvt_pk_bf16_f32 v168, v96, v97
    v_mul_f32 v98, v98, v120
    v_mfma_f32_16x16x32_bf16 v[108:111], v[228:231], v[68:71], v[108:111]
    s_waitcnt lgkmcnt(3)
    s_sub_u32 s49, s46, s45
    v_mul_f32 v99, v99, v120
    v_cvt_pk_bf16_f32 v169, v98, v99
    v_mfma_f32_16x16x32_bf16 v[104:107], v[52:55], v[24:27], 0
    s_waitcnt lgkmcnt(2)
    ds_write_b64 v136, v[168:169] offset:0
    v_max3_f32 v168, v88, v89, v90
    v_mfma_f32_16x16x32_bf16 v[104:107], v[212:215], v[164:167], v[104:107]
    v_max3_f32 v168, v168, v91, v92
    v_max3_f32 v168, v168, v93, v94
    v_mfma_f32_16x16x32_bf16 v[120:123], v[52:55], v[28:31], 0
    v_max3_f32 v168, v168, v95, v84
    v_max3_f32 v168, v168, v85, v86
    v_mfma_f32_16x16x32_bf16 v[120:123], v[212:215], v[160:163], v[120:123]
    v_max3_f32 v168, v168, v87, v117
    v_mov_b32 v169, v168
    v_mfma_f32_16x16x32_bf16 v[100:103], v[52:55], v[44:47], 0
    s_nop 0
    v_permlane32_swap_b32 v169, v168
    v_mfma_f32_16x16x32_bf16 v[100:103], v[212:215], v[156:159], v[100:103]
    v_max_f32 v168, v169, v168
    v_mov_b32 v169, v168
    v_mfma_f32_16x16x32_bf16 v[52:55], v[232:235], v[76:79], 0
    s_nop 0
    v_permlane16_swap_b32 v169, v168
    v_mfma_f32_16x16x32_bf16 v[52:55], v[236:239], v[80:83], v[52:55]
    v_max_f32 v168, v169, v168
    v_sub_f32 v88, v88, v168
    v_mfma_f32_16x16x32_bf16 v[52:55], v[240:243], v[60:63], v[52:55]
    v_sub_f32 v89, v89, v168
    v_sub_f32 v90, v90, v168
    v_mfma_f32_16x16x32_bf16 v[52:55], v[244:247], v[72:75], v[52:55]
    v_sub_f32 v91, v91, v168
    v_sub_f32 v92, v92, v168
    v_mfma_f32_16x16x32_bf16 v[52:55], v[248:251], v[64:67], v[52:55]
    v_sub_f32 v93, v93, v168
    v_sub_f32 v94, v94, v168
    v_mfma_f32_16x16x32_bf16 v[52:55], v[252:255], v[68:71], v[52:55]
    v_sub_f32 v95, v95, v168
    v_sub_f32 v84, v84, v168
    v_sub_f32 v85, v85, v168
    v_sub_f32 v86, v86, v168
    v_sub_f32 v87, v87, v168
    v_sub_f32 v117, v117, v168
    v_exp_f32 v88, v88
    v_exp_f32 v89, v89
    v_exp_f32 v90, v90
    v_exp_f32 v91, v91
    v_cvt_pk_bf16_f32 v76, v88, v89
    v_cvt_pk_bf16_f32 v77, v90, v91
    v_exp_f32 v92, v92
    v_exp_f32 v93, v93
    v_exp_f32 v94, v94
    v_exp_f32 v95, v95
    v_cvt_pk_bf16_f32 v78, v92, v93
    v_cvt_pk_bf16_f32 v79, v94, v95
    v_exp_f32 v84, v84
    v_exp_f32 v85, v85
    v_exp_f32 v86, v86
    v_exp_f32 v87, v87
    v_cvt_pk_bf16_f32 v168, v84, v85
    v_cvt_pk_bf16_f32 v169, v86, v87
    v_exp_f32 v117, v117
    v_mov_b32_dpp v107, v123 quad_perm:[0,1,2,3] row_mask:0x2 bank_mask:0xf
    v_cvt_pk_bf16_f32 v170, v117, 0
    v_mfma_f32_16x16x32_bf16 v[80:83], v[220:223], v[76:79], 0
    v_mov_b32_dpp v107, v103 quad_perm:[0,1,2,3] row_mask:0x4 bank_mask:0xf
    v_cvt_pk_bf16_f32 v107, v107, v107
    v_mfma_f32_16x16x32_bf16 v[80:83], v[220:223], v[168:171], v[80:83]
    ds_write_b16 v133, v107 offset:56
    v_mfma_f32_16x16x32_bf16 v[60:63], v[24:27], v[76:79], 0
    ds_read_b128 v[72:75], v135 offset:3072
    v_fma_f32 v154, v40, v40, s42
    v_mfma_f32_16x16x32_bf16 v[60:63], v[164:167], v[168:171], v[60:63]
    ds_read_b128 v[68:71], v139 offset:3072
    v_fmac_f32 v154, v41, v41
    v_mfma_f32_16x16x32_bf16 v[64:67], v[28:31], v[76:79], 0
    ds_read_b128 v[104:107], v138 offset:3072
    v_fmac_f32 v154, v42, v42
    v_mfma_f32_16x16x32_bf16 v[64:67], v[160:163], v[168:171], v[64:67]
    ds_read_b128 v[120:123], v139 offset:3200
    v_fmac_f32 v154, v43, v43
    v_mfma_f32_16x16x32_bf16 v[100:103], v[44:47], v[76:79], 0
    ds_read_b128 v[76:79], v138 offset:3200
    v_fmac_f32 v154, v36, v36
    v_mfma_f32_16x16x32_bf16 v[100:103], v[156:159], v[168:171], v[100:103]
    ds_read_b128 v[112:115], v139 offset:3328
    v_add_u32 v139, s48, v139
    v_mfma_f32_16x16x32_f16 v[96:99], v[0:3], v[56:59], v[180:183]
    ds_read_b128 v[82:85], v138 offset:3328
    v_add_u32 v138, s48, v138
    v_mfma_f32_16x16x32_f16 v[96:99], v[2:5], v[144:147], v[96:99]
    ds_read_b128 v[0:3], v135 offset:4096
    v_fmac_f32 v154, v37, v37
    v_mfma_f32_16x16x32_f16 v[88:91], v[6:9], v[56:59], v[176:179]
    v_rcp_f32 v80, v80
    v_mfma_f32_16x16x32_f16 v[88:91], v[8:11], v[144:147], v[88:91]
    s_waitcnt lgkmcnt(7)
    buffer_load_dwordx4 v127, s[24:27], s56 offen nt lds
    v_mul_f32 v60, v60, v80
    v_mfma_f32_16x16x32_f16 v[4:7], v[18:21], v[56:59], v[172:175]
    v_mul_f32 v61, v61, v80
    v_cvt_pk_bf16_f32 v8, v60, v61
    v_mfma_f32_16x16x32_f16 v[4:7], v[20:23], v[144:147], v[4:7]
    v_mul_f32 v62, v62, v80
    v_mul_f32 v63, v63, v80
    v_mfma_f32_16x16x32_f16 v[20:23], v[12:15], v[56:59], v[208:211]
    v_cvt_pk_bf16_f32 v9, v62, v63
    v_mul_f32 v64, v64, v80
    v_mfma_f32_16x16x32_f16 v[20:23], v[14:17], v[144:147], v[20:23]
    s_waitcnt lgkmcnt(3)
    ds_write_b64 v137, v[8:9] offset:1536
    v_mfma_f32_16x16x32_bf16 v[12:15], a[216:219], v[68:71], 0
    v_mul_f32 v65, v65, v80
    v_cvt_pk_bf16_f32 v10, v64, v65
    v_mfma_f32_16x16x32_bf16 v[12:15], a[220:223], v[104:107], v[12:15]
    v_mul_f32 v66, v66, v80
    v_mul_f32 v67, v67, v80
    v_mfma_f32_16x16x32_bf16 v[12:15], a[224:227], v[120:123], v[12:15]
    s_add_u32 m0, s67, 4096
    buffer_store_dwordx4 v[72:75], v127, s[28:31], s60 offen sc1
    v_cvt_pk_bf16_f32 v11, v66, v67
    v_mul_f32 v100, v100, v80
    v_mul_f32 v101, v101, v80
    v_cvt_pk_bf16_f32 v168, v100, v101
    v_mfma_f32_16x16x32_bf16 v[12:15], a[228:231], v[76:79], v[12:15]
    s_waitcnt lgkmcnt(1)
    s_cmp_lg_u32 s5, -1
    ds_write_b64 v137, v[10:11] offset:1544
    v_mfma_f32_16x16x32_bf16 v[12:15], a[232:235], v[112:115], v[12:15]
    v_mul_f32 v102, v102, v80
    v_mul_f32 v103, v103, v80
    v_mfma_f32_16x16x32_bf16 v[12:15], a[236:239], v[82:85], v[12:15]
    buffer_load_dwordx4 v126, s[24:27], s56 offen nt lds
    v_cvt_pk_bf16_f32 v169, v102, v103
    v_mfma_f32_16x16x32_bf16 v[16:19], a[240:243], v[68:71], 0
    ds_write_b64 v136, v[168:169] offset:1536
    v_mfma_f32_16x16x32_bf16 v[16:19], a[244:247], v[104:107], v[16:19]
    v_max3_f32 v155, v96, v97, v98
    v_max3_f32 v155, v155, v99, v88
    v_mfma_f32_16x16x32_bf16 v[16:19], a[248:251], v[120:123], v[16:19]
    v_max3_f32 v155, v155, v89, v90
    v_max3_f32 v155, v155, v91, v4
    v_mfma_f32_16x16x32_bf16 v[16:19], a[252:255], v[76:79], v[16:19]
    v_max3_f32 v155, v155, v5, v6
    v_max3_f32 v155, v155, v7, v22
    v_mfma_f32_16x16x32_bf16 v[16:19], v[224:227], v[112:115], v[16:19]
    v_mov_b32 v168, v155
    v_fmac_f32 v154, v38, v38
    v_mfma_f32_16x16x32_bf16 v[16:19], v[228:231], v[82:85], v[16:19]
    ds_read_b128 v[8:11], v139 offset:0
    v_fmac_f32 v154, v39, v39
    v_mfma_f32_16x16x32_bf16 v[56:59], v[232:235], v[68:71], 0
    buffer_store_dwordx4 v[0:3], v126, s[28:31], s60 offen sc1
    ds_read_b128 v[60:63], v138 offset:0
    v_permlane32_swap_b32 v168, v155
    v_max_f32 v155, v168, v155
    v_mfma_f32_16x16x32_bf16 v[56:59], v[236:239], v[104:107], v[56:59]
    ds_read_b128 v[0:3], v139 offset:128
    v_mov_b32 v168, v155
    v_mfma_f32_16x16x32_bf16 v[56:59], v[240:243], v[120:123], v[56:59]
    ds_read_b128 v[72:75], v138 offset:128
    v_fmac_f32 v154, v32, v32
    v_mfma_f32_16x16x32_bf16 v[56:59], v[244:247], v[76:79], v[56:59]
    ds_read_b128 v[76:79], v139 offset:256
    v_fmac_f32 v154, v33, v33
    v_mfma_f32_16x16x32_bf16 v[56:59], v[248:251], v[112:115], v[56:59]
    ds_read_b128 v[64:67], v138 offset:256
    v_fmac_f32 v154, v34, v34
    v_mfma_f32_16x16x32_bf16 v[56:59], v[252:255], v[82:85], v[56:59]
    v_permlane16_swap_b32 v168, v155
    v_max_f32 v155, v168, v155
    v_sub_f32 v96, v96, v155
    v_sub_f32 v97, v97, v155
    v_sub_f32 v98, v98, v155
    v_sub_f32 v99, v99, v155
    v_sub_f32 v88, v88, v155
    v_sub_f32 v89, v89, v155
    v_sub_f32 v90, v90, v155
    v_sub_f32 v91, v91, v155
    v_sub_f32 v4, v4, v155
    v_sub_f32 v5, v5, v155
    v_sub_f32 v6, v6, v155
    v_sub_f32 v7, v7, v155
    v_sub_f32 v22, v22, v155
    v_exp_f32 v96, v96
    v_exp_f32 v97, v97
    v_exp_f32 v98, v98
    v_exp_f32 v99, v99
    v_cvt_pk_bf16_f32 v80, v96, v97
    v_cvt_pk_bf16_f32 v81, v98, v99
    v_exp_f32 v88, v88
    v_exp_f32 v89, v89
    v_exp_f32 v90, v90
    v_exp_f32 v91, v91
    v_cvt_pk_bf16_f32 v82, v88, v89
    v_cvt_pk_bf16_f32 v83, v90, v91
    v_exp_f32 v4, v4
    v_exp_f32 v5, v5
    v_exp_f32 v6, v6
    v_exp_f32 v7, v7
    v_cvt_pk_bf16_f32 v168, v4, v5
    v_cvt_pk_bf16_f32 v169, v6, v7
    v_exp_f32 v22, v22
    v_fmac_f32 v154, v35, v35
    v_cvt_pk_bf16_f32 v170, v22, 0
    v_mfma_f32_16x16x32_bf16 v[4:7], v[220:223], v[80:83], 0
    v_fma_f32 v155, v48, v48, s42
    v_fmac_f32 v155, v49, v49
    v_mfma_f32_16x16x32_bf16 v[4:7], v[220:223], v[168:171], v[4:7]
    v_fmac_f32 v155, v50, v50
    v_fmac_f32 v155, v51, v51
    v_mfma_f32_16x16x32_bf16 v[20:23], v[24:27], v[80:83], 0
    s_nop 0
    v_fmac_f32 v155, v108, v108
    v_fmac_f32 v155, v109, v109
    v_mfma_f32_16x16x32_bf16 v[20:23], v[164:167], v[168:171], v[20:23]
    s_nop 0
    v_rcp_f32 v4, v4
    v_mfma_f32_16x16x32_bf16 v[24:27], v[28:31], v[80:83], 0
    s_nop 0
    v_fmac_f32 v155, v110, v110
    v_fmac_f32 v155, v111, v111
    v_mfma_f32_16x16x32_bf16 v[24:27], v[160:163], v[168:171], v[24:27]
    s_nop 0
    v_mul_f32 v20, v20, v4
    v_mul_f32 v21, v21, v4
    v_mfma_f32_16x16x32_bf16 v[28:31], v[44:47], v[80:83], 0
    v_cvt_pk_bf16_f32 v44, v20, v21
    v_mul_f32 v22, v22, v4
    v_mfma_f32_16x16x32_bf16 v[28:31], v[156:159], v[168:171], v[28:31]
    s_waitcnt lgkmcnt(0)
    v_mul_f32 v23, v23, v4
    v_cvt_pk_bf16_f32 v45, v22, v23
    v_mfma_f32_16x16x32_bf16 v[20:23], a[0:3], v[8:11], 0
    s_cbranch_scc1 L_loopS0
    ds_write_b64 v137, v[44:45] offset:3072
    v_mul_f32 v24, v24, v4
    v_mul_f32 v25, v25, v4
    v_cvt_pk_bf16_f32 v46, v24, v25
    v_mul_f32 v26, v26, v4
    v_mul_f32 v27, v27, v4
    v_cvt_pk_bf16_f32 v47, v26, v27
    v_mul_f32 v28, v28, v4
    v_mul_f32 v29, v29, v4
    v_cvt_pk_bf16_f32 v28, v28, v29
    v_mul_f32 v30, v30, v4
    v_mul_f32 v31, v31, v4
    v_cvt_pk_bf16_f32 v29, v30, v31
    s_mov_b32 s30, 100270464
    s_mul_i32 s89, s68, 5376
    ds_write_b64 v137, v[46:47] offset:3080
    v_fmac_f32 v155, v52, v52
    s_add_u32 s89, s89, 142336
    s_movk_i32 s90, 336
    ds_write_b64 v136, v[28:29] offset:3072
    v_fmac_f32 v155, v53, v53
    v_fmac_f32 v155, v54, v54
    v_fmac_f32 v155, v55, v55
    v_fma_f32 v125, v12, v12, s42
    v_fmac_f32 v125, v13, v13
    v_fmac_f32 v125, v14, v14
    v_fmac_f32 v125, v15, v15
    v_fmac_f32 v125, v16, v16
    v_fmac_f32 v125, v17, v17
    v_fmac_f32 v125, v18, v18
    v_fmac_f32 v125, v19, v19
    v_fmac_f32 v125, v56, v56
    v_fmac_f32 v125, v57, v57
    v_fmac_f32 v125, v58, v58
    v_fmac_f32 v125, v59, v59
    v_cvt_pk_bf16_f32 v0, v154, v155
    v_cvt_pk_bf16_f32 v1, v125, v124
    s_lshr_b32 s91, s64, 16
    s_sub_u32 s84, s45, s44
    ds_write_b64 v132, v[0:1]
    v_mbcnt_lo_u32_b32 v124, -1, 0
    v_mbcnt_hi_u32_b32 v124, -1, v124
    v_and_b32 v125, 15, v124
    v_lshrrev_b32 v124, 4, v124
    v_mul_u32_u24 v0, 80, v124
    v_add_u32 v0, s89, v0
    v_mad_u32_u24 v69, v125, s90, v0
    v_lshrrev_b32 v124, v125, s64
    v_and_b32 v124, 1, v124
    v_cmp_eq_u32 vcc, 1, v124
    v_mad_u32_u24 v23, v125, s90, v0
    v_lshrrev_b32 v68, v125, s91
    v_cndmask_b32 v69, v0, v69, vcc
    s_sub_u32 s85, s46, s45
    s_sub_u32 s86, s44, s45
    ds_read_b128 v[8:11], v69
    ds_read_b128 v[60:63], v69 offset:16
    v_and_b32 v68, 1, v68
    v_subrev_u32 v23, 21504, v23
    s_sub_u32 s93, s44, s47
    s_sub_u32 s94, s45, s47
    ds_read_b64 v[70:71], v69 offset:56
    ds_read_b128 v[72:75], v69 offset:64
    v_cmp_eq_u32 vcc, 1, v68
    v_add_u32 v3, s84, v139
    v_add_u32 v2, s84, v138
    v_cndmask_b32 v23, v0, v23, vcc
    v_add_u32 v44, s85, v137
    v_add_u32 v22, s85, v136
    v_add_u32 v133, s86, v137
    v_add_u32 v125, s86, v136
    v_add_u32 v124, s93, v135
    s_waitcnt lgkmcnt(4)
    s_barrier
    ds_read_b128 v[24:27], v131 offset:0
    ds_read_b128 v[4:7], v131 offset:1024
    v_add_u32 v134, s94, v135
    s_sub_u32 s95, s46, s47
    ds_read_b128 v[76:79], v3 offset:1536
    v_add_u32 v20, s95, v135
    v_mov_b32 v21, 0
    s_waitcnt lgkmcnt(6)
    v_mfma_f32_16x16x32_bf16 v[80:83], v[220:223], v[8:11], 0
    s_waitcnt lgkmcnt(5)
    s_lshl_b32 s92, s68, 10
    ds_read_b128 v[8:11], v3 offset:1664
    ds_read_b128 v[28:31], v3 offset:1792
    v_mfma_f32_16x16x32_bf16 v[80:83], v[220:223], v[60:63], v[80:83]
    s_waitcnt lgkmcnt(5)
    v_lshlrev_b32 v60, 16, v70
    v_and_b32 v70, 0xffff0000, v70
    v_lshlrev_b32 v61, 16, v71
    v_and_b32 v71, 0xffff0000, v71
    v_lshlrev_b32 v62, 16, v72
    v_and_b32 v72, 0xffff0000, v72
    v_lshlrev_b32 v63, 16, v73
    v_rcp_f32 v80, v80
    v_and_b32 v73, 0xffff0000, v73
    v_mul_f32 v60, v60, v80
    v_mul_f32 v70, v70, v80
    v_cvt_pk_bf16_f32 v60, v60, v70
    v_mul_f32 v61, v61, v80
    v_mul_f32 v71, v71, v80
    v_cvt_pk_bf16_f32 v61, v61, v71
    v_mul_f32 v62, v62, v80
    v_mul_f32 v72, v72, v80
    v_cvt_pk_bf16_f32 v62, v62, v72
    v_mul_f32 v63, v63, v80
    s_waitcnt lgkmcnt(3)
    v_mfma_f32_16x16x32_bf16 v[84:87], v[216:219], v[24:27], 0
    ds_read_b128 v[68:71], v2 offset:1536
    ds_read_b128 v[64:67], v2 offset:1664
    v_mfma_f32_16x16x32_bf16 v[84:87], v[216:219], v[4:7], v[84:87]
    s_waitcnt lgkmcnt(4)
    ds_read_b128 v[24:27], v2 offset:1792
    v_mul_f32 v73, v73, v80
    v_mfma_f32_16x16x32_bf16 v[4:7], a[216:219], v[76:79], 0
    v_cvt_pk_bf16_f32 v63, v63, v73
    v_lshlrev_b32 v135, 16, v74
    v_and_b32 v74, 0xffff0000, v74
    v_mul_f32 v135, v135, v80
    v_mul_f32 v74, v74, v80
    v_cvt_pk_bf16_f32 v46, v135, v74
    v_lshlrev_b32 v87, 16, v75
    v_and_b32 v75, 0xffff0000, v75
    v_mul_f32 v87, v87, v80
    v_mul_f32 v75, v75, v80
    v_cvt_pk_bf16_f32 v47, v87, v75
    v_rsq_f32 v84, v84
    v_rsq_f32 v85, v85
    v_mul_f32 v84, s43, v84
    v_mul_f32 v40, v40, v84
    v_mul_f32 v41, v41, v84
    v_cvt_pk_bf16_f32 v40, v40, v41
    v_mul_f32 v42, v42, v84
    v_mul_f32 v43, v43, v84
    v_cvt_pk_bf16_f32 v41, v42, v43
    v_mul_f32 v36, v36, v84
    v_mul_f32 v37, v37, v84
    v_cvt_pk_bf16_f32 v42, v36, v37
    v_mul_f32 v38, v38, v84
    v_mul_f32 v39, v39, v84
    s_waitcnt lgkmcnt(1)
    v_mfma_f32_16x16x32_bf16 v[4:7], a[220:223], v[68:71], v[4:7]
    ds_write_b128 v133, v[60:63] offset:0
    v_mfma_f32_16x16x32_bf16 v[4:7], a[224:227], v[8:11], v[4:7]
    v_cvt_pk_bf16_f32 v43, v38, v39
    v_mul_f32 v32, v32, v84
    v_mfma_f32_16x16x32_bf16 v[4:7], a[228:231], v[64:67], v[4:7]
    ds_write_b128 v44, v[40:43] offset:0
    v_mfma_f32_16x16x32_bf16 v[4:7], a[232:235], v[28:31], v[4:7]
    s_waitcnt lgkmcnt(2)
    v_mul_f32 v33, v33, v84
    v_cvt_pk_bf16_f32 v0, v32, v33
    v_mfma_f32_16x16x32_bf16 v[4:7], a[236:239], v[24:27], v[4:7]
    ds_write_b64 v125, v[46:47] offset:0
    v_mfma_f32_16x16x32_bf16 v[92:95], a[240:243], v[76:79], 0
    v_mul_f32 v34, v34, v84
    v_mul_f32 v35, v35, v84
    v_mfma_f32_16x16x32_bf16 v[92:95], a[244:247], v[68:71], v[92:95]
    ds_read_b128 v[96:99], v3 offset:0
    v_cvt_pk_bf16_f32 v1, v34, v35
    v_mfma_f32_16x16x32_bf16 v[92:95], a[248:251], v[8:11], v[92:95]
    ds_write_b64 v22, v[0:1] offset:0
    v_mfma_f32_16x16x32_bf16 v[92:95], a[252:255], v[64:67], v[92:95]
    v_mul_f32 v85, s43, v85
    v_mul_f32 v48, v48, v85
    v_mfma_f32_16x16x32_bf16 v[92:95], v[224:227], v[28:31], v[92:95]
    ds_read_b128 v[88:91], v2 offset:0
    v_mul_f32 v49, v49, v85
    v_mfma_f32_16x16x32_bf16 v[92:95], v[228:231], v[24:27], v[92:95]
    ds_read_b128 v[60:63], v3 offset:128
    v_cvt_pk_bf16_f32 v0, v48, v49
    v_mfma_f32_16x16x32_bf16 v[72:75], v[232:235], v[76:79], 0
    ds_read_b128 v[40:43], v2 offset:128
    v_mul_f32 v50, v50, v85
    v_mfma_f32_16x16x32_bf16 v[72:75], v[236:239], v[68:71], v[72:75]
    ds_read_b128 v[32:35], v3 offset:256
    v_mul_f32 v51, v51, v85
    v_mfma_f32_16x16x32_bf16 v[72:75], v[240:243], v[8:11], v[72:75]
    ds_read_b128 v[8:11], v2 offset:256
    v_cvt_pk_bf16_f32 v1, v50, v51
    v_mfma_f32_16x16x32_bf16 v[72:75], v[244:247], v[64:67], v[72:75]
    v_rsq_f32 v86, v86
    v_mfma_f32_16x16x32_bf16 v[72:75], v[248:251], v[28:31], v[72:75]
    v_mul_f32 v86, s43, v86
    v_mul_f32 v12, v12, v86
    v_mfma_f32_16x16x32_bf16 v[72:75], v[252:255], v[24:27], v[72:75]
    s_waitcnt lgkmcnt(5)
    v_mul_f32 v13, v13, v86
    v_cvt_pk_bf16_f32 v12, v12, v13
    v_mfma_f32_16x16x32_bf16 v[24:27], a[216:219], v[96:99], 0
    s_waitcnt lgkmcnt(4)
    v_mul_f32 v14, v14, v86
    v_mul_f32 v15, v15, v86
    v_cvt_pk_bf16_f32 v13, v14, v15
    v_mfma_f32_16x16x32_bf16 v[24:27], a[220:223], v[88:91], v[24:27]
    s_waitcnt lgkmcnt(3)
    ds_read_b128 v[80:83], v3 offset:3072
    ds_read_b128 v[76:79], v2 offset:3072
    v_mfma_f32_16x16x32_bf16 v[24:27], a[224:227], v[60:63], v[24:27]
    s_waitcnt lgkmcnt(4)
    ds_read_b128 v[68:71], v3 offset:3200
    v_mul_f32 v16, v16, v86
    v_mfma_f32_16x16x32_bf16 v[24:27], a[228:231], v[40:43], v[24:27]
    s_waitcnt lgkmcnt(4)
    ds_read_b128 v[64:67], v2 offset:3200
    v_mul_f32 v17, v17, v86
    v_mfma_f32_16x16x32_bf16 v[24:27], a[232:235], v[32:35], v[24:27]
    s_waitcnt lgkmcnt(4)
    ds_read_b128 v[48:51], v3 offset:3328
    v_cvt_pk_bf16_f32 v14, v16, v17
    v_mfma_f32_16x16x32_bf16 v[24:27], a[236:239], v[8:11], v[24:27]
    ds_read_b128 v[28:31], v2 offset:3328
    v_mul_f32 v18, v18, v86
    v_mfma_f32_16x16x32_bf16 v[36:39], a[240:243], v[96:99], 0
    v_mul_f32 v19, v19, v86
    v_cvt_pk_bf16_f32 v15, v18, v19
    v_mfma_f32_16x16x32_bf16 v[36:39], a[244:247], v[88:91], v[36:39]
    ds_write_b128 v44, v[12:15] offset:3072
    v_mfma_f32_16x16x32_bf16 v[36:39], a[248:251], v[60:63], v[36:39]
    v_mul_f32 v56, v56, v86
    v_mul_f32 v57, v57, v86
    v_mfma_f32_16x16x32_bf16 v[36:39], a[252:255], v[40:43], v[36:39]
    v_cvt_pk_bf16_f32 v2, v56, v57
    v_mul_f32 v58, v58, v86
    v_mfma_f32_16x16x32_bf16 v[36:39], v[224:227], v[32:35], v[36:39]
    v_mul_f32 v59, v59, v86
    v_cvt_pk_bf16_f32 v3, v58, v59
    v_mfma_f32_16x16x32_bf16 v[36:39], v[228:231], v[8:11], v[36:39]
    ds_write_b64 v22, v[2:3] offset:3072
    v_mfma_f32_16x16x32_bf16 v[16:19], v[232:235], v[96:99], 0
    v_fma_f32 v135, v24, v24, s42
    v_fmac_f32 v135, v25, v25
    v_mfma_f32_16x16x32_bf16 v[16:19], v[236:239], v[88:91], v[16:19]
    v_fmac_f32 v135, v26, v26
    v_fmac_f32 v135, v27, v27
    v_mfma_f32_16x16x32_bf16 v[16:19], v[240:243], v[60:63], v[16:19]
    v_fmac_f32 v135, v36, v36
    v_fmac_f32 v135, v37, v37
    v_mfma_f32_16x16x32_bf16 v[16:19], v[244:247], v[40:43], v[16:19]
    v_fmac_f32 v135, v38, v38
    v_fmac_f32 v135, v39, v39
    v_mfma_f32_16x16x32_bf16 v[16:19], v[248:251], v[32:35], v[16:19]
    v_mul_f32 v108, v108, v85
    v_mul_f32 v109, v109, v85
    v_mfma_f32_16x16x32_bf16 v[16:19], v[252:255], v[8:11], v[16:19]
    s_waitcnt lgkmcnt(1)
    v_cvt_pk_bf16_f32 v2, v108, v109
    v_mul_f32 v110, v110, v85
    v_mfma_f32_16x16x32_bf16 v[8:11], a[216:219], v[80:83], 0
    v_mul_f32 v111, v111, v85
    v_cvt_pk_bf16_f32 v3, v110, v111
    v_mfma_f32_16x16x32_bf16 v[8:11], a[220:223], v[76:79], v[8:11]
    ds_write_b128 v44, v[0:3] offset:1536
    v_mfma_f32_16x16x32_bf16 v[8:11], a[224:227], v[68:71], v[8:11]
    v_fmac_f32 v135, v16, v16
    v_fmac_f32 v135, v17, v17
    v_mfma_f32_16x16x32_bf16 v[8:11], a[228:231], v[64:67], v[8:11]
    ds_read_b128 v[32:35], v23
    v_fmac_f32 v135, v18, v18
    v_mfma_f32_16x16x32_bf16 v[8:11], a[232:235], v[48:51], v[8:11]
    ds_read_b128 v[0:3], v23 offset:16
    v_fmac_f32 v135, v19, v19
    v_mfma_f32_16x16x32_bf16 v[8:11], a[236:239], v[28:31], v[8:11]
    ds_read_b64 v[40:41], v23 offset:56
    ds_read_b128 v[42:45], v23 offset:64
    v_mfma_f32_16x16x32_bf16 v[60:63], a[240:243], v[80:83], 0
    v_mul_f32 v52, v52, v85
    v_mul_f32 v53, v53, v85
    v_mfma_f32_16x16x32_bf16 v[60:63], a[244:247], v[76:79], v[60:63]
    v_cvt_pk_bf16_f32 v46, v52, v53
    v_mul_f32 v54, v54, v85
    v_mfma_f32_16x16x32_bf16 v[60:63], a[248:251], v[68:71], v[60:63]
    v_mul_f32 v55, v55, v85
    v_cvt_pk_bf16_f32 v47, v54, v55
    v_mfma_f32_16x16x32_bf16 v[60:63], a[252:255], v[64:67], v[60:63]
    ds_write_b64 v22, v[46:47] offset:1536
    v_mfma_f32_16x16x32_bf16 v[60:63], v[224:227], v[48:51], v[60:63]
    v_fma_f32 v23, v8, v8, s42
    v_fmac_f32 v23, v9, v9
    v_mfma_f32_16x16x32_bf16 v[60:63], v[228:231], v[28:31], v[60:63]
    v_fmac_f32 v23, v10, v10
    v_fmac_f32 v23, v11, v11
    v_mfma_f32_16x16x32_bf16 v[12:15], v[232:235], v[80:83], 0
    s_nop 0
    v_fma_f32 v22, v4, v4, s42
    v_fmac_f32 v22, v5, v5
    v_mfma_f32_16x16x32_bf16 v[12:15], v[236:239], v[76:79], v[12:15]
    s_nop 0
    v_fmac_f32 v23, v60, v60
    v_fmac_f32 v23, v61, v61
    v_mfma_f32_16x16x32_bf16 v[12:15], v[240:243], v[68:71], v[12:15]
    v_fmac_f32 v23, v62, v62
    v_fmac_f32 v23, v63, v63
    v_mfma_f32_16x16x32_bf16 v[12:15], v[244:247], v[64:67], v[12:15]
    v_fmac_f32 v22, v6, v6
    v_fmac_f32 v22, v7, v7
    v_mfma_f32_16x16x32_bf16 v[12:15], v[248:251], v[48:51], v[12:15]
    v_fmac_f32 v22, v92, v92
    v_fmac_f32 v22, v93, v93
    v_mfma_f32_16x16x32_bf16 v[12:15], v[252:255], v[28:31], v[12:15]
    s_waitcnt lgkmcnt(0)
    v_fmac_f32 v22, v94, v94
    v_fmac_f32 v22, v95, v95
    v_mfma_f32_16x16x32_bf16 v[28:31], v[220:223], v[32:35], 0
    v_fmac_f32 v22, v72, v72
    v_fmac_f32 v22, v73, v73
    v_mfma_f32_16x16x32_bf16 v[28:31], v[220:223], v[0:3], v[28:31]
    s_nop 0
    v_fmac_f32 v23, v12, v12
    v_fmac_f32 v23, v13, v13
    v_fmac_f32 v23, v14, v14
    v_fmac_f32 v23, v15, v15
    v_cvt_pk_bf16_f32 v23, v23, v23
    v_fmac_f32 v22, v74, v74
    v_fmac_f32 v22, v75, v75
    v_cvt_pk_bf16_f32 v22, v135, v22
    ds_write_b64 v132, v[22:23] offset:2048
    v_rcp_f32 v28, v28
    v_lshlrev_b32 v135, 16, v40
    v_and_b32 v40, 0xffff0000, v40
    v_mul_f32 v135, v135, v28
    v_mul_f32 v40, v40, v28
    v_cvt_pk_bf16_f32 v0, v135, v40
    v_lshlrev_b32 v40, 16, v41
    v_and_b32 v41, 0xffff0000, v41
    v_mul_f32 v40, v40, v28
    v_mul_f32 v41, v41, v28
    v_cvt_pk_bf16_f32 v1, v40, v41
    v_lshlrev_b32 v135, 16, v42
    v_and_b32 v42, 0xffff0000, v42
    v_mul_f32 v135, v135, v28
    v_mul_f32 v42, v42, v28
    v_cvt_pk_bf16_f32 v2, v135, v42
    v_lshlrev_b32 v3, 16, v43
    v_and_b32 v43, 0xffff0000, v43
    v_mul_f32 v3, v3, v28
    v_mul_f32 v43, v43, v28
    v_cvt_pk_bf16_f32 v3, v3, v43
    v_lshlrev_b32 v135, 16, v44
    v_and_b32 v44, 0xffff0000, v44
    v_mul_f32 v135, v135, v28
    v_mul_f32 v44, v44, v28
    v_cvt_pk_bf16_f32 v22, v135, v44
    v_lshlrev_b32 v23, 16, v45
    v_and_b32 v45, 0xffff0000, v45
    v_mul_f32 v23, v23, v28
    v_mul_f32 v45, v45, v28
    v_cvt_pk_bf16_f32 v23, v23, v45
    s_waitcnt lgkmcnt(0)
    s_barrier
    ds_write_b128 v133, v[0:3] offset:1536
    v_add_u32 v135, s92, v131
    ds_write_b64 v125, v[22:23] offset:1536
    ds_read_b128 v[48:51], v131 offset:2048
    ds_read_b128 v[44:47], v131 offset:3072
    ds_read_b128 v[0:3], v20 offset:0
    ds_read_b128 v[40:43], v20 offset:1024
    ds_read_b128 v[104:107], v20 offset:2048
    ds_read_b128 v[100:103], v20 offset:3072
    ds_read_b128 v[28:31], v20 offset:4096
    s_waitcnt lgkmcnt(7)
    s_barrier
    s_waitcnt lgkmcnt(6)
    v_mfma_f32_16x16x32_bf16 v[32:35], v[216:219], v[48:51], 0
    s_waitcnt lgkmcnt(5)
    ds_read_b128 v[96:99], v139 offset:0
    ds_read_b128 v[88:91], v138 offset:0
    v_mfma_f32_16x16x32_bf16 v[32:35], v[216:219], v[44:47], v[32:35]
    s_waitcnt lgkmcnt(6)
    ds_read_b128 v[84:87], v139 offset:128
    s_nop 0
    buffer_store_dwordx4 v[0:3], v130, s[28:31], s59 offen sc1
    s_nop 0
    ds_read_b128 v[80:83], v138 offset:128
    s_nop 1
    v_rsq_f32 v32, v32
    ds_read_b128 v[76:79], v139 offset:256
    ds_read_b128 v[0:3], v138 offset:256
    v_mul_f32 v32, s43, v32
    v_mul_f32 v24, v24, v32
    v_mul_f32 v25, v25, v32
    ds_read_b128 v[68:71], v139 offset:1536
    s_waitcnt lgkmcnt(8)
    buffer_store_dwordx4 v[40:43], v129, s[28:31], s59 offen sc1
    ds_read_b128 v[64:67], v138 offset:1536
    v_cvt_pk_bf16_f32 v48, v24, v25
    v_mul_f32 v26, v26, v32
    v_mul_f32 v27, v27, v32
    v_cvt_pk_bf16_f32 v49, v26, v27
    v_mul_f32 v36, v36, v32
    ds_read_b128 v[56:59], v139 offset:1664
    ds_read_b128 v[52:55], v138 offset:1664
    v_mul_f32 v37, v37, v32
    s_waitcnt lgkmcnt(8)
    v_mfma_f32_16x16x32_bf16 v[24:27], a[216:219], v[96:99], 0
    ds_read_b128 v[44:47], v139 offset:1792
    v_cvt_pk_bf16_f32 v50, v36, v37
    v_mfma_f32_16x16x32_bf16 v[24:27], a[220:223], v[88:91], v[24:27]
    s_waitcnt lgkmcnt(7)
    ds_read_b128 v[40:43], v138 offset:1792
    v_mul_f32 v38, v38, v32
    v_mfma_f32_16x16x32_bf16 v[24:27], a[224:227], v[84:87], v[24:27]
    buffer_store_dwordx4 v[104:107], v128, s[28:31], s59 offen sc1
    v_mul_f32 v39, v39, v32
    v_cvt_pk_bf16_f32 v51, v38, v39
    v_mul_f32 v16, v16, v32
    v_mul_f32 v17, v17, v32
    v_mfma_f32_16x16x32_bf16 v[24:27], a[228:231], v[80:83], v[24:27]
    s_waitcnt lgkmcnt(6)
    v_cvt_pk_bf16_f32 v16, v16, v17
    v_mul_f32 v18, v18, v32
    v_mfma_f32_16x16x32_bf16 v[24:27], a[232:235], v[76:79], v[24:27]
    v_rsq_f32 v33, v33
    v_mfma_f32_16x16x32_bf16 v[24:27], a[236:239], v[0:3], v[24:27]
    s_nop 0
    v_mul_f32 v19, v19, v32
    v_cvt_pk_bf16_f32 v17, v18, v19
    v_mfma_f32_16x16x32_bf16 v[36:39], a[240:243], v[96:99], 0
    s_nop 0
    buffer_store_dwordx4 v[100:103], v127, s[28:31], s59 offen sc1
    v_mul_f32 v33, s43, v33
    v_mul_f32 v4, v4, v33
    v_fma_f32 v138, v24, v24, s42
    v_fmac_f32 v138, v25, v25
    v_mfma_f32_16x16x32_bf16 v[36:39], a[244:247], v[88:91], v[36:39]
    v_fmac_f32 v138, v26, v26
    v_fmac_f32 v138, v27, v27
    v_mfma_f32_16x16x32_bf16 v[36:39], a[248:251], v[84:87], v[36:39]
    v_mul_f32 v5, v5, v33
    v_cvt_pk_bf16_f32 v4, v4, v5
    v_mfma_f32_16x16x32_bf16 v[36:39], a[252:255], v[80:83], v[36:39]
    v_mul_f32 v6, v6, v33
    v_mul_f32 v7, v7, v33
    v_mfma_f32_16x16x32_bf16 v[36:39], v[224:227], v[76:79], v[36:39]
    buffer_store_dwordx4 v[28:31], v126, s[28:31], s59 offen sc1
    v_cvt_pk_bf16_f32 v5, v6, v7
    v_mul_f32 v92, v92, v33
    v_mul_f32 v93, v93, v33
    v_cvt_pk_bf16_f32 v6, v92, v93
    v_mfma_f32_16x16x32_bf16 v[36:39], v[228:231], v[0:3], v[36:39]
    v_mul_f32 v94, v94, v33
    v_mul_f32 v95, v95, v33
    v_mfma_f32_16x16x32_bf16 v[28:31], v[232:235], v[96:99], 0
    s_nop 0
    v_cvt_pk_bf16_f32 v7, v94, v95
    v_mul_f32 v72, v72, v33
    v_mfma_f32_16x16x32_bf16 v[28:31], v[236:239], v[88:91], v[28:31]
    s_nop 0
    v_fmac_f32 v138, v36, v36
    v_fmac_f32 v138, v37, v37
    v_mfma_f32_16x16x32_bf16 v[28:31], v[240:243], v[84:87], v[28:31]
    v_fmac_f32 v138, v38, v38
    v_fmac_f32 v138, v39, v39
    v_mfma_f32_16x16x32_bf16 v[28:31], v[244:247], v[80:83], v[28:31]
    v_mul_f32 v73, v73, v33
    v_cvt_pk_bf16_f32 v22, v72, v73
    v_mfma_f32_16x16x32_bf16 v[28:31], v[248:251], v[76:79], v[28:31]
    v_mul_f32 v74, v74, v33
    v_mul_f32 v75, v75, v33
    v_mfma_f32_16x16x32_bf16 v[28:31], v[252:255], v[0:3], v[28:31]
    s_waitcnt lgkmcnt(0)
    v_rsq_f32 v34, v34
    v_mfma_f32_16x16x32_bf16 v[0:3], a[216:219], v[68:71], 0
    v_cvt_pk_bf16_f32 v23, v74, v75
    v_mul_f32 v34, s43, v34
    v_mfma_f32_16x16x32_bf16 v[0:3], a[220:223], v[64:67], v[0:3]
    ds_write_b128 v137, v[48:51] offset:0
    v_mfma_f32_16x16x32_bf16 v[0:3], a[224:227], v[56:59], v[0:3]
    v_fmac_f32 v138, v28, v28
    v_fmac_f32 v138, v29, v29
    v_mfma_f32_16x16x32_bf16 v[0:3], a[228:231], v[52:55], v[0:3]
    ds_write_b64 v136, v[16:17] offset:0
    v_mfma_f32_16x16x32_bf16 v[0:3], a[232:235], v[44:47], v[0:3]
    v_fmac_f32 v138, v30, v30
    v_fmac_f32 v138, v31, v31
    v_mfma_f32_16x16x32_bf16 v[0:3], a[236:239], v[40:43], v[0:3]
    ds_write_b128 v137, v[4:7] offset:1536
    v_mfma_f32_16x16x32_bf16 v[16:19], a[240:243], v[68:71], 0
    v_mul_f32 v8, v8, v34
    v_mul_f32 v9, v9, v34
    v_mfma_f32_16x16x32_bf16 v[16:19], a[244:247], v[64:67], v[16:19]
    ds_write_b64 v136, v[22:23] offset:1536
    v_mfma_f32_16x16x32_bf16 v[16:19], a[248:251], v[56:59], v[16:19]
    v_cvt_pk_bf16_f32 v48, v8, v9
    v_mul_f32 v10, v10, v34
    v_mfma_f32_16x16x32_bf16 v[16:19], a[252:255], v[52:55], v[16:19]
    ds_read_b128 v[4:7], v135 offset:6144
    v_mul_f32 v11, v11, v34
    v_mfma_f32_16x16x32_bf16 v[16:19], v[224:227], v[44:47], v[16:19]
    v_cvt_pk_bf16_f32 v49, v10, v11
    v_mul_f32 v60, v60, v34
    v_mfma_f32_16x16x32_bf16 v[16:19], v[228:231], v[40:43], v[16:19]
    v_mul_f32 v61, v61, v34
    v_cvt_pk_bf16_f32 v50, v60, v61
    v_mfma_f32_16x16x32_bf16 v[8:11], v[232:235], v[68:71], 0
    v_mul_f32 v62, v62, v34
    v_mul_f32 v63, v63, v34
    v_mfma_f32_16x16x32_bf16 v[8:11], v[236:239], v[64:67], v[8:11]
    v_cvt_pk_bf16_f32 v51, v62, v63
    v_mul_f32 v12, v12, v34
    v_mfma_f32_16x16x32_bf16 v[8:11], v[240:243], v[56:59], v[8:11]
    ds_write_b128 v137, v[48:51] offset:3072
    v_mfma_f32_16x16x32_bf16 v[8:11], v[244:247], v[52:55], v[8:11]
    v_mul_f32 v13, v13, v34
    v_cvt_pk_bf16_f32 v22, v12, v13
    v_mfma_f32_16x16x32_bf16 v[8:11], v[248:251], v[44:47], v[8:11]
    v_mul_f32 v14, v14, v34
    v_mul_f32 v15, v15, v34
    v_mfma_f32_16x16x32_bf16 v[8:11], v[252:255], v[40:43], v[8:11]
    v_cvt_pk_bf16_f32 v23, v14, v15
    v_fma_f32 v135, v0, v0, s42
    v_fmac_f32 v135, v1, v1
    v_fmac_f32 v135, v2, v2
    ds_write_b64 v136, v[22:23] offset:3072
    v_fmac_f32 v135, v3, v3
    v_fmac_f32 v135, v16, v16
    v_fmac_f32 v135, v17, v17
    v_fmac_f32 v135, v18, v18
    v_fmac_f32 v135, v19, v19
    v_fmac_f32 v135, v8, v8
    v_fmac_f32 v135, v9, v9
    v_fmac_f32 v135, v10, v10
    v_fmac_f32 v135, v11, v11
    v_cvt_pk_bf16_f32 v20, v138, v135
    ds_write_b64 v132, v[20:21] offset:4096
    s_waitcnt lgkmcnt(2)
    v_lshrrev_b32 v132, 0, v7
    v_lshrrev_b32 v132, v132, s64
    v_and_b32 v132, 1, v132
    v_cmp_eq_u32 vcc, 1, v132
    v_lshrrev_b32 v132, 8, v7
    v_lshrrev_b32 v132, v132, s64
    v_cndmask_b32 v4, 2.0, v4, vcc
    v_and_b32 v132, 1, v132
    v_cmp_eq_u32 vcc, 1, v132
    v_lshrrev_b32 v7, 16, v7
    v_lshrrev_b32 v7, v7, s64
    v_cndmask_b32 v5, 2.0, v5, vcc
    v_and_b32 v7, 1, v7
    v_cmp_eq_u32 vcc, 1, v7
    s_nop 1
    v_cndmask_b32 v6, 2.0, v6, vcc
    s_waitcnt lgkmcnt(1)
    s_barrier
    ds_read_b128 v[52:55], v134 offset:0
    ds_read_b128 v[12:15], v134 offset:1024
    ds_read_b128 v[40:43], v134 offset:2048
    s_waitcnt lgkmcnt(3)
    s_barrier
    ds_read_b128 v[32:35], v134 offset:3072
    ds_read_b128 v[20:23], v134 offset:4096
    ds_read_b128 v[48:51], v131 offset:4096
    ds_read_b128 v[44:47], v131 offset:5120
    s_waitcnt lgkmcnt(6)
    buffer_store_dwordx4 v[52:55], v130, s[28:31], s58 offen sc1
    s_waitcnt lgkmcnt(1)
    buffer_store_dwordx4 v[12:15], v129, s[28:31], s58 offen sc1
    s_nop 1
    v_mfma_f32_16x16x32_bf16 v[12:15], v[216:219], v[48:51], 0
    s_waitcnt lgkmcnt(0)
    v_mfma_f32_16x16x32_bf16 v[12:15], v[216:219], v[44:47], v[12:15]
    s_nop 5
    buffer_store_dwordx4 v[40:43], v128, s[28:31], s58 offen sc1
    s_nop 0
    v_rsq_f32 v12, v12
    s_nop 0
    v_mul_f32 v12, s43, v12
    v_mul_f32 v24, v24, v12
    v_mul_f32 v25, v25, v12
    v_cvt_pk_bf16_f32 v24, v24, v25
    v_mul_f32 v26, v26, v12
    v_mul_f32 v27, v27, v12
    v_cvt_pk_bf16_f32 v25, v26, v27
    v_mul_f32 v36, v36, v12
    v_mul_f32 v37, v37, v12
    v_cvt_pk_bf16_f32 v26, v36, v37
    v_mul_f32 v38, v38, v12
    buffer_store_dwordx4 v[32:35], v127, s[28:31], s58 offen sc1
    v_mul_f32 v39, v39, v12
    v_cvt_pk_bf16_f32 v27, v38, v39
    v_mul_f32 v28, v28, v12
    v_mul_f32 v29, v29, v12
    v_cvt_pk_bf16_f32 v14, v28, v29
    v_mul_f32 v30, v30, v12
    v_mul_f32 v31, v31, v12
    v_cvt_pk_bf16_f32 v15, v30, v31
    ds_write_b128 v133, v[24:27] offset:0
    buffer_store_dwordx4 v[20:23], v126, s[28:31], s58 offen sc1
    v_rsq_f32 v13, v13
    s_nop 0
    v_mul_f32 v13, s43, v13
    v_mul_f32 v0, v0, v13
    v_mul_f32 v1, v1, v13
    ds_write_b64 v125, v[14:15] offset:0
    v_cvt_pk_bf16_f32 v0, v0, v1
    v_mul_f32 v2, v2, v13
    v_mul_f32 v3, v3, v13
    v_cvt_pk_bf16_f32 v1, v2, v3
    v_mul_f32 v16, v16, v13
    v_mul_f32 v17, v17, v13
    v_cvt_pk_bf16_f32 v2, v16, v17
    v_mul_f32 v18, v18, v13
    v_mul_f32 v19, v19, v13
    v_cvt_pk_bf16_f32 v3, v18, v19
    v_mul_f32 v8, v8, v13
    v_mul_f32 v9, v9, v13
    v_cvt_pk_bf16_f32 v126, v8, v9
    v_mul_f32 v10, v10, v13
    v_mul_f32 v11, v11, v13
    v_cvt_pk_bf16_f32 v127, v10, v11
    ds_write_b128 v133, v[0:3] offset:1536
    ds_write_b64 v125, v[126:127] offset:1536
    s_waitcnt lgkmcnt(0)
    s_barrier
    ds_read_b128 v[12:15], v124 offset:0
    ds_read_b128 v[8:11], v124 offset:1024
    ds_read_b128 v[0:3], v124 offset:2048
    s_waitcnt lgkmcnt(1)
    buffer_store_dwordx4 v[12:15], v4, s[28:31], 0 offen sc1
    buffer_store_dwordx4 v[8:11], v5, s[28:31], 0 offen sc1
    s_waitcnt lgkmcnt(0)
    buffer_store_dwordx4 v[0:3], v6, s[28:31], 0 offen sc1
    s_endpgm
L_bndF:
    s_movk_i32 s73, 24
    s_sub_u32 s70, s70, 20
    s_cmp_lt_u32 s2, 247
    s_cbranch_scc1 L_bndrF
    s_movk_i32 s73, 20
    s_movk_i32 s71, 18
    s_movk_i32 s70, -20
    s_mov_b32 s74, 0
    s_cmp_lt_u32 s2, 251
    s_cbranch_scc1 L_bndcF
    s_sub_u32 s94, s2, 251
    s_mul_i32 s69, s94, 18
    s_mov_b32 s74, 25239312
    s_sub_u32 s93, s93, 1373568
    v_cmp_le_u32 vcc, 4, v132
    v_add_u32 v98, 98896896, v130
    v_subrev_u32 v99, 1373568, v130
    v_cndmask_b32 v130, v98, v99, vcc
    v_cmp_le_u32 vcc, 4, v26
    v_add_u32 v98, 98896896, v129
    v_subrev_u32 v99, 1373568, v129
    v_cndmask_b32 v129, v98, v99, vcc
    v_cmp_le_u32 vcc, 4, v114
    v_add_u32 v98, 98896896, v128
    v_subrev_u32 v99, 1373568, v128
    v_cndmask_b32 v128, v98, v99, vcc
    v_cmp_le_u32 vcc, 4, v1
    v_add_u32 v98, 98896896, v127
    v_subrev_u32 v99, 1373568, v127
    v_cndmask_b32 v127, v98, v99, vcc
    v_cmp_le_u32 vcc, 4, v96
    v_add_u32 v98, 98896896, v126
    v_subrev_u32 v99, 1373568, v126
    v_cndmask_b32 v126, v98, v99, vcc
    s_cmp_lt_u32 s2, 255
    s_cbranch_scc1 L_bndrF
L_bndcF:
    s_sub_u32 s94, s2, 247
    s_mul_i32 s69, s94, 18
    s_mov_b32 s62, 1373568
    s_add_u32 s74, s74, 345744
    s_sub_u32 s93, s93, 2688
    v_mad_i32_i24 v98, v132, -7, v112
    v_cmp_le_u32 vcc, 4, v98
    v_add_u32 v98, 193536, v130
    v_subrev_u32 v99, 2688, v130
    v_cndmask_b32 v130, v98, v99, vcc
    v_mad_i32_i24 v98, v26, -7, v8
    v_cmp_le_u32 vcc, 4, v98
    v_add_u32 v98, 193536, v129
    v_subrev_u32 v99, 2688, v129
    v_cndmask_b32 v129, v98, v99, vcc
    v_mad_i32_i24 v98, v114, -7, v125
    v_cmp_le_u32 vcc, 4, v98
    v_add_u32 v98, 193536, v128
    v_subrev_u32 v99, 2688, v128
    v_cndmask_b32 v128, v98, v99, vcc
    v_mad_i32_i24 v98, v1, -7, v135
    v_cmp_le_u32 vcc, 4, v98
    v_add_u32 v98, 193536, v127
    v_subrev_u32 v99, 2688, v127
    v_cndmask_b32 v127, v98, v99, vcc
    v_mad_i32_i24 v98, v96, -7, v113
    v_cmp_le_u32 vcc, 4, v98
    v_add_u32 v98, 193536, v126
    v_subrev_u32 v99, 2688, v126
    v_cndmask_b32 v126, v98, v99, vcc
    s_cmp_eq_u32 s2, 255
    s_cselect_b32 s62, 0, s62
    s_cselect_b32 s69, 0, s69
    s_cselect_b32 s71, 2, s71
    s_branch L_bndrF
L_maskF:
    s_add_u32 s20, s20, s74
    s_addc_u32 s21, s21, 0
    s_mov_b32 s22, 4802
    s_mov_b32 s23, 0x20000
    s_mov_b32 s85, 0x3fb8aa3b
    s_waitcnt vmcnt(0)
    v_lshrrev_b32 v42, 2, v79
    v_add_u32 v42, 0, v42
    v_mul_u32_u24 v42, 98, v42
    v_mad_u32_u24 v43, v97, 24, v42
    buffer_load_ushort v21, v43, s[20:23], 0 offen offset:0
    buffer_load_ushort v25, v43, s[20:23], 0 offen offset:2
    buffer_load_ushort v100, v43, s[20:23], 0 offen offset:4
    buffer_load_ushort v101, v43, s[20:23], 0 offen offset:6
    buffer_load_ushort v20, v43, s[20:23], 0 offen offset:8
    buffer_load_ushort v96, v43, s[20:23], 0 offen offset:10
    buffer_load_ushort v148, v43, s[20:23], 0 offen offset:12
    buffer_load_ushort v38, v43, s[20:23], 0 offen offset:14
    buffer_load_ushort v145, v43, s[20:23], 0 offen offset:16
    buffer_load_ushort v78, v43, s[20:23], 0 offen offset:18
    buffer_load_ushort v144, v43, s[20:23], 0 offen offset:20
    buffer_load_ushort v121, v43, s[20:23], 0 offen offset:22
    buffer_load_ushort v120, v42, s[20:23], 0 offen offset:96
    s_waitcnt vmcnt(0)
    v_lshlrev_b32 v21, 16, v21
    v_fmac_f32 v204, s85, v21
    v_lshlrev_b32 v25, 16, v25
    v_fmac_f32 v205, s85, v25
    v_lshlrev_b32 v100, 16, v100
    v_fmac_f32 v206, s85, v100
    v_lshlrev_b32 v101, 16, v101
    v_fmac_f32 v207, s85, v101
    v_lshlrev_b32 v20, 16, v20
    v_fmac_f32 v200, s85, v20
    v_lshlrev_b32 v96, 16, v96
    v_fmac_f32 v201, s85, v96
    v_lshlrev_b32 v148, 16, v148
    v_fmac_f32 v202, s85, v148
    v_lshlrev_b32 v38, 16, v38
    v_fmac_f32 v203, s85, v38
    v_lshlrev_b32 v145, 16, v145
    v_fmac_f32 v196, s85, v145
    v_lshlrev_b32 v78, 16, v78
    v_fmac_f32 v197, s85, v78
    v_lshlrev_b32 v144, 16, v144
    v_fmac_f32 v198, s85, v144
    v_lshlrev_b32 v121, 16, v121
    v_fmac_f32 v199, s85, v121
    v_lshlrev_b32 v120, 16, v120
    v_fmac_f32 v208, s85, v120
    v_lshrrev_b32 v42, 2, v79
    v_add_u32 v42, 4, v42
    v_mul_u32_u24 v42, 98, v42
    v_mad_u32_u24 v43, v97, 24, v42
    buffer_load_ushort v21, v43, s[20:23], 0 offen offset:0
    buffer_load_ushort v25, v43, s[20:23], 0 offen offset:2
    buffer_load_ushort v100, v43, s[20:23], 0 offen offset:4
    buffer_load_ushort v101, v43, s[20:23], 0 offen offset:6
    buffer_load_ushort v20, v43, s[20:23], 0 offen offset:8
    buffer_load_ushort v96, v43, s[20:23], 0 offen offset:10
    buffer_load_ushort v148, v43, s[20:23], 0 offen offset:12
    buffer_load_ushort v38, v43, s[20:23], 0 offen offset:14
    buffer_load_ushort v145, v43, s[20:23], 0 offen offset:16
    buffer_load_ushort v78, v43, s[20:23], 0 offen offset:18
    buffer_load_ushort v144, v43, s[20:23], 0 offen offset:20
    buffer_load_ushort v121, v43, s[20:23], 0 offen offset:22
    buffer_load_ushort v120, v42, s[20:23], 0 offen offset:96
    s_waitcnt vmcnt(0)
    v_lshlrev_b32 v21, 16, v21
    v_fmac_f32 v192, s85, v21
    v_lshlrev_b32 v25, 16, v25
    v_fmac_f32 v193, s85, v25
    v_lshlrev_b32 v100, 16, v100
    v_fmac_f32 v194, s85, v100
    v_lshlrev_b32 v101, 16, v101
    v_fmac_f32 v195, s85, v101
    v_lshlrev_b32 v20, 16, v20
    v_fmac_f32 v188, s85, v20
    v_lshlrev_b32 v96, 16, v96
    v_fmac_f32 v189, s85, v96
    v_lshlrev_b32 v148, 16, v148
    v_fmac_f32 v190, s85, v148
    v_lshlrev_b32 v38, 16, v38
    v_fmac_f32 v191, s85, v38
    v_lshlrev_b32 v145, 16, v145
    v_fmac_f32 v184, s85, v145
    v_lshlrev_b32 v78, 16, v78
    v_fmac_f32 v185, s85, v78
    v_lshlrev_b32 v144, 16, v144
    v_fmac_f32 v186, s85, v144
    v_lshlrev_b32 v121, 16, v121
    v_fmac_f32 v187, s85, v121
    v_lshlrev_b32 v120, 16, v120
    v_fmac_f32 v209, s85, v120
    v_lshrrev_b32 v42, 2, v79
    v_add_u32 v42, 8, v42
    v_mul_u32_u24 v42, 98, v42
    v_mad_u32_u24 v43, v97, 24, v42
    buffer_load_ushort v21, v43, s[20:23], 0 offen offset:0
    buffer_load_ushort v25, v43, s[20:23], 0 offen offset:2
    buffer_load_ushort v100, v43, s[20:23], 0 offen offset:4
    buffer_load_ushort v101, v43, s[20:23], 0 offen offset:6
    buffer_load_ushort v20, v43, s[20:23], 0 offen offset:8
    buffer_load_ushort v96, v43, s[20:23], 0 offen offset:10
    buffer_load_ushort v148, v43, s[20:23], 0 offen offset:12
    buffer_load_ushort v38, v43, s[20:23], 0 offen offset:14
    buffer_load_ushort v145, v43, s[20:23], 0 offen offset:16
    buffer_load_ushort v78, v43, s[20:23], 0 offen offset:18
    buffer_load_ushort v144, v43, s[20:23], 0 offen offset:20
    buffer_load_ushort v121, v43, s[20:23], 0 offen offset:22
    buffer_load_ushort v120, v42, s[20:23], 0 offen offset:96
    s_waitcnt vmcnt(0)
    v_lshlrev_b32 v21, 16, v21
    v_fmac_f32 v180, s85, v21
    v_lshlrev_b32 v25, 16, v25
    v_fmac_f32 v181, s85, v25
    v_lshlrev_b32 v100, 16, v100
    v_fmac_f32 v182, s85, v100
    v_lshlrev_b32 v101, 16, v101
    v_fmac_f32 v183, s85, v101
    v_lshlrev_b32 v20, 16, v20
    v_fmac_f32 v176, s85, v20
    v_lshlrev_b32 v96, 16, v96
    v_fmac_f32 v177, s85, v96
    v_lshlrev_b32 v148, 16, v148
    v_fmac_f32 v178, s85, v148
    v_lshlrev_b32 v38, 16, v38
    v_fmac_f32 v179, s85, v38
    v_lshlrev_b32 v145, 16, v145
    v_fmac_f32 v172, s85, v145
    v_lshlrev_b32 v78, 16, v78
    v_fmac_f32 v173, s85, v78
    v_lshlrev_b32 v144, 16, v144
    v_fmac_f32 v174, s85, v144
    v_lshlrev_b32 v121, 16, v121
    v_fmac_f32 v175, s85, v121
    v_lshlrev_b32 v120, 16, v120
    v_fmac_f32 v210, s85, v120
    v_lshrrev_b32 v42, 2, v79
    v_lshl_add_u32 v42, v97, 2, v42
    v_cmp_gt_u32 vcc, 3, v97
    v_mov_b32 v43, 48
    s_nop 1
    v_cndmask_b32 v42, v43, v42, vcc
    v_add_u32 v42, 2352, v42
    v_lshlrev_b32 v42, 1, v42
    buffer_load_ushort v21, v42, s[20:23], 0 offen
    s_waitcnt vmcnt(0)
    v_lshlrev_b32 v21, 16, v21
    v_fmac_f32 v211, s85, v21
    s_branch L_nomaskF
L_atomF0:
    v_mov_b32 v124, 0x800000
    buffer_atomic_add v124, v131, s[8:11], 0 offen sc0 sc1
    s_branch L_atomrF0
L_bndS:
    s_movk_i32 s73, 24
    s_sub_u32 s70, s70, 20
    s_cmp_lt_u32 s2, 247
    s_cbranch_scc1 L_bndrS
    s_movk_i32 s73, 20
    s_movk_i32 s71, 18
    s_movk_i32 s70, -20
    s_mov_b32 s74, 0
    s_cmp_lt_u32 s2, 251
    s_cbranch_scc1 L_bndcS
    s_sub_u32 s94, s2, 251
    s_mul_i32 s69, s94, 18
    s_mov_b32 s74, 25239312
    s_sub_u32 s93, s93, 1373568
    v_cmp_le_u32 vcc, 4, v39
    v_add_u32 v42, 98896896, v130
    v_subrev_u32 v43, 1373568, v130
    v_cndmask_b32 v130, v42, v43, vcc
    v_cmp_le_u32 vcc, 4, v73
    v_add_u32 v42, 98896896, v129
    v_subrev_u32 v43, 1373568, v129
    v_cndmask_b32 v129, v42, v43, vcc
    v_cmp_le_u32 vcc, 4, v124
    v_add_u32 v42, 98896896, v128
    v_subrev_u32 v43, 1373568, v128
    v_cndmask_b32 v128, v42, v43, vcc
    v_cmp_le_u32 vcc, 4, v19
    v_add_u32 v42, 98896896, v127
    v_subrev_u32 v43, 1373568, v127
    v_cndmask_b32 v127, v42, v43, vcc
    v_cmp_le_u32 vcc, 4, v8
    v_add_u32 v42, 98896896, v126
    v_subrev_u32 v43, 1373568, v126
    v_cndmask_b32 v126, v42, v43, vcc
    s_cmp_lt_u32 s2, 255
    s_cbranch_scc1 L_bndrS
L_bndcS:
    s_sub_u32 s94, s2, 247
    s_mul_i32 s69, s94, 18
    s_mov_b32 s62, 1373568
    s_add_u32 s74, s74, 345744
    s_sub_u32 s93, s93, 2688
    v_mad_i32_i24 v42, v39, -7, v36
    v_cmp_le_u32 vcc, 4, v42
    v_add_u32 v42, 193536, v130
    v_subrev_u32 v43, 2688, v130
    v_cndmask_b32 v130, v42, v43, vcc
    v_mad_i32_i24 v42, v73, -7, v26
    v_cmp_le_u32 vcc, 4, v42
    v_add_u32 v42, 193536, v129
    v_subrev_u32 v43, 2688, v129
    v_cndmask_b32 v129, v42, v43, vcc
    v_mad_i32_i24 v42, v124, -7, v27
    v_cmp_le_u32 vcc, 4, v42
    v_add_u32 v42, 193536, v128
    v_subrev_u32 v43, 2688, v128
    v_cndmask_b32 v128, v42, v43, vcc
    v_mad_i32_i24 v42, v19, -7, v149
    v_cmp_le_u32 vcc, 4, v42
    v_add_u32 v42, 193536, v127
    v_subrev_u32 v43, 2688, v127
    v_cndmask_b32 v127, v42, v43, vcc
    v_mad_i32_i24 v42, v8, -7, v72
    v_cmp_le_u32 vcc, 4, v42
    v_add_u32 v42, 193536, v126
    v_subrev_u32 v43, 2688, v126
    v_cndmask_b32 v126, v42, v43, vcc
    s_cmp_eq_u32 s2, 255
    s_cselect_b32 s62, 0, s62
    s_cselect_b32 s69, 0, s69
    s_cselect_b32 s71, 2, s71
    s_branch L_bndrS
L_maskS:
    s_add_u32 s20, s20, s74
    s_addc_u32 s21, s21, 0
    s_mov_b32 s22, 4802
    s_mov_b32 s23, 0x20000
    s_mov_b32 s85, 0x3fb8aa3b
    s_waitcnt vmcnt(0)
    v_lshrrev_b32 v154, 2, v150
    v_add_u32 v154, 0, v154
    v_mul_u32_u24 v154, 98, v154
    v_mad_u32_u24 v155, v151, 24, v154
    buffer_load_ushort v41, v155, s[20:23], 0 offen offset:0
    buffer_load_ushort v142, v155, s[20:23], 0 offen offset:2
    buffer_load_ushort v160, v155, s[20:23], 0 offen offset:4
    buffer_load_ushort v156, v155, s[20:23], 0 offen offset:6
    buffer_load_ushort v168, v155, s[20:23], 0 offen offset:8
    buffer_load_ushort v166, v155, s[20:23], 0 offen offset:10
    buffer_load_ushort v143, v155, s[20:23], 0 offen offset:12
    buffer_load_ushort v164, v155, s[20:23], 0 offen offset:14
    buffer_load_ushort v161, v155, s[20:23], 0 offen offset:16
    buffer_load_ushort v158, v155, s[20:23], 0 offen offset:18
    buffer_load_ushort v162, v155, s[20:23], 0 offen offset:20
    buffer_load_ushort v165, v155, s[20:23], 0 offen offset:22
    buffer_load_ushort v157, v154, s[20:23], 0 offen offset:96
    s_waitcnt vmcnt(0)
    v_lshlrev_b32 v41, 16, v41
    v_fmac_f32 v204, s85, v41
    v_lshlrev_b32 v142, 16, v142
    v_fmac_f32 v205, s85, v142
    v_lshlrev_b32 v160, 16, v160
    v_fmac_f32 v206, s85, v160
    v_lshlrev_b32 v156, 16, v156
    v_fmac_f32 v207, s85, v156
    v_lshlrev_b32 v168, 16, v168
    v_fmac_f32 v200, s85, v168
    v_lshlrev_b32 v166, 16, v166
    v_fmac_f32 v201, s85, v166
    v_lshlrev_b32 v143, 16, v143
    v_fmac_f32 v202, s85, v143
    v_lshlrev_b32 v164, 16, v164
    v_fmac_f32 v203, s85, v164
    v_lshlrev_b32 v161, 16, v161
    v_fmac_f32 v196, s85, v161
    v_lshlrev_b32 v158, 16, v158
    v_fmac_f32 v197, s85, v158
    v_lshlrev_b32 v162, 16, v162
    v_fmac_f32 v198, s85, v162
    v_lshlrev_b32 v165, 16, v165
    v_fmac_f32 v199, s85, v165
    v_lshlrev_b32 v157, 16, v157
    v_fmac_f32 v208, s85, v157
    v_lshrrev_b32 v154, 2, v150
    v_add_u32 v154, 4, v154
    v_mul_u32_u24 v154, 98, v154
    v_mad_u32_u24 v155, v151, 24, v154
    buffer_load_ushort v41, v155, s[20:23], 0 offen offset:0
    buffer_load_ushort v142, v155, s[20:23], 0 offen offset:2
    buffer_load_ushort v160, v155, s[20:23], 0 offen offset:4
    buffer_load_ushort v156, v155, s[20:23], 0 offen offset:6
    buffer_load_ushort v168, v155, s[20:23], 0 offen offset:8
    buffer_load_ushort v166, v155, s[20:23], 0 offen offset:10
    buffer_load_ushort v143, v155, s[20:23], 0 offen offset:12
    buffer_load_ushort v164, v155, s[20:23], 0 offen offset:14
    buffer_load_ushort v161, v155, s[20:23], 0 offen offset:16
    buffer_load_ushort v158, v155, s[20:23], 0 offen offset:18
    buffer_load_ushort v162, v155, s[20:23], 0 offen offset:20
    buffer_load_ushort v165, v155, s[20:23], 0 offen offset:22
    buffer_load_ushort v157, v154, s[20:23], 0 offen offset:96
    s_waitcnt vmcnt(0)
    v_lshlrev_b32 v41, 16, v41
    v_fmac_f32 v192, s85, v41
    v_lshlrev_b32 v142, 16, v142
    v_fmac_f32 v193, s85, v142
    v_lshlrev_b32 v160, 16, v160
    v_fmac_f32 v194, s85, v160
    v_lshlrev_b32 v156, 16, v156
    v_fmac_f32 v195, s85, v156
    v_lshlrev_b32 v168, 16, v168
    v_fmac_f32 v188, s85, v168
    v_lshlrev_b32 v166, 16, v166
    v_fmac_f32 v189, s85, v166
    v_lshlrev_b32 v143, 16, v143
    v_fmac_f32 v190, s85, v143
    v_lshlrev_b32 v164, 16, v164
    v_fmac_f32 v191, s85, v164
    v_lshlrev_b32 v161, 16, v161
    v_fmac_f32 v184, s85, v161
    v_lshlrev_b32 v158, 16, v158
    v_fmac_f32 v185, s85, v158
    v_lshlrev_b32 v162, 16, v162
    v_fmac_f32 v186, s85, v162
    v_lshlrev_b32 v165, 16, v165
    v_fmac_f32 v187, s85, v165
    v_lshlrev_b32 v157, 16, v157
    v_fmac_f32 v209, s85, v157
    v_lshrrev_b32 v154, 2, v150
    v_add_u32 v154, 8, v154
    v_mul_u32_u24 v154, 98, v154
    v_mad_u32_u24 v155, v151, 24, v154
    buffer_load_ushort v41, v155, s[20:23], 0 offen offset:0
    buffer_load_ushort v142, v155, s[20:23], 0 offen offset:2
    buffer_load_ushort v160, v155, s[20:23], 0 offen offset:4
    buffer_load_ushort v156, v155, s[20:23], 0 offen offset:6
    buffer_load_ushort v168, v155, s[20:23], 0 offen offset:8
    buffer_load_ushort v166, v155, s[20:23], 0 offen offset:10
    buffer_load_ushort v143, v155, s[20:23], 0 offen offset:12
    buffer_load_ushort v164, v155, s[20:23], 0 offen offset:14
    buffer_load_ushort v161, v155, s[20:23], 0 offen offset:16
    buffer_load_ushort v158, v155, s[20:23], 0 offen offset:18
    buffer_load_ushort v162, v155, s[20:23], 0 offen offset:20
    buffer_load_ushort v165, v155, s[20:23], 0 offen offset:22
    buffer_load_ushort v157, v154, s[20:23], 0 offen offset:96
    s_waitcnt vmcnt(0)
    v_lshlrev_b32 v41, 16, v41
    v_fmac_f32 v180, s85, v41
    v_lshlrev_b32 v142, 16, v142
    v_fmac_f32 v181, s85, v142
    v_lshlrev_b32 v160, 16, v160
    v_fmac_f32 v182, s85, v160
    v_lshlrev_b32 v156, 16, v156
    v_fmac_f32 v183, s85, v156
    v_lshlrev_b32 v168, 16, v168
    v_fmac_f32 v176, s85, v168
    v_lshlrev_b32 v166, 16, v166
    v_fmac_f32 v177, s85, v166
    v_lshlrev_b32 v143, 16, v143
    v_fmac_f32 v178, s85, v143
    v_lshlrev_b32 v164, 16, v164
    v_fmac_f32 v179, s85, v164
    v_lshlrev_b32 v161, 16, v161
    v_fmac_f32 v172, s85, v161
    v_lshlrev_b32 v158, 16, v158
    v_fmac_f32 v173, s85, v158
    v_lshlrev_b32 v162, 16, v162
    v_fmac_f32 v174, s85, v162
    v_lshlrev_b32 v165, 16, v165
    v_fmac_f32 v175, s85, v165
    v_lshlrev_b32 v157, 16, v157
    v_fmac_f32 v210, s85, v157
    v_lshrrev_b32 v154, 2, v150
    v_lshl_add_u32 v154, v151, 2, v154
    v_cmp_gt_u32 vcc, 3, v151
    v_mov_b32 v155, 48
    s_nop 1
    v_cndmask_b32 v154, v155, v154, vcc
    v_add_u32 v154, 2352, v154
    v_lshlrev_b32 v154, 1, v154
    buffer_load_ushort v41, v154, s[20:23], 0 offen
    s_waitcnt vmcnt(0)
    v_lshlrev_b32 v41, 16, v41
    v_fmac_f32 v211, s85, v41
    s_branch L_nomaskS
L_atomS0:
    v_mov_b32 v124, 0x800000
    buffer_atomic_add v124, v131, s[8:11], 0 offen sc0 sc1
    s_branch L_atomrS0
.section .rodata,"a"
.p2align 6
.amdhsa_kernel standalone__window_attn_swin_v2__vision_kernel
  .amdhsa_next_free_vgpr 512
  .amdhsa_next_free_sgpr 102
  .amdhsa_accum_offset 256
  .amdhsa_group_segment_fixed_size 0
  .amdhsa_kernarg_size 96
  .amdhsa_user_sgpr_count 2
  .amdhsa_user_sgpr_kernarg_segment_ptr 1
  .amdhsa_system_sgpr_workgroup_id_x 1
.end_amdhsa_kernel
```

```asm
; @launch grid=(256,1,1) block=(256,1,1) lds=163840
.amdgcn_target "amdgcn-amd-amdhsa--gfx950"
.text
.globl standalone__window_attn_swin_v2__vision_kernel
.p2align 8
.type standalone__window_attn_swin_v2__vision_kernel,@function
standalone__window_attn_swin_v2__vision_kernel:
    v_lshrrev_b32 v0, 6, v0
    s_cmp_ge_u32 s2, 256
    s_cbranch_scc1 L_end
    v_readfirstlane_b32 s68, v0
    s_mov_b32 s64, 0
    s_nop 0
    v_mbcnt_lo_u32_b32 v8, -1, 0
    v_mbcnt_hi_u32_b32 v8, -1, v8
    s_load_dwordx16 s[4:19], s[0:1], 0
    s_load_dwordx4 s[20:23], s[0:1], 64
    s_load_dwordx2 s[38:39], s[0:1], 80
    s_lshr_b32 s88, s2, 3
    s_lshl2_add_u32 s88, s88, s68
    v_lshlrev_b32 v9, 7, v8
    s_getpc_b64 s[80:81]
    s_lshl_b32 s84, s88, 8
    v_and_b32 v10, 128, v9
    v_add_u32 v10, s84, v10
    v_min_u32 v10, L_slow-standalone__window_attn_swin_v2__vision_kernel-256, v10
    s_mul_i32 s89, s88, 576
    s_mul_i32 s88, s88, 1728
    global_load_dword a255, v10, s[80:81]
    v_min_u32 v135, 1664, v9
    v_min_u32 v132, 512, v9
    s_mov_b32 s34, 221184
    s_mov_b32 s35, 0x20000
    s_mov_b32 s78, 73728
    s_mov_b32 s79, 0x20000
    v_and_b32 v30, 15, v8
    v_lshrrev_b32 v152, 4, v8
    v_lshrrev_b32 v134, 2, v30
    v_and_b32 v133, 3, v30
    s_mul_i32 s87, s68, 192
    v_mad_u32_u24 v0, v30, 12, s87
    v_lshlrev_b32 v43, 1, v30
    v_lshlrev_b32 v115, 1, v134
    v_lshl_add_u32 v115, v152, 5, v115
    s_movk_i32 s86, 384
    s_mov_b32 s26, 100270464
    s_mov_b32 s27, 0x20000
    s_mov_b32 s30, 0
    s_mov_b32 s31, 0x20000
    s_waitcnt lgkmcnt(0)
    s_mov_b32 s24, s4
    s_mov_b32 s25, s5
    s_mov_b32 s32, s6
    s_mov_b32 s33, s7
    s_mov_b32 s76, s8
    s_mov_b32 s77, s9
    buffer_load_dword a254, v135, s[32:35], s88 offen
    buffer_load_dword a253, v132, s[76:79], s89 offen
    s_load_dwordx2 s[82:83], s[10:11], 0
    s_movk_i32 s18, 676
    s_mov_b32 s19, 0x20000
    buffer_load_dwordx3 v[40:42], v0, s[16:19], 0 offen
    s_mul_i32 s96, s68, 288
    s_and_b32 s97, s68, 1
    s_lshl_b32 s97, s97, 2
    s_mov_b32 s98, 193536
    s_mov_b32 s99, 589824
    global_load_ushort v24, v43, s[12:13]
    v_add_u32 v124, s96, v8
    v_mul_u32_u24 v2, 2731, v124
    v_mul_u32_u24 v114, 6242, v124
    v_lshrrev_b32 v2, 16, v2
    v_lshrrev_b32 v114, 20, v114
    s_lshr_b32 s94, s2, 3
    s_mul_i32 s70, s94, 168
    global_load_ushort v25, v43, s[12:13] offset:32
    v_and_or_b32 v112, v2, 3, s97
    v_xor_b32 v112, v124, v112
    v_lshl_add_u32 v130, v112, 4, s99
    v_mad_u32_u24 v130, v114, s98, v130
    v_add_u32 v11, 64, v124
    s_mul_i32 s69, s2, 20
    s_lshl3_add_u32 s69, s94, s69
    global_load_ushort v10, v115, s[14:15] offset:0
    v_mul_u32_u24 v9, 2731, v11
    v_mul_u32_u24 v43, 6242, v11
    v_lshrrev_b32 v9, 16, v9
    v_lshrrev_b32 v43, 20, v43
    v_and_or_b32 v113, v9, 3, s97
    s_add_u32 s70, s70, 140
    s_movk_i32 s62, 2688
    global_load_ushort v131, v115, s[14:15] offset:8
    v_xor_b32 v113, v11, v113
    v_lshl_add_u32 v129, v113, 4, s99
    v_mad_u32_u24 v129, v43, s98, v129
    v_add_u32 v128, 128, v124
    v_mul_u32_u24 v27, 2731, v128
    s_movk_i32 s71, 20
    s_movk_i32 s73, 28
    global_load_ushort v11, v115, s[14:15] offset:16
    v_mul_u32_u24 v125, 6242, v128
    v_lshrrev_b32 v27, 16, v27
    v_lshrrev_b32 v125, 20, v125
    v_and_or_b32 v26, v27, 3, s97
    v_xor_b32 v26, v128, v26
    s_mov_b32 s93, 1769472
    s_mul_i32 s54, s68, 5120
    global_load_ushort v1, v115, s[14:15] offset:24
    v_lshl_add_u32 v128, v26, 4, s99
    v_mad_u32_u24 v128, v125, s98, v128
    v_add_u32 v135, 192, v124
    v_mul_u32_u24 v115, 2731, v135
    v_mul_u32_u24 v3, 6242, v135
    v_lshrrev_b32 v115, 16, v115
    v_lshrrev_b32 v3, 20, v3
    v_and_or_b32 v132, v115, 3, s97
    v_xor_b32 v132, v135, v132
    v_lshl_add_u32 v127, v132, 4, s99
    v_mad_u32_u24 v127, v3, s98, v127
    v_add_u32 v28, 256, v124
    v_mul_u32_u24 v31, 2731, v28
    v_mul_u32_u24 v124, 6242, v28
    v_lshrrev_b32 v31, 16, v31
    v_lshrrev_b32 v124, 20, v124
    v_and_or_b32 v126, v31, 3, s97
    v_xor_b32 v126, v28, v126
    v_lshl_add_u32 v126, v126, 4, s99
    v_mad_u32_u24 v126, v124, s98, v126
    s_cmp_ge_u32 s2, 240
    s_cbranch_scc1 L_bndF
L_bndrF:
    s_mov_b32 s63, 1180032
    s_mul_i32 s94, s69, 58255
    s_lshr_b32 s94, s94, 22
    s_mul_i32 s94, s94, s63
    s_mul_i32 s72, s69, s62
    s_add_u32 s72, s72, s94
    v_lshl_or_b32 v29, v8, 4, 2.0
    s_sub_u32 s94, s73, 1
    s_max_u32 s94, s94, 20
    s_mul_i32 s95, s68, -44
    s_movk_i32 s99, -24
    s_add_u32 m0, s54, 0
    v_and_b32 v43, -4, v27
    s_mul_i32 s85, s68, 96
    s_sub_u32 s100, s85, 1024
    buffer_load_dwordx4 v130, s[24:27], s72 offen nt lds
    s_add_u32 m0, s54, 1024
    v_mad_u32_u24 v3, v43, 3, v27
    v_add_u32 v3, s95, v3
    v_mad_i32_i24 v114, v27, s99, v26
    v_med3_u32 v43, v3, 20, s94
    v_add_u32 v43, s70, v43
    v_add_u32 v115, s69, v3
    s_sub_u32 s87, s85, 2048
    s_movk_i32 s91, 1152
    buffer_load_dwordx4 v129, s[24:27], s72 offen nt lds
    v_cmp_gt_u32 vcc, s71, v3
    v_lshl_add_u32 v114, v114, 4, s93
    s_add_u32 m0, s54, 43008
    v_cndmask_b32 v115, v43, v115, vcc
    v_mul_u32_u24 v43, 58255, v115
    v_mad_u32_u24 v114, v115, s62, v114
    v_lshrrev_b32 v43, 22, v43
    v_mad_u32_u24 v114, v43, s63, v114
    s_mul_i32 s90, s68, 3072
    s_add_u32 s90, s90, 61440
    buffer_load_dwordx4 v114, s[24:27], 0 offen  lds
    v_lshlrev_b32 v115, 16, v3
    s_add_u32 m0, s54, 2048
    v_and_b32 v43, -4, v9
    v_mad_u32_u24 v3, v43, 3, v9
    v_add_u32 v3, s95, v3
    v_mad_i32_i24 v113, v9, s99, v113
    v_med3_u32 v43, v3, 20, s94
    s_add_u32 s101, s54, 44032
    s_mov_b32 s28, s22
    buffer_load_dwordx4 v128, s[24:27], s72 offen nt lds
    v_add_u32 v43, s70, v43
    v_add_u32 v9, s69, v3
    v_cmp_gt_u32 vcc, s71, v3
    v_lshl_add_u32 v113, v113, 4, s93
    s_add_u32 m0, s54, 41984
    v_cndmask_b32 v9, v43, v9, vcc
    v_mul_u32_u24 v43, 58255, v9
    v_mad_u32_u24 v113, v9, s62, v113
    v_lshrrev_b32 v43, 22, v43
    v_mad_u32_u24 v113, v43, s63, v113
    s_mov_b32 s29, s23
    s_mov_b32 s41, 0x2a8cbccc
    buffer_load_dwordx4 v113, s[24:27], 0 offen  lds
    v_lshl_or_b32 v115, v3, 8, v115
    s_add_u32 m0, s54, 3072
    v_cmp_gt_u32 vcc, 32, v8
    v_and_b32 v43, -4, v2
    v_mad_u32_u24 v9, v43, 3, v2
    v_cndmask_b32 v126, v29, v126, vcc
    v_add_u32 v9, s95, v9
    s_mov_b32 s42, 0x38fba882
    s_mov_b32 s43, 0x415db3d7
    buffer_load_dwordx4 v127, s[24:27], s72 offen nt lds
    s_add_u32 m0, s54, 4096
    v_mad_i32_i24 v112, v2, s99, v112
    v_med3_u32 v43, v9, 20, s94
    v_add_u32 v43, s70, v43
    v_add_u32 v2, s69, v9
    v_cmp_gt_u32 vcc, s71, v9
    v_lshl_add_u32 v112, v112, 4, s93
    s_mul_i32 s93, s68, 6
    s_lshl_b32 s94, s97, 1
    buffer_load_dwordx4 v126, s[24:27], s72 offen nt lds
    v_cndmask_b32 v2, v43, v2, vcc
    v_mul_u32_u24 v43, 58255, v2
    v_mad_u32_u24 v112, v2, s62, v112
    v_lshrrev_b32 v43, 22, v43
    v_mad_u32_u24 v112, v43, s63, v112
    s_add_u32 m0, s54, 40960
    v_lshl_or_b32 v115, v9, 0, v115
    s_mov_b32 s44, 61440
    s_mov_b32 s45, 40960
    buffer_load_dwordx4 v112, s[24:27], 0 offen nt lds
    v_mul_u32_u24 v2, 10923, v8
    v_lshrrev_b32 v141, 17, v2
    v_lshrrev_b32 v2, 16, v2
    v_mad_i32_i24 v27, v2, -6, v8
    v_bitop3_b32 v141, v141, v2, 4 bitop3:0x28
    v_lshl_add_u32 v27, v27, 4, s85
    v_mul_u32_u24 v141, 3, v141
    v_xor_b32 v2, v2, v141
    v_mad_u32_u24 v141, v2, s91, v27
    v_add_u32 v3, 64, v8
    v_mul_u32_u24 v9, 10923, v3
    v_lshrrev_b32 v57, 17, v9
    v_lshrrev_b32 v9, 16, v9
    v_mad_i32_i24 v26, v9, -6, v3
    v_bitop3_b32 v57, v57, v9, 4 bitop3:0x28
    v_lshl_add_u32 v26, v26, 4, s100
    v_mul_u32_u24 v57, 3, v57
    v_xor_b32 v9, v9, v57
    v_mad_u32_u24 v57, v9, s91, v26
    v_add_u32 v43, 128, v8
    v_mul_u32_u24 v3, 10923, v43
    v_lshrrev_b32 v34, 17, v3
    v_lshrrev_b32 v3, 16, v3
    v_mad_i32_i24 v43, v3, -6, v43
    v_bitop3_b32 v34, v34, v3, 4 bitop3:0x28
    v_lshl_add_u32 v43, v43, 4, s87
    v_mul_u32_u24 v34, 3, v34
    v_xor_b32 v3, v3, v34
    v_mad_u32_u24 v34, v3, s91, v43
    v_mad_u32_u24 v62, v2, s86, v27
    v_mad_u32_u24 v63, v9, s86, v26
    v_mad_u32_u24 v9, v3, s86, v43
    s_add_u32 m0, s90, 0
    s_mov_b32 s92, 0
    buffer_load_dwordx4 v141, s[32:35], s92 offen offset:0 lds
    v_lshrrev_b32 v2, 1, v152
    v_lshl_add_u32 v43, v152, 2, v134
    v_lshl_add_u32 v43, v2, 3, v43
    v_mul_u32_u24 v43, 96, v43
    v_add_u32 v43, s90, v43
    v_lshl_add_u32 v13, v133, 4, v43
    v_lshl_add_u32 v12, v133, 3, v43
    v_mov_b32 v3, 0x3f803f80
    v_cmp_eq_u32 vcc, 0, v133
    v_and_b32 v2, 1, v8
    v_lshlrev_b32 v2, 4, v2
    v_cndmask_b32 v220, 0, v3, vcc
    v_cndmask_b32 v221, 0, v3, vcc
    v_cndmask_b32 v222, 0, v3, vcc
    v_cndmask_b32 v223, 0, v3, vcc
    v_mov_b32 v43, 0x3f80
    v_lshlrev_b32 v43, v2, v43
    v_cmp_gt_u32 vcc, 2, v133
    v_mov_b32 v14, 0x44004400
    v_mul_u32_u24 v148, 48, v134
    v_cndmask_b32 v216, 0, v43, vcc
    v_cndmask_b32 v218, 0, v43, vcc
    v_cmp_le_u32 vcc, 2, v133
    v_lshl_add_u32 v148, v133, 2, v148
    v_mul_u32_u24 v15, 48, v152
    v_cndmask_b32 v217, 0, v43, vcc
    v_cndmask_b32 v219, 0, v43, vcc
    v_cmp_eq_u32 vcc, v152, v134
    v_add_u32 v149, 0, v148
    v_mul_u32_u24 v43, 37, v149
    v_cndmask_b32 v18, 0, v216, vcc
    v_cndmask_b32 v19, 0, v217, vcc
    v_cmp_eq_u32 vcc, 0, v133
    v_lshrrev_b32 v43, 10, v43
    v_mad_u32_u24 v149, v43, 24, v149
    v_cndmask_b32 v212, 0, v14, vcc
    v_cmp_eq_u32 vcc, 1, v133
    v_add_u32 v149, s101, v149
    v_add_u32 v187, 16, v148
    v_cndmask_b32 v213, 0, v14, vcc
    v_cmp_eq_u32 vcc, 2, v133
    v_mul_u32_u24 v43, 37, v187
    v_lshrrev_b32 v43, 10, v43
    v_cndmask_b32 v214, 0, v14, vcc
    v_cmp_eq_u32 vcc, 3, v133
    v_mad_u32_u24 v187, v43, 24, v187
    v_add_u32 v187, s101, v187
    v_cndmask_b32 v215, 0, v14, vcc
    v_add_u32 v175, 32, v148
    v_mul_u32_u24 v14, 37, v175
    v_lshrrev_b32 v14, 10, v14
    v_mad_u32_u24 v175, v14, 24, v175
    v_add_u32 v175, s101, v175
    v_add_u32 v211, 0, v15
    v_mul_u32_u24 v14, 37, v211
    v_lshrrev_b32 v14, 10, v14
    v_mad_u32_u24 v211, v14, 24, v211
    v_add_u32 v208, 4, v15
    v_mul_u32_u24 v14, 37, v208
    v_lshrrev_b32 v14, 10, v14
    v_mad_u32_u24 v208, v14, 24, v208
    v_add_u32 v151, 8, v15
    v_mul_u32_u24 v14, 37, v151
    v_lshrrev_b32 v14, 10, v14
    v_mad_u32_u24 v151, v14, 24, v151
    v_add_u32 v142, 12, v15
    v_mul_u32_u24 v14, 37, v142
    v_lshrrev_b32 v14, 10, v14
    v_mad_u32_u24 v142, v14, 24, v142
    v_add_u32 v150, 16, v15
    v_mul_u32_u24 v14, 37, v150
    v_lshrrev_b32 v14, 10, v14
    v_mad_u32_u24 v150, v14, 24, v150
    v_add_u32 v60, 20, v15
    v_mul_u32_u24 v14, 37, v60
    v_lshrrev_b32 v14, 10, v14
    v_mad_u32_u24 v60, v14, 24, v60
    v_add_u32 v140, 24, v15
    v_mul_u32_u24 v14, 37, v140
    v_lshrrev_b32 v14, 10, v14
    v_mad_u32_u24 v140, v14, 24, v140
    v_add_u32 v61, 28, v15
    v_mul_u32_u24 v14, 37, v61
    v_lshrrev_b32 v14, 10, v14
    v_mad_u32_u24 v61, v14, 24, v61
    v_add_u32 v17, 32, v15
    v_mul_u32_u24 v14, 37, v17
    v_lshrrev_b32 v14, 10, v14
    v_mad_u32_u24 v17, v14, 24, v17
    s_waitcnt lgkmcnt(0)
    s_sext_i32_i16 s84, s82
    s_ashr_i32 s85, s82, 16
    s_max_i32 s84, s84, s85
    s_sext_i32_i16 s85, s83
    s_max_i32 s84, s84, s85
    s_ashr_i32 s85, s83, 16
    s_max_i32 s84, s84, s85
    s_cmp_gt_i32 s84, 16492
    s_cbranch_scc1 L_slow
    s_lshl_b32 s84, s68, 4
    buffer_load_dwordx4 v57, s[32:35], s92 offen offset:1024 lds
    v_add_u32 v16, 36, v15
    v_mul_u32_u24 v14, 37, v16
    v_lshrrev_b32 v14, 10, v14
    v_mad_u32_u24 v16, v14, 24, v16
    v_add_u32 v14, 40, v15
    v_mul_u32_u24 v43, 37, v14
    v_lshrrev_b32 v43, 10, v43
    s_lshr_b64 s[82:83], s[82:83], s84
    s_lshl_b32 s82, s82, 16
    buffer_load_dwordx4 v34, s[32:35], s92 offen offset:2048 lds
    s_add_u32 m0, s90, 12288
    s_mov_b32 s92, 36864
    v_mad_u32_u24 v14, v43, 24, v14
    v_add_u32 v15, 44, v15
    v_mul_u32_u24 v43, 37, v15
    v_lshrrev_b32 v43, 10, v43
    v_mad_u32_u24 v15, v43, 24, v15
    s_mov_b32 s84, 0x41b8aa3b
    s_mov_b32 s46, 20480
    buffer_load_dwordx4 v141, s[32:35], s92 offen offset:0 lds
    v_lshl_add_u32 v143, v152, 4, v148
    v_mul_u32_u24 v43, 37, v143
    v_lshrrev_b32 v43, 10, v43
    v_mad_u32_u24 v143, v43, 24, v143
    v_mov_b32 v2, 336
    v_cmp_gt_u32 vcc, 3, v152
    v_and_b32 v43, 8, v30
    v_add_u32 v43, v43, v30
    v_cndmask_b32 v143, v2, v143, vcc
    v_sub_u32 v143, s101, v143
    v_mul_u32_u24 v43, 96, v43
    v_add_u32 v43, s90, v43
    v_lshl_add_u32 v90, v152, 4, v43
    v_lshl_add_u32 v3, v152, 3, v43
    v_lshlrev_b32 v2, 4, v152
    s_mov_b32 s47, 0
    s_mov_b32 s57, s72
    buffer_load_dwordx4 v57, s[32:35], s92 offen offset:1024 lds
    v_add_u32 v2, 4608, v2
    v_mov_b32 v43, s82
    v_min_f32 v43, 0x40930000, v43
    v_max_f32 v43, 0xc2c80000, v43
    v_mul_f32 v43, 0x3fb8aa3b, v43
    v_exp_f32 v43, v43
    s_waitcnt vmcnt(17)
    v_lshl_or_b32 v24, v25, 16, v24
    v_cvt_pk_bf16_f32 v43, v43, v43
    v_lshlrev_b32 v43, 16, v43
    v_mul_f32 v43, 0x4038aa3b, v43
    s_waitcnt vmcnt(15)
    v_lshl_or_b32 v10, v131, 16, v10
    v_readfirstlane_b32 s55, v43
    v_add_f32 v43, v43, v43
    s_waitcnt vmcnt(13)
    v_lshl_or_b32 v11, v1, 16, v11
    v_readfirstlane_b32 s52, v43
    v_cmp_gt_u32 vcc, 16, v8
    v_mov_b32 v25, 0
    v_mov_b32 v26, 0
    v_cndmask_b32 v27, 0, v24, vcc
    v_cndmask_b32 v24, 0, v24, vcc
    v_mov_b32 v43, 0
    v_mfma_f32_16x16x16_bf16 v[4:7], v[26:27], v[40:41], 0
    s_mov_b32 s58, 0
    v_mul_u32_u24 v1, 5120, v152
    v_add_u32 v1, v0, v1
    v_mfma_f32_16x16x16_bf16 v[20:23], v[24:25], v[40:41], 0
    s_mov_b32 s59, 0
    v_mov_b32 v31, 0xc138aa3b
    v_mul_u32_u24 v0, 5120, v134
    v_mfma_f32_16x16x16_bf16 v[36:39], v[24:25], v[42:43], 0
    s_mov_b32 s60, 0
    v_max_f32 v4, 0, v4
    v_max_f32 v5, 0, v5
    v_max_f32 v6, 0, v6
    v_max_f32 v20, 0, v20
    v_max_f32 v21, 0, v21
    v_max_f32 v22, 0, v22
    v_max_f32 v23, 0, v23
    v_cvt_pk_bf16_f32 v20, v20, v21
    v_cvt_pk_bf16_f32 v21, v22, v23
    v_max_f32 v7, 0, v7
    v_cvt_pk_bf16_f32 v4, v4, v5
    v_mfma_f32_16x16x16_bf16 v[24:27], v[10:11], v[20:21], 0
    s_mov_b32 s65, -1
    v_cvt_pk_bf16_f32 v5, v6, v7
    v_max_f32 v36, 0, v36
    v_max_f32 v37, 0, v37
    v_mfma_f32_16x16x16_bf16 v[20:23], v[10:11], v[4:5], 0
    s_mov_b32 s61, 1
    v_max_f32 v38, 0, v38
    v_max_f32 v39, 0, v39
    v_cvt_pk_bf16_f32 v36, v36, v37
    v_cvt_pk_bf16_f32 v37, v38, v39
    v_cvt_pk_bf16_f32 v24, v24, v24
    v_lshlrev_b32 v24, 16, v24
    v_mfma_f32_16x16x16_bf16 v[4:7], v[10:11], v[36:37], 0
    s_movk_i32 s4, 336
    v_mul_f32 v24, 0xbfb8aa3b, v24
    v_cvt_pk_bf16_f32 v20, v20, v20
    v_exp_f32 v24, v24
    v_lshlrev_b32 v20, 16, v20
    v_add_f32 v24, 1.0, v24
    v_rcp_f32 v24, v24
    v_mul_f32 v20, 0xbfb8aa3b, v20
    v_cvt_pk_bf16_f32 v24, v24, v24
    v_lshlrev_b32 v24, 16, v24
    v_fma_f32 v24, v24, s84, v31
    s_mov_b32 s5, 0
    s_mov_b32 s6, 0
    ds_write_b32 v1, v24 offset:44032
    v_exp_f32 v20, v20
    v_cvt_pk_bf16_f32 v4, v4, v4
    v_add_f32 v20, 1.0, v20
    v_rcp_f32 v20, v20
    v_lshlrev_b32 v4, 16, v4
    v_cvt_pk_bf16_f32 v20, v20, v20
    v_lshlrev_b32 v20, 16, v20
    v_fma_f32 v20, v20, s84, v31
    s_mov_b32 s12, 0
    s_mov_b32 s64, 3
    ds_write_b32 v1, v20 offset:44036
    v_mul_f32 v4, 0xbfb8aa3b, v4
    v_exp_f32 v4, v4
    v_mad_u32_u24 v0, v133, s86, v0
    v_add_f32 v4, 1.0, v4
    v_rcp_f32 v4, v4
    v_and_b32 v28, 7, v30
    v_cvt_pk_bf16_f32 v4, v4, v4
    v_lshlrev_b32 v4, 16, v4
    v_fma_f32 v4, v4, s84, v31
    s_mov_b32 s10, 81924
    s_mov_b32 s11, 0x20000
    ds_write_b32 v1, v4 offset:44040
    v_xor_b32 v31, v28, v152
    v_lshl_add_u32 v111, v31, 4, v0
    v_xor_b32 v1, 64, v111
    v_add_u32 v139, 40960, v111
    v_xor_b32 v138, 64, v139
    v_add_u32 v0, 61440, v0
    v_add_u32 v31, s93, v152
    v_xor_b32 v31, v28, v31
    v_lshl_add_u32 v137, v31, 4, v0
    v_lshrrev_b32 v31, 1, v152
    v_add3_u32 v31, v31, s93, 4
    v_xor_b32 v31, v28, v31
    v_lshl_add_u32 v31, v31, 4, v0
    v_and_b32 v0, 1, v152
    v_lshl_add_u32 v136, v0, 3, v31
    v_lshlrev_b32 v0, 4, v8
    s_add_u32 s93, s54, 20480
    v_add_u32 v135, s93, v0
    v_add_u32 v131, 81920, v0
    s_lshr_b32 s93, s68, 1
    s_lshl_b32 s93, s93, 10
    s_add_u32 s93, s93, s94
    v_add_u32 v132, s93, v131
    s_mul_i32 s93, s68, 5376
    s_add_u32 s93, s93, 142336
    v_mul_u32_u24 v0, 80, v152
    v_add_u32 v31, s93, v0
    v_mul_u32_u24 v0, 336, v30
    v_add_u32 v28, v0, v31
    v_subrev_u32 v28, 21504, v28
    v_cmp_eq_u32 vcc, 0, v134
    v_mul_u32_u24 v0, 80, v134
    v_lshl_add_u32 v0, v152, 3, v0
    s_waitcnt lgkmcnt(0)
    s_barrier
    v_cndmask_b32 v134, v29, v31, vcc
    v_cmp_eq_u32 vcc, 3, v133
    v_lshl_add_u32 v0, v133, 1, v0
    v_add_u32 v0, s93, v0
    s_add_u32 s93, s69, 1
    s_mul_i32 s94, s93, 58255
    buffer_load_dwordx4 v34, s[32:35], s92 offen offset:2048 lds
    s_add_u32 m0, s90, 24576
    s_mov_b32 s92, 73728
    ds_read_b32 v209, v187
    v_cndmask_b32 v134, v134, v31, vcc
    v_cmp_gt_u32 vcc, 3, v152
    v_mov_b32 v125, 0
    s_lshr_b32 s94, s94, 22
    v_cndmask_b32 v133, v29, v0, vcc
    s_mul_i32 s94, s94, s63
    s_mul_i32 s56, s93, s62
    s_add_u32 s56, s56, s94
    s_and_b32 s94, s68, 1
    s_mul_i32 s94, s94, -2304
    ds_read_b32 v210, v175
    v_mov_b32 v124, 0
    s_sub_u32 s93, s71, 1
    s_cmp_eq_u32 s68, 0
    s_cselect_b32 s13, s93, -1
    s_cmp_gt_u32 s73, 20
    s_cselect_b32 s13, s13, -1
    s_and_b32 s93, s2, -8
    buffer_load_dwordx4 v141, s[32:35], s92 offen offset:0 lds
    s_sub_u32 s93, 81920, s93
    s_sub_u32 s8, s38, s93
    s_subb_u32 s9, s39, 0
    s_lshr_b32 s93, s68, 1
    s_mul_i32 s93, s93, 30720
    s_add_u32 s93, s93, s94
    ds_write_b128 v28, v[216:219] offset:21584
    buffer_load_dwordx4 v57, s[32:35], s92 offen offset:1024 lds
    v_add_u32 v11, s93, v90
    v_add_u32 v10, s93, v3
    s_lshr_b32 s93, s68, 1
    s_mul_i32 s93, s93, 5120
    s_lshl_b32 s94, s97, 4
    s_add_u32 s93, s93, s94
    v_add_u32 v0, s93, v2
    v_cmp_eq_u32 vcc, 0, v30
    s_mov_b32 s39, 0x00010001
    v_sub_u32 v192, v187, v211
    v_cndmask_b32 v0, v29, v0, vcc
    ds_read_b32 v192, v192 offset:336
    v_sub_u32 v193, v187, v208
    v_sub_u32 v194, v187, v151
    v_sub_u32 v195, v187, v142
    v_sub_u32 v188, v187, v150
    v_sub_u32 v189, v187, v60
    ds_read_b32 v193, v193 offset:336
    v_sub_u32 v190, v187, v140
    buffer_load_dwordx4 v34, s[32:35], s92 offen offset:2048 lds
    s_add_u32 m0, s90, 36864
    s_mov_b32 s92, 110592
    ds_read_b32 v194, v194 offset:336
    v_sub_u32 v191, v187, v61
    v_sub_u32 v184, v187, v17
    v_sub_u32 v185, v187, v16
    v_sub_u32 v186, v187, v14
    v_sub_u32 v187, v187, v15
    s_waitcnt vmcnt(9)
    s_barrier
    ds_read_b32 v195, v195 offset:336
    v_sub_u32 v180, v175, v211
    v_sub_u32 v181, v175, v208
    v_sub_u32 v182, v175, v151
    v_sub_u32 v183, v175, v142
    v_sub_u32 v176, v175, v150
    ds_read_b32 v188, v188 offset:336
    v_sub_u32 v177, v175, v60
    v_sub_u32 v178, v175, v140
    v_sub_u32 v179, v175, v61
    v_sub_u32 v172, v175, v17
    v_sub_u32 v173, v175, v16
    ds_read_b32 v189, v189 offset:336
    v_sub_u32 v174, v175, v14
    v_sub_u32 v175, v175, v15
    buffer_load_dwordx4 v141, s[32:35], s92 offen offset:0 lds
    ds_read_b32 v190, v190 offset:336
    v_sub_u32 v204, v149, v211
    v_sub_u32 v205, v149, v208
    v_sub_u32 v206, v149, v151
    v_sub_u32 v207, v149, v142
    v_sub_u32 v200, v149, v150
    ds_read_b32 v191, v191 offset:336
    v_sub_u32 v201, v149, v60
    v_sub_u32 v202, v149, v140
    v_sub_u32 v203, v149, v61
    v_sub_u32 v196, v149, v17
    v_sub_u32 v197, v149, v16
    ds_read_b32 v184, v184 offset:336
    buffer_load_dwordx4 v57, s[32:35], s92 offen offset:1024 lds
    v_sub_u32 v198, v149, v14
    v_sub_u32 v199, v149, v15
    ds_read_b32 v185, v185 offset:336
    ds_read_b32 v186, v186 offset:336
    ds_read_b32 v187, v187 offset:336
    buffer_load_dwordx4 v34, s[32:35], s92 offen offset:2048 lds
    s_add_u32 m0, s90, 49152
    s_mov_b32 s92, 147456
    s_waitcnt vmcnt(9)
    ds_read_b64_tr_b16 a[0:1], v12 offset:0
    ds_read_b64_tr_b16 a[2:3], v12 offset:768
    ds_read_b64_tr_b16 a[24:25], v12 offset:32
    ds_read_b64_tr_b16 a[26:27], v12 offset:800
    ds_read_b64_tr_b16 a[48:49], v12 offset:64
    ds_read_b64_tr_b16 a[50:51], v12 offset:832
    ds_read_b128 v[36:39], v111 offset:40960
    ds_read_b128 v[24:27], v111 offset:42496
    buffer_load_dwordx4 v141, s[32:35], s92 offen offset:0 lds
    ds_read_b128 v[40:43], v111 offset:0
    ds_read_b128 v[4:7], v111 offset:1536
    ds_read_b128 v[116:119], v111 offset:3072
    ds_read_b32 v180, v180 offset:336
    buffer_load_dwordx4 v57, s[32:35], s92 offen offset:1024 lds
    ds_read_b32 v181, v181 offset:336
    ds_read_b32 v182, v182 offset:336
    s_waitcnt lgkmcnt(7)
    v_mfma_f32_16x16x32_bf16 v[72:75], a[0:3], v[36:39], 0
    ds_read_b128 v[144:147], v1 offset:41088
    v_mfma_f32_16x16x32_bf16 v[52:55], a[24:27], v[36:39], 0
    ds_read_b128 v[120:123], v1 offset:42624
    v_mfma_f32_16x16x32_bf16 v[20:23], a[48:51], v[36:39], 0
    s_waitcnt vmcnt(8) lgkmcnt(6)
    buffer_load_dwordx4 v34, s[32:35], s92 offen offset:2048 lds
    ds_read_b64_tr_b16 a[4:5], v12 offset:12288
    v_mfma_f32_16x16x32_bf16 v[68:71], a[0:3], v[24:27], 0
    s_add_u32 m0, s90, 61440
    ds_read_b64_tr_b16 a[6:7], v12 offset:13056
    v_mfma_f32_16x16x32_bf16 v[64:67], a[24:27], v[24:27], 0
    s_mov_b32 s92, 184320
    ds_read_b64_tr_b16 a[28:29], v12 offset:12320
    v_mfma_f32_16x16x32_bf16 v[44:47], a[48:51], v[24:27], 0
    ds_read_b64_tr_b16 a[30:31], v12 offset:13088
    v_mfma_f32_16x16x32_bf16 v[36:39], a[0:3], v[40:43], 0
    ds_read_b64_tr_b16 a[52:53], v12 offset:12352
    v_mfma_f32_16x16x32_bf16 v[24:27], a[24:27], v[40:43], 0
    buffer_load_dwordx4 v141, s[32:35], s92 offen offset:0 lds
    ds_read_b64_tr_b16 a[54:55], v12 offset:13120
    v_mfma_f32_16x16x32_bf16 v[84:87], a[48:51], v[40:43], 0
    ds_read_b128 v[92:95], v1 offset:128
    v_mfma_f32_16x16x32_bf16 v[96:99], a[0:3], v[4:7], 0
    ds_read_b128 v[100:103], v1 offset:1664
    v_mfma_f32_16x16x32_bf16 v[236:239], a[24:27], v[4:7], 0
    ds_read_b128 v[40:43], v1 offset:3200
    v_mfma_f32_16x16x32_bf16 v[104:107], a[48:51], v[4:7], 0
    s_waitcnt lgkmcnt(8)
    ds_read_b128 v[48:51], v1 offset:40960
    v_mfma_f32_16x16x32_bf16 v[80:83], a[0:3], v[116:119], 0
    buffer_load_dwordx4 v57, s[32:35], s92 offen offset:1024 lds
    ds_read_b128 v[156:159], v1 offset:42496
    v_mfma_f32_16x16x32_bf16 v[4:7], a[24:27], v[116:119], 0
    ds_read_b128 v[164:167], v1 offset:0
    v_mfma_f32_16x16x32_bf16 v[76:79], a[48:51], v[116:119], 0
    ds_read_b128 v[160:163], v1 offset:1536
    ds_read_b128 v[116:119], v1 offset:3072
    ds_read_b32 v183, v183 offset:336
    buffer_load_dwordx4 v34, s[32:35], s92 offen offset:2048 lds
    s_add_u32 m0, s90, 0
    s_mov_b32 s92, 384
    s_waitcnt vmcnt(9)
    ds_read_b64_tr_b16 a[8:9], v12 offset:24576
    ds_read_b64_tr_b16 a[10:11], v12 offset:25344
    ds_read_b64_tr_b16 a[32:33], v12 offset:24608
    ds_read_b64_tr_b16 a[34:35], v12 offset:25376
    s_waitcnt lgkmcnt(9)
    v_mfma_f32_16x16x32_bf16 v[72:75], a[4:7], v[48:51], v[72:75]
    ds_read_b64_tr_b16 a[56:57], v12 offset:24640
    v_mfma_f32_16x16x32_bf16 v[52:55], a[28:31], v[48:51], v[52:55]
    ds_read_b64_tr_b16 a[58:59], v12 offset:25408
    v_mfma_f32_16x16x32_bf16 v[20:23], a[52:55], v[48:51], v[20:23]
    s_waitcnt lgkmcnt(9)
    buffer_load_dwordx4 v141, s[32:35], s92 offen offset:0 lds
    ds_read_b128 v[48:51], v111 offset:41088
    v_mfma_f32_16x16x32_bf16 v[68:71], a[4:7], v[156:159], v[68:71]
    ds_read_b32 v176, v176 offset:336
    v_mfma_f32_16x16x32_bf16 v[64:67], a[28:31], v[156:159], v[64:67]
    v_mfma_f32_16x16x32_bf16 v[44:47], a[52:55], v[156:159], v[44:47]
    ds_read_b32 v177, v177 offset:336
    v_mfma_f32_16x16x32_bf16 v[36:39], a[4:7], v[164:167], v[36:39]
    v_mfma_f32_16x16x32_bf16 v[24:27], a[28:31], v[164:167], v[24:27]
    buffer_load_dwordx4 v57, s[32:35], s92 offen offset:1024 lds
    ds_read_b128 v[156:159], v111 offset:42624
    v_mfma_f32_16x16x32_bf16 v[84:87], a[52:55], v[164:167], v[84:87]
    s_waitcnt lgkmcnt(6)
    ds_read_b32 v178, v178 offset:336
    v_mfma_f32_16x16x32_bf16 v[96:99], a[4:7], v[160:163], v[96:99]
    v_mfma_f32_16x16x32_bf16 v[236:239], a[28:31], v[160:163], v[236:239]
    ds_read_b32 v179, v179 offset:336
    v_mfma_f32_16x16x32_bf16 v[104:107], a[52:55], v[160:163], v[104:107]
    v_mfma_f32_16x16x32_bf16 v[80:83], a[4:7], v[116:119], v[80:83]
    s_waitcnt vmcnt(8)
    buffer_load_dwordx4 v34, s[32:35], s92 offen offset:2048 lds
    ds_read_b64_tr_b16 a[12:13], v12 offset:36864
    v_mfma_f32_16x16x32_bf16 v[4:7], a[28:31], v[116:119], v[4:7]
    s_add_u32 m0, s90, 12288
    ds_read_b64_tr_b16 a[14:15], v12 offset:37632
    v_mfma_f32_16x16x32_bf16 v[76:79], a[52:55], v[116:119], v[76:79]
    s_waitcnt lgkmcnt(5)
    s_mov_b32 s92, 37248
    ds_read_b64_tr_b16 a[36:37], v12 offset:36896
    v_mfma_f32_16x16x32_bf16 v[72:75], a[8:11], v[48:51], v[72:75]
    ds_read_b64_tr_b16 a[38:39], v12 offset:37664
    v_mfma_f32_16x16x32_bf16 v[52:55], a[32:35], v[48:51], v[52:55]
    ds_read_b64_tr_b16 a[60:61], v12 offset:36928
    v_mfma_f32_16x16x32_bf16 v[20:23], a[56:59], v[48:51], v[20:23]
    s_waitcnt lgkmcnt(6)
    buffer_load_dwordx4 v141, s[32:35], s92 offen offset:0 lds
    ds_read_b64_tr_b16 a[62:63], v12 offset:37696
    v_mfma_f32_16x16x32_bf16 v[68:71], a[8:11], v[156:159], v[68:71]
    ds_read_b128 v[116:119], v111 offset:128
    v_mfma_f32_16x16x32_bf16 v[64:67], a[32:35], v[156:159], v[64:67]
    ds_read_b128 v[48:51], v111 offset:1664
    v_mfma_f32_16x16x32_bf16 v[44:47], a[56:59], v[156:159], v[44:47]
    s_waitcnt lgkmcnt(6)
    ds_read_b32 v172, v172 offset:336
    ds_read_b32 v173, v173 offset:336
    v_mfma_f32_16x16x32_bf16 v[72:75], a[12:15], v[144:147], v[72:75]
    buffer_load_dwordx4 v57, s[32:35], s92 offen offset:1024 lds
    v_mfma_f32_16x16x32_bf16 v[68:71], a[12:15], v[120:123], v[68:71]
    s_waitcnt lgkmcnt(6)
    ds_read_b32 v174, v174 offset:336
    v_mfma_f32_16x16x32_bf16 v[52:55], a[36:39], v[144:147], v[52:55]
    v_mfma_f32_16x16x32_bf16 v[64:67], a[36:39], v[120:123], v[64:67]
    s_waitcnt lgkmcnt(5)
    ds_read_b128 v[160:163], v111 offset:3200
    v_mfma_f32_16x16x32_bf16 v[20:23], a[60:63], v[144:147], v[20:23]
    ds_read_b32 v175, v175 offset:336
    buffer_load_dwordx4 v34, s[32:35], s92 offen offset:2048 lds
    v_mfma_f32_16x16x32_bf16 v[44:47], a[60:63], v[120:123], v[44:47]
    s_waitcnt lgkmcnt(5)
    s_add_u32 m0, s90, 24576
    v_mfma_f32_16x16x32_bf16 v[36:39], a[8:11], v[116:119], v[36:39]
    s_waitcnt vmcnt(9)
    s_mov_b32 s92, 74112
    ds_read_b64_tr_b16 a[16:17], v12 offset:49152
    v_mfma_f32_16x16x32_bf16 v[36:39], a[12:15], v[92:95], v[36:39]
    ds_read_b64_tr_b16 a[18:19], v12 offset:49920
    v_mfma_f32_16x16x32_bf16 v[24:27], a[32:35], v[116:119], v[24:27]
    ds_read_b64_tr_b16 a[40:41], v12 offset:49184
    v_mfma_f32_16x16x32_bf16 v[24:27], a[36:39], v[92:95], v[24:27]
    ds_read_b64_tr_b16 a[42:43], v12 offset:49952
    buffer_load_dwordx4 v141, s[32:35], s92 offen offset:0 lds
    v_mfma_f32_16x16x32_bf16 v[84:87], a[56:59], v[116:119], v[84:87]
    ds_read_b64_tr_b16 a[64:65], v12 offset:49216
    v_mfma_f32_16x16x32_bf16 v[84:87], a[60:63], v[92:95], v[84:87]
    ds_read_b64_tr_b16 a[66:67], v12 offset:49984
    v_mfma_f32_16x16x32_bf16 v[96:99], a[8:11], v[48:51], v[96:99]
    ds_read_b128 v[156:159], v1 offset:41216
    v_mfma_f32_16x16x32_bf16 v[96:99], a[12:15], v[100:103], v[96:99]
    ds_read_b128 v[120:123], v1 offset:42752
    v_mfma_f32_16x16x32_bf16 v[236:239], a[32:35], v[48:51], v[236:239]
    ds_read_b128 v[116:119], v1 offset:256
    buffer_load_dwordx4 v57, s[32:35], s92 offen offset:1024 lds
    v_mfma_f32_16x16x32_bf16 v[236:239], a[36:39], v[100:103], v[236:239]
    ds_read_b128 v[92:95], v1 offset:1792
    v_mfma_f32_16x16x32_bf16 v[104:107], a[56:59], v[48:51], v[104:107]
    ds_read_b128 v[48:51], v1 offset:3328
    v_mfma_f32_16x16x32_bf16 v[104:107], a[60:63], v[100:103], v[104:107]
    s_waitcnt lgkmcnt(8)
    ds_read_b128 v[100:103], v111 offset:41216
    v_mfma_f32_16x16x32_bf16 v[80:83], a[8:11], v[160:163], v[80:83]
    ds_read_b128 v[144:147], v111 offset:42752
    v_mov_b32 v35, 0
    v_mfma_f32_16x16x32_bf16 v[80:83], a[12:15], v[40:43], v[80:83]
    ds_read_b32 v204, v204 offset:336
    buffer_load_dwordx4 v34, s[32:35], s92 offen offset:2048 lds
    v_mfma_f32_16x16x32_bf16 v[4:7], a[32:35], v[160:163], v[4:7]
    s_add_u32 m0, s90, 36864
    v_mfma_f32_16x16x32_bf16 v[4:7], a[36:39], v[40:43], v[4:7]
    s_waitcnt vmcnt(9)
    s_mov_b32 s92, 110976
    ds_read_b64_tr_b16 a[20:21], v12 offset:61440
    v_mfma_f32_16x16x32_bf16 v[76:79], a[56:59], v[160:163], v[76:79]
    ds_read_b64_tr_b16 a[22:23], v12 offset:62208
    v_mfma_f32_16x16x32_bf16 v[76:79], a[60:63], v[40:43], v[76:79]
    ds_read_b64_tr_b16 a[44:45], v12 offset:61472
    ds_read_b64_tr_b16 a[46:47], v12 offset:62240
    ds_read_b64_tr_b16 a[68:69], v12 offset:61504
    buffer_load_dwordx4 v141, s[32:35], s92 offen offset:0 lds
    ds_read_b64_tr_b16 a[70:71], v12 offset:62272
    ds_read_b128 v[40:43], v111 offset:256
    s_waitcnt lgkmcnt(9)
    v_mfma_f32_16x16x32_bf16 v[72:75], a[16:19], v[100:103], v[72:75]
    ds_read_b32 v205, v205 offset:336
    v_mfma_f32_16x16x32_bf16 v[52:55], a[40:43], v[100:103], v[52:55]
    v_mfma_f32_16x16x32_bf16 v[20:23], a[64:67], v[100:103], v[20:23]
    s_waitcnt lgkmcnt(8)
    ds_read_b32 v206, v206 offset:336
    v_mfma_f32_16x16x32_bf16 v[68:71], a[16:19], v[144:147], v[68:71]
    buffer_load_dwordx4 v57, s[32:35], s92 offen offset:1024 lds
    v_mfma_f32_16x16x32_bf16 v[64:67], a[40:43], v[144:147], v[64:67]
    s_waitcnt lgkmcnt(7)
    ds_read_b128 v[100:103], v111 offset:1792
    v_mfma_f32_16x16x32_bf16 v[72:75], a[20:23], v[156:159], v[72:75]
    ds_read_b32 v207, v207 offset:336
    v_mfma_f32_16x16x32_bf16 v[68:71], a[20:23], v[120:123], v[68:71]
    s_waitcnt lgkmcnt(6)
    s_nop 0
    v_mfma_f32_16x16x32_bf16 v[52:55], a[44:47], v[156:159], v[52:55]
    s_waitcnt lgkmcnt(4)
    s_nop 0
    ds_read_b32 v200, v200 offset:336
    v_cvt_pk_f16_f32 v72, v72, v73
    v_mfma_f32_16x16x32_bf16 v[20:23], a[68:71], v[156:159], v[20:23]
    buffer_load_dwordx4 v34, s[32:35], s92 offen offset:2048 lds
    v_cvt_pk_f16_f32 v73, v74, v75
    v_mfma_f32_16x16x32_bf16 v[64:67], a[44:47], v[120:123], v[64:67]
    s_waitcnt vmcnt(9)
    s_add_u32 m0, s90, 49152
    ds_read_b64_tr_b16 a[72:73], v12 offset:0
    v_pk_fma_f16 v140, v72, v72, s39
    v_mfma_f32_16x16x32_bf16 v[44:47], a[64:67], v[144:147], v[44:47]
    s_mov_b32 s92, 147840
    ds_read_b64_tr_b16 a[74:75], v12 offset:768
    v_pk_fmac_f16 v140, v73, v73
    v_mfma_f32_16x16x32_bf16 v[44:47], a[68:71], v[120:123], v[44:47]
    ds_read_b64_tr_b16 a[96:97], v12 offset:32
    v_cvt_pk_f16_f32 v74, v52, v53
    v_mfma_f32_16x16x32_bf16 v[36:39], a[16:19], v[40:43], v[36:39]
    ds_read_b64_tr_b16 a[98:99], v12 offset:800
    v_cvt_pk_f16_f32 v75, v54, v55
    v_mfma_f32_16x16x32_bf16 v[36:39], a[20:23], v[116:119], v[36:39]
    buffer_load_dwordx4 v141, s[32:35], s92 offen offset:0 lds
    ds_read_b64_tr_b16 a[120:121], v12 offset:64
    v_mfma_f32_16x16x32_bf16 v[24:27], a[40:43], v[40:43], v[24:27]
    ds_read_b64_tr_b16 a[122:123], v12 offset:832
    v_pk_fmac_f16 v140, v74, v74
    v_mfma_f32_16x16x32_bf16 v[24:27], a[44:47], v[116:119], v[24:27]
    ds_read_b128 v[52:55], v111 offset:3328
    v_pk_fmac_f16 v140, v75, v75
    v_mfma_f32_16x16x32_bf16 v[84:87], a[64:67], v[40:43], v[84:87]
    ds_read_b128 v[40:43], v111 offset:40960
    v_cvt_pk_f16_f32 v32, v20, v21
    v_mfma_f32_16x16x32_bf16 v[84:87], a[68:71], v[116:119], v[84:87]
    s_waitcnt lgkmcnt(8)
    ds_read_b32 v201, v201 offset:336
    v_cvt_pk_f16_f32 v33, v22, v23
    v_mfma_f32_16x16x32_bf16 v[96:99], a[16:19], v[100:103], v[96:99]
    buffer_load_dwordx4 v57, s[32:35], s92 offen offset:1024 lds
    v_pk_fmac_f16 v140, v32, v32
    v_mfma_f32_16x16x32_bf16 v[96:99], a[20:23], v[92:95], v[96:99]
    ds_read_b128 v[20:23], v111 offset:42496
    v_pk_fmac_f16 v140, v33, v33
    v_mfma_f32_16x16x32_bf16 v[236:239], a[40:43], v[100:103], v[236:239]
    ds_read_b32 v202, v202 offset:336
    v_cvt_pk_f16_f32 v68, v68, v69
    v_mfma_f32_16x16x32_bf16 v[236:239], a[44:47], v[92:95], v[236:239]
    v_cvt_pk_f16_f32 v69, v70, v71
    v_pk_fma_f16 v142, v68, v68, s39
    v_mfma_f32_16x16x32_bf16 v[104:107], a[64:67], v[100:103], v[104:107]
    ds_read_b128 v[144:147], v111 offset:0
    v_pk_fmac_f16 v142, v69, v69
    v_mfma_f32_16x16x32_bf16 v[104:107], a[68:71], v[92:95], v[104:107]
    s_waitcnt vmcnt(8) lgkmcnt(5)
    buffer_load_dwordx4 v34, s[32:35], s92 offen offset:2048 lds
    ds_read_b64_tr_b16 a[76:77], v12 offset:12288
    v_cvt_pk_f16_f32 v70, v64, v65
    v_mfma_f32_16x16x32_bf16 v[80:83], a[16:19], v[52:55], v[80:83]
    s_add_u32 m0, s90, 61440
    ds_read_b64_tr_b16 a[78:79], v12 offset:13056
    v_cvt_pk_f16_f32 v71, v66, v67
    v_mfma_f32_16x16x32_bf16 v[80:83], a[20:23], v[48:51], v[80:83]
    s_mov_b32 s92, 184704
    ds_read_b64_tr_b16 a[100:101], v12 offset:12320
    v_pk_fmac_f16 v142, v70, v70
    v_mfma_f32_16x16x32_bf16 v[4:7], a[40:43], v[52:55], v[4:7]
    ds_read_b64_tr_b16 a[102:103], v12 offset:13088
    v_pk_fmac_f16 v142, v71, v71
    v_mfma_f32_16x16x32_bf16 v[4:7], a[44:47], v[48:51], v[4:7]
    ds_read_b64_tr_b16 a[124:125], v12 offset:12352
    v_cvt_pk_f16_f32 v60, v44, v45
    v_mfma_f32_16x16x32_bf16 v[76:79], a[64:67], v[52:55], v[76:79]
    buffer_load_dwordx4 v141, s[32:35], s92 offen offset:0 lds
    ds_read_b64_tr_b16 a[126:127], v12 offset:13120
    v_mfma_f32_16x16x32_bf16 v[76:79], a[68:71], v[48:51], v[76:79]
    s_waitcnt lgkmcnt(7)
    ds_read_b128 v[48:51], v111 offset:1536
    v_cvt_pk_f16_f32 v61, v46, v47
    v_mfma_f32_16x16x32_bf16 v[44:47], a[72:75], v[40:43], 0
    ds_read_b128 v[228:231], v111 offset:3072
    v_pk_fmac_f16 v142, v60, v60
    v_mfma_f32_16x16x32_bf16 v[160:163], a[96:99], v[40:43], 0
    ds_read_b128 v[64:67], v1 offset:40960
    v_pk_fmac_f16 v142, v61, v61
    v_mfma_f32_16x16x32_bf16 v[156:159], a[120:123], v[40:43], 0
    ds_read_b32 v203, v203 offset:336
    v_cvt_pk_f16_f32 v120, v36, v37
    v_mfma_f32_16x16x32_bf16 v[52:55], a[72:75], v[20:23], 0
    buffer_load_dwordx4 v57, s[32:35], s92 offen offset:1024 lds
    v_cvt_pk_f16_f32 v121, v38, v39
    v_mfma_f32_16x16x32_bf16 v[232:235], a[96:99], v[20:23], 0
    ds_read_b128 v[100:103], v1 offset:42496
    v_pk_fma_f16 v36, v120, v120, s39
    v_mfma_f32_16x16x32_bf16 v[40:43], a[120:123], v[20:23], 0
    s_waitcnt lgkmcnt(7)
    ds_read_b32 v196, v196 offset:336
    v_pk_fmac_f16 v36, v121, v121
    v_mfma_f32_16x16x32_bf16 v[20:23], a[72:75], v[144:147], 0
    v_cvt_pk_f16_f32 v122, v24, v25
    v_cvt_pk_f16_f32 v123, v26, v27
    v_mfma_f32_16x16x32_bf16 v[92:95], a[96:99], v[144:147], 0
    ds_read_b128 v[116:119], v1 offset:0
    v_pk_fmac_f16 v36, v122, v122
    v_mfma_f32_16x16x32_bf16 v[24:27], a[120:123], v[144:147], 0
    s_waitcnt vmcnt(8) lgkmcnt(6)
    buffer_load_dwordx4 v34, s[32:35], s92 offen offset:2048 lds
    ds_read_b64_tr_b16 a[80:81], v12 offset:24576
    v_mfma_f32_16x16x32_bf16 v[224:227], a[72:75], v[48:51], 0
    s_waitcnt lgkmcnt(5)
    s_add_u32 m0, s90, 0
    ds_read_b64_tr_b16 a[82:83], v12 offset:25344
    v_pk_fmac_f16 v36, v123, v123
    v_cvt_pk_f16_f32 v154, v84, v85
    v_mfma_f32_16x16x32_bf16 v[44:47], a[76:79], v[64:67], v[44:47]
    s_mov_b32 s92, 768
    ds_read_b64_tr_b16 a[104:105], v12 offset:24608
    v_cvt_pk_f16_f32 v155, v86, v87
    v_mfma_f32_16x16x32_bf16 v[160:163], a[100:103], v[64:67], v[160:163]
    ds_read_b64_tr_b16 a[106:107], v12 offset:25376
    v_pk_fmac_f16 v36, v154, v154
    v_mfma_f32_16x16x32_bf16 v[156:159], a[124:127], v[64:67], v[156:159]
    ds_read_b64_tr_b16 a[128:129], v12 offset:24640
    v_pk_fmac_f16 v36, v155, v155
    v_mfma_f32_16x16x32_bf16 v[168:171], a[96:99], v[48:51], 0
    buffer_load_dwordx4 v141, s[32:35], s92 offen offset:0 lds
    ds_read_b64_tr_b16 a[130:131], v12 offset:25408
    v_mfma_f32_16x16x32_bf16 v[164:167], a[120:123], v[48:51], 0
    ds_read_b128 v[64:67], v1 offset:1536
    v_cvt_pk_f16_f32 v96, v96, v97
    v_mfma_f32_16x16x32_bf16 v[84:87], a[72:75], v[228:231], 0
    s_waitcnt lgkmcnt(7)
    ds_read_b128 v[48:51], v1 offset:3072
    v_cvt_pk_f16_f32 v97, v98, v99
    v_mfma_f32_16x16x32_bf16 v[52:55], a[76:79], v[100:103], v[52:55]
    ds_read_b128 v[144:147], v111 offset:41088
    v_pk_fma_f16 v38, v96, v96, s39
    v_mfma_f32_16x16x32_bf16 v[232:235], a[100:103], v[100:103], v[232:235]
    ds_read_b32 v197, v197 offset:336
    v_pk_fmac_f16 v38, v97, v97
    v_mfma_f32_16x16x32_bf16 v[40:43], a[124:127], v[100:103], v[40:43]
    buffer_load_dwordx4 v57, s[32:35], s92 offen offset:1024 lds
    v_cvt_pk_f16_f32 v98, v236, v237
    v_mfma_f32_16x16x32_bf16 v[20:23], a[76:79], v[116:119], v[20:23]
    ds_read_b128 v[100:103], v111 offset:42624
    v_cvt_pk_f16_f32 v99, v238, v239
    v_mfma_f32_16x16x32_bf16 v[92:95], a[100:103], v[116:119], v[92:95]
    ds_read_b32 v198, v198 offset:336
    v_pk_fmac_f16 v38, v98, v98
    v_mfma_f32_16x16x32_bf16 v[24:27], a[124:127], v[116:119], v[24:27]
    v_pk_fmac_f16 v38, v99, v99
    v_cvt_pk_f16_f32 v150, v104, v105
    v_cvt_pk_f16_f32 v151, v106, v107
    v_pk_fmac_f16 v38, v150, v150
    v_pk_fmac_f16 v38, v151, v151
    v_mfma_f32_16x16x32_bf16 v[116:119], a[96:99], v[228:231], 0
    s_waitcnt vmcnt(8)
    buffer_load_dwordx4 v34, s[32:35], s92 offen offset:2048 lds
    ds_read_b64_tr_b16 a[84:85], v12 offset:36864
    v_mfma_f32_16x16x32_bf16 v[104:107], a[120:123], v[228:231], 0
    s_waitcnt lgkmcnt(5)
    s_add_u32 m0, s90, 12288
    ds_read_b64_tr_b16 a[86:87], v12 offset:37632
    v_cvt_pk_f16_f32 v14, v80, v81
    v_mfma_f32_16x16x32_bf16 v[224:227], a[76:79], v[64:67], v[224:227]
    s_mov_b32 s92, 37632
    ds_read_b64_tr_b16 a[108:109], v12 offset:36896
    v_cvt_pk_f16_f32 v15, v82, v83
    v_mfma_f32_16x16x32_bf16 v[168:171], a[100:103], v[64:67], v[168:171]
    ds_read_b64_tr_b16 a[110:111], v12 offset:37664
    v_pk_fma_f16 v56, v14, v14, s39
    v_mfma_f32_16x16x32_bf16 v[164:167], a[124:127], v[64:67], v[164:167]
    ds_read_b64_tr_b16 a[132:133], v12 offset:36928
    v_pk_fmac_f16 v56, v15, v15
    v_mfma_f32_16x16x32_bf16 v[84:87], a[76:79], v[48:51], v[84:87]
    buffer_load_dwordx4 v141, s[32:35], s92 offen offset:0 lds
    ds_read_b64_tr_b16 a[134:135], v12 offset:37696
    v_mfma_f32_16x16x32_bf16 v[116:119], a[100:103], v[48:51], v[116:119]
    ds_read_b128 v[64:67], v111 offset:128
    v_cvt_pk_f16_f32 v16, v4, v5
    v_mfma_f32_16x16x32_bf16 v[104:107], a[124:127], v[48:51], v[104:107]
    s_waitcnt lgkmcnt(7)
    ds_read_b128 v[48:51], v111 offset:1664
    v_cvt_pk_f16_f32 v17, v6, v7
    v_mfma_f32_16x16x32_bf16 v[44:47], a[80:83], v[144:147], v[44:47]
    ds_read_b128 v[4:7], v111 offset:3200
    v_pk_fmac_f16 v56, v16, v16
    v_mfma_f32_16x16x32_bf16 v[160:163], a[104:107], v[144:147], v[160:163]
    ds_read_b128 v[80:83], v1 offset:41088
    v_pk_fmac_f16 v56, v17, v17
    v_mfma_f32_16x16x32_bf16 v[156:159], a[128:131], v[144:147], v[156:159]
    buffer_load_dwordx4 v57, s[32:35], s92 offen offset:1024 lds
    ds_read_b32 v199, v199 offset:336
    v_mfma_f32_16x16x32_bf16 v[52:55], a[80:83], v[100:103], v[52:55]
    v_cvt_pk_f16_f32 v146, v76, v77
    v_cvt_pk_f16_f32 v147, v78, v79
    v_mfma_f32_16x16x32_bf16 v[232:235], a[104:107], v[100:103], v[232:235]
    ds_read_b128 v[76:79], v1 offset:42624
    v_pk_fmac_f16 v56, v146, v146
    v_mfma_f32_16x16x32_bf16 v[40:43], a[128:131], v[100:103], v[40:43]
    s_waitcnt lgkmcnt(5)
    ds_read_b32 v208, v149
    v_pk_fmac_f16 v56, v147, v147
    ds_read_b32 v211, v143 offset:672
    v_mfma_f32_16x16x32_bf16 v[20:23], a[80:83], v[64:67], v[20:23]
    buffer_load_dwordx4 v34, s[32:35], s92 offen offset:2048 lds
    v_mfma_f32_16x16x32_bf16 v[92:95], a[104:107], v[64:67], v[92:95]
    s_waitcnt vmcnt(9)
    s_add_u32 m0, s90, 24576
    ds_read_b64_tr_b16 a[88:89], v12 offset:49152
    v_mfma_f32_16x16x32_bf16 v[24:27], a[128:131], v[64:67], v[24:27]
    s_waitcnt lgkmcnt(5)
    s_mov_b32 s92, 74496
    ds_read_b64_tr_b16 a[90:91], v12 offset:49920
    v_mfma_f32_16x16x32_bf16 v[224:227], a[80:83], v[48:51], v[224:227]
    ds_read_b64_tr_b16 a[112:113], v12 offset:49184
    v_mfma_f32_16x16x32_bf16 v[168:171], a[104:107], v[48:51], v[168:171]
    ds_read_b64_tr_b16 a[114:115], v12 offset:49952
    v_mfma_f32_16x16x32_bf16 v[164:167], a[128:131], v[48:51], v[164:167]
    buffer_load_dwordx4 v141, s[32:35], s92 offen offset:0 lds
    ds_read_b64_tr_b16 a[136:137], v12 offset:49216
    v_mfma_f32_16x16x32_bf16 v[84:87], a[80:83], v[4:7], v[84:87]
    ds_read_b64_tr_b16 a[138:139], v12 offset:49984
    v_mfma_f32_16x16x32_bf16 v[116:119], a[104:107], v[4:7], v[116:119]
    ds_read_b128 v[64:67], v1 offset:128
    v_mfma_f32_16x16x32_bf16 v[104:107], a[128:131], v[4:7], v[104:107]
    ds_read_b128 v[4:7], v1 offset:1664
    v_mfma_f32_16x16x32_bf16 v[44:47], a[84:87], v[80:83], v[44:47]
    ds_read_b128 v[48:51], v1 offset:3200
    v_mfma_f32_16x16x32_bf16 v[160:163], a[108:111], v[80:83], v[160:163]
    buffer_load_dwordx4 v57, s[32:35], s92 offen offset:1024 lds
    ds_read_b128 v[100:103], v111 offset:41216
    v_mfma_f32_16x16x32_bf16 v[156:159], a[132:135], v[80:83], v[156:159]
    s_waitcnt lgkmcnt(8)
    s_cmp_ge_u32 s2, 247
    s_cbranch_scc1 L_maskF
L_nomaskF:
    v_mfma_f32_16x16x32_bf16 v[52:55], a[84:87], v[76:79], v[52:55]
    ds_read_b128 v[80:83], v111 offset:42752
    v_mfma_f32_16x16x32_bf16 v[232:235], a[108:111], v[76:79], v[232:235]
    v_mfma_f32_16x16x32_bf16 v[40:43], a[132:135], v[76:79], v[40:43]
    s_waitcnt vmcnt(8) lgkmcnt(4)
    buffer_load_dwordx4 v34, s[32:35], s92 offen offset:2048 lds
    ds_read_b64_tr_b16 a[92:93], v12 offset:61440
    s_add_u32 m0, s90, 36864
    s_mov_b32 s92, 111360
    ds_read_b64_tr_b16 a[94:95], v12 offset:62208
    v_mfma_f32_16x16x32_bf16 v[20:23], a[84:87], v[64:67], v[20:23]
    s_mov_b32 s53, s47
    ds_read_b64_tr_b16 a[116:117], v12 offset:61472
    v_readlane_b32 s84, v211, 48
    v_mfma_f32_16x16x32_bf16 v[92:95], a[108:111], v[64:67], v[92:95]
    s_mov_b32 s47, s46
    ds_read_b64_tr_b16 a[118:119], v12 offset:62240
    v_mov_b32 v143, 0xf149f2ca
    v_mfma_f32_16x16x32_bf16 v[24:27], a[132:135], v[64:67], v[24:27]
    s_waitcnt lgkmcnt(6)
    s_mov_b32 s46, s45
    ds_read_b64_tr_b16 a[140:141], v12 offset:61504
    v_cmp_gt_u32 vcc, 16, v8
    v_mfma_f32_16x16x32_bf16 v[224:227], a[84:87], v[4:7], v[224:227]
    s_mov_b32 s45, s44
    ds_read_b64_tr_b16 a[142:143], v12 offset:62272
    buffer_load_dwordx4 v141, s[32:35], s92 offen offset:0 lds
    v_mfma_f32_16x16x32_bf16 v[168:171], a[108:111], v[4:7], v[168:171]
    s_mov_b32 s44, s53
    ds_read_b128 v[76:79], v111 offset:256
    v_cndmask_b32 v208, v143, v208, vcc
    v_mfma_f32_16x16x32_bf16 v[164:167], a[132:135], v[4:7], v[164:167]
    s_sub_u32 s48, s44, s46
    ds_read_b128 v[4:7], v111 offset:1792
    v_cndmask_b32 v209, v143, v209, vcc
    v_mfma_f32_16x16x32_bf16 v[84:87], a[84:87], v[48:51], v[84:87]
    s_sub_u32 s49, s46, s45
    ds_read_b128 v[64:67], v111 offset:3328
    v_cndmask_b32 v210, v143, v210, vcc
    v_mfma_f32_16x16x32_bf16 v[116:119], a[108:111], v[48:51], v[116:119]
    s_sub_u32 s50, s45, s44
    v_cmp_gt_u32 vcc, 49, v8
    v_add_u32 v139, s48, v139
    v_mfma_f32_16x16x32_bf16 v[104:107], a[132:135], v[48:51], v[104:107]
    s_waitcnt lgkmcnt(7)
    s_sub_u32 s51, s46, s47
    v_cndmask_b32 v211, v143, v211, vcc
    v_add_u32 v138, s48, v138
    v_mfma_f32_16x16x32_bf16 v[44:47], a[88:91], v[100:103], v[44:47]
    s_mov_b32 s60, s59
    buffer_load_dwordx4 v57, s[32:35], s92 offen offset:1024 lds
    ds_read_b128 v[48:51], v1 offset:41216
    v_mfma_f32_16x16x32_bf16 v[160:163], a[112:115], v[100:103], v[160:163]
    s_mov_b32 s59, s58
    v_add_u32 v137, s49, v137
    v_add_u32 v136, s49, v136
    v_mfma_f32_16x16x32_bf16 v[156:159], a[136:139], v[100:103], v[156:159]
    s_mov_b32 s58, s57
    v_add_u32 v139, s50, v139
    v_add_u32 v138, s50, v138
    v_mfma_f32_16x16x32_bf16 v[52:55], a[88:91], v[80:83], v[52:55]
    s_mov_b32 s57, s56
    ds_read_b128 v[240:243], v1 offset:42752
    v_add_u32 v137, s48, v137
    v_mfma_f32_16x16x32_bf16 v[232:235], a[112:115], v[80:83], v[232:235]
    s_mov_b32 s7, s6
    v_add_u32 v136, s48, v136
    v_add_u32 v135, s51, v135
    v_mfma_f32_16x16x32_bf16 v[40:43], a[136:139], v[80:83], v[40:43]
    s_waitcnt vmcnt(8) lgkmcnt(3)
    s_mov_b32 s6, s5
    ds_read_b64_tr_b16 a[144:145], v13 offset:0
    buffer_load_dwordx4 v34, s[32:35], s92 offen offset:2048 lds
    v_mfma_f32_16x16x32_bf16 v[20:23], a[88:91], v[76:79], v[20:23]
    s_add_u32 m0, s90, 49152
    ds_read_b64_tr_b16 a[146:147], v13 offset:768
    v_mfma_f32_16x16x32_bf16 v[92:95], a[112:115], v[76:79], v[92:95]
    s_mov_b32 s92, 148224
    ds_read_b64_tr_b16 a[168:169], v13 offset:8
    v_mfma_f32_16x16x32_bf16 v[24:27], a[136:139], v[76:79], v[24:27]
    s_mov_b32 s5, s4
    ds_read_b64_tr_b16 a[170:171], v13 offset:776
    v_mfma_f32_16x16x32_bf16 v[224:227], a[88:91], v[4:7], v[224:227]
    s_sub_u32 s14, s6, s7
    ds_read_b64_tr_b16 a[192:193], v12 offset:64
    buffer_load_dwordx4 v141, s[32:35], s92 offen offset:0 lds
    v_mfma_f32_16x16x32_bf16 v[168:171], a[112:115], v[4:7], v[168:171]
    s_add_u32 s61, s61, 1
    ds_read_b64_tr_b16 a[194:195], v12 offset:832
    v_add_u32 v134, s14, v134
    v_mfma_f32_16x16x32_bf16 v[164:167], a[136:139], v[4:7], v[164:167]
    s_waitcnt lgkmcnt(7)
    s_add_u32 s12, s12, 20
    ds_read_b128 v[236:239], v1 offset:256
    v_add_u32 v133, s14, v133
    v_mfma_f32_16x16x32_bf16 v[84:87], a[88:91], v[64:67], v[84:87]
    s_max_u32 s12, s12, s61
    ds_read_b128 v[4:7], v1 offset:1792
    v_mfma_f32_16x16x32_bf16 v[116:119], a[112:115], v[64:67], v[116:119]
    s_add_u32 s65, s65, 1
    ds_read_b128 v[228:231], v1 offset:3328
    v_mfma_f32_16x16x32_bf16 v[104:107], a[136:139], v[64:67], v[104:107]
    s_cmp_ge_i32 s65, 2
    buffer_load_dwordx4 v57, s[32:35], s92 offen offset:1024 lds
    v_mfma_f32_16x16x32_bf16 v[44:47], a[92:95], v[48:51], v[44:47]
    s_cselect_b32 s30, 100270464, 0
    ds_read_b128 v[80:83], v111 offset:3072
    v_mov_b32 v58, 0
    v_mfma_f32_16x16x32_bf16 v[160:163], a[116:119], v[48:51], v[160:163]
    s_add_u32 s67, s46, s54
    ds_read_b128 v[76:79], v1 offset:3072
    v_mov_b32 v59, 0
    v_mfma_f32_16x16x32_bf16 v[156:159], a[140:143], v[48:51], v[156:159]
    s_waitcnt lgkmcnt(7)
    ds_read_b128 v[64:67], v111 offset:3200
    v_cvt_pk_f16_f32 v100, v44, v45
    v_mfma_f32_16x16x32_bf16 v[52:55], a[92:95], v[240:243], v[52:55]
    ds_read_b128 v[48:51], v1 offset:3200
    v_cvt_pk_f16_f32 v101, v46, v47
    v_mfma_f32_16x16x32_bf16 v[232:235], a[116:119], v[240:243], v[232:235]
    ds_read_b128 v[44:47], v111 offset:3328
    buffer_load_dwordx4 v34, s[32:35], s92 offen offset:2048 lds
    v_mfma_f32_16x16x32_bf16 v[40:43], a[140:143], v[240:243], v[40:43]
    s_waitcnt vmcnt(9) lgkmcnt(7)
    s_add_u32 m0, s90, 61440
    ds_read_b64_tr_b16 a[148:149], v13 offset:12288
    v_cvt_pk_f16_f32 v52, v52, v53
    v_mfma_f32_16x16x32_bf16 v[20:23], a[92:95], v[236:239], v[20:23]
    s_mov_b32 s92, 185088
    ds_read_b64_tr_b16 a[150:151], v13 offset:13056
    v_cvt_pk_f16_f32 v53, v54, v55
    v_mfma_f32_16x16x32_bf16 v[92:95], a[116:119], v[236:239], v[92:95]
    ds_read_b64_tr_b16 a[172:173], v13 offset:12296
    v_pk_fma_f16 v143, v52, v52, s39
    v_mfma_f32_16x16x32_bf16 v[24:27], a[140:143], v[236:239], v[24:27]
    s_waitcnt lgkmcnt(8)
    ds_read_b64_tr_b16 a[174:175], v13 offset:13064
    v_pk_fmac_f16 v143, v53, v53
    v_mfma_f32_16x16x32_bf16 v[224:227], a[92:95], v[4:7], v[224:227]
    ds_read_b64_tr_b16 a[196:197], v12 offset:12352
    buffer_load_dwordx4 v141, s[32:35], s92 offen offset:0 lds
    v_mfma_f32_16x16x32_bf16 v[168:171], a[116:119], v[4:7], v[168:171]
    ds_read_b64_tr_b16 a[198:199], v12 offset:13120
    v_cvt_pk_f16_f32 v54, v232, v233
    v_mfma_f32_16x16x32_bf16 v[164:167], a[140:143], v[4:7], v[164:167]
    ds_read_b128 v[4:7], v1 offset:3328
    v_cvt_pk_f16_f32 v55, v234, v235
    v_mfma_f32_16x16x32_bf16 v[84:87], a[92:95], v[228:231], v[84:87]
    v_pk_fmac_f16 v143, v54, v54
    v_pk_fmac_f16 v143, v55, v55
    v_mfma_f32_16x16x32_bf16 v[116:119], a[116:119], v[228:231], v[116:119]
    v_cvt_pk_f16_f32 v40, v40, v41
    v_cvt_pk_f16_f32 v41, v42, v43
    v_mfma_f32_16x16x32_bf16 v[104:107], a[140:143], v[228:231], v[104:107]
    v_pk_fmac_f16 v143, v40, v40
    v_pk_fmac_f16 v143, v41, v41
    v_cvt_pk_f16_f32 v248, v224, v225
    v_cvt_pk_f16_f32 v249, v226, v227
    buffer_load_dwordx4 v57, s[32:35], s92 offen offset:1024 lds
    v_pk_fma_f16 v39, v248, v248, s39
    v_pk_fmac_f16 v39, v249, v249
    v_cvt_pk_f16_f32 v250, v168, v169
    v_cvt_pk_f16_f32 v251, v170, v171
    v_pk_fmac_f16 v39, v250, v250
    v_pk_fmac_f16 v39, v251, v251
    v_cvt_pk_f16_f32 v252, v164, v165
    v_cvt_pk_f16_f32 v253, v166, v167
    v_pk_fmac_f16 v39, v252, v252
    v_pk_fmac_f16 v39, v253, v253
    v_cvt_pk_f16_f32 v20, v20, v21
    v_cvt_pk_f16_f32 v21, v22, v23
    v_pk_fma_f16 v37, v20, v20, s39
    v_pk_fmac_f16 v37, v21, v21
    s_waitcnt vmcnt(8)
    ds_read_b64_tr_b16 a[152:153], v13 offset:24576
    buffer_load_dwordx4 v34, s[32:35], s92 offen offset:2048 lds
    s_add_u32 m0, s90, 0
    s_mov_b32 s92, 0
    ds_read_b64_tr_b16 a[154:155], v13 offset:25344
    v_cvt_pk_f16_f32 v22, v92, v93
    v_cvt_pk_f16_f32 v23, v94, v95
    v_pk_fmac_f16 v37, v22, v22
    ds_read_b64_tr_b16 a[176:177], v13 offset:24584
    v_pk_fmac_f16 v37, v23, v23
    v_cvt_pk_f16_f32 v24, v24, v25
    v_cvt_pk_f16_f32 v25, v26, v27
    ds_read_b64_tr_b16 a[178:179], v13 offset:25352
    v_pk_fmac_f16 v37, v24, v24
    ds_read_b64_tr_b16 a[200:201], v12 offset:24640
    buffer_load_dwordx4 v62, s[76:79], s92 offen offset:0 lds
    ds_read_b64_tr_b16 a[202:203], v12 offset:25408
    v_pk_fmac_f16 v37, v25, v25
    v_pk_fma_f16 v141, v100, v100, s39
    v_pk_fmac_f16 v141, v101, v101
    v_mfma_f32_16x16x32_f16 v[92:95], v[212:215], v[36:39], 0
    v_cvt_pk_f16_f32 v102, v160, v161
    v_cvt_pk_f16_f32 v103, v162, v163
    v_pk_fmac_f16 v141, v102, v102
    v_pk_fmac_f16 v141, v103, v103
    v_cvt_pk_f16_f32 v36, v156, v157
    v_cvt_pk_f16_f32 v37, v158, v159
    v_pk_fmac_f16 v141, v36, v36
    v_pk_fmac_f16 v141, v37, v37
    v_cvt_pk_f16_f32 v224, v84, v85
    v_cvt_pk_f16_f32 v225, v86, v87
    v_mfma_f32_16x16x32_f16 v[84:87], v[212:215], v[140:143], 0
    s_nop 0
    buffer_load_dwordx4 v63, s[76:79], s92 offen offset:1024 lds
    v_pk_fma_f16 v57, v224, v224, s39
    v_pk_fmac_f16 v57, v225, v225
    v_cvt_pk_f16_f32 v226, v116, v117
    v_cvt_pk_f16_f32 v227, v118, v119
    v_pk_fmac_f16 v57, v226, v226
    v_pk_fmac_f16 v57, v227, v227
    v_or3_b32 v125, v125, v84, v85
    v_rsq_f32 v84, v84
    v_rsq_f32 v85, v85
    v_mul_f32 v84, s52, v84
    v_cvt_pk_f16_f32 v84, v84, v85
    v_or3_b32 v125, v125, v86, v87
    v_rsq_f32 v86, v86
    v_rsq_f32 v87, v87
    s_waitcnt vmcnt(8)
    ds_read_b64_tr_b16 a[156:157], v13 offset:36864
    buffer_load_dwordx4 v9, s[76:79], s92 offen offset:2048 lds
    s_add_u32 m0, s90, 12288
    s_mov_b32 s92, 12288
    ds_read_b64_tr_b16 a[158:159], v13 offset:37632
    v_mul_f32 v86, s52, v86
    v_cvt_pk_f16_f32 v86, v86, v87
    v_pk_mul_f16 v72, v72, v84 op_sel:[0,0] op_sel_hi:[1,0]
    ds_read_b64_tr_b16 a[180:181], v13 offset:36872
    v_pk_mul_f16 v73, v73, v84 op_sel:[0,0] op_sel_hi:[1,0]
    v_pk_mul_f16 v74, v74, v84 op_sel:[0,0] op_sel_hi:[1,0]
    v_pk_mul_f16 v75, v75, v84 op_sel:[0,0] op_sel_hi:[1,0]
    ds_read_b64_tr_b16 a[182:183], v13 offset:37640
    s_waitcnt lgkmcnt(4)
    buffer_load_dwordx4 v62, s[76:79], s92 offen offset:0 lds
    v_pk_mul_f16 v32, v32, v84 op_sel:[0,0] op_sel_hi:[1,0]
    v_pk_mul_f16 v33, v33, v84 op_sel:[0,0] op_sel_hi:[1,0]
    ds_read_b64_tr_b16 a[204:205], v12 offset:36928
    v_pk_mul_f16 v100, v100, v84 op_sel:[0,1] op_sel_hi:[1,1]
    ds_read_b64_tr_b16 a[206:207], v12 offset:37696
    v_pk_mul_f16 v101, v101, v84 op_sel:[0,1] op_sel_hi:[1,1]
    v_pk_mul_f16 v102, v102, v84 op_sel:[0,1] op_sel_hi:[1,1]
    v_pk_mul_f16 v103, v103, v84 op_sel:[0,1] op_sel_hi:[1,1]
    v_pk_mul_f16 v36, v36, v84 op_sel:[0,1] op_sel_hi:[1,1]
    v_pk_mul_f16 v37, v37, v84 op_sel:[0,1] op_sel_hi:[1,1]
    v_fma_mix_f32 v34, v72, v100, 0 op_sel:[0,0,0] op_sel_hi:[1,1,0]
    v_fma_mix_f32 v34, v72, v100, v34 op_sel:[1,1,0] op_sel_hi:[1,1,0]
    v_fma_mix_f32 v34, v73, v101, v34 op_sel:[0,0,0] op_sel_hi:[1,1,0]
    v_fma_mix_f32 v34, v73, v101, v34 op_sel:[1,1,0] op_sel_hi:[1,1,0]
    v_fma_mix_f32 v34, v74, v102, v34 op_sel:[0,0,0] op_sel_hi:[1,1,0]
    buffer_load_dwordx4 v63, s[76:79], s92 offen offset:1024 lds
    v_fma_mix_f32 v34, v74, v102, v34 op_sel:[1,1,0] op_sel_hi:[1,1,0]
    v_fma_mix_f32 v34, v75, v103, v34 op_sel:[0,0,0] op_sel_hi:[1,1,0]
    v_fma_mix_f32 v34, v75, v103, v34 op_sel:[1,1,0] op_sel_hi:[1,1,0]
    v_fma_mix_f32 v34, v32, v36, v34 op_sel:[0,0,0] op_sel_hi:[1,1,0]
    v_fma_mix_f32 v34, v32, v36, v34 op_sel:[1,1,0] op_sel_hi:[1,1,0]
    v_fma_mix_f32 v34, v33, v37, v34 op_sel:[0,0,0] op_sel_hi:[1,1,0]
    v_fma_mix_f32 v34, v33, v37, v34 op_sel:[1,1,0] op_sel_hi:[1,1,0]
    v_mov_b32 v26, v34
    v_or3_b32 v125, v125, v92, v93
    v_rsq_f32 v92, v92
    v_permlane32_swap_b32 v26, v34
    v_add_f32 v34, v26, v34
    v_mov_b32 v26, v34
    v_rsq_f32 v93, v93
    s_waitcnt vmcnt(8)
    ds_read_b64_tr_b16 a[160:161], v13 offset:49152
    buffer_load_dwordx4 v9, s[76:79], s92 offen offset:2048 lds
    s_add_u32 m0, s90, 24576
    s_mov_b32 s92, 24576
    ds_read_b64_tr_b16 a[162:163], v13 offset:49920
    v_permlane16_swap_b32 v26, v34
    v_add_f32 v34, v26, v34
    ds_read_b64_tr_b16 a[184:185], v13 offset:49160
    v_mul_f32 v92, s52, v92
    v_cvt_pk_f16_f32 v92, v92, v93
    v_or3_b32 v125, v125, v94, v95
    ds_read_b64_tr_b16 a[186:187], v13 offset:49928
    v_rsq_f32 v94, v94
    ds_read_b64_tr_b16 a[208:209], v12 offset:49216
    buffer_load_dwordx4 v62, s[76:79], s92 offen offset:0 lds
    ds_read_b64_tr_b16 a[210:211], v12 offset:49984
    v_rsq_f32 v95, v95
    v_mul_f32 v94, s52, v94
    v_cvt_pk_f16_f32 v94, v94, v95
    v_pk_mul_f16 v20, v20, v92 op_sel:[0,1] op_sel_hi:[1,1]
    v_pk_mul_f16 v21, v21, v92 op_sel:[0,1] op_sel_hi:[1,1]
    v_pk_mul_f16 v22, v22, v92 op_sel:[0,1] op_sel_hi:[1,1]
    v_pk_mul_f16 v23, v23, v92 op_sel:[0,1] op_sel_hi:[1,1]
    v_pk_mul_f16 v24, v24, v92 op_sel:[0,1] op_sel_hi:[1,1]
    v_pk_mul_f16 v25, v25, v92 op_sel:[0,1] op_sel_hi:[1,1]
    v_pk_mul_f16 v120, v120, v92 op_sel:[0,0] op_sel_hi:[1,0]
    v_pk_mul_f16 v121, v121, v92 op_sel:[0,0] op_sel_hi:[1,0]
    v_pk_mul_f16 v122, v122, v92 op_sel:[0,0] op_sel_hi:[1,0]
    v_pk_mul_f16 v123, v123, v92 op_sel:[0,0] op_sel_hi:[1,0]
    buffer_load_dwordx4 v63, s[76:79], s92 offen offset:1024 lds
    v_pk_mul_f16 v154, v154, v92 op_sel:[0,0] op_sel_hi:[1,0]
    v_pk_mul_f16 v155, v155, v92 op_sel:[0,0] op_sel_hi:[1,0]
    v_pk_mul_f16 v248, v248, v94 op_sel:[0,1] op_sel_hi:[1,1]
    v_pk_mul_f16 v249, v249, v94 op_sel:[0,1] op_sel_hi:[1,1]
    v_pk_mul_f16 v250, v250, v94 op_sel:[0,1] op_sel_hi:[1,1]
    v_pk_mul_f16 v251, v251, v94 op_sel:[0,1] op_sel_hi:[1,1]
    v_pk_mul_f16 v252, v252, v94 op_sel:[0,1] op_sel_hi:[1,1]
    v_pk_mul_f16 v253, v253, v94 op_sel:[0,1] op_sel_hi:[1,1]
    v_pk_mul_f16 v96, v96, v94 op_sel:[0,0] op_sel_hi:[1,0]
    v_pk_mul_f16 v97, v97, v94 op_sel:[0,0] op_sel_hi:[1,0]
    v_pk_mul_f16 v98, v98, v94 op_sel:[0,0] op_sel_hi:[1,0]
    v_pk_mul_f16 v99, v99, v94 op_sel:[0,0] op_sel_hi:[1,0]
    v_pk_mul_f16 v150, v150, v94 op_sel:[0,0] op_sel_hi:[1,0]
    v_pk_mul_f16 v151, v151, v94 op_sel:[0,0] op_sel_hi:[1,0]
    v_add_f32 v34, s84, v34
    v_exp_f32 v34, v34
    buffer_load_dwordx4 v9, s[76:79], s92 offen offset:2048 lds
    s_add_u32 m0, s90, 36864
    s_mov_b32 s92, 36864
    s_waitcnt vmcnt(9)
    ds_read_b64_tr_b16 a[164:165], v13 offset:61440
    v_cvt_pk_bf16_f32 v34, v34, 0
    v_cmp_gt_u32 vcc, 16, v8
    v_cvt_pk_f16_f32 v228, v104, v105
    ds_read_b64_tr_b16 a[166:167], v13 offset:62208
    v_mfma_f32_16x16x32_bf16 v[92:95], v[80:83], a[144:147], 0
    v_cndmask_b32 v34, 0, v34, vcc
    v_cvt_pk_f16_f32 v229, v106, v107
    v_mfma_f32_16x16x32_bf16 v[92:95], v[76:79], a[148:151], v[92:95]
    ds_read_b64_tr_b16 a[188:189], v13 offset:61448
    v_pk_fmac_f16 v57, v228, v228
    v_mfma_f32_16x16x32_bf16 v[92:95], v[64:67], a[152:155], v[92:95]
    s_waitcnt lgkmcnt(3)
    buffer_load_dwordx4 v62, s[76:79], s92 offen offset:0 lds
    ds_read_b64_tr_b16 a[190:191], v13 offset:62216
    v_mfma_f32_16x16x32_bf16 v[92:95], v[48:51], a[156:159], v[92:95]
    v_pk_fmac_f16 v57, v229, v229
    v_pk_mul_f16 v68, v68, v86 op_sel:[0,0] op_sel_hi:[1,0]
    v_mfma_f32_16x16x32_bf16 v[92:95], v[44:47], a[160:163], v[92:95]
    s_waitcnt lgkmcnt(2)
    ds_read_b64_tr_b16 a[212:213], v12 offset:61504
    v_pk_mul_f16 v69, v69, v86 op_sel:[0,0] op_sel_hi:[1,0]
    v_pk_mul_f16 v70, v70, v86 op_sel:[0,0] op_sel_hi:[1,0]
    v_pk_mul_f16 v71, v71, v86 op_sel:[0,0] op_sel_hi:[1,0]
    ds_read_b64_tr_b16 a[214:215], v12 offset:62272
    v_pk_mul_f16 v60, v60, v86 op_sel:[0,0] op_sel_hi:[1,0]
    buffer_load_dwordx4 v63, s[76:79], s92 offen offset:1024 lds
    ds_write_b128 v28, v[72:75] offset:21504
    v_mfma_f32_16x16x32_bf16 v[92:95], v[4:7], a[164:167], v[92:95]
    v_pk_mul_f16 v61, v61, v86 op_sel:[0,0] op_sel_hi:[1,0]
    v_pk_mul_f16 v52, v52, v86 op_sel:[0,1] op_sel_hi:[1,1]
    v_mfma_f32_16x16x32_bf16 v[72:75], v[80:83], a[168:171], 0
    v_pk_mul_f16 v53, v53, v86 op_sel:[0,1] op_sel_hi:[1,1]
    v_pk_mul_f16 v54, v54, v86 op_sel:[0,1] op_sel_hi:[1,1]
    v_mfma_f32_16x16x32_bf16 v[72:75], v[76:79], a[172:175], v[72:75]
    ds_write_b128 v28, v[100:103] offset:21536
    v_mfma_f32_16x16x32_bf16 v[72:75], v[64:67], a[176:179], v[72:75]
    buffer_load_dwordx4 v9, s[76:79], s92 offen offset:2048 lds
    v_cvt_pk_bf16_f32 v164, v92, v93
    v_mfma_f32_16x16x32_bf16 v[72:75], v[48:51], a[180:183], v[72:75]
    s_add_u32 m0, s90, 49152
    v_cvt_pk_bf16_f32 v165, v94, v95
    v_pk_mul_f16 v55, v55, v86 op_sel:[0,1] op_sel_hi:[1,1]
    v_mfma_f32_16x16x32_bf16 v[72:75], v[44:47], a[184:187], v[72:75]
    s_waitcnt lgkmcnt(2)
    s_mov_b32 s92, 49152
    ds_write_b64 v28, v[36:37] offset:21552
    v_mfma_f32_16x16x32_bf16 v[72:75], v[4:7], a[188:191], v[72:75]
    v_pk_mul_f16 v40, v40, v86 op_sel:[0,1] op_sel_hi:[1,1]
    v_pk_mul_f16 v41, v41, v86 op_sel:[0,1] op_sel_hi:[1,1]
    v_mfma_f32_16x16x32_bf16 v[36:39], v[80:83], a[192:195], 0
    s_nop 0
    buffer_load_dwordx4 v62, s[76:79], s92 offen offset:0 lds
    ds_read_b128 v[84:87], v111 offset:40960
    v_mfma_f32_16x16x32_bf16 v[36:39], v[76:79], a[196:199], v[36:39]
    s_nop 0
    v_cvt_pk_bf16_f32 v160, v72, v73
    v_cvt_pk_bf16_f32 v161, v74, v75
    v_mfma_f32_16x16x32_bf16 v[36:39], v[64:67], a[200:203], v[36:39]
    ds_read_b128 v[72:75], v1 offset:40960
    v_mov_b32 v171, 0
    v_mfma_f32_16x16x32_bf16 v[36:39], v[48:51], a[204:207], v[36:39]
    ds_read_b128 v[64:67], v111 offset:41088
    v_mov_b32 v167, 0
    v_mfma_f32_16x16x32_bf16 v[36:39], v[44:47], a[208:211], v[36:39]
    ds_read_b128 v[48:51], v1 offset:41088
    v_mov_b32 v163, 0
    v_mfma_f32_16x16x32_bf16 v[36:39], v[4:7], a[212:215], v[36:39]
    buffer_load_dwordx4 v63, s[76:79], s92 offen offset:1024 lds
    ds_read_b128 v[44:47], v111 offset:41216
    v_mov_b32 v159, 0
    v_mov_b32 v152, 0
    v_mov_b32 v153, 0
    v_mfma_f32_16x16x32_f16 v[80:83], v[20:23], v[120:123], v[204:207]
    s_nop 0
    ds_read_b128 v[4:7], v1 offset:41216
    v_cvt_pk_bf16_f32 v156, v36, v37
    v_mfma_f32_16x16x32_f16 v[80:83], v[22:25], v[152:155], v[80:83]
    v_cvt_pk_bf16_f32 v157, v38, v39
    v_mov_b32 v148, 0
    v_mfma_f32_16x16x32_f16 v[104:107], v[248:251], v[120:123], v[200:203]
    v_mov_b32 v149, 0
    v_mov_b32 v144, 0
    v_mfma_f32_16x16x32_f16 v[104:107], v[250:253], v[152:155], v[104:107]
    s_waitcnt lgkmcnt(5)
    v_mov_b32 v145, 0
    v_mov_b32 v140, 0
    v_mfma_f32_16x16x32_bf16 v[92:95], a[144:147], v[84:87], 0
    s_waitcnt lgkmcnt(4)
    buffer_load_dwordx4 v9, s[76:79], s92 offen offset:2048 lds
    v_mov_b32 v141, 0
    v_mfma_f32_16x16x32_bf16 v[92:95], a[148:151], v[72:75], v[92:95]
    s_waitcnt lgkmcnt(3)
    s_add_u32 m0, s90, 61440
    v_exp_f32 v80, v80
    v_mfma_f32_16x16x32_bf16 v[92:95], a[152:155], v[64:67], v[92:95]
    s_waitcnt lgkmcnt(2)
    s_mov_b32 s92, 61440
    v_exp_f32 v81, v81
    v_mfma_f32_16x16x32_bf16 v[92:95], a[156:159], v[48:51], v[92:95]
    s_waitcnt lgkmcnt(1)
    ds_write_b128 v28, v[32:35] offset:21520
    v_mfma_f32_16x16x32_bf16 v[92:95], a[160:163], v[44:47], v[92:95]
    s_waitcnt lgkmcnt(1)
    buffer_load_dwordx4 v62, s[76:79], s92 offen offset:0 lds
    v_cvt_pk_bf16_f32 v100, v80, v81
    v_mfma_f32_16x16x32_bf16 v[92:95], a[164:167], v[4:7], v[92:95]
    v_exp_f32 v82, v82
    v_mfma_f32_16x16x32_bf16 v[32:35], a[168:171], v[84:87], 0
    s_nop 0
    ds_read_b128 v[240:243], v134 offset:32
    v_fma_mix_f32 v62, v68, v52, 0 op_sel:[0,0,0] op_sel_hi:[1,1,0]
    v_mfma_f32_16x16x32_bf16 v[32:35], a[172:175], v[72:75], v[32:35]
    s_nop 0
    ds_read_b64 v[244:245], v134 offset:48
    v_cvt_pk_bf16_f32 v38, v92, v93
    v_mfma_f32_16x16x32_bf16 v[32:35], a[176:179], v[64:67], v[32:35]
    ds_read_b128 v[76:79], v134 offset:0
    v_cvt_pk_bf16_f32 v39, v94, v95
    v_mfma_f32_16x16x32_bf16 v[32:35], a[180:183], v[48:51], v[32:35]
    buffer_load_dwordx4 v63, s[76:79], s92 offen offset:1024 lds
    ds_read_b64 v[142:143], v134 offset:16
    v_mfma_f32_16x16x32_bf16 v[32:35], a[184:187], v[44:47], v[32:35]
    ds_write_b64 v28, v[38:39] offset:21560
    v_mfma_f32_16x16x32_bf16 v[32:35], a[188:191], v[4:7], v[32:35]
    v_exp_f32 v83, v83
    v_mfma_f32_16x16x32_bf16 v[36:39], a[192:195], v[84:87], 0
    ds_read_b128 v[84:87], v111 offset:42496
    v_cvt_pk_bf16_f32 v101, v82, v83
    v_mfma_f32_16x16x32_bf16 v[36:39], a[196:199], v[72:75], v[36:39]
    ds_read_b128 v[80:83], v1 offset:42496
    buffer_load_dwordx4 v9, s[76:79], s92 offen offset:2048 lds
    v_mfma_f32_16x16x32_bf16 v[36:39], a[200:203], v[64:67], v[36:39]
    s_add_u32 m0, s54, 20480
    ds_read_b128 v[72:75], v111 offset:42624
    v_cvt_pk_bf16_f32 v32, v32, v33
    v_mfma_f32_16x16x32_bf16 v[36:39], a[204:207], v[48:51], v[36:39]
    ds_read_b128 v[64:67], v1 offset:42624
    v_cvt_pk_bf16_f32 v33, v34, v35
    v_mfma_f32_16x16x32_bf16 v[36:39], a[208:211], v[44:47], v[36:39]
    ds_read_b128 v[44:47], v111 offset:42752
    v_fma_mix_f32 v62, v68, v52, v62 op_sel:[1,1,0] op_sel_hi:[1,1,0]
    v_mfma_f32_16x16x32_bf16 v[36:39], a[212:215], v[4:7], v[36:39]
    s_waitcnt lgkmcnt(7)
    ds_read_b128 v[4:7], v1 offset:42752
    v_fma_mix_f32 v62, v69, v53, v62 op_sel:[0,0,0] op_sel_hi:[1,1,0]
    v_mfma_f32_16x16x32_f16 v[92:95], v[240:243], v[120:123], v[208:211]
    v_exp_f32 v104, v104
    v_mfma_f32_16x16x32_f16 v[92:95], v[242:245], v[152:155], v[92:95]
    s_nop 0
    buffer_load_dwordx4 v130, s[24:27], s56 offen nt lds
    v_cvt_pk_bf16_f32 v34, v36, v37
    v_mfma_f32_16x16x32_f16 v[48:51], v[76:79], v[20:23], v[208:211]
    s_waitcnt lgkmcnt(6)
    s_add_u32 m0, s54, 21504
    v_cvt_pk_bf16_f32 v35, v38, v39
    v_fma_mix_f32 v62, v69, v53, v62 op_sel:[1,1,0] op_sel_hi:[1,1,0]
    v_mfma_f32_16x16x32_f16 v[48:51], v[140:143], v[22:25], v[48:51]
    ds_write_b128 v28, v[32:35] offset:21568
    v_mfma_f32_16x16x32_f16 v[32:35], v[76:79], v[248:251], v[208:211]
    v_exp_f32 v105, v105
    v_mfma_f32_16x16x32_f16 v[32:35], v[140:143], v[250:253], v[32:35]
    s_waitcnt lgkmcnt(3)
    buffer_load_dwordx4 v129, s[24:27], s56 offen nt lds
    v_cvt_pk_bf16_f32 v102, v104, v105
    v_mfma_f32_16x16x32_bf16 v[36:39], a[144:147], v[84:87], 0
    s_add_u32 m0, s54, 22528
    ds_read_u16 v166, v133 offset:56
    v_fma_mix_f32 v62, v70, v54, v62 op_sel:[0,0,0] op_sel_hi:[1,1,0]
    v_mfma_f32_16x16x32_bf16 v[36:39], a[148:151], v[80:83], v[36:39]
    ds_read_u16 v162, v133 offset:64
    v_mov_b32_dpp v51, v35 quad_perm:[0,1,2,3] row_mask:0x2 bank_mask:0xf
    v_mfma_f32_16x16x32_bf16 v[36:39], a[152:155], v[72:75], v[36:39]
    ds_read_u16 v158, v133 offset:72
    v_fma_mix_f32 v62, v70, v54, v62 op_sel:[1,1,0] op_sel_hi:[1,1,0]
    v_mfma_f32_16x16x32_bf16 v[36:39], a[156:159], v[64:67], v[36:39]
    s_waitcnt lgkmcnt(4)
    v_exp_f32 v106, v106
    v_mfma_f32_16x16x32_bf16 v[36:39], a[160:163], v[44:47], v[36:39]
    buffer_load_dwordx4 v128, s[24:27], s56 offen nt lds
    v_fma_mix_f32 v62, v71, v55, v62 op_sel:[0,0,0] op_sel_hi:[1,1,0]
    v_mfma_f32_16x16x32_bf16 v[36:39], a[164:167], v[4:7], v[36:39]
    s_add_u32 m0, s54, 23552
    v_exp_f32 v107, v107
    v_mfma_f32_16x16x32_bf16 v[32:35], a[168:171], v[84:87], 0
    v_cvt_pk_bf16_f32 v103, v106, v107
    v_fma_mix_f32 v62, v71, v55, v62 op_sel:[1,1,0] op_sel_hi:[1,1,0]
    v_mfma_f32_16x16x32_bf16 v[32:35], a[172:175], v[80:83], v[32:35]
    v_exp_f32 v92, v92
    v_mfma_f32_16x16x32_bf16 v[32:35], a[176:179], v[72:75], v[32:35]
    v_cvt_pk_bf16_f32 v170, v92, 0
    v_cvt_pk_bf16_f32 v42, v36, v37
    v_mfma_f32_16x16x32_bf16 v[32:35], a[180:183], v[64:67], v[32:35]
    buffer_load_dwordx4 v127, s[24:27], s56 offen nt lds
    v_cvt_pk_bf16_f32 v43, v38, v39
    v_mfma_f32_16x16x32_bf16 v[32:35], a[184:187], v[44:47], v[32:35]
    s_add_u32 m0, s54, 24576
    v_fma_mix_f32 v62, v60, v40, v62 op_sel:[0,0,0] op_sel_hi:[1,1,0]
    v_fma_mix_f32 v62, v60, v40, v62 op_sel:[1,1,0] op_sel_hi:[1,1,0]
    v_mfma_f32_16x16x32_bf16 v[32:35], a[188:191], v[4:7], v[32:35]
    v_fma_mix_f32 v62, v61, v41, v62 op_sel:[0,0,0] op_sel_hi:[1,1,0]
    v_fma_mix_f32 v62, v61, v41, v62 op_sel:[1,1,0] op_sel_hi:[1,1,0]
    v_mfma_f32_16x16x32_bf16 v[36:39], a[192:195], v[84:87], 0
    s_nop 0
    v_mov_b32 v9, v62
    v_mov_b32 v63, 0
    v_mfma_f32_16x16x32_bf16 v[36:39], a[196:199], v[80:83], v[36:39]
    s_nop 0
    v_cvt_pk_bf16_f32 v32, v32, v33
    v_cvt_pk_bf16_f32 v33, v34, v35
    v_mfma_f32_16x16x32_bf16 v[36:39], a[200:203], v[72:75], v[36:39]
    buffer_load_dwordx4 v126, s[24:27], s56 offen nt lds
    v_mfma_f32_16x16x32_bf16 v[36:39], a[204:207], v[64:67], v[36:39]
    s_cmp_lt_u32 s61, s71
    v_permlane32_swap_b32 v9, v62
    v_mfma_f32_16x16x32_bf16 v[36:39], a[208:211], v[44:47], v[36:39]
    s_cselect_b32 s15, s61, s12
    v_add_f32 v62, v9, v62
    v_mov_b32 v9, v62
    v_mfma_f32_16x16x32_bf16 v[36:39], a[212:215], v[4:7], v[36:39]
    s_cselect_b32 s56, s69, s70
    v_permlane16_swap_b32 v9, v62
    v_mfma_f32_16x16x32_f16 v[4:7], v[20:23], v[96:99], v[192:195]
    s_add_u32 s56, s56, s15
    ds_read_b128 v[104:107], v111 offset:0
    v_add_f32 v62, v9, v62
    v_mfma_f32_16x16x32_f16 v[4:7], v[22:25], v[148:151], v[4:7]
    s_mul_i32 s53, s56, 58255
    ds_read_b128 v[92:95], v1 offset:0
    v_cvt_pk_bf16_f32 v34, v36, v37
    v_mfma_f32_16x16x32_f16 v[232:235], v[248:251], v[96:99], v[188:191]
    s_lshr_b32 s53, s53, 22
    ds_read_b128 v[84:87], v111 offset:128
    v_cvt_pk_bf16_f32 v35, v38, v39
    v_mfma_f32_16x16x32_f16 v[232:235], v[250:253], v[148:151], v[232:235]
    s_mul_i32 s53, s53, s63
    ds_read_b128 v[80:83], v1 offset:128
    v_add_f32 v62, s84, v62
    v_exp_f32 v62, v62
    s_mul_i32 s56, s56, s62
    s_add_u32 s56, s56, s53
    s_mul_i32 s4, s15, 336
    s_cmp_ge_u32 s15, 16
    s_cselect_b32 s53, -26880, 0
    s_add_u32 s4, s4, s53
    s_cmp_lt_u32 s15, s73
    s_cselect_b32 s26, 100270464, 0
    s_cselect_b32 s56, s56, 0
    s_cselect_b32 s4, s4, -1
    s_cselect_b32 s15, s15, 0
    s_cselect_b32 s13, s13, -1
    s_bitset1_b32 s64, s15
    v_mfma_f32_16x16x32_f16 v[64:67], v[240:243], v[96:99], v[208:211]
    s_add_u32 m0, s67, 0
    ds_read_b128 v[44:47], v111 offset:256
    v_cvt_pk_bf16_f32 v62, v62, 0
    v_mfma_f32_16x16x32_f16 v[64:67], v[242:245], v[148:151], v[64:67]
    ds_read_b128 v[36:39], v1 offset:256
    v_cmp_gt_u32 vcc, 16, v8
    v_mfma_f32_16x16x32_f16 v[116:119], v[212:215], v[56:59], 0
    s_waitcnt lgkmcnt(4)
    v_exp_f32 v4, v4
    v_mfma_f32_16x16x32_bf16 v[72:75], v[104:107], a[144:147], 0
    v_exp_f32 v5, v5
    v_mfma_f32_16x16x32_bf16 v[72:75], v[92:95], a[148:151], v[72:75]
    s_waitcnt lgkmcnt(2)
    s_nop 0
    v_cndmask_b32 v62, 0, v62, vcc
    v_or3_b32 v125, v125, v116, v117
    v_mfma_f32_16x16x32_bf16 v[72:75], v[84:87], a[152:155], v[72:75]
    v_rsq_f32 v116, v116
    v_mfma_f32_16x16x32_bf16 v[72:75], v[80:83], a[156:159], v[72:75]
    v_rsq_f32 v117, v117
    v_mul_f32 v116, s52, v116
    v_cvt_pk_f16_f32 v116, v116, v117
    v_pk_mul_f16 v224, v224, v116 op_sel:[0,1] op_sel_hi:[1,1]
    v_pk_mul_f16 v225, v225, v116 op_sel:[0,1] op_sel_hi:[1,1]
    v_pk_mul_f16 v226, v226, v116 op_sel:[0,1] op_sel_hi:[1,1]
    v_pk_mul_f16 v227, v227, v116 op_sel:[0,1] op_sel_hi:[1,1]
    v_pk_mul_f16 v228, v228, v116 op_sel:[0,1] op_sel_hi:[1,1]
    v_pk_mul_f16 v229, v229, v116 op_sel:[0,1] op_sel_hi:[1,1]
    v_pk_mul_f16 v14, v14, v116 op_sel:[0,0] op_sel_hi:[1,0]
    s_waitcnt lgkmcnt(1)
    v_mfma_f32_16x16x32_bf16 v[72:75], v[44:47], a[160:163], v[72:75]
    s_waitcnt vmcnt(5) lgkmcnt(0)
    s_barrier
    v_pk_mul_f16 v15, v15, v116 op_sel:[0,0] op_sel_hi:[1,0]
    v_pk_mul_f16 v16, v16, v116 op_sel:[0,0] op_sel_hi:[1,0]
    v_mfma_f32_16x16x32_bf16 v[72:75], v[36:39], a[164:167], v[72:75]
    v_pk_mul_f16 v17, v17, v116 op_sel:[0,0] op_sel_hi:[1,0]
    v_pk_mul_f16 v146, v146, v116 op_sel:[0,0] op_sel_hi:[1,0]
    v_mfma_f32_16x16x32_f16 v[56:59], v[224:227], v[120:123], v[196:199]
    s_nop 0
    v_pk_mul_f16 v147, v147, v116 op_sel:[0,0] op_sel_hi:[1,0]
    v_cvt_pk_bf16_f32 v108, v4, v5
    v_mfma_f32_16x16x32_f16 v[56:59], v[226:229], v[152:155], v[56:59]
    s_nop 0
    v_cvt_pk_bf16_f32 v8, v72, v73
    v_cvt_pk_bf16_f32 v9, v74, v75
    v_mfma_f32_16x16x32_f16 v[72:75], v[76:79], v[224:227], v[208:211]
    s_nop 0
    v_exp_f32 v6, v6
    v_mfma_f32_16x16x32_f16 v[72:75], v[140:143], v[226:229], v[72:75]
    s_nop 0
    v_exp_f32 v56, v56
    v_mfma_f32_16x16x32_f16 v[76:79], v[224:227], v[96:99], v[184:187]
    v_exp_f32 v57, v57
    v_mfma_f32_16x16x32_f16 v[76:79], v[226:229], v[148:151], v[76:79]
    v_exp_f32 v58, v58
    v_mfma_f32_16x16x32_bf16 v[96:99], v[104:107], a[168:171], 0
    s_nop 0
    v_mov_b32_dpp v51, v75 quad_perm:[0,1,2,3] row_mask:0x4 bank_mask:0xf
    v_cvt_pk_bf16_f32 v168, v56, v57
    v_mfma_f32_16x16x32_bf16 v[96:99], v[92:95], a[172:175], v[96:99]
    v_exp_f32 v51, v51
    v_mfma_f32_16x16x32_bf16 v[96:99], v[84:87], a[176:179], v[96:99]
    v_exp_f32 v59, v59
    v_mfma_f32_16x16x32_bf16 v[96:99], v[80:83], a[180:183], v[96:99]
    s_lshl_b32 s93, s68, 10
    v_cvt_pk_bf16_f32 v51, v51, v51
    v_cvt_pk_bf16_f32 v169, v58, v59
    v_mfma_f32_16x16x32_bf16 v[96:99], v[44:47], a[184:187], v[96:99]
    s_mov_b32 s53, s47
    ds_write_b16 v133, v51
    v_mfma_f32_16x16x32_bf16 v[96:99], v[36:39], a[188:191], v[96:99]
    s_mov_b32 s47, s46
    ds_read_b128 v[72:75], v134
    v_add_u32 v247, s93, v131
    v_mfma_f32_16x16x32_bf16 v[56:59], v[220:223], v[100:103], 0
    s_mov_b32 s46, s45
    ds_read_b128 v[48:51], v134 offset:16
    v_mfma_f32_16x16x32_bf16 v[56:59], v[220:223], v[168:171], v[56:59]
    s_mov_b32 s45, s44
    ds_read_b128 v[116:119], v11 offset:0
    v_cvt_pk_bf16_f32 v12, v96, v97
    v_mfma_f32_16x16x32_bf16 v[120:123], v[104:107], a[192:195], 0
    s_mov_b32 s44, s53
    ds_read_b64 v[96:97], v10 offset:64
    v_cvt_pk_bf16_f32 v13, v98, v99
    v_mfma_f32_16x16x32_bf16 v[120:123], v[92:95], a[196:199], v[120:123]
    s_sub_u32 s48, s44, s46
    ds_read_b128 v[236:239], v11 offset:3072
    v_add_u32 v139, s48, v139
    v_mfma_f32_16x16x32_bf16 v[120:123], v[84:87], a[200:203], v[120:123]
    s_sub_u32 s49, s46, s45
    ds_read_b64 v[98:99], v10 offset:3136
    v_add_u32 v138, s48, v138
    v_mfma_f32_16x16x32_bf16 v[120:123], v[80:83], a[204:207], v[120:123]
    ds_read_b128 v[92:95], v11 offset:6144
    v_mfma_f32_16x16x32_bf16 v[120:123], v[44:47], a[208:211], v[120:123]
    ds_read_b64 v[44:45], v10 offset:6208
    v_mfma_f32_16x16x32_bf16 v[120:123], v[36:39], a[212:215], v[120:123]
    ds_read_b128 v[104:107], v11 offset:9216
    v_mfma_f32_16x16x32_f16 v[80:83], v[20:23], v[14:17], v[180:183]
    s_nop 0
    ds_read_b64 v[46:47], v10 offset:9280
    s_nop 0
    v_mfma_f32_16x16x32_f16 v[80:83], v[22:25], v[144:147], v[80:83]
    s_nop 0
    ds_read_b128 v[84:87], v11 offset:12288
    v_cvt_pk_bf16_f32 v4, v120, v121
    v_mfma_f32_16x16x32_f16 v[36:39], v[248:251], v[14:17], v[176:179]
    ds_read_b64 v[120:121], v10 offset:12352
    v_cvt_pk_bf16_f32 v5, v122, v123
    v_mfma_f32_16x16x32_f16 v[36:39], v[250:253], v[144:147], v[36:39]
    ds_read_b128 v[252:255], v11 offset:15360
    v_mfma_f32_16x16x32_f16 v[24:27], v[224:227], v[14:17], v[172:175]
    ds_read_b64 v[122:123], v10 offset:15424
    v_mfma_f32_16x16x32_f16 v[24:27], v[226:229], v[144:147], v[24:27]
    ds_read_b128 v[248:251], v11 offset:18432
    v_mfma_f32_16x16x32_f16 v[20:23], v[240:243], v[14:17], v[208:211]
    ds_read_b64 v[228:229], v10 offset:18496
    v_mfma_f32_16x16x32_f16 v[20:23], v[242:245], v[144:147], v[20:23]
    s_waitcnt lgkmcnt(8)
    ds_read_b128 v[224:227], v11 offset:21504
    v_mfma_f32_16x16x32_bf16 v[240:243], v[116:119], v[220:223], 0
    ds_read_b64 v[230:231], v10 offset:21568
    v_mfma_f32_16x16x32_bf16 v[240:243], v[236:239], v[220:223], v[240:243]
    ds_read_b128 v[236:239], v11 offset:24576
    v_mfma_f32_16x16x32_bf16 v[240:243], v[92:95], v[220:223], v[240:243]
    s_waitcnt lgkmcnt(8)
    ds_read_b64 v[92:93], v10 offset:24640
    v_mfma_f32_16x16x32_bf16 v[240:243], v[104:107], v[220:223], v[240:243]
    ds_read_b128 v[116:119], v11 offset:27648
    v_mfma_f32_16x16x32_bf16 v[240:243], v[96:99], v[220:223], v[240:243]
    ds_read_b64 v[94:95], v10 offset:27712
    v_mfma_f32_16x16x32_bf16 v[240:243], v[44:47], v[220:223], v[240:243]
    ds_read_b128 v[104:107], v11 offset:30720
    v_mfma_f32_16x16x32_bf16 v[44:47], v[84:87], v[220:223], 0
    s_waitcnt lgkmcnt(8)
    ds_read_b64 v[84:85], v10 offset:30784
    s_nop 0
    v_mfma_f32_16x16x32_bf16 v[44:47], v[252:255], v[220:223], v[44:47]
    s_nop 0
    ds_read_b128 v[96:99], v11 offset:33792
    v_mul_f32 v240, 0xbbaaaaab, v240
    v_mfma_f32_16x16x32_bf16 v[44:47], v[248:251], v[220:223], v[44:47]
    s_waitcnt lgkmcnt(8)
    ds_read_b64 v[86:87], v10 offset:33856
    v_mul_f32 v241, 0xbbaaaaab, v241
    v_mfma_f32_16x16x32_bf16 v[44:47], v[224:227], v[220:223], v[44:47]
    ds_read_b128 v[224:227], v111 offset:1536
    v_mul_f32 v242, 0xbbaaaaab, v242
    v_mfma_f32_16x16x32_bf16 v[44:47], v[120:123], v[220:223], v[44:47]
    s_waitcnt lgkmcnt(8)
    ds_read_b128 v[120:123], v1 offset:1536
    v_mul_f32 v243, 0xbbaaaaab, v243
    v_mfma_f32_16x16x32_bf16 v[44:47], v[228:231], v[220:223], v[44:47]
    ds_write_b128 v0, v[240:243] offset:0
    v_mfma_f32_16x16x32_bf16 v[228:231], v[236:239], v[220:223], 0
    s_waitcnt lgkmcnt(7)
    v_exp_f32 v7, v7
    v_mfma_f32_16x16x32_bf16 v[228:231], v[116:119], v[220:223], v[228:231]
    s_waitcnt lgkmcnt(6)
    v_exp_f32 v232, v232
    v_mfma_f32_16x16x32_bf16 v[228:231], v[104:107], v[220:223], v[228:231]
    s_waitcnt lgkmcnt(4)
    ds_read_b128 v[116:119], v111 offset:1664
    v_cvt_pk_bf16_f32 v109, v6, v7
    v_exp_f32 v233, v233
    v_mfma_f32_16x16x32_bf16 v[228:231], v[96:99], v[220:223], v[228:231]
    ds_read_b128 v[104:107], v1 offset:1664
    v_cvt_pk_bf16_f32 v110, v232, v233
    v_mfma_f32_16x16x32_bf16 v[228:231], v[92:95], v[220:223], v[228:231]
    s_waitcnt lgkmcnt(4)
    ds_read_b128 v[96:99], v111 offset:1792
    v_mul_f32 v44, 0xbbaaaaab, v44
    v_mfma_f32_16x16x32_bf16 v[228:231], v[84:87], v[220:223], v[228:231]
    ds_read_b128 v[92:95], v1 offset:1792
    v_mul_f32 v45, 0xbbaaaaab, v45
    v_mfma_f32_16x16x32_bf16 v[84:87], v[224:227], a[144:147], 0
    s_waitcnt lgkmcnt(4)
    v_exp_f32 v234, v234
    v_mfma_f32_16x16x32_bf16 v[84:87], v[120:123], a[148:151], v[84:87]
    s_waitcnt lgkmcnt(3)
    v_exp_f32 v235, v235
    v_exp_f32 v76, v76
    v_cvt_pk_bf16_f32 v111, v234, v235
    v_exp_f32 v77, v77
    v_exp_f32 v78, v78
    v_exp_f32 v79, v79
    v_exp_f32 v65, v65
    v_mfma_f32_16x16x32_bf16 v[84:87], v[116:119], a[152:155], v[84:87]
    s_waitcnt lgkmcnt(2)
    v_rcp_f32 v56, v56
    v_mul_f32 v46, 0xbbaaaaab, v46
    v_mul_f32 v47, 0xbbaaaaab, v47
    v_mfma_f32_16x16x32_bf16 v[84:87], v[104:107], a[156:159], v[84:87]
    s_waitcnt lgkmcnt(0)
    ds_write_b128 v0, v[44:47] offset:128
    v_mfma_f32_16x16x32_bf16 v[84:87], v[96:99], a[160:163], v[84:87]
    s_barrier
    buffer_load_dwordx4 v130, s[24:27], s56 offen nt lds
    v_mul_f32 v228, 0xbbaaaaab, v228
    v_mfma_f32_16x16x32_bf16 v[84:87], v[92:95], a[164:167], v[84:87]
    s_add_u32 m0, s67, 1024
    v_mul_f32 v229, 0xbbaaaaab, v229
    v_mul_f32 v230, 0xbbaaaaab, v230
    v_mfma_f32_16x16x32_bf16 v[44:47], v[224:227], a[168:171], 0
    buffer_load_dwordx4 v129, s[24:27], s56 offen nt lds
    v_mul_f32 v231, 0xbbaaaaab, v231
    v_mfma_f32_16x16x32_bf16 v[44:47], v[120:123], a[172:175], v[44:47]
    s_add_u32 m0, s67, 2048
    ds_write_b128 v0, v[228:231] offset:256
    v_mfma_f32_16x16x32_bf16 v[44:47], v[116:119], a[176:179], v[44:47]
    buffer_load_dwordx4 v128, s[24:27], s56 offen nt lds
    v_cvt_pk_bf16_f32 v10, v84, v85
    v_mfma_f32_16x16x32_bf16 v[44:47], v[104:107], a[180:183], v[44:47]
    s_add_u32 m0, s67, 3072
    v_exp_f32 v80, v80
    v_mfma_f32_16x16x32_bf16 v[44:47], v[96:99], a[184:187], v[44:47]
    buffer_load_dwordx4 v127, s[24:27], s56 offen nt lds
    v_cvt_pk_bf16_f32 v11, v86, v87
    v_mfma_f32_16x16x32_bf16 v[44:47], v[92:95], a[188:191], v[44:47]
    s_add_u32 m0, s67, 4096
    v_exp_f32 v81, v81
    v_mfma_f32_16x16x32_bf16 v[84:87], v[8:11], v[100:103], 0
    s_nop 0
    buffer_load_dwordx4 v126, s[24:27], s56 offen nt lds
    v_cvt_pk_bf16_f32 v16, v80, v81
    v_mfma_f32_16x16x32_bf16 v[84:87], v[164:167], v[168:171], v[84:87]
    s_nop 0
    v_cvt_pk_bf16_f32 v14, v44, v45
    v_cvt_pk_bf16_f32 v15, v46, v47
    v_mfma_f32_16x16x32_bf16 v[44:47], v[224:227], a[192:195], 0
    v_exp_f32 v82, v82
    v_mfma_f32_16x16x32_bf16 v[44:47], v[120:123], a[196:199], v[44:47]
    s_waitcnt lgkmcnt(0)
    s_nop 0
    v_mul_f32 v84, v84, v56
    v_mul_f32 v85, v85, v56
    v_mfma_f32_16x16x32_bf16 v[44:47], v[116:119], a[200:203], v[44:47]
    s_barrier
    v_cvt_pk_bf16_f32 v84, v84, v85
    v_mul_f32 v86, v86, v56
    v_mfma_f32_16x16x32_bf16 v[44:47], v[104:107], a[204:207], v[44:47]
    v_exp_f32 v83, v83
    v_mfma_f32_16x16x32_bf16 v[44:47], v[96:99], a[208:211], v[44:47]
    v_mul_f32 v87, v87, v56
    v_cvt_pk_bf16_f32 v85, v86, v87
    v_mfma_f32_16x16x32_bf16 v[44:47], v[92:95], a[212:215], v[44:47]
    ds_write_b64 v137, v[84:85] offset:0
    v_mfma_f32_16x16x32_bf16 v[96:99], v[12:15], v[100:103], 0
    v_exp_f32 v36, v36
    v_mfma_f32_16x16x32_bf16 v[96:99], v[160:163], v[168:171], v[96:99]
    s_nop 0
    v_exp_f32 v37, v37
    v_mfma_f32_16x16x32_bf16 v[92:95], v[72:75], v[8:11], 0
    s_nop 0
    v_cvt_pk_bf16_f32 v6, v44, v45
    v_cvt_pk_bf16_f32 v7, v46, v47
    v_mfma_f32_16x16x32_bf16 v[92:95], v[48:51], v[164:167], v[92:95]
    s_nop 0
    v_mul_f32 v96, v96, v56
    v_mul_f32 v97, v97, v56
    v_mfma_f32_16x16x32_bf16 v[44:47], v[4:7], v[100:103], 0
    v_cvt_pk_bf16_f32 v86, v96, v97
    v_mul_f32 v98, v98, v56
    v_mfma_f32_16x16x32_bf16 v[44:47], v[156:159], v[168:171], v[44:47]
    v_mul_f32 v99, v99, v56
    v_cvt_pk_bf16_f32 v87, v98, v99
    v_mfma_f32_16x16x32_bf16 v[104:107], v[72:75], v[12:15], 0
    ds_write_b64 v137, v[86:87] offset:8
    v_mfma_f32_16x16x32_bf16 v[104:107], v[48:51], v[160:163], v[104:107]
    v_cvt_pk_bf16_f32 v168, v76, v77
    v_cvt_pk_bf16_f32 v169, v78, v79
    v_mfma_f32_16x16x32_bf16 v[100:103], v[72:75], v[4:7], 0
    ds_read_b128 v[72:75], v90 offset:49152
    v_cvt_pk_bf16_f32 v170, v65, 0
    v_mfma_f32_16x16x32_bf16 v[100:103], v[48:51], v[156:159], v[100:103]
    ds_read_b64 v[76:77], v3 offset:49216
    v_mul_f32 v44, v44, v56
    v_mfma_f32_16x16x32_bf16 v[48:51], v[220:223], v[108:111], 0
    ds_read_b128 v[64:67], v2 offset:5248
    v_mul_f32 v45, v45, v56
    v_mfma_f32_16x16x32_bf16 v[48:51], v[220:223], v[168:171], v[48:51]
    ds_read_b128 v[84:87], v90 offset:49920
    v_cvt_pk_bf16_f32 v0, v44, v45
    v_mfma_f32_16x16x32_bf16 v[96:99], v[8:11], v[108:111], 0
    ds_read_b64 v[88:89], v3 offset:49984
    v_mul_f32 v46, v46, v56
    v_mfma_f32_16x16x32_bf16 v[96:99], v[164:167], v[168:171], v[96:99]
    ds_read_b128 v[116:119], v2 offset:5312
    v_mul_f32 v47, v47, v56
    v_mfma_f32_16x16x32_bf16 v[56:59], v[12:15], v[108:111], 0
    ds_read_b128 v[78:81], v90 offset:24576
    v_cvt_pk_bf16_f32 v1, v46, v47
    v_mfma_f32_16x16x32_bf16 v[56:59], v[160:163], v[168:171], v[56:59]
    ds_write_b64 v136, v[0:1] offset:0
    v_mfma_f32_16x16x32_bf16 v[44:47], v[4:7], v[108:111], 0
    v_mov_b32_dpp v95, v107 quad_perm:[0,1,2,3] row_mask:0x2 bank_mask:0xf
    v_cvt_pk_bf16_f32 v17, v82, v83
    v_mfma_f32_16x16x32_bf16 v[44:47], v[156:159], v[168:171], v[44:47]
    s_waitcnt lgkmcnt(5)
    ds_read_b64 v[82:83], v3 offset:24640
    v_mov_b32_dpp v95, v103 quad_perm:[0,1,2,3] row_mask:0x4 bank_mask:0xf
    v_cvt_pk_bf16_f32 v95, v95, v95
    v_rcp_f32 v48, v48
    v_mfma_f32_16x16x16_bf16 v[228:231], v[72:73], v[18:19], v[64:67]
    ds_write_b16 v133, v95 offset:56
    v_mfma_f32_16x16x16_bf16 v[224:227], v[74:75], v[18:19], v[64:67]
    ds_read_b128 v[92:95], v2 offset:256
    v_mul_f32 v96, v96, v48
    v_mfma_f32_16x16x16_bf16 v[108:111], v[76:77], v[18:19], v[64:67]
    s_waitcnt lgkmcnt(5)
    s_nop 0
    ds_read_b128 v[72:75], v90 offset:25344
    v_cvt_pk_bf16_f32 v228, v228, v229
    v_mfma_f32_16x16x16_bf16 v[104:107], v[84:85], v[18:19], v[116:119]
    ds_read_b64 v[76:77], v3 offset:25408
    v_accvgpr_write_b32 a232, v228
    v_mfma_f32_16x16x16_bf16 v[100:103], v[86:87], v[18:19], v[116:119]
    ds_read_b128 v[120:123], v2 offset:320
    v_cvt_pk_bf16_f32 v230, v230, v231
    v_mfma_f32_16x16x16_bf16 v[64:67], v[88:89], v[18:19], v[116:119]
    ds_read_b128 v[84:87], v90 offset:61440
    v_accvgpr_write_b32 a233, v230
    v_cvt_pk_bf16_f32 v224, v224, v225
    v_cvt_pk_bf16_f32 v225, v226, v227
    v_cvt_pk_bf16_f32 v248, v108, v109
    v_cvt_pk_bf16_f32 v249, v110, v111
    v_cvt_pk_bf16_f32 v104, v104, v105
    v_accvgpr_write_b32 a234, v104
    v_cvt_pk_bf16_f32 v106, v106, v107
    v_accvgpr_write_b32 a235, v106
    v_cvt_pk_bf16_f32 v226, v100, v101
    v_cvt_pk_bf16_f32 v227, v102, v103
    v_cvt_pk_bf16_f32 v250, v64, v65
    v_cvt_pk_bf16_f32 v251, v66, v67
    ds_read_b64 v[88:89], v3 offset:61504
    v_mul_f32 v97, v97, v48
    s_waitcnt lgkmcnt(5)
    v_mfma_f32_16x16x16_bf16 v[232:235], v[78:79], v[18:19], v[92:95]
    ds_read_b128 v[64:67], v2 offset:5376
    v_cvt_pk_bf16_f32 v0, v96, v97
    v_mfma_f32_16x16x16_bf16 v[108:111], v[80:81], v[18:19], v[92:95]
    ds_read_b128 v[78:81], v90 offset:62208
    v_mul_f32 v98, v98, v48
    v_mfma_f32_16x16x16_bf16 v[116:119], v[82:83], v[18:19], v[92:95]
    s_waitcnt lgkmcnt(4)
    ds_read_b64 v[82:83], v3 offset:62272
    v_cvt_pk_bf16_f32 v232, v232, v233
    v_mfma_f32_16x16x16_bf16 v[92:95], v[72:73], v[18:19], v[120:123]
    ds_read_b128 v[228:231], v2 offset:5440
    v_accvgpr_write_b32 a224, v232
    v_mfma_f32_16x16x16_bf16 v[104:107], v[74:75], v[18:19], v[120:123]
    ds_read_b128 v[72:75], v90 offset:12288
    v_cvt_pk_bf16_f32 v234, v234, v235
    v_mfma_f32_16x16x16_bf16 v[100:103], v[76:77], v[18:19], v[120:123]
    ds_read_b64 v[76:77], v3 offset:12352
    v_accvgpr_write_b32 a225, v234
    v_cvt_pk_bf16_f32 v108, v108, v109
    v_accvgpr_write_b32 a248, v108
    v_cvt_pk_bf16_f32 v110, v110, v111
    v_accvgpr_write_b32 a249, v110
    v_cvt_pk_bf16_f32 v240, v116, v117
    v_cvt_pk_bf16_f32 v241, v118, v119
    v_cvt_pk_bf16_f32 v92, v92, v93
    v_accvgpr_write_b32 a226, v92
    v_cvt_pk_bf16_f32 v94, v94, v95
    v_accvgpr_write_b32 a227, v94
    v_cvt_pk_bf16_f32 v104, v104, v105
    v_accvgpr_write_b32 a250, v104
    v_cvt_pk_bf16_f32 v106, v106, v107
    s_waitcnt lgkmcnt(5)
    v_mfma_f32_16x16x16_bf16 v[232:235], v[84:85], v[18:19], v[64:67]
    ds_read_b128 v[92:95], v2 offset:128
    v_accvgpr_write_b32 a251, v106
    v_mfma_f32_16x16x16_bf16 v[116:119], v[86:87], v[18:19], v[64:67]
    ds_read_b128 v[84:87], v90 offset:13056
    v_cvt_pk_bf16_f32 v242, v100, v101
    v_mfma_f32_16x16x16_bf16 v[108:111], v[88:89], v[18:19], v[64:67]
    s_waitcnt lgkmcnt(4)
    ds_read_b64 v[88:89], v3 offset:13120
    v_cvt_pk_bf16_f32 v243, v102, v103
    v_mfma_f32_16x16x16_bf16 v[104:107], v[78:79], v[18:19], v[228:231]
    ds_read_b128 v[120:123], v2 offset:192
    v_cvt_pk_bf16_f32 v232, v232, v233
    v_mfma_f32_16x16x16_bf16 v[100:103], v[80:81], v[18:19], v[228:231]
    ds_read_b128 v[78:81], v90 offset:36864
    v_accvgpr_write_b32 a236, v232
    v_mfma_f32_16x16x16_bf16 v[64:67], v[82:83], v[18:19], v[228:231]
    ds_read_b64 v[82:83], v3 offset:36928
    v_cvt_pk_bf16_f32 v234, v234, v235
    v_accvgpr_write_b32 a237, v234
    v_cvt_pk_bf16_f32 v228, v116, v117
    v_cvt_pk_bf16_f32 v229, v118, v119
    v_cvt_pk_bf16_f32 v252, v108, v109
    v_cvt_pk_bf16_f32 v253, v110, v111
    v_cvt_pk_bf16_f32 v104, v104, v105
    v_accvgpr_write_b32 a238, v104
    v_cvt_pk_bf16_f32 v106, v106, v107
    v_accvgpr_write_b32 a239, v106
    v_cvt_pk_bf16_f32 v230, v100, v101
    v_cvt_pk_bf16_f32 v231, v102, v103
    v_cvt_pk_bf16_f32 v254, v64, v65
    v_cvt_pk_bf16_f32 v255, v66, v67
    s_waitcnt lgkmcnt(5)
    v_mfma_f32_16x16x16_bf16 v[108:111], v[72:73], v[18:19], v[92:95]
    ds_read_b128 v[64:67], v2 offset:5120
    v_mul_f32 v99, v99, v48
    v_mfma_f32_16x16x16_bf16 v[116:119], v[74:75], v[18:19], v[92:95]
    ds_read_b128 v[72:75], v90 offset:37632
    v_cvt_pk_bf16_f32 v1, v98, v99
    v_mfma_f32_16x16x16_bf16 v[100:103], v[76:77], v[18:19], v[92:95]
    s_waitcnt lgkmcnt(4)
    ds_read_b64 v[76:77], v3 offset:37696
    v_cvt_pk_bf16_f32 v108, v108, v109
    v_mfma_f32_16x16x16_bf16 v[96:99], v[84:85], v[18:19], v[120:123]
    ds_read_b128 v[232:235], v2 offset:5184
    v_accvgpr_write_b32 a220, v108
    v_mfma_f32_16x16x16_bf16 v[92:95], v[86:87], v[18:19], v[120:123]
    ds_read_b128 v[104:107], v90 offset:0
    v_cvt_pk_bf16_f32 v110, v110, v111
    v_mfma_f32_16x16x16_bf16 v[84:87], v[88:89], v[18:19], v[120:123]
    ds_read_b64 v[108:109], v3 offset:64
    v_accvgpr_write_b32 a221, v110
    v_cvt_pk_bf16_f32 v116, v116, v117
    v_accvgpr_write_b32 a244, v116
    v_cvt_pk_bf16_f32 v118, v118, v119
    v_accvgpr_write_b32 a245, v118
    v_cvt_pk_bf16_f32 v236, v100, v101
    v_cvt_pk_bf16_f32 v237, v102, v103
    v_cvt_pk_bf16_f32 v96, v96, v97
    v_accvgpr_write_b32 a222, v96
    v_cvt_pk_bf16_f32 v98, v98, v99
    v_accvgpr_write_b32 a223, v98
    v_cvt_pk_bf16_f32 v92, v92, v93
    v_accvgpr_write_b32 a246, v92
    v_cvt_pk_bf16_f32 v94, v94, v95
    s_waitcnt lgkmcnt(5)
    v_mfma_f32_16x16x16_bf16 v[120:123], v[78:79], v[18:19], v[64:67]
    ds_read_b128 v[100:103], v2 offset:0
    v_accvgpr_write_b32 a247, v94
    v_mfma_f32_16x16x16_bf16 v[116:119], v[80:81], v[18:19], v[64:67]
    ds_read_b128 v[92:95], v90 offset:768
    v_cvt_pk_bf16_f32 v238, v84, v85
    v_mfma_f32_16x16x16_bf16 v[88:91], v[82:83], v[18:19], v[64:67]
    s_waitcnt lgkmcnt(4)
    ds_read_b64 v[96:97], v3 offset:832
    v_cvt_pk_bf16_f32 v239, v86, v87
    v_mfma_f32_16x16x16_bf16 v[80:83], v[72:73], v[18:19], v[232:235]
    ds_read_b128 v[84:87], v2 offset:64
    v_cvt_pk_bf16_f32 v120, v120, v121
    v_mfma_f32_16x16x16_bf16 v[64:67], v[74:75], v[18:19], v[232:235]
    ds_write_b64 v137, v[0:1] offset:1536
    v_mfma_f32_16x16x16_bf16 v[0:3], v[76:77], v[18:19], v[232:235]
    v_accvgpr_write_b32 a228, v120
    v_cvt_pk_bf16_f32 v122, v122, v123
    v_accvgpr_write_b32 a229, v122
    v_cvt_pk_bf16_f32 v116, v116, v117
    v_accvgpr_write_b32 a252, v116
    v_cvt_pk_bf16_f32 v118, v118, v119
    v_accvgpr_write_b32 a253, v118
    v_cvt_pk_bf16_f32 v244, v88, v89
    v_cvt_pk_bf16_f32 v245, v90, v91
    v_cvt_pk_bf16_f32 v80, v80, v81
    v_accvgpr_write_b32 a230, v80
    v_cvt_pk_bf16_f32 v82, v82, v83
    v_accvgpr_write_b32 a231, v82
    v_cvt_pk_bf16_f32 v64, v64, v65
    s_waitcnt lgkmcnt(4)
    v_mfma_f32_16x16x16_bf16 v[88:91], v[104:105], v[18:19], v[100:103]
    v_accvgpr_write_b32 a254, v64
    v_cvt_pk_bf16_f32 v66, v66, v67
    v_mfma_f32_16x16x16_bf16 v[80:83], v[106:107], v[18:19], v[100:103]
    s_waitcnt vmcnt(5) lgkmcnt(2)
    v_accvgpr_write_b32 a255, v66
    v_cvt_pk_bf16_f32 v246, v0, v1
    v_mfma_f32_16x16x16_bf16 v[76:79], v[108:109], v[18:19], v[100:103]
    s_waitcnt lgkmcnt(1)
    s_barrier
    ds_write_b128 v247, v[112:115] offset:6144
    v_mfma_f32_16x16x16_bf16 v[72:75], v[92:93], v[18:19], v[84:87]
    v_cvt_pk_bf16_f32 v247, v2, v3
    v_cvt_pk_bf16_f32 v88, v88, v89
    v_mfma_f32_16x16x16_bf16 v[64:67], v[94:95], v[18:19], v[84:87]
    v_accvgpr_write_b32 a216, v88
    v_cvt_pk_bf16_f32 v90, v90, v91
    v_mfma_f32_16x16x16_bf16 v[0:3], v[96:97], v[18:19], v[84:87]
    ds_write_b128 v28, v[216:219] offset:80
    v_accvgpr_write_b32 a217, v90
    v_cvt_pk_bf16_f32 v80, v80, v81
    v_accvgpr_write_b32 a240, v80
    v_cvt_pk_bf16_f32 v82, v82, v83
    v_accvgpr_write_b32 a241, v82
    v_cvt_pk_bf16_f32 v232, v76, v77
    v_cvt_pk_bf16_f32 v233, v78, v79
    v_cvt_pk_bf16_f32 v72, v72, v73
    ds_write_b128 v28, v[68:71] offset:0
    v_accvgpr_write_b32 a218, v72
    v_cvt_pk_bf16_f32 v74, v74, v75
    v_accvgpr_write_b32 a219, v74
    v_cvt_pk_bf16_f32 v64, v64, v65
    v_accvgpr_write_b32 a242, v64
    v_cvt_pk_bf16_f32 v66, v66, v67
    v_accvgpr_write_b32 a243, v66
    v_cvt_pk_bf16_f32 v234, v0, v1
    ds_write_b128 v28, v[60:63] offset:16
    v_cvt_pk_bf16_f32 v235, v2, v3
    v_mul_f32 v56, v56, v48
    v_mul_f32 v57, v57, v48
    v_cvt_pk_bf16_f32 v2, v56, v57
    v_mul_f32 v58, v58, v48
    v_mul_f32 v59, v59, v48
    v_cvt_pk_bf16_f32 v3, v58, v59
    v_mul_f32 v44, v44, v48
    ds_write_b128 v28, v[52:55] offset:32
    v_mul_f32 v45, v45, v48
    v_cvt_pk_bf16_f32 v0, v44, v45
    v_mul_f32 v46, v46, v48
    v_mul_f32 v47, v47, v48
    v_cvt_pk_bf16_f32 v1, v46, v47
    v_exp_f32 v38, v38
    v_exp_f32 v39, v39
    ds_write_b128 v28, v[40:43] offset:48
    v_cvt_pk_bf16_f32 v18, v36, v37
    v_cvt_pk_bf16_f32 v19, v38, v39
    v_exp_f32 v24, v24
    v_exp_f32 v25, v25
    v_exp_f32 v26, v26
    ds_write_b128 v28, v[32:35] offset:64
    v_exp_f32 v27, v27
    v_cvt_pk_bf16_f32 v168, v24, v25
    v_cvt_pk_bf16_f32 v169, v26, v27
    v_exp_f32 v22, v22
    s_nop 0
    v_cvt_pk_bf16_f32 v170, v22, 0
    v_mfma_f32_16x16x32_bf16 v[52:55], v[220:223], v[16:19], 0
    ds_read_b128 v[68:71], v139 offset:0
    v_mfma_f32_16x16x32_bf16 v[52:55], v[220:223], v[168:171], v[52:55]
    ds_read_b128 v[64:67], v138 offset:0
    v_mfma_f32_16x16x32_bf16 v[84:87], v[8:11], v[16:19], 0
    ds_read_b128 v[40:43], v139 offset:128
    v_mfma_f32_16x16x32_bf16 v[84:87], v[164:167], v[168:171], v[84:87]
    ds_read_b128 v[8:11], v138 offset:128
    v_mfma_f32_16x16x32_bf16 v[24:27], v[12:15], v[16:19], 0
    ds_read_b128 v[12:15], v139 offset:256
    v_mfma_f32_16x16x32_bf16 v[24:27], v[160:163], v[168:171], v[24:27]
    ds_read_b128 v[92:95], v138 offset:256
    v_mfma_f32_16x16x32_bf16 v[20:23], v[4:7], v[16:19], 0
    ds_write_b64 v137, v[2:3] offset:1544
    v_mfma_f32_16x16x32_bf16 v[20:23], v[156:159], v[168:171], v[20:23]
    s_waitcnt lgkmcnt(6)
    v_mfma_f32_16x16x32_bf16 v[36:39], a[0:3], v[68:71], 0
    s_waitcnt lgkmcnt(0)
.p2align 6
L_loopF0:
    v_mfma_f32_16x16x32_bf16 v[36:39], a[4:7], v[64:67], v[36:39]
    ds_write_b64 v136, v[0:1] offset:1536
    v_mfma_f32_16x16x32_bf16 v[36:39], a[8:11], v[40:43], v[36:39]
    v_rcp_f32 v52, v52
    v_mfma_f32_16x16x32_bf16 v[36:39], a[12:15], v[8:11], v[36:39]
    v_mul_f32 v84, v84, v52
    v_mul_f32 v85, v85, v52
    v_mfma_f32_16x16x32_bf16 v[36:39], a[16:19], v[12:15], v[36:39]
    ds_read_b128 v[96:99], v139 offset:1792
    v_cvt_pk_bf16_f32 v0, v84, v85
    v_mfma_f32_16x16x32_bf16 v[36:39], a[20:23], v[92:95], v[36:39]
    ds_read_b128 v[112:115], v138 offset:1792
    v_mul_f32 v86, v86, v52
    v_mfma_f32_16x16x32_bf16 v[4:7], v[68:71], a[168:171], 0
    ds_read_b128 v[80:83], v138 offset:1536
    v_mul_f32 v87, v87, v52
    v_mfma_f32_16x16x32_bf16 v[4:7], v[64:67], a[172:175], v[4:7]
    v_cvt_pk_bf16_f32 v1, v86, v87
    v_mul_f32 v24, v24, v52
    v_mfma_f32_16x16x32_bf16 v[4:7], v[40:43], a[176:179], v[4:7]
    v_mul_f32 v25, v25, v52
    v_cvt_pk_bf16_f32 v2, v24, v25
    v_mfma_f32_16x16x32_bf16 v[4:7], v[8:11], a[180:183], v[4:7]
    ds_read_b128 v[84:87], v139 offset:1664
    v_mul_f32 v26, v26, v52
    v_mfma_f32_16x16x32_bf16 v[4:7], v[12:15], a[184:187], v[4:7]
    ds_read_b128 v[16:19], v138 offset:1664
    v_mul_f32 v27, v27, v52
    v_mfma_f32_16x16x32_bf16 v[4:7], v[92:95], a[188:191], v[4:7]
    ds_read_b128 v[108:111], v139 offset:1536
    v_cvt_pk_bf16_f32 v3, v26, v27
    v_mfma_f32_16x16x32_bf16 v[24:27], a[48:51], v[68:71], 0
    v_mul_f32 v20, v20, v52
    v_mul_f32 v21, v21, v52
    v_mfma_f32_16x16x32_bf16 v[24:27], a[52:55], v[64:67], v[24:27]
    v_cvt_pk_bf16_f32 v150, v20, v21
    v_mul_f32 v22, v22, v52
    v_mfma_f32_16x16x32_bf16 v[24:27], a[56:59], v[40:43], v[24:27]
    v_mul_f32 v23, v23, v52
    v_cvt_pk_bf16_f32 v151, v22, v23
    v_mfma_f32_16x16x32_bf16 v[24:27], a[60:63], v[8:11], v[24:27]
    ds_write_b64 v137, v[0:1] offset:3072
    v_mfma_f32_16x16x32_bf16 v[24:27], a[64:67], v[12:15], v[24:27]
    v_cvt_pk_bf16_f32 v20, v4, v5
    v_cvt_pk_bf16_f32 v21, v6, v7
    v_mfma_f32_16x16x32_bf16 v[24:27], a[68:71], v[92:95], v[24:27]
    v_fmac_f32 v154, v34, v34
    v_fmac_f32 v154, v35, v35
    v_mfma_f32_16x16x32_bf16 v[4:7], a[120:123], v[68:71], 0
    v_fmac_f32 v154, v104, v104
    v_fmac_f32 v154, v105, v105
    v_mfma_f32_16x16x32_bf16 v[4:7], a[124:127], v[64:67], v[4:7]
    ds_write_b64 v137, v[2:3] offset:3080
    v_mfma_f32_16x16x32_bf16 v[4:7], a[128:131], v[40:43], v[4:7]
    v_fmac_f32 v154, v106, v106
    v_fmac_f32 v154, v107, v107
    v_mfma_f32_16x16x32_bf16 v[4:7], a[132:135], v[8:11], v[4:7]
    v_fma_f32 v155, v44, v44, s42
    v_fmac_f32 v155, v45, v45
    v_mfma_f32_16x16x32_bf16 v[4:7], a[136:139], v[12:15], v[4:7]
    v_fmac_f32 v155, v46, v46
    v_fmac_f32 v155, v47, v47
    v_mfma_f32_16x16x32_bf16 v[4:7], a[140:143], v[92:95], v[4:7]
    ds_write_b64 v136, v[150:151] offset:3072
    v_mfma_f32_16x16x32_bf16 v[0:3], a[24:27], v[68:71], 0
    v_fmac_f32 v155, v60, v60
    v_fmac_f32 v155, v61, v61
    v_mfma_f32_16x16x32_bf16 v[0:3], a[28:31], v[64:67], v[0:3]
    v_fmac_f32 v155, v62, v62
    v_fmac_f32 v155, v63, v63
    v_mfma_f32_16x16x32_bf16 v[0:3], a[32:35], v[40:43], v[0:3]
    v_fmac_f32 v155, v48, v48
    v_fmac_f32 v155, v49, v49
    v_mfma_f32_16x16x32_bf16 v[0:3], a[36:39], v[8:11], v[0:3]
    v_fmac_f32 v155, v50, v50
    v_fmac_f32 v155, v51, v51
    v_mfma_f32_16x16x32_bf16 v[0:3], a[40:43], v[12:15], v[0:3]
    v_fma_f32 v150, v76, v76, s42
    v_fmac_f32 v150, v77, v77
    v_mfma_f32_16x16x32_bf16 v[0:3], a[44:47], v[92:95], v[0:3]
    v_fmac_f32 v150, v78, v78
    v_fmac_f32 v150, v79, v79
    v_mfma_f32_16x16x32_bf16 v[28:31], v[68:71], a[144:147], 0
    v_fmac_f32 v150, v100, v100
    v_fmac_f32 v150, v101, v101
    v_mfma_f32_16x16x32_bf16 v[28:31], v[64:67], a[148:151], v[28:31]
    v_fmac_f32 v150, v102, v102
    v_fmac_f32 v150, v103, v103
    v_mfma_f32_16x16x32_bf16 v[28:31], v[40:43], a[152:155], v[28:31]
    s_waitcnt vmcnt(10)
    v_fmac_f32 v150, v88, v88
    v_fmac_f32 v150, v89, v89
    v_mfma_f32_16x16x32_bf16 v[28:31], v[8:11], a[156:159], v[28:31]
    v_fmac_f32 v150, v90, v90
    v_fmac_f32 v150, v91, v91
    v_mfma_f32_16x16x32_bf16 v[28:31], v[12:15], a[160:163], v[28:31]
    v_cvt_pk_bf16_f32 v154, v154, v155
    v_cvt_pk_bf16_f32 v155, v150, v124
    v_mfma_f32_16x16x32_bf16 v[28:31], v[92:95], a[164:167], v[28:31]
    ds_write_b64 v132, v[154:155]
    v_mfma_f32_16x16x32_bf16 v[56:59], a[72:75], v[68:71], 0
    v_add_u32 v137, s49, v137
    v_add_u32 v136, s49, v136
    v_mfma_f32_16x16x32_bf16 v[56:59], a[76:79], v[64:67], v[56:59]
    v_cvt_pk_f16_f32 v36, v36, v37
    v_cvt_pk_f16_f32 v37, v38, v39
    v_mfma_f32_16x16x32_bf16 v[56:59], a[80:83], v[40:43], v[56:59]
    v_pk_fma_f16 v52, v36, v36, s39
    v_pk_fmac_f16 v52, v37, v37
    v_mfma_f32_16x16x32_bf16 v[56:59], a[84:87], v[8:11], v[56:59]
    v_cvt_pk_f16_f32 v4, v4, v5
    v_cvt_pk_f16_f32 v5, v6, v7
    v_mfma_f32_16x16x32_bf16 v[56:59], a[88:91], v[12:15], v[56:59]
    v_cvt_pk_f16_f32 v38, v0, v1
    v_cvt_pk_f16_f32 v39, v2, v3
    v_mfma_f32_16x16x32_bf16 v[56:59], a[92:95], v[92:95], v[56:59]
    v_pk_fmac_f16 v52, v38, v38
    v_pk_fmac_f16 v52, v39, v39
    v_mfma_f32_16x16x32_bf16 v[116:119], a[96:99], v[68:71], 0
    v_cvt_pk_f16_f32 v154, v24, v25
    v_cvt_pk_f16_f32 v155, v26, v27
    v_mfma_f32_16x16x32_bf16 v[116:119], a[100:103], v[64:67], v[116:119]
    s_waitcnt lgkmcnt(0)
    v_pk_fmac_f16 v52, v154, v154
    v_pk_fmac_f16 v52, v155, v155
    v_mfma_f32_16x16x32_bf16 v[116:119], a[104:107], v[40:43], v[116:119]
    s_barrier
    ds_read_b128 v[120:123], v131 offset:0
    v_cvt_pk_f16_f32 v0, v56, v57
    v_mfma_f32_16x16x32_bf16 v[116:119], a[108:111], v[8:11], v[116:119]
    ds_read_b128 v[54:57], v131 offset:1024
    v_cvt_pk_f16_f32 v1, v58, v59
    v_mfma_f32_16x16x32_bf16 v[116:119], a[112:115], v[12:15], v[116:119]
    v_pk_fma_f16 v53, v0, v0, s39
    v_pk_fmac_f16 v53, v1, v1
    v_mfma_f32_16x16x32_bf16 v[116:119], a[116:119], v[92:95], v[116:119]
    v_cvt_pk_bf16_f32 v24, v28, v29
    v_cvt_pk_bf16_f32 v25, v30, v31
    v_mfma_f32_16x16x32_bf16 v[28:31], v[68:71], a[192:195], 0
    s_nop 2
    v_mfma_f32_16x16x32_bf16 v[28:31], v[64:67], a[196:199], v[28:31]
    s_nop 0
    v_cvt_pk_f16_f32 v2, v116, v117
    v_cvt_pk_f16_f32 v3, v118, v119
    v_mfma_f32_16x16x32_bf16 v[28:31], v[40:43], a[200:203], v[28:31]
    v_pk_fmac_f16 v53, v2, v2
    v_pk_fmac_f16 v53, v3, v3
    v_mfma_f32_16x16x32_bf16 v[28:31], v[8:11], a[204:207], v[28:31]
    v_pk_fmac_f16 v53, v4, v4
    v_pk_fmac_f16 v53, v5, v5
    v_mfma_f32_16x16x32_bf16 v[28:31], v[12:15], a[208:211], v[28:31]
    v_mfma_f32_16x16x32_bf16 v[28:31], v[92:95], a[212:215], v[28:31]
    s_waitcnt lgkmcnt(1)
    v_readfirstlane_b32 s12, v121
    v_mfma_f32_16x16x32_bf16 v[12:15], v[216:219], v[120:123], 0
    s_waitcnt lgkmcnt(0)
    s_nop 1
    v_mfma_f32_16x16x32_bf16 v[12:15], v[216:219], v[54:57], v[12:15]
    s_lshr_b32 s12, s12, 23
    v_cvt_pk_bf16_f32 v28, v28, v29
    v_cvt_pk_bf16_f32 v29, v30, v31
    v_mfma_f32_16x16x32_bf16 v[68:71], a[96:99], v[108:111], 0
    s_nop 1
    v_mfma_f32_16x16x32_bf16 v[68:71], a[100:103], v[80:83], v[68:71]
    s_nop 0
    v_rsq_f32 v12, v12
    v_mfma_f32_16x16x32_bf16 v[68:71], a[104:107], v[84:87], v[68:71]
    v_rsq_f32 v13, v13
    v_mfma_f32_16x16x32_bf16 v[68:71], a[108:111], v[16:19], v[68:71]
    v_rsq_f32 v14, v14
    v_mfma_f32_16x16x32_bf16 v[68:71], a[112:115], v[96:99], v[68:71]
    v_mul_f32 v12, s43, v12
    v_mul_f32 v13, s43, v13
    v_mfma_f32_16x16x32_bf16 v[68:71], a[116:119], v[112:115], v[68:71]
    v_mul_f32 v44, v44, v13
    v_mul_f32 v45, v45, v13
    v_mfma_f32_16x16x32_bf16 v[54:57], v[108:111], a[168:171], 0
    v_cvt_pk_bf16_f32 v44, v44, v45
    v_mul_f32 v46, v46, v13
    v_mfma_f32_16x16x32_bf16 v[54:57], v[80:83], a[172:175], v[54:57]
    v_mul_f32 v47, v47, v13
    v_cvt_pk_bf16_f32 v45, v46, v47
    v_mfma_f32_16x16x32_bf16 v[54:57], v[84:87], a[176:179], v[54:57]
    ds_write_b64 v137, v[44:45] offset:1536
    v_mfma_f32_16x16x32_bf16 v[54:57], v[16:19], a[180:183], v[54:57]
    v_mul_f32 v60, v60, v13
    v_mul_f32 v61, v61, v13
    v_mfma_f32_16x16x32_bf16 v[54:57], v[96:99], a[184:187], v[54:57]
    v_cvt_pk_bf16_f32 v46, v60, v61
    v_mul_f32 v62, v62, v13
    v_mfma_f32_16x16x32_bf16 v[54:57], v[112:115], a[188:191], v[54:57]
    v_mul_f32 v63, v63, v13
    v_cvt_pk_bf16_f32 v47, v62, v63
    v_mfma_f32_16x16x32_bf16 v[60:63], a[48:51], v[108:111], 0
    ds_write_b64 v137, v[46:47] offset:1544
    v_mfma_f32_16x16x32_bf16 v[60:63], a[52:55], v[80:83], v[60:63]
    v_mul_f32 v48, v48, v13
    v_mul_f32 v49, v49, v13
    v_mfma_f32_16x16x32_bf16 v[60:63], a[56:59], v[84:87], v[60:63]
    v_cvt_pk_bf16_f32 v150, v48, v49
    v_mul_f32 v50, v50, v13
    v_mfma_f32_16x16x32_bf16 v[60:63], a[60:63], v[16:19], v[60:63]
    v_mul_f32 v51, v51, v13
    v_cvt_pk_bf16_f32 v151, v50, v51
    v_mfma_f32_16x16x32_bf16 v[60:63], a[64:67], v[96:99], v[60:63]
    s_sub_u32 s50, s45, s44
    ds_write_b64 v136, v[150:151] offset:1536
    v_mfma_f32_16x16x32_bf16 v[60:63], a[68:71], v[112:115], v[60:63]
    s_sub_u32 s51, s46, s47
    v_mul_f32 v14, s43, v14
    v_cvt_pk_f16_f32 v8, v68, v69
    v_mfma_f32_16x16x32_bf16 v[92:95], a[24:27], v[108:111], 0
    s_mov_b32 s60, s59
    v_cvt_pk_f16_f32 v9, v70, v71
    v_mul_f32 v72, v72, v12
    v_mfma_f32_16x16x32_bf16 v[92:95], a[28:31], v[80:83], v[92:95]
    s_mov_b32 s59, s58
    ds_read_b128 v[68:71], v138 offset:3072
    v_cvt_pk_f16_f32 v150, v60, v61
    v_mfma_f32_16x16x32_bf16 v[92:95], a[32:35], v[84:87], v[92:95]
    s_mov_b32 s58, s57
    ds_read_b128 v[44:47], v139 offset:3200
    v_cvt_pk_f16_f32 v151, v62, v63
    v_mfma_f32_16x16x32_bf16 v[92:95], a[36:39], v[16:19], v[92:95]
    s_mov_b32 s57, s56
    ds_read_b128 v[60:63], v138 offset:3200
    v_mul_f32 v73, v73, v12
    v_mfma_f32_16x16x32_bf16 v[92:95], a[40:43], v[96:99], v[92:95]
    s_mov_b32 s7, s6
    ds_read_b128 v[64:67], v139 offset:3328
    v_cvt_pk_bf16_f32 v72, v72, v73
    v_mfma_f32_16x16x32_bf16 v[92:95], a[44:47], v[112:115], v[92:95]
    s_mov_b32 s6, s5
    ds_read_b128 v[48:51], v138 offset:3328
    v_mul_f32 v74, v74, v12
    v_mfma_f32_16x16x32_bf16 v[116:119], a[72:75], v[108:111], 0
    s_mov_b32 s5, s4
    v_mul_f32 v75, v75, v12
    v_cvt_pk_bf16_f32 v73, v74, v75
    v_mfma_f32_16x16x32_bf16 v[116:119], a[76:79], v[80:83], v[116:119]
    s_sub_u32 s14, s6, s7
    v_mul_f32 v32, v32, v12
    v_mul_f32 v33, v33, v12
    v_mfma_f32_16x16x32_bf16 v[116:119], a[80:83], v[84:87], v[116:119]
    s_add_u32 s61, s61, 1
    v_cvt_pk_bf16_f32 v74, v32, v33
    v_mul_f32 v34, v34, v12
    v_mfma_f32_16x16x32_bf16 v[116:119], a[84:87], v[16:19], v[116:119]
    s_add_u32 s12, s12, 20
    ds_write_b64 v137, v[72:73] offset:0
    v_mfma_f32_16x16x32_bf16 v[116:119], a[88:91], v[96:99], v[116:119]
    s_max_u32 s12, s12, s61
    v_mul_f32 v35, v35, v12
    v_cvt_pk_bf16_f32 v75, v34, v35
    v_mfma_f32_16x16x32_bf16 v[116:119], a[92:95], v[112:115], v[116:119]
    s_cmp_lt_u32 s61, s71
    v_mul_f32 v104, v104, v12
    v_mul_f32 v105, v105, v12
    v_mfma_f32_16x16x32_bf16 v[30:33], a[120:123], v[108:111], 0
    s_cselect_b32 s15, s61, s12
    v_cvt_pk_bf16_f32 v6, v104, v105
    v_mul_f32 v106, v106, v12
    v_mfma_f32_16x16x32_bf16 v[30:33], a[124:127], v[80:83], v[30:33]
    s_cselect_b32 s56, s69, s70
    ds_write_b64 v137, v[74:75] offset:8
    v_mfma_f32_16x16x32_bf16 v[30:33], a[128:131], v[84:87], v[30:33]
    s_add_u32 s56, s56, s15
    v_mul_f32 v107, v107, v12
    v_cvt_pk_bf16_f32 v7, v106, v107
    v_mfma_f32_16x16x32_bf16 v[30:33], a[132:135], v[16:19], v[30:33]
    s_mul_i32 s53, s56, 58255
    v_cvt_pk_f16_f32 v42, v92, v93
    v_cvt_pk_f16_f32 v43, v94, v95
    v_mfma_f32_16x16x32_bf16 v[30:33], a[136:139], v[96:99], v[30:33]
    s_lshr_b32 s53, s53, 22
    v_cvt_pk_bf16_f32 v22, v54, v55
    v_cvt_pk_bf16_f32 v23, v56, v57
    v_mfma_f32_16x16x32_bf16 v[30:33], a[140:143], v[112:115], v[30:33]
    s_mul_i32 s53, s53, s63
    ds_write_b64 v136, v[6:7] offset:0
    v_mfma_f32_16x16x32_bf16 v[56:59], a[0:3], v[108:111], 0
    s_mul_i32 s56, s56, s62
    v_cvt_pk_f16_f32 v6, v116, v117
    v_cvt_pk_f16_f32 v7, v118, v119
    v_mfma_f32_16x16x32_bf16 v[56:59], a[4:7], v[80:83], v[56:59]
    s_add_u32 s56, s56, s53
    v_cvt_pk_f16_f32 v10, v30, v31
    v_cvt_pk_f16_f32 v11, v32, v33
    v_mfma_f32_16x16x32_bf16 v[56:59], a[8:11], v[84:87], v[56:59]
    s_mul_i32 s4, s15, 336
    ds_read_b128 v[72:75], v139 offset:3072
    v_pk_fma_f16 v55, v6, v6, s39
    v_mfma_f32_16x16x32_bf16 v[56:59], a[12:15], v[16:19], v[56:59]
    s_cmp_ge_u32 s15, 16
    v_pk_fmac_f16 v55, v7, v7
    v_pk_fmac_f16 v55, v8, v8
    v_mfma_f32_16x16x32_bf16 v[56:59], a[16:19], v[96:99], v[56:59]
    s_cselect_b32 s53, -26880, 0
    v_pk_fmac_f16 v55, v9, v9
    v_pk_fmac_f16 v55, v10, v10
    v_mfma_f32_16x16x32_bf16 v[56:59], a[20:23], v[112:115], v[56:59]
    s_add_u32 s4, s4, s53
    v_pk_fmac_f16 v55, v11, v11
    v_mul_f32 v76, v76, v14
    v_mfma_f32_16x16x32_bf16 v[92:95], v[108:111], a[144:147], 0
    s_cmp_lt_u32 s15, s73
    v_mul_f32 v77, v77, v14
    v_cvt_pk_bf16_f32 v76, v76, v77
    v_mfma_f32_16x16x32_bf16 v[92:95], v[80:83], a[148:151], v[92:95]
    s_cselect_b32 s26, 100270464, 0
    v_cvt_pk_f16_f32 v40, v56, v57
    v_cvt_pk_f16_f32 v41, v58, v59
    v_mfma_f32_16x16x32_bf16 v[92:95], v[84:87], a[152:155], v[92:95]
    s_cselect_b32 s56, s56, 0
    v_pk_fma_f16 v54, v40, v40, s39
    v_pk_fmac_f16 v54, v41, v41
    v_mfma_f32_16x16x32_bf16 v[92:95], v[16:19], a[156:159], v[92:95]
    s_cselect_b32 s4, s4, -1
    v_pk_fmac_f16 v54, v42, v42
    v_pk_fmac_f16 v54, v43, v43
    v_mfma_f32_16x16x32_bf16 v[92:95], v[96:99], a[160:163], v[92:95]
    s_cselect_b32 s15, s15, 0
    v_pk_fmac_f16 v54, v150, v150
    v_pk_fmac_f16 v54, v151, v151
    v_mfma_f32_16x16x32_bf16 v[92:95], v[112:115], a[164:167], v[92:95]
    s_cselect_b32 s13, s13, -1
    v_mul_f32 v78, v78, v14
    v_mul_f32 v79, v79, v14
    v_mfma_f32_16x16x32_f16 v[104:107], v[212:215], v[52:55], 0
    s_waitcnt lgkmcnt(0)
    v_cvt_pk_bf16_f32 v77, v78, v79
    v_mul_f32 v100, v100, v14
    v_mfma_f32_16x16x32_bf16 v[56:59], a[72:75], v[72:75], 0
    s_add_u32 s65, s65, 1
    v_cvt_pk_bf16_f32 v26, v92, v93
    v_cvt_pk_bf16_f32 v27, v94, v95
    v_mfma_f32_16x16x32_bf16 v[56:59], a[76:79], v[68:71], v[56:59]
    s_cmp_ge_i32 s65, 2
    v_or3_b32 v125, v125, v104, v105
    v_or3_b32 v125, v125, v106, v107
    v_mfma_f32_16x16x32_bf16 v[56:59], a[80:83], v[44:47], v[56:59]
    s_cselect_b32 s30, 100270464, 0
    v_rsq_f32 v104, v104
    v_mfma_f32_16x16x32_bf16 v[56:59], a[84:87], v[60:63], v[56:59]
    s_add_u32 s67, s46, s54
    v_rsq_f32 v105, v105
    v_mfma_f32_16x16x32_bf16 v[56:59], a[88:91], v[64:67], v[56:59]
    s_add_u32 m0, s67, 0
    v_mul_f32 v104, s52, v104
    v_cvt_pk_f16_f32 v104, v104, v105
    v_mfma_f32_16x16x32_bf16 v[56:59], a[92:95], v[48:51], v[56:59]
    s_bitset1_b32 s64, s15
    v_rsq_f32 v106, v106
    v_mfma_f32_16x16x32_bf16 v[92:95], a[0:3], v[72:75], 0
    v_rsq_f32 v107, v107
    v_mfma_f32_16x16x32_bf16 v[92:95], a[4:7], v[68:71], v[92:95]
    v_mul_f32 v106, s52, v106
    v_cvt_pk_f16_f32 v106, v106, v107
    v_mfma_f32_16x16x32_bf16 v[92:95], a[8:11], v[44:47], v[92:95]
    v_pk_mul_f16 v0, v0, v104 op_sel:[0,1] op_sel_hi:[1,1]
    v_pk_mul_f16 v1, v1, v104 op_sel:[0,1] op_sel_hi:[1,1]
    v_mfma_f32_16x16x32_bf16 v[92:95], a[12:15], v[60:63], v[92:95]
    v_pk_mul_f16 v2, v2, v104 op_sel:[0,1] op_sel_hi:[1,1]
    v_pk_mul_f16 v3, v3, v104 op_sel:[0,1] op_sel_hi:[1,1]
    v_mfma_f32_16x16x32_bf16 v[92:95], a[16:19], v[64:67], v[92:95]
    v_pk_mul_f16 v4, v4, v104 op_sel:[0,1] op_sel_hi:[1,1]
    v_pk_mul_f16 v5, v5, v104 op_sel:[0,1] op_sel_hi:[1,1]
    v_mfma_f32_16x16x32_bf16 v[92:95], a[20:23], v[48:51], v[92:95]
    v_cvt_pk_f16_f32 v12, v56, v57
    v_cvt_pk_f16_f32 v13, v58, v59
    v_mfma_f32_16x16x32_bf16 v[30:33], a[48:51], v[72:75], 0
    s_nop 0
    v_pk_fma_f16 v53, v12, v12, s39
    v_pk_fmac_f16 v53, v13, v13
    v_mfma_f32_16x16x32_bf16 v[30:33], a[52:55], v[68:71], v[30:33]
    s_nop 0
    v_cvt_pk_f16_f32 v56, v92, v93
    v_cvt_pk_f16_f32 v57, v94, v95
    v_mfma_f32_16x16x32_bf16 v[30:33], a[56:59], v[44:47], v[30:33]
    v_pk_fma_f16 v52, v56, v56, s39
    v_pk_fmac_f16 v52, v57, v57
    v_mfma_f32_16x16x32_bf16 v[30:33], a[60:63], v[60:63], v[30:33]
    v_pk_mul_f16 v6, v6, v106 op_sel:[0,1] op_sel_hi:[1,1]
    v_pk_mul_f16 v7, v7, v106 op_sel:[0,1] op_sel_hi:[1,1]
    v_mfma_f32_16x16x32_bf16 v[30:33], a[64:67], v[64:67], v[30:33]
    v_pk_mul_f16 v8, v8, v106 op_sel:[0,1] op_sel_hi:[1,1]
    v_pk_mul_f16 v9, v9, v106 op_sel:[0,1] op_sel_hi:[1,1]
    v_mfma_f32_16x16x32_bf16 v[30:33], a[68:71], v[48:51], v[30:33]
    v_pk_mul_f16 v10, v10, v106 op_sel:[0,1] op_sel_hi:[1,1]
    v_pk_mul_f16 v11, v11, v106 op_sel:[0,1] op_sel_hi:[1,1]
    v_mfma_f32_16x16x32_bf16 v[116:119], v[72:75], a[144:147], 0
    v_pk_mul_f16 v36, v36, v104 op_sel:[0,0] op_sel_hi:[1,0]
    v_pk_mul_f16 v37, v37, v104 op_sel:[0,0] op_sel_hi:[1,0]
    v_mfma_f32_16x16x32_bf16 v[116:119], v[68:71], a[148:151], v[116:119]
    v_pk_mul_f16 v38, v38, v104 op_sel:[0,0] op_sel_hi:[1,0]
    v_pk_mul_f16 v39, v39, v104 op_sel:[0,0] op_sel_hi:[1,0]
    v_mfma_f32_16x16x32_bf16 v[116:119], v[44:47], a[152:155], v[116:119]
    v_pk_mul_f16 v154, v154, v104 op_sel:[0,0] op_sel_hi:[1,0]
    v_pk_mul_f16 v155, v155, v104 op_sel:[0,0] op_sel_hi:[1,0]
    v_mfma_f32_16x16x32_bf16 v[116:119], v[60:63], a[156:159], v[116:119]
    v_cvt_pk_f16_f32 v146, v30, v31
    v_cvt_pk_f16_f32 v147, v32, v33
    v_mfma_f32_16x16x32_bf16 v[116:119], v[64:67], a[160:163], v[116:119]
    v_mul_f32 v101, v101, v14
    v_cvt_pk_bf16_f32 v78, v100, v101
    v_mfma_f32_16x16x32_bf16 v[116:119], v[48:51], a[164:167], v[116:119]
    ds_write_b64 v137, v[76:77] offset:3072
    v_mfma_f32_16x16x32_bf16 v[92:95], v[108:111], a[192:195], 0
    v_mul_f32 v102, v102, v14
    v_mul_f32 v103, v103, v14
    v_mfma_f32_16x16x32_bf16 v[92:95], v[80:83], a[196:199], v[92:95]
    v_cvt_pk_bf16_f32 v79, v102, v103
    v_mul_f32 v88, v88, v14
    v_mfma_f32_16x16x32_bf16 v[92:95], v[84:87], a[200:203], v[92:95]
    v_mul_f32 v89, v89, v14
    v_cvt_pk_bf16_f32 v88, v88, v89
    v_mfma_f32_16x16x32_bf16 v[92:95], v[16:19], a[204:207], v[92:95]
    ds_write_b64 v137, v[78:79] offset:3080
    v_mfma_f32_16x16x32_bf16 v[92:95], v[96:99], a[208:211], v[92:95]
    v_mul_f32 v90, v90, v14
    v_mul_f32 v91, v91, v14
    v_mfma_f32_16x16x32_bf16 v[92:95], v[112:115], a[212:215], v[92:95]
    v_cvt_pk_bf16_f32 v89, v90, v91
    v_add_u32 v139, s50, v139
    v_mfma_f32_16x16x32_bf16 v[96:99], a[120:123], v[72:75], 0
    s_nop 0
    ds_read_b128 v[76:79], v139 offset:0
    v_add_u32 v138, s50, v138
    v_mfma_f32_16x16x32_bf16 v[96:99], a[124:127], v[68:71], v[96:99]
    s_nop 0
    v_cvt_pk_bf16_f32 v30, v92, v93
    v_cvt_pk_bf16_f32 v31, v94, v95
    v_mfma_f32_16x16x32_bf16 v[96:99], a[128:131], v[44:47], v[96:99]
    v_add_u32 v137, s48, v137
    v_add_u32 v135, s51, v135
    v_mfma_f32_16x16x32_bf16 v[96:99], a[132:135], v[60:63], v[96:99]
    v_add_u32 v134, s14, v134
    v_add_u32 v133, s14, v133
    v_mfma_f32_16x16x32_bf16 v[96:99], a[136:139], v[64:67], v[96:99]
    ds_write_b64 v136, v[88:89] offset:3072
    v_mfma_f32_16x16x32_bf16 v[96:99], a[140:143], v[48:51], v[96:99]
    s_waitcnt vmcnt(0)
    v_add_u32 v136, s48, v136
    v_pk_mul_f16 v40, v40, v106 op_sel:[0,0] op_sel_hi:[1,0]
    v_mfma_f32_16x16x32_bf16 v[80:83], v[72:75], a[168:171], 0
    v_pk_mul_f16 v41, v41, v106 op_sel:[0,0] op_sel_hi:[1,0]
    v_pk_mul_f16 v42, v42, v106 op_sel:[0,0] op_sel_hi:[1,0]
    v_mfma_f32_16x16x32_bf16 v[80:83], v[68:71], a[172:175], v[80:83]
    ds_read_b128 v[92:95], v138 offset:0
    v_cvt_pk_f16_f32 v16, v96, v97
    v_mfma_f32_16x16x32_bf16 v[80:83], v[44:47], a[176:179], v[80:83]
    ds_read_b128 v[84:87], v139 offset:128
    v_cvt_pk_f16_f32 v17, v98, v99
    v_mfma_f32_16x16x32_bf16 v[80:83], v[60:63], a[180:183], v[80:83]
    ds_read_b128 v[96:99], v138 offset:128
    v_pk_mul_f16 v43, v43, v106 op_sel:[0,0] op_sel_hi:[1,0]
    v_mfma_f32_16x16x32_bf16 v[80:83], v[64:67], a[184:187], v[80:83]
    ds_read_b128 v[100:103], v139 offset:256
    v_pk_mul_f16 v150, v150, v106 op_sel:[0,0] op_sel_hi:[1,0]
    v_mfma_f32_16x16x32_bf16 v[80:83], v[48:51], a[188:191], v[80:83]
    ds_read_b128 v[88:91], v138 offset:256
    v_pk_mul_f16 v151, v151, v106 op_sel:[0,0] op_sel_hi:[1,0]
    v_mfma_f32_16x16x32_bf16 v[32:35], a[24:27], v[72:75], 0
    s_waitcnt lgkmcnt(5)
    v_cvt_pk_bf16_f32 v164, v116, v117
    v_cvt_pk_bf16_f32 v165, v118, v119
    v_mfma_f32_16x16x32_bf16 v[32:35], a[28:31], v[68:71], v[32:35]
    s_barrier
    ds_read_b128 v[112:115], v135 offset:0
    v_cvt_pk_bf16_f32 v160, v80, v81
    v_mfma_f32_16x16x32_bf16 v[32:35], a[32:35], v[44:47], v[32:35]
    s_cmp_ge_u32 s61, s13
    ds_read_b128 v[104:107], v135 offset:1024
    v_cvt_pk_bf16_f32 v161, v82, v83
    v_mfma_f32_16x16x32_bf16 v[32:35], a[36:39], v[60:63], v[32:35]
    s_cbranch_scc1 L_atomF0
L_atomrF0:
    v_mfma_f32_16x16x32_bf16 v[32:35], a[40:43], v[64:67], v[32:35]
    ds_read_b128 v[80:83], v135 offset:3072
    v_mfma_f32_16x16x32_bf16 v[32:35], a[44:47], v[48:51], v[32:35]
    s_nop 1
    v_mfma_f32_16x16x32_bf16 v[108:111], a[96:99], v[72:75], 0
    s_nop 2
    v_mfma_f32_16x16x32_bf16 v[108:111], a[100:103], v[68:71], v[108:111]
    s_nop 0
    v_cvt_pk_f16_f32 v58, v32, v33
    v_cvt_pk_f16_f32 v59, v34, v35
    v_mfma_f32_16x16x32_bf16 v[108:111], a[104:107], v[44:47], v[108:111]
    v_pk_fmac_f16 v52, v58, v58
    v_pk_fmac_f16 v52, v59, v59
    v_mfma_f32_16x16x32_bf16 v[108:111], a[108:111], v[60:63], v[108:111]
    v_pk_fmac_f16 v52, v146, v146
    v_pk_fmac_f16 v52, v147, v147
    v_mfma_f32_16x16x32_bf16 v[108:111], a[112:115], v[64:67], v[108:111]
    s_waitcnt lgkmcnt(2)
    buffer_load_dwordx4 v130, s[24:27], s56 offen nt lds
    v_mfma_f32_16x16x32_bf16 v[108:111], a[116:119], v[48:51], v[108:111]
    s_nop 1
    v_mfma_f32_16x16x32_bf16 v[32:35], a[240:243], v[76:79], 0
    s_nop 2
    v_mfma_f32_16x16x32_bf16 v[32:35], a[244:247], v[92:95], v[32:35]
    s_nop 0
    v_cvt_pk_f16_f32 v14, v108, v109
    v_cvt_pk_f16_f32 v15, v110, v111
    v_mfma_f32_16x16x32_bf16 v[32:35], a[248:251], v[84:87], v[32:35]
    ds_read_b128 v[108:111], v135 offset:2048
    v_pk_fmac_f16 v53, v14, v14
    v_mfma_f32_16x16x32_bf16 v[32:35], a[252:255], v[96:99], v[32:35]
    v_pk_fmac_f16 v53, v15, v15
    v_pk_fmac_f16 v53, v16, v16
    v_mfma_f32_16x16x32_bf16 v[32:35], v[224:227], v[100:103], v[32:35]
    v_pk_fmac_f16 v53, v17, v17
    v_mfma_f32_16x16x32_bf16 v[32:35], v[228:231], v[88:91], v[32:35]
    buffer_store_dwordx4 v[112:115], v130, s[28:31], s60 offen sc1
    s_nop 1
    v_mfma_f32_16x16x32_f16 v[112:115], v[212:215], v[52:55], 0
    s_add_u32 m0, s67, 1024
    s_nop 0
    v_mfma_f32_16x16x32_bf16 v[52:55], v[72:75], a[192:195], 0
    s_nop 2
    v_mfma_f32_16x16x32_bf16 v[52:55], v[68:71], a[196:199], v[52:55]
    s_nop 0
    v_or3_b32 v125, v125, v112, v113
    v_mfma_f32_16x16x32_bf16 v[52:55], v[44:47], a[200:203], v[52:55]
    s_waitcnt lgkmcnt(1)
    buffer_load_dwordx4 v129, s[24:27], s56 offen nt lds
    v_mfma_f32_16x16x32_bf16 v[52:55], v[60:63], a[204:207], v[52:55]
    ds_read_u16 v166, v133 offset:56
    v_mfma_f32_16x16x32_bf16 v[52:55], v[64:67], a[208:211], v[52:55]
    ds_read_u16 v158, v133 offset:72
    v_mfma_f32_16x16x32_bf16 v[52:55], v[48:51], a[212:215], v[52:55]
    ds_read_u16 v162, v133 offset:64
    v_mfma_f32_16x16x32_f16 v[68:71], v[6:9], v[36:39], v[200:203]
    s_nop 0
    ds_read_b128 v[44:47], v135 offset:4096
    s_nop 0
    v_mfma_f32_16x16x32_f16 v[68:71], v[8:11], v[152:155], v[68:71]
    s_nop 0
    ds_read_b128 v[48:51], v134 offset:32
    v_cvt_pk_bf16_f32 v156, v52, v53
    v_mfma_f32_16x16x32_bf16 v[72:75], a[216:219], v[76:79], 0
    ds_read_b128 v[60:63], v134 offset:0
    v_cvt_pk_bf16_f32 v157, v54, v55
    v_mfma_f32_16x16x32_bf16 v[72:75], a[220:223], v[92:95], v[72:75]
    buffer_store_dwordx4 v[104:107], v129, s[28:31], s60 offen sc1
    ds_read_b64 v[142:143], v134 offset:16
    v_rsq_f32 v112, v112
    v_mfma_f32_16x16x32_bf16 v[72:75], a[224:227], v[84:87], v[72:75]
    s_add_u32 m0, s67, 2048
    v_rsq_f32 v113, v113
    v_mfma_f32_16x16x32_bf16 v[72:75], a[228:231], v[96:99], v[72:75]
    v_exp_f32 v68, v68
    v_mfma_f32_16x16x32_bf16 v[72:75], a[232:235], v[100:103], v[72:75]
    v_exp_f32 v69, v69
    v_mfma_f32_16x16x32_bf16 v[72:75], a[236:239], v[88:91], v[72:75]
    s_waitcnt lgkmcnt(4)
    buffer_load_dwordx4 v128, s[24:27], s56 offen nt lds
    v_mul_f32 v112, s52, v112
    v_mfma_f32_16x16x32_bf16 v[104:107], v[232:235], v[76:79], 0
    ds_read_b64 v[52:53], v134 offset:48
    v_cvt_pk_f16_f32 v112, v112, v113
    v_mfma_f32_16x16x32_bf16 v[104:107], v[236:239], v[92:95], v[104:107]
    v_pk_mul_f16 v56, v56, v112 op_sel:[0,0] op_sel_hi:[1,0]
    v_pk_mul_f16 v57, v57, v112 op_sel:[0,0] op_sel_hi:[1,0]
    v_mfma_f32_16x16x32_bf16 v[104:107], v[240:243], v[84:87], v[104:107]
    v_pk_mul_f16 v58, v58, v112 op_sel:[0,0] op_sel_hi:[1,0]
    v_pk_mul_f16 v59, v59, v112 op_sel:[0,0] op_sel_hi:[1,0]
    v_mfma_f32_16x16x32_bf16 v[104:107], v[244:247], v[96:99], v[104:107]
    v_pk_mul_f16 v146, v146, v112 op_sel:[0,0] op_sel_hi:[1,0]
    v_pk_mul_f16 v147, v147, v112 op_sel:[0,0] op_sel_hi:[1,0]
    v_mfma_f32_16x16x32_bf16 v[104:107], v[248:251], v[100:103], v[104:107]
    v_pk_mul_f16 v12, v12, v112 op_sel:[0,1] op_sel_hi:[1,1]
    v_pk_mul_f16 v13, v13, v112 op_sel:[0,1] op_sel_hi:[1,1]
    v_mfma_f32_16x16x32_bf16 v[104:107], v[252:255], v[88:91], v[104:107]
    v_pk_mul_f16 v14, v14, v112 op_sel:[0,1] op_sel_hi:[1,1]
    v_pk_mul_f16 v15, v15, v112 op_sel:[0,1] op_sel_hi:[1,1]
    v_mfma_f32_16x16x32_f16 v[64:67], v[0:3], v[36:39], v[204:207]
    s_add_u32 m0, s67, 3072
    buffer_store_dwordx4 v[108:111], v128, s[28:31], s60 offen sc1
    v_pk_mul_f16 v16, v16, v112 op_sel:[0,1] op_sel_hi:[1,1]
    v_pk_mul_f16 v17, v17, v112 op_sel:[0,1] op_sel_hi:[1,1]
    v_exp_f32 v70, v70
    v_mfma_f32_16x16x32_f16 v[64:67], v[2:5], v[152:155], v[64:67]
    s_waitcnt lgkmcnt(1)
    v_exp_f32 v71, v71
    v_mfma_f32_16x16x32_f16 v[92:95], v[48:51], v[36:39], v[208:211]
    s_waitcnt lgkmcnt(0)
    v_cvt_pk_bf16_f32 v78, v68, v69
    v_cvt_pk_bf16_f32 v79, v70, v71
    v_mfma_f32_16x16x32_f16 v[92:95], v[50:53], v[152:155], v[92:95]
    s_nop 0
    v_exp_f32 v64, v64
    v_mfma_f32_16x16x32_f16 v[68:71], v[60:63], v[0:3], v[208:211]
    buffer_load_dwordx4 v127, s[24:27], s56 offen nt lds
    v_mfma_f32_16x16x32_f16 v[68:71], v[140:143], v[2:5], v[68:71]
    v_exp_f32 v65, v65
    v_mfma_f32_16x16x32_f16 v[84:87], v[60:63], v[6:9], v[208:211]
    v_exp_f32 v66, v66
    v_mfma_f32_16x16x32_f16 v[84:87], v[140:143], v[8:11], v[84:87]
    v_exp_f32 v67, v67
    v_mfma_f32_16x16x32_f16 v[96:99], v[60:63], v[12:15], v[208:211]
    v_cvt_pk_bf16_f32 v76, v64, v65
    v_cvt_pk_bf16_f32 v77, v66, v67
    v_mfma_f32_16x16x32_f16 v[96:99], v[140:143], v[14:17], v[96:99]
    v_exp_f32 v92, v92
    v_mfma_f32_16x16x32_f16 v[60:63], v[12:15], v[36:39], v[196:199]
    s_nop 0
    v_cvt_pk_bf16_f32 v170, v92, 0
    v_mov_b32_dpp v71, v87 quad_perm:[0,1,2,3] row_mask:0x2 bank_mask:0xf
    v_mfma_f32_16x16x32_f16 v[60:63], v[14:17], v[152:155], v[60:63]
    s_nop 0
    buffer_store_dwordx4 v[80:83], v127, s[28:31], s60 offen sc1
    v_mov_b32_dpp v71, v99 quad_perm:[0,1,2,3] row_mask:0x4 bank_mask:0xf
    v_exp_f32 v71, v71
    v_mfma_f32_16x16x32_f16 v[36:39], v[6:9], v[40:43], v[188:191]
    s_add_u32 m0, s67, 4096
    v_cvt_pk_bf16_f32 v71, v71, v71
    v_mfma_f32_16x16x32_f16 v[36:39], v[8:11], v[148:151], v[36:39]
    s_mov_b32 s53, s47
    ds_write_b16 v133, v71
    v_mfma_f32_16x16x32_f16 v[68:71], v[0:3], v[40:43], v[192:195]
    s_mov_b32 s47, s46
    v_exp_f32 v60, v60
    v_mfma_f32_16x16x32_f16 v[68:71], v[2:5], v[148:151], v[68:71]
    s_mov_b32 s46, s45
    v_exp_f32 v61, v61
    v_mfma_f32_16x16x32_f16 v[64:67], v[12:15], v[56:59], v[172:175]
    s_mov_b32 s45, s44
    ds_read_b128 v[92:95], v134
    buffer_load_dwordx4 v126, s[24:27], s56 offen nt lds
    v_mfma_f32_16x16x32_f16 v[64:67], v[14:17], v[144:147], v[64:67]
    s_mov_b32 s44, s53
    ds_read_b128 v[84:87], v134 offset:16
    v_cvt_pk_bf16_f32 v168, v60, v61
    v_mfma_f32_16x16x32_f16 v[96:99], v[12:15], v[40:43], v[184:187]
    s_sub_u32 s48, s44, s46
    v_exp_f32 v62, v62
    v_mfma_f32_16x16x32_f16 v[96:99], v[14:17], v[148:151], v[96:99]
    v_exp_f32 v63, v63
    v_mfma_f32_16x16x32_f16 v[12:15], v[48:51], v[40:43], v[208:211]
    v_exp_f32 v36, v36
    v_mfma_f32_16x16x32_f16 v[12:15], v[50:53], v[148:151], v[12:15]
    v_exp_f32 v37, v37
    v_mfma_f32_16x16x32_f16 v[40:43], v[48:51], v[56:59], v[208:211]
    v_cvt_pk_bf16_f32 v169, v62, v63
    v_cvt_pk_bf16_f32 v54, v36, v37
    v_mfma_f32_16x16x32_f16 v[40:43], v[50:53], v[144:147], v[40:43]
    v_exp_f32 v38, v38
    v_mfma_f32_16x16x32_bf16 v[50:53], v[220:223], v[76:79], 0
    v_exp_f32 v39, v39
    v_mfma_f32_16x16x32_bf16 v[50:53], v[220:223], v[168:171], v[50:53]
    s_waitcnt lgkmcnt(1)
    buffer_store_dwordx4 v[44:47], v126, s[28:31], s60 offen sc1
    v_cvt_pk_bf16_f32 v55, v38, v39
    v_exp_f32 v68, v68
    v_mfma_f32_16x16x32_bf16 v[36:39], v[92:95], v[24:27], 0
    s_waitcnt lgkmcnt(0)
    v_exp_f32 v69, v69
    v_mfma_f32_16x16x32_bf16 v[36:39], v[84:87], v[164:167], v[36:39]
    v_exp_f32 v70, v70
    v_mfma_f32_16x16x32_bf16 v[44:47], v[92:95], v[20:23], 0
    v_exp_f32 v71, v71
    v_mfma_f32_16x16x32_bf16 v[44:47], v[84:87], v[160:163], v[44:47]
    v_cvt_pk_bf16_f32 v52, v68, v69
    v_cvt_pk_bf16_f32 v53, v70, v71
    v_mfma_f32_16x16x32_bf16 v[60:63], v[92:95], v[28:31], 0
    ds_read_b128 v[68:71], v138 offset:1536
    s_nop 0
    v_mfma_f32_16x16x32_bf16 v[60:63], v[84:87], v[156:159], v[60:63]
    s_sub_u32 s49, s46, s45
    ds_read_b128 v[92:95], v139 offset:1536
    v_mov_b32_dpp v39, v47 quad_perm:[0,1,2,3] row_mask:0x2 bank_mask:0xf
    v_mfma_f32_16x16x32_bf16 v[44:47], v[24:27], v[76:79], 0
    s_cmp_lg_u32 s5, -1
    ds_read_b128 v[84:87], v139 offset:1664
    v_fma_f32 v154, v72, v72, s42
    v_mfma_f32_16x16x32_bf16 v[44:47], v[164:167], v[168:171], v[44:47]
    v_exp_f32 v96, v96
    v_mfma_f32_16x16x32_bf16 v[100:103], v[20:23], v[76:79], 0
    v_exp_f32 v97, v97
    v_mfma_f32_16x16x32_bf16 v[100:103], v[160:163], v[168:171], v[100:103]
    v_exp_f32 v98, v98
    v_mfma_f32_16x16x32_bf16 v[88:91], v[28:31], v[76:79], 0
    v_exp_f32 v99, v99
    v_mfma_f32_16x16x32_bf16 v[88:91], v[156:159], v[168:171], v[88:91]
    ds_read_b128 v[76:79], v138 offset:1664
    v_mov_b32_dpp v39, v63 quad_perm:[0,1,2,3] row_mask:0x4 bank_mask:0xf
    v_mfma_f32_16x16x32_f16 v[60:63], v[0:3], v[56:59], v[180:183]
    v_cvt_pk_bf16_f32 v39, v39, v39
    v_cvt_pk_bf16_f32 v168, v96, v97
    v_mfma_f32_16x16x32_f16 v[60:63], v[2:5], v[144:147], v[60:63]
    v_exp_f32 v13, v13
    v_mfma_f32_16x16x32_f16 v[112:115], v[6:9], v[56:59], v[176:179]
    ds_read_b128 v[4:7], v139 offset:1792
    v_cvt_pk_bf16_f32 v169, v98, v99
    v_mfma_f32_16x16x32_f16 v[112:115], v[8:11], v[144:147], v[112:115]
    ds_read_b128 v[8:11], v138 offset:1792
    v_cvt_pk_bf16_f32 v170, v13, 0
    v_mfma_f32_16x16x32_bf16 v[56:59], v[220:223], v[52:55], 0
    v_rcp_f32 v50, v50
    v_mfma_f32_16x16x32_bf16 v[56:59], v[220:223], v[168:171], v[56:59]
    ds_read_b128 v[12:15], v139 offset:3072
    v_mul_f32 v44, v44, v50
    v_mfma_f32_16x16x32_bf16 v[96:99], v[24:27], v[52:55], 0
    ds_read_b128 v[80:83], v138 offset:3200
    v_mul_f32 v45, v45, v50
    v_mfma_f32_16x16x32_bf16 v[96:99], v[164:167], v[168:171], v[96:99]
    ds_read_b128 v[16:19], v138 offset:3072
    v_cvt_pk_bf16_f32 v36, v44, v45
    v_mfma_f32_16x16x32_bf16 v[108:111], v[20:23], v[52:55], 0
    ds_read_b128 v[116:119], v139 offset:3200
    v_mul_f32 v46, v46, v50
    v_mfma_f32_16x16x32_bf16 v[108:111], v[160:163], v[168:171], v[108:111]
    ds_read_b128 v[120:123], v138 offset:3328
    v_mul_f32 v47, v47, v50
    v_mfma_f32_16x16x32_bf16 v[0:3], v[28:31], v[52:55], 0
    v_cvt_pk_bf16_f32 v37, v46, v47
    v_mul_f32 v100, v100, v50
    v_mfma_f32_16x16x32_bf16 v[0:3], v[156:159], v[168:171], v[0:3]
    s_waitcnt lgkmcnt(6)
    v_mul_f32 v101, v101, v50
    v_cvt_pk_bf16_f32 v38, v100, v101
    v_mfma_f32_16x16x32_bf16 v[44:47], a[216:219], v[92:95], 0
    v_mul_f32 v102, v102, v50
    v_mul_f32 v103, v103, v50
    v_mfma_f32_16x16x32_bf16 v[44:47], a[220:223], v[68:71], v[44:47]
    ds_write_b16 v133, v39 offset:56
    v_mfma_f32_16x16x32_bf16 v[44:47], a[224:227], v[84:87], v[44:47]
    v_cvt_pk_bf16_f32 v39, v102, v103
    v_mul_f32 v88, v88, v50
    v_mfma_f32_16x16x32_bf16 v[44:47], a[228:231], v[76:79], v[44:47]
    v_mul_f32 v89, v89, v50
    v_cvt_pk_bf16_f32 v168, v88, v89
    v_mfma_f32_16x16x32_bf16 v[44:47], a[232:235], v[4:7], v[44:47]
    s_waitcnt lgkmcnt(3)
    ds_read_b128 v[52:55], v139 offset:3328
    v_mul_f32 v90, v90, v50
    v_mfma_f32_16x16x32_bf16 v[44:47], a[236:239], v[8:11], v[44:47]
    v_mul_f32 v91, v91, v50
    v_cvt_pk_bf16_f32 v169, v90, v91
    v_mfma_f32_16x16x32_bf16 v[48:51], v[232:235], v[92:95], 0
    v_exp_f32 v60, v60
    v_mfma_f32_16x16x32_bf16 v[48:51], v[236:239], v[68:71], v[48:51]
    v_exp_f32 v61, v61
    v_mfma_f32_16x16x32_bf16 v[48:51], v[240:243], v[84:87], v[48:51]
    ds_write_b64 v137, v[36:37] offset:0
    v_mfma_f32_16x16x32_bf16 v[48:51], v[244:247], v[76:79], v[48:51]
    v_exp_f32 v62, v62
    v_mfma_f32_16x16x32_bf16 v[48:51], v[248:251], v[4:7], v[48:51]
    v_exp_f32 v63, v63
    v_mfma_f32_16x16x32_bf16 v[48:51], v[252:255], v[8:11], v[48:51]
    v_cvt_pk_bf16_f32 v36, v60, v61
    v_cvt_pk_bf16_f32 v37, v62, v63
    v_mfma_f32_16x16x32_bf16 v[100:103], a[240:243], v[12:15], 0
    ds_write_b64 v137, v[38:39] offset:8
    v_mfma_f32_16x16x32_bf16 v[100:103], a[244:247], v[16:19], v[100:103]
    s_waitcnt lgkmcnt(2)
    v_exp_f32 v112, v112
    v_mfma_f32_16x16x32_bf16 v[100:103], a[248:251], v[116:119], v[100:103]
    v_exp_f32 v113, v113
    v_mfma_f32_16x16x32_bf16 v[100:103], a[252:255], v[80:83], v[100:103]
    v_exp_f32 v114, v114
    v_mfma_f32_16x16x32_bf16 v[100:103], v[224:227], v[52:55], v[100:103]
    ds_write_b64 v136, v[168:169] offset:0
    v_mfma_f32_16x16x32_bf16 v[100:103], v[228:231], v[120:123], v[100:103]
    v_exp_f32 v115, v115
    v_mfma_f32_16x16x32_bf16 v[88:91], v[232:235], v[12:15], 0
    v_cvt_pk_bf16_f32 v38, v112, v113
    v_cvt_pk_bf16_f32 v39, v114, v115
    v_mfma_f32_16x16x32_bf16 v[88:91], v[236:239], v[16:19], v[88:91]
    v_exp_f32 v64, v64
    v_mfma_f32_16x16x32_bf16 v[88:91], v[240:243], v[116:119], v[88:91]
    v_exp_f32 v65, v65
    v_mfma_f32_16x16x32_bf16 v[88:91], v[244:247], v[80:83], v[88:91]
    v_exp_f32 v66, v66
    v_mfma_f32_16x16x32_bf16 v[88:91], v[248:251], v[52:55], v[88:91]
    v_exp_f32 v67, v67
    v_mfma_f32_16x16x32_bf16 v[88:91], v[252:255], v[120:123], v[88:91]
    v_cvt_pk_bf16_f32 v168, v64, v65
    v_cvt_pk_bf16_f32 v169, v66, v67
    v_mfma_f32_16x16x32_bf16 v[60:63], a[240:243], v[92:95], 0
    v_exp_f32 v42, v42
    v_mfma_f32_16x16x32_bf16 v[60:63], a[244:247], v[68:71], v[60:63]
    v_cvt_pk_bf16_f32 v170, v42, 0
    v_add_u32 v139, s48, v139
    v_mfma_f32_16x16x32_bf16 v[60:63], a[248:251], v[84:87], v[60:63]
    ds_read_b128 v[68:71], v139 offset:0
    v_add_u32 v138, s48, v138
    v_mfma_f32_16x16x32_bf16 v[60:63], a[252:255], v[76:79], v[60:63]
    ds_read_b128 v[64:67], v138 offset:0
    v_fmac_f32 v154, v73, v73
    v_mfma_f32_16x16x32_bf16 v[60:63], v[224:227], v[4:7], v[60:63]
    ds_read_b128 v[40:43], v139 offset:128
    v_fmac_f32 v154, v74, v74
    v_mfma_f32_16x16x32_bf16 v[60:63], v[228:231], v[8:11], v[60:63]
    ds_read_b128 v[8:11], v138 offset:128
    v_fmac_f32 v154, v75, v75
    v_mfma_f32_16x16x32_bf16 v[76:79], a[216:219], v[12:15], 0
    ds_read_b128 v[12:15], v139 offset:256
    v_fmac_f32 v154, v32, v32
    v_mfma_f32_16x16x32_bf16 v[76:79], a[220:223], v[16:19], v[76:79]
    ds_read_b128 v[92:95], v138 offset:256
    v_fmac_f32 v154, v33, v33
    v_mfma_f32_16x16x32_bf16 v[76:79], a[224:227], v[116:119], v[76:79]
    v_rcp_f32 v56, v56
    v_mfma_f32_16x16x32_bf16 v[76:79], a[228:231], v[80:83], v[76:79]
    v_mul_f32 v96, v96, v56
    v_mul_f32 v97, v97, v56
    v_mfma_f32_16x16x32_bf16 v[76:79], a[232:235], v[52:55], v[76:79]
    v_cvt_pk_bf16_f32 v4, v96, v97
    v_mul_f32 v98, v98, v56
    v_mfma_f32_16x16x32_bf16 v[76:79], a[236:239], v[120:123], v[76:79]
    v_mul_f32 v99, v99, v56
    v_cvt_pk_bf16_f32 v5, v98, v99
    v_mfma_f32_16x16x32_bf16 v[52:55], v[220:223], v[36:39], 0
    ds_write_b64 v137, v[4:5] offset:1536
    v_mfma_f32_16x16x32_bf16 v[52:55], v[220:223], v[168:171], v[52:55]
    v_mul_f32 v108, v108, v56
    v_mul_f32 v109, v109, v56
    v_mfma_f32_16x16x32_bf16 v[84:87], v[24:27], v[36:39], 0
    v_cvt_pk_bf16_f32 v6, v108, v109
    v_mul_f32 v110, v110, v56
    v_mfma_f32_16x16x32_bf16 v[84:87], v[164:167], v[168:171], v[84:87]
    v_mul_f32 v111, v111, v56
    v_cvt_pk_bf16_f32 v7, v110, v111
    v_mfma_f32_16x16x32_bf16 v[24:27], v[20:23], v[36:39], 0
    ds_write_b64 v137, v[6:7] offset:1544
    v_mfma_f32_16x16x32_bf16 v[24:27], v[160:163], v[168:171], v[24:27]
    v_mul_f32 v0, v0, v56
    v_mul_f32 v1, v1, v56
    v_mfma_f32_16x16x32_bf16 v[20:23], v[28:31], v[36:39], 0
    v_cvt_pk_bf16_f32 v0, v0, v1
    v_mul_f32 v2, v2, v56
    v_mfma_f32_16x16x32_bf16 v[20:23], v[156:159], v[168:171], v[20:23]
    s_waitcnt lgkmcnt(2)
    v_mul_f32 v3, v3, v56
    v_cvt_pk_bf16_f32 v1, v2, v3
    v_mfma_f32_16x16x32_bf16 v[36:39], a[0:3], v[68:71], 0
    s_cbranch_scc1 L_loopF0
L_tailF:
    ds_write_b64 v136, v[0:1] offset:1536
    v_rcp_f32 v52, v52
    v_fmac_f32 v154, v34, v34
    v_mul_f32 v84, v84, v52
    v_mul_f32 v85, v85, v52
    v_cvt_pk_bf16_f32 v0, v84, v85
    v_mul_f32 v86, v86, v52
    v_mul_f32 v87, v87, v52
    v_cvt_pk_bf16_f32 v1, v86, v87
    v_mul_f32 v24, v24, v52
    v_mul_f32 v25, v25, v52
    v_cvt_pk_bf16_f32 v2, v24, v25
    v_mul_f32 v26, v26, v52
    v_mul_f32 v27, v27, v52
    v_cvt_pk_bf16_f32 v3, v26, v27
    v_mul_f32 v20, v20, v52
    v_mul_f32 v21, v21, v52
    v_cvt_pk_bf16_f32 v20, v20, v21
    v_mul_f32 v22, v22, v52
    v_mul_f32 v23, v23, v52
    v_cvt_pk_bf16_f32 v21, v22, v23
    s_mov_b32 s30, 100270464
    s_mul_i32 s89, s68, 5376
    ds_write_b64 v137, v[0:1] offset:3072
    v_fmac_f32 v154, v35, v35
    s_add_u32 s89, s89, 142336
    s_movk_i32 s90, 336
    ds_write_b64 v137, v[2:3] offset:3080
    v_fmac_f32 v154, v104, v104
    v_fmac_f32 v154, v105, v105
    v_fmac_f32 v154, v106, v106
    s_lshr_b32 s91, s64, 16
    s_sub_u32 s84, s45, s44
    ds_write_b64 v136, v[20:21] offset:3072
    v_fmac_f32 v154, v107, v107
    v_fma_f32 v134, v44, v44, s42
    v_fmac_f32 v134, v45, v45
    v_fmac_f32 v134, v46, v46
    v_fmac_f32 v134, v47, v47
    v_fmac_f32 v134, v60, v60
    v_fmac_f32 v134, v61, v61
    v_fmac_f32 v134, v62, v62
    v_fmac_f32 v134, v63, v63
    v_fmac_f32 v134, v48, v48
    v_fmac_f32 v134, v49, v49
    v_fmac_f32 v134, v50, v50
    v_fmac_f32 v134, v51, v51
    v_fma_f32 v133, v76, v76, s42
    v_fmac_f32 v133, v77, v77
    v_fmac_f32 v133, v78, v78
    v_fmac_f32 v133, v79, v79
    v_fmac_f32 v133, v100, v100
    v_fmac_f32 v133, v101, v101
    v_fmac_f32 v133, v102, v102
    v_fmac_f32 v133, v103, v103
    v_fmac_f32 v133, v88, v88
    v_fmac_f32 v133, v89, v89
    v_fmac_f32 v133, v90, v90
    v_fmac_f32 v133, v91, v91
    v_cvt_pk_bf16_f32 v0, v154, v134
    v_cvt_pk_bf16_f32 v1, v133, v124
    s_sub_u32 s85, s46, s45
    s_sub_u32 s86, s44, s45
    ds_write_b64 v132, v[0:1]
    v_mbcnt_lo_u32_b32 v124, -1, 0
    v_mbcnt_hi_u32_b32 v124, -1, v124
    v_and_b32 v134, 15, v124
    v_lshrrev_b32 v124, 4, v124
    v_mul_u32_u24 v124, 80, v124
    v_add_u32 v124, s89, v124
    v_mad_u32_u24 v66, v134, s90, v124
    v_lshrrev_b32 v133, v134, s64
    v_and_b32 v133, 1, v133
    v_cmp_eq_u32 vcc, 1, v133
    v_mad_u32_u24 v22, v134, s90, v124
    v_lshrrev_b32 v70, v134, s91
    v_cndmask_b32 v66, v124, v66, vcc
    s_sub_u32 s93, s44, s47
    s_sub_u32 s94, s45, s47
    ds_read_b128 v[8:11], v66
    ds_read_b128 v[12:15], v66 offset:16
    v_and_b32 v70, 1, v70
    v_subrev_u32 v22, 21504, v22
    s_sub_u32 s95, s46, s47
    ds_read_b64 v[64:65], v66 offset:56
    ds_read_b128 v[66:69], v66 offset:64
    v_cmp_eq_u32 vcc, 1, v70
    v_add_u32 v18, s84, v139
    v_add_u32 v19, s84, v138
    v_cndmask_b32 v22, v124, v22, vcc
    v_add_u32 v23, s85, v137
    v_add_u32 v42, s85, v136
    v_add_u32 v134, s86, v137
    v_add_u32 v133, s86, v136
    v_add_u32 v124, s93, v135
    s_waitcnt lgkmcnt(4)
    s_barrier
    ds_read_b128 v[24:27], v131 offset:0
    ds_read_b128 v[4:7], v131 offset:1024
    v_add_u32 v20, s94, v135
    v_add_u32 v21, s95, v135
    ds_read_b128 v[36:39], v18 offset:1536
    v_and_b32 v125, 0xb8000000, v125
    s_waitcnt lgkmcnt(6)
    v_mfma_f32_16x16x32_bf16 v[0:3], v[220:223], v[8:11], 0
    s_waitcnt lgkmcnt(5)
    s_lshl_b32 s92, s68, 10
    ds_read_b128 v[8:11], v18 offset:1664
    ds_read_b128 v[52:55], v18 offset:1792
    v_mfma_f32_16x16x32_bf16 v[0:3], v[220:223], v[12:15], v[0:3]
    s_waitcnt lgkmcnt(5)
    v_lshlrev_b32 v70, 16, v64
    v_and_b32 v64, 0xffff0000, v64
    v_lshlrev_b32 v17, 16, v65
    v_and_b32 v65, 0xffff0000, v65
    v_lshlrev_b32 v16, 16, v66
    v_and_b32 v66, 0xffff0000, v66
    v_lshlrev_b32 v135, 16, v67
    v_rcp_f32 v0, v0
    v_and_b32 v67, 0xffff0000, v67
    v_mul_f32 v70, v70, v0
    v_mul_f32 v64, v64, v0
    v_cvt_pk_bf16_f32 v64, v70, v64
    v_mul_f32 v17, v17, v0
    v_mul_f32 v65, v65, v0
    v_cvt_pk_bf16_f32 v65, v17, v65
    v_mul_f32 v16, v16, v0
    v_mul_f32 v66, v66, v0
    v_cvt_pk_bf16_f32 v66, v16, v66
    v_mul_f32 v135, v135, v0
    s_waitcnt lgkmcnt(3)
    v_mfma_f32_16x16x32_bf16 v[12:15], v[216:219], v[24:27], 0
    ds_read_b128 v[28:31], v19 offset:1536
    ds_read_b128 v[56:59], v19 offset:1664
    v_mfma_f32_16x16x32_bf16 v[12:15], v[216:219], v[4:7], v[12:15]
    s_waitcnt lgkmcnt(4)
    ds_read_b128 v[24:27], v19 offset:1792
    v_mul_f32 v67, v67, v0
    v_mfma_f32_16x16x32_bf16 v[4:7], a[216:219], v[36:39], 0
    v_cvt_pk_bf16_f32 v67, v135, v67
    v_lshlrev_b32 v135, 16, v68
    v_and_b32 v68, 0xffff0000, v68
    v_mul_f32 v135, v135, v0
    v_mul_f32 v68, v68, v0
    v_cvt_pk_bf16_f32 v40, v135, v68
    v_lshlrev_b32 v15, 16, v69
    v_and_b32 v69, 0xffff0000, v69
    v_mul_f32 v15, v15, v0
    v_mul_f32 v69, v69, v0
    v_cvt_pk_bf16_f32 v41, v15, v69
    v_rsq_f32 v12, v12
    v_rsq_f32 v13, v13
    v_mul_f32 v12, s43, v12
    v_mul_f32 v72, v72, v12
    v_mul_f32 v73, v73, v12
    v_cvt_pk_bf16_f32 v0, v72, v73
    v_mul_f32 v74, v74, v12
    v_mul_f32 v75, v75, v12
    v_cvt_pk_bf16_f32 v1, v74, v75
    v_mul_f32 v32, v32, v12
    v_mul_f32 v33, v33, v12
    v_cvt_pk_bf16_f32 v2, v32, v33
    v_mul_f32 v34, v34, v12
    v_mul_f32 v35, v35, v12
    s_waitcnt lgkmcnt(1)
    v_mfma_f32_16x16x32_bf16 v[4:7], a[220:223], v[28:31], v[4:7]
    ds_write_b128 v134, v[64:67] offset:0
    v_mfma_f32_16x16x32_bf16 v[4:7], a[224:227], v[8:11], v[4:7]
    v_cvt_pk_bf16_f32 v3, v34, v35
    v_mul_f32 v104, v104, v12
    v_mfma_f32_16x16x32_bf16 v[4:7], a[228:231], v[56:59], v[4:7]
    ds_write_b128 v23, v[0:3] offset:0
    v_mfma_f32_16x16x32_bf16 v[4:7], a[232:235], v[52:55], v[4:7]
    s_waitcnt lgkmcnt(2)
    v_mul_f32 v105, v105, v12
    v_cvt_pk_bf16_f32 v16, v104, v105
    v_mfma_f32_16x16x32_bf16 v[4:7], a[236:239], v[24:27], v[4:7]
    ds_write_b64 v133, v[40:41] offset:0
    v_mfma_f32_16x16x32_bf16 v[92:95], a[240:243], v[36:39], 0
    v_mul_f32 v106, v106, v12
    v_mul_f32 v107, v107, v12
    v_mfma_f32_16x16x32_bf16 v[92:95], a[244:247], v[28:31], v[92:95]
    ds_read_b128 v[96:99], v18 offset:0
    v_cvt_pk_bf16_f32 v17, v106, v107
    v_mfma_f32_16x16x32_bf16 v[92:95], a[248:251], v[8:11], v[92:95]
    ds_write_b64 v42, v[16:17] offset:0
    v_mfma_f32_16x16x32_bf16 v[92:95], a[252:255], v[56:59], v[92:95]
    v_mul_f32 v13, s43, v13
    v_mul_f32 v44, v44, v13
    v_mfma_f32_16x16x32_bf16 v[92:95], v[224:227], v[52:55], v[92:95]
    ds_read_b128 v[84:87], v19 offset:0
    v_mul_f32 v45, v45, v13
    v_mfma_f32_16x16x32_bf16 v[92:95], v[228:231], v[24:27], v[92:95]
    ds_read_b128 v[64:67], v18 offset:128
    v_cvt_pk_bf16_f32 v0, v44, v45
    v_mfma_f32_16x16x32_bf16 v[72:75], v[232:235], v[36:39], 0
    ds_read_b128 v[36:39], v19 offset:128
    v_mul_f32 v46, v46, v13
    v_mfma_f32_16x16x32_bf16 v[72:75], v[236:239], v[28:31], v[72:75]
    ds_read_b128 v[28:31], v18 offset:256
    v_mul_f32 v47, v47, v13
    v_mfma_f32_16x16x32_bf16 v[72:75], v[240:243], v[8:11], v[72:75]
    ds_read_b128 v[8:11], v19 offset:256
    v_cvt_pk_bf16_f32 v1, v46, v47
    v_mfma_f32_16x16x32_bf16 v[72:75], v[244:247], v[56:59], v[72:75]
    v_rsq_f32 v14, v14
    v_mfma_f32_16x16x32_bf16 v[72:75], v[248:251], v[52:55], v[72:75]
    v_mul_f32 v14, s43, v14
    v_mul_f32 v76, v76, v14
    v_mfma_f32_16x16x32_bf16 v[72:75], v[252:255], v[24:27], v[72:75]
    s_waitcnt lgkmcnt(5)
    v_mul_f32 v77, v77, v14
    v_cvt_pk_bf16_f32 v16, v76, v77
    v_mfma_f32_16x16x32_bf16 v[24:27], a[216:219], v[96:99], 0
    s_waitcnt lgkmcnt(4)
    v_mul_f32 v78, v78, v14
    v_mul_f32 v79, v79, v14
    v_cvt_pk_bf16_f32 v17, v78, v79
    v_mfma_f32_16x16x32_bf16 v[24:27], a[220:223], v[84:87], v[24:27]
    s_waitcnt lgkmcnt(3)
    ds_read_b128 v[80:83], v18 offset:3072
    ds_read_b128 v[76:79], v19 offset:3072
    v_mfma_f32_16x16x32_bf16 v[24:27], a[224:227], v[64:67], v[24:27]
    s_waitcnt lgkmcnt(4)
    ds_read_b128 v[68:71], v18 offset:3200
    v_mul_f32 v100, v100, v14
    v_mfma_f32_16x16x32_bf16 v[24:27], a[228:231], v[36:39], v[24:27]
    s_waitcnt lgkmcnt(4)
    ds_read_b128 v[56:59], v19 offset:3200
    v_mul_f32 v101, v101, v14
    v_mfma_f32_16x16x32_bf16 v[24:27], a[232:235], v[28:31], v[24:27]
    s_waitcnt lgkmcnt(4)
    ds_read_b128 v[52:55], v18 offset:3328
    v_cvt_pk_bf16_f32 v18, v100, v101
    v_mfma_f32_16x16x32_bf16 v[24:27], a[236:239], v[8:11], v[24:27]
    ds_read_b128 v[44:47], v19 offset:3328
    v_mul_f32 v102, v102, v14
    v_mfma_f32_16x16x32_bf16 v[32:35], a[240:243], v[96:99], 0
    v_mul_f32 v103, v103, v14
    v_cvt_pk_bf16_f32 v19, v102, v103
    v_mfma_f32_16x16x32_bf16 v[32:35], a[244:247], v[84:87], v[32:35]
    ds_write_b128 v23, v[16:19] offset:3072
    v_mfma_f32_16x16x32_bf16 v[32:35], a[248:251], v[64:67], v[32:35]
    v_mul_f32 v88, v88, v14
    v_mul_f32 v89, v89, v14
    v_mfma_f32_16x16x32_bf16 v[32:35], a[252:255], v[36:39], v[32:35]
    v_cvt_pk_bf16_f32 v2, v88, v89
    v_mul_f32 v90, v90, v14
    v_mfma_f32_16x16x32_bf16 v[32:35], v[224:227], v[28:31], v[32:35]
    v_mul_f32 v91, v91, v14
    v_cvt_pk_bf16_f32 v3, v90, v91
    v_mfma_f32_16x16x32_bf16 v[32:35], v[228:231], v[8:11], v[32:35]
    ds_write_b64 v42, v[2:3] offset:3072
    v_mfma_f32_16x16x32_bf16 v[16:19], v[232:235], v[96:99], 0
    v_fma_f32 v135, v24, v24, s42
    v_fmac_f32 v135, v25, v25
    v_mfma_f32_16x16x32_bf16 v[16:19], v[236:239], v[84:87], v[16:19]
    v_fmac_f32 v135, v26, v26
    v_fmac_f32 v135, v27, v27
    v_mfma_f32_16x16x32_bf16 v[16:19], v[240:243], v[64:67], v[16:19]
    v_fmac_f32 v135, v32, v32
    v_fmac_f32 v135, v33, v33
    v_mfma_f32_16x16x32_bf16 v[16:19], v[244:247], v[36:39], v[16:19]
    v_fmac_f32 v135, v34, v34
    v_fmac_f32 v135, v35, v35
    v_mfma_f32_16x16x32_bf16 v[16:19], v[248:251], v[28:31], v[16:19]
    v_mul_f32 v60, v60, v13
    v_mul_f32 v61, v61, v13
    v_mfma_f32_16x16x32_bf16 v[16:19], v[252:255], v[8:11], v[16:19]
    s_waitcnt lgkmcnt(1)
    v_cvt_pk_bf16_f32 v2, v60, v61
    v_mul_f32 v62, v62, v13
    v_mfma_f32_16x16x32_bf16 v[8:11], a[216:219], v[80:83], 0
    v_mul_f32 v63, v63, v13
    v_cvt_pk_bf16_f32 v3, v62, v63
    v_mfma_f32_16x16x32_bf16 v[8:11], a[220:223], v[76:79], v[8:11]
    ds_write_b128 v23, v[0:3] offset:1536
    v_mfma_f32_16x16x32_bf16 v[8:11], a[224:227], v[68:71], v[8:11]
    v_fmac_f32 v135, v16, v16
    v_fmac_f32 v135, v17, v17
    v_mfma_f32_16x16x32_bf16 v[8:11], a[228:231], v[56:59], v[8:11]
    ds_read_b128 v[28:31], v22
    v_fmac_f32 v135, v18, v18
    v_mfma_f32_16x16x32_bf16 v[8:11], a[232:235], v[52:55], v[8:11]
    ds_read_b128 v[0:3], v22 offset:16
    v_fmac_f32 v135, v19, v19
    v_mfma_f32_16x16x32_bf16 v[8:11], a[236:239], v[44:47], v[8:11]
    ds_read_b64 v[36:37], v22 offset:56
    ds_read_b128 v[38:41], v22 offset:64
    v_mfma_f32_16x16x32_bf16 v[64:67], a[240:243], v[80:83], 0
    v_mul_f32 v48, v48, v13
    v_mul_f32 v49, v49, v13
    v_mfma_f32_16x16x32_bf16 v[64:67], a[244:247], v[76:79], v[64:67]
    v_cvt_pk_bf16_f32 v22, v48, v49
    v_mul_f32 v50, v50, v13
    v_mfma_f32_16x16x32_bf16 v[64:67], a[248:251], v[68:71], v[64:67]
    v_mul_f32 v51, v51, v13
    v_cvt_pk_bf16_f32 v23, v50, v51
    v_mfma_f32_16x16x32_bf16 v[64:67], a[252:255], v[56:59], v[64:67]
    ds_write_b64 v42, v[22:23] offset:1536
    v_mfma_f32_16x16x32_bf16 v[64:67], v[224:227], v[52:55], v[64:67]
    v_fma_f32 v23, v8, v8, s42
    v_fmac_f32 v23, v9, v9
    v_mfma_f32_16x16x32_bf16 v[64:67], v[228:231], v[44:47], v[64:67]
    v_fmac_f32 v23, v10, v10
    v_fmac_f32 v23, v11, v11
    v_mfma_f32_16x16x32_bf16 v[12:15], v[232:235], v[80:83], 0
    s_nop 0
    v_fma_f32 v22, v4, v4, s42
    v_fmac_f32 v22, v5, v5
    v_mfma_f32_16x16x32_bf16 v[12:15], v[236:239], v[76:79], v[12:15]
    s_nop 0
    v_fmac_f32 v23, v64, v64
    v_fmac_f32 v23, v65, v65
    v_mfma_f32_16x16x32_bf16 v[12:15], v[240:243], v[68:71], v[12:15]
    v_fmac_f32 v23, v66, v66
    v_fmac_f32 v23, v67, v67
    v_mfma_f32_16x16x32_bf16 v[12:15], v[244:247], v[56:59], v[12:15]
    v_fmac_f32 v22, v6, v6
    v_fmac_f32 v22, v7, v7
    v_mfma_f32_16x16x32_bf16 v[12:15], v[248:251], v[52:55], v[12:15]
    v_fmac_f32 v22, v92, v92
    v_fmac_f32 v22, v93, v93
    v_mfma_f32_16x16x32_bf16 v[12:15], v[252:255], v[44:47], v[12:15]
    s_waitcnt lgkmcnt(0)
    v_fmac_f32 v22, v94, v94
    v_fmac_f32 v22, v95, v95
    v_mfma_f32_16x16x32_bf16 v[44:47], v[220:223], v[28:31], 0
    v_fmac_f32 v22, v72, v72
    v_fmac_f32 v22, v73, v73
    v_mfma_f32_16x16x32_bf16 v[44:47], v[220:223], v[0:3], v[44:47]
    s_nop 0
    v_fmac_f32 v23, v12, v12
    v_fmac_f32 v23, v13, v13
    v_fmac_f32 v23, v14, v14
    v_fmac_f32 v23, v15, v15
    v_cvt_pk_bf16_f32 v23, v23, v23
    v_fmac_f32 v22, v74, v74
    v_fmac_f32 v22, v75, v75
    v_cvt_pk_bf16_f32 v22, v135, v22
    ds_write_b64 v132, v[22:23] offset:2048
    v_rcp_f32 v44, v44
    v_lshlrev_b32 v135, 16, v36
    v_and_b32 v36, 0xffff0000, v36
    v_mul_f32 v135, v135, v44
    v_mul_f32 v36, v36, v44
    v_cvt_pk_bf16_f32 v28, v135, v36
    v_lshlrev_b32 v36, 16, v37
    v_and_b32 v37, 0xffff0000, v37
    v_mul_f32 v36, v36, v44
    v_mul_f32 v37, v37, v44
    v_cvt_pk_bf16_f32 v29, v36, v37
    v_lshlrev_b32 v135, 16, v38
    v_and_b32 v38, 0xffff0000, v38
    v_mul_f32 v135, v135, v44
    v_mul_f32 v38, v38, v44
    v_cvt_pk_bf16_f32 v30, v135, v38
    v_lshlrev_b32 v31, 16, v39
    v_and_b32 v39, 0xffff0000, v39
    v_mul_f32 v31, v31, v44
    v_mul_f32 v39, v39, v44
    v_cvt_pk_bf16_f32 v31, v31, v39
    v_lshlrev_b32 v135, 16, v40
    v_and_b32 v40, 0xffff0000, v40
    v_mul_f32 v135, v135, v44
    v_mul_f32 v40, v40, v44
    v_cvt_pk_bf16_f32 v0, v135, v40
    v_lshlrev_b32 v135, 16, v41
    v_and_b32 v41, 0xffff0000, v41
    v_mul_f32 v135, v135, v44
    v_mul_f32 v41, v41, v44
    v_cvt_pk_bf16_f32 v1, v135, v41
    s_waitcnt lgkmcnt(0)
    s_barrier
    ds_write_b128 v134, v[28:31] offset:1536
    v_mov_b32 v23, 0x3f803f80
    v_cmp_ne_u32 vcc, 0, v125
    v_add_u32 v135, s92, v131
    ds_write_b64 v133, v[0:1] offset:1536
    v_cndmask_b32 v23, 0, v23, vcc
    ds_read_b128 v[48:51], v131 offset:2048
    ds_read_b128 v[44:47], v131 offset:3072
    ds_read_b128 v[0:3], v21 offset:0
    ds_read_b128 v[40:43], v21 offset:1024
    ds_read_b128 v[104:107], v21 offset:2048
    ds_read_b128 v[100:103], v21 offset:3072
    ds_read_b128 v[28:31], v21 offset:4096
    s_waitcnt lgkmcnt(7)
    s_barrier
    s_waitcnt lgkmcnt(6)
    v_mfma_f32_16x16x32_bf16 v[36:39], v[216:219], v[48:51], 0
    s_waitcnt lgkmcnt(5)
    ds_read_b128 v[96:99], v139 offset:0
    ds_read_b128 v[88:91], v138 offset:0
    v_mfma_f32_16x16x32_bf16 v[36:39], v[216:219], v[44:47], v[36:39]
    s_waitcnt lgkmcnt(6)
    ds_read_b128 v[84:87], v139 offset:128
    s_nop 0
    buffer_store_dwordx4 v[0:3], v130, s[28:31], s59 offen sc1
    s_nop 0
    ds_read_b128 v[80:83], v138 offset:128
    s_nop 1
    v_rsq_f32 v36, v36
    ds_read_b128 v[76:79], v139 offset:256
    ds_read_b128 v[0:3], v138 offset:256
    v_mul_f32 v36, s43, v36
    v_mul_f32 v24, v24, v36
    v_mul_f32 v25, v25, v36
    ds_read_b128 v[68:71], v139 offset:1536
    s_waitcnt lgkmcnt(8)
    buffer_store_dwordx4 v[40:43], v129, s[28:31], s59 offen sc1
    ds_read_b128 v[60:63], v138 offset:1536
    v_cvt_pk_bf16_f32 v52, v24, v25
    v_mul_f32 v26, v26, v36
    v_mul_f32 v27, v27, v36
    v_cvt_pk_bf16_f32 v53, v26, v27
    v_mul_f32 v32, v32, v36
    ds_read_b128 v[56:59], v139 offset:1664
    ds_read_b128 v[48:51], v138 offset:1664
    v_mul_f32 v33, v33, v36
    s_waitcnt lgkmcnt(8)
    v_mfma_f32_16x16x32_bf16 v[24:27], a[216:219], v[96:99], 0
    ds_read_b128 v[44:47], v139 offset:1792
    v_cvt_pk_bf16_f32 v54, v32, v33
    v_mfma_f32_16x16x32_bf16 v[24:27], a[220:223], v[88:91], v[24:27]
    s_waitcnt lgkmcnt(7)
    ds_read_b128 v[40:43], v138 offset:1792
    v_mul_f32 v34, v34, v36
    v_mfma_f32_16x16x32_bf16 v[24:27], a[224:227], v[84:87], v[24:27]
    buffer_store_dwordx4 v[104:107], v128, s[28:31], s59 offen sc1
    v_mul_f32 v35, v35, v36
    v_cvt_pk_bf16_f32 v55, v34, v35
    v_mul_f32 v16, v16, v36
    v_mul_f32 v17, v17, v36
    v_mfma_f32_16x16x32_bf16 v[24:27], a[228:231], v[80:83], v[24:27]
    s_waitcnt lgkmcnt(6)
    v_cvt_pk_bf16_f32 v16, v16, v17
    v_mul_f32 v18, v18, v36
    v_mfma_f32_16x16x32_bf16 v[24:27], a[232:235], v[76:79], v[24:27]
    v_rsq_f32 v37, v37
    v_mfma_f32_16x16x32_bf16 v[24:27], a[236:239], v[0:3], v[24:27]
    s_nop 0
    v_mul_f32 v19, v19, v36
    v_cvt_pk_bf16_f32 v17, v18, v19
    v_mfma_f32_16x16x32_bf16 v[32:35], a[240:243], v[96:99], 0
    s_nop 0
    buffer_store_dwordx4 v[100:103], v127, s[28:31], s59 offen sc1
    v_mul_f32 v37, s43, v37
    v_mul_f32 v4, v4, v37
    v_fma_f32 v125, v24, v24, s42
    v_fmac_f32 v125, v25, v25
    v_mfma_f32_16x16x32_bf16 v[32:35], a[244:247], v[88:91], v[32:35]
    v_fmac_f32 v125, v26, v26
    v_fmac_f32 v125, v27, v27
    v_mfma_f32_16x16x32_bf16 v[32:35], a[248:251], v[84:87], v[32:35]
    v_mul_f32 v5, v5, v37
    v_cvt_pk_bf16_f32 v4, v4, v5
    v_mfma_f32_16x16x32_bf16 v[32:35], a[252:255], v[80:83], v[32:35]
    v_mul_f32 v6, v6, v37
    v_mul_f32 v7, v7, v37
    v_mfma_f32_16x16x32_bf16 v[32:35], v[224:227], v[76:79], v[32:35]
    buffer_store_dwordx4 v[28:31], v126, s[28:31], s59 offen sc1
    v_cvt_pk_bf16_f32 v5, v6, v7
    v_mul_f32 v92, v92, v37
    v_mul_f32 v93, v93, v37
    v_cvt_pk_bf16_f32 v6, v92, v93
    v_mfma_f32_16x16x32_bf16 v[32:35], v[228:231], v[0:3], v[32:35]
    v_mul_f32 v94, v94, v37
    v_mul_f32 v95, v95, v37
    v_mfma_f32_16x16x32_bf16 v[28:31], v[232:235], v[96:99], 0
    s_nop 0
    v_cvt_pk_bf16_f32 v7, v94, v95
    v_mul_f32 v72, v72, v37
    v_mfma_f32_16x16x32_bf16 v[28:31], v[236:239], v[88:91], v[28:31]
    s_nop 0
    v_fmac_f32 v125, v32, v32
    v_fmac_f32 v125, v33, v33
    v_mfma_f32_16x16x32_bf16 v[28:31], v[240:243], v[84:87], v[28:31]
    v_fmac_f32 v125, v34, v34
    v_fmac_f32 v125, v35, v35
    v_mfma_f32_16x16x32_bf16 v[28:31], v[244:247], v[80:83], v[28:31]
    v_mul_f32 v73, v73, v37
    v_cvt_pk_bf16_f32 v138, v72, v73
    v_mfma_f32_16x16x32_bf16 v[28:31], v[248:251], v[76:79], v[28:31]
    v_mul_f32 v74, v74, v37
    v_mul_f32 v75, v75, v37
    v_mfma_f32_16x16x32_bf16 v[28:31], v[252:255], v[0:3], v[28:31]
    s_waitcnt lgkmcnt(0)
    v_rsq_f32 v38, v38
    v_mfma_f32_16x16x32_bf16 v[0:3], a[216:219], v[68:71], 0
    v_cvt_pk_bf16_f32 v139, v74, v75
    v_mul_f32 v38, s43, v38
    v_mfma_f32_16x16x32_bf16 v[0:3], a[220:223], v[60:63], v[0:3]
    ds_write_b128 v137, v[52:55] offset:0
    v_mfma_f32_16x16x32_bf16 v[0:3], a[224:227], v[56:59], v[0:3]
    v_fmac_f32 v125, v28, v28
    v_fmac_f32 v125, v29, v29
    v_mfma_f32_16x16x32_bf16 v[0:3], a[228:231], v[48:51], v[0:3]
    ds_write_b64 v136, v[16:17] offset:0
    v_mfma_f32_16x16x32_bf16 v[0:3], a[232:235], v[44:47], v[0:3]
    v_fmac_f32 v125, v30, v30
    v_fmac_f32 v125, v31, v31
    v_mfma_f32_16x16x32_bf16 v[0:3], a[236:239], v[40:43], v[0:3]
    ds_write_b128 v137, v[4:7] offset:1536
    v_mfma_f32_16x16x32_bf16 v[16:19], a[240:243], v[68:71], 0
    v_mul_f32 v8, v8, v38
    v_mul_f32 v9, v9, v38
    v_mfma_f32_16x16x32_bf16 v[16:19], a[244:247], v[60:63], v[16:19]
    ds_write_b64 v136, v[138:139] offset:1536
    v_mfma_f32_16x16x32_bf16 v[16:19], a[248:251], v[56:59], v[16:19]
    v_cvt_pk_bf16_f32 v52, v8, v9
    v_mul_f32 v10, v10, v38
    v_mfma_f32_16x16x32_bf16 v[16:19], a[252:255], v[48:51], v[16:19]
    ds_read_b128 v[4:7], v135 offset:6144
    v_mul_f32 v11, v11, v38
    v_mfma_f32_16x16x32_bf16 v[16:19], v[224:227], v[44:47], v[16:19]
    v_cvt_pk_bf16_f32 v53, v10, v11
    v_mul_f32 v64, v64, v38
    v_mfma_f32_16x16x32_bf16 v[16:19], v[228:231], v[40:43], v[16:19]
    v_mul_f32 v65, v65, v38
    v_cvt_pk_bf16_f32 v54, v64, v65
    v_mfma_f32_16x16x32_bf16 v[8:11], v[232:235], v[68:71], 0
    v_mul_f32 v66, v66, v38
    v_mul_f32 v67, v67, v38
    v_mfma_f32_16x16x32_bf16 v[8:11], v[236:239], v[60:63], v[8:11]
    v_cvt_pk_bf16_f32 v55, v66, v67
    v_mul_f32 v12, v12, v38
    v_mfma_f32_16x16x32_bf16 v[8:11], v[240:243], v[56:59], v[8:11]
    ds_write_b128 v137, v[52:55] offset:3072
    v_mfma_f32_16x16x32_bf16 v[8:11], v[244:247], v[48:51], v[8:11]
    v_mul_f32 v13, v13, v38
    v_cvt_pk_bf16_f32 v138, v12, v13
    v_mfma_f32_16x16x32_bf16 v[8:11], v[248:251], v[44:47], v[8:11]
    v_mul_f32 v14, v14, v38
    v_mul_f32 v15, v15, v38
    v_mfma_f32_16x16x32_bf16 v[8:11], v[252:255], v[40:43], v[8:11]
    v_cvt_pk_bf16_f32 v139, v14, v15
    v_fma_f32 v135, v0, v0, s42
    v_fmac_f32 v135, v1, v1
    v_fmac_f32 v135, v2, v2
    ds_write_b64 v136, v[138:139] offset:3072
    v_fmac_f32 v135, v3, v3
    v_fmac_f32 v135, v16, v16
    v_fmac_f32 v135, v17, v17
    v_fmac_f32 v135, v18, v18
    v_fmac_f32 v135, v19, v19
    v_fmac_f32 v135, v8, v8
    v_fmac_f32 v135, v9, v9
    v_fmac_f32 v135, v10, v10
    v_fmac_f32 v135, v11, v11
    v_cvt_pk_bf16_f32 v22, v125, v135
    ds_write_b64 v132, v[22:23] offset:4096
    s_waitcnt lgkmcnt(2)
    v_lshrrev_b32 v125, 0, v7
    v_lshrrev_b32 v125, v125, s64
    v_and_b32 v125, 1, v125
    v_cmp_eq_u32 vcc, 1, v125
    v_lshrrev_b32 v125, 8, v7
    v_lshrrev_b32 v125, v125, s64
    v_cndmask_b32 v4, 2.0, v4, vcc
    v_and_b32 v125, 1, v125
    v_cmp_eq_u32 vcc, 1, v125
    v_lshrrev_b32 v7, 16, v7
    v_lshrrev_b32 v7, v7, s64
    v_cndmask_b32 v5, 2.0, v5, vcc
    v_and_b32 v7, 1, v7
    v_cmp_eq_u32 vcc, 1, v7
    s_nop 1
    v_cndmask_b32 v6, 2.0, v6, vcc
    s_waitcnt lgkmcnt(1)
    s_barrier
    ds_read_b128 v[52:55], v20 offset:0
    ds_read_b128 v[12:15], v20 offset:1024
    ds_read_b128 v[40:43], v20 offset:2048
    s_waitcnt lgkmcnt(3)
    s_barrier
    ds_read_b128 v[36:39], v20 offset:3072
    ds_read_b128 v[20:23], v20 offset:4096
    ds_read_b128 v[48:51], v131 offset:4096
    ds_read_b128 v[44:47], v131 offset:5120
    s_waitcnt lgkmcnt(6)
    buffer_store_dwordx4 v[52:55], v130, s[28:31], s58 offen sc1
    s_waitcnt lgkmcnt(1)
    buffer_store_dwordx4 v[12:15], v129, s[28:31], s58 offen sc1
    s_nop 1
    v_mfma_f32_16x16x32_bf16 v[12:15], v[216:219], v[48:51], 0
    s_waitcnt lgkmcnt(0)
    v_mfma_f32_16x16x32_bf16 v[12:15], v[216:219], v[44:47], v[12:15]
    s_nop 5
    buffer_store_dwordx4 v[40:43], v128, s[28:31], s58 offen sc1
    s_nop 0
    v_rsq_f32 v12, v12
    v_cmp_neq_f32 vcc, 0, v14
    v_mul_f32 v12, s43, v12
    v_mul_f32 v24, v24, v12
    v_mul_f32 v25, v25, v12
    v_cvt_pk_bf16_f32 v24, v24, v25
    v_mul_f32 v26, v26, v12
    v_mul_f32 v27, v27, v12
    v_cvt_pk_bf16_f32 v25, v26, v27
    v_mul_f32 v32, v32, v12
    v_mul_f32 v33, v33, v12
    v_cvt_pk_bf16_f32 v26, v32, v33
    v_mul_f32 v34, v34, v12
    buffer_store_dwordx4 v[36:39], v127, s[28:31], s58 offen sc1
    v_mul_f32 v35, v35, v12
    v_cvt_pk_bf16_f32 v27, v34, v35
    v_mul_f32 v28, v28, v12
    v_mul_f32 v29, v29, v12
    v_cvt_pk_bf16_f32 v14, v28, v29
    v_mul_f32 v30, v30, v12
    v_mul_f32 v31, v31, v12
    v_cvt_pk_bf16_f32 v15, v30, v31
    ds_write_b128 v134, v[24:27] offset:0
    buffer_store_dwordx4 v[20:23], v126, s[28:31], s58 offen sc1
    v_rsq_f32 v13, v13
    s_nop 0
    v_mul_f32 v13, s43, v13
    v_mul_f32 v0, v0, v13
    v_mul_f32 v1, v1, v13
    ds_write_b64 v133, v[14:15] offset:0
    v_cvt_pk_bf16_f32 v0, v0, v1
    v_mul_f32 v2, v2, v13
    v_mul_f32 v3, v3, v13
    v_cvt_pk_bf16_f32 v1, v2, v3
    v_mul_f32 v16, v16, v13
    v_mul_f32 v17, v17, v13
    v_cvt_pk_bf16_f32 v2, v16, v17
    v_mul_f32 v18, v18, v13
    v_mul_f32 v19, v19, v13
    v_cvt_pk_bf16_f32 v3, v18, v19
    v_mul_f32 v8, v8, v13
    v_mul_f32 v9, v9, v13
    v_cvt_pk_bf16_f32 v126, v8, v9
    v_mul_f32 v10, v10, v13
    v_mul_f32 v11, v11, v13
    v_cvt_pk_bf16_f32 v127, v10, v11
    ds_write_b128 v134, v[0:3] offset:1536
    ds_write_b64 v133, v[126:127] offset:1536
    s_waitcnt lgkmcnt(0)
    s_barrier
    ds_read_b128 v[12:15], v124 offset:0
    ds_read_b128 v[8:11], v124 offset:1024
    ds_read_b128 v[0:3], v124 offset:2048
    s_waitcnt lgkmcnt(1)
    buffer_store_dwordx4 v[12:15], v4, s[28:31], 0 offen sc1
    buffer_store_dwordx4 v[8:11], v5, s[28:31], 0 offen sc1
    s_waitcnt lgkmcnt(0)
    buffer_store_dwordx4 v[0:3], v6, s[28:31], 0 offen sc1
    s_nop 4
    s_cbranch_vccnz L_slow
L_end:
    s_endpgm
L_slow:
    s_waitcnt vmcnt(0) lgkmcnt(0)
    s_nop 15
    s_barrier
    s_lshr_b32 s66, s64, 20
    v_mbcnt_lo_u32_b32 v40, -1, 0
    v_mbcnt_hi_u32_b32 v40, -1, v40
    s_load_dwordx16 s[4:19], s[0:1], 0
    s_load_dwordx4 s[20:23], s[0:1], 64
    s_load_dwordx2 s[38:39], s[0:1], 80
    s_lshr_b32 s88, s2, 3
    s_lshl2_add_u32 s88, s88, s68
    v_lshlrev_b32 v8, 7, v40
    s_mul_i32 s89, s88, 576
    s_mul_i32 s88, s88, 1728
    v_min_u32 v9, 1664, v8
    v_min_u32 v8, 512, v8
    s_mov_b32 s34, 221184
    s_mov_b32 s35, 0x20000
    s_mov_b32 s78, 73728
    s_mov_b32 s79, 0x20000
    v_and_b32 v154, 15, v40
    v_lshrrev_b32 v151, 4, v40
    v_lshrrev_b32 v150, 2, v154
    v_and_b32 v142, 3, v154
    s_mul_i32 s87, s68, 192
    v_mad_u32_u24 v10, v154, 12, s87
    v_lshlrev_b32 v19, 1, v154
    v_lshlrev_b32 v11, 1, v150
    v_lshl_add_u32 v11, v151, 5, v11
    s_movk_i32 s86, 384
    s_mov_b32 s26, 100270464
    s_mov_b32 s27, 0x20000
    s_mov_b32 s30, 0
    s_mov_b32 s31, 0x20000
    s_mul_i32 s96, s68, 288
    s_and_b32 s97, s68, 1
    s_lshl_b32 s97, s97, 2
    s_mov_b32 s98, 193536
    s_waitcnt lgkmcnt(0)
    s_mov_b32 s24, s4
    s_mov_b32 s25, s5
    s_mov_b32 s32, s6
    s_mov_b32 s33, s7
    s_mov_b32 s76, s8
    s_mov_b32 s77, s9
    buffer_load_dword a254, v9, s[32:35], s88 offen
    buffer_load_dword a253, v8, s[76:79], s89 offen
    s_load_dwordx2 s[82:83], s[10:11], 0
    s_movk_i32 s18, 676
    s_mov_b32 s19, 0x20000
    buffer_load_dwordx3 v[16:18], v10, s[16:19], 0 offen
    s_mov_b32 s99, 589824
    v_add_u32 v9, s96, v40
    v_mul_u32_u24 v8, 2731, v9
    v_mul_u32_u24 v38, 6242, v9
    v_lshrrev_b32 v8, 16, v8
    s_lshr_b32 s94, s2, 3
    s_mul_i32 s70, s94, 168
    global_load_ushort v24, v19, s[12:13]
    v_lshrrev_b32 v38, 20, v38
    v_and_or_b32 v36, v8, 3, s97
    v_xor_b32 v36, v9, v36
    v_lshl_add_u32 v130, v36, 4, s99
    v_mad_u32_u24 v130, v38, s98, v130
    s_mul_i32 s69, s2, 20
    s_lshl3_add_u32 s69, s94, s69
    global_load_ushort v25, v19, s[12:13] offset:32
    v_add_u32 v19, 64, v9
    v_mul_u32_u24 v131, 2731, v19
    v_mul_u32_u24 v72, 6242, v19
    v_lshrrev_b32 v131, 16, v131
    v_lshrrev_b32 v72, 20, v72
    s_add_u32 s70, s70, 140
    s_movk_i32 s62, 2688
    global_load_ushort v74, v11, s[14:15] offset:0
    v_and_or_b32 v37, v131, 3, s97
    v_xor_b32 v37, v19, v37
    v_lshl_add_u32 v129, v37, 4, s99
    v_mad_u32_u24 v129, v72, s98, v129
    v_add_u32 v19, 128, v9
    s_movk_i32 s71, 20
    s_movk_i32 s73, 28
    global_load_ushort v32, v11, s[14:15] offset:8
    v_mul_u32_u24 v26, 2731, v19
    v_mul_u32_u24 v125, 6242, v19
    v_lshrrev_b32 v26, 16, v26
    v_lshrrev_b32 v125, 20, v125
    v_and_or_b32 v27, v26, 3, s97
    s_mov_b32 s93, 1769472
    s_mul_i32 s54, s68, 5120
    global_load_ushort v75, v11, s[14:15] offset:16
    v_xor_b32 v27, v19, v27
    v_lshl_add_u32 v128, v27, 4, s99
    v_mad_u32_u24 v128, v125, s98, v128
    v_add_u32 v73, 192, v9
    v_mul_u32_u24 v124, 2731, v73
    s_mov_b32 s63, 1180032
    s_mul_i32 s95, s68, -44
    global_load_ushort v11, v11, s[14:15] offset:24
    v_mul_u32_u24 v19, 6242, v73
    v_lshrrev_b32 v124, 16, v124
    v_lshrrev_b32 v19, 20, v19
    v_and_or_b32 v39, v124, 3, s97
    v_xor_b32 v39, v73, v39
    v_lshl_add_u32 v127, v39, 4, s99
    v_mad_u32_u24 v127, v19, s98, v127
    v_add_u32 v126, 256, v9
    v_mul_u32_u24 v39, 2731, v126
    v_mul_u32_u24 v9, 6242, v126
    v_lshrrev_b32 v39, 16, v39
    v_lshrrev_b32 v9, 20, v9
    v_and_or_b32 v73, v39, 3, s97
    v_xor_b32 v73, v126, v73
    v_lshl_add_u32 v126, v73, 4, s99
    v_mad_u32_u24 v126, v9, s98, v126
    s_cmp_ge_u32 s2, 240
    s_cbranch_scc1 L_bndS
L_bndrS:
    s_mul_i32 s94, s69, 58255
    s_lshr_b32 s94, s94, 22
    s_mul_i32 s94, s94, s63
    s_mul_i32 s72, s69, s62
    s_add_u32 s72, s72, s94
    v_lshl_or_b32 v143, v40, 4, 2.0
    s_sub_u32 s94, s73, 1
    s_max_u32 s94, s94, 20
    s_movk_i32 s99, -24
    s_add_u32 m0, s54, 0
    v_and_b32 v19, -4, v26
    s_mul_i32 s85, s68, 96
    s_sub_u32 s100, s85, 1024
    buffer_load_dwordx4 v130, s[24:27], s72 offen nt lds
    s_add_u32 m0, s54, 1024
    v_mad_u32_u24 v9, v19, 3, v26
    v_add_u32 v9, s95, v9
    v_mad_i32_i24 v38, v26, s99, v27
    v_med3_u32 v19, v9, 20, s94
    v_add_u32 v19, s70, v19
    v_add_u32 v39, s69, v9
    s_sub_u32 s87, s85, 2048
    s_movk_i32 s91, 1152
    buffer_load_dwordx4 v129, s[24:27], s72 offen nt lds
    v_cmp_gt_u32 vcc, s71, v9
    v_lshl_add_u32 v38, v38, 4, s93
    s_add_u32 m0, s54, 43008
    v_cndmask_b32 v39, v19, v39, vcc
    v_mul_u32_u24 v19, 58255, v39
    v_mad_u32_u24 v38, v39, s62, v38
    v_lshrrev_b32 v19, 22, v19
    v_mad_u32_u24 v38, v19, s63, v38
    s_mul_i32 s90, s68, 3072
    s_add_u32 s90, s90, 61440
    buffer_load_dwordx4 v38, s[24:27], 0 offen  lds
    v_lshlrev_b32 v39, 16, v9
    s_add_u32 m0, s54, 2048
    v_and_b32 v19, -4, v131
    v_mad_u32_u24 v9, v19, 3, v131
    v_add_u32 v9, s95, v9
    v_mad_i32_i24 v37, v131, s99, v37
    v_med3_u32 v19, v9, 20, s94
    s_mov_b32 s28, s22
    s_mov_b32 s29, s23
    buffer_load_dwordx4 v128, s[24:27], s72 offen nt lds
    v_add_u32 v19, s70, v19
    v_add_u32 v131, s69, v9
    v_cmp_gt_u32 vcc, s71, v9
    v_lshl_add_u32 v37, v37, 4, s93
    s_add_u32 m0, s54, 41984
    v_cndmask_b32 v131, v19, v131, vcc
    v_mul_u32_u24 v19, 58255, v131
    v_mad_u32_u24 v37, v131, s62, v37
    v_lshrrev_b32 v19, 22, v19
    v_mad_u32_u24 v37, v19, s63, v37
    s_mov_b32 s41, 0x2a8cbccc
    s_mov_b32 s42, 0x38fba882
    buffer_load_dwordx4 v37, s[24:27], 0 offen  lds
    v_lshl_or_b32 v39, v9, 8, v39
    s_add_u32 m0, s54, 3072
    v_cmp_gt_u32 vcc, 32, v40
    v_and_b32 v131, -4, v8
    v_mad_u32_u24 v19, v131, 3, v8
    v_cndmask_b32 v126, v143, v126, vcc
    v_add_u32 v19, s95, v19
    s_mov_b32 s43, 0x415db3d7
    s_mov_b32 s44, 61440
    buffer_load_dwordx4 v127, s[24:27], s72 offen nt lds
    s_add_u32 m0, s54, 4096
    v_mad_i32_i24 v36, v8, s99, v36
    v_med3_u32 v131, v19, 20, s94
    v_add_u32 v131, s70, v131
    v_add_u32 v8, s69, v19
    v_cmp_gt_u32 vcc, s71, v19
    v_lshl_add_u32 v36, v36, 4, s93
    s_mul_i32 s93, s68, 6
    s_lshl_b32 s94, s97, 1
    buffer_load_dwordx4 v126, s[24:27], s72 offen nt lds
    v_cndmask_b32 v8, v131, v8, vcc
    v_mul_u32_u24 v131, 58255, v8
    v_mad_u32_u24 v36, v8, s62, v36
    v_lshrrev_b32 v131, 22, v131
    v_mad_u32_u24 v36, v131, s63, v36
    s_add_u32 m0, s54, 40960
    v_lshl_or_b32 v39, v19, 0, v39
    s_mov_b32 s45, 40960
    s_mov_b32 s46, 20480
    buffer_load_dwordx4 v36, s[24:27], 0 offen nt lds
    v_mul_u32_u24 v72, 10923, v40
    v_lshrrev_b32 v56, 17, v72
    v_lshrrev_b32 v72, 16, v72
    v_mad_i32_i24 v131, v72, -6, v40
    v_bitop3_b32 v56, v56, v72, 4 bitop3:0x28
    v_lshl_add_u32 v131, v131, 4, s85
    v_mul_u32_u24 v56, 3, v56
    v_xor_b32 v72, v72, v56
    v_mad_u32_u24 v56, v72, s91, v131
    v_add_u32 v8, 64, v40
    v_mul_u32_u24 v9, 10923, v8
    v_lshrrev_b32 v13, 17, v9
    v_lshrrev_b32 v9, 16, v9
    v_mad_i32_i24 v73, v9, -6, v8
    v_bitop3_b32 v13, v13, v9, 4 bitop3:0x28
    v_lshl_add_u32 v73, v73, 4, s100
    v_mul_u32_u24 v13, 3, v13
    v_xor_b32 v9, v9, v13
    v_mad_u32_u24 v13, v9, s91, v73
    v_add_u32 v8, 128, v40
    v_mul_u32_u24 v19, 10923, v8
    v_lshrrev_b32 v12, 17, v19
    v_lshrrev_b32 v19, 16, v19
    v_mad_i32_i24 v8, v19, -6, v8
    v_bitop3_b32 v12, v12, v19, 4 bitop3:0x28
    v_lshl_add_u32 v8, v8, 4, s87
    v_mul_u32_u24 v12, 3, v12
    v_xor_b32 v19, v19, v12
    v_mad_u32_u24 v12, v19, s91, v8
    v_mad_u32_u24 v72, v72, s86, v131
    v_mad_u32_u24 v9, v9, s86, v73
    v_mad_u32_u24 v8, v19, s86, v8
    s_add_u32 m0, s90, 0
    s_mov_b32 s92, 0
    buffer_load_dwordx4 v56, s[32:35], s92 offen offset:0 lds
    v_mov_b32 v19, 0x3f803f80
    v_cmp_eq_u32 vcc, 0, v142
    v_and_b32 v73, 1, v40
    v_lshlrev_b32 v73, 4, v73
    v_cndmask_b32 v220, 0, v19, vcc
    v_cndmask_b32 v221, 0, v19, vcc
    v_cndmask_b32 v222, 0, v19, vcc
    v_cndmask_b32 v223, 0, v19, vcc
    v_mov_b32 v19, 0x3f80
    v_lshlrev_b32 v19, v73, v19
    v_cmp_gt_u32 vcc, 2, v142
    v_mov_b32 v171, 0
    v_mov_b32 v167, 0
    v_cndmask_b32 v216, 0, v19, vcc
    v_cndmask_b32 v218, 0, v19, vcc
    v_cmp_le_u32 vcc, 2, v142
    v_mov_b32 v163, 0
    v_mov_b32 v159, 0
    v_cndmask_b32 v217, 0, v19, vcc
    v_cndmask_b32 v219, 0, v19, vcc
    v_cmp_eq_u32 vcc, v151, v150
    v_mov_b32 v152, 0
    v_mov_b32 v153, 0
    v_cndmask_b32 v146, 0, v216, vcc
    v_cndmask_b32 v147, 0, v217, vcc
    v_mov_b32 v148, 0
    v_mov_b32 v149, 0
    v_mov_b32 v144, 0
    v_mov_b32 v145, 0
    v_mov_b32 v140, 0
    v_mov_b32 v141, 0
    v_lshrrev_b32 v15, 1, v151
    v_lshl_add_u32 v14, v151, 2, v150
    v_lshl_add_u32 v14, v15, 3, v14
    v_mul_u32_u24 v14, 96, v14
    v_add_u32 v14, s90, v14
    v_lshl_add_u32 v15, v142, 4, v14
    v_lshl_add_u32 v14, v142, 3, v14
    s_waitcnt lgkmcnt(0)
    s_lshl_b32 s84, s68, 4
    s_lshr_b64 s[82:83], s[82:83], s84
    s_lshl_b32 s82, s82, 16
    v_mov_b32 v27, s82
    v_min_f32 v27, 0x40930000, v27
    v_max_f32 v27, 0xc2c80000, v27
    v_mul_f32 v27, 0x3fb8aa3b, v27
    v_exp_f32 v27, v27
    v_mov_b32 v26, 0
    v_cvt_pk_bf16_f32 v27, v27, v27
    v_lshlrev_b32 v27, 16, v27
    v_mul_f32 v27, 0x4038aa3b, v27
    v_mov_b32 v19, 0
    v_readfirstlane_b32 s55, v27
    v_add_f32 v27, v27, v27
    v_mul_u32_u24 v155, 5120, v151
    v_readfirstlane_b32 s52, v27
    v_add_u32 v155, v10, v155
    s_mov_b32 s84, 0x41b8aa3b
    v_mov_b32 v10, 0xc138aa3b
    v_mul_u32_u24 v124, 5120, v150
    v_mad_u32_u24 v124, v142, s86, v124
    v_and_b32 v27, 7, v154
    v_xor_b32 v125, v27, v151
    v_lshl_add_u32 v73, v125, 4, v124
    s_mov_b32 s47, 0
    s_mov_b32 s57, s72
    buffer_load_dwordx4 v13, s[32:35], s92 offen offset:1024 lds
    v_xor_b32 v35, 64, v73
    v_add_u32 v139, 40960, v73
    v_xor_b32 v138, 64, v139
    v_add_u32 v124, 61440, v124
    v_add_u32 v125, s93, v151
    v_xor_b32 v125, v27, v125
    v_lshl_add_u32 v137, v125, 4, v124
    s_mov_b32 s58, 0
    s_mov_b32 s59, 0
    buffer_load_dwordx4 v12, s[32:35], s92 offen offset:2048 lds
    s_add_u32 m0, s90, 12288
    s_mov_b32 s92, 36864
    v_lshrrev_b32 v125, 1, v151
    v_add3_u32 v125, v125, s93, 4
    v_xor_b32 v125, v27, v125
    v_lshl_add_u32 v125, v125, 4, v124
    v_and_b32 v124, 1, v151
    s_add_u32 s93, s54, 20480
    s_mov_b32 s60, 0
    buffer_load_dwordx4 v56, s[32:35], s92 offen offset:0 lds
    s_waitcnt vmcnt(16)
    v_lshl_or_b32 v24, v25, 16, v24
    v_cmp_gt_u32 vcc, 16, v40
    v_mov_b32 v25, 0
    v_lshl_add_u32 v136, v124, 3, v125
    v_cndmask_b32 v27, 0, v24, vcc
    v_cndmask_b32 v24, 0, v24, vcc
    v_lshlrev_b32 v131, 4, v40
    v_mfma_f32_16x16x16_bf16 v[0:3], v[26:27], v[16:17], 0
    s_waitcnt vmcnt(14)
    s_mov_b32 s65, -1
    v_lshl_or_b32 v74, v32, 16, v74
    v_add_u32 v135, s93, v131
    v_mfma_f32_16x16x16_bf16 v[4:7], v[24:25], v[16:17], 0
    s_lshr_b32 s93, s68, 1
    v_add_u32 v131, 81920, v131
    v_mul_u32_u24 v124, 80, v151
    v_mfma_f32_16x16x16_bf16 v[20:23], v[24:25], v[18:19], 0
    s_waitcnt vmcnt(12)
    s_lshl_b32 s93, s93, 10
    buffer_load_dwordx4 v13, s[32:35], s92 offen offset:1024 lds
    v_lshl_or_b32 v75, v11, 16, v75
    v_max_f32 v0, 0, v0
    v_max_f32 v4, 0, v4
    v_max_f32 v5, 0, v5
    v_max_f32 v6, 0, v6
    v_max_f32 v7, 0, v7
    v_cvt_pk_bf16_f32 v4, v4, v5
    v_cvt_pk_bf16_f32 v5, v6, v7
    v_max_f32 v1, 0, v1
    v_max_f32 v2, 0, v2
    v_mfma_f32_16x16x16_bf16 v[16:19], v[74:75], v[4:5], 0
    s_add_u32 s93, s93, s94
    v_max_f32 v3, 0, v3
    v_cvt_pk_bf16_f32 v0, v0, v1
    v_cvt_pk_bf16_f32 v1, v2, v3
    v_max_f32 v20, 0, v20
    v_max_f32 v21, 0, v21
    v_mfma_f32_16x16x16_bf16 v[4:7], v[74:75], v[0:1], 0
    s_mov_b32 s61, 1
    v_max_f32 v22, 0, v22
    v_max_f32 v23, 0, v23
    v_cvt_pk_bf16_f32 v20, v20, v21
    v_cvt_pk_bf16_f32 v21, v22, v23
    v_cvt_pk_bf16_f32 v16, v16, v16
    v_lshlrev_b32 v16, 16, v16
    v_mfma_f32_16x16x16_bf16 v[0:3], v[74:75], v[20:21], 0
    s_movk_i32 s4, 336
    v_mul_f32 v16, 0xbfb8aa3b, v16
    v_cvt_pk_bf16_f32 v4, v4, v4
    v_exp_f32 v16, v16
    v_lshlrev_b32 v4, 16, v4
    v_add_f32 v16, 1.0, v16
    v_rcp_f32 v16, v16
    v_mul_f32 v4, 0xbfb8aa3b, v4
    v_cvt_pk_bf16_f32 v16, v16, v16
    v_lshlrev_b32 v16, 16, v16
    v_fma_f32 v16, v16, s84, v10
    s_mov_b32 s5, 0
    s_mov_b32 s6, 0
    ds_write_b32 v155, v16 offset:44032
    v_exp_f32 v4, v4
    v_cvt_pk_bf16_f32 v0, v0, v0
    v_add_f32 v4, 1.0, v4
    v_rcp_f32 v4, v4
    v_lshlrev_b32 v0, 16, v0
    v_cvt_pk_bf16_f32 v4, v4, v4
    v_lshlrev_b32 v4, 16, v4
    v_fma_f32 v4, v4, s84, v10
    s_mov_b32 s12, 0
    s_mov_b32 s64, 3
    ds_write_b32 v155, v4 offset:44036
    v_mul_f32 v0, 0xbfb8aa3b, v0
    v_exp_f32 v0, v0
    v_add_u32 v132, s93, v131
    v_add_f32 v0, 1.0, v0
    v_rcp_f32 v0, v0
    s_mul_i32 s93, s68, 5376
    v_cvt_pk_bf16_f32 v0, v0, v0
    v_lshlrev_b32 v0, 16, v0
    v_fma_f32 v0, v0, s84, v10
    s_add_u32 s93, s93, 142336
    s_mov_b32 s10, 81924
    ds_write_b32 v155, v0 offset:44040
    v_add_u32 v125, s93, v124
    v_mul_u32_u24 v124, 336, v154
    v_add_u32 v34, v124, v125
    v_subrev_u32 v34, 21504, v34
    v_cmp_eq_u32 vcc, 0, v150
    v_mul_u32_u24 v124, 80, v150
    v_lshl_add_u32 v124, v151, 3, v124
    v_cndmask_b32 v134, v143, v125, vcc
    v_cmp_eq_u32 vcc, 3, v142
    v_lshl_add_u32 v124, v142, 1, v124
    v_add_u32 v124, s93, v124
    v_cndmask_b32 v134, v134, v125, vcc
    v_cmp_gt_u32 vcc, 3, v151
    v_mov_b32 v125, v124
    s_add_u32 s93, s69, 1
    v_cndmask_b32 v133, v143, v124, vcc
    s_mul_i32 s94, s93, 58255
    s_lshr_b32 s94, s94, 22
    s_mul_i32 s94, s94, s63
    s_mul_i32 s56, s93, s62
    s_add_u32 s56, s56, s94
    ds_write_b128 v34, v[216:219] offset:21584
    v_mov_b32 v124, 0
    s_sub_u32 s93, s71, 1
    s_cmp_eq_u32 s68, 0
    s_cselect_b32 s13, s93, -1
    s_cmp_gt_u32 s73, 20
    s_cselect_b32 s13, s13, -1
    s_and_b32 s93, s2, -8
    s_waitcnt lgkmcnt(1)
    s_barrier
    s_sub_u32 s93, 81920, s93
    s_sub_u32 s8, s38, s93
    s_subb_u32 s9, s39, 0
    s_mov_b32 s11, 0x20000
    s_mov_b32 s39, 0x00010001
    s_add_u32 s101, s54, 44032
    v_mul_u32_u24 v150, 48, v150
    v_lshl_add_u32 v150, v142, 2, v150
    v_mul_u32_u24 v32, 48, v151
    v_add_u32 v199, 0, v150
    v_mul_u32_u24 v33, 37, v199
    v_lshrrev_b32 v33, 10, v33
    v_mad_u32_u24 v199, v33, 24, v199
    v_add_u32 v199, s101, v199
    v_add_u32 v142, 16, v150
    v_mul_u32_u24 v33, 37, v142
    v_lshrrev_b32 v33, 10, v33
    v_mad_u32_u24 v142, v33, 24, v142
    v_add_u32 v142, s101, v142
    v_add_u32 v41, 32, v150
    v_mul_u32_u24 v33, 37, v41
    v_lshrrev_b32 v33, 10, v33
    v_mad_u32_u24 v41, v33, 24, v41
    v_add_u32 v41, s101, v41
    v_add_u32 v59, 0, v32
    v_mul_u32_u24 v33, 37, v59
    v_lshrrev_b32 v33, 10, v33
    v_mad_u32_u24 v59, v33, 24, v59
    v_add_u32 v57, 4, v32
    v_mul_u32_u24 v33, 37, v57
    v_lshrrev_b32 v33, 10, v33
    v_mad_u32_u24 v57, v33, 24, v57
    v_add_u32 v58, 8, v32
    v_mul_u32_u24 v33, 37, v58
    v_lshrrev_b32 v33, 10, v33
    v_mad_u32_u24 v58, v33, 24, v58
    v_add_u32 v75, 12, v32
    v_mul_u32_u24 v33, 37, v75
    v_lshrrev_b32 v33, 10, v33
    v_mad_u32_u24 v75, v33, 24, v75
    v_add_u32 v74, 16, v32
    v_mul_u32_u24 v33, 37, v74
    v_lshrrev_b32 v33, 10, v33
    v_mad_u32_u24 v74, v33, 24, v74
    v_add_u32 v42, 20, v32
    v_mul_u32_u24 v33, 37, v42
    v_lshrrev_b32 v33, 10, v33
    v_mad_u32_u24 v42, v33, 24, v42
    v_add_u32 v43, 24, v32
    v_mul_u32_u24 v33, 37, v43
    v_lshrrev_b32 v33, 10, v33
    v_mad_u32_u24 v43, v33, 24, v43
    v_add_u32 v179, 28, v32
    v_mul_u32_u24 v33, 37, v179
    v_lshrrev_b32 v33, 10, v33
    v_mad_u32_u24 v179, v33, 24, v179
    v_add_u32 v11, 32, v32
    v_mul_u32_u24 v10, 37, v11
    v_lshrrev_b32 v10, 10, v10
    v_mad_u32_u24 v11, v10, 24, v11
    v_add_u32 v10, 36, v32
    v_mul_u32_u24 v33, 37, v10
    v_lshrrev_b32 v33, 10, v33
    v_mad_u32_u24 v10, v33, 24, v10
    v_add_u32 v155, 40, v32
    s_lshr_b32 s93, s68, 1
    s_mul_i32 s93, s93, 30720
    buffer_load_dwordx4 v12, s[32:35], s92 offen offset:2048 lds
    s_add_u32 m0, s90, 24576
    s_mov_b32 s92, 73728
    ds_read_b32 v208, v199
    v_mul_u32_u24 v33, 37, v155
    v_lshrrev_b32 v33, 10, v33
    v_mad_u32_u24 v155, v33, 24, v155
    v_add_u32 v32, 44, v32
    v_mul_u32_u24 v33, 37, v32
    v_lshrrev_b32 v33, 10, v33
    v_mad_u32_u24 v32, v33, 24, v32
    v_lshl_add_u32 v33, v151, 4, v150
    v_mul_u32_u24 v156, 37, v33
    v_lshrrev_b32 v156, 10, v156
    v_mad_u32_u24 v33, v156, 24, v33
    v_mov_b32 v156, 336
    v_cmp_gt_u32 vcc, 3, v151
    v_sub_u32 v204, v199, v59
    s_and_b32 s94, s68, 1
    v_cndmask_b32 v33, v156, v33, vcc
    v_sub_u32 v33, s101, v33
    s_mul_i32 s94, s94, -2304
    s_add_u32 s93, s93, s94
    buffer_load_dwordx4 v56, s[32:35], s92 offen offset:0 lds
    ds_read_b32 v204, v204 offset:336
    v_sub_u32 v205, v199, v57
    v_sub_u32 v206, v199, v58
    v_sub_u32 v207, v199, v75
    v_sub_u32 v200, v199, v74
    v_sub_u32 v201, v199, v42
    s_lshl_b32 s94, s97, 4
    ds_read_b32 v205, v205 offset:336
    v_sub_u32 v202, v199, v43
    buffer_load_dwordx4 v13, s[32:35], s92 offen offset:1024 lds
    v_sub_u32 v203, v199, v179
    ds_read_b32 v206, v206 offset:336
    v_sub_u32 v196, v199, v11
    v_sub_u32 v197, v199, v10
    v_sub_u32 v198, v199, v155
    v_sub_u32 v199, v199, v32
    v_sub_u32 v192, v142, v59
    ds_read_b32 v207, v207 offset:336
    v_sub_u32 v193, v142, v57
    v_sub_u32 v194, v142, v58
    v_sub_u32 v195, v142, v75
    v_sub_u32 v188, v142, v74
    v_sub_u32 v189, v142, v42
    ds_read_b32 v200, v200 offset:336
    v_sub_u32 v190, v142, v43
    buffer_load_dwordx4 v12, s[32:35], s92 offen offset:2048 lds
    s_add_u32 m0, s90, 36864
    s_mov_b32 s92, 110592
    ds_read_b32 v201, v201 offset:336
    v_sub_u32 v191, v142, v179
    v_sub_u32 v184, v142, v11
    v_sub_u32 v185, v142, v10
    v_sub_u32 v186, v142, v155
    v_sub_u32 v187, v142, v32
    s_waitcnt vmcnt(9)
    s_barrier
    ds_read_b32 v202, v202 offset:336
    v_sub_u32 v180, v41, v59
    v_sub_u32 v181, v41, v57
    v_sub_u32 v182, v41, v58
    v_sub_u32 v183, v41, v75
    v_sub_u32 v176, v41, v74
    ds_read_b32 v203, v203 offset:336
    v_sub_u32 v177, v41, v42
    v_sub_u32 v178, v41, v43
    v_sub_u32 v179, v41, v179
    v_sub_u32 v172, v41, v11
    v_sub_u32 v173, v41, v10
    ds_read_b32 v196, v196 offset:336
    v_sub_u32 v174, v41, v155
    v_sub_u32 v175, v41, v32
    buffer_load_dwordx4 v56, s[32:35], s92 offen offset:0 lds
    ds_read_b32 v197, v197 offset:336
    v_mov_b32 v57, 0xf149f2ca
    v_mov_b32 v58, 0x3f80
    v_mov_b32 v59, 0
    v_mov_b32 v42, 0x3f80
    v_mov_b32 v43, 0
    ds_read_b32 v198, v198 offset:336
    v_and_b32 v155, 8, v154
    v_add_u32 v155, v155, v154
    v_mul_u32_u24 v155, 96, v155
    v_add_u32 v155, s90, v155
    v_lshl_add_u32 v32, v151, 4, v155
    ds_read_b32 v199, v199 offset:336
    buffer_load_dwordx4 v13, s[32:35], s92 offen offset:1024 lds
    v_lshl_add_u32 v75, v151, 3, v155
    v_add_u32 v11, s93, v32
    v_add_u32 v10, s93, v75
    v_lshlrev_b32 v74, 4, v151
    s_lshr_b32 s93, s68, 1
    s_mul_i32 s93, s93, 5120
    ds_read_b32 v211, v33 offset:672
    v_add_u32 v74, 4608, v74
    s_add_u32 s93, s93, s94
    v_add_u32 v33, s93, v74
    v_cmp_eq_u32 vcc, 0, v154
    s_nop 0
    ds_read_b32 v192, v192 offset:336
    v_cndmask_b32 v33, v143, v33, vcc
    buffer_load_dwordx4 v12, s[32:35], s92 offen offset:2048 lds
    s_add_u32 m0, s90, 49152
    s_mov_b32 s92, 147456
    ds_read_b32 v193, v193 offset:336
    ds_read_b32 v194, v194 offset:336
    ds_read_b32 v195, v195 offset:336
    buffer_load_dwordx4 v56, s[32:35], s92 offen offset:0 lds
    ds_read_b32 v188, v188 offset:336
    ds_read_b32 v189, v189 offset:336
    ds_read_b32 v190, v190 offset:336
    ds_read_b32 v191, v191 offset:336
    buffer_load_dwordx4 v13, s[32:35], s92 offen offset:1024 lds
    ds_read_b32 v184, v184 offset:336
    ds_read_b32 v185, v185 offset:336
    ds_read_b32 v186, v186 offset:336
    buffer_load_dwordx4 v12, s[32:35], s92 offen offset:2048 lds
    s_add_u32 m0, s90, 61440
    s_mov_b32 s92, 184320
    ds_read_b32 v187, v187 offset:336
    ds_read_b32 v209, v142
    ds_read_b32 v180, v180 offset:336
    buffer_load_dwordx4 v56, s[32:35], s92 offen offset:0 lds
    ds_read_b32 v181, v181 offset:336
    ds_read_b32 v182, v182 offset:336
    ds_read_b32 v183, v183 offset:336
    ds_read_b32 v176, v176 offset:336
    buffer_load_dwordx4 v13, s[32:35], s92 offen offset:1024 lds
    ds_read_b32 v177, v177 offset:336
    ds_read_b32 v178, v178 offset:336
    ds_read_b32 v179, v179 offset:336
    buffer_load_dwordx4 v12, s[32:35], s92 offen offset:2048 lds
    ds_read_b32 v172, v172 offset:336
    ds_read_b32 v173, v173 offset:336
    ds_read_b32 v174, v174 offset:336
    ds_read_b32 v175, v175 offset:336
    ds_read_b32 v210, v41
    s_waitcnt vmcnt(15)
    ds_read_b64_tr_b16 a[0:1], v14 offset:0
    ds_read_b64_tr_b16 a[2:3], v14 offset:768
    ds_read_b64_tr_b16 a[24:25], v14 offset:32
    ds_read_b64_tr_b16 a[26:27], v14 offset:800
    ds_read_b64_tr_b16 a[48:49], v14 offset:64
    ds_read_b64_tr_b16 a[50:51], v14 offset:832
    s_add_u32 m0, s90, 0
    s_mov_b32 s92, 384
    s_waitcnt vmcnt(12)
    ds_read_b64_tr_b16 a[4:5], v14 offset:12288
    ds_read_b64_tr_b16 a[6:7], v14 offset:13056
    ds_read_b64_tr_b16 a[28:29], v14 offset:12320
    ds_read_b64_tr_b16 a[30:31], v14 offset:13088
    ds_read_b64_tr_b16 a[52:53], v14 offset:12352
    ds_read_b64_tr_b16 a[54:55], v14 offset:13120
    s_waitcnt vmcnt(9)
    ds_read_b64_tr_b16 a[8:9], v14 offset:24576
    ds_read_b64_tr_b16 a[10:11], v14 offset:25344
    ds_read_b64_tr_b16 a[32:33], v14 offset:24608
    s_waitcnt lgkmcnt(15)
    s_cmp_ge_u32 s2, 247
    s_cbranch_scc1 L_maskS
L_nomaskS:
    v_cmp_gt_u32 vcc, 16, v40
    v_readlane_b32 s84, v211, 48
    ds_read_b64_tr_b16 a[34:35], v14 offset:25376
    v_cndmask_b32 v208, v57, v208, vcc
    v_cndmask_b32 v209, v57, v209, vcc
    v_cndmask_b32 v210, v57, v210, vcc
    v_cmp_gt_u32 vcc, 49, v40
    ds_read_b64_tr_b16 a[56:57], v14 offset:24640
    s_waitcnt lgkmcnt(10)
    buffer_load_dwordx4 v56, s[32:35], s92 offen offset:0 lds
    ds_read_b64_tr_b16 a[58:59], v14 offset:25408
    v_cndmask_b32 v211, v57, v211, vcc
    s_waitcnt vmcnt(7)
    ds_read_b64_tr_b16 a[12:13], v14 offset:36864
    ds_read_b64_tr_b16 a[14:15], v14 offset:37632
    buffer_load_dwordx4 v13, s[32:35], s92 offen offset:1024 lds
    ds_read_b64_tr_b16 a[36:37], v14 offset:36896
    ds_read_b64_tr_b16 a[38:39], v14 offset:37664
    ds_read_b64_tr_b16 a[60:61], v14 offset:36928
    ds_read_b64_tr_b16 a[62:63], v14 offset:37696
    buffer_load_dwordx4 v12, s[32:35], s92 offen offset:2048 lds
    s_add_u32 m0, s90, 12288
    s_mov_b32 s92, 37248
    ds_read_b128 v[68:71], v73 offset:40960
    ds_read_b128 v[64:67], v35 offset:40960
    s_waitcnt lgkmcnt(10)
    buffer_load_dwordx4 v56, s[32:35], s92 offen offset:0 lds
    ds_read_b128 v[60:63], v73 offset:41088
    ds_read_b128 v[48:51], v35 offset:41088
    buffer_load_dwordx4 v13, s[32:35], s92 offen offset:1024 lds
    ds_read_b128 v[44:47], v73 offset:41216
    ds_read_b128 v[28:31], v35 offset:41216
    buffer_load_dwordx4 v12, s[32:35], s92 offen offset:2048 lds
    s_add_u32 m0, s90, 24576
    s_mov_b32 s92, 74112
    s_waitcnt vmcnt(9)
    ds_read_b64_tr_b16 a[16:17], v14 offset:49152
    ds_read_b64_tr_b16 a[18:19], v14 offset:49920
    ds_read_b64_tr_b16 a[40:41], v14 offset:49184
    ds_read_b64_tr_b16 a[42:43], v14 offset:49952
    ds_read_b64_tr_b16 a[64:65], v14 offset:49216
    ds_read_b64_tr_b16 a[66:67], v14 offset:49984
    s_waitcnt lgkmcnt(9)
    buffer_load_dwordx4 v56, s[32:35], s92 offen offset:0 lds
    buffer_load_dwordx4 v13, s[32:35], s92 offen offset:1024 lds
    buffer_load_dwordx4 v12, s[32:35], s92 offen offset:2048 lds
    s_add_u32 m0, s90, 36864
    s_mov_b32 s92, 110976
    s_waitcnt vmcnt(9)
    ds_read_b64_tr_b16 a[20:21], v14 offset:61440
    ds_read_b64_tr_b16 a[22:23], v14 offset:62208
    v_mfma_f32_16x16x32_bf16 v[92:95], a[0:3], v[68:71], 0
    ds_read_b64_tr_b16 a[44:45], v14 offset:61472
    v_mfma_f32_16x16x32_bf16 v[92:95], a[4:7], v[64:67], v[92:95]
    ds_read_b64_tr_b16 a[46:47], v14 offset:62240
    v_mfma_f32_16x16x32_bf16 v[92:95], a[8:11], v[60:63], v[92:95]
    s_waitcnt lgkmcnt(4)
    ds_read_b64_tr_b16 a[68:69], v14 offset:61504
    v_mfma_f32_16x16x32_bf16 v[92:95], a[12:15], v[48:51], v[92:95]
    ds_read_b64_tr_b16 a[70:71], v14 offset:62272
    v_mfma_f32_16x16x32_bf16 v[92:95], a[16:19], v[44:47], v[92:95]
    ds_read_b128 v[24:27], v73 offset:42496
    ds_read_b128 v[20:23], v35 offset:42496
    ds_read_b128 v[16:19], v73 offset:42624
    ds_read_b128 v[52:55], v35 offset:42624
    s_waitcnt lgkmcnt(7)
    v_mfma_f32_16x16x32_bf16 v[92:95], a[20:23], v[28:31], v[92:95]
    ds_read_b128 v[4:7], v73 offset:42752
    s_nop 0
    v_mfma_f32_16x16x32_bf16 v[100:103], a[24:27], v[68:71], 0
    s_nop 0
    ds_read_b128 v[0:3], v35 offset:42752
    s_nop 0
    v_mfma_f32_16x16x32_bf16 v[100:103], a[28:31], v[64:67], v[100:103]
    s_nop 0
    v_fma_f32 v41, v92, v92, s41
    v_fmac_f32 v41, v93, v93
    v_mfma_f32_16x16x32_bf16 v[100:103], a[32:35], v[60:63], v[100:103]
    v_fmac_f32 v41, v94, v94
    v_fmac_f32 v41, v95, v95
    v_mfma_f32_16x16x32_bf16 v[100:103], a[36:39], v[48:51], v[100:103]
    v_mfma_f32_16x16x32_bf16 v[100:103], a[40:43], v[44:47], v[100:103]
    s_waitcnt lgkmcnt(4)
    v_mfma_f32_16x16x32_bf16 v[100:103], a[44:47], v[28:31], v[100:103]
    s_nop 0
    v_mfma_f32_16x16x32_bf16 v[96:99], a[48:51], v[68:71], 0
    s_nop 2
    v_mfma_f32_16x16x32_bf16 v[96:99], a[52:55], v[64:67], v[96:99]
    s_nop 0
    buffer_load_dwordx4 v56, s[32:35], s92 offen offset:0 lds
    v_fmac_f32 v41, v100, v100
    v_mfma_f32_16x16x32_bf16 v[96:99], a[56:59], v[60:63], v[96:99]
    v_fmac_f32 v41, v101, v101
    v_fmac_f32 v41, v102, v102
    v_mfma_f32_16x16x32_bf16 v[96:99], a[60:63], v[48:51], v[96:99]
    v_fmac_f32 v41, v103, v103
    v_mfma_f32_16x16x32_bf16 v[96:99], a[64:67], v[44:47], v[96:99]
    v_mfma_f32_16x16x32_bf16 v[96:99], a[68:71], v[28:31], v[96:99]
    s_nop 0
    v_mfma_f32_16x16x32_bf16 v[48:51], a[0:3], v[24:27], 0
    s_nop 0
    buffer_load_dwordx4 v13, s[32:35], s92 offen offset:1024 lds
    s_nop 0
    v_mfma_f32_16x16x32_bf16 v[48:51], a[4:7], v[20:23], v[48:51]
    s_waitcnt lgkmcnt(0)
    s_nop 0
    v_fmac_f32 v41, v96, v96
    v_fmac_f32 v41, v97, v97
    v_mfma_f32_16x16x32_bf16 v[48:51], a[8:11], v[16:19], v[48:51]
    v_fmac_f32 v41, v98, v98
    v_fmac_f32 v41, v99, v99
    v_mfma_f32_16x16x32_bf16 v[48:51], a[12:15], v[52:55], v[48:51]
    ds_read_b128 v[108:111], v73 offset:40960
    v_mfma_f32_16x16x32_bf16 v[48:51], a[16:19], v[4:7], v[48:51]
    ds_read_b128 v[80:83], v35 offset:40960
    v_mfma_f32_16x16x32_bf16 v[48:51], a[20:23], v[0:3], v[48:51]
    s_waitcnt vmcnt(8)
    buffer_load_dwordx4 v12, s[32:35], s92 offen offset:2048 lds
    ds_read_b64_tr_b16 a[72:73], v14 offset:0
    v_mfma_f32_16x16x32_bf16 v[44:47], a[24:27], v[24:27], 0
    s_add_u32 m0, s90, 49152
    ds_read_b64_tr_b16 a[74:75], v14 offset:768
    v_mfma_f32_16x16x32_bf16 v[44:47], a[28:31], v[20:23], v[44:47]
    s_mov_b32 s92, 147840
    ds_read_b64_tr_b16 a[96:97], v14 offset:32
    v_fma_f32 v40, v48, v48, s41
    v_mfma_f32_16x16x32_bf16 v[44:47], a[32:35], v[16:19], v[44:47]
    ds_read_b64_tr_b16 a[98:99], v14 offset:800
    v_fmac_f32 v40, v49, v49
    v_mfma_f32_16x16x32_bf16 v[44:47], a[36:39], v[52:55], v[44:47]
    ds_read_b64_tr_b16 a[120:121], v14 offset:64
    v_fmac_f32 v40, v50, v50
    v_mfma_f32_16x16x32_bf16 v[44:47], a[40:43], v[4:7], v[44:47]
    buffer_load_dwordx4 v56, s[32:35], s92 offen offset:0 lds
    ds_read_b64_tr_b16 a[122:123], v14 offset:832
    v_mfma_f32_16x16x32_bf16 v[44:47], a[44:47], v[0:3], v[44:47]
    ds_read_b128 v[76:79], v73 offset:41088
    v_fmac_f32 v40, v51, v51
    v_mfma_f32_16x16x32_bf16 v[28:31], a[48:51], v[24:27], 0
    ds_read_b128 v[24:27], v35 offset:41088
    s_nop 0
    v_mfma_f32_16x16x32_bf16 v[28:31], a[52:55], v[20:23], v[28:31]
    s_nop 0
    ds_read_b128 v[20:23], v73 offset:41216
    v_fmac_f32 v40, v44, v44
    v_mfma_f32_16x16x32_bf16 v[28:31], a[56:59], v[16:19], v[28:31]
    ds_read_b128 v[16:19], v35 offset:41216
    v_fmac_f32 v40, v45, v45
    v_mfma_f32_16x16x32_bf16 v[28:31], a[60:63], v[52:55], v[28:31]
    buffer_load_dwordx4 v13, s[32:35], s92 offen offset:1024 lds
    v_fmac_f32 v40, v46, v46
    v_mfma_f32_16x16x32_bf16 v[28:31], a[64:67], v[4:7], v[28:31]
    v_fmac_f32 v40, v47, v47
    v_mfma_f32_16x16x32_bf16 v[28:31], a[68:71], v[0:3], v[28:31]
    s_nop 7
    v_fmac_f32 v40, v28, v28
    v_fmac_f32 v40, v29, v29
    v_fmac_f32 v40, v30, v30
    v_fmac_f32 v40, v31, v31
    buffer_load_dwordx4 v12, s[32:35], s92 offen offset:2048 lds
    s_add_u32 m0, s90, 61440
    s_mov_b32 s92, 184704
    s_waitcnt vmcnt(9)
    ds_read_b64_tr_b16 a[76:77], v14 offset:12288
    ds_read_b64_tr_b16 a[78:79], v14 offset:13056
    ds_read_b64_tr_b16 a[100:101], v14 offset:12320
    ds_read_b64_tr_b16 a[102:103], v14 offset:13088
    ds_read_b64_tr_b16 a[124:125], v14 offset:12352
    ds_read_b64_tr_b16 a[126:127], v14 offset:13120
    buffer_load_dwordx4 v56, s[32:35], s92 offen offset:0 lds
    buffer_load_dwordx4 v13, s[32:35], s92 offen offset:1024 lds
    buffer_load_dwordx4 v12, s[32:35], s92 offen offset:2048 lds
    s_add_u32 m0, s90, 0
    s_mov_b32 s92, 768
    s_waitcnt vmcnt(9)
    ds_read_b64_tr_b16 a[80:81], v14 offset:24576
    ds_read_b64_tr_b16 a[82:83], v14 offset:25344
    ds_read_b64_tr_b16 a[104:105], v14 offset:24608
    ds_read_b64_tr_b16 a[106:107], v14 offset:25376
    ds_read_b64_tr_b16 a[128:129], v14 offset:24640
    ds_read_b64_tr_b16 a[130:131], v14 offset:25408
    s_waitcnt lgkmcnt(6)
    buffer_load_dwordx4 v56, s[32:35], s92 offen offset:0 lds
    buffer_load_dwordx4 v13, s[32:35], s92 offen offset:1024 lds
    buffer_load_dwordx4 v12, s[32:35], s92 offen offset:2048 lds
    s_add_u32 m0, s90, 12288
    s_mov_b32 s92, 37632
    s_waitcnt vmcnt(9)
    ds_read_b64_tr_b16 a[84:85], v14 offset:36864
    ds_read_b64_tr_b16 a[86:87], v14 offset:37632
    ds_read_b64_tr_b16 a[108:109], v14 offset:36896
    ds_read_b64_tr_b16 a[110:111], v14 offset:37664
    ds_read_b64_tr_b16 a[132:133], v14 offset:36928
    ds_read_b64_tr_b16 a[134:135], v14 offset:37696
    buffer_load_dwordx4 v56, s[32:35], s92 offen offset:0 lds
    buffer_load_dwordx4 v13, s[32:35], s92 offen offset:1024 lds
    buffer_load_dwordx4 v12, s[32:35], s92 offen offset:2048 lds
    s_add_u32 m0, s90, 24576
    s_mov_b32 s92, 74496
    s_waitcnt vmcnt(9)
    ds_read_b64_tr_b16 a[88:89], v14 offset:49152
    ds_read_b64_tr_b16 a[90:91], v14 offset:49920
    ds_read_b64_tr_b16 a[112:113], v14 offset:49184
    ds_read_b64_tr_b16 a[114:115], v14 offset:49952
    ds_read_b64_tr_b16 a[136:137], v14 offset:49216
    ds_read_b64_tr_b16 a[138:139], v14 offset:49984
    s_waitcnt lgkmcnt(6)
    buffer_load_dwordx4 v56, s[32:35], s92 offen offset:0 lds
    buffer_load_dwordx4 v13, s[32:35], s92 offen offset:1024 lds
    buffer_load_dwordx4 v12, s[32:35], s92 offen offset:2048 lds
    s_add_u32 m0, s90, 36864
    s_mov_b32 s92, 111360
    s_waitcnt vmcnt(9)
    ds_read_b64_tr_b16 a[92:93], v14 offset:61440
    ds_read_b64_tr_b16 a[94:95], v14 offset:62208
    v_mfma_f32_16x16x32_bf16 v[52:55], a[72:75], v[108:111], 0
    ds_read_b64_tr_b16 a[116:117], v14 offset:61472
    v_mfma_f32_16x16x32_bf16 v[52:55], a[76:79], v[80:83], v[52:55]
    ds_read_b64_tr_b16 a[118:119], v14 offset:62240
    v_mfma_f32_16x16x32_bf16 v[52:55], a[80:83], v[76:79], v[52:55]
    ds_read_b64_tr_b16 a[140:141], v14 offset:61504
    v_mfma_f32_16x16x32_bf16 v[52:55], a[84:87], v[24:27], v[52:55]
    s_waitcnt lgkmcnt(5)
    buffer_load_dwordx4 v56, s[32:35], s92 offen offset:0 lds
    ds_read_b64_tr_b16 a[142:143], v14 offset:62272
    v_mfma_f32_16x16x32_bf16 v[52:55], a[88:91], v[20:23], v[52:55]
    ds_read_b128 v[104:107], v73 offset:42496
    ds_read_b128 v[84:87], v35 offset:42496
    ds_read_b128 v[68:71], v73 offset:42624
    ds_read_b128 v[64:67], v35 offset:42624
    s_waitcnt lgkmcnt(7)
    v_mfma_f32_16x16x32_bf16 v[52:55], a[92:95], v[16:19], v[52:55]
    buffer_load_dwordx4 v13, s[32:35], s92 offen offset:1024 lds
    ds_read_b128 v[60:63], v73 offset:42752
    v_mfma_f32_16x16x32_bf16 v[88:91], a[96:99], v[108:111], 0
    s_nop 1
    ds_read_b128 v[0:3], v35 offset:42752
    v_mfma_f32_16x16x32_bf16 v[88:91], a[100:103], v[80:83], v[88:91]
    s_nop 0
    v_fma_f32 v57, v52, v52, s41
    v_fmac_f32 v57, v53, v53
    v_mfma_f32_16x16x32_bf16 v[88:91], a[104:107], v[76:79], v[88:91]
    v_fmac_f32 v57, v54, v54
    v_fmac_f32 v57, v55, v55
    v_mfma_f32_16x16x32_bf16 v[88:91], a[108:111], v[24:27], v[88:91]
    v_mfma_f32_16x16x32_bf16 v[88:91], a[112:115], v[20:23], v[88:91]
    s_waitcnt vmcnt(8) lgkmcnt(4)
    buffer_load_dwordx4 v12, s[32:35], s92 offen offset:2048 lds
    ds_read_b64_tr_b16 a[144:145], v15 offset:0
    v_mfma_f32_16x16x32_bf16 v[88:91], a[116:119], v[16:19], v[88:91]
    s_add_u32 m0, s90, 49152
    ds_read_b64_tr_b16 a[146:147], v15 offset:768
    v_mfma_f32_16x16x32_bf16 v[4:7], a[120:123], v[108:111], 0
    s_mov_b32 s92, 148224
    s_nop 0
    ds_read_b64_tr_b16 a[168:169], v15 offset:8
    v_mfma_f32_16x16x32_bf16 v[4:7], a[124:127], v[80:83], v[4:7]
    s_nop 0
    v_fmac_f32 v57, v88, v88
    v_fmac_f32 v57, v89, v89
    v_mfma_f32_16x16x32_bf16 v[4:7], a[128:131], v[76:79], v[4:7]
    ds_read_b64_tr_b16 a[170:171], v15 offset:776
    v_fmac_f32 v57, v90, v90
    v_mfma_f32_16x16x32_bf16 v[4:7], a[132:135], v[24:27], v[4:7]
    buffer_load_dwordx4 v56, s[32:35], s92 offen offset:0 lds
    ds_read_b64_tr_b16 a[192:193], v14 offset:64
    v_mfma_f32_16x16x32_bf16 v[4:7], a[136:139], v[20:23], v[4:7]
    ds_read_b64_tr_b16 a[194:195], v14 offset:832
    v_fmac_f32 v57, v91, v91
    v_mfma_f32_16x16x32_bf16 v[4:7], a[140:143], v[16:19], v[4:7]
    s_nop 0
    v_mfma_f32_16x16x32_bf16 v[16:19], a[72:75], v[104:107], 0
    s_nop 2
    v_mfma_f32_16x16x32_bf16 v[16:19], a[76:79], v[84:87], v[16:19]
    s_waitcnt lgkmcnt(5)
    s_nop 0
    v_fmac_f32 v57, v4, v4
    v_fmac_f32 v57, v5, v5
    v_mfma_f32_16x16x32_bf16 v[16:19], a[80:83], v[68:71], v[16:19]
    buffer_load_dwordx4 v13, s[32:35], s92 offen offset:1024 lds
    v_fmac_f32 v57, v6, v6
    v_mfma_f32_16x16x32_bf16 v[16:19], a[84:87], v[64:67], v[16:19]
    v_fmac_f32 v57, v7, v7
    v_cvt_pk_bf16_f32 v170, v41, v57
    v_mfma_f32_16x16x32_bf16 v[16:19], a[88:91], v[60:63], v[16:19]
    v_mfma_f32_16x16x32_bf16 v[16:19], a[92:95], v[0:3], v[16:19]
    ds_read_b128 v[80:83], v73 offset:40960
    v_mfma_f32_16x16x32_bf16 v[24:27], a[96:99], v[104:107], 0
    ds_read_b128 v[76:79], v35 offset:40960
    v_mfma_f32_16x16x32_bf16 v[24:27], a[100:103], v[84:87], v[24:27]
    s_waitcnt vmcnt(8)
    buffer_load_dwordx4 v12, s[32:35], s92 offen offset:2048 lds
    ds_read_b64_tr_b16 a[148:149], v15 offset:12288
    v_mfma_f32_16x16x32_bf16 v[24:27], a[104:107], v[68:71], v[24:27]
    s_add_u32 m0, s90, 61440
    v_fma_f32 v41, v16, v16, s41
    v_fmac_f32 v41, v17, v17
    v_mfma_f32_16x16x32_bf16 v[24:27], a[108:111], v[64:67], v[24:27]
    s_mov_b32 s92, 185088
    ds_read_b64_tr_b16 a[150:151], v15 offset:13056
    v_fmac_f32 v41, v18, v18
    v_mfma_f32_16x16x32_bf16 v[24:27], a[112:115], v[60:63], v[24:27]
    ds_read_b64_tr_b16 a[172:173], v15 offset:12296
    v_fmac_f32 v41, v19, v19
    v_mfma_f32_16x16x32_bf16 v[24:27], a[116:119], v[0:3], v[24:27]
    ds_read_b64_tr_b16 a[174:175], v15 offset:13064
    v_mfma_f32_16x16x32_bf16 v[20:23], a[120:123], v[104:107], 0
    s_nop 0
    buffer_load_dwordx4 v56, s[32:35], s92 offen offset:0 lds
    ds_read_b64_tr_b16 a[196:197], v14 offset:12352
    v_mfma_f32_16x16x32_bf16 v[20:23], a[124:127], v[84:87], v[20:23]
    s_nop 0
    ds_read_b64_tr_b16 a[198:199], v14 offset:13120
    v_fmac_f32 v41, v24, v24
    v_mfma_f32_16x16x32_bf16 v[20:23], a[128:131], v[68:71], v[20:23]
    ds_read_b128 v[68:71], v73 offset:41088
    v_fmac_f32 v41, v25, v25
    v_mfma_f32_16x16x32_bf16 v[20:23], a[132:135], v[64:67], v[20:23]
    ds_read_b128 v[64:67], v35 offset:41088
    v_fmac_f32 v41, v26, v26
    v_mfma_f32_16x16x32_bf16 v[20:23], a[136:139], v[60:63], v[20:23]
    ds_read_b128 v[60:63], v73 offset:41216
    v_fmac_f32 v41, v27, v27
    v_mfma_f32_16x16x32_bf16 v[20:23], a[140:143], v[0:3], v[20:23]
    s_nop 0
    buffer_load_dwordx4 v13, s[32:35], s92 offen offset:1024 lds
    ds_read_b128 v[0:3], v35 offset:41216
    v_mfma_f32_16x16x16_bf16 v[84:87], v[216:217], v[170:171], 0
    s_nop 3
    v_fmac_f32 v41, v20, v20
    v_fmac_f32 v41, v21, v21
    v_fmac_f32 v41, v22, v22
    v_fmac_f32 v41, v23, v23
    v_rsq_f32 v84, v84
    v_rsq_f32 v85, v85
    v_mul_f32 v84, s55, v84
    v_mul_f32 v85, 0.5, v85
    v_mul_f32 v92, v92, v84
    buffer_load_dwordx4 v12, s[32:35], s92 offen offset:2048 lds
    s_add_u32 m0, s90, 0
    s_mov_b32 s92, 0
    s_waitcnt vmcnt(9)
    ds_read_b64_tr_b16 a[152:153], v15 offset:24576
    v_mul_f32 v93, v93, v84
    v_cvt_pk_f16_f32 v92, v92, v93
    v_mul_f32 v94, v94, v84
    ds_read_b64_tr_b16 a[154:155], v15 offset:25344
    v_mul_f32 v95, v95, v84
    v_cvt_pk_f16_f32 v93, v94, v95
    v_mul_f32 v100, v100, v84
    ds_read_b64_tr_b16 a[176:177], v15 offset:24584
    v_mul_f32 v101, v101, v84
    v_cvt_pk_f16_f32 v94, v100, v101
    s_waitcnt lgkmcnt(3)
    buffer_load_dwordx4 v72, s[76:79], s92 offen offset:0 lds
    ds_read_b64_tr_b16 a[178:179], v15 offset:25352
    v_mul_f32 v102, v102, v84
    v_mul_f32 v103, v103, v84
    v_cvt_pk_f16_f32 v95, v102, v103
    ds_read_b64_tr_b16 a[200:201], v14 offset:24640
    v_mul_f32 v96, v96, v84
    ds_read_b64_tr_b16 a[202:203], v14 offset:25408
    v_mul_f32 v97, v97, v84
    v_cvt_pk_f16_f32 v56, v96, v97
    v_mul_f32 v98, v98, v84
    v_mul_f32 v99, v99, v84
    v_cvt_pk_f16_f32 v57, v98, v99
    v_mul_f32 v52, v52, v85
    buffer_load_dwordx4 v9, s[76:79], s92 offen offset:1024 lds
    ds_write_b128 v34, v[92:95] offset:21504
    v_mul_f32 v53, v53, v85
    v_cvt_pk_f16_f32 v52, v52, v53
    v_mul_f32 v54, v54, v85
    v_mul_f32 v55, v55, v85
    v_cvt_pk_f16_f32 v53, v54, v55
    v_mul_f32 v88, v88, v85
    v_mul_f32 v89, v89, v85
    v_cvt_pk_f16_f32 v54, v88, v89
    v_mul_f32 v90, v90, v85
    v_mul_f32 v91, v91, v85
    v_cvt_pk_f16_f32 v55, v90, v91
    v_mul_f32 v4, v4, v85
    buffer_load_dwordx4 v8, s[76:79], s92 offen offset:2048 lds
    s_add_u32 m0, s90, 12288
    s_mov_b32 s92, 12288
    s_waitcnt vmcnt(9)
    ds_read_b64_tr_b16 a[156:157], v15 offset:36864
    v_mul_f32 v5, v5, v85
    v_cvt_pk_f16_f32 v12, v4, v5
    v_mul_f32 v6, v6, v85
    ds_read_b64_tr_b16 a[158:159], v15 offset:37632
    v_mul_f32 v7, v7, v85
    v_cvt_pk_f16_f32 v13, v6, v7
    v_cvt_pk_bf16_f32 v170, v40, v41
    ds_read_b64_tr_b16 a[180:181], v15 offset:36872
    s_nop 0
    v_mfma_f32_16x16x16_bf16 v[4:7], v[216:217], v[170:171], 0
    buffer_load_dwordx4 v72, s[76:79], s92 offen offset:0 lds
    ds_read_b64_tr_b16 a[182:183], v15 offset:37640
    s_nop 2
    ds_read_b64_tr_b16 a[204:205], v14 offset:36928
    s_nop 0
    ds_read_b64_tr_b16 a[206:207], v14 offset:37696
    v_rsq_f32 v4, v4
    ds_write_b128 v34, v[56:59] offset:21520
    v_rsq_f32 v5, v5
    buffer_load_dwordx4 v9, s[76:79], s92 offen offset:1024 lds
    v_mul_f32 v4, s55, v4
    v_mul_f32 v5, 0.5, v5
    v_mul_f32 v48, v48, v4
    ds_write_b128 v34, v[52:55] offset:21536
    v_mul_f32 v49, v49, v4
    v_cvt_pk_f16_f32 v88, v48, v49
    v_mul_f32 v50, v50, v4
    v_mul_f32 v51, v51, v4
    v_cvt_pk_f16_f32 v89, v50, v51
    v_mul_f32 v44, v44, v4
    v_mul_f32 v45, v45, v4
    buffer_load_dwordx4 v8, s[76:79], s92 offen offset:2048 lds
    s_add_u32 m0, s90, 24576
    s_mov_b32 s92, 24576
    s_waitcnt vmcnt(9)
    ds_read_b64_tr_b16 a[160:161], v15 offset:49152
    v_cvt_pk_f16_f32 v90, v44, v45
    v_mul_f32 v46, v46, v4
    v_mul_f32 v47, v47, v4
    ds_read_b64_tr_b16 a[162:163], v15 offset:49920
    v_cvt_pk_f16_f32 v91, v46, v47
    v_mul_f32 v28, v28, v4
    v_mul_f32 v29, v29, v4
    ds_read_b64_tr_b16 a[184:185], v15 offset:49160
    v_cvt_pk_f16_f32 v40, v28, v29
    v_mul_f32 v30, v30, v4
    s_waitcnt lgkmcnt(3)
    buffer_load_dwordx4 v72, s[76:79], s92 offen offset:0 lds
    ds_read_b64_tr_b16 a[186:187], v15 offset:49928
    v_mul_f32 v31, v31, v4
    v_cvt_pk_f16_f32 v41, v30, v31
    v_mul_f32 v16, v16, v5
    ds_read_b64_tr_b16 a[208:209], v14 offset:49216
    v_mul_f32 v17, v17, v5
    ds_read_b64_tr_b16 a[210:211], v14 offset:49984
    v_cvt_pk_f16_f32 v16, v16, v17
    ds_write_b64 v34, v[12:13] offset:21552
    buffer_load_dwordx4 v9, s[76:79], s92 offen offset:1024 lds
    v_mul_f32 v18, v18, v5
    v_mul_f32 v19, v19, v5
    v_cvt_pk_f16_f32 v17, v18, v19
    v_mul_f32 v24, v24, v5
    v_mul_f32 v25, v25, v5
    v_cvt_pk_f16_f32 v18, v24, v25
    v_mul_f32 v26, v26, v5
    v_mul_f32 v27, v27, v5
    v_cvt_pk_f16_f32 v19, v26, v27
    v_mul_f32 v20, v20, v5
    v_mul_f32 v21, v21, v5
    v_cvt_pk_f16_f32 v12, v20, v21
    v_mul_f32 v22, v22, v5
    v_mul_f32 v23, v23, v5
    v_cvt_pk_f16_f32 v13, v22, v23
    buffer_load_dwordx4 v8, s[76:79], s92 offen offset:2048 lds
    s_add_u32 m0, s90, 36864
    s_mov_b32 s92, 36864
    s_waitcnt vmcnt(9)
    ds_read_b64_tr_b16 a[164:165], v15 offset:61440
    ds_read_b64_tr_b16 a[166:167], v15 offset:62208
    v_mfma_f32_16x16x32_bf16 v[56:59], a[144:147], v[80:83], 0
    ds_read_b64_tr_b16 a[188:189], v15 offset:61448
    v_mfma_f32_16x16x32_bf16 v[56:59], a[148:151], v[76:79], v[56:59]
    ds_read_b64_tr_b16 a[190:191], v15 offset:62216
    v_mfma_f32_16x16x32_bf16 v[56:59], a[152:155], v[68:71], v[56:59]
    ds_read_b64_tr_b16 a[212:213], v14 offset:61504
    v_mfma_f32_16x16x32_bf16 v[56:59], a[156:159], v[64:67], v[56:59]
    s_waitcnt lgkmcnt(5)
    buffer_load_dwordx4 v72, s[76:79], s92 offen offset:0 lds
    ds_read_b64_tr_b16 a[214:215], v14 offset:62272
    v_mfma_f32_16x16x32_bf16 v[56:59], a[160:163], v[60:63], v[56:59]
    ds_read_b128 v[52:55], v73 offset:42496
    ds_read_b128 v[48:51], v35 offset:42496
    ds_read_b128 v[44:47], v73 offset:42624
    ds_read_b128 v[28:31], v35 offset:42624
    buffer_load_dwordx4 v9, s[76:79], s92 offen offset:1024 lds
    s_waitcnt lgkmcnt(8)
    v_mfma_f32_16x16x32_bf16 v[56:59], a[164:167], v[0:3], v[56:59]
    ds_read_b128 v[24:27], v73 offset:42752
    s_nop 0
    v_mfma_f32_16x16x32_bf16 v[4:7], a[168:171], v[80:83], 0
    s_nop 0
    ds_read_b128 v[20:23], v35 offset:42752
    s_nop 0
    v_mfma_f32_16x16x32_bf16 v[4:7], a[172:175], v[76:79], v[4:7]
    s_nop 0
    v_cvt_pk_bf16_f32 v14, v56, v57
    v_cvt_pk_bf16_f32 v15, v58, v59
    v_mfma_f32_16x16x32_bf16 v[4:7], a[176:179], v[68:71], v[4:7]
    ds_write_b64 v34, v[14:15] offset:21560
    v_mfma_f32_16x16x32_bf16 v[4:7], a[180:183], v[64:67], v[4:7]
    s_lshl_b32 s93, s68, 10
    buffer_load_dwordx4 v8, s[76:79], s92 offen offset:2048 lds
    v_add_u32 v35, s93, v131
    v_mfma_f32_16x16x32_bf16 v[4:7], a[184:187], v[60:63], v[4:7]
    s_waitcnt lgkmcnt(5)
    s_add_u32 m0, s90, 49152
    v_mfma_f32_16x16x32_bf16 v[4:7], a[188:191], v[0:3], v[4:7]
    s_mov_b32 s92, 49152
    s_nop 0
    v_mfma_f32_16x16x32_bf16 v[56:59], a[192:195], v[80:83], 0
    s_mov_b32 s53, s47
    s_nop 1
    v_mfma_f32_16x16x32_bf16 v[56:59], a[196:199], v[76:79], v[56:59]
    s_mov_b32 s47, s46
    v_cvt_pk_bf16_f32 v4, v4, v5
    v_cvt_pk_bf16_f32 v5, v6, v7
    v_mfma_f32_16x16x32_bf16 v[56:59], a[200:203], v[68:71], v[56:59]
    s_mov_b32 s46, s45
    buffer_load_dwordx4 v72, s[76:79], s92 offen offset:0 lds
    v_mfma_f32_16x16x32_bf16 v[56:59], a[204:207], v[64:67], v[56:59]
    s_mov_b32 s45, s44
    v_mfma_f32_16x16x32_bf16 v[56:59], a[208:211], v[60:63], v[56:59]
    s_mov_b32 s44, s53
    v_mfma_f32_16x16x32_bf16 v[56:59], a[212:215], v[0:3], v[56:59]
    s_sub_u32 s48, s44, s46
    v_add_u32 v139, s48, v139
    v_add_u32 v138, s48, v138
    v_mfma_f32_16x16x32_bf16 v[0:3], a[144:147], v[52:55], 0
    s_sub_u32 s49, s46, s45
    v_mfma_f32_16x16x32_bf16 v[0:3], a[148:151], v[48:51], v[0:3]
    s_waitcnt lgkmcnt(0)
    buffer_load_dwordx4 v9, s[76:79], s92 offen offset:1024 lds
    v_cvt_pk_bf16_f32 v6, v56, v57
    v_mfma_f32_16x16x32_bf16 v[0:3], a[152:155], v[44:47], v[0:3]
    v_cvt_pk_bf16_f32 v7, v58, v59
    v_mfma_f32_16x16x32_bf16 v[0:3], a[156:159], v[28:31], v[0:3]
    ds_write_b128 v34, v[4:7] offset:21568
    v_mfma_f32_16x16x32_bf16 v[0:3], a[160:163], v[24:27], v[0:3]
    v_mfma_f32_16x16x32_bf16 v[0:3], a[164:167], v[20:23], v[0:3]
    buffer_load_dwordx4 v8, s[76:79], s92 offen offset:2048 lds
    s_nop 0
    v_mfma_f32_16x16x32_bf16 v[4:7], a[168:171], v[52:55], 0
    s_add_u32 m0, s90, 61440
    s_nop 1
    v_mfma_f32_16x16x32_bf16 v[4:7], a[172:175], v[48:51], v[4:7]
    s_mov_b32 s92, 61440
    v_cvt_pk_bf16_f32 v14, v0, v1
    v_cvt_pk_bf16_f32 v15, v2, v3
    v_mfma_f32_16x16x32_bf16 v[4:7], a[176:179], v[44:47], v[4:7]
    v_mfma_f32_16x16x32_bf16 v[4:7], a[180:183], v[28:31], v[4:7]
    v_mfma_f32_16x16x32_bf16 v[4:7], a[184:187], v[24:27], v[4:7]
    buffer_load_dwordx4 v72, s[76:79], s92 offen offset:0 lds
    v_mfma_f32_16x16x32_bf16 v[4:7], a[188:191], v[20:23], v[4:7]
    s_nop 1
    v_mfma_f32_16x16x32_bf16 v[0:3], a[192:195], v[52:55], 0
    s_nop 2
    v_mfma_f32_16x16x32_bf16 v[0:3], a[196:199], v[48:51], v[0:3]
    s_nop 0
    v_cvt_pk_bf16_f32 v4, v4, v5
    v_cvt_pk_bf16_f32 v5, v6, v7
    v_mfma_f32_16x16x32_bf16 v[0:3], a[200:203], v[44:47], v[0:3]
    v_mfma_f32_16x16x32_bf16 v[0:3], a[204:207], v[28:31], v[0:3]
    buffer_load_dwordx4 v9, s[76:79], s92 offen offset:1024 lds
    v_mfma_f32_16x16x32_bf16 v[0:3], a[208:211], v[24:27], v[0:3]
    v_mfma_f32_16x16x32_bf16 v[0:3], a[212:215], v[20:23], v[0:3]
    s_nop 7
    v_cvt_pk_bf16_f32 v6, v0, v1
    v_cvt_pk_bf16_f32 v7, v2, v3
    buffer_load_dwordx4 v8, s[76:79], s92 offen offset:2048 lds
    s_add_u32 m0, s54, 20480
    s_nop 0
    buffer_load_dwordx4 v130, s[24:27], s56 offen nt lds
    s_add_u32 m0, s54, 21504
    s_nop 0
    buffer_load_dwordx4 v129, s[24:27], s56 offen nt lds
    s_add_u32 m0, s54, 22528
    s_nop 0
    buffer_load_dwordx4 v128, s[24:27], s56 offen nt lds
    s_add_u32 m0, s54, 23552
    s_nop 0
    buffer_load_dwordx4 v127, s[24:27], s56 offen nt lds
    s_add_u32 m0, s54, 24576
    s_nop 0
    buffer_load_dwordx4 v126, s[24:27], s56 offen nt lds
    s_waitcnt vmcnt(5)
    s_barrier
    ds_read_b128 v[28:31], v11 offset:0
    ds_read_b64 v[48:49], v10 offset:64
    ds_read_b128 v[0:3], v11 offset:3072
    ds_read_b64 v[50:51], v10 offset:3136
    ds_read_b128 v[52:55], v11 offset:6144
    ds_read_b64 v[20:21], v10 offset:6208
    ds_read_b128 v[24:27], v11 offset:9216
    ds_read_b64 v[22:23], v10 offset:9280
    ds_read_b128 v[44:47], v11 offset:12288
    ds_read_b64 v[56:57], v10 offset:12352
    ds_read_b128 v[68:71], v11 offset:15360
    ds_read_b64 v[58:59], v10 offset:15424
    s_waitcnt lgkmcnt(11)
    v_mfma_f32_16x16x32_bf16 v[60:63], v[28:31], v[220:223], 0
    s_waitcnt lgkmcnt(9)
    ds_read_b128 v[28:31], v11 offset:18432
    v_mfma_f32_16x16x32_bf16 v[60:63], v[0:3], v[220:223], v[60:63]
    s_waitcnt lgkmcnt(8)
    ds_read_b64 v[0:1], v10 offset:18496
    ds_read_b128 v[64:67], v11 offset:21504
    v_mfma_f32_16x16x32_bf16 v[60:63], v[52:55], v[220:223], v[60:63]
    s_waitcnt lgkmcnt(8)
    ds_read_b64 v[2:3], v10 offset:21568
    ds_read_b128 v[52:55], v11 offset:24576
    v_mfma_f32_16x16x32_bf16 v[60:63], v[24:27], v[220:223], v[60:63]
    ds_read_b64 v[24:25], v10 offset:24640
    v_mfma_f32_16x16x32_bf16 v[60:63], v[48:51], v[220:223], v[60:63]
    s_waitcnt lgkmcnt(9)
    ds_read_b128 v[48:51], v11 offset:27648
    v_mfma_f32_16x16x32_bf16 v[60:63], v[20:23], v[220:223], v[60:63]
    ds_read_b64 v[26:27], v10 offset:27712
    v_mfma_f32_16x16x32_bf16 v[20:23], v[44:47], v[220:223], 0
    s_waitcnt lgkmcnt(8)
    ds_read_b128 v[44:47], v11 offset:30720
    v_mfma_f32_16x16x32_bf16 v[20:23], v[68:71], v[220:223], v[20:23]
    s_waitcnt lgkmcnt(8)
    s_nop 0
    ds_read_b64 v[8:9], v10 offset:30784
    v_mul_f32 v60, 0xbbaaaaab, v60
    v_mfma_f32_16x16x32_bf16 v[20:23], v[28:31], v[220:223], v[20:23]
    s_waitcnt lgkmcnt(7)
    ds_read_b128 v[28:31], v11 offset:33792
    v_mul_f32 v61, 0xbbaaaaab, v61
    v_mul_f32 v62, 0xbbaaaaab, v62
    v_mul_f32 v63, 0xbbaaaaab, v63
    v_mfma_f32_16x16x32_bf16 v[20:23], v[64:67], v[220:223], v[20:23]
    ds_write_b128 v33, v[60:63] offset:0
    v_mfma_f32_16x16x32_bf16 v[20:23], v[56:59], v[220:223], v[20:23]
    s_waitcnt lgkmcnt(6)
    v_mfma_f32_16x16x32_bf16 v[20:23], v[0:3], v[220:223], v[20:23]
    v_mfma_f32_16x16x32_bf16 v[0:3], v[52:55], v[220:223], 0
    s_waitcnt lgkmcnt(4)
    ds_read_b64 v[10:11], v10 offset:33856
    s_nop 0
    v_mfma_f32_16x16x32_bf16 v[0:3], v[48:51], v[220:223], v[0:3]
    s_waitcnt lgkmcnt(4)
    s_nop 0
    ds_read_b128 v[52:55], v32 offset:0
    v_mul_f32 v20, 0xbbaaaaab, v20
    v_mfma_f32_16x16x32_bf16 v[0:3], v[44:47], v[220:223], v[0:3]
    s_waitcnt lgkmcnt(3)
    ds_read_b64 v[56:57], v75 offset:64
    v_mul_f32 v21, 0xbbaaaaab, v21
    v_mul_f32 v22, 0xbbaaaaab, v22
    v_mul_f32 v23, 0xbbaaaaab, v23
    v_mfma_f32_16x16x32_bf16 v[0:3], v[28:31], v[220:223], v[0:3]
    ds_write_b128 v33, v[20:23] offset:128
    v_mfma_f32_16x16x32_bf16 v[0:3], v[24:27], v[220:223], v[0:3]
    ds_read_b128 v[82:85], v32 offset:768
    ds_read_b64 v[86:87], v75 offset:832
    ds_read_b128 v[76:79], v32 offset:12288
    s_waitcnt lgkmcnt(6)
    v_mfma_f32_16x16x32_bf16 v[0:3], v[8:11], v[220:223], v[0:3]
    s_nop 0
    ds_read_b64 v[80:81], v75 offset:12352
    s_nop 0
    ds_read_b128 v[68:71], v32 offset:13056
    s_nop 2
    ds_read_b64 v[72:73], v75 offset:13120
    v_mul_f32 v0, 0xbbaaaaab, v0
    v_mul_f32 v1, 0xbbaaaaab, v1
    v_mul_f32 v2, 0xbbaaaaab, v2
    v_mul_f32 v3, 0xbbaaaaab, v3
    ds_write_b128 v33, v[0:3] offset:256
    s_waitcnt lgkmcnt(0)
    s_barrier
    ds_read_b128 v[0:3], v74 offset:0
    ds_read_b128 v[48:51], v74 offset:64
    ds_read_b128 v[28:31], v74 offset:128
    ds_read_b128 v[24:27], v74 offset:192
    s_waitcnt lgkmcnt(3)
    v_mfma_f32_16x16x16_bf16 v[44:47], v[52:53], v[146:147], v[0:3]
    v_mfma_f32_16x16x16_bf16 v[20:23], v[54:55], v[146:147], v[0:3]
    s_nop 2
    v_mfma_f32_16x16x16_bf16 v[64:67], v[56:57], v[146:147], v[0:3]
    s_waitcnt lgkmcnt(0)
    s_nop 0
    ds_read_b128 v[56:59], v32 offset:24576
    v_cvt_pk_bf16_f32 v44, v44, v45
    v_mfma_f32_16x16x16_bf16 v[8:11], v[82:83], v[146:147], v[48:51]
    ds_read_b64 v[60:61], v75 offset:24640
    v_accvgpr_write_b32 a216, v44
    v_mfma_f32_16x16x16_bf16 v[116:119], v[84:85], v[146:147], v[48:51]
    ds_read_b128 v[52:55], v74 offset:256
    v_cvt_pk_bf16_f32 v46, v46, v47
    v_mfma_f32_16x16x16_bf16 v[0:3], v[86:87], v[146:147], v[48:51]
    ds_read_b128 v[108:111], v32 offset:25344
    v_accvgpr_write_b32 a217, v46
    v_mfma_f32_16x16x16_bf16 v[100:103], v[76:77], v[146:147], v[28:31]
    ds_read_b64 v[112:113], v75 offset:25408
    v_cvt_pk_bf16_f32 v20, v20, v21
    v_mfma_f32_16x16x16_bf16 v[48:51], v[78:79], v[146:147], v[28:31]
    ds_read_b128 v[104:107], v74 offset:320
    v_accvgpr_write_b32 a240, v20
    v_mfma_f32_16x16x16_bf16 v[44:47], v[80:81], v[146:147], v[28:31]
    ds_read_b128 v[92:95], v32 offset:36864
    v_cvt_pk_bf16_f32 v22, v22, v23
    v_mfma_f32_16x16x16_bf16 v[84:87], v[68:69], v[146:147], v[24:27]
    ds_read_b64 v[96:97], v75 offset:36928
    v_accvgpr_write_b32 a241, v22
    v_mfma_f32_16x16x16_bf16 v[28:31], v[70:71], v[146:147], v[24:27]
    ds_read_b128 v[80:83], v74 offset:5120
    v_cvt_pk_bf16_f32 v232, v64, v65
    v_mfma_f32_16x16x16_bf16 v[20:23], v[72:73], v[146:147], v[24:27]
    s_waitcnt lgkmcnt(6)
    ds_read_b128 v[224:227], v32 offset:37632
    v_cvt_pk_bf16_f32 v233, v66, v67
    v_cvt_pk_bf16_f32 v8, v8, v9
    v_accvgpr_write_b32 a218, v8
    v_cvt_pk_bf16_f32 v10, v10, v11
    v_accvgpr_write_b32 a219, v10
    v_cvt_pk_bf16_f32 v116, v116, v117
    v_mfma_f32_16x16x16_bf16 v[76:79], v[56:57], v[146:147], v[52:55]
    ds_read_b64 v[228:229], v75 offset:37696
    v_accvgpr_write_b32 a242, v116
    v_mfma_f32_16x16x16_bf16 v[24:27], v[58:59], v[146:147], v[52:55]
    ds_read_b128 v[64:67], v74 offset:5184
    v_cvt_pk_bf16_f32 v118, v118, v119
    v_mfma_f32_16x16x16_bf16 v[8:11], v[60:61], v[146:147], v[52:55]
    s_waitcnt lgkmcnt(6)
    ds_read_b128 v[68:71], v32 offset:49152
    v_accvgpr_write_b32 a243, v118
    v_cvt_pk_bf16_f32 v234, v0, v1
    v_cvt_pk_bf16_f32 v235, v2, v3
    v_mfma_f32_16x16x16_bf16 v[56:59], v[108:109], v[146:147], v[104:107]
    ds_read_b64 v[72:73], v75 offset:49216
    v_cvt_pk_bf16_f32 v100, v100, v101
    v_mfma_f32_16x16x16_bf16 v[52:55], v[110:111], v[146:147], v[104:107]
    ds_read_b128 v[60:63], v74 offset:5248
    v_accvgpr_write_b32 a220, v100
    v_mfma_f32_16x16x16_bf16 v[0:3], v[112:113], v[146:147], v[104:107]
    s_waitcnt lgkmcnt(6)
    ds_read_b128 v[116:119], v32 offset:49920
    v_cvt_pk_bf16_f32 v102, v102, v103
    v_accvgpr_write_b32 a221, v102
    v_cvt_pk_bf16_f32 v48, v48, v49
    v_accvgpr_write_b32 a244, v48
    v_cvt_pk_bf16_f32 v50, v50, v51
    v_accvgpr_write_b32 a245, v50
    v_cvt_pk_bf16_f32 v236, v44, v45
    v_cvt_pk_bf16_f32 v237, v46, v47
    v_mfma_f32_16x16x16_bf16 v[108:111], v[92:93], v[146:147], v[80:83]
    ds_read_b64 v[120:121], v75 offset:49984
    v_cvt_pk_bf16_f32 v84, v84, v85
    v_mfma_f32_16x16x16_bf16 v[44:47], v[94:95], v[146:147], v[80:83]
    ds_read_b128 v[112:115], v74 offset:5312
    v_accvgpr_write_b32 a222, v84
    v_mfma_f32_16x16x16_bf16 v[48:51], v[96:97], v[146:147], v[80:83]
    s_waitcnt lgkmcnt(5)
    ds_read_b128 v[100:103], v32 offset:61440
    v_cvt_pk_bf16_f32 v86, v86, v87
    v_accvgpr_write_b32 a223, v86
    v_cvt_pk_bf16_f32 v28, v28, v29
    v_accvgpr_write_b32 a246, v28
    v_cvt_pk_bf16_f32 v30, v30, v31
    v_accvgpr_write_b32 a247, v30
    v_cvt_pk_bf16_f32 v238, v20, v21
    v_cvt_pk_bf16_f32 v239, v22, v23
    v_mfma_f32_16x16x16_bf16 v[96:99], v[224:225], v[146:147], v[64:67]
    ds_read_b64 v[104:105], v75 offset:61504
    v_cvt_pk_bf16_f32 v76, v76, v77
    v_mfma_f32_16x16x16_bf16 v[92:95], v[226:227], v[146:147], v[64:67]
    ds_read_b128 v[20:23], v74 offset:5376
    v_accvgpr_write_b32 a224, v76
    v_mfma_f32_16x16x16_bf16 v[84:87], v[228:229], v[146:147], v[64:67]
    s_waitcnt lgkmcnt(5)
    ds_read_b128 v[28:31], v32 offset:62208
    v_cvt_pk_bf16_f32 v78, v78, v79
    v_accvgpr_write_b32 a225, v78
    v_cvt_pk_bf16_f32 v24, v24, v25
    v_accvgpr_write_b32 a248, v24
    v_cvt_pk_bf16_f32 v26, v26, v27
    v_accvgpr_write_b32 a249, v26
    v_cvt_pk_bf16_f32 v240, v8, v9
    v_cvt_pk_bf16_f32 v241, v10, v11
    v_mfma_f32_16x16x16_bf16 v[80:83], v[68:69], v[146:147], v[60:63]
    ds_read_b64 v[32:33], v75 offset:62272
    v_cvt_pk_bf16_f32 v56, v56, v57
    v_mfma_f32_16x16x16_bf16 v[76:79], v[70:71], v[146:147], v[60:63]
    ds_read_b128 v[24:27], v74 offset:5440
    v_accvgpr_write_b32 a226, v56
    v_mfma_f32_16x16x16_bf16 v[68:71], v[72:73], v[146:147], v[60:63]
    s_waitcnt lgkmcnt(5)
    ds_read_b128 v[8:11], v139 offset:0
    v_cvt_pk_bf16_f32 v58, v58, v59
    v_accvgpr_write_b32 a227, v58
    v_cvt_pk_bf16_f32 v52, v52, v53
    v_accvgpr_write_b32 a250, v52
    v_cvt_pk_bf16_f32 v54, v54, v55
    v_accvgpr_write_b32 a251, v54
    v_cvt_pk_bf16_f32 v242, v0, v1
    v_cvt_pk_bf16_f32 v243, v2, v3
    v_mfma_f32_16x16x16_bf16 v[64:67], v[116:117], v[146:147], v[112:115]
    ds_read_b128 v[60:63], v138 offset:0
    v_cvt_pk_bf16_f32 v108, v108, v109
    v_mfma_f32_16x16x16_bf16 v[56:59], v[118:119], v[146:147], v[112:115]
    ds_read_b128 v[0:3], v139 offset:128
    v_accvgpr_write_b32 a228, v108
    v_mfma_f32_16x16x16_bf16 v[52:55], v[120:121], v[146:147], v[112:115]
    s_waitcnt lgkmcnt(5)
    ds_read_b128 v[72:75], v138 offset:128
    v_cvt_pk_bf16_f32 v110, v110, v111
    v_accvgpr_write_b32 a229, v110
    v_cvt_pk_bf16_f32 v44, v44, v45
    v_accvgpr_write_b32 a252, v44
    v_cvt_pk_bf16_f32 v46, v46, v47
    v_accvgpr_write_b32 a253, v46
    v_cvt_pk_bf16_f32 v244, v48, v49
    v_cvt_pk_bf16_f32 v245, v50, v51
    v_mfma_f32_16x16x16_bf16 v[48:51], v[100:101], v[146:147], v[20:23]
    s_waitcnt vmcnt(0) lgkmcnt(4)
    s_barrier
    ds_write_b128 v35, v[36:39] offset:6144
    v_mfma_f32_16x16x16_bf16 v[44:47], v[102:103], v[146:147], v[20:23]
    v_cvt_pk_bf16_f32 v96, v96, v97
    v_accvgpr_write_b32 a230, v96
    v_mfma_f32_16x16x16_bf16 v[36:39], v[104:105], v[146:147], v[20:23]
    s_waitcnt lgkmcnt(4)
    v_cvt_pk_bf16_f32 v98, v98, v99
    v_accvgpr_write_b32 a231, v98
    v_cvt_pk_bf16_f32 v92, v92, v93
    v_mfma_f32_16x16x32_bf16 v[20:23], a[0:3], v[8:11], 0
    s_waitcnt lgkmcnt(3)
    ds_write_b128 v34, v[216:219] offset:80
    v_mfma_f32_16x16x32_bf16 v[20:23], a[4:7], v[60:63], v[20:23]
    s_waitcnt lgkmcnt(2)
    v_accvgpr_write_b32 a254, v92
    v_cvt_pk_bf16_f32 v94, v94, v95
    v_mfma_f32_16x16x32_bf16 v[20:23], a[8:11], v[0:3], v[20:23]
    v_accvgpr_write_b32 a255, v94
    v_cvt_pk_bf16_f32 v246, v84, v85
    v_mfma_f32_16x16x32_bf16 v[20:23], a[12:15], v[72:75], v[20:23]
    ds_write_b128 v34, v[88:91] offset:0
    v_cvt_pk_bf16_f32 v247, v86, v87
    v_cvt_pk_bf16_f32 v80, v80, v81
    v_accvgpr_write_b32 a232, v80
    v_cvt_pk_bf16_f32 v82, v82, v83
    v_accvgpr_write_b32 a233, v82
    v_cvt_pk_bf16_f32 v224, v76, v77
    v_cvt_pk_bf16_f32 v225, v78, v79
    v_cvt_pk_bf16_f32 v248, v68, v69
    v_cvt_pk_bf16_f32 v249, v70, v71
    v_cvt_pk_bf16_f32 v64, v64, v65
    v_accvgpr_write_b32 a234, v64
    v_cvt_pk_bf16_f32 v66, v66, v67
    v_accvgpr_write_b32 a235, v66
    v_cvt_pk_bf16_f32 v226, v56, v57
    v_cvt_pk_bf16_f32 v227, v58, v59
    v_cvt_pk_bf16_f32 v250, v52, v53
    v_cvt_pk_bf16_f32 v251, v54, v55
    v_cvt_pk_bf16_f32 v48, v48, v49
    v_accvgpr_write_b32 a236, v48
    v_cvt_pk_bf16_f32 v50, v50, v51
    v_accvgpr_write_b32 a237, v50
    v_cvt_pk_bf16_f32 v228, v44, v45
    v_cvt_pk_bf16_f32 v229, v46, v47
    v_cvt_pk_bf16_f32 v252, v36, v37
    v_cvt_pk_bf16_f32 v253, v38, v39
    ds_write_b128 v34, v[40:43] offset:16
    v_add_u32 v137, s49, v137
    v_add_u32 v136, s49, v136
    ds_write_b128 v34, v[16:19] offset:32
    ds_write_b128 v34, v[12:15] offset:48
    ds_write_b128 v34, v[4:7] offset:64
    ds_read_b128 v[76:79], v139 offset:256
    ds_read_b128 v[64:67], v138 offset:256
    s_waitcnt lgkmcnt(1)
    v_mfma_f32_16x16x32_bf16 v[20:23], a[16:19], v[76:79], v[20:23]
    s_waitcnt lgkmcnt(0)
    v_mfma_f32_16x16x32_bf16 v[20:23], a[20:23], v[64:67], v[20:23]
    s_nop 0
    v_mfma_f32_16x16x16_bf16 v[16:19], v[28:29], v[146:147], v[24:27]
    s_nop 3
    v_mfma_f32_16x16x16_bf16 v[12:15], v[30:31], v[146:147], v[24:27]
    s_nop 0
    v_fma_f32 v143, v20, v20, s41
    v_fmac_f32 v143, v21, v21
    v_mfma_f32_16x16x16_bf16 v[4:7], v[32:33], v[146:147], v[24:27]
    v_cvt_pk_bf16_f32 v16, v16, v17
    v_accvgpr_write_b32 a238, v16
    v_cvt_pk_bf16_f32 v18, v18, v19
    v_mfma_f32_16x16x32_bf16 v[52:55], a[24:27], v[8:11], 0
    v_accvgpr_write_b32 a239, v18
    v_cvt_pk_bf16_f32 v230, v12, v13
    v_mfma_f32_16x16x32_bf16 v[52:55], a[28:31], v[60:63], v[52:55]
    v_cvt_pk_bf16_f32 v231, v14, v15
    v_cvt_pk_bf16_f32 v254, v4, v5
    v_mfma_f32_16x16x32_bf16 v[52:55], a[32:35], v[0:3], v[52:55]
    v_cvt_pk_bf16_f32 v255, v6, v7
    v_fmac_f32 v143, v22, v22
    v_mfma_f32_16x16x32_bf16 v[52:55], a[36:39], v[72:75], v[52:55]
    v_fmac_f32 v143, v23, v23
    v_mfma_f32_16x16x32_bf16 v[52:55], a[40:43], v[76:79], v[52:55]
    v_mfma_f32_16x16x32_bf16 v[52:55], a[44:47], v[64:67], v[52:55]
    s_nop 1
    v_mfma_f32_16x16x32_bf16 v[48:51], a[48:51], v[8:11], 0
    s_nop 2
    v_mfma_f32_16x16x32_bf16 v[48:51], a[52:55], v[60:63], v[48:51]
    s_nop 0
    v_fmac_f32 v143, v52, v52
    v_fmac_f32 v143, v53, v53
    v_mfma_f32_16x16x32_bf16 v[48:51], a[56:59], v[0:3], v[48:51]
    v_fmac_f32 v143, v54, v54
    v_fmac_f32 v143, v55, v55
    v_mfma_f32_16x16x32_bf16 v[48:51], a[60:63], v[72:75], v[48:51]
    v_mfma_f32_16x16x32_bf16 v[48:51], a[64:67], v[76:79], v[48:51]
    v_mfma_f32_16x16x32_bf16 v[48:51], a[68:71], v[64:67], v[48:51]
    s_nop 1
    v_mfma_f32_16x16x32_bf16 v[44:47], a[72:75], v[8:11], 0
    s_nop 2
    v_mfma_f32_16x16x32_bf16 v[44:47], a[76:79], v[60:63], v[44:47]
    s_nop 0
    v_fmac_f32 v143, v48, v48
    v_fmac_f32 v143, v49, v49
    v_mfma_f32_16x16x32_bf16 v[44:47], a[80:83], v[0:3], v[44:47]
    v_fmac_f32 v143, v50, v50
    v_fmac_f32 v143, v51, v51
    v_mfma_f32_16x16x32_bf16 v[44:47], a[84:87], v[72:75], v[44:47]
    v_mfma_f32_16x16x32_bf16 v[44:47], a[88:91], v[76:79], v[44:47]
    v_mfma_f32_16x16x32_bf16 v[44:47], a[92:95], v[64:67], v[44:47]
    s_nop 1
    v_mfma_f32_16x16x32_bf16 v[4:7], a[96:99], v[8:11], 0
    s_nop 2
    v_mfma_f32_16x16x32_bf16 v[4:7], a[100:103], v[60:63], v[4:7]
    s_nop 0
    v_fma_f32 v142, v44, v44, s41
    v_fmac_f32 v142, v45, v45
    v_mfma_f32_16x16x32_bf16 v[4:7], a[104:107], v[0:3], v[4:7]
    v_fmac_f32 v142, v46, v46
    v_fmac_f32 v142, v47, v47
    v_mfma_f32_16x16x32_bf16 v[4:7], a[108:111], v[72:75], v[4:7]
    v_mfma_f32_16x16x32_bf16 v[4:7], a[112:115], v[76:79], v[4:7]
    v_mfma_f32_16x16x32_bf16 v[4:7], a[116:119], v[64:67], v[4:7]
    s_nop 1
    v_mfma_f32_16x16x32_bf16 v[36:39], a[120:123], v[8:11], 0
    s_nop 2
    v_mfma_f32_16x16x32_bf16 v[36:39], a[124:127], v[60:63], v[36:39]
    s_nop 0
    v_fmac_f32 v142, v4, v4
    v_fmac_f32 v142, v5, v5
    v_mfma_f32_16x16x32_bf16 v[36:39], a[128:131], v[0:3], v[36:39]
    v_fmac_f32 v142, v6, v6
    v_fmac_f32 v142, v7, v7
    v_mfma_f32_16x16x32_bf16 v[36:39], a[132:135], v[72:75], v[36:39]
    v_mfma_f32_16x16x32_bf16 v[36:39], a[136:139], v[76:79], v[36:39]
    v_mfma_f32_16x16x32_bf16 v[36:39], a[140:143], v[64:67], v[36:39]
    s_nop 1
    v_mfma_f32_16x16x32_bf16 v[12:15], v[8:11], a[144:147], 0
    s_nop 2
    v_mfma_f32_16x16x32_bf16 v[12:15], v[60:63], a[148:151], v[12:15]
    s_nop 0
    v_fmac_f32 v142, v36, v36
    v_fmac_f32 v142, v37, v37
    v_mfma_f32_16x16x32_bf16 v[12:15], v[0:3], a[152:155], v[12:15]
    v_fmac_f32 v142, v38, v38
    v_fmac_f32 v142, v39, v39
    v_mfma_f32_16x16x32_bf16 v[12:15], v[72:75], a[156:159], v[12:15]
    v_cvt_pk_bf16_f32 v170, v143, v142
    v_mfma_f32_16x16x32_bf16 v[12:15], v[76:79], a[160:163], v[12:15]
    ds_read_b128 v[108:111], v139 offset:1536
    v_mfma_f32_16x16x32_bf16 v[12:15], v[64:67], a[164:167], v[12:15]
    s_nop 0
    ds_read_b128 v[104:107], v138 offset:1536
    s_nop 0
    v_mfma_f32_16x16x16_bf16 v[40:43], v[216:217], v[170:171], 0
    s_nop 0
    ds_read_b128 v[88:91], v139 offset:1664
    s_nop 1
    v_cvt_pk_bf16_f32 v24, v12, v13
    v_mfma_f32_16x16x32_bf16 v[16:19], v[8:11], a[168:171], 0
    ds_read_b128 v[100:103], v138 offset:1664
    v_cvt_pk_bf16_f32 v25, v14, v15
    v_mfma_f32_16x16x32_bf16 v[16:19], v[60:63], a[172:175], v[16:19]
    ds_read_b128 v[68:71], v139 offset:1792
    v_mfma_f32_16x16x32_bf16 v[16:19], v[0:3], a[176:179], v[16:19]
    ds_read_b128 v[12:15], v138 offset:1792
    v_mfma_f32_16x16x32_bf16 v[16:19], v[72:75], a[180:183], v[16:19]
    v_rsq_f32 v40, v40
    v_mfma_f32_16x16x32_bf16 v[16:19], v[76:79], a[184:187], v[16:19]
    v_rsq_f32 v41, v41
    v_mfma_f32_16x16x32_bf16 v[16:19], v[64:67], a[188:191], v[16:19]
    v_mul_f32 v40, s55, v40
    v_mul_f32 v41, 0.5, v41
    v_mfma_f32_16x16x32_bf16 v[32:35], v[8:11], a[192:195], 0
    s_nop 0
    v_mul_f32 v20, v20, v40
    v_mul_f32 v21, v21, v40
    v_mfma_f32_16x16x32_bf16 v[32:35], v[60:63], a[196:199], v[32:35]
    s_nop 0
    v_cvt_pk_bf16_f32 v28, v16, v17
    v_cvt_pk_bf16_f32 v29, v18, v19
    v_mfma_f32_16x16x32_bf16 v[32:35], v[0:3], a[200:203], v[32:35]
    v_cvt_pk_f16_f32 v16, v20, v21
    v_mul_f32 v22, v22, v40
    v_mfma_f32_16x16x32_bf16 v[32:35], v[72:75], a[204:207], v[32:35]
    v_mul_f32 v23, v23, v40
    v_cvt_pk_f16_f32 v17, v22, v23
    v_mfma_f32_16x16x32_bf16 v[32:35], v[76:79], a[208:211], v[32:35]
    v_mul_f32 v52, v52, v40
    v_mul_f32 v53, v53, v40
    v_mfma_f32_16x16x32_bf16 v[32:35], v[64:67], a[212:215], v[32:35]
    s_waitcnt lgkmcnt(0)
    v_cvt_pk_f16_f32 v18, v52, v53
    v_mul_f32 v54, v54, v40
    v_mfma_f32_16x16x32_bf16 v[64:67], a[0:3], v[108:111], 0
    v_mul_f32 v55, v55, v40
    v_cvt_pk_f16_f32 v19, v54, v55
    v_mfma_f32_16x16x32_bf16 v[64:67], a[4:7], v[104:107], v[64:67]
    v_mul_f32 v48, v48, v40
    v_mul_f32 v49, v49, v40
    v_mfma_f32_16x16x32_bf16 v[64:67], a[8:11], v[88:91], v[64:67]
    v_cvt_pk_f16_f32 v154, v48, v49
    v_mul_f32 v50, v50, v40
    v_mfma_f32_16x16x32_bf16 v[64:67], a[12:15], v[100:103], v[64:67]
    v_mul_f32 v51, v51, v40
    v_cvt_pk_f16_f32 v155, v50, v51
    v_mfma_f32_16x16x32_bf16 v[64:67], a[16:19], v[68:71], v[64:67]
    v_mul_f32 v44, v44, v41
    v_mul_f32 v45, v45, v41
    v_mfma_f32_16x16x32_bf16 v[64:67], a[20:23], v[12:15], v[64:67]
    v_cvt_pk_f16_f32 v82, v44, v45
    v_mul_f32 v46, v46, v41
    v_mfma_f32_16x16x32_bf16 v[52:55], a[24:27], v[108:111], 0
    v_mul_f32 v47, v47, v41
    v_cvt_pk_f16_f32 v83, v46, v47
    v_mfma_f32_16x16x32_bf16 v[52:55], a[28:31], v[104:107], v[52:55]
    v_mul_f32 v4, v4, v41
    v_mul_f32 v5, v5, v41
    v_mfma_f32_16x16x32_bf16 v[52:55], a[32:35], v[88:91], v[52:55]
    v_cvt_pk_f16_f32 v84, v4, v5
    v_mul_f32 v6, v6, v41
    v_mfma_f32_16x16x32_bf16 v[52:55], a[36:39], v[100:103], v[52:55]
    v_mul_f32 v7, v7, v41
    v_cvt_pk_f16_f32 v85, v6, v7
    v_mfma_f32_16x16x32_bf16 v[52:55], a[40:43], v[68:71], v[52:55]
    v_mul_f32 v36, v36, v41
    v_mul_f32 v37, v37, v41
    v_mfma_f32_16x16x32_bf16 v[52:55], a[44:47], v[12:15], v[52:55]
    v_cvt_pk_f16_f32 v86, v36, v37
    v_mul_f32 v38, v38, v41
    v_mfma_f32_16x16x32_bf16 v[4:7], a[48:51], v[108:111], 0
    v_mul_f32 v39, v39, v41
    v_cvt_pk_f16_f32 v87, v38, v39
    v_mfma_f32_16x16x32_bf16 v[4:7], a[52:55], v[104:107], v[4:7]
    v_cvt_pk_bf16_f32 v32, v32, v33
    v_cvt_pk_bf16_f32 v33, v34, v35
    v_mfma_f32_16x16x32_bf16 v[4:7], a[56:59], v[88:91], v[4:7]
    v_fma_f32 v26, v64, v64, s41
    v_fmac_f32 v26, v65, v65
    v_mfma_f32_16x16x32_bf16 v[4:7], a[60:63], v[100:103], v[4:7]
    v_fmac_f32 v26, v66, v66
    v_fmac_f32 v26, v67, v67
    v_mfma_f32_16x16x32_bf16 v[4:7], a[64:67], v[68:71], v[4:7]
    v_fmac_f32 v26, v52, v52
    v_fmac_f32 v26, v53, v53
    v_mfma_f32_16x16x32_bf16 v[4:7], a[68:71], v[12:15], v[4:7]
    v_fmac_f32 v26, v54, v54
    v_fmac_f32 v26, v55, v55
    v_mfma_f32_16x16x32_bf16 v[48:51], a[72:75], v[108:111], 0
    s_nop 2
    v_mfma_f32_16x16x32_bf16 v[48:51], a[76:79], v[104:107], v[48:51]
    s_nop 0
    v_fmac_f32 v26, v4, v4
    v_fmac_f32 v26, v5, v5
    v_mfma_f32_16x16x32_bf16 v[48:51], a[80:83], v[88:91], v[48:51]
    v_fmac_f32 v26, v6, v6
    v_fmac_f32 v26, v7, v7
    v_mfma_f32_16x16x32_bf16 v[48:51], a[84:87], v[100:103], v[48:51]
    v_mfma_f32_16x16x32_bf16 v[48:51], a[88:91], v[68:71], v[48:51]
    v_mfma_f32_16x16x32_bf16 v[48:51], a[92:95], v[12:15], v[48:51]
    s_nop 1
    v_mfma_f32_16x16x32_bf16 v[0:3], a[96:99], v[108:111], 0
    s_nop 2
    v_mfma_f32_16x16x32_bf16 v[0:3], a[100:103], v[104:107], v[0:3]
    s_nop 0
    v_fma_f32 v27, v48, v48, s41
    v_fmac_f32 v27, v49, v49
    v_mfma_f32_16x16x32_bf16 v[0:3], a[104:107], v[88:91], v[0:3]
    v_fmac_f32 v27, v50, v50
    v_fmac_f32 v27, v51, v51
    v_mfma_f32_16x16x32_bf16 v[0:3], a[108:111], v[100:103], v[0:3]
    v_mfma_f32_16x16x32_bf16 v[0:3], a[112:115], v[68:71], v[0:3]
    v_mfma_f32_16x16x32_bf16 v[0:3], a[116:119], v[12:15], v[0:3]
    s_sub_u32 s50, s45, s44
    v_add_u32 v137, s48, v137
    v_add_u32 v136, s48, v136
    v_mfma_f32_16x16x32_bf16 v[44:47], a[120:123], v[108:111], 0
    s_sub_u32 s51, s46, s47
    v_add_u32 v135, s51, v135
    v_mfma_f32_16x16x32_bf16 v[44:47], a[124:127], v[104:107], v[44:47]
    s_mov_b32 s60, s59
    v_fmac_f32 v27, v0, v0
    v_fmac_f32 v27, v1, v1
    v_mfma_f32_16x16x32_bf16 v[44:47], a[128:131], v[88:91], v[44:47]
    s_mov_b32 s59, s58
    v_fmac_f32 v27, v2, v2
    v_fmac_f32 v27, v3, v3
    v_mfma_f32_16x16x32_bf16 v[44:47], a[132:135], v[100:103], v[44:47]
    s_mov_b32 s58, s57
    v_mfma_f32_16x16x32_bf16 v[44:47], a[136:139], v[68:71], v[44:47]
    s_mov_b32 s57, s56
    v_mfma_f32_16x16x32_bf16 v[44:47], a[140:143], v[12:15], v[44:47]
    s_mov_b32 s7, s6
    s_nop 0
    v_mfma_f32_16x16x32_bf16 v[8:11], v[108:111], a[144:147], 0
    s_mov_b32 s6, s5
    s_nop 1
    v_mfma_f32_16x16x32_bf16 v[8:11], v[104:107], a[148:151], v[8:11]
    s_mov_b32 s5, s4
    v_fmac_f32 v27, v44, v44
    v_fmac_f32 v27, v45, v45
    v_mfma_f32_16x16x32_bf16 v[8:11], v[88:91], a[152:155], v[8:11]
    s_sub_u32 s14, s6, s7
    v_fmac_f32 v27, v46, v46
    v_fmac_f32 v27, v47, v47
    v_mfma_f32_16x16x32_bf16 v[8:11], v[100:103], a[156:159], v[8:11]
    s_add_u32 s61, s61, 1
    v_cvt_pk_bf16_f32 v170, v26, v27
    v_add_u32 v134, s14, v134
    v_mfma_f32_16x16x32_bf16 v[8:11], v[68:71], a[160:163], v[8:11]
    s_ff1_i32_b32 s15, s66
    ds_read_b128 v[96:99], v139 offset:3072
    v_add_u32 v133, s14, v133
    v_mfma_f32_16x16x32_bf16 v[8:11], v[12:15], a[164:167], v[8:11]
    s_cmp_lg_u32 s66, 0
    ds_read_b128 v[92:95], v138 offset:3072
    v_add_u32 v125, s14, v125
    v_mfma_f32_16x16x16_bf16 v[20:23], v[216:217], v[170:171], 0
    s_cselect_b32 s12, s15, s12
    ds_read_b128 v[40:43], v139 offset:3200
    s_nop 1
    v_cvt_pk_bf16_f32 v26, v8, v9
    v_mfma_f32_16x16x32_bf16 v[72:75], v[108:111], a[168:171], 0
    s_cmp_lt_u32 s61, s71
    ds_read_b128 v[60:63], v138 offset:3200
    v_cvt_pk_bf16_f32 v27, v10, v11
    v_mfma_f32_16x16x32_bf16 v[72:75], v[104:107], a[172:175], v[72:75]
    s_cselect_b32 s15, 31, s15
    ds_read_b128 v[56:59], v139 offset:3328
    v_add_u32 v139, s50, v139
    v_mfma_f32_16x16x32_bf16 v[72:75], v[88:91], a[176:179], v[72:75]
    s_bitset0_b32 s66, s15
    ds_read_b128 v[36:39], v138 offset:3328
    v_add_u32 v138, s50, v138
    v_mfma_f32_16x16x32_bf16 v[72:75], v[100:103], a[180:183], v[72:75]
    s_add_u32 s12, s12, 20
    v_rsq_f32 v20, v20
    v_mfma_f32_16x16x32_bf16 v[72:75], v[68:71], a[184:187], v[72:75]
    s_max_u32 s12, s12, s61
    v_rsq_f32 v21, v21
    v_mfma_f32_16x16x32_bf16 v[72:75], v[12:15], a[188:191], v[72:75]
    s_cmp_lt_u32 s61, s71
    v_mul_f32 v20, s55, v20
    v_mul_f32 v21, 0.5, v21
    v_mfma_f32_16x16x32_bf16 v[8:11], v[108:111], a[192:195], 0
    s_cselect_b32 s15, s61, s12
    v_mul_f32 v64, v64, v20
    v_mul_f32 v65, v65, v20
    v_mfma_f32_16x16x32_bf16 v[8:11], v[104:107], a[196:199], v[8:11]
    s_cselect_b32 s56, s69, s70
    v_cvt_pk_bf16_f32 v30, v72, v73
    v_cvt_pk_bf16_f32 v31, v74, v75
    v_mfma_f32_16x16x32_bf16 v[8:11], v[88:91], a[200:203], v[8:11]
    s_add_u32 s56, s56, s15
    v_cvt_pk_f16_f32 v88, v64, v65
    v_mul_f32 v66, v66, v20
    v_mfma_f32_16x16x32_bf16 v[8:11], v[100:103], a[204:207], v[8:11]
    s_mul_i32 s53, s56, 58255
    v_mul_f32 v67, v67, v20
    v_cvt_pk_f16_f32 v89, v66, v67
    v_mfma_f32_16x16x32_bf16 v[8:11], v[68:71], a[208:211], v[8:11]
    s_waitcnt lgkmcnt(0)
    s_lshr_b32 s53, s53, 22
    v_mul_f32 v52, v52, v20
    v_mul_f32 v53, v53, v20
    v_mfma_f32_16x16x32_bf16 v[8:11], v[12:15], a[212:215], v[8:11]
    s_barrier
    v_cvt_pk_f16_f32 v90, v52, v53
    v_mul_f32 v54, v54, v20
    v_mfma_f32_16x16x32_bf16 v[12:15], a[0:3], v[96:99], 0
    s_mul_i32 s53, s53, s63
    v_mul_f32 v55, v55, v20
    v_cvt_pk_f16_f32 v91, v54, v55
    v_mfma_f32_16x16x32_bf16 v[12:15], a[4:7], v[92:95], v[12:15]
    s_mul_i32 s56, s56, s62
    v_mul_f32 v4, v4, v20
    v_mul_f32 v5, v5, v20
    v_mfma_f32_16x16x32_bf16 v[12:15], a[8:11], v[40:43], v[12:15]
    s_add_u32 s56, s56, s53
    v_cvt_pk_f16_f32 v150, v4, v5
    v_mul_f32 v6, v6, v20
    v_mfma_f32_16x16x32_bf16 v[12:15], a[12:15], v[60:63], v[12:15]
    s_mul_i32 s4, s15, 336
    v_mul_f32 v7, v7, v20
    v_cvt_pk_f16_f32 v151, v6, v7
    v_mfma_f32_16x16x32_bf16 v[12:15], a[16:19], v[56:59], v[12:15]
    s_cmp_ge_u32 s15, 16
    v_mul_f32 v48, v48, v21
    v_mul_f32 v49, v49, v21
    v_mfma_f32_16x16x32_bf16 v[12:15], a[20:23], v[36:39], v[12:15]
    s_cselect_b32 s53, -26880, 0
    v_cvt_pk_f16_f32 v76, v48, v49
    v_mul_f32 v50, v50, v21
    v_mfma_f32_16x16x32_bf16 v[4:7], a[24:27], v[96:99], 0
    s_add_u32 s4, s4, s53
    v_mul_f32 v51, v51, v21
    v_cvt_pk_f16_f32 v77, v50, v51
    v_mfma_f32_16x16x32_bf16 v[4:7], a[28:31], v[92:95], v[4:7]
    s_cmp_lt_u32 s15, s73
    v_mul_f32 v0, v0, v21
    v_mul_f32 v1, v1, v21
    v_mfma_f32_16x16x32_bf16 v[4:7], a[32:35], v[40:43], v[4:7]
    s_cselect_b32 s26, 100270464, 0
    v_cvt_pk_f16_f32 v78, v0, v1
    v_mul_f32 v2, v2, v21
    v_mfma_f32_16x16x32_bf16 v[4:7], a[36:39], v[60:63], v[4:7]
    s_cselect_b32 s56, s56, 0
    v_mul_f32 v3, v3, v21
    v_cvt_pk_f16_f32 v79, v2, v3
    v_mfma_f32_16x16x32_bf16 v[4:7], a[40:43], v[56:59], v[4:7]
    s_cselect_b32 s4, s4, -1
    v_mul_f32 v44, v44, v21
    v_mul_f32 v45, v45, v21
    v_mfma_f32_16x16x32_bf16 v[4:7], a[44:47], v[36:39], v[4:7]
    s_cselect_b32 s15, s15, 0
    v_cvt_pk_f16_f32 v80, v44, v45
    v_mul_f32 v46, v46, v21
    v_mfma_f32_16x16x32_bf16 v[0:3], a[48:51], v[96:99], 0
    s_cselect_b32 s13, s13, -1
    v_mul_f32 v47, v47, v21
    v_cvt_pk_f16_f32 v81, v46, v47
    v_mfma_f32_16x16x32_bf16 v[0:3], a[52:55], v[92:95], v[0:3]
    s_bitset1_b32 s64, s15
    v_cvt_pk_bf16_f32 v34, v8, v9
    v_cvt_pk_bf16_f32 v35, v10, v11
    v_mfma_f32_16x16x32_bf16 v[0:3], a[56:59], v[40:43], v[0:3]
    s_add_u32 s65, s65, 1
    v_fma_f32 v143, v12, v12, s41
    v_fmac_f32 v143, v13, v13
    v_mfma_f32_16x16x32_bf16 v[0:3], a[60:63], v[60:63], v[0:3]
    s_cmp_ge_i32 s65, 2
    v_fmac_f32 v143, v14, v14
    v_fmac_f32 v143, v15, v15
    v_mfma_f32_16x16x32_bf16 v[0:3], a[64:67], v[56:59], v[0:3]
    s_cselect_b32 s30, 100270464, 0
    v_fmac_f32 v143, v4, v4
    v_fmac_f32 v143, v5, v5
    v_mfma_f32_16x16x32_bf16 v[0:3], a[68:71], v[36:39], v[0:3]
    s_add_u32 s67, s46, s54
    v_fmac_f32 v143, v6, v6
    v_fmac_f32 v143, v7, v7
    v_mfma_f32_16x16x32_bf16 v[52:55], a[72:75], v[96:99], 0
    s_add_u32 m0, s67, 0
    s_nop 0
    buffer_load_dwordx4 v130, s[24:27], s56 offen nt lds
    v_mfma_f32_16x16x32_bf16 v[52:55], a[76:79], v[92:95], v[52:55]
    s_add_u32 m0, s67, 1024
    v_fmac_f32 v143, v0, v0
    v_fmac_f32 v143, v1, v1
    v_mfma_f32_16x16x32_bf16 v[52:55], a[80:83], v[40:43], v[52:55]
    v_fmac_f32 v143, v2, v2
    v_fmac_f32 v143, v3, v3
    v_mfma_f32_16x16x32_bf16 v[52:55], a[84:87], v[60:63], v[52:55]
    buffer_load_dwordx4 v129, s[24:27], s56 offen nt lds
    v_mfma_f32_16x16x32_bf16 v[52:55], a[88:91], v[56:59], v[52:55]
    s_add_u32 m0, s67, 2048
    v_mfma_f32_16x16x32_bf16 v[52:55], a[92:95], v[36:39], v[52:55]
    buffer_load_dwordx4 v128, s[24:27], s56 offen nt lds
    s_nop 0
    v_mfma_f32_16x16x32_bf16 v[8:11], a[96:99], v[96:99], 0
    s_nop 2
    v_mfma_f32_16x16x32_bf16 v[8:11], a[100:103], v[92:95], v[8:11]
    s_nop 0
    v_fma_f32 v142, v52, v52, s41
    v_fmac_f32 v142, v53, v53
    v_mfma_f32_16x16x32_bf16 v[8:11], a[104:107], v[40:43], v[8:11]
    v_fmac_f32 v142, v54, v54
    v_fmac_f32 v142, v55, v55
    v_mfma_f32_16x16x32_bf16 v[8:11], a[108:111], v[60:63], v[8:11]
    v_mfma_f32_16x16x32_bf16 v[8:11], a[112:115], v[56:59], v[8:11]
    s_add_u32 m0, s67, 3072
    s_nop 0
    buffer_load_dwordx4 v127, s[24:27], s56 offen nt lds
    v_mfma_f32_16x16x32_bf16 v[8:11], a[116:119], v[36:39], v[8:11]
    s_add_u32 m0, s67, 4096
    s_nop 0
    v_mfma_f32_16x16x32_bf16 v[44:47], a[120:123], v[96:99], 0
    s_nop 1
    buffer_load_dwordx4 v126, s[24:27], s56 offen nt lds
    v_mfma_f32_16x16x32_bf16 v[44:47], a[124:127], v[92:95], v[44:47]
    s_nop 0
    v_fmac_f32 v142, v8, v8
    v_fmac_f32 v142, v9, v9
    v_mfma_f32_16x16x32_bf16 v[44:47], a[128:131], v[40:43], v[44:47]
    v_fmac_f32 v142, v10, v10
    v_fmac_f32 v142, v11, v11
    v_mfma_f32_16x16x32_bf16 v[44:47], a[132:135], v[60:63], v[44:47]
    v_mfma_f32_16x16x32_bf16 v[44:47], a[136:139], v[56:59], v[44:47]
    v_mfma_f32_16x16x32_bf16 v[44:47], a[140:143], v[36:39], v[44:47]
    s_nop 1
    v_mfma_f32_16x16x32_bf16 v[20:23], v[96:99], a[144:147], 0
    s_mov_b32 s53, s47
    s_nop 1
    v_mfma_f32_16x16x32_bf16 v[20:23], v[92:95], a[148:151], v[20:23]
    s_mov_b32 s47, s46
    v_fmac_f32 v142, v44, v44
    v_fmac_f32 v142, v45, v45
    v_mfma_f32_16x16x32_bf16 v[20:23], v[40:43], a[152:155], v[20:23]
    s_mov_b32 s46, s45
    v_fmac_f32 v142, v46, v46
    v_fmac_f32 v142, v47, v47
    v_mfma_f32_16x16x32_bf16 v[20:23], v[60:63], a[156:159], v[20:23]
    s_mov_b32 s45, s44
    v_cvt_pk_bf16_f32 v170, v143, v142
    v_mfma_f32_16x16x32_bf16 v[20:23], v[56:59], a[160:163], v[20:23]
    s_mov_b32 s44, s53
    ds_read_b128 v[64:67], v134 offset:32
    v_mfma_f32_16x16x32_bf16 v[20:23], v[36:39], a[164:167], v[20:23]
    s_sub_u32 s48, s44, s46
    ds_read_b64 v[68:69], v134 offset:48
    v_add_u32 v139, s48, v139
    v_mfma_f32_16x16x16_bf16 v[48:51], v[216:217], v[170:171], 0
    s_sub_u32 s49, s46, s45
    v_add_u32 v138, s48, v138
    s_nop 1
    v_cvt_pk_bf16_f32 v164, v20, v21
    v_mfma_f32_16x16x32_bf16 v[72:75], v[96:99], a[168:171], 0
    v_cvt_pk_bf16_f32 v165, v22, v23
    v_mfma_f32_16x16x32_bf16 v[72:75], v[92:95], a[172:175], v[72:75]
    v_rsq_f32 v48, v48
    v_mfma_f32_16x16x32_bf16 v[72:75], v[40:43], a[176:179], v[72:75]
    v_rsq_f32 v49, v49
    v_mfma_f32_16x16x32_bf16 v[72:75], v[60:63], a[180:183], v[72:75]
    v_mul_f32 v48, s55, v48
    v_mul_f32 v49, 0.5, v49
    v_mfma_f32_16x16x32_bf16 v[72:75], v[56:59], a[184:187], v[72:75]
    v_mul_f32 v52, v52, v49
    v_mul_f32 v53, v53, v49
    v_mfma_f32_16x16x32_bf16 v[72:75], v[36:39], a[188:191], v[72:75]
    ds_read_u16 v166, v133 offset:56
    v_cvt_pk_f16_f32 v70, v52, v53
    v_mfma_f32_16x16x32_bf16 v[20:23], v[96:99], a[192:195], 0
    ds_read_u16 v162, v133 offset:64
    v_mul_f32 v54, v54, v49
    v_mfma_f32_16x16x32_bf16 v[20:23], v[92:95], a[196:199], v[20:23]
    s_nop 0
    ds_read_u16 v158, v133 offset:72
    v_cvt_pk_bf16_f32 v160, v72, v73
    v_mfma_f32_16x16x32_bf16 v[20:23], v[40:43], a[200:203], v[20:23]
    ds_read_b128 v[40:43], v134 offset:0
    v_cvt_pk_bf16_f32 v161, v74, v75
    v_mfma_f32_16x16x32_bf16 v[20:23], v[60:63], a[204:207], v[20:23]
    ds_read_b64 v[142:143], v134 offset:16
    v_mul_f32 v55, v55, v49
    v_mfma_f32_16x16x32_bf16 v[20:23], v[56:59], a[208:211], v[20:23]
    v_cvt_pk_f16_f32 v71, v54, v55
    v_mul_f32 v8, v8, v49
    v_mfma_f32_16x16x32_bf16 v[20:23], v[36:39], a[212:215], v[20:23]
    v_mul_f32 v9, v9, v49
    v_cvt_pk_f16_f32 v72, v8, v9
    v_mfma_f32_16x16x32_f16 v[36:39], v[82:85], v[16:19], v[204:207]
    v_mul_f32 v10, v10, v49
    v_mul_f32 v11, v11, v49
    v_mfma_f32_16x16x32_f16 v[36:39], v[84:87], v[152:155], v[36:39]
    v_cvt_pk_f16_f32 v73, v10, v11
    v_mul_f32 v44, v44, v49
    v_mfma_f32_16x16x32_f16 v[60:63], v[76:79], v[16:19], v[200:203]
    v_mul_f32 v45, v45, v49
    v_cvt_pk_f16_f32 v74, v44, v45
    v_mfma_f32_16x16x32_f16 v[60:63], v[78:81], v[152:155], v[60:63]
    s_waitcnt lgkmcnt(3)
    v_mul_f32 v46, v46, v49
    v_mul_f32 v47, v47, v49
    v_mfma_f32_16x16x32_f16 v[8:11], v[64:67], v[16:19], v[208:211]
    v_cvt_pk_f16_f32 v75, v46, v47
    v_mul_f32 v12, v12, v48
    v_mfma_f32_16x16x32_f16 v[8:11], v[66:69], v[152:155], v[8:11]
    v_mul_f32 v13, v13, v48
    v_cvt_pk_f16_f32 v44, v12, v13
    v_mfma_f32_16x16x32_f16 v[56:59], v[70:73], v[16:19], v[196:199]
    v_mul_f32 v14, v14, v48
    v_mul_f32 v15, v15, v48
    v_mfma_f32_16x16x32_f16 v[56:59], v[72:75], v[152:155], v[56:59]
    s_waitcnt lgkmcnt(0)
    v_cvt_pk_f16_f32 v45, v14, v15
    v_mul_f32 v4, v4, v48
    v_mfma_f32_16x16x32_f16 v[16:19], v[40:43], v[82:85], v[208:211]
    v_mul_f32 v5, v5, v48
    v_cvt_pk_f16_f32 v46, v4, v5
    v_mfma_f32_16x16x32_f16 v[16:19], v[140:143], v[84:87], v[16:19]
    v_mul_f32 v6, v6, v48
    v_mul_f32 v7, v7, v48
    v_mfma_f32_16x16x32_f16 v[12:15], v[40:43], v[76:79], v[208:211]
    v_cvt_pk_f16_f32 v47, v6, v7
    v_mul_f32 v0, v0, v48
    v_mfma_f32_16x16x32_f16 v[12:15], v[140:143], v[78:81], v[12:15]
    v_mul_f32 v1, v1, v48
    v_cvt_pk_f16_f32 v146, v0, v1
    v_mfma_f32_16x16x32_f16 v[4:7], v[40:43], v[70:73], v[208:211]
    v_mul_f32 v2, v2, v48
    v_mul_f32 v3, v3, v48
    v_mfma_f32_16x16x32_f16 v[4:7], v[140:143], v[72:75], v[4:7]
    v_cvt_pk_f16_f32 v147, v2, v3
    v_cvt_pk_bf16_f32 v156, v20, v21
    v_mfma_f32_16x16x32_f16 v[0:3], v[40:43], v[64:67], v[208:211]
    v_cvt_pk_bf16_f32 v157, v22, v23
    v_max3_f32 v154, v36, v37, v38
    v_mfma_f32_16x16x32_f16 v[0:3], v[140:143], v[66:69], v[0:3]
    v_max3_f32 v154, v154, v39, v60
    v_max3_f32 v154, v154, v61, v62
    v_mfma_f32_16x16x32_f16 v[40:43], v[82:85], v[88:91], v[192:195]
    v_max3_f32 v154, v154, v63, v56
    v_max3_f32 v154, v154, v57, v58
    v_mfma_f32_16x16x32_f16 v[40:43], v[84:87], v[148:151], v[40:43]
    v_max3_f32 v154, v154, v59, v8
    v_mov_b32 v155, v154
    v_mfma_f32_16x16x32_f16 v[52:55], v[76:79], v[88:91], v[188:191]
    s_nop 0
    v_permlane32_swap_b32 v155, v154
    v_mfma_f32_16x16x32_f16 v[52:55], v[78:81], v[148:151], v[52:55]
    v_max_f32 v154, v155, v154
    v_mov_b32 v155, v154
    v_mfma_f32_16x16x32_f16 v[48:51], v[70:73], v[88:91], v[184:187]
    s_nop 0
    v_permlane16_swap_b32 v155, v154
    v_mfma_f32_16x16x32_f16 v[48:51], v[72:75], v[148:151], v[48:51]
    v_max_f32 v154, v155, v154
    v_sub_f32 v36, v36, v154
    v_mfma_f32_16x16x32_f16 v[20:23], v[64:67], v[88:91], v[208:211]
    v_sub_f32 v37, v37, v154
    v_sub_f32 v38, v38, v154
    v_mfma_f32_16x16x32_f16 v[20:23], v[66:69], v[148:151], v[20:23]
    v_sub_f32 v39, v39, v154
    v_sub_f32 v60, v60, v154
    v_sub_f32 v61, v61, v154
    v_sub_f32 v62, v62, v154
    v_sub_f32 v63, v63, v154
    v_sub_f32 v56, v56, v154
    v_sub_f32 v57, v57, v154
    v_sub_f32 v58, v58, v154
    v_sub_f32 v59, v59, v154
    v_sub_f32 v8, v8, v154
    v_exp_f32 v36, v36
    v_exp_f32 v37, v37
    v_exp_f32 v38, v38
    v_exp_f32 v39, v39
    v_cvt_pk_bf16_f32 v36, v36, v37
    v_cvt_pk_bf16_f32 v37, v38, v39
    v_exp_f32 v60, v60
    v_exp_f32 v61, v61
    v_exp_f32 v62, v62
    v_exp_f32 v63, v63
    v_cvt_pk_bf16_f32 v38, v60, v61
    v_cvt_pk_bf16_f32 v39, v62, v63
    v_exp_f32 v56, v56
    v_exp_f32 v57, v57
    v_exp_f32 v58, v58
    v_exp_f32 v59, v59
    v_cvt_pk_bf16_f32 v168, v56, v57
    v_cvt_pk_bf16_f32 v169, v58, v59
    v_exp_f32 v8, v8
    v_mov_b32_dpp v19, v15 quad_perm:[0,1,2,3] row_mask:0x2 bank_mask:0xf
    v_cvt_pk_bf16_f32 v170, v8, 0
    v_mfma_f32_16x16x32_bf16 v[8:11], v[220:223], v[36:39], 0
    v_mov_b32_dpp v19, v7 quad_perm:[0,1,2,3] row_mask:0x4 bank_mask:0xf
    v_max3_f32 v142, v40, v41, v42
    v_mfma_f32_16x16x32_bf16 v[8:11], v[220:223], v[168:171], v[8:11]
    v_mov_b32_dpp v19, v3 quad_perm:[0,1,2,3] row_mask:0x8 bank_mask:0xf
    v_mov_b32 v150, v19
    v_mfma_f32_16x16x32_bf16 v[4:7], v[24:27], v[36:39], 0
    s_nop 0
    v_max_f32_dpp v150, v150, v150 row_ror:8 row_mask:0xf bank_mask:0xf
    v_max3_f32 v142, v142, v43, v52
    v_mfma_f32_16x16x32_bf16 v[4:7], v[164:167], v[168:171], v[4:7]
    v_max_f32_dpp v150, v150, v150 row_ror:4 row_mask:0xf bank_mask:0xf
    v_max3_f32 v142, v142, v53, v54
    v_mfma_f32_16x16x32_bf16 v[12:15], v[28:31], v[36:39], 0
    v_max_f32_dpp v150, v150, v150 row_ror:2 row_mask:0xf bank_mask:0xf
    v_max3_f32 v142, v142, v55, v48
    v_mfma_f32_16x16x32_bf16 v[12:15], v[160:163], v[168:171], v[12:15]
    v_max_f32_dpp v150, v150, v150 row_ror:1 row_mask:0xf bank_mask:0xf
    v_mov_b32 v143, v150
    v_mfma_f32_16x16x32_bf16 v[0:3], v[32:35], v[36:39], 0
    s_nop 0
    v_permlane32_swap_b32 v143, v150
    v_mfma_f32_16x16x32_bf16 v[0:3], v[156:159], v[168:171], v[0:3]
    v_max_f32 v150, v143, v150
    v_mov_b32 v143, v150
    v_rcp_f32 v8, v8
    v_max3_f32 v142, v142, v49, v50
    v_permlane16_swap_b32 v143, v150
    v_max_f32 v150, v143, v150
    v_sub_f32 v19, v19, v150
    v_exp_f32 v19, v19
    v_mul_f32 v4, v4, v8
    v_cvt_pk_bf16_f32 v19, v19, v19
    ds_write_b16 v125, v19
    v_mul_f32 v5, v5, v8
    v_cvt_pk_bf16_f32 v4, v4, v5
    ds_read_b128 v[60:63], v134
    v_mul_f32 v6, v6, v8
    v_mul_f32 v7, v7, v8
    v_cvt_pk_bf16_f32 v5, v6, v7
    ds_read_b128 v[56:59], v134 offset:16
    v_mfma_f32_16x16x32_f16 v[16:19], v[82:85], v[44:47], v[180:183]
    v_mul_f32 v12, v12, v8
    v_mul_f32 v13, v13, v8
    v_mfma_f32_16x16x32_f16 v[16:19], v[84:87], v[144:147], v[16:19]
    ds_write_b64 v137, v[4:5] offset:0
    v_mfma_f32_16x16x32_f16 v[36:39], v[76:79], v[44:47], v[176:179]
    v_cvt_pk_bf16_f32 v6, v12, v13
    v_mul_f32 v14, v14, v8
    v_mfma_f32_16x16x32_f16 v[36:39], v[78:81], v[144:147], v[36:39]
    v_mul_f32 v15, v15, v8
    v_cvt_pk_bf16_f32 v7, v14, v15
    v_mfma_f32_16x16x32_f16 v[12:15], v[70:73], v[44:47], v[172:175]
    ds_write_b64 v137, v[6:7] offset:8
    v_mfma_f32_16x16x32_f16 v[12:15], v[72:75], v[144:147], v[12:15]
    v_mul_f32 v0, v0, v8
    v_mul_f32 v1, v1, v8
    v_mfma_f32_16x16x32_f16 v[4:7], v[64:67], v[44:47], v[208:211]
    v_cvt_pk_bf16_f32 v150, v0, v1
    v_mul_f32 v2, v2, v8
    v_mfma_f32_16x16x32_f16 v[4:7], v[66:69], v[144:147], v[4:7]
    s_waitcnt lgkmcnt(2)
    v_mul_f32 v3, v3, v8
    v_cvt_pk_bf16_f32 v151, v2, v3
    v_mfma_f32_16x16x32_bf16 v[0:3], v[60:63], v[24:27], 0
    ds_write_b64 v136, v[150:151] offset:0
    v_mfma_f32_16x16x32_bf16 v[0:3], v[56:59], v[164:167], v[0:3]
    v_max3_f32 v142, v142, v51, v21
    v_mov_b32 v143, v142
    v_mfma_f32_16x16x32_bf16 v[44:47], v[60:63], v[28:31], 0
    s_nop 0
    v_permlane32_swap_b32 v143, v142
    v_mfma_f32_16x16x32_bf16 v[44:47], v[56:59], v[160:163], v[44:47]
    v_max_f32 v142, v143, v142
    v_mov_b32 v143, v142
    v_mfma_f32_16x16x32_bf16 v[8:11], v[60:63], v[32:35], 0
    s_nop 0
    v_permlane16_swap_b32 v143, v142
    v_mfma_f32_16x16x32_bf16 v[8:11], v[56:59], v[156:159], v[8:11]
    v_max_f32 v142, v143, v142
    v_sub_f32 v40, v40, v142
    v_sub_f32 v41, v41, v142
    v_sub_f32 v42, v42, v142
    v_sub_f32 v43, v43, v142
    v_sub_f32 v52, v52, v142
    v_sub_f32 v53, v53, v142
    v_sub_f32 v54, v54, v142
    v_sub_f32 v55, v55, v142
    v_sub_f32 v48, v48, v142
    v_sub_f32 v49, v49, v142
    v_sub_f32 v50, v50, v142
    v_sub_f32 v51, v51, v142
    v_sub_f32 v21, v21, v142
    v_exp_f32 v40, v40
    v_exp_f32 v41, v41
    v_exp_f32 v42, v42
    v_exp_f32 v43, v43
    v_cvt_pk_bf16_f32 v40, v40, v41
    v_cvt_pk_bf16_f32 v41, v42, v43
    v_exp_f32 v52, v52
    v_exp_f32 v53, v53
    v_exp_f32 v54, v54
    v_exp_f32 v55, v55
    v_cvt_pk_bf16_f32 v42, v52, v53
    v_cvt_pk_bf16_f32 v43, v54, v55
    v_exp_f32 v48, v48
    v_exp_f32 v49, v49
    v_exp_f32 v50, v50
    v_exp_f32 v51, v51
    v_cvt_pk_bf16_f32 v168, v48, v49
    v_cvt_pk_bf16_f32 v169, v50, v51
    v_exp_f32 v21, v21
    v_mov_b32_dpp v3, v47 quad_perm:[0,1,2,3] row_mask:0x2 bank_mask:0xf
    v_cvt_pk_bf16_f32 v170, v21, 0
    v_mfma_f32_16x16x32_bf16 v[44:47], v[220:223], v[40:43], 0
    v_mov_b32_dpp v3, v11 quad_perm:[0,1,2,3] row_mask:0x4 bank_mask:0xf
    v_cvt_pk_bf16_f32 v3, v3, v3
    v_mfma_f32_16x16x32_bf16 v[44:47], v[220:223], v[168:171], v[44:47]
    ds_write_b16 v133, v3 offset:56
    v_mfma_f32_16x16x32_bf16 v[20:23], v[24:27], v[40:43], 0
    ds_read_b128 v[8:11], v139 offset:0
    v_max3_f32 v142, v16, v17, v18
    v_mfma_f32_16x16x32_bf16 v[20:23], v[164:167], v[168:171], v[20:23]
    ds_read_b128 v[60:63], v138 offset:0
    v_max3_f32 v142, v142, v19, v36
    v_mfma_f32_16x16x32_bf16 v[52:55], v[28:31], v[40:43], 0
    ds_read_b128 v[0:3], v139 offset:128
    v_max3_f32 v142, v142, v37, v38
    v_mfma_f32_16x16x32_bf16 v[52:55], v[160:163], v[168:171], v[52:55]
    ds_read_b128 v[72:75], v138 offset:128
    v_max3_f32 v142, v142, v39, v12
    v_mfma_f32_16x16x32_bf16 v[48:51], v[32:35], v[40:43], 0
    ds_read_b128 v[76:79], v139 offset:256
    v_max3_f32 v142, v142, v13, v14
    v_mfma_f32_16x16x32_bf16 v[48:51], v[156:159], v[168:171], v[48:51]
    ds_read_b128 v[64:67], v138 offset:256
    v_max3_f32 v142, v142, v15, v6
    v_rcp_f32 v44, v44
    v_mov_b32 v143, v142
    v_mul_f32 v20, v20, v44
    v_mul_f32 v21, v21, v44
    v_cvt_pk_bf16_f32 v40, v20, v21
    v_mul_f32 v22, v22, v44
    v_mul_f32 v23, v23, v44
    v_cvt_pk_bf16_f32 v41, v22, v23
    v_mul_f32 v52, v52, v44
    v_mul_f32 v53, v53, v44
    v_cvt_pk_bf16_f32 v42, v52, v53
    v_mul_f32 v54, v54, v44
    s_waitcnt lgkmcnt(5)
    v_mfma_f32_16x16x32_bf16 v[20:23], a[0:3], v[8:11], 0
    ds_write_b64 v137, v[40:41] offset:1536
    v_mul_f32 v55, v55, v44
    v_cvt_pk_bf16_f32 v43, v54, v55
    v_mul_f32 v48, v48, v44
    v_mul_f32 v49, v49, v44
    v_cvt_pk_bf16_f32 v146, v48, v49
    v_mul_f32 v50, v50, v44
    v_mul_f32 v51, v51, v44
    v_cvt_pk_bf16_f32 v147, v50, v51
    ds_write_b64 v137, v[42:43] offset:1544
    v_permlane32_swap_b32 v143, v142
    v_max_f32 v142, v143, v142
    v_mov_b32 v143, v142
    s_nop 0
    ds_write_b64 v136, v[146:147] offset:1536
    v_permlane16_swap_b32 v143, v142
    v_max_f32 v142, v143, v142
    v_sub_f32 v16, v16, v142
    v_sub_f32 v17, v17, v142
    v_sub_f32 v18, v18, v142
    v_sub_f32 v19, v19, v142
    v_sub_f32 v36, v36, v142
    v_sub_f32 v37, v37, v142
    v_sub_f32 v38, v38, v142
    v_sub_f32 v39, v39, v142
    v_sub_f32 v12, v12, v142
    v_sub_f32 v13, v13, v142
    v_sub_f32 v14, v14, v142
    v_sub_f32 v15, v15, v142
    v_sub_f32 v6, v6, v142
    v_exp_f32 v16, v16
    v_exp_f32 v17, v17
    v_exp_f32 v18, v18
    v_exp_f32 v19, v19
    v_cvt_pk_bf16_f32 v16, v16, v17
    v_cvt_pk_bf16_f32 v17, v18, v19
    v_exp_f32 v36, v36
    v_exp_f32 v37, v37
    v_exp_f32 v38, v38
    v_exp_f32 v39, v39
    v_cvt_pk_bf16_f32 v18, v36, v37
    v_cvt_pk_bf16_f32 v19, v38, v39
    v_exp_f32 v12, v12
    v_exp_f32 v13, v13
    v_exp_f32 v14, v14
    v_exp_f32 v15, v15
    v_cvt_pk_bf16_f32 v168, v12, v13
    v_cvt_pk_bf16_f32 v169, v14, v15
    v_exp_f32 v6, v6
    s_nop 0
    v_cvt_pk_bf16_f32 v170, v6, 0
    v_mfma_f32_16x16x32_bf16 v[4:7], v[220:223], v[16:19], 0
    s_nop 0
    v_mfma_f32_16x16x32_bf16 v[4:7], v[220:223], v[168:171], v[4:7]
    s_nop 1
    v_mfma_f32_16x16x32_bf16 v[12:15], v[24:27], v[16:19], 0
    s_nop 2
    v_mfma_f32_16x16x32_bf16 v[12:15], v[164:167], v[168:171], v[12:15]
    s_nop 0
    v_rcp_f32 v4, v4
    v_mfma_f32_16x16x32_bf16 v[24:27], v[28:31], v[16:19], 0
    s_nop 2
    v_mfma_f32_16x16x32_bf16 v[24:27], v[160:163], v[168:171], v[24:27]
    s_nop 0
    v_mul_f32 v12, v12, v4
    v_mul_f32 v13, v13, v4
    v_mfma_f32_16x16x32_bf16 v[28:31], v[32:35], v[16:19], 0
    v_cvt_pk_bf16_f32 v44, v12, v13
    v_mul_f32 v14, v14, v4
    v_mfma_f32_16x16x32_bf16 v[28:31], v[156:159], v[168:171], v[28:31]
    v_mul_f32 v15, v15, v4
    v_cvt_pk_bf16_f32 v45, v14, v15
    s_waitcnt lgkmcnt(0)
.p2align 6
L_loopS0:
    v_mfma_f32_16x16x32_bf16 v[20:23], a[4:7], v[60:63], v[20:23]
    ds_write_b64 v137, v[44:45] offset:3072
    v_mfma_f32_16x16x32_bf16 v[20:23], a[8:11], v[0:3], v[20:23]
    v_mul_f32 v24, v24, v4
    v_mul_f32 v25, v25, v4
    v_mfma_f32_16x16x32_bf16 v[20:23], a[12:15], v[72:75], v[20:23]
    v_cvt_pk_bf16_f32 v46, v24, v25
    v_mul_f32 v26, v26, v4
    v_mfma_f32_16x16x32_bf16 v[20:23], a[16:19], v[76:79], v[20:23]
    v_mul_f32 v27, v27, v4
    v_cvt_pk_bf16_f32 v47, v26, v27
    v_mfma_f32_16x16x32_bf16 v[20:23], a[20:23], v[64:67], v[20:23]
    ds_write_b64 v137, v[46:47] offset:3080
    v_mfma_f32_16x16x32_bf16 v[44:47], a[24:27], v[8:11], 0
    v_mul_f32 v28, v28, v4
    v_mul_f32 v29, v29, v4
    v_mfma_f32_16x16x32_bf16 v[44:47], a[28:31], v[60:63], v[44:47]
    v_cvt_pk_bf16_f32 v28, v28, v29
    v_mul_f32 v30, v30, v4
    v_mfma_f32_16x16x32_bf16 v[44:47], a[32:35], v[0:3], v[44:47]
    v_mul_f32 v31, v31, v4
    v_cvt_pk_bf16_f32 v29, v30, v31
    v_mfma_f32_16x16x32_bf16 v[44:47], a[36:39], v[72:75], v[44:47]
    ds_write_b64 v136, v[28:29] offset:3072
    v_mfma_f32_16x16x32_bf16 v[44:47], a[40:43], v[76:79], v[44:47]
    v_fmac_f32 v155, v52, v52
    v_fmac_f32 v155, v53, v53
    v_mfma_f32_16x16x32_bf16 v[44:47], a[44:47], v[64:67], v[44:47]
    v_fmac_f32 v155, v54, v54
    v_fmac_f32 v155, v55, v55
    v_mfma_f32_16x16x32_bf16 v[4:7], a[48:51], v[8:11], 0
    v_fma_f32 v170, v12, v12, s42
    v_fmac_f32 v170, v13, v13
    v_mfma_f32_16x16x32_bf16 v[4:7], a[52:55], v[60:63], v[4:7]
    v_fmac_f32 v170, v14, v14
    v_fmac_f32 v170, v15, v15
    v_mfma_f32_16x16x32_bf16 v[4:7], a[56:59], v[0:3], v[4:7]
    v_fmac_f32 v170, v16, v16
    v_fmac_f32 v170, v17, v17
    v_mfma_f32_16x16x32_bf16 v[4:7], a[60:63], v[72:75], v[4:7]
    v_fmac_f32 v170, v18, v18
    v_fmac_f32 v170, v19, v19
    v_mfma_f32_16x16x32_bf16 v[4:7], a[64:67], v[76:79], v[4:7]
    s_waitcnt vmcnt(10)
    v_fmac_f32 v170, v56, v56
    v_fmac_f32 v170, v57, v57
    v_mfma_f32_16x16x32_bf16 v[4:7], a[68:71], v[64:67], v[4:7]
    v_fmac_f32 v170, v58, v58
    v_fmac_f32 v170, v59, v59
    v_mfma_f32_16x16x32_bf16 v[88:91], a[72:75], v[8:11], 0
    v_cvt_pk_bf16_f32 v154, v154, v155
    v_cvt_pk_bf16_f32 v155, v170, v124
    v_mfma_f32_16x16x32_bf16 v[88:91], a[76:79], v[60:63], v[88:91]
    ds_write_b64 v132, v[154:155]
    v_mfma_f32_16x16x32_bf16 v[88:91], a[80:83], v[0:3], v[88:91]
    v_add_u32 v137, s49, v137
    v_add_u32 v136, s49, v136
    v_mfma_f32_16x16x32_bf16 v[88:91], a[84:87], v[72:75], v[88:91]
    v_fma_f32 v154, v20, v20, s41
    v_fmac_f32 v154, v21, v21
    v_mfma_f32_16x16x32_bf16 v[88:91], a[88:91], v[76:79], v[88:91]
    v_fmac_f32 v154, v22, v22
    v_fmac_f32 v154, v23, v23
    v_mfma_f32_16x16x32_bf16 v[88:91], a[92:95], v[64:67], v[88:91]
    v_fmac_f32 v154, v44, v44
    v_fmac_f32 v154, v45, v45
    v_mfma_f32_16x16x32_bf16 v[104:107], a[96:99], v[8:11], 0
    v_fmac_f32 v154, v46, v46
    v_fmac_f32 v154, v47, v47
    v_mfma_f32_16x16x32_bf16 v[104:107], a[100:103], v[60:63], v[104:107]
    v_fmac_f32 v154, v4, v4
    v_fmac_f32 v154, v5, v5
    v_mfma_f32_16x16x32_bf16 v[104:107], a[104:107], v[0:3], v[104:107]
    v_fmac_f32 v154, v6, v6
    v_fmac_f32 v154, v7, v7
    v_mfma_f32_16x16x32_bf16 v[104:107], a[108:111], v[72:75], v[104:107]
    s_waitcnt lgkmcnt(0)
    v_fma_f32 v155, v88, v88, s41
    v_fmac_f32 v155, v89, v89
    v_mfma_f32_16x16x32_bf16 v[104:107], a[112:115], v[76:79], v[104:107]
    s_barrier
    ds_read_b128 v[68:71], v131 offset:0
    v_fmac_f32 v155, v90, v90
    v_mfma_f32_16x16x32_bf16 v[104:107], a[116:119], v[64:67], v[104:107]
    ds_read_b128 v[120:123], v131 offset:1024
    v_fmac_f32 v155, v91, v91
    v_mfma_f32_16x16x32_bf16 v[84:87], a[120:123], v[8:11], 0
    s_nop 2
    v_mfma_f32_16x16x32_bf16 v[84:87], a[124:127], v[60:63], v[84:87]
    s_nop 0
    v_fmac_f32 v155, v104, v104
    v_fmac_f32 v155, v105, v105
    v_mfma_f32_16x16x32_bf16 v[84:87], a[128:131], v[0:3], v[84:87]
    v_fmac_f32 v155, v106, v106
    v_fmac_f32 v155, v107, v107
    v_mfma_f32_16x16x32_bf16 v[84:87], a[132:135], v[72:75], v[84:87]
    v_mfma_f32_16x16x32_bf16 v[84:87], a[136:139], v[76:79], v[84:87]
    v_mfma_f32_16x16x32_bf16 v[84:87], a[140:143], v[64:67], v[84:87]
    v_mfma_f32_16x16x32_bf16 v[112:115], v[8:11], a[144:147], 0
    s_nop 2
    v_mfma_f32_16x16x32_bf16 v[112:115], v[60:63], a[148:151], v[112:115]
    s_waitcnt lgkmcnt(1)
    s_nop 0
    v_readfirstlane_b32 s12, v69
    v_fmac_f32 v155, v84, v84
    v_mfma_f32_16x16x32_bf16 v[112:115], v[0:3], a[152:155], v[112:115]
    s_lshr_b32 s12, s12, 23
    v_fmac_f32 v155, v85, v85
    v_fmac_f32 v155, v86, v86
    v_mfma_f32_16x16x32_bf16 v[112:115], v[72:75], a[156:159], v[112:115]
    v_fmac_f32 v155, v87, v87
    v_cvt_pk_bf16_f32 v170, v154, v155
    v_mfma_f32_16x16x32_bf16 v[112:115], v[76:79], a[160:163], v[112:115]
    v_mfma_f32_16x16x32_bf16 v[112:115], v[64:67], a[164:167], v[112:115]
    v_mfma_f32_16x16x32_bf16 v[80:83], v[216:219], v[68:71], 0
    s_waitcnt lgkmcnt(0)
    s_nop 0
    ds_read_b128 v[68:71], v139 offset:1536
    s_nop 0
    v_mfma_f32_16x16x32_bf16 v[80:83], v[216:219], v[120:123], v[80:83]
    s_nop 0
    ds_read_b128 v[120:123], v138 offset:1536
    v_cvt_pk_bf16_f32 v24, v112, v113
    v_mfma_f32_16x16x16_bf16 v[26:29], v[216:217], v[170:171], 0
    s_nop 0
    ds_read_b128 v[100:103], v139 offset:1664
    v_cvt_pk_bf16_f32 v25, v114, v115
    s_nop 0
    v_rsq_f32 v80, v80
    v_mfma_f32_16x16x32_bf16 v[154:157], v[8:11], a[168:171], 0
    ds_read_b128 v[112:115], v138 offset:1664
    v_mul_f32 v80, s43, v80
    v_mfma_f32_16x16x32_bf16 v[154:157], v[60:63], a[172:175], v[154:157]
    ds_read_b128 v[96:99], v139 offset:1792
    v_mul_f32 v40, v40, v80
    v_mfma_f32_16x16x32_bf16 v[154:157], v[0:3], a[176:179], v[154:157]
    ds_read_b128 v[92:95], v138 offset:1792
    v_mul_f32 v41, v41, v80
    v_mfma_f32_16x16x32_bf16 v[154:157], v[72:75], a[180:183], v[154:157]
    v_rsq_f32 v81, v81
    v_mfma_f32_16x16x32_bf16 v[154:157], v[76:79], a[184:187], v[154:157]
    v_rsq_f32 v82, v82
    v_mfma_f32_16x16x32_bf16 v[154:157], v[64:67], a[188:191], v[154:157]
    v_mul_f32 v81, s43, v81
    v_mul_f32 v82, s43, v82
    v_mfma_f32_16x16x32_bf16 v[116:119], v[8:11], a[192:195], 0
    v_rsq_f32 v26, v26
    v_mfma_f32_16x16x32_bf16 v[116:119], v[60:63], a[196:199], v[116:119]
    v_rsq_f32 v27, v27
    v_mfma_f32_16x16x32_bf16 v[116:119], v[0:3], a[200:203], v[116:119]
    v_mul_f32 v26, s55, v26
    v_mul_f32 v27, 0.5, v27
    v_mfma_f32_16x16x32_bf16 v[116:119], v[72:75], a[204:207], v[116:119]
    v_cvt_pk_bf16_f32 v28, v154, v155
    v_cvt_pk_bf16_f32 v29, v156, v157
    v_mfma_f32_16x16x32_bf16 v[116:119], v[76:79], a[208:211], v[116:119]
    v_mul_f32 v20, v20, v26
    v_mul_f32 v21, v21, v26
    v_mfma_f32_16x16x32_bf16 v[116:119], v[64:67], a[212:215], v[116:119]
    s_waitcnt lgkmcnt(0)
    v_cvt_pk_f16_f32 v64, v20, v21
    v_mul_f32 v22, v22, v26
    v_mfma_f32_16x16x32_bf16 v[8:11], a[0:3], v[68:71], 0
    v_mul_f32 v23, v23, v26
    v_cvt_pk_f16_f32 v65, v22, v23
    v_mfma_f32_16x16x32_bf16 v[8:11], a[4:7], v[120:123], v[8:11]
    v_mul_f32 v44, v44, v26
    v_mul_f32 v45, v45, v26
    v_mfma_f32_16x16x32_bf16 v[8:11], a[8:11], v[100:103], v[8:11]
    v_cvt_pk_f16_f32 v66, v44, v45
    v_mul_f32 v46, v46, v26
    v_mfma_f32_16x16x32_bf16 v[8:11], a[12:15], v[112:115], v[8:11]
    v_mul_f32 v47, v47, v26
    v_cvt_pk_f16_f32 v67, v46, v47
    v_mfma_f32_16x16x32_bf16 v[8:11], a[16:19], v[96:99], v[8:11]
    v_mul_f32 v4, v4, v26
    v_mul_f32 v5, v5, v26
    v_mfma_f32_16x16x32_bf16 v[8:11], a[20:23], v[92:95], v[8:11]
    v_cvt_pk_f16_f32 v154, v4, v5
    v_mul_f32 v6, v6, v26
    v_mfma_f32_16x16x32_bf16 v[20:23], a[24:27], v[68:71], 0
    v_mul_f32 v7, v7, v26
    v_cvt_pk_f16_f32 v155, v6, v7
    v_mfma_f32_16x16x32_bf16 v[20:23], a[28:31], v[120:123], v[20:23]
    v_mul_f32 v88, v88, v27
    v_mul_f32 v89, v89, v27
    v_mfma_f32_16x16x32_bf16 v[20:23], a[32:35], v[100:103], v[20:23]
    v_cvt_pk_f16_f32 v0, v88, v89
    v_mul_f32 v90, v90, v27
    v_mfma_f32_16x16x32_bf16 v[20:23], a[36:39], v[112:115], v[20:23]
    v_mul_f32 v91, v91, v27
    v_cvt_pk_f16_f32 v1, v90, v91
    v_mfma_f32_16x16x32_bf16 v[20:23], a[40:43], v[96:99], v[20:23]
    v_mul_f32 v104, v104, v27
    v_mul_f32 v105, v105, v27
    v_mfma_f32_16x16x32_bf16 v[20:23], a[44:47], v[92:95], v[20:23]
    v_cvt_pk_f16_f32 v2, v104, v105
    v_mul_f32 v106, v106, v27
    v_mfma_f32_16x16x32_bf16 v[76:79], a[48:51], v[68:71], 0
    v_mul_f32 v107, v107, v27
    v_cvt_pk_f16_f32 v3, v106, v107
    v_mfma_f32_16x16x32_bf16 v[76:79], a[52:55], v[120:123], v[76:79]
    v_mul_f32 v84, v84, v27
    v_mul_f32 v85, v85, v27
    v_mfma_f32_16x16x32_bf16 v[76:79], a[56:59], v[100:103], v[76:79]
    v_cvt_pk_f16_f32 v4, v84, v85
    v_mul_f32 v86, v86, v27
    v_mfma_f32_16x16x32_bf16 v[76:79], a[60:63], v[112:115], v[76:79]
    v_mul_f32 v87, v87, v27
    v_cvt_pk_f16_f32 v5, v86, v87
    v_mfma_f32_16x16x32_bf16 v[76:79], a[64:67], v[96:99], v[76:79]
    v_cvt_pk_bf16_f32 v44, v116, v117
    v_cvt_pk_bf16_f32 v45, v118, v119
    v_mfma_f32_16x16x32_bf16 v[76:79], a[68:71], v[92:95], v[76:79]
    v_cvt_pk_bf16_f32 v40, v40, v41
    v_mul_f32 v42, v42, v80
    v_mfma_f32_16x16x32_bf16 v[60:63], a[72:75], v[68:71], 0
    v_mul_f32 v43, v43, v80
    v_cvt_pk_bf16_f32 v41, v42, v43
    v_mfma_f32_16x16x32_bf16 v[60:63], a[76:79], v[120:123], v[60:63]
    ds_write_b64 v137, v[40:41] offset:0
    v_mfma_f32_16x16x32_bf16 v[60:63], a[80:83], v[100:103], v[60:63]
    v_mul_f32 v36, v36, v80
    v_mul_f32 v37, v37, v80
    v_mfma_f32_16x16x32_bf16 v[60:63], a[84:87], v[112:115], v[60:63]
    v_cvt_pk_bf16_f32 v42, v36, v37
    v_mul_f32 v38, v38, v80
    v_mfma_f32_16x16x32_bf16 v[60:63], a[88:91], v[96:99], v[60:63]
    v_mul_f32 v39, v39, v80
    v_cvt_pk_bf16_f32 v43, v38, v39
    v_mfma_f32_16x16x32_bf16 v[60:63], a[92:95], v[92:95], v[60:63]
    ds_write_b64 v137, v[42:43] offset:8
    v_mfma_f32_16x16x32_bf16 v[40:43], a[96:99], v[68:71], 0
    v_mul_f32 v32, v32, v80
    v_mul_f32 v33, v33, v80
    v_mfma_f32_16x16x32_bf16 v[40:43], a[100:103], v[120:123], v[40:43]
    v_cvt_pk_bf16_f32 v26, v32, v33
    v_mul_f32 v34, v34, v80
    v_mfma_f32_16x16x32_bf16 v[40:43], a[104:107], v[100:103], v[40:43]
    v_mul_f32 v35, v35, v80
    v_cvt_pk_bf16_f32 v27, v34, v35
    v_mfma_f32_16x16x32_bf16 v[40:43], a[108:111], v[112:115], v[40:43]
    ds_write_b64 v136, v[26:27] offset:0
    v_mfma_f32_16x16x32_bf16 v[40:43], a[112:115], v[96:99], v[40:43]
    v_fma_f32 v26, v8, v8, s41
    v_fmac_f32 v26, v9, v9
    v_mfma_f32_16x16x32_bf16 v[40:43], a[116:119], v[92:95], v[40:43]
    v_fmac_f32 v26, v10, v10
    v_fmac_f32 v26, v11, v11
    v_mfma_f32_16x16x32_bf16 v[36:39], a[120:123], v[68:71], 0
    v_fmac_f32 v26, v20, v20
    v_fmac_f32 v26, v21, v21
    v_mfma_f32_16x16x32_bf16 v[36:39], a[124:127], v[120:123], v[36:39]
    v_fmac_f32 v26, v22, v22
    v_fmac_f32 v26, v23, v23
    v_mfma_f32_16x16x32_bf16 v[36:39], a[128:131], v[100:103], v[36:39]
    v_fmac_f32 v26, v76, v76
    v_fmac_f32 v26, v77, v77
    v_mfma_f32_16x16x32_bf16 v[36:39], a[132:135], v[112:115], v[36:39]
    v_fmac_f32 v26, v78, v78
    v_fmac_f32 v26, v79, v79
    v_mfma_f32_16x16x32_bf16 v[36:39], a[136:139], v[96:99], v[36:39]
    v_mul_f32 v48, v48, v81
    v_mul_f32 v49, v49, v81
    v_mfma_f32_16x16x32_bf16 v[36:39], a[140:143], v[92:95], v[36:39]
    v_cvt_pk_bf16_f32 v30, v48, v49
    v_mul_f32 v50, v50, v81
    v_mfma_f32_16x16x32_bf16 v[46:49], v[68:71], a[144:147], 0
    v_mul_f32 v51, v51, v81
    v_cvt_pk_bf16_f32 v31, v50, v51
    v_mfma_f32_16x16x32_bf16 v[46:49], v[120:123], a[148:151], v[46:49]
    ds_write_b64 v137, v[30:31] offset:1536
    v_mfma_f32_16x16x32_bf16 v[46:49], v[100:103], a[152:155], v[46:49]
    v_mul_f32 v108, v108, v81
    v_mul_f32 v109, v109, v81
    v_mfma_f32_16x16x32_bf16 v[46:49], v[112:115], a[156:159], v[46:49]
    v_cvt_pk_bf16_f32 v32, v108, v109
    v_mul_f32 v110, v110, v81
    v_mfma_f32_16x16x32_bf16 v[46:49], v[96:99], a[160:163], v[46:49]
    ds_read_b128 v[72:75], v139 offset:3072
    v_mul_f32 v111, v111, v81
    v_mfma_f32_16x16x32_bf16 v[46:49], v[92:95], a[164:167], v[46:49]
    ds_read_b128 v[88:91], v138 offset:3072
    v_cvt_pk_bf16_f32 v33, v110, v111
    v_mfma_f32_16x16x32_bf16 v[106:109], v[68:71], a[168:171], 0
    ds_write_b64 v137, v[32:33] offset:1544
    v_mfma_f32_16x16x32_bf16 v[106:109], v[120:123], a[172:175], v[106:109]
    v_mul_f32 v52, v52, v81
    v_mul_f32 v53, v53, v81
    v_mfma_f32_16x16x32_bf16 v[106:109], v[100:103], a[176:179], v[106:109]
    ds_read_b128 v[32:35], v139 offset:3200
    v_cvt_pk_bf16_f32 v30, v52, v53
    v_mfma_f32_16x16x32_bf16 v[106:109], v[112:115], a[180:183], v[106:109]
    ds_read_b128 v[84:87], v138 offset:3200
    v_mul_f32 v54, v54, v81
    v_mfma_f32_16x16x32_bf16 v[106:109], v[96:99], a[184:187], v[106:109]
    ds_read_b128 v[116:119], v139 offset:3328
    v_mul_f32 v55, v55, v81
    v_mfma_f32_16x16x32_bf16 v[106:109], v[92:95], a[188:191], v[106:109]
    ds_read_b128 v[212:215], v138 offset:3328
    v_cvt_pk_bf16_f32 v31, v54, v55
    v_fma_f32 v27, v60, v60, s41
    v_fmac_f32 v27, v61, v61
    ds_write_b64 v136, v[30:31] offset:1536
    v_fmac_f32 v27, v62, v62
    v_fmac_f32 v27, v63, v63
    v_mfma_f32_16x16x32_bf16 v[52:55], v[68:71], a[192:195], 0
    v_fmac_f32 v27, v40, v40
    v_fmac_f32 v27, v41, v41
    v_mfma_f32_16x16x32_bf16 v[52:55], v[120:123], a[196:199], v[52:55]
    s_sub_u32 s50, s45, s44
    v_fmac_f32 v27, v42, v42
    v_fmac_f32 v27, v43, v43
    v_mfma_f32_16x16x32_bf16 v[52:55], v[100:103], a[200:203], v[52:55]
    s_sub_u32 s51, s46, s47
    v_fmac_f32 v27, v36, v36
    v_fmac_f32 v27, v37, v37
    v_mfma_f32_16x16x32_bf16 v[52:55], v[112:115], a[204:207], v[52:55]
    s_mov_b32 s60, s59
    v_fmac_f32 v27, v38, v38
    v_fmac_f32 v27, v39, v39
    v_mfma_f32_16x16x32_bf16 v[52:55], v[96:99], a[208:211], v[52:55]
    s_mov_b32 s59, s58
    v_cvt_pk_bf16_f32 v170, v26, v27
    v_cvt_pk_bf16_f32 v26, v46, v47
    v_mfma_f32_16x16x32_bf16 v[52:55], v[92:95], a[212:215], v[52:55]
    s_mov_b32 s58, s57
    v_cvt_pk_bf16_f32 v27, v48, v49
    v_cvt_pk_bf16_f32 v30, v106, v107
    v_mfma_f32_16x16x16_bf16 v[68:71], v[216:217], v[170:171], 0
    s_waitcnt lgkmcnt(0)
    s_mov_b32 s57, s56
    v_cvt_pk_bf16_f32 v31, v108, v109
    v_mul_f32 v12, v12, v82
    v_mul_f32 v13, v13, v82
    v_cvt_pk_bf16_f32 v46, v52, v53
    v_mfma_f32_16x16x32_bf16 v[48:51], a[0:3], v[72:75], 0
    s_mov_b32 s7, s6
    v_cvt_pk_bf16_f32 v47, v54, v55
    v_cvt_pk_bf16_f32 v12, v12, v13
    v_mfma_f32_16x16x32_bf16 v[48:51], a[4:7], v[88:91], v[48:51]
    s_mov_b32 s6, s5
    v_rsq_f32 v68, v68
    v_mfma_f32_16x16x32_bf16 v[48:51], a[8:11], v[32:35], v[48:51]
    s_mov_b32 s5, s4
    v_rsq_f32 v69, v69
    v_mfma_f32_16x16x32_bf16 v[48:51], a[12:15], v[84:87], v[48:51]
    s_sub_u32 s14, s6, s7
    v_mul_f32 v68, s55, v68
    v_mul_f32 v69, 0.5, v69
    v_mfma_f32_16x16x32_bf16 v[48:51], a[16:19], v[116:119], v[48:51]
    s_add_u32 s61, s61, 1
    v_mul_f32 v8, v8, v68
    v_mul_f32 v9, v9, v68
    v_mfma_f32_16x16x32_bf16 v[48:51], a[20:23], v[212:215], v[48:51]
    s_ff1_i32_b32 s15, s66
    v_cvt_pk_f16_f32 v52, v8, v9
    v_mul_f32 v10, v10, v68
    v_mfma_f32_16x16x32_bf16 v[106:109], a[24:27], v[72:75], 0
    s_cmp_lg_u32 s66, 0
    v_mul_f32 v11, v11, v68
    v_cvt_pk_f16_f32 v53, v10, v11
    v_mfma_f32_16x16x32_bf16 v[106:109], a[28:31], v[88:91], v[106:109]
    s_cselect_b32 s12, s15, s12
    v_mul_f32 v20, v20, v68
    v_mul_f32 v21, v21, v68
    v_mfma_f32_16x16x32_bf16 v[106:109], a[32:35], v[32:35], v[106:109]
    s_cmp_lt_u32 s61, s71
    v_cvt_pk_f16_f32 v54, v20, v21
    v_mul_f32 v22, v22, v68
    v_mfma_f32_16x16x32_bf16 v[106:109], a[36:39], v[84:87], v[106:109]
    s_cselect_b32 s15, 31, s15
    v_mul_f32 v23, v23, v68
    v_cvt_pk_f16_f32 v55, v22, v23
    v_mfma_f32_16x16x32_bf16 v[106:109], a[40:43], v[116:119], v[106:109]
    s_bitset0_b32 s66, s15
    v_mul_f32 v76, v76, v68
    v_mul_f32 v77, v77, v68
    v_mfma_f32_16x16x32_bf16 v[106:109], a[44:47], v[212:215], v[106:109]
    s_add_u32 s12, s12, 20
    v_cvt_pk_f16_f32 v150, v76, v77
    v_mul_f32 v78, v78, v68
    v_mfma_f32_16x16x32_bf16 v[120:123], a[48:51], v[72:75], 0
    s_max_u32 s12, s12, s61
    v_mul_f32 v79, v79, v68
    v_cvt_pk_f16_f32 v151, v78, v79
    v_mfma_f32_16x16x32_bf16 v[120:123], a[52:55], v[88:91], v[120:123]
    s_cmp_lt_u32 s61, s71
    v_mul_f32 v60, v60, v69
    v_mul_f32 v61, v61, v69
    v_mfma_f32_16x16x32_bf16 v[120:123], a[56:59], v[32:35], v[120:123]
    s_cselect_b32 s15, s61, s12
    v_cvt_pk_f16_f32 v6, v60, v61
    v_mul_f32 v62, v62, v69
    v_mfma_f32_16x16x32_bf16 v[120:123], a[60:63], v[84:87], v[120:123]
    s_cselect_b32 s56, s69, s70
    v_mul_f32 v63, v63, v69
    v_cvt_pk_f16_f32 v7, v62, v63
    v_mfma_f32_16x16x32_bf16 v[120:123], a[64:67], v[116:119], v[120:123]
    s_add_u32 s56, s56, s15
    v_mul_f32 v40, v40, v69
    v_mul_f32 v41, v41, v69
    v_mfma_f32_16x16x32_bf16 v[120:123], a[68:71], v[212:215], v[120:123]
    s_mul_i32 s53, s56, 58255
    v_cvt_pk_f16_f32 v8, v40, v41
    v_mul_f32 v42, v42, v69
    v_mfma_f32_16x16x32_bf16 v[20:23], a[72:75], v[72:75], 0
    s_lshr_b32 s53, s53, 22
    v_mul_f32 v43, v43, v69
    v_cvt_pk_f16_f32 v9, v42, v43
    v_mfma_f32_16x16x32_bf16 v[20:23], a[76:79], v[88:91], v[20:23]
    s_mul_i32 s53, s53, s63
    v_mul_f32 v36, v36, v69
    v_mul_f32 v37, v37, v69
    v_mfma_f32_16x16x32_bf16 v[20:23], a[80:83], v[32:35], v[20:23]
    s_mul_i32 s56, s56, s62
    v_cvt_pk_f16_f32 v10, v36, v37
    v_mul_f32 v38, v38, v69
    v_mfma_f32_16x16x32_bf16 v[20:23], a[84:87], v[84:87], v[20:23]
    s_add_u32 s56, s56, s53
    v_mul_f32 v39, v39, v69
    v_cvt_pk_f16_f32 v11, v38, v39
    v_mfma_f32_16x16x32_bf16 v[20:23], a[88:91], v[116:119], v[20:23]
    s_mul_i32 s4, s15, 336
    v_mul_f32 v14, v14, v82
    v_mul_f32 v15, v15, v82
    v_mfma_f32_16x16x32_bf16 v[20:23], a[92:95], v[212:215], v[20:23]
    s_cmp_ge_u32 s15, 16
    v_cvt_pk_bf16_f32 v13, v14, v15
    v_mul_f32 v16, v16, v82
    v_mfma_f32_16x16x32_bf16 v[36:39], a[96:99], v[72:75], 0
    s_cselect_b32 s53, -26880, 0
    ds_write_b64 v137, v[12:13] offset:3072
    v_mfma_f32_16x16x32_bf16 v[36:39], a[100:103], v[88:91], v[36:39]
    s_add_u32 s4, s4, s53
    v_mul_f32 v17, v17, v82
    v_cvt_pk_bf16_f32 v14, v16, v17
    v_mfma_f32_16x16x32_bf16 v[36:39], a[104:107], v[32:35], v[36:39]
    s_cmp_lt_u32 s15, s73
    v_mul_f32 v18, v18, v82
    v_mul_f32 v19, v19, v82
    v_mfma_f32_16x16x32_bf16 v[36:39], a[108:111], v[84:87], v[36:39]
    s_cselect_b32 s26, 100270464, 0
    v_cvt_pk_bf16_f32 v15, v18, v19
    v_mul_f32 v56, v56, v82
    v_mfma_f32_16x16x32_bf16 v[36:39], a[112:115], v[116:119], v[36:39]
    s_cselect_b32 s56, s56, 0
    ds_write_b64 v137, v[14:15] offset:3080
    v_mfma_f32_16x16x32_bf16 v[36:39], a[116:119], v[212:215], v[36:39]
    s_cselect_b32 s4, s4, -1
    v_mul_f32 v57, v57, v82
    v_cvt_pk_bf16_f32 v56, v56, v57
    v_mul_f32 v58, v58, v82
    v_mul_f32 v59, v59, v82
    v_cvt_pk_bf16_f32 v57, v58, v59
    s_cselect_b32 s15, s15, 0
    s_cselect_b32 s13, s13, -1
    ds_write_b64 v136, v[56:57] offset:3072
    v_fma_f32 v142, v48, v48, s41
    v_fmac_f32 v142, v49, v49
    v_fmac_f32 v142, v50, v50
    v_fmac_f32 v142, v51, v51
    v_mfma_f32_16x16x32_bf16 v[56:59], a[120:123], v[72:75], 0
    s_waitcnt vmcnt(0)
    v_fmac_f32 v142, v106, v106
    v_fmac_f32 v142, v107, v107
    v_mfma_f32_16x16x32_bf16 v[56:59], a[124:127], v[88:91], v[56:59]
    s_bitset1_b32 s64, s15
    v_fmac_f32 v142, v108, v108
    v_fmac_f32 v142, v109, v109
    v_mfma_f32_16x16x32_bf16 v[56:59], a[128:131], v[32:35], v[56:59]
    s_add_u32 s65, s65, 1
    v_fmac_f32 v142, v120, v120
    v_fmac_f32 v142, v121, v121
    v_mfma_f32_16x16x32_bf16 v[56:59], a[132:135], v[84:87], v[56:59]
    s_cmp_ge_i32 s65, 2
    v_fmac_f32 v142, v122, v122
    v_fmac_f32 v142, v123, v123
    v_mfma_f32_16x16x32_bf16 v[56:59], a[136:139], v[116:119], v[56:59]
    s_cselect_b32 s30, 100270464, 0
    v_fma_f32 v143, v20, v20, s41
    v_fmac_f32 v143, v21, v21
    v_mfma_f32_16x16x32_bf16 v[56:59], a[140:143], v[212:215], v[56:59]
    s_add_u32 s67, s46, s54
    v_fmac_f32 v143, v22, v22
    v_fmac_f32 v143, v23, v23
    v_mfma_f32_16x16x32_bf16 v[12:15], v[72:75], a[144:147], 0
    s_waitcnt lgkmcnt(0)
    s_add_u32 m0, s67, 0
    v_fmac_f32 v143, v36, v36
    v_fmac_f32 v143, v37, v37
    v_mfma_f32_16x16x32_bf16 v[12:15], v[88:91], a[148:151], v[12:15]
    s_barrier
    v_fmac_f32 v143, v38, v38
    v_fmac_f32 v143, v39, v39
    v_mfma_f32_16x16x32_bf16 v[12:15], v[32:35], a[152:155], v[12:15]
    s_cmp_ge_u32 s61, s13
    v_fmac_f32 v143, v56, v56
    v_fmac_f32 v143, v57, v57
    v_mfma_f32_16x16x32_bf16 v[12:15], v[84:87], a[156:159], v[12:15]
    s_cbranch_scc1 L_atomS0
L_atomrS0:
    v_mfma_f32_16x16x32_bf16 v[12:15], v[116:119], a[160:163], v[12:15]
    v_fmac_f32 v143, v58, v58
    v_fmac_f32 v143, v59, v59
    v_mfma_f32_16x16x32_bf16 v[12:15], v[212:215], a[164:167], v[12:15]
    v_cvt_pk_bf16_f32 v170, v142, v143
    v_add_u32 v139, s50, v139
    v_mfma_f32_16x16x32_bf16 v[40:43], v[72:75], a[168:171], 0
    ds_read_b128 v[76:79], v139 offset:0
    v_add_u32 v138, s50, v138
    v_mfma_f32_16x16x32_bf16 v[40:43], v[88:91], a[172:175], v[40:43]
    s_nop 0
    ds_read_b128 v[80:83], v138 offset:0
    v_cvt_pk_bf16_f32 v164, v12, v13
    v_mfma_f32_16x16x32_bf16 v[40:43], v[32:35], a[176:179], v[40:43]
    ds_read_b128 v[68:71], v139 offset:128
    v_cvt_pk_bf16_f32 v165, v14, v15
    v_mfma_f32_16x16x32_bf16 v[40:43], v[84:87], a[180:183], v[40:43]
    ds_read_b128 v[100:103], v138 offset:128
    v_add_u32 v137, s48, v137
    v_mfma_f32_16x16x32_bf16 v[40:43], v[116:119], a[184:187], v[40:43]
    ds_read_b128 v[112:115], v139 offset:256
    v_add_u32 v136, s48, v136
    v_mfma_f32_16x16x32_bf16 v[40:43], v[212:215], a[188:191], v[40:43]
    s_nop 0
    ds_read_b128 v[96:99], v138 offset:256
    v_add_u32 v135, s51, v135
    v_mfma_f32_16x16x16_bf16 v[92:95], v[216:217], v[170:171], 0
    s_nop 0
    v_add_u32 v134, s14, v134
    v_add_u32 v133, s14, v133
    v_add_u32 v125, s14, v125
    v_cvt_pk_bf16_f32 v160, v40, v41
    v_mfma_f32_16x16x32_bf16 v[60:63], v[72:75], a[192:195], 0
    v_cvt_pk_bf16_f32 v161, v42, v43
    v_mfma_f32_16x16x32_bf16 v[60:63], v[88:91], a[196:199], v[60:63]
    v_rsq_f32 v92, v92
    v_mfma_f32_16x16x32_bf16 v[60:63], v[32:35], a[200:203], v[60:63]
    v_rsq_f32 v93, v93
    v_mfma_f32_16x16x32_bf16 v[60:63], v[84:87], a[204:207], v[60:63]
    ds_read_b128 v[12:15], v134 offset:32
    v_mul_f32 v92, s55, v92
    v_mfma_f32_16x16x32_bf16 v[60:63], v[116:119], a[208:211], v[60:63]
    ds_read_b64 v[16:17], v134 offset:48
    v_mul_f32 v93, 0.5, v93
    v_mfma_f32_16x16x32_bf16 v[60:63], v[212:215], a[212:215], v[60:63]
    s_waitcnt lgkmcnt(3)
    ds_read_b128 v[72:75], v135 offset:0
    v_mul_f32 v20, v20, v93
    v_mfma_f32_16x16x32_bf16 v[40:43], a[216:219], v[76:79], 0
    v_mul_f32 v21, v21, v93
    v_cvt_pk_f16_f32 v18, v20, v21
    v_mfma_f32_16x16x32_bf16 v[40:43], a[220:223], v[80:83], v[40:43]
    v_mul_f32 v22, v22, v93
    v_mul_f32 v23, v23, v93
    v_mfma_f32_16x16x32_bf16 v[40:43], a[224:227], v[68:71], v[40:43]
    v_cvt_pk_f16_f32 v19, v22, v23
    v_mul_f32 v36, v36, v93
    v_mfma_f32_16x16x32_bf16 v[40:43], a[228:231], v[100:103], v[40:43]
    v_mul_f32 v37, v37, v93
    v_cvt_pk_f16_f32 v20, v36, v37
    v_mfma_f32_16x16x32_bf16 v[40:43], a[232:235], v[112:115], v[40:43]
    s_waitcnt lgkmcnt(3)
    v_mul_f32 v38, v38, v93
    v_mul_f32 v39, v39, v93
    v_mfma_f32_16x16x32_bf16 v[40:43], a[236:239], v[96:99], v[40:43]
    v_cvt_pk_f16_f32 v21, v38, v39
    v_mul_f32 v56, v56, v93
    v_mfma_f32_16x16x32_bf16 v[36:39], a[240:243], v[76:79], 0
    v_mul_f32 v57, v57, v93
    v_cvt_pk_f16_f32 v22, v56, v57
    v_mfma_f32_16x16x32_bf16 v[36:39], a[244:247], v[80:83], v[36:39]
    v_mul_f32 v58, v58, v93
    v_mul_f32 v59, v59, v93
    v_mfma_f32_16x16x32_bf16 v[36:39], a[248:251], v[68:71], v[36:39]
    s_waitcnt lgkmcnt(0)
    buffer_load_dwordx4 v130, s[24:27], s56 offen nt lds
    v_cvt_pk_f16_f32 v23, v58, v59
    v_mfma_f32_16x16x32_bf16 v[36:39], a[252:255], v[100:103], v[36:39]
    v_mul_f32 v48, v48, v92
    v_mul_f32 v49, v49, v92
    v_mfma_f32_16x16x32_bf16 v[36:39], v[224:227], v[112:115], v[36:39]
    v_cvt_pk_f16_f32 v56, v48, v49
    v_mul_f32 v50, v50, v92
    v_mfma_f32_16x16x32_bf16 v[36:39], v[228:231], v[96:99], v[36:39]
    ds_read_u16 v166, v133 offset:56
    v_mul_f32 v51, v51, v92
    v_mfma_f32_16x16x32_bf16 v[32:35], v[232:235], v[76:79], 0
    ds_read_u16 v162, v133 offset:64
    v_cvt_pk_f16_f32 v57, v50, v51
    v_mfma_f32_16x16x32_bf16 v[32:35], v[236:239], v[80:83], v[32:35]
    ds_read_u16 v158, v133 offset:72
    v_mul_f32 v106, v106, v92
    v_mfma_f32_16x16x32_bf16 v[32:35], v[240:243], v[68:71], v[32:35]
    ds_read_b128 v[48:51], v134 offset:0
    v_mul_f32 v107, v107, v92
    v_mfma_f32_16x16x32_bf16 v[32:35], v[244:247], v[100:103], v[32:35]
    buffer_store_dwordx4 v[72:75], v130, s[28:31], s60 offen sc1
    ds_read_b64 v[142:143], v134 offset:16
    v_cvt_pk_f16_f32 v58, v106, v107
    v_mul_f32 v108, v108, v92
    v_mul_f32 v109, v109, v92
    v_mfma_f32_16x16x32_bf16 v[32:35], v[248:251], v[112:115], v[32:35]
    s_add_u32 m0, s67, 1024
    v_cvt_pk_f16_f32 v59, v108, v109
    v_mul_f32 v120, v120, v92
    v_mfma_f32_16x16x32_bf16 v[32:35], v[252:255], v[96:99], v[32:35]
    v_mul_f32 v121, v121, v92
    v_cvt_pk_f16_f32 v146, v120, v121
    v_mfma_f32_16x16x32_f16 v[100:103], v[0:3], v[64:67], v[204:207]
    v_mul_f32 v122, v122, v92
    v_mul_f32 v123, v123, v92
    v_mfma_f32_16x16x32_f16 v[100:103], v[2:5], v[152:155], v[100:103]
    ds_read_b128 v[112:115], v135 offset:1024
    v_cvt_pk_f16_f32 v147, v122, v123
    v_mfma_f32_16x16x32_f16 v[120:123], v[6:9], v[64:67], v[200:203]
    ds_read_b128 v[76:79], v139 offset:1536
    v_cvt_pk_bf16_f32 v156, v60, v61
    v_mfma_f32_16x16x32_f16 v[120:123], v[8:11], v[152:155], v[120:123]
    ds_read_b128 v[80:83], v138 offset:1536
    v_cvt_pk_bf16_f32 v157, v62, v63
    v_mfma_f32_16x16x32_f16 v[96:99], v[18:21], v[64:67], v[196:199]
    ds_read_b128 v[60:63], v139 offset:1664
    v_max3_f32 v104, v100, v101, v102
    v_mfma_f32_16x16x32_f16 v[96:99], v[20:23], v[152:155], v[96:99]
    s_nop 0
    ds_read_b128 v[72:75], v138 offset:1664
    v_max3_f32 v104, v104, v103, v120
    v_mfma_f32_16x16x32_f16 v[88:91], v[12:15], v[64:67], v[208:211]
    ds_read_b128 v[64:67], v139 offset:1792
    v_max3_f32 v104, v104, v121, v122
    v_mfma_f32_16x16x32_f16 v[88:91], v[14:17], v[152:155], v[88:91]
    s_waitcnt lgkmcnt(6)
    ds_read_b128 v[68:71], v138 offset:1792
    v_max3_f32 v104, v104, v123, v96
    v_mfma_f32_16x16x32_f16 v[106:109], v[48:51], v[0:3], v[208:211]
    v_max3_f32 v104, v104, v97, v98
    s_nop 0
    v_mfma_f32_16x16x32_f16 v[106:109], v[140:143], v[2:5], v[106:109]
    s_nop 0
    v_max3_f32 v104, v104, v99, v88
    v_mov_b32 v105, v104
    v_mfma_f32_16x16x32_f16 v[92:95], v[48:51], v[6:9], v[208:211]
    s_waitcnt lgkmcnt(6)
    buffer_load_dwordx4 v129, s[24:27], s56 offen nt lds
    v_mfma_f32_16x16x32_f16 v[92:95], v[140:143], v[8:11], v[92:95]
    v_permlane32_swap_b32 v105, v104
    v_mfma_f32_16x16x32_f16 v[84:87], v[48:51], v[18:21], v[208:211]
    v_max_f32 v104, v105, v104
    v_mov_b32 v105, v104
    v_mfma_f32_16x16x32_f16 v[84:87], v[140:143], v[20:23], v[84:87]
    s_nop 0
    v_permlane16_swap_b32 v105, v104
    v_mfma_f32_16x16x32_f16 v[90:93], v[48:51], v[12:15], v[208:211]
    v_max_f32 v104, v105, v104
    v_sub_f32 v100, v100, v104
    v_mfma_f32_16x16x32_f16 v[90:93], v[140:143], v[14:17], v[90:93]
    s_waitcnt lgkmcnt(1)
    v_sub_f32 v101, v101, v104
    v_sub_f32 v102, v102, v104
    v_mfma_f32_16x16x32_bf16 v[48:51], a[216:219], v[76:79], 0
    v_sub_f32 v103, v103, v104
    v_sub_f32 v120, v120, v104
    v_mfma_f32_16x16x32_bf16 v[48:51], a[220:223], v[80:83], v[48:51]
    buffer_store_dwordx4 v[112:115], v129, s[28:31], s60 offen sc1
    v_sub_f32 v121, v121, v104
    v_sub_f32 v122, v122, v104
    v_sub_f32 v123, v123, v104
    v_sub_f32 v96, v96, v104
    v_mfma_f32_16x16x32_bf16 v[48:51], a[224:227], v[60:63], v[48:51]
    s_add_u32 m0, s67, 2048
    v_sub_f32 v97, v97, v104
    v_sub_f32 v98, v98, v104
    v_mfma_f32_16x16x32_bf16 v[48:51], a[228:231], v[72:75], v[48:51]
    v_sub_f32 v99, v99, v104
    v_sub_f32 v88, v88, v104
    v_mfma_f32_16x16x32_bf16 v[48:51], a[232:235], v[64:67], v[48:51]
    s_waitcnt lgkmcnt(0)
    v_exp_f32 v100, v100
    v_mfma_f32_16x16x32_bf16 v[48:51], a[236:239], v[68:71], v[48:51]
    v_exp_f32 v101, v101
    v_exp_f32 v102, v102
    v_exp_f32 v103, v103
    v_cvt_pk_bf16_f32 v116, v100, v101
    v_cvt_pk_bf16_f32 v117, v102, v103
    v_exp_f32 v120, v120
    v_exp_f32 v121, v121
    v_exp_f32 v122, v122
    v_exp_f32 v123, v123
    v_cvt_pk_bf16_f32 v118, v120, v121
    v_cvt_pk_bf16_f32 v119, v122, v123
    v_exp_f32 v96, v96
    v_exp_f32 v97, v97
    v_exp_f32 v98, v98
    v_exp_f32 v99, v99
    v_cvt_pk_bf16_f32 v168, v96, v97
    v_cvt_pk_bf16_f32 v169, v98, v99
    v_exp_f32 v88, v88
    v_mov_b32_dpp v109, v95 quad_perm:[0,1,2,3] row_mask:0x2 bank_mask:0xf
    v_cvt_pk_bf16_f32 v170, v88, 0
    v_mfma_f32_16x16x32_bf16 v[120:123], v[220:223], v[116:119], 0
    v_mov_b32_dpp v109, v87 quad_perm:[0,1,2,3] row_mask:0x4 bank_mask:0xf
    v_mfma_f32_16x16x32_bf16 v[120:123], v[220:223], v[168:171], v[120:123]
    ds_read_b128 v[100:103], v135 offset:2048
    v_mov_b32_dpp v109, v93 quad_perm:[0,1,2,3] row_mask:0x8 bank_mask:0xf
    v_mfma_f32_16x16x32_bf16 v[112:115], v[24:27], v[116:119], 0
    s_nop 0
    v_mov_b32 v142, v109
    s_nop 0
    v_mfma_f32_16x16x32_bf16 v[112:115], v[164:167], v[168:171], v[112:115]
    s_nop 0
    v_rcp_f32 v120, v120
    v_mfma_f32_16x16x32_bf16 v[104:107], v[28:31], v[116:119], 0
    v_max_f32_dpp v142, v142, v142 row_ror:8 row_mask:0xf bank_mask:0xf
    s_nop 0
    v_mfma_f32_16x16x32_bf16 v[104:107], v[160:163], v[168:171], v[104:107]
    s_nop 0
    v_max_f32_dpp v142, v142, v142 row_ror:4 row_mask:0xf bank_mask:0xf
    v_mul_f32 v112, v112, v120
    v_mfma_f32_16x16x32_bf16 v[96:99], v[44:47], v[116:119], 0
    v_max_f32_dpp v142, v142, v142 row_ror:2 row_mask:0xf bank_mask:0xf
    v_mul_f32 v113, v113, v120
    v_mfma_f32_16x16x32_bf16 v[96:99], v[156:159], v[168:171], v[96:99]
    v_max_f32_dpp v142, v142, v142 row_ror:1 row_mask:0xf bank_mask:0xf
    v_mov_b32 v143, v142
    v_mfma_f32_16x16x32_f16 v[88:91], v[0:3], v[52:55], v[192:195]
    s_nop 0
    v_permlane32_swap_b32 v143, v142
    v_mfma_f32_16x16x32_f16 v[88:91], v[2:5], v[148:151], v[88:91]
    v_max_f32 v142, v143, v142
    v_mov_b32 v143, v142
    v_mfma_f32_16x16x32_f16 v[92:95], v[6:9], v[52:55], v[188:191]
    s_waitcnt lgkmcnt(0)
    buffer_load_dwordx4 v128, s[24:27], s56 offen nt lds
    v_cvt_pk_bf16_f32 v112, v112, v113
    v_mfma_f32_16x16x32_f16 v[92:95], v[8:11], v[148:151], v[92:95]
    v_permlane16_swap_b32 v143, v142
    v_mfma_f32_16x16x32_f16 v[84:87], v[18:21], v[52:55], v[184:187]
    v_max_f32 v142, v143, v142
    v_sub_f32 v109, v109, v142
    v_mfma_f32_16x16x32_f16 v[84:87], v[20:23], v[148:151], v[84:87]
    v_exp_f32 v109, v109
    v_mfma_f32_16x16x32_f16 v[116:119], v[12:15], v[52:55], v[208:211]
    v_cvt_pk_bf16_f32 v109, v109, v109
    v_mul_f32 v114, v114, v120
    v_mfma_f32_16x16x32_f16 v[116:119], v[14:17], v[148:151], v[116:119]
    s_mov_b32 s53, s47
    ds_write_b16 v125, v109
    v_mul_f32 v115, v115, v120
    v_cvt_pk_bf16_f32 v113, v114, v115
    s_mov_b32 s47, s46
    s_mov_b32 s46, s45
    ds_read_b128 v[52:55], v134
    v_mul_f32 v104, v104, v120
    v_mul_f32 v105, v105, v120
    v_cvt_pk_bf16_f32 v114, v104, v105
    s_add_u32 m0, s67, 3072
    s_mov_b32 s45, s44
    ds_read_b128 v[212:215], v134 offset:16
    v_mfma_f32_16x16x32_bf16 v[108:111], a[240:243], v[76:79], 0
    s_mov_b32 s44, s53
    buffer_store_dwordx4 v[100:103], v128, s[28:31], s60 offen sc1
    ds_write_b64 v137, v[112:113] offset:0
    v_mul_f32 v106, v106, v120
    v_mfma_f32_16x16x32_bf16 v[108:111], a[244:247], v[80:83], v[108:111]
    s_sub_u32 s48, s44, s46
    v_mul_f32 v107, v107, v120
    v_cvt_pk_bf16_f32 v115, v106, v107
    v_mfma_f32_16x16x32_bf16 v[108:111], a[248:251], v[60:63], v[108:111]
    ds_write_b64 v137, v[114:115] offset:8
    v_mfma_f32_16x16x32_bf16 v[108:111], a[252:255], v[72:75], v[108:111]
    v_mul_f32 v96, v96, v120
    v_mul_f32 v97, v97, v120
    v_mfma_f32_16x16x32_bf16 v[108:111], v[224:227], v[64:67], v[108:111]
    s_sub_u32 s49, s46, s45
    v_cvt_pk_bf16_f32 v168, v96, v97
    v_mul_f32 v98, v98, v120
    v_mfma_f32_16x16x32_bf16 v[108:111], v[228:231], v[68:71], v[108:111]
    s_waitcnt lgkmcnt(3)
    v_mul_f32 v99, v99, v120
    v_cvt_pk_bf16_f32 v169, v98, v99
    v_mfma_f32_16x16x32_bf16 v[104:107], v[52:55], v[24:27], 0
    s_waitcnt lgkmcnt(2)
    ds_write_b64 v136, v[168:169] offset:0
    v_max3_f32 v168, v88, v89, v90
    v_mfma_f32_16x16x32_bf16 v[104:107], v[212:215], v[164:167], v[104:107]
    v_max3_f32 v168, v168, v91, v92
    v_max3_f32 v168, v168, v93, v94
    v_mfma_f32_16x16x32_bf16 v[120:123], v[52:55], v[28:31], 0
    v_max3_f32 v168, v168, v95, v84
    v_max3_f32 v168, v168, v85, v86
    v_mfma_f32_16x16x32_bf16 v[120:123], v[212:215], v[160:163], v[120:123]
    v_max3_f32 v168, v168, v87, v117
    v_mov_b32 v169, v168
    v_mfma_f32_16x16x32_bf16 v[100:103], v[52:55], v[44:47], 0
    s_nop 0
    v_permlane32_swap_b32 v169, v168
    v_mfma_f32_16x16x32_bf16 v[100:103], v[212:215], v[156:159], v[100:103]
    v_max_f32 v168, v169, v168
    v_mov_b32 v169, v168
    v_mfma_f32_16x16x32_bf16 v[52:55], v[232:235], v[76:79], 0
    s_nop 0
    v_permlane16_swap_b32 v169, v168
    v_mfma_f32_16x16x32_bf16 v[52:55], v[236:239], v[80:83], v[52:55]
    v_max_f32 v168, v169, v168
    v_sub_f32 v88, v88, v168
    v_mfma_f32_16x16x32_bf16 v[52:55], v[240:243], v[60:63], v[52:55]
    v_sub_f32 v89, v89, v168
    v_sub_f32 v90, v90, v168
    v_mfma_f32_16x16x32_bf16 v[52:55], v[244:247], v[72:75], v[52:55]
    v_sub_f32 v91, v91, v168
    v_sub_f32 v92, v92, v168
    v_mfma_f32_16x16x32_bf16 v[52:55], v[248:251], v[64:67], v[52:55]
    v_sub_f32 v93, v93, v168
    v_sub_f32 v94, v94, v168
    v_mfma_f32_16x16x32_bf16 v[52:55], v[252:255], v[68:71], v[52:55]
    v_sub_f32 v95, v95, v168
    v_sub_f32 v84, v84, v168
    v_sub_f32 v85, v85, v168
    v_sub_f32 v86, v86, v168
    v_sub_f32 v87, v87, v168
    v_sub_f32 v117, v117, v168
    v_exp_f32 v88, v88
    v_exp_f32 v89, v89
    v_exp_f32 v90, v90
    v_exp_f32 v91, v91
    v_cvt_pk_bf16_f32 v76, v88, v89
    v_cvt_pk_bf16_f32 v77, v90, v91
    v_exp_f32 v92, v92
    v_exp_f32 v93, v93
    v_exp_f32 v94, v94
    v_exp_f32 v95, v95
    v_cvt_pk_bf16_f32 v78, v92, v93
    v_cvt_pk_bf16_f32 v79, v94, v95
    v_exp_f32 v84, v84
    v_exp_f32 v85, v85
    v_exp_f32 v86, v86
    v_exp_f32 v87, v87
    v_cvt_pk_bf16_f32 v168, v84, v85
    v_cvt_pk_bf16_f32 v169, v86, v87
    v_exp_f32 v117, v117
    v_mov_b32_dpp v107, v123 quad_perm:[0,1,2,3] row_mask:0x2 bank_mask:0xf
    v_cvt_pk_bf16_f32 v170, v117, 0
    v_mfma_f32_16x16x32_bf16 v[80:83], v[220:223], v[76:79], 0
    v_mov_b32_dpp v107, v103 quad_perm:[0,1,2,3] row_mask:0x4 bank_mask:0xf
    v_cvt_pk_bf16_f32 v107, v107, v107
    v_mfma_f32_16x16x32_bf16 v[80:83], v[220:223], v[168:171], v[80:83]
    ds_write_b16 v133, v107 offset:56
    v_mfma_f32_16x16x32_bf16 v[60:63], v[24:27], v[76:79], 0
    ds_read_b128 v[72:75], v135 offset:3072
    v_fma_f32 v154, v40, v40, s42
    v_mfma_f32_16x16x32_bf16 v[60:63], v[164:167], v[168:171], v[60:63]
    ds_read_b128 v[68:71], v139 offset:3072
    v_fmac_f32 v154, v41, v41
    v_mfma_f32_16x16x32_bf16 v[64:67], v[28:31], v[76:79], 0
    ds_read_b128 v[104:107], v138 offset:3072
    v_fmac_f32 v154, v42, v42
    v_mfma_f32_16x16x32_bf16 v[64:67], v[160:163], v[168:171], v[64:67]
    ds_read_b128 v[120:123], v139 offset:3200
    v_fmac_f32 v154, v43, v43
    v_mfma_f32_16x16x32_bf16 v[100:103], v[44:47], v[76:79], 0
    ds_read_b128 v[76:79], v138 offset:3200
    v_fmac_f32 v154, v36, v36
    v_mfma_f32_16x16x32_bf16 v[100:103], v[156:159], v[168:171], v[100:103]
    ds_read_b128 v[112:115], v139 offset:3328
    v_add_u32 v139, s48, v139
    v_mfma_f32_16x16x32_f16 v[96:99], v[0:3], v[56:59], v[180:183]
    ds_read_b128 v[82:85], v138 offset:3328
    v_add_u32 v138, s48, v138
    v_mfma_f32_16x16x32_f16 v[96:99], v[2:5], v[144:147], v[96:99]
    ds_read_b128 v[0:3], v135 offset:4096
    v_fmac_f32 v154, v37, v37
    v_mfma_f32_16x16x32_f16 v[88:91], v[6:9], v[56:59], v[176:179]
    v_rcp_f32 v80, v80
    v_mfma_f32_16x16x32_f16 v[88:91], v[8:11], v[144:147], v[88:91]
    s_waitcnt lgkmcnt(7)
    buffer_load_dwordx4 v127, s[24:27], s56 offen nt lds
    v_mul_f32 v60, v60, v80
    v_mfma_f32_16x16x32_f16 v[4:7], v[18:21], v[56:59], v[172:175]
    v_mul_f32 v61, v61, v80
    v_cvt_pk_bf16_f32 v8, v60, v61
    v_mfma_f32_16x16x32_f16 v[4:7], v[20:23], v[144:147], v[4:7]
    v_mul_f32 v62, v62, v80
    v_mul_f32 v63, v63, v80
    v_mfma_f32_16x16x32_f16 v[20:23], v[12:15], v[56:59], v[208:211]
    v_cvt_pk_bf16_f32 v9, v62, v63
    v_mul_f32 v64, v64, v80
    v_mfma_f32_16x16x32_f16 v[20:23], v[14:17], v[144:147], v[20:23]
    s_waitcnt lgkmcnt(3)
    ds_write_b64 v137, v[8:9] offset:1536
    v_mfma_f32_16x16x32_bf16 v[12:15], a[216:219], v[68:71], 0
    v_mul_f32 v65, v65, v80
    v_cvt_pk_bf16_f32 v10, v64, v65
    v_mfma_f32_16x16x32_bf16 v[12:15], a[220:223], v[104:107], v[12:15]
    v_mul_f32 v66, v66, v80
    v_mul_f32 v67, v67, v80
    v_mfma_f32_16x16x32_bf16 v[12:15], a[224:227], v[120:123], v[12:15]
    s_add_u32 m0, s67, 4096
    buffer_store_dwordx4 v[72:75], v127, s[28:31], s60 offen sc1
    v_cvt_pk_bf16_f32 v11, v66, v67
    v_mul_f32 v100, v100, v80
    v_mul_f32 v101, v101, v80
    v_cvt_pk_bf16_f32 v168, v100, v101
    v_mfma_f32_16x16x32_bf16 v[12:15], a[228:231], v[76:79], v[12:15]
    s_waitcnt lgkmcnt(1)
    ds_write_b64 v137, v[10:11] offset:1544
    v_mfma_f32_16x16x32_bf16 v[12:15], a[232:235], v[112:115], v[12:15]
    s_cmp_lg_u32 s5, -1
    v_mul_f32 v102, v102, v80
    v_mul_f32 v103, v103, v80
    v_mfma_f32_16x16x32_bf16 v[12:15], a[236:239], v[82:85], v[12:15]
    buffer_load_dwordx4 v126, s[24:27], s56 offen nt lds
    v_cvt_pk_bf16_f32 v169, v102, v103
    v_mfma_f32_16x16x32_bf16 v[16:19], a[240:243], v[68:71], 0
    ds_write_b64 v136, v[168:169] offset:1536
    v_mfma_f32_16x16x32_bf16 v[16:19], a[244:247], v[104:107], v[16:19]
    v_max3_f32 v155, v96, v97, v98
    v_max3_f32 v155, v155, v99, v88
    v_mfma_f32_16x16x32_bf16 v[16:19], a[248:251], v[120:123], v[16:19]
    v_max3_f32 v155, v155, v89, v90
    v_max3_f32 v155, v155, v91, v4
    v_mfma_f32_16x16x32_bf16 v[16:19], a[252:255], v[76:79], v[16:19]
    v_max3_f32 v155, v155, v5, v6
    v_max3_f32 v155, v155, v7, v22
    v_mfma_f32_16x16x32_bf16 v[16:19], v[224:227], v[112:115], v[16:19]
    v_mov_b32 v168, v155
    v_fmac_f32 v154, v38, v38
    v_mfma_f32_16x16x32_bf16 v[16:19], v[228:231], v[82:85], v[16:19]
    ds_read_b128 v[8:11], v139 offset:0
    v_fmac_f32 v154, v39, v39
    v_mfma_f32_16x16x32_bf16 v[56:59], v[232:235], v[68:71], 0
    buffer_store_dwordx4 v[0:3], v126, s[28:31], s60 offen sc1
    ds_read_b128 v[60:63], v138 offset:0
    v_permlane32_swap_b32 v168, v155
    v_max_f32 v155, v168, v155
    v_mfma_f32_16x16x32_bf16 v[56:59], v[236:239], v[104:107], v[56:59]
    ds_read_b128 v[0:3], v139 offset:128
    v_mov_b32 v168, v155
    v_mfma_f32_16x16x32_bf16 v[56:59], v[240:243], v[120:123], v[56:59]
    ds_read_b128 v[72:75], v138 offset:128
    v_fmac_f32 v154, v32, v32
    v_mfma_f32_16x16x32_bf16 v[56:59], v[244:247], v[76:79], v[56:59]
    ds_read_b128 v[76:79], v139 offset:256
    v_fmac_f32 v154, v33, v33
    v_mfma_f32_16x16x32_bf16 v[56:59], v[248:251], v[112:115], v[56:59]
    ds_read_b128 v[64:67], v138 offset:256
    v_fmac_f32 v154, v34, v34
    v_mfma_f32_16x16x32_bf16 v[56:59], v[252:255], v[82:85], v[56:59]
    v_permlane16_swap_b32 v168, v155
    v_max_f32 v155, v168, v155
    v_sub_f32 v96, v96, v155
    v_sub_f32 v97, v97, v155
    v_sub_f32 v98, v98, v155
    v_sub_f32 v99, v99, v155
    v_sub_f32 v88, v88, v155
    v_sub_f32 v89, v89, v155
    v_sub_f32 v90, v90, v155
    v_sub_f32 v91, v91, v155
    v_sub_f32 v4, v4, v155
    v_sub_f32 v5, v5, v155
    v_sub_f32 v6, v6, v155
    v_sub_f32 v7, v7, v155
    v_sub_f32 v22, v22, v155
    v_exp_f32 v96, v96
    v_exp_f32 v97, v97
    v_exp_f32 v98, v98
    v_exp_f32 v99, v99
    v_cvt_pk_bf16_f32 v80, v96, v97
    v_cvt_pk_bf16_f32 v81, v98, v99
    v_exp_f32 v88, v88
    v_exp_f32 v89, v89
    v_exp_f32 v90, v90
    v_exp_f32 v91, v91
    v_cvt_pk_bf16_f32 v82, v88, v89
    v_cvt_pk_bf16_f32 v83, v90, v91
    v_exp_f32 v4, v4
    v_exp_f32 v5, v5
    v_exp_f32 v6, v6
    v_exp_f32 v7, v7
    v_cvt_pk_bf16_f32 v168, v4, v5
    v_cvt_pk_bf16_f32 v169, v6, v7
    v_exp_f32 v22, v22
    v_fmac_f32 v154, v35, v35
    v_cvt_pk_bf16_f32 v170, v22, 0
    v_mfma_f32_16x16x32_bf16 v[4:7], v[220:223], v[80:83], 0
    v_fma_f32 v155, v48, v48, s42
    v_fmac_f32 v155, v49, v49
    v_mfma_f32_16x16x32_bf16 v[4:7], v[220:223], v[168:171], v[4:7]
    v_fmac_f32 v155, v50, v50
    v_fmac_f32 v155, v51, v51
    v_mfma_f32_16x16x32_bf16 v[20:23], v[24:27], v[80:83], 0
    s_nop 0
    v_fmac_f32 v155, v108, v108
    v_fmac_f32 v155, v109, v109
    v_mfma_f32_16x16x32_bf16 v[20:23], v[164:167], v[168:171], v[20:23]
    s_nop 0
    v_rcp_f32 v4, v4
    v_mfma_f32_16x16x32_bf16 v[24:27], v[28:31], v[80:83], 0
    s_nop 0
    v_fmac_f32 v155, v110, v110
    v_fmac_f32 v155, v111, v111
    v_mfma_f32_16x16x32_bf16 v[24:27], v[160:163], v[168:171], v[24:27]
    s_nop 0
    v_mul_f32 v20, v20, v4
    v_mul_f32 v21, v21, v4
    v_mfma_f32_16x16x32_bf16 v[28:31], v[44:47], v[80:83], 0
    v_cvt_pk_bf16_f32 v44, v20, v21
    v_mul_f32 v22, v22, v4
    v_mfma_f32_16x16x32_bf16 v[28:31], v[156:159], v[168:171], v[28:31]
    s_waitcnt lgkmcnt(0)
    v_mul_f32 v23, v23, v4
    v_cvt_pk_bf16_f32 v45, v22, v23
    v_mfma_f32_16x16x32_bf16 v[20:23], a[0:3], v[8:11], 0
    s_cbranch_scc1 L_loopS0
    ds_write_b64 v137, v[44:45] offset:3072
    v_mul_f32 v24, v24, v4
    v_mul_f32 v25, v25, v4
    v_cvt_pk_bf16_f32 v46, v24, v25
    v_mul_f32 v26, v26, v4
    v_mul_f32 v27, v27, v4
    v_cvt_pk_bf16_f32 v47, v26, v27
    v_mul_f32 v28, v28, v4
    v_mul_f32 v29, v29, v4
    v_cvt_pk_bf16_f32 v28, v28, v29
    v_mul_f32 v30, v30, v4
    v_mul_f32 v31, v31, v4
    v_cvt_pk_bf16_f32 v29, v30, v31
    s_mov_b32 s30, 100270464
    s_mul_i32 s89, s68, 5376
    ds_write_b64 v137, v[46:47] offset:3080
    v_fmac_f32 v155, v52, v52
    s_add_u32 s89, s89, 142336
    s_movk_i32 s90, 336
    ds_write_b64 v136, v[28:29] offset:3072
    v_fmac_f32 v155, v53, v53
    v_fmac_f32 v155, v54, v54
    v_fmac_f32 v155, v55, v55
    v_fma_f32 v125, v12, v12, s42
    v_fmac_f32 v125, v13, v13
    v_fmac_f32 v125, v14, v14
    v_fmac_f32 v125, v15, v15
    v_fmac_f32 v125, v16, v16
    v_fmac_f32 v125, v17, v17
    v_fmac_f32 v125, v18, v18
    v_fmac_f32 v125, v19, v19
    v_fmac_f32 v125, v56, v56
    v_fmac_f32 v125, v57, v57
    v_fmac_f32 v125, v58, v58
    v_fmac_f32 v125, v59, v59
    v_cvt_pk_bf16_f32 v0, v154, v155
    v_cvt_pk_bf16_f32 v1, v125, v124
    s_lshr_b32 s91, s64, 16
    s_sub_u32 s84, s45, s44
    ds_write_b64 v132, v[0:1]
    v_mbcnt_lo_u32_b32 v124, -1, 0
    v_mbcnt_hi_u32_b32 v124, -1, v124
    v_and_b32 v125, 15, v124
    v_lshrrev_b32 v124, 4, v124
    v_mul_u32_u24 v0, 80, v124
    v_add_u32 v0, s89, v0
    v_mad_u32_u24 v69, v125, s90, v0
    v_lshrrev_b32 v124, v125, s64
    v_and_b32 v124, 1, v124
    v_cmp_eq_u32 vcc, 1, v124
    v_mad_u32_u24 v23, v125, s90, v0
    v_lshrrev_b32 v68, v125, s91
    v_cndmask_b32 v69, v0, v69, vcc
    s_sub_u32 s85, s46, s45
    s_sub_u32 s86, s44, s45
    ds_read_b128 v[8:11], v69
    ds_read_b128 v[60:63], v69 offset:16
    v_and_b32 v68, 1, v68
    v_subrev_u32 v23, 21504, v23
    s_sub_u32 s93, s44, s47
    s_sub_u32 s94, s45, s47
    ds_read_b64 v[70:71], v69 offset:56
    ds_read_b128 v[72:75], v69 offset:64
    v_cmp_eq_u32 vcc, 1, v68
    v_add_u32 v3, s84, v139
    v_add_u32 v2, s84, v138
    v_cndmask_b32 v23, v0, v23, vcc
    v_add_u32 v44, s85, v137
    v_add_u32 v22, s85, v136
    v_add_u32 v133, s86, v137
    v_add_u32 v125, s86, v136
    v_add_u32 v124, s93, v135
    s_waitcnt lgkmcnt(4)
    s_barrier
    ds_read_b128 v[24:27], v131 offset:0
    ds_read_b128 v[4:7], v131 offset:1024
    v_add_u32 v134, s94, v135
    s_sub_u32 s95, s46, s47
    ds_read_b128 v[76:79], v3 offset:1536
    v_add_u32 v20, s95, v135
    v_mov_b32 v21, 0
    s_waitcnt lgkmcnt(6)
    v_mfma_f32_16x16x32_bf16 v[80:83], v[220:223], v[8:11], 0
    s_waitcnt lgkmcnt(5)
    s_lshl_b32 s92, s68, 10
    ds_read_b128 v[8:11], v3 offset:1664
    ds_read_b128 v[28:31], v3 offset:1792
    v_mfma_f32_16x16x32_bf16 v[80:83], v[220:223], v[60:63], v[80:83]
    s_waitcnt lgkmcnt(5)
    v_lshlrev_b32 v60, 16, v70
    v_and_b32 v70, 0xffff0000, v70
    v_lshlrev_b32 v61, 16, v71
    v_and_b32 v71, 0xffff0000, v71
    v_lshlrev_b32 v62, 16, v72
    v_and_b32 v72, 0xffff0000, v72
    v_lshlrev_b32 v63, 16, v73
    v_rcp_f32 v80, v80
    v_and_b32 v73, 0xffff0000, v73
    v_mul_f32 v60, v60, v80
    v_mul_f32 v70, v70, v80
    v_cvt_pk_bf16_f32 v60, v60, v70
    v_mul_f32 v61, v61, v80
    v_mul_f32 v71, v71, v80
    v_cvt_pk_bf16_f32 v61, v61, v71
    v_mul_f32 v62, v62, v80
    v_mul_f32 v72, v72, v80
    v_cvt_pk_bf16_f32 v62, v62, v72
    v_mul_f32 v63, v63, v80
    s_waitcnt lgkmcnt(3)
    v_mfma_f32_16x16x32_bf16 v[84:87], v[216:219], v[24:27], 0
    ds_read_b128 v[68:71], v2 offset:1536
    ds_read_b128 v[64:67], v2 offset:1664
    v_mfma_f32_16x16x32_bf16 v[84:87], v[216:219], v[4:7], v[84:87]
    s_waitcnt lgkmcnt(4)
    ds_read_b128 v[24:27], v2 offset:1792
    v_mul_f32 v73, v73, v80
    v_mfma_f32_16x16x32_bf16 v[4:7], a[216:219], v[76:79], 0
    v_cvt_pk_bf16_f32 v63, v63, v73
    v_lshlrev_b32 v135, 16, v74
    v_and_b32 v74, 0xffff0000, v74
    v_mul_f32 v135, v135, v80
    v_mul_f32 v74, v74, v80
    v_cvt_pk_bf16_f32 v46, v135, v74
    v_lshlrev_b32 v87, 16, v75
    v_and_b32 v75, 0xffff0000, v75
    v_mul_f32 v87, v87, v80
    v_mul_f32 v75, v75, v80
    v_cvt_pk_bf16_f32 v47, v87, v75
    v_rsq_f32 v84, v84
    v_rsq_f32 v85, v85
    v_mul_f32 v84, s43, v84
    v_mul_f32 v40, v40, v84
    v_mul_f32 v41, v41, v84
    v_cvt_pk_bf16_f32 v40, v40, v41
    v_mul_f32 v42, v42, v84
    v_mul_f32 v43, v43, v84
    v_cvt_pk_bf16_f32 v41, v42, v43
    v_mul_f32 v36, v36, v84
    v_mul_f32 v37, v37, v84
    v_cvt_pk_bf16_f32 v42, v36, v37
    v_mul_f32 v38, v38, v84
    v_mul_f32 v39, v39, v84
    s_waitcnt lgkmcnt(1)
    v_mfma_f32_16x16x32_bf16 v[4:7], a[220:223], v[68:71], v[4:7]
    ds_write_b128 v133, v[60:63] offset:0
    v_mfma_f32_16x16x32_bf16 v[4:7], a[224:227], v[8:11], v[4:7]
    v_cvt_pk_bf16_f32 v43, v38, v39
    v_mul_f32 v32, v32, v84
    v_mfma_f32_16x16x32_bf16 v[4:7], a[228:231], v[64:67], v[4:7]
    ds_write_b128 v44, v[40:43] offset:0
    v_mfma_f32_16x16x32_bf16 v[4:7], a[232:235], v[28:31], v[4:7]
    s_waitcnt lgkmcnt(2)
    v_mul_f32 v33, v33, v84
    v_cvt_pk_bf16_f32 v0, v32, v33
    v_mfma_f32_16x16x32_bf16 v[4:7], a[236:239], v[24:27], v[4:7]
    ds_write_b64 v125, v[46:47] offset:0
    v_mfma_f32_16x16x32_bf16 v[92:95], a[240:243], v[76:79], 0
    v_mul_f32 v34, v34, v84
    v_mul_f32 v35, v35, v84
    v_mfma_f32_16x16x32_bf16 v[92:95], a[244:247], v[68:71], v[92:95]
    ds_read_b128 v[96:99], v3 offset:0
    v_cvt_pk_bf16_f32 v1, v34, v35
    v_mfma_f32_16x16x32_bf16 v[92:95], a[248:251], v[8:11], v[92:95]
    ds_write_b64 v22, v[0:1] offset:0
    v_mfma_f32_16x16x32_bf16 v[92:95], a[252:255], v[64:67], v[92:95]
    v_mul_f32 v85, s43, v85
    v_mul_f32 v48, v48, v85
    v_mfma_f32_16x16x32_bf16 v[92:95], v[224:227], v[28:31], v[92:95]
    ds_read_b128 v[88:91], v2 offset:0
    v_mul_f32 v49, v49, v85
    v_mfma_f32_16x16x32_bf16 v[92:95], v[228:231], v[24:27], v[92:95]
    ds_read_b128 v[60:63], v3 offset:128
    v_cvt_pk_bf16_f32 v0, v48, v49
    v_mfma_f32_16x16x32_bf16 v[72:75], v[232:235], v[76:79], 0
    ds_read_b128 v[40:43], v2 offset:128
    v_mul_f32 v50, v50, v85
    v_mfma_f32_16x16x32_bf16 v[72:75], v[236:239], v[68:71], v[72:75]
    ds_read_b128 v[32:35], v3 offset:256
    v_mul_f32 v51, v51, v85
    v_mfma_f32_16x16x32_bf16 v[72:75], v[240:243], v[8:11], v[72:75]
    ds_read_b128 v[8:11], v2 offset:256
    v_cvt_pk_bf16_f32 v1, v50, v51
    v_mfma_f32_16x16x32_bf16 v[72:75], v[244:247], v[64:67], v[72:75]
    v_rsq_f32 v86, v86
    v_mfma_f32_16x16x32_bf16 v[72:75], v[248:251], v[28:31], v[72:75]
    v_mul_f32 v86, s43, v86
    v_mul_f32 v12, v12, v86
    v_mfma_f32_16x16x32_bf16 v[72:75], v[252:255], v[24:27], v[72:75]
    s_waitcnt lgkmcnt(5)
    v_mul_f32 v13, v13, v86
    v_cvt_pk_bf16_f32 v12, v12, v13
    v_mfma_f32_16x16x32_bf16 v[24:27], a[216:219], v[96:99], 0
    s_waitcnt lgkmcnt(4)
    v_mul_f32 v14, v14, v86
    v_mul_f32 v15, v15, v86
    v_cvt_pk_bf16_f32 v13, v14, v15
    v_mfma_f32_16x16x32_bf16 v[24:27], a[220:223], v[88:91], v[24:27]
    s_waitcnt lgkmcnt(3)
    ds_read_b128 v[80:83], v3 offset:3072
    ds_read_b128 v[76:79], v2 offset:3072
    v_mfma_f32_16x16x32_bf16 v[24:27], a[224:227], v[60:63], v[24:27]
    s_waitcnt lgkmcnt(4)
    ds_read_b128 v[68:71], v3 offset:3200
    v_mul_f32 v16, v16, v86
    v_mfma_f32_16x16x32_bf16 v[24:27], a[228:231], v[40:43], v[24:27]
    s_waitcnt lgkmcnt(4)
    ds_read_b128 v[64:67], v2 offset:3200
    v_mul_f32 v17, v17, v86
    v_mfma_f32_16x16x32_bf16 v[24:27], a[232:235], v[32:35], v[24:27]
    s_waitcnt lgkmcnt(4)
    ds_read_b128 v[48:51], v3 offset:3328
    v_cvt_pk_bf16_f32 v14, v16, v17
    v_mfma_f32_16x16x32_bf16 v[24:27], a[236:239], v[8:11], v[24:27]
    ds_read_b128 v[28:31], v2 offset:3328
    v_mul_f32 v18, v18, v86
    v_mfma_f32_16x16x32_bf16 v[36:39], a[240:243], v[96:99], 0
    v_mul_f32 v19, v19, v86
    v_cvt_pk_bf16_f32 v15, v18, v19
    v_mfma_f32_16x16x32_bf16 v[36:39], a[244:247], v[88:91], v[36:39]
    ds_write_b128 v44, v[12:15] offset:3072
    v_mfma_f32_16x16x32_bf16 v[36:39], a[248:251], v[60:63], v[36:39]
    v_mul_f32 v56, v56, v86
    v_mul_f32 v57, v57, v86
    v_mfma_f32_16x16x32_bf16 v[36:39], a[252:255], v[40:43], v[36:39]
    v_cvt_pk_bf16_f32 v2, v56, v57
    v_mul_f32 v58, v58, v86
    v_mfma_f32_16x16x32_bf16 v[36:39], v[224:227], v[32:35], v[36:39]
    v_mul_f32 v59, v59, v86
    v_cvt_pk_bf16_f32 v3, v58, v59
    v_mfma_f32_16x16x32_bf16 v[36:39], v[228:231], v[8:11], v[36:39]
    ds_write_b64 v22, v[2:3] offset:3072
    v_mfma_f32_16x16x32_bf16 v[16:19], v[232:235], v[96:99], 0
    v_fma_f32 v135, v24, v24, s42
    v_fmac_f32 v135, v25, v25
    v_mfma_f32_16x16x32_bf16 v[16:19], v[236:239], v[88:91], v[16:19]
    v_fmac_f32 v135, v26, v26
    v_fmac_f32 v135, v27, v27
    v_mfma_f32_16x16x32_bf16 v[16:19], v[240:243], v[60:63], v[16:19]
    v_fmac_f32 v135, v36, v36
    v_fmac_f32 v135, v37, v37
    v_mfma_f32_16x16x32_bf16 v[16:19], v[244:247], v[40:43], v[16:19]
    v_fmac_f32 v135, v38, v38
    v_fmac_f32 v135, v39, v39
    v_mfma_f32_16x16x32_bf16 v[16:19], v[248:251], v[32:35], v[16:19]
    v_mul_f32 v108, v108, v85
    v_mul_f32 v109, v109, v85
    v_mfma_f32_16x16x32_bf16 v[16:19], v[252:255], v[8:11], v[16:19]
    s_waitcnt lgkmcnt(1)
    v_cvt_pk_bf16_f32 v2, v108, v109
    v_mul_f32 v110, v110, v85
    v_mfma_f32_16x16x32_bf16 v[8:11], a[216:219], v[80:83], 0
    v_mul_f32 v111, v111, v85
    v_cvt_pk_bf16_f32 v3, v110, v111
    v_mfma_f32_16x16x32_bf16 v[8:11], a[220:223], v[76:79], v[8:11]
    ds_write_b128 v44, v[0:3] offset:1536
    v_mfma_f32_16x16x32_bf16 v[8:11], a[224:227], v[68:71], v[8:11]
    v_fmac_f32 v135, v16, v16
    v_fmac_f32 v135, v17, v17
    v_mfma_f32_16x16x32_bf16 v[8:11], a[228:231], v[64:67], v[8:11]
    ds_read_b128 v[32:35], v23
    v_fmac_f32 v135, v18, v18
    v_mfma_f32_16x16x32_bf16 v[8:11], a[232:235], v[48:51], v[8:11]
    ds_read_b128 v[0:3], v23 offset:16
    v_fmac_f32 v135, v19, v19
    v_mfma_f32_16x16x32_bf16 v[8:11], a[236:239], v[28:31], v[8:11]
    ds_read_b64 v[40:41], v23 offset:56
    ds_read_b128 v[42:45], v23 offset:64
    v_mfma_f32_16x16x32_bf16 v[60:63], a[240:243], v[80:83], 0
    v_mul_f32 v52, v52, v85
    v_mul_f32 v53, v53, v85
    v_mfma_f32_16x16x32_bf16 v[60:63], a[244:247], v[76:79], v[60:63]
    v_cvt_pk_bf16_f32 v46, v52, v53
    v_mul_f32 v54, v54, v85
    v_mfma_f32_16x16x32_bf16 v[60:63], a[248:251], v[68:71], v[60:63]
    v_mul_f32 v55, v55, v85
    v_cvt_pk_bf16_f32 v47, v54, v55
    v_mfma_f32_16x16x32_bf16 v[60:63], a[252:255], v[64:67], v[60:63]
    ds_write_b64 v22, v[46:47] offset:1536
    v_mfma_f32_16x16x32_bf16 v[60:63], v[224:227], v[48:51], v[60:63]
    v_fma_f32 v23, v8, v8, s42
    v_fmac_f32 v23, v9, v9
    v_mfma_f32_16x16x32_bf16 v[60:63], v[228:231], v[28:31], v[60:63]
    v_fmac_f32 v23, v10, v10
    v_fmac_f32 v23, v11, v11
    v_mfma_f32_16x16x32_bf16 v[12:15], v[232:235], v[80:83], 0
    s_nop 0
    v_fma_f32 v22, v4, v4, s42
    v_fmac_f32 v22, v5, v5
    v_mfma_f32_16x16x32_bf16 v[12:15], v[236:239], v[76:79], v[12:15]
    s_nop 0
    v_fmac_f32 v23, v60, v60
    v_fmac_f32 v23, v61, v61
    v_mfma_f32_16x16x32_bf16 v[12:15], v[240:243], v[68:71], v[12:15]
    v_fmac_f32 v23, v62, v62
    v_fmac_f32 v23, v63, v63
    v_mfma_f32_16x16x32_bf16 v[12:15], v[244:247], v[64:67], v[12:15]
    v_fmac_f32 v22, v6, v6
    v_fmac_f32 v22, v7, v7
    v_mfma_f32_16x16x32_bf16 v[12:15], v[248:251], v[48:51], v[12:15]
    v_fmac_f32 v22, v92, v92
    v_fmac_f32 v22, v93, v93
    v_mfma_f32_16x16x32_bf16 v[12:15], v[252:255], v[28:31], v[12:15]
    s_waitcnt lgkmcnt(0)
    v_fmac_f32 v22, v94, v94
    v_fmac_f32 v22, v95, v95
    v_mfma_f32_16x16x32_bf16 v[28:31], v[220:223], v[32:35], 0
    v_fmac_f32 v22, v72, v72
    v_fmac_f32 v22, v73, v73
    v_mfma_f32_16x16x32_bf16 v[28:31], v[220:223], v[0:3], v[28:31]
    s_nop 0
    v_fmac_f32 v23, v12, v12
    v_fmac_f32 v23, v13, v13
    v_fmac_f32 v23, v14, v14
    v_fmac_f32 v23, v15, v15
    v_cvt_pk_bf16_f32 v23, v23, v23
    v_fmac_f32 v22, v74, v74
    v_fmac_f32 v22, v75, v75
    v_cvt_pk_bf16_f32 v22, v135, v22
    ds_write_b64 v132, v[22:23] offset:2048
    v_rcp_f32 v28, v28
    v_lshlrev_b32 v135, 16, v40
    v_and_b32 v40, 0xffff0000, v40
    v_mul_f32 v135, v135, v28
    v_mul_f32 v40, v40, v28
    v_cvt_pk_bf16_f32 v0, v135, v40
    v_lshlrev_b32 v40, 16, v41
    v_and_b32 v41, 0xffff0000, v41
    v_mul_f32 v40, v40, v28
    v_mul_f32 v41, v41, v28
    v_cvt_pk_bf16_f32 v1, v40, v41
    v_lshlrev_b32 v135, 16, v42
    v_and_b32 v42, 0xffff0000, v42
    v_mul_f32 v135, v135, v28
    v_mul_f32 v42, v42, v28
    v_cvt_pk_bf16_f32 v2, v135, v42
    v_lshlrev_b32 v3, 16, v43
    v_and_b32 v43, 0xffff0000, v43
    v_mul_f32 v3, v3, v28
    v_mul_f32 v43, v43, v28
    v_cvt_pk_bf16_f32 v3, v3, v43
    v_lshlrev_b32 v135, 16, v44
    v_and_b32 v44, 0xffff0000, v44
    v_mul_f32 v135, v135, v28
    v_mul_f32 v44, v44, v28
    v_cvt_pk_bf16_f32 v22, v135, v44
    v_lshlrev_b32 v23, 16, v45
    v_and_b32 v45, 0xffff0000, v45
    v_mul_f32 v23, v23, v28
    v_mul_f32 v45, v45, v28
    v_cvt_pk_bf16_f32 v23, v23, v45
    s_waitcnt lgkmcnt(0)
    s_barrier
    ds_write_b128 v133, v[0:3] offset:1536
    v_add_u32 v135, s92, v131
    ds_write_b64 v125, v[22:23] offset:1536
    ds_read_b128 v[48:51], v131 offset:2048
    ds_read_b128 v[44:47], v131 offset:3072
    ds_read_b128 v[0:3], v20 offset:0
    ds_read_b128 v[40:43], v20 offset:1024
    ds_read_b128 v[104:107], v20 offset:2048
    ds_read_b128 v[100:103], v20 offset:3072
    ds_read_b128 v[28:31], v20 offset:4096
    s_waitcnt lgkmcnt(7)
    s_barrier
    s_waitcnt lgkmcnt(6)
    v_mfma_f32_16x16x32_bf16 v[32:35], v[216:219], v[48:51], 0
    s_waitcnt lgkmcnt(5)
    ds_read_b128 v[96:99], v139 offset:0
    ds_read_b128 v[88:91], v138 offset:0
    v_mfma_f32_16x16x32_bf16 v[32:35], v[216:219], v[44:47], v[32:35]
    s_waitcnt lgkmcnt(6)
    ds_read_b128 v[84:87], v139 offset:128
    s_nop 0
    buffer_store_dwordx4 v[0:3], v130, s[28:31], s59 offen sc1
    s_nop 0
    ds_read_b128 v[80:83], v138 offset:128
    s_nop 1
    v_rsq_f32 v32, v32
    ds_read_b128 v[76:79], v139 offset:256
    ds_read_b128 v[0:3], v138 offset:256
    v_mul_f32 v32, s43, v32
    v_mul_f32 v24, v24, v32
    v_mul_f32 v25, v25, v32
    ds_read_b128 v[68:71], v139 offset:1536
    s_waitcnt lgkmcnt(8)
    buffer_store_dwordx4 v[40:43], v129, s[28:31], s59 offen sc1
    ds_read_b128 v[64:67], v138 offset:1536
    v_cvt_pk_bf16_f32 v48, v24, v25
    v_mul_f32 v26, v26, v32
    v_mul_f32 v27, v27, v32
    v_cvt_pk_bf16_f32 v49, v26, v27
    v_mul_f32 v36, v36, v32
    ds_read_b128 v[56:59], v139 offset:1664
    ds_read_b128 v[52:55], v138 offset:1664
    v_mul_f32 v37, v37, v32
    s_waitcnt lgkmcnt(8)
    v_mfma_f32_16x16x32_bf16 v[24:27], a[216:219], v[96:99], 0
    ds_read_b128 v[44:47], v139 offset:1792
    v_cvt_pk_bf16_f32 v50, v36, v37
    v_mfma_f32_16x16x32_bf16 v[24:27], a[220:223], v[88:91], v[24:27]
    s_waitcnt lgkmcnt(7)
    ds_read_b128 v[40:43], v138 offset:1792
    v_mul_f32 v38, v38, v32
    v_mfma_f32_16x16x32_bf16 v[24:27], a[224:227], v[84:87], v[24:27]
    buffer_store_dwordx4 v[104:107], v128, s[28:31], s59 offen sc1
    v_mul_f32 v39, v39, v32
    v_cvt_pk_bf16_f32 v51, v38, v39
    v_mul_f32 v16, v16, v32
    v_mul_f32 v17, v17, v32
    v_mfma_f32_16x16x32_bf16 v[24:27], a[228:231], v[80:83], v[24:27]
    s_waitcnt lgkmcnt(6)
    v_cvt_pk_bf16_f32 v16, v16, v17
    v_mul_f32 v18, v18, v32
    v_mfma_f32_16x16x32_bf16 v[24:27], a[232:235], v[76:79], v[24:27]
    v_rsq_f32 v33, v33
    v_mfma_f32_16x16x32_bf16 v[24:27], a[236:239], v[0:3], v[24:27]
    s_nop 0
    v_mul_f32 v19, v19, v32
    v_cvt_pk_bf16_f32 v17, v18, v19
    v_mfma_f32_16x16x32_bf16 v[36:39], a[240:243], v[96:99], 0
    s_nop 0
    buffer_store_dwordx4 v[100:103], v127, s[28:31], s59 offen sc1
    v_mul_f32 v33, s43, v33
    v_mul_f32 v4, v4, v33
    v_fma_f32 v138, v24, v24, s42
    v_fmac_f32 v138, v25, v25
    v_mfma_f32_16x16x32_bf16 v[36:39], a[244:247], v[88:91], v[36:39]
    v_fmac_f32 v138, v26, v26
    v_fmac_f32 v138, v27, v27
    v_mfma_f32_16x16x32_bf16 v[36:39], a[248:251], v[84:87], v[36:39]
    v_mul_f32 v5, v5, v33
    v_cvt_pk_bf16_f32 v4, v4, v5
    v_mfma_f32_16x16x32_bf16 v[36:39], a[252:255], v[80:83], v[36:39]
    v_mul_f32 v6, v6, v33
    v_mul_f32 v7, v7, v33
    v_mfma_f32_16x16x32_bf16 v[36:39], v[224:227], v[76:79], v[36:39]
    buffer_store_dwordx4 v[28:31], v126, s[28:31], s59 offen sc1
    v_cvt_pk_bf16_f32 v5, v6, v7
    v_mul_f32 v92, v92, v33
    v_mul_f32 v93, v93, v33
    v_cvt_pk_bf16_f32 v6, v92, v93
    v_mfma_f32_16x16x32_bf16 v[36:39], v[228:231], v[0:3], v[36:39]
    v_mul_f32 v94, v94, v33
    v_mul_f32 v95, v95, v33
    v_mfma_f32_16x16x32_bf16 v[28:31], v[232:235], v[96:99], 0
    s_nop 0
    v_cvt_pk_bf16_f32 v7, v94, v95
    v_mul_f32 v72, v72, v33
    v_mfma_f32_16x16x32_bf16 v[28:31], v[236:239], v[88:91], v[28:31]
    s_nop 0
    v_fmac_f32 v138, v36, v36
    v_fmac_f32 v138, v37, v37
    v_mfma_f32_16x16x32_bf16 v[28:31], v[240:243], v[84:87], v[28:31]
    v_fmac_f32 v138, v38, v38
    v_fmac_f32 v138, v39, v39
    v_mfma_f32_16x16x32_bf16 v[28:31], v[244:247], v[80:83], v[28:31]
    v_mul_f32 v73, v73, v33
    v_cvt_pk_bf16_f32 v22, v72, v73
    v_mfma_f32_16x16x32_bf16 v[28:31], v[248:251], v[76:79], v[28:31]
    v_mul_f32 v74, v74, v33
    v_mul_f32 v75, v75, v33
    v_mfma_f32_16x16x32_bf16 v[28:31], v[252:255], v[0:3], v[28:31]
    s_waitcnt lgkmcnt(0)
    v_rsq_f32 v34, v34
    v_mfma_f32_16x16x32_bf16 v[0:3], a[216:219], v[68:71], 0
    v_cvt_pk_bf16_f32 v23, v74, v75
    v_mul_f32 v34, s43, v34
    v_mfma_f32_16x16x32_bf16 v[0:3], a[220:223], v[64:67], v[0:3]
    ds_write_b128 v137, v[48:51] offset:0
    v_mfma_f32_16x16x32_bf16 v[0:3], a[224:227], v[56:59], v[0:3]
    v_fmac_f32 v138, v28, v28
    v_fmac_f32 v138, v29, v29
    v_mfma_f32_16x16x32_bf16 v[0:3], a[228:231], v[52:55], v[0:3]
    ds_write_b64 v136, v[16:17] offset:0
    v_mfma_f32_16x16x32_bf16 v[0:3], a[232:235], v[44:47], v[0:3]
    v_fmac_f32 v138, v30, v30
    v_fmac_f32 v138, v31, v31
    v_mfma_f32_16x16x32_bf16 v[0:3], a[236:239], v[40:43], v[0:3]
    ds_write_b128 v137, v[4:7] offset:1536
    v_mfma_f32_16x16x32_bf16 v[16:19], a[240:243], v[68:71], 0
    v_mul_f32 v8, v8, v34
    v_mul_f32 v9, v9, v34
    v_mfma_f32_16x16x32_bf16 v[16:19], a[244:247], v[64:67], v[16:19]
    ds_write_b64 v136, v[22:23] offset:1536
    v_mfma_f32_16x16x32_bf16 v[16:19], a[248:251], v[56:59], v[16:19]
    v_cvt_pk_bf16_f32 v48, v8, v9
    v_mul_f32 v10, v10, v34
    v_mfma_f32_16x16x32_bf16 v[16:19], a[252:255], v[52:55], v[16:19]
    ds_read_b128 v[4:7], v135 offset:6144
    v_mul_f32 v11, v11, v34
    v_mfma_f32_16x16x32_bf16 v[16:19], v[224:227], v[44:47], v[16:19]
    v_cvt_pk_bf16_f32 v49, v10, v11
    v_mul_f32 v60, v60, v34
    v_mfma_f32_16x16x32_bf16 v[16:19], v[228:231], v[40:43], v[16:19]
    v_mul_f32 v61, v61, v34
    v_cvt_pk_bf16_f32 v50, v60, v61
    v_mfma_f32_16x16x32_bf16 v[8:11], v[232:235], v[68:71], 0
    v_mul_f32 v62, v62, v34
    v_mul_f32 v63, v63, v34
    v_mfma_f32_16x16x32_bf16 v[8:11], v[236:239], v[64:67], v[8:11]
    v_cvt_pk_bf16_f32 v51, v62, v63
    v_mul_f32 v12, v12, v34
    v_mfma_f32_16x16x32_bf16 v[8:11], v[240:243], v[56:59], v[8:11]
    ds_write_b128 v137, v[48:51] offset:3072
    v_mfma_f32_16x16x32_bf16 v[8:11], v[244:247], v[52:55], v[8:11]
    v_mul_f32 v13, v13, v34
    v_cvt_pk_bf16_f32 v22, v12, v13
    v_mfma_f32_16x16x32_bf16 v[8:11], v[248:251], v[44:47], v[8:11]
    v_mul_f32 v14, v14, v34
    v_mul_f32 v15, v15, v34
    v_mfma_f32_16x16x32_bf16 v[8:11], v[252:255], v[40:43], v[8:11]
    v_cvt_pk_bf16_f32 v23, v14, v15
    v_fma_f32 v135, v0, v0, s42
    v_fmac_f32 v135, v1, v1
    v_fmac_f32 v135, v2, v2
    ds_write_b64 v136, v[22:23] offset:3072
    v_fmac_f32 v135, v3, v3
    v_fmac_f32 v135, v16, v16
    v_fmac_f32 v135, v17, v17
    v_fmac_f32 v135, v18, v18
    v_fmac_f32 v135, v19, v19
    v_fmac_f32 v135, v8, v8
    v_fmac_f32 v135, v9, v9
    v_fmac_f32 v135, v10, v10
    v_fmac_f32 v135, v11, v11
    v_cvt_pk_bf16_f32 v20, v138, v135
    ds_write_b64 v132, v[20:21] offset:4096
    s_waitcnt lgkmcnt(2)
    v_lshrrev_b32 v132, 0, v7
    v_lshrrev_b32 v132, v132, s64
    v_and_b32 v132, 1, v132
    v_cmp_eq_u32 vcc, 1, v132
    v_lshrrev_b32 v132, 8, v7
    v_lshrrev_b32 v132, v132, s64
    v_cndmask_b32 v4, 2.0, v4, vcc
    v_and_b32 v132, 1, v132
    v_cmp_eq_u32 vcc, 1, v132
    v_lshrrev_b32 v7, 16, v7
    v_lshrrev_b32 v7, v7, s64
    v_cndmask_b32 v5, 2.0, v5, vcc
    v_and_b32 v7, 1, v7
    v_cmp_eq_u32 vcc, 1, v7
    s_nop 1
    v_cndmask_b32 v6, 2.0, v6, vcc
    s_waitcnt lgkmcnt(1)
    s_barrier
    ds_read_b128 v[52:55], v134 offset:0
    ds_read_b128 v[12:15], v134 offset:1024
    ds_read_b128 v[40:43], v134 offset:2048
    s_waitcnt lgkmcnt(3)
    s_barrier
    ds_read_b128 v[32:35], v134 offset:3072
    ds_read_b128 v[20:23], v134 offset:4096
    ds_read_b128 v[48:51], v131 offset:4096
    ds_read_b128 v[44:47], v131 offset:5120
    s_waitcnt lgkmcnt(6)
    buffer_store_dwordx4 v[52:55], v130, s[28:31], s58 offen sc1
    s_waitcnt lgkmcnt(1)
    buffer_store_dwordx4 v[12:15], v129, s[28:31], s58 offen sc1
    s_nop 1
    v_mfma_f32_16x16x32_bf16 v[12:15], v[216:219], v[48:51], 0
    s_waitcnt lgkmcnt(0)
    v_mfma_f32_16x16x32_bf16 v[12:15], v[216:219], v[44:47], v[12:15]
    s_nop 5
    buffer_store_dwordx4 v[40:43], v128, s[28:31], s58 offen sc1
    s_nop 0
    v_rsq_f32 v12, v12
    s_nop 0
    v_mul_f32 v12, s43, v12
    v_mul_f32 v24, v24, v12
    v_mul_f32 v25, v25, v12
    v_cvt_pk_bf16_f32 v24, v24, v25
    v_mul_f32 v26, v26, v12
    v_mul_f32 v27, v27, v12
    v_cvt_pk_bf16_f32 v25, v26, v27
    v_mul_f32 v36, v36, v12
    v_mul_f32 v37, v37, v12
    v_cvt_pk_bf16_f32 v26, v36, v37
    v_mul_f32 v38, v38, v12
    buffer_store_dwordx4 v[32:35], v127, s[28:31], s58 offen sc1
    v_mul_f32 v39, v39, v12
    v_cvt_pk_bf16_f32 v27, v38, v39
    v_mul_f32 v28, v28, v12
    v_mul_f32 v29, v29, v12
    v_cvt_pk_bf16_f32 v14, v28, v29
    v_mul_f32 v30, v30, v12
    v_mul_f32 v31, v31, v12
    v_cvt_pk_bf16_f32 v15, v30, v31
    ds_write_b128 v133, v[24:27] offset:0
    buffer_store_dwordx4 v[20:23], v126, s[28:31], s58 offen sc1
    v_rsq_f32 v13, v13
    s_nop 0
    v_mul_f32 v13, s43, v13
    v_mul_f32 v0, v0, v13
    v_mul_f32 v1, v1, v13
    ds_write_b64 v125, v[14:15] offset:0
    v_cvt_pk_bf16_f32 v0, v0, v1
    v_mul_f32 v2, v2, v13
    v_mul_f32 v3, v3, v13
    v_cvt_pk_bf16_f32 v1, v2, v3
    v_mul_f32 v16, v16, v13
    v_mul_f32 v17, v17, v13
    v_cvt_pk_bf16_f32 v2, v16, v17
    v_mul_f32 v18, v18, v13
    v_mul_f32 v19, v19, v13
    v_cvt_pk_bf16_f32 v3, v18, v19
    v_mul_f32 v8, v8, v13
    v_mul_f32 v9, v9, v13
    v_cvt_pk_bf16_f32 v126, v8, v9
    v_mul_f32 v10, v10, v13
    v_mul_f32 v11, v11, v13
    v_cvt_pk_bf16_f32 v127, v10, v11
    ds_write_b128 v133, v[0:3] offset:1536
    ds_write_b64 v125, v[126:127] offset:1536
    s_waitcnt lgkmcnt(0)
    s_barrier
    ds_read_b128 v[12:15], v124 offset:0
    ds_read_b128 v[8:11], v124 offset:1024
    ds_read_b128 v[0:3], v124 offset:2048
    s_waitcnt lgkmcnt(1)
    buffer_store_dwordx4 v[12:15], v4, s[28:31], 0 offen sc1
    buffer_store_dwordx4 v[8:11], v5, s[28:31], 0 offen sc1
    s_waitcnt lgkmcnt(0)
    buffer_store_dwordx4 v[0:3], v6, s[28:31], 0 offen sc1
    s_endpgm
L_bndF:
    s_movk_i32 s73, 24
    s_sub_u32 s70, s70, 20
    s_cmp_lt_u32 s2, 247
    s_cbranch_scc1 L_bndrF
    s_movk_i32 s73, 20
    s_movk_i32 s71, 18
    s_movk_i32 s70, -20
    s_mov_b32 s74, 0
    s_cmp_lt_u32 s2, 251
    s_cbranch_scc1 L_bndcF
    s_sub_u32 s94, s2, 251
    s_mul_i32 s69, s94, 18
    s_mov_b32 s74, 25239312
    s_sub_u32 s93, s93, 1373568
    v_cmp_le_u32 vcc, 4, v114
    v_add_u32 v28, 98896896, v130
    v_subrev_u32 v29, 1373568, v130
    v_cndmask_b32 v130, v28, v29, vcc
    v_cmp_le_u32 vcc, 4, v43
    v_add_u32 v28, 98896896, v129
    v_subrev_u32 v29, 1373568, v129
    v_cndmask_b32 v129, v28, v29, vcc
    v_cmp_le_u32 vcc, 4, v125
    v_add_u32 v28, 98896896, v128
    v_subrev_u32 v29, 1373568, v128
    v_cndmask_b32 v128, v28, v29, vcc
    v_cmp_le_u32 vcc, 4, v3
    v_add_u32 v28, 98896896, v127
    v_subrev_u32 v29, 1373568, v127
    v_cndmask_b32 v127, v28, v29, vcc
    v_cmp_le_u32 vcc, 4, v124
    v_add_u32 v28, 98896896, v126
    v_subrev_u32 v29, 1373568, v126
    v_cndmask_b32 v126, v28, v29, vcc
    s_cmp_lt_u32 s2, 255
    s_cbranch_scc1 L_bndrF
L_bndcF:
    s_sub_u32 s94, s2, 247
    s_mul_i32 s69, s94, 18
    s_mov_b32 s62, 1373568
    s_add_u32 s74, s74, 345744
    s_sub_u32 s93, s93, 2688
    v_mad_i32_i24 v28, v114, -7, v2
    v_cmp_le_u32 vcc, 4, v28
    v_add_u32 v28, 193536, v130
    v_subrev_u32 v29, 2688, v130
    v_cndmask_b32 v130, v28, v29, vcc
    v_mad_i32_i24 v28, v43, -7, v9
    v_cmp_le_u32 vcc, 4, v28
    v_add_u32 v28, 193536, v129
    v_subrev_u32 v29, 2688, v129
    v_cndmask_b32 v129, v28, v29, vcc
    v_mad_i32_i24 v28, v125, -7, v27
    v_cmp_le_u32 vcc, 4, v28
    v_add_u32 v28, 193536, v128
    v_subrev_u32 v29, 2688, v128
    v_cndmask_b32 v128, v28, v29, vcc
    v_mad_i32_i24 v28, v3, -7, v115
    v_cmp_le_u32 vcc, 4, v28
    v_add_u32 v28, 193536, v127
    v_subrev_u32 v29, 2688, v127
    v_cndmask_b32 v127, v28, v29, vcc
    v_mad_i32_i24 v28, v124, -7, v31
    v_cmp_le_u32 vcc, 4, v28
    v_add_u32 v28, 193536, v126
    v_subrev_u32 v29, 2688, v126
    v_cndmask_b32 v126, v28, v29, vcc
    s_cmp_eq_u32 s2, 255
    s_cselect_b32 s62, 0, s62
    s_cselect_b32 s69, 0, s69
    s_cselect_b32 s71, 2, s71
    s_branch L_bndrF
L_maskF:
    s_add_u32 s20, s20, s74
    s_addc_u32 s21, s21, 0
    s_mov_b32 s22, 4802
    s_mov_b32 s23, 0x20000
    s_mov_b32 s85, 0x3fb8aa3b
    s_waitcnt vmcnt(0)
    v_lshrrev_b32 v58, 2, v148
    v_add_u32 v58, 0, v58
    v_mul_u32_u24 v58, 98, v58
    v_mad_u32_u24 v59, v152, 24, v58
    buffer_load_ushort v144, v59, s[20:23], 0 offen offset:0
    buffer_load_ushort v143, v59, s[20:23], 0 offen offset:2
    buffer_load_ushort v153, v59, s[20:23], 0 offen offset:4
    buffer_load_ushort v29, v59, s[20:23], 0 offen offset:6
    buffer_load_ushort v39, v59, s[20:23], 0 offen offset:8
    buffer_load_ushort v149, v59, s[20:23], 0 offen offset:10
    buffer_load_ushort v91, v59, s[20:23], 0 offen offset:12
    buffer_load_ushort v37, v59, s[20:23], 0 offen offset:14
    buffer_load_ushort v89, v59, s[20:23], 0 offen offset:16
    buffer_load_ushort v145, v59, s[20:23], 0 offen offset:18
    buffer_load_ushort v88, v59, s[20:23], 0 offen offset:20
    buffer_load_ushort v31, v59, s[20:23], 0 offen offset:22
    buffer_load_ushort v30, v58, s[20:23], 0 offen offset:96
    s_waitcnt vmcnt(0)
    v_lshlrev_b32 v144, 16, v144
    v_fmac_f32 v204, s85, v144
    v_lshlrev_b32 v143, 16, v143
    v_fmac_f32 v205, s85, v143
    v_lshlrev_b32 v153, 16, v153
    v_fmac_f32 v206, s85, v153
    v_lshlrev_b32 v29, 16, v29
    v_fmac_f32 v207, s85, v29
    v_lshlrev_b32 v39, 16, v39
    v_fmac_f32 v200, s85, v39
    v_lshlrev_b32 v149, 16, v149
    v_fmac_f32 v201, s85, v149
    v_lshlrev_b32 v91, 16, v91
    v_fmac_f32 v202, s85, v91
    v_lshlrev_b32 v37, 16, v37
    v_fmac_f32 v203, s85, v37
    v_lshlrev_b32 v89, 16, v89
    v_fmac_f32 v196, s85, v89
    v_lshlrev_b32 v145, 16, v145
    v_fmac_f32 v197, s85, v145
    v_lshlrev_b32 v88, 16, v88
    v_fmac_f32 v198, s85, v88
    v_lshlrev_b32 v31, 16, v31
    v_fmac_f32 v199, s85, v31
    v_lshlrev_b32 v30, 16, v30
    v_fmac_f32 v208, s85, v30
    v_lshrrev_b32 v58, 2, v148
    v_add_u32 v58, 4, v58
    v_mul_u32_u24 v58, 98, v58
    v_mad_u32_u24 v59, v152, 24, v58
    buffer_load_ushort v144, v59, s[20:23], 0 offen offset:0
    buffer_load_ushort v143, v59, s[20:23], 0 offen offset:2
    buffer_load_ushort v153, v59, s[20:23], 0 offen offset:4
    buffer_load_ushort v29, v59, s[20:23], 0 offen offset:6
    buffer_load_ushort v39, v59, s[20:23], 0 offen offset:8
    buffer_load_ushort v149, v59, s[20:23], 0 offen offset:10
    buffer_load_ushort v91, v59, s[20:23], 0 offen offset:12
    buffer_load_ushort v37, v59, s[20:23], 0 offen offset:14
    buffer_load_ushort v89, v59, s[20:23], 0 offen offset:16
    buffer_load_ushort v145, v59, s[20:23], 0 offen offset:18
    buffer_load_ushort v88, v59, s[20:23], 0 offen offset:20
    buffer_load_ushort v31, v59, s[20:23], 0 offen offset:22
    buffer_load_ushort v30, v58, s[20:23], 0 offen offset:96
    s_waitcnt vmcnt(0)
    v_lshlrev_b32 v144, 16, v144
    v_fmac_f32 v192, s85, v144
    v_lshlrev_b32 v143, 16, v143
    v_fmac_f32 v193, s85, v143
    v_lshlrev_b32 v153, 16, v153
    v_fmac_f32 v194, s85, v153
    v_lshlrev_b32 v29, 16, v29
    v_fmac_f32 v195, s85, v29
    v_lshlrev_b32 v39, 16, v39
    v_fmac_f32 v188, s85, v39
    v_lshlrev_b32 v149, 16, v149
    v_fmac_f32 v189, s85, v149
    v_lshlrev_b32 v91, 16, v91
    v_fmac_f32 v190, s85, v91
    v_lshlrev_b32 v37, 16, v37
    v_fmac_f32 v191, s85, v37
    v_lshlrev_b32 v89, 16, v89
    v_fmac_f32 v184, s85, v89
    v_lshlrev_b32 v145, 16, v145
    v_fmac_f32 v185, s85, v145
    v_lshlrev_b32 v88, 16, v88
    v_fmac_f32 v186, s85, v88
    v_lshlrev_b32 v31, 16, v31
    v_fmac_f32 v187, s85, v31
    v_lshlrev_b32 v30, 16, v30
    v_fmac_f32 v209, s85, v30
    v_lshrrev_b32 v58, 2, v148
    v_add_u32 v58, 8, v58
    v_mul_u32_u24 v58, 98, v58
    v_mad_u32_u24 v59, v152, 24, v58
    buffer_load_ushort v144, v59, s[20:23], 0 offen offset:0
    buffer_load_ushort v143, v59, s[20:23], 0 offen offset:2
    buffer_load_ushort v153, v59, s[20:23], 0 offen offset:4
    buffer_load_ushort v29, v59, s[20:23], 0 offen offset:6
    buffer_load_ushort v39, v59, s[20:23], 0 offen offset:8
    buffer_load_ushort v149, v59, s[20:23], 0 offen offset:10
    buffer_load_ushort v91, v59, s[20:23], 0 offen offset:12
    buffer_load_ushort v37, v59, s[20:23], 0 offen offset:14
    buffer_load_ushort v89, v59, s[20:23], 0 offen offset:16
    buffer_load_ushort v145, v59, s[20:23], 0 offen offset:18
    buffer_load_ushort v88, v59, s[20:23], 0 offen offset:20
    buffer_load_ushort v31, v59, s[20:23], 0 offen offset:22
    buffer_load_ushort v30, v58, s[20:23], 0 offen offset:96
    s_waitcnt vmcnt(0)
    v_lshlrev_b32 v144, 16, v144
    v_fmac_f32 v180, s85, v144
    v_lshlrev_b32 v143, 16, v143
    v_fmac_f32 v181, s85, v143
    v_lshlrev_b32 v153, 16, v153
    v_fmac_f32 v182, s85, v153
    v_lshlrev_b32 v29, 16, v29
    v_fmac_f32 v183, s85, v29
    v_lshlrev_b32 v39, 16, v39
    v_fmac_f32 v176, s85, v39
    v_lshlrev_b32 v149, 16, v149
    v_fmac_f32 v177, s85, v149
    v_lshlrev_b32 v91, 16, v91
    v_fmac_f32 v178, s85, v91
    v_lshlrev_b32 v37, 16, v37
    v_fmac_f32 v179, s85, v37
    v_lshlrev_b32 v89, 16, v89
    v_fmac_f32 v172, s85, v89
    v_lshlrev_b32 v145, 16, v145
    v_fmac_f32 v173, s85, v145
    v_lshlrev_b32 v88, 16, v88
    v_fmac_f32 v174, s85, v88
    v_lshlrev_b32 v31, 16, v31
    v_fmac_f32 v175, s85, v31
    v_lshlrev_b32 v30, 16, v30
    v_fmac_f32 v210, s85, v30
    v_lshrrev_b32 v58, 2, v148
    v_lshl_add_u32 v58, v152, 2, v58
    v_cmp_gt_u32 vcc, 3, v152
    v_mov_b32 v59, 48
    s_nop 1
    v_cndmask_b32 v58, v59, v58, vcc
    v_add_u32 v58, 2352, v58
    v_lshlrev_b32 v58, 1, v58
    buffer_load_ushort v144, v58, s[20:23], 0 offen
    s_waitcnt vmcnt(0)
    v_lshlrev_b32 v144, 16, v144
    v_fmac_f32 v211, s85, v144
    s_branch L_nomaskF
L_atomF0:
    v_mov_b32 v124, 0x800000
    buffer_atomic_add v124, v131, s[8:11], 0 offen sc0 sc1
    s_branch L_atomrF0
L_bndS:
    s_movk_i32 s73, 24
    s_sub_u32 s70, s70, 20
    s_cmp_lt_u32 s2, 247
    s_cbranch_scc1 L_bndrS
    s_movk_i32 s73, 20
    s_movk_i32 s71, 18
    s_movk_i32 s70, -20
    s_mov_b32 s74, 0
    s_cmp_lt_u32 s2, 251
    s_cbranch_scc1 L_bndcS
    s_sub_u32 s94, s2, 251
    s_mul_i32 s69, s94, 18
    s_mov_b32 s74, 25239312
    s_sub_u32 s93, s93, 1373568
    v_cmp_le_u32 vcc, 4, v38
    v_add_u32 v148, 98896896, v130
    v_subrev_u32 v149, 1373568, v130
    v_cndmask_b32 v130, v148, v149, vcc
    v_cmp_le_u32 vcc, 4, v72
    v_add_u32 v148, 98896896, v129
    v_subrev_u32 v149, 1373568, v129
    v_cndmask_b32 v129, v148, v149, vcc
    v_cmp_le_u32 vcc, 4, v125
    v_add_u32 v148, 98896896, v128
    v_subrev_u32 v149, 1373568, v128
    v_cndmask_b32 v128, v148, v149, vcc
    v_cmp_le_u32 vcc, 4, v19
    v_add_u32 v148, 98896896, v127
    v_subrev_u32 v149, 1373568, v127
    v_cndmask_b32 v127, v148, v149, vcc
    v_cmp_le_u32 vcc, 4, v9
    v_add_u32 v148, 98896896, v126
    v_subrev_u32 v149, 1373568, v126
    v_cndmask_b32 v126, v148, v149, vcc
    s_cmp_lt_u32 s2, 255
    s_cbranch_scc1 L_bndrS
L_bndcS:
    s_sub_u32 s94, s2, 247
    s_mul_i32 s69, s94, 18
    s_mov_b32 s62, 1373568
    s_add_u32 s74, s74, 345744
    s_sub_u32 s93, s93, 2688
    v_mad_i32_i24 v148, v38, -7, v8
    v_cmp_le_u32 vcc, 4, v148
    v_add_u32 v148, 193536, v130
    v_subrev_u32 v149, 2688, v130
    v_cndmask_b32 v130, v148, v149, vcc
    v_mad_i32_i24 v148, v72, -7, v131
    v_cmp_le_u32 vcc, 4, v148
    v_add_u32 v148, 193536, v129
    v_subrev_u32 v149, 2688, v129
    v_cndmask_b32 v129, v148, v149, vcc
    v_mad_i32_i24 v148, v125, -7, v26
    v_cmp_le_u32 vcc, 4, v148
    v_add_u32 v148, 193536, v128
    v_subrev_u32 v149, 2688, v128
    v_cndmask_b32 v128, v148, v149, vcc
    v_mad_i32_i24 v148, v19, -7, v124
    v_cmp_le_u32 vcc, 4, v148
    v_add_u32 v148, 193536, v127
    v_subrev_u32 v149, 2688, v127
    v_cndmask_b32 v127, v148, v149, vcc
    v_mad_i32_i24 v148, v9, -7, v39
    v_cmp_le_u32 vcc, 4, v148
    v_add_u32 v148, 193536, v126
    v_subrev_u32 v149, 2688, v126
    v_cndmask_b32 v126, v148, v149, vcc
    s_cmp_eq_u32 s2, 255
    s_cselect_b32 s62, 0, s62
    s_cselect_b32 s69, 0, s69
    s_cselect_b32 s71, 2, s71
    s_branch L_bndrS
L_maskS:
    s_add_u32 s20, s20, s74
    s_addc_u32 s21, s21, 0
    s_mov_b32 s22, 4802
    s_mov_b32 s23, 0x20000
    s_mov_b32 s85, 0x3fb8aa3b
    s_waitcnt vmcnt(0)
    v_lshrrev_b32 v154, 2, v150
    v_add_u32 v154, 0, v154
    v_mul_u32_u24 v154, 98, v154
    v_mad_u32_u24 v155, v151, 24, v154
    buffer_load_ushort v41, v155, s[20:23], 0 offen offset:0
    buffer_load_ushort v142, v155, s[20:23], 0 offen offset:2
    buffer_load_ushort v160, v155, s[20:23], 0 offen offset:4
    buffer_load_ushort v156, v155, s[20:23], 0 offen offset:6
    buffer_load_ushort v168, v155, s[20:23], 0 offen offset:8
    buffer_load_ushort v166, v155, s[20:23], 0 offen offset:10
    buffer_load_ushort v143, v155, s[20:23], 0 offen offset:12
    buffer_load_ushort v164, v155, s[20:23], 0 offen offset:14
    buffer_load_ushort v161, v155, s[20:23], 0 offen offset:16
    buffer_load_ushort v158, v155, s[20:23], 0 offen offset:18
    buffer_load_ushort v162, v155, s[20:23], 0 offen offset:20
    buffer_load_ushort v165, v155, s[20:23], 0 offen offset:22
    buffer_load_ushort v157, v154, s[20:23], 0 offen offset:96
    s_waitcnt vmcnt(0)
    v_lshlrev_b32 v41, 16, v41
    v_fmac_f32 v204, s85, v41
    v_lshlrev_b32 v142, 16, v142
    v_fmac_f32 v205, s85, v142
    v_lshlrev_b32 v160, 16, v160
    v_fmac_f32 v206, s85, v160
    v_lshlrev_b32 v156, 16, v156
    v_fmac_f32 v207, s85, v156
    v_lshlrev_b32 v168, 16, v168
    v_fmac_f32 v200, s85, v168
    v_lshlrev_b32 v166, 16, v166
    v_fmac_f32 v201, s85, v166
    v_lshlrev_b32 v143, 16, v143
    v_fmac_f32 v202, s85, v143
    v_lshlrev_b32 v164, 16, v164
    v_fmac_f32 v203, s85, v164
    v_lshlrev_b32 v161, 16, v161
    v_fmac_f32 v196, s85, v161
    v_lshlrev_b32 v158, 16, v158
    v_fmac_f32 v197, s85, v158
    v_lshlrev_b32 v162, 16, v162
    v_fmac_f32 v198, s85, v162
    v_lshlrev_b32 v165, 16, v165
    v_fmac_f32 v199, s85, v165
    v_lshlrev_b32 v157, 16, v157
    v_fmac_f32 v208, s85, v157
    v_lshrrev_b32 v154, 2, v150
    v_add_u32 v154, 4, v154
    v_mul_u32_u24 v154, 98, v154
    v_mad_u32_u24 v155, v151, 24, v154
    buffer_load_ushort v41, v155, s[20:23], 0 offen offset:0
    buffer_load_ushort v142, v155, s[20:23], 0 offen offset:2
    buffer_load_ushort v160, v155, s[20:23], 0 offen offset:4
    buffer_load_ushort v156, v155, s[20:23], 0 offen offset:6
    buffer_load_ushort v168, v155, s[20:23], 0 offen offset:8
    buffer_load_ushort v166, v155, s[20:23], 0 offen offset:10
    buffer_load_ushort v143, v155, s[20:23], 0 offen offset:12
    buffer_load_ushort v164, v155, s[20:23], 0 offen offset:14
    buffer_load_ushort v161, v155, s[20:23], 0 offen offset:16
    buffer_load_ushort v158, v155, s[20:23], 0 offen offset:18
    buffer_load_ushort v162, v155, s[20:23], 0 offen offset:20
    buffer_load_ushort v165, v155, s[20:23], 0 offen offset:22
    buffer_load_ushort v157, v154, s[20:23], 0 offen offset:96
    s_waitcnt vmcnt(0)
    v_lshlrev_b32 v41, 16, v41
    v_fmac_f32 v192, s85, v41
    v_lshlrev_b32 v142, 16, v142
    v_fmac_f32 v193, s85, v142
    v_lshlrev_b32 v160, 16, v160
    v_fmac_f32 v194, s85, v160
    v_lshlrev_b32 v156, 16, v156
    v_fmac_f32 v195, s85, v156
    v_lshlrev_b32 v168, 16, v168
    v_fmac_f32 v188, s85, v168
    v_lshlrev_b32 v166, 16, v166
    v_fmac_f32 v189, s85, v166
    v_lshlrev_b32 v143, 16, v143
    v_fmac_f32 v190, s85, v143
    v_lshlrev_b32 v164, 16, v164
    v_fmac_f32 v191, s85, v164
    v_lshlrev_b32 v161, 16, v161
    v_fmac_f32 v184, s85, v161
    v_lshlrev_b32 v158, 16, v158
    v_fmac_f32 v185, s85, v158
    v_lshlrev_b32 v162, 16, v162
    v_fmac_f32 v186, s85, v162
    v_lshlrev_b32 v165, 16, v165
    v_fmac_f32 v187, s85, v165
    v_lshlrev_b32 v157, 16, v157
    v_fmac_f32 v209, s85, v157
    v_lshrrev_b32 v154, 2, v150
    v_add_u32 v154, 8, v154
    v_mul_u32_u24 v154, 98, v154
    v_mad_u32_u24 v155, v151, 24, v154
    buffer_load_ushort v41, v155, s[20:23], 0 offen offset:0
    buffer_load_ushort v142, v155, s[20:23], 0 offen offset:2
    buffer_load_ushort v160, v155, s[20:23], 0 offen offset:4
    buffer_load_ushort v156, v155, s[20:23], 0 offen offset:6
    buffer_load_ushort v168, v155, s[20:23], 0 offen offset:8
    buffer_load_ushort v166, v155, s[20:23], 0 offen offset:10
    buffer_load_ushort v143, v155, s[20:23], 0 offen offset:12
    buffer_load_ushort v164, v155, s[20:23], 0 offen offset:14
    buffer_load_ushort v161, v155, s[20:23], 0 offen offset:16
    buffer_load_ushort v158, v155, s[20:23], 0 offen offset:18
    buffer_load_ushort v162, v155, s[20:23], 0 offen offset:20
    buffer_load_ushort v165, v155, s[20:23], 0 offen offset:22
    buffer_load_ushort v157, v154, s[20:23], 0 offen offset:96
    s_waitcnt vmcnt(0)
    v_lshlrev_b32 v41, 16, v41
    v_fmac_f32 v180, s85, v41
    v_lshlrev_b32 v142, 16, v142
    v_fmac_f32 v181, s85, v142
    v_lshlrev_b32 v160, 16, v160
    v_fmac_f32 v182, s85, v160
    v_lshlrev_b32 v156, 16, v156
    v_fmac_f32 v183, s85, v156
    v_lshlrev_b32 v168, 16, v168
    v_fmac_f32 v176, s85, v168
    v_lshlrev_b32 v166, 16, v166
    v_fmac_f32 v177, s85, v166
    v_lshlrev_b32 v143, 16, v143
    v_fmac_f32 v178, s85, v143
    v_lshlrev_b32 v164, 16, v164
    v_fmac_f32 v179, s85, v164
    v_lshlrev_b32 v161, 16, v161
    v_fmac_f32 v172, s85, v161
    v_lshlrev_b32 v158, 16, v158
    v_fmac_f32 v173, s85, v158
    v_lshlrev_b32 v162, 16, v162
    v_fmac_f32 v174, s85, v162
    v_lshlrev_b32 v165, 16, v165
    v_fmac_f32 v175, s85, v165
    v_lshlrev_b32 v157, 16, v157
    v_fmac_f32 v210, s85, v157
    v_lshrrev_b32 v154, 2, v150
    v_lshl_add_u32 v154, v151, 2, v154
    v_cmp_gt_u32 vcc, 3, v151
    v_mov_b32 v155, 48
    s_nop 1
    v_cndmask_b32 v154, v155, v154, vcc
    v_add_u32 v154, 2352, v154
    v_lshlrev_b32 v154, 1, v154
    buffer_load_ushort v41, v154, s[20:23], 0 offen
    s_waitcnt vmcnt(0)
    v_lshlrev_b32 v41, 16, v41
    v_fmac_f32 v211, s85, v41
    s_branch L_nomaskS
L_atomS0:
    v_mov_b32 v124, 0x800000
    buffer_atomic_add v124, v131, s[8:11], 0 offen sc0 sc1
    s_branch L_atomrS0
.section .rodata,"a"
.p2align 6
.amdhsa_kernel standalone__window_attn_swin_v2__vision_kernel
  .amdhsa_next_free_vgpr 512
  .amdhsa_next_free_sgpr 102
  .amdhsa_accum_offset 256
  .amdhsa_group_segment_fixed_size 0
  .amdhsa_kernarg_size 96
  .amdhsa_user_sgpr_count 2
  .amdhsa_user_sgpr_kernarg_segment_ptr 1
  .amdhsa_system_sgpr_workgroup_id_x 1
.end_amdhsa_kernel
```

```asm
; @launch grid=(256,1,1) block=(256,1,1) lds=163840
.amdgcn_target "amdgcn-amd-amdhsa--gfx950"
.text
.globl standalone__window_attn_swin_v2__vision_kernel
.p2align 8
.type standalone__window_attn_swin_v2__vision_kernel,@function
standalone__window_attn_swin_v2__vision_kernel:
    v_lshrrev_b32 v0, 6, v0
    s_cmp_ge_u32 s2, 256
    s_cbranch_scc1 L_end
    v_readfirstlane_b32 s68, v0
    s_mov_b32 s64, 0
    s_nop 0
    v_mbcnt_lo_u32_b32 v29, -1, 0
    v_mbcnt_hi_u32_b32 v29, -1, v29
    s_load_dwordx16 s[4:19], s[0:1], 0
    s_load_dwordx4 s[20:23], s[0:1], 64
    s_load_dwordx2 s[38:39], s[0:1], 80
    s_lshr_b32 s88, s2, 3
    s_lshl2_add_u32 s88, s88, s68
    v_lshlrev_b32 v0, 7, v29
    s_getpc_b64 s[80:81]
    s_lshl_b32 s84, s88, 8
    v_and_b32 v1, 128, v0
    v_add_u32 v1, s84, v1
    v_min_u32 v1, L_slow-standalone__window_attn_swin_v2__vision_kernel-256, v1
    s_mul_i32 s89, s88, 576
    s_mul_i32 s88, s88, 1728
    global_load_dword a255, v1, s[80:81]
    v_min_u32 v1, 1664, v0
    v_min_u32 v3, 512, v0
    s_mov_b32 s34, 221184
    s_mov_b32 s35, 0x20000
    s_mov_b32 s78, 73728
    s_mov_b32 s79, 0x20000
    v_and_b32 v109, 15, v29
    v_lshrrev_b32 v144, 4, v29
    v_lshrrev_b32 v9, 2, v109
    v_and_b32 v8, 3, v109
    s_mul_i32 s87, s68, 192
    v_mad_u32_u24 v2, v109, 12, s87
    v_lshlrev_b32 v0, 1, v109
    v_lshlrev_b32 v19, 1, v9
    v_lshl_add_u32 v19, v144, 5, v19
    s_movk_i32 s86, 384
    s_mov_b32 s26, 100270464
    s_mov_b32 s27, 0x20000
    s_mov_b32 s30, 0
    s_mov_b32 s31, 0x20000
    s_waitcnt lgkmcnt(0)
    s_mov_b32 s24, s4
    s_mov_b32 s25, s5
    s_mov_b32 s32, s6
    s_mov_b32 s33, s7
    s_mov_b32 s76, s8
    s_mov_b32 s77, s9
    buffer_load_dword a254, v1, s[32:35], s88 offen
    buffer_load_dword a253, v3, s[76:79], s89 offen
    s_load_dwordx2 s[82:83], s[10:11], 0
    s_movk_i32 s18, 676
    s_mov_b32 s19, 0x20000
    buffer_load_dwordx3 v[16:18], v2, s[16:19], 0 offen
    s_mul_i32 s96, s68, 288
    s_and_b32 s97, s68, 1
    s_lshl_b32 s97, s97, 2
    s_mov_b32 s98, 193536
    s_mov_b32 s99, 589824
    global_load_ushort v32, v0, s[12:13]
    v_add_u32 v115, s96, v29
    v_mul_u32_u24 v11, 2731, v115
    v_mul_u32_u24 v10, 6242, v115
    v_lshrrev_b32 v11, 16, v11
    v_lshrrev_b32 v10, 20, v10
    s_lshr_b32 s94, s2, 3
    s_mul_i32 s70, s94, 168
    global_load_ushort v33, v0, s[12:13] offset:32
    v_and_or_b32 v112, v11, 3, s97
    v_xor_b32 v112, v115, v112
    v_lshl_add_u32 v130, v112, 4, s99
    v_mad_u32_u24 v130, v10, s98, v130
    v_add_u32 v31, 64, v115
    s_mul_i32 s69, s2, 20
    s_lshl3_add_u32 s69, s94, s69
    global_load_ushort v124, v19, s[14:15] offset:0
    v_mul_u32_u24 v113, 2731, v31
    v_mul_u32_u24 v131, 6242, v31
    v_lshrrev_b32 v113, 16, v113
    v_lshrrev_b32 v131, 20, v131
    v_and_or_b32 v30, v113, 3, s97
    s_add_u32 s70, s70, 140
    s_movk_i32 s62, 2688
    global_load_ushort v28, v19, s[14:15] offset:8
    v_xor_b32 v30, v31, v30
    v_lshl_add_u32 v129, v30, 4, s99
    v_mad_u32_u24 v129, v131, s98, v129
    v_add_u32 v128, 128, v115
    v_mul_u32_u24 v31, 2731, v128
    s_movk_i32 s71, 20
    s_movk_i32 s73, 28
    global_load_ushort v125, v19, s[14:15] offset:16
    v_mul_u32_u24 v3, 6242, v128
    v_lshrrev_b32 v31, 16, v31
    v_lshrrev_b32 v3, 20, v3
    v_and_or_b32 v114, v31, 3, s97
    v_xor_b32 v114, v128, v114
    s_mov_b32 s93, 1769472
    s_mul_i32 s54, s68, 5120
    global_load_ushort v19, v19, s[14:15] offset:24
    v_lshl_add_u32 v128, v114, 4, s99
    v_mad_u32_u24 v128, v3, s98, v128
    v_add_u32 v35, 192, v115
    v_mul_u32_u24 v1, 2731, v35
    v_mul_u32_u24 v0, 6242, v35
    v_lshrrev_b32 v1, 16, v1
    v_lshrrev_b32 v0, 20, v0
    v_and_or_b32 v34, v1, 3, s97
    v_xor_b32 v34, v35, v34
    v_lshl_add_u32 v127, v34, 4, s99
    v_mad_u32_u24 v127, v0, s98, v127
    v_add_u32 v126, 256, v115
    v_mul_u32_u24 v108, 2731, v126
    v_mul_u32_u24 v115, 6242, v126
    v_lshrrev_b32 v108, 16, v108
    v_lshrrev_b32 v115, 20, v115
    v_and_or_b32 v34, v108, 3, s97
    v_xor_b32 v34, v126, v34
    v_lshl_add_u32 v126, v34, 4, s99
    v_mad_u32_u24 v126, v115, s98, v126
    s_cmp_ge_u32 s2, 240
    s_cbranch_scc1 L_bndF
L_bndrF:
    s_mov_b32 s63, 1180032
    s_mul_i32 s94, s69, 58255
    s_lshr_b32 s94, s94, 22
    s_mul_i32 s94, s94, s63
    s_mul_i32 s72, s69, s62
    s_add_u32 s72, s72, s94
    v_lshl_or_b32 v108, v29, 4, 2.0
    s_sub_u32 s94, s73, 1
    s_max_u32 s94, s94, 20
    s_mul_i32 s95, s68, -44
    s_movk_i32 s99, -24
    s_add_u32 m0, s54, 0
    v_and_b32 v115, -4, v31
    s_mul_i32 s85, s68, 96
    s_sub_u32 s100, s85, 1024
    buffer_load_dwordx4 v130, s[24:27], s72 offen nt lds
    s_add_u32 m0, s54, 1024
    v_mad_u32_u24 v10, v115, 3, v31
    v_add_u32 v10, s95, v10
    v_mad_i32_i24 v114, v31, s99, v114
    v_med3_u32 v115, v10, 20, s94
    v_add_u32 v115, s70, v115
    v_add_u32 v31, s69, v10
    s_sub_u32 s87, s85, 2048
    s_movk_i32 s91, 1152
    buffer_load_dwordx4 v129, s[24:27], s72 offen nt lds
    v_cmp_gt_u32 vcc, s71, v10
    v_lshl_add_u32 v114, v114, 4, s93
    s_add_u32 m0, s54, 43008
    v_cndmask_b32 v31, v115, v31, vcc
    v_mul_u32_u24 v115, 58255, v31
    v_mad_u32_u24 v114, v31, s62, v114
    v_lshrrev_b32 v115, 22, v115
    v_mad_u32_u24 v114, v115, s63, v114
    s_mul_i32 s90, s68, 3072
    s_add_u32 s90, s90, 61440
    buffer_load_dwordx4 v114, s[24:27], 0 offen  lds
    v_lshlrev_b32 v115, 16, v10
    s_add_u32 m0, s54, 2048
    v_and_b32 v131, -4, v113
    v_mad_u32_u24 v10, v131, 3, v113
    v_add_u32 v10, s95, v10
    v_mad_i32_i24 v113, v113, s99, v30
    v_med3_u32 v131, v10, 20, s94
    s_add_u32 s101, s54, 44032
    s_mov_b32 s28, s22
    buffer_load_dwordx4 v128, s[24:27], s72 offen nt lds
    v_add_u32 v131, s70, v131
    v_add_u32 v30, s69, v10
    v_cmp_gt_u32 vcc, s71, v10
    v_lshl_add_u32 v113, v113, 4, s93
    s_add_u32 m0, s54, 41984
    v_cndmask_b32 v30, v131, v30, vcc
    v_mul_u32_u24 v131, 58255, v30
    v_mad_u32_u24 v113, v30, s62, v113
    v_lshrrev_b32 v131, 22, v131
    v_mad_u32_u24 v113, v131, s63, v113
    s_mov_b32 s29, s23
    s_mov_b32 s41, 0x2a8cbccc
    buffer_load_dwordx4 v113, s[24:27], 0 offen  lds
    v_lshl_or_b32 v115, v10, 8, v115
    s_add_u32 m0, s54, 3072
    v_cmp_gt_u32 vcc, 32, v29
    v_and_b32 v10, -4, v11
    v_mad_u32_u24 v131, v10, 3, v11
    v_cndmask_b32 v126, v108, v126, vcc
    v_add_u32 v131, s95, v131
    s_mov_b32 s42, 0x38fba882
    s_mov_b32 s43, 0x415db3d7
    buffer_load_dwordx4 v127, s[24:27], s72 offen nt lds
    s_add_u32 m0, s54, 4096
    v_mad_i32_i24 v112, v11, s99, v112
    v_med3_u32 v10, v131, 20, s94
    v_add_u32 v10, s70, v10
    v_add_u32 v11, s69, v131
    v_cmp_gt_u32 vcc, s71, v131
    v_lshl_add_u32 v112, v112, 4, s93
    s_mul_i32 s93, s68, 6
    s_lshl_b32 s94, s97, 1
    buffer_load_dwordx4 v126, s[24:27], s72 offen nt lds
    v_cndmask_b32 v11, v10, v11, vcc
    v_mul_u32_u24 v10, 58255, v11
    v_mad_u32_u24 v112, v11, s62, v112
    v_lshrrev_b32 v10, 22, v10
    v_mad_u32_u24 v112, v10, s63, v112
    s_add_u32 m0, s54, 40960
    v_lshl_or_b32 v115, v131, 0, v115
    s_mov_b32 s44, 61440
    s_mov_b32 s45, 40960
    buffer_load_dwordx4 v112, s[24:27], 0 offen nt lds
    v_mul_u32_u24 v10, 10923, v29
    v_lshrrev_b32 v141, 17, v10
    v_lshrrev_b32 v10, 16, v10
    v_mad_i32_i24 v111, v10, -6, v29
    v_bitop3_b32 v141, v141, v10, 4 bitop3:0x28
    v_lshl_add_u32 v111, v111, 4, s85
    v_mul_u32_u24 v141, 3, v141
    v_xor_b32 v10, v10, v141
    v_mad_u32_u24 v141, v10, s91, v111
    v_add_u32 v11, 64, v29
    v_mul_u32_u24 v131, 10923, v11
    v_lshrrev_b32 v41, 17, v131
    v_lshrrev_b32 v131, 16, v131
    v_mad_i32_i24 v30, v131, -6, v11
    v_bitop3_b32 v41, v41, v131, 4 bitop3:0x28
    v_lshl_add_u32 v30, v30, 4, s100
    v_mul_u32_u24 v41, 3, v41
    v_xor_b32 v131, v131, v41
    v_mad_u32_u24 v41, v131, s91, v30
    v_add_u32 v31, 128, v29
    v_mul_u32_u24 v11, 10923, v31
    v_lshrrev_b32 v26, 17, v11
    v_lshrrev_b32 v11, 16, v11
    v_mad_i32_i24 v110, v11, -6, v31
    v_bitop3_b32 v26, v26, v11, 4 bitop3:0x28
    v_lshl_add_u32 v110, v110, 4, s87
    v_mul_u32_u24 v26, 3, v26
    v_xor_b32 v11, v11, v26
    v_mad_u32_u24 v26, v11, s91, v110
    v_mad_u32_u24 v62, v10, s86, v111
    v_mad_u32_u24 v111, v131, s86, v30
    v_mad_u32_u24 v63, v11, s86, v110
    s_add_u32 m0, s90, 0
    s_mov_b32 s92, 0
    buffer_load_dwordx4 v141, s[32:35], s92 offen offset:0 lds
    v_lshrrev_b32 v131, 1, v144
    v_lshl_add_u32 v110, v144, 2, v9
    v_lshl_add_u32 v110, v131, 3, v110
    v_mul_u32_u24 v110, 96, v110
    v_add_u32 v110, s90, v110
    v_lshl_add_u32 v1, v8, 4, v110
    v_lshl_add_u32 v0, v8, 3, v110
    v_mov_b32 v3, 0x3f803f80
    v_cmp_eq_u32 vcc, 0, v8
    v_and_b32 v110, 1, v29
    v_lshlrev_b32 v110, 4, v110
    v_cndmask_b32 v220, 0, v3, vcc
    v_cndmask_b32 v221, 0, v3, vcc
    v_cndmask_b32 v222, 0, v3, vcc
    v_cndmask_b32 v223, 0, v3, vcc
    v_mov_b32 v3, 0x3f80
    v_lshlrev_b32 v3, v110, v3
    v_cmp_gt_u32 vcc, 2, v8
    v_mov_b32 v40, 0x44004400
    v_mul_u32_u24 v42, 48, v9
    v_cndmask_b32 v216, 0, v3, vcc
    v_cndmask_b32 v218, 0, v3, vcc
    v_cmp_le_u32 vcc, 2, v8
    v_lshl_add_u32 v42, v8, 2, v42
    v_mul_u32_u24 v43, 48, v144
    v_cndmask_b32 v217, 0, v3, vcc
    v_cndmask_b32 v219, 0, v3, vcc
    v_cmp_eq_u32 vcc, v144, v9
    v_add_u32 v143, 0, v42
    v_mul_u32_u24 v3, 37, v143
    v_cndmask_b32 v10, 0, v216, vcc
    v_cndmask_b32 v11, 0, v217, vcc
    v_cmp_eq_u32 vcc, 0, v8
    v_lshrrev_b32 v3, 10, v3
    v_mad_u32_u24 v143, v3, 24, v143
    v_cndmask_b32 v212, 0, v40, vcc
    v_cmp_eq_u32 vcc, 1, v8
    v_add_u32 v143, s101, v143
    v_add_u32 v187, 16, v42
    v_cndmask_b32 v213, 0, v40, vcc
    v_cmp_eq_u32 vcc, 2, v8
    v_mul_u32_u24 v3, 37, v187
    v_lshrrev_b32 v3, 10, v3
    v_cndmask_b32 v214, 0, v40, vcc
    v_cmp_eq_u32 vcc, 3, v8
    v_mad_u32_u24 v187, v3, 24, v187
    v_add_u32 v187, s101, v187
    v_cndmask_b32 v215, 0, v40, vcc
    v_add_u32 v69, 32, v42
    v_mul_u32_u24 v3, 37, v69
    v_lshrrev_b32 v3, 10, v3
    v_mad_u32_u24 v69, v3, 24, v69
    v_add_u32 v69, s101, v69
    v_add_u32 v68, 0, v43
    v_mul_u32_u24 v3, 37, v68
    v_lshrrev_b32 v3, 10, v3
    v_mad_u32_u24 v68, v3, 24, v68
    v_add_u32 v61, 4, v43
    v_mul_u32_u24 v3, 37, v61
    v_lshrrev_b32 v3, 10, v3
    v_mad_u32_u24 v61, v3, 24, v61
    v_add_u32 v200, 8, v43
    v_mul_u32_u24 v3, 37, v200
    v_lshrrev_b32 v3, 10, v3
    v_mad_u32_u24 v200, v3, 24, v200
    v_add_u32 v207, 12, v43
    v_mul_u32_u24 v3, 37, v207
    v_lshrrev_b32 v3, 10, v3
    v_mad_u32_u24 v207, v3, 24, v207
    v_add_u32 v60, 16, v43
    v_mul_u32_u24 v3, 37, v60
    v_lshrrev_b32 v3, 10, v3
    v_mad_u32_u24 v60, v3, 24, v60
    v_add_u32 v201, 20, v43
    v_mul_u32_u24 v3, 37, v201
    v_lshrrev_b32 v3, 10, v3
    v_mad_u32_u24 v201, v3, 24, v201
    v_add_u32 v202, 24, v43
    v_mul_u32_u24 v3, 37, v202
    v_lshrrev_b32 v3, 10, v3
    v_mad_u32_u24 v202, v3, 24, v202
    v_add_u32 v203, 28, v43
    v_mul_u32_u24 v3, 37, v203
    v_lshrrev_b32 v3, 10, v3
    v_mad_u32_u24 v203, v3, 24, v203
    v_add_u32 v31, 32, v43
    v_mul_u32_u24 v3, 37, v31
    v_lshrrev_b32 v3, 10, v3
    v_mad_u32_u24 v31, v3, 24, v31
    s_waitcnt lgkmcnt(0)
    s_sext_i32_i16 s84, s82
    s_ashr_i32 s85, s82, 16
    s_max_i32 s84, s84, s85
    s_sext_i32_i16 s85, s83
    s_max_i32 s84, s84, s85
    s_ashr_i32 s85, s83, 16
    s_max_i32 s84, s84, s85
    s_cmp_gt_i32 s84, 16492
    s_cbranch_scc1 L_slow
    s_lshl_b32 s84, s68, 4
    buffer_load_dwordx4 v41, s[32:35], s92 offen offset:1024 lds
    v_add_u32 v30, 36, v43
    v_mul_u32_u24 v3, 37, v30
    v_lshrrev_b32 v3, 10, v3
    v_mad_u32_u24 v30, v3, 24, v30
    v_add_u32 v40, 40, v43
    v_mul_u32_u24 v3, 37, v40
    v_lshrrev_b32 v3, 10, v3
    s_lshr_b64 s[82:83], s[82:83], s84
    s_lshl_b32 s82, s82, 16
    buffer_load_dwordx4 v26, s[32:35], s92 offen offset:2048 lds
    s_add_u32 m0, s90, 12288
    s_mov_b32 s92, 36864
    v_mad_u32_u24 v40, v3, 24, v40
    v_add_u32 v199, 44, v43
    v_mul_u32_u24 v3, 37, v199
    v_lshrrev_b32 v3, 10, v3
    v_mad_u32_u24 v199, v3, 24, v199
    s_mov_b32 s84, 0x41b8aa3b
    s_mov_b32 s46, 20480
    buffer_load_dwordx4 v141, s[32:35], s92 offen offset:0 lds
    v_lshl_add_u32 v43, v144, 4, v42
    v_mul_u32_u24 v3, 37, v43
    v_lshrrev_b32 v3, 10, v3
    v_mad_u32_u24 v43, v3, 24, v43
    v_mov_b32 v110, 336
    v_cmp_gt_u32 vcc, 3, v144
    v_and_b32 v3, 8, v109
    v_add_u32 v3, v3, v109
    v_cndmask_b32 v43, v110, v43, vcc
    v_sub_u32 v43, s101, v43
    v_mul_u32_u24 v3, 96, v3
    v_add_u32 v3, s90, v3
    v_lshl_add_u32 v110, v144, 4, v3
    v_lshl_add_u32 v71, v144, 3, v3
    v_lshlrev_b32 v70, 4, v144
    s_mov_b32 s47, 0
    s_mov_b32 s57, s72
    buffer_load_dwordx4 v41, s[32:35], s92 offen offset:1024 lds
    v_add_u32 v70, 4608, v70
    v_mov_b32 v3, s82
    v_min_f32 v3, 0x40930000, v3
    v_max_f32 v3, 0xc2c80000, v3
    v_mul_f32 v3, 0x3fb8aa3b, v3
    v_exp_f32 v3, v3
    s_waitcnt vmcnt(17)
    v_lshl_or_b32 v32, v33, 16, v32
    v_cvt_pk_bf16_f32 v3, v3, v3
    v_lshlrev_b32 v3, 16, v3
    v_mul_f32 v3, 0x4038aa3b, v3
    s_waitcnt vmcnt(15)
    v_lshl_or_b32 v124, v28, 16, v124
    v_readfirstlane_b32 s55, v3
    v_add_f32 v3, v3, v3
    s_waitcnt vmcnt(13)
    v_lshl_or_b32 v125, v19, 16, v125
    v_readfirstlane_b32 s52, v3
    v_cmp_gt_u32 vcc, 16, v29
    v_mov_b32 v33, 0
    v_mov_b32 v34, 0
    v_cndmask_b32 v35, 0, v32, vcc
    v_cndmask_b32 v32, 0, v32, vcc
    v_mov_b32 v19, 0
    v_mfma_f32_16x16x16_bf16 v[4:7], v[34:35], v[16:17], 0
    s_mov_b32 s58, 0
    v_mul_u32_u24 v3, 5120, v144
    v_add_u32 v3, v2, v3
    v_mfma_f32_16x16x16_bf16 v[12:15], v[32:33], v[16:17], 0
    s_mov_b32 s59, 0
    v_mov_b32 v131, 0xc138aa3b
    v_mul_u32_u24 v2, 5120, v9
    v_mfma_f32_16x16x16_bf16 v[20:23], v[32:33], v[18:19], 0
    s_mov_b32 s60, 0
    v_max_f32 v4, 0, v4
    v_max_f32 v5, 0, v5
    v_max_f32 v6, 0, v6
    v_max_f32 v12, 0, v12
    v_max_f32 v13, 0, v13
    v_max_f32 v14, 0, v14
    v_max_f32 v15, 0, v15
    v_cvt_pk_bf16_f32 v12, v12, v13
    v_cvt_pk_bf16_f32 v13, v14, v15
    v_max_f32 v7, 0, v7
    v_cvt_pk_bf16_f32 v4, v4, v5
    v_mfma_f32_16x16x16_bf16 v[16:19], v[124:125], v[12:13], 0
    s_mov_b32 s65, -1
    v_cvt_pk_bf16_f32 v5, v6, v7
    v_max_f32 v20, 0, v20
    v_max_f32 v21, 0, v21
    v_mfma_f32_16x16x16_bf16 v[12:15], v[124:125], v[4:5], 0
    s_mov_b32 s61, 1
    v_max_f32 v22, 0, v22
    v_max_f32 v23, 0, v23
    v_cvt_pk_bf16_f32 v20, v20, v21
    v_cvt_pk_bf16_f32 v21, v22, v23
    v_cvt_pk_bf16_f32 v16, v16, v16
    v_lshlrev_b32 v16, 16, v16
    v_mfma_f32_16x16x16_bf16 v[4:7], v[124:125], v[20:21], 0
    s_movk_i32 s4, 336
    v_mul_f32 v16, 0xbfb8aa3b, v16
    v_cvt_pk_bf16_f32 v12, v12, v12
    v_exp_f32 v16, v16
    v_lshlrev_b32 v12, 16, v12
    v_add_f32 v16, 1.0, v16
    v_rcp_f32 v16, v16
    v_mul_f32 v12, 0xbfb8aa3b, v12
    v_cvt_pk_bf16_f32 v16, v16, v16
    v_lshlrev_b32 v16, 16, v16
    v_fma_f32 v16, v16, s84, v131
    s_mov_b32 s5, 0
    s_mov_b32 s6, 0
    ds_write_b32 v3, v16 offset:44032
    v_exp_f32 v12, v12
    v_cvt_pk_bf16_f32 v4, v4, v4
    v_add_f32 v12, 1.0, v12
    v_rcp_f32 v12, v12
    v_lshlrev_b32 v4, 16, v4
    v_cvt_pk_bf16_f32 v12, v12, v12
    v_lshlrev_b32 v12, 16, v12
    v_fma_f32 v12, v12, s84, v131
    s_mov_b32 s12, 0
    s_mov_b32 s64, 3
    ds_write_b32 v3, v12 offset:44036
    v_mul_f32 v4, 0xbfb8aa3b, v4
    v_exp_f32 v4, v4
    v_mad_u32_u24 v2, v8, s86, v2
    v_add_f32 v4, 1.0, v4
    v_rcp_f32 v4, v4
    v_and_b32 v28, 7, v109
    v_cvt_pk_bf16_f32 v4, v4, v4
    v_lshlrev_b32 v4, 16, v4
    v_fma_f32 v4, v4, s84, v131
    s_mov_b32 s10, 81924
    s_mov_b32 s11, 0x20000
    ds_write_b32 v3, v4 offset:44040
    v_xor_b32 v133, v28, v144
    v_lshl_add_u32 v99, v133, 4, v2
    v_xor_b32 v3, 64, v99
    v_add_u32 v139, 40960, v99
    v_xor_b32 v138, 64, v139
    v_add_u32 v2, 61440, v2
    v_add_u32 v133, s93, v144
    v_xor_b32 v133, v28, v133
    v_lshl_add_u32 v137, v133, 4, v2
    v_lshrrev_b32 v133, 1, v144
    v_add3_u32 v133, v133, s93, 4
    v_xor_b32 v133, v28, v133
    v_lshl_add_u32 v133, v133, 4, v2
    v_and_b32 v2, 1, v144
    v_lshl_add_u32 v136, v2, 3, v133
    v_lshlrev_b32 v2, 4, v29
    s_add_u32 s93, s54, 20480
    v_add_u32 v135, s93, v2
    v_add_u32 v131, 81920, v2
    s_lshr_b32 s93, s68, 1
    s_lshl_b32 s93, s93, 10
    s_add_u32 s93, s93, s94
    v_add_u32 v132, s93, v131
    s_mul_i32 s93, s68, 5376
    s_add_u32 s93, s93, 142336
    v_mul_u32_u24 v2, 80, v144
    v_add_u32 v133, s93, v2
    v_mul_u32_u24 v2, 336, v109
    v_add_u32 v28, v2, v133
    v_subrev_u32 v28, 21504, v28
    v_cmp_eq_u32 vcc, 0, v9
    v_mul_u32_u24 v2, 80, v9
    v_lshl_add_u32 v2, v144, 3, v2
    s_waitcnt lgkmcnt(0)
    s_barrier
    v_cndmask_b32 v134, v108, v133, vcc
    v_cmp_eq_u32 vcc, 3, v8
    v_lshl_add_u32 v2, v8, 1, v2
    v_add_u32 v2, s93, v2
    s_add_u32 s93, s69, 1
    s_mul_i32 s94, s93, 58255
    buffer_load_dwordx4 v26, s[32:35], s92 offen offset:2048 lds
    s_add_u32 m0, s90, 24576
    s_mov_b32 s92, 73728
    ds_read_b32 v209, v187
    v_cndmask_b32 v134, v134, v133, vcc
    v_cmp_gt_u32 vcc, 3, v144
    v_mov_b32 v125, 0
    s_lshr_b32 s94, s94, 22
    v_cndmask_b32 v133, v108, v2, vcc
    s_mul_i32 s94, s94, s63
    s_mul_i32 s56, s93, s62
    s_add_u32 s56, s56, s94
    s_and_b32 s94, s68, 1
    s_mul_i32 s94, s94, -2304
    ds_read_b32 v210, v69
    v_mov_b32 v124, 0
    s_sub_u32 s93, s71, 1
    s_cmp_eq_u32 s68, 0
    s_cselect_b32 s13, s93, -1
    s_cmp_gt_u32 s73, 20
    s_cselect_b32 s13, s13, -1
    s_and_b32 s93, s2, -8
    buffer_load_dwordx4 v141, s[32:35], s92 offen offset:0 lds
    s_sub_u32 s93, 81920, s93
    s_sub_u32 s8, s38, s93
    s_subb_u32 s9, s39, 0
    s_lshr_b32 s93, s68, 1
    s_mul_i32 s93, s93, 30720
    s_add_u32 s93, s93, s94
    ds_write_b128 v28, v[216:219] offset:21584
    buffer_load_dwordx4 v41, s[32:35], s92 offen offset:1024 lds
    v_add_u32 v9, s93, v110
    v_add_u32 v8, s93, v71
    s_lshr_b32 s93, s68, 1
    s_mul_i32 s93, s93, 5120
    s_lshl_b32 s94, s97, 4
    s_add_u32 s93, s93, s94
    v_add_u32 v2, s93, v70
    v_cmp_eq_u32 vcc, 0, v109
    s_mov_b32 s39, 0x00010001
    v_sub_u32 v192, v187, v68
    v_cndmask_b32 v2, v108, v2, vcc
    ds_read_b32 v192, v192 offset:336
    v_sub_u32 v193, v187, v61
    v_sub_u32 v194, v187, v200
    v_sub_u32 v195, v187, v207
    v_sub_u32 v188, v187, v60
    v_sub_u32 v189, v187, v201
    ds_read_b32 v193, v193 offset:336
    v_sub_u32 v190, v187, v202
    buffer_load_dwordx4 v26, s[32:35], s92 offen offset:2048 lds
    s_add_u32 m0, s90, 36864
    s_mov_b32 s92, 110592
    ds_read_b32 v194, v194 offset:336
    v_sub_u32 v191, v187, v203
    v_sub_u32 v184, v187, v31
    v_sub_u32 v185, v187, v30
    v_sub_u32 v186, v187, v40
    v_sub_u32 v187, v187, v199
    s_waitcnt vmcnt(9)
    s_barrier
    ds_read_b32 v195, v195 offset:336
    v_sub_u32 v180, v69, v68
    v_sub_u32 v181, v69, v61
    v_sub_u32 v182, v69, v200
    v_sub_u32 v183, v69, v207
    v_sub_u32 v176, v69, v60
    ds_read_b32 v188, v188 offset:336
    v_sub_u32 v177, v69, v201
    v_sub_u32 v178, v69, v202
    v_sub_u32 v179, v69, v203
    v_sub_u32 v172, v69, v31
    v_sub_u32 v173, v69, v30
    ds_read_b32 v189, v189 offset:336
    v_sub_u32 v174, v69, v40
    v_sub_u32 v175, v69, v199
    buffer_load_dwordx4 v141, s[32:35], s92 offen offset:0 lds
    ds_read_b32 v190, v190 offset:336
    v_sub_u32 v204, v143, v68
    v_sub_u32 v205, v143, v61
    v_sub_u32 v206, v143, v200
    v_sub_u32 v207, v143, v207
    v_sub_u32 v200, v143, v60
    ds_read_b32 v191, v191 offset:336
    v_sub_u32 v201, v143, v201
    v_sub_u32 v202, v143, v202
    v_sub_u32 v203, v143, v203
    v_sub_u32 v196, v143, v31
    v_sub_u32 v197, v143, v30
    ds_read_b32 v184, v184 offset:336
    buffer_load_dwordx4 v41, s[32:35], s92 offen offset:1024 lds
    v_sub_u32 v198, v143, v40
    v_sub_u32 v199, v143, v199
    ds_read_b32 v185, v185 offset:336
    ds_read_b32 v186, v186 offset:336
    ds_read_b32 v187, v187 offset:336
    buffer_load_dwordx4 v26, s[32:35], s92 offen offset:2048 lds
    s_add_u32 m0, s90, 49152
    s_mov_b32 s92, 147456
    s_waitcnt vmcnt(9)
    ds_read_b64_tr_b16 a[0:1], v0 offset:0
    ds_read_b64_tr_b16 a[2:3], v0 offset:768
    ds_read_b64_tr_b16 a[24:25], v0 offset:32
    ds_read_b64_tr_b16 a[26:27], v0 offset:800
    ds_read_b64_tr_b16 a[48:49], v0 offset:64
    ds_read_b64_tr_b16 a[50:51], v0 offset:832
    ds_read_b128 v[12:15], v99 offset:40960
    ds_read_b128 v[20:23], v99 offset:42496
    buffer_load_dwordx4 v141, s[32:35], s92 offen offset:0 lds
    ds_read_b128 v[16:19], v99 offset:0
    ds_read_b128 v[4:7], v99 offset:1536
    ds_read_b128 v[100:103], v99 offset:3072
    ds_read_b32 v180, v180 offset:336
    buffer_load_dwordx4 v41, s[32:35], s92 offen offset:1024 lds
    ds_read_b32 v181, v181 offset:336
    ds_read_b32 v182, v182 offset:336
    s_waitcnt lgkmcnt(7)
    v_mfma_f32_16x16x32_bf16 v[64:67], a[0:3], v[12:15], 0
    ds_read_b128 v[116:119], v3 offset:41088
    v_mfma_f32_16x16x32_bf16 v[48:51], a[24:27], v[12:15], 0
    ds_read_b128 v[104:107], v3 offset:42624
    v_mfma_f32_16x16x32_bf16 v[92:95], a[48:51], v[12:15], 0
    s_waitcnt vmcnt(8) lgkmcnt(6)
    buffer_load_dwordx4 v26, s[32:35], s92 offen offset:2048 lds
    ds_read_b64_tr_b16 a[4:5], v0 offset:12288
    v_mfma_f32_16x16x32_bf16 v[72:75], a[0:3], v[20:23], 0
    s_add_u32 m0, s90, 61440
    ds_read_b64_tr_b16 a[6:7], v0 offset:13056
    v_mfma_f32_16x16x32_bf16 v[52:55], a[24:27], v[20:23], 0
    s_mov_b32 s92, 184320
    ds_read_b64_tr_b16 a[28:29], v0 offset:12320
    v_mfma_f32_16x16x32_bf16 v[12:15], a[48:51], v[20:23], 0
    ds_read_b64_tr_b16 a[30:31], v0 offset:13088
    v_mfma_f32_16x16x32_bf16 v[20:23], a[0:3], v[16:19], 0
    ds_read_b64_tr_b16 a[52:53], v0 offset:12352
    v_mfma_f32_16x16x32_bf16 v[32:35], a[24:27], v[16:19], 0
    buffer_load_dwordx4 v141, s[32:35], s92 offen offset:0 lds
    ds_read_b64_tr_b16 a[54:55], v0 offset:13120
    v_mfma_f32_16x16x32_bf16 v[164:167], a[48:51], v[16:19], 0
    ds_read_b128 v[84:87], v3 offset:128
    v_mfma_f32_16x16x32_bf16 v[76:79], a[0:3], v[4:7], 0
    ds_read_b128 v[88:91], v3 offset:1664
    v_mfma_f32_16x16x32_bf16 v[148:151], a[24:27], v[4:7], 0
    ds_read_b128 v[36:39], v3 offset:3200
    v_mfma_f32_16x16x32_bf16 v[16:19], a[48:51], v[4:7], 0
    s_waitcnt lgkmcnt(8)
    ds_read_b128 v[44:47], v3 offset:40960
    v_mfma_f32_16x16x32_bf16 v[80:83], a[0:3], v[100:103], 0
    buffer_load_dwordx4 v41, s[32:35], s92 offen offset:1024 lds
    ds_read_b128 v[120:123], v3 offset:42496
    v_mfma_f32_16x16x32_bf16 v[4:7], a[24:27], v[100:103], 0
    ds_read_b128 v[156:159], v3 offset:0
    v_mfma_f32_16x16x32_bf16 v[56:59], a[48:51], v[100:103], 0
    ds_read_b128 v[152:155], v3 offset:1536
    ds_read_b128 v[100:103], v3 offset:3072
    ds_read_b32 v183, v183 offset:336
    buffer_load_dwordx4 v26, s[32:35], s92 offen offset:2048 lds
    s_add_u32 m0, s90, 0
    s_mov_b32 s92, 384
    s_waitcnt vmcnt(9)
    ds_read_b64_tr_b16 a[8:9], v0 offset:24576
    ds_read_b64_tr_b16 a[10:11], v0 offset:25344
    ds_read_b64_tr_b16 a[32:33], v0 offset:24608
    ds_read_b64_tr_b16 a[34:35], v0 offset:25376
    s_waitcnt lgkmcnt(9)
    v_mfma_f32_16x16x32_bf16 v[64:67], a[4:7], v[44:47], v[64:67]
    ds_read_b64_tr_b16 a[56:57], v0 offset:24640
    v_mfma_f32_16x16x32_bf16 v[48:51], a[28:31], v[44:47], v[48:51]
    ds_read_b64_tr_b16 a[58:59], v0 offset:25408
    v_mfma_f32_16x16x32_bf16 v[92:95], a[52:55], v[44:47], v[92:95]
    s_waitcnt lgkmcnt(9)
    buffer_load_dwordx4 v141, s[32:35], s92 offen offset:0 lds
    ds_read_b128 v[44:47], v99 offset:41088
    v_mfma_f32_16x16x32_bf16 v[72:75], a[4:7], v[120:123], v[72:75]
    ds_read_b32 v176, v176 offset:336
    v_mfma_f32_16x16x32_bf16 v[52:55], a[28:31], v[120:123], v[52:55]
    v_mfma_f32_16x16x32_bf16 v[12:15], a[52:55], v[120:123], v[12:15]
    ds_read_b32 v177, v177 offset:336
    v_mfma_f32_16x16x32_bf16 v[20:23], a[4:7], v[156:159], v[20:23]
    v_mfma_f32_16x16x32_bf16 v[32:35], a[28:31], v[156:159], v[32:35]
    buffer_load_dwordx4 v41, s[32:35], s92 offen offset:1024 lds
    ds_read_b128 v[120:123], v99 offset:42624
    v_mfma_f32_16x16x32_bf16 v[164:167], a[52:55], v[156:159], v[164:167]
    s_waitcnt lgkmcnt(6)
    ds_read_b32 v178, v178 offset:336
    v_mfma_f32_16x16x32_bf16 v[76:79], a[4:7], v[152:155], v[76:79]
    v_mfma_f32_16x16x32_bf16 v[148:151], a[28:31], v[152:155], v[148:151]
    ds_read_b32 v179, v179 offset:336
    v_mfma_f32_16x16x32_bf16 v[16:19], a[52:55], v[152:155], v[16:19]
    v_mfma_f32_16x16x32_bf16 v[80:83], a[4:7], v[100:103], v[80:83]
    s_waitcnt vmcnt(8)
    buffer_load_dwordx4 v26, s[32:35], s92 offen offset:2048 lds
    ds_read_b64_tr_b16 a[12:13], v0 offset:36864
    v_mfma_f32_16x16x32_bf16 v[4:7], a[28:31], v[100:103], v[4:7]
    s_add_u32 m0, s90, 12288
    ds_read_b64_tr_b16 a[14:15], v0 offset:37632
    v_mfma_f32_16x16x32_bf16 v[56:59], a[52:55], v[100:103], v[56:59]
    s_waitcnt lgkmcnt(5)
    s_mov_b32 s92, 37248
    ds_read_b64_tr_b16 a[36:37], v0 offset:36896
    v_mfma_f32_16x16x32_bf16 v[64:67], a[8:11], v[44:47], v[64:67]
    ds_read_b64_tr_b16 a[38:39], v0 offset:37664
    v_mfma_f32_16x16x32_bf16 v[48:51], a[32:35], v[44:47], v[48:51]
    ds_read_b64_tr_b16 a[60:61], v0 offset:36928
    v_mfma_f32_16x16x32_bf16 v[92:95], a[56:59], v[44:47], v[92:95]
    s_waitcnt lgkmcnt(6)
    buffer_load_dwordx4 v141, s[32:35], s92 offen offset:0 lds
    ds_read_b64_tr_b16 a[62:63], v0 offset:37696
    v_mfma_f32_16x16x32_bf16 v[72:75], a[8:11], v[120:123], v[72:75]
    ds_read_b128 v[100:103], v99 offset:128
    v_mfma_f32_16x16x32_bf16 v[52:55], a[32:35], v[120:123], v[52:55]
    ds_read_b128 v[44:47], v99 offset:1664
    v_mfma_f32_16x16x32_bf16 v[12:15], a[56:59], v[120:123], v[12:15]
    s_waitcnt lgkmcnt(6)
    ds_read_b32 v172, v172 offset:336
    ds_read_b32 v173, v173 offset:336
    v_mfma_f32_16x16x32_bf16 v[64:67], a[12:15], v[116:119], v[64:67]
    buffer_load_dwordx4 v41, s[32:35], s92 offen offset:1024 lds
    v_mfma_f32_16x16x32_bf16 v[72:75], a[12:15], v[104:107], v[72:75]
    s_waitcnt lgkmcnt(6)
    ds_read_b32 v174, v174 offset:336
    v_mfma_f32_16x16x32_bf16 v[48:51], a[36:39], v[116:119], v[48:51]
    v_mfma_f32_16x16x32_bf16 v[52:55], a[36:39], v[104:107], v[52:55]
    s_waitcnt lgkmcnt(5)
    ds_read_b128 v[152:155], v99 offset:3200
    v_mfma_f32_16x16x32_bf16 v[92:95], a[60:63], v[116:119], v[92:95]
    ds_read_b32 v175, v175 offset:336
    buffer_load_dwordx4 v26, s[32:35], s92 offen offset:2048 lds
    v_mfma_f32_16x16x32_bf16 v[12:15], a[60:63], v[104:107], v[12:15]
    s_waitcnt lgkmcnt(5)
    s_add_u32 m0, s90, 24576
    v_mfma_f32_16x16x32_bf16 v[20:23], a[8:11], v[100:103], v[20:23]
    s_waitcnt vmcnt(9)
    s_mov_b32 s92, 74112
    ds_read_b64_tr_b16 a[16:17], v0 offset:49152
    v_mfma_f32_16x16x32_bf16 v[20:23], a[12:15], v[84:87], v[20:23]
    ds_read_b64_tr_b16 a[18:19], v0 offset:49920
    v_mfma_f32_16x16x32_bf16 v[32:35], a[32:35], v[100:103], v[32:35]
    ds_read_b64_tr_b16 a[40:41], v0 offset:49184
    v_mfma_f32_16x16x32_bf16 v[32:35], a[36:39], v[84:87], v[32:35]
    ds_read_b64_tr_b16 a[42:43], v0 offset:49952
    buffer_load_dwordx4 v141, s[32:35], s92 offen offset:0 lds
    v_mfma_f32_16x16x32_bf16 v[164:167], a[56:59], v[100:103], v[164:167]
    ds_read_b64_tr_b16 a[64:65], v0 offset:49216
    v_mfma_f32_16x16x32_bf16 v[164:167], a[60:63], v[84:87], v[164:167]
    ds_read_b64_tr_b16 a[66:67], v0 offset:49984
    v_mfma_f32_16x16x32_bf16 v[76:79], a[8:11], v[44:47], v[76:79]
    ds_read_b128 v[120:123], v3 offset:41216
    v_mfma_f32_16x16x32_bf16 v[76:79], a[12:15], v[88:91], v[76:79]
    ds_read_b128 v[104:107], v3 offset:42752
    v_mfma_f32_16x16x32_bf16 v[148:151], a[32:35], v[44:47], v[148:151]
    ds_read_b128 v[100:103], v3 offset:256
    buffer_load_dwordx4 v41, s[32:35], s92 offen offset:1024 lds
    v_mfma_f32_16x16x32_bf16 v[148:151], a[36:39], v[88:91], v[148:151]
    ds_read_b128 v[84:87], v3 offset:1792
    v_mfma_f32_16x16x32_bf16 v[16:19], a[56:59], v[44:47], v[16:19]
    ds_read_b128 v[44:47], v3 offset:3328
    v_mfma_f32_16x16x32_bf16 v[16:19], a[60:63], v[88:91], v[16:19]
    s_waitcnt lgkmcnt(8)
    ds_read_b128 v[88:91], v99 offset:41216
    v_mfma_f32_16x16x32_bf16 v[80:83], a[8:11], v[152:155], v[80:83]
    ds_read_b128 v[116:119], v99 offset:42752
    v_mov_b32 v27, 0
    v_mfma_f32_16x16x32_bf16 v[80:83], a[12:15], v[36:39], v[80:83]
    ds_read_b32 v204, v204 offset:336
    buffer_load_dwordx4 v26, s[32:35], s92 offen offset:2048 lds
    v_mfma_f32_16x16x32_bf16 v[4:7], a[32:35], v[152:155], v[4:7]
    s_add_u32 m0, s90, 36864
    v_mfma_f32_16x16x32_bf16 v[4:7], a[36:39], v[36:39], v[4:7]
    s_waitcnt vmcnt(9)
    s_mov_b32 s92, 110976
    ds_read_b64_tr_b16 a[20:21], v0 offset:61440
    v_mfma_f32_16x16x32_bf16 v[56:59], a[56:59], v[152:155], v[56:59]
    ds_read_b64_tr_b16 a[22:23], v0 offset:62208
    v_mfma_f32_16x16x32_bf16 v[56:59], a[60:63], v[36:39], v[56:59]
    ds_read_b64_tr_b16 a[44:45], v0 offset:61472
    ds_read_b64_tr_b16 a[46:47], v0 offset:62240
    ds_read_b64_tr_b16 a[68:69], v0 offset:61504
    buffer_load_dwordx4 v141, s[32:35], s92 offen offset:0 lds
    ds_read_b64_tr_b16 a[70:71], v0 offset:62272
    ds_read_b128 v[36:39], v99 offset:256
    s_waitcnt lgkmcnt(9)
    v_mfma_f32_16x16x32_bf16 v[64:67], a[16:19], v[88:91], v[64:67]
    ds_read_b32 v205, v205 offset:336
    v_mfma_f32_16x16x32_bf16 v[48:51], a[40:43], v[88:91], v[48:51]
    v_mfma_f32_16x16x32_bf16 v[92:95], a[64:67], v[88:91], v[92:95]
    s_waitcnt lgkmcnt(8)
    ds_read_b32 v206, v206 offset:336
    v_mfma_f32_16x16x32_bf16 v[72:75], a[16:19], v[116:119], v[72:75]
    buffer_load_dwordx4 v41, s[32:35], s92 offen offset:1024 lds
    v_mfma_f32_16x16x32_bf16 v[52:55], a[40:43], v[116:119], v[52:55]
    s_waitcnt lgkmcnt(7)
    ds_read_b128 v[88:91], v99 offset:1792
    v_mfma_f32_16x16x32_bf16 v[64:67], a[20:23], v[120:123], v[64:67]
    ds_read_b32 v207, v207 offset:336
    v_mfma_f32_16x16x32_bf16 v[72:75], a[20:23], v[104:107], v[72:75]
    s_waitcnt lgkmcnt(6)
    s_nop 0
    v_mfma_f32_16x16x32_bf16 v[48:51], a[44:47], v[120:123], v[48:51]
    s_waitcnt lgkmcnt(4)
    s_nop 0
    ds_read_b32 v200, v200 offset:336
    v_cvt_pk_f16_f32 v64, v64, v65
    v_mfma_f32_16x16x32_bf16 v[92:95], a[68:71], v[120:123], v[92:95]
    buffer_load_dwordx4 v26, s[32:35], s92 offen offset:2048 lds
    v_cvt_pk_f16_f32 v65, v66, v67
    v_mfma_f32_16x16x32_bf16 v[52:55], a[44:47], v[104:107], v[52:55]
    s_waitcnt vmcnt(9)
    s_add_u32 m0, s90, 49152
    ds_read_b64_tr_b16 a[72:73], v0 offset:0
    v_pk_fma_f16 v140, v64, v64, s39
    v_mfma_f32_16x16x32_bf16 v[12:15], a[64:67], v[116:119], v[12:15]
    s_mov_b32 s92, 147840
    ds_read_b64_tr_b16 a[74:75], v0 offset:768
    v_pk_fmac_f16 v140, v65, v65
    v_mfma_f32_16x16x32_bf16 v[12:15], a[68:71], v[104:107], v[12:15]
    ds_read_b64_tr_b16 a[96:97], v0 offset:32
    v_cvt_pk_f16_f32 v66, v48, v49
    v_mfma_f32_16x16x32_bf16 v[20:23], a[16:19], v[36:39], v[20:23]
    ds_read_b64_tr_b16 a[98:99], v0 offset:800
    v_cvt_pk_f16_f32 v67, v50, v51
    v_mfma_f32_16x16x32_bf16 v[20:23], a[20:23], v[100:103], v[20:23]
    buffer_load_dwordx4 v141, s[32:35], s92 offen offset:0 lds
    ds_read_b64_tr_b16 a[120:121], v0 offset:64
    v_mfma_f32_16x16x32_bf16 v[32:35], a[40:43], v[36:39], v[32:35]
    ds_read_b64_tr_b16 a[122:123], v0 offset:832
    v_pk_fmac_f16 v140, v66, v66
    v_mfma_f32_16x16x32_bf16 v[32:35], a[44:47], v[100:103], v[32:35]
    ds_read_b128 v[48:51], v99 offset:3328
    v_pk_fmac_f16 v140, v67, v67
    v_mfma_f32_16x16x32_bf16 v[164:167], a[64:67], v[36:39], v[164:167]
    ds_read_b128 v[36:39], v99 offset:40960
    v_cvt_pk_f16_f32 v24, v92, v93
    v_mfma_f32_16x16x32_bf16 v[164:167], a[68:71], v[100:103], v[164:167]
    s_waitcnt lgkmcnt(8)
    ds_read_b32 v201, v201 offset:336
    v_cvt_pk_f16_f32 v25, v94, v95
    v_mfma_f32_16x16x32_bf16 v[76:79], a[16:19], v[88:91], v[76:79]
    buffer_load_dwordx4 v41, s[32:35], s92 offen offset:1024 lds
    v_pk_fmac_f16 v140, v24, v24
    v_mfma_f32_16x16x32_bf16 v[76:79], a[20:23], v[84:87], v[76:79]
    ds_read_b128 v[100:103], v99 offset:42496
    v_pk_fmac_f16 v140, v25, v25
    v_mfma_f32_16x16x32_bf16 v[148:151], a[40:43], v[88:91], v[148:151]
    ds_read_b32 v202, v202 offset:336
    v_cvt_pk_f16_f32 v72, v72, v73
    v_mfma_f32_16x16x32_bf16 v[148:151], a[44:47], v[84:87], v[148:151]
    v_cvt_pk_f16_f32 v73, v74, v75
    v_pk_fma_f16 v142, v72, v72, s39
    v_mfma_f32_16x16x32_bf16 v[16:19], a[64:67], v[88:91], v[16:19]
    ds_read_b128 v[104:107], v99 offset:0
    v_pk_fmac_f16 v142, v73, v73
    v_mfma_f32_16x16x32_bf16 v[16:19], a[68:71], v[84:87], v[16:19]
    s_waitcnt vmcnt(8) lgkmcnt(5)
    buffer_load_dwordx4 v26, s[32:35], s92 offen offset:2048 lds
    ds_read_b64_tr_b16 a[76:77], v0 offset:12288
    v_cvt_pk_f16_f32 v74, v52, v53
    v_mfma_f32_16x16x32_bf16 v[80:83], a[16:19], v[48:51], v[80:83]
    s_add_u32 m0, s90, 61440
    ds_read_b64_tr_b16 a[78:79], v0 offset:13056
    v_cvt_pk_f16_f32 v75, v54, v55
    v_mfma_f32_16x16x32_bf16 v[80:83], a[20:23], v[44:47], v[80:83]
    s_mov_b32 s92, 184704
    ds_read_b64_tr_b16 a[100:101], v0 offset:12320
    v_pk_fmac_f16 v142, v74, v74
    v_mfma_f32_16x16x32_bf16 v[4:7], a[40:43], v[48:51], v[4:7]
    ds_read_b64_tr_b16 a[102:103], v0 offset:13088
    v_pk_fmac_f16 v142, v75, v75
    v_mfma_f32_16x16x32_bf16 v[4:7], a[44:47], v[44:47], v[4:7]
    ds_read_b64_tr_b16 a[124:125], v0 offset:12352
    v_cvt_pk_f16_f32 v60, v12, v13
    v_mfma_f32_16x16x32_bf16 v[56:59], a[64:67], v[48:51], v[56:59]
    buffer_load_dwordx4 v141, s[32:35], s92 offen offset:0 lds
    ds_read_b64_tr_b16 a[126:127], v0 offset:13120
    v_mfma_f32_16x16x32_bf16 v[56:59], a[68:71], v[44:47], v[56:59]
    s_waitcnt lgkmcnt(7)
    ds_read_b128 v[52:55], v99 offset:1536
    v_cvt_pk_f16_f32 v61, v14, v15
    v_mfma_f32_16x16x32_bf16 v[116:119], a[72:75], v[36:39], 0
    ds_read_b128 v[232:235], v99 offset:3072
    v_pk_fmac_f16 v142, v60, v60
    v_mfma_f32_16x16x32_bf16 v[44:47], a[96:99], v[36:39], 0
    ds_read_b128 v[92:95], v3 offset:40960
    v_pk_fmac_f16 v142, v61, v61
    v_mfma_f32_16x16x32_bf16 v[12:15], a[120:123], v[36:39], 0
    ds_read_b32 v203, v203 offset:336
    v_cvt_pk_f16_f32 v88, v20, v21
    v_mfma_f32_16x16x32_bf16 v[48:51], a[72:75], v[100:103], 0
    buffer_load_dwordx4 v41, s[32:35], s92 offen offset:1024 lds
    v_cvt_pk_f16_f32 v89, v22, v23
    v_mfma_f32_16x16x32_bf16 v[228:231], a[96:99], v[100:103], 0
    ds_read_b128 v[84:87], v3 offset:42496
    v_pk_fma_f16 v156, v88, v88, s39
    v_mfma_f32_16x16x32_bf16 v[36:39], a[120:123], v[100:103], 0
    s_waitcnt lgkmcnt(7)
    ds_read_b32 v196, v196 offset:336
    v_pk_fmac_f16 v156, v89, v89
    v_mfma_f32_16x16x32_bf16 v[160:163], a[72:75], v[104:107], 0
    v_cvt_pk_f16_f32 v90, v32, v33
    v_cvt_pk_f16_f32 v91, v34, v35
    v_mfma_f32_16x16x32_bf16 v[32:35], a[96:99], v[104:107], 0
    ds_read_b128 v[120:123], v3 offset:0
    v_pk_fmac_f16 v156, v90, v90
    v_mfma_f32_16x16x32_bf16 v[100:103], a[120:123], v[104:107], 0
    s_waitcnt vmcnt(8) lgkmcnt(6)
    buffer_load_dwordx4 v26, s[32:35], s92 offen offset:2048 lds
    ds_read_b64_tr_b16 a[80:81], v0 offset:24576
    v_mfma_f32_16x16x32_bf16 v[104:107], a[72:75], v[52:55], 0
    s_waitcnt lgkmcnt(5)
    s_add_u32 m0, s90, 0
    ds_read_b64_tr_b16 a[82:83], v0 offset:25344
    v_pk_fmac_f16 v156, v91, v91
    v_cvt_pk_f16_f32 v154, v164, v165
    v_mfma_f32_16x16x32_bf16 v[116:119], a[76:79], v[92:95], v[116:119]
    s_mov_b32 s92, 768
    ds_read_b64_tr_b16 a[104:105], v0 offset:24608
    v_cvt_pk_f16_f32 v155, v166, v167
    v_mfma_f32_16x16x32_bf16 v[44:47], a[100:103], v[92:95], v[44:47]
    ds_read_b64_tr_b16 a[106:107], v0 offset:25376
    v_pk_fmac_f16 v156, v154, v154
    v_mfma_f32_16x16x32_bf16 v[12:15], a[124:127], v[92:95], v[12:15]
    ds_read_b64_tr_b16 a[128:129], v0 offset:24640
    v_pk_fmac_f16 v156, v155, v155
    v_mfma_f32_16x16x32_bf16 v[168:171], a[96:99], v[52:55], 0
    buffer_load_dwordx4 v141, s[32:35], s92 offen offset:0 lds
    ds_read_b64_tr_b16 a[130:131], v0 offset:25408
    v_mfma_f32_16x16x32_bf16 v[164:167], a[120:123], v[52:55], 0
    ds_read_b128 v[52:55], v3 offset:1536
    v_cvt_pk_f16_f32 v76, v76, v77
    v_mfma_f32_16x16x32_bf16 v[92:95], a[72:75], v[232:235], 0
    s_waitcnt lgkmcnt(7)
    ds_read_b128 v[20:23], v3 offset:3072
    v_cvt_pk_f16_f32 v77, v78, v79
    v_mfma_f32_16x16x32_bf16 v[48:51], a[76:79], v[84:87], v[48:51]
    ds_read_b128 v[224:227], v99 offset:41088
    v_pk_fma_f16 v158, v76, v76, s39
    v_mfma_f32_16x16x32_bf16 v[228:231], a[100:103], v[84:87], v[228:231]
    ds_read_b32 v197, v197 offset:336
    v_pk_fmac_f16 v158, v77, v77
    v_mfma_f32_16x16x32_bf16 v[36:39], a[124:127], v[84:87], v[36:39]
    buffer_load_dwordx4 v41, s[32:35], s92 offen offset:1024 lds
    v_cvt_pk_f16_f32 v78, v148, v149
    v_mfma_f32_16x16x32_bf16 v[160:163], a[76:79], v[120:123], v[160:163]
    ds_read_b128 v[84:87], v99 offset:42624
    v_cvt_pk_f16_f32 v79, v150, v151
    v_mfma_f32_16x16x32_bf16 v[32:35], a[100:103], v[120:123], v[32:35]
    ds_read_b32 v198, v198 offset:336
    v_pk_fmac_f16 v158, v78, v78
    v_mfma_f32_16x16x32_bf16 v[100:103], a[124:127], v[120:123], v[100:103]
    v_pk_fmac_f16 v158, v79, v79
    v_cvt_pk_f16_f32 v150, v16, v17
    v_cvt_pk_f16_f32 v151, v18, v19
    v_pk_fmac_f16 v158, v150, v150
    v_pk_fmac_f16 v158, v151, v151
    v_mfma_f32_16x16x32_bf16 v[16:19], a[96:99], v[232:235], 0
    s_waitcnt vmcnt(8)
    buffer_load_dwordx4 v26, s[32:35], s92 offen offset:2048 lds
    ds_read_b64_tr_b16 a[84:85], v0 offset:36864
    v_mfma_f32_16x16x32_bf16 v[120:123], a[120:123], v[232:235], 0
    s_waitcnt lgkmcnt(5)
    s_add_u32 m0, s90, 12288
    ds_read_b64_tr_b16 a[86:87], v0 offset:37632
    v_cvt_pk_f16_f32 v240, v80, v81
    v_mfma_f32_16x16x32_bf16 v[104:107], a[76:79], v[52:55], v[104:107]
    s_mov_b32 s92, 37632
    ds_read_b64_tr_b16 a[108:109], v0 offset:36896
    v_cvt_pk_f16_f32 v241, v82, v83
    v_mfma_f32_16x16x32_bf16 v[168:171], a[100:103], v[52:55], v[168:171]
    ds_read_b64_tr_b16 a[110:111], v0 offset:37664
    v_pk_fma_f16 v40, v240, v240, s39
    v_mfma_f32_16x16x32_bf16 v[164:167], a[124:127], v[52:55], v[164:167]
    ds_read_b64_tr_b16 a[132:133], v0 offset:36928
    v_pk_fmac_f16 v40, v241, v241
    v_mfma_f32_16x16x32_bf16 v[92:95], a[76:79], v[20:23], v[92:95]
    buffer_load_dwordx4 v141, s[32:35], s92 offen offset:0 lds
    ds_read_b64_tr_b16 a[134:135], v0 offset:37696
    v_mfma_f32_16x16x32_bf16 v[16:19], a[100:103], v[20:23], v[16:19]
    ds_read_b128 v[52:55], v99 offset:128
    v_cvt_pk_f16_f32 v242, v4, v5
    v_mfma_f32_16x16x32_bf16 v[120:123], a[124:127], v[20:23], v[120:123]
    s_waitcnt lgkmcnt(7)
    ds_read_b128 v[20:23], v99 offset:1664
    v_cvt_pk_f16_f32 v243, v6, v7
    v_mfma_f32_16x16x32_bf16 v[116:119], a[80:83], v[224:227], v[116:119]
    ds_read_b128 v[4:7], v99 offset:3200
    v_pk_fmac_f16 v40, v242, v242
    v_mfma_f32_16x16x32_bf16 v[44:47], a[104:107], v[224:227], v[44:47]
    ds_read_b128 v[80:83], v3 offset:41088
    v_pk_fmac_f16 v40, v243, v243
    v_mfma_f32_16x16x32_bf16 v[12:15], a[128:131], v[224:227], v[12:15]
    buffer_load_dwordx4 v41, s[32:35], s92 offen offset:1024 lds
    ds_read_b32 v199, v199 offset:336
    v_mfma_f32_16x16x32_bf16 v[48:51], a[80:83], v[84:87], v[48:51]
    v_cvt_pk_f16_f32 v146, v56, v57
    v_cvt_pk_f16_f32 v147, v58, v59
    v_mfma_f32_16x16x32_bf16 v[228:231], a[104:107], v[84:87], v[228:231]
    ds_read_b128 v[56:59], v3 offset:42624
    v_pk_fmac_f16 v40, v146, v146
    v_mfma_f32_16x16x32_bf16 v[36:39], a[128:131], v[84:87], v[36:39]
    s_waitcnt lgkmcnt(5)
    ds_read_b32 v208, v143
    v_pk_fmac_f16 v40, v147, v147
    ds_read_b32 v211, v43 offset:672
    v_mfma_f32_16x16x32_bf16 v[160:163], a[80:83], v[52:55], v[160:163]
    buffer_load_dwordx4 v26, s[32:35], s92 offen offset:2048 lds
    v_mfma_f32_16x16x32_bf16 v[32:35], a[104:107], v[52:55], v[32:35]
    s_waitcnt vmcnt(9)
    s_add_u32 m0, s90, 24576
    ds_read_b64_tr_b16 a[88:89], v0 offset:49152
    v_mfma_f32_16x16x32_bf16 v[100:103], a[128:131], v[52:55], v[100:103]
    s_waitcnt lgkmcnt(5)
    s_mov_b32 s92, 74496
    ds_read_b64_tr_b16 a[90:91], v0 offset:49920
    v_mfma_f32_16x16x32_bf16 v[104:107], a[80:83], v[20:23], v[104:107]
    ds_read_b64_tr_b16 a[112:113], v0 offset:49184
    v_mfma_f32_16x16x32_bf16 v[168:171], a[104:107], v[20:23], v[168:171]
    ds_read_b64_tr_b16 a[114:115], v0 offset:49952
    v_mfma_f32_16x16x32_bf16 v[164:167], a[128:131], v[20:23], v[164:167]
    buffer_load_dwordx4 v141, s[32:35], s92 offen offset:0 lds
    ds_read_b64_tr_b16 a[136:137], v0 offset:49216
    v_mfma_f32_16x16x32_bf16 v[92:95], a[80:83], v[4:7], v[92:95]
    ds_read_b64_tr_b16 a[138:139], v0 offset:49984
    v_mfma_f32_16x16x32_bf16 v[16:19], a[104:107], v[4:7], v[16:19]
    ds_read_b128 v[52:55], v3 offset:128
    v_mfma_f32_16x16x32_bf16 v[120:123], a[128:131], v[4:7], v[120:123]
    ds_read_b128 v[4:7], v3 offset:1664
    v_mfma_f32_16x16x32_bf16 v[116:119], a[84:87], v[80:83], v[116:119]
    ds_read_b128 v[20:23], v3 offset:3200
    v_mfma_f32_16x16x32_bf16 v[44:47], a[108:111], v[80:83], v[44:47]
    buffer_load_dwordx4 v41, s[32:35], s92 offen offset:1024 lds
    ds_read_b128 v[84:87], v99 offset:41216
    v_mfma_f32_16x16x32_bf16 v[12:15], a[132:135], v[80:83], v[12:15]
    s_waitcnt lgkmcnt(8)
    s_cmp_ge_u32 s2, 247
    s_cbranch_scc1 L_maskF
L_nomaskF:
    v_mfma_f32_16x16x32_bf16 v[48:51], a[84:87], v[56:59], v[48:51]
    ds_read_b128 v[80:83], v99 offset:42752
    v_mfma_f32_16x16x32_bf16 v[228:231], a[108:111], v[56:59], v[228:231]
    v_mfma_f32_16x16x32_bf16 v[36:39], a[132:135], v[56:59], v[36:39]
    s_waitcnt vmcnt(8) lgkmcnt(4)
    buffer_load_dwordx4 v26, s[32:35], s92 offen offset:2048 lds
    ds_read_b64_tr_b16 a[92:93], v0 offset:61440
    s_add_u32 m0, s90, 36864
    s_mov_b32 s92, 111360
    ds_read_b64_tr_b16 a[94:95], v0 offset:62208
    v_mfma_f32_16x16x32_bf16 v[160:163], a[84:87], v[52:55], v[160:163]
    s_mov_b32 s53, s47
    ds_read_b64_tr_b16 a[116:117], v0 offset:61472
    v_readlane_b32 s84, v211, 48
    v_mfma_f32_16x16x32_bf16 v[32:35], a[108:111], v[52:55], v[32:35]
    s_mov_b32 s47, s46
    ds_read_b64_tr_b16 a[118:119], v0 offset:62240
    v_mov_b32 v143, 0xf149f2ca
    v_mfma_f32_16x16x32_bf16 v[100:103], a[132:135], v[52:55], v[100:103]
    s_waitcnt lgkmcnt(6)
    s_mov_b32 s46, s45
    ds_read_b64_tr_b16 a[140:141], v0 offset:61504
    v_cmp_gt_u32 vcc, 16, v29
    v_mfma_f32_16x16x32_bf16 v[104:107], a[84:87], v[4:7], v[104:107]
    s_mov_b32 s45, s44
    ds_read_b64_tr_b16 a[142:143], v0 offset:62272
    buffer_load_dwordx4 v141, s[32:35], s92 offen offset:0 lds
    v_mfma_f32_16x16x32_bf16 v[168:171], a[108:111], v[4:7], v[168:171]
    s_mov_b32 s44, s53
    ds_read_b128 v[56:59], v99 offset:256
    v_cndmask_b32 v208, v143, v208, vcc
    v_mfma_f32_16x16x32_bf16 v[164:167], a[132:135], v[4:7], v[164:167]
    s_sub_u32 s48, s44, s46
    ds_read_b128 v[4:7], v99 offset:1792
    v_cndmask_b32 v209, v143, v209, vcc
    v_mfma_f32_16x16x32_bf16 v[92:95], a[84:87], v[20:23], v[92:95]
    s_sub_u32 s49, s46, s45
    ds_read_b128 v[52:55], v99 offset:3328
    v_cndmask_b32 v210, v143, v210, vcc
    v_mfma_f32_16x16x32_bf16 v[16:19], a[108:111], v[20:23], v[16:19]
    s_sub_u32 s50, s45, s44
    v_cmp_gt_u32 vcc, 49, v29
    v_add_u32 v139, s48, v139
    v_mfma_f32_16x16x32_bf16 v[120:123], a[132:135], v[20:23], v[120:123]
    s_waitcnt lgkmcnt(7)
    s_sub_u32 s51, s46, s47
    v_cndmask_b32 v211, v143, v211, vcc
    v_add_u32 v138, s48, v138
    v_mfma_f32_16x16x32_bf16 v[116:119], a[88:91], v[84:87], v[116:119]
    s_mov_b32 s60, s59
    buffer_load_dwordx4 v41, s[32:35], s92 offen offset:1024 lds
    ds_read_b128 v[20:23], v3 offset:41216
    v_mfma_f32_16x16x32_bf16 v[44:47], a[112:115], v[84:87], v[44:47]
    s_mov_b32 s59, s58
    v_add_u32 v137, s49, v137
    v_add_u32 v136, s49, v136
    v_mfma_f32_16x16x32_bf16 v[12:15], a[136:139], v[84:87], v[12:15]
    s_mov_b32 s58, s57
    v_add_u32 v139, s50, v139
    v_add_u32 v138, s50, v138
    v_mfma_f32_16x16x32_bf16 v[48:51], a[88:91], v[80:83], v[48:51]
    s_mov_b32 s57, s56
    ds_read_b128 v[236:239], v3 offset:42752
    v_add_u32 v137, s48, v137
    v_mfma_f32_16x16x32_bf16 v[228:231], a[112:115], v[80:83], v[228:231]
    s_mov_b32 s7, s6
    v_add_u32 v136, s48, v136
    v_add_u32 v135, s51, v135
    v_mfma_f32_16x16x32_bf16 v[36:39], a[136:139], v[80:83], v[36:39]
    s_waitcnt vmcnt(8) lgkmcnt(3)
    s_mov_b32 s6, s5
    ds_read_b64_tr_b16 a[144:145], v1 offset:0
    buffer_load_dwordx4 v26, s[32:35], s92 offen offset:2048 lds
    v_mfma_f32_16x16x32_bf16 v[160:163], a[88:91], v[56:59], v[160:163]
    s_add_u32 m0, s90, 49152
    ds_read_b64_tr_b16 a[146:147], v1 offset:768
    v_mfma_f32_16x16x32_bf16 v[32:35], a[112:115], v[56:59], v[32:35]
    s_mov_b32 s92, 148224
    ds_read_b64_tr_b16 a[168:169], v1 offset:8
    v_mfma_f32_16x16x32_bf16 v[100:103], a[136:139], v[56:59], v[100:103]
    s_mov_b32 s5, s4
    ds_read_b64_tr_b16 a[170:171], v1 offset:776
    v_mfma_f32_16x16x32_bf16 v[104:107], a[88:91], v[4:7], v[104:107]
    s_sub_u32 s14, s6, s7
    ds_read_b64_tr_b16 a[192:193], v0 offset:64
    buffer_load_dwordx4 v141, s[32:35], s92 offen offset:0 lds
    v_mfma_f32_16x16x32_bf16 v[168:171], a[112:115], v[4:7], v[168:171]
    s_add_u32 s61, s61, 1
    ds_read_b64_tr_b16 a[194:195], v0 offset:832
    v_add_u32 v134, s14, v134
    v_mfma_f32_16x16x32_bf16 v[164:167], a[136:139], v[4:7], v[164:167]
    s_waitcnt lgkmcnt(7)
    s_add_u32 s12, s12, 20
    ds_read_b128 v[232:235], v3 offset:256
    v_add_u32 v133, s14, v133
    v_mfma_f32_16x16x32_bf16 v[92:95], a[88:91], v[52:55], v[92:95]
    s_max_u32 s12, s12, s61
    ds_read_b128 v[4:7], v3 offset:1792
    v_mfma_f32_16x16x32_bf16 v[16:19], a[112:115], v[52:55], v[16:19]
    s_add_u32 s65, s65, 1
    ds_read_b128 v[224:227], v3 offset:3328
    v_mfma_f32_16x16x32_bf16 v[120:123], a[136:139], v[52:55], v[120:123]
    s_cmp_ge_i32 s65, 2
    buffer_load_dwordx4 v41, s[32:35], s92 offen offset:1024 lds
    v_mfma_f32_16x16x32_bf16 v[116:119], a[92:95], v[20:23], v[116:119]
    s_cselect_b32 s30, 100270464, 0
    ds_read_b128 v[84:87], v99 offset:3072
    v_mov_b32 v42, 0
    v_mfma_f32_16x16x32_bf16 v[44:47], a[116:119], v[20:23], v[44:47]
    s_add_u32 s67, s46, s54
    ds_read_b128 v[80:83], v3 offset:3072
    v_mov_b32 v43, 0
    v_mfma_f32_16x16x32_bf16 v[12:15], a[140:143], v[20:23], v[12:15]
    s_waitcnt lgkmcnt(7)
    ds_read_b128 v[56:59], v99 offset:3200
    v_cvt_pk_f16_f32 v116, v116, v117
    v_mfma_f32_16x16x32_bf16 v[48:51], a[92:95], v[236:239], v[48:51]
    ds_read_b128 v[52:55], v3 offset:3200
    v_cvt_pk_f16_f32 v117, v118, v119
    v_mfma_f32_16x16x32_bf16 v[228:231], a[116:119], v[236:239], v[228:231]
    ds_read_b128 v[20:23], v99 offset:3328
    buffer_load_dwordx4 v26, s[32:35], s92 offen offset:2048 lds
    v_mfma_f32_16x16x32_bf16 v[36:39], a[140:143], v[236:239], v[36:39]
    s_waitcnt vmcnt(9) lgkmcnt(7)
    s_add_u32 m0, s90, 61440
    ds_read_b64_tr_b16 a[148:149], v1 offset:12288
    v_cvt_pk_f16_f32 v48, v48, v49
    v_mfma_f32_16x16x32_bf16 v[160:163], a[92:95], v[232:235], v[160:163]
    s_mov_b32 s92, 185088
    ds_read_b64_tr_b16 a[150:151], v1 offset:13056
    v_cvt_pk_f16_f32 v49, v50, v51
    v_mfma_f32_16x16x32_bf16 v[32:35], a[116:119], v[232:235], v[32:35]
    ds_read_b64_tr_b16 a[172:173], v1 offset:12296
    v_pk_fma_f16 v143, v48, v48, s39
    v_mfma_f32_16x16x32_bf16 v[100:103], a[140:143], v[232:235], v[100:103]
    s_waitcnt lgkmcnt(8)
    ds_read_b64_tr_b16 a[174:175], v1 offset:13064
    v_pk_fmac_f16 v143, v49, v49
    v_mfma_f32_16x16x32_bf16 v[104:107], a[92:95], v[4:7], v[104:107]
    ds_read_b64_tr_b16 a[196:197], v0 offset:12352
    buffer_load_dwordx4 v141, s[32:35], s92 offen offset:0 lds
    v_mfma_f32_16x16x32_bf16 v[168:171], a[116:119], v[4:7], v[168:171]
    ds_read_b64_tr_b16 a[198:199], v0 offset:13120
    v_cvt_pk_f16_f32 v50, v228, v229
    v_mfma_f32_16x16x32_bf16 v[164:167], a[140:143], v[4:7], v[164:167]
    ds_read_b128 v[4:7], v3 offset:3328
    v_cvt_pk_f16_f32 v51, v230, v231
    v_mfma_f32_16x16x32_bf16 v[92:95], a[92:95], v[224:227], v[92:95]
    v_pk_fmac_f16 v143, v50, v50
    v_pk_fmac_f16 v143, v51, v51
    v_mfma_f32_16x16x32_bf16 v[16:19], a[116:119], v[224:227], v[16:19]
    v_cvt_pk_f16_f32 v36, v36, v37
    v_cvt_pk_f16_f32 v37, v38, v39
    v_mfma_f32_16x16x32_bf16 v[120:123], a[140:143], v[224:227], v[120:123]
    v_pk_fmac_f16 v143, v36, v36
    v_pk_fmac_f16 v143, v37, v37
    v_cvt_pk_f16_f32 v104, v104, v105
    v_cvt_pk_f16_f32 v105, v106, v107
    buffer_load_dwordx4 v41, s[32:35], s92 offen offset:1024 lds
    v_pk_fma_f16 v159, v104, v104, s39
    v_pk_fmac_f16 v159, v105, v105
    v_cvt_pk_f16_f32 v106, v168, v169
    v_cvt_pk_f16_f32 v107, v170, v171
    v_pk_fmac_f16 v159, v106, v106
    v_pk_fmac_f16 v159, v107, v107
    v_cvt_pk_f16_f32 v108, v164, v165
    v_cvt_pk_f16_f32 v109, v166, v167
    v_pk_fmac_f16 v159, v108, v108
    v_pk_fmac_f16 v159, v109, v109
    v_cvt_pk_f16_f32 v30, v160, v161
    v_cvt_pk_f16_f32 v31, v162, v163
    v_pk_fma_f16 v157, v30, v30, s39
    v_pk_fmac_f16 v157, v31, v31
    s_waitcnt vmcnt(8)
    ds_read_b64_tr_b16 a[152:153], v1 offset:24576
    buffer_load_dwordx4 v26, s[32:35], s92 offen offset:2048 lds
    s_add_u32 m0, s90, 0
    s_mov_b32 s92, 0
    ds_read_b64_tr_b16 a[154:155], v1 offset:25344
    v_cvt_pk_f16_f32 v32, v32, v33
    v_cvt_pk_f16_f32 v33, v34, v35
    v_pk_fmac_f16 v157, v32, v32
    ds_read_b64_tr_b16 a[176:177], v1 offset:24584
    v_pk_fmac_f16 v157, v33, v33
    v_cvt_pk_f16_f32 v34, v100, v101
    v_cvt_pk_f16_f32 v35, v102, v103
    ds_read_b64_tr_b16 a[178:179], v1 offset:25352
    v_pk_fmac_f16 v157, v34, v34
    ds_read_b64_tr_b16 a[200:201], v0 offset:24640
    buffer_load_dwordx4 v62, s[76:79], s92 offen offset:0 lds
    ds_read_b64_tr_b16 a[202:203], v0 offset:25408
    v_pk_fmac_f16 v157, v35, v35
    v_pk_fma_f16 v141, v116, v116, s39
    v_pk_fmac_f16 v141, v117, v117
    v_mfma_f32_16x16x32_f16 v[100:103], v[212:215], v[156:159], 0
    v_cvt_pk_f16_f32 v118, v44, v45
    v_cvt_pk_f16_f32 v119, v46, v47
    v_pk_fmac_f16 v141, v118, v118
    v_pk_fmac_f16 v141, v119, v119
    v_cvt_pk_f16_f32 v44, v12, v13
    v_cvt_pk_f16_f32 v45, v14, v15
    v_pk_fmac_f16 v141, v44, v44
    v_pk_fmac_f16 v141, v45, v45
    v_cvt_pk_f16_f32 v14, v92, v93
    v_cvt_pk_f16_f32 v15, v94, v95
    v_mfma_f32_16x16x32_f16 v[92:95], v[212:215], v[140:143], 0
    s_nop 0
    buffer_load_dwordx4 v111, s[76:79], s92 offen offset:1024 lds
    v_pk_fma_f16 v41, v14, v14, s39
    v_pk_fmac_f16 v41, v15, v15
    v_cvt_pk_f16_f32 v16, v16, v17
    v_cvt_pk_f16_f32 v17, v18, v19
    v_pk_fmac_f16 v41, v16, v16
    v_pk_fmac_f16 v41, v17, v17
    v_or3_b32 v125, v125, v92, v93
    v_rsq_f32 v92, v92
    v_rsq_f32 v93, v93
    v_mul_f32 v92, s52, v92
    v_cvt_pk_f16_f32 v92, v92, v93
    v_or3_b32 v125, v125, v94, v95
    v_rsq_f32 v94, v94
    v_rsq_f32 v95, v95
    s_waitcnt vmcnt(8)
    ds_read_b64_tr_b16 a[156:157], v1 offset:36864
    buffer_load_dwordx4 v63, s[76:79], s92 offen offset:2048 lds
    s_add_u32 m0, s90, 12288
    s_mov_b32 s92, 12288
    ds_read_b64_tr_b16 a[158:159], v1 offset:37632
    v_mul_f32 v94, s52, v94
    v_cvt_pk_f16_f32 v94, v94, v95
    v_pk_mul_f16 v64, v64, v92 op_sel:[0,0] op_sel_hi:[1,0]
    ds_read_b64_tr_b16 a[180:181], v1 offset:36872
    v_pk_mul_f16 v65, v65, v92 op_sel:[0,0] op_sel_hi:[1,0]
    v_pk_mul_f16 v66, v66, v92 op_sel:[0,0] op_sel_hi:[1,0]
    v_pk_mul_f16 v67, v67, v92 op_sel:[0,0] op_sel_hi:[1,0]
    ds_read_b64_tr_b16 a[182:183], v1 offset:37640
    s_waitcnt lgkmcnt(4)
    buffer_load_dwordx4 v62, s[76:79], s92 offen offset:0 lds
    v_pk_mul_f16 v24, v24, v92 op_sel:[0,0] op_sel_hi:[1,0]
    v_pk_mul_f16 v25, v25, v92 op_sel:[0,0] op_sel_hi:[1,0]
    ds_read_b64_tr_b16 a[204:205], v0 offset:36928
    v_pk_mul_f16 v116, v116, v92 op_sel:[0,1] op_sel_hi:[1,1]
    ds_read_b64_tr_b16 a[206:207], v0 offset:37696
    v_pk_mul_f16 v117, v117, v92 op_sel:[0,1] op_sel_hi:[1,1]
    v_pk_mul_f16 v118, v118, v92 op_sel:[0,1] op_sel_hi:[1,1]
    v_pk_mul_f16 v119, v119, v92 op_sel:[0,1] op_sel_hi:[1,1]
    v_pk_mul_f16 v44, v44, v92 op_sel:[0,1] op_sel_hi:[1,1]
    v_pk_mul_f16 v45, v45, v92 op_sel:[0,1] op_sel_hi:[1,1]
    v_fma_mix_f32 v26, v64, v116, 0 op_sel:[0,0,0] op_sel_hi:[1,1,0]
    v_fma_mix_f32 v26, v64, v116, v26 op_sel:[1,1,0] op_sel_hi:[1,1,0]
    v_fma_mix_f32 v26, v65, v117, v26 op_sel:[0,0,0] op_sel_hi:[1,1,0]
    v_fma_mix_f32 v26, v65, v117, v26 op_sel:[1,1,0] op_sel_hi:[1,1,0]
    v_fma_mix_f32 v26, v66, v118, v26 op_sel:[0,0,0] op_sel_hi:[1,1,0]
    buffer_load_dwordx4 v111, s[76:79], s92 offen offset:1024 lds
    v_fma_mix_f32 v26, v66, v118, v26 op_sel:[1,1,0] op_sel_hi:[1,1,0]
    v_fma_mix_f32 v26, v67, v119, v26 op_sel:[0,0,0] op_sel_hi:[1,1,0]
    v_fma_mix_f32 v26, v67, v119, v26 op_sel:[1,1,0] op_sel_hi:[1,1,0]
    v_fma_mix_f32 v26, v24, v44, v26 op_sel:[0,0,0] op_sel_hi:[1,1,0]
    v_fma_mix_f32 v26, v24, v44, v26 op_sel:[1,1,0] op_sel_hi:[1,1,0]
    v_fma_mix_f32 v26, v25, v45, v26 op_sel:[0,0,0] op_sel_hi:[1,1,0]
    v_fma_mix_f32 v26, v25, v45, v26 op_sel:[1,1,0] op_sel_hi:[1,1,0]
    v_mov_b32 v12, v26
    v_or3_b32 v125, v125, v100, v101
    v_rsq_f32 v100, v100
    v_permlane32_swap_b32 v12, v26
    v_add_f32 v26, v12, v26
    v_mov_b32 v12, v26
    v_rsq_f32 v101, v101
    s_waitcnt vmcnt(8)
    ds_read_b64_tr_b16 a[160:161], v1 offset:49152
    buffer_load_dwordx4 v63, s[76:79], s92 offen offset:2048 lds
    s_add_u32 m0, s90, 24576
    s_mov_b32 s92, 24576
    ds_read_b64_tr_b16 a[162:163], v1 offset:49920
    v_permlane16_swap_b32 v12, v26
    v_add_f32 v26, v12, v26
    ds_read_b64_tr_b16 a[184:185], v1 offset:49160
    v_mul_f32 v100, s52, v100
    v_cvt_pk_f16_f32 v100, v100, v101
    v_or3_b32 v125, v125, v102, v103
    ds_read_b64_tr_b16 a[186:187], v1 offset:49928
    v_rsq_f32 v102, v102
    ds_read_b64_tr_b16 a[208:209], v0 offset:49216
    buffer_load_dwordx4 v62, s[76:79], s92 offen offset:0 lds
    ds_read_b64_tr_b16 a[210:211], v0 offset:49984
    v_rsq_f32 v103, v103
    v_mul_f32 v102, s52, v102
    v_cvt_pk_f16_f32 v102, v102, v103
    v_pk_mul_f16 v30, v30, v100 op_sel:[0,1] op_sel_hi:[1,1]
    v_pk_mul_f16 v31, v31, v100 op_sel:[0,1] op_sel_hi:[1,1]
    v_pk_mul_f16 v32, v32, v100 op_sel:[0,1] op_sel_hi:[1,1]
    v_pk_mul_f16 v33, v33, v100 op_sel:[0,1] op_sel_hi:[1,1]
    v_pk_mul_f16 v34, v34, v100 op_sel:[0,1] op_sel_hi:[1,1]
    v_pk_mul_f16 v35, v35, v100 op_sel:[0,1] op_sel_hi:[1,1]
    v_pk_mul_f16 v88, v88, v100 op_sel:[0,0] op_sel_hi:[1,0]
    v_pk_mul_f16 v89, v89, v100 op_sel:[0,0] op_sel_hi:[1,0]
    v_pk_mul_f16 v90, v90, v100 op_sel:[0,0] op_sel_hi:[1,0]
    v_pk_mul_f16 v91, v91, v100 op_sel:[0,0] op_sel_hi:[1,0]
    buffer_load_dwordx4 v111, s[76:79], s92 offen offset:1024 lds
    v_pk_mul_f16 v154, v154, v100 op_sel:[0,0] op_sel_hi:[1,0]
    v_pk_mul_f16 v155, v155, v100 op_sel:[0,0] op_sel_hi:[1,0]
    v_pk_mul_f16 v104, v104, v102 op_sel:[0,1] op_sel_hi:[1,1]
    v_pk_mul_f16 v105, v105, v102 op_sel:[0,1] op_sel_hi:[1,1]
    v_pk_mul_f16 v106, v106, v102 op_sel:[0,1] op_sel_hi:[1,1]
    v_pk_mul_f16 v107, v107, v102 op_sel:[0,1] op_sel_hi:[1,1]
    v_pk_mul_f16 v108, v108, v102 op_sel:[0,1] op_sel_hi:[1,1]
    v_pk_mul_f16 v109, v109, v102 op_sel:[0,1] op_sel_hi:[1,1]
    v_pk_mul_f16 v76, v76, v102 op_sel:[0,0] op_sel_hi:[1,0]
    v_pk_mul_f16 v77, v77, v102 op_sel:[0,0] op_sel_hi:[1,0]
    v_pk_mul_f16 v78, v78, v102 op_sel:[0,0] op_sel_hi:[1,0]
    v_pk_mul_f16 v79, v79, v102 op_sel:[0,0] op_sel_hi:[1,0]
    v_pk_mul_f16 v150, v150, v102 op_sel:[0,0] op_sel_hi:[1,0]
    v_pk_mul_f16 v151, v151, v102 op_sel:[0,0] op_sel_hi:[1,0]
    v_add_f32 v26, s84, v26
    v_exp_f32 v26, v26
    buffer_load_dwordx4 v63, s[76:79], s92 offen offset:2048 lds
    s_add_u32 m0, s90, 36864
    s_mov_b32 s92, 36864
    s_waitcnt vmcnt(9)
    ds_read_b64_tr_b16 a[164:165], v1 offset:61440
    v_cvt_pk_bf16_f32 v26, v26, 0
    v_cmp_gt_u32 vcc, 16, v29
    v_cvt_pk_f16_f32 v18, v120, v121
    ds_read_b64_tr_b16 a[166:167], v1 offset:62208
    v_mfma_f32_16x16x32_bf16 v[100:103], v[84:87], a[144:147], 0
    v_cndmask_b32 v26, 0, v26, vcc
    v_cvt_pk_f16_f32 v19, v122, v123
    v_mfma_f32_16x16x32_bf16 v[100:103], v[80:83], a[148:151], v[100:103]
    ds_read_b64_tr_b16 a[188:189], v1 offset:61448
    v_pk_fmac_f16 v41, v18, v18
    v_mfma_f32_16x16x32_bf16 v[100:103], v[56:59], a[152:155], v[100:103]
    s_waitcnt lgkmcnt(3)
    buffer_load_dwordx4 v62, s[76:79], s92 offen offset:0 lds
    ds_read_b64_tr_b16 a[190:191], v1 offset:62216
    v_mfma_f32_16x16x32_bf16 v[100:103], v[52:55], a[156:159], v[100:103]
    v_pk_fmac_f16 v41, v19, v19
    v_pk_mul_f16 v72, v72, v94 op_sel:[0,0] op_sel_hi:[1,0]
    v_mfma_f32_16x16x32_bf16 v[100:103], v[20:23], a[160:163], v[100:103]
    s_waitcnt lgkmcnt(2)
    ds_read_b64_tr_b16 a[212:213], v0 offset:61504
    v_pk_mul_f16 v73, v73, v94 op_sel:[0,0] op_sel_hi:[1,0]
    v_pk_mul_f16 v74, v74, v94 op_sel:[0,0] op_sel_hi:[1,0]
    v_pk_mul_f16 v75, v75, v94 op_sel:[0,0] op_sel_hi:[1,0]
    ds_read_b64_tr_b16 a[214:215], v0 offset:62272
    v_pk_mul_f16 v60, v60, v94 op_sel:[0,0] op_sel_hi:[1,0]
    buffer_load_dwordx4 v111, s[76:79], s92 offen offset:1024 lds
    ds_write_b128 v28, v[64:67] offset:21504
    v_mfma_f32_16x16x32_bf16 v[100:103], v[4:7], a[164:167], v[100:103]
    v_pk_mul_f16 v61, v61, v94 op_sel:[0,0] op_sel_hi:[1,0]
    v_pk_mul_f16 v48, v48, v94 op_sel:[0,1] op_sel_hi:[1,1]
    v_mfma_f32_16x16x32_bf16 v[64:67], v[84:87], a[168:171], 0
    v_pk_mul_f16 v49, v49, v94 op_sel:[0,1] op_sel_hi:[1,1]
    v_pk_mul_f16 v50, v50, v94 op_sel:[0,1] op_sel_hi:[1,1]
    v_mfma_f32_16x16x32_bf16 v[64:67], v[80:83], a[172:175], v[64:67]
    ds_write_b128 v28, v[116:119] offset:21536
    v_mfma_f32_16x16x32_bf16 v[64:67], v[56:59], a[176:179], v[64:67]
    buffer_load_dwordx4 v63, s[76:79], s92 offen offset:2048 lds
    v_cvt_pk_bf16_f32 v164, v100, v101
    v_mfma_f32_16x16x32_bf16 v[64:67], v[52:55], a[180:183], v[64:67]
    s_add_u32 m0, s90, 49152
    v_cvt_pk_bf16_f32 v165, v102, v103
    v_pk_mul_f16 v51, v51, v94 op_sel:[0,1] op_sel_hi:[1,1]
    v_mfma_f32_16x16x32_bf16 v[64:67], v[20:23], a[184:187], v[64:67]
    s_waitcnt lgkmcnt(2)
    s_mov_b32 s92, 49152
    ds_write_b64 v28, v[44:45] offset:21552
    v_mfma_f32_16x16x32_bf16 v[64:67], v[4:7], a[188:191], v[64:67]
    v_pk_mul_f16 v36, v36, v94 op_sel:[0,1] op_sel_hi:[1,1]
    v_pk_mul_f16 v37, v37, v94 op_sel:[0,1] op_sel_hi:[1,1]
    v_mfma_f32_16x16x32_bf16 v[44:47], v[84:87], a[192:195], 0
    s_nop 0
    buffer_load_dwordx4 v62, s[76:79], s92 offen offset:0 lds
    ds_read_b128 v[100:103], v99 offset:40960
    v_mfma_f32_16x16x32_bf16 v[44:47], v[80:83], a[196:199], v[44:47]
    s_nop 0
    v_cvt_pk_bf16_f32 v160, v64, v65
    v_cvt_pk_bf16_f32 v161, v66, v67
    v_mfma_f32_16x16x32_bf16 v[44:47], v[56:59], a[200:203], v[44:47]
    ds_read_b128 v[64:67], v3 offset:40960
    v_mov_b32 v171, 0
    v_mfma_f32_16x16x32_bf16 v[44:47], v[52:55], a[204:207], v[44:47]
    ds_read_b128 v[56:59], v99 offset:41088
    v_mov_b32 v167, 0
    v_mfma_f32_16x16x32_bf16 v[44:47], v[20:23], a[208:211], v[44:47]
    ds_read_b128 v[52:55], v3 offset:41088
    v_mov_b32 v163, 0
    v_mfma_f32_16x16x32_bf16 v[44:47], v[4:7], a[212:215], v[44:47]
    buffer_load_dwordx4 v111, s[76:79], s92 offen offset:1024 lds
    ds_read_b128 v[20:23], v99 offset:41216
    v_mov_b32 v159, 0
    v_mov_b32 v152, 0
    v_mov_b32 v153, 0
    v_mfma_f32_16x16x32_f16 v[80:83], v[30:33], v[88:91], v[204:207]
    s_nop 0
    ds_read_b128 v[4:7], v3 offset:41216
    v_cvt_pk_bf16_f32 v156, v44, v45
    v_mfma_f32_16x16x32_f16 v[80:83], v[32:35], v[152:155], v[80:83]
    v_cvt_pk_bf16_f32 v157, v46, v47
    v_mov_b32 v148, 0
    v_mfma_f32_16x16x32_f16 v[120:123], v[104:107], v[88:91], v[200:203]
    v_mov_b32 v149, 0
    v_mov_b32 v144, 0
    v_mfma_f32_16x16x32_f16 v[120:123], v[106:109], v[152:155], v[120:123]
    s_waitcnt lgkmcnt(5)
    v_mov_b32 v145, 0
    v_mov_b32 v140, 0
    v_mfma_f32_16x16x32_bf16 v[116:119], a[144:147], v[100:103], 0
    s_waitcnt lgkmcnt(4)
    buffer_load_dwordx4 v63, s[76:79], s92 offen offset:2048 lds
    v_mov_b32 v141, 0
    v_mfma_f32_16x16x32_bf16 v[116:119], a[148:151], v[64:67], v[116:119]
    s_waitcnt lgkmcnt(3)
    s_add_u32 m0, s90, 61440
    v_exp_f32 v80, v80
    v_mfma_f32_16x16x32_bf16 v[116:119], a[152:155], v[56:59], v[116:119]
    s_waitcnt lgkmcnt(2)
    s_mov_b32 s92, 61440
    v_exp_f32 v81, v81
    v_mfma_f32_16x16x32_bf16 v[116:119], a[156:159], v[52:55], v[116:119]
    s_waitcnt lgkmcnt(1)
    ds_write_b128 v28, v[24:27] offset:21520
    v_mfma_f32_16x16x32_bf16 v[116:119], a[160:163], v[20:23], v[116:119]
    s_waitcnt lgkmcnt(1)
    buffer_load_dwordx4 v62, s[76:79], s92 offen offset:0 lds
    v_cvt_pk_bf16_f32 v92, v80, v81
    v_mfma_f32_16x16x32_bf16 v[116:119], a[164:167], v[4:7], v[116:119]
    v_exp_f32 v82, v82
    v_mfma_f32_16x16x32_bf16 v[24:27], a[168:171], v[100:103], 0
    s_nop 0
    ds_read_b128 v[224:227], v134 offset:32
    v_fma_mix_f32 v62, v72, v48, 0 op_sel:[0,0,0] op_sel_hi:[1,1,0]
    v_mfma_f32_16x16x32_bf16 v[24:27], a[172:175], v[64:67], v[24:27]
    s_nop 0
    ds_read_b64 v[228:229], v134 offset:48
    v_cvt_pk_bf16_f32 v46, v116, v117
    v_mfma_f32_16x16x32_bf16 v[24:27], a[176:179], v[56:59], v[24:27]
    ds_read_b128 v[84:87], v134 offset:0
    v_cvt_pk_bf16_f32 v47, v118, v119
    v_mfma_f32_16x16x32_bf16 v[24:27], a[180:183], v[52:55], v[24:27]
    buffer_load_dwordx4 v111, s[76:79], s92 offen offset:1024 lds
    ds_read_b64 v[142:143], v134 offset:16
    v_mfma_f32_16x16x32_bf16 v[24:27], a[184:187], v[20:23], v[24:27]
    ds_write_b64 v28, v[46:47] offset:21560
    v_mfma_f32_16x16x32_bf16 v[24:27], a[188:191], v[4:7], v[24:27]
    v_exp_f32 v83, v83
    v_mfma_f32_16x16x32_bf16 v[44:47], a[192:195], v[100:103], 0
    ds_read_b128 v[100:103], v99 offset:42496
    v_cvt_pk_bf16_f32 v93, v82, v83
    v_mfma_f32_16x16x32_bf16 v[44:47], a[196:199], v[64:67], v[44:47]
    ds_read_b128 v[80:83], v3 offset:42496
    buffer_load_dwordx4 v63, s[76:79], s92 offen offset:2048 lds
    v_mfma_f32_16x16x32_bf16 v[44:47], a[200:203], v[56:59], v[44:47]
    s_add_u32 m0, s54, 20480
    ds_read_b128 v[64:67], v99 offset:42624
    v_cvt_pk_bf16_f32 v24, v24, v25
    v_mfma_f32_16x16x32_bf16 v[44:47], a[204:207], v[52:55], v[44:47]
    ds_read_b128 v[56:59], v3 offset:42624
    v_cvt_pk_bf16_f32 v25, v26, v27
    v_mfma_f32_16x16x32_bf16 v[44:47], a[208:211], v[20:23], v[44:47]
    ds_read_b128 v[52:55], v99 offset:42752
    v_fma_mix_f32 v62, v72, v48, v62 op_sel:[1,1,0] op_sel_hi:[1,1,0]
    v_mfma_f32_16x16x32_bf16 v[44:47], a[212:215], v[4:7], v[44:47]
    s_waitcnt lgkmcnt(7)
    ds_read_b128 v[4:7], v3 offset:42752
    v_fma_mix_f32 v62, v73, v49, v62 op_sel:[0,0,0] op_sel_hi:[1,1,0]
    v_mfma_f32_16x16x32_f16 v[116:119], v[224:227], v[88:91], v[208:211]
    v_exp_f32 v120, v120
    v_mfma_f32_16x16x32_f16 v[116:119], v[226:229], v[152:155], v[116:119]
    s_nop 0
    buffer_load_dwordx4 v130, s[24:27], s56 offen nt lds
    v_cvt_pk_bf16_f32 v26, v44, v45
    v_mfma_f32_16x16x32_f16 v[20:23], v[84:87], v[30:33], v[208:211]
    s_waitcnt lgkmcnt(6)
    s_add_u32 m0, s54, 21504
    v_cvt_pk_bf16_f32 v27, v46, v47
    v_fma_mix_f32 v62, v73, v49, v62 op_sel:[1,1,0] op_sel_hi:[1,1,0]
    v_mfma_f32_16x16x32_f16 v[20:23], v[140:143], v[32:35], v[20:23]
    ds_write_b128 v28, v[24:27] offset:21568
    v_mfma_f32_16x16x32_f16 v[24:27], v[84:87], v[104:107], v[208:211]
    v_exp_f32 v121, v121
    v_mfma_f32_16x16x32_f16 v[24:27], v[140:143], v[106:109], v[24:27]
    s_waitcnt lgkmcnt(3)
    buffer_load_dwordx4 v129, s[24:27], s56 offen nt lds
    v_cvt_pk_bf16_f32 v94, v120, v121
    v_mfma_f32_16x16x32_bf16 v[44:47], a[144:147], v[100:103], 0
    s_add_u32 m0, s54, 22528
    ds_read_u16 v166, v133 offset:56
    v_fma_mix_f32 v62, v74, v50, v62 op_sel:[0,0,0] op_sel_hi:[1,1,0]
    v_mfma_f32_16x16x32_bf16 v[44:47], a[148:151], v[80:83], v[44:47]
    ds_read_u16 v162, v133 offset:64
    v_mov_b32_dpp v23, v27 quad_perm:[0,1,2,3] row_mask:0x2 bank_mask:0xf
    v_mfma_f32_16x16x32_bf16 v[44:47], a[152:155], v[64:67], v[44:47]
    ds_read_u16 v158, v133 offset:72
    v_fma_mix_f32 v62, v74, v50, v62 op_sel:[1,1,0] op_sel_hi:[1,1,0]
    v_mfma_f32_16x16x32_bf16 v[44:47], a[156:159], v[56:59], v[44:47]
    s_waitcnt lgkmcnt(4)
    v_exp_f32 v122, v122
    v_mfma_f32_16x16x32_bf16 v[44:47], a[160:163], v[52:55], v[44:47]
    buffer_load_dwordx4 v128, s[24:27], s56 offen nt lds
    v_fma_mix_f32 v62, v75, v51, v62 op_sel:[0,0,0] op_sel_hi:[1,1,0]
    v_mfma_f32_16x16x32_bf16 v[44:47], a[164:167], v[4:7], v[44:47]
    s_add_u32 m0, s54, 23552
    v_exp_f32 v123, v123
    v_mfma_f32_16x16x32_bf16 v[24:27], a[168:171], v[100:103], 0
    v_cvt_pk_bf16_f32 v95, v122, v123
    v_fma_mix_f32 v62, v75, v51, v62 op_sel:[1,1,0] op_sel_hi:[1,1,0]
    v_mfma_f32_16x16x32_bf16 v[24:27], a[172:175], v[80:83], v[24:27]
    v_exp_f32 v116, v116
    v_mfma_f32_16x16x32_bf16 v[24:27], a[176:179], v[64:67], v[24:27]
    v_cvt_pk_bf16_f32 v170, v116, 0
    v_cvt_pk_bf16_f32 v38, v44, v45
    v_mfma_f32_16x16x32_bf16 v[24:27], a[180:183], v[56:59], v[24:27]
    buffer_load_dwordx4 v127, s[24:27], s56 offen nt lds
    v_cvt_pk_bf16_f32 v39, v46, v47
    v_mfma_f32_16x16x32_bf16 v[24:27], a[184:187], v[52:55], v[24:27]
    s_add_u32 m0, s54, 24576
    v_fma_mix_f32 v62, v60, v36, v62 op_sel:[0,0,0] op_sel_hi:[1,1,0]
    v_fma_mix_f32 v62, v60, v36, v62 op_sel:[1,1,0] op_sel_hi:[1,1,0]
    v_mfma_f32_16x16x32_bf16 v[24:27], a[188:191], v[4:7], v[24:27]
    v_fma_mix_f32 v62, v61, v37, v62 op_sel:[0,0,0] op_sel_hi:[1,1,0]
    v_fma_mix_f32 v62, v61, v37, v62 op_sel:[1,1,0] op_sel_hi:[1,1,0]
    v_mfma_f32_16x16x32_bf16 v[44:47], a[192:195], v[100:103], 0
    s_nop 0
    v_mov_b32 v111, v62
    v_mov_b32 v63, 0
    v_mfma_f32_16x16x32_bf16 v[44:47], a[196:199], v[80:83], v[44:47]
    s_nop 0
    v_cvt_pk_bf16_f32 v24, v24, v25
    v_cvt_pk_bf16_f32 v25, v26, v27
    v_mfma_f32_16x16x32_bf16 v[44:47], a[200:203], v[64:67], v[44:47]
    buffer_load_dwordx4 v126, s[24:27], s56 offen nt lds
    v_mfma_f32_16x16x32_bf16 v[44:47], a[204:207], v[56:59], v[44:47]
    s_cmp_lt_u32 s61, s71
    v_permlane32_swap_b32 v111, v62
    v_mfma_f32_16x16x32_bf16 v[44:47], a[208:211], v[52:55], v[44:47]
    s_cselect_b32 s15, s61, s12
    v_add_f32 v62, v111, v62
    v_mov_b32 v111, v62
    v_mfma_f32_16x16x32_bf16 v[44:47], a[212:215], v[4:7], v[44:47]
    s_cselect_b32 s56, s69, s70
    v_permlane16_swap_b32 v111, v62
    v_mfma_f32_16x16x32_f16 v[4:7], v[30:33], v[76:79], v[192:195]
    s_add_u32 s56, s56, s15
    ds_read_b128 v[120:123], v99 offset:0
    v_add_f32 v62, v111, v62
    v_mfma_f32_16x16x32_f16 v[4:7], v[32:35], v[148:151], v[4:7]
    s_mul_i32 s53, s56, 58255
    ds_read_b128 v[116:119], v3 offset:0
    v_cvt_pk_bf16_f32 v26, v44, v45
    v_mfma_f32_16x16x32_f16 v[232:235], v[104:107], v[76:79], v[188:191]
    s_lshr_b32 s53, s53, 22
    ds_read_b128 v[100:103], v99 offset:128
    v_cvt_pk_bf16_f32 v27, v46, v47
    v_mfma_f32_16x16x32_f16 v[232:235], v[106:109], v[148:151], v[232:235]
    s_mul_i32 s53, s53, s63
    ds_read_b128 v[80:83], v3 offset:128
    v_add_f32 v62, s84, v62
    v_exp_f32 v62, v62
    s_mul_i32 s56, s56, s62
    s_add_u32 s56, s56, s53
    s_mul_i32 s4, s15, 336
    s_cmp_ge_u32 s15, 16
    s_cselect_b32 s53, -26880, 0
    s_add_u32 s4, s4, s53
    s_cmp_lt_u32 s15, s73
    s_cselect_b32 s26, 100270464, 0
    s_cselect_b32 s56, s56, 0
    s_cselect_b32 s4, s4, -1
    s_cselect_b32 s15, s15, 0
    s_cselect_b32 s13, s13, -1
    s_bitset1_b32 s64, s15
    v_mfma_f32_16x16x32_f16 v[64:67], v[224:227], v[76:79], v[208:211]
    s_add_u32 m0, s67, 0
    ds_read_b128 v[44:47], v99 offset:256
    v_cvt_pk_bf16_f32 v62, v62, 0
    v_mfma_f32_16x16x32_f16 v[64:67], v[226:229], v[148:151], v[64:67]
    ds_read_b128 v[56:59], v3 offset:256
    v_cmp_gt_u32 vcc, 16, v29
    v_mfma_f32_16x16x32_f16 v[236:239], v[212:215], v[40:43], 0
    s_waitcnt lgkmcnt(4)
    v_exp_f32 v4, v4
    v_mfma_f32_16x16x32_bf16 v[52:55], v[120:123], a[144:147], 0
    v_exp_f32 v5, v5
    v_mfma_f32_16x16x32_bf16 v[52:55], v[116:119], a[148:151], v[52:55]
    s_waitcnt lgkmcnt(2)
    s_nop 0
    v_cndmask_b32 v62, 0, v62, vcc
    v_or3_b32 v125, v125, v236, v237
    v_mfma_f32_16x16x32_bf16 v[52:55], v[100:103], a[152:155], v[52:55]
    v_rsq_f32 v236, v236
    v_mfma_f32_16x16x32_bf16 v[52:55], v[80:83], a[156:159], v[52:55]
    v_rsq_f32 v237, v237
    v_mul_f32 v236, s52, v236
    v_cvt_pk_f16_f32 v236, v236, v237
    v_pk_mul_f16 v14, v14, v236 op_sel:[0,1] op_sel_hi:[1,1]
    v_pk_mul_f16 v15, v15, v236 op_sel:[0,1] op_sel_hi:[1,1]
    v_pk_mul_f16 v16, v16, v236 op_sel:[0,1] op_sel_hi:[1,1]
    v_pk_mul_f16 v17, v17, v236 op_sel:[0,1] op_sel_hi:[1,1]
    v_pk_mul_f16 v18, v18, v236 op_sel:[0,1] op_sel_hi:[1,1]
    v_pk_mul_f16 v19, v19, v236 op_sel:[0,1] op_sel_hi:[1,1]
    v_pk_mul_f16 v240, v240, v236 op_sel:[0,0] op_sel_hi:[1,0]
    s_waitcnt lgkmcnt(1)
    v_mfma_f32_16x16x32_bf16 v[52:55], v[44:47], a[160:163], v[52:55]
    s_waitcnt vmcnt(5) lgkmcnt(0)
    s_barrier
    v_pk_mul_f16 v241, v241, v236 op_sel:[0,0] op_sel_hi:[1,0]
    v_pk_mul_f16 v242, v242, v236 op_sel:[0,0] op_sel_hi:[1,0]
    v_mfma_f32_16x16x32_bf16 v[52:55], v[56:59], a[164:167], v[52:55]
    v_pk_mul_f16 v243, v243, v236 op_sel:[0,0] op_sel_hi:[1,0]
    v_pk_mul_f16 v146, v146, v236 op_sel:[0,0] op_sel_hi:[1,0]
    v_mfma_f32_16x16x32_f16 v[40:43], v[14:17], v[88:91], v[196:199]
    s_nop 0
    v_pk_mul_f16 v147, v147, v236 op_sel:[0,0] op_sel_hi:[1,0]
    v_cvt_pk_bf16_f32 v96, v4, v5
    v_mfma_f32_16x16x32_f16 v[40:43], v[16:19], v[152:155], v[40:43]
    s_nop 0
    v_cvt_pk_bf16_f32 v12, v52, v53
    v_cvt_pk_bf16_f32 v13, v54, v55
    v_mfma_f32_16x16x32_f16 v[52:55], v[84:87], v[14:17], v[208:211]
    s_nop 0
    v_exp_f32 v6, v6
    v_mfma_f32_16x16x32_f16 v[52:55], v[140:143], v[16:19], v[52:55]
    s_nop 0
    v_exp_f32 v40, v40
    v_mfma_f32_16x16x32_f16 v[84:87], v[14:17], v[76:79], v[184:187]
    v_exp_f32 v41, v41
    v_mfma_f32_16x16x32_f16 v[84:87], v[16:19], v[148:151], v[84:87]
    v_exp_f32 v42, v42
    v_mfma_f32_16x16x32_bf16 v[88:91], v[120:123], a[168:171], 0
    s_nop 0
    v_mov_b32_dpp v23, v55 quad_perm:[0,1,2,3] row_mask:0x4 bank_mask:0xf
    v_cvt_pk_bf16_f32 v168, v40, v41
    v_mfma_f32_16x16x32_bf16 v[88:91], v[116:119], a[172:175], v[88:91]
    v_exp_f32 v23, v23
    v_mfma_f32_16x16x32_bf16 v[88:91], v[100:103], a[176:179], v[88:91]
    v_exp_f32 v43, v43
    v_mfma_f32_16x16x32_bf16 v[88:91], v[80:83], a[180:183], v[88:91]
    s_lshl_b32 s93, s68, 10
    v_cvt_pk_bf16_f32 v23, v23, v23
    v_cvt_pk_bf16_f32 v169, v42, v43
    v_mfma_f32_16x16x32_bf16 v[88:91], v[44:47], a[184:187], v[88:91]
    s_mov_b32 s53, s47
    ds_write_b16 v133, v23
    v_mfma_f32_16x16x32_bf16 v[88:91], v[56:59], a[188:191], v[88:91]
    s_mov_b32 s47, s46
    ds_read_b128 v[76:79], v134
    v_add_u32 v247, s93, v131
    v_mfma_f32_16x16x32_bf16 v[52:55], v[220:223], v[92:95], 0
    s_mov_b32 s46, s45
    ds_read_b128 v[40:43], v134 offset:16
    v_mfma_f32_16x16x32_bf16 v[52:55], v[220:223], v[168:171], v[52:55]
    s_mov_b32 s45, s44
    ds_read_b128 v[252:255], v9 offset:0
    v_cvt_pk_bf16_f32 v0, v88, v89
    v_mfma_f32_16x16x32_bf16 v[20:23], v[120:123], a[192:195], 0
    s_mov_b32 s44, s53
    ds_read_b64 v[88:89], v8 offset:64
    v_cvt_pk_bf16_f32 v1, v90, v91
    v_mfma_f32_16x16x32_bf16 v[20:23], v[116:119], a[196:199], v[20:23]
    s_sub_u32 s48, s44, s46
    ds_read_b128 v[236:239], v9 offset:3072
    v_add_u32 v139, s48, v139
    v_mfma_f32_16x16x32_bf16 v[20:23], v[100:103], a[200:203], v[20:23]
    s_sub_u32 s49, s46, s45
    ds_read_b64 v[90:91], v8 offset:3136
    v_add_u32 v138, s48, v138
    v_mfma_f32_16x16x32_bf16 v[20:23], v[80:83], a[204:207], v[20:23]
    ds_read_b128 v[80:83], v9 offset:6144
    v_mfma_f32_16x16x32_bf16 v[20:23], v[44:47], a[208:211], v[20:23]
    ds_read_b64 v[44:45], v8 offset:6208
    v_mfma_f32_16x16x32_bf16 v[20:23], v[56:59], a[212:215], v[20:23]
    ds_read_b128 v[116:119], v9 offset:9216
    v_mfma_f32_16x16x32_f16 v[100:103], v[30:33], v[240:243], v[180:183]
    s_nop 0
    ds_read_b64 v[46:47], v8 offset:9280
    s_nop 0
    v_mfma_f32_16x16x32_f16 v[100:103], v[32:35], v[144:147], v[100:103]
    s_nop 0
    ds_read_b128 v[56:59], v9 offset:12288
    v_cvt_pk_bf16_f32 v4, v20, v21
    v_mfma_f32_16x16x32_f16 v[32:35], v[104:107], v[240:243], v[176:179]
    ds_read_b64 v[120:121], v8 offset:12352
    v_cvt_pk_bf16_f32 v5, v22, v23
    v_mfma_f32_16x16x32_f16 v[32:35], v[106:109], v[144:147], v[32:35]
    ds_read_b128 v[104:107], v9 offset:15360
    v_mfma_f32_16x16x32_f16 v[20:23], v[14:17], v[240:243], v[172:175]
    ds_read_b64 v[122:123], v8 offset:15424
    v_mfma_f32_16x16x32_f16 v[20:23], v[16:19], v[144:147], v[20:23]
    ds_read_b128 v[248:251], v9 offset:18432
    v_mfma_f32_16x16x32_f16 v[16:19], v[224:227], v[240:243], v[208:211]
    ds_read_b64 v[240:241], v8 offset:18496
    v_mfma_f32_16x16x32_f16 v[16:19], v[226:229], v[144:147], v[16:19]
    s_waitcnt lgkmcnt(8)
    ds_read_b128 v[224:227], v9 offset:21504
    v_mfma_f32_16x16x32_bf16 v[228:231], v[252:255], v[220:223], 0
    ds_read_b64 v[242:243], v8 offset:21568
    v_mfma_f32_16x16x32_bf16 v[228:231], v[236:239], v[220:223], v[228:231]
    ds_read_b128 v[236:239], v9 offset:24576
    v_mfma_f32_16x16x32_bf16 v[228:231], v[80:83], v[220:223], v[228:231]
    s_waitcnt lgkmcnt(8)
    ds_read_b64 v[80:81], v8 offset:24640
    v_mfma_f32_16x16x32_bf16 v[228:231], v[116:119], v[220:223], v[228:231]
    ds_read_b128 v[116:119], v9 offset:27648
    v_mfma_f32_16x16x32_bf16 v[228:231], v[88:91], v[220:223], v[228:231]
    ds_read_b64 v[82:83], v8 offset:27712
    v_mfma_f32_16x16x32_bf16 v[228:231], v[44:47], v[220:223], v[228:231]
    ds_read_b128 v[88:91], v9 offset:30720
    v_mfma_f32_16x16x32_bf16 v[44:47], v[56:59], v[220:223], 0
    s_waitcnt lgkmcnt(8)
    ds_read_b64 v[56:57], v8 offset:30784
    s_nop 0
    v_mfma_f32_16x16x32_bf16 v[44:47], v[104:107], v[220:223], v[44:47]
    s_nop 0
    ds_read_b128 v[104:107], v9 offset:33792
    v_mul_f32 v228, 0xbbaaaaab, v228
    v_mfma_f32_16x16x32_bf16 v[44:47], v[248:251], v[220:223], v[44:47]
    s_waitcnt lgkmcnt(8)
    ds_read_b64 v[58:59], v8 offset:33856
    v_mul_f32 v229, 0xbbaaaaab, v229
    v_mfma_f32_16x16x32_bf16 v[44:47], v[224:227], v[220:223], v[44:47]
    ds_read_b128 v[224:227], v99 offset:1536
    v_mul_f32 v230, 0xbbaaaaab, v230
    v_mfma_f32_16x16x32_bf16 v[44:47], v[120:123], v[220:223], v[44:47]
    s_waitcnt lgkmcnt(8)
    ds_read_b128 v[120:123], v3 offset:1536
    v_mul_f32 v231, 0xbbaaaaab, v231
    v_mfma_f32_16x16x32_bf16 v[44:47], v[240:243], v[220:223], v[44:47]
    ds_write_b128 v2, v[228:231] offset:0
    v_mfma_f32_16x16x32_bf16 v[228:231], v[236:239], v[220:223], 0
    s_waitcnt lgkmcnt(7)
    v_exp_f32 v7, v7
    v_mfma_f32_16x16x32_bf16 v[228:231], v[116:119], v[220:223], v[228:231]
    s_waitcnt lgkmcnt(6)
    v_exp_f32 v232, v232
    v_mfma_f32_16x16x32_bf16 v[228:231], v[88:91], v[220:223], v[228:231]
    s_waitcnt lgkmcnt(4)
    ds_read_b128 v[88:91], v99 offset:1664
    v_cvt_pk_bf16_f32 v97, v6, v7
    v_exp_f32 v233, v233
    v_mfma_f32_16x16x32_bf16 v[228:231], v[104:107], v[220:223], v[228:231]
    ds_read_b128 v[116:119], v3 offset:1664
    v_cvt_pk_bf16_f32 v98, v232, v233
    v_mfma_f32_16x16x32_bf16 v[228:231], v[80:83], v[220:223], v[228:231]
    s_waitcnt lgkmcnt(4)
    ds_read_b128 v[104:107], v99 offset:1792
    v_mul_f32 v44, 0xbbaaaaab, v44
    v_mfma_f32_16x16x32_bf16 v[228:231], v[56:59], v[220:223], v[228:231]
    ds_read_b128 v[56:59], v3 offset:1792
    v_mul_f32 v45, 0xbbaaaaab, v45
    v_mfma_f32_16x16x32_bf16 v[80:83], v[224:227], a[144:147], 0
    s_waitcnt lgkmcnt(4)
    v_exp_f32 v234, v234
    v_mfma_f32_16x16x32_bf16 v[80:83], v[120:123], a[148:151], v[80:83]
    s_waitcnt lgkmcnt(3)
    v_exp_f32 v235, v235
    v_exp_f32 v84, v84
    v_cvt_pk_bf16_f32 v99, v234, v235
    v_exp_f32 v85, v85
    v_exp_f32 v86, v86
    v_exp_f32 v87, v87
    v_exp_f32 v65, v65
    v_mfma_f32_16x16x32_bf16 v[80:83], v[88:91], a[152:155], v[80:83]
    s_waitcnt lgkmcnt(2)
    v_rcp_f32 v52, v52
    v_mul_f32 v46, 0xbbaaaaab, v46
    v_mul_f32 v47, 0xbbaaaaab, v47
    v_mfma_f32_16x16x32_bf16 v[80:83], v[116:119], a[156:159], v[80:83]
    s_waitcnt lgkmcnt(0)
    ds_write_b128 v2, v[44:47] offset:128
    v_mfma_f32_16x16x32_bf16 v[80:83], v[104:107], a[160:163], v[80:83]
    s_barrier
    buffer_load_dwordx4 v130, s[24:27], s56 offen nt lds
    v_mul_f32 v228, 0xbbaaaaab, v228
    v_mfma_f32_16x16x32_bf16 v[80:83], v[56:59], a[164:167], v[80:83]
    s_add_u32 m0, s67, 1024
    v_mul_f32 v229, 0xbbaaaaab, v229
    v_mul_f32 v230, 0xbbaaaaab, v230
    v_mfma_f32_16x16x32_bf16 v[44:47], v[224:227], a[168:171], 0
    buffer_load_dwordx4 v129, s[24:27], s56 offen nt lds
    v_mul_f32 v231, 0xbbaaaaab, v231
    v_mfma_f32_16x16x32_bf16 v[44:47], v[120:123], a[172:175], v[44:47]
    s_add_u32 m0, s67, 2048
    ds_write_b128 v2, v[228:231] offset:256
    v_mfma_f32_16x16x32_bf16 v[44:47], v[88:91], a[176:179], v[44:47]
    buffer_load_dwordx4 v128, s[24:27], s56 offen nt lds
    v_cvt_pk_bf16_f32 v14, v80, v81
    v_mfma_f32_16x16x32_bf16 v[44:47], v[116:119], a[180:183], v[44:47]
    s_add_u32 m0, s67, 3072
    v_exp_f32 v100, v100
    v_mfma_f32_16x16x32_bf16 v[44:47], v[104:107], a[184:187], v[44:47]
    buffer_load_dwordx4 v127, s[24:27], s56 offen nt lds
    v_cvt_pk_bf16_f32 v15, v82, v83
    v_mfma_f32_16x16x32_bf16 v[44:47], v[56:59], a[188:191], v[44:47]
    s_add_u32 m0, s67, 4096
    v_exp_f32 v101, v101
    v_mfma_f32_16x16x32_bf16 v[80:83], v[12:15], v[92:95], 0
    s_nop 0
    buffer_load_dwordx4 v126, s[24:27], s56 offen nt lds
    v_cvt_pk_bf16_f32 v8, v100, v101
    v_mfma_f32_16x16x32_bf16 v[80:83], v[164:167], v[168:171], v[80:83]
    s_nop 0
    v_cvt_pk_bf16_f32 v2, v44, v45
    v_cvt_pk_bf16_f32 v3, v46, v47
    v_mfma_f32_16x16x32_bf16 v[44:47], v[224:227], a[192:195], 0
    v_exp_f32 v102, v102
    v_mfma_f32_16x16x32_bf16 v[44:47], v[120:123], a[196:199], v[44:47]
    s_waitcnt lgkmcnt(0)
    s_nop 0
    v_mul_f32 v80, v80, v52
    v_mul_f32 v81, v81, v52
    v_mfma_f32_16x16x32_bf16 v[44:47], v[88:91], a[200:203], v[44:47]
    s_barrier
    v_cvt_pk_bf16_f32 v88, v80, v81
    v_mul_f32 v82, v82, v52
    v_mfma_f32_16x16x32_bf16 v[44:47], v[116:119], a[204:207], v[44:47]
    v_exp_f32 v103, v103
    v_mfma_f32_16x16x32_bf16 v[44:47], v[104:107], a[208:211], v[44:47]
    v_mul_f32 v83, v83, v52
    v_cvt_pk_bf16_f32 v89, v82, v83
    v_mfma_f32_16x16x32_bf16 v[44:47], v[56:59], a[212:215], v[44:47]
    ds_write_b64 v137, v[88:89] offset:0
    v_mfma_f32_16x16x32_bf16 v[80:83], v[0:3], v[92:95], 0
    v_exp_f32 v32, v32
    v_mfma_f32_16x16x32_bf16 v[80:83], v[160:163], v[168:171], v[80:83]
    s_nop 0
    v_exp_f32 v33, v33
    v_mfma_f32_16x16x32_bf16 v[56:59], v[76:79], v[12:15], 0
    s_nop 0
    v_cvt_pk_bf16_f32 v6, v44, v45
    v_cvt_pk_bf16_f32 v7, v46, v47
    v_mfma_f32_16x16x32_bf16 v[56:59], v[40:43], v[164:167], v[56:59]
    s_nop 0
    v_mul_f32 v80, v80, v52
    v_mul_f32 v81, v81, v52
    v_mfma_f32_16x16x32_bf16 v[44:47], v[4:7], v[92:95], 0
    v_cvt_pk_bf16_f32 v90, v80, v81
    v_mul_f32 v82, v82, v52
    v_mfma_f32_16x16x32_bf16 v[44:47], v[156:159], v[168:171], v[44:47]
    v_mul_f32 v83, v83, v52
    v_cvt_pk_bf16_f32 v91, v82, v83
    v_mfma_f32_16x16x32_bf16 v[80:83], v[76:79], v[0:3], 0
    ds_write_b64 v137, v[90:91] offset:8
    v_mfma_f32_16x16x32_bf16 v[80:83], v[40:43], v[160:163], v[80:83]
    v_cvt_pk_bf16_f32 v168, v84, v85
    v_cvt_pk_bf16_f32 v169, v86, v87
    v_mfma_f32_16x16x32_bf16 v[88:91], v[76:79], v[4:7], 0
    s_nop 0
    ds_read_b128 v[76:79], v110 offset:49152
    v_cvt_pk_bf16_f32 v170, v65, 0
    v_mfma_f32_16x16x32_bf16 v[88:91], v[40:43], v[156:159], v[88:91]
    s_nop 0
    ds_read_b64 v[80:81], v71 offset:49216
    v_mul_f32 v44, v44, v52
    v_mfma_f32_16x16x32_bf16 v[40:43], v[220:223], v[96:99], 0
    ds_read_b128 v[84:87], v70 offset:5248
    v_mul_f32 v45, v45, v52
    v_mfma_f32_16x16x32_bf16 v[40:43], v[220:223], v[168:171], v[40:43]
    ds_read_b128 v[104:107], v110 offset:49920
    v_cvt_pk_bf16_f32 v68, v44, v45
    v_mfma_f32_16x16x32_bf16 v[92:95], v[12:15], v[96:99], 0
    ds_read_b64 v[108:109], v71 offset:49984
    v_mul_f32 v46, v46, v52
    v_mfma_f32_16x16x32_bf16 v[92:95], v[164:167], v[168:171], v[92:95]
    ds_read_b128 v[224:227], v70 offset:5312
    v_mul_f32 v47, v47, v52
    v_mfma_f32_16x16x32_bf16 v[52:55], v[0:3], v[96:99], 0
    ds_read_b128 v[64:67], v110 offset:24576
    v_cvt_pk_bf16_f32 v69, v46, v47
    v_mfma_f32_16x16x32_bf16 v[52:55], v[160:163], v[168:171], v[52:55]
    ds_write_b64 v136, v[68:69] offset:0
    v_mfma_f32_16x16x32_bf16 v[44:47], v[4:7], v[96:99], 0
    v_mov_b32_dpp v59, v83 quad_perm:[0,1,2,3] row_mask:0x2 bank_mask:0xf
    v_cvt_pk_bf16_f32 v9, v102, v103
    v_mfma_f32_16x16x32_bf16 v[44:47], v[156:159], v[168:171], v[44:47]
    s_waitcnt lgkmcnt(5)
    ds_read_b64 v[68:69], v71 offset:24640
    v_mov_b32_dpp v59, v91 quad_perm:[0,1,2,3] row_mask:0x4 bank_mask:0xf
    v_cvt_pk_bf16_f32 v59, v59, v59
    v_rcp_f32 v40, v40
    v_mfma_f32_16x16x16_bf16 v[120:123], v[76:77], v[10:11], v[84:87]
    ds_write_b16 v133, v59 offset:56
    v_mfma_f32_16x16x16_bf16 v[116:119], v[78:79], v[10:11], v[84:87]
    ds_read_b128 v[56:59], v70 offset:256
    v_mul_f32 v92, v92, v40
    v_mfma_f32_16x16x16_bf16 v[100:103], v[80:81], v[10:11], v[84:87]
    s_waitcnt lgkmcnt(5)
    s_nop 0
    ds_read_b128 v[78:81], v110 offset:25344
    v_cvt_pk_bf16_f32 v120, v120, v121
    v_mfma_f32_16x16x16_bf16 v[96:99], v[104:105], v[10:11], v[224:227]
    ds_read_b64 v[82:83], v71 offset:25408
    v_accvgpr_write_b32 a232, v120
    v_mfma_f32_16x16x16_bf16 v[88:91], v[106:107], v[10:11], v[224:227]
    ds_read_b128 v[228:231], v70 offset:320
    v_cvt_pk_bf16_f32 v122, v122, v123
    v_mfma_f32_16x16x16_bf16 v[84:87], v[108:109], v[10:11], v[224:227]
    s_nop 0
    ds_read_b128 v[104:107], v110 offset:61440
    v_accvgpr_write_b32 a233, v122
    v_cvt_pk_bf16_f32 v224, v116, v117
    v_cvt_pk_bf16_f32 v225, v118, v119
    v_cvt_pk_bf16_f32 v248, v100, v101
    v_cvt_pk_bf16_f32 v249, v102, v103
    v_cvt_pk_bf16_f32 v96, v96, v97
    v_accvgpr_write_b32 a234, v96
    v_cvt_pk_bf16_f32 v98, v98, v99
    v_accvgpr_write_b32 a235, v98
    v_cvt_pk_bf16_f32 v226, v88, v89
    v_cvt_pk_bf16_f32 v227, v90, v91
    v_cvt_pk_bf16_f32 v250, v84, v85
    v_cvt_pk_bf16_f32 v251, v86, v87
    ds_read_b64 v[108:109], v71 offset:61504
    v_mul_f32 v93, v93, v40
    s_waitcnt lgkmcnt(5)
    v_mfma_f32_16x16x16_bf16 v[232:235], v[64:65], v[10:11], v[56:59]
    ds_read_b128 v[88:91], v70 offset:5376
    v_cvt_pk_bf16_f32 v84, v92, v93
    v_mfma_f32_16x16x16_bf16 v[120:123], v[66:67], v[10:11], v[56:59]
    ds_read_b128 v[64:67], v110 offset:62208
    v_mul_f32 v94, v94, v40
    v_mfma_f32_16x16x16_bf16 v[116:119], v[68:69], v[10:11], v[56:59]
    s_waitcnt lgkmcnt(4)
    ds_read_b64 v[68:69], v71 offset:62272
    v_cvt_pk_bf16_f32 v232, v232, v233
    v_mfma_f32_16x16x16_bf16 v[56:59], v[78:79], v[10:11], v[228:231]
    ds_read_b128 v[236:239], v70 offset:5440
    v_accvgpr_write_b32 a224, v232
    v_mfma_f32_16x16x16_bf16 v[100:103], v[80:81], v[10:11], v[228:231]
    ds_read_b128 v[78:81], v110 offset:12288
    v_cvt_pk_bf16_f32 v234, v234, v235
    v_mfma_f32_16x16x16_bf16 v[96:99], v[82:83], v[10:11], v[228:231]
    ds_read_b64 v[82:83], v71 offset:12352
    v_accvgpr_write_b32 a225, v234
    v_cvt_pk_bf16_f32 v120, v120, v121
    v_accvgpr_write_b32 a248, v120
    v_cvt_pk_bf16_f32 v122, v122, v123
    v_accvgpr_write_b32 a249, v122
    v_cvt_pk_bf16_f32 v240, v116, v117
    v_cvt_pk_bf16_f32 v241, v118, v119
    v_cvt_pk_bf16_f32 v56, v56, v57
    v_accvgpr_write_b32 a226, v56
    v_cvt_pk_bf16_f32 v58, v58, v59
    v_accvgpr_write_b32 a227, v58
    v_cvt_pk_bf16_f32 v100, v100, v101
    v_accvgpr_write_b32 a250, v100
    v_cvt_pk_bf16_f32 v102, v102, v103
    s_waitcnt lgkmcnt(5)
    v_mfma_f32_16x16x16_bf16 v[232:235], v[104:105], v[10:11], v[88:91]
    ds_read_b128 v[56:59], v70 offset:128
    v_accvgpr_write_b32 a251, v102
    v_mfma_f32_16x16x16_bf16 v[228:231], v[106:107], v[10:11], v[88:91]
    ds_read_b128 v[104:107], v110 offset:13056
    v_cvt_pk_bf16_f32 v242, v96, v97
    v_mfma_f32_16x16x16_bf16 v[116:119], v[108:109], v[10:11], v[88:91]
    s_waitcnt lgkmcnt(4)
    ds_read_b64 v[108:109], v71 offset:13120
    v_cvt_pk_bf16_f32 v243, v98, v99
    v_mfma_f32_16x16x16_bf16 v[100:103], v[64:65], v[10:11], v[236:239]
    ds_read_b128 v[120:123], v70 offset:192
    v_cvt_pk_bf16_f32 v232, v232, v233
    v_mfma_f32_16x16x16_bf16 v[96:99], v[66:67], v[10:11], v[236:239]
    ds_read_b128 v[86:89], v110 offset:36864
    v_accvgpr_write_b32 a236, v232
    v_mfma_f32_16x16x16_bf16 v[64:67], v[68:69], v[10:11], v[236:239]
    ds_read_b64 v[90:91], v71 offset:36928
    v_cvt_pk_bf16_f32 v234, v234, v235
    v_accvgpr_write_b32 a237, v234
    v_cvt_pk_bf16_f32 v228, v228, v229
    v_cvt_pk_bf16_f32 v229, v230, v231
    v_cvt_pk_bf16_f32 v252, v116, v117
    v_cvt_pk_bf16_f32 v253, v118, v119
    v_cvt_pk_bf16_f32 v100, v100, v101
    v_accvgpr_write_b32 a238, v100
    v_cvt_pk_bf16_f32 v102, v102, v103
    v_accvgpr_write_b32 a239, v102
    v_cvt_pk_bf16_f32 v230, v96, v97
    v_cvt_pk_bf16_f32 v231, v98, v99
    v_cvt_pk_bf16_f32 v254, v64, v65
    v_cvt_pk_bf16_f32 v255, v66, v67
    s_waitcnt lgkmcnt(5)
    v_mfma_f32_16x16x16_bf16 v[116:119], v[78:79], v[10:11], v[56:59]
    ds_read_b128 v[76:79], v70 offset:5120
    v_mul_f32 v95, v95, v40
    v_mfma_f32_16x16x16_bf16 v[100:103], v[80:81], v[10:11], v[56:59]
    ds_read_b128 v[64:67], v110 offset:37632
    v_cvt_pk_bf16_f32 v85, v94, v95
    v_mfma_f32_16x16x16_bf16 v[96:99], v[82:83], v[10:11], v[56:59]
    s_waitcnt lgkmcnt(4)
    ds_read_b64 v[68:69], v71 offset:37696
    v_cvt_pk_bf16_f32 v116, v116, v117
    v_mfma_f32_16x16x16_bf16 v[56:59], v[104:105], v[10:11], v[120:123]
    ds_read_b128 v[232:235], v70 offset:5184
    v_accvgpr_write_b32 a220, v116
    v_mfma_f32_16x16x16_bf16 v[92:95], v[106:107], v[10:11], v[120:123]
    ds_read_b128 v[104:107], v110 offset:0
    v_cvt_pk_bf16_f32 v118, v118, v119
    v_mfma_f32_16x16x16_bf16 v[80:83], v[108:109], v[10:11], v[120:123]
    ds_read_b64 v[108:109], v71 offset:64
    v_accvgpr_write_b32 a221, v118
    v_cvt_pk_bf16_f32 v100, v100, v101
    v_accvgpr_write_b32 a244, v100
    v_cvt_pk_bf16_f32 v102, v102, v103
    v_accvgpr_write_b32 a245, v102
    v_cvt_pk_bf16_f32 v236, v96, v97
    v_cvt_pk_bf16_f32 v237, v98, v99
    v_cvt_pk_bf16_f32 v56, v56, v57
    v_accvgpr_write_b32 a222, v56
    v_cvt_pk_bf16_f32 v58, v58, v59
    v_accvgpr_write_b32 a223, v58
    v_cvt_pk_bf16_f32 v92, v92, v93
    v_accvgpr_write_b32 a246, v92
    v_cvt_pk_bf16_f32 v94, v94, v95
    s_waitcnt lgkmcnt(5)
    v_mfma_f32_16x16x16_bf16 v[56:59], v[86:87], v[10:11], v[76:79]
    ds_read_b128 v[100:103], v70 offset:0
    v_accvgpr_write_b32 a247, v94
    v_mfma_f32_16x16x16_bf16 v[120:123], v[88:89], v[10:11], v[76:79]
    ds_read_b128 v[92:95], v110 offset:768
    v_cvt_pk_bf16_f32 v238, v80, v81
    v_mfma_f32_16x16x16_bf16 v[116:119], v[90:91], v[10:11], v[76:79]
    s_waitcnt lgkmcnt(4)
    ds_read_b64 v[96:97], v71 offset:832
    v_cvt_pk_bf16_f32 v239, v82, v83
    v_mfma_f32_16x16x16_bf16 v[80:83], v[64:65], v[10:11], v[232:235]
    ds_read_b128 v[88:91], v70 offset:64
    v_cvt_pk_bf16_f32 v56, v56, v57
    v_mfma_f32_16x16x16_bf16 v[76:79], v[66:67], v[10:11], v[232:235]
    ds_write_b64 v137, v[84:85] offset:1536
    v_mfma_f32_16x16x16_bf16 v[64:67], v[68:69], v[10:11], v[232:235]
    v_accvgpr_write_b32 a228, v56
    v_cvt_pk_bf16_f32 v58, v58, v59
    v_accvgpr_write_b32 a229, v58
    v_cvt_pk_bf16_f32 v120, v120, v121
    v_accvgpr_write_b32 a252, v120
    v_cvt_pk_bf16_f32 v122, v122, v123
    v_accvgpr_write_b32 a253, v122
    v_cvt_pk_bf16_f32 v244, v116, v117
    v_cvt_pk_bf16_f32 v245, v118, v119
    v_cvt_pk_bf16_f32 v80, v80, v81
    v_accvgpr_write_b32 a230, v80
    v_cvt_pk_bf16_f32 v82, v82, v83
    v_accvgpr_write_b32 a231, v82
    v_cvt_pk_bf16_f32 v76, v76, v77
    s_waitcnt lgkmcnt(4)
    v_mfma_f32_16x16x16_bf16 v[84:87], v[104:105], v[10:11], v[100:103]
    v_accvgpr_write_b32 a254, v76
    v_cvt_pk_bf16_f32 v78, v78, v79
    v_mfma_f32_16x16x16_bf16 v[80:83], v[106:107], v[10:11], v[100:103]
    s_waitcnt vmcnt(5) lgkmcnt(2)
    v_accvgpr_write_b32 a255, v78
    v_cvt_pk_bf16_f32 v246, v64, v65
    v_mfma_f32_16x16x16_bf16 v[76:79], v[108:109], v[10:11], v[100:103]
    s_waitcnt lgkmcnt(1)
    s_barrier
    ds_write_b128 v247, v[112:115] offset:6144
    v_mfma_f32_16x16x16_bf16 v[68:71], v[92:93], v[10:11], v[88:91]
    v_cvt_pk_bf16_f32 v247, v66, v67
    v_cvt_pk_bf16_f32 v84, v84, v85
    v_mfma_f32_16x16x16_bf16 v[64:67], v[94:95], v[10:11], v[88:91]
    v_accvgpr_write_b32 a216, v84
    v_cvt_pk_bf16_f32 v86, v86, v87
    v_mfma_f32_16x16x16_bf16 v[56:59], v[96:97], v[10:11], v[88:91]
    ds_write_b128 v28, v[216:219] offset:80
    v_accvgpr_write_b32 a217, v86
    v_cvt_pk_bf16_f32 v80, v80, v81
    v_accvgpr_write_b32 a240, v80
    v_cvt_pk_bf16_f32 v82, v82, v83
    v_accvgpr_write_b32 a241, v82
    v_cvt_pk_bf16_f32 v232, v76, v77
    v_cvt_pk_bf16_f32 v233, v78, v79
    v_cvt_pk_bf16_f32 v68, v68, v69
    ds_write_b128 v28, v[72:75] offset:0
    v_accvgpr_write_b32 a218, v68
    v_cvt_pk_bf16_f32 v70, v70, v71
    v_accvgpr_write_b32 a219, v70
    v_cvt_pk_bf16_f32 v64, v64, v65
    v_accvgpr_write_b32 a242, v64
    v_cvt_pk_bf16_f32 v66, v66, v67
    v_accvgpr_write_b32 a243, v66
    v_cvt_pk_bf16_f32 v234, v56, v57
    ds_write_b128 v28, v[60:63] offset:16
    v_cvt_pk_bf16_f32 v235, v58, v59
    v_mul_f32 v52, v52, v40
    v_mul_f32 v53, v53, v40
    v_cvt_pk_bf16_f32 v86, v52, v53
    v_mul_f32 v54, v54, v40
    v_mul_f32 v55, v55, v40
    v_cvt_pk_bf16_f32 v87, v54, v55
    v_mul_f32 v44, v44, v40
    ds_write_b128 v28, v[48:51] offset:32
    v_mul_f32 v45, v45, v40
    v_cvt_pk_bf16_f32 v154, v44, v45
    v_mul_f32 v46, v46, v40
    v_mul_f32 v47, v47, v40
    v_cvt_pk_bf16_f32 v155, v46, v47
    v_exp_f32 v34, v34
    v_exp_f32 v35, v35
    ds_write_b128 v28, v[36:39] offset:48
    v_cvt_pk_bf16_f32 v10, v32, v33
    v_cvt_pk_bf16_f32 v11, v34, v35
    v_exp_f32 v20, v20
    v_exp_f32 v21, v21
    v_exp_f32 v22, v22
    ds_write_b128 v28, v[24:27] offset:64
    v_exp_f32 v23, v23
    v_cvt_pk_bf16_f32 v168, v20, v21
    v_cvt_pk_bf16_f32 v169, v22, v23
    v_exp_f32 v18, v18
    s_nop 0
    v_cvt_pk_bf16_f32 v170, v18, 0
    v_mfma_f32_16x16x32_bf16 v[76:79], v[220:223], v[8:11], 0
    ds_read_b128 v[68:71], v139 offset:0
    v_mfma_f32_16x16x32_bf16 v[76:79], v[220:223], v[168:171], v[76:79]
    ds_read_b128 v[60:63], v138 offset:0
    v_mfma_f32_16x16x32_bf16 v[96:99], v[12:15], v[8:11], 0
    ds_read_b128 v[52:55], v139 offset:128
    v_mfma_f32_16x16x32_bf16 v[96:99], v[164:167], v[168:171], v[96:99]
    ds_read_b128 v[48:51], v138 offset:128
    v_mfma_f32_16x16x32_bf16 v[16:19], v[0:3], v[8:11], 0
    ds_read_b128 v[56:59], v139 offset:256
    v_mfma_f32_16x16x32_bf16 v[16:19], v[160:163], v[168:171], v[16:19]
    ds_read_b128 v[64:67], v138 offset:256
    v_mfma_f32_16x16x32_bf16 v[0:3], v[4:7], v[8:11], 0
    ds_write_b32 v137, v86 offset:1544
    v_mfma_f32_16x16x32_bf16 v[0:3], v[156:159], v[168:171], v[0:3]
    s_waitcnt lgkmcnt(6)
    v_mfma_f32_16x16x32_bf16 v[20:23], a[0:3], v[68:71], 0
    s_waitcnt lgkmcnt(0)
.p2align 6
L_loopF0:
    v_mfma_f32_16x16x32_bf16 v[20:23], a[4:7], v[60:63], v[20:23]
    ds_write_b32 v137, v87 offset:1548
    v_mfma_f32_16x16x32_bf16 v[20:23], a[8:11], v[52:55], v[20:23]
    v_rcp_f32 v76, v76
    v_mfma_f32_16x16x32_bf16 v[20:23], a[12:15], v[48:51], v[20:23]
    v_mul_f32 v96, v96, v76
    v_mul_f32 v97, v97, v76
    v_mfma_f32_16x16x32_bf16 v[20:23], a[16:19], v[56:59], v[20:23]
    v_cvt_pk_bf16_f32 v84, v96, v97
    v_mul_f32 v98, v98, v76
    v_mfma_f32_16x16x32_bf16 v[20:23], a[20:23], v[64:67], v[20:23]
    ds_write_b64 v136, v[154:155] offset:1536
    v_mfma_f32_16x16x32_bf16 v[116:119], v[68:71], a[168:171], 0
    v_mul_f32 v99, v99, v76
    v_cvt_pk_bf16_f32 v85, v98, v99
    v_mfma_f32_16x16x32_bf16 v[116:119], v[60:63], a[172:175], v[116:119]
    v_mul_f32 v16, v16, v76
    v_mul_f32 v17, v17, v76
    v_mfma_f32_16x16x32_bf16 v[116:119], v[52:55], a[176:179], v[116:119]
    v_cvt_pk_bf16_f32 v86, v16, v17
    v_mul_f32 v18, v18, v76
    v_mfma_f32_16x16x32_bf16 v[116:119], v[48:51], a[180:183], v[116:119]
    ds_write_b64 v137, v[84:85] offset:3072
    v_mfma_f32_16x16x32_bf16 v[116:119], v[56:59], a[184:187], v[116:119]
    v_mul_f32 v19, v19, v76
    v_cvt_pk_bf16_f32 v87, v18, v19
    v_mfma_f32_16x16x32_bf16 v[116:119], v[64:67], a[188:191], v[116:119]
    v_mul_f32 v0, v0, v76
    v_mul_f32 v1, v1, v76
    v_mfma_f32_16x16x32_bf16 v[16:19], a[48:51], v[68:71], 0
    v_cvt_pk_bf16_f32 v154, v0, v1
    v_mul_f32 v2, v2, v76
    v_mfma_f32_16x16x32_bf16 v[16:19], a[52:55], v[60:63], v[16:19]
    ds_write_b64 v137, v[86:87] offset:3080
    v_mfma_f32_16x16x32_bf16 v[16:19], a[56:59], v[52:55], v[16:19]
    v_mul_f32 v3, v3, v76
    v_cvt_pk_bf16_f32 v155, v2, v3
    v_mfma_f32_16x16x32_bf16 v[16:19], a[60:63], v[48:51], v[16:19]
    v_fmac_f32 v114, v5, v5
    v_fmac_f32 v114, v6, v6
    v_mfma_f32_16x16x32_bf16 v[16:19], a[64:67], v[56:59], v[16:19]
    v_fmac_f32 v114, v7, v7
    v_fmac_f32 v114, v8, v8
    v_mfma_f32_16x16x32_bf16 v[16:19], a[68:71], v[64:67], v[16:19]
    ds_write_b32 v136, v154 offset:3072
    v_mfma_f32_16x16x32_bf16 v[84:87], a[72:75], v[68:71], 0
    v_fmac_f32 v114, v9, v9
    v_fmac_f32 v114, v10, v10
    v_mfma_f32_16x16x32_bf16 v[84:87], a[76:79], v[60:63], v[84:87]
    v_fmac_f32 v114, v11, v11
    v_fma_f32 v154, v44, v44, s42
    v_mfma_f32_16x16x32_bf16 v[84:87], a[80:83], v[52:55], v[84:87]
    ds_read_b128 v[76:79], v139 offset:1536
    v_fmac_f32 v154, v45, v45
    v_mfma_f32_16x16x32_bf16 v[84:87], a[84:87], v[48:51], v[84:87]
    ds_read_b128 v[80:83], v139 offset:1664
    v_fmac_f32 v154, v46, v46
    v_mfma_f32_16x16x32_bf16 v[84:87], a[88:91], v[56:59], v[84:87]
    v_fmac_f32 v154, v47, v47
    v_fmac_f32 v154, v40, v40
    v_mfma_f32_16x16x32_bf16 v[84:87], a[92:95], v[64:67], v[84:87]
    v_fmac_f32 v154, v41, v41
    v_fmac_f32 v154, v42, v42
    v_mfma_f32_16x16x32_bf16 v[0:3], a[120:123], v[68:71], 0
    v_fmac_f32 v154, v43, v43
    v_fmac_f32 v154, v32, v32
    v_mfma_f32_16x16x32_bf16 v[0:3], a[124:127], v[60:63], v[0:3]
    ds_write_b32 v136, v155 offset:3076
    v_mfma_f32_16x16x32_bf16 v[0:3], a[128:131], v[52:55], v[0:3]
    v_fmac_f32 v154, v33, v33
    v_fmac_f32 v154, v34, v34
    v_mfma_f32_16x16x32_bf16 v[0:3], a[132:135], v[48:51], v[0:3]
    v_fmac_f32 v154, v35, v35
    v_fma_f32 v155, v36, v36, s42
    v_mfma_f32_16x16x32_bf16 v[0:3], a[136:139], v[56:59], v[0:3]
    v_fmac_f32 v155, v37, v37
    v_fmac_f32 v155, v38, v38
    v_mfma_f32_16x16x32_bf16 v[0:3], a[140:143], v[64:67], v[0:3]
    v_fmac_f32 v155, v39, v39
    v_fmac_f32 v155, v28, v28
    v_mfma_f32_16x16x32_bf16 v[72:75], a[24:27], v[68:71], 0
    v_fmac_f32 v155, v29, v29
    v_fmac_f32 v155, v30, v30
    v_mfma_f32_16x16x32_bf16 v[72:75], a[28:31], v[60:63], v[72:75]
    ds_read_b128 v[96:99], v138 offset:1536
    v_fmac_f32 v155, v31, v31
    v_mfma_f32_16x16x32_bf16 v[72:75], a[32:35], v[52:55], v[72:75]
    s_waitcnt vmcnt(10)
    v_fmac_f32 v155, v24, v24
    v_fmac_f32 v155, v25, v25
    v_mfma_f32_16x16x32_bf16 v[72:75], a[36:39], v[48:51], v[72:75]
    v_fmac_f32 v155, v26, v26
    v_fmac_f32 v155, v27, v27
    v_mfma_f32_16x16x32_bf16 v[72:75], a[40:43], v[56:59], v[72:75]
    v_cvt_pk_bf16_f32 v154, v114, v154
    v_cvt_pk_bf16_f32 v155, v155, v124
    v_mfma_f32_16x16x32_bf16 v[72:75], a[44:47], v[64:67], v[72:75]
    ds_write_b64 v132, v[154:155]
    v_mfma_f32_16x16x32_bf16 v[104:107], v[68:71], a[192:195], 0
    v_add_u32 v137, s49, v137
    v_add_u32 v136, s49, v136
    v_mfma_f32_16x16x32_bf16 v[104:107], v[60:63], a[196:199], v[104:107]
    v_cvt_pk_f16_f32 v92, v20, v21
    v_cvt_pk_f16_f32 v93, v22, v23
    v_mfma_f32_16x16x32_bf16 v[104:107], v[52:55], a[200:203], v[104:107]
    v_pk_fma_f16 v88, v92, v92, s39
    v_pk_fmac_f16 v88, v93, v93
    v_mfma_f32_16x16x32_bf16 v[104:107], v[48:51], a[204:207], v[104:107]
    v_cvt_pk_f16_f32 v108, v0, v1
    v_cvt_pk_f16_f32 v109, v2, v3
    v_mfma_f32_16x16x32_bf16 v[104:107], v[56:59], a[208:211], v[104:107]
    v_cvt_pk_f16_f32 v94, v72, v73
    v_cvt_pk_f16_f32 v95, v74, v75
    v_mfma_f32_16x16x32_bf16 v[104:107], v[64:67], a[212:215], v[104:107]
    v_pk_fmac_f16 v88, v94, v94
    v_pk_fmac_f16 v88, v95, v95
    v_mfma_f32_16x16x32_bf16 v[72:75], a[96:99], v[68:71], 0
    v_cvt_pk_f16_f32 v154, v16, v17
    v_cvt_pk_f16_f32 v155, v18, v19
    v_mfma_f32_16x16x32_bf16 v[72:75], a[100:103], v[60:63], v[72:75]
    s_waitcnt lgkmcnt(0)
    ds_read_b128 v[100:103], v138 offset:1664
    v_pk_fmac_f16 v88, v154, v154
    v_mfma_f32_16x16x32_bf16 v[72:75], a[104:107], v[52:55], v[72:75]
    s_barrier
    ds_read_b128 v[16:19], v131 offset:0
    v_pk_fmac_f16 v88, v155, v155
    v_mfma_f32_16x16x32_bf16 v[72:75], a[108:111], v[48:51], v[72:75]
    ds_read_b128 v[110:113], v131 offset:1024
    v_cvt_pk_bf16_f32 v0, v116, v117
    v_mfma_f32_16x16x32_bf16 v[72:75], a[112:115], v[56:59], v[72:75]
    v_cvt_pk_bf16_f32 v1, v118, v119
    v_cvt_pk_bf16_f32 v20, v104, v105
    v_mfma_f32_16x16x32_bf16 v[72:75], a[116:119], v[64:67], v[72:75]
    ds_read_b128 v[116:119], v138 offset:1792
    v_cvt_pk_bf16_f32 v21, v106, v107
    v_mfma_f32_16x16x32_bf16 v[120:123], v[68:71], a[144:147], 0
    s_nop 0
    v_cvt_pk_f16_f32 v104, v84, v85
    v_cvt_pk_f16_f32 v105, v86, v87
    v_mfma_f32_16x16x32_bf16 v[120:123], v[60:63], a[148:151], v[120:123]
    s_nop 0
    v_cvt_pk_f16_f32 v106, v72, v73
    v_cvt_pk_f16_f32 v107, v74, v75
    v_mfma_f32_16x16x32_bf16 v[120:123], v[52:55], a[152:155], v[120:123]
    ds_read_b128 v[84:87], v139 offset:1792
    v_pk_fma_f16 v89, v104, v104, s39
    v_mfma_f32_16x16x32_bf16 v[120:123], v[48:51], a[156:159], v[120:123]
    v_pk_fmac_f16 v89, v105, v105
    v_pk_fmac_f16 v89, v106, v106
    v_mfma_f32_16x16x32_bf16 v[120:123], v[56:59], a[160:163], v[120:123]
    v_pk_fmac_f16 v89, v107, v107
    v_pk_fmac_f16 v89, v108, v108
    v_mfma_f32_16x16x32_bf16 v[120:123], v[64:67], a[164:167], v[120:123]
    s_waitcnt lgkmcnt(3)
    v_readfirstlane_b32 s12, v17
    v_pk_fmac_f16 v89, v109, v109
    v_mfma_f32_16x16x32_bf16 v[72:75], v[216:219], v[16:19], 0
    s_waitcnt lgkmcnt(2)
    s_nop 0
    v_mfma_f32_16x16x32_bf16 v[72:75], v[216:219], v[110:113], v[72:75]
    s_lshr_b32 s12, s12, 23
    v_cvt_pk_bf16_f32 v16, v120, v121
    v_cvt_pk_bf16_f32 v17, v122, v123
    v_mfma_f32_16x16x32_bf16 v[56:59], a[96:99], v[76:79], 0
    s_nop 1
    v_mfma_f32_16x16x32_bf16 v[56:59], a[100:103], v[96:99], v[56:59]
    s_nop 0
    v_rsq_f32 v72, v72
    v_mfma_f32_16x16x32_bf16 v[56:59], a[104:107], v[80:83], v[56:59]
    v_rsq_f32 v73, v73
    v_mfma_f32_16x16x32_bf16 v[56:59], a[108:111], v[100:103], v[56:59]
    s_waitcnt lgkmcnt(0)
    v_rsq_f32 v74, v74
    v_mfma_f32_16x16x32_bf16 v[56:59], a[112:115], v[84:87], v[56:59]
    v_mul_f32 v72, s43, v72
    v_mul_f32 v73, s43, v73
    v_mfma_f32_16x16x32_bf16 v[56:59], a[116:119], v[116:119], v[56:59]
    v_mul_f32 v74, s43, v74
    v_mul_f32 v44, v44, v73
    v_mfma_f32_16x16x32_bf16 v[60:63], a[48:51], v[76:79], 0
    s_nop 0
    v_mul_f32 v45, v45, v73
    v_cvt_pk_bf16_f32 v44, v44, v45
    v_mfma_f32_16x16x32_bf16 v[60:63], a[52:55], v[96:99], v[60:63]
    s_nop 0
    v_cvt_pk_f16_f32 v70, v56, v57
    v_cvt_pk_f16_f32 v71, v58, v59
    v_mfma_f32_16x16x32_bf16 v[60:63], a[56:59], v[80:83], v[60:63]
    v_mul_f32 v46, v46, v73
    v_mul_f32 v47, v47, v73
    v_mfma_f32_16x16x32_bf16 v[60:63], a[60:63], v[100:103], v[60:63]
    v_cvt_pk_bf16_f32 v45, v46, v47
    v_mul_f32 v40, v40, v73
    v_mfma_f32_16x16x32_bf16 v[60:63], a[64:67], v[84:87], v[60:63]
    ds_write_b64 v137, v[44:45] offset:1536
    v_mfma_f32_16x16x32_bf16 v[60:63], a[68:71], v[116:119], v[60:63]
    v_mul_f32 v41, v41, v73
    v_cvt_pk_bf16_f32 v46, v40, v41
    v_mfma_f32_16x16x32_bf16 v[66:69], a[24:27], v[76:79], 0
    s_nop 0
    v_mul_f32 v42, v42, v73
    v_mul_f32 v43, v43, v73
    v_mfma_f32_16x16x32_bf16 v[66:69], a[28:31], v[96:99], v[66:69]
    s_nop 0
    v_cvt_pk_f16_f32 v150, v60, v61
    v_cvt_pk_f16_f32 v151, v62, v63
    v_mfma_f32_16x16x32_bf16 v[66:69], a[32:35], v[80:83], v[66:69]
    v_cvt_pk_bf16_f32 v47, v42, v43
    v_mul_f32 v32, v32, v73
    v_mfma_f32_16x16x32_bf16 v[66:69], a[36:39], v[100:103], v[66:69]
    ds_write_b32 v137, v46 offset:1544
    v_mfma_f32_16x16x32_bf16 v[66:69], a[40:43], v[84:87], v[66:69]
    v_mul_f32 v33, v33, v73
    v_cvt_pk_bf16_f32 v2, v32, v33
    v_mfma_f32_16x16x32_bf16 v[66:69], a[44:47], v[116:119], v[66:69]
    v_mul_f32 v34, v34, v73
    v_mul_f32 v35, v35, v73
    v_mfma_f32_16x16x32_bf16 v[40:43], a[72:75], v[76:79], 0
    s_nop 0
    ds_read_b128 v[56:59], v138 offset:3328
    v_cvt_pk_bf16_f32 v3, v34, v35
    v_mfma_f32_16x16x32_bf16 v[40:43], a[76:79], v[96:99], v[40:43]
    s_nop 0
    v_cvt_pk_f16_f32 v34, v66, v67
    v_cvt_pk_f16_f32 v35, v68, v69
    v_mfma_f32_16x16x32_bf16 v[40:43], a[80:83], v[80:83], v[40:43]
    ds_read_b128 v[60:63], v138 offset:3072
    v_mul_f32 v12, v12, v72
    v_mfma_f32_16x16x32_bf16 v[40:43], a[84:87], v[100:103], v[40:43]
    v_mul_f32 v13, v13, v72
    v_cvt_pk_bf16_f32 v12, v12, v13
    v_mfma_f32_16x16x32_bf16 v[40:43], a[88:91], v[84:87], v[40:43]
    v_mul_f32 v14, v14, v72
    v_mul_f32 v15, v15, v72
    v_mfma_f32_16x16x32_bf16 v[40:43], a[92:95], v[116:119], v[40:43]
    s_sub_u32 s50, s45, s44
    v_cvt_pk_bf16_f32 v13, v14, v15
    v_mul_f32 v4, v4, v72
    v_mfma_f32_16x16x32_bf16 v[66:69], v[76:79], a[168:171], 0
    s_sub_u32 s51, s46, s47
    ds_write_b64 v136, v[2:3] offset:1536
    v_mfma_f32_16x16x32_bf16 v[66:69], v[96:99], a[172:175], v[66:69]
    s_mov_b32 s60, s59
    v_mul_f32 v5, v5, v72
    v_cvt_pk_bf16_f32 v14, v4, v5
    v_mfma_f32_16x16x32_bf16 v[66:69], v[80:83], a[176:179], v[66:69]
    s_mov_b32 s59, s58
    v_mul_f32 v6, v6, v72
    v_mul_f32 v7, v7, v72
    v_mfma_f32_16x16x32_bf16 v[66:69], v[100:103], a[180:183], v[66:69]
    s_mov_b32 s58, s57
    v_cvt_pk_bf16_f32 v15, v6, v7
    v_mul_f32 v8, v8, v72
    v_mfma_f32_16x16x32_bf16 v[66:69], v[84:87], a[184:187], v[66:69]
    s_mov_b32 s57, s56
    ds_write_b32 v137, v47 offset:1548
    v_mfma_f32_16x16x32_bf16 v[66:69], v[116:119], a[188:191], v[66:69]
    s_mov_b32 s7, s6
    v_mul_f32 v9, v9, v72
    v_cvt_pk_bf16_f32 v22, v8, v9
    v_mfma_f32_16x16x32_bf16 v[4:7], a[0:3], v[76:79], 0
    s_mov_b32 s6, s5
    v_mul_f32 v10, v10, v72
    v_mul_f32 v11, v11, v72
    v_mfma_f32_16x16x32_bf16 v[4:7], a[4:7], v[96:99], v[4:7]
    s_mov_b32 s5, s4
    v_cvt_pk_bf16_f32 v2, v66, v67
    v_cvt_pk_bf16_f32 v3, v68, v69
    v_mfma_f32_16x16x32_bf16 v[4:7], a[8:11], v[80:83], v[4:7]
    s_sub_u32 s14, s6, s7
    ds_write_b64 v137, v[12:13] offset:0
    v_mfma_f32_16x16x32_bf16 v[4:7], a[12:15], v[100:103], v[4:7]
    s_add_u32 s61, s61, 1
    v_cvt_pk_bf16_f32 v23, v10, v11
    v_cvt_pk_f16_f32 v68, v40, v41
    v_mfma_f32_16x16x32_bf16 v[4:7], a[16:19], v[84:87], v[4:7]
    s_add_u32 s12, s12, 20
    v_cvt_pk_f16_f32 v69, v42, v43
    v_pk_fma_f16 v91, v68, v68, s39
    v_mfma_f32_16x16x32_bf16 v[4:7], a[20:23], v[116:119], v[4:7]
    s_max_u32 s12, s12, s61
    ds_read_b128 v[8:11], v138 offset:3200
    v_pk_fmac_f16 v91, v69, v69
    v_mfma_f32_16x16x32_bf16 v[40:43], v[76:79], a[144:147], 0
    s_cmp_lt_u32 s61, s71
    ds_read_b128 v[44:47], v139 offset:3328
    v_pk_fmac_f16 v91, v70, v70
    v_mfma_f32_16x16x32_bf16 v[40:43], v[96:99], a[148:151], v[40:43]
    s_cselect_b32 s15, s61, s12
    ds_read_b128 v[52:55], v139 offset:3072
    v_cvt_pk_f16_f32 v32, v4, v5
    v_mfma_f32_16x16x32_bf16 v[40:43], v[80:83], a[152:155], v[40:43]
    s_cselect_b32 s56, s69, s70
    ds_read_b128 v[110:113], v139 offset:3200
    v_cvt_pk_f16_f32 v33, v6, v7
    v_mfma_f32_16x16x32_bf16 v[40:43], v[100:103], a[156:159], v[40:43]
    s_add_u32 s56, s56, s15
    v_pk_fma_f16 v90, v32, v32, s39
    v_pk_fmac_f16 v90, v33, v33
    v_mfma_f32_16x16x32_bf16 v[40:43], v[84:87], a[160:163], v[40:43]
    s_mul_i32 s53, s56, 58255
    v_pk_fmac_f16 v90, v34, v34
    v_pk_fmac_f16 v90, v35, v35
    v_mfma_f32_16x16x32_bf16 v[40:43], v[116:119], a[164:167], v[40:43]
    s_lshr_b32 s53, s53, 22
    v_pk_fmac_f16 v90, v150, v150
    v_pk_fmac_f16 v90, v151, v151
    v_mfma_f32_16x16x32_bf16 v[4:7], a[120:123], v[76:79], 0
    s_mul_i32 s53, s53, s63
    ds_write_b32 v137, v14 offset:8
    v_mfma_f32_16x16x32_bf16 v[4:7], a[124:127], v[96:99], v[4:7]
    s_mul_i32 s56, s56, s62
    v_cvt_pk_bf16_f32 v18, v40, v41
    v_cvt_pk_bf16_f32 v19, v42, v43
    v_mfma_f32_16x16x32_bf16 v[4:7], a[128:131], v[80:83], v[4:7]
    s_add_u32 s56, s56, s53
    v_pk_fmac_f16 v91, v71, v71
    v_mul_f32 v36, v36, v74
    v_mfma_f32_16x16x32_bf16 v[4:7], a[132:135], v[100:103], v[4:7]
    s_mul_i32 s4, s15, 336
    v_mul_f32 v37, v37, v74
    v_cvt_pk_bf16_f32 v12, v36, v37
    v_mfma_f32_16x16x32_bf16 v[4:7], a[136:139], v[84:87], v[4:7]
    s_cmp_ge_u32 s15, 16
    ds_write_b32 v137, v15 offset:12
    v_mfma_f32_16x16x32_bf16 v[4:7], a[140:143], v[116:119], v[4:7]
    s_waitcnt lgkmcnt(2)
    s_cselect_b32 s53, -26880, 0
    v_mul_f32 v38, v38, v74
    v_mul_f32 v39, v39, v74
    v_mfma_f32_16x16x32_bf16 v[40:43], a[72:75], v[52:55], 0
    s_add_u32 s4, s4, s53
    v_cvt_pk_bf16_f32 v13, v38, v39
    v_mul_f32 v28, v28, v74
    v_mfma_f32_16x16x32_bf16 v[40:43], a[76:79], v[60:63], v[40:43]
    s_cmp_lt_u32 s15, s73
    v_cvt_pk_f16_f32 v72, v4, v5
    v_cvt_pk_f16_f32 v73, v6, v7
    v_mfma_f32_16x16x32_bf16 v[40:43], a[80:83], v[110:113], v[40:43]
    s_cselect_b32 s26, 100270464, 0
    ds_write_b64 v136, v[22:23] offset:0
    v_mfma_f32_16x16x32_bf16 v[40:43], a[84:87], v[8:11], v[40:43]
    s_cselect_b32 s56, s56, 0
    v_pk_fmac_f16 v91, v72, v72
    v_pk_fmac_f16 v91, v73, v73
    v_mfma_f32_16x16x32_bf16 v[40:43], a[88:91], v[44:47], v[40:43]
    s_cselect_b32 s4, s4, -1
    v_mul_f32 v29, v29, v74
    v_cvt_pk_bf16_f32 v14, v28, v29
    v_mfma_f32_16x16x32_bf16 v[40:43], a[92:95], v[56:59], v[40:43]
    s_cselect_b32 s15, s15, 0
    v_mul_f32 v30, v30, v74
    v_mul_f32 v31, v31, v74
    v_mfma_f32_16x16x32_f16 v[4:7], v[212:215], v[88:91], 0
    s_cselect_b32 s13, s13, -1
    v_cvt_pk_bf16_f32 v15, v30, v31
    v_mul_f32 v24, v24, v74
    v_mfma_f32_16x16x32_bf16 v[28:31], a[0:3], v[52:55], 0
    s_bitset1_b32 s64, s15
    ds_write_b64 v137, v[14:15] offset:3080
    v_mfma_f32_16x16x32_bf16 v[28:31], a[4:7], v[60:63], v[28:31]
    s_add_u32 s65, s65, 1
    v_cvt_pk_f16_f32 v114, v40, v41
    v_cvt_pk_f16_f32 v115, v42, v43
    v_mfma_f32_16x16x32_bf16 v[28:31], a[8:11], v[110:113], v[28:31]
    s_cmp_ge_i32 s65, 2
    v_or3_b32 v125, v125, v4, v5
    v_or3_b32 v125, v125, v6, v7
    v_mfma_f32_16x16x32_bf16 v[28:31], a[12:15], v[8:11], v[28:31]
    s_cselect_b32 s30, 100270464, 0
    v_rsq_f32 v4, v4
    v_mfma_f32_16x16x32_bf16 v[28:31], a[16:19], v[44:47], v[28:31]
    s_add_u32 s67, s46, s54
    ds_write_b64 v137, v[12:13] offset:3072
    v_mfma_f32_16x16x32_bf16 v[28:31], a[20:23], v[56:59], v[28:31]
    s_add_u32 m0, s67, 0
    v_rsq_f32 v5, v5
    v_mfma_f32_16x16x32_bf16 v[12:15], a[48:51], v[52:55], 0
    v_mul_f32 v4, s52, v4
    v_cvt_pk_f16_f32 v4, v4, v5
    v_mfma_f32_16x16x32_bf16 v[12:15], a[52:55], v[60:63], v[12:15]
    v_rsq_f32 v6, v6
    v_mfma_f32_16x16x32_bf16 v[12:15], a[56:59], v[110:113], v[12:15]
    v_rsq_f32 v7, v7
    v_mfma_f32_16x16x32_bf16 v[12:15], a[60:63], v[8:11], v[12:15]
    v_mul_f32 v6, s52, v6
    v_cvt_pk_f16_f32 v6, v6, v7
    v_mfma_f32_16x16x32_bf16 v[12:15], a[64:67], v[44:47], v[12:15]
    v_pk_mul_f16 v104, v104, v4 op_sel:[0,1] op_sel_hi:[1,1]
    v_pk_mul_f16 v105, v105, v4 op_sel:[0,1] op_sel_hi:[1,1]
    v_mfma_f32_16x16x32_bf16 v[12:15], a[68:71], v[56:59], v[12:15]
    v_pk_mul_f16 v106, v106, v4 op_sel:[0,1] op_sel_hi:[1,1]
    v_pk_mul_f16 v107, v107, v4 op_sel:[0,1] op_sel_hi:[1,1]
    v_mfma_f32_16x16x32_bf16 v[40:43], v[52:55], a[144:147], 0
    v_pk_mul_f16 v108, v108, v4 op_sel:[0,1] op_sel_hi:[1,1]
    v_pk_mul_f16 v109, v109, v4 op_sel:[0,1] op_sel_hi:[1,1]
    v_mfma_f32_16x16x32_bf16 v[40:43], v[60:63], a[148:151], v[40:43]
    v_pk_mul_f16 v92, v92, v4 op_sel:[0,0] op_sel_hi:[1,0]
    v_pk_mul_f16 v93, v93, v4 op_sel:[0,0] op_sel_hi:[1,0]
    v_mfma_f32_16x16x32_bf16 v[40:43], v[110:113], a[152:155], v[40:43]
    v_pk_mul_f16 v94, v94, v4 op_sel:[0,0] op_sel_hi:[1,0]
    v_pk_mul_f16 v95, v95, v4 op_sel:[0,0] op_sel_hi:[1,0]
    v_mfma_f32_16x16x32_bf16 v[40:43], v[8:11], a[156:159], v[40:43]
    v_pk_mul_f16 v154, v154, v4 op_sel:[0,0] op_sel_hi:[1,0]
    v_pk_mul_f16 v155, v155, v4 op_sel:[0,0] op_sel_hi:[1,0]
    v_mfma_f32_16x16x32_bf16 v[40:43], v[44:47], a[160:163], v[40:43]
    v_pk_mul_f16 v68, v68, v6 op_sel:[0,1] op_sel_hi:[1,1]
    v_pk_mul_f16 v69, v69, v6 op_sel:[0,1] op_sel_hi:[1,1]
    v_mfma_f32_16x16x32_bf16 v[40:43], v[56:59], a[164:167], v[40:43]
    v_pk_mul_f16 v70, v70, v6 op_sel:[0,1] op_sel_hi:[1,1]
    v_pk_mul_f16 v71, v71, v6 op_sel:[0,1] op_sel_hi:[1,1]
    v_mfma_f32_16x16x32_bf16 v[48:51], v[76:79], a[192:195], 0
    v_pk_mul_f16 v72, v72, v6 op_sel:[0,1] op_sel_hi:[1,1]
    v_pk_mul_f16 v73, v73, v6 op_sel:[0,1] op_sel_hi:[1,1]
    v_mfma_f32_16x16x32_bf16 v[48:51], v[96:99], a[196:199], v[48:51]
    v_pk_fma_f16 v89, v114, v114, s39
    v_pk_fmac_f16 v89, v115, v115
    v_mfma_f32_16x16x32_bf16 v[48:51], v[80:83], a[200:203], v[48:51]
    v_cvt_pk_f16_f32 v76, v28, v29
    v_cvt_pk_f16_f32 v77, v30, v31
    v_mfma_f32_16x16x32_bf16 v[48:51], v[100:103], a[204:207], v[48:51]
    v_pk_fma_f16 v88, v76, v76, s39
    v_pk_fmac_f16 v88, v77, v77
    v_mfma_f32_16x16x32_bf16 v[48:51], v[84:87], a[208:211], v[48:51]
    v_mul_f32 v25, v25, v74
    v_cvt_pk_bf16_f32 v146, v24, v25
    v_mfma_f32_16x16x32_bf16 v[48:51], v[116:119], a[212:215], v[48:51]
    ds_write_b32 v136, v146 offset:3072
    v_mfma_f32_16x16x32_bf16 v[78:81], a[120:123], v[52:55], 0
    s_nop 0
    v_mul_f32 v26, v26, v74
    v_mul_f32 v27, v27, v74
    v_mfma_f32_16x16x32_bf16 v[78:81], a[124:127], v[60:63], v[78:81]
    s_nop 0
    v_cvt_pk_bf16_f32 v147, v26, v27
    v_cvt_pk_bf16_f32 v22, v48, v49
    v_mfma_f32_16x16x32_bf16 v[78:81], a[128:131], v[110:113], v[78:81]
    v_cvt_pk_bf16_f32 v23, v50, v51
    v_cvt_pk_f16_f32 v146, v12, v13
    v_mfma_f32_16x16x32_bf16 v[78:81], a[132:135], v[8:11], v[78:81]
    ds_write_b32 v136, v147 offset:3076
    v_mfma_f32_16x16x32_bf16 v[78:81], a[136:139], v[44:47], v[78:81]
    s_waitcnt vmcnt(0)
    v_cvt_pk_f16_f32 v147, v14, v15
    v_pk_mul_f16 v32, v32, v6 op_sel:[0,0] op_sel_hi:[1,0]
    v_mfma_f32_16x16x32_bf16 v[78:81], a[140:143], v[56:59], v[78:81]
    v_pk_mul_f16 v33, v33, v6 op_sel:[0,0] op_sel_hi:[1,0]
    v_pk_mul_f16 v34, v34, v6 op_sel:[0,0] op_sel_hi:[1,0]
    v_mfma_f32_16x16x32_bf16 v[12:15], v[52:55], a[168:171], 0
    v_pk_mul_f16 v35, v35, v6 op_sel:[0,0] op_sel_hi:[1,0]
    v_pk_mul_f16 v150, v150, v6 op_sel:[0,0] op_sel_hi:[1,0]
    v_mfma_f32_16x16x32_bf16 v[12:15], v[60:63], a[172:175], v[12:15]
    s_nop 0
    v_pk_mul_f16 v151, v151, v6 op_sel:[0,0] op_sel_hi:[1,0]
    v_cvt_pk_f16_f32 v118, v78, v79
    v_mfma_f32_16x16x32_bf16 v[12:15], v[110:113], a[176:179], v[12:15]
    v_cvt_pk_f16_f32 v119, v80, v81
    v_add_u32 v139, s50, v139
    v_mfma_f32_16x16x32_bf16 v[12:15], v[8:11], a[180:183], v[12:15]
    ds_read_b128 v[84:87], v139 offset:0
    v_add_u32 v138, s50, v138
    v_mfma_f32_16x16x32_bf16 v[12:15], v[44:47], a[184:187], v[12:15]
    ds_read_b128 v[80:83], v138 offset:0
    v_add_u32 v137, s48, v137
    v_mfma_f32_16x16x32_bf16 v[12:15], v[56:59], a[188:191], v[12:15]
    s_waitcnt lgkmcnt(2)
    ds_read_b128 v[96:99], v139 offset:128
    v_add_u32 v136, s48, v136
    v_mfma_f32_16x16x32_bf16 v[4:7], a[24:27], v[52:55], 0
    s_barrier
    ds_read_b128 v[100:103], v138 offset:128
    v_add_u32 v135, s51, v135
    v_mfma_f32_16x16x32_bf16 v[4:7], a[28:31], v[60:63], v[4:7]
    s_cmp_ge_u32 s61, s13
    ds_read_b128 v[28:31], v135 offset:0
    v_add_u32 v134, s14, v134
    v_mfma_f32_16x16x32_bf16 v[4:7], a[32:35], v[110:113], v[4:7]
    s_cbranch_scc1 L_atomF0
L_atomrF0:
    v_mfma_f32_16x16x32_bf16 v[4:7], a[36:39], v[8:11], v[4:7]
    ds_read_b128 v[24:27], v135 offset:2048
    v_add_u32 v133, s14, v133
    v_mfma_f32_16x16x32_bf16 v[4:7], a[40:43], v[44:47], v[4:7]
    ds_read_b128 v[48:51], v139 offset:256
    v_cvt_pk_bf16_f32 v164, v40, v41
    v_mfma_f32_16x16x32_bf16 v[4:7], a[44:47], v[56:59], v[4:7]
    ds_read_b128 v[64:67], v138 offset:256
    v_cvt_pk_bf16_f32 v165, v42, v43
    v_mfma_f32_16x16x32_bf16 v[40:43], a[96:99], v[52:55], 0
    s_nop 0
    v_cvt_pk_bf16_f32 v160, v12, v13
    v_cvt_pk_bf16_f32 v161, v14, v15
    v_mfma_f32_16x16x32_bf16 v[40:43], a[100:103], v[60:63], v[40:43]
    s_nop 0
    v_cvt_pk_f16_f32 v78, v4, v5
    v_cvt_pk_f16_f32 v79, v6, v7
    v_mfma_f32_16x16x32_bf16 v[40:43], a[104:107], v[110:113], v[40:43]
    v_pk_fmac_f16 v88, v78, v78
    v_pk_fmac_f16 v88, v79, v79
    v_mfma_f32_16x16x32_bf16 v[40:43], a[108:111], v[8:11], v[40:43]
    v_pk_fmac_f16 v88, v146, v146
    v_pk_fmac_f16 v88, v147, v147
    v_mfma_f32_16x16x32_bf16 v[40:43], a[112:115], v[44:47], v[40:43]
    s_waitcnt lgkmcnt(3)
    buffer_load_dwordx4 v130, s[24:27], s56 offen nt lds
    v_mfma_f32_16x16x32_bf16 v[40:43], a[116:119], v[56:59], v[40:43]
    s_nop 0
    v_mfma_f32_16x16x32_bf16 v[4:7], a[240:243], v[84:87], 0
    s_nop 0
    ds_read_b128 v[36:39], v135 offset:3072
    s_nop 0
    v_mfma_f32_16x16x32_bf16 v[4:7], a[244:247], v[80:83], v[4:7]
    s_nop 0
    ds_read_b128 v[120:123], v135 offset:1024
    v_cvt_pk_f16_f32 v116, v40, v41
    v_mfma_f32_16x16x32_bf16 v[4:7], a[248:251], v[96:99], v[4:7]
    v_cvt_pk_f16_f32 v117, v42, v43
    v_pk_fmac_f16 v89, v116, v116
    v_mfma_f32_16x16x32_bf16 v[4:7], a[252:255], v[100:103], v[4:7]
    s_waitcnt lgkmcnt(2)
    v_pk_fmac_f16 v89, v117, v117
    v_pk_fmac_f16 v89, v118, v118
    v_mfma_f32_16x16x32_bf16 v[4:7], v[224:227], v[48:51], v[4:7]
    v_pk_fmac_f16 v89, v119, v119
    v_mfma_f32_16x16x32_bf16 v[4:7], v[228:231], v[64:67], v[4:7]
    buffer_store_dwordx4 v[28:31], v130, s[28:31], s60 offen sc1
    v_mfma_f32_16x16x32_f16 v[40:43], v[212:215], v[88:91], 0
    s_add_u32 m0, s67, 1024
    s_nop 0
    v_mfma_f32_16x16x32_bf16 v[88:91], v[52:55], a[192:195], 0
    s_nop 2
    v_mfma_f32_16x16x32_bf16 v[88:91], v[60:63], a[196:199], v[88:91]
    s_nop 0
    v_or3_b32 v125, v125, v40, v41
    v_mfma_f32_16x16x32_bf16 v[88:91], v[110:113], a[200:203], v[88:91]
    s_waitcnt lgkmcnt(0)
    buffer_load_dwordx4 v129, s[24:27], s56 offen nt lds
    v_mfma_f32_16x16x32_bf16 v[88:91], v[8:11], a[204:207], v[88:91]
    ds_read_b128 v[60:63], v135 offset:4096
    v_mfma_f32_16x16x32_bf16 v[88:91], v[44:47], a[208:211], v[88:91]
    ds_read_u16 v166, v133 offset:56
    v_mfma_f32_16x16x32_bf16 v[88:91], v[56:59], a[212:215], v[88:91]
    ds_read_u16 v162, v133 offset:64
    v_mfma_f32_16x16x32_f16 v[44:47], v[68:71], v[92:95], v[200:203]
    s_nop 0
    ds_read_u16 v158, v133 offset:72
    s_nop 0
    v_mfma_f32_16x16x32_f16 v[44:47], v[70:73], v[152:155], v[44:47]
    s_nop 0
    ds_read_b128 v[54:57], v134 offset:32
    v_cvt_pk_bf16_f32 v156, v88, v89
    v_mfma_f32_16x16x32_bf16 v[12:15], a[216:219], v[84:87], 0
    ds_read_b128 v[28:31], v134 offset:0
    v_cvt_pk_bf16_f32 v157, v90, v91
    v_mfma_f32_16x16x32_bf16 v[12:15], a[220:223], v[80:83], v[12:15]
    buffer_store_dwordx4 v[120:123], v129, s[28:31], s60 offen sc1
    ds_read_b64 v[142:143], v134 offset:16
    v_rsq_f32 v40, v40
    v_mfma_f32_16x16x32_bf16 v[12:15], a[224:227], v[96:99], v[12:15]
    s_add_u32 m0, s67, 2048
    v_rsq_f32 v41, v41
    v_mfma_f32_16x16x32_bf16 v[12:15], a[228:231], v[100:103], v[12:15]
    v_exp_f32 v44, v44
    v_mfma_f32_16x16x32_bf16 v[12:15], a[232:235], v[48:51], v[12:15]
    v_exp_f32 v45, v45
    v_mfma_f32_16x16x32_bf16 v[12:15], a[236:239], v[64:67], v[12:15]
    buffer_load_dwordx4 v128, s[24:27], s56 offen nt lds
    v_mul_f32 v40, s52, v40
    v_mfma_f32_16x16x32_bf16 v[8:11], v[232:235], v[84:87], 0
    ds_read_b64 v[58:59], v134 offset:48
    v_cvt_pk_f16_f32 v40, v40, v41
    v_mfma_f32_16x16x32_bf16 v[8:11], v[236:239], v[80:83], v[8:11]
    v_pk_mul_f16 v114, v114, v40 op_sel:[0,1] op_sel_hi:[1,1]
    v_pk_mul_f16 v115, v115, v40 op_sel:[0,1] op_sel_hi:[1,1]
    v_mfma_f32_16x16x32_bf16 v[8:11], v[240:243], v[96:99], v[8:11]
    v_pk_mul_f16 v116, v116, v40 op_sel:[0,1] op_sel_hi:[1,1]
    v_pk_mul_f16 v117, v117, v40 op_sel:[0,1] op_sel_hi:[1,1]
    v_mfma_f32_16x16x32_bf16 v[8:11], v[244:247], v[100:103], v[8:11]
    v_pk_mul_f16 v118, v118, v40 op_sel:[0,1] op_sel_hi:[1,1]
    v_pk_mul_f16 v119, v119, v40 op_sel:[0,1] op_sel_hi:[1,1]
    v_mfma_f32_16x16x32_bf16 v[8:11], v[248:251], v[48:51], v[8:11]
    v_pk_mul_f16 v76, v76, v40 op_sel:[0,0] op_sel_hi:[1,0]
    v_pk_mul_f16 v77, v77, v40 op_sel:[0,0] op_sel_hi:[1,0]
    v_mfma_f32_16x16x32_bf16 v[8:11], v[252:255], v[64:67], v[8:11]
    v_pk_mul_f16 v78, v78, v40 op_sel:[0,0] op_sel_hi:[1,0]
    v_pk_mul_f16 v79, v79, v40 op_sel:[0,0] op_sel_hi:[1,0]
    v_mfma_f32_16x16x32_f16 v[84:87], v[104:107], v[92:95], v[204:207]
    s_add_u32 m0, s67, 3072
    buffer_store_dwordx4 v[24:27], v128, s[28:31], s60 offen sc1
    v_pk_mul_f16 v146, v146, v40 op_sel:[0,0] op_sel_hi:[1,0]
    v_pk_mul_f16 v147, v147, v40 op_sel:[0,0] op_sel_hi:[1,0]
    v_exp_f32 v46, v46
    v_mfma_f32_16x16x32_f16 v[84:87], v[106:109], v[152:155], v[84:87]
    s_waitcnt lgkmcnt(1)
    v_exp_f32 v47, v47
    v_mfma_f32_16x16x32_f16 v[80:83], v[54:57], v[92:95], v[208:211]
    s_waitcnt lgkmcnt(0)
    v_cvt_pk_bf16_f32 v98, v44, v45
    v_cvt_pk_bf16_f32 v99, v46, v47
    v_mfma_f32_16x16x32_f16 v[80:83], v[56:59], v[152:155], v[80:83]
    s_nop 0
    v_exp_f32 v84, v84
    v_mfma_f32_16x16x32_f16 v[44:47], v[28:31], v[104:107], v[208:211]
    buffer_load_dwordx4 v127, s[24:27], s56 offen nt lds
    v_mfma_f32_16x16x32_f16 v[44:47], v[140:143], v[106:109], v[44:47]
    v_exp_f32 v85, v85
    v_mfma_f32_16x16x32_f16 v[88:91], v[28:31], v[68:71], v[208:211]
    v_exp_f32 v86, v86
    v_mfma_f32_16x16x32_f16 v[88:91], v[140:143], v[70:73], v[88:91]
    v_exp_f32 v87, v87
    v_mfma_f32_16x16x32_f16 v[100:103], v[28:31], v[114:117], v[208:211]
    v_cvt_pk_bf16_f32 v96, v84, v85
    v_cvt_pk_bf16_f32 v97, v86, v87
    v_mfma_f32_16x16x32_f16 v[100:103], v[140:143], v[116:119], v[100:103]
    v_exp_f32 v80, v80
    v_mfma_f32_16x16x32_f16 v[84:87], v[114:117], v[92:95], v[196:199]
    s_nop 0
    v_cvt_pk_bf16_f32 v170, v80, 0
    v_mov_b32_dpp v47, v91 quad_perm:[0,1,2,3] row_mask:0x2 bank_mask:0xf
    v_mfma_f32_16x16x32_f16 v[84:87], v[116:119], v[152:155], v[84:87]
    s_nop 0
    buffer_store_dwordx4 v[36:39], v127, s[28:31], s60 offen sc1
    v_mov_b32_dpp v47, v103 quad_perm:[0,1,2,3] row_mask:0x4 bank_mask:0xf
    v_exp_f32 v47, v47
    v_mfma_f32_16x16x32_f16 v[80:83], v[68:71], v[32:35], v[188:191]
    s_add_u32 m0, s67, 4096
    v_cvt_pk_bf16_f32 v47, v47, v47
    v_mfma_f32_16x16x32_f16 v[80:83], v[70:73], v[148:151], v[80:83]
    s_mov_b32 s53, s47
    ds_write_b16 v133, v47
    v_mfma_f32_16x16x32_f16 v[44:47], v[104:107], v[32:35], v[192:195]
    s_mov_b32 s47, s46
    v_exp_f32 v84, v84
    v_mfma_f32_16x16x32_f16 v[44:47], v[106:109], v[148:151], v[44:47]
    s_mov_b32 s46, s45
    v_exp_f32 v85, v85
    v_mfma_f32_16x16x32_f16 v[28:31], v[114:117], v[76:79], v[172:175]
    s_mov_b32 s45, s44
    ds_read_b128 v[92:95], v134 offset:16
    v_cvt_pk_bf16_f32 v168, v84, v85
    v_mfma_f32_16x16x32_f16 v[28:31], v[116:119], v[144:147], v[28:31]
    s_mov_b32 s44, s53
    v_exp_f32 v86, v86
    v_mfma_f32_16x16x32_f16 v[88:91], v[54:57], v[32:35], v[208:211]
    s_sub_u32 s48, s44, s46
    ds_read_b128 v[100:103], v134
    v_mfma_f32_16x16x32_f16 v[88:91], v[56:59], v[148:151], v[88:91]
    v_exp_f32 v87, v87
    v_mfma_f32_16x16x32_f16 v[40:43], v[114:117], v[32:35], v[184:187]
    v_exp_f32 v80, v80
    v_mfma_f32_16x16x32_f16 v[40:43], v[116:119], v[148:151], v[40:43]
    v_exp_f32 v81, v81
    v_mfma_f32_16x16x32_f16 v[24:27], v[54:57], v[76:79], v[208:211]
    v_cvt_pk_bf16_f32 v169, v86, v87
    v_cvt_pk_bf16_f32 v34, v80, v81
    v_mfma_f32_16x16x32_f16 v[24:27], v[56:59], v[144:147], v[24:27]
    buffer_load_dwordx4 v126, s[24:27], s56 offen nt lds
    v_mfma_f32_16x16x32_bf16 v[56:59], v[220:223], v[96:99], 0
    v_exp_f32 v82, v82
    v_mfma_f32_16x16x32_bf16 v[56:59], v[220:223], v[168:171], v[56:59]
    v_exp_f32 v83, v83
    v_mfma_f32_16x16x32_bf16 v[52:55], v[16:19], v[96:99], 0
    v_exp_f32 v44, v44
    v_mfma_f32_16x16x32_bf16 v[52:55], v[164:167], v[168:171], v[52:55]
    s_waitcnt lgkmcnt(0)
    buffer_store_dwordx4 v[60:63], v126, s[28:31], s60 offen sc1
    v_cvt_pk_bf16_f32 v35, v82, v83
    v_exp_f32 v45, v45
    v_mfma_f32_16x16x32_bf16 v[80:83], v[100:103], v[16:19], 0
    v_exp_f32 v46, v46
    v_mfma_f32_16x16x32_bf16 v[80:83], v[92:95], v[164:167], v[80:83]
    v_exp_f32 v47, v47
    v_mfma_f32_16x16x32_bf16 v[84:87], v[100:103], v[0:3], 0
    ds_read_b128 v[60:63], v138 offset:1536
    v_cvt_pk_bf16_f32 v32, v44, v45
    v_mfma_f32_16x16x32_bf16 v[84:87], v[92:95], v[160:163], v[84:87]
    s_sub_u32 s49, s46, s45
    ds_read_b128 v[48:51], v139 offset:1664
    v_cvt_pk_bf16_f32 v33, v46, v47
    v_mfma_f32_16x16x32_bf16 v[116:119], v[100:103], v[20:23], 0
    s_cmp_lg_u32 s5, -1
    v_exp_f32 v89, v89
    v_mfma_f32_16x16x32_bf16 v[116:119], v[92:95], v[156:159], v[116:119]
    v_exp_f32 v40, v40
    v_mfma_f32_16x16x32_bf16 v[92:95], v[0:3], v[96:99], 0
    v_exp_f32 v41, v41
    v_mfma_f32_16x16x32_bf16 v[92:95], v[160:163], v[168:171], v[92:95]
    v_exp_f32 v42, v42
    v_mfma_f32_16x16x32_bf16 v[100:103], v[20:23], v[96:99], 0
    v_exp_f32 v43, v43
    v_mfma_f32_16x16x32_bf16 v[100:103], v[156:159], v[168:171], v[100:103]
    ds_read_b128 v[64:67], v138 offset:1664
    v_mov_b32_dpp v83, v87 quad_perm:[0,1,2,3] row_mask:0x2 bank_mask:0xf
    v_mfma_f32_16x16x32_f16 v[36:39], v[68:71], v[76:79], v[176:179]
    ds_read_b128 v[112:115], v139 offset:1536
    v_mov_b32_dpp v83, v119 quad_perm:[0,1,2,3] row_mask:0x4 bank_mask:0xf
    v_mfma_f32_16x16x32_f16 v[36:39], v[70:73], v[144:147], v[36:39]
    v_cvt_pk_bf16_f32 v83, v83, v83
    v_cvt_pk_bf16_f32 v168, v40, v41
    v_mfma_f32_16x16x32_f16 v[84:87], v[104:107], v[76:79], v[180:183]
    ds_read_b128 v[68:71], v139 offset:1792
    v_cvt_pk_bf16_f32 v169, v42, v43
    v_mfma_f32_16x16x32_f16 v[84:87], v[106:109], v[144:147], v[84:87]
    ds_read_b128 v[120:123], v138 offset:1792
    v_cvt_pk_bf16_f32 v170, v89, 0
    v_mfma_f32_16x16x32_bf16 v[116:119], v[220:223], v[32:35], 0
    v_rcp_f32 v56, v56
    v_mfma_f32_16x16x32_bf16 v[116:119], v[220:223], v[168:171], v[116:119]
    v_mul_f32 v52, v52, v56
    v_mul_f32 v53, v53, v56
    v_mfma_f32_16x16x32_bf16 v[76:79], v[16:19], v[32:35], 0
    v_cvt_pk_bf16_f32 v52, v52, v53
    v_mul_f32 v54, v54, v56
    v_mfma_f32_16x16x32_bf16 v[76:79], v[164:167], v[168:171], v[76:79]
    ds_write_b16 v133, v83 offset:56
    v_mfma_f32_16x16x32_bf16 v[80:83], v[0:3], v[32:35], 0
    v_mul_f32 v55, v55, v56
    v_cvt_pk_bf16_f32 v53, v54, v55
    v_mfma_f32_16x16x32_bf16 v[80:83], v[160:163], v[168:171], v[80:83]
    v_mul_f32 v92, v92, v56
    v_mul_f32 v93, v93, v56
    v_mfma_f32_16x16x32_bf16 v[72:75], v[20:23], v[32:35], 0
    v_cvt_pk_bf16_f32 v54, v92, v93
    v_mul_f32 v94, v94, v56
    v_mfma_f32_16x16x32_bf16 v[72:75], v[156:159], v[168:171], v[72:75]
    s_waitcnt lgkmcnt(2)
    ds_write_b64 v137, v[52:53] offset:0
    v_mfma_f32_16x16x32_bf16 v[44:47], a[216:219], v[112:115], 0
    v_mul_f32 v95, v95, v56
    v_cvt_pk_bf16_f32 v55, v94, v95
    v_mfma_f32_16x16x32_bf16 v[44:47], a[220:223], v[60:63], v[44:47]
    v_mul_f32 v100, v100, v56
    v_mul_f32 v101, v101, v56
    v_mfma_f32_16x16x32_bf16 v[44:47], a[224:227], v[48:51], v[44:47]
    ds_read_b128 v[96:99], v139 offset:3072
    v_cvt_pk_bf16_f32 v52, v100, v101
    v_mfma_f32_16x16x32_bf16 v[44:47], a[228:231], v[64:67], v[44:47]
    ds_read_b128 v[104:107], v139 offset:3200
    v_mul_f32 v102, v102, v56
    v_mfma_f32_16x16x32_bf16 v[44:47], a[232:235], v[68:71], v[44:47]
    s_waitcnt lgkmcnt(3)
    ds_read_b128 v[92:95], v138 offset:3200
    v_mul_f32 v103, v103, v56
    v_mfma_f32_16x16x32_bf16 v[44:47], a[236:239], v[120:123], v[44:47]
    ds_read_b128 v[88:91], v138 offset:3328
    v_cvt_pk_bf16_f32 v53, v102, v103
    v_mfma_f32_16x16x32_bf16 v[32:35], v[232:235], v[112:115], 0
    v_exp_f32 v28, v28
    v_mfma_f32_16x16x32_bf16 v[32:35], v[236:239], v[60:63], v[32:35]
    ds_read_b128 v[100:103], v139 offset:3328
    v_add_u32 v139, s48, v139
    v_mfma_f32_16x16x32_bf16 v[32:35], v[240:243], v[48:51], v[32:35]
    v_exp_f32 v29, v29
    v_mfma_f32_16x16x32_bf16 v[32:35], v[244:247], v[64:67], v[32:35]
    ds_read_b128 v[108:111], v138 offset:3072
    v_cvt_pk_bf16_f32 v168, v28, v29
    v_mfma_f32_16x16x32_bf16 v[32:35], v[248:251], v[68:71], v[32:35]
    v_exp_f32 v30, v30
    v_mfma_f32_16x16x32_bf16 v[32:35], v[252:255], v[120:123], v[32:35]
    v_exp_f32 v31, v31
    v_mfma_f32_16x16x32_bf16 v[40:43], a[240:243], v[112:115], 0
    v_exp_f32 v26, v26
    v_mfma_f32_16x16x32_bf16 v[40:43], a[244:247], v[60:63], v[40:43]
    ds_write_b64 v137, v[54:55] offset:8
    v_mfma_f32_16x16x32_bf16 v[40:43], a[248:251], v[48:51], v[40:43]
    v_cvt_pk_bf16_f32 v169, v30, v31
    v_cvt_pk_bf16_f32 v170, v26, 0
    v_mfma_f32_16x16x32_bf16 v[40:43], a[252:255], v[64:67], v[40:43]
    v_exp_f32 v36, v36
    v_mfma_f32_16x16x32_bf16 v[40:43], v[224:227], v[68:71], v[40:43]
    ds_read_b128 v[56:59], v139 offset:256
    v_add_u32 v138, s48, v138
    v_mfma_f32_16x16x32_bf16 v[40:43], v[228:231], v[120:123], v[40:43]
    s_waitcnt lgkmcnt(2)
    ds_read_b128 v[60:63], v138 offset:0
    v_fma_f32 v114, v12, v12, s42
    v_mfma_f32_16x16x32_bf16 v[28:31], a[240:243], v[96:99], 0
    ds_read_b128 v[68:71], v139 offset:0
    v_fmac_f32 v114, v13, v13
    v_mfma_f32_16x16x32_bf16 v[28:31], a[244:247], v[108:111], v[28:31]
    v_exp_f32 v37, v37
    v_mfma_f32_16x16x32_bf16 v[28:31], a[248:251], v[104:107], v[28:31]
    v_exp_f32 v38, v38
    v_mfma_f32_16x16x32_bf16 v[28:31], a[252:255], v[92:95], v[28:31]
    v_exp_f32 v39, v39
    v_mfma_f32_16x16x32_bf16 v[28:31], v[224:227], v[100:103], v[28:31]
    ds_write_b64 v136, v[52:53] offset:0
    v_mfma_f32_16x16x32_bf16 v[28:31], v[228:231], v[88:91], v[28:31]
    v_cvt_pk_bf16_f32 v112, v36, v37
    v_cvt_pk_bf16_f32 v113, v38, v39
    v_mfma_f32_16x16x32_bf16 v[24:27], v[232:235], v[96:99], 0
    v_exp_f32 v84, v84
    v_mfma_f32_16x16x32_bf16 v[24:27], v[236:239], v[108:111], v[24:27]
    ds_read_b128 v[52:55], v139 offset:128
    v_fmac_f32 v114, v14, v14
    v_mfma_f32_16x16x32_bf16 v[24:27], v[240:243], v[104:107], v[24:27]
    ds_read_b128 v[48:51], v138 offset:128
    v_fmac_f32 v114, v15, v15
    v_mfma_f32_16x16x32_bf16 v[24:27], v[244:247], v[92:95], v[24:27]
    ds_read_b128 v[64:67], v138 offset:256
    v_fmac_f32 v114, v4, v4
    v_mfma_f32_16x16x32_bf16 v[24:27], v[248:251], v[100:103], v[24:27]
    v_exp_f32 v85, v85
    v_mfma_f32_16x16x32_bf16 v[24:27], v[252:255], v[88:91], v[24:27]
    v_exp_f32 v86, v86
    v_mfma_f32_16x16x32_bf16 v[36:39], a[216:219], v[96:99], 0
    v_exp_f32 v87, v87
    v_mfma_f32_16x16x32_bf16 v[36:39], a[220:223], v[108:111], v[36:39]
    v_cvt_pk_bf16_f32 v110, v84, v85
    v_cvt_pk_bf16_f32 v111, v86, v87
    v_mfma_f32_16x16x32_bf16 v[36:39], a[224:227], v[104:107], v[36:39]
    v_rcp_f32 v116, v116
    v_mfma_f32_16x16x32_bf16 v[36:39], a[228:231], v[92:95], v[36:39]
    v_mul_f32 v76, v76, v116
    v_mul_f32 v77, v77, v116
    v_mfma_f32_16x16x32_bf16 v[36:39], a[232:235], v[100:103], v[36:39]
    v_cvt_pk_bf16_f32 v84, v76, v77
    v_mul_f32 v78, v78, v116
    v_mfma_f32_16x16x32_bf16 v[36:39], a[236:239], v[88:91], v[36:39]
    v_mul_f32 v79, v79, v116
    v_cvt_pk_bf16_f32 v85, v78, v79
    v_mfma_f32_16x16x32_bf16 v[76:79], v[220:223], v[110:113], 0
    ds_write_b64 v137, v[84:85] offset:1536
    v_mfma_f32_16x16x32_bf16 v[76:79], v[220:223], v[168:171], v[76:79]
    v_mul_f32 v80, v80, v116
    v_mul_f32 v81, v81, v116
    v_mfma_f32_16x16x32_bf16 v[96:99], v[16:19], v[110:113], 0
    v_cvt_pk_bf16_f32 v86, v80, v81
    v_mul_f32 v82, v82, v116
    v_mfma_f32_16x16x32_bf16 v[96:99], v[164:167], v[168:171], v[96:99]
    v_mul_f32 v83, v83, v116
    v_cvt_pk_bf16_f32 v87, v82, v83
    v_mfma_f32_16x16x32_bf16 v[16:19], v[0:3], v[110:113], 0
    ds_write_b32 v137, v86 offset:1544
    v_mfma_f32_16x16x32_bf16 v[16:19], v[160:163], v[168:171], v[16:19]
    v_mul_f32 v72, v72, v116
    v_mul_f32 v73, v73, v116
    v_mfma_f32_16x16x32_bf16 v[0:3], v[20:23], v[110:113], 0
    v_cvt_pk_bf16_f32 v154, v72, v73
    v_mul_f32 v74, v74, v116
    v_mfma_f32_16x16x32_bf16 v[0:3], v[156:159], v[168:171], v[0:3]
    s_waitcnt lgkmcnt(2)
    v_mul_f32 v75, v75, v116
    v_cvt_pk_bf16_f32 v155, v74, v75
    v_mfma_f32_16x16x32_bf16 v[20:23], a[0:3], v[68:71], 0
    s_cbranch_scc1 L_loopF0
L_tailF:
    ds_write_b32 v137, v87 offset:1548
    v_rcp_f32 v76, v76
    s_mov_b32 s30, 100270464
    s_mul_i32 s89, s68, 5376
    ds_write_b64 v136, v[154:155] offset:1536
    v_mul_f32 v96, v96, v76
    v_mul_f32 v97, v97, v76
    v_cvt_pk_bf16_f32 v20, v96, v97
    v_mul_f32 v98, v98, v76
    v_mul_f32 v99, v99, v76
    v_cvt_pk_bf16_f32 v21, v98, v99
    v_mul_f32 v16, v16, v76
    v_mul_f32 v17, v17, v76
    v_cvt_pk_bf16_f32 v22, v16, v17
    v_mul_f32 v18, v18, v76
    v_mul_f32 v19, v19, v76
    v_cvt_pk_bf16_f32 v23, v18, v19
    v_mul_f32 v0, v0, v76
    v_mul_f32 v1, v1, v76
    v_cvt_pk_bf16_f32 v0, v0, v1
    v_mul_f32 v2, v2, v76
    v_mul_f32 v3, v3, v76
    v_cvt_pk_bf16_f32 v1, v2, v3
    s_add_u32 s89, s89, 142336
    s_movk_i32 s90, 336
    ds_write_b64 v137, v[20:21] offset:3072
    v_fmac_f32 v114, v5, v5
    s_lshr_b32 s91, s64, 16
    s_sub_u32 s84, s45, s44
    ds_write_b64 v137, v[22:23] offset:3080
    v_fmac_f32 v114, v6, v6
    v_fmac_f32 v114, v7, v7
    v_fmac_f32 v114, v8, v8
    s_sub_u32 s85, s46, s45
    s_sub_u32 s86, s44, s45
    ds_write_b32 v136, v0 offset:3072
    ds_write_b32 v136, v1 offset:3076
    v_fmac_f32 v114, v9, v9
    v_fmac_f32 v114, v10, v10
    v_fmac_f32 v114, v11, v11
    v_fma_f32 v133, v44, v44, s42
    v_fmac_f32 v133, v45, v45
    v_fmac_f32 v133, v46, v46
    v_fmac_f32 v133, v47, v47
    v_fmac_f32 v133, v40, v40
    v_fmac_f32 v133, v41, v41
    v_fmac_f32 v133, v42, v42
    v_fmac_f32 v133, v43, v43
    v_fmac_f32 v133, v32, v32
    v_fmac_f32 v133, v33, v33
    v_fmac_f32 v133, v34, v34
    v_fmac_f32 v133, v35, v35
    v_fma_f32 v134, v36, v36, s42
    v_fmac_f32 v134, v37, v37
    v_fmac_f32 v134, v38, v38
    v_fmac_f32 v134, v39, v39
    v_fmac_f32 v134, v28, v28
    v_fmac_f32 v134, v29, v29
    v_fmac_f32 v134, v30, v30
    v_fmac_f32 v134, v31, v31
    v_fmac_f32 v134, v24, v24
    v_fmac_f32 v134, v25, v25
    v_fmac_f32 v134, v26, v26
    v_fmac_f32 v134, v27, v27
    v_cvt_pk_bf16_f32 v0, v114, v133
    v_cvt_pk_bf16_f32 v1, v134, v124
    s_sub_u32 s93, s44, s47
    s_sub_u32 s94, s45, s47
    ds_write_b64 v132, v[0:1]
    v_mbcnt_lo_u32_b32 v124, -1, 0
    v_mbcnt_hi_u32_b32 v124, -1, v124
    v_and_b32 v133, 15, v124
    v_lshrrev_b32 v124, 4, v124
    v_mul_u32_u24 v124, 80, v124
    v_add_u32 v124, s89, v124
    v_mad_u32_u24 v69, v133, s90, v124
    v_lshrrev_b32 v134, v133, s64
    v_and_b32 v134, 1, v134
    v_cmp_eq_u32 vcc, 1, v134
    v_mad_u32_u24 v22, v133, s90, v124
    v_lshrrev_b32 v68, v133, s91
    v_cndmask_b32 v69, v124, v69, vcc
    s_sub_u32 s95, s46, s47
    ds_read_b128 v[52:55], v69
    ds_read_b128 v[60:63], v69 offset:16
    v_and_b32 v68, 1, v68
    v_subrev_u32 v22, 21504, v22
    ds_read_b64 v[70:71], v69 offset:56
    ds_read_b128 v[72:75], v69 offset:64
    v_cmp_eq_u32 vcc, 1, v68
    v_add_u32 v18, s84, v139
    v_add_u32 v19, s84, v138
    v_cndmask_b32 v22, v124, v22, vcc
    v_add_u32 v23, s85, v137
    v_add_u32 v80, s85, v136
    v_add_u32 v134, s86, v137
    v_add_u32 v133, s86, v136
    v_add_u32 v124, s93, v135
    s_waitcnt lgkmcnt(4)
    s_barrier
    ds_read_b128 v[56:59], v131 offset:0
    ds_read_b128 v[48:51], v131 offset:1024
    v_add_u32 v20, s94, v135
    v_add_u32 v135, s95, v135
    ds_read_b128 v[76:79], v18 offset:1536
    v_and_b32 v125, 0xb8000000, v125
    s_waitcnt lgkmcnt(6)
    v_mfma_f32_16x16x32_bf16 v[0:3], v[220:223], v[52:55], 0
    s_waitcnt lgkmcnt(5)
    s_lshl_b32 s92, s68, 10
    ds_read_b128 v[64:67], v18 offset:1664
    ds_read_b128 v[52:55], v18 offset:1792
    v_mfma_f32_16x16x32_bf16 v[0:3], v[220:223], v[60:63], v[0:3]
    s_waitcnt lgkmcnt(5)
    v_lshlrev_b32 v68, 16, v70
    v_and_b32 v70, 0xffff0000, v70
    v_lshlrev_b32 v17, 16, v71
    v_and_b32 v71, 0xffff0000, v71
    v_lshlrev_b32 v16, 16, v72
    v_and_b32 v72, 0xffff0000, v72
    v_lshlrev_b32 v21, 16, v73
    v_rcp_f32 v0, v0
    v_and_b32 v73, 0xffff0000, v73
    v_mul_f32 v68, v68, v0
    v_mul_f32 v70, v70, v0
    v_cvt_pk_bf16_f32 v60, v68, v70
    v_mul_f32 v17, v17, v0
    v_mul_f32 v71, v71, v0
    v_cvt_pk_bf16_f32 v61, v17, v71
    v_mul_f32 v16, v16, v0
    v_mul_f32 v72, v72, v0
    v_cvt_pk_bf16_f32 v62, v16, v72
    v_mul_f32 v21, v21, v0
    s_waitcnt lgkmcnt(3)
    v_mfma_f32_16x16x32_bf16 v[84:87], v[216:219], v[56:59], 0
    ds_read_b128 v[68:71], v19 offset:1536
    ds_read_b128 v[56:59], v19 offset:1664
    v_mfma_f32_16x16x32_bf16 v[84:87], v[216:219], v[48:51], v[84:87]
    s_waitcnt lgkmcnt(4)
    ds_read_b128 v[48:51], v19 offset:1792
    v_mul_f32 v73, v73, v0
    v_mfma_f32_16x16x32_bf16 v[100:103], a[216:219], v[76:79], 0
    v_cvt_pk_bf16_f32 v63, v21, v73
    v_lshlrev_b32 v21, 16, v74
    v_and_b32 v74, 0xffff0000, v74
    v_mul_f32 v21, v21, v0
    v_mul_f32 v74, v74, v0
    v_cvt_pk_bf16_f32 v16, v21, v74
    v_lshlrev_b32 v17, 16, v75
    v_and_b32 v75, 0xffff0000, v75
    v_mul_f32 v17, v17, v0
    v_mul_f32 v75, v75, v0
    v_cvt_pk_bf16_f32 v17, v17, v75
    v_rsq_f32 v84, v84
    v_rsq_f32 v85, v85
    v_mul_f32 v84, s43, v84
    v_mul_f32 v12, v12, v84
    v_mul_f32 v13, v13, v84
    v_cvt_pk_bf16_f32 v0, v12, v13
    v_mul_f32 v14, v14, v84
    v_mul_f32 v15, v15, v84
    v_cvt_pk_bf16_f32 v1, v14, v15
    v_mul_f32 v4, v4, v84
    v_mul_f32 v5, v5, v84
    v_cvt_pk_bf16_f32 v2, v4, v5
    v_mul_f32 v6, v6, v84
    v_mul_f32 v7, v7, v84
    s_waitcnt lgkmcnt(1)
    v_mfma_f32_16x16x32_bf16 v[100:103], a[220:223], v[68:71], v[100:103]
    ds_write_b128 v134, v[60:63] offset:0
    v_mfma_f32_16x16x32_bf16 v[100:103], a[224:227], v[64:67], v[100:103]
    v_cvt_pk_bf16_f32 v3, v6, v7
    v_mul_f32 v8, v8, v84
    v_mfma_f32_16x16x32_bf16 v[100:103], a[228:231], v[56:59], v[100:103]
    ds_write_b128 v23, v[0:3] offset:0
    v_mfma_f32_16x16x32_bf16 v[100:103], a[232:235], v[52:55], v[100:103]
    s_waitcnt lgkmcnt(2)
    v_mul_f32 v9, v9, v84
    v_cvt_pk_bf16_f32 v8, v8, v9
    v_mfma_f32_16x16x32_bf16 v[100:103], a[236:239], v[48:51], v[100:103]
    ds_write_b64 v133, v[16:17] offset:0
    v_mfma_f32_16x16x32_bf16 v[96:99], a[240:243], v[76:79], 0
    v_mul_f32 v10, v10, v84
    v_mul_f32 v11, v11, v84
    v_mfma_f32_16x16x32_bf16 v[96:99], a[244:247], v[68:71], v[96:99]
    ds_read_b128 v[92:95], v18 offset:0
    v_cvt_pk_bf16_f32 v9, v10, v11
    v_mfma_f32_16x16x32_bf16 v[96:99], a[248:251], v[64:67], v[96:99]
    ds_write_b64 v80, v[8:9] offset:0
    v_mfma_f32_16x16x32_bf16 v[96:99], a[252:255], v[56:59], v[96:99]
    v_mul_f32 v85, s43, v85
    v_mul_f32 v44, v44, v85
    v_mfma_f32_16x16x32_bf16 v[96:99], v[224:227], v[52:55], v[96:99]
    ds_read_b128 v[88:91], v19 offset:0
    v_mul_f32 v45, v45, v85
    v_mfma_f32_16x16x32_bf16 v[96:99], v[228:231], v[48:51], v[96:99]
    ds_read_b128 v[60:63], v18 offset:128
    v_cvt_pk_bf16_f32 v0, v44, v45
    v_mfma_f32_16x16x32_bf16 v[72:75], v[232:235], v[76:79], 0
    ds_read_b128 v[12:15], v19 offset:128
    v_mul_f32 v46, v46, v85
    v_mfma_f32_16x16x32_bf16 v[72:75], v[236:239], v[68:71], v[72:75]
    ds_read_b128 v[8:11], v18 offset:256
    v_mul_f32 v47, v47, v85
    v_mfma_f32_16x16x32_bf16 v[72:75], v[240:243], v[64:67], v[72:75]
    ds_read_b128 v[4:7], v19 offset:256
    v_cvt_pk_bf16_f32 v1, v46, v47
    v_mfma_f32_16x16x32_bf16 v[72:75], v[244:247], v[56:59], v[72:75]
    v_rsq_f32 v86, v86
    v_mfma_f32_16x16x32_bf16 v[72:75], v[248:251], v[52:55], v[72:75]
    v_mul_f32 v86, s43, v86
    v_mul_f32 v36, v36, v86
    v_mfma_f32_16x16x32_bf16 v[72:75], v[252:255], v[48:51], v[72:75]
    s_waitcnt lgkmcnt(5)
    v_mul_f32 v37, v37, v86
    v_cvt_pk_bf16_f32 v16, v36, v37
    v_mfma_f32_16x16x32_bf16 v[44:47], a[216:219], v[92:95], 0
    s_waitcnt lgkmcnt(4)
    v_mul_f32 v38, v38, v86
    v_mul_f32 v39, v39, v86
    v_cvt_pk_bf16_f32 v17, v38, v39
    v_mfma_f32_16x16x32_bf16 v[44:47], a[220:223], v[88:91], v[44:47]
    s_waitcnt lgkmcnt(3)
    ds_read_b128 v[76:79], v18 offset:3072
    ds_read_b128 v[68:71], v19 offset:3072
    v_mfma_f32_16x16x32_bf16 v[44:47], a[224:227], v[60:63], v[44:47]
    s_waitcnt lgkmcnt(4)
    ds_read_b128 v[64:67], v18 offset:3200
    v_mul_f32 v28, v28, v86
    v_mfma_f32_16x16x32_bf16 v[44:47], a[228:231], v[12:15], v[44:47]
    s_waitcnt lgkmcnt(4)
    ds_read_b128 v[56:59], v19 offset:3200
    v_mul_f32 v29, v29, v86
    v_mfma_f32_16x16x32_bf16 v[44:47], a[232:235], v[8:11], v[44:47]
    s_waitcnt lgkmcnt(4)
    ds_read_b128 v[52:55], v18 offset:3328
    v_cvt_pk_bf16_f32 v18, v28, v29
    v_mfma_f32_16x16x32_bf16 v[44:47], a[236:239], v[4:7], v[44:47]
    ds_read_b128 v[48:51], v19 offset:3328
    v_mul_f32 v30, v30, v86
    v_mfma_f32_16x16x32_bf16 v[104:107], a[240:243], v[92:95], 0
    v_mul_f32 v31, v31, v86
    v_cvt_pk_bf16_f32 v19, v30, v31
    v_mfma_f32_16x16x32_bf16 v[104:107], a[244:247], v[88:91], v[104:107]
    ds_write_b128 v23, v[16:19] offset:3072
    v_mfma_f32_16x16x32_bf16 v[104:107], a[248:251], v[60:63], v[104:107]
    v_mul_f32 v24, v24, v86
    v_mul_f32 v25, v25, v86
    v_mfma_f32_16x16x32_bf16 v[104:107], a[252:255], v[12:15], v[104:107]
    v_cvt_pk_bf16_f32 v2, v24, v25
    v_mul_f32 v26, v26, v86
    v_mfma_f32_16x16x32_bf16 v[104:107], v[224:227], v[8:11], v[104:107]
    v_mul_f32 v27, v27, v86
    v_cvt_pk_bf16_f32 v3, v26, v27
    v_mfma_f32_16x16x32_bf16 v[104:107], v[228:231], v[4:7], v[104:107]
    ds_write_b64 v80, v[2:3] offset:3072
    v_mfma_f32_16x16x32_bf16 v[16:19], v[232:235], v[92:95], 0
    v_fma_f32 v21, v44, v44, s42
    v_fmac_f32 v21, v45, v45
    v_mfma_f32_16x16x32_bf16 v[16:19], v[236:239], v[88:91], v[16:19]
    v_fmac_f32 v21, v46, v46
    v_fmac_f32 v21, v47, v47
    v_mfma_f32_16x16x32_bf16 v[16:19], v[240:243], v[60:63], v[16:19]
    v_fmac_f32 v21, v104, v104
    v_fmac_f32 v21, v105, v105
    v_mfma_f32_16x16x32_bf16 v[16:19], v[244:247], v[12:15], v[16:19]
    v_fmac_f32 v21, v106, v106
    v_fmac_f32 v21, v107, v107
    v_mfma_f32_16x16x32_bf16 v[16:19], v[248:251], v[8:11], v[16:19]
    v_mul_f32 v40, v40, v85
    v_mul_f32 v41, v41, v85
    v_mfma_f32_16x16x32_bf16 v[16:19], v[252:255], v[4:7], v[16:19]
    s_waitcnt lgkmcnt(1)
    v_cvt_pk_bf16_f32 v2, v40, v41
    v_mul_f32 v42, v42, v85
    v_mfma_f32_16x16x32_bf16 v[8:11], a[216:219], v[76:79], 0
    v_mul_f32 v43, v43, v85
    v_cvt_pk_bf16_f32 v3, v42, v43
    v_mfma_f32_16x16x32_bf16 v[8:11], a[220:223], v[68:71], v[8:11]
    ds_write_b128 v23, v[0:3] offset:1536
    v_mfma_f32_16x16x32_bf16 v[8:11], a[224:227], v[64:67], v[8:11]
    v_fmac_f32 v21, v16, v16
    v_fmac_f32 v21, v17, v17
    v_mfma_f32_16x16x32_bf16 v[8:11], a[228:231], v[56:59], v[8:11]
    ds_read_b128 v[4:7], v22
    v_fmac_f32 v21, v18, v18
    v_mfma_f32_16x16x32_bf16 v[8:11], a[232:235], v[52:55], v[8:11]
    ds_read_b128 v[0:3], v22 offset:16
    v_fmac_f32 v21, v19, v19
    v_mfma_f32_16x16x32_bf16 v[8:11], a[236:239], v[48:51], v[8:11]
    ds_read_b64 v[36:37], v22 offset:56
    ds_read_b128 v[38:41], v22 offset:64
    v_mfma_f32_16x16x32_bf16 v[60:63], a[240:243], v[76:79], 0
    v_mul_f32 v32, v32, v85
    v_mul_f32 v33, v33, v85
    v_mfma_f32_16x16x32_bf16 v[60:63], a[244:247], v[68:71], v[60:63]
    v_cvt_pk_bf16_f32 v22, v32, v33
    v_mul_f32 v34, v34, v85
    v_mfma_f32_16x16x32_bf16 v[60:63], a[248:251], v[64:67], v[60:63]
    v_mul_f32 v35, v35, v85
    v_cvt_pk_bf16_f32 v23, v34, v35
    v_mfma_f32_16x16x32_bf16 v[60:63], a[252:255], v[56:59], v[60:63]
    ds_write_b64 v80, v[22:23] offset:1536
    v_mfma_f32_16x16x32_bf16 v[60:63], v[224:227], v[52:55], v[60:63]
    v_fma_f32 v43, v8, v8, s42
    v_fmac_f32 v43, v9, v9
    v_mfma_f32_16x16x32_bf16 v[60:63], v[228:231], v[48:51], v[60:63]
    v_fmac_f32 v43, v10, v10
    v_fmac_f32 v43, v11, v11
    v_mfma_f32_16x16x32_bf16 v[12:15], v[232:235], v[76:79], 0
    s_nop 0
    v_fma_f32 v42, v100, v100, s42
    v_fmac_f32 v42, v101, v101
    v_mfma_f32_16x16x32_bf16 v[12:15], v[236:239], v[68:71], v[12:15]
    s_nop 0
    v_fmac_f32 v43, v60, v60
    v_fmac_f32 v43, v61, v61
    v_mfma_f32_16x16x32_bf16 v[12:15], v[240:243], v[64:67], v[12:15]
    v_fmac_f32 v43, v62, v62
    v_fmac_f32 v43, v63, v63
    v_mfma_f32_16x16x32_bf16 v[12:15], v[244:247], v[56:59], v[12:15]
    v_fmac_f32 v42, v102, v102
    v_fmac_f32 v42, v103, v103
    v_mfma_f32_16x16x32_bf16 v[12:15], v[248:251], v[52:55], v[12:15]
    v_fmac_f32 v42, v96, v96
    v_fmac_f32 v42, v97, v97
    v_mfma_f32_16x16x32_bf16 v[12:15], v[252:255], v[48:51], v[12:15]
    s_waitcnt lgkmcnt(0)
    v_fmac_f32 v42, v98, v98
    v_fmac_f32 v42, v99, v99
    v_mfma_f32_16x16x32_bf16 v[24:27], v[220:223], v[4:7], 0
    v_fmac_f32 v42, v72, v72
    v_fmac_f32 v42, v73, v73
    v_mfma_f32_16x16x32_bf16 v[24:27], v[220:223], v[0:3], v[24:27]
    s_nop 0
    v_fmac_f32 v43, v12, v12
    v_fmac_f32 v43, v13, v13
    v_fmac_f32 v43, v14, v14
    v_fmac_f32 v43, v15, v15
    v_cvt_pk_bf16_f32 v43, v43, v43
    v_fmac_f32 v42, v74, v74
    v_fmac_f32 v42, v75, v75
    v_cvt_pk_bf16_f32 v42, v21, v42
    ds_write_b64 v132, v[42:43] offset:2048
    v_rcp_f32 v24, v24
    v_lshlrev_b32 v42, 16, v36
    v_and_b32 v36, 0xffff0000, v36
    v_mul_f32 v42, v42, v24
    v_mul_f32 v36, v36, v24
    v_cvt_pk_bf16_f32 v4, v42, v36
    v_lshlrev_b32 v36, 16, v37
    v_and_b32 v37, 0xffff0000, v37
    v_mul_f32 v36, v36, v24
    v_mul_f32 v37, v37, v24
    v_cvt_pk_bf16_f32 v5, v36, v37
    v_lshlrev_b32 v6, 16, v38
    v_and_b32 v38, 0xffff0000, v38
    v_mul_f32 v6, v6, v24
    v_mul_f32 v38, v38, v24
    v_cvt_pk_bf16_f32 v6, v6, v38
    v_lshlrev_b32 v7, 16, v39
    v_and_b32 v39, 0xffff0000, v39
    v_mul_f32 v7, v7, v24
    v_mul_f32 v39, v39, v24
    v_cvt_pk_bf16_f32 v7, v7, v39
    v_lshlrev_b32 v42, 16, v40
    v_and_b32 v40, 0xffff0000, v40
    v_mul_f32 v42, v42, v24
    v_mul_f32 v40, v40, v24
    v_cvt_pk_bf16_f32 v0, v42, v40
    v_lshlrev_b32 v1, 16, v41
    v_and_b32 v41, 0xffff0000, v41
    v_mul_f32 v1, v1, v24
    v_mul_f32 v41, v41, v24
    v_cvt_pk_bf16_f32 v1, v1, v41
    s_waitcnt lgkmcnt(0)
    s_barrier
    ds_write_b128 v134, v[4:7] offset:1536
    v_mov_b32 v23, 0x3f803f80
    v_cmp_ne_u32 vcc, 0, v125
    v_add_u32 v125, s92, v131
    ds_write_b64 v133, v[0:1] offset:1536
    v_cndmask_b32 v23, 0, v23, vcc
    ds_read_b128 v[48:51], v131 offset:2048
    ds_read_b128 v[40:43], v131 offset:3072
    ds_read_b128 v[0:3], v135 offset:0
    ds_read_b128 v[24:27], v135 offset:1024
    ds_read_b128 v[36:39], v135 offset:2048
    ds_read_b128 v[4:7], v135 offset:3072
    ds_read_b128 v[28:31], v135 offset:4096
    s_waitcnt lgkmcnt(7)
    s_barrier
    s_waitcnt lgkmcnt(6)
    v_mfma_f32_16x16x32_bf16 v[32:35], v[216:219], v[48:51], 0
    s_waitcnt lgkmcnt(5)
    ds_read_b128 v[92:95], v139 offset:0
    ds_read_b128 v[88:91], v138 offset:0
    v_mfma_f32_16x16x32_bf16 v[32:35], v[216:219], v[40:43], v[32:35]
    s_waitcnt lgkmcnt(6)
    ds_read_b128 v[84:87], v139 offset:128
    s_nop 0
    buffer_store_dwordx4 v[0:3], v130, s[28:31], s59 offen sc1
    s_nop 0
    ds_read_b128 v[80:83], v138 offset:128
    s_nop 1
    v_rsq_f32 v32, v32
    ds_read_b128 v[76:79], v139 offset:256
    ds_read_b128 v[0:3], v138 offset:256
    v_mul_f32 v32, s43, v32
    v_mul_f32 v44, v44, v32
    v_mul_f32 v45, v45, v32
    ds_read_b128 v[68:71], v139 offset:1536
    s_waitcnt lgkmcnt(8)
    buffer_store_dwordx4 v[24:27], v129, s[28:31], s59 offen sc1
    ds_read_b128 v[64:67], v138 offset:1536
    v_cvt_pk_bf16_f32 v52, v44, v45
    v_mul_f32 v46, v46, v32
    v_mul_f32 v47, v47, v32
    v_cvt_pk_bf16_f32 v53, v46, v47
    v_mul_f32 v104, v104, v32
    ds_read_b128 v[56:59], v139 offset:1664
    ds_read_b128 v[48:51], v138 offset:1664
    v_mul_f32 v105, v105, v32
    s_waitcnt lgkmcnt(8)
    v_mfma_f32_16x16x32_bf16 v[24:27], a[216:219], v[92:95], 0
    ds_read_b128 v[44:47], v139 offset:1792
    v_cvt_pk_bf16_f32 v54, v104, v105
    v_mfma_f32_16x16x32_bf16 v[24:27], a[220:223], v[88:91], v[24:27]
    s_waitcnt lgkmcnt(7)
    ds_read_b128 v[40:43], v138 offset:1792
    v_mul_f32 v106, v106, v32
    v_mfma_f32_16x16x32_bf16 v[24:27], a[224:227], v[84:87], v[24:27]
    buffer_store_dwordx4 v[36:39], v128, s[28:31], s59 offen sc1
    v_mul_f32 v107, v107, v32
    v_cvt_pk_bf16_f32 v55, v106, v107
    v_mul_f32 v16, v16, v32
    v_mul_f32 v17, v17, v32
    v_mfma_f32_16x16x32_bf16 v[24:27], a[228:231], v[80:83], v[24:27]
    s_waitcnt lgkmcnt(6)
    v_cvt_pk_bf16_f32 v16, v16, v17
    v_mul_f32 v18, v18, v32
    v_mfma_f32_16x16x32_bf16 v[24:27], a[232:235], v[76:79], v[24:27]
    v_rsq_f32 v33, v33
    v_mfma_f32_16x16x32_bf16 v[24:27], a[236:239], v[0:3], v[24:27]
    s_nop 0
    v_mul_f32 v19, v19, v32
    v_cvt_pk_bf16_f32 v17, v18, v19
    v_mfma_f32_16x16x32_bf16 v[36:39], a[240:243], v[92:95], 0
    s_nop 0
    buffer_store_dwordx4 v[4:7], v127, s[28:31], s59 offen sc1
    v_mul_f32 v33, s43, v33
    v_mul_f32 v100, v100, v33
    v_fma_f32 v135, v24, v24, s42
    v_fmac_f32 v135, v25, v25
    v_mfma_f32_16x16x32_bf16 v[36:39], a[244:247], v[88:91], v[36:39]
    v_fmac_f32 v135, v26, v26
    v_fmac_f32 v135, v27, v27
    v_mfma_f32_16x16x32_bf16 v[36:39], a[248:251], v[84:87], v[36:39]
    v_mul_f32 v101, v101, v33
    v_cvt_pk_bf16_f32 v4, v100, v101
    v_mfma_f32_16x16x32_bf16 v[36:39], a[252:255], v[80:83], v[36:39]
    v_mul_f32 v102, v102, v33
    v_mul_f32 v103, v103, v33
    v_mfma_f32_16x16x32_bf16 v[36:39], v[224:227], v[76:79], v[36:39]
    buffer_store_dwordx4 v[28:31], v126, s[28:31], s59 offen sc1
    v_cvt_pk_bf16_f32 v5, v102, v103
    v_mul_f32 v96, v96, v33
    v_mul_f32 v97, v97, v33
    v_cvt_pk_bf16_f32 v6, v96, v97
    v_mfma_f32_16x16x32_bf16 v[36:39], v[228:231], v[0:3], v[36:39]
    v_mul_f32 v98, v98, v33
    v_mul_f32 v99, v99, v33
    v_mfma_f32_16x16x32_bf16 v[28:31], v[232:235], v[92:95], 0
    s_nop 0
    v_cvt_pk_bf16_f32 v7, v98, v99
    v_mul_f32 v72, v72, v33
    v_mfma_f32_16x16x32_bf16 v[28:31], v[236:239], v[88:91], v[28:31]
    s_nop 0
    v_fmac_f32 v135, v36, v36
    v_fmac_f32 v135, v37, v37
    v_mfma_f32_16x16x32_bf16 v[28:31], v[240:243], v[84:87], v[28:31]
    v_fmac_f32 v135, v38, v38
    v_fmac_f32 v135, v39, v39
    v_mfma_f32_16x16x32_bf16 v[28:31], v[244:247], v[80:83], v[28:31]
    v_mul_f32 v73, v73, v33
    v_cvt_pk_bf16_f32 v138, v72, v73
    v_mfma_f32_16x16x32_bf16 v[28:31], v[248:251], v[76:79], v[28:31]
    v_mul_f32 v74, v74, v33
    v_mul_f32 v75, v75, v33
    v_mfma_f32_16x16x32_bf16 v[28:31], v[252:255], v[0:3], v[28:31]
    s_waitcnt lgkmcnt(0)
    v_rsq_f32 v34, v34
    v_mfma_f32_16x16x32_bf16 v[0:3], a[216:219], v[68:71], 0
    v_cvt_pk_bf16_f32 v139, v74, v75
    v_mul_f32 v34, s43, v34
    v_mfma_f32_16x16x32_bf16 v[0:3], a[220:223], v[64:67], v[0:3]
    ds_write_b128 v137, v[52:55] offset:0
    v_mfma_f32_16x16x32_bf16 v[0:3], a[224:227], v[56:59], v[0:3]
    v_fmac_f32 v135, v28, v28
    v_fmac_f32 v135, v29, v29
    v_mfma_f32_16x16x32_bf16 v[0:3], a[228:231], v[48:51], v[0:3]
    ds_write_b64 v136, v[16:17] offset:0
    v_mfma_f32_16x16x32_bf16 v[0:3], a[232:235], v[44:47], v[0:3]
    v_fmac_f32 v135, v30, v30
    v_fmac_f32 v135, v31, v31
    v_mfma_f32_16x16x32_bf16 v[0:3], a[236:239], v[40:43], v[0:3]
    ds_write_b128 v137, v[4:7] offset:1536
    v_mfma_f32_16x16x32_bf16 v[16:19], a[240:243], v[68:71], 0
    v_mul_f32 v8, v8, v34
    v_mul_f32 v9, v9, v34
    v_mfma_f32_16x16x32_bf16 v[16:19], a[244:247], v[64:67], v[16:19]
    ds_write_b64 v136, v[138:139] offset:1536
    v_mfma_f32_16x16x32_bf16 v[16:19], a[248:251], v[56:59], v[16:19]
    v_cvt_pk_bf16_f32 v52, v8, v9
    v_mul_f32 v10, v10, v34
    v_mfma_f32_16x16x32_bf16 v[16:19], a[252:255], v[48:51], v[16:19]
    ds_read_b128 v[4:7], v125 offset:6144
    v_mul_f32 v11, v11, v34
    v_mfma_f32_16x16x32_bf16 v[16:19], v[224:227], v[44:47], v[16:19]
    v_cvt_pk_bf16_f32 v53, v10, v11
    v_mul_f32 v60, v60, v34
    v_mfma_f32_16x16x32_bf16 v[16:19], v[228:231], v[40:43], v[16:19]
    v_mul_f32 v61, v61, v34
    v_cvt_pk_bf16_f32 v54, v60, v61
    v_mfma_f32_16x16x32_bf16 v[8:11], v[232:235], v[68:71], 0
    v_mul_f32 v62, v62, v34
    v_mul_f32 v63, v63, v34
    v_mfma_f32_16x16x32_bf16 v[8:11], v[236:239], v[64:67], v[8:11]
    v_cvt_pk_bf16_f32 v55, v62, v63
    v_mul_f32 v12, v12, v34
    v_mfma_f32_16x16x32_bf16 v[8:11], v[240:243], v[56:59], v[8:11]
    ds_write_b128 v137, v[52:55] offset:3072
    v_mfma_f32_16x16x32_bf16 v[8:11], v[244:247], v[48:51], v[8:11]
    v_mul_f32 v13, v13, v34
    v_cvt_pk_bf16_f32 v138, v12, v13
    v_mfma_f32_16x16x32_bf16 v[8:11], v[248:251], v[44:47], v[8:11]
    v_mul_f32 v14, v14, v34
    v_mul_f32 v15, v15, v34
    v_mfma_f32_16x16x32_bf16 v[8:11], v[252:255], v[40:43], v[8:11]
    v_cvt_pk_bf16_f32 v139, v14, v15
    v_fma_f32 v125, v0, v0, s42
    v_fmac_f32 v125, v1, v1
    v_fmac_f32 v125, v2, v2
    ds_write_b64 v136, v[138:139] offset:3072
    v_fmac_f32 v125, v3, v3
    v_fmac_f32 v125, v16, v16
    v_fmac_f32 v125, v17, v17
    v_fmac_f32 v125, v18, v18
    v_fmac_f32 v125, v19, v19
    v_fmac_f32 v125, v8, v8
    v_fmac_f32 v125, v9, v9
    v_fmac_f32 v125, v10, v10
    v_fmac_f32 v125, v11, v11
    v_cvt_pk_bf16_f32 v22, v135, v125
    ds_write_b64 v132, v[22:23] offset:4096
    s_waitcnt lgkmcnt(2)
    v_lshrrev_b32 v125, 0, v7
    v_lshrrev_b32 v125, v125, s64
    v_and_b32 v125, 1, v125
    v_cmp_eq_u32 vcc, 1, v125
    v_lshrrev_b32 v125, 8, v7
    v_lshrrev_b32 v125, v125, s64
    v_cndmask_b32 v4, 2.0, v4, vcc
    v_and_b32 v125, 1, v125
    v_cmp_eq_u32 vcc, 1, v125
    v_lshrrev_b32 v7, 16, v7
    v_lshrrev_b32 v7, v7, s64
    v_cndmask_b32 v5, 2.0, v5, vcc
    v_and_b32 v7, 1, v7
    v_cmp_eq_u32 vcc, 1, v7
    s_nop 1
    v_cndmask_b32 v6, 2.0, v6, vcc
    s_waitcnt lgkmcnt(1)
    s_barrier
    ds_read_b128 v[52:55], v20 offset:0
    ds_read_b128 v[12:15], v20 offset:1024
    ds_read_b128 v[40:43], v20 offset:2048
    s_waitcnt lgkmcnt(3)
    s_barrier
    ds_read_b128 v[32:35], v20 offset:3072
    ds_read_b128 v[20:23], v20 offset:4096
    ds_read_b128 v[48:51], v131 offset:4096
    ds_read_b128 v[44:47], v131 offset:5120
    s_waitcnt lgkmcnt(6)
    buffer_store_dwordx4 v[52:55], v130, s[28:31], s58 offen sc1
    s_waitcnt lgkmcnt(1)
    buffer_store_dwordx4 v[12:15], v129, s[28:31], s58 offen sc1
    s_nop 1
    v_mfma_f32_16x16x32_bf16 v[12:15], v[216:219], v[48:51], 0
    s_waitcnt lgkmcnt(0)
    v_mfma_f32_16x16x32_bf16 v[12:15], v[216:219], v[44:47], v[12:15]
    s_nop 5
    buffer_store_dwordx4 v[40:43], v128, s[28:31], s58 offen sc1
    s_nop 0
    v_rsq_f32 v12, v12
    v_cmp_neq_f32 vcc, 0, v14
    v_mul_f32 v12, s43, v12
    v_mul_f32 v24, v24, v12
    v_mul_f32 v25, v25, v12
    v_cvt_pk_bf16_f32 v24, v24, v25
    v_mul_f32 v26, v26, v12
    v_mul_f32 v27, v27, v12
    v_cvt_pk_bf16_f32 v25, v26, v27
    v_mul_f32 v36, v36, v12
    v_mul_f32 v37, v37, v12
    v_cvt_pk_bf16_f32 v26, v36, v37
    v_mul_f32 v38, v38, v12
    buffer_store_dwordx4 v[32:35], v127, s[28:31], s58 offen sc1
    v_mul_f32 v39, v39, v12
    v_cvt_pk_bf16_f32 v27, v38, v39
    v_mul_f32 v28, v28, v12
    v_mul_f32 v29, v29, v12
    v_cvt_pk_bf16_f32 v14, v28, v29
    v_mul_f32 v30, v30, v12
    v_mul_f32 v31, v31, v12
    v_cvt_pk_bf16_f32 v15, v30, v31
    ds_write_b128 v134, v[24:27] offset:0
    buffer_store_dwordx4 v[20:23], v126, s[28:31], s58 offen sc1
    v_rsq_f32 v13, v13
    s_nop 0
    v_mul_f32 v13, s43, v13
    v_mul_f32 v0, v0, v13
    v_mul_f32 v1, v1, v13
    ds_write_b64 v133, v[14:15] offset:0
    v_cvt_pk_bf16_f32 v0, v0, v1
    v_mul_f32 v2, v2, v13
    v_mul_f32 v3, v3, v13
    v_cvt_pk_bf16_f32 v1, v2, v3
    v_mul_f32 v16, v16, v13
    v_mul_f32 v17, v17, v13
    v_cvt_pk_bf16_f32 v2, v16, v17
    v_mul_f32 v18, v18, v13
    v_mul_f32 v19, v19, v13
    v_cvt_pk_bf16_f32 v3, v18, v19
    v_mul_f32 v8, v8, v13
    v_mul_f32 v9, v9, v13
    v_cvt_pk_bf16_f32 v126, v8, v9
    v_mul_f32 v10, v10, v13
    v_mul_f32 v11, v11, v13
    v_cvt_pk_bf16_f32 v127, v10, v11
    ds_write_b128 v134, v[0:3] offset:1536
    ds_write_b64 v133, v[126:127] offset:1536
    s_waitcnt lgkmcnt(0)
    s_barrier
    ds_read_b128 v[12:15], v124 offset:0
    ds_read_b128 v[8:11], v124 offset:1024
    ds_read_b128 v[0:3], v124 offset:2048
    s_waitcnt lgkmcnt(1)
    buffer_store_dwordx4 v[12:15], v4, s[28:31], 0 offen sc1
    buffer_store_dwordx4 v[8:11], v5, s[28:31], 0 offen sc1
    s_waitcnt lgkmcnt(0)
    buffer_store_dwordx4 v[0:3], v6, s[28:31], 0 offen sc1
    s_nop 4
    s_cbranch_vccnz L_slow
L_end:
    s_endpgm
L_slow:
    s_waitcnt vmcnt(0) lgkmcnt(0)
    s_nop 15
    s_barrier
    s_lshr_b32 s66, s64, 20
    v_mbcnt_lo_u32_b32 v40, -1, 0
    v_mbcnt_hi_u32_b32 v40, -1, v40
    s_load_dwordx16 s[4:19], s[0:1], 0
    s_load_dwordx4 s[20:23], s[0:1], 64
    s_load_dwordx2 s[38:39], s[0:1], 80
    s_lshr_b32 s88, s2, 3
    s_lshl2_add_u32 s88, s88, s68
    v_lshlrev_b32 v8, 7, v40
    s_mul_i32 s89, s88, 576
    s_mul_i32 s88, s88, 1728
    v_min_u32 v9, 1664, v8
    v_min_u32 v8, 512, v8
    s_mov_b32 s34, 221184
    s_mov_b32 s35, 0x20000
    s_mov_b32 s78, 73728
    s_mov_b32 s79, 0x20000
    v_and_b32 v154, 15, v40
    v_lshrrev_b32 v151, 4, v40
    v_lshrrev_b32 v150, 2, v154
    v_and_b32 v142, 3, v154
    s_mul_i32 s87, s68, 192
    v_mad_u32_u24 v10, v154, 12, s87
    v_lshlrev_b32 v19, 1, v154
    v_lshlrev_b32 v11, 1, v150
    v_lshl_add_u32 v11, v151, 5, v11
    s_movk_i32 s86, 384
    s_mov_b32 s26, 100270464
    s_mov_b32 s27, 0x20000
    s_mov_b32 s30, 0
    s_mov_b32 s31, 0x20000
    s_mul_i32 s96, s68, 288
    s_and_b32 s97, s68, 1
    s_lshl_b32 s97, s97, 2
    s_mov_b32 s98, 193536
    s_waitcnt lgkmcnt(0)
    s_mov_b32 s24, s4
    s_mov_b32 s25, s5
    s_mov_b32 s32, s6
    s_mov_b32 s33, s7
    s_mov_b32 s76, s8
    s_mov_b32 s77, s9
    buffer_load_dword a254, v9, s[32:35], s88 offen
    buffer_load_dword a253, v8, s[76:79], s89 offen
    s_load_dwordx2 s[82:83], s[10:11], 0
    s_movk_i32 s18, 676
    s_mov_b32 s19, 0x20000
    buffer_load_dwordx3 v[16:18], v10, s[16:19], 0 offen
    s_mov_b32 s99, 589824
    v_add_u32 v9, s96, v40
    v_mul_u32_u24 v8, 2731, v9
    v_mul_u32_u24 v38, 6242, v9
    v_lshrrev_b32 v8, 16, v8
    s_lshr_b32 s94, s2, 3
    s_mul_i32 s70, s94, 168
    global_load_ushort v24, v19, s[12:13]
    v_lshrrev_b32 v38, 20, v38
    v_and_or_b32 v36, v8, 3, s97
    v_xor_b32 v36, v9, v36
    v_lshl_add_u32 v130, v36, 4, s99
    v_mad_u32_u24 v130, v38, s98, v130
    s_mul_i32 s69, s2, 20
    s_lshl3_add_u32 s69, s94, s69
    global_load_ushort v25, v19, s[12:13] offset:32
    v_add_u32 v19, 64, v9
    v_mul_u32_u24 v131, 2731, v19
    v_mul_u32_u24 v72, 6242, v19
    v_lshrrev_b32 v131, 16, v131
    v_lshrrev_b32 v72, 20, v72
    s_add_u32 s70, s70, 140
    s_movk_i32 s62, 2688
    global_load_ushort v74, v11, s[14:15] offset:0
    v_and_or_b32 v37, v131, 3, s97
    v_xor_b32 v37, v19, v37
    v_lshl_add_u32 v129, v37, 4, s99
    v_mad_u32_u24 v129, v72, s98, v129
    v_add_u32 v19, 128, v9
    s_movk_i32 s71, 20
    s_movk_i32 s73, 28
    global_load_ushort v32, v11, s[14:15] offset:8
    v_mul_u32_u24 v26, 2731, v19
    v_mul_u32_u24 v125, 6242, v19
    v_lshrrev_b32 v26, 16, v26
    v_lshrrev_b32 v125, 20, v125
    v_and_or_b32 v27, v26, 3, s97
    s_mov_b32 s93, 1769472
    s_mul_i32 s54, s68, 5120
    global_load_ushort v75, v11, s[14:15] offset:16
    v_xor_b32 v27, v19, v27
    v_lshl_add_u32 v128, v27, 4, s99
    v_mad_u32_u24 v128, v125, s98, v128
    v_add_u32 v73, 192, v9
    v_mul_u32_u24 v124, 2731, v73
    s_mov_b32 s63, 1180032
    s_mul_i32 s95, s68, -44
    global_load_ushort v11, v11, s[14:15] offset:24
    v_mul_u32_u24 v19, 6242, v73
    v_lshrrev_b32 v124, 16, v124
    v_lshrrev_b32 v19, 20, v19
    v_and_or_b32 v39, v124, 3, s97
    v_xor_b32 v39, v73, v39
    v_lshl_add_u32 v127, v39, 4, s99
    v_mad_u32_u24 v127, v19, s98, v127
    v_add_u32 v126, 256, v9
    v_mul_u32_u24 v39, 2731, v126
    v_mul_u32_u24 v9, 6242, v126
    v_lshrrev_b32 v39, 16, v39
    v_lshrrev_b32 v9, 20, v9
    v_and_or_b32 v73, v39, 3, s97
    v_xor_b32 v73, v126, v73
    v_lshl_add_u32 v126, v73, 4, s99
    v_mad_u32_u24 v126, v9, s98, v126
    s_cmp_ge_u32 s2, 240
    s_cbranch_scc1 L_bndS
L_bndrS:
    s_mul_i32 s94, s69, 58255
    s_lshr_b32 s94, s94, 22
    s_mul_i32 s94, s94, s63
    s_mul_i32 s72, s69, s62
    s_add_u32 s72, s72, s94
    v_lshl_or_b32 v143, v40, 4, 2.0
    s_sub_u32 s94, s73, 1
    s_max_u32 s94, s94, 20
    s_movk_i32 s99, -24
    s_add_u32 m0, s54, 0
    v_and_b32 v19, -4, v26
    s_mul_i32 s85, s68, 96
    s_sub_u32 s100, s85, 1024
    buffer_load_dwordx4 v130, s[24:27], s72 offen nt lds
    s_add_u32 m0, s54, 1024
    v_mad_u32_u24 v9, v19, 3, v26
    v_add_u32 v9, s95, v9
    v_mad_i32_i24 v38, v26, s99, v27
    v_med3_u32 v19, v9, 20, s94
    v_add_u32 v19, s70, v19
    v_add_u32 v39, s69, v9
    s_sub_u32 s87, s85, 2048
    s_movk_i32 s91, 1152
    buffer_load_dwordx4 v129, s[24:27], s72 offen nt lds
    v_cmp_gt_u32 vcc, s71, v9
    v_lshl_add_u32 v38, v38, 4, s93
    s_add_u32 m0, s54, 43008
    v_cndmask_b32 v39, v19, v39, vcc
    v_mul_u32_u24 v19, 58255, v39
    v_mad_u32_u24 v38, v39, s62, v38
    v_lshrrev_b32 v19, 22, v19
    v_mad_u32_u24 v38, v19, s63, v38
    s_mul_i32 s90, s68, 3072
    s_add_u32 s90, s90, 61440
    buffer_load_dwordx4 v38, s[24:27], 0 offen  lds
    v_lshlrev_b32 v39, 16, v9
    s_add_u32 m0, s54, 2048
    v_and_b32 v19, -4, v131
    v_mad_u32_u24 v9, v19, 3, v131
    v_add_u32 v9, s95, v9
    v_mad_i32_i24 v37, v131, s99, v37
    v_med3_u32 v19, v9, 20, s94
    s_mov_b32 s28, s22
    s_mov_b32 s29, s23
    buffer_load_dwordx4 v128, s[24:27], s72 offen nt lds
    v_add_u32 v19, s70, v19
    v_add_u32 v131, s69, v9
    v_cmp_gt_u32 vcc, s71, v9
    v_lshl_add_u32 v37, v37, 4, s93
    s_add_u32 m0, s54, 41984
    v_cndmask_b32 v131, v19, v131, vcc
    v_mul_u32_u24 v19, 58255, v131
    v_mad_u32_u24 v37, v131, s62, v37
    v_lshrrev_b32 v19, 22, v19
    v_mad_u32_u24 v37, v19, s63, v37
    s_mov_b32 s41, 0x2a8cbccc
    s_mov_b32 s42, 0x38fba882
    buffer_load_dwordx4 v37, s[24:27], 0 offen  lds
    v_lshl_or_b32 v39, v9, 8, v39
    s_add_u32 m0, s54, 3072
    v_cmp_gt_u32 vcc, 32, v40
    v_and_b32 v131, -4, v8
    v_mad_u32_u24 v19, v131, 3, v8
    v_cndmask_b32 v126, v143, v126, vcc
    v_add_u32 v19, s95, v19
    s_mov_b32 s43, 0x415db3d7
    s_mov_b32 s44, 61440
    buffer_load_dwordx4 v127, s[24:27], s72 offen nt lds
    s_add_u32 m0, s54, 4096
    v_mad_i32_i24 v36, v8, s99, v36
    v_med3_u32 v131, v19, 20, s94
    v_add_u32 v131, s70, v131
    v_add_u32 v8, s69, v19
    v_cmp_gt_u32 vcc, s71, v19
    v_lshl_add_u32 v36, v36, 4, s93
    s_mul_i32 s93, s68, 6
    s_lshl_b32 s94, s97, 1
    buffer_load_dwordx4 v126, s[24:27], s72 offen nt lds
    v_cndmask_b32 v8, v131, v8, vcc
    v_mul_u32_u24 v131, 58255, v8
    v_mad_u32_u24 v36, v8, s62, v36
    v_lshrrev_b32 v131, 22, v131
    v_mad_u32_u24 v36, v131, s63, v36
    s_add_u32 m0, s54, 40960
    v_lshl_or_b32 v39, v19, 0, v39
    s_mov_b32 s45, 40960
    s_mov_b32 s46, 20480
    buffer_load_dwordx4 v36, s[24:27], 0 offen nt lds
    v_mul_u32_u24 v72, 10923, v40
    v_lshrrev_b32 v56, 17, v72
    v_lshrrev_b32 v72, 16, v72
    v_mad_i32_i24 v131, v72, -6, v40
    v_bitop3_b32 v56, v56, v72, 4 bitop3:0x28
    v_lshl_add_u32 v131, v131, 4, s85
    v_mul_u32_u24 v56, 3, v56
    v_xor_b32 v72, v72, v56
    v_mad_u32_u24 v56, v72, s91, v131
    v_add_u32 v8, 64, v40
    v_mul_u32_u24 v9, 10923, v8
    v_lshrrev_b32 v13, 17, v9
    v_lshrrev_b32 v9, 16, v9
    v_mad_i32_i24 v73, v9, -6, v8
    v_bitop3_b32 v13, v13, v9, 4 bitop3:0x28
    v_lshl_add_u32 v73, v73, 4, s100
    v_mul_u32_u24 v13, 3, v13
    v_xor_b32 v9, v9, v13
    v_mad_u32_u24 v13, v9, s91, v73
    v_add_u32 v8, 128, v40
    v_mul_u32_u24 v19, 10923, v8
    v_lshrrev_b32 v12, 17, v19
    v_lshrrev_b32 v19, 16, v19
    v_mad_i32_i24 v8, v19, -6, v8
    v_bitop3_b32 v12, v12, v19, 4 bitop3:0x28
    v_lshl_add_u32 v8, v8, 4, s87
    v_mul_u32_u24 v12, 3, v12
    v_xor_b32 v19, v19, v12
    v_mad_u32_u24 v12, v19, s91, v8
    v_mad_u32_u24 v72, v72, s86, v131
    v_mad_u32_u24 v9, v9, s86, v73
    v_mad_u32_u24 v8, v19, s86, v8
    s_add_u32 m0, s90, 0
    s_mov_b32 s92, 0
    buffer_load_dwordx4 v56, s[32:35], s92 offen offset:0 lds
    v_mov_b32 v19, 0x3f803f80
    v_cmp_eq_u32 vcc, 0, v142
    v_and_b32 v73, 1, v40
    v_lshlrev_b32 v73, 4, v73
    v_cndmask_b32 v220, 0, v19, vcc
    v_cndmask_b32 v221, 0, v19, vcc
    v_cndmask_b32 v222, 0, v19, vcc
    v_cndmask_b32 v223, 0, v19, vcc
    v_mov_b32 v19, 0x3f80
    v_lshlrev_b32 v19, v73, v19
    v_cmp_gt_u32 vcc, 2, v142
    v_mov_b32 v171, 0
    v_mov_b32 v167, 0
    v_cndmask_b32 v216, 0, v19, vcc
    v_cndmask_b32 v218, 0, v19, vcc
    v_cmp_le_u32 vcc, 2, v142
    v_mov_b32 v163, 0
    v_mov_b32 v159, 0
    v_cndmask_b32 v217, 0, v19, vcc
    v_cndmask_b32 v219, 0, v19, vcc
    v_cmp_eq_u32 vcc, v151, v150
    v_mov_b32 v152, 0
    v_mov_b32 v153, 0
    v_cndmask_b32 v146, 0, v216, vcc
    v_cndmask_b32 v147, 0, v217, vcc
    v_mov_b32 v148, 0
    v_mov_b32 v149, 0
    v_mov_b32 v144, 0
    v_mov_b32 v145, 0
    v_mov_b32 v140, 0
    v_mov_b32 v141, 0
    v_lshrrev_b32 v15, 1, v151
    v_lshl_add_u32 v14, v151, 2, v150
    v_lshl_add_u32 v14, v15, 3, v14
    v_mul_u32_u24 v14, 96, v14
    v_add_u32 v14, s90, v14
    v_lshl_add_u32 v15, v142, 4, v14
    v_lshl_add_u32 v14, v142, 3, v14
    s_waitcnt lgkmcnt(0)
    s_lshl_b32 s84, s68, 4
    s_lshr_b64 s[82:83], s[82:83], s84
    s_lshl_b32 s82, s82, 16
    v_mov_b32 v27, s82
    v_min_f32 v27, 0x40930000, v27
    v_max_f32 v27, 0xc2c80000, v27
    v_mul_f32 v27, 0x3fb8aa3b, v27
    v_exp_f32 v27, v27
    v_mov_b32 v26, 0
    v_cvt_pk_bf16_f32 v27, v27, v27
    v_lshlrev_b32 v27, 16, v27
    v_mul_f32 v27, 0x4038aa3b, v27
    v_mov_b32 v19, 0
    v_readfirstlane_b32 s55, v27
    v_add_f32 v27, v27, v27
    v_mul_u32_u24 v155, 5120, v151
    v_readfirstlane_b32 s52, v27
    v_add_u32 v155, v10, v155
    s_mov_b32 s84, 0x41b8aa3b
    v_mov_b32 v10, 0xc138aa3b
    v_mul_u32_u24 v124, 5120, v150
    v_mad_u32_u24 v124, v142, s86, v124
    v_and_b32 v27, 7, v154
    v_xor_b32 v125, v27, v151
    v_lshl_add_u32 v73, v125, 4, v124
    s_mov_b32 s47, 0
    s_mov_b32 s57, s72
    buffer_load_dwordx4 v13, s[32:35], s92 offen offset:1024 lds
    v_xor_b32 v35, 64, v73
    v_add_u32 v139, 40960, v73
    v_xor_b32 v138, 64, v139
    v_add_u32 v124, 61440, v124
    v_add_u32 v125, s93, v151
    v_xor_b32 v125, v27, v125
    v_lshl_add_u32 v137, v125, 4, v124
    s_mov_b32 s58, 0
    s_mov_b32 s59, 0
    buffer_load_dwordx4 v12, s[32:35], s92 offen offset:2048 lds
    s_add_u32 m0, s90, 12288
    s_mov_b32 s92, 36864
    v_lshrrev_b32 v125, 1, v151
    v_add3_u32 v125, v125, s93, 4
    v_xor_b32 v125, v27, v125
    v_lshl_add_u32 v125, v125, 4, v124
    v_and_b32 v124, 1, v151
    s_add_u32 s93, s54, 20480
    s_mov_b32 s60, 0
    buffer_load_dwordx4 v56, s[32:35], s92 offen offset:0 lds
    s_waitcnt vmcnt(16)
    v_lshl_or_b32 v24, v25, 16, v24
    v_cmp_gt_u32 vcc, 16, v40
    v_mov_b32 v25, 0
    v_lshl_add_u32 v136, v124, 3, v125
    v_cndmask_b32 v27, 0, v24, vcc
    v_cndmask_b32 v24, 0, v24, vcc
    v_lshlrev_b32 v131, 4, v40
    v_mfma_f32_16x16x16_bf16 v[0:3], v[26:27], v[16:17], 0
    s_waitcnt vmcnt(14)
    s_mov_b32 s65, -1
    v_lshl_or_b32 v74, v32, 16, v74
    v_add_u32 v135, s93, v131
    v_mfma_f32_16x16x16_bf16 v[4:7], v[24:25], v[16:17], 0
    s_lshr_b32 s93, s68, 1
    v_add_u32 v131, 81920, v131
    v_mul_u32_u24 v124, 80, v151
    v_mfma_f32_16x16x16_bf16 v[20:23], v[24:25], v[18:19], 0
    s_waitcnt vmcnt(12)
    s_lshl_b32 s93, s93, 10
    buffer_load_dwordx4 v13, s[32:35], s92 offen offset:1024 lds
    v_lshl_or_b32 v75, v11, 16, v75
    v_max_f32 v0, 0, v0
    v_max_f32 v4, 0, v4
    v_max_f32 v5, 0, v5
    v_max_f32 v6, 0, v6
    v_max_f32 v7, 0, v7
    v_cvt_pk_bf16_f32 v4, v4, v5
    v_cvt_pk_bf16_f32 v5, v6, v7
    v_max_f32 v1, 0, v1
    v_max_f32 v2, 0, v2
    v_mfma_f32_16x16x16_bf16 v[16:19], v[74:75], v[4:5], 0
    s_add_u32 s93, s93, s94
    v_max_f32 v3, 0, v3
    v_cvt_pk_bf16_f32 v0, v0, v1
    v_cvt_pk_bf16_f32 v1, v2, v3
    v_max_f32 v20, 0, v20
    v_max_f32 v21, 0, v21
    v_mfma_f32_16x16x16_bf16 v[4:7], v[74:75], v[0:1], 0
    s_mov_b32 s61, 1
    v_max_f32 v22, 0, v22
    v_max_f32 v23, 0, v23
    v_cvt_pk_bf16_f32 v20, v20, v21
    v_cvt_pk_bf16_f32 v21, v22, v23
    v_cvt_pk_bf16_f32 v16, v16, v16
    v_lshlrev_b32 v16, 16, v16
    v_mfma_f32_16x16x16_bf16 v[0:3], v[74:75], v[20:21], 0
    s_movk_i32 s4, 336
    v_mul_f32 v16, 0xbfb8aa3b, v16
    v_cvt_pk_bf16_f32 v4, v4, v4
    v_exp_f32 v16, v16
    v_lshlrev_b32 v4, 16, v4
    v_add_f32 v16, 1.0, v16
    v_rcp_f32 v16, v16
    v_mul_f32 v4, 0xbfb8aa3b, v4
    v_cvt_pk_bf16_f32 v16, v16, v16
    v_lshlrev_b32 v16, 16, v16
    v_fma_f32 v16, v16, s84, v10
    s_mov_b32 s5, 0
    s_mov_b32 s6, 0
    ds_write_b32 v155, v16 offset:44032
    v_exp_f32 v4, v4
    v_cvt_pk_bf16_f32 v0, v0, v0
    v_add_f32 v4, 1.0, v4
    v_rcp_f32 v4, v4
    v_lshlrev_b32 v0, 16, v0
    v_cvt_pk_bf16_f32 v4, v4, v4
    v_lshlrev_b32 v4, 16, v4
    v_fma_f32 v4, v4, s84, v10
    s_mov_b32 s12, 0
    s_mov_b32 s64, 3
    ds_write_b32 v155, v4 offset:44036
    v_mul_f32 v0, 0xbfb8aa3b, v0
    v_exp_f32 v0, v0
    v_add_u32 v132, s93, v131
    v_add_f32 v0, 1.0, v0
    v_rcp_f32 v0, v0
    s_mul_i32 s93, s68, 5376
    v_cvt_pk_bf16_f32 v0, v0, v0
    v_lshlrev_b32 v0, 16, v0
    v_fma_f32 v0, v0, s84, v10
    s_add_u32 s93, s93, 142336
    s_mov_b32 s10, 81924
    ds_write_b32 v155, v0 offset:44040
    v_add_u32 v125, s93, v124
    v_mul_u32_u24 v124, 336, v154
    v_add_u32 v34, v124, v125
    v_subrev_u32 v34, 21504, v34
    v_cmp_eq_u32 vcc, 0, v150
    v_mul_u32_u24 v124, 80, v150
    v_lshl_add_u32 v124, v151, 3, v124
    v_cndmask_b32 v134, v143, v125, vcc
    v_cmp_eq_u32 vcc, 3, v142
    v_lshl_add_u32 v124, v142, 1, v124
    v_add_u32 v124, s93, v124
    v_cndmask_b32 v134, v134, v125, vcc
    v_cmp_gt_u32 vcc, 3, v151
    v_mov_b32 v125, v124
    s_add_u32 s93, s69, 1
    v_cndmask_b32 v133, v143, v124, vcc
    s_mul_i32 s94, s93, 58255
    s_lshr_b32 s94, s94, 22
    s_mul_i32 s94, s94, s63
    s_mul_i32 s56, s93, s62
    s_add_u32 s56, s56, s94
    ds_write_b128 v34, v[216:219] offset:21584
    v_mov_b32 v124, 0
    s_sub_u32 s93, s71, 1
    s_cmp_eq_u32 s68, 0
    s_cselect_b32 s13, s93, -1
    s_cmp_gt_u32 s73, 20
    s_cselect_b32 s13, s13, -1
    s_and_b32 s93, s2, -8
    s_waitcnt lgkmcnt(1)
    s_barrier
    s_sub_u32 s93, 81920, s93
    s_sub_u32 s8, s38, s93
    s_subb_u32 s9, s39, 0
    s_mov_b32 s11, 0x20000
    s_mov_b32 s39, 0x00010001
    s_add_u32 s101, s54, 44032
    v_mul_u32_u24 v150, 48, v150
    v_lshl_add_u32 v150, v142, 2, v150
    v_mul_u32_u24 v32, 48, v151
    v_add_u32 v199, 0, v150
    v_mul_u32_u24 v33, 37, v199
    v_lshrrev_b32 v33, 10, v33
    v_mad_u32_u24 v199, v33, 24, v199
    v_add_u32 v199, s101, v199
    v_add_u32 v142, 16, v150
    v_mul_u32_u24 v33, 37, v142
    v_lshrrev_b32 v33, 10, v33
    v_mad_u32_u24 v142, v33, 24, v142
    v_add_u32 v142, s101, v142
    v_add_u32 v41, 32, v150
    v_mul_u32_u24 v33, 37, v41
    v_lshrrev_b32 v33, 10, v33
    v_mad_u32_u24 v41, v33, 24, v41
    v_add_u32 v41, s101, v41
    v_add_u32 v59, 0, v32
    v_mul_u32_u24 v33, 37, v59
    v_lshrrev_b32 v33, 10, v33
    v_mad_u32_u24 v59, v33, 24, v59
    v_add_u32 v57, 4, v32
    v_mul_u32_u24 v33, 37, v57
    v_lshrrev_b32 v33, 10, v33
    v_mad_u32_u24 v57, v33, 24, v57
    v_add_u32 v58, 8, v32
    v_mul_u32_u24 v33, 37, v58
    v_lshrrev_b32 v33, 10, v33
    v_mad_u32_u24 v58, v33, 24, v58
    v_add_u32 v75, 12, v32
    v_mul_u32_u24 v33, 37, v75
    v_lshrrev_b32 v33, 10, v33
    v_mad_u32_u24 v75, v33, 24, v75
    v_add_u32 v74, 16, v32
    v_mul_u32_u24 v33, 37, v74
    v_lshrrev_b32 v33, 10, v33
    v_mad_u32_u24 v74, v33, 24, v74
    v_add_u32 v42, 20, v32
    v_mul_u32_u24 v33, 37, v42
    v_lshrrev_b32 v33, 10, v33
    v_mad_u32_u24 v42, v33, 24, v42
    v_add_u32 v43, 24, v32
    v_mul_u32_u24 v33, 37, v43
    v_lshrrev_b32 v33, 10, v33
    v_mad_u32_u24 v43, v33, 24, v43
    v_add_u32 v179, 28, v32
    v_mul_u32_u24 v33, 37, v179
    v_lshrrev_b32 v33, 10, v33
    v_mad_u32_u24 v179, v33, 24, v179
    v_add_u32 v11, 32, v32
    v_mul_u32_u24 v10, 37, v11
    v_lshrrev_b32 v10, 10, v10
    v_mad_u32_u24 v11, v10, 24, v11
    v_add_u32 v10, 36, v32
    v_mul_u32_u24 v33, 37, v10
    v_lshrrev_b32 v33, 10, v33
    v_mad_u32_u24 v10, v33, 24, v10
    v_add_u32 v155, 40, v32
    s_lshr_b32 s93, s68, 1
    s_mul_i32 s93, s93, 30720
    buffer_load_dwordx4 v12, s[32:35], s92 offen offset:2048 lds
    s_add_u32 m0, s90, 24576
    s_mov_b32 s92, 73728
    ds_read_b32 v208, v199
    v_mul_u32_u24 v33, 37, v155
    v_lshrrev_b32 v33, 10, v33
    v_mad_u32_u24 v155, v33, 24, v155
    v_add_u32 v32, 44, v32
    v_mul_u32_u24 v33, 37, v32
    v_lshrrev_b32 v33, 10, v33
    v_mad_u32_u24 v32, v33, 24, v32
    v_lshl_add_u32 v33, v151, 4, v150
    v_mul_u32_u24 v156, 37, v33
    v_lshrrev_b32 v156, 10, v156
    v_mad_u32_u24 v33, v156, 24, v33
    v_mov_b32 v156, 336
    v_cmp_gt_u32 vcc, 3, v151
    v_sub_u32 v204, v199, v59
    s_and_b32 s94, s68, 1
    v_cndmask_b32 v33, v156, v33, vcc
    v_sub_u32 v33, s101, v33
    s_mul_i32 s94, s94, -2304
    s_add_u32 s93, s93, s94
    buffer_load_dwordx4 v56, s[32:35], s92 offen offset:0 lds
    ds_read_b32 v204, v204 offset:336
    v_sub_u32 v205, v199, v57
    v_sub_u32 v206, v199, v58
    v_sub_u32 v207, v199, v75
    v_sub_u32 v200, v199, v74
    v_sub_u32 v201, v199, v42
    s_lshl_b32 s94, s97, 4
    ds_read_b32 v205, v205 offset:336
    v_sub_u32 v202, v199, v43
    buffer_load_dwordx4 v13, s[32:35], s92 offen offset:1024 lds
    v_sub_u32 v203, v199, v179
    ds_read_b32 v206, v206 offset:336
    v_sub_u32 v196, v199, v11
    v_sub_u32 v197, v199, v10
    v_sub_u32 v198, v199, v155
    v_sub_u32 v199, v199, v32
    v_sub_u32 v192, v142, v59
    ds_read_b32 v207, v207 offset:336
    v_sub_u32 v193, v142, v57
    v_sub_u32 v194, v142, v58
    v_sub_u32 v195, v142, v75
    v_sub_u32 v188, v142, v74
    v_sub_u32 v189, v142, v42
    ds_read_b32 v200, v200 offset:336
    v_sub_u32 v190, v142, v43
    buffer_load_dwordx4 v12, s[32:35], s92 offen offset:2048 lds
    s_add_u32 m0, s90, 36864
    s_mov_b32 s92, 110592
    ds_read_b32 v201, v201 offset:336
    v_sub_u32 v191, v142, v179
    v_sub_u32 v184, v142, v11
    v_sub_u32 v185, v142, v10
    v_sub_u32 v186, v142, v155
    v_sub_u32 v187, v142, v32
    s_waitcnt vmcnt(9)
    s_barrier
    ds_read_b32 v202, v202 offset:336
    v_sub_u32 v180, v41, v59
    v_sub_u32 v181, v41, v57
    v_sub_u32 v182, v41, v58
    v_sub_u32 v183, v41, v75
    v_sub_u32 v176, v41, v74
    ds_read_b32 v203, v203 offset:336
    v_sub_u32 v177, v41, v42
    v_sub_u32 v178, v41, v43
    v_sub_u32 v179, v41, v179
    v_sub_u32 v172, v41, v11
    v_sub_u32 v173, v41, v10
    ds_read_b32 v196, v196 offset:336
    v_sub_u32 v174, v41, v155
    v_sub_u32 v175, v41, v32
    buffer_load_dwordx4 v56, s[32:35], s92 offen offset:0 lds
    ds_read_b32 v197, v197 offset:336
    v_mov_b32 v57, 0xf149f2ca
    v_mov_b32 v58, 0x3f80
    v_mov_b32 v59, 0
    v_mov_b32 v42, 0x3f80
    v_mov_b32 v43, 0
    ds_read_b32 v198, v198 offset:336
    v_and_b32 v155, 8, v154
    v_add_u32 v155, v155, v154
    v_mul_u32_u24 v155, 96, v155
    v_add_u32 v155, s90, v155
    v_lshl_add_u32 v32, v151, 4, v155
    ds_read_b32 v199, v199 offset:336
    buffer_load_dwordx4 v13, s[32:35], s92 offen offset:1024 lds
    v_lshl_add_u32 v75, v151, 3, v155
    v_add_u32 v11, s93, v32
    v_add_u32 v10, s93, v75
    v_lshlrev_b32 v74, 4, v151
    s_lshr_b32 s93, s68, 1
    s_mul_i32 s93, s93, 5120
    ds_read_b32 v211, v33 offset:672
    v_add_u32 v74, 4608, v74
    s_add_u32 s93, s93, s94
    v_add_u32 v33, s93, v74
    v_cmp_eq_u32 vcc, 0, v154
    s_nop 0
    ds_read_b32 v192, v192 offset:336
    v_cndmask_b32 v33, v143, v33, vcc
    buffer_load_dwordx4 v12, s[32:35], s92 offen offset:2048 lds
    s_add_u32 m0, s90, 49152
    s_mov_b32 s92, 147456
    ds_read_b32 v193, v193 offset:336
    ds_read_b32 v194, v194 offset:336
    ds_read_b32 v195, v195 offset:336
    buffer_load_dwordx4 v56, s[32:35], s92 offen offset:0 lds
    ds_read_b32 v188, v188 offset:336
    ds_read_b32 v189, v189 offset:336
    ds_read_b32 v190, v190 offset:336
    ds_read_b32 v191, v191 offset:336
    buffer_load_dwordx4 v13, s[32:35], s92 offen offset:1024 lds
    ds_read_b32 v184, v184 offset:336
    ds_read_b32 v185, v185 offset:336
    ds_read_b32 v186, v186 offset:336
    buffer_load_dwordx4 v12, s[32:35], s92 offen offset:2048 lds
    s_add_u32 m0, s90, 61440
    s_mov_b32 s92, 184320
    ds_read_b32 v187, v187 offset:336
    ds_read_b32 v209, v142
    ds_read_b32 v180, v180 offset:336
    buffer_load_dwordx4 v56, s[32:35], s92 offen offset:0 lds
    ds_read_b32 v181, v181 offset:336
    ds_read_b32 v182, v182 offset:336
    ds_read_b32 v183, v183 offset:336
    ds_read_b32 v176, v176 offset:336
    buffer_load_dwordx4 v13, s[32:35], s92 offen offset:1024 lds
    ds_read_b32 v177, v177 offset:336
    ds_read_b32 v178, v178 offset:336
    ds_read_b32 v179, v179 offset:336
    buffer_load_dwordx4 v12, s[32:35], s92 offen offset:2048 lds
    ds_read_b32 v172, v172 offset:336
    ds_read_b32 v173, v173 offset:336
    ds_read_b32 v174, v174 offset:336
    ds_read_b32 v175, v175 offset:336
    ds_read_b32 v210, v41
    s_waitcnt vmcnt(15)
    ds_read_b64_tr_b16 a[0:1], v14 offset:0
    ds_read_b64_tr_b16 a[2:3], v14 offset:768
    ds_read_b64_tr_b16 a[24:25], v14 offset:32
    ds_read_b64_tr_b16 a[26:27], v14 offset:800
    ds_read_b64_tr_b16 a[48:49], v14 offset:64
    ds_read_b64_tr_b16 a[50:51], v14 offset:832
    s_add_u32 m0, s90, 0
    s_mov_b32 s92, 384
    s_waitcnt vmcnt(12)
    ds_read_b64_tr_b16 a[4:5], v14 offset:12288
    ds_read_b64_tr_b16 a[6:7], v14 offset:13056
    ds_read_b64_tr_b16 a[28:29], v14 offset:12320
    ds_read_b64_tr_b16 a[30:31], v14 offset:13088
    ds_read_b64_tr_b16 a[52:53], v14 offset:12352
    ds_read_b64_tr_b16 a[54:55], v14 offset:13120
    s_waitcnt vmcnt(9)
    ds_read_b64_tr_b16 a[8:9], v14 offset:24576
    ds_read_b64_tr_b16 a[10:11], v14 offset:25344
    ds_read_b64_tr_b16 a[32:33], v14 offset:24608
    s_waitcnt lgkmcnt(15)
    s_cmp_ge_u32 s2, 247
    s_cbranch_scc1 L_maskS
L_nomaskS:
    v_cmp_gt_u32 vcc, 16, v40
    v_readlane_b32 s84, v211, 48
    ds_read_b64_tr_b16 a[34:35], v14 offset:25376
    v_cndmask_b32 v208, v57, v208, vcc
    v_cndmask_b32 v209, v57, v209, vcc
    v_cndmask_b32 v210, v57, v210, vcc
    v_cmp_gt_u32 vcc, 49, v40
    ds_read_b64_tr_b16 a[56:57], v14 offset:24640
    s_waitcnt lgkmcnt(10)
    buffer_load_dwordx4 v56, s[32:35], s92 offen offset:0 lds
    ds_read_b64_tr_b16 a[58:59], v14 offset:25408
    v_cndmask_b32 v211, v57, v211, vcc
    s_waitcnt vmcnt(7)
    ds_read_b64_tr_b16 a[12:13], v14 offset:36864
    ds_read_b64_tr_b16 a[14:15], v14 offset:37632
    buffer_load_dwordx4 v13, s[32:35], s92 offen offset:1024 lds
    ds_read_b64_tr_b16 a[36:37], v14 offset:36896
    ds_read_b64_tr_b16 a[38:39], v14 offset:37664
    ds_read_b64_tr_b16 a[60:61], v14 offset:36928
    ds_read_b64_tr_b16 a[62:63], v14 offset:37696
    buffer_load_dwordx4 v12, s[32:35], s92 offen offset:2048 lds
    s_add_u32 m0, s90, 12288
    s_mov_b32 s92, 37248
    ds_read_b128 v[68:71], v73 offset:40960
    ds_read_b128 v[64:67], v35 offset:40960
    s_waitcnt lgkmcnt(10)
    buffer_load_dwordx4 v56, s[32:35], s92 offen offset:0 lds
    ds_read_b128 v[60:63], v73 offset:41088
    ds_read_b128 v[48:51], v35 offset:41088
    buffer_load_dwordx4 v13, s[32:35], s92 offen offset:1024 lds
    ds_read_b128 v[44:47], v73 offset:41216
    ds_read_b128 v[28:31], v35 offset:41216
    buffer_load_dwordx4 v12, s[32:35], s92 offen offset:2048 lds
    s_add_u32 m0, s90, 24576
    s_mov_b32 s92, 74112
    s_waitcnt vmcnt(9)
    ds_read_b64_tr_b16 a[16:17], v14 offset:49152
    ds_read_b64_tr_b16 a[18:19], v14 offset:49920
    ds_read_b64_tr_b16 a[40:41], v14 offset:49184
    ds_read_b64_tr_b16 a[42:43], v14 offset:49952
    ds_read_b64_tr_b16 a[64:65], v14 offset:49216
    ds_read_b64_tr_b16 a[66:67], v14 offset:49984
    s_waitcnt lgkmcnt(9)
    buffer_load_dwordx4 v56, s[32:35], s92 offen offset:0 lds
    buffer_load_dwordx4 v13, s[32:35], s92 offen offset:1024 lds
    buffer_load_dwordx4 v12, s[32:35], s92 offen offset:2048 lds
    s_add_u32 m0, s90, 36864
    s_mov_b32 s92, 110976
    s_waitcnt vmcnt(9)
    ds_read_b64_tr_b16 a[20:21], v14 offset:61440
    ds_read_b64_tr_b16 a[22:23], v14 offset:62208
    v_mfma_f32_16x16x32_bf16 v[92:95], a[0:3], v[68:71], 0
    ds_read_b64_tr_b16 a[44:45], v14 offset:61472
    v_mfma_f32_16x16x32_bf16 v[92:95], a[4:7], v[64:67], v[92:95]
    ds_read_b64_tr_b16 a[46:47], v14 offset:62240
    v_mfma_f32_16x16x32_bf16 v[92:95], a[8:11], v[60:63], v[92:95]
    s_waitcnt lgkmcnt(4)
    ds_read_b64_tr_b16 a[68:69], v14 offset:61504
    v_mfma_f32_16x16x32_bf16 v[92:95], a[12:15], v[48:51], v[92:95]
    ds_read_b64_tr_b16 a[70:71], v14 offset:62272
    v_mfma_f32_16x16x32_bf16 v[92:95], a[16:19], v[44:47], v[92:95]
    ds_read_b128 v[24:27], v73 offset:42496
    ds_read_b128 v[20:23], v35 offset:42496
    ds_read_b128 v[16:19], v73 offset:42624
    ds_read_b128 v[52:55], v35 offset:42624
    s_waitcnt lgkmcnt(7)
    v_mfma_f32_16x16x32_bf16 v[92:95], a[20:23], v[28:31], v[92:95]
    ds_read_b128 v[4:7], v73 offset:42752
    s_nop 0
    v_mfma_f32_16x16x32_bf16 v[100:103], a[24:27], v[68:71], 0
    s_nop 0
    ds_read_b128 v[0:3], v35 offset:42752
    s_nop 0
    v_mfma_f32_16x16x32_bf16 v[100:103], a[28:31], v[64:67], v[100:103]
    s_nop 0
    v_fma_f32 v41, v92, v92, s41
    v_fmac_f32 v41, v93, v93
    v_mfma_f32_16x16x32_bf16 v[100:103], a[32:35], v[60:63], v[100:103]
    v_fmac_f32 v41, v94, v94
    v_fmac_f32 v41, v95, v95
    v_mfma_f32_16x16x32_bf16 v[100:103], a[36:39], v[48:51], v[100:103]
    v_mfma_f32_16x16x32_bf16 v[100:103], a[40:43], v[44:47], v[100:103]
    s_waitcnt lgkmcnt(4)
    v_mfma_f32_16x16x32_bf16 v[100:103], a[44:47], v[28:31], v[100:103]
    s_nop 0
    v_mfma_f32_16x16x32_bf16 v[96:99], a[48:51], v[68:71], 0
    s_nop 2
    v_mfma_f32_16x16x32_bf16 v[96:99], a[52:55], v[64:67], v[96:99]
    s_nop 0
    buffer_load_dwordx4 v56, s[32:35], s92 offen offset:0 lds
    v_fmac_f32 v41, v100, v100
    v_mfma_f32_16x16x32_bf16 v[96:99], a[56:59], v[60:63], v[96:99]
    v_fmac_f32 v41, v101, v101
    v_fmac_f32 v41, v102, v102
    v_mfma_f32_16x16x32_bf16 v[96:99], a[60:63], v[48:51], v[96:99]
    v_fmac_f32 v41, v103, v103
    v_mfma_f32_16x16x32_bf16 v[96:99], a[64:67], v[44:47], v[96:99]
    v_mfma_f32_16x16x32_bf16 v[96:99], a[68:71], v[28:31], v[96:99]
    s_nop 0
    v_mfma_f32_16x16x32_bf16 v[48:51], a[0:3], v[24:27], 0
    s_nop 0
    buffer_load_dwordx4 v13, s[32:35], s92 offen offset:1024 lds
    s_nop 0
    v_mfma_f32_16x16x32_bf16 v[48:51], a[4:7], v[20:23], v[48:51]
    s_waitcnt lgkmcnt(0)
    s_nop 0
    v_fmac_f32 v41, v96, v96
    v_fmac_f32 v41, v97, v97
    v_mfma_f32_16x16x32_bf16 v[48:51], a[8:11], v[16:19], v[48:51]
    v_fmac_f32 v41, v98, v98
    v_fmac_f32 v41, v99, v99
    v_mfma_f32_16x16x32_bf16 v[48:51], a[12:15], v[52:55], v[48:51]
    ds_read_b128 v[108:111], v73 offset:40960
    v_mfma_f32_16x16x32_bf16 v[48:51], a[16:19], v[4:7], v[48:51]
    ds_read_b128 v[80:83], v35 offset:40960
    v_mfma_f32_16x16x32_bf16 v[48:51], a[20:23], v[0:3], v[48:51]
    s_waitcnt vmcnt(8)
    buffer_load_dwordx4 v12, s[32:35], s92 offen offset:2048 lds
    ds_read_b64_tr_b16 a[72:73], v14 offset:0
    v_mfma_f32_16x16x32_bf16 v[44:47], a[24:27], v[24:27], 0
    s_add_u32 m0, s90, 49152
    ds_read_b64_tr_b16 a[74:75], v14 offset:768
    v_mfma_f32_16x16x32_bf16 v[44:47], a[28:31], v[20:23], v[44:47]
    s_mov_b32 s92, 147840
    ds_read_b64_tr_b16 a[96:97], v14 offset:32
    v_fma_f32 v40, v48, v48, s41
    v_mfma_f32_16x16x32_bf16 v[44:47], a[32:35], v[16:19], v[44:47]
    ds_read_b64_tr_b16 a[98:99], v14 offset:800
    v_fmac_f32 v40, v49, v49
    v_mfma_f32_16x16x32_bf16 v[44:47], a[36:39], v[52:55], v[44:47]
    ds_read_b64_tr_b16 a[120:121], v14 offset:64
    v_fmac_f32 v40, v50, v50
    v_mfma_f32_16x16x32_bf16 v[44:47], a[40:43], v[4:7], v[44:47]
    buffer_load_dwordx4 v56, s[32:35], s92 offen offset:0 lds
    ds_read_b64_tr_b16 a[122:123], v14 offset:832
    v_mfma_f32_16x16x32_bf16 v[44:47], a[44:47], v[0:3], v[44:47]
    ds_read_b128 v[76:79], v73 offset:41088
    v_fmac_f32 v40, v51, v51
    v_mfma_f32_16x16x32_bf16 v[28:31], a[48:51], v[24:27], 0
    ds_read_b128 v[24:27], v35 offset:41088
    s_nop 0
    v_mfma_f32_16x16x32_bf16 v[28:31], a[52:55], v[20:23], v[28:31]
    s_nop 0
    ds_read_b128 v[20:23], v73 offset:41216
    v_fmac_f32 v40, v44, v44
    v_mfma_f32_16x16x32_bf16 v[28:31], a[56:59], v[16:19], v[28:31]
    ds_read_b128 v[16:19], v35 offset:41216
    v_fmac_f32 v40, v45, v45
    v_mfma_f32_16x16x32_bf16 v[28:31], a[60:63], v[52:55], v[28:31]
    buffer_load_dwordx4 v13, s[32:35], s92 offen offset:1024 lds
    v_fmac_f32 v40, v46, v46
    v_mfma_f32_16x16x32_bf16 v[28:31], a[64:67], v[4:7], v[28:31]
    v_fmac_f32 v40, v47, v47
    v_mfma_f32_16x16x32_bf16 v[28:31], a[68:71], v[0:3], v[28:31]
    s_nop 7
    v_fmac_f32 v40, v28, v28
    v_fmac_f32 v40, v29, v29
    v_fmac_f32 v40, v30, v30
    v_fmac_f32 v40, v31, v31
    buffer_load_dwordx4 v12, s[32:35], s92 offen offset:2048 lds
    s_add_u32 m0, s90, 61440
    s_mov_b32 s92, 184704
    s_waitcnt vmcnt(9)
    ds_read_b64_tr_b16 a[76:77], v14 offset:12288
    ds_read_b64_tr_b16 a[78:79], v14 offset:13056
    ds_read_b64_tr_b16 a[100:101], v14 offset:12320
    ds_read_b64_tr_b16 a[102:103], v14 offset:13088
    ds_read_b64_tr_b16 a[124:125], v14 offset:12352
    ds_read_b64_tr_b16 a[126:127], v14 offset:13120
    buffer_load_dwordx4 v56, s[32:35], s92 offen offset:0 lds
    buffer_load_dwordx4 v13, s[32:35], s92 offen offset:1024 lds
    buffer_load_dwordx4 v12, s[32:35], s92 offen offset:2048 lds
    s_add_u32 m0, s90, 0
    s_mov_b32 s92, 768
    s_waitcnt vmcnt(9)
    ds_read_b64_tr_b16 a[80:81], v14 offset:24576
    ds_read_b64_tr_b16 a[82:83], v14 offset:25344
    ds_read_b64_tr_b16 a[104:105], v14 offset:24608
    ds_read_b64_tr_b16 a[106:107], v14 offset:25376
    ds_read_b64_tr_b16 a[128:129], v14 offset:24640
    ds_read_b64_tr_b16 a[130:131], v14 offset:25408
    s_waitcnt lgkmcnt(6)
    buffer_load_dwordx4 v56, s[32:35], s92 offen offset:0 lds
    buffer_load_dwordx4 v13, s[32:35], s92 offen offset:1024 lds
    buffer_load_dwordx4 v12, s[32:35], s92 offen offset:2048 lds
    s_add_u32 m0, s90, 12288
    s_mov_b32 s92, 37632
    s_waitcnt vmcnt(9)
    ds_read_b64_tr_b16 a[84:85], v14 offset:36864
    ds_read_b64_tr_b16 a[86:87], v14 offset:37632
    ds_read_b64_tr_b16 a[108:109], v14 offset:36896
    ds_read_b64_tr_b16 a[110:111], v14 offset:37664
    ds_read_b64_tr_b16 a[132:133], v14 offset:36928
    ds_read_b64_tr_b16 a[134:135], v14 offset:37696
    buffer_load_dwordx4 v56, s[32:35], s92 offen offset:0 lds
    buffer_load_dwordx4 v13, s[32:35], s92 offen offset:1024 lds
    buffer_load_dwordx4 v12, s[32:35], s92 offen offset:2048 lds
    s_add_u32 m0, s90, 24576
    s_mov_b32 s92, 74496
    s_waitcnt vmcnt(9)
    ds_read_b64_tr_b16 a[88:89], v14 offset:49152
    ds_read_b64_tr_b16 a[90:91], v14 offset:49920
    ds_read_b64_tr_b16 a[112:113], v14 offset:49184
    ds_read_b64_tr_b16 a[114:115], v14 offset:49952
    ds_read_b64_tr_b16 a[136:137], v14 offset:49216
    ds_read_b64_tr_b16 a[138:139], v14 offset:49984
    s_waitcnt lgkmcnt(6)
    buffer_load_dwordx4 v56, s[32:35], s92 offen offset:0 lds
    buffer_load_dwordx4 v13, s[32:35], s92 offen offset:1024 lds
    buffer_load_dwordx4 v12, s[32:35], s92 offen offset:2048 lds
    s_add_u32 m0, s90, 36864
    s_mov_b32 s92, 111360
    s_waitcnt vmcnt(9)
    ds_read_b64_tr_b16 a[92:93], v14 offset:61440
    ds_read_b64_tr_b16 a[94:95], v14 offset:62208
    v_mfma_f32_16x16x32_bf16 v[52:55], a[72:75], v[108:111], 0
    ds_read_b64_tr_b16 a[116:117], v14 offset:61472
    v_mfma_f32_16x16x32_bf16 v[52:55], a[76:79], v[80:83], v[52:55]
    ds_read_b64_tr_b16 a[118:119], v14 offset:62240
    v_mfma_f32_16x16x32_bf16 v[52:55], a[80:83], v[76:79], v[52:55]
    ds_read_b64_tr_b16 a[140:141], v14 offset:61504
    v_mfma_f32_16x16x32_bf16 v[52:55], a[84:87], v[24:27], v[52:55]
    s_waitcnt lgkmcnt(5)
    buffer_load_dwordx4 v56, s[32:35], s92 offen offset:0 lds
    ds_read_b64_tr_b16 a[142:143], v14 offset:62272
    v_mfma_f32_16x16x32_bf16 v[52:55], a[88:91], v[20:23], v[52:55]
    ds_read_b128 v[104:107], v73 offset:42496
    ds_read_b128 v[84:87], v35 offset:42496
    ds_read_b128 v[68:71], v73 offset:42624
    ds_read_b128 v[64:67], v35 offset:42624
    s_waitcnt lgkmcnt(7)
    v_mfma_f32_16x16x32_bf16 v[52:55], a[92:95], v[16:19], v[52:55]
    buffer_load_dwordx4 v13, s[32:35], s92 offen offset:1024 lds
    ds_read_b128 v[60:63], v73 offset:42752
    v_mfma_f32_16x16x32_bf16 v[88:91], a[96:99], v[108:111], 0
    s_nop 1
    ds_read_b128 v[0:3], v35 offset:42752
    v_mfma_f32_16x16x32_bf16 v[88:91], a[100:103], v[80:83], v[88:91]
    s_nop 0
    v_fma_f32 v57, v52, v52, s41
    v_fmac_f32 v57, v53, v53
    v_mfma_f32_16x16x32_bf16 v[88:91], a[104:107], v[76:79], v[88:91]
    v_fmac_f32 v57, v54, v54
    v_fmac_f32 v57, v55, v55
    v_mfma_f32_16x16x32_bf16 v[88:91], a[108:111], v[24:27], v[88:91]
    v_mfma_f32_16x16x32_bf16 v[88:91], a[112:115], v[20:23], v[88:91]
    s_waitcnt vmcnt(8) lgkmcnt(4)
    buffer_load_dwordx4 v12, s[32:35], s92 offen offset:2048 lds
    ds_read_b64_tr_b16 a[144:145], v15 offset:0
    v_mfma_f32_16x16x32_bf16 v[88:91], a[116:119], v[16:19], v[88:91]
    s_add_u32 m0, s90, 49152
    ds_read_b64_tr_b16 a[146:147], v15 offset:768
    v_mfma_f32_16x16x32_bf16 v[4:7], a[120:123], v[108:111], 0
    s_mov_b32 s92, 148224
    s_nop 0
    ds_read_b64_tr_b16 a[168:169], v15 offset:8
    v_mfma_f32_16x16x32_bf16 v[4:7], a[124:127], v[80:83], v[4:7]
    s_nop 0
    v_fmac_f32 v57, v88, v88
    v_fmac_f32 v57, v89, v89
    v_mfma_f32_16x16x32_bf16 v[4:7], a[128:131], v[76:79], v[4:7]
    ds_read_b64_tr_b16 a[170:171], v15 offset:776
    v_fmac_f32 v57, v90, v90
    v_mfma_f32_16x16x32_bf16 v[4:7], a[132:135], v[24:27], v[4:7]
    buffer_load_dwordx4 v56, s[32:35], s92 offen offset:0 lds
    ds_read_b64_tr_b16 a[192:193], v14 offset:64
    v_mfma_f32_16x16x32_bf16 v[4:7], a[136:139], v[20:23], v[4:7]
    ds_read_b64_tr_b16 a[194:195], v14 offset:832
    v_fmac_f32 v57, v91, v91
    v_mfma_f32_16x16x32_bf16 v[4:7], a[140:143], v[16:19], v[4:7]
    s_nop 0
    v_mfma_f32_16x16x32_bf16 v[16:19], a[72:75], v[104:107], 0
    s_nop 2
    v_mfma_f32_16x16x32_bf16 v[16:19], a[76:79], v[84:87], v[16:19]
    s_waitcnt lgkmcnt(5)
    s_nop 0
    v_fmac_f32 v57, v4, v4
    v_fmac_f32 v57, v5, v5
    v_mfma_f32_16x16x32_bf16 v[16:19], a[80:83], v[68:71], v[16:19]
    buffer_load_dwordx4 v13, s[32:35], s92 offen offset:1024 lds
    v_fmac_f32 v57, v6, v6
    v_mfma_f32_16x16x32_bf16 v[16:19], a[84:87], v[64:67], v[16:19]
    v_fmac_f32 v57, v7, v7
    v_cvt_pk_bf16_f32 v170, v41, v57
    v_mfma_f32_16x16x32_bf16 v[16:19], a[88:91], v[60:63], v[16:19]
    v_mfma_f32_16x16x32_bf16 v[16:19], a[92:95], v[0:3], v[16:19]
    ds_read_b128 v[80:83], v73 offset:40960
    v_mfma_f32_16x16x32_bf16 v[24:27], a[96:99], v[104:107], 0
    ds_read_b128 v[76:79], v35 offset:40960
    v_mfma_f32_16x16x32_bf16 v[24:27], a[100:103], v[84:87], v[24:27]
    s_waitcnt vmcnt(8)
    buffer_load_dwordx4 v12, s[32:35], s92 offen offset:2048 lds
    ds_read_b64_tr_b16 a[148:149], v15 offset:12288
    v_mfma_f32_16x16x32_bf16 v[24:27], a[104:107], v[68:71], v[24:27]
    s_add_u32 m0, s90, 61440
    v_fma_f32 v41, v16, v16, s41
    v_fmac_f32 v41, v17, v17
    v_mfma_f32_16x16x32_bf16 v[24:27], a[108:111], v[64:67], v[24:27]
    s_mov_b32 s92, 185088
    ds_read_b64_tr_b16 a[150:151], v15 offset:13056
    v_fmac_f32 v41, v18, v18
    v_mfma_f32_16x16x32_bf16 v[24:27], a[112:115], v[60:63], v[24:27]
    ds_read_b64_tr_b16 a[172:173], v15 offset:12296
    v_fmac_f32 v41, v19, v19
    v_mfma_f32_16x16x32_bf16 v[24:27], a[116:119], v[0:3], v[24:27]
    ds_read_b64_tr_b16 a[174:175], v15 offset:13064
    v_mfma_f32_16x16x32_bf16 v[20:23], a[120:123], v[104:107], 0
    s_nop 0
    buffer_load_dwordx4 v56, s[32:35], s92 offen offset:0 lds
    ds_read_b64_tr_b16 a[196:197], v14 offset:12352
    v_mfma_f32_16x16x32_bf16 v[20:23], a[124:127], v[84:87], v[20:23]
    s_nop 0
    ds_read_b64_tr_b16 a[198:199], v14 offset:13120
    v_fmac_f32 v41, v24, v24
    v_mfma_f32_16x16x32_bf16 v[20:23], a[128:131], v[68:71], v[20:23]
    ds_read_b128 v[68:71], v73 offset:41088
    v_fmac_f32 v41, v25, v25
    v_mfma_f32_16x16x32_bf16 v[20:23], a[132:135], v[64:67], v[20:23]
    ds_read_b128 v[64:67], v35 offset:41088
    v_fmac_f32 v41, v26, v26
    v_mfma_f32_16x16x32_bf16 v[20:23], a[136:139], v[60:63], v[20:23]
    ds_read_b128 v[60:63], v73 offset:41216
    v_fmac_f32 v41, v27, v27
    v_mfma_f32_16x16x32_bf16 v[20:23], a[140:143], v[0:3], v[20:23]
    s_nop 0
    buffer_load_dwordx4 v13, s[32:35], s92 offen offset:1024 lds
    ds_read_b128 v[0:3], v35 offset:41216
    v_mfma_f32_16x16x16_bf16 v[84:87], v[216:217], v[170:171], 0
    s_nop 3
    v_fmac_f32 v41, v20, v20
    v_fmac_f32 v41, v21, v21
    v_fmac_f32 v41, v22, v22
    v_fmac_f32 v41, v23, v23
    v_rsq_f32 v84, v84
    v_rsq_f32 v85, v85
    v_mul_f32 v84, s55, v84
    v_mul_f32 v85, 0.5, v85
    v_mul_f32 v92, v92, v84
    buffer_load_dwordx4 v12, s[32:35], s92 offen offset:2048 lds
    s_add_u32 m0, s90, 0
    s_mov_b32 s92, 0
    s_waitcnt vmcnt(9)
    ds_read_b64_tr_b16 a[152:153], v15 offset:24576
    v_mul_f32 v93, v93, v84
    v_cvt_pk_f16_f32 v92, v92, v93
    v_mul_f32 v94, v94, v84
    ds_read_b64_tr_b16 a[154:155], v15 offset:25344
    v_mul_f32 v95, v95, v84
    v_cvt_pk_f16_f32 v93, v94, v95
    v_mul_f32 v100, v100, v84
    ds_read_b64_tr_b16 a[176:177], v15 offset:24584
    v_mul_f32 v101, v101, v84
    v_cvt_pk_f16_f32 v94, v100, v101
    s_waitcnt lgkmcnt(3)
    buffer_load_dwordx4 v72, s[76:79], s92 offen offset:0 lds
    ds_read_b64_tr_b16 a[178:179], v15 offset:25352
    v_mul_f32 v102, v102, v84
    v_mul_f32 v103, v103, v84
    v_cvt_pk_f16_f32 v95, v102, v103
    ds_read_b64_tr_b16 a[200:201], v14 offset:24640
    v_mul_f32 v96, v96, v84
    ds_read_b64_tr_b16 a[202:203], v14 offset:25408
    v_mul_f32 v97, v97, v84
    v_cvt_pk_f16_f32 v56, v96, v97
    v_mul_f32 v98, v98, v84
    v_mul_f32 v99, v99, v84
    v_cvt_pk_f16_f32 v57, v98, v99
    v_mul_f32 v52, v52, v85
    buffer_load_dwordx4 v9, s[76:79], s92 offen offset:1024 lds
    ds_write_b128 v34, v[92:95] offset:21504
    v_mul_f32 v53, v53, v85
    v_cvt_pk_f16_f32 v52, v52, v53
    v_mul_f32 v54, v54, v85
    v_mul_f32 v55, v55, v85
    v_cvt_pk_f16_f32 v53, v54, v55
    v_mul_f32 v88, v88, v85
    v_mul_f32 v89, v89, v85
    v_cvt_pk_f16_f32 v54, v88, v89
    v_mul_f32 v90, v90, v85
    v_mul_f32 v91, v91, v85
    v_cvt_pk_f16_f32 v55, v90, v91
    v_mul_f32 v4, v4, v85
    buffer_load_dwordx4 v8, s[76:79], s92 offen offset:2048 lds
    s_add_u32 m0, s90, 12288
    s_mov_b32 s92, 12288
    s_waitcnt vmcnt(9)
    ds_read_b64_tr_b16 a[156:157], v15 offset:36864
    v_mul_f32 v5, v5, v85
    v_cvt_pk_f16_f32 v12, v4, v5
    v_mul_f32 v6, v6, v85
    ds_read_b64_tr_b16 a[158:159], v15 offset:37632
    v_mul_f32 v7, v7, v85
    v_cvt_pk_f16_f32 v13, v6, v7
    v_cvt_pk_bf16_f32 v170, v40, v41
    ds_read_b64_tr_b16 a[180:181], v15 offset:36872
    s_nop 0
    v_mfma_f32_16x16x16_bf16 v[4:7], v[216:217], v[170:171], 0
    buffer_load_dwordx4 v72, s[76:79], s92 offen offset:0 lds
    ds_read_b64_tr_b16 a[182:183], v15 offset:37640
    s_nop 2
    ds_read_b64_tr_b16 a[204:205], v14 offset:36928
    s_nop 0
    ds_read_b64_tr_b16 a[206:207], v14 offset:37696
    v_rsq_f32 v4, v4
    ds_write_b128 v34, v[56:59] offset:21520
    v_rsq_f32 v5, v5
    buffer_load_dwordx4 v9, s[76:79], s92 offen offset:1024 lds
    v_mul_f32 v4, s55, v4
    v_mul_f32 v5, 0.5, v5
    v_mul_f32 v48, v48, v4
    ds_write_b128 v34, v[52:55] offset:21536
    v_mul_f32 v49, v49, v4
    v_cvt_pk_f16_f32 v88, v48, v49
    v_mul_f32 v50, v50, v4
    v_mul_f32 v51, v51, v4
    v_cvt_pk_f16_f32 v89, v50, v51
    v_mul_f32 v44, v44, v4
    v_mul_f32 v45, v45, v4
    buffer_load_dwordx4 v8, s[76:79], s92 offen offset:2048 lds
    s_add_u32 m0, s90, 24576
    s_mov_b32 s92, 24576
    s_waitcnt vmcnt(9)
    ds_read_b64_tr_b16 a[160:161], v15 offset:49152
    v_cvt_pk_f16_f32 v90, v44, v45
    v_mul_f32 v46, v46, v4
    v_mul_f32 v47, v47, v4
    ds_read_b64_tr_b16 a[162:163], v15 offset:49920
    v_cvt_pk_f16_f32 v91, v46, v47
    v_mul_f32 v28, v28, v4
    v_mul_f32 v29, v29, v4
    ds_read_b64_tr_b16 a[184:185], v15 offset:49160
    v_cvt_pk_f16_f32 v40, v28, v29
    v_mul_f32 v30, v30, v4
    s_waitcnt lgkmcnt(3)
    buffer_load_dwordx4 v72, s[76:79], s92 offen offset:0 lds
    ds_read_b64_tr_b16 a[186:187], v15 offset:49928
    v_mul_f32 v31, v31, v4
    v_cvt_pk_f16_f32 v41, v30, v31
    v_mul_f32 v16, v16, v5
    ds_read_b64_tr_b16 a[208:209], v14 offset:49216
    v_mul_f32 v17, v17, v5
    ds_read_b64_tr_b16 a[210:211], v14 offset:49984
    v_cvt_pk_f16_f32 v16, v16, v17
    ds_write_b64 v34, v[12:13] offset:21552
    buffer_load_dwordx4 v9, s[76:79], s92 offen offset:1024 lds
    v_mul_f32 v18, v18, v5
    v_mul_f32 v19, v19, v5
    v_cvt_pk_f16_f32 v17, v18, v19
    v_mul_f32 v24, v24, v5
    v_mul_f32 v25, v25, v5
    v_cvt_pk_f16_f32 v18, v24, v25
    v_mul_f32 v26, v26, v5
    v_mul_f32 v27, v27, v5
    v_cvt_pk_f16_f32 v19, v26, v27
    v_mul_f32 v20, v20, v5
    v_mul_f32 v21, v21, v5
    v_cvt_pk_f16_f32 v12, v20, v21
    v_mul_f32 v22, v22, v5
    v_mul_f32 v23, v23, v5
    v_cvt_pk_f16_f32 v13, v22, v23
    buffer_load_dwordx4 v8, s[76:79], s92 offen offset:2048 lds
    s_add_u32 m0, s90, 36864
    s_mov_b32 s92, 36864
    s_waitcnt vmcnt(9)
    ds_read_b64_tr_b16 a[164:165], v15 offset:61440
    ds_read_b64_tr_b16 a[166:167], v15 offset:62208
    v_mfma_f32_16x16x32_bf16 v[56:59], a[144:147], v[80:83], 0
    ds_read_b64_tr_b16 a[188:189], v15 offset:61448
    v_mfma_f32_16x16x32_bf16 v[56:59], a[148:151], v[76:79], v[56:59]
    ds_read_b64_tr_b16 a[190:191], v15 offset:62216
    v_mfma_f32_16x16x32_bf16 v[56:59], a[152:155], v[68:71], v[56:59]
    ds_read_b64_tr_b16 a[212:213], v14 offset:61504
    v_mfma_f32_16x16x32_bf16 v[56:59], a[156:159], v[64:67], v[56:59]
    s_waitcnt lgkmcnt(5)
    buffer_load_dwordx4 v72, s[76:79], s92 offen offset:0 lds
    ds_read_b64_tr_b16 a[214:215], v14 offset:62272
    v_mfma_f32_16x16x32_bf16 v[56:59], a[160:163], v[60:63], v[56:59]
    ds_read_b128 v[52:55], v73 offset:42496
    ds_read_b128 v[48:51], v35 offset:42496
    ds_read_b128 v[44:47], v73 offset:42624
    ds_read_b128 v[28:31], v35 offset:42624
    buffer_load_dwordx4 v9, s[76:79], s92 offen offset:1024 lds
    s_waitcnt lgkmcnt(8)
    v_mfma_f32_16x16x32_bf16 v[56:59], a[164:167], v[0:3], v[56:59]
    ds_read_b128 v[24:27], v73 offset:42752
    s_nop 0
    v_mfma_f32_16x16x32_bf16 v[4:7], a[168:171], v[80:83], 0
    s_nop 0
    ds_read_b128 v[20:23], v35 offset:42752
    s_nop 0
    v_mfma_f32_16x16x32_bf16 v[4:7], a[172:175], v[76:79], v[4:7]
    s_nop 0
    v_cvt_pk_bf16_f32 v14, v56, v57
    v_cvt_pk_bf16_f32 v15, v58, v59
    v_mfma_f32_16x16x32_bf16 v[4:7], a[176:179], v[68:71], v[4:7]
    ds_write_b64 v34, v[14:15] offset:21560
    v_mfma_f32_16x16x32_bf16 v[4:7], a[180:183], v[64:67], v[4:7]
    s_lshl_b32 s93, s68, 10
    buffer_load_dwordx4 v8, s[76:79], s92 offen offset:2048 lds
    v_add_u32 v35, s93, v131
    v_mfma_f32_16x16x32_bf16 v[4:7], a[184:187], v[60:63], v[4:7]
    s_waitcnt lgkmcnt(5)
    s_add_u32 m0, s90, 49152
    v_mfma_f32_16x16x32_bf16 v[4:7], a[188:191], v[0:3], v[4:7]
    s_mov_b32 s92, 49152
    s_nop 0
    v_mfma_f32_16x16x32_bf16 v[56:59], a[192:195], v[80:83], 0
    s_mov_b32 s53, s47
    s_nop 1
    v_mfma_f32_16x16x32_bf16 v[56:59], a[196:199], v[76:79], v[56:59]
    s_mov_b32 s47, s46
    v_cvt_pk_bf16_f32 v4, v4, v5
    v_cvt_pk_bf16_f32 v5, v6, v7
    v_mfma_f32_16x16x32_bf16 v[56:59], a[200:203], v[68:71], v[56:59]
    s_mov_b32 s46, s45
    buffer_load_dwordx4 v72, s[76:79], s92 offen offset:0 lds
    v_mfma_f32_16x16x32_bf16 v[56:59], a[204:207], v[64:67], v[56:59]
    s_mov_b32 s45, s44
    v_mfma_f32_16x16x32_bf16 v[56:59], a[208:211], v[60:63], v[56:59]
    s_mov_b32 s44, s53
    v_mfma_f32_16x16x32_bf16 v[56:59], a[212:215], v[0:3], v[56:59]
    s_sub_u32 s48, s44, s46
    v_add_u32 v139, s48, v139
    v_add_u32 v138, s48, v138
    v_mfma_f32_16x16x32_bf16 v[0:3], a[144:147], v[52:55], 0
    s_sub_u32 s49, s46, s45
    v_mfma_f32_16x16x32_bf16 v[0:3], a[148:151], v[48:51], v[0:3]
    s_waitcnt lgkmcnt(0)
    buffer_load_dwordx4 v9, s[76:79], s92 offen offset:1024 lds
    v_cvt_pk_bf16_f32 v6, v56, v57
    v_mfma_f32_16x16x32_bf16 v[0:3], a[152:155], v[44:47], v[0:3]
    v_cvt_pk_bf16_f32 v7, v58, v59
    v_mfma_f32_16x16x32_bf16 v[0:3], a[156:159], v[28:31], v[0:3]
    ds_write_b128 v34, v[4:7] offset:21568
    v_mfma_f32_16x16x32_bf16 v[0:3], a[160:163], v[24:27], v[0:3]
    v_mfma_f32_16x16x32_bf16 v[0:3], a[164:167], v[20:23], v[0:3]
    buffer_load_dwordx4 v8, s[76:79], s92 offen offset:2048 lds
    s_nop 0
    v_mfma_f32_16x16x32_bf16 v[4:7], a[168:171], v[52:55], 0
    s_add_u32 m0, s90, 61440
    s_nop 1
    v_mfma_f32_16x16x32_bf16 v[4:7], a[172:175], v[48:51], v[4:7]
    s_mov_b32 s92, 61440
    v_cvt_pk_bf16_f32 v14, v0, v1
    v_cvt_pk_bf16_f32 v15, v2, v3
    v_mfma_f32_16x16x32_bf16 v[4:7], a[176:179], v[44:47], v[4:7]
    v_mfma_f32_16x16x32_bf16 v[4:7], a[180:183], v[28:31], v[4:7]
    v_mfma_f32_16x16x32_bf16 v[4:7], a[184:187], v[24:27], v[4:7]
    buffer_load_dwordx4 v72, s[76:79], s92 offen offset:0 lds
    v_mfma_f32_16x16x32_bf16 v[4:7], a[188:191], v[20:23], v[4:7]
    s_nop 1
    v_mfma_f32_16x16x32_bf16 v[0:3], a[192:195], v[52:55], 0
    s_nop 2
    v_mfma_f32_16x16x32_bf16 v[0:3], a[196:199], v[48:51], v[0:3]
    s_nop 0
    v_cvt_pk_bf16_f32 v4, v4, v5
    v_cvt_pk_bf16_f32 v5, v6, v7
    v_mfma_f32_16x16x32_bf16 v[0:3], a[200:203], v[44:47], v[0:3]
    v_mfma_f32_16x16x32_bf16 v[0:3], a[204:207], v[28:31], v[0:3]
    buffer_load_dwordx4 v9, s[76:79], s92 offen offset:1024 lds
    v_mfma_f32_16x16x32_bf16 v[0:3], a[208:211], v[24:27], v[0:3]
    v_mfma_f32_16x16x32_bf16 v[0:3], a[212:215], v[20:23], v[0:3]
    s_nop 7
    v_cvt_pk_bf16_f32 v6, v0, v1
    v_cvt_pk_bf16_f32 v7, v2, v3
    buffer_load_dwordx4 v8, s[76:79], s92 offen offset:2048 lds
    s_add_u32 m0, s54, 20480
    s_nop 0
    buffer_load_dwordx4 v130, s[24:27], s56 offen nt lds
    s_add_u32 m0, s54, 21504
    s_nop 0
    buffer_load_dwordx4 v129, s[24:27], s56 offen nt lds
    s_add_u32 m0, s54, 22528
    s_nop 0
    buffer_load_dwordx4 v128, s[24:27], s56 offen nt lds
    s_add_u32 m0, s54, 23552
    s_nop 0
    buffer_load_dwordx4 v127, s[24:27], s56 offen nt lds
    s_add_u32 m0, s54, 24576
    s_nop 0
    buffer_load_dwordx4 v126, s[24:27], s56 offen nt lds
    s_waitcnt vmcnt(5)
    s_barrier
    ds_read_b128 v[28:31], v11 offset:0
    ds_read_b64 v[48:49], v10 offset:64
    ds_read_b128 v[0:3], v11 offset:3072
    ds_read_b64 v[50:51], v10 offset:3136
    ds_read_b128 v[52:55], v11 offset:6144
    ds_read_b64 v[20:21], v10 offset:6208
    ds_read_b128 v[24:27], v11 offset:9216
    ds_read_b64 v[22:23], v10 offset:9280
    ds_read_b128 v[44:47], v11 offset:12288
    ds_read_b64 v[56:57], v10 offset:12352
    ds_read_b128 v[68:71], v11 offset:15360
    ds_read_b64 v[58:59], v10 offset:15424
    s_waitcnt lgkmcnt(11)
    v_mfma_f32_16x16x32_bf16 v[60:63], v[28:31], v[220:223], 0
    s_waitcnt lgkmcnt(9)
    ds_read_b128 v[28:31], v11 offset:18432
    v_mfma_f32_16x16x32_bf16 v[60:63], v[0:3], v[220:223], v[60:63]
    s_waitcnt lgkmcnt(8)
    ds_read_b64 v[0:1], v10 offset:18496
    ds_read_b128 v[64:67], v11 offset:21504
    v_mfma_f32_16x16x32_bf16 v[60:63], v[52:55], v[220:223], v[60:63]
    s_waitcnt lgkmcnt(8)
    ds_read_b64 v[2:3], v10 offset:21568
    ds_read_b128 v[52:55], v11 offset:24576
    v_mfma_f32_16x16x32_bf16 v[60:63], v[24:27], v[220:223], v[60:63]
    ds_read_b64 v[24:25], v10 offset:24640
    v_mfma_f32_16x16x32_bf16 v[60:63], v[48:51], v[220:223], v[60:63]
    s_waitcnt lgkmcnt(9)
    ds_read_b128 v[48:51], v11 offset:27648
    v_mfma_f32_16x16x32_bf16 v[60:63], v[20:23], v[220:223], v[60:63]
    ds_read_b64 v[26:27], v10 offset:27712
    v_mfma_f32_16x16x32_bf16 v[20:23], v[44:47], v[220:223], 0
    s_waitcnt lgkmcnt(8)
    ds_read_b128 v[44:47], v11 offset:30720
    v_mfma_f32_16x16x32_bf16 v[20:23], v[68:71], v[220:223], v[20:23]
    s_waitcnt lgkmcnt(8)
    s_nop 0
    ds_read_b64 v[8:9], v10 offset:30784
    v_mul_f32 v60, 0xbbaaaaab, v60
    v_mfma_f32_16x16x32_bf16 v[20:23], v[28:31], v[220:223], v[20:23]
    s_waitcnt lgkmcnt(7)
    ds_read_b128 v[28:31], v11 offset:33792
    v_mul_f32 v61, 0xbbaaaaab, v61
    v_mul_f32 v62, 0xbbaaaaab, v62
    v_mul_f32 v63, 0xbbaaaaab, v63
    v_mfma_f32_16x16x32_bf16 v[20:23], v[64:67], v[220:223], v[20:23]
    ds_write_b128 v33, v[60:63] offset:0
    v_mfma_f32_16x16x32_bf16 v[20:23], v[56:59], v[220:223], v[20:23]
    s_waitcnt lgkmcnt(6)
    v_mfma_f32_16x16x32_bf16 v[20:23], v[0:3], v[220:223], v[20:23]
    v_mfma_f32_16x16x32_bf16 v[0:3], v[52:55], v[220:223], 0
    s_waitcnt lgkmcnt(4)
    ds_read_b64 v[10:11], v10 offset:33856
    s_nop 0
    v_mfma_f32_16x16x32_bf16 v[0:3], v[48:51], v[220:223], v[0:3]
    s_waitcnt lgkmcnt(4)
    s_nop 0
    ds_read_b128 v[52:55], v32 offset:0
    v_mul_f32 v20, 0xbbaaaaab, v20
    v_mfma_f32_16x16x32_bf16 v[0:3], v[44:47], v[220:223], v[0:3]
    s_waitcnt lgkmcnt(3)
    ds_read_b64 v[56:57], v75 offset:64
    v_mul_f32 v21, 0xbbaaaaab, v21
    v_mul_f32 v22, 0xbbaaaaab, v22
    v_mul_f32 v23, 0xbbaaaaab, v23
    v_mfma_f32_16x16x32_bf16 v[0:3], v[28:31], v[220:223], v[0:3]
    ds_write_b128 v33, v[20:23] offset:128
    v_mfma_f32_16x16x32_bf16 v[0:3], v[24:27], v[220:223], v[0:3]
    ds_read_b128 v[82:85], v32 offset:768
    ds_read_b64 v[86:87], v75 offset:832
    ds_read_b128 v[76:79], v32 offset:12288
    s_waitcnt lgkmcnt(6)
    v_mfma_f32_16x16x32_bf16 v[0:3], v[8:11], v[220:223], v[0:3]
    s_nop 0
    ds_read_b64 v[80:81], v75 offset:12352
    s_nop 0
    ds_read_b128 v[68:71], v32 offset:13056
    s_nop 2
    ds_read_b64 v[72:73], v75 offset:13120
    v_mul_f32 v0, 0xbbaaaaab, v0
    v_mul_f32 v1, 0xbbaaaaab, v1
    v_mul_f32 v2, 0xbbaaaaab, v2
    v_mul_f32 v3, 0xbbaaaaab, v3
    ds_write_b128 v33, v[0:3] offset:256
    s_waitcnt lgkmcnt(0)
    s_barrier
    ds_read_b128 v[0:3], v74 offset:0
    ds_read_b128 v[48:51], v74 offset:64
    ds_read_b128 v[28:31], v74 offset:128
    ds_read_b128 v[24:27], v74 offset:192
    s_waitcnt lgkmcnt(3)
    v_mfma_f32_16x16x16_bf16 v[44:47], v[52:53], v[146:147], v[0:3]
    v_mfma_f32_16x16x16_bf16 v[20:23], v[54:55], v[146:147], v[0:3]
    s_nop 2
    v_mfma_f32_16x16x16_bf16 v[64:67], v[56:57], v[146:147], v[0:3]
    s_waitcnt lgkmcnt(0)
    s_nop 0
    ds_read_b128 v[56:59], v32 offset:24576
    v_cvt_pk_bf16_f32 v44, v44, v45
    v_mfma_f32_16x16x16_bf16 v[8:11], v[82:83], v[146:147], v[48:51]
    ds_read_b64 v[60:61], v75 offset:24640
    v_accvgpr_write_b32 a216, v44
    v_mfma_f32_16x16x16_bf16 v[116:119], v[84:85], v[146:147], v[48:51]
    ds_read_b128 v[52:55], v74 offset:256
    v_cvt_pk_bf16_f32 v46, v46, v47
    v_mfma_f32_16x16x16_bf16 v[0:3], v[86:87], v[146:147], v[48:51]
    ds_read_b128 v[108:111], v32 offset:25344
    v_accvgpr_write_b32 a217, v46
    v_mfma_f32_16x16x16_bf16 v[100:103], v[76:77], v[146:147], v[28:31]
    ds_read_b64 v[112:113], v75 offset:25408
    v_cvt_pk_bf16_f32 v20, v20, v21
    v_mfma_f32_16x16x16_bf16 v[48:51], v[78:79], v[146:147], v[28:31]
    ds_read_b128 v[104:107], v74 offset:320
    v_accvgpr_write_b32 a240, v20
    v_mfma_f32_16x16x16_bf16 v[44:47], v[80:81], v[146:147], v[28:31]
    ds_read_b128 v[92:95], v32 offset:36864
    v_cvt_pk_bf16_f32 v22, v22, v23
    v_mfma_f32_16x16x16_bf16 v[84:87], v[68:69], v[146:147], v[24:27]
    ds_read_b64 v[96:97], v75 offset:36928
    v_accvgpr_write_b32 a241, v22
    v_mfma_f32_16x16x16_bf16 v[28:31], v[70:71], v[146:147], v[24:27]
    ds_read_b128 v[80:83], v74 offset:5120
    v_cvt_pk_bf16_f32 v232, v64, v65
    v_mfma_f32_16x16x16_bf16 v[20:23], v[72:73], v[146:147], v[24:27]
    s_waitcnt lgkmcnt(6)
    ds_read_b128 v[224:227], v32 offset:37632
    v_cvt_pk_bf16_f32 v233, v66, v67
    v_cvt_pk_bf16_f32 v8, v8, v9
    v_accvgpr_write_b32 a218, v8
    v_cvt_pk_bf16_f32 v10, v10, v11
    v_accvgpr_write_b32 a219, v10
    v_cvt_pk_bf16_f32 v116, v116, v117
    v_mfma_f32_16x16x16_bf16 v[76:79], v[56:57], v[146:147], v[52:55]
    ds_read_b64 v[228:229], v75 offset:37696
    v_accvgpr_write_b32 a242, v116
    v_mfma_f32_16x16x16_bf16 v[24:27], v[58:59], v[146:147], v[52:55]
    ds_read_b128 v[64:67], v74 offset:5184
    v_cvt_pk_bf16_f32 v118, v118, v119
    v_mfma_f32_16x16x16_bf16 v[8:11], v[60:61], v[146:147], v[52:55]
    s_waitcnt lgkmcnt(6)
    ds_read_b128 v[68:71], v32 offset:49152
    v_accvgpr_write_b32 a243, v118
    v_cvt_pk_bf16_f32 v234, v0, v1
    v_cvt_pk_bf16_f32 v235, v2, v3
    v_mfma_f32_16x16x16_bf16 v[56:59], v[108:109], v[146:147], v[104:107]
    ds_read_b64 v[72:73], v75 offset:49216
    v_cvt_pk_bf16_f32 v100, v100, v101
    v_mfma_f32_16x16x16_bf16 v[52:55], v[110:111], v[146:147], v[104:107]
    ds_read_b128 v[60:63], v74 offset:5248
    v_accvgpr_write_b32 a220, v100
    v_mfma_f32_16x16x16_bf16 v[0:3], v[112:113], v[146:147], v[104:107]
    s_waitcnt lgkmcnt(6)
    ds_read_b128 v[116:119], v32 offset:49920
    v_cvt_pk_bf16_f32 v102, v102, v103
    v_accvgpr_write_b32 a221, v102
    v_cvt_pk_bf16_f32 v48, v48, v49
    v_accvgpr_write_b32 a244, v48
    v_cvt_pk_bf16_f32 v50, v50, v51
    v_accvgpr_write_b32 a245, v50
    v_cvt_pk_bf16_f32 v236, v44, v45
    v_cvt_pk_bf16_f32 v237, v46, v47
    v_mfma_f32_16x16x16_bf16 v[108:111], v[92:93], v[146:147], v[80:83]
    ds_read_b64 v[120:121], v75 offset:49984
    v_cvt_pk_bf16_f32 v84, v84, v85
    v_mfma_f32_16x16x16_bf16 v[44:47], v[94:95], v[146:147], v[80:83]
    ds_read_b128 v[112:115], v74 offset:5312
    v_accvgpr_write_b32 a222, v84
    v_mfma_f32_16x16x16_bf16 v[48:51], v[96:97], v[146:147], v[80:83]
    s_waitcnt lgkmcnt(5)
    ds_read_b128 v[100:103], v32 offset:61440
    v_cvt_pk_bf16_f32 v86, v86, v87
    v_accvgpr_write_b32 a223, v86
    v_cvt_pk_bf16_f32 v28, v28, v29
    v_accvgpr_write_b32 a246, v28
    v_cvt_pk_bf16_f32 v30, v30, v31
    v_accvgpr_write_b32 a247, v30
    v_cvt_pk_bf16_f32 v238, v20, v21
    v_cvt_pk_bf16_f32 v239, v22, v23
    v_mfma_f32_16x16x16_bf16 v[96:99], v[224:225], v[146:147], v[64:67]
    ds_read_b64 v[104:105], v75 offset:61504
    v_cvt_pk_bf16_f32 v76, v76, v77
    v_mfma_f32_16x16x16_bf16 v[92:95], v[226:227], v[146:147], v[64:67]
    ds_read_b128 v[20:23], v74 offset:5376
    v_accvgpr_write_b32 a224, v76
    v_mfma_f32_16x16x16_bf16 v[84:87], v[228:229], v[146:147], v[64:67]
    s_waitcnt lgkmcnt(5)
    ds_read_b128 v[28:31], v32 offset:62208
    v_cvt_pk_bf16_f32 v78, v78, v79
    v_accvgpr_write_b32 a225, v78
    v_cvt_pk_bf16_f32 v24, v24, v25
    v_accvgpr_write_b32 a248, v24
    v_cvt_pk_bf16_f32 v26, v26, v27
    v_accvgpr_write_b32 a249, v26
    v_cvt_pk_bf16_f32 v240, v8, v9
    v_cvt_pk_bf16_f32 v241, v10, v11
    v_mfma_f32_16x16x16_bf16 v[80:83], v[68:69], v[146:147], v[60:63]
    ds_read_b64 v[32:33], v75 offset:62272
    v_cvt_pk_bf16_f32 v56, v56, v57
    v_mfma_f32_16x16x16_bf16 v[76:79], v[70:71], v[146:147], v[60:63]
    ds_read_b128 v[24:27], v74 offset:5440
    v_accvgpr_write_b32 a226, v56
    v_mfma_f32_16x16x16_bf16 v[68:71], v[72:73], v[146:147], v[60:63]
    s_waitcnt lgkmcnt(5)
    ds_read_b128 v[8:11], v139 offset:0
    v_cvt_pk_bf16_f32 v58, v58, v59
    v_accvgpr_write_b32 a227, v58
    v_cvt_pk_bf16_f32 v52, v52, v53
    v_accvgpr_write_b32 a250, v52
    v_cvt_pk_bf16_f32 v54, v54, v55
    v_accvgpr_write_b32 a251, v54
    v_cvt_pk_bf16_f32 v242, v0, v1
    v_cvt_pk_bf16_f32 v243, v2, v3
    v_mfma_f32_16x16x16_bf16 v[64:67], v[116:117], v[146:147], v[112:115]
    ds_read_b128 v[60:63], v138 offset:0
    v_cvt_pk_bf16_f32 v108, v108, v109
    v_mfma_f32_16x16x16_bf16 v[56:59], v[118:119], v[146:147], v[112:115]
    ds_read_b128 v[0:3], v139 offset:128
    v_accvgpr_write_b32 a228, v108
    v_mfma_f32_16x16x16_bf16 v[52:55], v[120:121], v[146:147], v[112:115]
    s_waitcnt lgkmcnt(5)
    ds_read_b128 v[72:75], v138 offset:128
    v_cvt_pk_bf16_f32 v110, v110, v111
    v_accvgpr_write_b32 a229, v110
    v_cvt_pk_bf16_f32 v44, v44, v45
    v_accvgpr_write_b32 a252, v44
    v_cvt_pk_bf16_f32 v46, v46, v47
    v_accvgpr_write_b32 a253, v46
    v_cvt_pk_bf16_f32 v244, v48, v49
    v_cvt_pk_bf16_f32 v245, v50, v51
    v_mfma_f32_16x16x16_bf16 v[48:51], v[100:101], v[146:147], v[20:23]
    s_waitcnt vmcnt(0) lgkmcnt(4)
    s_barrier
    ds_write_b128 v35, v[36:39] offset:6144
    v_mfma_f32_16x16x16_bf16 v[44:47], v[102:103], v[146:147], v[20:23]
    v_cvt_pk_bf16_f32 v96, v96, v97
    v_accvgpr_write_b32 a230, v96
    v_mfma_f32_16x16x16_bf16 v[36:39], v[104:105], v[146:147], v[20:23]
    s_waitcnt lgkmcnt(4)
    v_cvt_pk_bf16_f32 v98, v98, v99
    v_accvgpr_write_b32 a231, v98
    v_cvt_pk_bf16_f32 v92, v92, v93
    v_mfma_f32_16x16x32_bf16 v[20:23], a[0:3], v[8:11], 0
    s_waitcnt lgkmcnt(3)
    ds_write_b128 v34, v[216:219] offset:80
    v_mfma_f32_16x16x32_bf16 v[20:23], a[4:7], v[60:63], v[20:23]
    s_waitcnt lgkmcnt(2)
    v_accvgpr_write_b32 a254, v92
    v_cvt_pk_bf16_f32 v94, v94, v95
    v_mfma_f32_16x16x32_bf16 v[20:23], a[8:11], v[0:3], v[20:23]
    v_accvgpr_write_b32 a255, v94
    v_cvt_pk_bf16_f32 v246, v84, v85
    v_mfma_f32_16x16x32_bf16 v[20:23], a[12:15], v[72:75], v[20:23]
    ds_write_b128 v34, v[88:91] offset:0
    v_cvt_pk_bf16_f32 v247, v86, v87
    v_cvt_pk_bf16_f32 v80, v80, v81
    v_accvgpr_write_b32 a232, v80
    v_cvt_pk_bf16_f32 v82, v82, v83
    v_accvgpr_write_b32 a233, v82
    v_cvt_pk_bf16_f32 v224, v76, v77
    v_cvt_pk_bf16_f32 v225, v78, v79
    v_cvt_pk_bf16_f32 v248, v68, v69
    v_cvt_pk_bf16_f32 v249, v70, v71
    v_cvt_pk_bf16_f32 v64, v64, v65
    v_accvgpr_write_b32 a234, v64
    v_cvt_pk_bf16_f32 v66, v66, v67
    v_accvgpr_write_b32 a235, v66
    v_cvt_pk_bf16_f32 v226, v56, v57
    v_cvt_pk_bf16_f32 v227, v58, v59
    v_cvt_pk_bf16_f32 v250, v52, v53
    v_cvt_pk_bf16_f32 v251, v54, v55
    v_cvt_pk_bf16_f32 v48, v48, v49
    v_accvgpr_write_b32 a236, v48
    v_cvt_pk_bf16_f32 v50, v50, v51
    v_accvgpr_write_b32 a237, v50
    v_cvt_pk_bf16_f32 v228, v44, v45
    v_cvt_pk_bf16_f32 v229, v46, v47
    v_cvt_pk_bf16_f32 v252, v36, v37
    v_cvt_pk_bf16_f32 v253, v38, v39
    ds_write_b128 v34, v[40:43] offset:16
    v_add_u32 v137, s49, v137
    v_add_u32 v136, s49, v136
    ds_write_b128 v34, v[16:19] offset:32
    ds_write_b128 v34, v[12:15] offset:48
    ds_write_b128 v34, v[4:7] offset:64
    ds_read_b128 v[76:79], v139 offset:256
    ds_read_b128 v[64:67], v138 offset:256
    s_waitcnt lgkmcnt(1)
    v_mfma_f32_16x16x32_bf16 v[20:23], a[16:19], v[76:79], v[20:23]
    s_waitcnt lgkmcnt(0)
    v_mfma_f32_16x16x32_bf16 v[20:23], a[20:23], v[64:67], v[20:23]
    s_nop 0
    v_mfma_f32_16x16x16_bf16 v[16:19], v[28:29], v[146:147], v[24:27]
    s_nop 3
    v_mfma_f32_16x16x16_bf16 v[12:15], v[30:31], v[146:147], v[24:27]
    s_nop 0
    v_fma_f32 v143, v20, v20, s41
    v_fmac_f32 v143, v21, v21
    v_mfma_f32_16x16x16_bf16 v[4:7], v[32:33], v[146:147], v[24:27]
    v_cvt_pk_bf16_f32 v16, v16, v17
    v_accvgpr_write_b32 a238, v16
    v_cvt_pk_bf16_f32 v18, v18, v19
    v_mfma_f32_16x16x32_bf16 v[52:55], a[24:27], v[8:11], 0
    v_accvgpr_write_b32 a239, v18
    v_cvt_pk_bf16_f32 v230, v12, v13
    v_mfma_f32_16x16x32_bf16 v[52:55], a[28:31], v[60:63], v[52:55]
    v_cvt_pk_bf16_f32 v231, v14, v15
    v_cvt_pk_bf16_f32 v254, v4, v5
    v_mfma_f32_16x16x32_bf16 v[52:55], a[32:35], v[0:3], v[52:55]
    v_cvt_pk_bf16_f32 v255, v6, v7
    v_fmac_f32 v143, v22, v22
    v_mfma_f32_16x16x32_bf16 v[52:55], a[36:39], v[72:75], v[52:55]
    v_fmac_f32 v143, v23, v23
    v_mfma_f32_16x16x32_bf16 v[52:55], a[40:43], v[76:79], v[52:55]
    v_mfma_f32_16x16x32_bf16 v[52:55], a[44:47], v[64:67], v[52:55]
    s_nop 1
    v_mfma_f32_16x16x32_bf16 v[48:51], a[48:51], v[8:11], 0
    s_nop 2
    v_mfma_f32_16x16x32_bf16 v[48:51], a[52:55], v[60:63], v[48:51]
    s_nop 0
    v_fmac_f32 v143, v52, v52
    v_fmac_f32 v143, v53, v53
    v_mfma_f32_16x16x32_bf16 v[48:51], a[56:59], v[0:3], v[48:51]
    v_fmac_f32 v143, v54, v54
    v_fmac_f32 v143, v55, v55
    v_mfma_f32_16x16x32_bf16 v[48:51], a[60:63], v[72:75], v[48:51]
    v_mfma_f32_16x16x32_bf16 v[48:51], a[64:67], v[76:79], v[48:51]
    v_mfma_f32_16x16x32_bf16 v[48:51], a[68:71], v[64:67], v[48:51]
    s_nop 1
    v_mfma_f32_16x16x32_bf16 v[44:47], a[72:75], v[8:11], 0
    s_nop 2
    v_mfma_f32_16x16x32_bf16 v[44:47], a[76:79], v[60:63], v[44:47]
    s_nop 0
    v_fmac_f32 v143, v48, v48
    v_fmac_f32 v143, v49, v49
    v_mfma_f32_16x16x32_bf16 v[44:47], a[80:83], v[0:3], v[44:47]
    v_fmac_f32 v143, v50, v50
    v_fmac_f32 v143, v51, v51
    v_mfma_f32_16x16x32_bf16 v[44:47], a[84:87], v[72:75], v[44:47]
    v_mfma_f32_16x16x32_bf16 v[44:47], a[88:91], v[76:79], v[44:47]
    v_mfma_f32_16x16x32_bf16 v[44:47], a[92:95], v[64:67], v[44:47]
    s_nop 1
    v_mfma_f32_16x16x32_bf16 v[4:7], a[96:99], v[8:11], 0
    s_nop 2
    v_mfma_f32_16x16x32_bf16 v[4:7], a[100:103], v[60:63], v[4:7]
    s_nop 0
    v_fma_f32 v142, v44, v44, s41
    v_fmac_f32 v142, v45, v45
    v_mfma_f32_16x16x32_bf16 v[4:7], a[104:107], v[0:3], v[4:7]
    v_fmac_f32 v142, v46, v46
    v_fmac_f32 v142, v47, v47
    v_mfma_f32_16x16x32_bf16 v[4:7], a[108:111], v[72:75], v[4:7]
    v_mfma_f32_16x16x32_bf16 v[4:7], a[112:115], v[76:79], v[4:7]
    v_mfma_f32_16x16x32_bf16 v[4:7], a[116:119], v[64:67], v[4:7]
    s_nop 1
    v_mfma_f32_16x16x32_bf16 v[36:39], a[120:123], v[8:11], 0
    s_nop 2
    v_mfma_f32_16x16x32_bf16 v[36:39], a[124:127], v[60:63], v[36:39]
    s_nop 0
    v_fmac_f32 v142, v4, v4
    v_fmac_f32 v142, v5, v5
    v_mfma_f32_16x16x32_bf16 v[36:39], a[128:131], v[0:3], v[36:39]
    v_fmac_f32 v142, v6, v6
    v_fmac_f32 v142, v7, v7
    v_mfma_f32_16x16x32_bf16 v[36:39], a[132:135], v[72:75], v[36:39]
    v_mfma_f32_16x16x32_bf16 v[36:39], a[136:139], v[76:79], v[36:39]
    v_mfma_f32_16x16x32_bf16 v[36:39], a[140:143], v[64:67], v[36:39]
    s_nop 1
    v_mfma_f32_16x16x32_bf16 v[12:15], v[8:11], a[144:147], 0
    s_nop 2
    v_mfma_f32_16x16x32_bf16 v[12:15], v[60:63], a[148:151], v[12:15]
    s_nop 0
    v_fmac_f32 v142, v36, v36
    v_fmac_f32 v142, v37, v37
    v_mfma_f32_16x16x32_bf16 v[12:15], v[0:3], a[152:155], v[12:15]
    v_fmac_f32 v142, v38, v38
    v_fmac_f32 v142, v39, v39
    v_mfma_f32_16x16x32_bf16 v[12:15], v[72:75], a[156:159], v[12:15]
    v_cvt_pk_bf16_f32 v170, v143, v142
    v_mfma_f32_16x16x32_bf16 v[12:15], v[76:79], a[160:163], v[12:15]
    ds_read_b128 v[108:111], v139 offset:1536
    v_mfma_f32_16x16x32_bf16 v[12:15], v[64:67], a[164:167], v[12:15]
    s_nop 0
    ds_read_b128 v[104:107], v138 offset:1536
    s_nop 0
    v_mfma_f32_16x16x16_bf16 v[40:43], v[216:217], v[170:171], 0
    s_nop 0
    ds_read_b128 v[88:91], v139 offset:1664
    s_nop 1
    v_cvt_pk_bf16_f32 v24, v12, v13
    v_mfma_f32_16x16x32_bf16 v[16:19], v[8:11], a[168:171], 0
    ds_read_b128 v[100:103], v138 offset:1664
    v_cvt_pk_bf16_f32 v25, v14, v15
    v_mfma_f32_16x16x32_bf16 v[16:19], v[60:63], a[172:175], v[16:19]
    ds_read_b128 v[68:71], v139 offset:1792
    v_mfma_f32_16x16x32_bf16 v[16:19], v[0:3], a[176:179], v[16:19]
    ds_read_b128 v[12:15], v138 offset:1792
    v_mfma_f32_16x16x32_bf16 v[16:19], v[72:75], a[180:183], v[16:19]
    v_rsq_f32 v40, v40
    v_mfma_f32_16x16x32_bf16 v[16:19], v[76:79], a[184:187], v[16:19]
    v_rsq_f32 v41, v41
    v_mfma_f32_16x16x32_bf16 v[16:19], v[64:67], a[188:191], v[16:19]
    v_mul_f32 v40, s55, v40
    v_mul_f32 v41, 0.5, v41
    v_mfma_f32_16x16x32_bf16 v[32:35], v[8:11], a[192:195], 0
    s_nop 0
    v_mul_f32 v20, v20, v40
    v_mul_f32 v21, v21, v40
    v_mfma_f32_16x16x32_bf16 v[32:35], v[60:63], a[196:199], v[32:35]
    s_nop 0
    v_cvt_pk_bf16_f32 v28, v16, v17
    v_cvt_pk_bf16_f32 v29, v18, v19
    v_mfma_f32_16x16x32_bf16 v[32:35], v[0:3], a[200:203], v[32:35]
    v_cvt_pk_f16_f32 v16, v20, v21
    v_mul_f32 v22, v22, v40
    v_mfma_f32_16x16x32_bf16 v[32:35], v[72:75], a[204:207], v[32:35]
    v_mul_f32 v23, v23, v40
    v_cvt_pk_f16_f32 v17, v22, v23
    v_mfma_f32_16x16x32_bf16 v[32:35], v[76:79], a[208:211], v[32:35]
    v_mul_f32 v52, v52, v40
    v_mul_f32 v53, v53, v40
    v_mfma_f32_16x16x32_bf16 v[32:35], v[64:67], a[212:215], v[32:35]
    s_waitcnt lgkmcnt(0)
    v_cvt_pk_f16_f32 v18, v52, v53
    v_mul_f32 v54, v54, v40
    v_mfma_f32_16x16x32_bf16 v[64:67], a[0:3], v[108:111], 0
    v_mul_f32 v55, v55, v40
    v_cvt_pk_f16_f32 v19, v54, v55
    v_mfma_f32_16x16x32_bf16 v[64:67], a[4:7], v[104:107], v[64:67]
    v_mul_f32 v48, v48, v40
    v_mul_f32 v49, v49, v40
    v_mfma_f32_16x16x32_bf16 v[64:67], a[8:11], v[88:91], v[64:67]
    v_cvt_pk_f16_f32 v154, v48, v49
    v_mul_f32 v50, v50, v40
    v_mfma_f32_16x16x32_bf16 v[64:67], a[12:15], v[100:103], v[64:67]
    v_mul_f32 v51, v51, v40
    v_cvt_pk_f16_f32 v155, v50, v51
    v_mfma_f32_16x16x32_bf16 v[64:67], a[16:19], v[68:71], v[64:67]
    v_mul_f32 v44, v44, v41
    v_mul_f32 v45, v45, v41
    v_mfma_f32_16x16x32_bf16 v[64:67], a[20:23], v[12:15], v[64:67]
    v_cvt_pk_f16_f32 v82, v44, v45
    v_mul_f32 v46, v46, v41
    v_mfma_f32_16x16x32_bf16 v[52:55], a[24:27], v[108:111], 0
    v_mul_f32 v47, v47, v41
    v_cvt_pk_f16_f32 v83, v46, v47
    v_mfma_f32_16x16x32_bf16 v[52:55], a[28:31], v[104:107], v[52:55]
    v_mul_f32 v4, v4, v41
    v_mul_f32 v5, v5, v41
    v_mfma_f32_16x16x32_bf16 v[52:55], a[32:35], v[88:91], v[52:55]
    v_cvt_pk_f16_f32 v84, v4, v5
    v_mul_f32 v6, v6, v41
    v_mfma_f32_16x16x32_bf16 v[52:55], a[36:39], v[100:103], v[52:55]
    v_mul_f32 v7, v7, v41
    v_cvt_pk_f16_f32 v85, v6, v7
    v_mfma_f32_16x16x32_bf16 v[52:55], a[40:43], v[68:71], v[52:55]
    v_mul_f32 v36, v36, v41
    v_mul_f32 v37, v37, v41
    v_mfma_f32_16x16x32_bf16 v[52:55], a[44:47], v[12:15], v[52:55]
    v_cvt_pk_f16_f32 v86, v36, v37
    v_mul_f32 v38, v38, v41
    v_mfma_f32_16x16x32_bf16 v[4:7], a[48:51], v[108:111], 0
    v_mul_f32 v39, v39, v41
    v_cvt_pk_f16_f32 v87, v38, v39
    v_mfma_f32_16x16x32_bf16 v[4:7], a[52:55], v[104:107], v[4:7]
    v_cvt_pk_bf16_f32 v32, v32, v33
    v_cvt_pk_bf16_f32 v33, v34, v35
    v_mfma_f32_16x16x32_bf16 v[4:7], a[56:59], v[88:91], v[4:7]
    v_fma_f32 v26, v64, v64, s41
    v_fmac_f32 v26, v65, v65
    v_mfma_f32_16x16x32_bf16 v[4:7], a[60:63], v[100:103], v[4:7]
    v_fmac_f32 v26, v66, v66
    v_fmac_f32 v26, v67, v67
    v_mfma_f32_16x16x32_bf16 v[4:7], a[64:67], v[68:71], v[4:7]
    v_fmac_f32 v26, v52, v52
    v_fmac_f32 v26, v53, v53
    v_mfma_f32_16x16x32_bf16 v[4:7], a[68:71], v[12:15], v[4:7]
    v_fmac_f32 v26, v54, v54
    v_fmac_f32 v26, v55, v55
    v_mfma_f32_16x16x32_bf16 v[48:51], a[72:75], v[108:111], 0
    s_nop 2
    v_mfma_f32_16x16x32_bf16 v[48:51], a[76:79], v[104:107], v[48:51]
    s_nop 0
    v_fmac_f32 v26, v4, v4
    v_fmac_f32 v26, v5, v5
    v_mfma_f32_16x16x32_bf16 v[48:51], a[80:83], v[88:91], v[48:51]
    v_fmac_f32 v26, v6, v6
    v_fmac_f32 v26, v7, v7
    v_mfma_f32_16x16x32_bf16 v[48:51], a[84:87], v[100:103], v[48:51]
    v_mfma_f32_16x16x32_bf16 v[48:51], a[88:91], v[68:71], v[48:51]
    v_mfma_f32_16x16x32_bf16 v[48:51], a[92:95], v[12:15], v[48:51]
    s_nop 1
    v_mfma_f32_16x16x32_bf16 v[0:3], a[96:99], v[108:111], 0
    s_nop 2
    v_mfma_f32_16x16x32_bf16 v[0:3], a[100:103], v[104:107], v[0:3]
    s_nop 0
    v_fma_f32 v27, v48, v48, s41
    v_fmac_f32 v27, v49, v49
    v_mfma_f32_16x16x32_bf16 v[0:3], a[104:107], v[88:91], v[0:3]
    v_fmac_f32 v27, v50, v50
    v_fmac_f32 v27, v51, v51
    v_mfma_f32_16x16x32_bf16 v[0:3], a[108:111], v[100:103], v[0:3]
    v_mfma_f32_16x16x32_bf16 v[0:3], a[112:115], v[68:71], v[0:3]
    v_mfma_f32_16x16x32_bf16 v[0:3], a[116:119], v[12:15], v[0:3]
    s_sub_u32 s50, s45, s44
    v_add_u32 v137, s48, v137
    v_add_u32 v136, s48, v136
    v_mfma_f32_16x16x32_bf16 v[44:47], a[120:123], v[108:111], 0
    s_sub_u32 s51, s46, s47
    v_add_u32 v135, s51, v135
    v_mfma_f32_16x16x32_bf16 v[44:47], a[124:127], v[104:107], v[44:47]
    s_mov_b32 s60, s59
    v_fmac_f32 v27, v0, v0
    v_fmac_f32 v27, v1, v1
    v_mfma_f32_16x16x32_bf16 v[44:47], a[128:131], v[88:91], v[44:47]
    s_mov_b32 s59, s58
    v_fmac_f32 v27, v2, v2
    v_fmac_f32 v27, v3, v3
    v_mfma_f32_16x16x32_bf16 v[44:47], a[132:135], v[100:103], v[44:47]
    s_mov_b32 s58, s57
    v_mfma_f32_16x16x32_bf16 v[44:47], a[136:139], v[68:71], v[44:47]
    s_mov_b32 s57, s56
    v_mfma_f32_16x16x32_bf16 v[44:47], a[140:143], v[12:15], v[44:47]
    s_mov_b32 s7, s6
    s_nop 0
    v_mfma_f32_16x16x32_bf16 v[8:11], v[108:111], a[144:147], 0
    s_mov_b32 s6, s5
    s_nop 1
    v_mfma_f32_16x16x32_bf16 v[8:11], v[104:107], a[148:151], v[8:11]
    s_mov_b32 s5, s4
    v_fmac_f32 v27, v44, v44
    v_fmac_f32 v27, v45, v45
    v_mfma_f32_16x16x32_bf16 v[8:11], v[88:91], a[152:155], v[8:11]
    s_sub_u32 s14, s6, s7
    v_fmac_f32 v27, v46, v46
    v_fmac_f32 v27, v47, v47
    v_mfma_f32_16x16x32_bf16 v[8:11], v[100:103], a[156:159], v[8:11]
    s_add_u32 s61, s61, 1
    v_cvt_pk_bf16_f32 v170, v26, v27
    v_add_u32 v134, s14, v134
    v_mfma_f32_16x16x32_bf16 v[8:11], v[68:71], a[160:163], v[8:11]
    s_ff1_i32_b32 s15, s66
    ds_read_b128 v[96:99], v139 offset:3072
    v_add_u32 v133, s14, v133
    v_mfma_f32_16x16x32_bf16 v[8:11], v[12:15], a[164:167], v[8:11]
    s_cmp_lg_u32 s66, 0
    ds_read_b128 v[92:95], v138 offset:3072
    v_add_u32 v125, s14, v125
    v_mfma_f32_16x16x16_bf16 v[20:23], v[216:217], v[170:171], 0
    s_cselect_b32 s12, s15, s12
    ds_read_b128 v[40:43], v139 offset:3200
    s_nop 1
    v_cvt_pk_bf16_f32 v26, v8, v9
    v_mfma_f32_16x16x32_bf16 v[72:75], v[108:111], a[168:171], 0
    s_cmp_lt_u32 s61, s71
    ds_read_b128 v[60:63], v138 offset:3200
    v_cvt_pk_bf16_f32 v27, v10, v11
    v_mfma_f32_16x16x32_bf16 v[72:75], v[104:107], a[172:175], v[72:75]
    s_cselect_b32 s15, 31, s15
    ds_read_b128 v[56:59], v139 offset:3328
    v_add_u32 v139, s50, v139
    v_mfma_f32_16x16x32_bf16 v[72:75], v[88:91], a[176:179], v[72:75]
    s_bitset0_b32 s66, s15
    ds_read_b128 v[36:39], v138 offset:3328
    v_add_u32 v138, s50, v138
    v_mfma_f32_16x16x32_bf16 v[72:75], v[100:103], a[180:183], v[72:75]
    s_add_u32 s12, s12, 20
    v_rsq_f32 v20, v20
    v_mfma_f32_16x16x32_bf16 v[72:75], v[68:71], a[184:187], v[72:75]
    s_max_u32 s12, s12, s61
    v_rsq_f32 v21, v21
    v_mfma_f32_16x16x32_bf16 v[72:75], v[12:15], a[188:191], v[72:75]
    s_cmp_lt_u32 s61, s71
    v_mul_f32 v20, s55, v20
    v_mul_f32 v21, 0.5, v21
    v_mfma_f32_16x16x32_bf16 v[8:11], v[108:111], a[192:195], 0
    s_cselect_b32 s15, s61, s12
    v_mul_f32 v64, v64, v20
    v_mul_f32 v65, v65, v20
    v_mfma_f32_16x16x32_bf16 v[8:11], v[104:107], a[196:199], v[8:11]
    s_cselect_b32 s56, s69, s70
    v_cvt_pk_bf16_f32 v30, v72, v73
    v_cvt_pk_bf16_f32 v31, v74, v75
    v_mfma_f32_16x16x32_bf16 v[8:11], v[88:91], a[200:203], v[8:11]
    s_add_u32 s56, s56, s15
    v_cvt_pk_f16_f32 v88, v64, v65
    v_mul_f32 v66, v66, v20
    v_mfma_f32_16x16x32_bf16 v[8:11], v[100:103], a[204:207], v[8:11]
    s_mul_i32 s53, s56, 58255
    v_mul_f32 v67, v67, v20
    v_cvt_pk_f16_f32 v89, v66, v67
    v_mfma_f32_16x16x32_bf16 v[8:11], v[68:71], a[208:211], v[8:11]
    s_waitcnt lgkmcnt(0)
    s_lshr_b32 s53, s53, 22
    v_mul_f32 v52, v52, v20
    v_mul_f32 v53, v53, v20
    v_mfma_f32_16x16x32_bf16 v[8:11], v[12:15], a[212:215], v[8:11]
    s_barrier
    v_cvt_pk_f16_f32 v90, v52, v53
    v_mul_f32 v54, v54, v20
    v_mfma_f32_16x16x32_bf16 v[12:15], a[0:3], v[96:99], 0
    s_mul_i32 s53, s53, s63
    v_mul_f32 v55, v55, v20
    v_cvt_pk_f16_f32 v91, v54, v55
    v_mfma_f32_16x16x32_bf16 v[12:15], a[4:7], v[92:95], v[12:15]
    s_mul_i32 s56, s56, s62
    v_mul_f32 v4, v4, v20
    v_mul_f32 v5, v5, v20
    v_mfma_f32_16x16x32_bf16 v[12:15], a[8:11], v[40:43], v[12:15]
    s_add_u32 s56, s56, s53
    v_cvt_pk_f16_f32 v150, v4, v5
    v_mul_f32 v6, v6, v20
    v_mfma_f32_16x16x32_bf16 v[12:15], a[12:15], v[60:63], v[12:15]
    s_mul_i32 s4, s15, 336
    v_mul_f32 v7, v7, v20
    v_cvt_pk_f16_f32 v151, v6, v7
    v_mfma_f32_16x16x32_bf16 v[12:15], a[16:19], v[56:59], v[12:15]
    s_cmp_ge_u32 s15, 16
    v_mul_f32 v48, v48, v21
    v_mul_f32 v49, v49, v21
    v_mfma_f32_16x16x32_bf16 v[12:15], a[20:23], v[36:39], v[12:15]
    s_cselect_b32 s53, -26880, 0
    v_cvt_pk_f16_f32 v76, v48, v49
    v_mul_f32 v50, v50, v21
    v_mfma_f32_16x16x32_bf16 v[4:7], a[24:27], v[96:99], 0
    s_add_u32 s4, s4, s53
    v_mul_f32 v51, v51, v21
    v_cvt_pk_f16_f32 v77, v50, v51
    v_mfma_f32_16x16x32_bf16 v[4:7], a[28:31], v[92:95], v[4:7]
    s_cmp_lt_u32 s15, s73
    v_mul_f32 v0, v0, v21
    v_mul_f32 v1, v1, v21
    v_mfma_f32_16x16x32_bf16 v[4:7], a[32:35], v[40:43], v[4:7]
    s_cselect_b32 s26, 100270464, 0
    v_cvt_pk_f16_f32 v78, v0, v1
    v_mul_f32 v2, v2, v21
    v_mfma_f32_16x16x32_bf16 v[4:7], a[36:39], v[60:63], v[4:7]
    s_cselect_b32 s56, s56, 0
    v_mul_f32 v3, v3, v21
    v_cvt_pk_f16_f32 v79, v2, v3
    v_mfma_f32_16x16x32_bf16 v[4:7], a[40:43], v[56:59], v[4:7]
    s_cselect_b32 s4, s4, -1
    v_mul_f32 v44, v44, v21
    v_mul_f32 v45, v45, v21
    v_mfma_f32_16x16x32_bf16 v[4:7], a[44:47], v[36:39], v[4:7]
    s_cselect_b32 s15, s15, 0
    v_cvt_pk_f16_f32 v80, v44, v45
    v_mul_f32 v46, v46, v21
    v_mfma_f32_16x16x32_bf16 v[0:3], a[48:51], v[96:99], 0
    s_cselect_b32 s13, s13, -1
    v_mul_f32 v47, v47, v21
    v_cvt_pk_f16_f32 v81, v46, v47
    v_mfma_f32_16x16x32_bf16 v[0:3], a[52:55], v[92:95], v[0:3]
    s_bitset1_b32 s64, s15
    v_cvt_pk_bf16_f32 v34, v8, v9
    v_cvt_pk_bf16_f32 v35, v10, v11
    v_mfma_f32_16x16x32_bf16 v[0:3], a[56:59], v[40:43], v[0:3]
    s_add_u32 s65, s65, 1
    v_fma_f32 v143, v12, v12, s41
    v_fmac_f32 v143, v13, v13
    v_mfma_f32_16x16x32_bf16 v[0:3], a[60:63], v[60:63], v[0:3]
    s_cmp_ge_i32 s65, 2
    v_fmac_f32 v143, v14, v14
    v_fmac_f32 v143, v15, v15
    v_mfma_f32_16x16x32_bf16 v[0:3], a[64:67], v[56:59], v[0:3]
    s_cselect_b32 s30, 100270464, 0
    v_fmac_f32 v143, v4, v4
    v_fmac_f32 v143, v5, v5
    v_mfma_f32_16x16x32_bf16 v[0:3], a[68:71], v[36:39], v[0:3]
    s_add_u32 s67, s46, s54
    v_fmac_f32 v143, v6, v6
    v_fmac_f32 v143, v7, v7
    v_mfma_f32_16x16x32_bf16 v[52:55], a[72:75], v[96:99], 0
    s_add_u32 m0, s67, 0
    s_nop 0
    buffer_load_dwordx4 v130, s[24:27], s56 offen nt lds
    v_mfma_f32_16x16x32_bf16 v[52:55], a[76:79], v[92:95], v[52:55]
    s_add_u32 m0, s67, 1024
    v_fmac_f32 v143, v0, v0
    v_fmac_f32 v143, v1, v1
    v_mfma_f32_16x16x32_bf16 v[52:55], a[80:83], v[40:43], v[52:55]
    v_fmac_f32 v143, v2, v2
    v_fmac_f32 v143, v3, v3
    v_mfma_f32_16x16x32_bf16 v[52:55], a[84:87], v[60:63], v[52:55]
    buffer_load_dwordx4 v129, s[24:27], s56 offen nt lds
    v_mfma_f32_16x16x32_bf16 v[52:55], a[88:91], v[56:59], v[52:55]
    s_add_u32 m0, s67, 2048
    v_mfma_f32_16x16x32_bf16 v[52:55], a[92:95], v[36:39], v[52:55]
    buffer_load_dwordx4 v128, s[24:27], s56 offen nt lds
    s_nop 0
    v_mfma_f32_16x16x32_bf16 v[8:11], a[96:99], v[96:99], 0
    s_nop 2
    v_mfma_f32_16x16x32_bf16 v[8:11], a[100:103], v[92:95], v[8:11]
    s_nop 0
    v_fma_f32 v142, v52, v52, s41
    v_fmac_f32 v142, v53, v53
    v_mfma_f32_16x16x32_bf16 v[8:11], a[104:107], v[40:43], v[8:11]
    v_fmac_f32 v142, v54, v54
    v_fmac_f32 v142, v55, v55
    v_mfma_f32_16x16x32_bf16 v[8:11], a[108:111], v[60:63], v[8:11]
    v_mfma_f32_16x16x32_bf16 v[8:11], a[112:115], v[56:59], v[8:11]
    s_add_u32 m0, s67, 3072
    s_nop 0
    buffer_load_dwordx4 v127, s[24:27], s56 offen nt lds
    v_mfma_f32_16x16x32_bf16 v[8:11], a[116:119], v[36:39], v[8:11]
    s_add_u32 m0, s67, 4096
    s_nop 0
    v_mfma_f32_16x16x32_bf16 v[44:47], a[120:123], v[96:99], 0
    s_nop 1
    buffer_load_dwordx4 v126, s[24:27], s56 offen nt lds
    v_mfma_f32_16x16x32_bf16 v[44:47], a[124:127], v[92:95], v[44:47]
    s_nop 0
    v_fmac_f32 v142, v8, v8
    v_fmac_f32 v142, v9, v9
    v_mfma_f32_16x16x32_bf16 v[44:47], a[128:131], v[40:43], v[44:47]
    v_fmac_f32 v142, v10, v10
    v_fmac_f32 v142, v11, v11
    v_mfma_f32_16x16x32_bf16 v[44:47], a[132:135], v[60:63], v[44:47]
    v_mfma_f32_16x16x32_bf16 v[44:47], a[136:139], v[56:59], v[44:47]
    v_mfma_f32_16x16x32_bf16 v[44:47], a[140:143], v[36:39], v[44:47]
    s_nop 1
    v_mfma_f32_16x16x32_bf16 v[20:23], v[96:99], a[144:147], 0
    s_mov_b32 s53, s47
    s_nop 1
    v_mfma_f32_16x16x32_bf16 v[20:23], v[92:95], a[148:151], v[20:23]
    s_mov_b32 s47, s46
    v_fmac_f32 v142, v44, v44
    v_fmac_f32 v142, v45, v45
    v_mfma_f32_16x16x32_bf16 v[20:23], v[40:43], a[152:155], v[20:23]
    s_mov_b32 s46, s45
    v_fmac_f32 v142, v46, v46
    v_fmac_f32 v142, v47, v47
    v_mfma_f32_16x16x32_bf16 v[20:23], v[60:63], a[156:159], v[20:23]
    s_mov_b32 s45, s44
    v_cvt_pk_bf16_f32 v170, v143, v142
    v_mfma_f32_16x16x32_bf16 v[20:23], v[56:59], a[160:163], v[20:23]
    s_mov_b32 s44, s53
    ds_read_b128 v[64:67], v134 offset:32
    v_mfma_f32_16x16x32_bf16 v[20:23], v[36:39], a[164:167], v[20:23]
    s_sub_u32 s48, s44, s46
    ds_read_b64 v[68:69], v134 offset:48
    v_add_u32 v139, s48, v139
    v_mfma_f32_16x16x16_bf16 v[48:51], v[216:217], v[170:171], 0
    s_sub_u32 s49, s46, s45
    v_add_u32 v138, s48, v138
    s_nop 1
    v_cvt_pk_bf16_f32 v164, v20, v21
    v_mfma_f32_16x16x32_bf16 v[72:75], v[96:99], a[168:171], 0
    v_cvt_pk_bf16_f32 v165, v22, v23
    v_mfma_f32_16x16x32_bf16 v[72:75], v[92:95], a[172:175], v[72:75]
    v_rsq_f32 v48, v48
    v_mfma_f32_16x16x32_bf16 v[72:75], v[40:43], a[176:179], v[72:75]
    v_rsq_f32 v49, v49
    v_mfma_f32_16x16x32_bf16 v[72:75], v[60:63], a[180:183], v[72:75]
    v_mul_f32 v48, s55, v48
    v_mul_f32 v49, 0.5, v49
    v_mfma_f32_16x16x32_bf16 v[72:75], v[56:59], a[184:187], v[72:75]
    v_mul_f32 v52, v52, v49
    v_mul_f32 v53, v53, v49
    v_mfma_f32_16x16x32_bf16 v[72:75], v[36:39], a[188:191], v[72:75]
    ds_read_u16 v166, v133 offset:56
    v_cvt_pk_f16_f32 v70, v52, v53
    v_mfma_f32_16x16x32_bf16 v[20:23], v[96:99], a[192:195], 0
    ds_read_u16 v162, v133 offset:64
    v_mul_f32 v54, v54, v49
    v_mfma_f32_16x16x32_bf16 v[20:23], v[92:95], a[196:199], v[20:23]
    s_nop 0
    ds_read_u16 v158, v133 offset:72
    v_cvt_pk_bf16_f32 v160, v72, v73
    v_mfma_f32_16x16x32_bf16 v[20:23], v[40:43], a[200:203], v[20:23]
    ds_read_b128 v[40:43], v134 offset:0
    v_cvt_pk_bf16_f32 v161, v74, v75
    v_mfma_f32_16x16x32_bf16 v[20:23], v[60:63], a[204:207], v[20:23]
    ds_read_b64 v[142:143], v134 offset:16
    v_mul_f32 v55, v55, v49
    v_mfma_f32_16x16x32_bf16 v[20:23], v[56:59], a[208:211], v[20:23]
    v_cvt_pk_f16_f32 v71, v54, v55
    v_mul_f32 v8, v8, v49
    v_mfma_f32_16x16x32_bf16 v[20:23], v[36:39], a[212:215], v[20:23]
    v_mul_f32 v9, v9, v49
    v_cvt_pk_f16_f32 v72, v8, v9
    v_mfma_f32_16x16x32_f16 v[36:39], v[82:85], v[16:19], v[204:207]
    v_mul_f32 v10, v10, v49
    v_mul_f32 v11, v11, v49
    v_mfma_f32_16x16x32_f16 v[36:39], v[84:87], v[152:155], v[36:39]
    v_cvt_pk_f16_f32 v73, v10, v11
    v_mul_f32 v44, v44, v49
    v_mfma_f32_16x16x32_f16 v[60:63], v[76:79], v[16:19], v[200:203]
    v_mul_f32 v45, v45, v49
    v_cvt_pk_f16_f32 v74, v44, v45
    v_mfma_f32_16x16x32_f16 v[60:63], v[78:81], v[152:155], v[60:63]
    s_waitcnt lgkmcnt(3)
    v_mul_f32 v46, v46, v49
    v_mul_f32 v47, v47, v49
    v_mfma_f32_16x16x32_f16 v[8:11], v[64:67], v[16:19], v[208:211]
    v_cvt_pk_f16_f32 v75, v46, v47
    v_mul_f32 v12, v12, v48
    v_mfma_f32_16x16x32_f16 v[8:11], v[66:69], v[152:155], v[8:11]
    v_mul_f32 v13, v13, v48
    v_cvt_pk_f16_f32 v44, v12, v13
    v_mfma_f32_16x16x32_f16 v[56:59], v[70:73], v[16:19], v[196:199]
    v_mul_f32 v14, v14, v48
    v_mul_f32 v15, v15, v48
    v_mfma_f32_16x16x32_f16 v[56:59], v[72:75], v[152:155], v[56:59]
    s_waitcnt lgkmcnt(0)
    v_cvt_pk_f16_f32 v45, v14, v15
    v_mul_f32 v4, v4, v48
    v_mfma_f32_16x16x32_f16 v[16:19], v[40:43], v[82:85], v[208:211]
    v_mul_f32 v5, v5, v48
    v_cvt_pk_f16_f32 v46, v4, v5
    v_mfma_f32_16x16x32_f16 v[16:19], v[140:143], v[84:87], v[16:19]
    v_mul_f32 v6, v6, v48
    v_mul_f32 v7, v7, v48
    v_mfma_f32_16x16x32_f16 v[12:15], v[40:43], v[76:79], v[208:211]
    v_cvt_pk_f16_f32 v47, v6, v7
    v_mul_f32 v0, v0, v48
    v_mfma_f32_16x16x32_f16 v[12:15], v[140:143], v[78:81], v[12:15]
    v_mul_f32 v1, v1, v48
    v_cvt_pk_f16_f32 v146, v0, v1
    v_mfma_f32_16x16x32_f16 v[4:7], v[40:43], v[70:73], v[208:211]
    v_mul_f32 v2, v2, v48
    v_mul_f32 v3, v3, v48
    v_mfma_f32_16x16x32_f16 v[4:7], v[140:143], v[72:75], v[4:7]
    v_cvt_pk_f16_f32 v147, v2, v3
    v_cvt_pk_bf16_f32 v156, v20, v21
    v_mfma_f32_16x16x32_f16 v[0:3], v[40:43], v[64:67], v[208:211]
    v_cvt_pk_bf16_f32 v157, v22, v23
    v_max3_f32 v154, v36, v37, v38
    v_mfma_f32_16x16x32_f16 v[0:3], v[140:143], v[66:69], v[0:3]
    v_max3_f32 v154, v154, v39, v60
    v_max3_f32 v154, v154, v61, v62
    v_mfma_f32_16x16x32_f16 v[40:43], v[82:85], v[88:91], v[192:195]
    v_max3_f32 v154, v154, v63, v56
    v_max3_f32 v154, v154, v57, v58
    v_mfma_f32_16x16x32_f16 v[40:43], v[84:87], v[148:151], v[40:43]
    v_max3_f32 v154, v154, v59, v8
    v_mov_b32 v155, v154
    v_mfma_f32_16x16x32_f16 v[52:55], v[76:79], v[88:91], v[188:191]
    s_nop 0
    v_permlane32_swap_b32 v155, v154
    v_mfma_f32_16x16x32_f16 v[52:55], v[78:81], v[148:151], v[52:55]
    v_max_f32 v154, v155, v154
    v_mov_b32 v155, v154
    v_mfma_f32_16x16x32_f16 v[48:51], v[70:73], v[88:91], v[184:187]
    s_nop 0
    v_permlane16_swap_b32 v155, v154
    v_mfma_f32_16x16x32_f16 v[48:51], v[72:75], v[148:151], v[48:51]
    v_max_f32 v154, v155, v154
    v_sub_f32 v36, v36, v154
    v_mfma_f32_16x16x32_f16 v[20:23], v[64:67], v[88:91], v[208:211]
    v_sub_f32 v37, v37, v154
    v_sub_f32 v38, v38, v154
    v_mfma_f32_16x16x32_f16 v[20:23], v[66:69], v[148:151], v[20:23]
    v_sub_f32 v39, v39, v154
    v_sub_f32 v60, v60, v154
    v_sub_f32 v61, v61, v154
    v_sub_f32 v62, v62, v154
    v_sub_f32 v63, v63, v154
    v_sub_f32 v56, v56, v154
    v_sub_f32 v57, v57, v154
    v_sub_f32 v58, v58, v154
    v_sub_f32 v59, v59, v154
    v_sub_f32 v8, v8, v154
    v_exp_f32 v36, v36
    v_exp_f32 v37, v37
    v_exp_f32 v38, v38
    v_exp_f32 v39, v39
    v_cvt_pk_bf16_f32 v36, v36, v37
    v_cvt_pk_bf16_f32 v37, v38, v39
    v_exp_f32 v60, v60
    v_exp_f32 v61, v61
    v_exp_f32 v62, v62
    v_exp_f32 v63, v63
    v_cvt_pk_bf16_f32 v38, v60, v61
    v_cvt_pk_bf16_f32 v39, v62, v63
    v_exp_f32 v56, v56
    v_exp_f32 v57, v57
    v_exp_f32 v58, v58
    v_exp_f32 v59, v59
    v_cvt_pk_bf16_f32 v168, v56, v57
    v_cvt_pk_bf16_f32 v169, v58, v59
    v_exp_f32 v8, v8
    v_mov_b32_dpp v19, v15 quad_perm:[0,1,2,3] row_mask:0x2 bank_mask:0xf
    v_cvt_pk_bf16_f32 v170, v8, 0
    v_mfma_f32_16x16x32_bf16 v[8:11], v[220:223], v[36:39], 0
    v_mov_b32_dpp v19, v7 quad_perm:[0,1,2,3] row_mask:0x4 bank_mask:0xf
    v_max3_f32 v142, v40, v41, v42
    v_mfma_f32_16x16x32_bf16 v[8:11], v[220:223], v[168:171], v[8:11]
    v_mov_b32_dpp v19, v3 quad_perm:[0,1,2,3] row_mask:0x8 bank_mask:0xf
    v_mov_b32 v150, v19
    v_mfma_f32_16x16x32_bf16 v[4:7], v[24:27], v[36:39], 0
    s_nop 0
    v_max_f32_dpp v150, v150, v150 row_ror:8 row_mask:0xf bank_mask:0xf
    v_max3_f32 v142, v142, v43, v52
    v_mfma_f32_16x16x32_bf16 v[4:7], v[164:167], v[168:171], v[4:7]
    v_max_f32_dpp v150, v150, v150 row_ror:4 row_mask:0xf bank_mask:0xf
    v_max3_f32 v142, v142, v53, v54
    v_mfma_f32_16x16x32_bf16 v[12:15], v[28:31], v[36:39], 0
    v_max_f32_dpp v150, v150, v150 row_ror:2 row_mask:0xf bank_mask:0xf
    v_max3_f32 v142, v142, v55, v48
    v_mfma_f32_16x16x32_bf16 v[12:15], v[160:163], v[168:171], v[12:15]
    v_max_f32_dpp v150, v150, v150 row_ror:1 row_mask:0xf bank_mask:0xf
    v_mov_b32 v143, v150
    v_mfma_f32_16x16x32_bf16 v[0:3], v[32:35], v[36:39], 0
    s_nop 0
    v_permlane32_swap_b32 v143, v150
    v_mfma_f32_16x16x32_bf16 v[0:3], v[156:159], v[168:171], v[0:3]
    v_max_f32 v150, v143, v150
    v_mov_b32 v143, v150
    v_rcp_f32 v8, v8
    v_max3_f32 v142, v142, v49, v50
    v_permlane16_swap_b32 v143, v150
    v_max_f32 v150, v143, v150
    v_sub_f32 v19, v19, v150
    v_exp_f32 v19, v19
    v_mul_f32 v4, v4, v8
    v_cvt_pk_bf16_f32 v19, v19, v19
    ds_write_b16 v125, v19
    v_mul_f32 v5, v5, v8
    v_cvt_pk_bf16_f32 v4, v4, v5
    ds_read_b128 v[60:63], v134
    v_mul_f32 v6, v6, v8
    v_mul_f32 v7, v7, v8
    v_cvt_pk_bf16_f32 v5, v6, v7
    ds_read_b128 v[56:59], v134 offset:16
    v_mfma_f32_16x16x32_f16 v[16:19], v[82:85], v[44:47], v[180:183]
    v_mul_f32 v12, v12, v8
    v_mul_f32 v13, v13, v8
    v_mfma_f32_16x16x32_f16 v[16:19], v[84:87], v[144:147], v[16:19]
    ds_write_b64 v137, v[4:5] offset:0
    v_mfma_f32_16x16x32_f16 v[36:39], v[76:79], v[44:47], v[176:179]
    v_cvt_pk_bf16_f32 v6, v12, v13
    v_mul_f32 v14, v14, v8
    v_mfma_f32_16x16x32_f16 v[36:39], v[78:81], v[144:147], v[36:39]
    v_mul_f32 v15, v15, v8
    v_cvt_pk_bf16_f32 v7, v14, v15
    v_mfma_f32_16x16x32_f16 v[12:15], v[70:73], v[44:47], v[172:175]
    ds_write_b64 v137, v[6:7] offset:8
    v_mfma_f32_16x16x32_f16 v[12:15], v[72:75], v[144:147], v[12:15]
    v_mul_f32 v0, v0, v8
    v_mul_f32 v1, v1, v8
    v_mfma_f32_16x16x32_f16 v[4:7], v[64:67], v[44:47], v[208:211]
    v_cvt_pk_bf16_f32 v150, v0, v1
    v_mul_f32 v2, v2, v8
    v_mfma_f32_16x16x32_f16 v[4:7], v[66:69], v[144:147], v[4:7]
    s_waitcnt lgkmcnt(2)
    v_mul_f32 v3, v3, v8
    v_cvt_pk_bf16_f32 v151, v2, v3
    v_mfma_f32_16x16x32_bf16 v[0:3], v[60:63], v[24:27], 0
    ds_write_b64 v136, v[150:151] offset:0
    v_mfma_f32_16x16x32_bf16 v[0:3], v[56:59], v[164:167], v[0:3]
    v_max3_f32 v142, v142, v51, v21
    v_mov_b32 v143, v142
    v_mfma_f32_16x16x32_bf16 v[44:47], v[60:63], v[28:31], 0
    s_nop 0
    v_permlane32_swap_b32 v143, v142
    v_mfma_f32_16x16x32_bf16 v[44:47], v[56:59], v[160:163], v[44:47]
    v_max_f32 v142, v143, v142
    v_mov_b32 v143, v142
    v_mfma_f32_16x16x32_bf16 v[8:11], v[60:63], v[32:35], 0
    s_nop 0
    v_permlane16_swap_b32 v143, v142
    v_mfma_f32_16x16x32_bf16 v[8:11], v[56:59], v[156:159], v[8:11]
    v_max_f32 v142, v143, v142
    v_sub_f32 v40, v40, v142
    v_sub_f32 v41, v41, v142
    v_sub_f32 v42, v42, v142
    v_sub_f32 v43, v43, v142
    v_sub_f32 v52, v52, v142
    v_sub_f32 v53, v53, v142
    v_sub_f32 v54, v54, v142
    v_sub_f32 v55, v55, v142
    v_sub_f32 v48, v48, v142
    v_sub_f32 v49, v49, v142
    v_sub_f32 v50, v50, v142
    v_sub_f32 v51, v51, v142
    v_sub_f32 v21, v21, v142
    v_exp_f32 v40, v40
    v_exp_f32 v41, v41
    v_exp_f32 v42, v42
    v_exp_f32 v43, v43
    v_cvt_pk_bf16_f32 v40, v40, v41
    v_cvt_pk_bf16_f32 v41, v42, v43
    v_exp_f32 v52, v52
    v_exp_f32 v53, v53
    v_exp_f32 v54, v54
    v_exp_f32 v55, v55
    v_cvt_pk_bf16_f32 v42, v52, v53
    v_cvt_pk_bf16_f32 v43, v54, v55
    v_exp_f32 v48, v48
    v_exp_f32 v49, v49
    v_exp_f32 v50, v50
    v_exp_f32 v51, v51
    v_cvt_pk_bf16_f32 v168, v48, v49
    v_cvt_pk_bf16_f32 v169, v50, v51
    v_exp_f32 v21, v21
    v_mov_b32_dpp v3, v47 quad_perm:[0,1,2,3] row_mask:0x2 bank_mask:0xf
    v_cvt_pk_bf16_f32 v170, v21, 0
    v_mfma_f32_16x16x32_bf16 v[44:47], v[220:223], v[40:43], 0
    v_mov_b32_dpp v3, v11 quad_perm:[0,1,2,3] row_mask:0x4 bank_mask:0xf
    v_cvt_pk_bf16_f32 v3, v3, v3
    v_mfma_f32_16x16x32_bf16 v[44:47], v[220:223], v[168:171], v[44:47]
    ds_write_b16 v133, v3 offset:56
    v_mfma_f32_16x16x32_bf16 v[20:23], v[24:27], v[40:43], 0
    ds_read_b128 v[8:11], v139 offset:0
    v_max3_f32 v142, v16, v17, v18
    v_mfma_f32_16x16x32_bf16 v[20:23], v[164:167], v[168:171], v[20:23]
    ds_read_b128 v[60:63], v138 offset:0
    v_max3_f32 v142, v142, v19, v36
    v_mfma_f32_16x16x32_bf16 v[52:55], v[28:31], v[40:43], 0
    ds_read_b128 v[0:3], v139 offset:128
    v_max3_f32 v142, v142, v37, v38
    v_mfma_f32_16x16x32_bf16 v[52:55], v[160:163], v[168:171], v[52:55]
    ds_read_b128 v[72:75], v138 offset:128
    v_max3_f32 v142, v142, v39, v12
    v_mfma_f32_16x16x32_bf16 v[48:51], v[32:35], v[40:43], 0
    ds_read_b128 v[76:79], v139 offset:256
    v_max3_f32 v142, v142, v13, v14
    v_mfma_f32_16x16x32_bf16 v[48:51], v[156:159], v[168:171], v[48:51]
    ds_read_b128 v[64:67], v138 offset:256
    v_max3_f32 v142, v142, v15, v6
    v_rcp_f32 v44, v44
    v_mov_b32 v143, v142
    v_mul_f32 v20, v20, v44
    v_mul_f32 v21, v21, v44
    v_cvt_pk_bf16_f32 v40, v20, v21
    v_mul_f32 v22, v22, v44
    v_mul_f32 v23, v23, v44
    v_cvt_pk_bf16_f32 v41, v22, v23
    v_mul_f32 v52, v52, v44
    v_mul_f32 v53, v53, v44
    v_cvt_pk_bf16_f32 v42, v52, v53
    v_mul_f32 v54, v54, v44
    s_waitcnt lgkmcnt(5)
    v_mfma_f32_16x16x32_bf16 v[20:23], a[0:3], v[8:11], 0
    ds_write_b64 v137, v[40:41] offset:1536
    v_mul_f32 v55, v55, v44
    v_cvt_pk_bf16_f32 v43, v54, v55
    v_mul_f32 v48, v48, v44
    v_mul_f32 v49, v49, v44
    v_cvt_pk_bf16_f32 v146, v48, v49
    v_mul_f32 v50, v50, v44
    v_mul_f32 v51, v51, v44
    v_cvt_pk_bf16_f32 v147, v50, v51
    ds_write_b64 v137, v[42:43] offset:1544
    v_permlane32_swap_b32 v143, v142
    v_max_f32 v142, v143, v142
    v_mov_b32 v143, v142
    s_nop 0
    ds_write_b64 v136, v[146:147] offset:1536
    v_permlane16_swap_b32 v143, v142
    v_max_f32 v142, v143, v142
    v_sub_f32 v16, v16, v142
    v_sub_f32 v17, v17, v142
    v_sub_f32 v18, v18, v142
    v_sub_f32 v19, v19, v142
    v_sub_f32 v36, v36, v142
    v_sub_f32 v37, v37, v142
    v_sub_f32 v38, v38, v142
    v_sub_f32 v39, v39, v142
    v_sub_f32 v12, v12, v142
    v_sub_f32 v13, v13, v142
    v_sub_f32 v14, v14, v142
    v_sub_f32 v15, v15, v142
    v_sub_f32 v6, v6, v142
    v_exp_f32 v16, v16
    v_exp_f32 v17, v17
    v_exp_f32 v18, v18
    v_exp_f32 v19, v19
    v_cvt_pk_bf16_f32 v16, v16, v17
    v_cvt_pk_bf16_f32 v17, v18, v19
    v_exp_f32 v36, v36
    v_exp_f32 v37, v37
    v_exp_f32 v38, v38
    v_exp_f32 v39, v39
    v_cvt_pk_bf16_f32 v18, v36, v37
    v_cvt_pk_bf16_f32 v19, v38, v39
    v_exp_f32 v12, v12
    v_exp_f32 v13, v13
    v_exp_f32 v14, v14
    v_exp_f32 v15, v15
    v_cvt_pk_bf16_f32 v168, v12, v13
    v_cvt_pk_bf16_f32 v169, v14, v15
    v_exp_f32 v6, v6
    s_nop 0
    v_cvt_pk_bf16_f32 v170, v6, 0
    v_mfma_f32_16x16x32_bf16 v[4:7], v[220:223], v[16:19], 0
    s_nop 0
    v_mfma_f32_16x16x32_bf16 v[4:7], v[220:223], v[168:171], v[4:7]
    s_nop 1
    v_mfma_f32_16x16x32_bf16 v[12:15], v[24:27], v[16:19], 0
    s_nop 2
    v_mfma_f32_16x16x32_bf16 v[12:15], v[164:167], v[168:171], v[12:15]
    s_nop 0
    v_rcp_f32 v4, v4
    v_mfma_f32_16x16x32_bf16 v[24:27], v[28:31], v[16:19], 0
    s_nop 2
    v_mfma_f32_16x16x32_bf16 v[24:27], v[160:163], v[168:171], v[24:27]
    s_nop 0
    v_mul_f32 v12, v12, v4
    v_mul_f32 v13, v13, v4
    v_mfma_f32_16x16x32_bf16 v[28:31], v[32:35], v[16:19], 0
    v_cvt_pk_bf16_f32 v44, v12, v13
    v_mul_f32 v14, v14, v4
    v_mfma_f32_16x16x32_bf16 v[28:31], v[156:159], v[168:171], v[28:31]
    v_mul_f32 v15, v15, v4
    v_cvt_pk_bf16_f32 v45, v14, v15
    s_waitcnt lgkmcnt(0)
.p2align 6
L_loopS0:
    v_mfma_f32_16x16x32_bf16 v[20:23], a[4:7], v[60:63], v[20:23]
    ds_write_b64 v137, v[44:45] offset:3072
    v_mfma_f32_16x16x32_bf16 v[20:23], a[8:11], v[0:3], v[20:23]
    v_mul_f32 v24, v24, v4
    v_mul_f32 v25, v25, v4
    v_mfma_f32_16x16x32_bf16 v[20:23], a[12:15], v[72:75], v[20:23]
    v_cvt_pk_bf16_f32 v46, v24, v25
    v_mul_f32 v26, v26, v4
    v_mfma_f32_16x16x32_bf16 v[20:23], a[16:19], v[76:79], v[20:23]
    v_mul_f32 v27, v27, v4
    v_cvt_pk_bf16_f32 v47, v26, v27
    v_mfma_f32_16x16x32_bf16 v[20:23], a[20:23], v[64:67], v[20:23]
    ds_write_b64 v137, v[46:47] offset:3080
    v_mfma_f32_16x16x32_bf16 v[44:47], a[24:27], v[8:11], 0
    v_mul_f32 v28, v28, v4
    v_mul_f32 v29, v29, v4
    v_mfma_f32_16x16x32_bf16 v[44:47], a[28:31], v[60:63], v[44:47]
    v_cvt_pk_bf16_f32 v28, v28, v29
    v_mul_f32 v30, v30, v4
    v_mfma_f32_16x16x32_bf16 v[44:47], a[32:35], v[0:3], v[44:47]
    v_mul_f32 v31, v31, v4
    v_cvt_pk_bf16_f32 v29, v30, v31
    v_mfma_f32_16x16x32_bf16 v[44:47], a[36:39], v[72:75], v[44:47]
    ds_write_b64 v136, v[28:29] offset:3072
    v_mfma_f32_16x16x32_bf16 v[44:47], a[40:43], v[76:79], v[44:47]
    v_fmac_f32 v155, v52, v52
    v_fmac_f32 v155, v53, v53
    v_mfma_f32_16x16x32_bf16 v[44:47], a[44:47], v[64:67], v[44:47]
    v_fmac_f32 v155, v54, v54
    v_fmac_f32 v155, v55, v55
    v_mfma_f32_16x16x32_bf16 v[4:7], a[48:51], v[8:11], 0
    v_fma_f32 v170, v12, v12, s42
    v_fmac_f32 v170, v13, v13
    v_mfma_f32_16x16x32_bf16 v[4:7], a[52:55], v[60:63], v[4:7]
    v_fmac_f32 v170, v14, v14
    v_fmac_f32 v170, v15, v15
    v_mfma_f32_16x16x32_bf16 v[4:7], a[56:59], v[0:3], v[4:7]
    v_fmac_f32 v170, v16, v16
    v_fmac_f32 v170, v17, v17
    v_mfma_f32_16x16x32_bf16 v[4:7], a[60:63], v[72:75], v[4:7]
    v_fmac_f32 v170, v18, v18
    v_fmac_f32 v170, v19, v19
    v_mfma_f32_16x16x32_bf16 v[4:7], a[64:67], v[76:79], v[4:7]
    s_waitcnt vmcnt(10)
    v_fmac_f32 v170, v56, v56
    v_fmac_f32 v170, v57, v57
    v_mfma_f32_16x16x32_bf16 v[4:7], a[68:71], v[64:67], v[4:7]
    v_fmac_f32 v170, v58, v58
    v_fmac_f32 v170, v59, v59
    v_mfma_f32_16x16x32_bf16 v[88:91], a[72:75], v[8:11], 0
    v_cvt_pk_bf16_f32 v154, v154, v155
    v_cvt_pk_bf16_f32 v155, v170, v124
    v_mfma_f32_16x16x32_bf16 v[88:91], a[76:79], v[60:63], v[88:91]
    ds_write_b64 v132, v[154:155]
    v_mfma_f32_16x16x32_bf16 v[88:91], a[80:83], v[0:3], v[88:91]
    v_add_u32 v137, s49, v137
    v_add_u32 v136, s49, v136
    v_mfma_f32_16x16x32_bf16 v[88:91], a[84:87], v[72:75], v[88:91]
    v_fma_f32 v154, v20, v20, s41
    v_fmac_f32 v154, v21, v21
    v_mfma_f32_16x16x32_bf16 v[88:91], a[88:91], v[76:79], v[88:91]
    v_fmac_f32 v154, v22, v22
    v_fmac_f32 v154, v23, v23
    v_mfma_f32_16x16x32_bf16 v[88:91], a[92:95], v[64:67], v[88:91]
    v_fmac_f32 v154, v44, v44
    v_fmac_f32 v154, v45, v45
    v_mfma_f32_16x16x32_bf16 v[104:107], a[96:99], v[8:11], 0
    v_fmac_f32 v154, v46, v46
    v_fmac_f32 v154, v47, v47
    v_mfma_f32_16x16x32_bf16 v[104:107], a[100:103], v[60:63], v[104:107]
    v_fmac_f32 v154, v4, v4
    v_fmac_f32 v154, v5, v5
    v_mfma_f32_16x16x32_bf16 v[104:107], a[104:107], v[0:3], v[104:107]
    v_fmac_f32 v154, v6, v6
    v_fmac_f32 v154, v7, v7
    v_mfma_f32_16x16x32_bf16 v[104:107], a[108:111], v[72:75], v[104:107]
    s_waitcnt lgkmcnt(0)
    v_fma_f32 v155, v88, v88, s41
    v_fmac_f32 v155, v89, v89
    v_mfma_f32_16x16x32_bf16 v[104:107], a[112:115], v[76:79], v[104:107]
    s_barrier
    ds_read_b128 v[68:71], v131 offset:0
    v_fmac_f32 v155, v90, v90
    v_mfma_f32_16x16x32_bf16 v[104:107], a[116:119], v[64:67], v[104:107]
    ds_read_b128 v[120:123], v131 offset:1024
    v_fmac_f32 v155, v91, v91
    v_mfma_f32_16x16x32_bf16 v[84:87], a[120:123], v[8:11], 0
    s_nop 2
    v_mfma_f32_16x16x32_bf16 v[84:87], a[124:127], v[60:63], v[84:87]
    s_nop 0
    v_fmac_f32 v155, v104, v104
    v_fmac_f32 v155, v105, v105
    v_mfma_f32_16x16x32_bf16 v[84:87], a[128:131], v[0:3], v[84:87]
    v_fmac_f32 v155, v106, v106
    v_fmac_f32 v155, v107, v107
    v_mfma_f32_16x16x32_bf16 v[84:87], a[132:135], v[72:75], v[84:87]
    v_mfma_f32_16x16x32_bf16 v[84:87], a[136:139], v[76:79], v[84:87]
    v_mfma_f32_16x16x32_bf16 v[84:87], a[140:143], v[64:67], v[84:87]
    v_mfma_f32_16x16x32_bf16 v[112:115], v[8:11], a[144:147], 0
    s_nop 2
    v_mfma_f32_16x16x32_bf16 v[112:115], v[60:63], a[148:151], v[112:115]
    s_waitcnt lgkmcnt(1)
    s_nop 0
    v_readfirstlane_b32 s12, v69
    v_fmac_f32 v155, v84, v84
    v_mfma_f32_16x16x32_bf16 v[112:115], v[0:3], a[152:155], v[112:115]
    s_lshr_b32 s12, s12, 23
    v_fmac_f32 v155, v85, v85
    v_fmac_f32 v155, v86, v86
    v_mfma_f32_16x16x32_bf16 v[112:115], v[72:75], a[156:159], v[112:115]
    v_fmac_f32 v155, v87, v87
    v_cvt_pk_bf16_f32 v170, v154, v155
    v_mfma_f32_16x16x32_bf16 v[112:115], v[76:79], a[160:163], v[112:115]
    v_mfma_f32_16x16x32_bf16 v[112:115], v[64:67], a[164:167], v[112:115]
    v_mfma_f32_16x16x32_bf16 v[80:83], v[216:219], v[68:71], 0
    s_waitcnt lgkmcnt(0)
    s_nop 0
    ds_read_b128 v[68:71], v139 offset:1536
    s_nop 0
    v_mfma_f32_16x16x32_bf16 v[80:83], v[216:219], v[120:123], v[80:83]
    s_nop 0
    ds_read_b128 v[120:123], v138 offset:1536
    v_cvt_pk_bf16_f32 v24, v112, v113
    v_mfma_f32_16x16x16_bf16 v[26:29], v[216:217], v[170:171], 0
    s_nop 0
    ds_read_b128 v[100:103], v139 offset:1664
    v_cvt_pk_bf16_f32 v25, v114, v115
    s_nop 0
    v_rsq_f32 v80, v80
    v_mfma_f32_16x16x32_bf16 v[154:157], v[8:11], a[168:171], 0
    ds_read_b128 v[112:115], v138 offset:1664
    v_mul_f32 v80, s43, v80
    v_mfma_f32_16x16x32_bf16 v[154:157], v[60:63], a[172:175], v[154:157]
    ds_read_b128 v[96:99], v139 offset:1792
    v_mul_f32 v40, v40, v80
    v_mfma_f32_16x16x32_bf16 v[154:157], v[0:3], a[176:179], v[154:157]
    ds_read_b128 v[92:95], v138 offset:1792
    v_mul_f32 v41, v41, v80
    v_mfma_f32_16x16x32_bf16 v[154:157], v[72:75], a[180:183], v[154:157]
    v_rsq_f32 v81, v81
    v_mfma_f32_16x16x32_bf16 v[154:157], v[76:79], a[184:187], v[154:157]
    v_rsq_f32 v82, v82
    v_mfma_f32_16x16x32_bf16 v[154:157], v[64:67], a[188:191], v[154:157]
    v_mul_f32 v81, s43, v81
    v_mul_f32 v82, s43, v82
    v_mfma_f32_16x16x32_bf16 v[116:119], v[8:11], a[192:195], 0
    v_rsq_f32 v26, v26
    v_mfma_f32_16x16x32_bf16 v[116:119], v[60:63], a[196:199], v[116:119]
    v_rsq_f32 v27, v27
    v_mfma_f32_16x16x32_bf16 v[116:119], v[0:3], a[200:203], v[116:119]
    v_mul_f32 v26, s55, v26
    v_mul_f32 v27, 0.5, v27
    v_mfma_f32_16x16x32_bf16 v[116:119], v[72:75], a[204:207], v[116:119]
    v_cvt_pk_bf16_f32 v28, v154, v155
    v_cvt_pk_bf16_f32 v29, v156, v157
    v_mfma_f32_16x16x32_bf16 v[116:119], v[76:79], a[208:211], v[116:119]
    v_mul_f32 v20, v20, v26
    v_mul_f32 v21, v21, v26
    v_mfma_f32_16x16x32_bf16 v[116:119], v[64:67], a[212:215], v[116:119]
    s_waitcnt lgkmcnt(0)
    v_cvt_pk_f16_f32 v64, v20, v21
    v_mul_f32 v22, v22, v26
    v_mfma_f32_16x16x32_bf16 v[8:11], a[0:3], v[68:71], 0
    v_mul_f32 v23, v23, v26
    v_cvt_pk_f16_f32 v65, v22, v23
    v_mfma_f32_16x16x32_bf16 v[8:11], a[4:7], v[120:123], v[8:11]
    v_mul_f32 v44, v44, v26
    v_mul_f32 v45, v45, v26
    v_mfma_f32_16x16x32_bf16 v[8:11], a[8:11], v[100:103], v[8:11]
    v_cvt_pk_f16_f32 v66, v44, v45
    v_mul_f32 v46, v46, v26
    v_mfma_f32_16x16x32_bf16 v[8:11], a[12:15], v[112:115], v[8:11]
    v_mul_f32 v47, v47, v26
    v_cvt_pk_f16_f32 v67, v46, v47
    v_mfma_f32_16x16x32_bf16 v[8:11], a[16:19], v[96:99], v[8:11]
    v_mul_f32 v4, v4, v26
    v_mul_f32 v5, v5, v26
    v_mfma_f32_16x16x32_bf16 v[8:11], a[20:23], v[92:95], v[8:11]
    v_cvt_pk_f16_f32 v154, v4, v5
    v_mul_f32 v6, v6, v26
    v_mfma_f32_16x16x32_bf16 v[20:23], a[24:27], v[68:71], 0
    v_mul_f32 v7, v7, v26
    v_cvt_pk_f16_f32 v155, v6, v7
    v_mfma_f32_16x16x32_bf16 v[20:23], a[28:31], v[120:123], v[20:23]
    v_mul_f32 v88, v88, v27
    v_mul_f32 v89, v89, v27
    v_mfma_f32_16x16x32_bf16 v[20:23], a[32:35], v[100:103], v[20:23]
    v_cvt_pk_f16_f32 v0, v88, v89
    v_mul_f32 v90, v90, v27
    v_mfma_f32_16x16x32_bf16 v[20:23], a[36:39], v[112:115], v[20:23]
    v_mul_f32 v91, v91, v27
    v_cvt_pk_f16_f32 v1, v90, v91
    v_mfma_f32_16x16x32_bf16 v[20:23], a[40:43], v[96:99], v[20:23]
    v_mul_f32 v104, v104, v27
    v_mul_f32 v105, v105, v27
    v_mfma_f32_16x16x32_bf16 v[20:23], a[44:47], v[92:95], v[20:23]
    v_cvt_pk_f16_f32 v2, v104, v105
    v_mul_f32 v106, v106, v27
    v_mfma_f32_16x16x32_bf16 v[76:79], a[48:51], v[68:71], 0
    v_mul_f32 v107, v107, v27
    v_cvt_pk_f16_f32 v3, v106, v107
    v_mfma_f32_16x16x32_bf16 v[76:79], a[52:55], v[120:123], v[76:79]
    v_mul_f32 v84, v84, v27
    v_mul_f32 v85, v85, v27
    v_mfma_f32_16x16x32_bf16 v[76:79], a[56:59], v[100:103], v[76:79]
    v_cvt_pk_f16_f32 v4, v84, v85
    v_mul_f32 v86, v86, v27
    v_mfma_f32_16x16x32_bf16 v[76:79], a[60:63], v[112:115], v[76:79]
    v_mul_f32 v87, v87, v27
    v_cvt_pk_f16_f32 v5, v86, v87
    v_mfma_f32_16x16x32_bf16 v[76:79], a[64:67], v[96:99], v[76:79]
    v_cvt_pk_bf16_f32 v44, v116, v117
    v_cvt_pk_bf16_f32 v45, v118, v119
    v_mfma_f32_16x16x32_bf16 v[76:79], a[68:71], v[92:95], v[76:79]
    v_cvt_pk_bf16_f32 v40, v40, v41
    v_mul_f32 v42, v42, v80
    v_mfma_f32_16x16x32_bf16 v[60:63], a[72:75], v[68:71], 0
    v_mul_f32 v43, v43, v80
    v_cvt_pk_bf16_f32 v41, v42, v43
    v_mfma_f32_16x16x32_bf16 v[60:63], a[76:79], v[120:123], v[60:63]
    ds_write_b64 v137, v[40:41] offset:0
    v_mfma_f32_16x16x32_bf16 v[60:63], a[80:83], v[100:103], v[60:63]
    v_mul_f32 v36, v36, v80
    v_mul_f32 v37, v37, v80
    v_mfma_f32_16x16x32_bf16 v[60:63], a[84:87], v[112:115], v[60:63]
    v_cvt_pk_bf16_f32 v42, v36, v37
    v_mul_f32 v38, v38, v80
    v_mfma_f32_16x16x32_bf16 v[60:63], a[88:91], v[96:99], v[60:63]
    v_mul_f32 v39, v39, v80
    v_cvt_pk_bf16_f32 v43, v38, v39
    v_mfma_f32_16x16x32_bf16 v[60:63], a[92:95], v[92:95], v[60:63]
    ds_write_b64 v137, v[42:43] offset:8
    v_mfma_f32_16x16x32_bf16 v[40:43], a[96:99], v[68:71], 0
    v_mul_f32 v32, v32, v80
    v_mul_f32 v33, v33, v80
    v_mfma_f32_16x16x32_bf16 v[40:43], a[100:103], v[120:123], v[40:43]
    v_cvt_pk_bf16_f32 v26, v32, v33
    v_mul_f32 v34, v34, v80
    v_mfma_f32_16x16x32_bf16 v[40:43], a[104:107], v[100:103], v[40:43]
    v_mul_f32 v35, v35, v80
    v_cvt_pk_bf16_f32 v27, v34, v35
    v_mfma_f32_16x16x32_bf16 v[40:43], a[108:111], v[112:115], v[40:43]
    ds_write_b64 v136, v[26:27] offset:0
    v_mfma_f32_16x16x32_bf16 v[40:43], a[112:115], v[96:99], v[40:43]
    v_fma_f32 v26, v8, v8, s41
    v_fmac_f32 v26, v9, v9
    v_mfma_f32_16x16x32_bf16 v[40:43], a[116:119], v[92:95], v[40:43]
    v_fmac_f32 v26, v10, v10
    v_fmac_f32 v26, v11, v11
    v_mfma_f32_16x16x32_bf16 v[36:39], a[120:123], v[68:71], 0
    v_fmac_f32 v26, v20, v20
    v_fmac_f32 v26, v21, v21
    v_mfma_f32_16x16x32_bf16 v[36:39], a[124:127], v[120:123], v[36:39]
    v_fmac_f32 v26, v22, v22
    v_fmac_f32 v26, v23, v23
    v_mfma_f32_16x16x32_bf16 v[36:39], a[128:131], v[100:103], v[36:39]
    v_fmac_f32 v26, v76, v76
    v_fmac_f32 v26, v77, v77
    v_mfma_f32_16x16x32_bf16 v[36:39], a[132:135], v[112:115], v[36:39]
    v_fmac_f32 v26, v78, v78
    v_fmac_f32 v26, v79, v79
    v_mfma_f32_16x16x32_bf16 v[36:39], a[136:139], v[96:99], v[36:39]
    v_mul_f32 v48, v48, v81
    v_mul_f32 v49, v49, v81
    v_mfma_f32_16x16x32_bf16 v[36:39], a[140:143], v[92:95], v[36:39]
    v_cvt_pk_bf16_f32 v30, v48, v49
    v_mul_f32 v50, v50, v81
    v_mfma_f32_16x16x32_bf16 v[46:49], v[68:71], a[144:147], 0
    v_mul_f32 v51, v51, v81
    v_cvt_pk_bf16_f32 v31, v50, v51
    v_mfma_f32_16x16x32_bf16 v[46:49], v[120:123], a[148:151], v[46:49]
    ds_write_b64 v137, v[30:31] offset:1536
    v_mfma_f32_16x16x32_bf16 v[46:49], v[100:103], a[152:155], v[46:49]
    v_mul_f32 v108, v108, v81
    v_mul_f32 v109, v109, v81
    v_mfma_f32_16x16x32_bf16 v[46:49], v[112:115], a[156:159], v[46:49]
    v_cvt_pk_bf16_f32 v32, v108, v109
    v_mul_f32 v110, v110, v81
    v_mfma_f32_16x16x32_bf16 v[46:49], v[96:99], a[160:163], v[46:49]
    ds_read_b128 v[72:75], v139 offset:3072
    v_mul_f32 v111, v111, v81
    v_mfma_f32_16x16x32_bf16 v[46:49], v[92:95], a[164:167], v[46:49]
    ds_read_b128 v[88:91], v138 offset:3072
    v_cvt_pk_bf16_f32 v33, v110, v111
    v_mfma_f32_16x16x32_bf16 v[106:109], v[68:71], a[168:171], 0
    ds_write_b64 v137, v[32:33] offset:1544
    v_mfma_f32_16x16x32_bf16 v[106:109], v[120:123], a[172:175], v[106:109]
    v_mul_f32 v52, v52, v81
    v_mul_f32 v53, v53, v81
    v_mfma_f32_16x16x32_bf16 v[106:109], v[100:103], a[176:179], v[106:109]
    ds_read_b128 v[32:35], v139 offset:3200
    v_cvt_pk_bf16_f32 v30, v52, v53
    v_mfma_f32_16x16x32_bf16 v[106:109], v[112:115], a[180:183], v[106:109]
    ds_read_b128 v[84:87], v138 offset:3200
    v_mul_f32 v54, v54, v81
    v_mfma_f32_16x16x32_bf16 v[106:109], v[96:99], a[184:187], v[106:109]
    ds_read_b128 v[116:119], v139 offset:3328
    v_mul_f32 v55, v55, v81
    v_mfma_f32_16x16x32_bf16 v[106:109], v[92:95], a[188:191], v[106:109]
    ds_read_b128 v[212:215], v138 offset:3328
    v_cvt_pk_bf16_f32 v31, v54, v55
    v_fma_f32 v27, v60, v60, s41
    v_fmac_f32 v27, v61, v61
    ds_write_b64 v136, v[30:31] offset:1536
    v_fmac_f32 v27, v62, v62
    v_fmac_f32 v27, v63, v63
    v_mfma_f32_16x16x32_bf16 v[52:55], v[68:71], a[192:195], 0
    v_fmac_f32 v27, v40, v40
    v_fmac_f32 v27, v41, v41
    v_mfma_f32_16x16x32_bf16 v[52:55], v[120:123], a[196:199], v[52:55]
    s_sub_u32 s50, s45, s44
    v_fmac_f32 v27, v42, v42
    v_fmac_f32 v27, v43, v43
    v_mfma_f32_16x16x32_bf16 v[52:55], v[100:103], a[200:203], v[52:55]
    s_sub_u32 s51, s46, s47
    v_fmac_f32 v27, v36, v36
    v_fmac_f32 v27, v37, v37
    v_mfma_f32_16x16x32_bf16 v[52:55], v[112:115], a[204:207], v[52:55]
    s_mov_b32 s60, s59
    v_fmac_f32 v27, v38, v38
    v_fmac_f32 v27, v39, v39
    v_mfma_f32_16x16x32_bf16 v[52:55], v[96:99], a[208:211], v[52:55]
    s_mov_b32 s59, s58
    v_cvt_pk_bf16_f32 v170, v26, v27
    v_cvt_pk_bf16_f32 v26, v46, v47
    v_mfma_f32_16x16x32_bf16 v[52:55], v[92:95], a[212:215], v[52:55]
    s_mov_b32 s58, s57
    v_cvt_pk_bf16_f32 v27, v48, v49
    v_cvt_pk_bf16_f32 v30, v106, v107
    v_mfma_f32_16x16x16_bf16 v[68:71], v[216:217], v[170:171], 0
    s_waitcnt lgkmcnt(0)
    s_mov_b32 s57, s56
    v_cvt_pk_bf16_f32 v31, v108, v109
    v_mul_f32 v12, v12, v82
    v_mul_f32 v13, v13, v82
    v_cvt_pk_bf16_f32 v46, v52, v53
    v_mfma_f32_16x16x32_bf16 v[48:51], a[0:3], v[72:75], 0
    s_mov_b32 s7, s6
    v_cvt_pk_bf16_f32 v47, v54, v55
    v_cvt_pk_bf16_f32 v12, v12, v13
    v_mfma_f32_16x16x32_bf16 v[48:51], a[4:7], v[88:91], v[48:51]
    s_mov_b32 s6, s5
    v_rsq_f32 v68, v68
    v_mfma_f32_16x16x32_bf16 v[48:51], a[8:11], v[32:35], v[48:51]
    s_mov_b32 s5, s4
    v_rsq_f32 v69, v69
    v_mfma_f32_16x16x32_bf16 v[48:51], a[12:15], v[84:87], v[48:51]
    s_sub_u32 s14, s6, s7
    v_mul_f32 v68, s55, v68
    v_mul_f32 v69, 0.5, v69
    v_mfma_f32_16x16x32_bf16 v[48:51], a[16:19], v[116:119], v[48:51]
    s_add_u32 s61, s61, 1
    v_mul_f32 v8, v8, v68
    v_mul_f32 v9, v9, v68
    v_mfma_f32_16x16x32_bf16 v[48:51], a[20:23], v[212:215], v[48:51]
    s_ff1_i32_b32 s15, s66
    v_cvt_pk_f16_f32 v52, v8, v9
    v_mul_f32 v10, v10, v68
    v_mfma_f32_16x16x32_bf16 v[106:109], a[24:27], v[72:75], 0
    s_cmp_lg_u32 s66, 0
    v_mul_f32 v11, v11, v68
    v_cvt_pk_f16_f32 v53, v10, v11
    v_mfma_f32_16x16x32_bf16 v[106:109], a[28:31], v[88:91], v[106:109]
    s_cselect_b32 s12, s15, s12
    v_mul_f32 v20, v20, v68
    v_mul_f32 v21, v21, v68
    v_mfma_f32_16x16x32_bf16 v[106:109], a[32:35], v[32:35], v[106:109]
    s_cmp_lt_u32 s61, s71
    v_cvt_pk_f16_f32 v54, v20, v21
    v_mul_f32 v22, v22, v68
    v_mfma_f32_16x16x32_bf16 v[106:109], a[36:39], v[84:87], v[106:109]
    s_cselect_b32 s15, 31, s15
    v_mul_f32 v23, v23, v68
    v_cvt_pk_f16_f32 v55, v22, v23
    v_mfma_f32_16x16x32_bf16 v[106:109], a[40:43], v[116:119], v[106:109]
    s_bitset0_b32 s66, s15
    v_mul_f32 v76, v76, v68
    v_mul_f32 v77, v77, v68
    v_mfma_f32_16x16x32_bf16 v[106:109], a[44:47], v[212:215], v[106:109]
    s_add_u32 s12, s12, 20
    v_cvt_pk_f16_f32 v150, v76, v77
    v_mul_f32 v78, v78, v68
    v_mfma_f32_16x16x32_bf16 v[120:123], a[48:51], v[72:75], 0
    s_max_u32 s12, s12, s61
    v_mul_f32 v79, v79, v68
    v_cvt_pk_f16_f32 v151, v78, v79
    v_mfma_f32_16x16x32_bf16 v[120:123], a[52:55], v[88:91], v[120:123]
    s_cmp_lt_u32 s61, s71
    v_mul_f32 v60, v60, v69
    v_mul_f32 v61, v61, v69
    v_mfma_f32_16x16x32_bf16 v[120:123], a[56:59], v[32:35], v[120:123]
    s_cselect_b32 s15, s61, s12
    v_cvt_pk_f16_f32 v6, v60, v61
    v_mul_f32 v62, v62, v69
    v_mfma_f32_16x16x32_bf16 v[120:123], a[60:63], v[84:87], v[120:123]
    s_cselect_b32 s56, s69, s70
    v_mul_f32 v63, v63, v69
    v_cvt_pk_f16_f32 v7, v62, v63
    v_mfma_f32_16x16x32_bf16 v[120:123], a[64:67], v[116:119], v[120:123]
    s_add_u32 s56, s56, s15
    v_mul_f32 v40, v40, v69
    v_mul_f32 v41, v41, v69
    v_mfma_f32_16x16x32_bf16 v[120:123], a[68:71], v[212:215], v[120:123]
    s_mul_i32 s53, s56, 58255
    v_cvt_pk_f16_f32 v8, v40, v41
    v_mul_f32 v42, v42, v69
    v_mfma_f32_16x16x32_bf16 v[20:23], a[72:75], v[72:75], 0
    s_lshr_b32 s53, s53, 22
    v_mul_f32 v43, v43, v69
    v_cvt_pk_f16_f32 v9, v42, v43
    v_mfma_f32_16x16x32_bf16 v[20:23], a[76:79], v[88:91], v[20:23]
    s_mul_i32 s53, s53, s63
    v_mul_f32 v36, v36, v69
    v_mul_f32 v37, v37, v69
    v_mfma_f32_16x16x32_bf16 v[20:23], a[80:83], v[32:35], v[20:23]
    s_mul_i32 s56, s56, s62
    v_cvt_pk_f16_f32 v10, v36, v37
    v_mul_f32 v38, v38, v69
    v_mfma_f32_16x16x32_bf16 v[20:23], a[84:87], v[84:87], v[20:23]
    s_add_u32 s56, s56, s53
    v_mul_f32 v39, v39, v69
    v_cvt_pk_f16_f32 v11, v38, v39
    v_mfma_f32_16x16x32_bf16 v[20:23], a[88:91], v[116:119], v[20:23]
    s_mul_i32 s4, s15, 336
    v_mul_f32 v14, v14, v82
    v_mul_f32 v15, v15, v82
    v_mfma_f32_16x16x32_bf16 v[20:23], a[92:95], v[212:215], v[20:23]
    s_cmp_ge_u32 s15, 16
    v_cvt_pk_bf16_f32 v13, v14, v15
    v_mul_f32 v16, v16, v82
    v_mfma_f32_16x16x32_bf16 v[36:39], a[96:99], v[72:75], 0
    s_cselect_b32 s53, -26880, 0
    ds_write_b64 v137, v[12:13] offset:3072
    v_mfma_f32_16x16x32_bf16 v[36:39], a[100:103], v[88:91], v[36:39]
    s_add_u32 s4, s4, s53
    v_mul_f32 v17, v17, v82
    v_cvt_pk_bf16_f32 v14, v16, v17
    v_mfma_f32_16x16x32_bf16 v[36:39], a[104:107], v[32:35], v[36:39]
    s_cmp_lt_u32 s15, s73
    v_mul_f32 v18, v18, v82
    v_mul_f32 v19, v19, v82
    v_mfma_f32_16x16x32_bf16 v[36:39], a[108:111], v[84:87], v[36:39]
    s_cselect_b32 s26, 100270464, 0
    v_cvt_pk_bf16_f32 v15, v18, v19
    v_mul_f32 v56, v56, v82
    v_mfma_f32_16x16x32_bf16 v[36:39], a[112:115], v[116:119], v[36:39]
    s_cselect_b32 s56, s56, 0
    ds_write_b64 v137, v[14:15] offset:3080
    v_mfma_f32_16x16x32_bf16 v[36:39], a[116:119], v[212:215], v[36:39]
    s_cselect_b32 s4, s4, -1
    v_mul_f32 v57, v57, v82
    v_cvt_pk_bf16_f32 v56, v56, v57
    v_mul_f32 v58, v58, v82
    v_mul_f32 v59, v59, v82
    v_cvt_pk_bf16_f32 v57, v58, v59
    s_cselect_b32 s15, s15, 0
    s_cselect_b32 s13, s13, -1
    ds_write_b64 v136, v[56:57] offset:3072
    v_fma_f32 v142, v48, v48, s41
    v_fmac_f32 v142, v49, v49
    v_fmac_f32 v142, v50, v50
    v_fmac_f32 v142, v51, v51
    v_mfma_f32_16x16x32_bf16 v[56:59], a[120:123], v[72:75], 0
    s_waitcnt vmcnt(0)
    v_fmac_f32 v142, v106, v106
    v_fmac_f32 v142, v107, v107
    v_mfma_f32_16x16x32_bf16 v[56:59], a[124:127], v[88:91], v[56:59]
    s_bitset1_b32 s64, s15
    v_fmac_f32 v142, v108, v108
    v_fmac_f32 v142, v109, v109
    v_mfma_f32_16x16x32_bf16 v[56:59], a[128:131], v[32:35], v[56:59]
    s_add_u32 s65, s65, 1
    v_fmac_f32 v142, v120, v120
    v_fmac_f32 v142, v121, v121
    v_mfma_f32_16x16x32_bf16 v[56:59], a[132:135], v[84:87], v[56:59]
    s_cmp_ge_i32 s65, 2
    v_fmac_f32 v142, v122, v122
    v_fmac_f32 v142, v123, v123
    v_mfma_f32_16x16x32_bf16 v[56:59], a[136:139], v[116:119], v[56:59]
    s_cselect_b32 s30, 100270464, 0
    v_fma_f32 v143, v20, v20, s41
    v_fmac_f32 v143, v21, v21
    v_mfma_f32_16x16x32_bf16 v[56:59], a[140:143], v[212:215], v[56:59]
    s_add_u32 s67, s46, s54
    v_fmac_f32 v143, v22, v22
    v_fmac_f32 v143, v23, v23
    v_mfma_f32_16x16x32_bf16 v[12:15], v[72:75], a[144:147], 0
    s_waitcnt lgkmcnt(0)
    s_add_u32 m0, s67, 0
    v_fmac_f32 v143, v36, v36
    v_fmac_f32 v143, v37, v37
    v_mfma_f32_16x16x32_bf16 v[12:15], v[88:91], a[148:151], v[12:15]
    s_barrier
    v_fmac_f32 v143, v38, v38
    v_fmac_f32 v143, v39, v39
    v_mfma_f32_16x16x32_bf16 v[12:15], v[32:35], a[152:155], v[12:15]
    s_cmp_ge_u32 s61, s13
    v_fmac_f32 v143, v56, v56
    v_fmac_f32 v143, v57, v57
    v_mfma_f32_16x16x32_bf16 v[12:15], v[84:87], a[156:159], v[12:15]
    s_cbranch_scc1 L_atomS0
L_atomrS0:
    v_mfma_f32_16x16x32_bf16 v[12:15], v[116:119], a[160:163], v[12:15]
    v_fmac_f32 v143, v58, v58
    v_fmac_f32 v143, v59, v59
    v_mfma_f32_16x16x32_bf16 v[12:15], v[212:215], a[164:167], v[12:15]
    v_cvt_pk_bf16_f32 v170, v142, v143
    v_add_u32 v139, s50, v139
    v_mfma_f32_16x16x32_bf16 v[40:43], v[72:75], a[168:171], 0
    ds_read_b128 v[76:79], v139 offset:0
    v_add_u32 v138, s50, v138
    v_mfma_f32_16x16x32_bf16 v[40:43], v[88:91], a[172:175], v[40:43]
    s_nop 0
    ds_read_b128 v[80:83], v138 offset:0
    v_cvt_pk_bf16_f32 v164, v12, v13
    v_mfma_f32_16x16x32_bf16 v[40:43], v[32:35], a[176:179], v[40:43]
    ds_read_b128 v[68:71], v139 offset:128
    v_cvt_pk_bf16_f32 v165, v14, v15
    v_mfma_f32_16x16x32_bf16 v[40:43], v[84:87], a[180:183], v[40:43]
    ds_read_b128 v[100:103], v138 offset:128
    v_add_u32 v137, s48, v137
    v_mfma_f32_16x16x32_bf16 v[40:43], v[116:119], a[184:187], v[40:43]
    ds_read_b128 v[112:115], v139 offset:256
    v_add_u32 v136, s48, v136
    v_mfma_f32_16x16x32_bf16 v[40:43], v[212:215], a[188:191], v[40:43]
    s_nop 0
    ds_read_b128 v[96:99], v138 offset:256
    v_add_u32 v135, s51, v135
    v_mfma_f32_16x16x16_bf16 v[92:95], v[216:217], v[170:171], 0
    s_nop 0
    v_add_u32 v134, s14, v134
    v_add_u32 v133, s14, v133
    v_add_u32 v125, s14, v125
    v_cvt_pk_bf16_f32 v160, v40, v41
    v_mfma_f32_16x16x32_bf16 v[60:63], v[72:75], a[192:195], 0
    v_cvt_pk_bf16_f32 v161, v42, v43
    v_mfma_f32_16x16x32_bf16 v[60:63], v[88:91], a[196:199], v[60:63]
    v_rsq_f32 v92, v92
    v_mfma_f32_16x16x32_bf16 v[60:63], v[32:35], a[200:203], v[60:63]
    v_rsq_f32 v93, v93
    v_mfma_f32_16x16x32_bf16 v[60:63], v[84:87], a[204:207], v[60:63]
    ds_read_b128 v[12:15], v134 offset:32
    v_mul_f32 v92, s55, v92
    v_mfma_f32_16x16x32_bf16 v[60:63], v[116:119], a[208:211], v[60:63]
    ds_read_b64 v[16:17], v134 offset:48
    v_mul_f32 v93, 0.5, v93
    v_mfma_f32_16x16x32_bf16 v[60:63], v[212:215], a[212:215], v[60:63]
    s_waitcnt lgkmcnt(3)
    ds_read_b128 v[72:75], v135 offset:0
    v_mul_f32 v20, v20, v93
    v_mfma_f32_16x16x32_bf16 v[40:43], a[216:219], v[76:79], 0
    v_mul_f32 v21, v21, v93
    v_cvt_pk_f16_f32 v18, v20, v21
    v_mfma_f32_16x16x32_bf16 v[40:43], a[220:223], v[80:83], v[40:43]
    v_mul_f32 v22, v22, v93
    v_mul_f32 v23, v23, v93
    v_mfma_f32_16x16x32_bf16 v[40:43], a[224:227], v[68:71], v[40:43]
    v_cvt_pk_f16_f32 v19, v22, v23
    v_mul_f32 v36, v36, v93
    v_mfma_f32_16x16x32_bf16 v[40:43], a[228:231], v[100:103], v[40:43]
    v_mul_f32 v37, v37, v93
    v_cvt_pk_f16_f32 v20, v36, v37
    v_mfma_f32_16x16x32_bf16 v[40:43], a[232:235], v[112:115], v[40:43]
    s_waitcnt lgkmcnt(3)
    v_mul_f32 v38, v38, v93
    v_mul_f32 v39, v39, v93
    v_mfma_f32_16x16x32_bf16 v[40:43], a[236:239], v[96:99], v[40:43]
    v_cvt_pk_f16_f32 v21, v38, v39
    v_mul_f32 v56, v56, v93
    v_mfma_f32_16x16x32_bf16 v[36:39], a[240:243], v[76:79], 0
    v_mul_f32 v57, v57, v93
    v_cvt_pk_f16_f32 v22, v56, v57
    v_mfma_f32_16x16x32_bf16 v[36:39], a[244:247], v[80:83], v[36:39]
    v_mul_f32 v58, v58, v93
    v_mul_f32 v59, v59, v93
    v_mfma_f32_16x16x32_bf16 v[36:39], a[248:251], v[68:71], v[36:39]
    s_waitcnt lgkmcnt(0)
    buffer_load_dwordx4 v130, s[24:27], s56 offen nt lds
    v_cvt_pk_f16_f32 v23, v58, v59
    v_mfma_f32_16x16x32_bf16 v[36:39], a[252:255], v[100:103], v[36:39]
    v_mul_f32 v48, v48, v92
    v_mul_f32 v49, v49, v92
    v_mfma_f32_16x16x32_bf16 v[36:39], v[224:227], v[112:115], v[36:39]
    v_cvt_pk_f16_f32 v56, v48, v49
    v_mul_f32 v50, v50, v92
    v_mfma_f32_16x16x32_bf16 v[36:39], v[228:231], v[96:99], v[36:39]
    ds_read_u16 v166, v133 offset:56
    v_mul_f32 v51, v51, v92
    v_mfma_f32_16x16x32_bf16 v[32:35], v[232:235], v[76:79], 0
    ds_read_u16 v162, v133 offset:64
    v_cvt_pk_f16_f32 v57, v50, v51
    v_mfma_f32_16x16x32_bf16 v[32:35], v[236:239], v[80:83], v[32:35]
    ds_read_u16 v158, v133 offset:72
    v_mul_f32 v106, v106, v92
    v_mfma_f32_16x16x32_bf16 v[32:35], v[240:243], v[68:71], v[32:35]
    ds_read_b128 v[48:51], v134 offset:0
    v_mul_f32 v107, v107, v92
    v_mfma_f32_16x16x32_bf16 v[32:35], v[244:247], v[100:103], v[32:35]
    buffer_store_dwordx4 v[72:75], v130, s[28:31], s60 offen sc1
    ds_read_b64 v[142:143], v134 offset:16
    v_cvt_pk_f16_f32 v58, v106, v107
    v_mul_f32 v108, v108, v92
    v_mul_f32 v109, v109, v92
    v_mfma_f32_16x16x32_bf16 v[32:35], v[248:251], v[112:115], v[32:35]
    s_add_u32 m0, s67, 1024
    v_cvt_pk_f16_f32 v59, v108, v109
    v_mul_f32 v120, v120, v92
    v_mfma_f32_16x16x32_bf16 v[32:35], v[252:255], v[96:99], v[32:35]
    v_mul_f32 v121, v121, v92
    v_cvt_pk_f16_f32 v146, v120, v121
    v_mfma_f32_16x16x32_f16 v[100:103], v[0:3], v[64:67], v[204:207]
    v_mul_f32 v122, v122, v92
    v_mul_f32 v123, v123, v92
    v_mfma_f32_16x16x32_f16 v[100:103], v[2:5], v[152:155], v[100:103]
    ds_read_b128 v[112:115], v135 offset:1024
    v_cvt_pk_f16_f32 v147, v122, v123
    v_mfma_f32_16x16x32_f16 v[120:123], v[6:9], v[64:67], v[200:203]
    ds_read_b128 v[76:79], v139 offset:1536
    v_cvt_pk_bf16_f32 v156, v60, v61
    v_mfma_f32_16x16x32_f16 v[120:123], v[8:11], v[152:155], v[120:123]
    ds_read_b128 v[80:83], v138 offset:1536
    v_cvt_pk_bf16_f32 v157, v62, v63
    v_mfma_f32_16x16x32_f16 v[96:99], v[18:21], v[64:67], v[196:199]
    ds_read_b128 v[60:63], v139 offset:1664
    v_max3_f32 v104, v100, v101, v102
    v_mfma_f32_16x16x32_f16 v[96:99], v[20:23], v[152:155], v[96:99]
    s_nop 0
    ds_read_b128 v[72:75], v138 offset:1664
    v_max3_f32 v104, v104, v103, v120
    v_mfma_f32_16x16x32_f16 v[88:91], v[12:15], v[64:67], v[208:211]
    ds_read_b128 v[64:67], v139 offset:1792
    v_max3_f32 v104, v104, v121, v122
    v_mfma_f32_16x16x32_f16 v[88:91], v[14:17], v[152:155], v[88:91]
    s_waitcnt lgkmcnt(6)
    ds_read_b128 v[68:71], v138 offset:1792
    v_max3_f32 v104, v104, v123, v96
    v_mfma_f32_16x16x32_f16 v[106:109], v[48:51], v[0:3], v[208:211]
    v_max3_f32 v104, v104, v97, v98
    s_nop 0
    v_mfma_f32_16x16x32_f16 v[106:109], v[140:143], v[2:5], v[106:109]
    s_nop 0
    v_max3_f32 v104, v104, v99, v88
    v_mov_b32 v105, v104
    v_mfma_f32_16x16x32_f16 v[92:95], v[48:51], v[6:9], v[208:211]
    s_waitcnt lgkmcnt(6)
    buffer_load_dwordx4 v129, s[24:27], s56 offen nt lds
    v_mfma_f32_16x16x32_f16 v[92:95], v[140:143], v[8:11], v[92:95]
    v_permlane32_swap_b32 v105, v104
    v_mfma_f32_16x16x32_f16 v[84:87], v[48:51], v[18:21], v[208:211]
    v_max_f32 v104, v105, v104
    v_mov_b32 v105, v104
    v_mfma_f32_16x16x32_f16 v[84:87], v[140:143], v[20:23], v[84:87]
    s_nop 0
    v_permlane16_swap_b32 v105, v104
    v_mfma_f32_16x16x32_f16 v[90:93], v[48:51], v[12:15], v[208:211]
    v_max_f32 v104, v105, v104
    v_sub_f32 v100, v100, v104
    v_mfma_f32_16x16x32_f16 v[90:93], v[140:143], v[14:17], v[90:93]
    s_waitcnt lgkmcnt(1)
    v_sub_f32 v101, v101, v104
    v_sub_f32 v102, v102, v104
    v_mfma_f32_16x16x32_bf16 v[48:51], a[216:219], v[76:79], 0
    v_sub_f32 v103, v103, v104
    v_sub_f32 v120, v120, v104
    v_mfma_f32_16x16x32_bf16 v[48:51], a[220:223], v[80:83], v[48:51]
    buffer_store_dwordx4 v[112:115], v129, s[28:31], s60 offen sc1
    v_sub_f32 v121, v121, v104
    v_sub_f32 v122, v122, v104
    v_sub_f32 v123, v123, v104
    v_sub_f32 v96, v96, v104
    v_mfma_f32_16x16x32_bf16 v[48:51], a[224:227], v[60:63], v[48:51]
    s_add_u32 m0, s67, 2048
    v_sub_f32 v97, v97, v104
    v_sub_f32 v98, v98, v104
    v_mfma_f32_16x16x32_bf16 v[48:51], a[228:231], v[72:75], v[48:51]
    v_sub_f32 v99, v99, v104
    v_sub_f32 v88, v88, v104
    v_mfma_f32_16x16x32_bf16 v[48:51], a[232:235], v[64:67], v[48:51]
    s_waitcnt lgkmcnt(0)
    v_exp_f32 v100, v100
    v_mfma_f32_16x16x32_bf16 v[48:51], a[236:239], v[68:71], v[48:51]
    v_exp_f32 v101, v101
    v_exp_f32 v102, v102
    v_exp_f32 v103, v103
    v_cvt_pk_bf16_f32 v116, v100, v101
    v_cvt_pk_bf16_f32 v117, v102, v103
    v_exp_f32 v120, v120
    v_exp_f32 v121, v121
    v_exp_f32 v122, v122
    v_exp_f32 v123, v123
    v_cvt_pk_bf16_f32 v118, v120, v121
    v_cvt_pk_bf16_f32 v119, v122, v123
    v_exp_f32 v96, v96
    v_exp_f32 v97, v97
    v_exp_f32 v98, v98
    v_exp_f32 v99, v99
    v_cvt_pk_bf16_f32 v168, v96, v97
    v_cvt_pk_bf16_f32 v169, v98, v99
    v_exp_f32 v88, v88
    v_mov_b32_dpp v109, v95 quad_perm:[0,1,2,3] row_mask:0x2 bank_mask:0xf
    v_cvt_pk_bf16_f32 v170, v88, 0
    v_mfma_f32_16x16x32_bf16 v[120:123], v[220:223], v[116:119], 0
    v_mov_b32_dpp v109, v87 quad_perm:[0,1,2,3] row_mask:0x4 bank_mask:0xf
    v_mfma_f32_16x16x32_bf16 v[120:123], v[220:223], v[168:171], v[120:123]
    ds_read_b128 v[100:103], v135 offset:2048
    v_mov_b32_dpp v109, v93 quad_perm:[0,1,2,3] row_mask:0x8 bank_mask:0xf
    v_mfma_f32_16x16x32_bf16 v[112:115], v[24:27], v[116:119], 0
    s_nop 0
    v_mov_b32 v142, v109
    s_nop 0
    v_mfma_f32_16x16x32_bf16 v[112:115], v[164:167], v[168:171], v[112:115]
    s_nop 0
    v_rcp_f32 v120, v120
    v_mfma_f32_16x16x32_bf16 v[104:107], v[28:31], v[116:119], 0
    v_max_f32_dpp v142, v142, v142 row_ror:8 row_mask:0xf bank_mask:0xf
    s_nop 0
    v_mfma_f32_16x16x32_bf16 v[104:107], v[160:163], v[168:171], v[104:107]
    s_nop 0
    v_max_f32_dpp v142, v142, v142 row_ror:4 row_mask:0xf bank_mask:0xf
    v_mul_f32 v112, v112, v120
    v_mfma_f32_16x16x32_bf16 v[96:99], v[44:47], v[116:119], 0
    v_max_f32_dpp v142, v142, v142 row_ror:2 row_mask:0xf bank_mask:0xf
    v_mul_f32 v113, v113, v120
    v_mfma_f32_16x16x32_bf16 v[96:99], v[156:159], v[168:171], v[96:99]
    v_max_f32_dpp v142, v142, v142 row_ror:1 row_mask:0xf bank_mask:0xf
    v_mov_b32 v143, v142
    v_mfma_f32_16x16x32_f16 v[88:91], v[0:3], v[52:55], v[192:195]
    s_nop 0
    v_permlane32_swap_b32 v143, v142
    v_mfma_f32_16x16x32_f16 v[88:91], v[2:5], v[148:151], v[88:91]
    v_max_f32 v142, v143, v142
    v_mov_b32 v143, v142
    v_mfma_f32_16x16x32_f16 v[92:95], v[6:9], v[52:55], v[188:191]
    s_waitcnt lgkmcnt(0)
    buffer_load_dwordx4 v128, s[24:27], s56 offen nt lds
    v_cvt_pk_bf16_f32 v112, v112, v113
    v_mfma_f32_16x16x32_f16 v[92:95], v[8:11], v[148:151], v[92:95]
    v_permlane16_swap_b32 v143, v142
    v_mfma_f32_16x16x32_f16 v[84:87], v[18:21], v[52:55], v[184:187]
    v_max_f32 v142, v143, v142
    v_sub_f32 v109, v109, v142
    v_mfma_f32_16x16x32_f16 v[84:87], v[20:23], v[148:151], v[84:87]
    v_exp_f32 v109, v109
    v_mfma_f32_16x16x32_f16 v[116:119], v[12:15], v[52:55], v[208:211]
    v_cvt_pk_bf16_f32 v109, v109, v109
    v_mul_f32 v114, v114, v120
    v_mfma_f32_16x16x32_f16 v[116:119], v[14:17], v[148:151], v[116:119]
    s_mov_b32 s53, s47
    ds_write_b16 v125, v109
    v_mul_f32 v115, v115, v120
    v_cvt_pk_bf16_f32 v113, v114, v115
    s_mov_b32 s47, s46
    s_mov_b32 s46, s45
    ds_read_b128 v[52:55], v134
    v_mul_f32 v104, v104, v120
    v_mul_f32 v105, v105, v120
    v_cvt_pk_bf16_f32 v114, v104, v105
    s_add_u32 m0, s67, 3072
    s_mov_b32 s45, s44
    ds_read_b128 v[212:215], v134 offset:16
    v_mfma_f32_16x16x32_bf16 v[108:111], a[240:243], v[76:79], 0
    s_mov_b32 s44, s53
    buffer_store_dwordx4 v[100:103], v128, s[28:31], s60 offen sc1
    ds_write_b64 v137, v[112:113] offset:0
    v_mul_f32 v106, v106, v120
    v_mfma_f32_16x16x32_bf16 v[108:111], a[244:247], v[80:83], v[108:111]
    s_sub_u32 s48, s44, s46
    v_mul_f32 v107, v107, v120
    v_cvt_pk_bf16_f32 v115, v106, v107
    v_mfma_f32_16x16x32_bf16 v[108:111], a[248:251], v[60:63], v[108:111]
    ds_write_b64 v137, v[114:115] offset:8
    v_mfma_f32_16x16x32_bf16 v[108:111], a[252:255], v[72:75], v[108:111]
    v_mul_f32 v96, v96, v120
    v_mul_f32 v97, v97, v120
    v_mfma_f32_16x16x32_bf16 v[108:111], v[224:227], v[64:67], v[108:111]
    s_sub_u32 s49, s46, s45
    v_cvt_pk_bf16_f32 v168, v96, v97
    v_mul_f32 v98, v98, v120
    v_mfma_f32_16x16x32_bf16 v[108:111], v[228:231], v[68:71], v[108:111]
    s_waitcnt lgkmcnt(3)
    v_mul_f32 v99, v99, v120
    v_cvt_pk_bf16_f32 v169, v98, v99
    v_mfma_f32_16x16x32_bf16 v[104:107], v[52:55], v[24:27], 0
    s_waitcnt lgkmcnt(2)
    ds_write_b64 v136, v[168:169] offset:0
    v_max3_f32 v168, v88, v89, v90
    v_mfma_f32_16x16x32_bf16 v[104:107], v[212:215], v[164:167], v[104:107]
    v_max3_f32 v168, v168, v91, v92
    v_max3_f32 v168, v168, v93, v94
    v_mfma_f32_16x16x32_bf16 v[120:123], v[52:55], v[28:31], 0
    v_max3_f32 v168, v168, v95, v84
    v_max3_f32 v168, v168, v85, v86
    v_mfma_f32_16x16x32_bf16 v[120:123], v[212:215], v[160:163], v[120:123]
    v_max3_f32 v168, v168, v87, v117
    v_mov_b32 v169, v168
    v_mfma_f32_16x16x32_bf16 v[100:103], v[52:55], v[44:47], 0
    s_nop 0
    v_permlane32_swap_b32 v169, v168
    v_mfma_f32_16x16x32_bf16 v[100:103], v[212:215], v[156:159], v[100:103]
    v_max_f32 v168, v169, v168
    v_mov_b32 v169, v168
    v_mfma_f32_16x16x32_bf16 v[52:55], v[232:235], v[76:79], 0
    s_nop 0
    v_permlane16_swap_b32 v169, v168
    v_mfma_f32_16x16x32_bf16 v[52:55], v[236:239], v[80:83], v[52:55]
    v_max_f32 v168, v169, v168
    v_sub_f32 v88, v88, v168
    v_mfma_f32_16x16x32_bf16 v[52:55], v[240:243], v[60:63], v[52:55]
    v_sub_f32 v89, v89, v168
    v_sub_f32 v90, v90, v168
    v_mfma_f32_16x16x32_bf16 v[52:55], v[244:247], v[72:75], v[52:55]
    v_sub_f32 v91, v91, v168
    v_sub_f32 v92, v92, v168
    v_mfma_f32_16x16x32_bf16 v[52:55], v[248:251], v[64:67], v[52:55]
    v_sub_f32 v93, v93, v168
    v_sub_f32 v94, v94, v168
    v_mfma_f32_16x16x32_bf16 v[52:55], v[252:255], v[68:71], v[52:55]
    v_sub_f32 v95, v95, v168
    v_sub_f32 v84, v84, v168
    v_sub_f32 v85, v85, v168
    v_sub_f32 v86, v86, v168
    v_sub_f32 v87, v87, v168
    v_sub_f32 v117, v117, v168
    v_exp_f32 v88, v88
    v_exp_f32 v89, v89
    v_exp_f32 v90, v90
    v_exp_f32 v91, v91
    v_cvt_pk_bf16_f32 v76, v88, v89
    v_cvt_pk_bf16_f32 v77, v90, v91
    v_exp_f32 v92, v92
    v_exp_f32 v93, v93
    v_exp_f32 v94, v94
    v_exp_f32 v95, v95
    v_cvt_pk_bf16_f32 v78, v92, v93
    v_cvt_pk_bf16_f32 v79, v94, v95
    v_exp_f32 v84, v84
    v_exp_f32 v85, v85
    v_exp_f32 v86, v86
    v_exp_f32 v87, v87
    v_cvt_pk_bf16_f32 v168, v84, v85
    v_cvt_pk_bf16_f32 v169, v86, v87
    v_exp_f32 v117, v117
    v_mov_b32_dpp v107, v123 quad_perm:[0,1,2,3] row_mask:0x2 bank_mask:0xf
    v_cvt_pk_bf16_f32 v170, v117, 0
    v_mfma_f32_16x16x32_bf16 v[80:83], v[220:223], v[76:79], 0
    v_mov_b32_dpp v107, v103 quad_perm:[0,1,2,3] row_mask:0x4 bank_mask:0xf
    v_cvt_pk_bf16_f32 v107, v107, v107
    v_mfma_f32_16x16x32_bf16 v[80:83], v[220:223], v[168:171], v[80:83]
    ds_write_b16 v133, v107 offset:56
    v_mfma_f32_16x16x32_bf16 v[60:63], v[24:27], v[76:79], 0
    ds_read_b128 v[72:75], v135 offset:3072
    v_fma_f32 v154, v40, v40, s42
    v_mfma_f32_16x16x32_bf16 v[60:63], v[164:167], v[168:171], v[60:63]
    ds_read_b128 v[68:71], v139 offset:3072
    v_fmac_f32 v154, v41, v41
    v_mfma_f32_16x16x32_bf16 v[64:67], v[28:31], v[76:79], 0
    ds_read_b128 v[104:107], v138 offset:3072
    v_fmac_f32 v154, v42, v42
    v_mfma_f32_16x16x32_bf16 v[64:67], v[160:163], v[168:171], v[64:67]
    ds_read_b128 v[120:123], v139 offset:3200
    v_fmac_f32 v154, v43, v43
    v_mfma_f32_16x16x32_bf16 v[100:103], v[44:47], v[76:79], 0
    ds_read_b128 v[76:79], v138 offset:3200
    v_fmac_f32 v154, v36, v36
    v_mfma_f32_16x16x32_bf16 v[100:103], v[156:159], v[168:171], v[100:103]
    ds_read_b128 v[112:115], v139 offset:3328
    v_add_u32 v139, s48, v139
    v_mfma_f32_16x16x32_f16 v[96:99], v[0:3], v[56:59], v[180:183]
    ds_read_b128 v[82:85], v138 offset:3328
    v_add_u32 v138, s48, v138
    v_mfma_f32_16x16x32_f16 v[96:99], v[2:5], v[144:147], v[96:99]
    ds_read_b128 v[0:3], v135 offset:4096
    v_fmac_f32 v154, v37, v37
    v_mfma_f32_16x16x32_f16 v[88:91], v[6:9], v[56:59], v[176:179]
    v_rcp_f32 v80, v80
    v_mfma_f32_16x16x32_f16 v[88:91], v[8:11], v[144:147], v[88:91]
    s_waitcnt lgkmcnt(7)
    buffer_load_dwordx4 v127, s[24:27], s56 offen nt lds
    v_mul_f32 v60, v60, v80
    v_mfma_f32_16x16x32_f16 v[4:7], v[18:21], v[56:59], v[172:175]
    v_mul_f32 v61, v61, v80
    v_cvt_pk_bf16_f32 v8, v60, v61
    v_mfma_f32_16x16x32_f16 v[4:7], v[20:23], v[144:147], v[4:7]
    v_mul_f32 v62, v62, v80
    v_mul_f32 v63, v63, v80
    v_mfma_f32_16x16x32_f16 v[20:23], v[12:15], v[56:59], v[208:211]
    v_cvt_pk_bf16_f32 v9, v62, v63
    v_mul_f32 v64, v64, v80
    v_mfma_f32_16x16x32_f16 v[20:23], v[14:17], v[144:147], v[20:23]
    s_waitcnt lgkmcnt(3)
    ds_write_b64 v137, v[8:9] offset:1536
    v_mfma_f32_16x16x32_bf16 v[12:15], a[216:219], v[68:71], 0
    v_mul_f32 v65, v65, v80
    v_cvt_pk_bf16_f32 v10, v64, v65
    v_mfma_f32_16x16x32_bf16 v[12:15], a[220:223], v[104:107], v[12:15]
    v_mul_f32 v66, v66, v80
    v_mul_f32 v67, v67, v80
    v_mfma_f32_16x16x32_bf16 v[12:15], a[224:227], v[120:123], v[12:15]
    s_add_u32 m0, s67, 4096
    buffer_store_dwordx4 v[72:75], v127, s[28:31], s60 offen sc1
    v_cvt_pk_bf16_f32 v11, v66, v67
    v_mul_f32 v100, v100, v80
    v_mul_f32 v101, v101, v80
    v_cvt_pk_bf16_f32 v168, v100, v101
    v_mfma_f32_16x16x32_bf16 v[12:15], a[228:231], v[76:79], v[12:15]
    s_waitcnt lgkmcnt(1)
    ds_write_b64 v137, v[10:11] offset:1544
    v_mfma_f32_16x16x32_bf16 v[12:15], a[232:235], v[112:115], v[12:15]
    s_cmp_lg_u32 s5, -1
    v_mul_f32 v102, v102, v80
    v_mul_f32 v103, v103, v80
    v_mfma_f32_16x16x32_bf16 v[12:15], a[236:239], v[82:85], v[12:15]
    buffer_load_dwordx4 v126, s[24:27], s56 offen nt lds
    v_cvt_pk_bf16_f32 v169, v102, v103
    v_mfma_f32_16x16x32_bf16 v[16:19], a[240:243], v[68:71], 0
    ds_write_b64 v136, v[168:169] offset:1536
    v_mfma_f32_16x16x32_bf16 v[16:19], a[244:247], v[104:107], v[16:19]
    v_max3_f32 v155, v96, v97, v98
    v_max3_f32 v155, v155, v99, v88
    v_mfma_f32_16x16x32_bf16 v[16:19], a[248:251], v[120:123], v[16:19]
    v_max3_f32 v155, v155, v89, v90
    v_max3_f32 v155, v155, v91, v4
    v_mfma_f32_16x16x32_bf16 v[16:19], a[252:255], v[76:79], v[16:19]
    v_max3_f32 v155, v155, v5, v6
    v_max3_f32 v155, v155, v7, v22
    v_mfma_f32_16x16x32_bf16 v[16:19], v[224:227], v[112:115], v[16:19]
    v_mov_b32 v168, v155
    v_fmac_f32 v154, v38, v38
    v_mfma_f32_16x16x32_bf16 v[16:19], v[228:231], v[82:85], v[16:19]
    ds_read_b128 v[8:11], v139 offset:0
    v_fmac_f32 v154, v39, v39
    v_mfma_f32_16x16x32_bf16 v[56:59], v[232:235], v[68:71], 0
    buffer_store_dwordx4 v[0:3], v126, s[28:31], s60 offen sc1
    ds_read_b128 v[60:63], v138 offset:0
    v_permlane32_swap_b32 v168, v155
    v_max_f32 v155, v168, v155
    v_mfma_f32_16x16x32_bf16 v[56:59], v[236:239], v[104:107], v[56:59]
    ds_read_b128 v[0:3], v139 offset:128
    v_mov_b32 v168, v155
    v_mfma_f32_16x16x32_bf16 v[56:59], v[240:243], v[120:123], v[56:59]
    ds_read_b128 v[72:75], v138 offset:128
    v_fmac_f32 v154, v32, v32
    v_mfma_f32_16x16x32_bf16 v[56:59], v[244:247], v[76:79], v[56:59]
    ds_read_b128 v[76:79], v139 offset:256
    v_fmac_f32 v154, v33, v33
    v_mfma_f32_16x16x32_bf16 v[56:59], v[248:251], v[112:115], v[56:59]
    ds_read_b128 v[64:67], v138 offset:256
    v_fmac_f32 v154, v34, v34
    v_mfma_f32_16x16x32_bf16 v[56:59], v[252:255], v[82:85], v[56:59]
    v_permlane16_swap_b32 v168, v155
    v_max_f32 v155, v168, v155
    v_sub_f32 v96, v96, v155
    v_sub_f32 v97, v97, v155
    v_sub_f32 v98, v98, v155
    v_sub_f32 v99, v99, v155
    v_sub_f32 v88, v88, v155
    v_sub_f32 v89, v89, v155
    v_sub_f32 v90, v90, v155
    v_sub_f32 v91, v91, v155
    v_sub_f32 v4, v4, v155
    v_sub_f32 v5, v5, v155
    v_sub_f32 v6, v6, v155
    v_sub_f32 v7, v7, v155
    v_sub_f32 v22, v22, v155
    v_exp_f32 v96, v96
    v_exp_f32 v97, v97
    v_exp_f32 v98, v98
    v_exp_f32 v99, v99
    v_cvt_pk_bf16_f32 v80, v96, v97
    v_cvt_pk_bf16_f32 v81, v98, v99
    v_exp_f32 v88, v88
    v_exp_f32 v89, v89
    v_exp_f32 v90, v90
    v_exp_f32 v91, v91
    v_cvt_pk_bf16_f32 v82, v88, v89
    v_cvt_pk_bf16_f32 v83, v90, v91
    v_exp_f32 v4, v4
    v_exp_f32 v5, v5
    v_exp_f32 v6, v6
    v_exp_f32 v7, v7
    v_cvt_pk_bf16_f32 v168, v4, v5
    v_cvt_pk_bf16_f32 v169, v6, v7
    v_exp_f32 v22, v22
    v_fmac_f32 v154, v35, v35
    v_cvt_pk_bf16_f32 v170, v22, 0
    v_mfma_f32_16x16x32_bf16 v[4:7], v[220:223], v[80:83], 0
    v_fma_f32 v155, v48, v48, s42
    v_fmac_f32 v155, v49, v49
    v_mfma_f32_16x16x32_bf16 v[4:7], v[220:223], v[168:171], v[4:7]
    v_fmac_f32 v155, v50, v50
    v_fmac_f32 v155, v51, v51
    v_mfma_f32_16x16x32_bf16 v[20:23], v[24:27], v[80:83], 0
    s_nop 0
    v_fmac_f32 v155, v108, v108
    v_fmac_f32 v155, v109, v109
    v_mfma_f32_16x16x32_bf16 v[20:23], v[164:167], v[168:171], v[20:23]
    s_nop 0
    v_rcp_f32 v4, v4
    v_mfma_f32_16x16x32_bf16 v[24:27], v[28:31], v[80:83], 0
    s_nop 0
    v_fmac_f32 v155, v110, v110
    v_fmac_f32 v155, v111, v111
    v_mfma_f32_16x16x32_bf16 v[24:27], v[160:163], v[168:171], v[24:27]
    s_nop 0
    v_mul_f32 v20, v20, v4
    v_mul_f32 v21, v21, v4
    v_mfma_f32_16x16x32_bf16 v[28:31], v[44:47], v[80:83], 0
    v_cvt_pk_bf16_f32 v44, v20, v21
    v_mul_f32 v22, v22, v4
    v_mfma_f32_16x16x32_bf16 v[28:31], v[156:159], v[168:171], v[28:31]
    s_waitcnt lgkmcnt(0)
    v_mul_f32 v23, v23, v4
    v_cvt_pk_bf16_f32 v45, v22, v23
    v_mfma_f32_16x16x32_bf16 v[20:23], a[0:3], v[8:11], 0
    s_cbranch_scc1 L_loopS0
    ds_write_b64 v137, v[44:45] offset:3072
    v_mul_f32 v24, v24, v4
    v_mul_f32 v25, v25, v4
    v_cvt_pk_bf16_f32 v46, v24, v25
    v_mul_f32 v26, v26, v4
    v_mul_f32 v27, v27, v4
    v_cvt_pk_bf16_f32 v47, v26, v27
    v_mul_f32 v28, v28, v4
    v_mul_f32 v29, v29, v4
    v_cvt_pk_bf16_f32 v28, v28, v29
    v_mul_f32 v30, v30, v4
    v_mul_f32 v31, v31, v4
    v_cvt_pk_bf16_f32 v29, v30, v31
    s_mov_b32 s30, 100270464
    s_mul_i32 s89, s68, 5376
    ds_write_b64 v137, v[46:47] offset:3080
    v_fmac_f32 v155, v52, v52
    s_add_u32 s89, s89, 142336
    s_movk_i32 s90, 336
    ds_write_b64 v136, v[28:29] offset:3072
    v_fmac_f32 v155, v53, v53
    v_fmac_f32 v155, v54, v54
    v_fmac_f32 v155, v55, v55
    v_fma_f32 v125, v12, v12, s42
    v_fmac_f32 v125, v13, v13
    v_fmac_f32 v125, v14, v14
    v_fmac_f32 v125, v15, v15
    v_fmac_f32 v125, v16, v16
    v_fmac_f32 v125, v17, v17
    v_fmac_f32 v125, v18, v18
    v_fmac_f32 v125, v19, v19
    v_fmac_f32 v125, v56, v56
    v_fmac_f32 v125, v57, v57
    v_fmac_f32 v125, v58, v58
    v_fmac_f32 v125, v59, v59
    v_cvt_pk_bf16_f32 v0, v154, v155
    v_cvt_pk_bf16_f32 v1, v125, v124
    s_lshr_b32 s91, s64, 16
    s_sub_u32 s84, s45, s44
    ds_write_b64 v132, v[0:1]
    v_mbcnt_lo_u32_b32 v124, -1, 0
    v_mbcnt_hi_u32_b32 v124, -1, v124
    v_and_b32 v125, 15, v124
    v_lshrrev_b32 v124, 4, v124
    v_mul_u32_u24 v0, 80, v124
    v_add_u32 v0, s89, v0
    v_mad_u32_u24 v69, v125, s90, v0
    v_lshrrev_b32 v124, v125, s64
    v_and_b32 v124, 1, v124
    v_cmp_eq_u32 vcc, 1, v124
    v_mad_u32_u24 v23, v125, s90, v0
    v_lshrrev_b32 v68, v125, s91
    v_cndmask_b32 v69, v0, v69, vcc
    s_sub_u32 s85, s46, s45
    s_sub_u32 s86, s44, s45
    ds_read_b128 v[8:11], v69
    ds_read_b128 v[60:63], v69 offset:16
    v_and_b32 v68, 1, v68
    v_subrev_u32 v23, 21504, v23
    s_sub_u32 s93, s44, s47
    s_sub_u32 s94, s45, s47
    ds_read_b64 v[70:71], v69 offset:56
    ds_read_b128 v[72:75], v69 offset:64
    v_cmp_eq_u32 vcc, 1, v68
    v_add_u32 v3, s84, v139
    v_add_u32 v2, s84, v138
    v_cndmask_b32 v23, v0, v23, vcc
    v_add_u32 v44, s85, v137
    v_add_u32 v22, s85, v136
    v_add_u32 v133, s86, v137
    v_add_u32 v125, s86, v136
    v_add_u32 v124, s93, v135
    s_waitcnt lgkmcnt(4)
    s_barrier
    ds_read_b128 v[24:27], v131 offset:0
    ds_read_b128 v[4:7], v131 offset:1024
    v_add_u32 v134, s94, v135
    s_sub_u32 s95, s46, s47
    ds_read_b128 v[76:79], v3 offset:1536
    v_add_u32 v20, s95, v135
    v_mov_b32 v21, 0
    s_waitcnt lgkmcnt(6)
    v_mfma_f32_16x16x32_bf16 v[80:83], v[220:223], v[8:11], 0
    s_waitcnt lgkmcnt(5)
    s_lshl_b32 s92, s68, 10
    ds_read_b128 v[8:11], v3 offset:1664
    ds_read_b128 v[28:31], v3 offset:1792
    v_mfma_f32_16x16x32_bf16 v[80:83], v[220:223], v[60:63], v[80:83]
    s_waitcnt lgkmcnt(5)
    v_lshlrev_b32 v60, 16, v70
    v_and_b32 v70, 0xffff0000, v70
    v_lshlrev_b32 v61, 16, v71
    v_and_b32 v71, 0xffff0000, v71
    v_lshlrev_b32 v62, 16, v72
    v_and_b32 v72, 0xffff0000, v72
    v_lshlrev_b32 v63, 16, v73
    v_rcp_f32 v80, v80
    v_and_b32 v73, 0xffff0000, v73
    v_mul_f32 v60, v60, v80
    v_mul_f32 v70, v70, v80
    v_cvt_pk_bf16_f32 v60, v60, v70
    v_mul_f32 v61, v61, v80
    v_mul_f32 v71, v71, v80
    v_cvt_pk_bf16_f32 v61, v61, v71
    v_mul_f32 v62, v62, v80
    v_mul_f32 v72, v72, v80
    v_cvt_pk_bf16_f32 v62, v62, v72
    v_mul_f32 v63, v63, v80
    s_waitcnt lgkmcnt(3)
    v_mfma_f32_16x16x32_bf16 v[84:87], v[216:219], v[24:27], 0
    ds_read_b128 v[68:71], v2 offset:1536
    ds_read_b128 v[64:67], v2 offset:1664
    v_mfma_f32_16x16x32_bf16 v[84:87], v[216:219], v[4:7], v[84:87]
    s_waitcnt lgkmcnt(4)
    ds_read_b128 v[24:27], v2 offset:1792
    v_mul_f32 v73, v73, v80
    v_mfma_f32_16x16x32_bf16 v[4:7], a[216:219], v[76:79], 0
    v_cvt_pk_bf16_f32 v63, v63, v73
    v_lshlrev_b32 v135, 16, v74
    v_and_b32 v74, 0xffff0000, v74
    v_mul_f32 v135, v135, v80
    v_mul_f32 v74, v74, v80
    v_cvt_pk_bf16_f32 v46, v135, v74
    v_lshlrev_b32 v87, 16, v75
    v_and_b32 v75, 0xffff0000, v75
    v_mul_f32 v87, v87, v80
    v_mul_f32 v75, v75, v80
    v_cvt_pk_bf16_f32 v47, v87, v75
    v_rsq_f32 v84, v84
    v_rsq_f32 v85, v85
    v_mul_f32 v84, s43, v84
    v_mul_f32 v40, v40, v84
    v_mul_f32 v41, v41, v84
    v_cvt_pk_bf16_f32 v40, v40, v41
    v_mul_f32 v42, v42, v84
    v_mul_f32 v43, v43, v84
    v_cvt_pk_bf16_f32 v41, v42, v43
    v_mul_f32 v36, v36, v84
    v_mul_f32 v37, v37, v84
    v_cvt_pk_bf16_f32 v42, v36, v37
    v_mul_f32 v38, v38, v84
    v_mul_f32 v39, v39, v84
    s_waitcnt lgkmcnt(1)
    v_mfma_f32_16x16x32_bf16 v[4:7], a[220:223], v[68:71], v[4:7]
    ds_write_b128 v133, v[60:63] offset:0
    v_mfma_f32_16x16x32_bf16 v[4:7], a[224:227], v[8:11], v[4:7]
    v_cvt_pk_bf16_f32 v43, v38, v39
    v_mul_f32 v32, v32, v84
    v_mfma_f32_16x16x32_bf16 v[4:7], a[228:231], v[64:67], v[4:7]
    ds_write_b128 v44, v[40:43] offset:0
    v_mfma_f32_16x16x32_bf16 v[4:7], a[232:235], v[28:31], v[4:7]
    s_waitcnt lgkmcnt(2)
    v_mul_f32 v33, v33, v84
    v_cvt_pk_bf16_f32 v0, v32, v33
    v_mfma_f32_16x16x32_bf16 v[4:7], a[236:239], v[24:27], v[4:7]
    ds_write_b64 v125, v[46:47] offset:0
    v_mfma_f32_16x16x32_bf16 v[92:95], a[240:243], v[76:79], 0
    v_mul_f32 v34, v34, v84
    v_mul_f32 v35, v35, v84
    v_mfma_f32_16x16x32_bf16 v[92:95], a[244:247], v[68:71], v[92:95]
    ds_read_b128 v[96:99], v3 offset:0
    v_cvt_pk_bf16_f32 v1, v34, v35
    v_mfma_f32_16x16x32_bf16 v[92:95], a[248:251], v[8:11], v[92:95]
    ds_write_b64 v22, v[0:1] offset:0
    v_mfma_f32_16x16x32_bf16 v[92:95], a[252:255], v[64:67], v[92:95]
    v_mul_f32 v85, s43, v85
    v_mul_f32 v48, v48, v85
    v_mfma_f32_16x16x32_bf16 v[92:95], v[224:227], v[28:31], v[92:95]
    ds_read_b128 v[88:91], v2 offset:0
    v_mul_f32 v49, v49, v85
    v_mfma_f32_16x16x32_bf16 v[92:95], v[228:231], v[24:27], v[92:95]
    ds_read_b128 v[60:63], v3 offset:128
    v_cvt_pk_bf16_f32 v0, v48, v49
    v_mfma_f32_16x16x32_bf16 v[72:75], v[232:235], v[76:79], 0
    ds_read_b128 v[40:43], v2 offset:128
    v_mul_f32 v50, v50, v85
    v_mfma_f32_16x16x32_bf16 v[72:75], v[236:239], v[68:71], v[72:75]
    ds_read_b128 v[32:35], v3 offset:256
    v_mul_f32 v51, v51, v85
    v_mfma_f32_16x16x32_bf16 v[72:75], v[240:243], v[8:11], v[72:75]
    ds_read_b128 v[8:11], v2 offset:256
    v_cvt_pk_bf16_f32 v1, v50, v51
    v_mfma_f32_16x16x32_bf16 v[72:75], v[244:247], v[64:67], v[72:75]
    v_rsq_f32 v86, v86
    v_mfma_f32_16x16x32_bf16 v[72:75], v[248:251], v[28:31], v[72:75]
    v_mul_f32 v86, s43, v86
    v_mul_f32 v12, v12, v86
    v_mfma_f32_16x16x32_bf16 v[72:75], v[252:255], v[24:27], v[72:75]
    s_waitcnt lgkmcnt(5)
    v_mul_f32 v13, v13, v86
    v_cvt_pk_bf16_f32 v12, v12, v13
    v_mfma_f32_16x16x32_bf16 v[24:27], a[216:219], v[96:99], 0
    s_waitcnt lgkmcnt(4)
    v_mul_f32 v14, v14, v86
    v_mul_f32 v15, v15, v86
    v_cvt_pk_bf16_f32 v13, v14, v15
    v_mfma_f32_16x16x32_bf16 v[24:27], a[220:223], v[88:91], v[24:27]
    s_waitcnt lgkmcnt(3)
    ds_read_b128 v[80:83], v3 offset:3072
    ds_read_b128 v[76:79], v2 offset:3072
    v_mfma_f32_16x16x32_bf16 v[24:27], a[224:227], v[60:63], v[24:27]
    s_waitcnt lgkmcnt(4)
    ds_read_b128 v[68:71], v3 offset:3200
    v_mul_f32 v16, v16, v86
    v_mfma_f32_16x16x32_bf16 v[24:27], a[228:231], v[40:43], v[24:27]
    s_waitcnt lgkmcnt(4)
    ds_read_b128 v[64:67], v2 offset:3200
    v_mul_f32 v17, v17, v86
    v_mfma_f32_16x16x32_bf16 v[24:27], a[232:235], v[32:35], v[24:27]
    s_waitcnt lgkmcnt(4)
    ds_read_b128 v[48:51], v3 offset:3328
    v_cvt_pk_bf16_f32 v14, v16, v17
    v_mfma_f32_16x16x32_bf16 v[24:27], a[236:239], v[8:11], v[24:27]
    ds_read_b128 v[28:31], v2 offset:3328
    v_mul_f32 v18, v18, v86
    v_mfma_f32_16x16x32_bf16 v[36:39], a[240:243], v[96:99], 0
    v_mul_f32 v19, v19, v86
    v_cvt_pk_bf16_f32 v15, v18, v19
    v_mfma_f32_16x16x32_bf16 v[36:39], a[244:247], v[88:91], v[36:39]
    ds_write_b128 v44, v[12:15] offset:3072
    v_mfma_f32_16x16x32_bf16 v[36:39], a[248:251], v[60:63], v[36:39]
    v_mul_f32 v56, v56, v86
    v_mul_f32 v57, v57, v86
    v_mfma_f32_16x16x32_bf16 v[36:39], a[252:255], v[40:43], v[36:39]
    v_cvt_pk_bf16_f32 v2, v56, v57
    v_mul_f32 v58, v58, v86
    v_mfma_f32_16x16x32_bf16 v[36:39], v[224:227], v[32:35], v[36:39]
    v_mul_f32 v59, v59, v86
    v_cvt_pk_bf16_f32 v3, v58, v59
    v_mfma_f32_16x16x32_bf16 v[36:39], v[228:231], v[8:11], v[36:39]
    ds_write_b64 v22, v[2:3] offset:3072
    v_mfma_f32_16x16x32_bf16 v[16:19], v[232:235], v[96:99], 0
    v_fma_f32 v135, v24, v24, s42
    v_fmac_f32 v135, v25, v25
    v_mfma_f32_16x16x32_bf16 v[16:19], v[236:239], v[88:91], v[16:19]
    v_fmac_f32 v135, v26, v26
    v_fmac_f32 v135, v27, v27
    v_mfma_f32_16x16x32_bf16 v[16:19], v[240:243], v[60:63], v[16:19]
    v_fmac_f32 v135, v36, v36
    v_fmac_f32 v135, v37, v37
    v_mfma_f32_16x16x32_bf16 v[16:19], v[244:247], v[40:43], v[16:19]
    v_fmac_f32 v135, v38, v38
    v_fmac_f32 v135, v39, v39
    v_mfma_f32_16x16x32_bf16 v[16:19], v[248:251], v[32:35], v[16:19]
    v_mul_f32 v108, v108, v85
    v_mul_f32 v109, v109, v85
    v_mfma_f32_16x16x32_bf16 v[16:19], v[252:255], v[8:11], v[16:19]
    s_waitcnt lgkmcnt(1)
    v_cvt_pk_bf16_f32 v2, v108, v109
    v_mul_f32 v110, v110, v85
    v_mfma_f32_16x16x32_bf16 v[8:11], a[216:219], v[80:83], 0
    v_mul_f32 v111, v111, v85
    v_cvt_pk_bf16_f32 v3, v110, v111
    v_mfma_f32_16x16x32_bf16 v[8:11], a[220:223], v[76:79], v[8:11]
    ds_write_b128 v44, v[0:3] offset:1536
    v_mfma_f32_16x16x32_bf16 v[8:11], a[224:227], v[68:71], v[8:11]
    v_fmac_f32 v135, v16, v16
    v_fmac_f32 v135, v17, v17
    v_mfma_f32_16x16x32_bf16 v[8:11], a[228:231], v[64:67], v[8:11]
    ds_read_b128 v[32:35], v23
    v_fmac_f32 v135, v18, v18
    v_mfma_f32_16x16x32_bf16 v[8:11], a[232:235], v[48:51], v[8:11]
    ds_read_b128 v[0:3], v23 offset:16
    v_fmac_f32 v135, v19, v19
    v_mfma_f32_16x16x32_bf16 v[8:11], a[236:239], v[28:31], v[8:11]
    ds_read_b64 v[40:41], v23 offset:56
    ds_read_b128 v[42:45], v23 offset:64
    v_mfma_f32_16x16x32_bf16 v[60:63], a[240:243], v[80:83], 0
    v_mul_f32 v52, v52, v85
    v_mul_f32 v53, v53, v85
    v_mfma_f32_16x16x32_bf16 v[60:63], a[244:247], v[76:79], v[60:63]
    v_cvt_pk_bf16_f32 v46, v52, v53
    v_mul_f32 v54, v54, v85
    v_mfma_f32_16x16x32_bf16 v[60:63], a[248:251], v[68:71], v[60:63]
    v_mul_f32 v55, v55, v85
    v_cvt_pk_bf16_f32 v47, v54, v55
    v_mfma_f32_16x16x32_bf16 v[60:63], a[252:255], v[64:67], v[60:63]
    ds_write_b64 v22, v[46:47] offset:1536
    v_mfma_f32_16x16x32_bf16 v[60:63], v[224:227], v[48:51], v[60:63]
    v_fma_f32 v23, v8, v8, s42
    v_fmac_f32 v23, v9, v9
    v_mfma_f32_16x16x32_bf16 v[60:63], v[228:231], v[28:31], v[60:63]
    v_fmac_f32 v23, v10, v10
    v_fmac_f32 v23, v11, v11
    v_mfma_f32_16x16x32_bf16 v[12:15], v[232:235], v[80:83], 0
    s_nop 0
    v_fma_f32 v22, v4, v4, s42
    v_fmac_f32 v22, v5, v5
    v_mfma_f32_16x16x32_bf16 v[12:15], v[236:239], v[76:79], v[12:15]
    s_nop 0
    v_fmac_f32 v23, v60, v60
    v_fmac_f32 v23, v61, v61
    v_mfma_f32_16x16x32_bf16 v[12:15], v[240:243], v[68:71], v[12:15]
    v_fmac_f32 v23, v62, v62
    v_fmac_f32 v23, v63, v63
    v_mfma_f32_16x16x32_bf16 v[12:15], v[244:247], v[64:67], v[12:15]
    v_fmac_f32 v22, v6, v6
    v_fmac_f32 v22, v7, v7
    v_mfma_f32_16x16x32_bf16 v[12:15], v[248:251], v[48:51], v[12:15]
    v_fmac_f32 v22, v92, v92
    v_fmac_f32 v22, v93, v93
    v_mfma_f32_16x16x32_bf16 v[12:15], v[252:255], v[28:31], v[12:15]
    s_waitcnt lgkmcnt(0)
    v_fmac_f32 v22, v94, v94
    v_fmac_f32 v22, v95, v95
    v_mfma_f32_16x16x32_bf16 v[28:31], v[220:223], v[32:35], 0
    v_fmac_f32 v22, v72, v72
    v_fmac_f32 v22, v73, v73
    v_mfma_f32_16x16x32_bf16 v[28:31], v[220:223], v[0:3], v[28:31]
    s_nop 0
    v_fmac_f32 v23, v12, v12
    v_fmac_f32 v23, v13, v13
    v_fmac_f32 v23, v14, v14
    v_fmac_f32 v23, v15, v15
    v_cvt_pk_bf16_f32 v23, v23, v23
    v_fmac_f32 v22, v74, v74
    v_fmac_f32 v22, v75, v75
    v_cvt_pk_bf16_f32 v22, v135, v22
    ds_write_b64 v132, v[22:23] offset:2048
    v_rcp_f32 v28, v28
    v_lshlrev_b32 v135, 16, v40
    v_and_b32 v40, 0xffff0000, v40
    v_mul_f32 v135, v135, v28
    v_mul_f32 v40, v40, v28
    v_cvt_pk_bf16_f32 v0, v135, v40
    v_lshlrev_b32 v40, 16, v41
    v_and_b32 v41, 0xffff0000, v41
    v_mul_f32 v40, v40, v28
    v_mul_f32 v41, v41, v28
    v_cvt_pk_bf16_f32 v1, v40, v41
    v_lshlrev_b32 v135, 16, v42
    v_and_b32 v42, 0xffff0000, v42
    v_mul_f32 v135, v135, v28
    v_mul_f32 v42, v42, v28
    v_cvt_pk_bf16_f32 v2, v135, v42
    v_lshlrev_b32 v3, 16, v43
    v_and_b32 v43, 0xffff0000, v43
    v_mul_f32 v3, v3, v28
    v_mul_f32 v43, v43, v28
    v_cvt_pk_bf16_f32 v3, v3, v43
    v_lshlrev_b32 v135, 16, v44
    v_and_b32 v44, 0xffff0000, v44
    v_mul_f32 v135, v135, v28
    v_mul_f32 v44, v44, v28
    v_cvt_pk_bf16_f32 v22, v135, v44
    v_lshlrev_b32 v23, 16, v45
    v_and_b32 v45, 0xffff0000, v45
    v_mul_f32 v23, v23, v28
    v_mul_f32 v45, v45, v28
    v_cvt_pk_bf16_f32 v23, v23, v45
    s_waitcnt lgkmcnt(0)
    s_barrier
    ds_write_b128 v133, v[0:3] offset:1536
    v_add_u32 v135, s92, v131
    ds_write_b64 v125, v[22:23] offset:1536
    ds_read_b128 v[48:51], v131 offset:2048
    ds_read_b128 v[44:47], v131 offset:3072
    ds_read_b128 v[0:3], v20 offset:0
    ds_read_b128 v[40:43], v20 offset:1024
    ds_read_b128 v[104:107], v20 offset:2048
    ds_read_b128 v[100:103], v20 offset:3072
    ds_read_b128 v[28:31], v20 offset:4096
    s_waitcnt lgkmcnt(7)
    s_barrier
    s_waitcnt lgkmcnt(6)
    v_mfma_f32_16x16x32_bf16 v[32:35], v[216:219], v[48:51], 0
    s_waitcnt lgkmcnt(5)
    ds_read_b128 v[96:99], v139 offset:0
    ds_read_b128 v[88:91], v138 offset:0
    v_mfma_f32_16x16x32_bf16 v[32:35], v[216:219], v[44:47], v[32:35]
    s_waitcnt lgkmcnt(6)
    ds_read_b128 v[84:87], v139 offset:128
    s_nop 0
    buffer_store_dwordx4 v[0:3], v130, s[28:31], s59 offen sc1
    s_nop 0
    ds_read_b128 v[80:83], v138 offset:128
    s_nop 1
    v_rsq_f32 v32, v32
    ds_read_b128 v[76:79], v139 offset:256
    ds_read_b128 v[0:3], v138 offset:256
    v_mul_f32 v32, s43, v32
    v_mul_f32 v24, v24, v32
    v_mul_f32 v25, v25, v32
    ds_read_b128 v[68:71], v139 offset:1536
    s_waitcnt lgkmcnt(8)
    buffer_store_dwordx4 v[40:43], v129, s[28:31], s59 offen sc1
    ds_read_b128 v[64:67], v138 offset:1536
    v_cvt_pk_bf16_f32 v48, v24, v25
    v_mul_f32 v26, v26, v32
    v_mul_f32 v27, v27, v32
    v_cvt_pk_bf16_f32 v49, v26, v27
    v_mul_f32 v36, v36, v32
    ds_read_b128 v[56:59], v139 offset:1664
    ds_read_b128 v[52:55], v138 offset:1664
    v_mul_f32 v37, v37, v32
    s_waitcnt lgkmcnt(8)
    v_mfma_f32_16x16x32_bf16 v[24:27], a[216:219], v[96:99], 0
    ds_read_b128 v[44:47], v139 offset:1792
    v_cvt_pk_bf16_f32 v50, v36, v37
    v_mfma_f32_16x16x32_bf16 v[24:27], a[220:223], v[88:91], v[24:27]
    s_waitcnt lgkmcnt(7)
    ds_read_b128 v[40:43], v138 offset:1792
    v_mul_f32 v38, v38, v32
    v_mfma_f32_16x16x32_bf16 v[24:27], a[224:227], v[84:87], v[24:27]
    buffer_store_dwordx4 v[104:107], v128, s[28:31], s59 offen sc1
    v_mul_f32 v39, v39, v32
    v_cvt_pk_bf16_f32 v51, v38, v39
    v_mul_f32 v16, v16, v32
    v_mul_f32 v17, v17, v32
    v_mfma_f32_16x16x32_bf16 v[24:27], a[228:231], v[80:83], v[24:27]
    s_waitcnt lgkmcnt(6)
    v_cvt_pk_bf16_f32 v16, v16, v17
    v_mul_f32 v18, v18, v32
    v_mfma_f32_16x16x32_bf16 v[24:27], a[232:235], v[76:79], v[24:27]
    v_rsq_f32 v33, v33
    v_mfma_f32_16x16x32_bf16 v[24:27], a[236:239], v[0:3], v[24:27]
    s_nop 0
    v_mul_f32 v19, v19, v32
    v_cvt_pk_bf16_f32 v17, v18, v19
    v_mfma_f32_16x16x32_bf16 v[36:39], a[240:243], v[96:99], 0
    s_nop 0
    buffer_store_dwordx4 v[100:103], v127, s[28:31], s59 offen sc1
    v_mul_f32 v33, s43, v33
    v_mul_f32 v4, v4, v33
    v_fma_f32 v138, v24, v24, s42
    v_fmac_f32 v138, v25, v25
    v_mfma_f32_16x16x32_bf16 v[36:39], a[244:247], v[88:91], v[36:39]
    v_fmac_f32 v138, v26, v26
    v_fmac_f32 v138, v27, v27
    v_mfma_f32_16x16x32_bf16 v[36:39], a[248:251], v[84:87], v[36:39]
    v_mul_f32 v5, v5, v33
    v_cvt_pk_bf16_f32 v4, v4, v5
    v_mfma_f32_16x16x32_bf16 v[36:39], a[252:255], v[80:83], v[36:39]
    v_mul_f32 v6, v6, v33
    v_mul_f32 v7, v7, v33
    v_mfma_f32_16x16x32_bf16 v[36:39], v[224:227], v[76:79], v[36:39]
    buffer_store_dwordx4 v[28:31], v126, s[28:31], s59 offen sc1
    v_cvt_pk_bf16_f32 v5, v6, v7
    v_mul_f32 v92, v92, v33
    v_mul_f32 v93, v93, v33
    v_cvt_pk_bf16_f32 v6, v92, v93
    v_mfma_f32_16x16x32_bf16 v[36:39], v[228:231], v[0:3], v[36:39]
    v_mul_f32 v94, v94, v33
    v_mul_f32 v95, v95, v33
    v_mfma_f32_16x16x32_bf16 v[28:31], v[232:235], v[96:99], 0
    s_nop 0
    v_cvt_pk_bf16_f32 v7, v94, v95
    v_mul_f32 v72, v72, v33
    v_mfma_f32_16x16x32_bf16 v[28:31], v[236:239], v[88:91], v[28:31]
    s_nop 0
    v_fmac_f32 v138, v36, v36
    v_fmac_f32 v138, v37, v37
    v_mfma_f32_16x16x32_bf16 v[28:31], v[240:243], v[84:87], v[28:31]
    v_fmac_f32 v138, v38, v38
    v_fmac_f32 v138, v39, v39
    v_mfma_f32_16x16x32_bf16 v[28:31], v[244:247], v[80:83], v[28:31]
    v_mul_f32 v73, v73, v33
    v_cvt_pk_bf16_f32 v22, v72, v73
    v_mfma_f32_16x16x32_bf16 v[28:31], v[248:251], v[76:79], v[28:31]
    v_mul_f32 v74, v74, v33
    v_mul_f32 v75, v75, v33
    v_mfma_f32_16x16x32_bf16 v[28:31], v[252:255], v[0:3], v[28:31]
    s_waitcnt lgkmcnt(0)
    v_rsq_f32 v34, v34
    v_mfma_f32_16x16x32_bf16 v[0:3], a[216:219], v[68:71], 0
    v_cvt_pk_bf16_f32 v23, v74, v75
    v_mul_f32 v34, s43, v34
    v_mfma_f32_16x16x32_bf16 v[0:3], a[220:223], v[64:67], v[0:3]
    ds_write_b128 v137, v[48:51] offset:0
    v_mfma_f32_16x16x32_bf16 v[0:3], a[224:227], v[56:59], v[0:3]
    v_fmac_f32 v138, v28, v28
    v_fmac_f32 v138, v29, v29
    v_mfma_f32_16x16x32_bf16 v[0:3], a[228:231], v[52:55], v[0:3]
    ds_write_b64 v136, v[16:17] offset:0
    v_mfma_f32_16x16x32_bf16 v[0:3], a[232:235], v[44:47], v[0:3]
    v_fmac_f32 v138, v30, v30
    v_fmac_f32 v138, v31, v31
    v_mfma_f32_16x16x32_bf16 v[0:3], a[236:239], v[40:43], v[0:3]
    ds_write_b128 v137, v[4:7] offset:1536
    v_mfma_f32_16x16x32_bf16 v[16:19], a[240:243], v[68:71], 0
    v_mul_f32 v8, v8, v34
    v_mul_f32 v9, v9, v34
    v_mfma_f32_16x16x32_bf16 v[16:19], a[244:247], v[64:67], v[16:19]
    ds_write_b64 v136, v[22:23] offset:1536
    v_mfma_f32_16x16x32_bf16 v[16:19], a[248:251], v[56:59], v[16:19]
    v_cvt_pk_bf16_f32 v48, v8, v9
    v_mul_f32 v10, v10, v34
    v_mfma_f32_16x16x32_bf16 v[16:19], a[252:255], v[52:55], v[16:19]
    ds_read_b128 v[4:7], v135 offset:6144
    v_mul_f32 v11, v11, v34
    v_mfma_f32_16x16x32_bf16 v[16:19], v[224:227], v[44:47], v[16:19]
    v_cvt_pk_bf16_f32 v49, v10, v11
    v_mul_f32 v60, v60, v34
    v_mfma_f32_16x16x32_bf16 v[16:19], v[228:231], v[40:43], v[16:19]
    v_mul_f32 v61, v61, v34
    v_cvt_pk_bf16_f32 v50, v60, v61
    v_mfma_f32_16x16x32_bf16 v[8:11], v[232:235], v[68:71], 0
    v_mul_f32 v62, v62, v34
    v_mul_f32 v63, v63, v34
    v_mfma_f32_16x16x32_bf16 v[8:11], v[236:239], v[64:67], v[8:11]
    v_cvt_pk_bf16_f32 v51, v62, v63
    v_mul_f32 v12, v12, v34
    v_mfma_f32_16x16x32_bf16 v[8:11], v[240:243], v[56:59], v[8:11]
    ds_write_b128 v137, v[48:51] offset:3072
    v_mfma_f32_16x16x32_bf16 v[8:11], v[244:247], v[52:55], v[8:11]
    v_mul_f32 v13, v13, v34
    v_cvt_pk_bf16_f32 v22, v12, v13
    v_mfma_f32_16x16x32_bf16 v[8:11], v[248:251], v[44:47], v[8:11]
    v_mul_f32 v14, v14, v34
    v_mul_f32 v15, v15, v34
    v_mfma_f32_16x16x32_bf16 v[8:11], v[252:255], v[40:43], v[8:11]
    v_cvt_pk_bf16_f32 v23, v14, v15
    v_fma_f32 v135, v0, v0, s42
    v_fmac_f32 v135, v1, v1
    v_fmac_f32 v135, v2, v2
    ds_write_b64 v136, v[22:23] offset:3072
    v_fmac_f32 v135, v3, v3
    v_fmac_f32 v135, v16, v16
    v_fmac_f32 v135, v17, v17
    v_fmac_f32 v135, v18, v18
    v_fmac_f32 v135, v19, v19
    v_fmac_f32 v135, v8, v8
    v_fmac_f32 v135, v9, v9
    v_fmac_f32 v135, v10, v10
    v_fmac_f32 v135, v11, v11
    v_cvt_pk_bf16_f32 v20, v138, v135
    ds_write_b64 v132, v[20:21] offset:4096
    s_waitcnt lgkmcnt(2)
    v_lshrrev_b32 v132, 0, v7
    v_lshrrev_b32 v132, v132, s64
    v_and_b32 v132, 1, v132
    v_cmp_eq_u32 vcc, 1, v132
    v_lshrrev_b32 v132, 8, v7
    v_lshrrev_b32 v132, v132, s64
    v_cndmask_b32 v4, 2.0, v4, vcc
    v_and_b32 v132, 1, v132
    v_cmp_eq_u32 vcc, 1, v132
    v_lshrrev_b32 v7, 16, v7
    v_lshrrev_b32 v7, v7, s64
    v_cndmask_b32 v5, 2.0, v5, vcc
    v_and_b32 v7, 1, v7
    v_cmp_eq_u32 vcc, 1, v7
    s_nop 1
    v_cndmask_b32 v6, 2.0, v6, vcc
    s_waitcnt lgkmcnt(1)
    s_barrier
    ds_read_b128 v[52:55], v134 offset:0
    ds_read_b128 v[12:15], v134 offset:1024
    ds_read_b128 v[40:43], v134 offset:2048
    s_waitcnt lgkmcnt(3)
    s_barrier
    ds_read_b128 v[32:35], v134 offset:3072
    ds_read_b128 v[20:23], v134 offset:4096
    ds_read_b128 v[48:51], v131 offset:4096
    ds_read_b128 v[44:47], v131 offset:5120
    s_waitcnt lgkmcnt(6)
    buffer_store_dwordx4 v[52:55], v130, s[28:31], s58 offen sc1
    s_waitcnt lgkmcnt(1)
    buffer_store_dwordx4 v[12:15], v129, s[28:31], s58 offen sc1
    s_nop 1
    v_mfma_f32_16x16x32_bf16 v[12:15], v[216:219], v[48:51], 0
    s_waitcnt lgkmcnt(0)
    v_mfma_f32_16x16x32_bf16 v[12:15], v[216:219], v[44:47], v[12:15]
    s_nop 5
    buffer_store_dwordx4 v[40:43], v128, s[28:31], s58 offen sc1
    s_nop 0
    v_rsq_f32 v12, v12
    s_nop 0
    v_mul_f32 v12, s43, v12
    v_mul_f32 v24, v24, v12
    v_mul_f32 v25, v25, v12
    v_cvt_pk_bf16_f32 v24, v24, v25
    v_mul_f32 v26, v26, v12
    v_mul_f32 v27, v27, v12
    v_cvt_pk_bf16_f32 v25, v26, v27
    v_mul_f32 v36, v36, v12
    v_mul_f32 v37, v37, v12
    v_cvt_pk_bf16_f32 v26, v36, v37
    v_mul_f32 v38, v38, v12
    buffer_store_dwordx4 v[32:35], v127, s[28:31], s58 offen sc1
    v_mul_f32 v39, v39, v12
    v_cvt_pk_bf16_f32 v27, v38, v39
    v_mul_f32 v28, v28, v12
    v_mul_f32 v29, v29, v12
    v_cvt_pk_bf16_f32 v14, v28, v29
    v_mul_f32 v30, v30, v12
    v_mul_f32 v31, v31, v12
    v_cvt_pk_bf16_f32 v15, v30, v31
    ds_write_b128 v133, v[24:27] offset:0
    buffer_store_dwordx4 v[20:23], v126, s[28:31], s58 offen sc1
    v_rsq_f32 v13, v13
    s_nop 0
    v_mul_f32 v13, s43, v13
    v_mul_f32 v0, v0, v13
    v_mul_f32 v1, v1, v13
    ds_write_b64 v125, v[14:15] offset:0
    v_cvt_pk_bf16_f32 v0, v0, v1
    v_mul_f32 v2, v2, v13
    v_mul_f32 v3, v3, v13
    v_cvt_pk_bf16_f32 v1, v2, v3
    v_mul_f32 v16, v16, v13
    v_mul_f32 v17, v17, v13
    v_cvt_pk_bf16_f32 v2, v16, v17
    v_mul_f32 v18, v18, v13
    v_mul_f32 v19, v19, v13
    v_cvt_pk_bf16_f32 v3, v18, v19
    v_mul_f32 v8, v8, v13
    v_mul_f32 v9, v9, v13
    v_cvt_pk_bf16_f32 v126, v8, v9
    v_mul_f32 v10, v10, v13
    v_mul_f32 v11, v11, v13
    v_cvt_pk_bf16_f32 v127, v10, v11
    ds_write_b128 v133, v[0:3] offset:1536
    ds_write_b64 v125, v[126:127] offset:1536
    s_waitcnt lgkmcnt(0)
    s_barrier
    ds_read_b128 v[12:15], v124 offset:0
    ds_read_b128 v[8:11], v124 offset:1024
    ds_read_b128 v[0:3], v124 offset:2048
    s_waitcnt lgkmcnt(1)
    buffer_store_dwordx4 v[12:15], v4, s[28:31], 0 offen sc1
    buffer_store_dwordx4 v[8:11], v5, s[28:31], 0 offen sc1
    s_waitcnt lgkmcnt(0)
    buffer_store_dwordx4 v[0:3], v6, s[28:31], 0 offen sc1
    s_endpgm
L_bndF:
    s_movk_i32 s73, 24
    s_sub_u32 s70, s70, 20
    s_cmp_lt_u32 s2, 247
    s_cbranch_scc1 L_bndrF
    s_movk_i32 s73, 20
    s_movk_i32 s71, 18
    s_movk_i32 s70, -20
    s_mov_b32 s74, 0
    s_cmp_lt_u32 s2, 251
    s_cbranch_scc1 L_bndcF
    s_sub_u32 s94, s2, 251
    s_mul_i32 s69, s94, 18
    s_mov_b32 s74, 25239312
    s_sub_u32 s93, s93, 1373568
    v_cmp_le_u32 vcc, 4, v10
    v_add_u32 v34, 98896896, v130
    v_subrev_u32 v35, 1373568, v130
    v_cndmask_b32 v130, v34, v35, vcc
    v_cmp_le_u32 vcc, 4, v131
    v_add_u32 v34, 98896896, v129
    v_subrev_u32 v35, 1373568, v129
    v_cndmask_b32 v129, v34, v35, vcc
    v_cmp_le_u32 vcc, 4, v3
    v_add_u32 v34, 98896896, v128
    v_subrev_u32 v35, 1373568, v128
    v_cndmask_b32 v128, v34, v35, vcc
    v_cmp_le_u32 vcc, 4, v0
    v_add_u32 v34, 98896896, v127
    v_subrev_u32 v35, 1373568, v127
    v_cndmask_b32 v127, v34, v35, vcc
    v_cmp_le_u32 vcc, 4, v115
    v_add_u32 v34, 98896896, v126
    v_subrev_u32 v35, 1373568, v126
    v_cndmask_b32 v126, v34, v35, vcc
    s_cmp_lt_u32 s2, 255
    s_cbranch_scc1 L_bndrF
L_bndcF:
    s_sub_u32 s94, s2, 247
    s_mul_i32 s69, s94, 18
    s_mov_b32 s62, 1373568
    s_add_u32 s74, s74, 345744
    s_sub_u32 s93, s93, 2688
    v_mad_i32_i24 v34, v10, -7, v11
    v_cmp_le_u32 vcc, 4, v34
    v_add_u32 v34, 193536, v130
    v_subrev_u32 v35, 2688, v130
    v_cndmask_b32 v130, v34, v35, vcc
    v_mad_i32_i24 v34, v131, -7, v113
    v_cmp_le_u32 vcc, 4, v34
    v_add_u32 v34, 193536, v129
    v_subrev_u32 v35, 2688, v129
    v_cndmask_b32 v129, v34, v35, vcc
    v_mad_i32_i24 v34, v3, -7, v31
    v_cmp_le_u32 vcc, 4, v34
    v_add_u32 v34, 193536, v128
    v_subrev_u32 v35, 2688, v128
    v_cndmask_b32 v128, v34, v35, vcc
    v_mad_i32_i24 v34, v0, -7, v1
    v_cmp_le_u32 vcc, 4, v34
    v_add_u32 v34, 193536, v127
    v_subrev_u32 v35, 2688, v127
    v_cndmask_b32 v127, v34, v35, vcc
    v_mad_i32_i24 v34, v115, -7, v108
    v_cmp_le_u32 vcc, 4, v34
    v_add_u32 v34, 193536, v126
    v_subrev_u32 v35, 2688, v126
    v_cndmask_b32 v126, v34, v35, vcc
    s_cmp_eq_u32 s2, 255
    s_cselect_b32 s62, 0, s62
    s_cselect_b32 s69, 0, s69
    s_cselect_b32 s71, 2, s71
    s_branch L_bndrF
L_maskF:
    s_add_u32 s20, s20, s74
    s_addc_u32 s21, s21, 0
    s_mov_b32 s22, 4802
    s_mov_b32 s23, 0x20000
    s_mov_b32 s85, 0x3fb8aa3b
    s_waitcnt vmcnt(0)
    v_lshrrev_b32 v30, 2, v42
    v_add_u32 v30, 0, v30
    v_mul_u32_u24 v30, 98, v30
    v_mad_u32_u24 v31, v144, 24, v30
    buffer_load_ushort v109, v31, s[20:23], 0 offen offset:0
    buffer_load_ushort v153, v31, s[20:23], 0 offen offset:2
    buffer_load_ushort v68, v31, s[20:23], 0 offen offset:4
    buffer_load_ushort v148, v31, s[20:23], 0 offen offset:6
    buffer_load_ushort v152, v31, s[20:23], 0 offen offset:8
    buffer_load_ushort v145, v31, s[20:23], 0 offen offset:10
    buffer_load_ushort v143, v31, s[20:23], 0 offen offset:12
    buffer_load_ushort v108, v31, s[20:23], 0 offen offset:14
    buffer_load_ushort v149, v31, s[20:23], 0 offen offset:16
    buffer_load_ushort v159, v31, s[20:23], 0 offen offset:18
    buffer_load_ushort v43, v31, s[20:23], 0 offen offset:20
    buffer_load_ushort v69, v31, s[20:23], 0 offen offset:22
    buffer_load_ushort v157, v30, s[20:23], 0 offen offset:96
    s_waitcnt vmcnt(0)
    v_lshlrev_b32 v109, 16, v109
    v_fmac_f32 v204, s85, v109
    v_lshlrev_b32 v153, 16, v153
    v_fmac_f32 v205, s85, v153
    v_lshlrev_b32 v68, 16, v68
    v_fmac_f32 v206, s85, v68
    v_lshlrev_b32 v148, 16, v148
    v_fmac_f32 v207, s85, v148
    v_lshlrev_b32 v152, 16, v152
    v_fmac_f32 v200, s85, v152
    v_lshlrev_b32 v145, 16, v145
    v_fmac_f32 v201, s85, v145
    v_lshlrev_b32 v143, 16, v143
    v_fmac_f32 v202, s85, v143
    v_lshlrev_b32 v108, 16, v108
    v_fmac_f32 v203, s85, v108
    v_lshlrev_b32 v149, 16, v149
    v_fmac_f32 v196, s85, v149
    v_lshlrev_b32 v159, 16, v159
    v_fmac_f32 v197, s85, v159
    v_lshlrev_b32 v43, 16, v43
    v_fmac_f32 v198, s85, v43
    v_lshlrev_b32 v69, 16, v69
    v_fmac_f32 v199, s85, v69
    v_lshlrev_b32 v157, 16, v157
    v_fmac_f32 v208, s85, v157
    v_lshrrev_b32 v30, 2, v42
    v_add_u32 v30, 4, v30
    v_mul_u32_u24 v30, 98, v30
    v_mad_u32_u24 v31, v144, 24, v30
    buffer_load_ushort v109, v31, s[20:23], 0 offen offset:0
    buffer_load_ushort v153, v31, s[20:23], 0 offen offset:2
    buffer_load_ushort v68, v31, s[20:23], 0 offen offset:4
    buffer_load_ushort v148, v31, s[20:23], 0 offen offset:6
    buffer_load_ushort v152, v31, s[20:23], 0 offen offset:8
    buffer_load_ushort v145, v31, s[20:23], 0 offen offset:10
    buffer_load_ushort v143, v31, s[20:23], 0 offen offset:12
    buffer_load_ushort v108, v31, s[20:23], 0 offen offset:14
    buffer_load_ushort v149, v31, s[20:23], 0 offen offset:16
    buffer_load_ushort v159, v31, s[20:23], 0 offen offset:18
    buffer_load_ushort v43, v31, s[20:23], 0 offen offset:20
    buffer_load_ushort v69, v31, s[20:23], 0 offen offset:22
    buffer_load_ushort v157, v30, s[20:23], 0 offen offset:96
    s_waitcnt vmcnt(0)
    v_lshlrev_b32 v109, 16, v109
    v_fmac_f32 v192, s85, v109
    v_lshlrev_b32 v153, 16, v153
    v_fmac_f32 v193, s85, v153
    v_lshlrev_b32 v68, 16, v68
    v_fmac_f32 v194, s85, v68
    v_lshlrev_b32 v148, 16, v148
    v_fmac_f32 v195, s85, v148
    v_lshlrev_b32 v152, 16, v152
    v_fmac_f32 v188, s85, v152
    v_lshlrev_b32 v145, 16, v145
    v_fmac_f32 v189, s85, v145
    v_lshlrev_b32 v143, 16, v143
    v_fmac_f32 v190, s85, v143
    v_lshlrev_b32 v108, 16, v108
    v_fmac_f32 v191, s85, v108
    v_lshlrev_b32 v149, 16, v149
    v_fmac_f32 v184, s85, v149
    v_lshlrev_b32 v159, 16, v159
    v_fmac_f32 v185, s85, v159
    v_lshlrev_b32 v43, 16, v43
    v_fmac_f32 v186, s85, v43
    v_lshlrev_b32 v69, 16, v69
    v_fmac_f32 v187, s85, v69
    v_lshlrev_b32 v157, 16, v157
    v_fmac_f32 v209, s85, v157
    v_lshrrev_b32 v30, 2, v42
    v_add_u32 v30, 8, v30
    v_mul_u32_u24 v30, 98, v30
    v_mad_u32_u24 v31, v144, 24, v30
    buffer_load_ushort v109, v31, s[20:23], 0 offen offset:0
    buffer_load_ushort v153, v31, s[20:23], 0 offen offset:2
    buffer_load_ushort v68, v31, s[20:23], 0 offen offset:4
    buffer_load_ushort v148, v31, s[20:23], 0 offen offset:6
    buffer_load_ushort v152, v31, s[20:23], 0 offen offset:8
    buffer_load_ushort v145, v31, s[20:23], 0 offen offset:10
    buffer_load_ushort v143, v31, s[20:23], 0 offen offset:12
    buffer_load_ushort v108, v31, s[20:23], 0 offen offset:14
    buffer_load_ushort v149, v31, s[20:23], 0 offen offset:16
    buffer_load_ushort v159, v31, s[20:23], 0 offen offset:18
    buffer_load_ushort v43, v31, s[20:23], 0 offen offset:20
    buffer_load_ushort v69, v31, s[20:23], 0 offen offset:22
    buffer_load_ushort v157, v30, s[20:23], 0 offen offset:96
    s_waitcnt vmcnt(0)
    v_lshlrev_b32 v109, 16, v109
    v_fmac_f32 v180, s85, v109
    v_lshlrev_b32 v153, 16, v153
    v_fmac_f32 v181, s85, v153
    v_lshlrev_b32 v68, 16, v68
    v_fmac_f32 v182, s85, v68
    v_lshlrev_b32 v148, 16, v148
    v_fmac_f32 v183, s85, v148
    v_lshlrev_b32 v152, 16, v152
    v_fmac_f32 v176, s85, v152
    v_lshlrev_b32 v145, 16, v145
    v_fmac_f32 v177, s85, v145
    v_lshlrev_b32 v143, 16, v143
    v_fmac_f32 v178, s85, v143
    v_lshlrev_b32 v108, 16, v108
    v_fmac_f32 v179, s85, v108
    v_lshlrev_b32 v149, 16, v149
    v_fmac_f32 v172, s85, v149
    v_lshlrev_b32 v159, 16, v159
    v_fmac_f32 v173, s85, v159
    v_lshlrev_b32 v43, 16, v43
    v_fmac_f32 v174, s85, v43
    v_lshlrev_b32 v69, 16, v69
    v_fmac_f32 v175, s85, v69
    v_lshlrev_b32 v157, 16, v157
    v_fmac_f32 v210, s85, v157
    v_lshrrev_b32 v30, 2, v42
    v_lshl_add_u32 v30, v144, 2, v30
    v_cmp_gt_u32 vcc, 3, v144
    v_mov_b32 v31, 48
    s_nop 1
    v_cndmask_b32 v30, v31, v30, vcc
    v_add_u32 v30, 2352, v30
    v_lshlrev_b32 v30, 1, v30
    buffer_load_ushort v109, v30, s[20:23], 0 offen
    s_waitcnt vmcnt(0)
    v_lshlrev_b32 v109, 16, v109
    v_fmac_f32 v211, s85, v109
    s_branch L_nomaskF
L_atomF0:
    v_mov_b32 v124, 0x800000
    buffer_atomic_add v124, v131, s[8:11], 0 offen sc0 sc1
    s_branch L_atomrF0
L_bndS:
    s_movk_i32 s73, 24
    s_sub_u32 s70, s70, 20
    s_cmp_lt_u32 s2, 247
    s_cbranch_scc1 L_bndrS
    s_movk_i32 s73, 20
    s_movk_i32 s71, 18
    s_movk_i32 s70, -20
    s_mov_b32 s74, 0
    s_cmp_lt_u32 s2, 251
    s_cbranch_scc1 L_bndcS
    s_sub_u32 s94, s2, 251
    s_mul_i32 s69, s94, 18
    s_mov_b32 s74, 25239312
    s_sub_u32 s93, s93, 1373568
    v_cmp_le_u32 vcc, 4, v38
    v_add_u32 v148, 98896896, v130
    v_subrev_u32 v149, 1373568, v130
    v_cndmask_b32 v130, v148, v149, vcc
    v_cmp_le_u32 vcc, 4, v72
    v_add_u32 v148, 98896896, v129
    v_subrev_u32 v149, 1373568, v129
    v_cndmask_b32 v129, v148, v149, vcc
    v_cmp_le_u32 vcc, 4, v125
    v_add_u32 v148, 98896896, v128
    v_subrev_u32 v149, 1373568, v128
    v_cndmask_b32 v128, v148, v149, vcc
    v_cmp_le_u32 vcc, 4, v19
    v_add_u32 v148, 98896896, v127
    v_subrev_u32 v149, 1373568, v127
    v_cndmask_b32 v127, v148, v149, vcc
    v_cmp_le_u32 vcc, 4, v9
    v_add_u32 v148, 98896896, v126
    v_subrev_u32 v149, 1373568, v126
    v_cndmask_b32 v126, v148, v149, vcc
    s_cmp_lt_u32 s2, 255
    s_cbranch_scc1 L_bndrS
L_bndcS:
    s_sub_u32 s94, s2, 247
    s_mul_i32 s69, s94, 18
    s_mov_b32 s62, 1373568
    s_add_u32 s74, s74, 345744
    s_sub_u32 s93, s93, 2688
    v_mad_i32_i24 v148, v38, -7, v8
    v_cmp_le_u32 vcc, 4, v148
    v_add_u32 v148, 193536, v130
    v_subrev_u32 v149, 2688, v130
    v_cndmask_b32 v130, v148, v149, vcc
    v_mad_i32_i24 v148, v72, -7, v131
    v_cmp_le_u32 vcc, 4, v148
    v_add_u32 v148, 193536, v129
    v_subrev_u32 v149, 2688, v129
    v_cndmask_b32 v129, v148, v149, vcc
    v_mad_i32_i24 v148, v125, -7, v26
    v_cmp_le_u32 vcc, 4, v148
    v_add_u32 v148, 193536, v128
    v_subrev_u32 v149, 2688, v128
    v_cndmask_b32 v128, v148, v149, vcc
    v_mad_i32_i24 v148, v19, -7, v124
    v_cmp_le_u32 vcc, 4, v148
    v_add_u32 v148, 193536, v127
    v_subrev_u32 v149, 2688, v127
    v_cndmask_b32 v127, v148, v149, vcc
    v_mad_i32_i24 v148, v9, -7, v39
    v_cmp_le_u32 vcc, 4, v148
    v_add_u32 v148, 193536, v126
    v_subrev_u32 v149, 2688, v126
    v_cndmask_b32 v126, v148, v149, vcc
    s_cmp_eq_u32 s2, 255
    s_cselect_b32 s62, 0, s62
    s_cselect_b32 s69, 0, s69
    s_cselect_b32 s71, 2, s71
    s_branch L_bndrS
L_maskS:
    s_add_u32 s20, s20, s74
    s_addc_u32 s21, s21, 0
    s_mov_b32 s22, 4802
    s_mov_b32 s23, 0x20000
    s_mov_b32 s85, 0x3fb8aa3b
    s_waitcnt vmcnt(0)
    v_lshrrev_b32 v154, 2, v150
    v_add_u32 v154, 0, v154
    v_mul_u32_u24 v154, 98, v154
    v_mad_u32_u24 v155, v151, 24, v154
    buffer_load_ushort v41, v155, s[20:23], 0 offen offset:0
    buffer_load_ushort v142, v155, s[20:23], 0 offen offset:2
    buffer_load_ushort v160, v155, s[20:23], 0 offen offset:4
    buffer_load_ushort v156, v155, s[20:23], 0 offen offset:6
    buffer_load_ushort v168, v155, s[20:23], 0 offen offset:8
    buffer_load_ushort v166, v155, s[20:23], 0 offen offset:10
    buffer_load_ushort v143, v155, s[20:23], 0 offen offset:12
    buffer_load_ushort v164, v155, s[20:23], 0 offen offset:14
    buffer_load_ushort v161, v155, s[20:23], 0 offen offset:16
    buffer_load_ushort v158, v155, s[20:23], 0 offen offset:18
    buffer_load_ushort v162, v155, s[20:23], 0 offen offset:20
    buffer_load_ushort v165, v155, s[20:23], 0 offen offset:22
    buffer_load_ushort v157, v154, s[20:23], 0 offen offset:96
    s_waitcnt vmcnt(0)
    v_lshlrev_b32 v41, 16, v41
    v_fmac_f32 v204, s85, v41
    v_lshlrev_b32 v142, 16, v142
    v_fmac_f32 v205, s85, v142
    v_lshlrev_b32 v160, 16, v160
    v_fmac_f32 v206, s85, v160
    v_lshlrev_b32 v156, 16, v156
    v_fmac_f32 v207, s85, v156
    v_lshlrev_b32 v168, 16, v168
    v_fmac_f32 v200, s85, v168
    v_lshlrev_b32 v166, 16, v166
    v_fmac_f32 v201, s85, v166
    v_lshlrev_b32 v143, 16, v143
    v_fmac_f32 v202, s85, v143
    v_lshlrev_b32 v164, 16, v164
    v_fmac_f32 v203, s85, v164
    v_lshlrev_b32 v161, 16, v161
    v_fmac_f32 v196, s85, v161
    v_lshlrev_b32 v158, 16, v158
    v_fmac_f32 v197, s85, v158
    v_lshlrev_b32 v162, 16, v162
    v_fmac_f32 v198, s85, v162
    v_lshlrev_b32 v165, 16, v165
    v_fmac_f32 v199, s85, v165
    v_lshlrev_b32 v157, 16, v157
    v_fmac_f32 v208, s85, v157
    v_lshrrev_b32 v154, 2, v150
    v_add_u32 v154, 4, v154
    v_mul_u32_u24 v154, 98, v154
    v_mad_u32_u24 v155, v151, 24, v154
    buffer_load_ushort v41, v155, s[20:23], 0 offen offset:0
    buffer_load_ushort v142, v155, s[20:23], 0 offen offset:2
    buffer_load_ushort v160, v155, s[20:23], 0 offen offset:4
    buffer_load_ushort v156, v155, s[20:23], 0 offen offset:6
    buffer_load_ushort v168, v155, s[20:23], 0 offen offset:8
    buffer_load_ushort v166, v155, s[20:23], 0 offen offset:10
    buffer_load_ushort v143, v155, s[20:23], 0 offen offset:12
    buffer_load_ushort v164, v155, s[20:23], 0 offen offset:14
    buffer_load_ushort v161, v155, s[20:23], 0 offen offset:16
    buffer_load_ushort v158, v155, s[20:23], 0 offen offset:18
    buffer_load_ushort v162, v155, s[20:23], 0 offen offset:20
    buffer_load_ushort v165, v155, s[20:23], 0 offen offset:22
    buffer_load_ushort v157, v154, s[20:23], 0 offen offset:96
    s_waitcnt vmcnt(0)
    v_lshlrev_b32 v41, 16, v41
    v_fmac_f32 v192, s85, v41
    v_lshlrev_b32 v142, 16, v142
    v_fmac_f32 v193, s85, v142
    v_lshlrev_b32 v160, 16, v160
    v_fmac_f32 v194, s85, v160
    v_lshlrev_b32 v156, 16, v156
    v_fmac_f32 v195, s85, v156
    v_lshlrev_b32 v168, 16, v168
    v_fmac_f32 v188, s85, v168
    v_lshlrev_b32 v166, 16, v166
    v_fmac_f32 v189, s85, v166
    v_lshlrev_b32 v143, 16, v143
    v_fmac_f32 v190, s85, v143
    v_lshlrev_b32 v164, 16, v164
    v_fmac_f32 v191, s85, v164
    v_lshlrev_b32 v161, 16, v161
    v_fmac_f32 v184, s85, v161
    v_lshlrev_b32 v158, 16, v158
    v_fmac_f32 v185, s85, v158
    v_lshlrev_b32 v162, 16, v162
    v_fmac_f32 v186, s85, v162
    v_lshlrev_b32 v165, 16, v165
    v_fmac_f32 v187, s85, v165
    v_lshlrev_b32 v157, 16, v157
    v_fmac_f32 v209, s85, v157
    v_lshrrev_b32 v154, 2, v150
    v_add_u32 v154, 8, v154
    v_mul_u32_u24 v154, 98, v154
    v_mad_u32_u24 v155, v151, 24, v154
    buffer_load_ushort v41, v155, s[20:23], 0 offen offset:0
    buffer_load_ushort v142, v155, s[20:23], 0 offen offset:2
    buffer_load_ushort v160, v155, s[20:23], 0 offen offset:4
    buffer_load_ushort v156, v155, s[20:23], 0 offen offset:6
    buffer_load_ushort v168, v155, s[20:23], 0 offen offset:8
    buffer_load_ushort v166, v155, s[20:23], 0 offen offset:10
    buffer_load_ushort v143, v155, s[20:23], 0 offen offset:12
    buffer_load_ushort v164, v155, s[20:23], 0 offen offset:14
    buffer_load_ushort v161, v155, s[20:23], 0 offen offset:16
    buffer_load_ushort v158, v155, s[20:23], 0 offen offset:18
    buffer_load_ushort v162, v155, s[20:23], 0 offen offset:20
    buffer_load_ushort v165, v155, s[20:23], 0 offen offset:22
    buffer_load_ushort v157, v154, s[20:23], 0 offen offset:96
    s_waitcnt vmcnt(0)
    v_lshlrev_b32 v41, 16, v41
    v_fmac_f32 v180, s85, v41
    v_lshlrev_b32 v142, 16, v142
    v_fmac_f32 v181, s85, v142
    v_lshlrev_b32 v160, 16, v160
    v_fmac_f32 v182, s85, v160
    v_lshlrev_b32 v156, 16, v156
    v_fmac_f32 v183, s85, v156
    v_lshlrev_b32 v168, 16, v168
    v_fmac_f32 v176, s85, v168
    v_lshlrev_b32 v166, 16, v166
    v_fmac_f32 v177, s85, v166
    v_lshlrev_b32 v143, 16, v143
    v_fmac_f32 v178, s85, v143
    v_lshlrev_b32 v164, 16, v164
    v_fmac_f32 v179, s85, v164
    v_lshlrev_b32 v161, 16, v161
    v_fmac_f32 v172, s85, v161
    v_lshlrev_b32 v158, 16, v158
    v_fmac_f32 v173, s85, v158
    v_lshlrev_b32 v162, 16, v162
    v_fmac_f32 v174, s85, v162
    v_lshlrev_b32 v165, 16, v165
    v_fmac_f32 v175, s85, v165
    v_lshlrev_b32 v157, 16, v157
    v_fmac_f32 v210, s85, v157
    v_lshrrev_b32 v154, 2, v150
    v_lshl_add_u32 v154, v151, 2, v154
    v_cmp_gt_u32 vcc, 3, v151
    v_mov_b32 v155, 48
    s_nop 1
    v_cndmask_b32 v154, v155, v154, vcc
    v_add_u32 v154, 2352, v154
    v_lshlrev_b32 v154, 1, v154
    buffer_load_ushort v41, v154, s[20:23], 0 offen
    s_waitcnt vmcnt(0)
    v_lshlrev_b32 v41, 16, v41
    v_fmac_f32 v211, s85, v41
    s_branch L_nomaskS
L_atomS0:
    v_mov_b32 v124, 0x800000
    buffer_atomic_add v124, v131, s[8:11], 0 offen sc0 sc1
    s_branch L_atomrS0
.section .rodata,"a"
.p2align 6
.amdhsa_kernel standalone__window_attn_swin_v2__vision_kernel
  .amdhsa_next_free_vgpr 512
  .amdhsa_next_free_sgpr 102
  .amdhsa_accum_offset 256
  .amdhsa_group_segment_fixed_size 0
  .amdhsa_kernarg_size 96
  .amdhsa_user_sgpr_count 2
  .amdhsa_user_sgpr_kernarg_segment_ptr 1
  .amdhsa_system_sgpr_workgroup_id_x 1
.end_amdhsa_kernel
```

```asm
; @launch grid=(256,1,1) block=(256,1,1) lds=163840
.amdgcn_target "amdgcn-amd-amdhsa--gfx950"
.text
.globl standalone__window_attn_swin_v2__vision_kernel
.p2align 8
.type standalone__window_attn_swin_v2__vision_kernel,@function
standalone__window_attn_swin_v2__vision_kernel:
    v_lshrrev_b32 v0, 6, v0
    s_cmp_ge_u32 s2, 256
    s_cbranch_scc1 L_end
    v_readfirstlane_b32 s68, v0
    s_mov_b32 s64, 0
    s_nop 0
    v_mbcnt_lo_u32_b32 v9, -1, 0
    v_mbcnt_hi_u32_b32 v9, -1, v9
    s_load_dwordx16 s[4:19], s[0:1], 0
    s_load_dwordx4 s[20:23], s[0:1], 64
    s_load_dwordx2 s[38:39], s[0:1], 80
    s_lshr_b32 s88, s2, 3
    s_lshl2_add_u32 s88, s88, s68
    v_lshlrev_b32 v8, 7, v9
    s_getpc_b64 s[80:81]
    s_lshl_b32 s84, s88, 8
    v_and_b32 v10, 128, v8
    v_add_u32 v10, s84, v10
    v_min_u32 v10, L_slow-standalone__window_attn_swin_v2__vision_kernel-256, v10
    s_mul_i32 s89, s88, 576
    s_mul_i32 s88, s88, 1728
    global_load_dword a255, v10, s[80:81]
    v_min_u32 v11, 1664, v8
    v_min_u32 v4, 512, v8
    s_mov_b32 s34, 221184
    s_mov_b32 s35, 0x20000
    s_mov_b32 s78, 73728
    s_mov_b32 s79, 0x20000
    v_and_b32 v122, 15, v9
    v_lshrrev_b32 v153, 4, v9
    v_lshrrev_b32 v124, 2, v122
    v_and_b32 v92, 3, v122
    s_mul_i32 s87, s68, 192
    v_mad_u32_u24 v7, v122, 12, s87
    v_lshlrev_b32 v10, 1, v122
    v_lshlrev_b32 v8, 1, v124
    v_lshl_add_u32 v8, v153, 5, v8
    s_movk_i32 s86, 384
    s_mov_b32 s26, 100270464
    s_mov_b32 s27, 0x20000
    s_mov_b32 s30, 0
    s_mov_b32 s31, 0x20000
    s_waitcnt lgkmcnt(0)
    s_mov_b32 s24, s4
    s_mov_b32 s25, s5
    s_mov_b32 s32, s6
    s_mov_b32 s33, s7
    s_mov_b32 s76, s8
    s_mov_b32 s77, s9
    buffer_load_dword a254, v11, s[32:35], s88 offen
    buffer_load_dword a253, v4, s[76:79], s89 offen
    s_load_dwordx2 s[82:83], s[10:11], 0
    s_movk_i32 s18, 676
    s_mov_b32 s19, 0x20000
    buffer_load_dwordx3 v[28:30], v7, s[16:19], 0 offen
    s_mul_i32 s96, s68, 288
    s_and_b32 s97, s68, 1
    s_lshl_b32 s97, s97, 2
    s_mov_b32 s98, 193536
    s_mov_b32 s99, 589824
    global_load_ushort v20, v10, s[12:13]
    v_add_u32 v11, s96, v9
    v_mul_u32_u24 v152, 2731, v11
    v_mul_u32_u24 v93, 6242, v11
    v_lshrrev_b32 v152, 16, v152
    v_lshrrev_b32 v93, 20, v93
    s_lshr_b32 s94, s2, 3
    s_mul_i32 s70, s94, 168
    global_load_ushort v21, v10, s[12:13] offset:32
    v_and_or_b32 v48, v152, 3, s97
    v_xor_b32 v48, v11, v48
    v_lshl_add_u32 v130, v48, 4, s99
    v_mad_u32_u24 v130, v93, s98, v130
    v_add_u32 v155, 64, v11
    s_mul_i32 s69, s2, 20
    s_lshl3_add_u32 s69, s94, s69
    global_load_ushort v154, v8, s[14:15] offset:0
    v_mul_u32_u24 v49, 2731, v155
    v_mul_u32_u24 v131, 6242, v155
    v_lshrrev_b32 v49, 16, v49
    v_lshrrev_b32 v131, 20, v131
    v_and_or_b32 v10, v49, 3, s97
    s_add_u32 s70, s70, 140
    s_movk_i32 s62, 2688
    global_load_ushort v31, v8, s[14:15] offset:8
    v_xor_b32 v10, v155, v10
    v_lshl_add_u32 v129, v10, 4, s99
    v_mad_u32_u24 v129, v131, s98, v129
    v_add_u32 v128, 128, v11
    v_mul_u32_u24 v125, 2731, v128
    s_movk_i32 s71, 20
    s_movk_i32 s73, 28
    global_load_ushort v155, v8, s[14:15] offset:16
    v_mul_u32_u24 v51, 6242, v128
    v_lshrrev_b32 v125, 16, v125
    v_lshrrev_b32 v51, 20, v51
    v_and_or_b32 v50, v125, 3, s97
    v_xor_b32 v50, v128, v50
    s_mov_b32 s93, 1769472
    s_mul_i32 s54, s68, 5120
    global_load_ushort v8, v8, s[14:15] offset:24
    v_lshl_add_u32 v128, v50, 4, s99
    v_mad_u32_u24 v128, v51, s98, v128
    v_add_u32 v4, 192, v11
    v_mul_u32_u24 v22, 2731, v4
    v_mul_u32_u24 v6, 6242, v4
    v_lshrrev_b32 v22, 16, v22
    v_lshrrev_b32 v6, 20, v6
    v_and_or_b32 v23, v22, 3, s97
    v_xor_b32 v23, v4, v23
    v_lshl_add_u32 v127, v23, 4, s99
    v_mad_u32_u24 v127, v6, s98, v127
    v_add_u32 v4, 256, v11
    v_mul_u32_u24 v23, 2731, v4
    v_mul_u32_u24 v11, 6242, v4
    v_lshrrev_b32 v23, 16, v23
    v_lshrrev_b32 v11, 20, v11
    v_and_or_b32 v126, v23, 3, s97
    v_xor_b32 v126, v4, v126
    v_lshl_add_u32 v126, v126, 4, s99
    v_mad_u32_u24 v126, v11, s98, v126
    s_cmp_ge_u32 s2, 240
    s_cbranch_scc1 L_bndF
L_bndrF:
    s_mov_b32 s63, 1180032
    s_mul_i32 s94, s69, 58255
    s_lshr_b32 s94, s94, 22
    s_mul_i32 s94, s94, s63
    s_mul_i32 s72, s69, s62
    s_add_u32 s72, s72, s94
    v_lshl_or_b32 v120, v9, 4, 2.0
    s_sub_u32 s94, s73, 1
    s_max_u32 s94, s94, 20
    s_mul_i32 s95, s68, -44
    s_movk_i32 s99, -24
    s_add_u32 m0, s54, 0
    v_and_b32 v51, -4, v125
    s_mul_i32 s85, s68, 96
    s_sub_u32 s100, s85, 1024
    buffer_load_dwordx4 v130, s[24:27], s72 offen nt lds
    s_add_u32 m0, s54, 1024
    v_mad_u32_u24 v11, v51, 3, v125
    v_add_u32 v11, s95, v11
    v_mad_i32_i24 v50, v125, s99, v50
    v_med3_u32 v51, v11, 20, s94
    v_add_u32 v51, s70, v51
    v_add_u32 v125, s69, v11
    s_sub_u32 s87, s85, 2048
    s_movk_i32 s91, 1152
    buffer_load_dwordx4 v129, s[24:27], s72 offen nt lds
    v_cmp_gt_u32 vcc, s71, v11
    v_lshl_add_u32 v50, v50, 4, s93
    s_add_u32 m0, s54, 43008
    v_cndmask_b32 v125, v51, v125, vcc
    v_mul_u32_u24 v51, 58255, v125
    v_mad_u32_u24 v50, v125, s62, v50
    v_lshrrev_b32 v51, 22, v51
    v_mad_u32_u24 v50, v51, s63, v50
    s_mul_i32 s90, s68, 3072
    s_add_u32 s90, s90, 61440
    buffer_load_dwordx4 v50, s[24:27], 0 offen  lds
    v_lshlrev_b32 v51, 16, v11
    s_add_u32 m0, s54, 2048
    v_and_b32 v131, -4, v49
    v_mad_u32_u24 v125, v131, 3, v49
    v_add_u32 v125, s95, v125
    v_mad_i32_i24 v49, v49, s99, v10
    v_med3_u32 v131, v125, 20, s94
    s_add_u32 s101, s54, 44032
    s_mov_b32 s28, s22
    buffer_load_dwordx4 v128, s[24:27], s72 offen nt lds
    v_add_u32 v131, s70, v131
    v_add_u32 v10, s69, v125
    v_cmp_gt_u32 vcc, s71, v125
    v_lshl_add_u32 v49, v49, 4, s93
    s_add_u32 m0, s54, 41984
    v_cndmask_b32 v10, v131, v10, vcc
    v_mul_u32_u24 v131, 58255, v10
    v_mad_u32_u24 v49, v10, s62, v49
    v_lshrrev_b32 v131, 22, v131
    v_mad_u32_u24 v49, v131, s63, v49
    s_mov_b32 s29, s23
    s_mov_b32 s41, 0x2a8cbccc
    buffer_load_dwordx4 v49, s[24:27], 0 offen  lds
    v_lshl_or_b32 v51, v125, 8, v51
    s_add_u32 m0, s54, 3072
    v_cmp_gt_u32 vcc, 32, v9
    v_and_b32 v131, -4, v152
    v_mad_u32_u24 v125, v131, 3, v152
    v_cndmask_b32 v126, v120, v126, vcc
    v_add_u32 v125, s95, v125
    s_mov_b32 s42, 0x38fba882
    s_mov_b32 s43, 0x415db3d7
    buffer_load_dwordx4 v127, s[24:27], s72 offen nt lds
    s_add_u32 m0, s54, 4096
    v_mad_i32_i24 v48, v152, s99, v48
    v_med3_u32 v131, v125, 20, s94
    v_add_u32 v131, s70, v131
    v_add_u32 v152, s69, v125
    v_cmp_gt_u32 vcc, s71, v125
    v_lshl_add_u32 v48, v48, 4, s93
    s_mul_i32 s93, s68, 6
    s_lshl_b32 s94, s97, 1
    buffer_load_dwordx4 v126, s[24:27], s72 offen nt lds
    v_cndmask_b32 v152, v131, v152, vcc
    v_mul_u32_u24 v131, 58255, v152
    v_mad_u32_u24 v48, v152, s62, v48
    v_lshrrev_b32 v131, 22, v131
    v_mad_u32_u24 v48, v131, s63, v48
    s_add_u32 m0, s54, 40960
    v_lshl_or_b32 v51, v125, 0, v51
    s_mov_b32 s44, 61440
    s_mov_b32 s45, 40960
    buffer_load_dwordx4 v48, s[24:27], 0 offen nt lds
    v_mul_u32_u24 v10, 10923, v9
    v_lshrrev_b32 v121, 17, v10
    v_lshrrev_b32 v10, 16, v10
    v_mad_i32_i24 v11, v10, -6, v9
    v_bitop3_b32 v121, v121, v10, 4 bitop3:0x28
    v_lshl_add_u32 v11, v11, 4, s85
    v_mul_u32_u24 v121, 3, v121
    v_xor_b32 v10, v10, v121
    v_mad_u32_u24 v121, v10, s91, v11
    v_add_u32 v125, 64, v9
    v_mul_u32_u24 v123, 10923, v125
    v_lshrrev_b32 v61, 17, v123
    v_lshrrev_b32 v123, 16, v123
    v_mad_i32_i24 v152, v123, -6, v125
    v_bitop3_b32 v61, v61, v123, 4 bitop3:0x28
    v_lshl_add_u32 v152, v152, 4, s100
    v_mul_u32_u24 v61, 3, v61
    v_xor_b32 v123, v123, v61
    v_mad_u32_u24 v61, v123, s91, v152
    v_add_u32 v125, 128, v9
    v_mul_u32_u24 v131, 10923, v125
    v_lshrrev_b32 v14, 17, v131
    v_lshrrev_b32 v131, 16, v131
    v_mad_i32_i24 v125, v131, -6, v125
    v_bitop3_b32 v14, v14, v131, 4 bitop3:0x28
    v_lshl_add_u32 v125, v125, 4, s87
    v_mul_u32_u24 v14, 3, v14
    v_xor_b32 v131, v131, v14
    v_mad_u32_u24 v14, v131, s91, v125
    v_mad_u32_u24 v46, v10, s86, v11
    v_mad_u32_u24 v158, v123, s86, v152
    v_mad_u32_u24 v47, v131, s86, v125
    s_add_u32 m0, s90, 0
    s_mov_b32 s92, 0
    buffer_load_dwordx4 v121, s[32:35], s92 offen offset:0 lds
    v_lshrrev_b32 v125, 1, v153
    v_lshl_add_u32 v123, v153, 2, v124
    v_lshl_add_u32 v123, v125, 3, v123
    v_mul_u32_u24 v123, 96, v123
    v_add_u32 v123, s90, v123
    v_lshl_add_u32 v5, v92, 4, v123
    v_lshl_add_u32 v4, v92, 3, v123
    v_mov_b32 v6, 0x3f803f80
    v_cmp_eq_u32 vcc, 0, v92
    v_and_b32 v123, 1, v9
    v_lshlrev_b32 v123, 4, v123
    v_cndmask_b32 v220, 0, v6, vcc
    v_cndmask_b32 v221, 0, v6, vcc
    v_cndmask_b32 v222, 0, v6, vcc
    v_cndmask_b32 v223, 0, v6, vcc
    v_mov_b32 v6, 0x3f80
    v_lshlrev_b32 v125, v123, v6
    v_cmp_gt_u32 vcc, 2, v92
    v_mov_b32 v6, 0x44004400
    v_mul_u32_u24 v123, 48, v124
    v_cndmask_b32 v216, 0, v125, vcc
    v_cndmask_b32 v218, 0, v125, vcc
    v_cmp_le_u32 vcc, 2, v92
    v_lshl_add_u32 v123, v92, 2, v123
    v_mul_u32_u24 v95, 48, v153
    v_cndmask_b32 v217, 0, v125, vcc
    v_cndmask_b32 v219, 0, v125, vcc
    v_cmp_eq_u32 vcc, v153, v124
    v_add_u32 v62, 0, v123
    v_mul_u32_u24 v125, 37, v62
    v_cndmask_b32 v10, 0, v216, vcc
    v_cndmask_b32 v11, 0, v217, vcc
    v_cmp_eq_u32 vcc, 0, v92
    v_lshrrev_b32 v125, 10, v125
    v_mad_u32_u24 v62, v125, 24, v62
    v_cndmask_b32 v212, 0, v6, vcc
    v_cmp_eq_u32 vcc, 1, v92
    v_add_u32 v62, s101, v62
    v_add_u32 v187, 16, v123
    v_cndmask_b32 v213, 0, v6, vcc
    v_cmp_eq_u32 vcc, 2, v92
    v_mul_u32_u24 v125, 37, v187
    v_lshrrev_b32 v125, 10, v125
    v_cndmask_b32 v214, 0, v6, vcc
    v_cmp_eq_u32 vcc, 3, v92
    v_mad_u32_u24 v187, v125, 24, v187
    v_add_u32 v187, s101, v187
    v_cndmask_b32 v215, 0, v6, vcc
    v_add_u32 v175, 32, v123
    v_mul_u32_u24 v6, 37, v175
    v_lshrrev_b32 v6, 10, v6
    v_mad_u32_u24 v175, v6, 24, v175
    v_add_u32 v175, s101, v175
    v_add_u32 v94, 0, v95
    v_mul_u32_u24 v6, 37, v94
    v_lshrrev_b32 v6, 10, v6
    v_mad_u32_u24 v94, v6, 24, v94
    v_add_u32 v60, 4, v95
    v_mul_u32_u24 v6, 37, v60
    v_lshrrev_b32 v6, 10, v6
    v_mad_u32_u24 v60, v6, 24, v60
    v_add_u32 v93, 8, v95
    v_mul_u32_u24 v6, 37, v93
    v_lshrrev_b32 v6, 10, v6
    v_mad_u32_u24 v93, v6, 24, v93
    v_add_u32 v63, 12, v95
    v_mul_u32_u24 v6, 37, v63
    v_lshrrev_b32 v6, 10, v6
    v_mad_u32_u24 v63, v6, 24, v63
    v_add_u32 v200, 16, v95
    v_mul_u32_u24 v6, 37, v200
    v_lshrrev_b32 v6, 10, v6
    v_mad_u32_u24 v200, v6, 24, v200
    v_add_u32 v201, 20, v95
    v_mul_u32_u24 v6, 37, v201
    v_lshrrev_b32 v6, 10, v6
    v_mad_u32_u24 v201, v6, 24, v201
    v_add_u32 v202, 24, v95
    v_mul_u32_u24 v6, 37, v202
    v_lshrrev_b32 v6, 10, v6
    v_mad_u32_u24 v202, v6, 24, v202
    v_add_u32 v203, 28, v95
    v_mul_u32_u24 v6, 37, v203
    v_lshrrev_b32 v6, 10, v6
    v_mad_u32_u24 v203, v6, 24, v203
    v_add_u32 v44, 32, v95
    v_mul_u32_u24 v6, 37, v44
    v_lshrrev_b32 v6, 10, v6
    v_mad_u32_u24 v44, v6, 24, v44
    s_waitcnt lgkmcnt(0)
    s_sext_i32_i16 s84, s82
    s_ashr_i32 s85, s82, 16
    s_max_i32 s84, s84, s85
    s_sext_i32_i16 s85, s83
    s_max_i32 s84, s84, s85
    s_ashr_i32 s85, s83, 16
    s_max_i32 s84, s84, s85
    s_cmp_gt_i32 s84, 16492
    s_cbranch_scc1 L_slow
    s_lshl_b32 s84, s68, 4
    buffer_load_dwordx4 v61, s[32:35], s92 offen offset:1024 lds
    v_add_u32 v45, 36, v95
    v_mul_u32_u24 v6, 37, v45
    v_lshrrev_b32 v6, 10, v6
    v_mad_u32_u24 v45, v6, 24, v45
    v_add_u32 v198, 40, v95
    v_mul_u32_u24 v6, 37, v198
    v_lshrrev_b32 v6, 10, v6
    s_lshr_b64 s[82:83], s[82:83], s84
    s_lshl_b32 s82, s82, 16
    buffer_load_dwordx4 v14, s[32:35], s92 offen offset:2048 lds
    s_add_u32 m0, s90, 12288
    s_mov_b32 s92, 36864
    v_mad_u32_u24 v198, v6, 24, v198
    v_add_u32 v199, 44, v95
    v_mul_u32_u24 v6, 37, v199
    v_lshrrev_b32 v6, 10, v6
    v_mad_u32_u24 v199, v6, 24, v199
    s_mov_b32 s84, 0x41b8aa3b
    s_mov_b32 s46, 20480
    buffer_load_dwordx4 v121, s[32:35], s92 offen offset:0 lds
    v_lshl_add_u32 v152, v153, 4, v123
    v_mul_u32_u24 v6, 37, v152
    v_lshrrev_b32 v6, 10, v6
    v_mad_u32_u24 v152, v6, 24, v152
    v_mov_b32 v95, 336
    v_cmp_gt_u32 vcc, 3, v153
    v_and_b32 v6, 8, v122
    v_add_u32 v6, v6, v122
    v_cndmask_b32 v152, v95, v152, vcc
    v_sub_u32 v152, s101, v152
    v_mul_u32_u24 v6, 96, v6
    v_add_u32 v6, s90, v6
    v_lshl_add_u32 v238, v153, 4, v6
    v_lshl_add_u32 v239, v153, 3, v6
    v_lshlrev_b32 v95, 4, v153
    s_mov_b32 s47, 0
    s_mov_b32 s57, s72
    buffer_load_dwordx4 v61, s[32:35], s92 offen offset:1024 lds
    v_add_u32 v95, 4608, v95
    v_mov_b32 v6, s82
    v_min_f32 v6, 0x40930000, v6
    v_max_f32 v6, 0xc2c80000, v6
    v_mul_f32 v6, 0x3fb8aa3b, v6
    v_exp_f32 v6, v6
    s_waitcnt vmcnt(17)
    v_lshl_or_b32 v20, v21, 16, v20
    v_cvt_pk_bf16_f32 v6, v6, v6
    v_lshlrev_b32 v6, 16, v6
    v_mul_f32 v6, 0x4038aa3b, v6
    s_waitcnt vmcnt(15)
    v_lshl_or_b32 v154, v31, 16, v154
    v_readfirstlane_b32 s55, v6
    v_add_f32 v6, v6, v6
    s_waitcnt vmcnt(13)
    v_lshl_or_b32 v155, v8, 16, v155
    v_readfirstlane_b32 s52, v6
    v_cmp_gt_u32 vcc, 16, v9
    v_mov_b32 v21, 0
    v_mov_b32 v22, 0
    v_cndmask_b32 v23, 0, v20, vcc
    v_cndmask_b32 v20, 0, v20, vcc
    v_mov_b32 v31, 0
    v_mfma_f32_16x16x16_bf16 v[0:3], v[22:23], v[28:29], 0
    s_mov_b32 s58, 0
    v_mul_u32_u24 v6, 5120, v153
    v_add_u32 v6, v7, v6
    v_mfma_f32_16x16x16_bf16 v[16:19], v[20:21], v[28:29], 0
    s_mov_b32 s59, 0
    v_mov_b32 v8, 0xc138aa3b
    v_mul_u32_u24 v7, 5120, v124
    v_mfma_f32_16x16x16_bf16 v[24:27], v[20:21], v[30:31], 0
    s_mov_b32 s60, 0
    v_max_f32 v0, 0, v0
    v_max_f32 v1, 0, v1
    v_max_f32 v2, 0, v2
    v_max_f32 v16, 0, v16
    v_max_f32 v17, 0, v17
    v_max_f32 v18, 0, v18
    v_max_f32 v19, 0, v19
    v_cvt_pk_bf16_f32 v16, v16, v17
    v_cvt_pk_bf16_f32 v17, v18, v19
    v_max_f32 v3, 0, v3
    v_cvt_pk_bf16_f32 v0, v0, v1
    v_mfma_f32_16x16x16_bf16 v[20:23], v[154:155], v[16:17], 0
    s_mov_b32 s65, -1
    v_cvt_pk_bf16_f32 v1, v2, v3
    v_max_f32 v24, 0, v24
    v_max_f32 v25, 0, v25
    v_mfma_f32_16x16x16_bf16 v[16:19], v[154:155], v[0:1], 0
    s_mov_b32 s61, 1
    v_max_f32 v26, 0, v26
    v_max_f32 v27, 0, v27
    v_cvt_pk_bf16_f32 v24, v24, v25
    v_cvt_pk_bf16_f32 v25, v26, v27
    v_cvt_pk_bf16_f32 v20, v20, v20
    v_lshlrev_b32 v20, 16, v20
    v_mfma_f32_16x16x16_bf16 v[0:3], v[154:155], v[24:25], 0
    s_movk_i32 s4, 336
    v_mul_f32 v20, 0xbfb8aa3b, v20
    v_cvt_pk_bf16_f32 v16, v16, v16
    v_exp_f32 v20, v20
    v_lshlrev_b32 v16, 16, v16
    v_add_f32 v20, 1.0, v20
    v_rcp_f32 v20, v20
    v_mul_f32 v16, 0xbfb8aa3b, v16
    v_cvt_pk_bf16_f32 v20, v20, v20
    v_lshlrev_b32 v20, 16, v20
    v_fma_f32 v20, v20, s84, v8
    s_mov_b32 s5, 0
    s_mov_b32 s6, 0
    ds_write_b32 v6, v20 offset:44032
    v_exp_f32 v16, v16
    v_cvt_pk_bf16_f32 v0, v0, v0
    v_add_f32 v16, 1.0, v16
    v_rcp_f32 v16, v16
    v_lshlrev_b32 v0, 16, v0
    v_cvt_pk_bf16_f32 v16, v16, v16
    v_lshlrev_b32 v16, 16, v16
    v_fma_f32 v16, v16, s84, v8
    s_mov_b32 s12, 0
    s_mov_b32 s64, 3
    ds_write_b32 v6, v16 offset:44036
    v_mul_f32 v0, 0xbfb8aa3b, v0
    v_exp_f32 v0, v0
    v_mad_u32_u24 v7, v92, s86, v7
    v_add_f32 v0, 1.0, v0
    v_rcp_f32 v0, v0
    v_and_b32 v125, 7, v122
    v_cvt_pk_bf16_f32 v0, v0, v0
    v_lshlrev_b32 v0, 16, v0
    v_fma_f32 v0, v0, s84, v8
    s_mov_b32 s10, 81924
    s_mov_b32 s11, 0x20000
    ds_write_b32 v6, v0 offset:44040
    v_xor_b32 v8, v125, v153
    v_lshl_add_u32 v6, v8, 4, v7
    v_xor_b32 v103, 64, v6
    v_add_u32 v139, 40960, v6
    v_xor_b32 v138, 64, v139
    v_add_u32 v7, 61440, v7
    v_add_u32 v8, s93, v153
    v_xor_b32 v8, v125, v8
    v_lshl_add_u32 v137, v8, 4, v7
    v_lshrrev_b32 v8, 1, v153
    v_add3_u32 v8, v8, s93, 4
    v_xor_b32 v8, v125, v8
    v_lshl_add_u32 v8, v8, 4, v7
    v_and_b32 v7, 1, v153
    v_lshl_add_u32 v136, v7, 3, v8
    v_lshlrev_b32 v7, 4, v9
    s_add_u32 s93, s54, 20480
    v_add_u32 v135, s93, v7
    v_add_u32 v131, 81920, v7
    s_lshr_b32 s93, s68, 1
    s_lshl_b32 s93, s93, 10
    s_add_u32 s93, s93, s94
    v_add_u32 v132, s93, v131
    s_mul_i32 s93, s68, 5376
    s_add_u32 s93, s93, 142336
    v_mul_u32_u24 v7, 80, v153
    v_add_u32 v8, s93, v7
    v_mul_u32_u24 v7, 336, v122
    v_add_u32 v0, v7, v8
    v_subrev_u32 v0, 21504, v0
    v_cmp_eq_u32 vcc, 0, v124
    v_mul_u32_u24 v7, 80, v124
    v_lshl_add_u32 v7, v153, 3, v7
    s_waitcnt lgkmcnt(0)
    s_barrier
    v_cndmask_b32 v134, v120, v8, vcc
    v_cmp_eq_u32 vcc, 3, v92
    v_lshl_add_u32 v7, v92, 1, v7
    v_add_u32 v7, s93, v7
    s_add_u32 s93, s69, 1
    s_mul_i32 s94, s93, 58255
    buffer_load_dwordx4 v14, s[32:35], s92 offen offset:2048 lds
    s_add_u32 m0, s90, 24576
    s_mov_b32 s92, 73728
    ds_read_b32 v209, v187
    v_cndmask_b32 v134, v134, v8, vcc
    v_cmp_gt_u32 vcc, 3, v153
    v_mov_b32 v125, 0
    s_lshr_b32 s94, s94, 22
    v_cndmask_b32 v133, v120, v7, vcc
    s_mul_i32 s94, s94, s63
    s_mul_i32 s56, s93, s62
    s_add_u32 s56, s56, s94
    s_and_b32 s94, s68, 1
    s_mul_i32 s94, s94, -2304
    ds_read_b32 v210, v175
    v_mov_b32 v124, 0
    s_sub_u32 s93, s71, 1
    s_cmp_eq_u32 s68, 0
    s_cselect_b32 s13, s93, -1
    s_cmp_gt_u32 s73, 20
    s_cselect_b32 s13, s13, -1
    s_and_b32 s93, s2, -8
    buffer_load_dwordx4 v121, s[32:35], s92 offen offset:0 lds
    s_sub_u32 s93, 81920, s93
    s_sub_u32 s8, s38, s93
    s_subb_u32 s9, s39, 0
    s_lshr_b32 s93, s68, 1
    s_mul_i32 s93, s93, 30720
    s_add_u32 s93, s93, s94
    ds_write_b128 v0, v[216:219] offset:21584
    buffer_load_dwordx4 v61, s[32:35], s92 offen offset:1024 lds
    v_add_u32 v92, s93, v238
    v_add_u32 v7, s93, v239
    s_lshr_b32 s93, s68, 1
    s_mul_i32 s93, s93, 5120
    s_lshl_b32 s94, s97, 4
    s_add_u32 s93, s93, s94
    v_add_u32 v8, s93, v95
    v_cmp_eq_u32 vcc, 0, v122
    s_mov_b32 s39, 0x00010001
    v_sub_u32 v192, v187, v94
    v_cndmask_b32 v8, v120, v8, vcc
    ds_read_b32 v192, v192 offset:336
    v_sub_u32 v193, v187, v60
    v_sub_u32 v194, v187, v93
    v_sub_u32 v195, v187, v63
    v_sub_u32 v188, v187, v200
    v_sub_u32 v189, v187, v201
    ds_read_b32 v193, v193 offset:336
    v_sub_u32 v190, v187, v202
    buffer_load_dwordx4 v14, s[32:35], s92 offen offset:2048 lds
    s_add_u32 m0, s90, 36864
    s_mov_b32 s92, 110592
    ds_read_b32 v194, v194 offset:336
    v_sub_u32 v191, v187, v203
    v_sub_u32 v184, v187, v44
    v_sub_u32 v185, v187, v45
    v_sub_u32 v186, v187, v198
    v_sub_u32 v187, v187, v199
    s_waitcnt vmcnt(9)
    s_barrier
    ds_read_b32 v195, v195 offset:336
    v_sub_u32 v180, v175, v94
    v_sub_u32 v181, v175, v60
    v_sub_u32 v182, v175, v93
    v_sub_u32 v183, v175, v63
    v_sub_u32 v176, v175, v200
    ds_read_b32 v188, v188 offset:336
    v_sub_u32 v177, v175, v201
    v_sub_u32 v178, v175, v202
    v_sub_u32 v179, v175, v203
    v_sub_u32 v172, v175, v44
    v_sub_u32 v173, v175, v45
    ds_read_b32 v189, v189 offset:336
    v_sub_u32 v174, v175, v198
    v_sub_u32 v175, v175, v199
    buffer_load_dwordx4 v121, s[32:35], s92 offen offset:0 lds
    ds_read_b32 v190, v190 offset:336
    v_sub_u32 v204, v62, v94
    v_sub_u32 v205, v62, v60
    v_sub_u32 v206, v62, v93
    v_sub_u32 v207, v62, v63
    v_sub_u32 v200, v62, v200
    ds_read_b32 v191, v191 offset:336
    v_sub_u32 v201, v62, v201
    v_sub_u32 v202, v62, v202
    v_sub_u32 v203, v62, v203
    v_sub_u32 v196, v62, v44
    v_sub_u32 v197, v62, v45
    ds_read_b32 v184, v184 offset:336
    buffer_load_dwordx4 v61, s[32:35], s92 offen offset:1024 lds
    v_sub_u32 v198, v62, v198
    v_sub_u32 v199, v62, v199
    ds_read_b32 v185, v185 offset:336
    ds_read_b32 v186, v186 offset:336
    ds_read_b32 v187, v187 offset:336
    buffer_load_dwordx4 v14, s[32:35], s92 offen offset:2048 lds
    s_add_u32 m0, s90, 49152
    s_mov_b32 s92, 147456
    s_waitcnt vmcnt(9)
    ds_read_b64_tr_b16 a[0:1], v4 offset:0
    ds_read_b64_tr_b16 a[2:3], v4 offset:768
    ds_read_b64_tr_b16 a[24:25], v4 offset:32
    ds_read_b64_tr_b16 a[26:27], v4 offset:800
    ds_read_b64_tr_b16 a[48:49], v4 offset:64
    ds_read_b64_tr_b16 a[50:51], v4 offset:832
    ds_read_b128 v[28:31], v6 offset:40960
    ds_read_b128 v[20:23], v6 offset:42496
    buffer_load_dwordx4 v121, s[32:35], s92 offen offset:0 lds
    ds_read_b128 v[24:27], v6 offset:0
    ds_read_b128 v[16:19], v6 offset:1536
    ds_read_b128 v[88:91], v6 offset:3072
    ds_read_b32 v180, v180 offset:336
    buffer_load_dwordx4 v61, s[32:35], s92 offen offset:1024 lds
    ds_read_b32 v181, v181 offset:336
    ds_read_b32 v182, v182 offset:336
    s_waitcnt lgkmcnt(7)
    v_mfma_f32_16x16x32_bf16 v[76:79], a[0:3], v[28:31], 0
    ds_read_b128 v[112:115], v103 offset:41088
    v_mfma_f32_16x16x32_bf16 v[40:43], a[24:27], v[28:31], 0
    ds_read_b128 v[108:111], v103 offset:42624
    v_mfma_f32_16x16x32_bf16 v[96:99], a[48:51], v[28:31], 0
    s_waitcnt vmcnt(8) lgkmcnt(6)
    buffer_load_dwordx4 v14, s[32:35], s92 offen offset:2048 lds
    ds_read_b64_tr_b16 a[4:5], v4 offset:12288
    v_mfma_f32_16x16x32_bf16 v[56:59], a[0:3], v[20:23], 0
    s_add_u32 m0, s90, 61440
    ds_read_b64_tr_b16 a[6:7], v4 offset:13056
    v_mfma_f32_16x16x32_bf16 v[52:55], a[24:27], v[20:23], 0
    s_mov_b32 s92, 184320
    ds_read_b64_tr_b16 a[28:29], v4 offset:12320
    v_mfma_f32_16x16x32_bf16 v[32:35], a[48:51], v[20:23], 0
    ds_read_b64_tr_b16 a[30:31], v4 offset:13088
    v_mfma_f32_16x16x32_bf16 v[20:23], a[0:3], v[24:27], 0
    ds_read_b64_tr_b16 a[52:53], v4 offset:12352
    v_mfma_f32_16x16x32_bf16 v[84:87], a[24:27], v[24:27], 0
    buffer_load_dwordx4 v121, s[32:35], s92 offen offset:0 lds
    ds_read_b64_tr_b16 a[54:55], v4 offset:13120
    v_mfma_f32_16x16x32_bf16 v[68:71], a[48:51], v[24:27], 0
    ds_read_b128 v[64:67], v103 offset:128
    v_mfma_f32_16x16x32_bf16 v[144:147], a[0:3], v[16:19], 0
    ds_read_b128 v[28:31], v103 offset:1664
    v_mfma_f32_16x16x32_bf16 v[148:151], a[24:27], v[16:19], 0
    ds_read_b128 v[24:27], v103 offset:3200
    v_mfma_f32_16x16x32_bf16 v[104:107], a[48:51], v[16:19], 0
    s_waitcnt lgkmcnt(8)
    ds_read_b128 v[36:39], v103 offset:40960
    v_mfma_f32_16x16x32_bf16 v[80:83], a[0:3], v[88:91], 0
    buffer_load_dwordx4 v61, s[32:35], s92 offen offset:1024 lds
    ds_read_b128 v[116:119], v103 offset:42496
    v_mfma_f32_16x16x32_bf16 v[16:19], a[24:27], v[88:91], 0
    ds_read_b128 v[160:163], v103 offset:0
    v_mfma_f32_16x16x32_bf16 v[72:75], a[48:51], v[88:91], 0
    ds_read_b128 v[140:143], v103 offset:1536
    ds_read_b128 v[88:91], v103 offset:3072
    ds_read_b32 v183, v183 offset:336
    buffer_load_dwordx4 v14, s[32:35], s92 offen offset:2048 lds
    s_add_u32 m0, s90, 0
    s_mov_b32 s92, 384
    s_waitcnt vmcnt(9)
    ds_read_b64_tr_b16 a[8:9], v4 offset:24576
    ds_read_b64_tr_b16 a[10:11], v4 offset:25344
    ds_read_b64_tr_b16 a[32:33], v4 offset:24608
    ds_read_b64_tr_b16 a[34:35], v4 offset:25376
    s_waitcnt lgkmcnt(9)
    v_mfma_f32_16x16x32_bf16 v[76:79], a[4:7], v[36:39], v[76:79]
    ds_read_b64_tr_b16 a[56:57], v4 offset:24640
    v_mfma_f32_16x16x32_bf16 v[40:43], a[28:31], v[36:39], v[40:43]
    ds_read_b64_tr_b16 a[58:59], v4 offset:25408
    v_mfma_f32_16x16x32_bf16 v[96:99], a[52:55], v[36:39], v[96:99]
    s_waitcnt lgkmcnt(9)
    buffer_load_dwordx4 v121, s[32:35], s92 offen offset:0 lds
    ds_read_b128 v[36:39], v6 offset:41088
    v_mfma_f32_16x16x32_bf16 v[56:59], a[4:7], v[116:119], v[56:59]
    ds_read_b32 v176, v176 offset:336
    v_mfma_f32_16x16x32_bf16 v[52:55], a[28:31], v[116:119], v[52:55]
    v_mfma_f32_16x16x32_bf16 v[32:35], a[52:55], v[116:119], v[32:35]
    ds_read_b32 v177, v177 offset:336
    v_mfma_f32_16x16x32_bf16 v[20:23], a[4:7], v[160:163], v[20:23]
    v_mfma_f32_16x16x32_bf16 v[84:87], a[28:31], v[160:163], v[84:87]
    buffer_load_dwordx4 v61, s[32:35], s92 offen offset:1024 lds
    ds_read_b128 v[116:119], v6 offset:42624
    v_mfma_f32_16x16x32_bf16 v[68:71], a[52:55], v[160:163], v[68:71]
    s_waitcnt lgkmcnt(6)
    ds_read_b32 v178, v178 offset:336
    v_mfma_f32_16x16x32_bf16 v[144:147], a[4:7], v[140:143], v[144:147]
    v_mfma_f32_16x16x32_bf16 v[148:151], a[28:31], v[140:143], v[148:151]
    ds_read_b32 v179, v179 offset:336
    v_mfma_f32_16x16x32_bf16 v[104:107], a[52:55], v[140:143], v[104:107]
    v_mfma_f32_16x16x32_bf16 v[80:83], a[4:7], v[88:91], v[80:83]
    s_waitcnt vmcnt(8)
    buffer_load_dwordx4 v14, s[32:35], s92 offen offset:2048 lds
    ds_read_b64_tr_b16 a[12:13], v4 offset:36864
    v_mfma_f32_16x16x32_bf16 v[16:19], a[28:31], v[88:91], v[16:19]
    s_add_u32 m0, s90, 12288
    ds_read_b64_tr_b16 a[14:15], v4 offset:37632
    v_mfma_f32_16x16x32_bf16 v[72:75], a[52:55], v[88:91], v[72:75]
    s_waitcnt lgkmcnt(5)
    s_mov_b32 s92, 37248
    ds_read_b64_tr_b16 a[36:37], v4 offset:36896
    v_mfma_f32_16x16x32_bf16 v[76:79], a[8:11], v[36:39], v[76:79]
    ds_read_b64_tr_b16 a[38:39], v4 offset:37664
    v_mfma_f32_16x16x32_bf16 v[40:43], a[32:35], v[36:39], v[40:43]
    ds_read_b64_tr_b16 a[60:61], v4 offset:36928
    v_mfma_f32_16x16x32_bf16 v[96:99], a[56:59], v[36:39], v[96:99]
    s_waitcnt lgkmcnt(6)
    buffer_load_dwordx4 v121, s[32:35], s92 offen offset:0 lds
    ds_read_b64_tr_b16 a[62:63], v4 offset:37696
    v_mfma_f32_16x16x32_bf16 v[56:59], a[8:11], v[116:119], v[56:59]
    ds_read_b128 v[88:91], v6 offset:128
    v_mfma_f32_16x16x32_bf16 v[52:55], a[32:35], v[116:119], v[52:55]
    ds_read_b128 v[36:39], v6 offset:1664
    v_mfma_f32_16x16x32_bf16 v[32:35], a[56:59], v[116:119], v[32:35]
    s_waitcnt lgkmcnt(6)
    ds_read_b32 v172, v172 offset:336
    ds_read_b32 v173, v173 offset:336
    v_mfma_f32_16x16x32_bf16 v[76:79], a[12:15], v[112:115], v[76:79]
    buffer_load_dwordx4 v61, s[32:35], s92 offen offset:1024 lds
    v_mfma_f32_16x16x32_bf16 v[56:59], a[12:15], v[108:111], v[56:59]
    s_waitcnt lgkmcnt(6)
    ds_read_b32 v174, v174 offset:336
    v_mfma_f32_16x16x32_bf16 v[40:43], a[36:39], v[112:115], v[40:43]
    v_mfma_f32_16x16x32_bf16 v[52:55], a[36:39], v[108:111], v[52:55]
    s_waitcnt lgkmcnt(5)
    ds_read_b128 v[140:143], v6 offset:3200
    v_mfma_f32_16x16x32_bf16 v[96:99], a[60:63], v[112:115], v[96:99]
    ds_read_b32 v175, v175 offset:336
    buffer_load_dwordx4 v14, s[32:35], s92 offen offset:2048 lds
    v_mfma_f32_16x16x32_bf16 v[32:35], a[60:63], v[108:111], v[32:35]
    s_waitcnt lgkmcnt(5)
    s_add_u32 m0, s90, 24576
    v_mfma_f32_16x16x32_bf16 v[20:23], a[8:11], v[88:91], v[20:23]
    s_waitcnt vmcnt(9)
    s_mov_b32 s92, 74112
    ds_read_b64_tr_b16 a[16:17], v4 offset:49152
    v_mfma_f32_16x16x32_bf16 v[20:23], a[12:15], v[64:67], v[20:23]
    ds_read_b64_tr_b16 a[18:19], v4 offset:49920
    v_mfma_f32_16x16x32_bf16 v[84:87], a[32:35], v[88:91], v[84:87]
    ds_read_b64_tr_b16 a[40:41], v4 offset:49184
    v_mfma_f32_16x16x32_bf16 v[84:87], a[36:39], v[64:67], v[84:87]
    ds_read_b64_tr_b16 a[42:43], v4 offset:49952
    buffer_load_dwordx4 v121, s[32:35], s92 offen offset:0 lds
    v_mfma_f32_16x16x32_bf16 v[68:71], a[56:59], v[88:91], v[68:71]
    ds_read_b64_tr_b16 a[64:65], v4 offset:49216
    v_mfma_f32_16x16x32_bf16 v[68:71], a[60:63], v[64:67], v[68:71]
    ds_read_b64_tr_b16 a[66:67], v4 offset:49984
    v_mfma_f32_16x16x32_bf16 v[144:147], a[8:11], v[36:39], v[144:147]
    ds_read_b128 v[116:119], v103 offset:41216
    v_mfma_f32_16x16x32_bf16 v[144:147], a[12:15], v[28:31], v[144:147]
    ds_read_b128 v[108:111], v103 offset:42752
    v_mfma_f32_16x16x32_bf16 v[148:151], a[32:35], v[36:39], v[148:151]
    ds_read_b128 v[88:91], v103 offset:256
    buffer_load_dwordx4 v61, s[32:35], s92 offen offset:1024 lds
    v_mfma_f32_16x16x32_bf16 v[148:151], a[36:39], v[28:31], v[148:151]
    ds_read_b128 v[64:67], v103 offset:1792
    v_mfma_f32_16x16x32_bf16 v[104:107], a[56:59], v[36:39], v[104:107]
    ds_read_b128 v[36:39], v103 offset:3328
    v_mfma_f32_16x16x32_bf16 v[104:107], a[60:63], v[28:31], v[104:107]
    s_waitcnt lgkmcnt(8)
    ds_read_b128 v[28:31], v6 offset:41216
    v_mfma_f32_16x16x32_bf16 v[80:83], a[8:11], v[140:143], v[80:83]
    ds_read_b128 v[112:115], v6 offset:42752
    v_mov_b32 v15, 0
    v_mfma_f32_16x16x32_bf16 v[80:83], a[12:15], v[24:27], v[80:83]
    ds_read_b32 v204, v204 offset:336
    buffer_load_dwordx4 v14, s[32:35], s92 offen offset:2048 lds
    v_mfma_f32_16x16x32_bf16 v[16:19], a[32:35], v[140:143], v[16:19]
    s_add_u32 m0, s90, 36864
    v_mfma_f32_16x16x32_bf16 v[16:19], a[36:39], v[24:27], v[16:19]
    s_waitcnt vmcnt(9)
    s_mov_b32 s92, 110976
    ds_read_b64_tr_b16 a[20:21], v4 offset:61440
    v_mfma_f32_16x16x32_bf16 v[72:75], a[56:59], v[140:143], v[72:75]
    ds_read_b64_tr_b16 a[22:23], v4 offset:62208
    v_mfma_f32_16x16x32_bf16 v[72:75], a[60:63], v[24:27], v[72:75]
    ds_read_b64_tr_b16 a[44:45], v4 offset:61472
    ds_read_b64_tr_b16 a[46:47], v4 offset:62240
    ds_read_b64_tr_b16 a[68:69], v4 offset:61504
    buffer_load_dwordx4 v121, s[32:35], s92 offen offset:0 lds
    ds_read_b64_tr_b16 a[70:71], v4 offset:62272
    ds_read_b128 v[24:27], v6 offset:256
    s_waitcnt lgkmcnt(9)
    v_mfma_f32_16x16x32_bf16 v[76:79], a[16:19], v[28:31], v[76:79]
    ds_read_b32 v205, v205 offset:336
    v_mfma_f32_16x16x32_bf16 v[40:43], a[40:43], v[28:31], v[40:43]
    v_mfma_f32_16x16x32_bf16 v[96:99], a[64:67], v[28:31], v[96:99]
    s_waitcnt lgkmcnt(8)
    ds_read_b32 v206, v206 offset:336
    v_mfma_f32_16x16x32_bf16 v[56:59], a[16:19], v[112:115], v[56:59]
    buffer_load_dwordx4 v61, s[32:35], s92 offen offset:1024 lds
    v_mfma_f32_16x16x32_bf16 v[52:55], a[40:43], v[112:115], v[52:55]
    s_waitcnt lgkmcnt(7)
    ds_read_b128 v[28:31], v6 offset:1792
    v_mfma_f32_16x16x32_bf16 v[76:79], a[20:23], v[116:119], v[76:79]
    ds_read_b32 v207, v207 offset:336
    v_mfma_f32_16x16x32_bf16 v[56:59], a[20:23], v[108:111], v[56:59]
    s_waitcnt lgkmcnt(6)
    s_nop 0
    v_mfma_f32_16x16x32_bf16 v[40:43], a[44:47], v[116:119], v[40:43]
    s_waitcnt lgkmcnt(4)
    s_nop 0
    ds_read_b32 v200, v200 offset:336
    v_cvt_pk_f16_f32 v76, v76, v77
    v_mfma_f32_16x16x32_bf16 v[96:99], a[68:71], v[116:119], v[96:99]
    buffer_load_dwordx4 v14, s[32:35], s92 offen offset:2048 lds
    v_cvt_pk_f16_f32 v77, v78, v79
    v_mfma_f32_16x16x32_bf16 v[52:55], a[44:47], v[108:111], v[52:55]
    s_waitcnt vmcnt(9)
    s_add_u32 m0, s90, 49152
    ds_read_b64_tr_b16 a[72:73], v4 offset:0
    v_pk_fma_f16 v120, v76, v76, s39
    v_mfma_f32_16x16x32_bf16 v[32:35], a[64:67], v[112:115], v[32:35]
    s_mov_b32 s92, 147840
    ds_read_b64_tr_b16 a[74:75], v4 offset:768
    v_pk_fmac_f16 v120, v77, v77
    v_mfma_f32_16x16x32_bf16 v[32:35], a[68:71], v[108:111], v[32:35]
    ds_read_b64_tr_b16 a[96:97], v4 offset:32
    v_cvt_pk_f16_f32 v78, v40, v41
    v_mfma_f32_16x16x32_bf16 v[20:23], a[16:19], v[24:27], v[20:23]
    ds_read_b64_tr_b16 a[98:99], v4 offset:800
    v_cvt_pk_f16_f32 v79, v42, v43
    v_mfma_f32_16x16x32_bf16 v[20:23], a[20:23], v[88:91], v[20:23]
    buffer_load_dwordx4 v121, s[32:35], s92 offen offset:0 lds
    ds_read_b64_tr_b16 a[120:121], v4 offset:64
    v_mfma_f32_16x16x32_bf16 v[84:87], a[40:43], v[24:27], v[84:87]
    ds_read_b64_tr_b16 a[122:123], v4 offset:832
    v_pk_fmac_f16 v120, v78, v78
    v_mfma_f32_16x16x32_bf16 v[84:87], a[44:47], v[88:91], v[84:87]
    ds_read_b128 v[40:43], v6 offset:3328
    v_pk_fmac_f16 v120, v79, v79
    v_mfma_f32_16x16x32_bf16 v[68:71], a[64:67], v[24:27], v[68:71]
    ds_read_b128 v[24:27], v6 offset:40960
    v_cvt_pk_f16_f32 v12, v96, v97
    v_mfma_f32_16x16x32_bf16 v[68:71], a[68:71], v[88:91], v[68:71]
    s_waitcnt lgkmcnt(8)
    ds_read_b32 v201, v201 offset:336
    v_cvt_pk_f16_f32 v13, v98, v99
    v_mfma_f32_16x16x32_bf16 v[144:147], a[16:19], v[28:31], v[144:147]
    buffer_load_dwordx4 v61, s[32:35], s92 offen offset:1024 lds
    v_pk_fmac_f16 v120, v12, v12
    v_mfma_f32_16x16x32_bf16 v[144:147], a[20:23], v[64:67], v[144:147]
    ds_read_b128 v[88:91], v6 offset:42496
    v_pk_fmac_f16 v120, v13, v13
    v_mfma_f32_16x16x32_bf16 v[148:151], a[40:43], v[28:31], v[148:151]
    ds_read_b32 v202, v202 offset:336
    v_cvt_pk_f16_f32 v56, v56, v57
    v_mfma_f32_16x16x32_bf16 v[148:151], a[44:47], v[64:67], v[148:151]
    v_cvt_pk_f16_f32 v57, v58, v59
    v_pk_fma_f16 v122, v56, v56, s39
    v_mfma_f32_16x16x32_bf16 v[104:107], a[64:67], v[28:31], v[104:107]
    ds_read_b128 v[28:31], v6 offset:0
    v_pk_fmac_f16 v122, v57, v57
    v_mfma_f32_16x16x32_bf16 v[104:107], a[68:71], v[64:67], v[104:107]
    s_waitcnt vmcnt(8) lgkmcnt(5)
    buffer_load_dwordx4 v14, s[32:35], s92 offen offset:2048 lds
    ds_read_b64_tr_b16 a[76:77], v4 offset:12288
    v_cvt_pk_f16_f32 v58, v52, v53
    v_mfma_f32_16x16x32_bf16 v[80:83], a[16:19], v[40:43], v[80:83]
    s_add_u32 m0, s90, 61440
    ds_read_b64_tr_b16 a[78:79], v4 offset:13056
    v_cvt_pk_f16_f32 v59, v54, v55
    v_mfma_f32_16x16x32_bf16 v[80:83], a[20:23], v[36:39], v[80:83]
    s_mov_b32 s92, 184704
    ds_read_b64_tr_b16 a[100:101], v4 offset:12320
    v_pk_fmac_f16 v122, v58, v58
    v_mfma_f32_16x16x32_bf16 v[16:19], a[40:43], v[40:43], v[16:19]
    ds_read_b64_tr_b16 a[102:103], v4 offset:13088
    v_pk_fmac_f16 v122, v59, v59
    v_mfma_f32_16x16x32_bf16 v[16:19], a[44:47], v[36:39], v[16:19]
    ds_read_b64_tr_b16 a[124:125], v4 offset:12352
    v_cvt_pk_f16_f32 v44, v32, v33
    v_mfma_f32_16x16x32_bf16 v[72:75], a[64:67], v[40:43], v[72:75]
    buffer_load_dwordx4 v121, s[32:35], s92 offen offset:0 lds
    ds_read_b64_tr_b16 a[126:127], v4 offset:13120
    v_mfma_f32_16x16x32_bf16 v[72:75], a[68:71], v[36:39], v[72:75]
    s_waitcnt lgkmcnt(7)
    ds_read_b128 v[64:67], v6 offset:1536
    v_cvt_pk_f16_f32 v45, v34, v35
    v_mfma_f32_16x16x32_bf16 v[52:55], a[72:75], v[24:27], 0
    ds_read_b128 v[224:227], v6 offset:3072
    v_pk_fmac_f16 v122, v44, v44
    v_mfma_f32_16x16x32_bf16 v[116:119], a[96:99], v[24:27], 0
    ds_read_b128 v[32:35], v103 offset:40960
    v_pk_fmac_f16 v122, v45, v45
    v_mfma_f32_16x16x32_bf16 v[40:43], a[120:123], v[24:27], 0
    ds_read_b32 v203, v203 offset:336
    v_cvt_pk_f16_f32 v112, v20, v21
    v_mfma_f32_16x16x32_bf16 v[36:39], a[72:75], v[88:91], 0
    buffer_load_dwordx4 v61, s[32:35], s92 offen offset:1024 lds
    v_cvt_pk_f16_f32 v113, v22, v23
    v_mfma_f32_16x16x32_bf16 v[232:235], a[96:99], v[88:91], 0
    ds_read_b128 v[96:99], v103 offset:42496
    v_pk_fma_f16 v140, v112, v112, s39
    v_mfma_f32_16x16x32_bf16 v[24:27], a[120:123], v[88:91], 0
    s_waitcnt lgkmcnt(7)
    ds_read_b32 v196, v196 offset:336
    v_pk_fmac_f16 v140, v113, v113
    v_mfma_f32_16x16x32_bf16 v[164:167], a[72:75], v[28:31], 0
    v_cvt_pk_f16_f32 v114, v84, v85
    v_cvt_pk_f16_f32 v115, v86, v87
    v_mfma_f32_16x16x32_bf16 v[160:163], a[96:99], v[28:31], 0
    ds_read_b128 v[108:111], v103 offset:0
    v_pk_fmac_f16 v140, v114, v114
    v_mfma_f32_16x16x32_bf16 v[88:91], a[120:123], v[28:31], 0
    s_waitcnt vmcnt(8) lgkmcnt(6)
    buffer_load_dwordx4 v14, s[32:35], s92 offen offset:2048 lds
    ds_read_b64_tr_b16 a[80:81], v4 offset:24576
    v_mfma_f32_16x16x32_bf16 v[28:31], a[72:75], v[64:67], 0
    s_waitcnt lgkmcnt(5)
    s_add_u32 m0, s90, 0
    ds_read_b64_tr_b16 a[82:83], v4 offset:25344
    v_pk_fmac_f16 v140, v115, v115
    v_cvt_pk_f16_f32 v154, v68, v69
    v_mfma_f32_16x16x32_bf16 v[52:55], a[76:79], v[32:35], v[52:55]
    s_mov_b32 s92, 768
    ds_read_b64_tr_b16 a[104:105], v4 offset:24608
    v_cvt_pk_f16_f32 v155, v70, v71
    v_mfma_f32_16x16x32_bf16 v[116:119], a[100:103], v[32:35], v[116:119]
    ds_read_b64_tr_b16 a[106:107], v4 offset:25376
    v_pk_fmac_f16 v140, v154, v154
    v_mfma_f32_16x16x32_bf16 v[40:43], a[124:127], v[32:35], v[40:43]
    ds_read_b64_tr_b16 a[128:129], v4 offset:24640
    v_pk_fmac_f16 v140, v155, v155
    v_mfma_f32_16x16x32_bf16 v[168:171], a[96:99], v[64:67], 0
    buffer_load_dwordx4 v121, s[32:35], s92 offen offset:0 lds
    ds_read_b64_tr_b16 a[130:131], v4 offset:25408
    v_mfma_f32_16x16x32_bf16 v[32:35], a[120:123], v[64:67], 0
    ds_read_b128 v[68:71], v103 offset:1536
    v_cvt_pk_f16_f32 v20, v144, v145
    v_mfma_f32_16x16x32_bf16 v[84:87], a[72:75], v[224:227], 0
    s_waitcnt lgkmcnt(7)
    ds_read_b128 v[64:67], v103 offset:3072
    v_cvt_pk_f16_f32 v21, v146, v147
    v_mfma_f32_16x16x32_bf16 v[36:39], a[76:79], v[96:99], v[36:39]
    ds_read_b128 v[144:147], v6 offset:41088
    v_pk_fma_f16 v142, v20, v20, s39
    v_mfma_f32_16x16x32_bf16 v[232:235], a[100:103], v[96:99], v[232:235]
    ds_read_b32 v197, v197 offset:336
    v_pk_fmac_f16 v142, v21, v21
    v_mfma_f32_16x16x32_bf16 v[24:27], a[124:127], v[96:99], v[24:27]
    buffer_load_dwordx4 v61, s[32:35], s92 offen offset:1024 lds
    v_cvt_pk_f16_f32 v22, v148, v149
    v_mfma_f32_16x16x32_bf16 v[164:167], a[76:79], v[108:111], v[164:167]
    ds_read_b128 v[96:99], v6 offset:42624
    v_cvt_pk_f16_f32 v23, v150, v151
    v_mfma_f32_16x16x32_bf16 v[160:163], a[100:103], v[108:111], v[160:163]
    ds_read_b32 v198, v198 offset:336
    v_pk_fmac_f16 v142, v22, v22
    v_mfma_f32_16x16x32_bf16 v[88:91], a[124:127], v[108:111], v[88:91]
    v_pk_fmac_f16 v142, v23, v23
    v_cvt_pk_f16_f32 v150, v104, v105
    v_cvt_pk_f16_f32 v151, v106, v107
    v_pk_fmac_f16 v142, v150, v150
    v_pk_fmac_f16 v142, v151, v151
    v_mfma_f32_16x16x32_bf16 v[108:111], a[96:99], v[224:227], 0
    s_waitcnt vmcnt(8)
    buffer_load_dwordx4 v14, s[32:35], s92 offen offset:2048 lds
    ds_read_b64_tr_b16 a[84:85], v4 offset:36864
    v_mfma_f32_16x16x32_bf16 v[104:107], a[120:123], v[224:227], 0
    s_waitcnt lgkmcnt(5)
    s_add_u32 m0, s90, 12288
    ds_read_b64_tr_b16 a[86:87], v4 offset:37632
    v_cvt_pk_f16_f32 v224, v80, v81
    v_mfma_f32_16x16x32_bf16 v[28:31], a[76:79], v[68:71], v[28:31]
    s_mov_b32 s92, 37632
    ds_read_b64_tr_b16 a[108:109], v4 offset:36896
    v_cvt_pk_f16_f32 v225, v82, v83
    v_mfma_f32_16x16x32_bf16 v[168:171], a[100:103], v[68:71], v[168:171]
    ds_read_b64_tr_b16 a[110:111], v4 offset:37664
    v_pk_fma_f16 v60, v224, v224, s39
    v_mfma_f32_16x16x32_bf16 v[32:35], a[124:127], v[68:71], v[32:35]
    ds_read_b64_tr_b16 a[132:133], v4 offset:36928
    v_pk_fmac_f16 v60, v225, v225
    v_mfma_f32_16x16x32_bf16 v[84:87], a[76:79], v[64:67], v[84:87]
    buffer_load_dwordx4 v121, s[32:35], s92 offen offset:0 lds
    ds_read_b64_tr_b16 a[134:135], v4 offset:37696
    v_mfma_f32_16x16x32_bf16 v[108:111], a[100:103], v[64:67], v[108:111]
    ds_read_b128 v[68:71], v6 offset:128
    v_cvt_pk_f16_f32 v226, v16, v17
    v_mfma_f32_16x16x32_bf16 v[104:107], a[124:127], v[64:67], v[104:107]
    s_waitcnt lgkmcnt(7)
    ds_read_b128 v[64:67], v6 offset:1664
    v_cvt_pk_f16_f32 v227, v18, v19
    v_mfma_f32_16x16x32_bf16 v[52:55], a[80:83], v[144:147], v[52:55]
    ds_read_b128 v[16:19], v6 offset:3200
    v_pk_fmac_f16 v60, v226, v226
    v_mfma_f32_16x16x32_bf16 v[116:119], a[104:107], v[144:147], v[116:119]
    ds_read_b128 v[80:83], v103 offset:41088
    v_pk_fmac_f16 v60, v227, v227
    v_mfma_f32_16x16x32_bf16 v[40:43], a[128:131], v[144:147], v[40:43]
    buffer_load_dwordx4 v61, s[32:35], s92 offen offset:1024 lds
    ds_read_b32 v199, v199 offset:336
    v_mfma_f32_16x16x32_bf16 v[36:39], a[80:83], v[96:99], v[36:39]
    v_cvt_pk_f16_f32 v146, v72, v73
    v_cvt_pk_f16_f32 v147, v74, v75
    v_mfma_f32_16x16x32_bf16 v[232:235], a[104:107], v[96:99], v[232:235]
    ds_read_b128 v[72:75], v103 offset:42624
    v_pk_fmac_f16 v60, v146, v146
    v_mfma_f32_16x16x32_bf16 v[24:27], a[128:131], v[96:99], v[24:27]
    s_waitcnt lgkmcnt(5)
    ds_read_b32 v208, v62
    v_pk_fmac_f16 v60, v147, v147
    ds_read_b32 v211, v152 offset:672
    v_mfma_f32_16x16x32_bf16 v[164:167], a[80:83], v[68:71], v[164:167]
    buffer_load_dwordx4 v14, s[32:35], s92 offen offset:2048 lds
    v_mfma_f32_16x16x32_bf16 v[160:163], a[104:107], v[68:71], v[160:163]
    s_waitcnt vmcnt(9)
    s_add_u32 m0, s90, 24576
    ds_read_b64_tr_b16 a[88:89], v4 offset:49152
    v_mfma_f32_16x16x32_bf16 v[88:91], a[128:131], v[68:71], v[88:91]
    s_waitcnt lgkmcnt(5)
    s_mov_b32 s92, 74496
    ds_read_b64_tr_b16 a[90:91], v4 offset:49920
    v_mfma_f32_16x16x32_bf16 v[28:31], a[80:83], v[64:67], v[28:31]
    ds_read_b64_tr_b16 a[112:113], v4 offset:49184
    v_mfma_f32_16x16x32_bf16 v[168:171], a[104:107], v[64:67], v[168:171]
    ds_read_b64_tr_b16 a[114:115], v4 offset:49952
    v_mfma_f32_16x16x32_bf16 v[32:35], a[128:131], v[64:67], v[32:35]
    buffer_load_dwordx4 v121, s[32:35], s92 offen offset:0 lds
    ds_read_b64_tr_b16 a[136:137], v4 offset:49216
    v_mfma_f32_16x16x32_bf16 v[84:87], a[80:83], v[16:19], v[84:87]
    ds_read_b64_tr_b16 a[138:139], v4 offset:49984
    v_mfma_f32_16x16x32_bf16 v[108:111], a[104:107], v[16:19], v[108:111]
    ds_read_b128 v[68:71], v103 offset:128
    v_mfma_f32_16x16x32_bf16 v[104:107], a[128:131], v[16:19], v[104:107]
    ds_read_b128 v[16:19], v103 offset:1664
    v_mfma_f32_16x16x32_bf16 v[52:55], a[84:87], v[80:83], v[52:55]
    ds_read_b128 v[64:67], v103 offset:3200
    v_mfma_f32_16x16x32_bf16 v[116:119], a[108:111], v[80:83], v[116:119]
    buffer_load_dwordx4 v61, s[32:35], s92 offen offset:1024 lds
    ds_read_b128 v[96:99], v6 offset:41216
    v_mfma_f32_16x16x32_bf16 v[40:43], a[132:135], v[80:83], v[40:43]
    s_waitcnt lgkmcnt(8)
    s_cmp_ge_u32 s2, 247
    s_cbranch_scc1 L_maskF
L_nomaskF:
    v_mfma_f32_16x16x32_bf16 v[36:39], a[84:87], v[72:75], v[36:39]
    ds_read_b128 v[80:83], v6 offset:42752
    v_mfma_f32_16x16x32_bf16 v[232:235], a[108:111], v[72:75], v[232:235]
    v_mfma_f32_16x16x32_bf16 v[24:27], a[132:135], v[72:75], v[24:27]
    s_waitcnt vmcnt(8) lgkmcnt(4)
    buffer_load_dwordx4 v14, s[32:35], s92 offen offset:2048 lds
    ds_read_b64_tr_b16 a[92:93], v4 offset:61440
    s_add_u32 m0, s90, 36864
    s_mov_b32 s92, 111360
    ds_read_b64_tr_b16 a[94:95], v4 offset:62208
    v_mfma_f32_16x16x32_bf16 v[164:167], a[84:87], v[68:71], v[164:167]
    s_mov_b32 s53, s47
    ds_read_b64_tr_b16 a[116:117], v4 offset:61472
    v_readlane_b32 s84, v211, 48
    v_mfma_f32_16x16x32_bf16 v[160:163], a[108:111], v[68:71], v[160:163]
    s_mov_b32 s47, s46
    ds_read_b64_tr_b16 a[118:119], v4 offset:62240
    v_mov_b32 v123, 0xf149f2ca
    v_mfma_f32_16x16x32_bf16 v[88:91], a[132:135], v[68:71], v[88:91]
    s_waitcnt lgkmcnt(6)
    s_mov_b32 s46, s45
    ds_read_b64_tr_b16 a[140:141], v4 offset:61504
    v_cmp_gt_u32 vcc, 16, v9
    v_mfma_f32_16x16x32_bf16 v[28:31], a[84:87], v[16:19], v[28:31]
    s_mov_b32 s45, s44
    ds_read_b64_tr_b16 a[142:143], v4 offset:62272
    buffer_load_dwordx4 v121, s[32:35], s92 offen offset:0 lds
    v_mfma_f32_16x16x32_bf16 v[168:171], a[108:111], v[16:19], v[168:171]
    s_mov_b32 s44, s53
    ds_read_b128 v[72:75], v6 offset:256
    v_cndmask_b32 v208, v123, v208, vcc
    v_mfma_f32_16x16x32_bf16 v[32:35], a[132:135], v[16:19], v[32:35]
    s_sub_u32 s48, s44, s46
    ds_read_b128 v[16:19], v6 offset:1792
    v_cndmask_b32 v209, v123, v209, vcc
    v_mfma_f32_16x16x32_bf16 v[84:87], a[84:87], v[64:67], v[84:87]
    s_sub_u32 s49, s46, s45
    ds_read_b128 v[68:71], v6 offset:3328
    v_cndmask_b32 v210, v123, v210, vcc
    v_mfma_f32_16x16x32_bf16 v[108:111], a[108:111], v[64:67], v[108:111]
    s_sub_u32 s50, s45, s44
    v_cmp_gt_u32 vcc, 49, v9
    v_add_u32 v139, s48, v139
    v_mfma_f32_16x16x32_bf16 v[104:107], a[132:135], v[64:67], v[104:107]
    s_waitcnt lgkmcnt(7)
    s_sub_u32 s51, s46, s47
    v_cndmask_b32 v211, v123, v211, vcc
    v_add_u32 v138, s48, v138
    v_mfma_f32_16x16x32_bf16 v[52:55], a[88:91], v[96:99], v[52:55]
    s_mov_b32 s60, s59
    buffer_load_dwordx4 v61, s[32:35], s92 offen offset:1024 lds
    ds_read_b128 v[64:67], v103 offset:41216
    v_mfma_f32_16x16x32_bf16 v[116:119], a[112:115], v[96:99], v[116:119]
    s_mov_b32 s59, s58
    v_add_u32 v137, s49, v137
    v_add_u32 v136, s49, v136
    v_mfma_f32_16x16x32_bf16 v[40:43], a[136:139], v[96:99], v[40:43]
    s_mov_b32 s58, s57
    v_add_u32 v139, s50, v139
    v_add_u32 v138, s50, v138
    v_mfma_f32_16x16x32_bf16 v[36:39], a[88:91], v[80:83], v[36:39]
    s_mov_b32 s57, s56
    ds_read_b128 v[244:247], v103 offset:42752
    v_add_u32 v137, s48, v137
    v_mfma_f32_16x16x32_bf16 v[232:235], a[112:115], v[80:83], v[232:235]
    s_mov_b32 s7, s6
    v_add_u32 v136, s48, v136
    v_add_u32 v135, s51, v135
    v_mfma_f32_16x16x32_bf16 v[24:27], a[136:139], v[80:83], v[24:27]
    s_waitcnt vmcnt(8) lgkmcnt(3)
    s_mov_b32 s6, s5
    ds_read_b64_tr_b16 a[144:145], v5 offset:0
    buffer_load_dwordx4 v14, s[32:35], s92 offen offset:2048 lds
    v_mfma_f32_16x16x32_bf16 v[164:167], a[88:91], v[72:75], v[164:167]
    s_add_u32 m0, s90, 49152
    ds_read_b64_tr_b16 a[146:147], v5 offset:768
    v_mfma_f32_16x16x32_bf16 v[160:163], a[112:115], v[72:75], v[160:163]
    s_mov_b32 s92, 148224
    ds_read_b64_tr_b16 a[168:169], v5 offset:8
    v_mfma_f32_16x16x32_bf16 v[88:91], a[136:139], v[72:75], v[88:91]
    s_mov_b32 s5, s4
    ds_read_b64_tr_b16 a[170:171], v5 offset:776
    v_mfma_f32_16x16x32_bf16 v[28:31], a[88:91], v[16:19], v[28:31]
    s_sub_u32 s14, s6, s7
    ds_read_b64_tr_b16 a[192:193], v4 offset:64
    buffer_load_dwordx4 v121, s[32:35], s92 offen offset:0 lds
    v_mfma_f32_16x16x32_bf16 v[168:171], a[112:115], v[16:19], v[168:171]
    s_add_u32 s61, s61, 1
    ds_read_b64_tr_b16 a[194:195], v4 offset:832
    v_add_u32 v134, s14, v134
    v_mfma_f32_16x16x32_bf16 v[32:35], a[136:139], v[16:19], v[32:35]
    s_waitcnt lgkmcnt(7)
    s_add_u32 s12, s12, 20
    ds_read_b128 v[240:243], v103 offset:256
    v_add_u32 v133, s14, v133
    v_mfma_f32_16x16x32_bf16 v[84:87], a[88:91], v[68:71], v[84:87]
    s_max_u32 s12, s12, s61
    ds_read_b128 v[16:19], v103 offset:1792
    v_mfma_f32_16x16x32_bf16 v[108:111], a[112:115], v[68:71], v[108:111]
    s_add_u32 s65, s65, 1
    ds_read_b128 v[228:231], v103 offset:3328
    v_mfma_f32_16x16x32_bf16 v[104:107], a[136:139], v[68:71], v[104:107]
    s_cmp_ge_i32 s65, 2
    buffer_load_dwordx4 v61, s[32:35], s92 offen offset:1024 lds
    v_mfma_f32_16x16x32_bf16 v[52:55], a[92:95], v[64:67], v[52:55]
    s_cselect_b32 s30, 100270464, 0
    ds_read_b128 v[80:83], v6 offset:3072
    v_mov_b32 v62, 0
    v_mfma_f32_16x16x32_bf16 v[116:119], a[116:119], v[64:67], v[116:119]
    s_add_u32 s67, s46, s54
    ds_read_b128 v[72:75], v103 offset:3072
    v_mov_b32 v63, 0
    v_mfma_f32_16x16x32_bf16 v[40:43], a[140:143], v[64:67], v[40:43]
    s_waitcnt lgkmcnt(7)
    ds_read_b128 v[68:71], v6 offset:3200
    v_cvt_pk_f16_f32 v96, v52, v53
    v_mfma_f32_16x16x32_bf16 v[36:39], a[92:95], v[244:247], v[36:39]
    ds_read_b128 v[64:67], v103 offset:3200
    v_cvt_pk_f16_f32 v97, v54, v55
    v_mfma_f32_16x16x32_bf16 v[232:235], a[116:119], v[244:247], v[232:235]
    ds_read_b128 v[52:55], v6 offset:3328
    buffer_load_dwordx4 v14, s[32:35], s92 offen offset:2048 lds
    v_mfma_f32_16x16x32_bf16 v[24:27], a[140:143], v[244:247], v[24:27]
    s_waitcnt vmcnt(9) lgkmcnt(7)
    s_add_u32 m0, s90, 61440
    ds_read_b64_tr_b16 a[148:149], v5 offset:12288
    v_cvt_pk_f16_f32 v36, v36, v37
    v_mfma_f32_16x16x32_bf16 v[164:167], a[92:95], v[240:243], v[164:167]
    s_mov_b32 s92, 185088
    ds_read_b64_tr_b16 a[150:151], v5 offset:13056
    v_cvt_pk_f16_f32 v37, v38, v39
    v_mfma_f32_16x16x32_bf16 v[160:163], a[116:119], v[240:243], v[160:163]
    ds_read_b64_tr_b16 a[172:173], v5 offset:12296
    v_pk_fma_f16 v123, v36, v36, s39
    v_mfma_f32_16x16x32_bf16 v[88:91], a[140:143], v[240:243], v[88:91]
    s_waitcnt lgkmcnt(8)
    ds_read_b64_tr_b16 a[174:175], v5 offset:13064
    v_pk_fmac_f16 v123, v37, v37
    v_mfma_f32_16x16x32_bf16 v[28:31], a[92:95], v[16:19], v[28:31]
    ds_read_b64_tr_b16 a[196:197], v4 offset:12352
    buffer_load_dwordx4 v121, s[32:35], s92 offen offset:0 lds
    v_mfma_f32_16x16x32_bf16 v[168:171], a[116:119], v[16:19], v[168:171]
    ds_read_b64_tr_b16 a[198:199], v4 offset:13120
    v_cvt_pk_f16_f32 v38, v232, v233
    v_mfma_f32_16x16x32_bf16 v[32:35], a[140:143], v[16:19], v[32:35]
    ds_read_b128 v[16:19], v103 offset:3328
    v_cvt_pk_f16_f32 v39, v234, v235
    v_mfma_f32_16x16x32_bf16 v[84:87], a[92:95], v[228:231], v[84:87]
    v_pk_fmac_f16 v123, v38, v38
    v_pk_fmac_f16 v123, v39, v39
    v_mfma_f32_16x16x32_bf16 v[108:111], a[116:119], v[228:231], v[108:111]
    v_cvt_pk_f16_f32 v24, v24, v25
    v_cvt_pk_f16_f32 v25, v26, v27
    v_mfma_f32_16x16x32_bf16 v[104:107], a[140:143], v[228:231], v[104:107]
    v_pk_fmac_f16 v123, v24, v24
    v_pk_fmac_f16 v123, v25, v25
    v_cvt_pk_f16_f32 v28, v28, v29
    v_cvt_pk_f16_f32 v29, v30, v31
    buffer_load_dwordx4 v61, s[32:35], s92 offen offset:1024 lds
    v_pk_fma_f16 v143, v28, v28, s39
    v_pk_fmac_f16 v143, v29, v29
    v_cvt_pk_f16_f32 v30, v168, v169
    v_cvt_pk_f16_f32 v31, v170, v171
    v_pk_fmac_f16 v143, v30, v30
    v_pk_fmac_f16 v143, v31, v31
    v_cvt_pk_f16_f32 v32, v32, v33
    v_cvt_pk_f16_f32 v33, v34, v35
    v_pk_fmac_f16 v143, v32, v32
    v_pk_fmac_f16 v143, v33, v33
    v_cvt_pk_f16_f32 v244, v164, v165
    v_cvt_pk_f16_f32 v245, v166, v167
    v_pk_fma_f16 v141, v244, v244, s39
    v_pk_fmac_f16 v141, v245, v245
    s_waitcnt vmcnt(8)
    ds_read_b64_tr_b16 a[152:153], v5 offset:24576
    buffer_load_dwordx4 v14, s[32:35], s92 offen offset:2048 lds
    s_add_u32 m0, s90, 0
    s_mov_b32 s92, 0
    ds_read_b64_tr_b16 a[154:155], v5 offset:25344
    v_cvt_pk_f16_f32 v246, v160, v161
    v_cvt_pk_f16_f32 v247, v162, v163
    v_pk_fmac_f16 v141, v246, v246
    ds_read_b64_tr_b16 a[176:177], v5 offset:24584
    v_pk_fmac_f16 v141, v247, v247
    v_cvt_pk_f16_f32 v248, v88, v89
    v_cvt_pk_f16_f32 v249, v90, v91
    ds_read_b64_tr_b16 a[178:179], v5 offset:25352
    v_pk_fmac_f16 v141, v248, v248
    ds_read_b64_tr_b16 a[200:201], v4 offset:24640
    buffer_load_dwordx4 v46, s[76:79], s92 offen offset:0 lds
    ds_read_b64_tr_b16 a[202:203], v4 offset:25408
    v_pk_fmac_f16 v141, v249, v249
    v_pk_fma_f16 v121, v96, v96, s39
    v_pk_fmac_f16 v121, v97, v97
    v_mfma_f32_16x16x32_f16 v[88:91], v[212:215], v[140:143], 0
    v_cvt_pk_f16_f32 v98, v116, v117
    v_cvt_pk_f16_f32 v99, v118, v119
    v_pk_fmac_f16 v121, v98, v98
    v_pk_fmac_f16 v121, v99, v99
    v_cvt_pk_f16_f32 v40, v40, v41
    v_cvt_pk_f16_f32 v41, v42, v43
    v_pk_fmac_f16 v121, v40, v40
    v_pk_fmac_f16 v121, v41, v41
    v_cvt_pk_f16_f32 v118, v84, v85
    v_cvt_pk_f16_f32 v119, v86, v87
    v_mfma_f32_16x16x32_f16 v[84:87], v[212:215], v[120:123], 0
    s_nop 0
    buffer_load_dwordx4 v158, s[76:79], s92 offen offset:1024 lds
    v_pk_fma_f16 v61, v118, v118, s39
    v_pk_fmac_f16 v61, v119, v119
    v_cvt_pk_f16_f32 v120, v108, v109
    v_cvt_pk_f16_f32 v121, v110, v111
    v_pk_fmac_f16 v61, v120, v120
    v_pk_fmac_f16 v61, v121, v121
    v_or3_b32 v125, v125, v84, v85
    v_rsq_f32 v84, v84
    v_rsq_f32 v85, v85
    v_mul_f32 v84, s52, v84
    v_cvt_pk_f16_f32 v84, v84, v85
    v_or3_b32 v125, v125, v86, v87
    v_rsq_f32 v86, v86
    v_rsq_f32 v87, v87
    s_waitcnt vmcnt(8)
    ds_read_b64_tr_b16 a[156:157], v5 offset:36864
    buffer_load_dwordx4 v47, s[76:79], s92 offen offset:2048 lds
    s_add_u32 m0, s90, 12288
    s_mov_b32 s92, 12288
    ds_read_b64_tr_b16 a[158:159], v5 offset:37632
    v_mul_f32 v86, s52, v86
    v_cvt_pk_f16_f32 v86, v86, v87
    v_pk_mul_f16 v76, v76, v84 op_sel:[0,0] op_sel_hi:[1,0]
    ds_read_b64_tr_b16 a[180:181], v5 offset:36872
    v_pk_mul_f16 v77, v77, v84 op_sel:[0,0] op_sel_hi:[1,0]
    v_pk_mul_f16 v78, v78, v84 op_sel:[0,0] op_sel_hi:[1,0]
    v_pk_mul_f16 v79, v79, v84 op_sel:[0,0] op_sel_hi:[1,0]
    ds_read_b64_tr_b16 a[182:183], v5 offset:37640
    s_waitcnt lgkmcnt(4)
    buffer_load_dwordx4 v46, s[76:79], s92 offen offset:0 lds
    v_pk_mul_f16 v12, v12, v84 op_sel:[0,0] op_sel_hi:[1,0]
    v_pk_mul_f16 v13, v13, v84 op_sel:[0,0] op_sel_hi:[1,0]
    ds_read_b64_tr_b16 a[204:205], v4 offset:36928
    v_pk_mul_f16 v96, v96, v84 op_sel:[0,1] op_sel_hi:[1,1]
    ds_read_b64_tr_b16 a[206:207], v4 offset:37696
    v_pk_mul_f16 v97, v97, v84 op_sel:[0,1] op_sel_hi:[1,1]
    v_pk_mul_f16 v98, v98, v84 op_sel:[0,1] op_sel_hi:[1,1]
    v_pk_mul_f16 v99, v99, v84 op_sel:[0,1] op_sel_hi:[1,1]
    v_pk_mul_f16 v40, v40, v84 op_sel:[0,1] op_sel_hi:[1,1]
    v_pk_mul_f16 v41, v41, v84 op_sel:[0,1] op_sel_hi:[1,1]
    v_fma_mix_f32 v14, v76, v96, 0 op_sel:[0,0,0] op_sel_hi:[1,1,0]
    v_fma_mix_f32 v14, v76, v96, v14 op_sel:[1,1,0] op_sel_hi:[1,1,0]
    v_fma_mix_f32 v14, v77, v97, v14 op_sel:[0,0,0] op_sel_hi:[1,1,0]
    v_fma_mix_f32 v14, v77, v97, v14 op_sel:[1,1,0] op_sel_hi:[1,1,0]
    v_fma_mix_f32 v14, v78, v98, v14 op_sel:[0,0,0] op_sel_hi:[1,1,0]
    buffer_load_dwordx4 v158, s[76:79], s92 offen offset:1024 lds
    v_fma_mix_f32 v14, v78, v98, v14 op_sel:[1,1,0] op_sel_hi:[1,1,0]
    v_fma_mix_f32 v14, v79, v99, v14 op_sel:[0,0,0] op_sel_hi:[1,1,0]
    v_fma_mix_f32 v14, v79, v99, v14 op_sel:[1,1,0] op_sel_hi:[1,1,0]
    v_fma_mix_f32 v14, v12, v40, v14 op_sel:[0,0,0] op_sel_hi:[1,1,0]
    v_fma_mix_f32 v14, v12, v40, v14 op_sel:[1,1,0] op_sel_hi:[1,1,0]
    v_fma_mix_f32 v14, v13, v41, v14 op_sel:[0,0,0] op_sel_hi:[1,1,0]
    v_fma_mix_f32 v14, v13, v41, v14 op_sel:[1,1,0] op_sel_hi:[1,1,0]
    v_mov_b32 v26, v14
    v_or3_b32 v125, v125, v88, v89
    v_rsq_f32 v88, v88
    v_permlane32_swap_b32 v26, v14
    v_add_f32 v14, v26, v14
    v_mov_b32 v26, v14
    v_rsq_f32 v89, v89
    s_waitcnt vmcnt(8)
    ds_read_b64_tr_b16 a[160:161], v5 offset:49152
    buffer_load_dwordx4 v47, s[76:79], s92 offen offset:2048 lds
    s_add_u32 m0, s90, 24576
    s_mov_b32 s92, 24576
    ds_read_b64_tr_b16 a[162:163], v5 offset:49920
    v_permlane16_swap_b32 v26, v14
    v_add_f32 v14, v26, v14
    ds_read_b64_tr_b16 a[184:185], v5 offset:49160
    v_mul_f32 v88, s52, v88
    v_cvt_pk_f16_f32 v88, v88, v89
    v_or3_b32 v125, v125, v90, v91
    ds_read_b64_tr_b16 a[186:187], v5 offset:49928
    v_rsq_f32 v90, v90
    ds_read_b64_tr_b16 a[208:209], v4 offset:49216
    buffer_load_dwordx4 v46, s[76:79], s92 offen offset:0 lds
    ds_read_b64_tr_b16 a[210:211], v4 offset:49984
    v_rsq_f32 v91, v91
    v_mul_f32 v90, s52, v90
    v_cvt_pk_f16_f32 v90, v90, v91
    v_pk_mul_f16 v244, v244, v88 op_sel:[0,1] op_sel_hi:[1,1]
    v_pk_mul_f16 v245, v245, v88 op_sel:[0,1] op_sel_hi:[1,1]
    v_pk_mul_f16 v246, v246, v88 op_sel:[0,1] op_sel_hi:[1,1]
    v_pk_mul_f16 v247, v247, v88 op_sel:[0,1] op_sel_hi:[1,1]
    v_pk_mul_f16 v248, v248, v88 op_sel:[0,1] op_sel_hi:[1,1]
    v_pk_mul_f16 v249, v249, v88 op_sel:[0,1] op_sel_hi:[1,1]
    v_pk_mul_f16 v112, v112, v88 op_sel:[0,0] op_sel_hi:[1,0]
    v_pk_mul_f16 v113, v113, v88 op_sel:[0,0] op_sel_hi:[1,0]
    v_pk_mul_f16 v114, v114, v88 op_sel:[0,0] op_sel_hi:[1,0]
    v_pk_mul_f16 v115, v115, v88 op_sel:[0,0] op_sel_hi:[1,0]
    buffer_load_dwordx4 v158, s[76:79], s92 offen offset:1024 lds
    v_pk_mul_f16 v154, v154, v88 op_sel:[0,0] op_sel_hi:[1,0]
    v_pk_mul_f16 v155, v155, v88 op_sel:[0,0] op_sel_hi:[1,0]
    v_pk_mul_f16 v28, v28, v90 op_sel:[0,1] op_sel_hi:[1,1]
    v_pk_mul_f16 v29, v29, v90 op_sel:[0,1] op_sel_hi:[1,1]
    v_pk_mul_f16 v30, v30, v90 op_sel:[0,1] op_sel_hi:[1,1]
    v_pk_mul_f16 v31, v31, v90 op_sel:[0,1] op_sel_hi:[1,1]
    v_pk_mul_f16 v32, v32, v90 op_sel:[0,1] op_sel_hi:[1,1]
    v_pk_mul_f16 v33, v33, v90 op_sel:[0,1] op_sel_hi:[1,1]
    v_pk_mul_f16 v20, v20, v90 op_sel:[0,0] op_sel_hi:[1,0]
    v_pk_mul_f16 v21, v21, v90 op_sel:[0,0] op_sel_hi:[1,0]
    v_pk_mul_f16 v22, v22, v90 op_sel:[0,0] op_sel_hi:[1,0]
    v_pk_mul_f16 v23, v23, v90 op_sel:[0,0] op_sel_hi:[1,0]
    v_pk_mul_f16 v150, v150, v90 op_sel:[0,0] op_sel_hi:[1,0]
    v_pk_mul_f16 v151, v151, v90 op_sel:[0,0] op_sel_hi:[1,0]
    v_add_f32 v14, s84, v14
    v_exp_f32 v14, v14
    buffer_load_dwordx4 v47, s[76:79], s92 offen offset:2048 lds
    s_add_u32 m0, s90, 36864
    s_mov_b32 s92, 36864
    s_waitcnt vmcnt(9)
    ds_read_b64_tr_b16 a[164:165], v5 offset:61440
    v_cvt_pk_bf16_f32 v14, v14, 0
    v_cmp_gt_u32 vcc, 16, v9
    v_cvt_pk_f16_f32 v122, v104, v105
    ds_read_b64_tr_b16 a[166:167], v5 offset:62208
    v_mfma_f32_16x16x32_bf16 v[88:91], v[80:83], a[144:147], 0
    v_cndmask_b32 v14, 0, v14, vcc
    v_cvt_pk_f16_f32 v123, v106, v107
    v_mfma_f32_16x16x32_bf16 v[88:91], v[72:75], a[148:151], v[88:91]
    ds_read_b64_tr_b16 a[188:189], v5 offset:61448
    v_pk_fmac_f16 v61, v122, v122
    v_mfma_f32_16x16x32_bf16 v[88:91], v[68:71], a[152:155], v[88:91]
    s_waitcnt lgkmcnt(3)
    buffer_load_dwordx4 v46, s[76:79], s92 offen offset:0 lds
    ds_read_b64_tr_b16 a[190:191], v5 offset:62216
    v_mfma_f32_16x16x32_bf16 v[88:91], v[64:67], a[156:159], v[88:91]
    v_pk_fmac_f16 v61, v123, v123
    v_pk_mul_f16 v56, v56, v86 op_sel:[0,0] op_sel_hi:[1,0]
    v_mfma_f32_16x16x32_bf16 v[88:91], v[52:55], a[160:163], v[88:91]
    s_waitcnt lgkmcnt(2)
    ds_read_b64_tr_b16 a[212:213], v4 offset:61504
    v_pk_mul_f16 v57, v57, v86 op_sel:[0,0] op_sel_hi:[1,0]
    v_pk_mul_f16 v58, v58, v86 op_sel:[0,0] op_sel_hi:[1,0]
    v_pk_mul_f16 v59, v59, v86 op_sel:[0,0] op_sel_hi:[1,0]
    ds_read_b64_tr_b16 a[214:215], v4 offset:62272
    v_pk_mul_f16 v44, v44, v86 op_sel:[0,0] op_sel_hi:[1,0]
    buffer_load_dwordx4 v158, s[76:79], s92 offen offset:1024 lds
    ds_write_b128 v0, v[76:79] offset:21504
    v_mfma_f32_16x16x32_bf16 v[88:91], v[16:19], a[164:167], v[88:91]
    v_pk_mul_f16 v45, v45, v86 op_sel:[0,0] op_sel_hi:[1,0]
    v_pk_mul_f16 v36, v36, v86 op_sel:[0,1] op_sel_hi:[1,1]
    v_mfma_f32_16x16x32_bf16 v[76:79], v[80:83], a[168:171], 0
    v_pk_mul_f16 v37, v37, v86 op_sel:[0,1] op_sel_hi:[1,1]
    v_pk_mul_f16 v38, v38, v86 op_sel:[0,1] op_sel_hi:[1,1]
    v_mfma_f32_16x16x32_bf16 v[76:79], v[72:75], a[172:175], v[76:79]
    ds_write_b128 v0, v[96:99] offset:21536
    v_mfma_f32_16x16x32_bf16 v[76:79], v[68:71], a[176:179], v[76:79]
    buffer_load_dwordx4 v47, s[76:79], s92 offen offset:2048 lds
    v_cvt_pk_bf16_f32 v164, v88, v89
    v_mfma_f32_16x16x32_bf16 v[76:79], v[64:67], a[180:183], v[76:79]
    s_add_u32 m0, s90, 49152
    v_cvt_pk_bf16_f32 v165, v90, v91
    v_pk_mul_f16 v39, v39, v86 op_sel:[0,1] op_sel_hi:[1,1]
    v_mfma_f32_16x16x32_bf16 v[76:79], v[52:55], a[184:187], v[76:79]
    s_waitcnt lgkmcnt(2)
    s_mov_b32 s92, 49152
    ds_write_b64 v0, v[40:41] offset:21552
    v_mfma_f32_16x16x32_bf16 v[76:79], v[16:19], a[188:191], v[76:79]
    v_pk_mul_f16 v24, v24, v86 op_sel:[0,1] op_sel_hi:[1,1]
    v_pk_mul_f16 v25, v25, v86 op_sel:[0,1] op_sel_hi:[1,1]
    v_mfma_f32_16x16x32_bf16 v[40:43], v[80:83], a[192:195], 0
    s_nop 0
    buffer_load_dwordx4 v46, s[76:79], s92 offen offset:0 lds
    ds_read_b128 v[80:83], v6 offset:40960
    v_mfma_f32_16x16x32_bf16 v[40:43], v[72:75], a[196:199], v[40:43]
    s_nop 0
    v_cvt_pk_bf16_f32 v160, v76, v77
    v_cvt_pk_bf16_f32 v161, v78, v79
    v_mfma_f32_16x16x32_bf16 v[40:43], v[68:71], a[200:203], v[40:43]
    ds_read_b128 v[72:75], v103 offset:40960
    v_mov_b32 v171, 0
    v_mfma_f32_16x16x32_bf16 v[40:43], v[64:67], a[204:207], v[40:43]
    ds_read_b128 v[68:71], v6 offset:41088
    v_mov_b32 v167, 0
    v_mfma_f32_16x16x32_bf16 v[40:43], v[52:55], a[208:211], v[40:43]
    ds_read_b128 v[64:67], v103 offset:41088
    v_mov_b32 v163, 0
    v_mfma_f32_16x16x32_bf16 v[40:43], v[16:19], a[212:215], v[40:43]
    buffer_load_dwordx4 v158, s[76:79], s92 offen offset:1024 lds
    ds_read_b128 v[52:55], v6 offset:41216
    v_mov_b32 v159, 0
    v_mov_b32 v152, 0
    v_mov_b32 v153, 0
    v_mfma_f32_16x16x32_f16 v[76:79], v[244:247], v[112:115], v[204:207]
    s_nop 0
    ds_read_b128 v[16:19], v103 offset:41216
    v_cvt_pk_bf16_f32 v156, v40, v41
    v_mfma_f32_16x16x32_f16 v[76:79], v[246:249], v[152:155], v[76:79]
    v_cvt_pk_bf16_f32 v157, v42, v43
    v_mov_b32 v148, 0
    v_mfma_f32_16x16x32_f16 v[96:99], v[28:31], v[112:115], v[200:203]
    v_mov_b32 v149, 0
    v_mov_b32 v144, 0
    v_mfma_f32_16x16x32_f16 v[96:99], v[30:33], v[152:155], v[96:99]
    s_waitcnt lgkmcnt(5)
    v_mov_b32 v145, 0
    v_mov_b32 v140, 0
    v_mfma_f32_16x16x32_bf16 v[88:91], a[144:147], v[80:83], 0
    s_waitcnt lgkmcnt(4)
    buffer_load_dwordx4 v47, s[76:79], s92 offen offset:2048 lds
    v_mov_b32 v141, 0
    v_mfma_f32_16x16x32_bf16 v[88:91], a[148:151], v[72:75], v[88:91]
    s_waitcnt lgkmcnt(3)
    s_add_u32 m0, s90, 61440
    v_exp_f32 v76, v76
    v_mfma_f32_16x16x32_bf16 v[88:91], a[152:155], v[68:71], v[88:91]
    s_waitcnt lgkmcnt(2)
    s_mov_b32 s92, 61440
    v_exp_f32 v77, v77
    v_mfma_f32_16x16x32_bf16 v[88:91], a[156:159], v[64:67], v[88:91]
    s_waitcnt lgkmcnt(1)
    ds_write_b128 v0, v[12:15] offset:21520
    v_mfma_f32_16x16x32_bf16 v[88:91], a[160:163], v[52:55], v[88:91]
    s_waitcnt lgkmcnt(1)
    buffer_load_dwordx4 v46, s[76:79], s92 offen offset:0 lds
    v_cvt_pk_bf16_f32 v104, v76, v77
    v_mfma_f32_16x16x32_bf16 v[88:91], a[164:167], v[16:19], v[88:91]
    v_exp_f32 v78, v78
    v_mfma_f32_16x16x32_bf16 v[12:15], a[168:171], v[80:83], 0
    s_nop 0
    ds_read_b128 v[232:235], v134 offset:32
    v_fma_mix_f32 v46, v56, v36, 0 op_sel:[0,0,0] op_sel_hi:[1,1,0]
    v_mfma_f32_16x16x32_bf16 v[12:15], a[172:175], v[72:75], v[12:15]
    s_nop 0
    ds_read_b64 v[236:237], v134 offset:48
    v_cvt_pk_bf16_f32 v42, v88, v89
    v_mfma_f32_16x16x32_bf16 v[12:15], a[176:179], v[68:71], v[12:15]
    ds_read_b128 v[84:87], v134 offset:0
    v_cvt_pk_bf16_f32 v43, v90, v91
    v_mfma_f32_16x16x32_bf16 v[12:15], a[180:183], v[64:67], v[12:15]
    buffer_load_dwordx4 v158, s[76:79], s92 offen offset:1024 lds
    ds_read_b64 v[142:143], v134 offset:16
    v_mfma_f32_16x16x32_bf16 v[12:15], a[184:187], v[52:55], v[12:15]
    ds_write_b64 v0, v[42:43] offset:21560
    v_mfma_f32_16x16x32_bf16 v[12:15], a[188:191], v[16:19], v[12:15]
    v_exp_f32 v79, v79
    v_mfma_f32_16x16x32_bf16 v[40:43], a[192:195], v[80:83], 0
    ds_read_b128 v[80:83], v6 offset:42496
    v_cvt_pk_bf16_f32 v105, v78, v79
    v_mfma_f32_16x16x32_bf16 v[40:43], a[196:199], v[72:75], v[40:43]
    ds_read_b128 v[76:79], v103 offset:42496
    buffer_load_dwordx4 v47, s[76:79], s92 offen offset:2048 lds
    v_mfma_f32_16x16x32_bf16 v[40:43], a[200:203], v[68:71], v[40:43]
    s_add_u32 m0, s54, 20480
    ds_read_b128 v[72:75], v6 offset:42624
    v_cvt_pk_bf16_f32 v12, v12, v13
    v_mfma_f32_16x16x32_bf16 v[40:43], a[204:207], v[64:67], v[40:43]
    ds_read_b128 v[68:71], v103 offset:42624
    v_cvt_pk_bf16_f32 v13, v14, v15
    v_mfma_f32_16x16x32_bf16 v[40:43], a[208:211], v[52:55], v[40:43]
    ds_read_b128 v[64:67], v6 offset:42752
    v_fma_mix_f32 v46, v56, v36, v46 op_sel:[1,1,0] op_sel_hi:[1,1,0]
    v_mfma_f32_16x16x32_bf16 v[40:43], a[212:215], v[16:19], v[40:43]
    s_waitcnt lgkmcnt(7)
    ds_read_b128 v[16:19], v103 offset:42752
    v_fma_mix_f32 v46, v57, v37, v46 op_sel:[0,0,0] op_sel_hi:[1,1,0]
    v_mfma_f32_16x16x32_f16 v[88:91], v[232:235], v[112:115], v[208:211]
    v_exp_f32 v96, v96
    v_mfma_f32_16x16x32_f16 v[88:91], v[234:237], v[152:155], v[88:91]
    s_nop 0
    buffer_load_dwordx4 v130, s[24:27], s56 offen nt lds
    v_cvt_pk_bf16_f32 v14, v40, v41
    v_mfma_f32_16x16x32_f16 v[52:55], v[84:87], v[244:247], v[208:211]
    s_waitcnt lgkmcnt(6)
    s_add_u32 m0, s54, 21504
    v_cvt_pk_bf16_f32 v15, v42, v43
    v_fma_mix_f32 v46, v57, v37, v46 op_sel:[1,1,0] op_sel_hi:[1,1,0]
    v_mfma_f32_16x16x32_f16 v[52:55], v[140:143], v[246:249], v[52:55]
    ds_write_b128 v0, v[12:15] offset:21568
    v_mfma_f32_16x16x32_f16 v[12:15], v[84:87], v[28:31], v[208:211]
    v_exp_f32 v97, v97
    v_mfma_f32_16x16x32_f16 v[12:15], v[140:143], v[30:33], v[12:15]
    s_waitcnt lgkmcnt(3)
    buffer_load_dwordx4 v129, s[24:27], s56 offen nt lds
    v_cvt_pk_bf16_f32 v106, v96, v97
    v_mfma_f32_16x16x32_bf16 v[40:43], a[144:147], v[80:83], 0
    s_add_u32 m0, s54, 22528
    ds_read_u16 v166, v133 offset:56
    v_fma_mix_f32 v46, v58, v38, v46 op_sel:[0,0,0] op_sel_hi:[1,1,0]
    v_mfma_f32_16x16x32_bf16 v[40:43], a[148:151], v[76:79], v[40:43]
    ds_read_u16 v162, v133 offset:64
    v_mov_b32_dpp v55, v15 quad_perm:[0,1,2,3] row_mask:0x2 bank_mask:0xf
    v_mfma_f32_16x16x32_bf16 v[40:43], a[152:155], v[72:75], v[40:43]
    ds_read_u16 v158, v133 offset:72
    v_fma_mix_f32 v46, v58, v38, v46 op_sel:[1,1,0] op_sel_hi:[1,1,0]
    v_mfma_f32_16x16x32_bf16 v[40:43], a[156:159], v[68:71], v[40:43]
    s_waitcnt lgkmcnt(4)
    v_exp_f32 v98, v98
    v_mfma_f32_16x16x32_bf16 v[40:43], a[160:163], v[64:67], v[40:43]
    buffer_load_dwordx4 v128, s[24:27], s56 offen nt lds
    v_fma_mix_f32 v46, v59, v39, v46 op_sel:[0,0,0] op_sel_hi:[1,1,0]
    v_mfma_f32_16x16x32_bf16 v[40:43], a[164:167], v[16:19], v[40:43]
    s_add_u32 m0, s54, 23552
    v_exp_f32 v99, v99
    v_mfma_f32_16x16x32_bf16 v[12:15], a[168:171], v[80:83], 0
    v_cvt_pk_bf16_f32 v107, v98, v99
    v_fma_mix_f32 v46, v59, v39, v46 op_sel:[1,1,0] op_sel_hi:[1,1,0]
    v_mfma_f32_16x16x32_bf16 v[12:15], a[172:175], v[76:79], v[12:15]
    v_exp_f32 v88, v88
    v_mfma_f32_16x16x32_bf16 v[12:15], a[176:179], v[72:75], v[12:15]
    v_cvt_pk_bf16_f32 v170, v88, 0
    v_cvt_pk_bf16_f32 v26, v40, v41
    v_mfma_f32_16x16x32_bf16 v[12:15], a[180:183], v[68:71], v[12:15]
    buffer_load_dwordx4 v127, s[24:27], s56 offen nt lds
    v_cvt_pk_bf16_f32 v27, v42, v43
    v_mfma_f32_16x16x32_bf16 v[12:15], a[184:187], v[64:67], v[12:15]
    s_add_u32 m0, s54, 24576
    v_fma_mix_f32 v46, v44, v24, v46 op_sel:[0,0,0] op_sel_hi:[1,1,0]
    v_fma_mix_f32 v46, v44, v24, v46 op_sel:[1,1,0] op_sel_hi:[1,1,0]
    v_mfma_f32_16x16x32_bf16 v[12:15], a[188:191], v[16:19], v[12:15]
    v_fma_mix_f32 v46, v45, v25, v46 op_sel:[0,0,0] op_sel_hi:[1,1,0]
    v_fma_mix_f32 v46, v45, v25, v46 op_sel:[1,1,0] op_sel_hi:[1,1,0]
    v_mfma_f32_16x16x32_bf16 v[40:43], a[192:195], v[80:83], 0
    s_nop 0
    v_mov_b32 v4, v46
    v_mov_b32 v47, 0
    v_mfma_f32_16x16x32_bf16 v[40:43], a[196:199], v[76:79], v[40:43]
    s_nop 0
    v_cvt_pk_bf16_f32 v12, v12, v13
    v_cvt_pk_bf16_f32 v13, v14, v15
    v_mfma_f32_16x16x32_bf16 v[40:43], a[200:203], v[72:75], v[40:43]
    buffer_load_dwordx4 v126, s[24:27], s56 offen nt lds
    v_mfma_f32_16x16x32_bf16 v[40:43], a[204:207], v[68:71], v[40:43]
    s_cmp_lt_u32 s61, s71
    v_permlane32_swap_b32 v4, v46
    v_mfma_f32_16x16x32_bf16 v[40:43], a[208:211], v[64:67], v[40:43]
    s_cselect_b32 s15, s61, s12
    v_add_f32 v46, v4, v46
    v_mov_b32 v4, v46
    v_mfma_f32_16x16x32_bf16 v[40:43], a[212:215], v[16:19], v[40:43]
    s_cselect_b32 s56, s69, s70
    v_permlane16_swap_b32 v4, v46
    v_mfma_f32_16x16x32_f16 v[16:19], v[244:247], v[20:23], v[192:195]
    s_add_u32 s56, s56, s15
    ds_read_b128 v[96:99], v6 offset:0
    v_add_f32 v46, v4, v46
    v_mfma_f32_16x16x32_f16 v[16:19], v[246:249], v[148:151], v[16:19]
    s_mul_i32 s53, s56, 58255
    ds_read_b128 v[88:91], v103 offset:0
    v_cvt_pk_bf16_f32 v14, v40, v41
    v_mfma_f32_16x16x32_f16 v[228:231], v[28:31], v[20:23], v[188:191]
    s_lshr_b32 s53, s53, 22
    ds_read_b128 v[80:83], v6 offset:128
    v_cvt_pk_bf16_f32 v15, v42, v43
    v_mfma_f32_16x16x32_f16 v[228:231], v[30:33], v[148:151], v[228:231]
    s_mul_i32 s53, s53, s63
    ds_read_b128 v[76:79], v103 offset:128
    v_add_f32 v46, s84, v46
    v_exp_f32 v46, v46
    s_mul_i32 s56, s56, s62
    s_add_u32 s56, s56, s53
    s_mul_i32 s4, s15, 336
    s_cmp_ge_u32 s15, 16
    s_cselect_b32 s53, -26880, 0
    s_add_u32 s4, s4, s53
    s_cmp_lt_u32 s15, s73
    s_cselect_b32 s26, 100270464, 0
    s_cselect_b32 s56, s56, 0
    s_cselect_b32 s4, s4, -1
    s_cselect_b32 s15, s15, 0
    s_cselect_b32 s13, s13, -1
    s_bitset1_b32 s64, s15
    v_mfma_f32_16x16x32_f16 v[64:67], v[232:235], v[20:23], v[208:211]
    s_add_u32 m0, s67, 0
    ds_read_b128 v[68:71], v6 offset:256
    v_cvt_pk_bf16_f32 v46, v46, 0
    v_mfma_f32_16x16x32_f16 v[64:67], v[234:237], v[148:151], v[64:67]
    ds_read_b128 v[40:43], v103 offset:256
    v_cmp_gt_u32 vcc, 16, v9
    v_mfma_f32_16x16x32_f16 v[108:111], v[212:215], v[60:63], 0
    s_waitcnt lgkmcnt(4)
    v_exp_f32 v16, v16
    v_mfma_f32_16x16x32_bf16 v[72:75], v[96:99], a[144:147], 0
    v_exp_f32 v17, v17
    v_mfma_f32_16x16x32_bf16 v[72:75], v[88:91], a[148:151], v[72:75]
    s_waitcnt lgkmcnt(2)
    s_nop 0
    v_cndmask_b32 v46, 0, v46, vcc
    v_or3_b32 v125, v125, v108, v109
    v_mfma_f32_16x16x32_bf16 v[72:75], v[80:83], a[152:155], v[72:75]
    v_rsq_f32 v108, v108
    v_mfma_f32_16x16x32_bf16 v[72:75], v[76:79], a[156:159], v[72:75]
    v_rsq_f32 v109, v109
    v_mul_f32 v108, s52, v108
    v_cvt_pk_f16_f32 v108, v108, v109
    v_pk_mul_f16 v118, v118, v108 op_sel:[0,1] op_sel_hi:[1,1]
    v_pk_mul_f16 v119, v119, v108 op_sel:[0,1] op_sel_hi:[1,1]
    v_pk_mul_f16 v120, v120, v108 op_sel:[0,1] op_sel_hi:[1,1]
    v_pk_mul_f16 v121, v121, v108 op_sel:[0,1] op_sel_hi:[1,1]
    v_pk_mul_f16 v122, v122, v108 op_sel:[0,1] op_sel_hi:[1,1]
    v_pk_mul_f16 v123, v123, v108 op_sel:[0,1] op_sel_hi:[1,1]
    v_pk_mul_f16 v224, v224, v108 op_sel:[0,0] op_sel_hi:[1,0]
    s_waitcnt lgkmcnt(1)
    v_mfma_f32_16x16x32_bf16 v[72:75], v[68:71], a[160:163], v[72:75]
    s_waitcnt vmcnt(5) lgkmcnt(0)
    s_barrier
    v_pk_mul_f16 v225, v225, v108 op_sel:[0,0] op_sel_hi:[1,0]
    v_pk_mul_f16 v226, v226, v108 op_sel:[0,0] op_sel_hi:[1,0]
    v_mfma_f32_16x16x32_bf16 v[72:75], v[40:43], a[164:167], v[72:75]
    v_pk_mul_f16 v227, v227, v108 op_sel:[0,0] op_sel_hi:[1,0]
    v_pk_mul_f16 v146, v146, v108 op_sel:[0,0] op_sel_hi:[1,0]
    v_mfma_f32_16x16x32_f16 v[60:63], v[118:121], v[112:115], v[196:199]
    s_nop 0
    v_pk_mul_f16 v147, v147, v108 op_sel:[0,0] op_sel_hi:[1,0]
    v_cvt_pk_bf16_f32 v100, v16, v17
    v_mfma_f32_16x16x32_f16 v[60:63], v[120:123], v[152:155], v[60:63]
    s_nop 0
    v_cvt_pk_bf16_f32 v16, v72, v73
    v_cvt_pk_bf16_f32 v17, v74, v75
    v_mfma_f32_16x16x32_f16 v[72:75], v[84:87], v[118:121], v[208:211]
    s_nop 0
    v_exp_f32 v18, v18
    v_mfma_f32_16x16x32_f16 v[72:75], v[140:143], v[120:123], v[72:75]
    s_nop 0
    v_exp_f32 v60, v60
    v_mfma_f32_16x16x32_f16 v[84:87], v[118:121], v[20:23], v[184:187]
    v_exp_f32 v61, v61
    v_mfma_f32_16x16x32_f16 v[84:87], v[120:123], v[148:151], v[84:87]
    v_exp_f32 v62, v62
    v_mfma_f32_16x16x32_bf16 v[20:23], v[96:99], a[168:171], 0
    s_nop 0
    v_mov_b32_dpp v55, v75 quad_perm:[0,1,2,3] row_mask:0x4 bank_mask:0xf
    v_cvt_pk_bf16_f32 v168, v60, v61
    v_mfma_f32_16x16x32_bf16 v[20:23], v[88:91], a[172:175], v[20:23]
    v_exp_f32 v55, v55
    v_mfma_f32_16x16x32_bf16 v[20:23], v[80:83], a[176:179], v[20:23]
    v_exp_f32 v63, v63
    v_mfma_f32_16x16x32_bf16 v[20:23], v[76:79], a[180:183], v[20:23]
    s_lshl_b32 s93, s68, 10
    v_cvt_pk_bf16_f32 v55, v55, v55
    v_cvt_pk_bf16_f32 v169, v62, v63
    v_mfma_f32_16x16x32_bf16 v[20:23], v[68:71], a[184:187], v[20:23]
    s_mov_b32 s53, s47
    ds_write_b16 v133, v55
    v_mfma_f32_16x16x32_bf16 v[20:23], v[40:43], a[188:191], v[20:23]
    s_mov_b32 s47, s46
    ds_read_b128 v[72:75], v134
    v_and_b32 v143, 0xb8000000, v125
    v_mfma_f32_16x16x32_bf16 v[60:63], v[220:223], v[104:107], 0
    s_mov_b32 s46, s45
    ds_read_b128 v[52:55], v134 offset:16
    v_cmp_ne_u32 s[94:95], 0, v143
    v_mfma_f32_16x16x32_bf16 v[60:63], v[220:223], v[168:171], v[60:63]
    s_mov_b32 s45, s44
    ds_read_b128 v[112:115], v92 offset:0
    v_cvt_pk_bf16_f32 v20, v20, v21
    v_mfma_f32_16x16x32_bf16 v[240:243], v[96:99], a[192:195], 0
    s_or_b32 s94, s94, s95
    ds_read_b64 v[96:97], v7 offset:64
    v_cvt_pk_bf16_f32 v21, v22, v23
    v_mfma_f32_16x16x32_bf16 v[240:243], v[88:91], a[196:199], v[240:243]
    s_lshl_b32 s95, s68, 2
    ds_read_b128 v[252:255], v92 offset:3072
    v_mov_b32 v143, s94
    v_mfma_f32_16x16x32_bf16 v[240:243], v[80:83], a[200:203], v[240:243]
    s_mov_b32 s44, s53
    ds_read_b64 v[98:99], v7 offset:3136
    v_mov_b32 v9, s95
    v_mfma_f32_16x16x32_bf16 v[240:243], v[76:79], a[204:207], v[240:243]
    s_sub_u32 s48, s44, s46
    ds_read_b128 v[88:91], v92 offset:6144
    v_add_u32 v94, s93, v131
    v_mfma_f32_16x16x32_bf16 v[240:243], v[68:71], a[208:211], v[240:243]
    s_sub_u32 s49, s46, s45
    ds_read_b64 v[68:69], v7 offset:6208
    v_add_u32 v139, s48, v139
    v_mfma_f32_16x16x32_bf16 v[240:243], v[40:43], a[212:215], v[240:243]
    ds_read_b128 v[108:111], v92 offset:9216
    v_add_u32 v138, s48, v138
    v_mfma_f32_16x16x32_f16 v[80:83], v[244:247], v[224:227], v[180:183]
    ds_read_b64 v[70:71], v7 offset:9280
    s_nop 0
    v_mfma_f32_16x16x32_f16 v[80:83], v[246:249], v[144:147], v[80:83]
    s_nop 0
    ds_read_b128 v[76:79], v92 offset:12288
    v_cvt_pk_bf16_f32 v4, v240, v241
    v_mfma_f32_16x16x32_f16 v[40:43], v[28:31], v[224:227], v[176:179]
    ds_read_b64 v[116:117], v7 offset:12352
    v_cvt_pk_bf16_f32 v5, v242, v243
    v_mfma_f32_16x16x32_f16 v[40:43], v[30:33], v[144:147], v[40:43]
    ds_read_b128 v[248:251], v92 offset:15360
    v_mfma_f32_16x16x32_f16 v[32:35], v[118:121], v[224:227], v[172:175]
    ds_read_b64 v[118:119], v7 offset:15424
    v_mfma_f32_16x16x32_f16 v[32:35], v[120:123], v[144:147], v[32:35]
    ds_read_b128 v[244:247], v92 offset:18432
    v_mfma_f32_16x16x32_f16 v[28:31], v[232:235], v[224:227], v[208:211]
    ds_read_b64 v[224:225], v7 offset:18496
    v_mfma_f32_16x16x32_f16 v[28:31], v[234:237], v[144:147], v[28:31]
    s_waitcnt lgkmcnt(8)
    ds_read_b128 v[120:123], v92 offset:21504
    v_mfma_f32_16x16x32_bf16 v[240:243], v[112:115], v[220:223], 0
    ds_read_b64 v[226:227], v7 offset:21568
    v_mfma_f32_16x16x32_bf16 v[240:243], v[252:255], v[220:223], v[240:243]
    ds_read_b128 v[232:235], v92 offset:24576
    v_mfma_f32_16x16x32_bf16 v[240:243], v[88:91], v[220:223], v[240:243]
    s_waitcnt lgkmcnt(8)
    ds_read_b64 v[88:89], v7 offset:24640
    v_mfma_f32_16x16x32_bf16 v[240:243], v[108:111], v[220:223], v[240:243]
    ds_read_b128 v[112:115], v92 offset:27648
    v_mfma_f32_16x16x32_bf16 v[240:243], v[96:99], v[220:223], v[240:243]
    ds_read_b64 v[90:91], v7 offset:27712
    v_mfma_f32_16x16x32_bf16 v[240:243], v[68:71], v[220:223], v[240:243]
    ds_read_b128 v[108:111], v92 offset:30720
    v_mfma_f32_16x16x32_bf16 v[68:71], v[76:79], v[220:223], 0
    s_waitcnt lgkmcnt(8)
    ds_read_b64 v[76:77], v7 offset:30784
    s_nop 0
    v_mfma_f32_16x16x32_bf16 v[68:71], v[248:251], v[220:223], v[68:71]
    s_nop 0
    ds_read_b128 v[96:99], v92 offset:33792
    v_mul_f32 v240, 0xbbaaaaab, v240
    v_mfma_f32_16x16x32_bf16 v[68:71], v[244:247], v[220:223], v[68:71]
    s_waitcnt lgkmcnt(8)
    ds_read_b64 v[78:79], v7 offset:33856
    v_mul_f32 v241, 0xbbaaaaab, v241
    v_mfma_f32_16x16x32_bf16 v[68:71], v[120:123], v[220:223], v[68:71]
    ds_read_b128 v[120:123], v6 offset:1536
    v_mul_f32 v242, 0xbbaaaaab, v242
    v_mfma_f32_16x16x32_bf16 v[68:71], v[116:119], v[220:223], v[68:71]
    s_waitcnt lgkmcnt(8)
    ds_read_b128 v[116:119], v103 offset:1536
    v_mul_f32 v243, 0xbbaaaaab, v243
    v_mfma_f32_16x16x32_bf16 v[68:71], v[224:227], v[220:223], v[68:71]
    ds_write_b128 v8, v[240:243] offset:0
    v_mfma_f32_16x16x32_bf16 v[224:227], v[232:235], v[220:223], 0
    s_waitcnt lgkmcnt(7)
    v_exp_f32 v19, v19
    v_mfma_f32_16x16x32_bf16 v[224:227], v[112:115], v[220:223], v[224:227]
    s_waitcnt lgkmcnt(6)
    v_exp_f32 v228, v228
    v_mfma_f32_16x16x32_bf16 v[224:227], v[108:111], v[220:223], v[224:227]
    s_waitcnt lgkmcnt(4)
    ds_read_b128 v[112:115], v6 offset:1664
    v_cvt_pk_bf16_f32 v101, v18, v19
    v_exp_f32 v229, v229
    v_mfma_f32_16x16x32_bf16 v[224:227], v[96:99], v[220:223], v[224:227]
    ds_read_b128 v[108:111], v103 offset:1664
    v_cvt_pk_bf16_f32 v102, v228, v229
    v_mfma_f32_16x16x32_bf16 v[224:227], v[88:91], v[220:223], v[224:227]
    s_waitcnt lgkmcnt(4)
    ds_read_b128 v[96:99], v6 offset:1792
    v_mul_f32 v68, 0xbbaaaaab, v68
    v_mfma_f32_16x16x32_bf16 v[224:227], v[76:79], v[220:223], v[224:227]
    ds_read_b128 v[76:79], v103 offset:1792
    v_mul_f32 v69, 0xbbaaaaab, v69
    v_mfma_f32_16x16x32_bf16 v[88:91], v[120:123], a[144:147], 0
    s_waitcnt lgkmcnt(4)
    v_exp_f32 v230, v230
    v_mfma_f32_16x16x32_bf16 v[88:91], v[116:119], a[148:151], v[88:91]
    s_waitcnt lgkmcnt(3)
    v_exp_f32 v231, v231
    v_exp_f32 v84, v84
    v_cvt_pk_bf16_f32 v103, v230, v231
    v_exp_f32 v85, v85
    v_exp_f32 v86, v86
    v_exp_f32 v87, v87
    v_exp_f32 v65, v65
    v_mfma_f32_16x16x32_bf16 v[88:91], v[112:115], a[152:155], v[88:91]
    s_waitcnt lgkmcnt(2)
    v_rcp_f32 v60, v60
    v_mul_f32 v70, 0xbbaaaaab, v70
    v_mul_f32 v71, 0xbbaaaaab, v71
    v_mfma_f32_16x16x32_bf16 v[88:91], v[108:111], a[156:159], v[88:91]
    s_waitcnt lgkmcnt(0)
    ds_write_b128 v8, v[68:71] offset:128
    v_mfma_f32_16x16x32_bf16 v[88:91], v[96:99], a[160:163], v[88:91]
    s_barrier
    buffer_load_dwordx4 v130, s[24:27], s56 offen nt lds
    v_mul_f32 v224, 0xbbaaaaab, v224
    v_mfma_f32_16x16x32_bf16 v[88:91], v[76:79], a[164:167], v[88:91]
    s_add_u32 m0, s67, 1024
    v_mul_f32 v225, 0xbbaaaaab, v225
    v_mul_f32 v226, 0xbbaaaaab, v226
    v_mfma_f32_16x16x32_bf16 v[68:71], v[120:123], a[168:171], 0
    buffer_load_dwordx4 v129, s[24:27], s56 offen nt lds
    v_mul_f32 v227, 0xbbaaaaab, v227
    v_mfma_f32_16x16x32_bf16 v[68:71], v[116:119], a[172:175], v[68:71]
    s_add_u32 m0, s67, 2048
    ds_write_b128 v8, v[224:227] offset:256
    v_mfma_f32_16x16x32_bf16 v[68:71], v[112:115], a[176:179], v[68:71]
    buffer_load_dwordx4 v128, s[24:27], s56 offen nt lds
    v_cvt_pk_bf16_f32 v18, v88, v89
    v_mfma_f32_16x16x32_bf16 v[68:71], v[108:111], a[180:183], v[68:71]
    s_add_u32 m0, s67, 3072
    v_exp_f32 v80, v80
    v_mfma_f32_16x16x32_bf16 v[68:71], v[96:99], a[184:187], v[68:71]
    buffer_load_dwordx4 v127, s[24:27], s56 offen nt lds
    v_cvt_pk_bf16_f32 v19, v90, v91
    v_mfma_f32_16x16x32_bf16 v[68:71], v[76:79], a[188:191], v[68:71]
    s_add_u32 m0, s67, 4096
    v_exp_f32 v81, v81
    v_mfma_f32_16x16x32_bf16 v[88:91], v[16:19], v[104:107], 0
    s_nop 0
    buffer_load_dwordx4 v126, s[24:27], s56 offen nt lds
    v_cvt_pk_bf16_f32 v8, v80, v81
    v_mfma_f32_16x16x32_bf16 v[88:91], v[164:167], v[168:171], v[88:91]
    s_nop 0
    v_cvt_pk_bf16_f32 v22, v68, v69
    v_cvt_pk_bf16_f32 v23, v70, v71
    v_mfma_f32_16x16x32_bf16 v[68:71], v[120:123], a[192:195], 0
    v_exp_f32 v82, v82
    v_mfma_f32_16x16x32_bf16 v[68:71], v[116:119], a[196:199], v[68:71]
    s_waitcnt lgkmcnt(0)
    s_nop 0
    v_mul_f32 v88, v88, v60
    v_mul_f32 v89, v89, v60
    v_mfma_f32_16x16x32_bf16 v[68:71], v[112:115], a[200:203], v[68:71]
    s_barrier
    v_cvt_pk_bf16_f32 v88, v88, v89
    v_mul_f32 v90, v90, v60
    v_mfma_f32_16x16x32_bf16 v[68:71], v[108:111], a[204:207], v[68:71]
    v_exp_f32 v83, v83
    v_mfma_f32_16x16x32_bf16 v[68:71], v[96:99], a[208:211], v[68:71]
    v_mul_f32 v91, v91, v60
    v_cvt_pk_bf16_f32 v89, v90, v91
    v_mfma_f32_16x16x32_bf16 v[68:71], v[76:79], a[212:215], v[68:71]
    ds_write_b64 v137, v[88:89] offset:0
    v_mfma_f32_16x16x32_bf16 v[96:99], v[20:23], v[104:107], 0
    v_exp_f32 v40, v40
    v_mfma_f32_16x16x32_bf16 v[96:99], v[160:163], v[168:171], v[96:99]
    s_nop 0
    v_exp_f32 v41, v41
    v_mfma_f32_16x16x32_bf16 v[76:79], v[72:75], v[16:19], 0
    s_nop 0
    v_cvt_pk_bf16_f32 v6, v68, v69
    v_cvt_pk_bf16_f32 v7, v70, v71
    v_mfma_f32_16x16x32_bf16 v[76:79], v[52:55], v[164:167], v[76:79]
    s_nop 0
    v_mul_f32 v96, v96, v60
    v_mul_f32 v97, v97, v60
    v_mfma_f32_16x16x32_bf16 v[68:71], v[4:7], v[104:107], 0
    v_cvt_pk_bf16_f32 v90, v96, v97
    v_mul_f32 v98, v98, v60
    v_mfma_f32_16x16x32_bf16 v[68:71], v[156:159], v[168:171], v[68:71]
    v_mul_f32 v99, v99, v60
    v_cvt_pk_bf16_f32 v91, v98, v99
    v_mfma_f32_16x16x32_bf16 v[104:107], v[72:75], v[20:23], 0
    ds_write_b64 v137, v[90:91] offset:8
    v_mfma_f32_16x16x32_bf16 v[104:107], v[52:55], v[160:163], v[104:107]
    v_cvt_pk_bf16_f32 v168, v84, v85
    v_cvt_pk_bf16_f32 v169, v86, v87
    v_mfma_f32_16x16x32_bf16 v[84:87], v[72:75], v[4:7], 0
    ds_read_b128 v[88:91], v238 offset:49152
    v_cvt_pk_bf16_f32 v170, v65, 0
    v_mfma_f32_16x16x32_bf16 v[84:87], v[52:55], v[156:159], v[84:87]
    ds_read_b64 v[92:93], v239 offset:49216
    v_mul_f32 v68, v68, v60
    v_mfma_f32_16x16x32_bf16 v[52:55], v[220:223], v[100:103], 0
    ds_read_b128 v[96:99], v95 offset:5248
    v_mul_f32 v69, v69, v60
    v_mfma_f32_16x16x32_bf16 v[52:55], v[220:223], v[168:171], v[52:55]
    ds_read_b128 v[72:75], v238 offset:49920
    v_cvt_pk_bf16_f32 v142, v68, v69
    v_mfma_f32_16x16x32_bf16 v[64:67], v[16:19], v[100:103], 0
    ds_read_b64 v[76:77], v239 offset:49984
    v_mul_f32 v70, v70, v60
    v_mfma_f32_16x16x32_bf16 v[64:67], v[164:167], v[168:171], v[64:67]
    ds_read_b128 v[116:119], v95 offset:5312
    v_mul_f32 v71, v71, v60
    v_mfma_f32_16x16x32_bf16 v[60:63], v[20:23], v[100:103], 0
    ds_write_b32 v9, v143 offset:14848
    v_mfma_f32_16x16x32_bf16 v[60:63], v[160:163], v[168:171], v[60:63]
    v_cvt_pk_bf16_f32 v143, v70, v71
    v_mov_b32_dpp v79, v107 quad_perm:[0,1,2,3] row_mask:0x2 bank_mask:0xf
    v_mfma_f32_16x16x32_bf16 v[68:71], v[4:7], v[100:103], 0
    s_nop 0
    v_mov_b32_dpp v79, v87 quad_perm:[0,1,2,3] row_mask:0x4 bank_mask:0xf
    v_cvt_pk_bf16_f32 v79, v79, v79
    v_mfma_f32_16x16x32_bf16 v[68:71], v[156:159], v[168:171], v[68:71]
    s_waitcnt lgkmcnt(4)
    v_rcp_f32 v52, v52
    v_cvt_pk_bf16_f32 v9, v82, v83
    v_mul_f32 v64, v64, v52
    ds_write_b64 v136, v[142:143] offset:0
    v_mfma_f32_16x16x16_bf16 v[80:83], v[88:89], v[10:11], v[96:99]
    v_mul_f32 v65, v65, v52
    v_cvt_pk_bf16_f32 v84, v64, v65
    v_mul_f32 v66, v66, v52
    v_mul_f32 v67, v67, v52
    ds_write_b16 v133, v79 offset:56
    v_mfma_f32_16x16x16_bf16 v[112:115], v[90:91], v[10:11], v[96:99]
    s_nop 0
    ds_read_b128 v[88:91], v238 offset:24576
    v_cvt_pk_bf16_f32 v80, v80, v81
    v_mfma_f32_16x16x16_bf16 v[108:111], v[92:93], v[10:11], v[96:99]
    s_waitcnt lgkmcnt(3)
    ds_read_b64 v[92:93], v239 offset:24640
    v_accvgpr_write_b32 a232, v80
    v_mfma_f32_16x16x16_bf16 v[96:99], v[72:73], v[10:11], v[116:119]
    ds_read_b128 v[100:103], v95 offset:256
    v_cvt_pk_bf16_f32 v82, v82, v83
    v_mfma_f32_16x16x16_bf16 v[104:107], v[74:75], v[10:11], v[116:119]
    ds_read_b128 v[72:75], v238 offset:25344
    v_accvgpr_write_b32 a233, v82
    v_mfma_f32_16x16x16_bf16 v[80:83], v[76:77], v[10:11], v[116:119]
    ds_read_b64 v[76:77], v239 offset:25408
    v_cvt_pk_bf16_f32 v224, v112, v113
    v_cvt_pk_bf16_f32 v225, v114, v115
    v_cvt_pk_bf16_f32 v248, v108, v109
    v_cvt_pk_bf16_f32 v249, v110, v111
    v_cvt_pk_bf16_f32 v96, v96, v97
    v_accvgpr_write_b32 a234, v96
    v_cvt_pk_bf16_f32 v98, v98, v99
    v_accvgpr_write_b32 a235, v98
    v_cvt_pk_bf16_f32 v226, v104, v105
    v_cvt_pk_bf16_f32 v227, v106, v107
    v_cvt_pk_bf16_f32 v250, v80, v81
    v_cvt_pk_bf16_f32 v251, v82, v83
    ds_read_b128 v[96:99], v95 offset:320
    v_cvt_pk_bf16_f32 v85, v66, v67
    v_mul_f32 v60, v60, v52
    v_mul_f32 v61, v61, v52
    ds_read_b128 v[116:119], v238 offset:61440
    v_cvt_pk_bf16_f32 v86, v60, v61
    v_mul_f32 v62, v62, v52
    v_mul_f32 v63, v63, v52
    s_waitcnt lgkmcnt(4)
    v_mfma_f32_16x16x16_bf16 v[80:83], v[88:89], v[10:11], v[100:103]
    ds_read_b64 v[120:121], v239 offset:61504
    v_cvt_pk_bf16_f32 v87, v62, v63
    v_mfma_f32_16x16x16_bf16 v[60:63], v[90:91], v[10:11], v[100:103]
    ds_read_b128 v[112:115], v95 offset:5376
    v_mul_f32 v68, v68, v52
    v_mfma_f32_16x16x16_bf16 v[64:67], v[92:93], v[10:11], v[100:103]
    s_nop 0
    ds_read_b128 v[88:91], v238 offset:62208
    v_cvt_pk_bf16_f32 v80, v80, v81
    v_accvgpr_write_b32 a224, v80
    v_cvt_pk_bf16_f32 v82, v82, v83
    v_accvgpr_write_b32 a225, v82
    v_cvt_pk_bf16_f32 v60, v60, v61
    v_accvgpr_write_b32 a248, v60
    v_cvt_pk_bf16_f32 v62, v62, v63
    v_accvgpr_write_b32 a249, v62
    v_cvt_pk_bf16_f32 v240, v64, v65
    v_cvt_pk_bf16_f32 v241, v66, v67
    s_waitcnt lgkmcnt(4)
    v_mfma_f32_16x16x16_bf16 v[64:67], v[72:73], v[10:11], v[96:99]
    ds_read_b64 v[92:93], v239 offset:62272
    v_mul_f32 v69, v69, v52
    v_mfma_f32_16x16x16_bf16 v[60:63], v[74:75], v[10:11], v[96:99]
    ds_read_b128 v[108:111], v95 offset:5440
    v_cvt_pk_bf16_f32 v154, v68, v69
    v_mfma_f32_16x16x16_bf16 v[104:107], v[76:77], v[10:11], v[96:99]
    s_waitcnt lgkmcnt(3)
    ds_read_b128 v[78:81], v238 offset:12288
    v_cvt_pk_bf16_f32 v64, v64, v65
    v_accvgpr_write_b32 a226, v64
    v_cvt_pk_bf16_f32 v66, v66, v67
    v_accvgpr_write_b32 a227, v66
    v_cvt_pk_bf16_f32 v60, v60, v61
    v_accvgpr_write_b32 a250, v60
    v_cvt_pk_bf16_f32 v62, v62, v63
    v_mfma_f32_16x16x16_bf16 v[96:99], v[116:117], v[10:11], v[112:115]
    ds_read_b64 v[82:83], v239 offset:12352
    v_accvgpr_write_b32 a251, v62
    v_mfma_f32_16x16x16_bf16 v[72:75], v[118:119], v[10:11], v[112:115]
    ds_read_b128 v[64:67], v95 offset:128
    v_cvt_pk_bf16_f32 v242, v104, v105
    v_mfma_f32_16x16x16_bf16 v[60:63], v[120:121], v[10:11], v[112:115]
    ds_read_b128 v[100:103], v238 offset:13056
    v_cvt_pk_bf16_f32 v243, v106, v107
    v_cvt_pk_bf16_f32 v96, v96, v97
    v_accvgpr_write_b32 a236, v96
    v_cvt_pk_bf16_f32 v98, v98, v99
    v_accvgpr_write_b32 a237, v98
    v_cvt_pk_bf16_f32 v228, v72, v73
    v_cvt_pk_bf16_f32 v229, v74, v75
    v_cvt_pk_bf16_f32 v252, v60, v61
    v_cvt_pk_bf16_f32 v253, v62, v63
    ds_read_b64 v[104:105], v239 offset:13120
    s_waitcnt lgkmcnt(5)
    v_mfma_f32_16x16x16_bf16 v[96:99], v[88:89], v[10:11], v[108:111]
    ds_read_b128 v[72:75], v95 offset:192
    v_mul_f32 v70, v70, v52
    v_mfma_f32_16x16x16_bf16 v[60:63], v[90:91], v[10:11], v[108:111]
    ds_read_b128 v[88:91], v238 offset:36864
    v_mul_f32 v71, v71, v52
    v_mfma_f32_16x16x16_bf16 v[52:55], v[92:93], v[10:11], v[108:111]
    s_waitcnt lgkmcnt(4)
    ds_read_b64 v[92:93], v239 offset:36928
    v_cvt_pk_bf16_f32 v96, v96, v97
    v_accvgpr_write_b32 a238, v96
    v_cvt_pk_bf16_f32 v98, v98, v99
    v_accvgpr_write_b32 a239, v98
    v_cvt_pk_bf16_f32 v230, v60, v61
    v_cvt_pk_bf16_f32 v231, v62, v63
    v_cvt_pk_bf16_f32 v254, v52, v53
    v_mfma_f32_16x16x16_bf16 v[60:63], v[78:79], v[10:11], v[64:67]
    ds_read_b128 v[76:79], v95 offset:5120
    v_cvt_pk_bf16_f32 v255, v54, v55
    v_mfma_f32_16x16x16_bf16 v[52:55], v[80:81], v[10:11], v[64:67]
    ds_read_b128 v[106:109], v238 offset:37632
    v_cvt_pk_bf16_f32 v155, v70, v71
    v_mfma_f32_16x16x16_bf16 v[68:71], v[82:83], v[10:11], v[64:67]
    s_waitcnt lgkmcnt(4)
    ds_read_b64 v[110:111], v239 offset:37696
    v_cvt_pk_bf16_f32 v60, v60, v61
    v_accvgpr_write_b32 a220, v60
    v_cvt_pk_bf16_f32 v62, v62, v63
    v_accvgpr_write_b32 a221, v62
    v_cvt_pk_bf16_f32 v52, v52, v53
    v_accvgpr_write_b32 a244, v52
    v_cvt_pk_bf16_f32 v54, v54, v55
    v_accvgpr_write_b32 a245, v54
    v_mfma_f32_16x16x16_bf16 v[52:55], v[100:101], v[10:11], v[72:75]
    ds_read_b128 v[64:67], v95 offset:5184
    v_cvt_pk_bf16_f32 v236, v68, v69
    v_mfma_f32_16x16x16_bf16 v[60:63], v[102:103], v[10:11], v[72:75]
    ds_read_b128 v[100:103], v238 offset:0
    v_cvt_pk_bf16_f32 v237, v70, v71
    v_mfma_f32_16x16x16_bf16 v[68:71], v[104:105], v[10:11], v[72:75]
    s_waitcnt lgkmcnt(4)
    ds_read_b64 v[104:105], v239 offset:64
    v_cvt_pk_bf16_f32 v52, v52, v53
    v_accvgpr_write_b32 a222, v52
    v_cvt_pk_bf16_f32 v54, v54, v55
    v_accvgpr_write_b32 a223, v54
    v_cvt_pk_bf16_f32 v60, v60, v61
    v_accvgpr_write_b32 a246, v60
    v_cvt_pk_bf16_f32 v62, v62, v63
    v_mfma_f32_16x16x16_bf16 v[52:55], v[88:89], v[10:11], v[76:79]
    ds_read_b128 v[80:83], v95 offset:0
    v_accvgpr_write_b32 a247, v62
    v_mfma_f32_16x16x16_bf16 v[60:63], v[90:91], v[10:11], v[76:79]
    ds_read_b128 v[88:91], v238 offset:768
    v_cvt_pk_bf16_f32 v238, v68, v69
    v_mfma_f32_16x16x16_bf16 v[72:75], v[92:93], v[10:11], v[76:79]
    s_waitcnt lgkmcnt(4)
    ds_read_b64 v[92:93], v239 offset:832
    v_cvt_pk_bf16_f32 v239, v70, v71
    v_cvt_pk_bf16_f32 v52, v52, v53
    v_accvgpr_write_b32 a228, v52
    v_cvt_pk_bf16_f32 v54, v54, v55
    v_accvgpr_write_b32 a229, v54
    v_cvt_pk_bf16_f32 v60, v60, v61
    v_accvgpr_write_b32 a252, v60
    v_cvt_pk_bf16_f32 v62, v62, v63
    v_mfma_f32_16x16x16_bf16 v[52:55], v[106:107], v[10:11], v[64:67]
    ds_read_b128 v[68:71], v95 offset:64
    v_accvgpr_write_b32 a253, v62
    v_mfma_f32_16x16x16_bf16 v[96:99], v[108:109], v[10:11], v[64:67]
    ds_write_b64 v137, v[84:85] offset:1536
    v_mfma_f32_16x16x16_bf16 v[60:63], v[110:111], v[10:11], v[64:67]
    s_waitcnt lgkmcnt(4)
    v_cvt_pk_bf16_f32 v244, v72, v73
    v_cvt_pk_bf16_f32 v245, v74, v75
    v_cvt_pk_bf16_f32 v52, v52, v53
    v_accvgpr_write_b32 a230, v52
    v_cvt_pk_bf16_f32 v54, v54, v55
    v_accvgpr_write_b32 a231, v54
    v_cvt_pk_bf16_f32 v96, v96, v97
    v_mfma_f32_16x16x16_bf16 v[52:55], v[100:101], v[10:11], v[80:83]
    ds_write_b32 v137, v86 offset:1544
    v_mfma_f32_16x16x16_bf16 v[72:75], v[102:103], v[10:11], v[80:83]
    s_waitcnt vmcnt(5) lgkmcnt(3)
    v_accvgpr_write_b32 a254, v96
    v_cvt_pk_bf16_f32 v98, v98, v99
    v_mfma_f32_16x16x16_bf16 v[76:79], v[104:105], v[10:11], v[80:83]
    s_waitcnt lgkmcnt(2)
    s_barrier
    ds_read_b128 v[64:67], v124 offset:14848
    v_accvgpr_write_b32 a255, v98
    v_cvt_pk_bf16_f32 v246, v60, v61
    v_cvt_pk_bf16_f32 v247, v62, v63
    v_cvt_pk_bf16_f32 v52, v52, v53
    v_accvgpr_write_b32 a216, v52
    v_cvt_pk_bf16_f32 v54, v54, v55
    v_accvgpr_write_b32 a217, v54
    v_cvt_pk_bf16_f32 v72, v72, v73
    v_mfma_f32_16x16x16_bf16 v[60:63], v[88:89], v[10:11], v[68:71]
    ds_write_b128 v94, v[48:51] offset:6144
    v_mfma_f32_16x16x16_bf16 v[52:55], v[90:91], v[10:11], v[68:71]
    v_accvgpr_write_b32 a240, v72
    v_cvt_pk_bf16_f32 v74, v74, v75
    v_mfma_f32_16x16x16_bf16 v[48:51], v[92:93], v[10:11], v[68:71]
    s_waitcnt lgkmcnt(1)
    v_accvgpr_write_b32 a241, v74
    v_cvt_pk_bf16_f32 v232, v76, v77
    v_cvt_pk_bf16_f32 v233, v78, v79
    v_cvt_pk_bf16_f32 v60, v60, v61
    ds_write_b128 v0, v[216:219] offset:80
    v_accvgpr_write_b32 a218, v60
    v_cvt_pk_bf16_f32 v62, v62, v63
    v_or3_b32 v64, v64, v65, v66
    v_or_b32 v64, v64, v67
    v_accvgpr_write_b32 a219, v62
    v_readfirstlane_b32 s75, v64
    v_cvt_pk_bf16_f32 v52, v52, v53
    v_accvgpr_write_b32 a242, v52
    ds_write_b128 v0, v[56:59] offset:0
    v_cvt_pk_bf16_f32 v54, v54, v55
    v_accvgpr_write_b32 a243, v54
    v_cvt_pk_bf16_f32 v234, v48, v49
    v_cvt_pk_bf16_f32 v235, v50, v51
    v_exp_f32 v42, v42
    v_exp_f32 v43, v43
    ds_write_b128 v0, v[44:47] offset:16
    v_cvt_pk_bf16_f32 v10, v40, v41
    v_cvt_pk_bf16_f32 v11, v42, v43
    v_exp_f32 v32, v32
    v_exp_f32 v33, v33
    v_exp_f32 v34, v34
    ds_write_b128 v0, v[36:39] offset:32
    v_exp_f32 v35, v35
    v_cvt_pk_bf16_f32 v168, v32, v33
    v_cvt_pk_bf16_f32 v169, v34, v35
    v_exp_f32 v30, v30
    s_nop 0
    v_cvt_pk_bf16_f32 v170, v30, 0
    v_mfma_f32_16x16x32_bf16 v[76:79], v[220:223], v[8:11], 0
    ds_write_b128 v0, v[24:27] offset:48
    v_mfma_f32_16x16x32_bf16 v[76:79], v[220:223], v[168:171], v[76:79]
    v_mfma_f32_16x16x32_bf16 v[96:99], v[16:19], v[8:11], 0
    v_mfma_f32_16x16x32_bf16 v[96:99], v[164:167], v[168:171], v[96:99]
    ds_write_b128 v0, v[12:15] offset:64
    v_mfma_f32_16x16x32_bf16 v[16:19], v[20:23], v[8:11], 0
    v_mfma_f32_16x16x32_bf16 v[16:19], v[160:163], v[168:171], v[16:19]
    v_mfma_f32_16x16x32_bf16 v[0:3], v[4:7], v[8:11], 0
    ds_read_b128 v[68:71], v139 offset:0
    v_mfma_f32_16x16x32_bf16 v[0:3], v[156:159], v[168:171], v[0:3]
    ds_read_b128 v[60:63], v138 offset:0
    ds_read_b128 v[52:55], v139 offset:128
    ds_read_b128 v[48:51], v138 offset:128
    ds_read_b128 v[56:59], v139 offset:256
    ds_read_b128 v[64:67], v138 offset:256
    s_waitcnt lgkmcnt(5)
    v_mfma_f32_16x16x32_bf16 v[20:23], a[0:3], v[68:71], 0
    s_waitcnt lgkmcnt(0)
    s_cmp_lg_u32 s75, 0
    s_cbranch_scc1 L_slow
.p2align 6
L_loopF0:
    v_mfma_f32_16x16x32_bf16 v[20:23], a[4:7], v[60:63], v[20:23]
    ds_write_b32 v137, v87 offset:1548
    v_mfma_f32_16x16x32_bf16 v[20:23], a[8:11], v[52:55], v[20:23]
    v_rcp_f32 v76, v76
    v_mfma_f32_16x16x32_bf16 v[20:23], a[12:15], v[48:51], v[20:23]
    v_mul_f32 v96, v96, v76
    v_mul_f32 v97, v97, v76
    v_mfma_f32_16x16x32_bf16 v[20:23], a[16:19], v[56:59], v[20:23]
    v_cvt_pk_bf16_f32 v84, v96, v97
    v_mul_f32 v98, v98, v76
    v_mfma_f32_16x16x32_bf16 v[20:23], a[20:23], v[64:67], v[20:23]
    ds_write_b64 v136, v[154:155] offset:1536
    v_mfma_f32_16x16x32_bf16 v[116:119], v[68:71], a[168:171], 0
    v_mul_f32 v99, v99, v76
    v_cvt_pk_bf16_f32 v85, v98, v99
    v_mfma_f32_16x16x32_bf16 v[116:119], v[60:63], a[172:175], v[116:119]
    v_mul_f32 v16, v16, v76
    v_mul_f32 v17, v17, v76
    v_mfma_f32_16x16x32_bf16 v[116:119], v[52:55], a[176:179], v[116:119]
    v_cvt_pk_bf16_f32 v86, v16, v17
    v_mul_f32 v18, v18, v76
    v_mfma_f32_16x16x32_bf16 v[116:119], v[48:51], a[180:183], v[116:119]
    ds_write_b64 v137, v[84:85] offset:3072
    v_mfma_f32_16x16x32_bf16 v[116:119], v[56:59], a[184:187], v[116:119]
    v_mul_f32 v19, v19, v76
    v_cvt_pk_bf16_f32 v87, v18, v19
    v_mfma_f32_16x16x32_bf16 v[116:119], v[64:67], a[188:191], v[116:119]
    v_mul_f32 v0, v0, v76
    v_mul_f32 v1, v1, v76
    v_mfma_f32_16x16x32_bf16 v[16:19], a[48:51], v[68:71], 0
    v_cvt_pk_bf16_f32 v154, v0, v1
    v_mul_f32 v2, v2, v76
    v_mfma_f32_16x16x32_bf16 v[16:19], a[52:55], v[60:63], v[16:19]
    ds_write_b64 v137, v[86:87] offset:3080
    v_mfma_f32_16x16x32_bf16 v[16:19], a[56:59], v[52:55], v[16:19]
    v_mul_f32 v3, v3, v76
    v_cvt_pk_bf16_f32 v155, v2, v3
    v_mfma_f32_16x16x32_bf16 v[16:19], a[60:63], v[48:51], v[16:19]
    v_fmac_f32 v114, v5, v5
    v_fmac_f32 v114, v6, v6
    v_mfma_f32_16x16x32_bf16 v[16:19], a[64:67], v[56:59], v[16:19]
    v_fmac_f32 v114, v7, v7
    v_fmac_f32 v114, v8, v8
    v_mfma_f32_16x16x32_bf16 v[16:19], a[68:71], v[64:67], v[16:19]
    ds_write_b32 v136, v154 offset:3072
    v_mfma_f32_16x16x32_bf16 v[84:87], a[72:75], v[68:71], 0
    v_fmac_f32 v114, v9, v9
    v_fmac_f32 v114, v10, v10
    v_mfma_f32_16x16x32_bf16 v[84:87], a[76:79], v[60:63], v[84:87]
    v_fmac_f32 v114, v11, v11
    v_fma_f32 v154, v44, v44, s42
    v_mfma_f32_16x16x32_bf16 v[84:87], a[80:83], v[52:55], v[84:87]
    ds_read_b128 v[76:79], v139 offset:1536
    v_fmac_f32 v154, v45, v45
    v_mfma_f32_16x16x32_bf16 v[84:87], a[84:87], v[48:51], v[84:87]
    ds_read_b128 v[80:83], v139 offset:1664
    v_fmac_f32 v154, v46, v46
    v_mfma_f32_16x16x32_bf16 v[84:87], a[88:91], v[56:59], v[84:87]
    v_fmac_f32 v154, v47, v47
    v_fmac_f32 v154, v40, v40
    v_mfma_f32_16x16x32_bf16 v[84:87], a[92:95], v[64:67], v[84:87]
    v_fmac_f32 v154, v41, v41
    v_fmac_f32 v154, v42, v42
    v_mfma_f32_16x16x32_bf16 v[0:3], a[120:123], v[68:71], 0
    v_fmac_f32 v154, v43, v43
    v_fmac_f32 v154, v32, v32
    v_mfma_f32_16x16x32_bf16 v[0:3], a[124:127], v[60:63], v[0:3]
    ds_write_b32 v136, v155 offset:3076
    v_mfma_f32_16x16x32_bf16 v[0:3], a[128:131], v[52:55], v[0:3]
    v_fmac_f32 v154, v33, v33
    v_fmac_f32 v154, v34, v34
    v_mfma_f32_16x16x32_bf16 v[0:3], a[132:135], v[48:51], v[0:3]
    v_fmac_f32 v154, v35, v35
    v_fma_f32 v155, v36, v36, s42
    v_mfma_f32_16x16x32_bf16 v[0:3], a[136:139], v[56:59], v[0:3]
    v_fmac_f32 v155, v37, v37
    v_fmac_f32 v155, v38, v38
    v_mfma_f32_16x16x32_bf16 v[0:3], a[140:143], v[64:67], v[0:3]
    v_fmac_f32 v155, v39, v39
    v_fmac_f32 v155, v28, v28
    v_mfma_f32_16x16x32_bf16 v[72:75], a[24:27], v[68:71], 0
    v_fmac_f32 v155, v29, v29
    v_fmac_f32 v155, v30, v30
    v_mfma_f32_16x16x32_bf16 v[72:75], a[28:31], v[60:63], v[72:75]
    ds_read_b128 v[96:99], v138 offset:1536
    v_fmac_f32 v155, v31, v31
    v_mfma_f32_16x16x32_bf16 v[72:75], a[32:35], v[52:55], v[72:75]
    s_waitcnt vmcnt(10)
    v_fmac_f32 v155, v24, v24
    v_fmac_f32 v155, v25, v25
    v_mfma_f32_16x16x32_bf16 v[72:75], a[36:39], v[48:51], v[72:75]
    v_fmac_f32 v155, v26, v26
    v_fmac_f32 v155, v27, v27
    v_mfma_f32_16x16x32_bf16 v[72:75], a[40:43], v[56:59], v[72:75]
    v_cvt_pk_bf16_f32 v154, v114, v154
    v_cvt_pk_bf16_f32 v155, v155, v124
    v_mfma_f32_16x16x32_bf16 v[72:75], a[44:47], v[64:67], v[72:75]
    ds_write_b64 v132, v[154:155]
    v_mfma_f32_16x16x32_bf16 v[104:107], v[68:71], a[192:195], 0
    v_add_u32 v137, s49, v137
    v_add_u32 v136, s49, v136
    v_mfma_f32_16x16x32_bf16 v[104:107], v[60:63], a[196:199], v[104:107]
    v_cvt_pk_f16_f32 v92, v20, v21
    v_cvt_pk_f16_f32 v93, v22, v23
    v_mfma_f32_16x16x32_bf16 v[104:107], v[52:55], a[200:203], v[104:107]
    v_pk_fma_f16 v88, v92, v92, s39
    v_pk_fmac_f16 v88, v93, v93
    v_mfma_f32_16x16x32_bf16 v[104:107], v[48:51], a[204:207], v[104:107]
    v_cvt_pk_f16_f32 v108, v0, v1
    v_cvt_pk_f16_f32 v109, v2, v3
    v_mfma_f32_16x16x32_bf16 v[104:107], v[56:59], a[208:211], v[104:107]
    v_cvt_pk_f16_f32 v94, v72, v73
    v_cvt_pk_f16_f32 v95, v74, v75
    v_mfma_f32_16x16x32_bf16 v[104:107], v[64:67], a[212:215], v[104:107]
    v_pk_fmac_f16 v88, v94, v94
    v_pk_fmac_f16 v88, v95, v95
    v_mfma_f32_16x16x32_bf16 v[72:75], a[96:99], v[68:71], 0
    v_cvt_pk_f16_f32 v154, v16, v17
    v_cvt_pk_f16_f32 v155, v18, v19
    v_mfma_f32_16x16x32_bf16 v[72:75], a[100:103], v[60:63], v[72:75]
    s_waitcnt lgkmcnt(0)
    ds_read_b128 v[100:103], v138 offset:1664
    v_pk_fmac_f16 v88, v154, v154
    v_mfma_f32_16x16x32_bf16 v[72:75], a[104:107], v[52:55], v[72:75]
    s_barrier
    ds_read_b128 v[16:19], v131 offset:0
    v_pk_fmac_f16 v88, v155, v155
    v_mfma_f32_16x16x32_bf16 v[72:75], a[108:111], v[48:51], v[72:75]
    ds_read_b128 v[110:113], v131 offset:1024
    v_cvt_pk_bf16_f32 v0, v116, v117
    v_mfma_f32_16x16x32_bf16 v[72:75], a[112:115], v[56:59], v[72:75]
    v_cvt_pk_bf16_f32 v1, v118, v119
    v_cvt_pk_bf16_f32 v20, v104, v105
    v_mfma_f32_16x16x32_bf16 v[72:75], a[116:119], v[64:67], v[72:75]
    ds_read_b128 v[116:119], v138 offset:1792
    v_cvt_pk_bf16_f32 v21, v106, v107
    v_mfma_f32_16x16x32_bf16 v[120:123], v[68:71], a[144:147], 0
    s_nop 0
    v_cvt_pk_f16_f32 v104, v84, v85
    v_cvt_pk_f16_f32 v105, v86, v87
    v_mfma_f32_16x16x32_bf16 v[120:123], v[60:63], a[148:151], v[120:123]
    s_nop 0
    v_cvt_pk_f16_f32 v106, v72, v73
    v_cvt_pk_f16_f32 v107, v74, v75
    v_mfma_f32_16x16x32_bf16 v[120:123], v[52:55], a[152:155], v[120:123]
    ds_read_b128 v[84:87], v139 offset:1792
    v_pk_fma_f16 v89, v104, v104, s39
    v_mfma_f32_16x16x32_bf16 v[120:123], v[48:51], a[156:159], v[120:123]
    v_pk_fmac_f16 v89, v105, v105
    v_pk_fmac_f16 v89, v106, v106
    v_mfma_f32_16x16x32_bf16 v[120:123], v[56:59], a[160:163], v[120:123]
    v_pk_fmac_f16 v89, v107, v107
    v_pk_fmac_f16 v89, v108, v108
    v_mfma_f32_16x16x32_bf16 v[120:123], v[64:67], a[164:167], v[120:123]
    s_waitcnt lgkmcnt(3)
    v_readfirstlane_b32 s12, v17
    v_pk_fmac_f16 v89, v109, v109
    v_mfma_f32_16x16x32_bf16 v[72:75], v[216:219], v[16:19], 0
    s_waitcnt lgkmcnt(2)
    s_nop 0
    v_mfma_f32_16x16x32_bf16 v[72:75], v[216:219], v[110:113], v[72:75]
    s_lshr_b32 s12, s12, 23
    v_cvt_pk_bf16_f32 v16, v120, v121
    v_cvt_pk_bf16_f32 v17, v122, v123
    v_mfma_f32_16x16x32_bf16 v[56:59], a[96:99], v[76:79], 0
    s_nop 1
    v_mfma_f32_16x16x32_bf16 v[56:59], a[100:103], v[96:99], v[56:59]
    s_nop 0
    v_rsq_f32 v72, v72
    v_mfma_f32_16x16x32_bf16 v[56:59], a[104:107], v[80:83], v[56:59]
    v_rsq_f32 v73, v73
    v_mfma_f32_16x16x32_bf16 v[56:59], a[108:111], v[100:103], v[56:59]
    s_waitcnt lgkmcnt(0)
    v_rsq_f32 v74, v74
    v_mfma_f32_16x16x32_bf16 v[56:59], a[112:115], v[84:87], v[56:59]
    v_mul_f32 v72, s43, v72
    v_mul_f32 v73, s43, v73
    v_mfma_f32_16x16x32_bf16 v[56:59], a[116:119], v[116:119], v[56:59]
    v_mul_f32 v74, s43, v74
    v_mul_f32 v44, v44, v73
    v_mfma_f32_16x16x32_bf16 v[60:63], a[48:51], v[76:79], 0
    s_nop 0
    v_mul_f32 v45, v45, v73
    v_cvt_pk_bf16_f32 v44, v44, v45
    v_mfma_f32_16x16x32_bf16 v[60:63], a[52:55], v[96:99], v[60:63]
    s_nop 0
    v_cvt_pk_f16_f32 v70, v56, v57
    v_cvt_pk_f16_f32 v71, v58, v59
    v_mfma_f32_16x16x32_bf16 v[60:63], a[56:59], v[80:83], v[60:63]
    v_mul_f32 v46, v46, v73
    v_mul_f32 v47, v47, v73
    v_mfma_f32_16x16x32_bf16 v[60:63], a[60:63], v[100:103], v[60:63]
    v_cvt_pk_bf16_f32 v45, v46, v47
    v_mul_f32 v40, v40, v73
    v_mfma_f32_16x16x32_bf16 v[60:63], a[64:67], v[84:87], v[60:63]
    ds_write_b64 v137, v[44:45] offset:1536
    v_mfma_f32_16x16x32_bf16 v[60:63], a[68:71], v[116:119], v[60:63]
    v_mul_f32 v41, v41, v73
    v_cvt_pk_bf16_f32 v46, v40, v41
    v_mfma_f32_16x16x32_bf16 v[66:69], a[24:27], v[76:79], 0
    s_nop 0
    v_mul_f32 v42, v42, v73
    v_mul_f32 v43, v43, v73
    v_mfma_f32_16x16x32_bf16 v[66:69], a[28:31], v[96:99], v[66:69]
    s_nop 0
    v_cvt_pk_f16_f32 v150, v60, v61
    v_cvt_pk_f16_f32 v151, v62, v63
    v_mfma_f32_16x16x32_bf16 v[66:69], a[32:35], v[80:83], v[66:69]
    v_cvt_pk_bf16_f32 v47, v42, v43
    v_mul_f32 v32, v32, v73
    v_mfma_f32_16x16x32_bf16 v[66:69], a[36:39], v[100:103], v[66:69]
    ds_write_b32 v137, v46 offset:1544
    v_mfma_f32_16x16x32_bf16 v[66:69], a[40:43], v[84:87], v[66:69]
    v_mul_f32 v33, v33, v73
    v_cvt_pk_bf16_f32 v2, v32, v33
    v_mfma_f32_16x16x32_bf16 v[66:69], a[44:47], v[116:119], v[66:69]
    v_mul_f32 v34, v34, v73
    v_mul_f32 v35, v35, v73
    v_mfma_f32_16x16x32_bf16 v[40:43], a[72:75], v[76:79], 0
    s_nop 0
    ds_read_b128 v[56:59], v138 offset:3328
    v_cvt_pk_bf16_f32 v3, v34, v35
    v_mfma_f32_16x16x32_bf16 v[40:43], a[76:79], v[96:99], v[40:43]
    s_nop 0
    v_cvt_pk_f16_f32 v34, v66, v67
    v_cvt_pk_f16_f32 v35, v68, v69
    v_mfma_f32_16x16x32_bf16 v[40:43], a[80:83], v[80:83], v[40:43]
    ds_read_b128 v[60:63], v138 offset:3072
    v_mul_f32 v12, v12, v72
    v_mfma_f32_16x16x32_bf16 v[40:43], a[84:87], v[100:103], v[40:43]
    v_mul_f32 v13, v13, v72
    v_cvt_pk_bf16_f32 v12, v12, v13
    v_mfma_f32_16x16x32_bf16 v[40:43], a[88:91], v[84:87], v[40:43]
    v_mul_f32 v14, v14, v72
    v_mul_f32 v15, v15, v72
    v_mfma_f32_16x16x32_bf16 v[40:43], a[92:95], v[116:119], v[40:43]
    s_sub_u32 s50, s45, s44
    v_cvt_pk_bf16_f32 v13, v14, v15
    v_mul_f32 v4, v4, v72
    v_mfma_f32_16x16x32_bf16 v[66:69], v[76:79], a[168:171], 0
    s_sub_u32 s51, s46, s47
    ds_write_b64 v136, v[2:3] offset:1536
    v_mfma_f32_16x16x32_bf16 v[66:69], v[96:99], a[172:175], v[66:69]
    s_mov_b32 s60, s59
    v_mul_f32 v5, v5, v72
    v_cvt_pk_bf16_f32 v14, v4, v5
    v_mfma_f32_16x16x32_bf16 v[66:69], v[80:83], a[176:179], v[66:69]
    s_mov_b32 s59, s58
    v_mul_f32 v6, v6, v72
    v_mul_f32 v7, v7, v72
    v_mfma_f32_16x16x32_bf16 v[66:69], v[100:103], a[180:183], v[66:69]
    s_mov_b32 s58, s57
    v_cvt_pk_bf16_f32 v15, v6, v7
    v_mul_f32 v8, v8, v72
    v_mfma_f32_16x16x32_bf16 v[66:69], v[84:87], a[184:187], v[66:69]
    s_mov_b32 s57, s56
    ds_write_b32 v137, v47 offset:1548
    v_mfma_f32_16x16x32_bf16 v[66:69], v[116:119], a[188:191], v[66:69]
    s_mov_b32 s7, s6
    v_mul_f32 v9, v9, v72
    v_cvt_pk_bf16_f32 v22, v8, v9
    v_mfma_f32_16x16x32_bf16 v[4:7], a[0:3], v[76:79], 0
    s_mov_b32 s6, s5
    v_mul_f32 v10, v10, v72
    v_mul_f32 v11, v11, v72
    v_mfma_f32_16x16x32_bf16 v[4:7], a[4:7], v[96:99], v[4:7]
    s_mov_b32 s5, s4
    v_cvt_pk_bf16_f32 v2, v66, v67
    v_cvt_pk_bf16_f32 v3, v68, v69
    v_mfma_f32_16x16x32_bf16 v[4:7], a[8:11], v[80:83], v[4:7]
    s_sub_u32 s14, s6, s7
    ds_write_b64 v137, v[12:13] offset:0
    v_mfma_f32_16x16x32_bf16 v[4:7], a[12:15], v[100:103], v[4:7]
    s_add_u32 s61, s61, 1
    v_cvt_pk_bf16_f32 v23, v10, v11
    v_cvt_pk_f16_f32 v68, v40, v41
    v_mfma_f32_16x16x32_bf16 v[4:7], a[16:19], v[84:87], v[4:7]
    s_add_u32 s12, s12, 20
    v_cvt_pk_f16_f32 v69, v42, v43
    v_pk_fma_f16 v91, v68, v68, s39
    v_mfma_f32_16x16x32_bf16 v[4:7], a[20:23], v[116:119], v[4:7]
    s_max_u32 s12, s12, s61
    ds_read_b128 v[8:11], v138 offset:3200
    v_pk_fmac_f16 v91, v69, v69
    v_mfma_f32_16x16x32_bf16 v[40:43], v[76:79], a[144:147], 0
    s_cmp_lt_u32 s61, s71
    ds_read_b128 v[44:47], v139 offset:3328
    v_pk_fmac_f16 v91, v70, v70
    v_mfma_f32_16x16x32_bf16 v[40:43], v[96:99], a[148:151], v[40:43]
    s_cselect_b32 s15, s61, s12
    ds_read_b128 v[52:55], v139 offset:3072
    v_cvt_pk_f16_f32 v32, v4, v5
    v_mfma_f32_16x16x32_bf16 v[40:43], v[80:83], a[152:155], v[40:43]
    s_cselect_b32 s56, s69, s70
    ds_read_b128 v[110:113], v139 offset:3200
    v_cvt_pk_f16_f32 v33, v6, v7
    v_mfma_f32_16x16x32_bf16 v[40:43], v[100:103], a[156:159], v[40:43]
    s_add_u32 s56, s56, s15
    v_pk_fma_f16 v90, v32, v32, s39
    v_pk_fmac_f16 v90, v33, v33
    v_mfma_f32_16x16x32_bf16 v[40:43], v[84:87], a[160:163], v[40:43]
    s_mul_i32 s53, s56, 58255
    v_pk_fmac_f16 v90, v34, v34
    v_pk_fmac_f16 v90, v35, v35
    v_mfma_f32_16x16x32_bf16 v[40:43], v[116:119], a[164:167], v[40:43]
    s_lshr_b32 s53, s53, 22
    v_pk_fmac_f16 v90, v150, v150
    v_pk_fmac_f16 v90, v151, v151
    v_mfma_f32_16x16x32_bf16 v[4:7], a[120:123], v[76:79], 0
    s_mul_i32 s53, s53, s63
    ds_write_b32 v137, v14 offset:8
    v_mfma_f32_16x16x32_bf16 v[4:7], a[124:127], v[96:99], v[4:7]
    s_mul_i32 s56, s56, s62
    v_cvt_pk_bf16_f32 v18, v40, v41
    v_cvt_pk_bf16_f32 v19, v42, v43
    v_mfma_f32_16x16x32_bf16 v[4:7], a[128:131], v[80:83], v[4:7]
    s_add_u32 s56, s56, s53
    v_pk_fmac_f16 v91, v71, v71
    v_mul_f32 v36, v36, v74
    v_mfma_f32_16x16x32_bf16 v[4:7], a[132:135], v[100:103], v[4:7]
    s_mul_i32 s4, s15, 336
    v_mul_f32 v37, v37, v74
    v_cvt_pk_bf16_f32 v12, v36, v37
    v_mfma_f32_16x16x32_bf16 v[4:7], a[136:139], v[84:87], v[4:7]
    s_cmp_ge_u32 s15, 16
    ds_write_b32 v137, v15 offset:12
    v_mfma_f32_16x16x32_bf16 v[4:7], a[140:143], v[116:119], v[4:7]
    s_waitcnt lgkmcnt(2)
    s_cselect_b32 s53, -26880, 0
    v_mul_f32 v38, v38, v74
    v_mul_f32 v39, v39, v74
    v_mfma_f32_16x16x32_bf16 v[40:43], a[72:75], v[52:55], 0
    s_add_u32 s4, s4, s53
    v_cvt_pk_bf16_f32 v13, v38, v39
    v_mul_f32 v28, v28, v74
    v_mfma_f32_16x16x32_bf16 v[40:43], a[76:79], v[60:63], v[40:43]
    s_cmp_lt_u32 s15, s73
    v_cvt_pk_f16_f32 v72, v4, v5
    v_cvt_pk_f16_f32 v73, v6, v7
    v_mfma_f32_16x16x32_bf16 v[40:43], a[80:83], v[110:113], v[40:43]
    s_cselect_b32 s26, 100270464, 0
    ds_write_b64 v136, v[22:23] offset:0
    v_mfma_f32_16x16x32_bf16 v[40:43], a[84:87], v[8:11], v[40:43]
    s_cselect_b32 s56, s56, 0
    v_pk_fmac_f16 v91, v72, v72
    v_pk_fmac_f16 v91, v73, v73
    v_mfma_f32_16x16x32_bf16 v[40:43], a[88:91], v[44:47], v[40:43]
    s_cselect_b32 s4, s4, -1
    v_mul_f32 v29, v29, v74
    v_cvt_pk_bf16_f32 v14, v28, v29
    v_mfma_f32_16x16x32_bf16 v[40:43], a[92:95], v[56:59], v[40:43]
    s_cselect_b32 s15, s15, 0
    v_mul_f32 v30, v30, v74
    v_mul_f32 v31, v31, v74
    v_mfma_f32_16x16x32_f16 v[4:7], v[212:215], v[88:91], 0
    s_cselect_b32 s13, s13, -1
    v_cvt_pk_bf16_f32 v15, v30, v31
    v_mul_f32 v24, v24, v74
    v_mfma_f32_16x16x32_bf16 v[28:31], a[0:3], v[52:55], 0
    s_bitset1_b32 s64, s15
    ds_write_b64 v137, v[14:15] offset:3080
    v_mfma_f32_16x16x32_bf16 v[28:31], a[4:7], v[60:63], v[28:31]
    s_add_u32 s65, s65, 1
    v_cvt_pk_f16_f32 v114, v40, v41
    v_cvt_pk_f16_f32 v115, v42, v43
    v_mfma_f32_16x16x32_bf16 v[28:31], a[8:11], v[110:113], v[28:31]
    s_cmp_ge_i32 s65, 2
    v_or3_b32 v125, v125, v4, v5
    v_or3_b32 v125, v125, v6, v7
    v_mfma_f32_16x16x32_bf16 v[28:31], a[12:15], v[8:11], v[28:31]
    s_cselect_b32 s30, 100270464, 0
    v_rsq_f32 v4, v4
    v_mfma_f32_16x16x32_bf16 v[28:31], a[16:19], v[44:47], v[28:31]
    s_add_u32 s67, s46, s54
    ds_write_b64 v137, v[12:13] offset:3072
    v_mfma_f32_16x16x32_bf16 v[28:31], a[20:23], v[56:59], v[28:31]
    s_add_u32 m0, s67, 0
    v_rsq_f32 v5, v5
    v_mfma_f32_16x16x32_bf16 v[12:15], a[48:51], v[52:55], 0
    v_mul_f32 v4, s52, v4
    v_cvt_pk_f16_f32 v4, v4, v5
    v_mfma_f32_16x16x32_bf16 v[12:15], a[52:55], v[60:63], v[12:15]
    v_rsq_f32 v6, v6
    v_mfma_f32_16x16x32_bf16 v[12:15], a[56:59], v[110:113], v[12:15]
    v_rsq_f32 v7, v7
    v_mfma_f32_16x16x32_bf16 v[12:15], a[60:63], v[8:11], v[12:15]
    v_mul_f32 v6, s52, v6
    v_cvt_pk_f16_f32 v6, v6, v7
    v_mfma_f32_16x16x32_bf16 v[12:15], a[64:67], v[44:47], v[12:15]
    v_pk_mul_f16 v104, v104, v4 op_sel:[0,1] op_sel_hi:[1,1]
    v_pk_mul_f16 v105, v105, v4 op_sel:[0,1] op_sel_hi:[1,1]
    v_mfma_f32_16x16x32_bf16 v[12:15], a[68:71], v[56:59], v[12:15]
    v_pk_mul_f16 v106, v106, v4 op_sel:[0,1] op_sel_hi:[1,1]
    v_pk_mul_f16 v107, v107, v4 op_sel:[0,1] op_sel_hi:[1,1]
    v_mfma_f32_16x16x32_bf16 v[40:43], v[52:55], a[144:147], 0
    v_pk_mul_f16 v108, v108, v4 op_sel:[0,1] op_sel_hi:[1,1]
    v_pk_mul_f16 v109, v109, v4 op_sel:[0,1] op_sel_hi:[1,1]
    v_mfma_f32_16x16x32_bf16 v[40:43], v[60:63], a[148:151], v[40:43]
    v_pk_mul_f16 v92, v92, v4 op_sel:[0,0] op_sel_hi:[1,0]
    v_pk_mul_f16 v93, v93, v4 op_sel:[0,0] op_sel_hi:[1,0]
    v_mfma_f32_16x16x32_bf16 v[40:43], v[110:113], a[152:155], v[40:43]
    v_pk_mul_f16 v94, v94, v4 op_sel:[0,0] op_sel_hi:[1,0]
    v_pk_mul_f16 v95, v95, v4 op_sel:[0,0] op_sel_hi:[1,0]
    v_mfma_f32_16x16x32_bf16 v[40:43], v[8:11], a[156:159], v[40:43]
    v_pk_mul_f16 v154, v154, v4 op_sel:[0,0] op_sel_hi:[1,0]
    v_pk_mul_f16 v155, v155, v4 op_sel:[0,0] op_sel_hi:[1,0]
    v_mfma_f32_16x16x32_bf16 v[40:43], v[44:47], a[160:163], v[40:43]
    v_pk_mul_f16 v68, v68, v6 op_sel:[0,1] op_sel_hi:[1,1]
    v_pk_mul_f16 v69, v69, v6 op_sel:[0,1] op_sel_hi:[1,1]
    v_mfma_f32_16x16x32_bf16 v[40:43], v[56:59], a[164:167], v[40:43]
    v_pk_mul_f16 v70, v70, v6 op_sel:[0,1] op_sel_hi:[1,1]
    v_pk_mul_f16 v71, v71, v6 op_sel:[0,1] op_sel_hi:[1,1]
    v_mfma_f32_16x16x32_bf16 v[48:51], v[76:79], a[192:195], 0
    v_pk_mul_f16 v72, v72, v6 op_sel:[0,1] op_sel_hi:[1,1]
    v_pk_mul_f16 v73, v73, v6 op_sel:[0,1] op_sel_hi:[1,1]
    v_mfma_f32_16x16x32_bf16 v[48:51], v[96:99], a[196:199], v[48:51]
    v_pk_fma_f16 v89, v114, v114, s39
    v_pk_fmac_f16 v89, v115, v115
    v_mfma_f32_16x16x32_bf16 v[48:51], v[80:83], a[200:203], v[48:51]
    v_cvt_pk_f16_f32 v76, v28, v29
    v_cvt_pk_f16_f32 v77, v30, v31
    v_mfma_f32_16x16x32_bf16 v[48:51], v[100:103], a[204:207], v[48:51]
    v_pk_fma_f16 v88, v76, v76, s39
    v_pk_fmac_f16 v88, v77, v77
    v_mfma_f32_16x16x32_bf16 v[48:51], v[84:87], a[208:211], v[48:51]
    v_mul_f32 v25, v25, v74
    v_cvt_pk_bf16_f32 v146, v24, v25
    v_mfma_f32_16x16x32_bf16 v[48:51], v[116:119], a[212:215], v[48:51]
    ds_write_b32 v136, v146 offset:3072
    v_mfma_f32_16x16x32_bf16 v[78:81], a[120:123], v[52:55], 0
    s_nop 0
    v_mul_f32 v26, v26, v74
    v_mul_f32 v27, v27, v74
    v_mfma_f32_16x16x32_bf16 v[78:81], a[124:127], v[60:63], v[78:81]
    s_nop 0
    v_cvt_pk_bf16_f32 v147, v26, v27
    v_cvt_pk_bf16_f32 v22, v48, v49
    v_mfma_f32_16x16x32_bf16 v[78:81], a[128:131], v[110:113], v[78:81]
    v_cvt_pk_bf16_f32 v23, v50, v51
    v_cvt_pk_f16_f32 v146, v12, v13
    v_mfma_f32_16x16x32_bf16 v[78:81], a[132:135], v[8:11], v[78:81]
    ds_write_b32 v136, v147 offset:3076
    v_mfma_f32_16x16x32_bf16 v[78:81], a[136:139], v[44:47], v[78:81]
    s_waitcnt vmcnt(0)
    v_cvt_pk_f16_f32 v147, v14, v15
    v_pk_mul_f16 v32, v32, v6 op_sel:[0,0] op_sel_hi:[1,0]
    v_mfma_f32_16x16x32_bf16 v[78:81], a[140:143], v[56:59], v[78:81]
    v_pk_mul_f16 v33, v33, v6 op_sel:[0,0] op_sel_hi:[1,0]
    v_pk_mul_f16 v34, v34, v6 op_sel:[0,0] op_sel_hi:[1,0]
    v_mfma_f32_16x16x32_bf16 v[12:15], v[52:55], a[168:171], 0
    v_pk_mul_f16 v35, v35, v6 op_sel:[0,0] op_sel_hi:[1,0]
    v_pk_mul_f16 v150, v150, v6 op_sel:[0,0] op_sel_hi:[1,0]
    v_mfma_f32_16x16x32_bf16 v[12:15], v[60:63], a[172:175], v[12:15]
    s_nop 0
    v_pk_mul_f16 v151, v151, v6 op_sel:[0,0] op_sel_hi:[1,0]
    v_cvt_pk_f16_f32 v118, v78, v79
    v_mfma_f32_16x16x32_bf16 v[12:15], v[110:113], a[176:179], v[12:15]
    v_cvt_pk_f16_f32 v119, v80, v81
    v_add_u32 v139, s50, v139
    v_mfma_f32_16x16x32_bf16 v[12:15], v[8:11], a[180:183], v[12:15]
    ds_read_b128 v[84:87], v139 offset:0
    v_add_u32 v138, s50, v138
    v_mfma_f32_16x16x32_bf16 v[12:15], v[44:47], a[184:187], v[12:15]
    ds_read_b128 v[80:83], v138 offset:0
    v_add_u32 v137, s48, v137
    v_mfma_f32_16x16x32_bf16 v[12:15], v[56:59], a[188:191], v[12:15]
    s_waitcnt lgkmcnt(2)
    ds_read_b128 v[96:99], v139 offset:128
    v_add_u32 v136, s48, v136
    v_mfma_f32_16x16x32_bf16 v[4:7], a[24:27], v[52:55], 0
    s_barrier
    ds_read_b128 v[100:103], v138 offset:128
    v_add_u32 v135, s51, v135
    v_mfma_f32_16x16x32_bf16 v[4:7], a[28:31], v[60:63], v[4:7]
    s_cmp_ge_u32 s61, s13
    ds_read_b128 v[28:31], v135 offset:0
    v_add_u32 v134, s14, v134
    v_mfma_f32_16x16x32_bf16 v[4:7], a[32:35], v[110:113], v[4:7]
    s_cbranch_scc1 L_atomF0
L_atomrF0:
    v_mfma_f32_16x16x32_bf16 v[4:7], a[36:39], v[8:11], v[4:7]
    ds_read_b128 v[24:27], v135 offset:2048
    v_add_u32 v133, s14, v133
    v_mfma_f32_16x16x32_bf16 v[4:7], a[40:43], v[44:47], v[4:7]
    ds_read_b128 v[48:51], v139 offset:256
    v_cvt_pk_bf16_f32 v164, v40, v41
    v_mfma_f32_16x16x32_bf16 v[4:7], a[44:47], v[56:59], v[4:7]
    ds_read_b128 v[64:67], v138 offset:256
    v_cvt_pk_bf16_f32 v165, v42, v43
    v_mfma_f32_16x16x32_bf16 v[40:43], a[96:99], v[52:55], 0
    s_nop 0
    v_cvt_pk_bf16_f32 v160, v12, v13
    v_cvt_pk_bf16_f32 v161, v14, v15
    v_mfma_f32_16x16x32_bf16 v[40:43], a[100:103], v[60:63], v[40:43]
    s_nop 0
    v_cvt_pk_f16_f32 v78, v4, v5
    v_cvt_pk_f16_f32 v79, v6, v7
    v_mfma_f32_16x16x32_bf16 v[40:43], a[104:107], v[110:113], v[40:43]
    v_pk_fmac_f16 v88, v78, v78
    v_pk_fmac_f16 v88, v79, v79
    v_mfma_f32_16x16x32_bf16 v[40:43], a[108:111], v[8:11], v[40:43]
    v_pk_fmac_f16 v88, v146, v146
    v_pk_fmac_f16 v88, v147, v147
    v_mfma_f32_16x16x32_bf16 v[40:43], a[112:115], v[44:47], v[40:43]
    s_waitcnt lgkmcnt(3)
    buffer_load_dwordx4 v130, s[24:27], s56 offen nt lds
    v_mfma_f32_16x16x32_bf16 v[40:43], a[116:119], v[56:59], v[40:43]
    s_nop 0
    v_mfma_f32_16x16x32_bf16 v[4:7], a[240:243], v[84:87], 0
    s_nop 0
    ds_read_b128 v[36:39], v135 offset:3072
    s_nop 0
    v_mfma_f32_16x16x32_bf16 v[4:7], a[244:247], v[80:83], v[4:7]
    s_nop 0
    ds_read_b128 v[120:123], v135 offset:1024
    v_cvt_pk_f16_f32 v116, v40, v41
    v_mfma_f32_16x16x32_bf16 v[4:7], a[248:251], v[96:99], v[4:7]
    v_cvt_pk_f16_f32 v117, v42, v43
    v_pk_fmac_f16 v89, v116, v116
    v_mfma_f32_16x16x32_bf16 v[4:7], a[252:255], v[100:103], v[4:7]
    s_waitcnt lgkmcnt(2)
    v_pk_fmac_f16 v89, v117, v117
    v_pk_fmac_f16 v89, v118, v118
    v_mfma_f32_16x16x32_bf16 v[4:7], v[224:227], v[48:51], v[4:7]
    v_pk_fmac_f16 v89, v119, v119
    v_mfma_f32_16x16x32_bf16 v[4:7], v[228:231], v[64:67], v[4:7]
    buffer_store_dwordx4 v[28:31], v130, s[28:31], s60 offen sc1
    v_mfma_f32_16x16x32_f16 v[40:43], v[212:215], v[88:91], 0
    s_add_u32 m0, s67, 1024
    s_nop 0
    v_mfma_f32_16x16x32_bf16 v[88:91], v[52:55], a[192:195], 0
    s_nop 2
    v_mfma_f32_16x16x32_bf16 v[88:91], v[60:63], a[196:199], v[88:91]
    s_nop 0
    v_or3_b32 v125, v125, v40, v41
    v_mfma_f32_16x16x32_bf16 v[88:91], v[110:113], a[200:203], v[88:91]
    s_waitcnt lgkmcnt(0)
    buffer_load_dwordx4 v129, s[24:27], s56 offen nt lds
    v_mfma_f32_16x16x32_bf16 v[88:91], v[8:11], a[204:207], v[88:91]
    ds_read_b128 v[60:63], v135 offset:4096
    v_mfma_f32_16x16x32_bf16 v[88:91], v[44:47], a[208:211], v[88:91]
    ds_read_u16 v166, v133 offset:56
    v_mfma_f32_16x16x32_bf16 v[88:91], v[56:59], a[212:215], v[88:91]
    ds_read_u16 v162, v133 offset:64
    v_mfma_f32_16x16x32_f16 v[44:47], v[68:71], v[92:95], v[200:203]
    s_nop 0
    ds_read_u16 v158, v133 offset:72
    s_nop 0
    v_mfma_f32_16x16x32_f16 v[44:47], v[70:73], v[152:155], v[44:47]
    s_nop 0
    ds_read_b128 v[54:57], v134 offset:32
    v_cvt_pk_bf16_f32 v156, v88, v89
    v_mfma_f32_16x16x32_bf16 v[12:15], a[216:219], v[84:87], 0
    ds_read_b128 v[28:31], v134 offset:0
    v_cvt_pk_bf16_f32 v157, v90, v91
    v_mfma_f32_16x16x32_bf16 v[12:15], a[220:223], v[80:83], v[12:15]
    buffer_store_dwordx4 v[120:123], v129, s[28:31], s60 offen sc1
    ds_read_b64 v[142:143], v134 offset:16
    v_rsq_f32 v40, v40
    v_mfma_f32_16x16x32_bf16 v[12:15], a[224:227], v[96:99], v[12:15]
    s_add_u32 m0, s67, 2048
    v_rsq_f32 v41, v41
    v_mfma_f32_16x16x32_bf16 v[12:15], a[228:231], v[100:103], v[12:15]
    v_exp_f32 v44, v44
    v_mfma_f32_16x16x32_bf16 v[12:15], a[232:235], v[48:51], v[12:15]
    v_exp_f32 v45, v45
    v_mfma_f32_16x16x32_bf16 v[12:15], a[236:239], v[64:67], v[12:15]
    buffer_load_dwordx4 v128, s[24:27], s56 offen nt lds
    v_mul_f32 v40, s52, v40
    v_mfma_f32_16x16x32_bf16 v[8:11], v[232:235], v[84:87], 0
    ds_read_b64 v[58:59], v134 offset:48
    v_cvt_pk_f16_f32 v40, v40, v41
    v_mfma_f32_16x16x32_bf16 v[8:11], v[236:239], v[80:83], v[8:11]
    v_pk_mul_f16 v114, v114, v40 op_sel:[0,1] op_sel_hi:[1,1]
    v_pk_mul_f16 v115, v115, v40 op_sel:[0,1] op_sel_hi:[1,1]
    v_mfma_f32_16x16x32_bf16 v[8:11], v[240:243], v[96:99], v[8:11]
    v_pk_mul_f16 v116, v116, v40 op_sel:[0,1] op_sel_hi:[1,1]
    v_pk_mul_f16 v117, v117, v40 op_sel:[0,1] op_sel_hi:[1,1]
    v_mfma_f32_16x16x32_bf16 v[8:11], v[244:247], v[100:103], v[8:11]
    v_pk_mul_f16 v118, v118, v40 op_sel:[0,1] op_sel_hi:[1,1]
    v_pk_mul_f16 v119, v119, v40 op_sel:[0,1] op_sel_hi:[1,1]
    v_mfma_f32_16x16x32_bf16 v[8:11], v[248:251], v[48:51], v[8:11]
    v_pk_mul_f16 v76, v76, v40 op_sel:[0,0] op_sel_hi:[1,0]
    v_pk_mul_f16 v77, v77, v40 op_sel:[0,0] op_sel_hi:[1,0]
    v_mfma_f32_16x16x32_bf16 v[8:11], v[252:255], v[64:67], v[8:11]
    v_pk_mul_f16 v78, v78, v40 op_sel:[0,0] op_sel_hi:[1,0]
    v_pk_mul_f16 v79, v79, v40 op_sel:[0,0] op_sel_hi:[1,0]
    v_mfma_f32_16x16x32_f16 v[84:87], v[104:107], v[92:95], v[204:207]
    s_add_u32 m0, s67, 3072
    buffer_store_dwordx4 v[24:27], v128, s[28:31], s60 offen sc1
    v_pk_mul_f16 v146, v146, v40 op_sel:[0,0] op_sel_hi:[1,0]
    v_pk_mul_f16 v147, v147, v40 op_sel:[0,0] op_sel_hi:[1,0]
    v_exp_f32 v46, v46
    v_mfma_f32_16x16x32_f16 v[84:87], v[106:109], v[152:155], v[84:87]
    s_waitcnt lgkmcnt(1)
    v_exp_f32 v47, v47
    v_mfma_f32_16x16x32_f16 v[80:83], v[54:57], v[92:95], v[208:211]
    s_waitcnt lgkmcnt(0)
    v_cvt_pk_bf16_f32 v98, v44, v45
    v_cvt_pk_bf16_f32 v99, v46, v47
    v_mfma_f32_16x16x32_f16 v[80:83], v[56:59], v[152:155], v[80:83]
    s_nop 0
    v_exp_f32 v84, v84
    v_mfma_f32_16x16x32_f16 v[44:47], v[28:31], v[104:107], v[208:211]
    buffer_load_dwordx4 v127, s[24:27], s56 offen nt lds
    v_mfma_f32_16x16x32_f16 v[44:47], v[140:143], v[106:109], v[44:47]
    v_exp_f32 v85, v85
    v_mfma_f32_16x16x32_f16 v[88:91], v[28:31], v[68:71], v[208:211]
    v_exp_f32 v86, v86
    v_mfma_f32_16x16x32_f16 v[88:91], v[140:143], v[70:73], v[88:91]
    v_exp_f32 v87, v87
    v_mfma_f32_16x16x32_f16 v[100:103], v[28:31], v[114:117], v[208:211]
    v_cvt_pk_bf16_f32 v96, v84, v85
    v_cvt_pk_bf16_f32 v97, v86, v87
    v_mfma_f32_16x16x32_f16 v[100:103], v[140:143], v[116:119], v[100:103]
    v_exp_f32 v80, v80
    v_mfma_f32_16x16x32_f16 v[84:87], v[114:117], v[92:95], v[196:199]
    s_nop 0
    v_cvt_pk_bf16_f32 v170, v80, 0
    v_mov_b32_dpp v47, v91 quad_perm:[0,1,2,3] row_mask:0x2 bank_mask:0xf
    v_mfma_f32_16x16x32_f16 v[84:87], v[116:119], v[152:155], v[84:87]
    s_nop 0
    buffer_store_dwordx4 v[36:39], v127, s[28:31], s60 offen sc1
    v_mov_b32_dpp v47, v103 quad_perm:[0,1,2,3] row_mask:0x4 bank_mask:0xf
    v_exp_f32 v47, v47
    v_mfma_f32_16x16x32_f16 v[80:83], v[68:71], v[32:35], v[188:191]
    s_add_u32 m0, s67, 4096
    v_cvt_pk_bf16_f32 v47, v47, v47
    v_mfma_f32_16x16x32_f16 v[80:83], v[70:73], v[148:151], v[80:83]
    s_mov_b32 s53, s47
    ds_write_b16 v133, v47
    v_mfma_f32_16x16x32_f16 v[44:47], v[104:107], v[32:35], v[192:195]
    s_mov_b32 s47, s46
    v_exp_f32 v84, v84
    v_mfma_f32_16x16x32_f16 v[44:47], v[106:109], v[148:151], v[44:47]
    s_mov_b32 s46, s45
    v_exp_f32 v85, v85
    v_mfma_f32_16x16x32_f16 v[28:31], v[114:117], v[76:79], v[172:175]
    s_mov_b32 s45, s44
    ds_read_b128 v[92:95], v134 offset:16
    v_cvt_pk_bf16_f32 v168, v84, v85
    v_mfma_f32_16x16x32_f16 v[28:31], v[116:119], v[144:147], v[28:31]
    s_mov_b32 s44, s53
    v_exp_f32 v86, v86
    v_mfma_f32_16x16x32_f16 v[88:91], v[54:57], v[32:35], v[208:211]
    s_sub_u32 s48, s44, s46
    ds_read_b128 v[100:103], v134
    v_mfma_f32_16x16x32_f16 v[88:91], v[56:59], v[148:151], v[88:91]
    v_exp_f32 v87, v87
    v_mfma_f32_16x16x32_f16 v[40:43], v[114:117], v[32:35], v[184:187]
    v_exp_f32 v80, v80
    v_mfma_f32_16x16x32_f16 v[40:43], v[116:119], v[148:151], v[40:43]
    v_exp_f32 v81, v81
    v_mfma_f32_16x16x32_f16 v[24:27], v[54:57], v[76:79], v[208:211]
    v_cvt_pk_bf16_f32 v169, v86, v87
    v_cvt_pk_bf16_f32 v34, v80, v81
    v_mfma_f32_16x16x32_f16 v[24:27], v[56:59], v[144:147], v[24:27]
    buffer_load_dwordx4 v126, s[24:27], s56 offen nt lds
    v_mfma_f32_16x16x32_bf16 v[56:59], v[220:223], v[96:99], 0
    v_exp_f32 v82, v82
    v_mfma_f32_16x16x32_bf16 v[56:59], v[220:223], v[168:171], v[56:59]
    v_exp_f32 v83, v83
    v_mfma_f32_16x16x32_bf16 v[52:55], v[16:19], v[96:99], 0
    v_exp_f32 v44, v44
    v_mfma_f32_16x16x32_bf16 v[52:55], v[164:167], v[168:171], v[52:55]
    s_waitcnt lgkmcnt(0)
    buffer_store_dwordx4 v[60:63], v126, s[28:31], s60 offen sc1
    v_cvt_pk_bf16_f32 v35, v82, v83
    v_exp_f32 v45, v45
    v_mfma_f32_16x16x32_bf16 v[80:83], v[100:103], v[16:19], 0
    v_exp_f32 v46, v46
    v_mfma_f32_16x16x32_bf16 v[80:83], v[92:95], v[164:167], v[80:83]
    v_exp_f32 v47, v47
    v_mfma_f32_16x16x32_bf16 v[84:87], v[100:103], v[0:3], 0
    ds_read_b128 v[60:63], v138 offset:1536
    v_cvt_pk_bf16_f32 v32, v44, v45
    v_mfma_f32_16x16x32_bf16 v[84:87], v[92:95], v[160:163], v[84:87]
    s_sub_u32 s49, s46, s45
    ds_read_b128 v[48:51], v139 offset:1664
    v_cvt_pk_bf16_f32 v33, v46, v47
    v_mfma_f32_16x16x32_bf16 v[116:119], v[100:103], v[20:23], 0
    s_cmp_lg_u32 s5, -1
    v_exp_f32 v89, v89
    v_mfma_f32_16x16x32_bf16 v[116:119], v[92:95], v[156:159], v[116:119]
    v_exp_f32 v40, v40
    v_mfma_f32_16x16x32_bf16 v[92:95], v[0:3], v[96:99], 0
    v_exp_f32 v41, v41
    v_mfma_f32_16x16x32_bf16 v[92:95], v[160:163], v[168:171], v[92:95]
    v_exp_f32 v42, v42
    v_mfma_f32_16x16x32_bf16 v[100:103], v[20:23], v[96:99], 0
    v_exp_f32 v43, v43
    v_mfma_f32_16x16x32_bf16 v[100:103], v[156:159], v[168:171], v[100:103]
    ds_read_b128 v[64:67], v138 offset:1664
    v_mov_b32_dpp v83, v87 quad_perm:[0,1,2,3] row_mask:0x2 bank_mask:0xf
    v_mfma_f32_16x16x32_f16 v[36:39], v[68:71], v[76:79], v[176:179]
    ds_read_b128 v[112:115], v139 offset:1536
    v_mov_b32_dpp v83, v119 quad_perm:[0,1,2,3] row_mask:0x4 bank_mask:0xf
    v_mfma_f32_16x16x32_f16 v[36:39], v[70:73], v[144:147], v[36:39]
    v_cvt_pk_bf16_f32 v83, v83, v83
    v_cvt_pk_bf16_f32 v168, v40, v41
    v_mfma_f32_16x16x32_f16 v[84:87], v[104:107], v[76:79], v[180:183]
    ds_read_b128 v[68:71], v139 offset:1792
    v_cvt_pk_bf16_f32 v169, v42, v43
    v_mfma_f32_16x16x32_f16 v[84:87], v[106:109], v[144:147], v[84:87]
    ds_read_b128 v[120:123], v138 offset:1792
    v_cvt_pk_bf16_f32 v170, v89, 0
    v_mfma_f32_16x16x32_bf16 v[116:119], v[220:223], v[32:35], 0
    v_rcp_f32 v56, v56
    v_mfma_f32_16x16x32_bf16 v[116:119], v[220:223], v[168:171], v[116:119]
    v_mul_f32 v52, v52, v56
    v_mul_f32 v53, v53, v56
    v_mfma_f32_16x16x32_bf16 v[76:79], v[16:19], v[32:35], 0
    v_cvt_pk_bf16_f32 v52, v52, v53
    v_mul_f32 v54, v54, v56
    v_mfma_f32_16x16x32_bf16 v[76:79], v[164:167], v[168:171], v[76:79]
    ds_write_b16 v133, v83 offset:56
    v_mfma_f32_16x16x32_bf16 v[80:83], v[0:3], v[32:35], 0
    v_mul_f32 v55, v55, v56
    v_cvt_pk_bf16_f32 v53, v54, v55
    v_mfma_f32_16x16x32_bf16 v[80:83], v[160:163], v[168:171], v[80:83]
    v_mul_f32 v92, v92, v56
    v_mul_f32 v93, v93, v56
    v_mfma_f32_16x16x32_bf16 v[72:75], v[20:23], v[32:35], 0
    v_cvt_pk_bf16_f32 v54, v92, v93
    v_mul_f32 v94, v94, v56
    v_mfma_f32_16x16x32_bf16 v[72:75], v[156:159], v[168:171], v[72:75]
    s_waitcnt lgkmcnt(2)
    ds_write_b64 v137, v[52:53] offset:0
    v_mfma_f32_16x16x32_bf16 v[44:47], a[216:219], v[112:115], 0
    v_mul_f32 v95, v95, v56
    v_cvt_pk_bf16_f32 v55, v94, v95
    v_mfma_f32_16x16x32_bf16 v[44:47], a[220:223], v[60:63], v[44:47]
    v_mul_f32 v100, v100, v56
    v_mul_f32 v101, v101, v56
    v_mfma_f32_16x16x32_bf16 v[44:47], a[224:227], v[48:51], v[44:47]
    ds_read_b128 v[96:99], v139 offset:3072
    v_cvt_pk_bf16_f32 v52, v100, v101
    v_mfma_f32_16x16x32_bf16 v[44:47], a[228:231], v[64:67], v[44:47]
    ds_read_b128 v[104:107], v139 offset:3200
    v_mul_f32 v102, v102, v56
    v_mfma_f32_16x16x32_bf16 v[44:47], a[232:235], v[68:71], v[44:47]
    s_waitcnt lgkmcnt(3)
    ds_read_b128 v[92:95], v138 offset:3200
    v_mul_f32 v103, v103, v56
    v_mfma_f32_16x16x32_bf16 v[44:47], a[236:239], v[120:123], v[44:47]
    ds_read_b128 v[88:91], v138 offset:3328
    v_cvt_pk_bf16_f32 v53, v102, v103
    v_mfma_f32_16x16x32_bf16 v[32:35], v[232:235], v[112:115], 0
    v_exp_f32 v28, v28
    v_mfma_f32_16x16x32_bf16 v[32:35], v[236:239], v[60:63], v[32:35]
    ds_read_b128 v[100:103], v139 offset:3328
    v_add_u32 v139, s48, v139
    v_mfma_f32_16x16x32_bf16 v[32:35], v[240:243], v[48:51], v[32:35]
    v_exp_f32 v29, v29
    v_mfma_f32_16x16x32_bf16 v[32:35], v[244:247], v[64:67], v[32:35]
    ds_read_b128 v[108:111], v138 offset:3072
    v_cvt_pk_bf16_f32 v168, v28, v29
    v_mfma_f32_16x16x32_bf16 v[32:35], v[248:251], v[68:71], v[32:35]
    v_exp_f32 v30, v30
    v_mfma_f32_16x16x32_bf16 v[32:35], v[252:255], v[120:123], v[32:35]
    v_exp_f32 v31, v31
    v_mfma_f32_16x16x32_bf16 v[40:43], a[240:243], v[112:115], 0
    v_exp_f32 v26, v26
    v_mfma_f32_16x16x32_bf16 v[40:43], a[244:247], v[60:63], v[40:43]
    ds_write_b64 v137, v[54:55] offset:8
    v_mfma_f32_16x16x32_bf16 v[40:43], a[248:251], v[48:51], v[40:43]
    v_cvt_pk_bf16_f32 v169, v30, v31
    v_cvt_pk_bf16_f32 v170, v26, 0
    v_mfma_f32_16x16x32_bf16 v[40:43], a[252:255], v[64:67], v[40:43]
    v_exp_f32 v36, v36
    v_mfma_f32_16x16x32_bf16 v[40:43], v[224:227], v[68:71], v[40:43]
    ds_read_b128 v[56:59], v139 offset:256
    v_add_u32 v138, s48, v138
    v_mfma_f32_16x16x32_bf16 v[40:43], v[228:231], v[120:123], v[40:43]
    s_waitcnt lgkmcnt(2)
    ds_read_b128 v[60:63], v138 offset:0
    v_fma_f32 v114, v12, v12, s42
    v_mfma_f32_16x16x32_bf16 v[28:31], a[240:243], v[96:99], 0
    ds_read_b128 v[68:71], v139 offset:0
    v_fmac_f32 v114, v13, v13
    v_mfma_f32_16x16x32_bf16 v[28:31], a[244:247], v[108:111], v[28:31]
    v_exp_f32 v37, v37
    v_mfma_f32_16x16x32_bf16 v[28:31], a[248:251], v[104:107], v[28:31]
    v_exp_f32 v38, v38
    v_mfma_f32_16x16x32_bf16 v[28:31], a[252:255], v[92:95], v[28:31]
    v_exp_f32 v39, v39
    v_mfma_f32_16x16x32_bf16 v[28:31], v[224:227], v[100:103], v[28:31]
    ds_write_b64 v136, v[52:53] offset:0
    v_mfma_f32_16x16x32_bf16 v[28:31], v[228:231], v[88:91], v[28:31]
    v_cvt_pk_bf16_f32 v112, v36, v37
    v_cvt_pk_bf16_f32 v113, v38, v39
    v_mfma_f32_16x16x32_bf16 v[24:27], v[232:235], v[96:99], 0
    v_exp_f32 v84, v84
    v_mfma_f32_16x16x32_bf16 v[24:27], v[236:239], v[108:111], v[24:27]
    ds_read_b128 v[52:55], v139 offset:128
    v_fmac_f32 v114, v14, v14
    v_mfma_f32_16x16x32_bf16 v[24:27], v[240:243], v[104:107], v[24:27]
    ds_read_b128 v[48:51], v138 offset:128
    v_fmac_f32 v114, v15, v15
    v_mfma_f32_16x16x32_bf16 v[24:27], v[244:247], v[92:95], v[24:27]
    ds_read_b128 v[64:67], v138 offset:256
    v_fmac_f32 v114, v4, v4
    v_mfma_f32_16x16x32_bf16 v[24:27], v[248:251], v[100:103], v[24:27]
    v_exp_f32 v85, v85
    v_mfma_f32_16x16x32_bf16 v[24:27], v[252:255], v[88:91], v[24:27]
    v_exp_f32 v86, v86
    v_mfma_f32_16x16x32_bf16 v[36:39], a[216:219], v[96:99], 0
    v_exp_f32 v87, v87
    v_mfma_f32_16x16x32_bf16 v[36:39], a[220:223], v[108:111], v[36:39]
    v_cvt_pk_bf16_f32 v110, v84, v85
    v_cvt_pk_bf16_f32 v111, v86, v87
    v_mfma_f32_16x16x32_bf16 v[36:39], a[224:227], v[104:107], v[36:39]
    v_rcp_f32 v116, v116
    v_mfma_f32_16x16x32_bf16 v[36:39], a[228:231], v[92:95], v[36:39]
    v_mul_f32 v76, v76, v116
    v_mul_f32 v77, v77, v116
    v_mfma_f32_16x16x32_bf16 v[36:39], a[232:235], v[100:103], v[36:39]
    v_cvt_pk_bf16_f32 v84, v76, v77
    v_mul_f32 v78, v78, v116
    v_mfma_f32_16x16x32_bf16 v[36:39], a[236:239], v[88:91], v[36:39]
    v_mul_f32 v79, v79, v116
    v_cvt_pk_bf16_f32 v85, v78, v79
    v_mfma_f32_16x16x32_bf16 v[76:79], v[220:223], v[110:113], 0
    ds_write_b64 v137, v[84:85] offset:1536
    v_mfma_f32_16x16x32_bf16 v[76:79], v[220:223], v[168:171], v[76:79]
    v_mul_f32 v80, v80, v116
    v_mul_f32 v81, v81, v116
    v_mfma_f32_16x16x32_bf16 v[96:99], v[16:19], v[110:113], 0
    v_cvt_pk_bf16_f32 v86, v80, v81
    v_mul_f32 v82, v82, v116
    v_mfma_f32_16x16x32_bf16 v[96:99], v[164:167], v[168:171], v[96:99]
    v_mul_f32 v83, v83, v116
    v_cvt_pk_bf16_f32 v87, v82, v83
    v_mfma_f32_16x16x32_bf16 v[16:19], v[0:3], v[110:113], 0
    ds_write_b32 v137, v86 offset:1544
    v_mfma_f32_16x16x32_bf16 v[16:19], v[160:163], v[168:171], v[16:19]
    v_mul_f32 v72, v72, v116
    v_mul_f32 v73, v73, v116
    v_mfma_f32_16x16x32_bf16 v[0:3], v[20:23], v[110:113], 0
    v_cvt_pk_bf16_f32 v154, v72, v73
    v_mul_f32 v74, v74, v116
    v_mfma_f32_16x16x32_bf16 v[0:3], v[156:159], v[168:171], v[0:3]
    s_waitcnt lgkmcnt(2)
    v_mul_f32 v75, v75, v116
    v_cvt_pk_bf16_f32 v155, v74, v75
    v_mfma_f32_16x16x32_bf16 v[20:23], a[0:3], v[68:71], 0
    s_cbranch_scc1 L_loopF0
L_tailF:
    ds_write_b32 v137, v87 offset:1548
    v_rcp_f32 v76, v76
    s_mov_b32 s30, 100270464
    s_mul_i32 s89, s68, 5376
    ds_write_b64 v136, v[154:155] offset:1536
    v_mul_f32 v96, v96, v76
    v_mul_f32 v97, v97, v76
    v_cvt_pk_bf16_f32 v20, v96, v97
    v_mul_f32 v98, v98, v76
    v_mul_f32 v99, v99, v76
    v_cvt_pk_bf16_f32 v21, v98, v99
    v_mul_f32 v16, v16, v76
    v_mul_f32 v17, v17, v76
    v_cvt_pk_bf16_f32 v22, v16, v17
    v_mul_f32 v18, v18, v76
    v_mul_f32 v19, v19, v76
    v_cvt_pk_bf16_f32 v23, v18, v19
    v_mul_f32 v0, v0, v76
    v_mul_f32 v1, v1, v76
    v_cvt_pk_bf16_f32 v0, v0, v1
    v_mul_f32 v2, v2, v76
    v_mul_f32 v3, v3, v76
    v_cvt_pk_bf16_f32 v1, v2, v3
    s_add_u32 s89, s89, 142336
    s_movk_i32 s90, 336
    ds_write_b64 v137, v[20:21] offset:3072
    v_fmac_f32 v114, v5, v5
    s_lshr_b32 s91, s64, 16
    s_lshl_b32 s92, s68, 10
    ds_write_b64 v137, v[22:23] offset:3080
    v_fmac_f32 v114, v6, v6
    v_fmac_f32 v114, v7, v7
    v_fmac_f32 v114, v8, v8
    s_sub_u32 s84, s45, s44
    s_sub_u32 s85, s46, s45
    ds_write_b32 v136, v0 offset:3072
    ds_write_b32 v136, v1 offset:3076
    v_fmac_f32 v114, v9, v9
    v_fmac_f32 v114, v10, v10
    v_fmac_f32 v114, v11, v11
    v_fma_f32 v133, v44, v44, s42
    v_fmac_f32 v133, v45, v45
    v_fmac_f32 v133, v46, v46
    v_fmac_f32 v133, v47, v47
    v_fmac_f32 v133, v40, v40
    v_fmac_f32 v133, v41, v41
    v_fmac_f32 v133, v42, v42
    v_fmac_f32 v133, v43, v43
    v_fmac_f32 v133, v32, v32
    v_fmac_f32 v133, v33, v33
    v_fmac_f32 v133, v34, v34
    v_fmac_f32 v133, v35, v35
    v_fma_f32 v134, v36, v36, s42
    v_fmac_f32 v134, v37, v37
    v_fmac_f32 v134, v38, v38
    v_fmac_f32 v134, v39, v39
    v_fmac_f32 v134, v28, v28
    v_fmac_f32 v134, v29, v29
    v_fmac_f32 v134, v30, v30
    v_fmac_f32 v134, v31, v31
    v_fmac_f32 v134, v24, v24
    v_fmac_f32 v134, v25, v25
    v_fmac_f32 v134, v26, v26
    v_fmac_f32 v134, v27, v27
    v_cvt_pk_bf16_f32 v0, v114, v133
    v_cvt_pk_bf16_f32 v1, v134, v124
    s_sub_u32 s86, s44, s45
    s_sub_u32 s93, s44, s47
    ds_write_b64 v132, v[0:1]
    v_mbcnt_lo_u32_b32 v124, -1, 0
    v_mbcnt_hi_u32_b32 v124, -1, v124
    v_and_b32 v133, 15, v124
    v_lshrrev_b32 v124, 4, v124
    v_mul_u32_u24 v124, 80, v124
    v_add_u32 v124, s89, v124
    v_mad_u32_u24 v100, v133, s90, v124
    v_lshrrev_b32 v134, v133, s64
    v_and_b32 v134, 1, v134
    v_cmp_eq_u32 vcc, 1, v134
    v_mad_u32_u24 v62, v133, s90, v124
    v_lshrrev_b32 v133, v133, s91
    v_cndmask_b32 v100, v124, v100, vcc
    v_and_b32 v133, 1, v133
    v_subrev_u32 v62, 21504, v62
    v_cmp_eq_u32 vcc, 1, v133
    s_sub_u32 s94, s45, s47
    s_sub_u32 s95, s46, s47
    ds_read_b128 v[64:67], v100
    ds_read_b128 v[56:59], v100 offset:16
    v_cndmask_b32 v62, v124, v62, vcc
    v_add_u32 v124, s92, v131
    s_waitcnt lgkmcnt(2)
    s_barrier
    ds_read_b64 v[102:103], v100 offset:56
    ds_read_b128 v[104:107], v100 offset:64
    v_add_u32 v1, s84, v139
    v_add_u32 v63, s84, v138
    ds_read_b128 v[16:19], v124 offset:6144
    v_add_u32 v61, s85, v137
    ds_read_b128 v[52:55], v131 offset:0
    v_add_u32 v60, s85, v136
    ds_read_b128 v[20:23], v131 offset:1024
    v_add_u32 v134, s86, v137
    v_add_u32 v133, s86, v136
    v_add_u32 v124, s93, v135
    v_add_u32 v0, s94, v135
    s_waitcnt lgkmcnt(6)
    v_mfma_f32_16x16x32_bf16 v[48:51], v[220:223], v[64:67], 0
    s_waitcnt lgkmcnt(5)
    ds_read_b128 v[92:95], v1 offset:1536
    ds_read_b128 v[88:91], v63 offset:1536
    v_mfma_f32_16x16x32_bf16 v[48:51], v[220:223], v[56:59], v[48:51]
    s_waitcnt lgkmcnt(3)
    ds_read_b128 v[84:87], v1 offset:1664
    v_lshlrev_b32 v96, 16, v102
    v_and_b32 v102, 0xffff0000, v102
    v_lshlrev_b32 v97, 16, v103
    v_and_b32 v103, 0xffff0000, v103
    v_lshlrev_b32 v98, 16, v104
    v_and_b32 v104, 0xffff0000, v104
    v_rcp_f32 v48, v48
    v_lshlrev_b32 v99, 16, v105
    v_mfma_f32_16x16x32_bf16 v[64:67], v[216:219], v[52:55], 0
    s_waitcnt lgkmcnt(3)
    ds_read_b128 v[80:83], v63 offset:1664
    ds_read_b128 v[76:79], v1 offset:1792
    v_mfma_f32_16x16x32_bf16 v[64:67], v[216:219], v[20:23], v[64:67]
    s_waitcnt lgkmcnt(4)
    ds_read_b128 v[72:75], v63 offset:1792
    v_mul_f32 v96, v96, v48
    v_mul_f32 v102, v102, v48
    v_cvt_pk_bf16_f32 v96, v96, v102
    v_mul_f32 v97, v97, v48
    v_mfma_f32_16x16x32_bf16 v[56:59], a[216:219], v[92:95], 0
    s_waitcnt lgkmcnt(4)
    v_mul_f32 v103, v103, v48
    v_cvt_pk_bf16_f32 v97, v97, v103
    v_mfma_f32_16x16x32_bf16 v[56:59], a[220:223], v[88:91], v[56:59]
    s_waitcnt lgkmcnt(3)
    ds_read_b128 v[120:123], v1 offset:0
    ds_read_b128 v[116:119], v63 offset:0
    v_mfma_f32_16x16x32_bf16 v[56:59], a[224:227], v[84:87], v[56:59]
    s_waitcnt lgkmcnt(4)
    ds_read_b128 v[112:115], v1 offset:128
    v_mul_f32 v98, v98, v48
    v_mul_f32 v104, v104, v48
    v_cvt_pk_bf16_f32 v98, v98, v104
    v_and_b32 v105, 0xffff0000, v105
    v_mul_f32 v99, v99, v48
    v_mfma_f32_16x16x32_bf16 v[56:59], a[228:231], v[80:83], v[56:59]
    s_waitcnt lgkmcnt(4)
    ds_read_b128 v[100:103], v63 offset:128
    ds_read_b128 v[68:71], v1 offset:256
    v_mfma_f32_16x16x32_bf16 v[56:59], a[232:235], v[76:79], v[56:59]
    s_waitcnt lgkmcnt(5)
    ds_read_b128 v[20:23], v63 offset:256
    v_mul_f32 v105, v105, v48
    v_mfma_f32_16x16x32_bf16 v[56:59], a[236:239], v[72:75], v[56:59]
    v_cvt_pk_bf16_f32 v99, v99, v105
    v_lshlrev_b32 v67, 16, v106
    v_mfma_f32_16x16x32_bf16 v[52:55], a[240:243], v[92:95], 0
    ds_write_b128 v134, v[96:99] offset:0
    v_mfma_f32_16x16x32_bf16 v[52:55], a[244:247], v[88:91], v[52:55]
    v_and_b32 v106, 0xffff0000, v106
    v_mul_f32 v67, v67, v48
    v_mfma_f32_16x16x32_bf16 v[52:55], a[248:251], v[84:87], v[52:55]
    v_mul_f32 v106, v106, v48
    v_cvt_pk_bf16_f32 v2, v67, v106
    v_mfma_f32_16x16x32_bf16 v[52:55], a[252:255], v[80:83], v[52:55]
    v_lshlrev_b32 v3, 16, v107
    v_and_b32 v107, 0xffff0000, v107
    v_mfma_f32_16x16x32_bf16 v[52:55], v[224:227], v[76:79], v[52:55]
    v_mul_f32 v3, v3, v48
    v_mul_f32 v107, v107, v48
    v_mfma_f32_16x16x32_bf16 v[52:55], v[228:231], v[72:75], v[52:55]
    v_cvt_pk_bf16_f32 v3, v3, v107
    v_lshrrev_b32 v67, 0, v19
    v_mfma_f32_16x16x32_bf16 v[48:51], v[232:235], v[92:95], 0
    ds_write_b64 v133, v[2:3] offset:0
    v_mfma_f32_16x16x32_bf16 v[48:51], v[236:239], v[88:91], v[48:51]
    v_lshrrev_b32 v67, v67, s64
    v_and_b32 v67, 1, v67
    v_mfma_f32_16x16x32_bf16 v[48:51], v[240:243], v[84:87], v[48:51]
    v_cmp_eq_u32 vcc, 1, v67
    v_lshrrev_b32 v67, 8, v19
    v_mfma_f32_16x16x32_bf16 v[48:51], v[244:247], v[80:83], v[48:51]
    v_cndmask_b32 v16, 2.0, v16, vcc
    v_lshrrev_b32 v67, v67, s64
    v_mfma_f32_16x16x32_bf16 v[48:51], v[248:251], v[76:79], v[48:51]
    v_and_b32 v67, 1, v67
    v_cmp_eq_u32 vcc, 1, v67
    v_mfma_f32_16x16x32_bf16 v[48:51], v[252:255], v[72:75], v[48:51]
    s_waitcnt lgkmcnt(1)
    v_cndmask_b32 v17, 2.0, v17, vcc
    v_lshrrev_b32 v19, 16, v19
    v_mfma_f32_16x16x32_bf16 v[80:83], a[216:219], v[120:123], 0
    v_lshrrev_b32 v19, v19, s64
    v_and_b32 v19, 1, v19
    v_mfma_f32_16x16x32_bf16 v[80:83], a[220:223], v[116:119], v[80:83]
    ds_read_b128 v[108:111], v1 offset:3072
    ds_read_b128 v[104:107], v63 offset:3072
    v_mfma_f32_16x16x32_bf16 v[80:83], a[224:227], v[112:115], v[80:83]
    ds_read_b128 v[96:99], v1 offset:3200
    v_cmp_eq_u32 vcc, 1, v19
    v_mfma_f32_16x16x32_bf16 v[80:83], a[228:231], v[100:103], v[80:83]
    ds_read_b128 v[92:95], v63 offset:3200
    v_cndmask_b32 v18, 2.0, v18, vcc
    v_mfma_f32_16x16x32_bf16 v[80:83], a[232:235], v[68:71], v[80:83]
    ds_read_b128 v[88:91], v1 offset:3328
    v_add_u32 v19, s95, v135
    v_mfma_f32_16x16x32_bf16 v[80:83], a[236:239], v[20:23], v[80:83]
    ds_read_b128 v[84:87], v63 offset:3328
    v_fma_f32 v1, v56, v56, s42
    v_mfma_f32_16x16x32_bf16 v[76:79], a[240:243], v[120:123], 0
    v_rsq_f32 v64, v64
    v_mfma_f32_16x16x32_bf16 v[76:79], a[244:247], v[116:119], v[76:79]
    v_mul_f32 v64, s43, v64
    v_mul_f32 v12, v12, v64
    v_mfma_f32_16x16x32_bf16 v[76:79], a[248:251], v[112:115], v[76:79]
    v_mul_f32 v13, v13, v64
    v_cvt_pk_bf16_f32 v12, v12, v13
    v_mfma_f32_16x16x32_bf16 v[76:79], a[252:255], v[100:103], v[76:79]
    v_mul_f32 v14, v14, v64
    v_mul_f32 v15, v15, v64
    v_mfma_f32_16x16x32_bf16 v[76:79], v[224:227], v[68:71], v[76:79]
    v_cvt_pk_bf16_f32 v13, v14, v15
    v_mul_f32 v4, v4, v64
    v_mfma_f32_16x16x32_bf16 v[76:79], v[228:231], v[20:23], v[76:79]
    v_mul_f32 v5, v5, v64
    v_cvt_pk_bf16_f32 v14, v4, v5
    v_mfma_f32_16x16x32_bf16 v[72:75], v[232:235], v[120:123], 0
    v_mul_f32 v6, v6, v64
    v_mul_f32 v7, v7, v64
    v_mfma_f32_16x16x32_bf16 v[72:75], v[236:239], v[116:119], v[72:75]
    v_cvt_pk_bf16_f32 v15, v6, v7
    v_mul_f32 v8, v8, v64
    v_mfma_f32_16x16x32_bf16 v[72:75], v[240:243], v[112:115], v[72:75]
    ds_write_b128 v61, v[12:15] offset:0
    v_mfma_f32_16x16x32_bf16 v[72:75], v[244:247], v[100:103], v[72:75]
    v_mul_f32 v9, v9, v64
    v_cvt_pk_bf16_f32 v2, v8, v9
    v_mfma_f32_16x16x32_bf16 v[72:75], v[248:251], v[68:71], v[72:75]
    v_mul_f32 v10, v10, v64
    v_mul_f32 v11, v11, v64
    v_mfma_f32_16x16x32_bf16 v[72:75], v[252:255], v[20:23], v[72:75]
    s_waitcnt lgkmcnt(1)
    v_cvt_pk_bf16_f32 v3, v10, v11
    v_fma_f32 v135, v80, v80, s42
    v_mfma_f32_16x16x32_bf16 v[20:23], a[216:219], v[108:111], 0
    ds_write_b64 v60, v[2:3] offset:0
    v_mfma_f32_16x16x32_bf16 v[20:23], a[220:223], v[104:107], v[20:23]
    ds_read_b128 v[68:71], v62
    v_fmac_f32 v135, v81, v81
    v_mfma_f32_16x16x32_bf16 v[20:23], a[224:227], v[96:99], v[20:23]
    ds_read_b128 v[8:11], v62 offset:16
    v_fmac_f32 v135, v82, v82
    v_mfma_f32_16x16x32_bf16 v[20:23], a[228:231], v[92:95], v[20:23]
    ds_read_b64 v[2:3], v62 offset:56
    ds_read_b128 v[4:7], v62 offset:64
    v_mfma_f32_16x16x32_bf16 v[20:23], a[232:235], v[88:91], v[20:23]
    v_rsq_f32 v65, v65
    v_mfma_f32_16x16x32_bf16 v[20:23], a[236:239], v[84:87], v[20:23]
    v_mul_f32 v65, s43, v65
    v_mul_f32 v44, v44, v65
    v_mfma_f32_16x16x32_bf16 v[100:103], a[240:243], v[108:111], 0
    v_mul_f32 v45, v45, v65
    v_cvt_pk_bf16_f32 v12, v44, v45
    v_mfma_f32_16x16x32_bf16 v[100:103], a[244:247], v[104:107], v[100:103]
    v_mul_f32 v46, v46, v65
    v_mul_f32 v47, v47, v65
    v_mfma_f32_16x16x32_bf16 v[100:103], a[248:251], v[96:99], v[100:103]
    v_cvt_pk_bf16_f32 v13, v46, v47
    v_mul_f32 v40, v40, v65
    v_mfma_f32_16x16x32_bf16 v[100:103], a[252:255], v[92:95], v[100:103]
    v_mul_f32 v41, v41, v65
    v_cvt_pk_bf16_f32 v14, v40, v41
    v_mfma_f32_16x16x32_bf16 v[100:103], v[224:227], v[88:91], v[100:103]
    v_mul_f32 v42, v42, v65
    v_mul_f32 v43, v43, v65
    v_mfma_f32_16x16x32_bf16 v[100:103], v[228:231], v[84:87], v[100:103]
    v_cvt_pk_bf16_f32 v15, v42, v43
    v_mul_f32 v32, v32, v65
    v_mfma_f32_16x16x32_bf16 v[40:43], v[232:235], v[108:111], 0
    ds_write_b128 v61, v[12:15] offset:1536
    v_mfma_f32_16x16x32_bf16 v[40:43], v[236:239], v[104:107], v[40:43]
    v_mul_f32 v33, v33, v65
    v_cvt_pk_bf16_f32 v32, v32, v33
    v_mfma_f32_16x16x32_bf16 v[40:43], v[240:243], v[96:99], v[40:43]
    v_mul_f32 v34, v34, v65
    v_mul_f32 v35, v35, v65
    v_mfma_f32_16x16x32_bf16 v[40:43], v[244:247], v[92:95], v[40:43]
    v_cvt_pk_bf16_f32 v33, v34, v35
    v_fmac_f32 v135, v83, v83
    v_mfma_f32_16x16x32_bf16 v[40:43], v[248:251], v[88:91], v[40:43]
    ds_write_b64 v60, v[32:33] offset:1536
    v_mfma_f32_16x16x32_bf16 v[40:43], v[252:255], v[84:87], v[40:43]
    s_waitcnt lgkmcnt(2)
    v_rsq_f32 v66, v66
    v_mfma_f32_16x16x32_bf16 v[12:15], v[220:223], v[68:71], 0
    v_mul_f32 v66, s43, v66
    v_mul_f32 v36, v36, v66
    v_mfma_f32_16x16x32_bf16 v[12:15], v[220:223], v[8:11], v[12:15]
    v_mul_f32 v37, v37, v66
    v_cvt_pk_bf16_f32 v8, v36, v37
    v_mul_f32 v38, v38, v66
    v_mul_f32 v39, v39, v66
    v_cvt_pk_bf16_f32 v9, v38, v39
    v_mul_f32 v28, v28, v66
    v_mul_f32 v29, v29, v66
    v_cvt_pk_bf16_f32 v10, v28, v29
    v_mul_f32 v30, v30, v66
    v_mul_f32 v31, v31, v66
    v_cvt_pk_bf16_f32 v11, v30, v31
    v_mul_f32 v24, v24, v66
    v_mul_f32 v25, v25, v66
    v_cvt_pk_bf16_f32 v24, v24, v25
    v_mul_f32 v26, v26, v66
    v_mul_f32 v27, v27, v66
    v_cvt_pk_bf16_f32 v25, v26, v27
    ds_write_b128 v61, v[8:11] offset:3072
    v_fmac_f32 v135, v76, v76
    v_fmac_f32 v135, v77, v77
    v_fmac_f32 v135, v78, v78
    v_fmac_f32 v135, v79, v79
    ds_write_b64 v60, v[24:25] offset:3072
    v_fmac_f32 v135, v72, v72
    v_fmac_f32 v135, v73, v73
    v_fmac_f32 v135, v74, v74
    v_fmac_f32 v135, v75, v75
    v_fmac_f32 v1, v57, v57
    v_fmac_f32 v1, v58, v58
    v_fmac_f32 v1, v59, v59
    v_fmac_f32 v1, v52, v52
    v_fmac_f32 v1, v53, v53
    v_fmac_f32 v1, v54, v54
    v_fmac_f32 v1, v55, v55
    v_fmac_f32 v1, v48, v48
    v_fmac_f32 v1, v49, v49
    v_fmac_f32 v1, v50, v50
    v_fmac_f32 v1, v51, v51
    v_cvt_pk_bf16_f32 v14, v135, v1
    v_fma_f32 v1, v20, v20, s42
    v_fmac_f32 v1, v21, v21
    v_fmac_f32 v1, v22, v22
    v_fmac_f32 v1, v23, v23
    v_fmac_f32 v1, v100, v100
    v_fmac_f32 v1, v101, v101
    v_fmac_f32 v1, v102, v102
    v_fmac_f32 v1, v103, v103
    v_fmac_f32 v1, v40, v40
    v_fmac_f32 v1, v41, v41
    v_fmac_f32 v1, v42, v42
    v_fmac_f32 v1, v43, v43
    v_cvt_pk_bf16_f32 v15, v1, v1
    ds_write_b64 v132, v[14:15] offset:2048
    v_rcp_f32 v12, v12
    v_lshlrev_b32 v1, 16, v2
    v_and_b32 v2, 0xffff0000, v2
    v_mul_f32 v1, v1, v12
    v_mul_f32 v2, v2, v12
    v_cvt_pk_bf16_f32 v8, v1, v2
    v_lshlrev_b32 v135, 16, v3
    v_and_b32 v3, 0xffff0000, v3
    v_mul_f32 v135, v135, v12
    v_mul_f32 v3, v3, v12
    v_cvt_pk_bf16_f32 v9, v135, v3
    v_lshlrev_b32 v135, 16, v4
    v_and_b32 v4, 0xffff0000, v4
    v_mul_f32 v135, v135, v12
    v_mul_f32 v4, v4, v12
    v_cvt_pk_bf16_f32 v10, v135, v4
    v_lshlrev_b32 v4, 16, v5
    v_and_b32 v5, 0xffff0000, v5
    v_mul_f32 v4, v4, v12
    v_mul_f32 v5, v5, v12
    v_cvt_pk_bf16_f32 v11, v4, v5
    v_lshlrev_b32 v135, 16, v6
    v_and_b32 v6, 0xffff0000, v6
    v_mul_f32 v135, v135, v12
    v_mul_f32 v6, v6, v12
    v_cvt_pk_bf16_f32 v4, v135, v6
    v_lshlrev_b32 v135, 16, v7
    v_and_b32 v7, 0xffff0000, v7
    v_mul_f32 v135, v135, v12
    v_mul_f32 v7, v7, v12
    v_cvt_pk_bf16_f32 v5, v135, v7
    s_waitcnt lgkmcnt(0)
    s_barrier
    ds_write_b128 v134, v[8:11] offset:1536
    v_and_b32 v125, 0xb8000000, v125
    v_mov_b32 v3, 0x3f803f80
    v_cmp_ne_u32 vcc, 0, v125
    s_nop 0
    ds_write_b64 v133, v[4:5] offset:1536
    v_cndmask_b32 v3, 0, v3, vcc
    ds_read_b128 v[28:31], v19 offset:0
    ds_read_b128 v[4:7], v19 offset:1024
    ds_read_b128 v[8:11], v19 offset:2048
    ds_read_b128 v[112:115], v19 offset:3072
    ds_read_b128 v[84:87], v19 offset:4096
    s_waitcnt lgkmcnt(5)
    s_barrier
    s_waitcnt lgkmcnt(4)
    buffer_store_dwordx4 v[28:31], v130, s[28:31], s59 offen sc1
    ds_read_b128 v[24:27], v131 offset:2048
    ds_read_b128 v[12:15], v131 offset:3072
    ds_read_b128 v[108:111], v139 offset:1536
    ds_read_b128 v[104:107], v138 offset:1536
    ds_read_b128 v[96:99], v139 offset:1664
    ds_read_b128 v[88:91], v138 offset:1664
    ds_read_b128 v[44:47], v139 offset:1792
    s_waitcnt lgkmcnt(9)
    buffer_store_dwordx4 v[4:7], v129, s[28:31], s59 offen sc1
    ds_read_b128 v[36:39], v138 offset:1792
    s_waitcnt lgkmcnt(7)
    v_mfma_f32_16x16x32_bf16 v[4:7], v[216:219], v[24:27], 0
    s_waitcnt lgkmcnt(6)
    v_mfma_f32_16x16x32_bf16 v[4:7], v[216:219], v[12:15], v[4:7]
    s_waitcnt lgkmcnt(5)
    v_mfma_f32_16x16x32_bf16 v[12:15], a[216:219], v[108:111], 0
    s_waitcnt lgkmcnt(4)
    v_mfma_f32_16x16x32_bf16 v[12:15], a[220:223], v[104:107], v[12:15]
    s_waitcnt lgkmcnt(3)
    ds_read_b128 v[68:71], v139 offset:0
    ds_read_b128 v[64:67], v138 offset:0
    v_mfma_f32_16x16x32_bf16 v[12:15], a[224:227], v[96:99], v[12:15]
    s_waitcnt lgkmcnt(4)
    ds_read_b128 v[60:63], v139 offset:128
    v_mfma_f32_16x16x32_bf16 v[12:15], a[228:231], v[88:91], v[12:15]
    s_waitcnt lgkmcnt(4)
    buffer_store_dwordx4 v[8:11], v128, s[28:31], s59 offen sc1
    ds_read_b128 v[32:35], v138 offset:128
    v_rsq_f32 v4, v4
    v_mfma_f32_16x16x32_bf16 v[12:15], a[232:235], v[44:47], v[12:15]
    s_waitcnt lgkmcnt(4)
    ds_read_b128 v[24:27], v139 offset:256
    ds_read_b128 v[8:11], v138 offset:256
    v_mfma_f32_16x16x32_bf16 v[12:15], a[236:239], v[36:39], v[12:15]
    v_rsq_f32 v5, v5
    v_mfma_f32_16x16x32_bf16 v[28:31], a[240:243], v[108:111], 0
    v_mul_f32 v4, s43, v4
    v_mul_f32 v5, s43, v5
    v_mfma_f32_16x16x32_bf16 v[28:31], a[244:247], v[104:107], v[28:31]
    v_rsq_f32 v6, v6
    v_mfma_f32_16x16x32_bf16 v[28:31], a[248:251], v[96:99], v[28:31]
    v_mul_f32 v6, s43, v6
    v_mul_f32 v20, v20, v6
    v_mfma_f32_16x16x32_bf16 v[28:31], a[252:255], v[88:91], v[28:31]
    buffer_store_dwordx4 v[112:115], v127, s[28:31], s59 offen sc1
    v_mul_f32 v21, v21, v6
    v_cvt_pk_bf16_f32 v92, v20, v21
    v_mul_f32 v22, v22, v6
    v_mul_f32 v23, v23, v6
    v_mfma_f32_16x16x32_bf16 v[28:31], v[224:227], v[44:47], v[28:31]
    v_cvt_pk_bf16_f32 v93, v22, v23
    v_mul_f32 v100, v100, v6
    v_mfma_f32_16x16x32_bf16 v[28:31], v[228:231], v[36:39], v[28:31]
    v_mul_f32 v101, v101, v6
    v_cvt_pk_bf16_f32 v94, v100, v101
    v_mfma_f32_16x16x32_bf16 v[20:23], v[232:235], v[108:111], 0
    v_mul_f32 v102, v102, v6
    v_mul_f32 v103, v103, v6
    v_mfma_f32_16x16x32_bf16 v[20:23], v[236:239], v[104:107], v[20:23]
    v_cvt_pk_bf16_f32 v95, v102, v103
    v_mul_f32 v40, v40, v6
    v_mfma_f32_16x16x32_bf16 v[20:23], v[240:243], v[96:99], v[20:23]
    ds_write_b128 v137, v[92:95] offset:3072
    v_mfma_f32_16x16x32_bf16 v[20:23], v[244:247], v[88:91], v[20:23]
    buffer_store_dwordx4 v[84:87], v126, s[28:31], s59 offen sc1
    v_mul_f32 v41, v41, v6
    v_cvt_pk_bf16_f32 v138, v40, v41
    v_mul_f32 v42, v42, v6
    v_mul_f32 v43, v43, v6
    v_mfma_f32_16x16x32_bf16 v[20:23], v[248:251], v[44:47], v[20:23]
    v_cvt_pk_bf16_f32 v139, v42, v43
    v_mul_f32 v80, v80, v4
    v_mfma_f32_16x16x32_bf16 v[20:23], v[252:255], v[36:39], v[20:23]
    s_waitcnt lgkmcnt(1)
    ds_write_b64 v136, v[138:139] offset:3072
    v_mfma_f32_16x16x32_bf16 v[36:39], a[216:219], v[68:71], 0
    v_mul_f32 v81, v81, v4
    v_cvt_pk_bf16_f32 v40, v80, v81
    v_mfma_f32_16x16x32_bf16 v[36:39], a[220:223], v[64:67], v[36:39]
    v_mul_f32 v82, v82, v4
    v_mul_f32 v83, v83, v4
    v_mfma_f32_16x16x32_bf16 v[36:39], a[224:227], v[60:63], v[36:39]
    v_cvt_pk_bf16_f32 v41, v82, v83
    v_mul_f32 v76, v76, v4
    v_mfma_f32_16x16x32_bf16 v[36:39], a[228:231], v[32:35], v[36:39]
    v_mul_f32 v77, v77, v4
    v_cvt_pk_bf16_f32 v42, v76, v77
    v_mfma_f32_16x16x32_bf16 v[36:39], a[232:235], v[24:27], v[36:39]
    v_mul_f32 v78, v78, v4
    v_mul_f32 v79, v79, v4
    v_mfma_f32_16x16x32_bf16 v[36:39], a[236:239], v[8:11], v[36:39]
    v_cvt_pk_bf16_f32 v43, v78, v79
    v_mul_f32 v72, v72, v4
    v_mfma_f32_16x16x32_bf16 v[44:47], a[240:243], v[68:71], 0
    ds_write_b128 v137, v[40:43] offset:0
    v_mfma_f32_16x16x32_bf16 v[44:47], a[244:247], v[64:67], v[44:47]
    v_mul_f32 v73, v73, v4
    v_cvt_pk_bf16_f32 v6, v72, v73
    v_mfma_f32_16x16x32_bf16 v[44:47], a[248:251], v[60:63], v[44:47]
    v_mul_f32 v74, v74, v4
    v_mul_f32 v75, v75, v4
    v_mfma_f32_16x16x32_bf16 v[44:47], a[252:255], v[32:35], v[44:47]
    v_cvt_pk_bf16_f32 v7, v74, v75
    v_fma_f32 v19, v12, v12, s42
    v_mfma_f32_16x16x32_bf16 v[44:47], v[224:227], v[24:27], v[44:47]
    ds_write_b64 v136, v[6:7] offset:0
    v_mfma_f32_16x16x32_bf16 v[44:47], v[228:231], v[8:11], v[44:47]
    v_fmac_f32 v19, v13, v13
    v_fmac_f32 v19, v14, v14
    v_mfma_f32_16x16x32_bf16 v[40:43], v[232:235], v[68:71], 0
    v_fmac_f32 v19, v15, v15
    v_fmac_f32 v19, v28, v28
    v_mfma_f32_16x16x32_bf16 v[40:43], v[236:239], v[64:67], v[40:43]
    v_fmac_f32 v19, v29, v29
    v_fmac_f32 v19, v30, v30
    v_mfma_f32_16x16x32_bf16 v[40:43], v[240:243], v[60:63], v[40:43]
    v_fmac_f32 v19, v31, v31
    v_fmac_f32 v19, v20, v20
    v_mfma_f32_16x16x32_bf16 v[40:43], v[244:247], v[32:35], v[40:43]
    v_fmac_f32 v19, v21, v21
    v_fmac_f32 v19, v22, v22
    v_mfma_f32_16x16x32_bf16 v[40:43], v[248:251], v[24:27], v[40:43]
    v_fmac_f32 v19, v23, v23
    v_fma_f32 v125, v36, v36, s42
    v_mfma_f32_16x16x32_bf16 v[40:43], v[252:255], v[8:11], v[40:43]
    s_nop 0
    v_fmac_f32 v125, v37, v37
    v_fmac_f32 v125, v38, v38
    v_fmac_f32 v125, v39, v39
    v_fmac_f32 v125, v44, v44
    v_fmac_f32 v125, v45, v45
    v_fmac_f32 v125, v46, v46
    v_fmac_f32 v125, v47, v47
    v_fmac_f32 v125, v40, v40
    v_fmac_f32 v125, v41, v41
    v_fmac_f32 v125, v42, v42
    v_fmac_f32 v125, v43, v43
    v_cvt_pk_bf16_f32 v2, v125, v19
    ds_write_b64 v132, v[2:3] offset:4096
    v_mul_f32 v56, v56, v5
    v_mul_f32 v57, v57, v5
    v_cvt_pk_bf16_f32 v8, v56, v57
    v_mul_f32 v58, v58, v5
    v_mul_f32 v59, v59, v5
    v_cvt_pk_bf16_f32 v9, v58, v59
    v_mul_f32 v52, v52, v5
    v_mul_f32 v53, v53, v5
    v_cvt_pk_bf16_f32 v10, v52, v53
    v_mul_f32 v54, v54, v5
    v_mul_f32 v55, v55, v5
    v_cvt_pk_bf16_f32 v11, v54, v55
    v_mul_f32 v48, v48, v5
    v_mul_f32 v49, v49, v5
    v_cvt_pk_bf16_f32 v138, v48, v49
    v_mul_f32 v50, v50, v5
    v_mul_f32 v51, v51, v5
    v_cvt_pk_bf16_f32 v139, v50, v51
    ds_write_b128 v137, v[8:11] offset:1536
    s_waitcnt lgkmcnt(1)
    s_barrier
    ds_write_b64 v136, v[138:139] offset:1536
    ds_read_b128 v[8:11], v131 offset:4096
    ds_read_b128 v[4:7], v131 offset:5120
    s_waitcnt lgkmcnt(2)
    s_barrier
    s_waitcnt lgkmcnt(1)
    v_mfma_f32_16x16x32_bf16 v[24:27], v[216:219], v[8:11], 0
    s_waitcnt lgkmcnt(0)
    ds_read_b128 v[48:51], v0 offset:0
    ds_read_b128 v[32:35], v0 offset:1024
    v_mfma_f32_16x16x32_bf16 v[24:27], v[216:219], v[4:7], v[24:27]
    s_nop 0
    ds_read_b128 v[8:11], v0 offset:2048
    s_nop 2
    ds_read_b128 v[4:7], v0 offset:3072
    s_nop 1
    v_rsq_f32 v24, v24
    ds_read_b128 v[0:3], v0 offset:4096
    v_mul_f32 v24, s43, v24
    v_mul_f32 v36, v36, v24
    v_mul_f32 v37, v37, v24
    v_cvt_pk_bf16_f32 v36, v36, v37
    v_mul_f32 v38, v38, v24
    v_mul_f32 v39, v39, v24
    v_cvt_pk_bf16_f32 v37, v38, v39
    v_mul_f32 v44, v44, v24
    v_mul_f32 v45, v45, v24
    s_waitcnt lgkmcnt(4)
    buffer_store_dwordx4 v[48:51], v130, s[28:31], s58 offen sc1
    v_cvt_pk_bf16_f32 v38, v44, v45
    v_mul_f32 v46, v46, v24
    v_mul_f32 v47, v47, v24
    v_cvt_pk_bf16_f32 v39, v46, v47
    v_mul_f32 v40, v40, v24
    v_mul_f32 v41, v41, v24
    v_cvt_pk_bf16_f32 v130, v40, v41
    v_mul_f32 v42, v42, v24
    v_mul_f32 v43, v43, v24
    v_cvt_pk_bf16_f32 v131, v42, v43
    ds_write_b128 v134, v[36:39] offset:0
    v_rsq_f32 v25, v25
    v_cmp_neq_f32 vcc, 0, v26
    v_mul_f32 v25, s43, v25
    s_waitcnt lgkmcnt(1)
    buffer_store_dwordx4 v[32:35], v129, s[28:31], s58 offen sc1
    ds_write_b64 v133, v[130:131] offset:0
    v_mul_f32 v12, v12, v25
    v_mul_f32 v13, v13, v25
    v_cvt_pk_bf16_f32 v12, v12, v13
    v_mul_f32 v14, v14, v25
    v_mul_f32 v15, v15, v25
    v_cvt_pk_bf16_f32 v13, v14, v15
    v_mul_f32 v28, v28, v25
    v_mul_f32 v29, v29, v25
    v_cvt_pk_bf16_f32 v14, v28, v29
    v_mul_f32 v30, v30, v25
    v_mul_f32 v31, v31, v25
    v_cvt_pk_bf16_f32 v15, v30, v31
    v_mul_f32 v20, v20, v25
    v_mul_f32 v21, v21, v25
    v_cvt_pk_bf16_f32 v130, v20, v21
    v_mul_f32 v22, v22, v25
    v_mul_f32 v23, v23, v25
    v_cvt_pk_bf16_f32 v131, v22, v23
    buffer_store_dwordx4 v[8:11], v128, s[28:31], s58 offen sc1
    ds_write_b128 v134, v[12:15] offset:1536
    ds_write_b64 v133, v[130:131] offset:1536
    buffer_store_dwordx4 v[4:7], v127, s[28:31], s58 offen sc1
    s_waitcnt lgkmcnt(0)
    s_barrier
    buffer_store_dwordx4 v[0:3], v126, s[28:31], s58 offen sc1
    ds_read_b128 v[8:11], v124 offset:0
    ds_read_b128 v[4:7], v124 offset:1024
    ds_read_b128 v[0:3], v124 offset:2048
    s_waitcnt lgkmcnt(2)
    buffer_store_dwordx4 v[8:11], v16, s[28:31], 0 offen sc1
    s_waitcnt lgkmcnt(0)
    buffer_store_dwordx4 v[4:7], v17, s[28:31], 0 offen sc1
    buffer_store_dwordx4 v[0:3], v18, s[28:31], 0 offen sc1
    s_nop 4
    s_cbranch_vccnz L_slow
L_end:
    s_endpgm
L_slow:
    s_waitcnt vmcnt(0) lgkmcnt(0)
    s_nop 15
    s_barrier
    s_lshr_b32 s66, s64, 20
    v_mbcnt_lo_u32_b32 v40, -1, 0
    v_mbcnt_hi_u32_b32 v40, -1, v40
    s_load_dwordx16 s[4:19], s[0:1], 0
    s_load_dwordx4 s[20:23], s[0:1], 64
    s_load_dwordx2 s[38:39], s[0:1], 80
    s_lshr_b32 s88, s2, 3
    s_lshl2_add_u32 s88, s88, s68
    v_lshlrev_b32 v8, 7, v40
    s_mul_i32 s89, s88, 576
    s_mul_i32 s88, s88, 1728
    v_min_u32 v9, 1664, v8
    v_min_u32 v8, 512, v8
    s_mov_b32 s34, 221184
    s_mov_b32 s35, 0x20000
    s_mov_b32 s78, 73728
    s_mov_b32 s79, 0x20000
    v_and_b32 v154, 15, v40
    v_lshrrev_b32 v151, 4, v40
    v_lshrrev_b32 v150, 2, v154
    v_and_b32 v142, 3, v154
    s_mul_i32 s87, s68, 192
    v_mad_u32_u24 v10, v154, 12, s87
    v_lshlrev_b32 v19, 1, v154
    v_lshlrev_b32 v11, 1, v150
    v_lshl_add_u32 v11, v151, 5, v11
    s_movk_i32 s86, 384
    s_mov_b32 s26, 100270464
    s_mov_b32 s27, 0x20000
    s_mov_b32 s30, 0
    s_mov_b32 s31, 0x20000
    s_mul_i32 s96, s68, 288
    s_and_b32 s97, s68, 1
    s_lshl_b32 s97, s97, 2
    s_mov_b32 s98, 193536
    s_waitcnt lgkmcnt(0)
    s_mov_b32 s24, s4
    s_mov_b32 s25, s5
    s_mov_b32 s32, s6
    s_mov_b32 s33, s7
    s_mov_b32 s76, s8
    s_mov_b32 s77, s9
    buffer_load_dword a254, v9, s[32:35], s88 offen
    buffer_load_dword a253, v8, s[76:79], s89 offen
    s_load_dwordx2 s[82:83], s[10:11], 0
    s_movk_i32 s18, 676
    s_mov_b32 s19, 0x20000
    buffer_load_dwordx3 v[16:18], v10, s[16:19], 0 offen
    s_mov_b32 s99, 589824
    v_add_u32 v9, s96, v40
    v_mul_u32_u24 v8, 2731, v9
    v_mul_u32_u24 v38, 6242, v9
    v_lshrrev_b32 v8, 16, v8
    s_lshr_b32 s94, s2, 3
    s_mul_i32 s70, s94, 168
    global_load_ushort v24, v19, s[12:13]
    v_lshrrev_b32 v38, 20, v38
    v_and_or_b32 v36, v8, 3, s97
    v_xor_b32 v36, v9, v36
    v_lshl_add_u32 v130, v36, 4, s99
    v_mad_u32_u24 v130, v38, s98, v130
    s_mul_i32 s69, s2, 20
    s_lshl3_add_u32 s69, s94, s69
    global_load_ushort v25, v19, s[12:13] offset:32
    v_add_u32 v19, 64, v9
    v_mul_u32_u24 v131, 2731, v19
    v_mul_u32_u24 v72, 6242, v19
    v_lshrrev_b32 v131, 16, v131
    v_lshrrev_b32 v72, 20, v72
    s_add_u32 s70, s70, 140
    s_movk_i32 s62, 2688
    global_load_ushort v74, v11, s[14:15] offset:0
    v_and_or_b32 v37, v131, 3, s97
    v_xor_b32 v37, v19, v37
    v_lshl_add_u32 v129, v37, 4, s99
    v_mad_u32_u24 v129, v72, s98, v129
    v_add_u32 v19, 128, v9
    s_movk_i32 s71, 20
    s_movk_i32 s73, 28
    global_load_ushort v32, v11, s[14:15] offset:8
    v_mul_u32_u24 v26, 2731, v19
    v_mul_u32_u24 v125, 6242, v19
    v_lshrrev_b32 v26, 16, v26
    v_lshrrev_b32 v125, 20, v125
    v_and_or_b32 v27, v26, 3, s97
    s_mov_b32 s93, 1769472
    s_mul_i32 s54, s68, 5120
    global_load_ushort v75, v11, s[14:15] offset:16
    v_xor_b32 v27, v19, v27
    v_lshl_add_u32 v128, v27, 4, s99
    v_mad_u32_u24 v128, v125, s98, v128
    v_add_u32 v73, 192, v9
    v_mul_u32_u24 v124, 2731, v73
    s_mov_b32 s63, 1180032
    s_mul_i32 s95, s68, -44
    global_load_ushort v11, v11, s[14:15] offset:24
    v_mul_u32_u24 v19, 6242, v73
    v_lshrrev_b32 v124, 16, v124
    v_lshrrev_b32 v19, 20, v19
    v_and_or_b32 v39, v124, 3, s97
    v_xor_b32 v39, v73, v39
    v_lshl_add_u32 v127, v39, 4, s99
    v_mad_u32_u24 v127, v19, s98, v127
    v_add_u32 v126, 256, v9
    v_mul_u32_u24 v39, 2731, v126
    v_mul_u32_u24 v9, 6242, v126
    v_lshrrev_b32 v39, 16, v39
    v_lshrrev_b32 v9, 20, v9
    v_and_or_b32 v73, v39, 3, s97
    v_xor_b32 v73, v126, v73
    v_lshl_add_u32 v126, v73, 4, s99
    v_mad_u32_u24 v126, v9, s98, v126
    s_cmp_ge_u32 s2, 240
    s_cbranch_scc1 L_bndS
L_bndrS:
    s_mul_i32 s94, s69, 58255
    s_lshr_b32 s94, s94, 22
    s_mul_i32 s94, s94, s63
    s_mul_i32 s72, s69, s62
    s_add_u32 s72, s72, s94
    v_lshl_or_b32 v143, v40, 4, 2.0
    s_sub_u32 s94, s73, 1
    s_max_u32 s94, s94, 20
    s_movk_i32 s99, -24
    s_add_u32 m0, s54, 0
    v_and_b32 v19, -4, v26
    s_mul_i32 s85, s68, 96
    s_sub_u32 s100, s85, 1024
    buffer_load_dwordx4 v130, s[24:27], s72 offen nt lds
    s_add_u32 m0, s54, 1024
    v_mad_u32_u24 v9, v19, 3, v26
    v_add_u32 v9, s95, v9
    v_mad_i32_i24 v38, v26, s99, v27
    v_med3_u32 v19, v9, 20, s94
    v_add_u32 v19, s70, v19
    v_add_u32 v39, s69, v9
    s_sub_u32 s87, s85, 2048
    s_movk_i32 s91, 1152
    buffer_load_dwordx4 v129, s[24:27], s72 offen nt lds
    v_cmp_gt_u32 vcc, s71, v9
    v_lshl_add_u32 v38, v38, 4, s93
    s_add_u32 m0, s54, 43008
    v_cndmask_b32 v39, v19, v39, vcc
    v_mul_u32_u24 v19, 58255, v39
    v_mad_u32_u24 v38, v39, s62, v38
    v_lshrrev_b32 v19, 22, v19
    v_mad_u32_u24 v38, v19, s63, v38
    s_mul_i32 s90, s68, 3072
    s_add_u32 s90, s90, 61440
    buffer_load_dwordx4 v38, s[24:27], 0 offen  lds
    v_lshlrev_b32 v39, 16, v9
    s_add_u32 m0, s54, 2048
    v_and_b32 v19, -4, v131
    v_mad_u32_u24 v9, v19, 3, v131
    v_add_u32 v9, s95, v9
    v_mad_i32_i24 v37, v131, s99, v37
    v_med3_u32 v19, v9, 20, s94
    s_mov_b32 s28, s22
    s_mov_b32 s29, s23
    buffer_load_dwordx4 v128, s[24:27], s72 offen nt lds
    v_add_u32 v19, s70, v19
    v_add_u32 v131, s69, v9
    v_cmp_gt_u32 vcc, s71, v9
    v_lshl_add_u32 v37, v37, 4, s93
    s_add_u32 m0, s54, 41984
    v_cndmask_b32 v131, v19, v131, vcc
    v_mul_u32_u24 v19, 58255, v131
    v_mad_u32_u24 v37, v131, s62, v37
    v_lshrrev_b32 v19, 22, v19
    v_mad_u32_u24 v37, v19, s63, v37
    s_mov_b32 s41, 0x2a8cbccc
    s_mov_b32 s42, 0x38fba882
    buffer_load_dwordx4 v37, s[24:27], 0 offen  lds
    v_lshl_or_b32 v39, v9, 8, v39
    s_add_u32 m0, s54, 3072
    v_cmp_gt_u32 vcc, 32, v40
    v_and_b32 v131, -4, v8
    v_mad_u32_u24 v19, v131, 3, v8
    v_cndmask_b32 v126, v143, v126, vcc
    v_add_u32 v19, s95, v19
    s_mov_b32 s43, 0x415db3d7
    s_mov_b32 s44, 61440
    buffer_load_dwordx4 v127, s[24:27], s72 offen nt lds
    s_add_u32 m0, s54, 4096
    v_mad_i32_i24 v36, v8, s99, v36
    v_med3_u32 v131, v19, 20, s94
    v_add_u32 v131, s70, v131
    v_add_u32 v8, s69, v19
    v_cmp_gt_u32 vcc, s71, v19
    v_lshl_add_u32 v36, v36, 4, s93
    s_mul_i32 s93, s68, 6
    s_lshl_b32 s94, s97, 1
    buffer_load_dwordx4 v126, s[24:27], s72 offen nt lds
    v_cndmask_b32 v8, v131, v8, vcc
    v_mul_u32_u24 v131, 58255, v8
    v_mad_u32_u24 v36, v8, s62, v36
    v_lshrrev_b32 v131, 22, v131
    v_mad_u32_u24 v36, v131, s63, v36
    s_add_u32 m0, s54, 40960
    v_lshl_or_b32 v39, v19, 0, v39
    s_mov_b32 s45, 40960
    s_mov_b32 s46, 20480
    buffer_load_dwordx4 v36, s[24:27], 0 offen nt lds
    v_mul_u32_u24 v72, 10923, v40
    v_lshrrev_b32 v56, 17, v72
    v_lshrrev_b32 v72, 16, v72
    v_mad_i32_i24 v131, v72, -6, v40
    v_bitop3_b32 v56, v56, v72, 4 bitop3:0x28
    v_lshl_add_u32 v131, v131, 4, s85
    v_mul_u32_u24 v56, 3, v56
    v_xor_b32 v72, v72, v56
    v_mad_u32_u24 v56, v72, s91, v131
    v_add_u32 v8, 64, v40
    v_mul_u32_u24 v9, 10923, v8
    v_lshrrev_b32 v13, 17, v9
    v_lshrrev_b32 v9, 16, v9
    v_mad_i32_i24 v73, v9, -6, v8
    v_bitop3_b32 v13, v13, v9, 4 bitop3:0x28
    v_lshl_add_u32 v73, v73, 4, s100
    v_mul_u32_u24 v13, 3, v13
    v_xor_b32 v9, v9, v13
    v_mad_u32_u24 v13, v9, s91, v73
    v_add_u32 v8, 128, v40
    v_mul_u32_u24 v19, 10923, v8
    v_lshrrev_b32 v12, 17, v19
    v_lshrrev_b32 v19, 16, v19
    v_mad_i32_i24 v8, v19, -6, v8
    v_bitop3_b32 v12, v12, v19, 4 bitop3:0x28
    v_lshl_add_u32 v8, v8, 4, s87
    v_mul_u32_u24 v12, 3, v12
    v_xor_b32 v19, v19, v12
    v_mad_u32_u24 v12, v19, s91, v8
    v_mad_u32_u24 v72, v72, s86, v131
    v_mad_u32_u24 v9, v9, s86, v73
    v_mad_u32_u24 v8, v19, s86, v8
    s_add_u32 m0, s90, 0
    s_mov_b32 s92, 0
    buffer_load_dwordx4 v56, s[32:35], s92 offen offset:0 lds
    v_mov_b32 v19, 0x3f803f80
    v_cmp_eq_u32 vcc, 0, v142
    v_and_b32 v73, 1, v40
    v_lshlrev_b32 v73, 4, v73
    v_cndmask_b32 v220, 0, v19, vcc
    v_cndmask_b32 v221, 0, v19, vcc
    v_cndmask_b32 v222, 0, v19, vcc
    v_cndmask_b32 v223, 0, v19, vcc
    v_mov_b32 v19, 0x3f80
    v_lshlrev_b32 v19, v73, v19
    v_cmp_gt_u32 vcc, 2, v142
    v_mov_b32 v171, 0
    v_mov_b32 v167, 0
    v_cndmask_b32 v216, 0, v19, vcc
    v_cndmask_b32 v218, 0, v19, vcc
    v_cmp_le_u32 vcc, 2, v142
    v_mov_b32 v163, 0
    v_mov_b32 v159, 0
    v_cndmask_b32 v217, 0, v19, vcc
    v_cndmask_b32 v219, 0, v19, vcc
    v_cmp_eq_u32 vcc, v151, v150
    v_mov_b32 v152, 0
    v_mov_b32 v153, 0
    v_cndmask_b32 v146, 0, v216, vcc
    v_cndmask_b32 v147, 0, v217, vcc
    v_mov_b32 v148, 0
    v_mov_b32 v149, 0
    v_mov_b32 v144, 0
    v_mov_b32 v145, 0
    v_mov_b32 v140, 0
    v_mov_b32 v141, 0
    v_lshrrev_b32 v15, 1, v151
    v_lshl_add_u32 v14, v151, 2, v150
    v_lshl_add_u32 v14, v15, 3, v14
    v_mul_u32_u24 v14, 96, v14
    v_add_u32 v14, s90, v14
    v_lshl_add_u32 v15, v142, 4, v14
    v_lshl_add_u32 v14, v142, 3, v14
    s_waitcnt lgkmcnt(0)
    s_lshl_b32 s84, s68, 4
    s_lshr_b64 s[82:83], s[82:83], s84
    s_lshl_b32 s82, s82, 16
    v_mov_b32 v27, s82
    v_min_f32 v27, 0x40930000, v27
    v_max_f32 v27, 0xc2c80000, v27
    v_mul_f32 v27, 0x3fb8aa3b, v27
    v_exp_f32 v27, v27
    v_mov_b32 v26, 0
    v_cvt_pk_bf16_f32 v27, v27, v27
    v_lshlrev_b32 v27, 16, v27
    v_mul_f32 v27, 0x4038aa3b, v27
    v_mov_b32 v19, 0
    v_readfirstlane_b32 s55, v27
    v_add_f32 v27, v27, v27
    v_mul_u32_u24 v155, 5120, v151
    v_readfirstlane_b32 s52, v27
    v_add_u32 v155, v10, v155
    s_mov_b32 s84, 0x41b8aa3b
    v_mov_b32 v10, 0xc138aa3b
    v_mul_u32_u24 v124, 5120, v150
    v_mad_u32_u24 v124, v142, s86, v124
    v_and_b32 v27, 7, v154
    v_xor_b32 v125, v27, v151
    v_lshl_add_u32 v73, v125, 4, v124
    s_mov_b32 s47, 0
    s_mov_b32 s57, s72
    buffer_load_dwordx4 v13, s[32:35], s92 offen offset:1024 lds
    v_xor_b32 v35, 64, v73
    v_add_u32 v139, 40960, v73
    v_xor_b32 v138, 64, v139
    v_add_u32 v124, 61440, v124
    v_add_u32 v125, s93, v151
    v_xor_b32 v125, v27, v125
    v_lshl_add_u32 v137, v125, 4, v124
    s_mov_b32 s58, 0
    s_mov_b32 s59, 0
    buffer_load_dwordx4 v12, s[32:35], s92 offen offset:2048 lds
    s_add_u32 m0, s90, 12288
    s_mov_b32 s92, 36864
    v_lshrrev_b32 v125, 1, v151
    v_add3_u32 v125, v125, s93, 4
    v_xor_b32 v125, v27, v125
    v_lshl_add_u32 v125, v125, 4, v124
    v_and_b32 v124, 1, v151
    s_add_u32 s93, s54, 20480
    s_mov_b32 s60, 0
    buffer_load_dwordx4 v56, s[32:35], s92 offen offset:0 lds
    s_waitcnt vmcnt(16)
    v_lshl_or_b32 v24, v25, 16, v24
    v_cmp_gt_u32 vcc, 16, v40
    v_mov_b32 v25, 0
    v_lshl_add_u32 v136, v124, 3, v125
    v_cndmask_b32 v27, 0, v24, vcc
    v_cndmask_b32 v24, 0, v24, vcc
    v_lshlrev_b32 v131, 4, v40
    v_mfma_f32_16x16x16_bf16 v[0:3], v[26:27], v[16:17], 0
    s_waitcnt vmcnt(14)
    s_mov_b32 s65, -1
    v_lshl_or_b32 v74, v32, 16, v74
    v_add_u32 v135, s93, v131
    v_mfma_f32_16x16x16_bf16 v[4:7], v[24:25], v[16:17], 0
    s_lshr_b32 s93, s68, 1
    v_add_u32 v131, 81920, v131
    v_mul_u32_u24 v124, 80, v151
    v_mfma_f32_16x16x16_bf16 v[20:23], v[24:25], v[18:19], 0
    s_waitcnt vmcnt(12)
    s_lshl_b32 s93, s93, 10
    buffer_load_dwordx4 v13, s[32:35], s92 offen offset:1024 lds
    v_lshl_or_b32 v75, v11, 16, v75
    v_max_f32 v0, 0, v0
    v_max_f32 v4, 0, v4
    v_max_f32 v5, 0, v5
    v_max_f32 v6, 0, v6
    v_max_f32 v7, 0, v7
    v_cvt_pk_bf16_f32 v4, v4, v5
    v_cvt_pk_bf16_f32 v5, v6, v7
    v_max_f32 v1, 0, v1
    v_max_f32 v2, 0, v2
    v_mfma_f32_16x16x16_bf16 v[16:19], v[74:75], v[4:5], 0
    s_add_u32 s93, s93, s94
    v_max_f32 v3, 0, v3
    v_cvt_pk_bf16_f32 v0, v0, v1
    v_cvt_pk_bf16_f32 v1, v2, v3
    v_max_f32 v20, 0, v20
    v_max_f32 v21, 0, v21
    v_mfma_f32_16x16x16_bf16 v[4:7], v[74:75], v[0:1], 0
    s_mov_b32 s61, 1
    v_max_f32 v22, 0, v22
    v_max_f32 v23, 0, v23
    v_cvt_pk_bf16_f32 v20, v20, v21
    v_cvt_pk_bf16_f32 v21, v22, v23
    v_cvt_pk_bf16_f32 v16, v16, v16
    v_lshlrev_b32 v16, 16, v16
    v_mfma_f32_16x16x16_bf16 v[0:3], v[74:75], v[20:21], 0
    s_movk_i32 s4, 336
    v_mul_f32 v16, 0xbfb8aa3b, v16
    v_cvt_pk_bf16_f32 v4, v4, v4
    v_exp_f32 v16, v16
    v_lshlrev_b32 v4, 16, v4
    v_add_f32 v16, 1.0, v16
    v_rcp_f32 v16, v16
    v_mul_f32 v4, 0xbfb8aa3b, v4
    v_cvt_pk_bf16_f32 v16, v16, v16
    v_lshlrev_b32 v16, 16, v16
    v_fma_f32 v16, v16, s84, v10
    s_mov_b32 s5, 0
    s_mov_b32 s6, 0
    ds_write_b32 v155, v16 offset:44032
    v_exp_f32 v4, v4
    v_cvt_pk_bf16_f32 v0, v0, v0
    v_add_f32 v4, 1.0, v4
    v_rcp_f32 v4, v4
    v_lshlrev_b32 v0, 16, v0
    v_cvt_pk_bf16_f32 v4, v4, v4
    v_lshlrev_b32 v4, 16, v4
    v_fma_f32 v4, v4, s84, v10
    s_mov_b32 s12, 0
    s_mov_b32 s64, 3
    ds_write_b32 v155, v4 offset:44036
    v_mul_f32 v0, 0xbfb8aa3b, v0
    v_exp_f32 v0, v0
    v_add_u32 v132, s93, v131
    v_add_f32 v0, 1.0, v0
    v_rcp_f32 v0, v0
    s_mul_i32 s93, s68, 5376
    v_cvt_pk_bf16_f32 v0, v0, v0
    v_lshlrev_b32 v0, 16, v0
    v_fma_f32 v0, v0, s84, v10
    s_add_u32 s93, s93, 142336
    s_mov_b32 s10, 81924
    ds_write_b32 v155, v0 offset:44040
    v_add_u32 v125, s93, v124
    v_mul_u32_u24 v124, 336, v154
    v_add_u32 v34, v124, v125
    v_subrev_u32 v34, 21504, v34
    v_cmp_eq_u32 vcc, 0, v150
    v_mul_u32_u24 v124, 80, v150
    v_lshl_add_u32 v124, v151, 3, v124
    v_cndmask_b32 v134, v143, v125, vcc
    v_cmp_eq_u32 vcc, 3, v142
    v_lshl_add_u32 v124, v142, 1, v124
    v_add_u32 v124, s93, v124
    v_cndmask_b32 v134, v134, v125, vcc
    v_cmp_gt_u32 vcc, 3, v151
    v_mov_b32 v125, v124
    s_add_u32 s93, s69, 1
    v_cndmask_b32 v133, v143, v124, vcc
    s_mul_i32 s94, s93, 58255
    s_lshr_b32 s94, s94, 22
    s_mul_i32 s94, s94, s63
    s_mul_i32 s56, s93, s62
    s_add_u32 s56, s56, s94
    ds_write_b128 v34, v[216:219] offset:21584
    v_mov_b32 v124, 0
    s_sub_u32 s93, s71, 1
    s_cmp_eq_u32 s68, 0
    s_cselect_b32 s13, s93, -1
    s_cmp_gt_u32 s73, 20
    s_cselect_b32 s13, s13, -1
    s_and_b32 s93, s2, -8
    s_waitcnt lgkmcnt(1)
    s_barrier
    s_sub_u32 s93, 81920, s93
    s_sub_u32 s8, s38, s93
    s_subb_u32 s9, s39, 0
    s_mov_b32 s11, 0x20000
    s_mov_b32 s39, 0x00010001
    s_add_u32 s101, s54, 44032
    v_mul_u32_u24 v150, 48, v150
    v_lshl_add_u32 v150, v142, 2, v150
    v_mul_u32_u24 v32, 48, v151
    v_add_u32 v199, 0, v150
    v_mul_u32_u24 v33, 37, v199
    v_lshrrev_b32 v33, 10, v33
    v_mad_u32_u24 v199, v33, 24, v199
    v_add_u32 v199, s101, v199
    v_add_u32 v142, 16, v150
    v_mul_u32_u24 v33, 37, v142
    v_lshrrev_b32 v33, 10, v33
    v_mad_u32_u24 v142, v33, 24, v142
    v_add_u32 v142, s101, v142
    v_add_u32 v41, 32, v150
    v_mul_u32_u24 v33, 37, v41
    v_lshrrev_b32 v33, 10, v33
    v_mad_u32_u24 v41, v33, 24, v41
    v_add_u32 v41, s101, v41
    v_add_u32 v59, 0, v32
    v_mul_u32_u24 v33, 37, v59
    v_lshrrev_b32 v33, 10, v33
    v_mad_u32_u24 v59, v33, 24, v59
    v_add_u32 v57, 4, v32
    v_mul_u32_u24 v33, 37, v57
    v_lshrrev_b32 v33, 10, v33
    v_mad_u32_u24 v57, v33, 24, v57
    v_add_u32 v58, 8, v32
    v_mul_u32_u24 v33, 37, v58
    v_lshrrev_b32 v33, 10, v33
    v_mad_u32_u24 v58, v33, 24, v58
    v_add_u32 v75, 12, v32
    v_mul_u32_u24 v33, 37, v75
    v_lshrrev_b32 v33, 10, v33
    v_mad_u32_u24 v75, v33, 24, v75
    v_add_u32 v74, 16, v32
    v_mul_u32_u24 v33, 37, v74
    v_lshrrev_b32 v33, 10, v33
    v_mad_u32_u24 v74, v33, 24, v74
    v_add_u32 v42, 20, v32
    v_mul_u32_u24 v33, 37, v42
    v_lshrrev_b32 v33, 10, v33
    v_mad_u32_u24 v42, v33, 24, v42
    v_add_u32 v43, 24, v32
    v_mul_u32_u24 v33, 37, v43
    v_lshrrev_b32 v33, 10, v33
    v_mad_u32_u24 v43, v33, 24, v43
    v_add_u32 v179, 28, v32
    v_mul_u32_u24 v33, 37, v179
    v_lshrrev_b32 v33, 10, v33
    v_mad_u32_u24 v179, v33, 24, v179
    v_add_u32 v11, 32, v32
    v_mul_u32_u24 v10, 37, v11
    v_lshrrev_b32 v10, 10, v10
    v_mad_u32_u24 v11, v10, 24, v11
    v_add_u32 v10, 36, v32
    v_mul_u32_u24 v33, 37, v10
    v_lshrrev_b32 v33, 10, v33
    v_mad_u32_u24 v10, v33, 24, v10
    v_add_u32 v155, 40, v32
    s_lshr_b32 s93, s68, 1
    s_mul_i32 s93, s93, 30720
    buffer_load_dwordx4 v12, s[32:35], s92 offen offset:2048 lds
    s_add_u32 m0, s90, 24576
    s_mov_b32 s92, 73728
    ds_read_b32 v208, v199
    v_mul_u32_u24 v33, 37, v155
    v_lshrrev_b32 v33, 10, v33
    v_mad_u32_u24 v155, v33, 24, v155
    v_add_u32 v32, 44, v32
    v_mul_u32_u24 v33, 37, v32
    v_lshrrev_b32 v33, 10, v33
    v_mad_u32_u24 v32, v33, 24, v32
    v_lshl_add_u32 v33, v151, 4, v150
    v_mul_u32_u24 v156, 37, v33
    v_lshrrev_b32 v156, 10, v156
    v_mad_u32_u24 v33, v156, 24, v33
    v_mov_b32 v156, 336
    v_cmp_gt_u32 vcc, 3, v151
    v_sub_u32 v204, v199, v59
    s_and_b32 s94, s68, 1
    v_cndmask_b32 v33, v156, v33, vcc
    v_sub_u32 v33, s101, v33
    s_mul_i32 s94, s94, -2304
    s_add_u32 s93, s93, s94
    buffer_load_dwordx4 v56, s[32:35], s92 offen offset:0 lds
    ds_read_b32 v204, v204 offset:336
    v_sub_u32 v205, v199, v57
    v_sub_u32 v206, v199, v58
    v_sub_u32 v207, v199, v75
    v_sub_u32 v200, v199, v74
    v_sub_u32 v201, v199, v42
    s_lshl_b32 s94, s97, 4
    ds_read_b32 v205, v205 offset:336
    v_sub_u32 v202, v199, v43
    buffer_load_dwordx4 v13, s[32:35], s92 offen offset:1024 lds
    v_sub_u32 v203, v199, v179
    ds_read_b32 v206, v206 offset:336
    v_sub_u32 v196, v199, v11
    v_sub_u32 v197, v199, v10
    v_sub_u32 v198, v199, v155
    v_sub_u32 v199, v199, v32
    v_sub_u32 v192, v142, v59
    ds_read_b32 v207, v207 offset:336
    v_sub_u32 v193, v142, v57
    v_sub_u32 v194, v142, v58
    v_sub_u32 v195, v142, v75
    v_sub_u32 v188, v142, v74
    v_sub_u32 v189, v142, v42
    ds_read_b32 v200, v200 offset:336
    v_sub_u32 v190, v142, v43
    buffer_load_dwordx4 v12, s[32:35], s92 offen offset:2048 lds
    s_add_u32 m0, s90, 36864
    s_mov_b32 s92, 110592
    ds_read_b32 v201, v201 offset:336
    v_sub_u32 v191, v142, v179
    v_sub_u32 v184, v142, v11
    v_sub_u32 v185, v142, v10
    v_sub_u32 v186, v142, v155
    v_sub_u32 v187, v142, v32
    s_waitcnt vmcnt(9)
    s_barrier
    ds_read_b32 v202, v202 offset:336
    v_sub_u32 v180, v41, v59
    v_sub_u32 v181, v41, v57
    v_sub_u32 v182, v41, v58
    v_sub_u32 v183, v41, v75
    v_sub_u32 v176, v41, v74
    ds_read_b32 v203, v203 offset:336
    v_sub_u32 v177, v41, v42
    v_sub_u32 v178, v41, v43
    v_sub_u32 v179, v41, v179
    v_sub_u32 v172, v41, v11
    v_sub_u32 v173, v41, v10
    ds_read_b32 v196, v196 offset:336
    v_sub_u32 v174, v41, v155
    v_sub_u32 v175, v41, v32
    buffer_load_dwordx4 v56, s[32:35], s92 offen offset:0 lds
    ds_read_b32 v197, v197 offset:336
    v_mov_b32 v57, 0xf149f2ca
    v_mov_b32 v58, 0x3f80
    v_mov_b32 v59, 0
    v_mov_b32 v42, 0x3f80
    v_mov_b32 v43, 0
    ds_read_b32 v198, v198 offset:336
    v_and_b32 v155, 8, v154
    v_add_u32 v155, v155, v154
    v_mul_u32_u24 v155, 96, v155
    v_add_u32 v155, s90, v155
    v_lshl_add_u32 v32, v151, 4, v155
    ds_read_b32 v199, v199 offset:336
    buffer_load_dwordx4 v13, s[32:35], s92 offen offset:1024 lds
    v_lshl_add_u32 v75, v151, 3, v155
    v_add_u32 v11, s93, v32
    v_add_u32 v10, s93, v75
    v_lshlrev_b32 v74, 4, v151
    s_lshr_b32 s93, s68, 1
    s_mul_i32 s93, s93, 5120
    ds_read_b32 v211, v33 offset:672
    v_add_u32 v74, 4608, v74
    s_add_u32 s93, s93, s94
    v_add_u32 v33, s93, v74
    v_cmp_eq_u32 vcc, 0, v154
    s_nop 0
    ds_read_b32 v192, v192 offset:336
    v_cndmask_b32 v33, v143, v33, vcc
    buffer_load_dwordx4 v12, s[32:35], s92 offen offset:2048 lds
    s_add_u32 m0, s90, 49152
    s_mov_b32 s92, 147456
    ds_read_b32 v193, v193 offset:336
    ds_read_b32 v194, v194 offset:336
    ds_read_b32 v195, v195 offset:336
    buffer_load_dwordx4 v56, s[32:35], s92 offen offset:0 lds
    ds_read_b32 v188, v188 offset:336
    ds_read_b32 v189, v189 offset:336
    ds_read_b32 v190, v190 offset:336
    ds_read_b32 v191, v191 offset:336
    buffer_load_dwordx4 v13, s[32:35], s92 offen offset:1024 lds
    ds_read_b32 v184, v184 offset:336
    ds_read_b32 v185, v185 offset:336
    ds_read_b32 v186, v186 offset:336
    buffer_load_dwordx4 v12, s[32:35], s92 offen offset:2048 lds
    s_add_u32 m0, s90, 61440
    s_mov_b32 s92, 184320
    ds_read_b32 v187, v187 offset:336
    ds_read_b32 v209, v142
    ds_read_b32 v180, v180 offset:336
    buffer_load_dwordx4 v56, s[32:35], s92 offen offset:0 lds
    ds_read_b32 v181, v181 offset:336
    ds_read_b32 v182, v182 offset:336
    ds_read_b32 v183, v183 offset:336
    ds_read_b32 v176, v176 offset:336
    buffer_load_dwordx4 v13, s[32:35], s92 offen offset:1024 lds
    ds_read_b32 v177, v177 offset:336
    ds_read_b32 v178, v178 offset:336
    ds_read_b32 v179, v179 offset:336
    buffer_load_dwordx4 v12, s[32:35], s92 offen offset:2048 lds
    ds_read_b32 v172, v172 offset:336
    ds_read_b32 v173, v173 offset:336
    ds_read_b32 v174, v174 offset:336
    ds_read_b32 v175, v175 offset:336
    ds_read_b32 v210, v41
    s_waitcnt vmcnt(15)
    ds_read_b64_tr_b16 a[0:1], v14 offset:0
    ds_read_b64_tr_b16 a[2:3], v14 offset:768
    ds_read_b64_tr_b16 a[24:25], v14 offset:32
    ds_read_b64_tr_b16 a[26:27], v14 offset:800
    ds_read_b64_tr_b16 a[48:49], v14 offset:64
    ds_read_b64_tr_b16 a[50:51], v14 offset:832
    s_add_u32 m0, s90, 0
    s_mov_b32 s92, 384
    s_waitcnt vmcnt(12)
    ds_read_b64_tr_b16 a[4:5], v14 offset:12288
    ds_read_b64_tr_b16 a[6:7], v14 offset:13056
    ds_read_b64_tr_b16 a[28:29], v14 offset:12320
    ds_read_b64_tr_b16 a[30:31], v14 offset:13088
    ds_read_b64_tr_b16 a[52:53], v14 offset:12352
    ds_read_b64_tr_b16 a[54:55], v14 offset:13120
    s_waitcnt vmcnt(9)
    ds_read_b64_tr_b16 a[8:9], v14 offset:24576
    ds_read_b64_tr_b16 a[10:11], v14 offset:25344
    ds_read_b64_tr_b16 a[32:33], v14 offset:24608
    s_waitcnt lgkmcnt(15)
    s_cmp_ge_u32 s2, 247
    s_cbranch_scc1 L_maskS
L_nomaskS:
    v_cmp_gt_u32 vcc, 16, v40
    v_readlane_b32 s84, v211, 48
    ds_read_b64_tr_b16 a[34:35], v14 offset:25376
    v_cndmask_b32 v208, v57, v208, vcc
    v_cndmask_b32 v209, v57, v209, vcc
    v_cndmask_b32 v210, v57, v210, vcc
    v_cmp_gt_u32 vcc, 49, v40
    ds_read_b64_tr_b16 a[56:57], v14 offset:24640
    s_waitcnt lgkmcnt(10)
    buffer_load_dwordx4 v56, s[32:35], s92 offen offset:0 lds
    ds_read_b64_tr_b16 a[58:59], v14 offset:25408
    v_cndmask_b32 v211, v57, v211, vcc
    s_waitcnt vmcnt(7)
    ds_read_b64_tr_b16 a[12:13], v14 offset:36864
    ds_read_b64_tr_b16 a[14:15], v14 offset:37632
    buffer_load_dwordx4 v13, s[32:35], s92 offen offset:1024 lds
    ds_read_b64_tr_b16 a[36:37], v14 offset:36896
    ds_read_b64_tr_b16 a[38:39], v14 offset:37664
    ds_read_b64_tr_b16 a[60:61], v14 offset:36928
    ds_read_b64_tr_b16 a[62:63], v14 offset:37696
    buffer_load_dwordx4 v12, s[32:35], s92 offen offset:2048 lds
    s_add_u32 m0, s90, 12288
    s_mov_b32 s92, 37248
    ds_read_b128 v[68:71], v73 offset:40960
    ds_read_b128 v[64:67], v35 offset:40960
    s_waitcnt lgkmcnt(10)
    buffer_load_dwordx4 v56, s[32:35], s92 offen offset:0 lds
    ds_read_b128 v[60:63], v73 offset:41088
    ds_read_b128 v[48:51], v35 offset:41088
    buffer_load_dwordx4 v13, s[32:35], s92 offen offset:1024 lds
    ds_read_b128 v[44:47], v73 offset:41216
    ds_read_b128 v[28:31], v35 offset:41216
    buffer_load_dwordx4 v12, s[32:35], s92 offen offset:2048 lds
    s_add_u32 m0, s90, 24576
    s_mov_b32 s92, 74112
    s_waitcnt vmcnt(9)
    ds_read_b64_tr_b16 a[16:17], v14 offset:49152
    ds_read_b64_tr_b16 a[18:19], v14 offset:49920
    ds_read_b64_tr_b16 a[40:41], v14 offset:49184
    ds_read_b64_tr_b16 a[42:43], v14 offset:49952
    ds_read_b64_tr_b16 a[64:65], v14 offset:49216
    ds_read_b64_tr_b16 a[66:67], v14 offset:49984
    s_waitcnt lgkmcnt(9)
    buffer_load_dwordx4 v56, s[32:35], s92 offen offset:0 lds
    buffer_load_dwordx4 v13, s[32:35], s92 offen offset:1024 lds
    buffer_load_dwordx4 v12, s[32:35], s92 offen offset:2048 lds
    s_add_u32 m0, s90, 36864
    s_mov_b32 s92, 110976
    s_waitcnt vmcnt(9)
    ds_read_b64_tr_b16 a[20:21], v14 offset:61440
    ds_read_b64_tr_b16 a[22:23], v14 offset:62208
    v_mfma_f32_16x16x32_bf16 v[92:95], a[0:3], v[68:71], 0
    ds_read_b64_tr_b16 a[44:45], v14 offset:61472
    v_mfma_f32_16x16x32_bf16 v[92:95], a[4:7], v[64:67], v[92:95]
    ds_read_b64_tr_b16 a[46:47], v14 offset:62240
    v_mfma_f32_16x16x32_bf16 v[92:95], a[8:11], v[60:63], v[92:95]
    s_waitcnt lgkmcnt(4)
    ds_read_b64_tr_b16 a[68:69], v14 offset:61504
    v_mfma_f32_16x16x32_bf16 v[92:95], a[12:15], v[48:51], v[92:95]
    ds_read_b64_tr_b16 a[70:71], v14 offset:62272
    v_mfma_f32_16x16x32_bf16 v[92:95], a[16:19], v[44:47], v[92:95]
    ds_read_b128 v[24:27], v73 offset:42496
    ds_read_b128 v[20:23], v35 offset:42496
    ds_read_b128 v[16:19], v73 offset:42624
    ds_read_b128 v[52:55], v35 offset:42624
    s_waitcnt lgkmcnt(7)
    v_mfma_f32_16x16x32_bf16 v[92:95], a[20:23], v[28:31], v[92:95]
    ds_read_b128 v[4:7], v73 offset:42752
    s_nop 0
    v_mfma_f32_16x16x32_bf16 v[100:103], a[24:27], v[68:71], 0
    s_nop 0
    ds_read_b128 v[0:3], v35 offset:42752
    s_nop 0
    v_mfma_f32_16x16x32_bf16 v[100:103], a[28:31], v[64:67], v[100:103]
    s_nop 0
    v_fma_f32 v41, v92, v92, s41
    v_fmac_f32 v41, v93, v93
    v_mfma_f32_16x16x32_bf16 v[100:103], a[32:35], v[60:63], v[100:103]
    v_fmac_f32 v41, v94, v94
    v_fmac_f32 v41, v95, v95
    v_mfma_f32_16x16x32_bf16 v[100:103], a[36:39], v[48:51], v[100:103]
    v_mfma_f32_16x16x32_bf16 v[100:103], a[40:43], v[44:47], v[100:103]
    s_waitcnt lgkmcnt(4)
    v_mfma_f32_16x16x32_bf16 v[100:103], a[44:47], v[28:31], v[100:103]
    s_nop 0
    v_mfma_f32_16x16x32_bf16 v[96:99], a[48:51], v[68:71], 0
    s_nop 2
    v_mfma_f32_16x16x32_bf16 v[96:99], a[52:55], v[64:67], v[96:99]
    s_nop 0
    buffer_load_dwordx4 v56, s[32:35], s92 offen offset:0 lds
    v_fmac_f32 v41, v100, v100
    v_mfma_f32_16x16x32_bf16 v[96:99], a[56:59], v[60:63], v[96:99]
    v_fmac_f32 v41, v101, v101
    v_fmac_f32 v41, v102, v102
    v_mfma_f32_16x16x32_bf16 v[96:99], a[60:63], v[48:51], v[96:99]
    v_fmac_f32 v41, v103, v103
    v_mfma_f32_16x16x32_bf16 v[96:99], a[64:67], v[44:47], v[96:99]
    v_mfma_f32_16x16x32_bf16 v[96:99], a[68:71], v[28:31], v[96:99]
    s_nop 0
    v_mfma_f32_16x16x32_bf16 v[48:51], a[0:3], v[24:27], 0
    s_nop 0
    buffer_load_dwordx4 v13, s[32:35], s92 offen offset:1024 lds
    s_nop 0
    v_mfma_f32_16x16x32_bf16 v[48:51], a[4:7], v[20:23], v[48:51]
    s_waitcnt lgkmcnt(0)
    s_nop 0
    v_fmac_f32 v41, v96, v96
    v_fmac_f32 v41, v97, v97
    v_mfma_f32_16x16x32_bf16 v[48:51], a[8:11], v[16:19], v[48:51]
    v_fmac_f32 v41, v98, v98
    v_fmac_f32 v41, v99, v99
    v_mfma_f32_16x16x32_bf16 v[48:51], a[12:15], v[52:55], v[48:51]
    ds_read_b128 v[108:111], v73 offset:40960
    v_mfma_f32_16x16x32_bf16 v[48:51], a[16:19], v[4:7], v[48:51]
    ds_read_b128 v[80:83], v35 offset:40960
    v_mfma_f32_16x16x32_bf16 v[48:51], a[20:23], v[0:3], v[48:51]
    s_waitcnt vmcnt(8)
    buffer_load_dwordx4 v12, s[32:35], s92 offen offset:2048 lds
    ds_read_b64_tr_b16 a[72:73], v14 offset:0
    v_mfma_f32_16x16x32_bf16 v[44:47], a[24:27], v[24:27], 0
    s_add_u32 m0, s90, 49152
    ds_read_b64_tr_b16 a[74:75], v14 offset:768
    v_mfma_f32_16x16x32_bf16 v[44:47], a[28:31], v[20:23], v[44:47]
    s_mov_b32 s92, 147840
    ds_read_b64_tr_b16 a[96:97], v14 offset:32
    v_fma_f32 v40, v48, v48, s41
    v_mfma_f32_16x16x32_bf16 v[44:47], a[32:35], v[16:19], v[44:47]
    ds_read_b64_tr_b16 a[98:99], v14 offset:800
    v_fmac_f32 v40, v49, v49
    v_mfma_f32_16x16x32_bf16 v[44:47], a[36:39], v[52:55], v[44:47]
    ds_read_b64_tr_b16 a[120:121], v14 offset:64
    v_fmac_f32 v40, v50, v50
    v_mfma_f32_16x16x32_bf16 v[44:47], a[40:43], v[4:7], v[44:47]
    buffer_load_dwordx4 v56, s[32:35], s92 offen offset:0 lds
    ds_read_b64_tr_b16 a[122:123], v14 offset:832
    v_mfma_f32_16x16x32_bf16 v[44:47], a[44:47], v[0:3], v[44:47]
    ds_read_b128 v[76:79], v73 offset:41088
    v_fmac_f32 v40, v51, v51
    v_mfma_f32_16x16x32_bf16 v[28:31], a[48:51], v[24:27], 0
    ds_read_b128 v[24:27], v35 offset:41088
    s_nop 0
    v_mfma_f32_16x16x32_bf16 v[28:31], a[52:55], v[20:23], v[28:31]
    s_nop 0
    ds_read_b128 v[20:23], v73 offset:41216
    v_fmac_f32 v40, v44, v44
    v_mfma_f32_16x16x32_bf16 v[28:31], a[56:59], v[16:19], v[28:31]
    ds_read_b128 v[16:19], v35 offset:41216
    v_fmac_f32 v40, v45, v45
    v_mfma_f32_16x16x32_bf16 v[28:31], a[60:63], v[52:55], v[28:31]
    buffer_load_dwordx4 v13, s[32:35], s92 offen offset:1024 lds
    v_fmac_f32 v40, v46, v46
    v_mfma_f32_16x16x32_bf16 v[28:31], a[64:67], v[4:7], v[28:31]
    v_fmac_f32 v40, v47, v47
    v_mfma_f32_16x16x32_bf16 v[28:31], a[68:71], v[0:3], v[28:31]
    s_nop 7
    v_fmac_f32 v40, v28, v28
    v_fmac_f32 v40, v29, v29
    v_fmac_f32 v40, v30, v30
    v_fmac_f32 v40, v31, v31
    buffer_load_dwordx4 v12, s[32:35], s92 offen offset:2048 lds
    s_add_u32 m0, s90, 61440
    s_mov_b32 s92, 184704
    s_waitcnt vmcnt(9)
    ds_read_b64_tr_b16 a[76:77], v14 offset:12288
    ds_read_b64_tr_b16 a[78:79], v14 offset:13056
    ds_read_b64_tr_b16 a[100:101], v14 offset:12320
    ds_read_b64_tr_b16 a[102:103], v14 offset:13088
    ds_read_b64_tr_b16 a[124:125], v14 offset:12352
    ds_read_b64_tr_b16 a[126:127], v14 offset:13120
    buffer_load_dwordx4 v56, s[32:35], s92 offen offset:0 lds
    buffer_load_dwordx4 v13, s[32:35], s92 offen offset:1024 lds
    buffer_load_dwordx4 v12, s[32:35], s92 offen offset:2048 lds
    s_add_u32 m0, s90, 0
    s_mov_b32 s92, 768
    s_waitcnt vmcnt(9)
    ds_read_b64_tr_b16 a[80:81], v14 offset:24576
    ds_read_b64_tr_b16 a[82:83], v14 offset:25344
    ds_read_b64_tr_b16 a[104:105], v14 offset:24608
    ds_read_b64_tr_b16 a[106:107], v14 offset:25376
    ds_read_b64_tr_b16 a[128:129], v14 offset:24640
    ds_read_b64_tr_b16 a[130:131], v14 offset:25408
    s_waitcnt lgkmcnt(6)
    buffer_load_dwordx4 v56, s[32:35], s92 offen offset:0 lds
    buffer_load_dwordx4 v13, s[32:35], s92 offen offset:1024 lds
    buffer_load_dwordx4 v12, s[32:35], s92 offen offset:2048 lds
    s_add_u32 m0, s90, 12288
    s_mov_b32 s92, 37632
    s_waitcnt vmcnt(9)
    ds_read_b64_tr_b16 a[84:85], v14 offset:36864
    ds_read_b64_tr_b16 a[86:87], v14 offset:37632
    ds_read_b64_tr_b16 a[108:109], v14 offset:36896
    ds_read_b64_tr_b16 a[110:111], v14 offset:37664
    ds_read_b64_tr_b16 a[132:133], v14 offset:36928
    ds_read_b64_tr_b16 a[134:135], v14 offset:37696
    buffer_load_dwordx4 v56, s[32:35], s92 offen offset:0 lds
    buffer_load_dwordx4 v13, s[32:35], s92 offen offset:1024 lds
    buffer_load_dwordx4 v12, s[32:35], s92 offen offset:2048 lds
    s_add_u32 m0, s90, 24576
    s_mov_b32 s92, 74496
    s_waitcnt vmcnt(9)
    ds_read_b64_tr_b16 a[88:89], v14 offset:49152
    ds_read_b64_tr_b16 a[90:91], v14 offset:49920
    ds_read_b64_tr_b16 a[112:113], v14 offset:49184
    ds_read_b64_tr_b16 a[114:115], v14 offset:49952
    ds_read_b64_tr_b16 a[136:137], v14 offset:49216
    ds_read_b64_tr_b16 a[138:139], v14 offset:49984
    s_waitcnt lgkmcnt(6)
    buffer_load_dwordx4 v56, s[32:35], s92 offen offset:0 lds
    buffer_load_dwordx4 v13, s[32:35], s92 offen offset:1024 lds
    buffer_load_dwordx4 v12, s[32:35], s92 offen offset:2048 lds
    s_add_u32 m0, s90, 36864
    s_mov_b32 s92, 111360
    s_waitcnt vmcnt(9)
    ds_read_b64_tr_b16 a[92:93], v14 offset:61440
    ds_read_b64_tr_b16 a[94:95], v14 offset:62208
    v_mfma_f32_16x16x32_bf16 v[52:55], a[72:75], v[108:111], 0
    ds_read_b64_tr_b16 a[116:117], v14 offset:61472
    v_mfma_f32_16x16x32_bf16 v[52:55], a[76:79], v[80:83], v[52:55]
    ds_read_b64_tr_b16 a[118:119], v14 offset:62240
    v_mfma_f32_16x16x32_bf16 v[52:55], a[80:83], v[76:79], v[52:55]
    ds_read_b64_tr_b16 a[140:141], v14 offset:61504
    v_mfma_f32_16x16x32_bf16 v[52:55], a[84:87], v[24:27], v[52:55]
    s_waitcnt lgkmcnt(5)
    buffer_load_dwordx4 v56, s[32:35], s92 offen offset:0 lds
    ds_read_b64_tr_b16 a[142:143], v14 offset:62272
    v_mfma_f32_16x16x32_bf16 v[52:55], a[88:91], v[20:23], v[52:55]
    ds_read_b128 v[104:107], v73 offset:42496
    ds_read_b128 v[84:87], v35 offset:42496
    ds_read_b128 v[68:71], v73 offset:42624
    ds_read_b128 v[64:67], v35 offset:42624
    s_waitcnt lgkmcnt(7)
    v_mfma_f32_16x16x32_bf16 v[52:55], a[92:95], v[16:19], v[52:55]
    buffer_load_dwordx4 v13, s[32:35], s92 offen offset:1024 lds
    ds_read_b128 v[60:63], v73 offset:42752
    v_mfma_f32_16x16x32_bf16 v[88:91], a[96:99], v[108:111], 0
    s_nop 1
    ds_read_b128 v[0:3], v35 offset:42752
    v_mfma_f32_16x16x32_bf16 v[88:91], a[100:103], v[80:83], v[88:91]
    s_nop 0
    v_fma_f32 v57, v52, v52, s41
    v_fmac_f32 v57, v53, v53
    v_mfma_f32_16x16x32_bf16 v[88:91], a[104:107], v[76:79], v[88:91]
    v_fmac_f32 v57, v54, v54
    v_fmac_f32 v57, v55, v55
    v_mfma_f32_16x16x32_bf16 v[88:91], a[108:111], v[24:27], v[88:91]
    v_mfma_f32_16x16x32_bf16 v[88:91], a[112:115], v[20:23], v[88:91]
    s_waitcnt vmcnt(8) lgkmcnt(4)
    buffer_load_dwordx4 v12, s[32:35], s92 offen offset:2048 lds
    ds_read_b64_tr_b16 a[144:145], v15 offset:0
    v_mfma_f32_16x16x32_bf16 v[88:91], a[116:119], v[16:19], v[88:91]
    s_add_u32 m0, s90, 49152
    ds_read_b64_tr_b16 a[146:147], v15 offset:768
    v_mfma_f32_16x16x32_bf16 v[4:7], a[120:123], v[108:111], 0
    s_mov_b32 s92, 148224
    s_nop 0
    ds_read_b64_tr_b16 a[168:169], v15 offset:8
    v_mfma_f32_16x16x32_bf16 v[4:7], a[124:127], v[80:83], v[4:7]
    s_nop 0
    v_fmac_f32 v57, v88, v88
    v_fmac_f32 v57, v89, v89
    v_mfma_f32_16x16x32_bf16 v[4:7], a[128:131], v[76:79], v[4:7]
    ds_read_b64_tr_b16 a[170:171], v15 offset:776
    v_fmac_f32 v57, v90, v90
    v_mfma_f32_16x16x32_bf16 v[4:7], a[132:135], v[24:27], v[4:7]
    buffer_load_dwordx4 v56, s[32:35], s92 offen offset:0 lds
    ds_read_b64_tr_b16 a[192:193], v14 offset:64
    v_mfma_f32_16x16x32_bf16 v[4:7], a[136:139], v[20:23], v[4:7]
    ds_read_b64_tr_b16 a[194:195], v14 offset:832
    v_fmac_f32 v57, v91, v91
    v_mfma_f32_16x16x32_bf16 v[4:7], a[140:143], v[16:19], v[4:7]
    s_nop 0
    v_mfma_f32_16x16x32_bf16 v[16:19], a[72:75], v[104:107], 0
    s_nop 2
    v_mfma_f32_16x16x32_bf16 v[16:19], a[76:79], v[84:87], v[16:19]
    s_waitcnt lgkmcnt(5)
    s_nop 0
    v_fmac_f32 v57, v4, v4
    v_fmac_f32 v57, v5, v5
    v_mfma_f32_16x16x32_bf16 v[16:19], a[80:83], v[68:71], v[16:19]
    buffer_load_dwordx4 v13, s[32:35], s92 offen offset:1024 lds
    v_fmac_f32 v57, v6, v6
    v_mfma_f32_16x16x32_bf16 v[16:19], a[84:87], v[64:67], v[16:19]
    v_fmac_f32 v57, v7, v7
    v_cvt_pk_bf16_f32 v170, v41, v57
    v_mfma_f32_16x16x32_bf16 v[16:19], a[88:91], v[60:63], v[16:19]
    v_mfma_f32_16x16x32_bf16 v[16:19], a[92:95], v[0:3], v[16:19]
    ds_read_b128 v[80:83], v73 offset:40960
    v_mfma_f32_16x16x32_bf16 v[24:27], a[96:99], v[104:107], 0
    ds_read_b128 v[76:79], v35 offset:40960
    v_mfma_f32_16x16x32_bf16 v[24:27], a[100:103], v[84:87], v[24:27]
    s_waitcnt vmcnt(8)
    buffer_load_dwordx4 v12, s[32:35], s92 offen offset:2048 lds
    ds_read_b64_tr_b16 a[148:149], v15 offset:12288
    v_mfma_f32_16x16x32_bf16 v[24:27], a[104:107], v[68:71], v[24:27]
    s_add_u32 m0, s90, 61440
    v_fma_f32 v41, v16, v16, s41
    v_fmac_f32 v41, v17, v17
    v_mfma_f32_16x16x32_bf16 v[24:27], a[108:111], v[64:67], v[24:27]
    s_mov_b32 s92, 185088
    ds_read_b64_tr_b16 a[150:151], v15 offset:13056
    v_fmac_f32 v41, v18, v18
    v_mfma_f32_16x16x32_bf16 v[24:27], a[112:115], v[60:63], v[24:27]
    ds_read_b64_tr_b16 a[172:173], v15 offset:12296
    v_fmac_f32 v41, v19, v19
    v_mfma_f32_16x16x32_bf16 v[24:27], a[116:119], v[0:3], v[24:27]
    ds_read_b64_tr_b16 a[174:175], v15 offset:13064
    v_mfma_f32_16x16x32_bf16 v[20:23], a[120:123], v[104:107], 0
    s_nop 0
    buffer_load_dwordx4 v56, s[32:35], s92 offen offset:0 lds
    ds_read_b64_tr_b16 a[196:197], v14 offset:12352
    v_mfma_f32_16x16x32_bf16 v[20:23], a[124:127], v[84:87], v[20:23]
    s_nop 0
    ds_read_b64_tr_b16 a[198:199], v14 offset:13120
    v_fmac_f32 v41, v24, v24
    v_mfma_f32_16x16x32_bf16 v[20:23], a[128:131], v[68:71], v[20:23]
    ds_read_b128 v[68:71], v73 offset:41088
    v_fmac_f32 v41, v25, v25
    v_mfma_f32_16x16x32_bf16 v[20:23], a[132:135], v[64:67], v[20:23]
    ds_read_b128 v[64:67], v35 offset:41088
    v_fmac_f32 v41, v26, v26
    v_mfma_f32_16x16x32_bf16 v[20:23], a[136:139], v[60:63], v[20:23]
    ds_read_b128 v[60:63], v73 offset:41216
    v_fmac_f32 v41, v27, v27
    v_mfma_f32_16x16x32_bf16 v[20:23], a[140:143], v[0:3], v[20:23]
    s_nop 0
    buffer_load_dwordx4 v13, s[32:35], s92 offen offset:1024 lds
    ds_read_b128 v[0:3], v35 offset:41216
    v_mfma_f32_16x16x16_bf16 v[84:87], v[216:217], v[170:171], 0
    s_nop 3
    v_fmac_f32 v41, v20, v20
    v_fmac_f32 v41, v21, v21
    v_fmac_f32 v41, v22, v22
    v_fmac_f32 v41, v23, v23
    v_rsq_f32 v84, v84
    v_rsq_f32 v85, v85
    v_mul_f32 v84, s55, v84
    v_mul_f32 v85, 0.5, v85
    v_mul_f32 v92, v92, v84
    buffer_load_dwordx4 v12, s[32:35], s92 offen offset:2048 lds
    s_add_u32 m0, s90, 0
    s_mov_b32 s92, 0
    s_waitcnt vmcnt(9)
    ds_read_b64_tr_b16 a[152:153], v15 offset:24576
    v_mul_f32 v93, v93, v84
    v_cvt_pk_f16_f32 v92, v92, v93
    v_mul_f32 v94, v94, v84
    ds_read_b64_tr_b16 a[154:155], v15 offset:25344
    v_mul_f32 v95, v95, v84
    v_cvt_pk_f16_f32 v93, v94, v95
    v_mul_f32 v100, v100, v84
    ds_read_b64_tr_b16 a[176:177], v15 offset:24584
    v_mul_f32 v101, v101, v84
    v_cvt_pk_f16_f32 v94, v100, v101
    s_waitcnt lgkmcnt(3)
    buffer_load_dwordx4 v72, s[76:79], s92 offen offset:0 lds
    ds_read_b64_tr_b16 a[178:179], v15 offset:25352
    v_mul_f32 v102, v102, v84
    v_mul_f32 v103, v103, v84
    v_cvt_pk_f16_f32 v95, v102, v103
    ds_read_b64_tr_b16 a[200:201], v14 offset:24640
    v_mul_f32 v96, v96, v84
    ds_read_b64_tr_b16 a[202:203], v14 offset:25408
    v_mul_f32 v97, v97, v84
    v_cvt_pk_f16_f32 v56, v96, v97
    v_mul_f32 v98, v98, v84
    v_mul_f32 v99, v99, v84
    v_cvt_pk_f16_f32 v57, v98, v99
    v_mul_f32 v52, v52, v85
    buffer_load_dwordx4 v9, s[76:79], s92 offen offset:1024 lds
    ds_write_b128 v34, v[92:95] offset:21504
    v_mul_f32 v53, v53, v85
    v_cvt_pk_f16_f32 v52, v52, v53
    v_mul_f32 v54, v54, v85
    v_mul_f32 v55, v55, v85
    v_cvt_pk_f16_f32 v53, v54, v55
    v_mul_f32 v88, v88, v85
    v_mul_f32 v89, v89, v85
    v_cvt_pk_f16_f32 v54, v88, v89
    v_mul_f32 v90, v90, v85
    v_mul_f32 v91, v91, v85
    v_cvt_pk_f16_f32 v55, v90, v91
    v_mul_f32 v4, v4, v85
    buffer_load_dwordx4 v8, s[76:79], s92 offen offset:2048 lds
    s_add_u32 m0, s90, 12288
    s_mov_b32 s92, 12288
    s_waitcnt vmcnt(9)
    ds_read_b64_tr_b16 a[156:157], v15 offset:36864
    v_mul_f32 v5, v5, v85
    v_cvt_pk_f16_f32 v12, v4, v5
    v_mul_f32 v6, v6, v85
    ds_read_b64_tr_b16 a[158:159], v15 offset:37632
    v_mul_f32 v7, v7, v85
    v_cvt_pk_f16_f32 v13, v6, v7
    v_cvt_pk_bf16_f32 v170, v40, v41
    ds_read_b64_tr_b16 a[180:181], v15 offset:36872
    s_nop 0
    v_mfma_f32_16x16x16_bf16 v[4:7], v[216:217], v[170:171], 0
    buffer_load_dwordx4 v72, s[76:79], s92 offen offset:0 lds
    ds_read_b64_tr_b16 a[182:183], v15 offset:37640
    s_nop 2
    ds_read_b64_tr_b16 a[204:205], v14 offset:36928
    s_nop 0
    ds_read_b64_tr_b16 a[206:207], v14 offset:37696
    v_rsq_f32 v4, v4
    ds_write_b128 v34, v[56:59] offset:21520
    v_rsq_f32 v5, v5
    buffer_load_dwordx4 v9, s[76:79], s92 offen offset:1024 lds
    v_mul_f32 v4, s55, v4
    v_mul_f32 v5, 0.5, v5
    v_mul_f32 v48, v48, v4
    ds_write_b128 v34, v[52:55] offset:21536
    v_mul_f32 v49, v49, v4
    v_cvt_pk_f16_f32 v88, v48, v49
    v_mul_f32 v50, v50, v4
    v_mul_f32 v51, v51, v4
    v_cvt_pk_f16_f32 v89, v50, v51
    v_mul_f32 v44, v44, v4
    v_mul_f32 v45, v45, v4
    buffer_load_dwordx4 v8, s[76:79], s92 offen offset:2048 lds
    s_add_u32 m0, s90, 24576
    s_mov_b32 s92, 24576
    s_waitcnt vmcnt(9)
    ds_read_b64_tr_b16 a[160:161], v15 offset:49152
    v_cvt_pk_f16_f32 v90, v44, v45
    v_mul_f32 v46, v46, v4
    v_mul_f32 v47, v47, v4
    ds_read_b64_tr_b16 a[162:163], v15 offset:49920
    v_cvt_pk_f16_f32 v91, v46, v47
    v_mul_f32 v28, v28, v4
    v_mul_f32 v29, v29, v4
    ds_read_b64_tr_b16 a[184:185], v15 offset:49160
    v_cvt_pk_f16_f32 v40, v28, v29
    v_mul_f32 v30, v30, v4
    s_waitcnt lgkmcnt(3)
    buffer_load_dwordx4 v72, s[76:79], s92 offen offset:0 lds
    ds_read_b64_tr_b16 a[186:187], v15 offset:49928
    v_mul_f32 v31, v31, v4
    v_cvt_pk_f16_f32 v41, v30, v31
    v_mul_f32 v16, v16, v5
    ds_read_b64_tr_b16 a[208:209], v14 offset:49216
    v_mul_f32 v17, v17, v5
    ds_read_b64_tr_b16 a[210:211], v14 offset:49984
    v_cvt_pk_f16_f32 v16, v16, v17
    ds_write_b64 v34, v[12:13] offset:21552
    buffer_load_dwordx4 v9, s[76:79], s92 offen offset:1024 lds
    v_mul_f32 v18, v18, v5
    v_mul_f32 v19, v19, v5
    v_cvt_pk_f16_f32 v17, v18, v19
    v_mul_f32 v24, v24, v5
    v_mul_f32 v25, v25, v5
    v_cvt_pk_f16_f32 v18, v24, v25
    v_mul_f32 v26, v26, v5
    v_mul_f32 v27, v27, v5
    v_cvt_pk_f16_f32 v19, v26, v27
    v_mul_f32 v20, v20, v5
    v_mul_f32 v21, v21, v5
    v_cvt_pk_f16_f32 v12, v20, v21
    v_mul_f32 v22, v22, v5
    v_mul_f32 v23, v23, v5
    v_cvt_pk_f16_f32 v13, v22, v23
    buffer_load_dwordx4 v8, s[76:79], s92 offen offset:2048 lds
    s_add_u32 m0, s90, 36864
    s_mov_b32 s92, 36864
    s_waitcnt vmcnt(9)
    ds_read_b64_tr_b16 a[164:165], v15 offset:61440
    ds_read_b64_tr_b16 a[166:167], v15 offset:62208
    v_mfma_f32_16x16x32_bf16 v[56:59], a[144:147], v[80:83], 0
    ds_read_b64_tr_b16 a[188:189], v15 offset:61448
    v_mfma_f32_16x16x32_bf16 v[56:59], a[148:151], v[76:79], v[56:59]
    ds_read_b64_tr_b16 a[190:191], v15 offset:62216
    v_mfma_f32_16x16x32_bf16 v[56:59], a[152:155], v[68:71], v[56:59]
    ds_read_b64_tr_b16 a[212:213], v14 offset:61504
    v_mfma_f32_16x16x32_bf16 v[56:59], a[156:159], v[64:67], v[56:59]
    s_waitcnt lgkmcnt(5)
    buffer_load_dwordx4 v72, s[76:79], s92 offen offset:0 lds
    ds_read_b64_tr_b16 a[214:215], v14 offset:62272
    v_mfma_f32_16x16x32_bf16 v[56:59], a[160:163], v[60:63], v[56:59]
    ds_read_b128 v[52:55], v73 offset:42496
    ds_read_b128 v[48:51], v35 offset:42496
    ds_read_b128 v[44:47], v73 offset:42624
    ds_read_b128 v[28:31], v35 offset:42624
    buffer_load_dwordx4 v9, s[76:79], s92 offen offset:1024 lds
    s_waitcnt lgkmcnt(8)
    v_mfma_f32_16x16x32_bf16 v[56:59], a[164:167], v[0:3], v[56:59]
    ds_read_b128 v[24:27], v73 offset:42752
    s_nop 0
    v_mfma_f32_16x16x32_bf16 v[4:7], a[168:171], v[80:83], 0
    s_nop 0
    ds_read_b128 v[20:23], v35 offset:42752
    s_nop 0
    v_mfma_f32_16x16x32_bf16 v[4:7], a[172:175], v[76:79], v[4:7]
    s_nop 0
    v_cvt_pk_bf16_f32 v14, v56, v57
    v_cvt_pk_bf16_f32 v15, v58, v59
    v_mfma_f32_16x16x32_bf16 v[4:7], a[176:179], v[68:71], v[4:7]
    ds_write_b64 v34, v[14:15] offset:21560
    v_mfma_f32_16x16x32_bf16 v[4:7], a[180:183], v[64:67], v[4:7]
    s_lshl_b32 s93, s68, 10
    buffer_load_dwordx4 v8, s[76:79], s92 offen offset:2048 lds
    v_add_u32 v35, s93, v131
    v_mfma_f32_16x16x32_bf16 v[4:7], a[184:187], v[60:63], v[4:7]
    s_waitcnt lgkmcnt(5)
    s_add_u32 m0, s90, 49152
    v_mfma_f32_16x16x32_bf16 v[4:7], a[188:191], v[0:3], v[4:7]
    s_mov_b32 s92, 49152
    s_nop 0
    v_mfma_f32_16x16x32_bf16 v[56:59], a[192:195], v[80:83], 0
    s_mov_b32 s53, s47
    s_nop 1
    v_mfma_f32_16x16x32_bf16 v[56:59], a[196:199], v[76:79], v[56:59]
    s_mov_b32 s47, s46
    v_cvt_pk_bf16_f32 v4, v4, v5
    v_cvt_pk_bf16_f32 v5, v6, v7
    v_mfma_f32_16x16x32_bf16 v[56:59], a[200:203], v[68:71], v[56:59]
    s_mov_b32 s46, s45
    buffer_load_dwordx4 v72, s[76:79], s92 offen offset:0 lds
    v_mfma_f32_16x16x32_bf16 v[56:59], a[204:207], v[64:67], v[56:59]
    s_mov_b32 s45, s44
    v_mfma_f32_16x16x32_bf16 v[56:59], a[208:211], v[60:63], v[56:59]
    s_mov_b32 s44, s53
    v_mfma_f32_16x16x32_bf16 v[56:59], a[212:215], v[0:3], v[56:59]
    s_sub_u32 s48, s44, s46
    v_add_u32 v139, s48, v139
    v_add_u32 v138, s48, v138
    v_mfma_f32_16x16x32_bf16 v[0:3], a[144:147], v[52:55], 0
    s_sub_u32 s49, s46, s45
    v_mfma_f32_16x16x32_bf16 v[0:3], a[148:151], v[48:51], v[0:3]
    s_waitcnt lgkmcnt(0)
    buffer_load_dwordx4 v9, s[76:79], s92 offen offset:1024 lds
    v_cvt_pk_bf16_f32 v6, v56, v57
    v_mfma_f32_16x16x32_bf16 v[0:3], a[152:155], v[44:47], v[0:3]
    v_cvt_pk_bf16_f32 v7, v58, v59
    v_mfma_f32_16x16x32_bf16 v[0:3], a[156:159], v[28:31], v[0:3]
    ds_write_b128 v34, v[4:7] offset:21568
    v_mfma_f32_16x16x32_bf16 v[0:3], a[160:163], v[24:27], v[0:3]
    v_mfma_f32_16x16x32_bf16 v[0:3], a[164:167], v[20:23], v[0:3]
    buffer_load_dwordx4 v8, s[76:79], s92 offen offset:2048 lds
    s_nop 0
    v_mfma_f32_16x16x32_bf16 v[4:7], a[168:171], v[52:55], 0
    s_add_u32 m0, s90, 61440
    s_nop 1
    v_mfma_f32_16x16x32_bf16 v[4:7], a[172:175], v[48:51], v[4:7]
    s_mov_b32 s92, 61440
    v_cvt_pk_bf16_f32 v14, v0, v1
    v_cvt_pk_bf16_f32 v15, v2, v3
    v_mfma_f32_16x16x32_bf16 v[4:7], a[176:179], v[44:47], v[4:7]
    v_mfma_f32_16x16x32_bf16 v[4:7], a[180:183], v[28:31], v[4:7]
    v_mfma_f32_16x16x32_bf16 v[4:7], a[184:187], v[24:27], v[4:7]
    buffer_load_dwordx4 v72, s[76:79], s92 offen offset:0 lds
    v_mfma_f32_16x16x32_bf16 v[4:7], a[188:191], v[20:23], v[4:7]
    s_nop 1
    v_mfma_f32_16x16x32_bf16 v[0:3], a[192:195], v[52:55], 0
    s_nop 2
    v_mfma_f32_16x16x32_bf16 v[0:3], a[196:199], v[48:51], v[0:3]
    s_nop 0
    v_cvt_pk_bf16_f32 v4, v4, v5
    v_cvt_pk_bf16_f32 v5, v6, v7
    v_mfma_f32_16x16x32_bf16 v[0:3], a[200:203], v[44:47], v[0:3]
    v_mfma_f32_16x16x32_bf16 v[0:3], a[204:207], v[28:31], v[0:3]
    buffer_load_dwordx4 v9, s[76:79], s92 offen offset:1024 lds
    v_mfma_f32_16x16x32_bf16 v[0:3], a[208:211], v[24:27], v[0:3]
    v_mfma_f32_16x16x32_bf16 v[0:3], a[212:215], v[20:23], v[0:3]
    s_nop 7
    v_cvt_pk_bf16_f32 v6, v0, v1
    v_cvt_pk_bf16_f32 v7, v2, v3
    buffer_load_dwordx4 v8, s[76:79], s92 offen offset:2048 lds
    s_add_u32 m0, s54, 20480
    s_nop 0
    buffer_load_dwordx4 v130, s[24:27], s56 offen nt lds
    s_add_u32 m0, s54, 21504
    s_nop 0
    buffer_load_dwordx4 v129, s[24:27], s56 offen nt lds
    s_add_u32 m0, s54, 22528
    s_nop 0
    buffer_load_dwordx4 v128, s[24:27], s56 offen nt lds
    s_add_u32 m0, s54, 23552
    s_nop 0
    buffer_load_dwordx4 v127, s[24:27], s56 offen nt lds
    s_add_u32 m0, s54, 24576
    s_nop 0
    buffer_load_dwordx4 v126, s[24:27], s56 offen nt lds
    s_waitcnt vmcnt(5)
    s_barrier
    ds_read_b128 v[28:31], v11 offset:0
    ds_read_b64 v[48:49], v10 offset:64
    ds_read_b128 v[0:3], v11 offset:3072
    ds_read_b64 v[50:51], v10 offset:3136
    ds_read_b128 v[52:55], v11 offset:6144
    ds_read_b64 v[20:21], v10 offset:6208
    ds_read_b128 v[24:27], v11 offset:9216
    ds_read_b64 v[22:23], v10 offset:9280
    ds_read_b128 v[44:47], v11 offset:12288
    ds_read_b64 v[56:57], v10 offset:12352
    ds_read_b128 v[68:71], v11 offset:15360
    ds_read_b64 v[58:59], v10 offset:15424
    s_waitcnt lgkmcnt(11)
    v_mfma_f32_16x16x32_bf16 v[60:63], v[28:31], v[220:223], 0
    s_waitcnt lgkmcnt(9)
    ds_read_b128 v[28:31], v11 offset:18432
    v_mfma_f32_16x16x32_bf16 v[60:63], v[0:3], v[220:223], v[60:63]
    s_waitcnt lgkmcnt(8)
    ds_read_b64 v[0:1], v10 offset:18496
    ds_read_b128 v[64:67], v11 offset:21504
    v_mfma_f32_16x16x32_bf16 v[60:63], v[52:55], v[220:223], v[60:63]
    s_waitcnt lgkmcnt(8)
    ds_read_b64 v[2:3], v10 offset:21568
    ds_read_b128 v[52:55], v11 offset:24576
    v_mfma_f32_16x16x32_bf16 v[60:63], v[24:27], v[220:223], v[60:63]
    ds_read_b64 v[24:25], v10 offset:24640
    v_mfma_f32_16x16x32_bf16 v[60:63], v[48:51], v[220:223], v[60:63]
    s_waitcnt lgkmcnt(9)
    ds_read_b128 v[48:51], v11 offset:27648
    v_mfma_f32_16x16x32_bf16 v[60:63], v[20:23], v[220:223], v[60:63]
    ds_read_b64 v[26:27], v10 offset:27712
    v_mfma_f32_16x16x32_bf16 v[20:23], v[44:47], v[220:223], 0
    s_waitcnt lgkmcnt(8)
    ds_read_b128 v[44:47], v11 offset:30720
    v_mfma_f32_16x16x32_bf16 v[20:23], v[68:71], v[220:223], v[20:23]
    s_waitcnt lgkmcnt(8)
    s_nop 0
    ds_read_b64 v[8:9], v10 offset:30784
    v_mul_f32 v60, 0xbbaaaaab, v60
    v_mfma_f32_16x16x32_bf16 v[20:23], v[28:31], v[220:223], v[20:23]
    s_waitcnt lgkmcnt(7)
    ds_read_b128 v[28:31], v11 offset:33792
    v_mul_f32 v61, 0xbbaaaaab, v61
    v_mul_f32 v62, 0xbbaaaaab, v62
    v_mul_f32 v63, 0xbbaaaaab, v63
    v_mfma_f32_16x16x32_bf16 v[20:23], v[64:67], v[220:223], v[20:23]
    ds_write_b128 v33, v[60:63] offset:0
    v_mfma_f32_16x16x32_bf16 v[20:23], v[56:59], v[220:223], v[20:23]
    s_waitcnt lgkmcnt(6)
    v_mfma_f32_16x16x32_bf16 v[20:23], v[0:3], v[220:223], v[20:23]
    v_mfma_f32_16x16x32_bf16 v[0:3], v[52:55], v[220:223], 0
    s_waitcnt lgkmcnt(4)
    ds_read_b64 v[10:11], v10 offset:33856
    s_nop 0
    v_mfma_f32_16x16x32_bf16 v[0:3], v[48:51], v[220:223], v[0:3]
    s_waitcnt lgkmcnt(4)
    s_nop 0
    ds_read_b128 v[52:55], v32 offset:0
    v_mul_f32 v20, 0xbbaaaaab, v20
    v_mfma_f32_16x16x32_bf16 v[0:3], v[44:47], v[220:223], v[0:3]
    s_waitcnt lgkmcnt(3)
    ds_read_b64 v[56:57], v75 offset:64
    v_mul_f32 v21, 0xbbaaaaab, v21
    v_mul_f32 v22, 0xbbaaaaab, v22
    v_mul_f32 v23, 0xbbaaaaab, v23
    v_mfma_f32_16x16x32_bf16 v[0:3], v[28:31], v[220:223], v[0:3]
    ds_write_b128 v33, v[20:23] offset:128
    v_mfma_f32_16x16x32_bf16 v[0:3], v[24:27], v[220:223], v[0:3]
    ds_read_b128 v[82:85], v32 offset:768
    ds_read_b64 v[86:87], v75 offset:832
    ds_read_b128 v[76:79], v32 offset:12288
    s_waitcnt lgkmcnt(6)
    v_mfma_f32_16x16x32_bf16 v[0:3], v[8:11], v[220:223], v[0:3]
    s_nop 0
    ds_read_b64 v[80:81], v75 offset:12352
    s_nop 0
    ds_read_b128 v[68:71], v32 offset:13056
    s_nop 2
    ds_read_b64 v[72:73], v75 offset:13120
    v_mul_f32 v0, 0xbbaaaaab, v0
    v_mul_f32 v1, 0xbbaaaaab, v1
    v_mul_f32 v2, 0xbbaaaaab, v2
    v_mul_f32 v3, 0xbbaaaaab, v3
    ds_write_b128 v33, v[0:3] offset:256
    s_waitcnt lgkmcnt(0)
    s_barrier
    ds_read_b128 v[0:3], v74 offset:0
    ds_read_b128 v[48:51], v74 offset:64
    ds_read_b128 v[28:31], v74 offset:128
    ds_read_b128 v[24:27], v74 offset:192
    s_waitcnt lgkmcnt(3)
    v_mfma_f32_16x16x16_bf16 v[44:47], v[52:53], v[146:147], v[0:3]
    v_mfma_f32_16x16x16_bf16 v[20:23], v[54:55], v[146:147], v[0:3]
    s_nop 2
    v_mfma_f32_16x16x16_bf16 v[64:67], v[56:57], v[146:147], v[0:3]
    s_waitcnt lgkmcnt(0)
    s_nop 0
    ds_read_b128 v[56:59], v32 offset:24576
    v_cvt_pk_bf16_f32 v44, v44, v45
    v_mfma_f32_16x16x16_bf16 v[8:11], v[82:83], v[146:147], v[48:51]
    ds_read_b64 v[60:61], v75 offset:24640
    v_accvgpr_write_b32 a216, v44
    v_mfma_f32_16x16x16_bf16 v[116:119], v[84:85], v[146:147], v[48:51]
    ds_read_b128 v[52:55], v74 offset:256
    v_cvt_pk_bf16_f32 v46, v46, v47
    v_mfma_f32_16x16x16_bf16 v[0:3], v[86:87], v[146:147], v[48:51]
    ds_read_b128 v[108:111], v32 offset:25344
    v_accvgpr_write_b32 a217, v46
    v_mfma_f32_16x16x16_bf16 v[100:103], v[76:77], v[146:147], v[28:31]
    ds_read_b64 v[112:113], v75 offset:25408
    v_cvt_pk_bf16_f32 v20, v20, v21
    v_mfma_f32_16x16x16_bf16 v[48:51], v[78:79], v[146:147], v[28:31]
    ds_read_b128 v[104:107], v74 offset:320
    v_accvgpr_write_b32 a240, v20
    v_mfma_f32_16x16x16_bf16 v[44:47], v[80:81], v[146:147], v[28:31]
    ds_read_b128 v[92:95], v32 offset:36864
    v_cvt_pk_bf16_f32 v22, v22, v23
    v_mfma_f32_16x16x16_bf16 v[84:87], v[68:69], v[146:147], v[24:27]
    ds_read_b64 v[96:97], v75 offset:36928
    v_accvgpr_write_b32 a241, v22
    v_mfma_f32_16x16x16_bf16 v[28:31], v[70:71], v[146:147], v[24:27]
    ds_read_b128 v[80:83], v74 offset:5120
    v_cvt_pk_bf16_f32 v232, v64, v65
    v_mfma_f32_16x16x16_bf16 v[20:23], v[72:73], v[146:147], v[24:27]
    s_waitcnt lgkmcnt(6)
    ds_read_b128 v[224:227], v32 offset:37632
    v_cvt_pk_bf16_f32 v233, v66, v67
    v_cvt_pk_bf16_f32 v8, v8, v9
    v_accvgpr_write_b32 a218, v8
    v_cvt_pk_bf16_f32 v10, v10, v11
    v_accvgpr_write_b32 a219, v10
    v_cvt_pk_bf16_f32 v116, v116, v117
    v_mfma_f32_16x16x16_bf16 v[76:79], v[56:57], v[146:147], v[52:55]
    ds_read_b64 v[228:229], v75 offset:37696
    v_accvgpr_write_b32 a242, v116
    v_mfma_f32_16x16x16_bf16 v[24:27], v[58:59], v[146:147], v[52:55]
    ds_read_b128 v[64:67], v74 offset:5184
    v_cvt_pk_bf16_f32 v118, v118, v119
    v_mfma_f32_16x16x16_bf16 v[8:11], v[60:61], v[146:147], v[52:55]
    s_waitcnt lgkmcnt(6)
    ds_read_b128 v[68:71], v32 offset:49152
    v_accvgpr_write_b32 a243, v118
    v_cvt_pk_bf16_f32 v234, v0, v1
    v_cvt_pk_bf16_f32 v235, v2, v3
    v_mfma_f32_16x16x16_bf16 v[56:59], v[108:109], v[146:147], v[104:107]
    ds_read_b64 v[72:73], v75 offset:49216
    v_cvt_pk_bf16_f32 v100, v100, v101
    v_mfma_f32_16x16x16_bf16 v[52:55], v[110:111], v[146:147], v[104:107]
    ds_read_b128 v[60:63], v74 offset:5248
    v_accvgpr_write_b32 a220, v100
    v_mfma_f32_16x16x16_bf16 v[0:3], v[112:113], v[146:147], v[104:107]
    s_waitcnt lgkmcnt(6)
    ds_read_b128 v[116:119], v32 offset:49920
    v_cvt_pk_bf16_f32 v102, v102, v103
    v_accvgpr_write_b32 a221, v102
    v_cvt_pk_bf16_f32 v48, v48, v49
    v_accvgpr_write_b32 a244, v48
    v_cvt_pk_bf16_f32 v50, v50, v51
    v_accvgpr_write_b32 a245, v50
    v_cvt_pk_bf16_f32 v236, v44, v45
    v_cvt_pk_bf16_f32 v237, v46, v47
    v_mfma_f32_16x16x16_bf16 v[108:111], v[92:93], v[146:147], v[80:83]
    ds_read_b64 v[120:121], v75 offset:49984
    v_cvt_pk_bf16_f32 v84, v84, v85
    v_mfma_f32_16x16x16_bf16 v[44:47], v[94:95], v[146:147], v[80:83]
    ds_read_b128 v[112:115], v74 offset:5312
    v_accvgpr_write_b32 a222, v84
    v_mfma_f32_16x16x16_bf16 v[48:51], v[96:97], v[146:147], v[80:83]
    s_waitcnt lgkmcnt(5)
    ds_read_b128 v[100:103], v32 offset:61440
    v_cvt_pk_bf16_f32 v86, v86, v87
    v_accvgpr_write_b32 a223, v86
    v_cvt_pk_bf16_f32 v28, v28, v29
    v_accvgpr_write_b32 a246, v28
    v_cvt_pk_bf16_f32 v30, v30, v31
    v_accvgpr_write_b32 a247, v30
    v_cvt_pk_bf16_f32 v238, v20, v21
    v_cvt_pk_bf16_f32 v239, v22, v23
    v_mfma_f32_16x16x16_bf16 v[96:99], v[224:225], v[146:147], v[64:67]
    ds_read_b64 v[104:105], v75 offset:61504
    v_cvt_pk_bf16_f32 v76, v76, v77
    v_mfma_f32_16x16x16_bf16 v[92:95], v[226:227], v[146:147], v[64:67]
    ds_read_b128 v[20:23], v74 offset:5376
    v_accvgpr_write_b32 a224, v76
    v_mfma_f32_16x16x16_bf16 v[84:87], v[228:229], v[146:147], v[64:67]
    s_waitcnt lgkmcnt(5)
    ds_read_b128 v[28:31], v32 offset:62208
    v_cvt_pk_bf16_f32 v78, v78, v79
    v_accvgpr_write_b32 a225, v78
    v_cvt_pk_bf16_f32 v24, v24, v25
    v_accvgpr_write_b32 a248, v24
    v_cvt_pk_bf16_f32 v26, v26, v27
    v_accvgpr_write_b32 a249, v26
    v_cvt_pk_bf16_f32 v240, v8, v9
    v_cvt_pk_bf16_f32 v241, v10, v11
    v_mfma_f32_16x16x16_bf16 v[80:83], v[68:69], v[146:147], v[60:63]
    ds_read_b64 v[32:33], v75 offset:62272
    v_cvt_pk_bf16_f32 v56, v56, v57
    v_mfma_f32_16x16x16_bf16 v[76:79], v[70:71], v[146:147], v[60:63]
    ds_read_b128 v[24:27], v74 offset:5440
    v_accvgpr_write_b32 a226, v56
    v_mfma_f32_16x16x16_bf16 v[68:71], v[72:73], v[146:147], v[60:63]
    s_waitcnt lgkmcnt(5)
    ds_read_b128 v[8:11], v139 offset:0
    v_cvt_pk_bf16_f32 v58, v58, v59
    v_accvgpr_write_b32 a227, v58
    v_cvt_pk_bf16_f32 v52, v52, v53
    v_accvgpr_write_b32 a250, v52
    v_cvt_pk_bf16_f32 v54, v54, v55
    v_accvgpr_write_b32 a251, v54
    v_cvt_pk_bf16_f32 v242, v0, v1
    v_cvt_pk_bf16_f32 v243, v2, v3
    v_mfma_f32_16x16x16_bf16 v[64:67], v[116:117], v[146:147], v[112:115]
    ds_read_b128 v[60:63], v138 offset:0
    v_cvt_pk_bf16_f32 v108, v108, v109
    v_mfma_f32_16x16x16_bf16 v[56:59], v[118:119], v[146:147], v[112:115]
    ds_read_b128 v[0:3], v139 offset:128
    v_accvgpr_write_b32 a228, v108
    v_mfma_f32_16x16x16_bf16 v[52:55], v[120:121], v[146:147], v[112:115]
    s_waitcnt lgkmcnt(5)
    ds_read_b128 v[72:75], v138 offset:128
    v_cvt_pk_bf16_f32 v110, v110, v111
    v_accvgpr_write_b32 a229, v110
    v_cvt_pk_bf16_f32 v44, v44, v45
    v_accvgpr_write_b32 a252, v44
    v_cvt_pk_bf16_f32 v46, v46, v47
    v_accvgpr_write_b32 a253, v46
    v_cvt_pk_bf16_f32 v244, v48, v49
    v_cvt_pk_bf16_f32 v245, v50, v51
    v_mfma_f32_16x16x16_bf16 v[48:51], v[100:101], v[146:147], v[20:23]
    s_waitcnt vmcnt(0) lgkmcnt(4)
    s_barrier
    ds_write_b128 v35, v[36:39] offset:6144
    v_mfma_f32_16x16x16_bf16 v[44:47], v[102:103], v[146:147], v[20:23]
    v_cvt_pk_bf16_f32 v96, v96, v97
    v_accvgpr_write_b32 a230, v96
    v_mfma_f32_16x16x16_bf16 v[36:39], v[104:105], v[146:147], v[20:23]
    s_waitcnt lgkmcnt(4)
    v_cvt_pk_bf16_f32 v98, v98, v99
    v_accvgpr_write_b32 a231, v98
    v_cvt_pk_bf16_f32 v92, v92, v93
    v_mfma_f32_16x16x32_bf16 v[20:23], a[0:3], v[8:11], 0
    s_waitcnt lgkmcnt(3)
    ds_write_b128 v34, v[216:219] offset:80
    v_mfma_f32_16x16x32_bf16 v[20:23], a[4:7], v[60:63], v[20:23]
    s_waitcnt lgkmcnt(2)
    v_accvgpr_write_b32 a254, v92
    v_cvt_pk_bf16_f32 v94, v94, v95
    v_mfma_f32_16x16x32_bf16 v[20:23], a[8:11], v[0:3], v[20:23]
    v_accvgpr_write_b32 a255, v94
    v_cvt_pk_bf16_f32 v246, v84, v85
    v_mfma_f32_16x16x32_bf16 v[20:23], a[12:15], v[72:75], v[20:23]
    ds_write_b128 v34, v[88:91] offset:0
    v_cvt_pk_bf16_f32 v247, v86, v87
    v_cvt_pk_bf16_f32 v80, v80, v81
    v_accvgpr_write_b32 a232, v80
    v_cvt_pk_bf16_f32 v82, v82, v83
    v_accvgpr_write_b32 a233, v82
    v_cvt_pk_bf16_f32 v224, v76, v77
    v_cvt_pk_bf16_f32 v225, v78, v79
    v_cvt_pk_bf16_f32 v248, v68, v69
    v_cvt_pk_bf16_f32 v249, v70, v71
    v_cvt_pk_bf16_f32 v64, v64, v65
    v_accvgpr_write_b32 a234, v64
    v_cvt_pk_bf16_f32 v66, v66, v67
    v_accvgpr_write_b32 a235, v66
    v_cvt_pk_bf16_f32 v226, v56, v57
    v_cvt_pk_bf16_f32 v227, v58, v59
    v_cvt_pk_bf16_f32 v250, v52, v53
    v_cvt_pk_bf16_f32 v251, v54, v55
    v_cvt_pk_bf16_f32 v48, v48, v49
    v_accvgpr_write_b32 a236, v48
    v_cvt_pk_bf16_f32 v50, v50, v51
    v_accvgpr_write_b32 a237, v50
    v_cvt_pk_bf16_f32 v228, v44, v45
    v_cvt_pk_bf16_f32 v229, v46, v47
    v_cvt_pk_bf16_f32 v252, v36, v37
    v_cvt_pk_bf16_f32 v253, v38, v39
    ds_write_b128 v34, v[40:43] offset:16
    v_add_u32 v137, s49, v137
    v_add_u32 v136, s49, v136
    ds_write_b128 v34, v[16:19] offset:32
    ds_write_b128 v34, v[12:15] offset:48
    ds_write_b128 v34, v[4:7] offset:64
    ds_read_b128 v[76:79], v139 offset:256
    ds_read_b128 v[64:67], v138 offset:256
    s_waitcnt lgkmcnt(1)
    v_mfma_f32_16x16x32_bf16 v[20:23], a[16:19], v[76:79], v[20:23]
    s_waitcnt lgkmcnt(0)
    v_mfma_f32_16x16x32_bf16 v[20:23], a[20:23], v[64:67], v[20:23]
    s_nop 0
    v_mfma_f32_16x16x16_bf16 v[16:19], v[28:29], v[146:147], v[24:27]
    s_nop 3
    v_mfma_f32_16x16x16_bf16 v[12:15], v[30:31], v[146:147], v[24:27]
    s_nop 0
    v_fma_f32 v143, v20, v20, s41
    v_fmac_f32 v143, v21, v21
    v_mfma_f32_16x16x16_bf16 v[4:7], v[32:33], v[146:147], v[24:27]
    v_cvt_pk_bf16_f32 v16, v16, v17
    v_accvgpr_write_b32 a238, v16
    v_cvt_pk_bf16_f32 v18, v18, v19
    v_mfma_f32_16x16x32_bf16 v[52:55], a[24:27], v[8:11], 0
    v_accvgpr_write_b32 a239, v18
    v_cvt_pk_bf16_f32 v230, v12, v13
    v_mfma_f32_16x16x32_bf16 v[52:55], a[28:31], v[60:63], v[52:55]
    v_cvt_pk_bf16_f32 v231, v14, v15
    v_cvt_pk_bf16_f32 v254, v4, v5
    v_mfma_f32_16x16x32_bf16 v[52:55], a[32:35], v[0:3], v[52:55]
    v_cvt_pk_bf16_f32 v255, v6, v7
    v_fmac_f32 v143, v22, v22
    v_mfma_f32_16x16x32_bf16 v[52:55], a[36:39], v[72:75], v[52:55]
    v_fmac_f32 v143, v23, v23
    v_mfma_f32_16x16x32_bf16 v[52:55], a[40:43], v[76:79], v[52:55]
    v_mfma_f32_16x16x32_bf16 v[52:55], a[44:47], v[64:67], v[52:55]
    s_nop 1
    v_mfma_f32_16x16x32_bf16 v[48:51], a[48:51], v[8:11], 0
    s_nop 2
    v_mfma_f32_16x16x32_bf16 v[48:51], a[52:55], v[60:63], v[48:51]
    s_nop 0
    v_fmac_f32 v143, v52, v52
    v_fmac_f32 v143, v53, v53
    v_mfma_f32_16x16x32_bf16 v[48:51], a[56:59], v[0:3], v[48:51]
    v_fmac_f32 v143, v54, v54
    v_fmac_f32 v143, v55, v55
    v_mfma_f32_16x16x32_bf16 v[48:51], a[60:63], v[72:75], v[48:51]
    v_mfma_f32_16x16x32_bf16 v[48:51], a[64:67], v[76:79], v[48:51]
    v_mfma_f32_16x16x32_bf16 v[48:51], a[68:71], v[64:67], v[48:51]
    s_nop 1
    v_mfma_f32_16x16x32_bf16 v[44:47], a[72:75], v[8:11], 0
    s_nop 2
    v_mfma_f32_16x16x32_bf16 v[44:47], a[76:79], v[60:63], v[44:47]
    s_nop 0
    v_fmac_f32 v143, v48, v48
    v_fmac_f32 v143, v49, v49
    v_mfma_f32_16x16x32_bf16 v[44:47], a[80:83], v[0:3], v[44:47]
    v_fmac_f32 v143, v50, v50
    v_fmac_f32 v143, v51, v51
    v_mfma_f32_16x16x32_bf16 v[44:47], a[84:87], v[72:75], v[44:47]
    v_mfma_f32_16x16x32_bf16 v[44:47], a[88:91], v[76:79], v[44:47]
    v_mfma_f32_16x16x32_bf16 v[44:47], a[92:95], v[64:67], v[44:47]
    s_nop 1
    v_mfma_f32_16x16x32_bf16 v[4:7], a[96:99], v[8:11], 0
    s_nop 2
    v_mfma_f32_16x16x32_bf16 v[4:7], a[100:103], v[60:63], v[4:7]
    s_nop 0
    v_fma_f32 v142, v44, v44, s41
    v_fmac_f32 v142, v45, v45
    v_mfma_f32_16x16x32_bf16 v[4:7], a[104:107], v[0:3], v[4:7]
    v_fmac_f32 v142, v46, v46
    v_fmac_f32 v142, v47, v47
    v_mfma_f32_16x16x32_bf16 v[4:7], a[108:111], v[72:75], v[4:7]
    v_mfma_f32_16x16x32_bf16 v[4:7], a[112:115], v[76:79], v[4:7]
    v_mfma_f32_16x16x32_bf16 v[4:7], a[116:119], v[64:67], v[4:7]
    s_nop 1
    v_mfma_f32_16x16x32_bf16 v[36:39], a[120:123], v[8:11], 0
    s_nop 2
    v_mfma_f32_16x16x32_bf16 v[36:39], a[124:127], v[60:63], v[36:39]
    s_nop 0
    v_fmac_f32 v142, v4, v4
    v_fmac_f32 v142, v5, v5
    v_mfma_f32_16x16x32_bf16 v[36:39], a[128:131], v[0:3], v[36:39]
    v_fmac_f32 v142, v6, v6
    v_fmac_f32 v142, v7, v7
    v_mfma_f32_16x16x32_bf16 v[36:39], a[132:135], v[72:75], v[36:39]
    v_mfma_f32_16x16x32_bf16 v[36:39], a[136:139], v[76:79], v[36:39]
    v_mfma_f32_16x16x32_bf16 v[36:39], a[140:143], v[64:67], v[36:39]
    s_nop 1
    v_mfma_f32_16x16x32_bf16 v[12:15], v[8:11], a[144:147], 0
    s_nop 2
    v_mfma_f32_16x16x32_bf16 v[12:15], v[60:63], a[148:151], v[12:15]
    s_nop 0
    v_fmac_f32 v142, v36, v36
    v_fmac_f32 v142, v37, v37
    v_mfma_f32_16x16x32_bf16 v[12:15], v[0:3], a[152:155], v[12:15]
    v_fmac_f32 v142, v38, v38
    v_fmac_f32 v142, v39, v39
    v_mfma_f32_16x16x32_bf16 v[12:15], v[72:75], a[156:159], v[12:15]
    v_cvt_pk_bf16_f32 v170, v143, v142
    v_mfma_f32_16x16x32_bf16 v[12:15], v[76:79], a[160:163], v[12:15]
    ds_read_b128 v[108:111], v139 offset:1536
    v_mfma_f32_16x16x32_bf16 v[12:15], v[64:67], a[164:167], v[12:15]
    s_nop 0
    ds_read_b128 v[104:107], v138 offset:1536
    s_nop 0
    v_mfma_f32_16x16x16_bf16 v[40:43], v[216:217], v[170:171], 0
    s_nop 0
    ds_read_b128 v[88:91], v139 offset:1664
    s_nop 1
    v_cvt_pk_bf16_f32 v24, v12, v13
    v_mfma_f32_16x16x32_bf16 v[16:19], v[8:11], a[168:171], 0
    ds_read_b128 v[100:103], v138 offset:1664
    v_cvt_pk_bf16_f32 v25, v14, v15
    v_mfma_f32_16x16x32_bf16 v[16:19], v[60:63], a[172:175], v[16:19]
    ds_read_b128 v[68:71], v139 offset:1792
    v_mfma_f32_16x16x32_bf16 v[16:19], v[0:3], a[176:179], v[16:19]
    ds_read_b128 v[12:15], v138 offset:1792
    v_mfma_f32_16x16x32_bf16 v[16:19], v[72:75], a[180:183], v[16:19]
    v_rsq_f32 v40, v40
    v_mfma_f32_16x16x32_bf16 v[16:19], v[76:79], a[184:187], v[16:19]
    v_rsq_f32 v41, v41
    v_mfma_f32_16x16x32_bf16 v[16:19], v[64:67], a[188:191], v[16:19]
    v_mul_f32 v40, s55, v40
    v_mul_f32 v41, 0.5, v41
    v_mfma_f32_16x16x32_bf16 v[32:35], v[8:11], a[192:195], 0
    s_nop 0
    v_mul_f32 v20, v20, v40
    v_mul_f32 v21, v21, v40
    v_mfma_f32_16x16x32_bf16 v[32:35], v[60:63], a[196:199], v[32:35]
    s_nop 0
    v_cvt_pk_bf16_f32 v28, v16, v17
    v_cvt_pk_bf16_f32 v29, v18, v19
    v_mfma_f32_16x16x32_bf16 v[32:35], v[0:3], a[200:203], v[32:35]
    v_cvt_pk_f16_f32 v16, v20, v21
    v_mul_f32 v22, v22, v40
    v_mfma_f32_16x16x32_bf16 v[32:35], v[72:75], a[204:207], v[32:35]
    v_mul_f32 v23, v23, v40
    v_cvt_pk_f16_f32 v17, v22, v23
    v_mfma_f32_16x16x32_bf16 v[32:35], v[76:79], a[208:211], v[32:35]
    v_mul_f32 v52, v52, v40
    v_mul_f32 v53, v53, v40
    v_mfma_f32_16x16x32_bf16 v[32:35], v[64:67], a[212:215], v[32:35]
    s_waitcnt lgkmcnt(0)
    v_cvt_pk_f16_f32 v18, v52, v53
    v_mul_f32 v54, v54, v40
    v_mfma_f32_16x16x32_bf16 v[64:67], a[0:3], v[108:111], 0
    v_mul_f32 v55, v55, v40
    v_cvt_pk_f16_f32 v19, v54, v55
    v_mfma_f32_16x16x32_bf16 v[64:67], a[4:7], v[104:107], v[64:67]
    v_mul_f32 v48, v48, v40
    v_mul_f32 v49, v49, v40
    v_mfma_f32_16x16x32_bf16 v[64:67], a[8:11], v[88:91], v[64:67]
    v_cvt_pk_f16_f32 v154, v48, v49
    v_mul_f32 v50, v50, v40
    v_mfma_f32_16x16x32_bf16 v[64:67], a[12:15], v[100:103], v[64:67]
    v_mul_f32 v51, v51, v40
    v_cvt_pk_f16_f32 v155, v50, v51
    v_mfma_f32_16x16x32_bf16 v[64:67], a[16:19], v[68:71], v[64:67]
    v_mul_f32 v44, v44, v41
    v_mul_f32 v45, v45, v41
    v_mfma_f32_16x16x32_bf16 v[64:67], a[20:23], v[12:15], v[64:67]
    v_cvt_pk_f16_f32 v82, v44, v45
    v_mul_f32 v46, v46, v41
    v_mfma_f32_16x16x32_bf16 v[52:55], a[24:27], v[108:111], 0
    v_mul_f32 v47, v47, v41
    v_cvt_pk_f16_f32 v83, v46, v47
    v_mfma_f32_16x16x32_bf16 v[52:55], a[28:31], v[104:107], v[52:55]
    v_mul_f32 v4, v4, v41
    v_mul_f32 v5, v5, v41
    v_mfma_f32_16x16x32_bf16 v[52:55], a[32:35], v[88:91], v[52:55]
    v_cvt_pk_f16_f32 v84, v4, v5
    v_mul_f32 v6, v6, v41
    v_mfma_f32_16x16x32_bf16 v[52:55], a[36:39], v[100:103], v[52:55]
    v_mul_f32 v7, v7, v41
    v_cvt_pk_f16_f32 v85, v6, v7
    v_mfma_f32_16x16x32_bf16 v[52:55], a[40:43], v[68:71], v[52:55]
    v_mul_f32 v36, v36, v41
    v_mul_f32 v37, v37, v41
    v_mfma_f32_16x16x32_bf16 v[52:55], a[44:47], v[12:15], v[52:55]
    v_cvt_pk_f16_f32 v86, v36, v37
    v_mul_f32 v38, v38, v41
    v_mfma_f32_16x16x32_bf16 v[4:7], a[48:51], v[108:111], 0
    v_mul_f32 v39, v39, v41
    v_cvt_pk_f16_f32 v87, v38, v39
    v_mfma_f32_16x16x32_bf16 v[4:7], a[52:55], v[104:107], v[4:7]
    v_cvt_pk_bf16_f32 v32, v32, v33
    v_cvt_pk_bf16_f32 v33, v34, v35
    v_mfma_f32_16x16x32_bf16 v[4:7], a[56:59], v[88:91], v[4:7]
    v_fma_f32 v26, v64, v64, s41
    v_fmac_f32 v26, v65, v65
    v_mfma_f32_16x16x32_bf16 v[4:7], a[60:63], v[100:103], v[4:7]
    v_fmac_f32 v26, v66, v66
    v_fmac_f32 v26, v67, v67
    v_mfma_f32_16x16x32_bf16 v[4:7], a[64:67], v[68:71], v[4:7]
    v_fmac_f32 v26, v52, v52
    v_fmac_f32 v26, v53, v53
    v_mfma_f32_16x16x32_bf16 v[4:7], a[68:71], v[12:15], v[4:7]
    v_fmac_f32 v26, v54, v54
    v_fmac_f32 v26, v55, v55
    v_mfma_f32_16x16x32_bf16 v[48:51], a[72:75], v[108:111], 0
    s_nop 2
    v_mfma_f32_16x16x32_bf16 v[48:51], a[76:79], v[104:107], v[48:51]
    s_nop 0
    v_fmac_f32 v26, v4, v4
    v_fmac_f32 v26, v5, v5
    v_mfma_f32_16x16x32_bf16 v[48:51], a[80:83], v[88:91], v[48:51]
    v_fmac_f32 v26, v6, v6
    v_fmac_f32 v26, v7, v7
    v_mfma_f32_16x16x32_bf16 v[48:51], a[84:87], v[100:103], v[48:51]
    v_mfma_f32_16x16x32_bf16 v[48:51], a[88:91], v[68:71], v[48:51]
    v_mfma_f32_16x16x32_bf16 v[48:51], a[92:95], v[12:15], v[48:51]
    s_nop 1
    v_mfma_f32_16x16x32_bf16 v[0:3], a[96:99], v[108:111], 0
    s_nop 2
    v_mfma_f32_16x16x32_bf16 v[0:3], a[100:103], v[104:107], v[0:3]
    s_nop 0
    v_fma_f32 v27, v48, v48, s41
    v_fmac_f32 v27, v49, v49
    v_mfma_f32_16x16x32_bf16 v[0:3], a[104:107], v[88:91], v[0:3]
    v_fmac_f32 v27, v50, v50
    v_fmac_f32 v27, v51, v51
    v_mfma_f32_16x16x32_bf16 v[0:3], a[108:111], v[100:103], v[0:3]
    v_mfma_f32_16x16x32_bf16 v[0:3], a[112:115], v[68:71], v[0:3]
    v_mfma_f32_16x16x32_bf16 v[0:3], a[116:119], v[12:15], v[0:3]
    s_sub_u32 s50, s45, s44
    v_add_u32 v137, s48, v137
    v_add_u32 v136, s48, v136
    v_mfma_f32_16x16x32_bf16 v[44:47], a[120:123], v[108:111], 0
    s_sub_u32 s51, s46, s47
    v_add_u32 v135, s51, v135
    v_mfma_f32_16x16x32_bf16 v[44:47], a[124:127], v[104:107], v[44:47]
    s_mov_b32 s60, s59
    v_fmac_f32 v27, v0, v0
    v_fmac_f32 v27, v1, v1
    v_mfma_f32_16x16x32_bf16 v[44:47], a[128:131], v[88:91], v[44:47]
    s_mov_b32 s59, s58
    v_fmac_f32 v27, v2, v2
    v_fmac_f32 v27, v3, v3
    v_mfma_f32_16x16x32_bf16 v[44:47], a[132:135], v[100:103], v[44:47]
    s_mov_b32 s58, s57
    v_mfma_f32_16x16x32_bf16 v[44:47], a[136:139], v[68:71], v[44:47]
    s_mov_b32 s57, s56
    v_mfma_f32_16x16x32_bf16 v[44:47], a[140:143], v[12:15], v[44:47]
    s_mov_b32 s7, s6
    s_nop 0
    v_mfma_f32_16x16x32_bf16 v[8:11], v[108:111], a[144:147], 0
    s_mov_b32 s6, s5
    s_nop 1
    v_mfma_f32_16x16x32_bf16 v[8:11], v[104:107], a[148:151], v[8:11]
    s_mov_b32 s5, s4
    v_fmac_f32 v27, v44, v44
    v_fmac_f32 v27, v45, v45
    v_mfma_f32_16x16x32_bf16 v[8:11], v[88:91], a[152:155], v[8:11]
    s_sub_u32 s14, s6, s7
    v_fmac_f32 v27, v46, v46
    v_fmac_f32 v27, v47, v47
    v_mfma_f32_16x16x32_bf16 v[8:11], v[100:103], a[156:159], v[8:11]
    s_add_u32 s61, s61, 1
    v_cvt_pk_bf16_f32 v170, v26, v27
    v_add_u32 v134, s14, v134
    v_mfma_f32_16x16x32_bf16 v[8:11], v[68:71], a[160:163], v[8:11]
    s_ff1_i32_b32 s15, s66
    ds_read_b128 v[96:99], v139 offset:3072
    v_add_u32 v133, s14, v133
    v_mfma_f32_16x16x32_bf16 v[8:11], v[12:15], a[164:167], v[8:11]
    s_cmp_lg_u32 s66, 0
    ds_read_b128 v[92:95], v138 offset:3072
    v_add_u32 v125, s14, v125
    v_mfma_f32_16x16x16_bf16 v[20:23], v[216:217], v[170:171], 0
    s_cselect_b32 s12, s15, s12
    ds_read_b128 v[40:43], v139 offset:3200
    s_nop 1
    v_cvt_pk_bf16_f32 v26, v8, v9
    v_mfma_f32_16x16x32_bf16 v[72:75], v[108:111], a[168:171], 0
    s_cmp_lt_u32 s61, s71
    ds_read_b128 v[60:63], v138 offset:3200
    v_cvt_pk_bf16_f32 v27, v10, v11
    v_mfma_f32_16x16x32_bf16 v[72:75], v[104:107], a[172:175], v[72:75]
    s_cselect_b32 s15, 31, s15
    ds_read_b128 v[56:59], v139 offset:3328
    v_add_u32 v139, s50, v139
    v_mfma_f32_16x16x32_bf16 v[72:75], v[88:91], a[176:179], v[72:75]
    s_bitset0_b32 s66, s15
    ds_read_b128 v[36:39], v138 offset:3328
    v_add_u32 v138, s50, v138
    v_mfma_f32_16x16x32_bf16 v[72:75], v[100:103], a[180:183], v[72:75]
    s_add_u32 s12, s12, 20
    v_rsq_f32 v20, v20
    v_mfma_f32_16x16x32_bf16 v[72:75], v[68:71], a[184:187], v[72:75]
    s_max_u32 s12, s12, s61
    v_rsq_f32 v21, v21
    v_mfma_f32_16x16x32_bf16 v[72:75], v[12:15], a[188:191], v[72:75]
    s_cmp_lt_u32 s61, s71
    v_mul_f32 v20, s55, v20
    v_mul_f32 v21, 0.5, v21
    v_mfma_f32_16x16x32_bf16 v[8:11], v[108:111], a[192:195], 0
    s_cselect_b32 s15, s61, s12
    v_mul_f32 v64, v64, v20
    v_mul_f32 v65, v65, v20
    v_mfma_f32_16x16x32_bf16 v[8:11], v[104:107], a[196:199], v[8:11]
    s_cselect_b32 s56, s69, s70
    v_cvt_pk_bf16_f32 v30, v72, v73
    v_cvt_pk_bf16_f32 v31, v74, v75
    v_mfma_f32_16x16x32_bf16 v[8:11], v[88:91], a[200:203], v[8:11]
    s_add_u32 s56, s56, s15
    v_cvt_pk_f16_f32 v88, v64, v65
    v_mul_f32 v66, v66, v20
    v_mfma_f32_16x16x32_bf16 v[8:11], v[100:103], a[204:207], v[8:11]
    s_mul_i32 s53, s56, 58255
    v_mul_f32 v67, v67, v20
    v_cvt_pk_f16_f32 v89, v66, v67
    v_mfma_f32_16x16x32_bf16 v[8:11], v[68:71], a[208:211], v[8:11]
    s_waitcnt lgkmcnt(0)
    s_lshr_b32 s53, s53, 22
    v_mul_f32 v52, v52, v20
    v_mul_f32 v53, v53, v20
    v_mfma_f32_16x16x32_bf16 v[8:11], v[12:15], a[212:215], v[8:11]
    s_barrier
    v_cvt_pk_f16_f32 v90, v52, v53
    v_mul_f32 v54, v54, v20
    v_mfma_f32_16x16x32_bf16 v[12:15], a[0:3], v[96:99], 0
    s_mul_i32 s53, s53, s63
    v_mul_f32 v55, v55, v20
    v_cvt_pk_f16_f32 v91, v54, v55
    v_mfma_f32_16x16x32_bf16 v[12:15], a[4:7], v[92:95], v[12:15]
    s_mul_i32 s56, s56, s62
    v_mul_f32 v4, v4, v20
    v_mul_f32 v5, v5, v20
    v_mfma_f32_16x16x32_bf16 v[12:15], a[8:11], v[40:43], v[12:15]
    s_add_u32 s56, s56, s53
    v_cvt_pk_f16_f32 v150, v4, v5
    v_mul_f32 v6, v6, v20
    v_mfma_f32_16x16x32_bf16 v[12:15], a[12:15], v[60:63], v[12:15]
    s_mul_i32 s4, s15, 336
    v_mul_f32 v7, v7, v20
    v_cvt_pk_f16_f32 v151, v6, v7
    v_mfma_f32_16x16x32_bf16 v[12:15], a[16:19], v[56:59], v[12:15]
    s_cmp_ge_u32 s15, 16
    v_mul_f32 v48, v48, v21
    v_mul_f32 v49, v49, v21
    v_mfma_f32_16x16x32_bf16 v[12:15], a[20:23], v[36:39], v[12:15]
    s_cselect_b32 s53, -26880, 0
    v_cvt_pk_f16_f32 v76, v48, v49
    v_mul_f32 v50, v50, v21
    v_mfma_f32_16x16x32_bf16 v[4:7], a[24:27], v[96:99], 0
    s_add_u32 s4, s4, s53
    v_mul_f32 v51, v51, v21
    v_cvt_pk_f16_f32 v77, v50, v51
    v_mfma_f32_16x16x32_bf16 v[4:7], a[28:31], v[92:95], v[4:7]
    s_cmp_lt_u32 s15, s73
    v_mul_f32 v0, v0, v21
    v_mul_f32 v1, v1, v21
    v_mfma_f32_16x16x32_bf16 v[4:7], a[32:35], v[40:43], v[4:7]
    s_cselect_b32 s26, 100270464, 0
    v_cvt_pk_f16_f32 v78, v0, v1
    v_mul_f32 v2, v2, v21
    v_mfma_f32_16x16x32_bf16 v[4:7], a[36:39], v[60:63], v[4:7]
    s_cselect_b32 s56, s56, 0
    v_mul_f32 v3, v3, v21
    v_cvt_pk_f16_f32 v79, v2, v3
    v_mfma_f32_16x16x32_bf16 v[4:7], a[40:43], v[56:59], v[4:7]
    s_cselect_b32 s4, s4, -1
    v_mul_f32 v44, v44, v21
    v_mul_f32 v45, v45, v21
    v_mfma_f32_16x16x32_bf16 v[4:7], a[44:47], v[36:39], v[4:7]
    s_cselect_b32 s15, s15, 0
    v_cvt_pk_f16_f32 v80, v44, v45
    v_mul_f32 v46, v46, v21
    v_mfma_f32_16x16x32_bf16 v[0:3], a[48:51], v[96:99], 0
    s_cselect_b32 s13, s13, -1
    v_mul_f32 v47, v47, v21
    v_cvt_pk_f16_f32 v81, v46, v47
    v_mfma_f32_16x16x32_bf16 v[0:3], a[52:55], v[92:95], v[0:3]
    s_bitset1_b32 s64, s15
    v_cvt_pk_bf16_f32 v34, v8, v9
    v_cvt_pk_bf16_f32 v35, v10, v11
    v_mfma_f32_16x16x32_bf16 v[0:3], a[56:59], v[40:43], v[0:3]
    s_add_u32 s65, s65, 1
    v_fma_f32 v143, v12, v12, s41
    v_fmac_f32 v143, v13, v13
    v_mfma_f32_16x16x32_bf16 v[0:3], a[60:63], v[60:63], v[0:3]
    s_cmp_ge_i32 s65, 2
    v_fmac_f32 v143, v14, v14
    v_fmac_f32 v143, v15, v15
    v_mfma_f32_16x16x32_bf16 v[0:3], a[64:67], v[56:59], v[0:3]
    s_cselect_b32 s30, 100270464, 0
    v_fmac_f32 v143, v4, v4
    v_fmac_f32 v143, v5, v5
    v_mfma_f32_16x16x32_bf16 v[0:3], a[68:71], v[36:39], v[0:3]
    s_add_u32 s67, s46, s54
    v_fmac_f32 v143, v6, v6
    v_fmac_f32 v143, v7, v7
    v_mfma_f32_16x16x32_bf16 v[52:55], a[72:75], v[96:99], 0
    s_add_u32 m0, s67, 0
    s_nop 0
    buffer_load_dwordx4 v130, s[24:27], s56 offen nt lds
    v_mfma_f32_16x16x32_bf16 v[52:55], a[76:79], v[92:95], v[52:55]
    s_add_u32 m0, s67, 1024
    v_fmac_f32 v143, v0, v0
    v_fmac_f32 v143, v1, v1
    v_mfma_f32_16x16x32_bf16 v[52:55], a[80:83], v[40:43], v[52:55]
    v_fmac_f32 v143, v2, v2
    v_fmac_f32 v143, v3, v3
    v_mfma_f32_16x16x32_bf16 v[52:55], a[84:87], v[60:63], v[52:55]
    buffer_load_dwordx4 v129, s[24:27], s56 offen nt lds
    v_mfma_f32_16x16x32_bf16 v[52:55], a[88:91], v[56:59], v[52:55]
    s_add_u32 m0, s67, 2048
    v_mfma_f32_16x16x32_bf16 v[52:55], a[92:95], v[36:39], v[52:55]
    buffer_load_dwordx4 v128, s[24:27], s56 offen nt lds
    s_nop 0
    v_mfma_f32_16x16x32_bf16 v[8:11], a[96:99], v[96:99], 0
    s_nop 2
    v_mfma_f32_16x16x32_bf16 v[8:11], a[100:103], v[92:95], v[8:11]
    s_nop 0
    v_fma_f32 v142, v52, v52, s41
    v_fmac_f32 v142, v53, v53
    v_mfma_f32_16x16x32_bf16 v[8:11], a[104:107], v[40:43], v[8:11]
    v_fmac_f32 v142, v54, v54
    v_fmac_f32 v142, v55, v55
    v_mfma_f32_16x16x32_bf16 v[8:11], a[108:111], v[60:63], v[8:11]
    v_mfma_f32_16x16x32_bf16 v[8:11], a[112:115], v[56:59], v[8:11]
    s_add_u32 m0, s67, 3072
    s_nop 0
    buffer_load_dwordx4 v127, s[24:27], s56 offen nt lds
    v_mfma_f32_16x16x32_bf16 v[8:11], a[116:119], v[36:39], v[8:11]
    s_add_u32 m0, s67, 4096
    s_nop 0
    v_mfma_f32_16x16x32_bf16 v[44:47], a[120:123], v[96:99], 0
    s_nop 1
    buffer_load_dwordx4 v126, s[24:27], s56 offen nt lds
    v_mfma_f32_16x16x32_bf16 v[44:47], a[124:127], v[92:95], v[44:47]
    s_nop 0
    v_fmac_f32 v142, v8, v8
    v_fmac_f32 v142, v9, v9
    v_mfma_f32_16x16x32_bf16 v[44:47], a[128:131], v[40:43], v[44:47]
    v_fmac_f32 v142, v10, v10
    v_fmac_f32 v142, v11, v11
    v_mfma_f32_16x16x32_bf16 v[44:47], a[132:135], v[60:63], v[44:47]
    v_mfma_f32_16x16x32_bf16 v[44:47], a[136:139], v[56:59], v[44:47]
    v_mfma_f32_16x16x32_bf16 v[44:47], a[140:143], v[36:39], v[44:47]
    s_nop 1
    v_mfma_f32_16x16x32_bf16 v[20:23], v[96:99], a[144:147], 0
    s_mov_b32 s53, s47
    s_nop 1
    v_mfma_f32_16x16x32_bf16 v[20:23], v[92:95], a[148:151], v[20:23]
    s_mov_b32 s47, s46
    v_fmac_f32 v142, v44, v44
    v_fmac_f32 v142, v45, v45
    v_mfma_f32_16x16x32_bf16 v[20:23], v[40:43], a[152:155], v[20:23]
    s_mov_b32 s46, s45
    v_fmac_f32 v142, v46, v46
    v_fmac_f32 v142, v47, v47
    v_mfma_f32_16x16x32_bf16 v[20:23], v[60:63], a[156:159], v[20:23]
    s_mov_b32 s45, s44
    v_cvt_pk_bf16_f32 v170, v143, v142
    v_mfma_f32_16x16x32_bf16 v[20:23], v[56:59], a[160:163], v[20:23]
    s_mov_b32 s44, s53
    ds_read_b128 v[64:67], v134 offset:32
    v_mfma_f32_16x16x32_bf16 v[20:23], v[36:39], a[164:167], v[20:23]
    s_sub_u32 s48, s44, s46
    ds_read_b64 v[68:69], v134 offset:48
    v_add_u32 v139, s48, v139
    v_mfma_f32_16x16x16_bf16 v[48:51], v[216:217], v[170:171], 0
    s_sub_u32 s49, s46, s45
    v_add_u32 v138, s48, v138
    s_nop 1
    v_cvt_pk_bf16_f32 v164, v20, v21
    v_mfma_f32_16x16x32_bf16 v[72:75], v[96:99], a[168:171], 0
    v_cvt_pk_bf16_f32 v165, v22, v23
    v_mfma_f32_16x16x32_bf16 v[72:75], v[92:95], a[172:175], v[72:75]
    v_rsq_f32 v48, v48
    v_mfma_f32_16x16x32_bf16 v[72:75], v[40:43], a[176:179], v[72:75]
    v_rsq_f32 v49, v49
    v_mfma_f32_16x16x32_bf16 v[72:75], v[60:63], a[180:183], v[72:75]
    v_mul_f32 v48, s55, v48
    v_mul_f32 v49, 0.5, v49
    v_mfma_f32_16x16x32_bf16 v[72:75], v[56:59], a[184:187], v[72:75]
    v_mul_f32 v52, v52, v49
    v_mul_f32 v53, v53, v49
    v_mfma_f32_16x16x32_bf16 v[72:75], v[36:39], a[188:191], v[72:75]
    ds_read_u16 v166, v133 offset:56
    v_cvt_pk_f16_f32 v70, v52, v53
    v_mfma_f32_16x16x32_bf16 v[20:23], v[96:99], a[192:195], 0
    ds_read_u16 v162, v133 offset:64
    v_mul_f32 v54, v54, v49
    v_mfma_f32_16x16x32_bf16 v[20:23], v[92:95], a[196:199], v[20:23]
    s_nop 0
    ds_read_u16 v158, v133 offset:72
    v_cvt_pk_bf16_f32 v160, v72, v73
    v_mfma_f32_16x16x32_bf16 v[20:23], v[40:43], a[200:203], v[20:23]
    ds_read_b128 v[40:43], v134 offset:0
    v_cvt_pk_bf16_f32 v161, v74, v75
    v_mfma_f32_16x16x32_bf16 v[20:23], v[60:63], a[204:207], v[20:23]
    ds_read_b64 v[142:143], v134 offset:16
    v_mul_f32 v55, v55, v49
    v_mfma_f32_16x16x32_bf16 v[20:23], v[56:59], a[208:211], v[20:23]
    v_cvt_pk_f16_f32 v71, v54, v55
    v_mul_f32 v8, v8, v49
    v_mfma_f32_16x16x32_bf16 v[20:23], v[36:39], a[212:215], v[20:23]
    v_mul_f32 v9, v9, v49
    v_cvt_pk_f16_f32 v72, v8, v9
    v_mfma_f32_16x16x32_f16 v[36:39], v[82:85], v[16:19], v[204:207]
    v_mul_f32 v10, v10, v49
    v_mul_f32 v11, v11, v49
    v_mfma_f32_16x16x32_f16 v[36:39], v[84:87], v[152:155], v[36:39]
    v_cvt_pk_f16_f32 v73, v10, v11
    v_mul_f32 v44, v44, v49
    v_mfma_f32_16x16x32_f16 v[60:63], v[76:79], v[16:19], v[200:203]
    v_mul_f32 v45, v45, v49
    v_cvt_pk_f16_f32 v74, v44, v45
    v_mfma_f32_16x16x32_f16 v[60:63], v[78:81], v[152:155], v[60:63]
    s_waitcnt lgkmcnt(3)
    v_mul_f32 v46, v46, v49
    v_mul_f32 v47, v47, v49
    v_mfma_f32_16x16x32_f16 v[8:11], v[64:67], v[16:19], v[208:211]
    v_cvt_pk_f16_f32 v75, v46, v47
    v_mul_f32 v12, v12, v48
    v_mfma_f32_16x16x32_f16 v[8:11], v[66:69], v[152:155], v[8:11]
    v_mul_f32 v13, v13, v48
    v_cvt_pk_f16_f32 v44, v12, v13
    v_mfma_f32_16x16x32_f16 v[56:59], v[70:73], v[16:19], v[196:199]
    v_mul_f32 v14, v14, v48
    v_mul_f32 v15, v15, v48
    v_mfma_f32_16x16x32_f16 v[56:59], v[72:75], v[152:155], v[56:59]
    s_waitcnt lgkmcnt(0)
    v_cvt_pk_f16_f32 v45, v14, v15
    v_mul_f32 v4, v4, v48
    v_mfma_f32_16x16x32_f16 v[16:19], v[40:43], v[82:85], v[208:211]
    v_mul_f32 v5, v5, v48
    v_cvt_pk_f16_f32 v46, v4, v5
    v_mfma_f32_16x16x32_f16 v[16:19], v[140:143], v[84:87], v[16:19]
    v_mul_f32 v6, v6, v48
    v_mul_f32 v7, v7, v48
    v_mfma_f32_16x16x32_f16 v[12:15], v[40:43], v[76:79], v[208:211]
    v_cvt_pk_f16_f32 v47, v6, v7
    v_mul_f32 v0, v0, v48
    v_mfma_f32_16x16x32_f16 v[12:15], v[140:143], v[78:81], v[12:15]
    v_mul_f32 v1, v1, v48
    v_cvt_pk_f16_f32 v146, v0, v1
    v_mfma_f32_16x16x32_f16 v[4:7], v[40:43], v[70:73], v[208:211]
    v_mul_f32 v2, v2, v48
    v_mul_f32 v3, v3, v48
    v_mfma_f32_16x16x32_f16 v[4:7], v[140:143], v[72:75], v[4:7]
    v_cvt_pk_f16_f32 v147, v2, v3
    v_cvt_pk_bf16_f32 v156, v20, v21
    v_mfma_f32_16x16x32_f16 v[0:3], v[40:43], v[64:67], v[208:211]
    v_cvt_pk_bf16_f32 v157, v22, v23
    v_max3_f32 v154, v36, v37, v38
    v_mfma_f32_16x16x32_f16 v[0:3], v[140:143], v[66:69], v[0:3]
    v_max3_f32 v154, v154, v39, v60
    v_max3_f32 v154, v154, v61, v62
    v_mfma_f32_16x16x32_f16 v[40:43], v[82:85], v[88:91], v[192:195]
    v_max3_f32 v154, v154, v63, v56
    v_max3_f32 v154, v154, v57, v58
    v_mfma_f32_16x16x32_f16 v[40:43], v[84:87], v[148:151], v[40:43]
    v_max3_f32 v154, v154, v59, v8
    v_mov_b32 v155, v154
    v_mfma_f32_16x16x32_f16 v[52:55], v[76:79], v[88:91], v[188:191]
    s_nop 0
    v_permlane32_swap_b32 v155, v154
    v_mfma_f32_16x16x32_f16 v[52:55], v[78:81], v[148:151], v[52:55]
    v_max_f32 v154, v155, v154
    v_mov_b32 v155, v154
    v_mfma_f32_16x16x32_f16 v[48:51], v[70:73], v[88:91], v[184:187]
    s_nop 0
    v_permlane16_swap_b32 v155, v154
    v_mfma_f32_16x16x32_f16 v[48:51], v[72:75], v[148:151], v[48:51]
    v_max_f32 v154, v155, v154
    v_sub_f32 v36, v36, v154
    v_mfma_f32_16x16x32_f16 v[20:23], v[64:67], v[88:91], v[208:211]
    v_sub_f32 v37, v37, v154
    v_sub_f32 v38, v38, v154
    v_mfma_f32_16x16x32_f16 v[20:23], v[66:69], v[148:151], v[20:23]
    v_sub_f32 v39, v39, v154
    v_sub_f32 v60, v60, v154
    v_sub_f32 v61, v61, v154
    v_sub_f32 v62, v62, v154
    v_sub_f32 v63, v63, v154
    v_sub_f32 v56, v56, v154
    v_sub_f32 v57, v57, v154
    v_sub_f32 v58, v58, v154
    v_sub_f32 v59, v59, v154
    v_sub_f32 v8, v8, v154
    v_exp_f32 v36, v36
    v_exp_f32 v37, v37
    v_exp_f32 v38, v38
    v_exp_f32 v39, v39
    v_cvt_pk_bf16_f32 v36, v36, v37
    v_cvt_pk_bf16_f32 v37, v38, v39
    v_exp_f32 v60, v60
    v_exp_f32 v61, v61
    v_exp_f32 v62, v62
    v_exp_f32 v63, v63
    v_cvt_pk_bf16_f32 v38, v60, v61
    v_cvt_pk_bf16_f32 v39, v62, v63
    v_exp_f32 v56, v56
    v_exp_f32 v57, v57
    v_exp_f32 v58, v58
    v_exp_f32 v59, v59
    v_cvt_pk_bf16_f32 v168, v56, v57
    v_cvt_pk_bf16_f32 v169, v58, v59
    v_exp_f32 v8, v8
    v_mov_b32_dpp v19, v15 quad_perm:[0,1,2,3] row_mask:0x2 bank_mask:0xf
    v_cvt_pk_bf16_f32 v170, v8, 0
    v_mfma_f32_16x16x32_bf16 v[8:11], v[220:223], v[36:39], 0
    v_mov_b32_dpp v19, v7 quad_perm:[0,1,2,3] row_mask:0x4 bank_mask:0xf
    v_max3_f32 v142, v40, v41, v42
    v_mfma_f32_16x16x32_bf16 v[8:11], v[220:223], v[168:171], v[8:11]
    v_mov_b32_dpp v19, v3 quad_perm:[0,1,2,3] row_mask:0x8 bank_mask:0xf
    v_mov_b32 v150, v19
    v_mfma_f32_16x16x32_bf16 v[4:7], v[24:27], v[36:39], 0
    s_nop 0
    v_max_f32_dpp v150, v150, v150 row_ror:8 row_mask:0xf bank_mask:0xf
    v_max3_f32 v142, v142, v43, v52
    v_mfma_f32_16x16x32_bf16 v[4:7], v[164:167], v[168:171], v[4:7]
    v_max_f32_dpp v150, v150, v150 row_ror:4 row_mask:0xf bank_mask:0xf
    v_max3_f32 v142, v142, v53, v54
    v_mfma_f32_16x16x32_bf16 v[12:15], v[28:31], v[36:39], 0
    v_max_f32_dpp v150, v150, v150 row_ror:2 row_mask:0xf bank_mask:0xf
    v_max3_f32 v142, v142, v55, v48
    v_mfma_f32_16x16x32_bf16 v[12:15], v[160:163], v[168:171], v[12:15]
    v_max_f32_dpp v150, v150, v150 row_ror:1 row_mask:0xf bank_mask:0xf
    v_mov_b32 v143, v150
    v_mfma_f32_16x16x32_bf16 v[0:3], v[32:35], v[36:39], 0
    s_nop 0
    v_permlane32_swap_b32 v143, v150
    v_mfma_f32_16x16x32_bf16 v[0:3], v[156:159], v[168:171], v[0:3]
    v_max_f32 v150, v143, v150
    v_mov_b32 v143, v150
    v_rcp_f32 v8, v8
    v_max3_f32 v142, v142, v49, v50
    v_permlane16_swap_b32 v143, v150
    v_max_f32 v150, v143, v150
    v_sub_f32 v19, v19, v150
    v_exp_f32 v19, v19
    v_mul_f32 v4, v4, v8
    v_cvt_pk_bf16_f32 v19, v19, v19
    ds_write_b16 v125, v19
    v_mul_f32 v5, v5, v8
    v_cvt_pk_bf16_f32 v4, v4, v5
    ds_read_b128 v[60:63], v134
    v_mul_f32 v6, v6, v8
    v_mul_f32 v7, v7, v8
    v_cvt_pk_bf16_f32 v5, v6, v7
    ds_read_b128 v[56:59], v134 offset:16
    v_mfma_f32_16x16x32_f16 v[16:19], v[82:85], v[44:47], v[180:183]
    v_mul_f32 v12, v12, v8
    v_mul_f32 v13, v13, v8
    v_mfma_f32_16x16x32_f16 v[16:19], v[84:87], v[144:147], v[16:19]
    ds_write_b64 v137, v[4:5] offset:0
    v_mfma_f32_16x16x32_f16 v[36:39], v[76:79], v[44:47], v[176:179]
    v_cvt_pk_bf16_f32 v6, v12, v13
    v_mul_f32 v14, v14, v8
    v_mfma_f32_16x16x32_f16 v[36:39], v[78:81], v[144:147], v[36:39]
    v_mul_f32 v15, v15, v8
    v_cvt_pk_bf16_f32 v7, v14, v15
    v_mfma_f32_16x16x32_f16 v[12:15], v[70:73], v[44:47], v[172:175]
    ds_write_b64 v137, v[6:7] offset:8
    v_mfma_f32_16x16x32_f16 v[12:15], v[72:75], v[144:147], v[12:15]
    v_mul_f32 v0, v0, v8
    v_mul_f32 v1, v1, v8
    v_mfma_f32_16x16x32_f16 v[4:7], v[64:67], v[44:47], v[208:211]
    v_cvt_pk_bf16_f32 v150, v0, v1
    v_mul_f32 v2, v2, v8
    v_mfma_f32_16x16x32_f16 v[4:7], v[66:69], v[144:147], v[4:7]
    s_waitcnt lgkmcnt(2)
    v_mul_f32 v3, v3, v8
    v_cvt_pk_bf16_f32 v151, v2, v3
    v_mfma_f32_16x16x32_bf16 v[0:3], v[60:63], v[24:27], 0
    ds_write_b64 v136, v[150:151] offset:0
    v_mfma_f32_16x16x32_bf16 v[0:3], v[56:59], v[164:167], v[0:3]
    v_max3_f32 v142, v142, v51, v21
    v_mov_b32 v143, v142
    v_mfma_f32_16x16x32_bf16 v[44:47], v[60:63], v[28:31], 0
    s_nop 0
    v_permlane32_swap_b32 v143, v142
    v_mfma_f32_16x16x32_bf16 v[44:47], v[56:59], v[160:163], v[44:47]
    v_max_f32 v142, v143, v142
    v_mov_b32 v143, v142
    v_mfma_f32_16x16x32_bf16 v[8:11], v[60:63], v[32:35], 0
    s_nop 0
    v_permlane16_swap_b32 v143, v142
    v_mfma_f32_16x16x32_bf16 v[8:11], v[56:59], v[156:159], v[8:11]
    v_max_f32 v142, v143, v142
    v_sub_f32 v40, v40, v142
    v_sub_f32 v41, v41, v142
    v_sub_f32 v42, v42, v142
    v_sub_f32 v43, v43, v142
    v_sub_f32 v52, v52, v142
    v_sub_f32 v53, v53, v142
    v_sub_f32 v54, v54, v142
    v_sub_f32 v55, v55, v142
    v_sub_f32 v48, v48, v142
    v_sub_f32 v49, v49, v142
    v_sub_f32 v50, v50, v142
    v_sub_f32 v51, v51, v142
    v_sub_f32 v21, v21, v142
    v_exp_f32 v40, v40
    v_exp_f32 v41, v41
    v_exp_f32 v42, v42
    v_exp_f32 v43, v43
    v_cvt_pk_bf16_f32 v40, v40, v41
    v_cvt_pk_bf16_f32 v41, v42, v43
    v_exp_f32 v52, v52
    v_exp_f32 v53, v53
    v_exp_f32 v54, v54
    v_exp_f32 v55, v55
    v_cvt_pk_bf16_f32 v42, v52, v53
    v_cvt_pk_bf16_f32 v43, v54, v55
    v_exp_f32 v48, v48
    v_exp_f32 v49, v49
    v_exp_f32 v50, v50
    v_exp_f32 v51, v51
    v_cvt_pk_bf16_f32 v168, v48, v49
    v_cvt_pk_bf16_f32 v169, v50, v51
    v_exp_f32 v21, v21
    v_mov_b32_dpp v3, v47 quad_perm:[0,1,2,3] row_mask:0x2 bank_mask:0xf
    v_cvt_pk_bf16_f32 v170, v21, 0
    v_mfma_f32_16x16x32_bf16 v[44:47], v[220:223], v[40:43], 0
    v_mov_b32_dpp v3, v11 quad_perm:[0,1,2,3] row_mask:0x4 bank_mask:0xf
    v_cvt_pk_bf16_f32 v3, v3, v3
    v_mfma_f32_16x16x32_bf16 v[44:47], v[220:223], v[168:171], v[44:47]
    ds_write_b16 v133, v3 offset:56
    v_mfma_f32_16x16x32_bf16 v[20:23], v[24:27], v[40:43], 0
    ds_read_b128 v[8:11], v139 offset:0
    v_max3_f32 v142, v16, v17, v18
    v_mfma_f32_16x16x32_bf16 v[20:23], v[164:167], v[168:171], v[20:23]
    ds_read_b128 v[60:63], v138 offset:0
    v_max3_f32 v142, v142, v19, v36
    v_mfma_f32_16x16x32_bf16 v[52:55], v[28:31], v[40:43], 0
    ds_read_b128 v[0:3], v139 offset:128
    v_max3_f32 v142, v142, v37, v38
    v_mfma_f32_16x16x32_bf16 v[52:55], v[160:163], v[168:171], v[52:55]
    ds_read_b128 v[72:75], v138 offset:128
    v_max3_f32 v142, v142, v39, v12
    v_mfma_f32_16x16x32_bf16 v[48:51], v[32:35], v[40:43], 0
    ds_read_b128 v[76:79], v139 offset:256
    v_max3_f32 v142, v142, v13, v14
    v_mfma_f32_16x16x32_bf16 v[48:51], v[156:159], v[168:171], v[48:51]
    ds_read_b128 v[64:67], v138 offset:256
    v_max3_f32 v142, v142, v15, v6
    v_rcp_f32 v44, v44
    v_mov_b32 v143, v142
    v_mul_f32 v20, v20, v44
    v_mul_f32 v21, v21, v44
    v_cvt_pk_bf16_f32 v40, v20, v21
    v_mul_f32 v22, v22, v44
    v_mul_f32 v23, v23, v44
    v_cvt_pk_bf16_f32 v41, v22, v23
    v_mul_f32 v52, v52, v44
    v_mul_f32 v53, v53, v44
    v_cvt_pk_bf16_f32 v42, v52, v53
    v_mul_f32 v54, v54, v44
    s_waitcnt lgkmcnt(5)
    v_mfma_f32_16x16x32_bf16 v[20:23], a[0:3], v[8:11], 0
    ds_write_b64 v137, v[40:41] offset:1536
    v_mul_f32 v55, v55, v44
    v_cvt_pk_bf16_f32 v43, v54, v55
    v_mul_f32 v48, v48, v44
    v_mul_f32 v49, v49, v44
    v_cvt_pk_bf16_f32 v146, v48, v49
    v_mul_f32 v50, v50, v44
    v_mul_f32 v51, v51, v44
    v_cvt_pk_bf16_f32 v147, v50, v51
    ds_write_b64 v137, v[42:43] offset:1544
    v_permlane32_swap_b32 v143, v142
    v_max_f32 v142, v143, v142
    v_mov_b32 v143, v142
    s_nop 0
    ds_write_b64 v136, v[146:147] offset:1536
    v_permlane16_swap_b32 v143, v142
    v_max_f32 v142, v143, v142
    v_sub_f32 v16, v16, v142
    v_sub_f32 v17, v17, v142
    v_sub_f32 v18, v18, v142
    v_sub_f32 v19, v19, v142
    v_sub_f32 v36, v36, v142
    v_sub_f32 v37, v37, v142
    v_sub_f32 v38, v38, v142
    v_sub_f32 v39, v39, v142
    v_sub_f32 v12, v12, v142
    v_sub_f32 v13, v13, v142
    v_sub_f32 v14, v14, v142
    v_sub_f32 v15, v15, v142
    v_sub_f32 v6, v6, v142
    v_exp_f32 v16, v16
    v_exp_f32 v17, v17
    v_exp_f32 v18, v18
    v_exp_f32 v19, v19
    v_cvt_pk_bf16_f32 v16, v16, v17
    v_cvt_pk_bf16_f32 v17, v18, v19
    v_exp_f32 v36, v36
    v_exp_f32 v37, v37
    v_exp_f32 v38, v38
    v_exp_f32 v39, v39
    v_cvt_pk_bf16_f32 v18, v36, v37
    v_cvt_pk_bf16_f32 v19, v38, v39
    v_exp_f32 v12, v12
    v_exp_f32 v13, v13
    v_exp_f32 v14, v14
    v_exp_f32 v15, v15
    v_cvt_pk_bf16_f32 v168, v12, v13
    v_cvt_pk_bf16_f32 v169, v14, v15
    v_exp_f32 v6, v6
    s_nop 0
    v_cvt_pk_bf16_f32 v170, v6, 0
    v_mfma_f32_16x16x32_bf16 v[4:7], v[220:223], v[16:19], 0
    s_nop 0
    v_mfma_f32_16x16x32_bf16 v[4:7], v[220:223], v[168:171], v[4:7]
    s_nop 1
    v_mfma_f32_16x16x32_bf16 v[12:15], v[24:27], v[16:19], 0
    s_nop 2
    v_mfma_f32_16x16x32_bf16 v[12:15], v[164:167], v[168:171], v[12:15]
    s_nop 0
    v_rcp_f32 v4, v4
    v_mfma_f32_16x16x32_bf16 v[24:27], v[28:31], v[16:19], 0
    s_nop 2
    v_mfma_f32_16x16x32_bf16 v[24:27], v[160:163], v[168:171], v[24:27]
    s_nop 0
    v_mul_f32 v12, v12, v4
    v_mul_f32 v13, v13, v4
    v_mfma_f32_16x16x32_bf16 v[28:31], v[32:35], v[16:19], 0
    v_cvt_pk_bf16_f32 v44, v12, v13
    v_mul_f32 v14, v14, v4
    v_mfma_f32_16x16x32_bf16 v[28:31], v[156:159], v[168:171], v[28:31]
    v_mul_f32 v15, v15, v4
    v_cvt_pk_bf16_f32 v45, v14, v15
    s_waitcnt lgkmcnt(0)
.p2align 6
L_loopS0:
    v_mfma_f32_16x16x32_bf16 v[20:23], a[4:7], v[60:63], v[20:23]
    ds_write_b64 v137, v[44:45] offset:3072
    v_mfma_f32_16x16x32_bf16 v[20:23], a[8:11], v[0:3], v[20:23]
    v_mul_f32 v24, v24, v4
    v_mul_f32 v25, v25, v4
    v_mfma_f32_16x16x32_bf16 v[20:23], a[12:15], v[72:75], v[20:23]
    v_cvt_pk_bf16_f32 v46, v24, v25
    v_mul_f32 v26, v26, v4
    v_mfma_f32_16x16x32_bf16 v[20:23], a[16:19], v[76:79], v[20:23]
    v_mul_f32 v27, v27, v4
    v_cvt_pk_bf16_f32 v47, v26, v27
    v_mfma_f32_16x16x32_bf16 v[20:23], a[20:23], v[64:67], v[20:23]
    ds_write_b64 v137, v[46:47] offset:3080
    v_mfma_f32_16x16x32_bf16 v[44:47], a[24:27], v[8:11], 0
    v_mul_f32 v28, v28, v4
    v_mul_f32 v29, v29, v4
    v_mfma_f32_16x16x32_bf16 v[44:47], a[28:31], v[60:63], v[44:47]
    v_cvt_pk_bf16_f32 v28, v28, v29
    v_mul_f32 v30, v30, v4
    v_mfma_f32_16x16x32_bf16 v[44:47], a[32:35], v[0:3], v[44:47]
    v_mul_f32 v31, v31, v4
    v_cvt_pk_bf16_f32 v29, v30, v31
    v_mfma_f32_16x16x32_bf16 v[44:47], a[36:39], v[72:75], v[44:47]
    ds_write_b64 v136, v[28:29] offset:3072
    v_mfma_f32_16x16x32_bf16 v[44:47], a[40:43], v[76:79], v[44:47]
    v_fmac_f32 v155, v52, v52
    v_fmac_f32 v155, v53, v53
    v_mfma_f32_16x16x32_bf16 v[44:47], a[44:47], v[64:67], v[44:47]
    v_fmac_f32 v155, v54, v54
    v_fmac_f32 v155, v55, v55
    v_mfma_f32_16x16x32_bf16 v[4:7], a[48:51], v[8:11], 0
    v_fma_f32 v170, v12, v12, s42
    v_fmac_f32 v170, v13, v13
    v_mfma_f32_16x16x32_bf16 v[4:7], a[52:55], v[60:63], v[4:7]
    v_fmac_f32 v170, v14, v14
    v_fmac_f32 v170, v15, v15
    v_mfma_f32_16x16x32_bf16 v[4:7], a[56:59], v[0:3], v[4:7]
    v_fmac_f32 v170, v16, v16
    v_fmac_f32 v170, v17, v17
    v_mfma_f32_16x16x32_bf16 v[4:7], a[60:63], v[72:75], v[4:7]
    v_fmac_f32 v170, v18, v18
    v_fmac_f32 v170, v19, v19
    v_mfma_f32_16x16x32_bf16 v[4:7], a[64:67], v[76:79], v[4:7]
    s_waitcnt vmcnt(10)
    v_fmac_f32 v170, v56, v56
    v_fmac_f32 v170, v57, v57
    v_mfma_f32_16x16x32_bf16 v[4:7], a[68:71], v[64:67], v[4:7]
    v_fmac_f32 v170, v58, v58
    v_fmac_f32 v170, v59, v59
    v_mfma_f32_16x16x32_bf16 v[88:91], a[72:75], v[8:11], 0
    v_cvt_pk_bf16_f32 v154, v154, v155
    v_cvt_pk_bf16_f32 v155, v170, v124
    v_mfma_f32_16x16x32_bf16 v[88:91], a[76:79], v[60:63], v[88:91]
    ds_write_b64 v132, v[154:155]
    v_mfma_f32_16x16x32_bf16 v[88:91], a[80:83], v[0:3], v[88:91]
    v_add_u32 v137, s49, v137
    v_add_u32 v136, s49, v136
    v_mfma_f32_16x16x32_bf16 v[88:91], a[84:87], v[72:75], v[88:91]
    v_fma_f32 v154, v20, v20, s41
    v_fmac_f32 v154, v21, v21
    v_mfma_f32_16x16x32_bf16 v[88:91], a[88:91], v[76:79], v[88:91]
    v_fmac_f32 v154, v22, v22
    v_fmac_f32 v154, v23, v23
    v_mfma_f32_16x16x32_bf16 v[88:91], a[92:95], v[64:67], v[88:91]
    v_fmac_f32 v154, v44, v44
    v_fmac_f32 v154, v45, v45
    v_mfma_f32_16x16x32_bf16 v[104:107], a[96:99], v[8:11], 0
    v_fmac_f32 v154, v46, v46
    v_fmac_f32 v154, v47, v47
    v_mfma_f32_16x16x32_bf16 v[104:107], a[100:103], v[60:63], v[104:107]
    v_fmac_f32 v154, v4, v4
    v_fmac_f32 v154, v5, v5
    v_mfma_f32_16x16x32_bf16 v[104:107], a[104:107], v[0:3], v[104:107]
    v_fmac_f32 v154, v6, v6
    v_fmac_f32 v154, v7, v7
    v_mfma_f32_16x16x32_bf16 v[104:107], a[108:111], v[72:75], v[104:107]
    s_waitcnt lgkmcnt(0)
    v_fma_f32 v155, v88, v88, s41
    v_fmac_f32 v155, v89, v89
    v_mfma_f32_16x16x32_bf16 v[104:107], a[112:115], v[76:79], v[104:107]
    s_barrier
    ds_read_b128 v[68:71], v131 offset:0
    v_fmac_f32 v155, v90, v90
    v_mfma_f32_16x16x32_bf16 v[104:107], a[116:119], v[64:67], v[104:107]
    ds_read_b128 v[120:123], v131 offset:1024
    v_fmac_f32 v155, v91, v91
    v_mfma_f32_16x16x32_bf16 v[84:87], a[120:123], v[8:11], 0
    s_nop 2
    v_mfma_f32_16x16x32_bf16 v[84:87], a[124:127], v[60:63], v[84:87]
    s_nop 0
    v_fmac_f32 v155, v104, v104
    v_fmac_f32 v155, v105, v105
    v_mfma_f32_16x16x32_bf16 v[84:87], a[128:131], v[0:3], v[84:87]
    v_fmac_f32 v155, v106, v106
    v_fmac_f32 v155, v107, v107
    v_mfma_f32_16x16x32_bf16 v[84:87], a[132:135], v[72:75], v[84:87]
    v_mfma_f32_16x16x32_bf16 v[84:87], a[136:139], v[76:79], v[84:87]
    v_mfma_f32_16x16x32_bf16 v[84:87], a[140:143], v[64:67], v[84:87]
    v_mfma_f32_16x16x32_bf16 v[112:115], v[8:11], a[144:147], 0
    s_nop 2
    v_mfma_f32_16x16x32_bf16 v[112:115], v[60:63], a[148:151], v[112:115]
    s_waitcnt lgkmcnt(1)
    s_nop 0
    v_readfirstlane_b32 s12, v69
    v_fmac_f32 v155, v84, v84
    v_mfma_f32_16x16x32_bf16 v[112:115], v[0:3], a[152:155], v[112:115]
    s_lshr_b32 s12, s12, 23
    v_fmac_f32 v155, v85, v85
    v_fmac_f32 v155, v86, v86
    v_mfma_f32_16x16x32_bf16 v[112:115], v[72:75], a[156:159], v[112:115]
    v_fmac_f32 v155, v87, v87
    v_cvt_pk_bf16_f32 v170, v154, v155
    v_mfma_f32_16x16x32_bf16 v[112:115], v[76:79], a[160:163], v[112:115]
    v_mfma_f32_16x16x32_bf16 v[112:115], v[64:67], a[164:167], v[112:115]
    v_mfma_f32_16x16x32_bf16 v[80:83], v[216:219], v[68:71], 0
    s_waitcnt lgkmcnt(0)
    s_nop 0
    ds_read_b128 v[68:71], v139 offset:1536
    s_nop 0
    v_mfma_f32_16x16x32_bf16 v[80:83], v[216:219], v[120:123], v[80:83]
    s_nop 0
    ds_read_b128 v[120:123], v138 offset:1536
    v_cvt_pk_bf16_f32 v24, v112, v113
    v_mfma_f32_16x16x16_bf16 v[26:29], v[216:217], v[170:171], 0
    s_nop 0
    ds_read_b128 v[100:103], v139 offset:1664
    v_cvt_pk_bf16_f32 v25, v114, v115
    s_nop 0
    v_rsq_f32 v80, v80
    v_mfma_f32_16x16x32_bf16 v[154:157], v[8:11], a[168:171], 0
    ds_read_b128 v[112:115], v138 offset:1664
    v_mul_f32 v80, s43, v80
    v_mfma_f32_16x16x32_bf16 v[154:157], v[60:63], a[172:175], v[154:157]
    ds_read_b128 v[96:99], v139 offset:1792
    v_mul_f32 v40, v40, v80
    v_mfma_f32_16x16x32_bf16 v[154:157], v[0:3], a[176:179], v[154:157]
    ds_read_b128 v[92:95], v138 offset:1792
    v_mul_f32 v41, v41, v80
    v_mfma_f32_16x16x32_bf16 v[154:157], v[72:75], a[180:183], v[154:157]
    v_rsq_f32 v81, v81
    v_mfma_f32_16x16x32_bf16 v[154:157], v[76:79], a[184:187], v[154:157]
    v_rsq_f32 v82, v82
    v_mfma_f32_16x16x32_bf16 v[154:157], v[64:67], a[188:191], v[154:157]
    v_mul_f32 v81, s43, v81
    v_mul_f32 v82, s43, v82
    v_mfma_f32_16x16x32_bf16 v[116:119], v[8:11], a[192:195], 0
    v_rsq_f32 v26, v26
    v_mfma_f32_16x16x32_bf16 v[116:119], v[60:63], a[196:199], v[116:119]
    v_rsq_f32 v27, v27
    v_mfma_f32_16x16x32_bf16 v[116:119], v[0:3], a[200:203], v[116:119]
    v_mul_f32 v26, s55, v26
    v_mul_f32 v27, 0.5, v27
    v_mfma_f32_16x16x32_bf16 v[116:119], v[72:75], a[204:207], v[116:119]
    v_cvt_pk_bf16_f32 v28, v154, v155
    v_cvt_pk_bf16_f32 v29, v156, v157
    v_mfma_f32_16x16x32_bf16 v[116:119], v[76:79], a[208:211], v[116:119]
    v_mul_f32 v20, v20, v26
    v_mul_f32 v21, v21, v26
    v_mfma_f32_16x16x32_bf16 v[116:119], v[64:67], a[212:215], v[116:119]
    s_waitcnt lgkmcnt(0)
    v_cvt_pk_f16_f32 v64, v20, v21
    v_mul_f32 v22, v22, v26
    v_mfma_f32_16x16x32_bf16 v[8:11], a[0:3], v[68:71], 0
    v_mul_f32 v23, v23, v26
    v_cvt_pk_f16_f32 v65, v22, v23
    v_mfma_f32_16x16x32_bf16 v[8:11], a[4:7], v[120:123], v[8:11]
    v_mul_f32 v44, v44, v26
    v_mul_f32 v45, v45, v26
    v_mfma_f32_16x16x32_bf16 v[8:11], a[8:11], v[100:103], v[8:11]
    v_cvt_pk_f16_f32 v66, v44, v45
    v_mul_f32 v46, v46, v26
    v_mfma_f32_16x16x32_bf16 v[8:11], a[12:15], v[112:115], v[8:11]
    v_mul_f32 v47, v47, v26
    v_cvt_pk_f16_f32 v67, v46, v47
    v_mfma_f32_16x16x32_bf16 v[8:11], a[16:19], v[96:99], v[8:11]
    v_mul_f32 v4, v4, v26
    v_mul_f32 v5, v5, v26
    v_mfma_f32_16x16x32_bf16 v[8:11], a[20:23], v[92:95], v[8:11]
    v_cvt_pk_f16_f32 v154, v4, v5
    v_mul_f32 v6, v6, v26
    v_mfma_f32_16x16x32_bf16 v[20:23], a[24:27], v[68:71], 0
    v_mul_f32 v7, v7, v26
    v_cvt_pk_f16_f32 v155, v6, v7
    v_mfma_f32_16x16x32_bf16 v[20:23], a[28:31], v[120:123], v[20:23]
    v_mul_f32 v88, v88, v27
    v_mul_f32 v89, v89, v27
    v_mfma_f32_16x16x32_bf16 v[20:23], a[32:35], v[100:103], v[20:23]
    v_cvt_pk_f16_f32 v0, v88, v89
    v_mul_f32 v90, v90, v27
    v_mfma_f32_16x16x32_bf16 v[20:23], a[36:39], v[112:115], v[20:23]
    v_mul_f32 v91, v91, v27
    v_cvt_pk_f16_f32 v1, v90, v91
    v_mfma_f32_16x16x32_bf16 v[20:23], a[40:43], v[96:99], v[20:23]
    v_mul_f32 v104, v104, v27
    v_mul_f32 v105, v105, v27
    v_mfma_f32_16x16x32_bf16 v[20:23], a[44:47], v[92:95], v[20:23]
    v_cvt_pk_f16_f32 v2, v104, v105
    v_mul_f32 v106, v106, v27
    v_mfma_f32_16x16x32_bf16 v[76:79], a[48:51], v[68:71], 0
    v_mul_f32 v107, v107, v27
    v_cvt_pk_f16_f32 v3, v106, v107
    v_mfma_f32_16x16x32_bf16 v[76:79], a[52:55], v[120:123], v[76:79]
    v_mul_f32 v84, v84, v27
    v_mul_f32 v85, v85, v27
    v_mfma_f32_16x16x32_bf16 v[76:79], a[56:59], v[100:103], v[76:79]
    v_cvt_pk_f16_f32 v4, v84, v85
    v_mul_f32 v86, v86, v27
    v_mfma_f32_16x16x32_bf16 v[76:79], a[60:63], v[112:115], v[76:79]
    v_mul_f32 v87, v87, v27
    v_cvt_pk_f16_f32 v5, v86, v87
    v_mfma_f32_16x16x32_bf16 v[76:79], a[64:67], v[96:99], v[76:79]
    v_cvt_pk_bf16_f32 v44, v116, v117
    v_cvt_pk_bf16_f32 v45, v118, v119
    v_mfma_f32_16x16x32_bf16 v[76:79], a[68:71], v[92:95], v[76:79]
    v_cvt_pk_bf16_f32 v40, v40, v41
    v_mul_f32 v42, v42, v80
    v_mfma_f32_16x16x32_bf16 v[60:63], a[72:75], v[68:71], 0
    v_mul_f32 v43, v43, v80
    v_cvt_pk_bf16_f32 v41, v42, v43
    v_mfma_f32_16x16x32_bf16 v[60:63], a[76:79], v[120:123], v[60:63]
    ds_write_b64 v137, v[40:41] offset:0
    v_mfma_f32_16x16x32_bf16 v[60:63], a[80:83], v[100:103], v[60:63]
    v_mul_f32 v36, v36, v80
    v_mul_f32 v37, v37, v80
    v_mfma_f32_16x16x32_bf16 v[60:63], a[84:87], v[112:115], v[60:63]
    v_cvt_pk_bf16_f32 v42, v36, v37
    v_mul_f32 v38, v38, v80
    v_mfma_f32_16x16x32_bf16 v[60:63], a[88:91], v[96:99], v[60:63]
    v_mul_f32 v39, v39, v80
    v_cvt_pk_bf16_f32 v43, v38, v39
    v_mfma_f32_16x16x32_bf16 v[60:63], a[92:95], v[92:95], v[60:63]
    ds_write_b64 v137, v[42:43] offset:8
    v_mfma_f32_16x16x32_bf16 v[40:43], a[96:99], v[68:71], 0
    v_mul_f32 v32, v32, v80
    v_mul_f32 v33, v33, v80
    v_mfma_f32_16x16x32_bf16 v[40:43], a[100:103], v[120:123], v[40:43]
    v_cvt_pk_bf16_f32 v26, v32, v33
    v_mul_f32 v34, v34, v80
    v_mfma_f32_16x16x32_bf16 v[40:43], a[104:107], v[100:103], v[40:43]
    v_mul_f32 v35, v35, v80
    v_cvt_pk_bf16_f32 v27, v34, v35
    v_mfma_f32_16x16x32_bf16 v[40:43], a[108:111], v[112:115], v[40:43]
    ds_write_b64 v136, v[26:27] offset:0
    v_mfma_f32_16x16x32_bf16 v[40:43], a[112:115], v[96:99], v[40:43]
    v_fma_f32 v26, v8, v8, s41
    v_fmac_f32 v26, v9, v9
    v_mfma_f32_16x16x32_bf16 v[40:43], a[116:119], v[92:95], v[40:43]
    v_fmac_f32 v26, v10, v10
    v_fmac_f32 v26, v11, v11
    v_mfma_f32_16x16x32_bf16 v[36:39], a[120:123], v[68:71], 0
    v_fmac_f32 v26, v20, v20
    v_fmac_f32 v26, v21, v21
    v_mfma_f32_16x16x32_bf16 v[36:39], a[124:127], v[120:123], v[36:39]
    v_fmac_f32 v26, v22, v22
    v_fmac_f32 v26, v23, v23
    v_mfma_f32_16x16x32_bf16 v[36:39], a[128:131], v[100:103], v[36:39]
    v_fmac_f32 v26, v76, v76
    v_fmac_f32 v26, v77, v77
    v_mfma_f32_16x16x32_bf16 v[36:39], a[132:135], v[112:115], v[36:39]
    v_fmac_f32 v26, v78, v78
    v_fmac_f32 v26, v79, v79
    v_mfma_f32_16x16x32_bf16 v[36:39], a[136:139], v[96:99], v[36:39]
    v_mul_f32 v48, v48, v81
    v_mul_f32 v49, v49, v81
    v_mfma_f32_16x16x32_bf16 v[36:39], a[140:143], v[92:95], v[36:39]
    v_cvt_pk_bf16_f32 v30, v48, v49
    v_mul_f32 v50, v50, v81
    v_mfma_f32_16x16x32_bf16 v[46:49], v[68:71], a[144:147], 0
    v_mul_f32 v51, v51, v81
    v_cvt_pk_bf16_f32 v31, v50, v51
    v_mfma_f32_16x16x32_bf16 v[46:49], v[120:123], a[148:151], v[46:49]
    ds_write_b64 v137, v[30:31] offset:1536
    v_mfma_f32_16x16x32_bf16 v[46:49], v[100:103], a[152:155], v[46:49]
    v_mul_f32 v108, v108, v81
    v_mul_f32 v109, v109, v81
    v_mfma_f32_16x16x32_bf16 v[46:49], v[112:115], a[156:159], v[46:49]
    v_cvt_pk_bf16_f32 v32, v108, v109
    v_mul_f32 v110, v110, v81
    v_mfma_f32_16x16x32_bf16 v[46:49], v[96:99], a[160:163], v[46:49]
    ds_read_b128 v[72:75], v139 offset:3072
    v_mul_f32 v111, v111, v81
    v_mfma_f32_16x16x32_bf16 v[46:49], v[92:95], a[164:167], v[46:49]
    ds_read_b128 v[88:91], v138 offset:3072
    v_cvt_pk_bf16_f32 v33, v110, v111
    v_mfma_f32_16x16x32_bf16 v[106:109], v[68:71], a[168:171], 0
    ds_write_b64 v137, v[32:33] offset:1544
    v_mfma_f32_16x16x32_bf16 v[106:109], v[120:123], a[172:175], v[106:109]
    v_mul_f32 v52, v52, v81
    v_mul_f32 v53, v53, v81
    v_mfma_f32_16x16x32_bf16 v[106:109], v[100:103], a[176:179], v[106:109]
    ds_read_b128 v[32:35], v139 offset:3200
    v_cvt_pk_bf16_f32 v30, v52, v53
    v_mfma_f32_16x16x32_bf16 v[106:109], v[112:115], a[180:183], v[106:109]
    ds_read_b128 v[84:87], v138 offset:3200
    v_mul_f32 v54, v54, v81
    v_mfma_f32_16x16x32_bf16 v[106:109], v[96:99], a[184:187], v[106:109]
    ds_read_b128 v[116:119], v139 offset:3328
    v_mul_f32 v55, v55, v81
    v_mfma_f32_16x16x32_bf16 v[106:109], v[92:95], a[188:191], v[106:109]
    ds_read_b128 v[212:215], v138 offset:3328
    v_cvt_pk_bf16_f32 v31, v54, v55
    v_fma_f32 v27, v60, v60, s41
    v_fmac_f32 v27, v61, v61
    ds_write_b64 v136, v[30:31] offset:1536
    v_fmac_f32 v27, v62, v62
    v_fmac_f32 v27, v63, v63
    v_mfma_f32_16x16x32_bf16 v[52:55], v[68:71], a[192:195], 0
    v_fmac_f32 v27, v40, v40
    v_fmac_f32 v27, v41, v41
    v_mfma_f32_16x16x32_bf16 v[52:55], v[120:123], a[196:199], v[52:55]
    s_sub_u32 s50, s45, s44
    v_fmac_f32 v27, v42, v42
    v_fmac_f32 v27, v43, v43
    v_mfma_f32_16x16x32_bf16 v[52:55], v[100:103], a[200:203], v[52:55]
    s_sub_u32 s51, s46, s47
    v_fmac_f32 v27, v36, v36
    v_fmac_f32 v27, v37, v37
    v_mfma_f32_16x16x32_bf16 v[52:55], v[112:115], a[204:207], v[52:55]
    s_mov_b32 s60, s59
    v_fmac_f32 v27, v38, v38
    v_fmac_f32 v27, v39, v39
    v_mfma_f32_16x16x32_bf16 v[52:55], v[96:99], a[208:211], v[52:55]
    s_mov_b32 s59, s58
    v_cvt_pk_bf16_f32 v170, v26, v27
    v_cvt_pk_bf16_f32 v26, v46, v47
    v_mfma_f32_16x16x32_bf16 v[52:55], v[92:95], a[212:215], v[52:55]
    s_mov_b32 s58, s57
    v_cvt_pk_bf16_f32 v27, v48, v49
    v_cvt_pk_bf16_f32 v30, v106, v107
    v_mfma_f32_16x16x16_bf16 v[68:71], v[216:217], v[170:171], 0
    s_waitcnt lgkmcnt(0)
    s_mov_b32 s57, s56
    v_cvt_pk_bf16_f32 v31, v108, v109
    v_mul_f32 v12, v12, v82
    v_mul_f32 v13, v13, v82
    v_cvt_pk_bf16_f32 v46, v52, v53
    v_mfma_f32_16x16x32_bf16 v[48:51], a[0:3], v[72:75], 0
    s_mov_b32 s7, s6
    v_cvt_pk_bf16_f32 v47, v54, v55
    v_cvt_pk_bf16_f32 v12, v12, v13
    v_mfma_f32_16x16x32_bf16 v[48:51], a[4:7], v[88:91], v[48:51]
    s_mov_b32 s6, s5
    v_rsq_f32 v68, v68
    v_mfma_f32_16x16x32_bf16 v[48:51], a[8:11], v[32:35], v[48:51]
    s_mov_b32 s5, s4
    v_rsq_f32 v69, v69
    v_mfma_f32_16x16x32_bf16 v[48:51], a[12:15], v[84:87], v[48:51]
    s_sub_u32 s14, s6, s7
    v_mul_f32 v68, s55, v68
    v_mul_f32 v69, 0.5, v69
    v_mfma_f32_16x16x32_bf16 v[48:51], a[16:19], v[116:119], v[48:51]
    s_add_u32 s61, s61, 1
    v_mul_f32 v8, v8, v68
    v_mul_f32 v9, v9, v68
    v_mfma_f32_16x16x32_bf16 v[48:51], a[20:23], v[212:215], v[48:51]
    s_ff1_i32_b32 s15, s66
    v_cvt_pk_f16_f32 v52, v8, v9
    v_mul_f32 v10, v10, v68
    v_mfma_f32_16x16x32_bf16 v[106:109], a[24:27], v[72:75], 0
    s_cmp_lg_u32 s66, 0
    v_mul_f32 v11, v11, v68
    v_cvt_pk_f16_f32 v53, v10, v11
    v_mfma_f32_16x16x32_bf16 v[106:109], a[28:31], v[88:91], v[106:109]
    s_cselect_b32 s12, s15, s12
    v_mul_f32 v20, v20, v68
    v_mul_f32 v21, v21, v68
    v_mfma_f32_16x16x32_bf16 v[106:109], a[32:35], v[32:35], v[106:109]
    s_cmp_lt_u32 s61, s71
    v_cvt_pk_f16_f32 v54, v20, v21
    v_mul_f32 v22, v22, v68
    v_mfma_f32_16x16x32_bf16 v[106:109], a[36:39], v[84:87], v[106:109]
    s_cselect_b32 s15, 31, s15
    v_mul_f32 v23, v23, v68
    v_cvt_pk_f16_f32 v55, v22, v23
    v_mfma_f32_16x16x32_bf16 v[106:109], a[40:43], v[116:119], v[106:109]
    s_bitset0_b32 s66, s15
    v_mul_f32 v76, v76, v68
    v_mul_f32 v77, v77, v68
    v_mfma_f32_16x16x32_bf16 v[106:109], a[44:47], v[212:215], v[106:109]
    s_add_u32 s12, s12, 20
    v_cvt_pk_f16_f32 v150, v76, v77
    v_mul_f32 v78, v78, v68
    v_mfma_f32_16x16x32_bf16 v[120:123], a[48:51], v[72:75], 0
    s_max_u32 s12, s12, s61
    v_mul_f32 v79, v79, v68
    v_cvt_pk_f16_f32 v151, v78, v79
    v_mfma_f32_16x16x32_bf16 v[120:123], a[52:55], v[88:91], v[120:123]
    s_cmp_lt_u32 s61, s71
    v_mul_f32 v60, v60, v69
    v_mul_f32 v61, v61, v69
    v_mfma_f32_16x16x32_bf16 v[120:123], a[56:59], v[32:35], v[120:123]
    s_cselect_b32 s15, s61, s12
    v_cvt_pk_f16_f32 v6, v60, v61
    v_mul_f32 v62, v62, v69
    v_mfma_f32_16x16x32_bf16 v[120:123], a[60:63], v[84:87], v[120:123]
    s_cselect_b32 s56, s69, s70
    v_mul_f32 v63, v63, v69
    v_cvt_pk_f16_f32 v7, v62, v63
    v_mfma_f32_16x16x32_bf16 v[120:123], a[64:67], v[116:119], v[120:123]
    s_add_u32 s56, s56, s15
    v_mul_f32 v40, v40, v69
    v_mul_f32 v41, v41, v69
    v_mfma_f32_16x16x32_bf16 v[120:123], a[68:71], v[212:215], v[120:123]
    s_mul_i32 s53, s56, 58255
    v_cvt_pk_f16_f32 v8, v40, v41
    v_mul_f32 v42, v42, v69
    v_mfma_f32_16x16x32_bf16 v[20:23], a[72:75], v[72:75], 0
    s_lshr_b32 s53, s53, 22
    v_mul_f32 v43, v43, v69
    v_cvt_pk_f16_f32 v9, v42, v43
    v_mfma_f32_16x16x32_bf16 v[20:23], a[76:79], v[88:91], v[20:23]
    s_mul_i32 s53, s53, s63
    v_mul_f32 v36, v36, v69
    v_mul_f32 v37, v37, v69
    v_mfma_f32_16x16x32_bf16 v[20:23], a[80:83], v[32:35], v[20:23]
    s_mul_i32 s56, s56, s62
    v_cvt_pk_f16_f32 v10, v36, v37
    v_mul_f32 v38, v38, v69
    v_mfma_f32_16x16x32_bf16 v[20:23], a[84:87], v[84:87], v[20:23]
    s_add_u32 s56, s56, s53
    v_mul_f32 v39, v39, v69
    v_cvt_pk_f16_f32 v11, v38, v39
    v_mfma_f32_16x16x32_bf16 v[20:23], a[88:91], v[116:119], v[20:23]
    s_mul_i32 s4, s15, 336
    v_mul_f32 v14, v14, v82
    v_mul_f32 v15, v15, v82
    v_mfma_f32_16x16x32_bf16 v[20:23], a[92:95], v[212:215], v[20:23]
    s_cmp_ge_u32 s15, 16
    v_cvt_pk_bf16_f32 v13, v14, v15
    v_mul_f32 v16, v16, v82
    v_mfma_f32_16x16x32_bf16 v[36:39], a[96:99], v[72:75], 0
    s_cselect_b32 s53, -26880, 0
    ds_write_b64 v137, v[12:13] offset:3072
    v_mfma_f32_16x16x32_bf16 v[36:39], a[100:103], v[88:91], v[36:39]
    s_add_u32 s4, s4, s53
    v_mul_f32 v17, v17, v82
    v_cvt_pk_bf16_f32 v14, v16, v17
    v_mfma_f32_16x16x32_bf16 v[36:39], a[104:107], v[32:35], v[36:39]
    s_cmp_lt_u32 s15, s73
    v_mul_f32 v18, v18, v82
    v_mul_f32 v19, v19, v82
    v_mfma_f32_16x16x32_bf16 v[36:39], a[108:111], v[84:87], v[36:39]
    s_cselect_b32 s26, 100270464, 0
    v_cvt_pk_bf16_f32 v15, v18, v19
    v_mul_f32 v56, v56, v82
    v_mfma_f32_16x16x32_bf16 v[36:39], a[112:115], v[116:119], v[36:39]
    s_cselect_b32 s56, s56, 0
    ds_write_b64 v137, v[14:15] offset:3080
    v_mfma_f32_16x16x32_bf16 v[36:39], a[116:119], v[212:215], v[36:39]
    s_cselect_b32 s4, s4, -1
    v_mul_f32 v57, v57, v82
    v_cvt_pk_bf16_f32 v56, v56, v57
    v_mul_f32 v58, v58, v82
    v_mul_f32 v59, v59, v82
    v_cvt_pk_bf16_f32 v57, v58, v59
    s_cselect_b32 s15, s15, 0
    s_cselect_b32 s13, s13, -1
    ds_write_b64 v136, v[56:57] offset:3072
    v_fma_f32 v142, v48, v48, s41
    v_fmac_f32 v142, v49, v49
    v_fmac_f32 v142, v50, v50
    v_fmac_f32 v142, v51, v51
    v_mfma_f32_16x16x32_bf16 v[56:59], a[120:123], v[72:75], 0
    s_waitcnt vmcnt(0)
    v_fmac_f32 v142, v106, v106
    v_fmac_f32 v142, v107, v107
    v_mfma_f32_16x16x32_bf16 v[56:59], a[124:127], v[88:91], v[56:59]
    s_bitset1_b32 s64, s15
    v_fmac_f32 v142, v108, v108
    v_fmac_f32 v142, v109, v109
    v_mfma_f32_16x16x32_bf16 v[56:59], a[128:131], v[32:35], v[56:59]
    s_add_u32 s65, s65, 1
    v_fmac_f32 v142, v120, v120
    v_fmac_f32 v142, v121, v121
    v_mfma_f32_16x16x32_bf16 v[56:59], a[132:135], v[84:87], v[56:59]
    s_cmp_ge_i32 s65, 2
    v_fmac_f32 v142, v122, v122
    v_fmac_f32 v142, v123, v123
    v_mfma_f32_16x16x32_bf16 v[56:59], a[136:139], v[116:119], v[56:59]
    s_cselect_b32 s30, 100270464, 0
    v_fma_f32 v143, v20, v20, s41
    v_fmac_f32 v143, v21, v21
    v_mfma_f32_16x16x32_bf16 v[56:59], a[140:143], v[212:215], v[56:59]
    s_add_u32 s67, s46, s54
    v_fmac_f32 v143, v22, v22
    v_fmac_f32 v143, v23, v23
    v_mfma_f32_16x16x32_bf16 v[12:15], v[72:75], a[144:147], 0
    s_waitcnt lgkmcnt(0)
    s_add_u32 m0, s67, 0
    v_fmac_f32 v143, v36, v36
    v_fmac_f32 v143, v37, v37
    v_mfma_f32_16x16x32_bf16 v[12:15], v[88:91], a[148:151], v[12:15]
    s_barrier
    v_fmac_f32 v143, v38, v38
    v_fmac_f32 v143, v39, v39
    v_mfma_f32_16x16x32_bf16 v[12:15], v[32:35], a[152:155], v[12:15]
    s_cmp_ge_u32 s61, s13
    v_fmac_f32 v143, v56, v56
    v_fmac_f32 v143, v57, v57
    v_mfma_f32_16x16x32_bf16 v[12:15], v[84:87], a[156:159], v[12:15]
    s_cbranch_scc1 L_atomS0
L_atomrS0:
    v_mfma_f32_16x16x32_bf16 v[12:15], v[116:119], a[160:163], v[12:15]
    v_fmac_f32 v143, v58, v58
    v_fmac_f32 v143, v59, v59
    v_mfma_f32_16x16x32_bf16 v[12:15], v[212:215], a[164:167], v[12:15]
    v_cvt_pk_bf16_f32 v170, v142, v143
    v_add_u32 v139, s50, v139
    v_mfma_f32_16x16x32_bf16 v[40:43], v[72:75], a[168:171], 0
    ds_read_b128 v[76:79], v139 offset:0
    v_add_u32 v138, s50, v138
    v_mfma_f32_16x16x32_bf16 v[40:43], v[88:91], a[172:175], v[40:43]
    s_nop 0
    ds_read_b128 v[80:83], v138 offset:0
    v_cvt_pk_bf16_f32 v164, v12, v13
    v_mfma_f32_16x16x32_bf16 v[40:43], v[32:35], a[176:179], v[40:43]
    ds_read_b128 v[68:71], v139 offset:128
    v_cvt_pk_bf16_f32 v165, v14, v15
    v_mfma_f32_16x16x32_bf16 v[40:43], v[84:87], a[180:183], v[40:43]
    ds_read_b128 v[100:103], v138 offset:128
    v_add_u32 v137, s48, v137
    v_mfma_f32_16x16x32_bf16 v[40:43], v[116:119], a[184:187], v[40:43]
    ds_read_b128 v[112:115], v139 offset:256
    v_add_u32 v136, s48, v136
    v_mfma_f32_16x16x32_bf16 v[40:43], v[212:215], a[188:191], v[40:43]
    s_nop 0
    ds_read_b128 v[96:99], v138 offset:256
    v_add_u32 v135, s51, v135
    v_mfma_f32_16x16x16_bf16 v[92:95], v[216:217], v[170:171], 0
    s_nop 0
    v_add_u32 v134, s14, v134
    v_add_u32 v133, s14, v133
    v_add_u32 v125, s14, v125
    v_cvt_pk_bf16_f32 v160, v40, v41
    v_mfma_f32_16x16x32_bf16 v[60:63], v[72:75], a[192:195], 0
    v_cvt_pk_bf16_f32 v161, v42, v43
    v_mfma_f32_16x16x32_bf16 v[60:63], v[88:91], a[196:199], v[60:63]
    v_rsq_f32 v92, v92
    v_mfma_f32_16x16x32_bf16 v[60:63], v[32:35], a[200:203], v[60:63]
    v_rsq_f32 v93, v93
    v_mfma_f32_16x16x32_bf16 v[60:63], v[84:87], a[204:207], v[60:63]
    ds_read_b128 v[12:15], v134 offset:32
    v_mul_f32 v92, s55, v92
    v_mfma_f32_16x16x32_bf16 v[60:63], v[116:119], a[208:211], v[60:63]
    ds_read_b64 v[16:17], v134 offset:48
    v_mul_f32 v93, 0.5, v93
    v_mfma_f32_16x16x32_bf16 v[60:63], v[212:215], a[212:215], v[60:63]
    s_waitcnt lgkmcnt(3)
    ds_read_b128 v[72:75], v135 offset:0
    v_mul_f32 v20, v20, v93
    v_mfma_f32_16x16x32_bf16 v[40:43], a[216:219], v[76:79], 0
    v_mul_f32 v21, v21, v93
    v_cvt_pk_f16_f32 v18, v20, v21
    v_mfma_f32_16x16x32_bf16 v[40:43], a[220:223], v[80:83], v[40:43]
    v_mul_f32 v22, v22, v93
    v_mul_f32 v23, v23, v93
    v_mfma_f32_16x16x32_bf16 v[40:43], a[224:227], v[68:71], v[40:43]
    v_cvt_pk_f16_f32 v19, v22, v23
    v_mul_f32 v36, v36, v93
    v_mfma_f32_16x16x32_bf16 v[40:43], a[228:231], v[100:103], v[40:43]
    v_mul_f32 v37, v37, v93
    v_cvt_pk_f16_f32 v20, v36, v37
    v_mfma_f32_16x16x32_bf16 v[40:43], a[232:235], v[112:115], v[40:43]
    s_waitcnt lgkmcnt(3)
    v_mul_f32 v38, v38, v93
    v_mul_f32 v39, v39, v93
    v_mfma_f32_16x16x32_bf16 v[40:43], a[236:239], v[96:99], v[40:43]
    v_cvt_pk_f16_f32 v21, v38, v39
    v_mul_f32 v56, v56, v93
    v_mfma_f32_16x16x32_bf16 v[36:39], a[240:243], v[76:79], 0
    v_mul_f32 v57, v57, v93
    v_cvt_pk_f16_f32 v22, v56, v57
    v_mfma_f32_16x16x32_bf16 v[36:39], a[244:247], v[80:83], v[36:39]
    v_mul_f32 v58, v58, v93
    v_mul_f32 v59, v59, v93
    v_mfma_f32_16x16x32_bf16 v[36:39], a[248:251], v[68:71], v[36:39]
    s_waitcnt lgkmcnt(0)
    buffer_load_dwordx4 v130, s[24:27], s56 offen nt lds
    v_cvt_pk_f16_f32 v23, v58, v59
    v_mfma_f32_16x16x32_bf16 v[36:39], a[252:255], v[100:103], v[36:39]
    v_mul_f32 v48, v48, v92
    v_mul_f32 v49, v49, v92
    v_mfma_f32_16x16x32_bf16 v[36:39], v[224:227], v[112:115], v[36:39]
    v_cvt_pk_f16_f32 v56, v48, v49
    v_mul_f32 v50, v50, v92
    v_mfma_f32_16x16x32_bf16 v[36:39], v[228:231], v[96:99], v[36:39]
    ds_read_u16 v166, v133 offset:56
    v_mul_f32 v51, v51, v92
    v_mfma_f32_16x16x32_bf16 v[32:35], v[232:235], v[76:79], 0
    ds_read_u16 v162, v133 offset:64
    v_cvt_pk_f16_f32 v57, v50, v51
    v_mfma_f32_16x16x32_bf16 v[32:35], v[236:239], v[80:83], v[32:35]
    ds_read_u16 v158, v133 offset:72
    v_mul_f32 v106, v106, v92
    v_mfma_f32_16x16x32_bf16 v[32:35], v[240:243], v[68:71], v[32:35]
    ds_read_b128 v[48:51], v134 offset:0
    v_mul_f32 v107, v107, v92
    v_mfma_f32_16x16x32_bf16 v[32:35], v[244:247], v[100:103], v[32:35]
    buffer_store_dwordx4 v[72:75], v130, s[28:31], s60 offen sc1
    ds_read_b64 v[142:143], v134 offset:16
    v_cvt_pk_f16_f32 v58, v106, v107
    v_mul_f32 v108, v108, v92
    v_mul_f32 v109, v109, v92
    v_mfma_f32_16x16x32_bf16 v[32:35], v[248:251], v[112:115], v[32:35]
    s_add_u32 m0, s67, 1024
    v_cvt_pk_f16_f32 v59, v108, v109
    v_mul_f32 v120, v120, v92
    v_mfma_f32_16x16x32_bf16 v[32:35], v[252:255], v[96:99], v[32:35]
    v_mul_f32 v121, v121, v92
    v_cvt_pk_f16_f32 v146, v120, v121
    v_mfma_f32_16x16x32_f16 v[100:103], v[0:3], v[64:67], v[204:207]
    v_mul_f32 v122, v122, v92
    v_mul_f32 v123, v123, v92
    v_mfma_f32_16x16x32_f16 v[100:103], v[2:5], v[152:155], v[100:103]
    ds_read_b128 v[112:115], v135 offset:1024
    v_cvt_pk_f16_f32 v147, v122, v123
    v_mfma_f32_16x16x32_f16 v[120:123], v[6:9], v[64:67], v[200:203]
    ds_read_b128 v[76:79], v139 offset:1536
    v_cvt_pk_bf16_f32 v156, v60, v61
    v_mfma_f32_16x16x32_f16 v[120:123], v[8:11], v[152:155], v[120:123]
    ds_read_b128 v[80:83], v138 offset:1536
    v_cvt_pk_bf16_f32 v157, v62, v63
    v_mfma_f32_16x16x32_f16 v[96:99], v[18:21], v[64:67], v[196:199]
    ds_read_b128 v[60:63], v139 offset:1664
    v_max3_f32 v104, v100, v101, v102
    v_mfma_f32_16x16x32_f16 v[96:99], v[20:23], v[152:155], v[96:99]
    s_nop 0
    ds_read_b128 v[72:75], v138 offset:1664
    v_max3_f32 v104, v104, v103, v120
    v_mfma_f32_16x16x32_f16 v[88:91], v[12:15], v[64:67], v[208:211]
    ds_read_b128 v[64:67], v139 offset:1792
    v_max3_f32 v104, v104, v121, v122
    v_mfma_f32_16x16x32_f16 v[88:91], v[14:17], v[152:155], v[88:91]
    s_waitcnt lgkmcnt(6)
    ds_read_b128 v[68:71], v138 offset:1792
    v_max3_f32 v104, v104, v123, v96
    v_mfma_f32_16x16x32_f16 v[106:109], v[48:51], v[0:3], v[208:211]
    v_max3_f32 v104, v104, v97, v98
    s_nop 0
    v_mfma_f32_16x16x32_f16 v[106:109], v[140:143], v[2:5], v[106:109]
    s_nop 0
    v_max3_f32 v104, v104, v99, v88
    v_mov_b32 v105, v104
    v_mfma_f32_16x16x32_f16 v[92:95], v[48:51], v[6:9], v[208:211]
    s_waitcnt lgkmcnt(6)
    buffer_load_dwordx4 v129, s[24:27], s56 offen nt lds
    v_mfma_f32_16x16x32_f16 v[92:95], v[140:143], v[8:11], v[92:95]
    v_permlane32_swap_b32 v105, v104
    v_mfma_f32_16x16x32_f16 v[84:87], v[48:51], v[18:21], v[208:211]
    v_max_f32 v104, v105, v104
    v_mov_b32 v105, v104
    v_mfma_f32_16x16x32_f16 v[84:87], v[140:143], v[20:23], v[84:87]
    s_nop 0
    v_permlane16_swap_b32 v105, v104
    v_mfma_f32_16x16x32_f16 v[90:93], v[48:51], v[12:15], v[208:211]
    v_max_f32 v104, v105, v104
    v_sub_f32 v100, v100, v104
    v_mfma_f32_16x16x32_f16 v[90:93], v[140:143], v[14:17], v[90:93]
    s_waitcnt lgkmcnt(1)
    v_sub_f32 v101, v101, v104
    v_sub_f32 v102, v102, v104
    v_mfma_f32_16x16x32_bf16 v[48:51], a[216:219], v[76:79], 0
    v_sub_f32 v103, v103, v104
    v_sub_f32 v120, v120, v104
    v_mfma_f32_16x16x32_bf16 v[48:51], a[220:223], v[80:83], v[48:51]
    buffer_store_dwordx4 v[112:115], v129, s[28:31], s60 offen sc1
    v_sub_f32 v121, v121, v104
    v_sub_f32 v122, v122, v104
    v_sub_f32 v123, v123, v104
    v_sub_f32 v96, v96, v104
    v_mfma_f32_16x16x32_bf16 v[48:51], a[224:227], v[60:63], v[48:51]
    s_add_u32 m0, s67, 2048
    v_sub_f32 v97, v97, v104
    v_sub_f32 v98, v98, v104
    v_mfma_f32_16x16x32_bf16 v[48:51], a[228:231], v[72:75], v[48:51]
    v_sub_f32 v99, v99, v104
    v_sub_f32 v88, v88, v104
    v_mfma_f32_16x16x32_bf16 v[48:51], a[232:235], v[64:67], v[48:51]
    s_waitcnt lgkmcnt(0)
    v_exp_f32 v100, v100
    v_mfma_f32_16x16x32_bf16 v[48:51], a[236:239], v[68:71], v[48:51]
    v_exp_f32 v101, v101
    v_exp_f32 v102, v102
    v_exp_f32 v103, v103
    v_cvt_pk_bf16_f32 v116, v100, v101
    v_cvt_pk_bf16_f32 v117, v102, v103
    v_exp_f32 v120, v120
    v_exp_f32 v121, v121
    v_exp_f32 v122, v122
    v_exp_f32 v123, v123
    v_cvt_pk_bf16_f32 v118, v120, v121
    v_cvt_pk_bf16_f32 v119, v122, v123
    v_exp_f32 v96, v96
    v_exp_f32 v97, v97
    v_exp_f32 v98, v98
    v_exp_f32 v99, v99
    v_cvt_pk_bf16_f32 v168, v96, v97
    v_cvt_pk_bf16_f32 v169, v98, v99
    v_exp_f32 v88, v88
    v_mov_b32_dpp v109, v95 quad_perm:[0,1,2,3] row_mask:0x2 bank_mask:0xf
    v_cvt_pk_bf16_f32 v170, v88, 0
    v_mfma_f32_16x16x32_bf16 v[120:123], v[220:223], v[116:119], 0
    v_mov_b32_dpp v109, v87 quad_perm:[0,1,2,3] row_mask:0x4 bank_mask:0xf
    v_mfma_f32_16x16x32_bf16 v[120:123], v[220:223], v[168:171], v[120:123]
    ds_read_b128 v[100:103], v135 offset:2048
    v_mov_b32_dpp v109, v93 quad_perm:[0,1,2,3] row_mask:0x8 bank_mask:0xf
    v_mfma_f32_16x16x32_bf16 v[112:115], v[24:27], v[116:119], 0
    s_nop 0
    v_mov_b32 v142, v109
    s_nop 0
    v_mfma_f32_16x16x32_bf16 v[112:115], v[164:167], v[168:171], v[112:115]
    s_nop 0
    v_rcp_f32 v120, v120
    v_mfma_f32_16x16x32_bf16 v[104:107], v[28:31], v[116:119], 0
    v_max_f32_dpp v142, v142, v142 row_ror:8 row_mask:0xf bank_mask:0xf
    s_nop 0
    v_mfma_f32_16x16x32_bf16 v[104:107], v[160:163], v[168:171], v[104:107]
    s_nop 0
    v_max_f32_dpp v142, v142, v142 row_ror:4 row_mask:0xf bank_mask:0xf
    v_mul_f32 v112, v112, v120
    v_mfma_f32_16x16x32_bf16 v[96:99], v[44:47], v[116:119], 0
    v_max_f32_dpp v142, v142, v142 row_ror:2 row_mask:0xf bank_mask:0xf
    v_mul_f32 v113, v113, v120
    v_mfma_f32_16x16x32_bf16 v[96:99], v[156:159], v[168:171], v[96:99]
    v_max_f32_dpp v142, v142, v142 row_ror:1 row_mask:0xf bank_mask:0xf
    v_mov_b32 v143, v142
    v_mfma_f32_16x16x32_f16 v[88:91], v[0:3], v[52:55], v[192:195]
    s_nop 0
    v_permlane32_swap_b32 v143, v142
    v_mfma_f32_16x16x32_f16 v[88:91], v[2:5], v[148:151], v[88:91]
    v_max_f32 v142, v143, v142
    v_mov_b32 v143, v142
    v_mfma_f32_16x16x32_f16 v[92:95], v[6:9], v[52:55], v[188:191]
    s_waitcnt lgkmcnt(0)
    buffer_load_dwordx4 v128, s[24:27], s56 offen nt lds
    v_cvt_pk_bf16_f32 v112, v112, v113
    v_mfma_f32_16x16x32_f16 v[92:95], v[8:11], v[148:151], v[92:95]
    v_permlane16_swap_b32 v143, v142
    v_mfma_f32_16x16x32_f16 v[84:87], v[18:21], v[52:55], v[184:187]
    v_max_f32 v142, v143, v142
    v_sub_f32 v109, v109, v142
    v_mfma_f32_16x16x32_f16 v[84:87], v[20:23], v[148:151], v[84:87]
    v_exp_f32 v109, v109
    v_mfma_f32_16x16x32_f16 v[116:119], v[12:15], v[52:55], v[208:211]
    v_cvt_pk_bf16_f32 v109, v109, v109
    v_mul_f32 v114, v114, v120
    v_mfma_f32_16x16x32_f16 v[116:119], v[14:17], v[148:151], v[116:119]
    s_mov_b32 s53, s47
    ds_write_b16 v125, v109
    v_mul_f32 v115, v115, v120
    v_cvt_pk_bf16_f32 v113, v114, v115
    s_mov_b32 s47, s46
    s_mov_b32 s46, s45
    ds_read_b128 v[52:55], v134
    v_mul_f32 v104, v104, v120
    v_mul_f32 v105, v105, v120
    v_cvt_pk_bf16_f32 v114, v104, v105
    s_add_u32 m0, s67, 3072
    s_mov_b32 s45, s44
    ds_read_b128 v[212:215], v134 offset:16
    v_mfma_f32_16x16x32_bf16 v[108:111], a[240:243], v[76:79], 0
    s_mov_b32 s44, s53
    buffer_store_dwordx4 v[100:103], v128, s[28:31], s60 offen sc1
    ds_write_b64 v137, v[112:113] offset:0
    v_mul_f32 v106, v106, v120
    v_mfma_f32_16x16x32_bf16 v[108:111], a[244:247], v[80:83], v[108:111]
    s_sub_u32 s48, s44, s46
    v_mul_f32 v107, v107, v120
    v_cvt_pk_bf16_f32 v115, v106, v107
    v_mfma_f32_16x16x32_bf16 v[108:111], a[248:251], v[60:63], v[108:111]
    ds_write_b64 v137, v[114:115] offset:8
    v_mfma_f32_16x16x32_bf16 v[108:111], a[252:255], v[72:75], v[108:111]
    v_mul_f32 v96, v96, v120
    v_mul_f32 v97, v97, v120
    v_mfma_f32_16x16x32_bf16 v[108:111], v[224:227], v[64:67], v[108:111]
    s_sub_u32 s49, s46, s45
    v_cvt_pk_bf16_f32 v168, v96, v97
    v_mul_f32 v98, v98, v120
    v_mfma_f32_16x16x32_bf16 v[108:111], v[228:231], v[68:71], v[108:111]
    s_waitcnt lgkmcnt(3)
    v_mul_f32 v99, v99, v120
    v_cvt_pk_bf16_f32 v169, v98, v99
    v_mfma_f32_16x16x32_bf16 v[104:107], v[52:55], v[24:27], 0
    s_waitcnt lgkmcnt(2)
    ds_write_b64 v136, v[168:169] offset:0
    v_max3_f32 v168, v88, v89, v90
    v_mfma_f32_16x16x32_bf16 v[104:107], v[212:215], v[164:167], v[104:107]
    v_max3_f32 v168, v168, v91, v92
    v_max3_f32 v168, v168, v93, v94
    v_mfma_f32_16x16x32_bf16 v[120:123], v[52:55], v[28:31], 0
    v_max3_f32 v168, v168, v95, v84
    v_max3_f32 v168, v168, v85, v86
    v_mfma_f32_16x16x32_bf16 v[120:123], v[212:215], v[160:163], v[120:123]
    v_max3_f32 v168, v168, v87, v117
    v_mov_b32 v169, v168
    v_mfma_f32_16x16x32_bf16 v[100:103], v[52:55], v[44:47], 0
    s_nop 0
    v_permlane32_swap_b32 v169, v168
    v_mfma_f32_16x16x32_bf16 v[100:103], v[212:215], v[156:159], v[100:103]
    v_max_f32 v168, v169, v168
    v_mov_b32 v169, v168
    v_mfma_f32_16x16x32_bf16 v[52:55], v[232:235], v[76:79], 0
    s_nop 0
    v_permlane16_swap_b32 v169, v168
    v_mfma_f32_16x16x32_bf16 v[52:55], v[236:239], v[80:83], v[52:55]
    v_max_f32 v168, v169, v168
    v_sub_f32 v88, v88, v168
    v_mfma_f32_16x16x32_bf16 v[52:55], v[240:243], v[60:63], v[52:55]
    v_sub_f32 v89, v89, v168
    v_sub_f32 v90, v90, v168
    v_mfma_f32_16x16x32_bf16 v[52:55], v[244:247], v[72:75], v[52:55]
    v_sub_f32 v91, v91, v168
    v_sub_f32 v92, v92, v168
    v_mfma_f32_16x16x32_bf16 v[52:55], v[248:251], v[64:67], v[52:55]
    v_sub_f32 v93, v93, v168
    v_sub_f32 v94, v94, v168
    v_mfma_f32_16x16x32_bf16 v[52:55], v[252:255], v[68:71], v[52:55]
    v_sub_f32 v95, v95, v168
    v_sub_f32 v84, v84, v168
    v_sub_f32 v85, v85, v168
    v_sub_f32 v86, v86, v168
    v_sub_f32 v87, v87, v168
    v_sub_f32 v117, v117, v168
    v_exp_f32 v88, v88
    v_exp_f32 v89, v89
    v_exp_f32 v90, v90
    v_exp_f32 v91, v91
    v_cvt_pk_bf16_f32 v76, v88, v89
    v_cvt_pk_bf16_f32 v77, v90, v91
    v_exp_f32 v92, v92
    v_exp_f32 v93, v93
    v_exp_f32 v94, v94
    v_exp_f32 v95, v95
    v_cvt_pk_bf16_f32 v78, v92, v93
    v_cvt_pk_bf16_f32 v79, v94, v95
    v_exp_f32 v84, v84
    v_exp_f32 v85, v85
    v_exp_f32 v86, v86
    v_exp_f32 v87, v87
    v_cvt_pk_bf16_f32 v168, v84, v85
    v_cvt_pk_bf16_f32 v169, v86, v87
    v_exp_f32 v117, v117
    v_mov_b32_dpp v107, v123 quad_perm:[0,1,2,3] row_mask:0x2 bank_mask:0xf
    v_cvt_pk_bf16_f32 v170, v117, 0
    v_mfma_f32_16x16x32_bf16 v[80:83], v[220:223], v[76:79], 0
    v_mov_b32_dpp v107, v103 quad_perm:[0,1,2,3] row_mask:0x4 bank_mask:0xf
    v_cvt_pk_bf16_f32 v107, v107, v107
    v_mfma_f32_16x16x32_bf16 v[80:83], v[220:223], v[168:171], v[80:83]
    ds_write_b16 v133, v107 offset:56
    v_mfma_f32_16x16x32_bf16 v[60:63], v[24:27], v[76:79], 0
    ds_read_b128 v[72:75], v135 offset:3072
    v_fma_f32 v154, v40, v40, s42
    v_mfma_f32_16x16x32_bf16 v[60:63], v[164:167], v[168:171], v[60:63]
    ds_read_b128 v[68:71], v139 offset:3072
    v_fmac_f32 v154, v41, v41
    v_mfma_f32_16x16x32_bf16 v[64:67], v[28:31], v[76:79], 0
    ds_read_b128 v[104:107], v138 offset:3072
    v_fmac_f32 v154, v42, v42
    v_mfma_f32_16x16x32_bf16 v[64:67], v[160:163], v[168:171], v[64:67]
    ds_read_b128 v[120:123], v139 offset:3200
    v_fmac_f32 v154, v43, v43
    v_mfma_f32_16x16x32_bf16 v[100:103], v[44:47], v[76:79], 0
    ds_read_b128 v[76:79], v138 offset:3200
    v_fmac_f32 v154, v36, v36
    v_mfma_f32_16x16x32_bf16 v[100:103], v[156:159], v[168:171], v[100:103]
    ds_read_b128 v[112:115], v139 offset:3328
    v_add_u32 v139, s48, v139
    v_mfma_f32_16x16x32_f16 v[96:99], v[0:3], v[56:59], v[180:183]
    ds_read_b128 v[82:85], v138 offset:3328
    v_add_u32 v138, s48, v138
    v_mfma_f32_16x16x32_f16 v[96:99], v[2:5], v[144:147], v[96:99]
    ds_read_b128 v[0:3], v135 offset:4096
    v_fmac_f32 v154, v37, v37
    v_mfma_f32_16x16x32_f16 v[88:91], v[6:9], v[56:59], v[176:179]
    v_rcp_f32 v80, v80
    v_mfma_f32_16x16x32_f16 v[88:91], v[8:11], v[144:147], v[88:91]
    s_waitcnt lgkmcnt(7)
    buffer_load_dwordx4 v127, s[24:27], s56 offen nt lds
    v_mul_f32 v60, v60, v80
    v_mfma_f32_16x16x32_f16 v[4:7], v[18:21], v[56:59], v[172:175]
    v_mul_f32 v61, v61, v80
    v_cvt_pk_bf16_f32 v8, v60, v61
    v_mfma_f32_16x16x32_f16 v[4:7], v[20:23], v[144:147], v[4:7]
    v_mul_f32 v62, v62, v80
    v_mul_f32 v63, v63, v80
    v_mfma_f32_16x16x32_f16 v[20:23], v[12:15], v[56:59], v[208:211]
    v_cvt_pk_bf16_f32 v9, v62, v63
    v_mul_f32 v64, v64, v80
    v_mfma_f32_16x16x32_f16 v[20:23], v[14:17], v[144:147], v[20:23]
    s_waitcnt lgkmcnt(3)
    ds_write_b64 v137, v[8:9] offset:1536
    v_mfma_f32_16x16x32_bf16 v[12:15], a[216:219], v[68:71], 0
    v_mul_f32 v65, v65, v80
    v_cvt_pk_bf16_f32 v10, v64, v65
    v_mfma_f32_16x16x32_bf16 v[12:15], a[220:223], v[104:107], v[12:15]
    v_mul_f32 v66, v66, v80
    v_mul_f32 v67, v67, v80
    v_mfma_f32_16x16x32_bf16 v[12:15], a[224:227], v[120:123], v[12:15]
    s_add_u32 m0, s67, 4096
    buffer_store_dwordx4 v[72:75], v127, s[28:31], s60 offen sc1
    v_cvt_pk_bf16_f32 v11, v66, v67
    v_mul_f32 v100, v100, v80
    v_mul_f32 v101, v101, v80
    v_cvt_pk_bf16_f32 v168, v100, v101
    v_mfma_f32_16x16x32_bf16 v[12:15], a[228:231], v[76:79], v[12:15]
    s_waitcnt lgkmcnt(1)
    ds_write_b64 v137, v[10:11] offset:1544
    v_mfma_f32_16x16x32_bf16 v[12:15], a[232:235], v[112:115], v[12:15]
    s_cmp_lg_u32 s5, -1
    v_mul_f32 v102, v102, v80
    v_mul_f32 v103, v103, v80
    v_mfma_f32_16x16x32_bf16 v[12:15], a[236:239], v[82:85], v[12:15]
    buffer_load_dwordx4 v126, s[24:27], s56 offen nt lds
    v_cvt_pk_bf16_f32 v169, v102, v103
    v_mfma_f32_16x16x32_bf16 v[16:19], a[240:243], v[68:71], 0
    ds_write_b64 v136, v[168:169] offset:1536
    v_mfma_f32_16x16x32_bf16 v[16:19], a[244:247], v[104:107], v[16:19]
    v_max3_f32 v155, v96, v97, v98
    v_max3_f32 v155, v155, v99, v88
    v_mfma_f32_16x16x32_bf16 v[16:19], a[248:251], v[120:123], v[16:19]
    v_max3_f32 v155, v155, v89, v90
    v_max3_f32 v155, v155, v91, v4
    v_mfma_f32_16x16x32_bf16 v[16:19], a[252:255], v[76:79], v[16:19]
    v_max3_f32 v155, v155, v5, v6
    v_max3_f32 v155, v155, v7, v22
    v_mfma_f32_16x16x32_bf16 v[16:19], v[224:227], v[112:115], v[16:19]
    v_mov_b32 v168, v155
    v_fmac_f32 v154, v38, v38
    v_mfma_f32_16x16x32_bf16 v[16:19], v[228:231], v[82:85], v[16:19]
    ds_read_b128 v[8:11], v139 offset:0
    v_fmac_f32 v154, v39, v39
    v_mfma_f32_16x16x32_bf16 v[56:59], v[232:235], v[68:71], 0
    buffer_store_dwordx4 v[0:3], v126, s[28:31], s60 offen sc1
    ds_read_b128 v[60:63], v138 offset:0
    v_permlane32_swap_b32 v168, v155
    v_max_f32 v155, v168, v155
    v_mfma_f32_16x16x32_bf16 v[56:59], v[236:239], v[104:107], v[56:59]
    ds_read_b128 v[0:3], v139 offset:128
    v_mov_b32 v168, v155
    v_mfma_f32_16x16x32_bf16 v[56:59], v[240:243], v[120:123], v[56:59]
    ds_read_b128 v[72:75], v138 offset:128
    v_fmac_f32 v154, v32, v32
    v_mfma_f32_16x16x32_bf16 v[56:59], v[244:247], v[76:79], v[56:59]
    ds_read_b128 v[76:79], v139 offset:256
    v_fmac_f32 v154, v33, v33
    v_mfma_f32_16x16x32_bf16 v[56:59], v[248:251], v[112:115], v[56:59]
    ds_read_b128 v[64:67], v138 offset:256
    v_fmac_f32 v154, v34, v34
    v_mfma_f32_16x16x32_bf16 v[56:59], v[252:255], v[82:85], v[56:59]
    v_permlane16_swap_b32 v168, v155
    v_max_f32 v155, v168, v155
    v_sub_f32 v96, v96, v155
    v_sub_f32 v97, v97, v155
    v_sub_f32 v98, v98, v155
    v_sub_f32 v99, v99, v155
    v_sub_f32 v88, v88, v155
    v_sub_f32 v89, v89, v155
    v_sub_f32 v90, v90, v155
    v_sub_f32 v91, v91, v155
    v_sub_f32 v4, v4, v155
    v_sub_f32 v5, v5, v155
    v_sub_f32 v6, v6, v155
    v_sub_f32 v7, v7, v155
    v_sub_f32 v22, v22, v155
    v_exp_f32 v96, v96
    v_exp_f32 v97, v97
    v_exp_f32 v98, v98
    v_exp_f32 v99, v99
    v_cvt_pk_bf16_f32 v80, v96, v97
    v_cvt_pk_bf16_f32 v81, v98, v99
    v_exp_f32 v88, v88
    v_exp_f32 v89, v89
    v_exp_f32 v90, v90
    v_exp_f32 v91, v91
    v_cvt_pk_bf16_f32 v82, v88, v89
    v_cvt_pk_bf16_f32 v83, v90, v91
    v_exp_f32 v4, v4
    v_exp_f32 v5, v5
    v_exp_f32 v6, v6
    v_exp_f32 v7, v7
    v_cvt_pk_bf16_f32 v168, v4, v5
    v_cvt_pk_bf16_f32 v169, v6, v7
    v_exp_f32 v22, v22
    v_fmac_f32 v154, v35, v35
    v_cvt_pk_bf16_f32 v170, v22, 0
    v_mfma_f32_16x16x32_bf16 v[4:7], v[220:223], v[80:83], 0
    v_fma_f32 v155, v48, v48, s42
    v_fmac_f32 v155, v49, v49
    v_mfma_f32_16x16x32_bf16 v[4:7], v[220:223], v[168:171], v[4:7]
    v_fmac_f32 v155, v50, v50
    v_fmac_f32 v155, v51, v51
    v_mfma_f32_16x16x32_bf16 v[20:23], v[24:27], v[80:83], 0
    s_nop 0
    v_fmac_f32 v155, v108, v108
    v_fmac_f32 v155, v109, v109
    v_mfma_f32_16x16x32_bf16 v[20:23], v[164:167], v[168:171], v[20:23]
    s_nop 0
    v_rcp_f32 v4, v4
    v_mfma_f32_16x16x32_bf16 v[24:27], v[28:31], v[80:83], 0
    s_nop 0
    v_fmac_f32 v155, v110, v110
    v_fmac_f32 v155, v111, v111
    v_mfma_f32_16x16x32_bf16 v[24:27], v[160:163], v[168:171], v[24:27]
    s_nop 0
    v_mul_f32 v20, v20, v4
    v_mul_f32 v21, v21, v4
    v_mfma_f32_16x16x32_bf16 v[28:31], v[44:47], v[80:83], 0
    v_cvt_pk_bf16_f32 v44, v20, v21
    v_mul_f32 v22, v22, v4
    v_mfma_f32_16x16x32_bf16 v[28:31], v[156:159], v[168:171], v[28:31]
    s_waitcnt lgkmcnt(0)
    v_mul_f32 v23, v23, v4
    v_cvt_pk_bf16_f32 v45, v22, v23
    v_mfma_f32_16x16x32_bf16 v[20:23], a[0:3], v[8:11], 0
    s_cbranch_scc1 L_loopS0
    ds_write_b64 v137, v[44:45] offset:3072
    v_mul_f32 v24, v24, v4
    v_mul_f32 v25, v25, v4
    v_cvt_pk_bf16_f32 v46, v24, v25
    v_mul_f32 v26, v26, v4
    v_mul_f32 v27, v27, v4
    v_cvt_pk_bf16_f32 v47, v26, v27
    v_mul_f32 v28, v28, v4
    v_mul_f32 v29, v29, v4
    v_cvt_pk_bf16_f32 v28, v28, v29
    v_mul_f32 v30, v30, v4
    v_mul_f32 v31, v31, v4
    v_cvt_pk_bf16_f32 v29, v30, v31
    s_mov_b32 s30, 100270464
    s_mul_i32 s89, s68, 5376
    ds_write_b64 v137, v[46:47] offset:3080
    v_fmac_f32 v155, v52, v52
    s_add_u32 s89, s89, 142336
    s_movk_i32 s90, 336
    ds_write_b64 v136, v[28:29] offset:3072
    v_fmac_f32 v155, v53, v53
    v_fmac_f32 v155, v54, v54
    v_fmac_f32 v155, v55, v55
    v_fma_f32 v125, v12, v12, s42
    v_fmac_f32 v125, v13, v13
    v_fmac_f32 v125, v14, v14
    v_fmac_f32 v125, v15, v15
    v_fmac_f32 v125, v16, v16
    v_fmac_f32 v125, v17, v17
    v_fmac_f32 v125, v18, v18
    v_fmac_f32 v125, v19, v19
    v_fmac_f32 v125, v56, v56
    v_fmac_f32 v125, v57, v57
    v_fmac_f32 v125, v58, v58
    v_fmac_f32 v125, v59, v59
    v_cvt_pk_bf16_f32 v0, v154, v155
    v_cvt_pk_bf16_f32 v1, v125, v124
    s_lshr_b32 s91, s64, 16
    s_lshl_b32 s92, s68, 10
    ds_write_b64 v132, v[0:1]
    v_mbcnt_lo_u32_b32 v124, -1, 0
    v_mbcnt_hi_u32_b32 v124, -1, v124
    v_and_b32 v47, 15, v124
    v_lshrrev_b32 v124, 4, v124
    v_mul_u32_u24 v44, 80, v124
    v_add_u32 v44, s89, v44
    v_mad_u32_u24 v45, v47, s90, v44
    v_lshrrev_b32 v46, v47, s64
    v_and_b32 v46, 1, v46
    v_cmp_eq_u32 vcc, 1, v46
    v_mad_u32_u24 v46, v47, s90, v44
    v_lshrrev_b32 v47, v47, s91
    v_cndmask_b32 v45, v44, v45, vcc
    v_and_b32 v47, 1, v47
    v_subrev_u32 v46, 21504, v46
    v_cmp_eq_u32 vcc, 1, v47
    s_sub_u32 s84, s45, s44
    s_sub_u32 s85, s46, s45
    ds_read_b128 v[60:63], v45
    ds_read_b128 v[24:27], v45 offset:16
    v_cndmask_b32 v46, v44, v46, vcc
    v_add_u32 v44, s92, v131
    s_waitcnt lgkmcnt(2)
    s_barrier
    s_sub_u32 s86, s44, s45
    ds_read_b64 v[102:103], v45 offset:56
    ds_read_b128 v[104:107], v45 offset:64
    v_add_u32 v28, s84, v139
    v_add_u32 v47, s84, v138
    s_sub_u32 s93, s44, s47
    s_sub_u32 s94, s45, s47
    ds_read_b128 v[4:7], v44 offset:6144
    v_add_u32 v45, s85, v137
    s_sub_u32 s95, s46, s47
    ds_read_b128 v[20:23], v131 offset:0
    v_add_u32 v44, s85, v136
    ds_read_b128 v[0:3], v131 offset:1024
    v_add_u32 v133, s86, v137
    v_add_u32 v125, s86, v136
    v_add_u32 v124, s93, v135
    v_add_u32 v134, s94, v135
    s_waitcnt lgkmcnt(6)
    v_mfma_f32_16x16x32_bf16 v[8:11], v[220:223], v[60:63], 0
    s_waitcnt lgkmcnt(5)
    ds_read_b128 v[92:95], v28 offset:1536
    ds_read_b128 v[88:91], v47 offset:1536
    v_mfma_f32_16x16x32_bf16 v[8:11], v[220:223], v[24:27], v[8:11]
    s_waitcnt lgkmcnt(3)
    ds_read_b128 v[84:87], v28 offset:1664
    v_lshlrev_b32 v96, 16, v102
    v_and_b32 v102, 0xffff0000, v102
    v_lshlrev_b32 v97, 16, v103
    v_and_b32 v103, 0xffff0000, v103
    v_lshlrev_b32 v98, 16, v104
    v_and_b32 v104, 0xffff0000, v104
    v_rcp_f32 v8, v8
    v_lshlrev_b32 v99, 16, v105
    v_mfma_f32_16x16x32_bf16 v[60:63], v[216:219], v[20:23], 0
    s_waitcnt lgkmcnt(3)
    ds_read_b128 v[80:83], v47 offset:1664
    ds_read_b128 v[76:79], v28 offset:1792
    v_mfma_f32_16x16x32_bf16 v[60:63], v[216:219], v[0:3], v[60:63]
    s_waitcnt lgkmcnt(4)
    ds_read_b128 v[72:75], v47 offset:1792
    v_mul_f32 v96, v96, v8
    v_mul_f32 v102, v102, v8
    v_cvt_pk_bf16_f32 v96, v96, v102
    v_mul_f32 v97, v97, v8
    v_mfma_f32_16x16x32_bf16 v[0:3], a[216:219], v[92:95], 0
    s_waitcnt lgkmcnt(4)
    v_mul_f32 v103, v103, v8
    v_cvt_pk_bf16_f32 v97, v97, v103
    v_mfma_f32_16x16x32_bf16 v[0:3], a[220:223], v[88:91], v[0:3]
    s_waitcnt lgkmcnt(3)
    ds_read_b128 v[116:119], v28 offset:0
    ds_read_b128 v[112:115], v47 offset:0
    v_mfma_f32_16x16x32_bf16 v[0:3], a[224:227], v[84:87], v[0:3]
    s_waitcnt lgkmcnt(4)
    ds_read_b128 v[100:103], v28 offset:128
    v_mul_f32 v98, v98, v8
    v_mul_f32 v104, v104, v8
    v_cvt_pk_bf16_f32 v98, v98, v104
    v_and_b32 v105, 0xffff0000, v105
    v_mul_f32 v99, v99, v8
    v_mfma_f32_16x16x32_bf16 v[0:3], a[228:231], v[80:83], v[0:3]
    s_waitcnt lgkmcnt(4)
    ds_read_b128 v[68:71], v47 offset:128
    ds_read_b128 v[64:67], v28 offset:256
    v_mfma_f32_16x16x32_bf16 v[0:3], a[232:235], v[76:79], v[0:3]
    s_waitcnt lgkmcnt(5)
    ds_read_b128 v[20:23], v47 offset:256
    v_mul_f32 v105, v105, v8
    v_mfma_f32_16x16x32_bf16 v[0:3], a[236:239], v[72:75], v[0:3]
    v_cvt_pk_bf16_f32 v99, v99, v105
    v_lshlrev_b32 v63, 16, v106
    v_mfma_f32_16x16x32_bf16 v[24:27], a[240:243], v[92:95], 0
    ds_write_b128 v133, v[96:99] offset:0
    v_mfma_f32_16x16x32_bf16 v[24:27], a[244:247], v[88:91], v[24:27]
    v_and_b32 v106, 0xffff0000, v106
    v_mul_f32 v63, v63, v8
    v_mfma_f32_16x16x32_bf16 v[24:27], a[248:251], v[84:87], v[24:27]
    v_mul_f32 v106, v106, v8
    v_cvt_pk_bf16_f32 v30, v63, v106
    v_mfma_f32_16x16x32_bf16 v[24:27], a[252:255], v[80:83], v[24:27]
    v_lshlrev_b32 v63, 16, v107
    v_and_b32 v107, 0xffff0000, v107
    v_mfma_f32_16x16x32_bf16 v[24:27], v[224:227], v[76:79], v[24:27]
    v_mul_f32 v63, v63, v8
    v_mul_f32 v107, v107, v8
    v_mfma_f32_16x16x32_bf16 v[24:27], v[228:231], v[72:75], v[24:27]
    v_cvt_pk_bf16_f32 v31, v63, v107
    v_lshrrev_b32 v63, 0, v7
    v_mfma_f32_16x16x32_bf16 v[8:11], v[232:235], v[92:95], 0
    ds_write_b64 v125, v[30:31] offset:0
    v_mfma_f32_16x16x32_bf16 v[8:11], v[236:239], v[88:91], v[8:11]
    v_lshrrev_b32 v63, v63, s64
    v_and_b32 v63, 1, v63
    v_mfma_f32_16x16x32_bf16 v[8:11], v[240:243], v[84:87], v[8:11]
    v_cmp_eq_u32 vcc, 1, v63
    v_lshrrev_b32 v63, 8, v7
    v_mfma_f32_16x16x32_bf16 v[8:11], v[244:247], v[80:83], v[8:11]
    v_cndmask_b32 v4, 2.0, v4, vcc
    v_lshrrev_b32 v63, v63, s64
    v_mfma_f32_16x16x32_bf16 v[8:11], v[248:251], v[76:79], v[8:11]
    v_and_b32 v63, 1, v63
    v_cmp_eq_u32 vcc, 1, v63
    v_mfma_f32_16x16x32_bf16 v[8:11], v[252:255], v[72:75], v[8:11]
    s_waitcnt lgkmcnt(1)
    v_cndmask_b32 v5, 2.0, v5, vcc
    v_lshrrev_b32 v7, 16, v7
    v_mfma_f32_16x16x32_bf16 v[72:75], a[216:219], v[116:119], 0
    v_lshrrev_b32 v7, v7, s64
    v_and_b32 v7, 1, v7
    v_mfma_f32_16x16x32_bf16 v[72:75], a[220:223], v[112:115], v[72:75]
    ds_read_b128 v[104:107], v28 offset:3072
    ds_read_b128 v[96:99], v47 offset:3072
    v_mfma_f32_16x16x32_bf16 v[72:75], a[224:227], v[100:103], v[72:75]
    ds_read_b128 v[92:95], v28 offset:3200
    v_cmp_eq_u32 vcc, 1, v7
    v_mfma_f32_16x16x32_bf16 v[72:75], a[228:231], v[68:71], v[72:75]
    ds_read_b128 v[88:91], v47 offset:3200
    v_cndmask_b32 v6, 2.0, v6, vcc
    v_mfma_f32_16x16x32_bf16 v[72:75], a[232:235], v[64:67], v[72:75]
    ds_read_b128 v[84:87], v28 offset:3328
    v_add_u32 v7, s95, v135
    v_mfma_f32_16x16x32_bf16 v[72:75], a[236:239], v[20:23], v[72:75]
    ds_read_b128 v[28:31], v47 offset:3328
    v_fma_f32 v135, v0, v0, s42
    v_mfma_f32_16x16x32_bf16 v[76:79], a[240:243], v[116:119], 0
    v_rsq_f32 v60, v60
    v_mfma_f32_16x16x32_bf16 v[76:79], a[244:247], v[112:115], v[76:79]
    v_mul_f32 v60, s43, v60
    v_mul_f32 v40, v40, v60
    v_mfma_f32_16x16x32_bf16 v[76:79], a[248:251], v[100:103], v[76:79]
    v_mul_f32 v41, v41, v60
    v_cvt_pk_bf16_f32 v80, v40, v41
    v_mfma_f32_16x16x32_bf16 v[76:79], a[252:255], v[68:71], v[76:79]
    v_mul_f32 v42, v42, v60
    v_mul_f32 v43, v43, v60
    v_mfma_f32_16x16x32_bf16 v[76:79], v[224:227], v[64:67], v[76:79]
    v_cvt_pk_bf16_f32 v81, v42, v43
    v_mul_f32 v36, v36, v60
    v_mfma_f32_16x16x32_bf16 v[76:79], v[228:231], v[20:23], v[76:79]
    v_mul_f32 v37, v37, v60
    v_cvt_pk_bf16_f32 v82, v36, v37
    v_mfma_f32_16x16x32_bf16 v[40:43], v[232:235], v[116:119], 0
    v_mul_f32 v38, v38, v60
    v_mul_f32 v39, v39, v60
    v_mfma_f32_16x16x32_bf16 v[40:43], v[236:239], v[112:115], v[40:43]
    v_cvt_pk_bf16_f32 v83, v38, v39
    v_mul_f32 v32, v32, v60
    v_mfma_f32_16x16x32_bf16 v[40:43], v[240:243], v[100:103], v[40:43]
    ds_write_b128 v45, v[80:83] offset:0
    v_mfma_f32_16x16x32_bf16 v[40:43], v[244:247], v[68:71], v[40:43]
    v_mul_f32 v33, v33, v60
    v_cvt_pk_bf16_f32 v32, v32, v33
    v_mfma_f32_16x16x32_bf16 v[40:43], v[248:251], v[64:67], v[40:43]
    v_mul_f32 v34, v34, v60
    v_mul_f32 v35, v35, v60
    v_mfma_f32_16x16x32_bf16 v[40:43], v[252:255], v[20:23], v[40:43]
    s_waitcnt lgkmcnt(1)
    v_cvt_pk_bf16_f32 v33, v34, v35
    v_fma_f32 v38, v72, v72, s42
    v_mfma_f32_16x16x32_bf16 v[20:23], a[216:219], v[104:107], 0
    ds_write_b64 v44, v[32:33] offset:0
    v_mfma_f32_16x16x32_bf16 v[20:23], a[220:223], v[96:99], v[20:23]
    ds_read_b128 v[68:71], v46
    v_fmac_f32 v38, v73, v73
    v_mfma_f32_16x16x32_bf16 v[20:23], a[224:227], v[92:95], v[20:23]
    ds_read_b128 v[64:67], v46 offset:16
    v_fmac_f32 v38, v74, v74
    v_mfma_f32_16x16x32_bf16 v[20:23], a[228:231], v[88:91], v[20:23]
    ds_read_b64 v[32:33], v46 offset:56
    ds_read_b128 v[34:37], v46 offset:64
    v_mfma_f32_16x16x32_bf16 v[20:23], a[232:235], v[84:87], v[20:23]
    v_rsq_f32 v61, v61
    v_mfma_f32_16x16x32_bf16 v[20:23], a[236:239], v[28:31], v[20:23]
    v_mul_f32 v61, s43, v61
    v_mul_f32 v48, v48, v61
    v_mfma_f32_16x16x32_bf16 v[100:103], a[240:243], v[104:107], 0
    v_mul_f32 v49, v49, v61
    v_cvt_pk_bf16_f32 v48, v48, v49
    v_mfma_f32_16x16x32_bf16 v[100:103], a[244:247], v[96:99], v[100:103]
    v_mul_f32 v50, v50, v61
    v_mul_f32 v51, v51, v61
    v_mfma_f32_16x16x32_bf16 v[100:103], a[248:251], v[92:95], v[100:103]
    v_cvt_pk_bf16_f32 v49, v50, v51
    v_mul_f32 v108, v108, v61
    v_mfma_f32_16x16x32_bf16 v[100:103], a[252:255], v[88:91], v[100:103]
    v_mul_f32 v109, v109, v61
    v_cvt_pk_bf16_f32 v50, v108, v109
    v_mfma_f32_16x16x32_bf16 v[100:103], v[224:227], v[84:87], v[100:103]
    v_mul_f32 v110, v110, v61
    v_mul_f32 v111, v111, v61
    v_mfma_f32_16x16x32_bf16 v[100:103], v[228:231], v[28:31], v[100:103]
    v_cvt_pk_bf16_f32 v51, v110, v111
    v_mul_f32 v52, v52, v61
    v_mfma_f32_16x16x32_bf16 v[80:83], v[232:235], v[104:107], 0
    ds_write_b128 v45, v[48:51] offset:1536
    v_mfma_f32_16x16x32_bf16 v[80:83], v[236:239], v[96:99], v[80:83]
    v_mul_f32 v53, v53, v61
    v_cvt_pk_bf16_f32 v46, v52, v53
    v_mfma_f32_16x16x32_bf16 v[80:83], v[240:243], v[92:95], v[80:83]
    v_mul_f32 v54, v54, v61
    v_mul_f32 v55, v55, v61
    v_mfma_f32_16x16x32_bf16 v[80:83], v[244:247], v[88:91], v[80:83]
    v_cvt_pk_bf16_f32 v47, v54, v55
    v_fmac_f32 v38, v75, v75
    v_mfma_f32_16x16x32_bf16 v[80:83], v[248:251], v[84:87], v[80:83]
    ds_write_b64 v44, v[46:47] offset:1536
    v_mfma_f32_16x16x32_bf16 v[80:83], v[252:255], v[28:31], v[80:83]
    s_waitcnt lgkmcnt(2)
    v_rsq_f32 v62, v62
    v_mfma_f32_16x16x32_bf16 v[28:31], v[220:223], v[68:71], 0
    v_mul_f32 v62, s43, v62
    v_mul_f32 v12, v12, v62
    v_mfma_f32_16x16x32_bf16 v[28:31], v[220:223], v[64:67], v[28:31]
    v_mul_f32 v13, v13, v62
    v_cvt_pk_bf16_f32 v12, v12, v13
    v_mul_f32 v14, v14, v62
    v_mul_f32 v15, v15, v62
    v_cvt_pk_bf16_f32 v13, v14, v15
    v_mul_f32 v16, v16, v62
    v_mul_f32 v17, v17, v62
    v_cvt_pk_bf16_f32 v14, v16, v17
    v_mul_f32 v18, v18, v62
    v_mul_f32 v19, v19, v62
    v_cvt_pk_bf16_f32 v15, v18, v19
    v_mul_f32 v56, v56, v62
    v_mul_f32 v57, v57, v62
    v_cvt_pk_bf16_f32 v56, v56, v57
    v_mul_f32 v58, v58, v62
    v_mul_f32 v59, v59, v62
    v_cvt_pk_bf16_f32 v57, v58, v59
    ds_write_b128 v45, v[12:15] offset:3072
    v_fmac_f32 v38, v76, v76
    v_fmac_f32 v38, v77, v77
    v_fmac_f32 v38, v78, v78
    v_fmac_f32 v38, v79, v79
    ds_write_b64 v44, v[56:57] offset:3072
    v_fmac_f32 v38, v40, v40
    v_fmac_f32 v38, v41, v41
    v_fmac_f32 v38, v42, v42
    v_fmac_f32 v38, v43, v43
    v_fmac_f32 v135, v1, v1
    v_fmac_f32 v135, v2, v2
    v_fmac_f32 v135, v3, v3
    v_fmac_f32 v135, v24, v24
    v_fmac_f32 v135, v25, v25
    v_fmac_f32 v135, v26, v26
    v_fmac_f32 v135, v27, v27
    v_fmac_f32 v135, v8, v8
    v_fmac_f32 v135, v9, v9
    v_fmac_f32 v135, v10, v10
    v_fmac_f32 v135, v11, v11
    v_cvt_pk_bf16_f32 v38, v38, v135
    v_fma_f32 v39, v20, v20, s42
    v_fmac_f32 v39, v21, v21
    v_fmac_f32 v39, v22, v22
    v_fmac_f32 v39, v23, v23
    v_fmac_f32 v39, v100, v100
    v_fmac_f32 v39, v101, v101
    v_fmac_f32 v39, v102, v102
    v_fmac_f32 v39, v103, v103
    v_fmac_f32 v39, v80, v80
    v_fmac_f32 v39, v81, v81
    v_fmac_f32 v39, v82, v82
    v_fmac_f32 v39, v83, v83
    v_cvt_pk_bf16_f32 v39, v39, v39
    ds_write_b64 v132, v[38:39] offset:2048
    v_rcp_f32 v28, v28
    v_lshlrev_b32 v135, 16, v32
    v_and_b32 v32, 0xffff0000, v32
    v_mul_f32 v135, v135, v28
    v_mul_f32 v32, v32, v28
    v_cvt_pk_bf16_f32 v12, v135, v32
    v_lshlrev_b32 v32, 16, v33
    v_and_b32 v33, 0xffff0000, v33
    v_mul_f32 v32, v32, v28
    v_mul_f32 v33, v33, v28
    v_cvt_pk_bf16_f32 v13, v32, v33
    v_lshlrev_b32 v135, 16, v34
    v_and_b32 v34, 0xffff0000, v34
    v_mul_f32 v135, v135, v28
    v_mul_f32 v34, v34, v28
    v_cvt_pk_bf16_f32 v14, v135, v34
    v_lshlrev_b32 v15, 16, v35
    v_and_b32 v35, 0xffff0000, v35
    v_mul_f32 v15, v15, v28
    v_mul_f32 v35, v35, v28
    v_cvt_pk_bf16_f32 v15, v15, v35
    v_lshlrev_b32 v135, 16, v36
    v_and_b32 v36, 0xffff0000, v36
    v_mul_f32 v135, v135, v28
    v_mul_f32 v36, v36, v28
    v_cvt_pk_bf16_f32 v34, v135, v36
    v_lshlrev_b32 v135, 16, v37
    v_and_b32 v37, 0xffff0000, v37
    v_mul_f32 v135, v135, v28
    v_mul_f32 v37, v37, v28
    v_cvt_pk_bf16_f32 v35, v135, v37
    s_waitcnt lgkmcnt(0)
    s_barrier
    ds_write_b128 v133, v[12:15] offset:1536
    v_mov_b32 v33, 0
    ds_write_b64 v125, v[34:35] offset:1536
    ds_read_b128 v[36:39], v7 offset:0
    ds_read_b128 v[12:15], v7 offset:1024
    ds_read_b128 v[28:31], v7 offset:2048
    ds_read_b128 v[112:115], v7 offset:3072
    ds_read_b128 v[84:87], v7 offset:4096
    s_waitcnt lgkmcnt(5)
    s_barrier
    s_waitcnt lgkmcnt(4)
    buffer_store_dwordx4 v[36:39], v130, s[28:31], s59 offen sc1
    ds_read_b128 v[44:47], v131 offset:2048
    ds_read_b128 v[16:19], v131 offset:3072
    ds_read_b128 v[108:111], v139 offset:1536
    ds_read_b128 v[104:107], v138 offset:1536
    ds_read_b128 v[96:99], v139 offset:1664
    ds_read_b128 v[92:95], v138 offset:1664
    ds_read_b128 v[48:51], v139 offset:1792
    s_waitcnt lgkmcnt(9)
    buffer_store_dwordx4 v[12:15], v129, s[28:31], s59 offen sc1
    ds_read_b128 v[36:39], v138 offset:1792
    s_waitcnt lgkmcnt(7)
    v_mfma_f32_16x16x32_bf16 v[12:15], v[216:219], v[44:47], 0
    s_waitcnt lgkmcnt(6)
    v_mfma_f32_16x16x32_bf16 v[12:15], v[216:219], v[16:19], v[12:15]
    s_waitcnt lgkmcnt(5)
    v_mfma_f32_16x16x32_bf16 v[16:19], a[216:219], v[108:111], 0
    s_waitcnt lgkmcnt(4)
    v_mfma_f32_16x16x32_bf16 v[16:19], a[220:223], v[104:107], v[16:19]
    s_waitcnt lgkmcnt(3)
    ds_read_b128 v[68:71], v139 offset:0
    ds_read_b128 v[64:67], v138 offset:0
    v_mfma_f32_16x16x32_bf16 v[16:19], a[224:227], v[96:99], v[16:19]
    s_waitcnt lgkmcnt(4)
    ds_read_b128 v[60:63], v139 offset:128
    v_mfma_f32_16x16x32_bf16 v[16:19], a[228:231], v[92:95], v[16:19]
    s_waitcnt lgkmcnt(4)
    buffer_store_dwordx4 v[28:31], v128, s[28:31], s59 offen sc1
    ds_read_b128 v[56:59], v138 offset:128
    v_rsq_f32 v12, v12
    v_mfma_f32_16x16x32_bf16 v[16:19], a[232:235], v[48:51], v[16:19]
    s_waitcnt lgkmcnt(4)
    ds_read_b128 v[52:55], v139 offset:256
    ds_read_b128 v[44:47], v138 offset:256
    v_mfma_f32_16x16x32_bf16 v[16:19], a[236:239], v[36:39], v[16:19]
    v_rsq_f32 v13, v13
    v_mfma_f32_16x16x32_bf16 v[28:31], a[240:243], v[108:111], 0
    v_mul_f32 v12, s43, v12
    v_mul_f32 v13, s43, v13
    v_mfma_f32_16x16x32_bf16 v[28:31], a[244:247], v[104:107], v[28:31]
    v_rsq_f32 v14, v14
    v_mfma_f32_16x16x32_bf16 v[28:31], a[248:251], v[96:99], v[28:31]
    v_mul_f32 v14, s43, v14
    v_mul_f32 v20, v20, v14
    v_mfma_f32_16x16x32_bf16 v[28:31], a[252:255], v[92:95], v[28:31]
    buffer_store_dwordx4 v[112:115], v127, s[28:31], s59 offen sc1
    v_mul_f32 v21, v21, v14
    v_cvt_pk_bf16_f32 v88, v20, v21
    v_mul_f32 v22, v22, v14
    v_mul_f32 v23, v23, v14
    v_mfma_f32_16x16x32_bf16 v[28:31], v[224:227], v[48:51], v[28:31]
    v_cvt_pk_bf16_f32 v89, v22, v23
    v_mul_f32 v100, v100, v14
    v_mfma_f32_16x16x32_bf16 v[28:31], v[228:231], v[36:39], v[28:31]
    v_mul_f32 v101, v101, v14
    v_cvt_pk_bf16_f32 v90, v100, v101
    v_mfma_f32_16x16x32_bf16 v[20:23], v[232:235], v[108:111], 0
    v_mul_f32 v102, v102, v14
    v_mul_f32 v103, v103, v14
    v_mfma_f32_16x16x32_bf16 v[20:23], v[236:239], v[104:107], v[20:23]
    v_cvt_pk_bf16_f32 v91, v102, v103
    v_mul_f32 v80, v80, v14
    v_mfma_f32_16x16x32_bf16 v[20:23], v[240:243], v[96:99], v[20:23]
    ds_write_b128 v137, v[88:91] offset:3072
    v_mfma_f32_16x16x32_bf16 v[20:23], v[244:247], v[92:95], v[20:23]
    buffer_store_dwordx4 v[84:87], v126, s[28:31], s59 offen sc1
    v_mul_f32 v81, v81, v14
    v_cvt_pk_bf16_f32 v138, v80, v81
    v_mul_f32 v82, v82, v14
    v_mul_f32 v83, v83, v14
    v_mfma_f32_16x16x32_bf16 v[20:23], v[248:251], v[48:51], v[20:23]
    v_cvt_pk_bf16_f32 v139, v82, v83
    v_mul_f32 v72, v72, v12
    v_mfma_f32_16x16x32_bf16 v[20:23], v[252:255], v[36:39], v[20:23]
    s_waitcnt lgkmcnt(1)
    ds_write_b64 v136, v[138:139] offset:3072
    v_mfma_f32_16x16x32_bf16 v[36:39], a[216:219], v[68:71], 0
    v_mul_f32 v73, v73, v12
    v_cvt_pk_bf16_f32 v72, v72, v73
    v_mfma_f32_16x16x32_bf16 v[36:39], a[220:223], v[64:67], v[36:39]
    v_mul_f32 v74, v74, v12
    v_mul_f32 v75, v75, v12
    v_mfma_f32_16x16x32_bf16 v[36:39], a[224:227], v[60:63], v[36:39]
    v_cvt_pk_bf16_f32 v73, v74, v75
    v_mul_f32 v76, v76, v12
    v_mfma_f32_16x16x32_bf16 v[36:39], a[228:231], v[56:59], v[36:39]
    v_mul_f32 v77, v77, v12
    v_cvt_pk_bf16_f32 v74, v76, v77
    v_mfma_f32_16x16x32_bf16 v[36:39], a[232:235], v[52:55], v[36:39]
    v_mul_f32 v78, v78, v12
    v_mul_f32 v79, v79, v12
    v_mfma_f32_16x16x32_bf16 v[36:39], a[236:239], v[44:47], v[36:39]
    v_cvt_pk_bf16_f32 v75, v78, v79
    v_mul_f32 v40, v40, v12
    v_mfma_f32_16x16x32_bf16 v[48:51], a[240:243], v[68:71], 0
    ds_write_b128 v137, v[72:75] offset:0
    v_mfma_f32_16x16x32_bf16 v[48:51], a[244:247], v[64:67], v[48:51]
    v_mul_f32 v41, v41, v12
    v_cvt_pk_bf16_f32 v14, v40, v41
    v_mfma_f32_16x16x32_bf16 v[48:51], a[248:251], v[60:63], v[48:51]
    v_mul_f32 v42, v42, v12
    v_mul_f32 v43, v43, v12
    v_mfma_f32_16x16x32_bf16 v[48:51], a[252:255], v[56:59], v[48:51]
    v_cvt_pk_bf16_f32 v15, v42, v43
    v_fma_f32 v7, v16, v16, s42
    v_mfma_f32_16x16x32_bf16 v[48:51], v[224:227], v[52:55], v[48:51]
    ds_write_b64 v136, v[14:15] offset:0
    v_mfma_f32_16x16x32_bf16 v[48:51], v[228:231], v[44:47], v[48:51]
    v_fmac_f32 v7, v17, v17
    v_fmac_f32 v7, v18, v18
    v_mfma_f32_16x16x32_bf16 v[40:43], v[232:235], v[68:71], 0
    v_fmac_f32 v7, v19, v19
    v_fmac_f32 v7, v28, v28
    v_mfma_f32_16x16x32_bf16 v[40:43], v[236:239], v[64:67], v[40:43]
    v_fmac_f32 v7, v29, v29
    v_fmac_f32 v7, v30, v30
    v_mfma_f32_16x16x32_bf16 v[40:43], v[240:243], v[60:63], v[40:43]
    v_fmac_f32 v7, v31, v31
    v_fmac_f32 v7, v20, v20
    v_mfma_f32_16x16x32_bf16 v[40:43], v[244:247], v[56:59], v[40:43]
    v_fmac_f32 v7, v21, v21
    v_fmac_f32 v7, v22, v22
    v_mfma_f32_16x16x32_bf16 v[40:43], v[248:251], v[52:55], v[40:43]
    v_fmac_f32 v7, v23, v23
    v_fma_f32 v135, v36, v36, s42
    v_mfma_f32_16x16x32_bf16 v[40:43], v[252:255], v[44:47], v[40:43]
    s_nop 0
    v_fmac_f32 v135, v37, v37
    v_fmac_f32 v135, v38, v38
    v_fmac_f32 v135, v39, v39
    v_fmac_f32 v135, v48, v48
    v_fmac_f32 v135, v49, v49
    v_fmac_f32 v135, v50, v50
    v_fmac_f32 v135, v51, v51
    v_fmac_f32 v135, v40, v40
    v_fmac_f32 v135, v41, v41
    v_fmac_f32 v135, v42, v42
    v_fmac_f32 v135, v43, v43
    v_cvt_pk_bf16_f32 v32, v135, v7
    ds_write_b64 v132, v[32:33] offset:4096
    v_mul_f32 v0, v0, v13
    v_mul_f32 v1, v1, v13
    v_cvt_pk_bf16_f32 v0, v0, v1
    v_mul_f32 v2, v2, v13
    v_mul_f32 v3, v3, v13
    v_cvt_pk_bf16_f32 v1, v2, v3
    v_mul_f32 v24, v24, v13
    v_mul_f32 v25, v25, v13
    v_cvt_pk_bf16_f32 v2, v24, v25
    v_mul_f32 v26, v26, v13
    v_mul_f32 v27, v27, v13
    v_cvt_pk_bf16_f32 v3, v26, v27
    v_mul_f32 v8, v8, v13
    v_mul_f32 v9, v9, v13
    v_cvt_pk_bf16_f32 v138, v8, v9
    v_mul_f32 v10, v10, v13
    v_mul_f32 v11, v11, v13
    v_cvt_pk_bf16_f32 v139, v10, v11
    ds_write_b128 v137, v[0:3] offset:1536
    s_waitcnt lgkmcnt(1)
    s_barrier
    ds_write_b64 v136, v[138:139] offset:1536
    ds_read_b128 v[8:11], v131 offset:4096
    ds_read_b128 v[0:3], v131 offset:5120
    s_waitcnt lgkmcnt(2)
    s_barrier
    s_waitcnt lgkmcnt(1)
    v_mfma_f32_16x16x32_bf16 v[24:27], v[216:219], v[8:11], 0
    s_waitcnt lgkmcnt(0)
    ds_read_b128 v[44:47], v134 offset:0
    ds_read_b128 v[32:35], v134 offset:1024
    v_mfma_f32_16x16x32_bf16 v[24:27], v[216:219], v[0:3], v[24:27]
    s_nop 0
    ds_read_b128 v[12:15], v134 offset:2048
    s_nop 2
    ds_read_b128 v[8:11], v134 offset:3072
    s_nop 1
    v_rsq_f32 v24, v24
    ds_read_b128 v[0:3], v134 offset:4096
    v_mul_f32 v24, s43, v24
    v_mul_f32 v36, v36, v24
    v_mul_f32 v37, v37, v24
    v_cvt_pk_bf16_f32 v36, v36, v37
    v_mul_f32 v38, v38, v24
    v_mul_f32 v39, v39, v24
    v_cvt_pk_bf16_f32 v37, v38, v39
    v_mul_f32 v48, v48, v24
    v_mul_f32 v49, v49, v24
    s_waitcnt lgkmcnt(4)
    buffer_store_dwordx4 v[44:47], v130, s[28:31], s58 offen sc1
    v_cvt_pk_bf16_f32 v38, v48, v49
    v_mul_f32 v50, v50, v24
    v_mul_f32 v51, v51, v24
    v_cvt_pk_bf16_f32 v39, v50, v51
    v_mul_f32 v40, v40, v24
    v_mul_f32 v41, v41, v24
    v_cvt_pk_bf16_f32 v26, v40, v41
    v_mul_f32 v42, v42, v24
    v_mul_f32 v43, v43, v24
    v_cvt_pk_bf16_f32 v27, v42, v43
    ds_write_b128 v133, v[36:39] offset:0
    v_rsq_f32 v25, v25
    s_nop 0
    v_mul_f32 v25, s43, v25
    s_waitcnt lgkmcnt(1)
    buffer_store_dwordx4 v[32:35], v129, s[28:31], s58 offen sc1
    ds_write_b64 v125, v[26:27] offset:0
    v_mul_f32 v16, v16, v25
    v_mul_f32 v17, v17, v25
    v_cvt_pk_bf16_f32 v16, v16, v17
    v_mul_f32 v18, v18, v25
    v_mul_f32 v19, v19, v25
    v_cvt_pk_bf16_f32 v17, v18, v19
    v_mul_f32 v28, v28, v25
    v_mul_f32 v29, v29, v25
    v_cvt_pk_bf16_f32 v18, v28, v29
    v_mul_f32 v30, v30, v25
    v_mul_f32 v31, v31, v25
    v_cvt_pk_bf16_f32 v19, v30, v31
    v_mul_f32 v20, v20, v25
    v_mul_f32 v21, v21, v25
    v_cvt_pk_bf16_f32 v130, v20, v21
    v_mul_f32 v22, v22, v25
    v_mul_f32 v23, v23, v25
    v_cvt_pk_bf16_f32 v131, v22, v23
    buffer_store_dwordx4 v[12:15], v128, s[28:31], s58 offen sc1
    ds_write_b128 v133, v[16:19] offset:1536
    ds_write_b64 v125, v[130:131] offset:1536
    buffer_store_dwordx4 v[8:11], v127, s[28:31], s58 offen sc1
    s_waitcnt lgkmcnt(0)
    s_barrier
    buffer_store_dwordx4 v[0:3], v126, s[28:31], s58 offen sc1
    ds_read_b128 v[12:15], v124 offset:0
    ds_read_b128 v[8:11], v124 offset:1024
    ds_read_b128 v[0:3], v124 offset:2048
    s_waitcnt lgkmcnt(2)
    buffer_store_dwordx4 v[12:15], v4, s[28:31], 0 offen sc1
    s_waitcnt lgkmcnt(0)
    buffer_store_dwordx4 v[8:11], v5, s[28:31], 0 offen sc1
    buffer_store_dwordx4 v[0:3], v6, s[28:31], 0 offen sc1
    s_endpgm
L_bndF:
    s_movk_i32 s73, 24
    s_sub_u32 s70, s70, 20
    s_cmp_lt_u32 s2, 247
    s_cbranch_scc1 L_bndrF
    s_movk_i32 s73, 20
    s_movk_i32 s71, 18
    s_movk_i32 s70, -20
    s_mov_b32 s74, 0
    s_cmp_lt_u32 s2, 251
    s_cbranch_scc1 L_bndcF
    s_sub_u32 s94, s2, 251
    s_mul_i32 s69, s94, 18
    s_mov_b32 s74, 25239312
    s_sub_u32 s93, s93, 1373568
    v_cmp_le_u32 vcc, 4, v93
    v_add_u32 v4, 98896896, v130
    v_subrev_u32 v5, 1373568, v130
    v_cndmask_b32 v130, v4, v5, vcc
    v_cmp_le_u32 vcc, 4, v131
    v_add_u32 v4, 98896896, v129
    v_subrev_u32 v5, 1373568, v129
    v_cndmask_b32 v129, v4, v5, vcc
    v_cmp_le_u32 vcc, 4, v51
    v_add_u32 v4, 98896896, v128
    v_subrev_u32 v5, 1373568, v128
    v_cndmask_b32 v128, v4, v5, vcc
    v_cmp_le_u32 vcc, 4, v6
    v_add_u32 v4, 98896896, v127
    v_subrev_u32 v5, 1373568, v127
    v_cndmask_b32 v127, v4, v5, vcc
    v_cmp_le_u32 vcc, 4, v11
    v_add_u32 v4, 98896896, v126
    v_subrev_u32 v5, 1373568, v126
    v_cndmask_b32 v126, v4, v5, vcc
    s_cmp_lt_u32 s2, 255
    s_cbranch_scc1 L_bndrF
L_bndcF:
    s_sub_u32 s94, s2, 247
    s_mul_i32 s69, s94, 18
    s_mov_b32 s62, 1373568
    s_add_u32 s74, s74, 345744
    s_sub_u32 s93, s93, 2688
    v_mad_i32_i24 v4, v93, -7, v152
    v_cmp_le_u32 vcc, 4, v4
    v_add_u32 v4, 193536, v130
    v_subrev_u32 v5, 2688, v130
    v_cndmask_b32 v130, v4, v5, vcc
    v_mad_i32_i24 v4, v131, -7, v49
    v_cmp_le_u32 vcc, 4, v4
    v_add_u32 v4, 193536, v129
    v_subrev_u32 v5, 2688, v129
    v_cndmask_b32 v129, v4, v5, vcc
    v_mad_i32_i24 v4, v51, -7, v125
    v_cmp_le_u32 vcc, 4, v4
    v_add_u32 v4, 193536, v128
    v_subrev_u32 v5, 2688, v128
    v_cndmask_b32 v128, v4, v5, vcc
    v_mad_i32_i24 v4, v6, -7, v22
    v_cmp_le_u32 vcc, 4, v4
    v_add_u32 v4, 193536, v127
    v_subrev_u32 v5, 2688, v127
    v_cndmask_b32 v127, v4, v5, vcc
    v_mad_i32_i24 v4, v11, -7, v23
    v_cmp_le_u32 vcc, 4, v4
    v_add_u32 v4, 193536, v126
    v_subrev_u32 v5, 2688, v126
    v_cndmask_b32 v126, v4, v5, vcc
    s_cmp_eq_u32 s2, 255
    s_cselect_b32 s62, 0, s62
    s_cselect_b32 s69, 0, s69
    s_cselect_b32 s71, 2, s71
    s_branch L_bndrF
L_maskF:
    s_add_u32 s20, s20, s74
    s_addc_u32 s21, s21, 0
    s_mov_b32 s22, 4802
    s_mov_b32 s23, 0x20000
    s_mov_b32 s85, 0x3fb8aa3b
    s_waitcnt vmcnt(0)
    v_lshrrev_b32 v144, 2, v123
    v_add_u32 v144, 0, v144
    v_mul_u32_u24 v144, 98, v144
    v_mad_u32_u24 v145, v153, 24, v144
    buffer_load_ushort v63, v145, s[20:23], 0 offen offset:0
    buffer_load_ushort v62, v145, s[20:23], 0 offen offset:2
    buffer_load_ushort v236, v145, s[20:23], 0 offen offset:4
    buffer_load_ushort v1, v145, s[20:23], 0 offen offset:6
    buffer_load_ushort v148, v145, s[20:23], 0 offen offset:8
    buffer_load_ushort v237, v145, s[20:23], 0 offen offset:10
    buffer_load_ushort v152, v145, s[20:23], 0 offen offset:12
    buffer_load_ushort v141, v145, s[20:23], 0 offen offset:14
    buffer_load_ushort v94, v145, s[20:23], 0 offen offset:16
    buffer_load_ushort v143, v145, s[20:23], 0 offen offset:18
    buffer_load_ushort v149, v145, s[20:23], 0 offen offset:20
    buffer_load_ushort v2, v145, s[20:23], 0 offen offset:22
    buffer_load_ushort v93, v144, s[20:23], 0 offen offset:96
    s_waitcnt vmcnt(0)
    v_lshlrev_b32 v63, 16, v63
    v_fmac_f32 v204, s85, v63
    v_lshlrev_b32 v62, 16, v62
    v_fmac_f32 v205, s85, v62
    v_lshlrev_b32 v236, 16, v236
    v_fmac_f32 v206, s85, v236
    v_lshlrev_b32 v1, 16, v1
    v_fmac_f32 v207, s85, v1
    v_lshlrev_b32 v148, 16, v148
    v_fmac_f32 v200, s85, v148
    v_lshlrev_b32 v237, 16, v237
    v_fmac_f32 v201, s85, v237
    v_lshlrev_b32 v152, 16, v152
    v_fmac_f32 v202, s85, v152
    v_lshlrev_b32 v141, 16, v141
    v_fmac_f32 v203, s85, v141
    v_lshlrev_b32 v94, 16, v94
    v_fmac_f32 v196, s85, v94
    v_lshlrev_b32 v143, 16, v143
    v_fmac_f32 v197, s85, v143
    v_lshlrev_b32 v149, 16, v149
    v_fmac_f32 v198, s85, v149
    v_lshlrev_b32 v2, 16, v2
    v_fmac_f32 v199, s85, v2
    v_lshlrev_b32 v93, 16, v93
    v_fmac_f32 v208, s85, v93
    v_lshrrev_b32 v144, 2, v123
    v_add_u32 v144, 4, v144
    v_mul_u32_u24 v144, 98, v144
    v_mad_u32_u24 v145, v153, 24, v144
    buffer_load_ushort v63, v145, s[20:23], 0 offen offset:0
    buffer_load_ushort v62, v145, s[20:23], 0 offen offset:2
    buffer_load_ushort v236, v145, s[20:23], 0 offen offset:4
    buffer_load_ushort v1, v145, s[20:23], 0 offen offset:6
    buffer_load_ushort v148, v145, s[20:23], 0 offen offset:8
    buffer_load_ushort v237, v145, s[20:23], 0 offen offset:10
    buffer_load_ushort v152, v145, s[20:23], 0 offen offset:12
    buffer_load_ushort v141, v145, s[20:23], 0 offen offset:14
    buffer_load_ushort v94, v145, s[20:23], 0 offen offset:16
    buffer_load_ushort v143, v145, s[20:23], 0 offen offset:18
    buffer_load_ushort v149, v145, s[20:23], 0 offen offset:20
    buffer_load_ushort v2, v145, s[20:23], 0 offen offset:22
    buffer_load_ushort v93, v144, s[20:23], 0 offen offset:96
    s_waitcnt vmcnt(0)
    v_lshlrev_b32 v63, 16, v63
    v_fmac_f32 v192, s85, v63
    v_lshlrev_b32 v62, 16, v62
    v_fmac_f32 v193, s85, v62
    v_lshlrev_b32 v236, 16, v236
    v_fmac_f32 v194, s85, v236
    v_lshlrev_b32 v1, 16, v1
    v_fmac_f32 v195, s85, v1
    v_lshlrev_b32 v148, 16, v148
    v_fmac_f32 v188, s85, v148
    v_lshlrev_b32 v237, 16, v237
    v_fmac_f32 v189, s85, v237
    v_lshlrev_b32 v152, 16, v152
    v_fmac_f32 v190, s85, v152
    v_lshlrev_b32 v141, 16, v141
    v_fmac_f32 v191, s85, v141
    v_lshlrev_b32 v94, 16, v94
    v_fmac_f32 v184, s85, v94
    v_lshlrev_b32 v143, 16, v143
    v_fmac_f32 v185, s85, v143
    v_lshlrev_b32 v149, 16, v149
    v_fmac_f32 v186, s85, v149
    v_lshlrev_b32 v2, 16, v2
    v_fmac_f32 v187, s85, v2
    v_lshlrev_b32 v93, 16, v93
    v_fmac_f32 v209, s85, v93
    v_lshrrev_b32 v144, 2, v123
    v_add_u32 v144, 8, v144
    v_mul_u32_u24 v144, 98, v144
    v_mad_u32_u24 v145, v153, 24, v144
    buffer_load_ushort v63, v145, s[20:23], 0 offen offset:0
    buffer_load_ushort v62, v145, s[20:23], 0 offen offset:2
    buffer_load_ushort v236, v145, s[20:23], 0 offen offset:4
    buffer_load_ushort v1, v145, s[20:23], 0 offen offset:6
    buffer_load_ushort v148, v145, s[20:23], 0 offen offset:8
    buffer_load_ushort v237, v145, s[20:23], 0 offen offset:10
    buffer_load_ushort v152, v145, s[20:23], 0 offen offset:12
    buffer_load_ushort v141, v145, s[20:23], 0 offen offset:14
    buffer_load_ushort v94, v145, s[20:23], 0 offen offset:16
    buffer_load_ushort v143, v145, s[20:23], 0 offen offset:18
    buffer_load_ushort v149, v145, s[20:23], 0 offen offset:20
    buffer_load_ushort v2, v145, s[20:23], 0 offen offset:22
    buffer_load_ushort v93, v144, s[20:23], 0 offen offset:96
    s_waitcnt vmcnt(0)
    v_lshlrev_b32 v63, 16, v63
    v_fmac_f32 v180, s85, v63
    v_lshlrev_b32 v62, 16, v62
    v_fmac_f32 v181, s85, v62
    v_lshlrev_b32 v236, 16, v236
    v_fmac_f32 v182, s85, v236
    v_lshlrev_b32 v1, 16, v1
    v_fmac_f32 v183, s85, v1
    v_lshlrev_b32 v148, 16, v148
    v_fmac_f32 v176, s85, v148
    v_lshlrev_b32 v237, 16, v237
    v_fmac_f32 v177, s85, v237
    v_lshlrev_b32 v152, 16, v152
    v_fmac_f32 v178, s85, v152
    v_lshlrev_b32 v141, 16, v141
    v_fmac_f32 v179, s85, v141
    v_lshlrev_b32 v94, 16, v94
    v_fmac_f32 v172, s85, v94
    v_lshlrev_b32 v143, 16, v143
    v_fmac_f32 v173, s85, v143
    v_lshlrev_b32 v149, 16, v149
    v_fmac_f32 v174, s85, v149
    v_lshlrev_b32 v2, 16, v2
    v_fmac_f32 v175, s85, v2
    v_lshlrev_b32 v93, 16, v93
    v_fmac_f32 v210, s85, v93
    v_lshrrev_b32 v144, 2, v123
    v_lshl_add_u32 v144, v153, 2, v144
    v_cmp_gt_u32 vcc, 3, v153
    v_mov_b32 v145, 48
    s_nop 1
    v_cndmask_b32 v144, v145, v144, vcc
    v_add_u32 v144, 2352, v144
    v_lshlrev_b32 v144, 1, v144
    buffer_load_ushort v63, v144, s[20:23], 0 offen
    s_waitcnt vmcnt(0)
    v_lshlrev_b32 v63, 16, v63
    v_fmac_f32 v211, s85, v63
    s_branch L_nomaskF
L_atomF0:
    v_mov_b32 v124, 0x800000
    buffer_atomic_add v124, v131, s[8:11], 0 offen sc0 sc1
    s_branch L_atomrF0
L_bndS:
    s_movk_i32 s73, 24
    s_sub_u32 s70, s70, 20
    s_cmp_lt_u32 s2, 247
    s_cbranch_scc1 L_bndrS
    s_movk_i32 s73, 20
    s_movk_i32 s71, 18
    s_movk_i32 s70, -20
    s_mov_b32 s74, 0
    s_cmp_lt_u32 s2, 251
    s_cbranch_scc1 L_bndcS
    s_sub_u32 s94, s2, 251
    s_mul_i32 s69, s94, 18
    s_mov_b32 s74, 25239312
    s_sub_u32 s93, s93, 1373568
    v_cmp_le_u32 vcc, 4, v38
    v_add_u32 v148, 98896896, v130
    v_subrev_u32 v149, 1373568, v130
    v_cndmask_b32 v130, v148, v149, vcc
    v_cmp_le_u32 vcc, 4, v72
    v_add_u32 v148, 98896896, v129
    v_subrev_u32 v149, 1373568, v129
    v_cndmask_b32 v129, v148, v149, vcc
    v_cmp_le_u32 vcc, 4, v125
    v_add_u32 v148, 98896896, v128
    v_subrev_u32 v149, 1373568, v128
    v_cndmask_b32 v128, v148, v149, vcc
    v_cmp_le_u32 vcc, 4, v19
    v_add_u32 v148, 98896896, v127
    v_subrev_u32 v149, 1373568, v127
    v_cndmask_b32 v127, v148, v149, vcc
    v_cmp_le_u32 vcc, 4, v9
    v_add_u32 v148, 98896896, v126
    v_subrev_u32 v149, 1373568, v126
    v_cndmask_b32 v126, v148, v149, vcc
    s_cmp_lt_u32 s2, 255
    s_cbranch_scc1 L_bndrS
L_bndcS:
    s_sub_u32 s94, s2, 247
    s_mul_i32 s69, s94, 18
    s_mov_b32 s62, 1373568
    s_add_u32 s74, s74, 345744
    s_sub_u32 s93, s93, 2688
    v_mad_i32_i24 v148, v38, -7, v8
    v_cmp_le_u32 vcc, 4, v148
    v_add_u32 v148, 193536, v130
    v_subrev_u32 v149, 2688, v130
    v_cndmask_b32 v130, v148, v149, vcc
    v_mad_i32_i24 v148, v72, -7, v131
    v_cmp_le_u32 vcc, 4, v148
    v_add_u32 v148, 193536, v129
    v_subrev_u32 v149, 2688, v129
    v_cndmask_b32 v129, v148, v149, vcc
    v_mad_i32_i24 v148, v125, -7, v26
    v_cmp_le_u32 vcc, 4, v148
    v_add_u32 v148, 193536, v128
    v_subrev_u32 v149, 2688, v128
    v_cndmask_b32 v128, v148, v149, vcc
    v_mad_i32_i24 v148, v19, -7, v124
    v_cmp_le_u32 vcc, 4, v148
    v_add_u32 v148, 193536, v127
    v_subrev_u32 v149, 2688, v127
    v_cndmask_b32 v127, v148, v149, vcc
    v_mad_i32_i24 v148, v9, -7, v39
    v_cmp_le_u32 vcc, 4, v148
    v_add_u32 v148, 193536, v126
    v_subrev_u32 v149, 2688, v126
    v_cndmask_b32 v126, v148, v149, vcc
    s_cmp_eq_u32 s2, 255
    s_cselect_b32 s62, 0, s62
    s_cselect_b32 s69, 0, s69
    s_cselect_b32 s71, 2, s71
    s_branch L_bndrS
L_maskS:
    s_add_u32 s20, s20, s74
    s_addc_u32 s21, s21, 0
    s_mov_b32 s22, 4802
    s_mov_b32 s23, 0x20000
    s_mov_b32 s85, 0x3fb8aa3b
    s_waitcnt vmcnt(0)
    v_lshrrev_b32 v154, 2, v150
    v_add_u32 v154, 0, v154
    v_mul_u32_u24 v154, 98, v154
    v_mad_u32_u24 v155, v151, 24, v154
    buffer_load_ushort v41, v155, s[20:23], 0 offen offset:0
    buffer_load_ushort v142, v155, s[20:23], 0 offen offset:2
    buffer_load_ushort v160, v155, s[20:23], 0 offen offset:4
    buffer_load_ushort v156, v155, s[20:23], 0 offen offset:6
    buffer_load_ushort v168, v155, s[20:23], 0 offen offset:8
    buffer_load_ushort v166, v155, s[20:23], 0 offen offset:10
    buffer_load_ushort v143, v155, s[20:23], 0 offen offset:12
    buffer_load_ushort v164, v155, s[20:23], 0 offen offset:14
    buffer_load_ushort v161, v155, s[20:23], 0 offen offset:16
    buffer_load_ushort v158, v155, s[20:23], 0 offen offset:18
    buffer_load_ushort v162, v155, s[20:23], 0 offen offset:20
    buffer_load_ushort v165, v155, s[20:23], 0 offen offset:22
    buffer_load_ushort v157, v154, s[20:23], 0 offen offset:96
    s_waitcnt vmcnt(0)
    v_lshlrev_b32 v41, 16, v41
    v_fmac_f32 v204, s85, v41
    v_lshlrev_b32 v142, 16, v142
    v_fmac_f32 v205, s85, v142
    v_lshlrev_b32 v160, 16, v160
    v_fmac_f32 v206, s85, v160
    v_lshlrev_b32 v156, 16, v156
    v_fmac_f32 v207, s85, v156
    v_lshlrev_b32 v168, 16, v168
    v_fmac_f32 v200, s85, v168
    v_lshlrev_b32 v166, 16, v166
    v_fmac_f32 v201, s85, v166
    v_lshlrev_b32 v143, 16, v143
    v_fmac_f32 v202, s85, v143
    v_lshlrev_b32 v164, 16, v164
    v_fmac_f32 v203, s85, v164
    v_lshlrev_b32 v161, 16, v161
    v_fmac_f32 v196, s85, v161
    v_lshlrev_b32 v158, 16, v158
    v_fmac_f32 v197, s85, v158
    v_lshlrev_b32 v162, 16, v162
    v_fmac_f32 v198, s85, v162
    v_lshlrev_b32 v165, 16, v165
    v_fmac_f32 v199, s85, v165
    v_lshlrev_b32 v157, 16, v157
    v_fmac_f32 v208, s85, v157
    v_lshrrev_b32 v154, 2, v150
    v_add_u32 v154, 4, v154
    v_mul_u32_u24 v154, 98, v154
    v_mad_u32_u24 v155, v151, 24, v154
    buffer_load_ushort v41, v155, s[20:23], 0 offen offset:0
    buffer_load_ushort v142, v155, s[20:23], 0 offen offset:2
    buffer_load_ushort v160, v155, s[20:23], 0 offen offset:4
    buffer_load_ushort v156, v155, s[20:23], 0 offen offset:6
    buffer_load_ushort v168, v155, s[20:23], 0 offen offset:8
    buffer_load_ushort v166, v155, s[20:23], 0 offen offset:10
    buffer_load_ushort v143, v155, s[20:23], 0 offen offset:12
    buffer_load_ushort v164, v155, s[20:23], 0 offen offset:14
    buffer_load_ushort v161, v155, s[20:23], 0 offen offset:16
    buffer_load_ushort v158, v155, s[20:23], 0 offen offset:18
    buffer_load_ushort v162, v155, s[20:23], 0 offen offset:20
    buffer_load_ushort v165, v155, s[20:23], 0 offen offset:22
    buffer_load_ushort v157, v154, s[20:23], 0 offen offset:96
    s_waitcnt vmcnt(0)
    v_lshlrev_b32 v41, 16, v41
    v_fmac_f32 v192, s85, v41
    v_lshlrev_b32 v142, 16, v142
    v_fmac_f32 v193, s85, v142
    v_lshlrev_b32 v160, 16, v160
    v_fmac_f32 v194, s85, v160
    v_lshlrev_b32 v156, 16, v156
    v_fmac_f32 v195, s85, v156
    v_lshlrev_b32 v168, 16, v168
    v_fmac_f32 v188, s85, v168
    v_lshlrev_b32 v166, 16, v166
    v_fmac_f32 v189, s85, v166
    v_lshlrev_b32 v143, 16, v143
    v_fmac_f32 v190, s85, v143
    v_lshlrev_b32 v164, 16, v164
    v_fmac_f32 v191, s85, v164
    v_lshlrev_b32 v161, 16, v161
    v_fmac_f32 v184, s85, v161
    v_lshlrev_b32 v158, 16, v158
    v_fmac_f32 v185, s85, v158
    v_lshlrev_b32 v162, 16, v162
    v_fmac_f32 v186, s85, v162
    v_lshlrev_b32 v165, 16, v165
    v_fmac_f32 v187, s85, v165
    v_lshlrev_b32 v157, 16, v157
    v_fmac_f32 v209, s85, v157
    v_lshrrev_b32 v154, 2, v150
    v_add_u32 v154, 8, v154
    v_mul_u32_u24 v154, 98, v154
    v_mad_u32_u24 v155, v151, 24, v154
    buffer_load_ushort v41, v155, s[20:23], 0 offen offset:0
    buffer_load_ushort v142, v155, s[20:23], 0 offen offset:2
    buffer_load_ushort v160, v155, s[20:23], 0 offen offset:4
    buffer_load_ushort v156, v155, s[20:23], 0 offen offset:6
    buffer_load_ushort v168, v155, s[20:23], 0 offen offset:8
    buffer_load_ushort v166, v155, s[20:23], 0 offen offset:10
    buffer_load_ushort v143, v155, s[20:23], 0 offen offset:12
    buffer_load_ushort v164, v155, s[20:23], 0 offen offset:14
    buffer_load_ushort v161, v155, s[20:23], 0 offen offset:16
    buffer_load_ushort v158, v155, s[20:23], 0 offen offset:18
    buffer_load_ushort v162, v155, s[20:23], 0 offen offset:20
    buffer_load_ushort v165, v155, s[20:23], 0 offen offset:22
    buffer_load_ushort v157, v154, s[20:23], 0 offen offset:96
    s_waitcnt vmcnt(0)
    v_lshlrev_b32 v41, 16, v41
    v_fmac_f32 v180, s85, v41
    v_lshlrev_b32 v142, 16, v142
    v_fmac_f32 v181, s85, v142
    v_lshlrev_b32 v160, 16, v160
    v_fmac_f32 v182, s85, v160
    v_lshlrev_b32 v156, 16, v156
    v_fmac_f32 v183, s85, v156
    v_lshlrev_b32 v168, 16, v168
    v_fmac_f32 v176, s85, v168
    v_lshlrev_b32 v166, 16, v166
    v_fmac_f32 v177, s85, v166
    v_lshlrev_b32 v143, 16, v143
    v_fmac_f32 v178, s85, v143
    v_lshlrev_b32 v164, 16, v164
    v_fmac_f32 v179, s85, v164
    v_lshlrev_b32 v161, 16, v161
    v_fmac_f32 v172, s85, v161
    v_lshlrev_b32 v158, 16, v158
    v_fmac_f32 v173, s85, v158
    v_lshlrev_b32 v162, 16, v162
    v_fmac_f32 v174, s85, v162
    v_lshlrev_b32 v165, 16, v165
    v_fmac_f32 v175, s85, v165
    v_lshlrev_b32 v157, 16, v157
    v_fmac_f32 v210, s85, v157
    v_lshrrev_b32 v154, 2, v150
    v_lshl_add_u32 v154, v151, 2, v154
    v_cmp_gt_u32 vcc, 3, v151
    v_mov_b32 v155, 48
    s_nop 1
    v_cndmask_b32 v154, v155, v154, vcc
    v_add_u32 v154, 2352, v154
    v_lshlrev_b32 v154, 1, v154
    buffer_load_ushort v41, v154, s[20:23], 0 offen
    s_waitcnt vmcnt(0)
    v_lshlrev_b32 v41, 16, v41
    v_fmac_f32 v211, s85, v41
    s_branch L_nomaskS
L_atomS0:
    v_mov_b32 v124, 0x800000
    buffer_atomic_add v124, v131, s[8:11], 0 offen sc0 sc1
    s_branch L_atomrS0
.section .rodata,"a"
.p2align 6
.amdhsa_kernel standalone__window_attn_swin_v2__vision_kernel
  .amdhsa_next_free_vgpr 512
  .amdhsa_next_free_sgpr 102
  .amdhsa_accum_offset 256
  .amdhsa_group_segment_fixed_size 0
  .amdhsa_kernarg_size 96
  .amdhsa_user_sgpr_count 2
  .amdhsa_user_sgpr_kernarg_segment_ptr 1
  .amdhsa_system_sgpr_workgroup_id_x 1
.end_amdhsa_kernel
```

```asm
; @launch grid=(256,1,1) block=(256,1,1) lds=163840
.amdgcn_target "amdgcn-amd-amdhsa--gfx950"
.text
.globl standalone__window_attn_swin_v2__vision_kernel
.p2align 8
.type standalone__window_attn_swin_v2__vision_kernel,@function
standalone__window_attn_swin_v2__vision_kernel:
    v_lshrrev_b32 v0, 6, v0
    s_cmp_ge_u32 s2, 256
    s_cbranch_scc1 L_end
    v_readfirstlane_b32 s68, v0
    s_mov_b32 s64, 0
    s_nop 0
    v_mbcnt_lo_u32_b32 v3, -1, 0
    v_mbcnt_hi_u32_b32 v3, -1, v3
    s_load_dwordx16 s[4:19], s[0:1], 0
    s_load_dwordx4 s[20:23], s[0:1], 64
    s_load_dwordx2 s[38:39], s[0:1], 80
    s_lshr_b32 s88, s2, 3
    s_lshl2_add_u32 s88, s88, s68
    v_lshlrev_b32 v0, 7, v3
    s_getpc_b64 s[80:81]
    s_lshl_b32 s84, s88, 8
    v_and_b32 v1, 128, v0
    v_add_u32 v1, s84, v1
    v_min_u32 v1, L_slow-standalone__window_attn_swin_v2__vision_kernel-256, v1
    s_mul_i32 s89, s88, 576
    s_mul_i32 s88, s88, 1728
    global_load_dword a255, v1, s[80:81]
    v_min_u32 v4, 1664, v0
    v_min_u32 v8, 512, v0
    s_mov_b32 s34, 221184
    s_mov_b32 s35, 0x20000
    s_mov_b32 s78, 73728
    s_mov_b32 s79, 0x20000
    v_and_b32 v5, 15, v3
    v_lshrrev_b32 v9, 4, v3
    v_lshrrev_b32 v131, 2, v5
    v_and_b32 v11, 3, v5
    s_mul_i32 s87, s68, 192
    v_mad_u32_u24 v7, v5, 12, s87
    v_lshlrev_b32 v6, 1, v5
    v_lshlrev_b32 v10, 1, v131
    v_lshl_add_u32 v10, v9, 5, v10
    s_movk_i32 s86, 384
    s_mov_b32 s26, 100270464
    s_mov_b32 s27, 0x20000
    s_mov_b32 s30, 0
    s_mov_b32 s31, 0x20000
    s_waitcnt lgkmcnt(0)
    s_mov_b32 s24, s4
    s_mov_b32 s25, s5
    s_mov_b32 s32, s6
    s_mov_b32 s33, s7
    s_mov_b32 s76, s8
    s_mov_b32 s77, s9
    buffer_load_dword a254, v4, s[32:35], s88 offen
    buffer_load_dword a253, v8, s[76:79], s89 offen
    s_load_dwordx2 s[82:83], s[10:11], 0
    s_movk_i32 s18, 676
    s_mov_b32 s19, 0x20000
    buffer_load_dwordx3 v[32:34], v7, s[16:19], 0 offen
    s_mul_i32 s96, s68, 288
    s_and_b32 s97, s68, 1
    s_lshl_b32 s97, s97, 2
    s_mov_b32 s98, 193536
    s_mov_b32 s99, 589824
    global_load_ushort v20, v6, s[12:13]
    v_add_u32 v4, s96, v3
    v_mul_u32_u24 v22, 2731, v4
    v_mul_u32_u24 v67, 6242, v4
    v_lshrrev_b32 v22, 16, v22
    v_lshrrev_b32 v67, 20, v67
    s_lshr_b32 s94, s2, 3
    s_mul_i32 s70, s94, 168
    global_load_ushort v21, v6, s[12:13] offset:32
    v_and_or_b32 v64, v22, 3, s97
    v_xor_b32 v64, v4, v64
    v_lshl_add_u32 v128, v64, 4, s99
    v_mad_u32_u24 v128, v67, s98, v128
    v_add_u32 v6, 64, v4
    s_mul_i32 s69, s2, 20
    s_lshl3_add_u32 s69, s94, s69
    global_load_ushort v28, v10, s[14:15] offset:0
    v_mul_u32_u24 v65, 2731, v6
    v_mul_u32_u24 v23, 6242, v6
    v_lshrrev_b32 v65, 16, v65
    v_lshrrev_b32 v23, 20, v23
    v_and_or_b32 v8, v65, 3, s97
    s_add_u32 s70, s70, 140
    s_movk_i32 s62, 2688
    global_load_ushort v35, v10, s[14:15] offset:8
    v_xor_b32 v8, v6, v8
    v_lshl_add_u32 v127, v8, 4, s99
    v_mad_u32_u24 v127, v23, s98, v127
    v_add_u32 v66, 128, v4
    v_mul_u32_u24 v31, 2731, v66
    s_movk_i32 s71, 20
    s_movk_i32 s73, 28
    global_load_ushort v29, v10, s[14:15] offset:16
    v_mul_u32_u24 v6, 6242, v66
    v_lshrrev_b32 v31, 16, v31
    v_lshrrev_b32 v6, 20, v6
    v_and_or_b32 v30, v31, 3, s97
    v_xor_b32 v30, v66, v30
    s_mov_b32 s93, 1769472
    s_mul_i32 s54, s68, 5120
    global_load_ushort v10, v10, s[14:15] offset:24
    v_lshl_add_u32 v126, v30, 4, s99
    v_mad_u32_u24 v126, v6, s98, v126
    v_add_u32 v124, 192, v4
    v_mul_u32_u24 v66, 2731, v124
    v_mul_u32_u24 v130, 6242, v124
    v_lshrrev_b32 v66, 16, v66
    v_lshrrev_b32 v130, 20, v130
    v_and_or_b32 v129, v66, 3, s97
    v_xor_b32 v129, v124, v129
    v_lshl_add_u32 v125, v129, 4, s99
    v_mad_u32_u24 v125, v130, s98, v125
    v_add_u32 v0, 256, v4
    v_mul_u32_u24 v129, 2731, v0
    v_mul_u32_u24 v4, 6242, v0
    v_lshrrev_b32 v129, 16, v129
    v_lshrrev_b32 v4, 20, v4
    v_and_or_b32 v124, v129, 3, s97
    v_xor_b32 v124, v0, v124
    v_lshl_add_u32 v124, v124, 4, s99
    v_mad_u32_u24 v124, v4, s98, v124
    s_cmp_ge_u32 s2, 240
    s_cbranch_scc1 L_bndF
L_bndrF:
    s_mov_b32 s63, 1180032
    s_mul_i32 s94, s69, 58255
    s_lshr_b32 s94, s94, 22
    s_mul_i32 s94, s94, s63
    s_mul_i32 s72, s69, s62
    s_add_u32 s72, s72, s94
    v_lshl_or_b32 v4, v3, 4, 2.0
    s_sub_u32 s94, s73, 1
    s_max_u32 s94, s94, 20
    s_mul_i32 s95, s68, -44
    s_movk_i32 s99, -24
    s_add_u32 m0, s54, 0
    v_and_b32 v23, -4, v31
    s_mul_i32 s85, s68, 96
    s_sub_u32 s100, s85, 1024
    buffer_load_dwordx4 v128, s[24:27], s72 offen nt lds
    s_add_u32 m0, s54, 1024
    v_mad_u32_u24 v6, v23, 3, v31
    v_add_u32 v6, s95, v6
    v_mad_i32_i24 v66, v31, s99, v30
    v_med3_u32 v23, v6, 20, s94
    v_add_u32 v23, s70, v23
    v_add_u32 v67, s69, v6
    s_sub_u32 s87, s85, 2048
    s_movk_i32 s91, 1152
    buffer_load_dwordx4 v127, s[24:27], s72 offen nt lds
    v_cmp_gt_u32 vcc, s71, v6
    v_lshl_add_u32 v66, v66, 4, s93
    s_add_u32 m0, s54, 43008
    v_cndmask_b32 v67, v23, v67, vcc
    v_mul_u32_u24 v23, 58255, v67
    v_mad_u32_u24 v66, v67, s62, v66
    v_lshrrev_b32 v23, 22, v23
    v_mad_u32_u24 v66, v23, s63, v66
    s_mul_i32 s90, s68, 3072
    s_add_u32 s90, s90, 61440
    buffer_load_dwordx4 v66, s[24:27], 0 offen  lds
    v_lshlrev_b32 v67, 16, v6
    s_add_u32 m0, s54, 2048
    v_and_b32 v23, -4, v65
    v_mad_u32_u24 v6, v23, 3, v65
    v_add_u32 v6, s95, v6
    v_mad_i32_i24 v65, v65, s99, v8
    v_med3_u32 v23, v6, 20, s94
    s_add_u32 s101, s54, 44032
    s_mov_b32 s28, s22
    buffer_load_dwordx4 v126, s[24:27], s72 offen nt lds
    v_add_u32 v23, s70, v23
    v_add_u32 v8, s69, v6
    v_cmp_gt_u32 vcc, s71, v6
    v_lshl_add_u32 v65, v65, 4, s93
    s_add_u32 m0, s54, 41984
    v_cndmask_b32 v8, v23, v8, vcc
    v_mul_u32_u24 v23, 58255, v8
    v_mad_u32_u24 v65, v8, s62, v65
    v_lshrrev_b32 v23, 22, v23
    v_mad_u32_u24 v65, v23, s63, v65
    s_mov_b32 s29, s23
    s_mov_b32 s41, 0x2a8cbccc
    buffer_load_dwordx4 v65, s[24:27], 0 offen  lds
    v_lshl_or_b32 v67, v6, 8, v67
    s_add_u32 m0, s54, 3072
    v_cmp_gt_u32 vcc, 32, v3
    v_and_b32 v6, -4, v22
    v_mad_u32_u24 v8, v6, 3, v22
    v_cndmask_b32 v124, v4, v124, vcc
    v_add_u32 v8, s95, v8
    s_mov_b32 s42, 0x38fba882
    s_mov_b32 s43, 0x415db3d7
    buffer_load_dwordx4 v125, s[24:27], s72 offen nt lds
    s_add_u32 m0, s54, 4096
    v_mad_i32_i24 v64, v22, s99, v64
    v_med3_u32 v6, v8, 20, s94
    v_add_u32 v6, s70, v6
    v_add_u32 v22, s69, v8
    v_cmp_gt_u32 vcc, s71, v8
    v_lshl_add_u32 v64, v64, 4, s93
    s_mul_i32 s93, s68, 6
    s_lshl_b32 s94, s97, 1
    buffer_load_dwordx4 v124, s[24:27], s72 offen nt lds
    v_cndmask_b32 v22, v6, v22, vcc
    v_mul_u32_u24 v6, 58255, v22
    v_mad_u32_u24 v64, v22, s62, v64
    v_lshrrev_b32 v6, 22, v6
    v_mad_u32_u24 v64, v6, s63, v64
    s_add_u32 m0, s54, 40960
    v_lshl_or_b32 v67, v8, 0, v67
    s_mov_b32 s44, 61440
    s_mov_b32 s45, 40960
    buffer_load_dwordx4 v64, s[24:27], 0 offen nt lds
    v_mul_u32_u24 v23, 10923, v3
    v_lshrrev_b32 v87, 17, v23
    v_lshrrev_b32 v23, 16, v23
    v_mad_i32_i24 v0, v23, -6, v3
    v_bitop3_b32 v87, v87, v23, 4 bitop3:0x28
    v_lshl_add_u32 v0, v0, 4, s85
    v_mul_u32_u24 v87, 3, v87
    v_xor_b32 v23, v23, v87
    v_mad_u32_u24 v87, v23, s91, v0
    v_add_u32 v1, 64, v3
    v_mul_u32_u24 v2, 10923, v1
    v_lshrrev_b32 v99, 17, v2
    v_lshrrev_b32 v2, 16, v2
    v_mad_i32_i24 v22, v2, -6, v1
    v_bitop3_b32 v99, v99, v2, 4 bitop3:0x28
    v_lshl_add_u32 v22, v22, 4, s100
    v_mul_u32_u24 v99, 3, v99
    v_xor_b32 v2, v2, v99
    v_mad_u32_u24 v99, v2, s91, v22
    v_add_u32 v1, 128, v3
    v_mul_u32_u24 v6, 10923, v1
    v_lshrrev_b32 v8, 17, v6
    v_lshrrev_b32 v6, 16, v6
    v_mad_i32_i24 v1, v6, -6, v1
    v_bitop3_b32 v8, v8, v6, 4 bitop3:0x28
    v_lshl_add_u32 v1, v1, 4, s87
    v_mul_u32_u24 v8, 3, v8
    v_xor_b32 v6, v6, v8
    v_mad_u32_u24 v8, v6, s91, v1
    v_mad_u32_u24 v0, v23, s86, v0
    v_mad_u32_u24 v166, v2, s86, v22
    v_mad_u32_u24 v162, v6, s86, v1
    s_add_u32 m0, s90, 0
    s_mov_b32 s92, 0
    buffer_load_dwordx4 v87, s[32:35], s92 offen offset:0 lds
    v_lshrrev_b32 v1, 1, v9
    v_lshl_add_u32 v6, v9, 2, v131
    v_lshl_add_u32 v6, v1, 3, v6
    v_mul_u32_u24 v6, 96, v6
    v_add_u32 v6, s90, v6
    v_lshl_add_u32 v139, v11, 4, v6
    v_lshl_add_u32 v37, v11, 3, v6
    v_mov_b32 v223, 0x3f803f80
    v_cmp_eq_u32 vcc, 0, v11
    v_and_b32 v6, 1, v3
    v_lshlrev_b32 v6, 4, v6
    v_cndmask_b32 v220, 0, v223, vcc
    v_cndmask_b32 v221, 0, v223, vcc
    v_cndmask_b32 v222, 0, v223, vcc
    v_cndmask_b32 v223, 0, v223, vcc
    v_mov_b32 v1, 0x3f80
    v_lshlrev_b32 v219, v6, v1
    v_cmp_gt_u32 vcc, 2, v11
    v_mov_b32 v215, 0x44004400
    v_mul_u32_u24 v71, 48, v131
    v_cndmask_b32 v216, 0, v219, vcc
    v_cndmask_b32 v218, 0, v219, vcc
    v_cmp_le_u32 vcc, 2, v11
    v_lshl_add_u32 v71, v11, 2, v71
    v_mul_u32_u24 v6, 48, v9
    v_cndmask_b32 v217, 0, v219, vcc
    v_cndmask_b32 v219, 0, v219, vcc
    v_cmp_eq_u32 vcc, v9, v131
    v_add_u32 v98, 0, v71
    v_mul_u32_u24 v1, 37, v98
    v_cndmask_b32 v94, 0, v216, vcc
    v_cndmask_b32 v95, 0, v217, vcc
    v_cmp_eq_u32 vcc, 0, v11
    v_lshrrev_b32 v1, 10, v1
    v_mad_u32_u24 v98, v1, 24, v98
    v_cndmask_b32 v212, 0, v215, vcc
    v_cmp_eq_u32 vcc, 1, v11
    v_add_u32 v98, s101, v98
    v_add_u32 v187, 16, v71
    v_cndmask_b32 v213, 0, v215, vcc
    v_cmp_eq_u32 vcc, 2, v11
    v_mul_u32_u24 v1, 37, v187
    v_lshrrev_b32 v1, 10, v1
    v_cndmask_b32 v214, 0, v215, vcc
    v_cmp_eq_u32 vcc, 3, v11
    v_mad_u32_u24 v187, v1, 24, v187
    v_add_u32 v187, s101, v187
    v_cndmask_b32 v215, 0, v215, vcc
    v_add_u32 v175, 32, v71
    v_mul_u32_u24 v1, 37, v175
    v_lshrrev_b32 v1, 10, v1
    v_mad_u32_u24 v175, v1, 24, v175
    v_add_u32 v175, s101, v175
    v_add_u32 v204, 0, v6
    v_mul_u32_u24 v1, 37, v204
    v_lshrrev_b32 v1, 10, v1
    v_mad_u32_u24 v204, v1, 24, v204
    v_add_u32 v205, 4, v6
    v_mul_u32_u24 v1, 37, v205
    v_lshrrev_b32 v1, 10, v1
    v_mad_u32_u24 v205, v1, 24, v205
    v_add_u32 v206, 8, v6
    v_mul_u32_u24 v207, 37, v206
    v_lshrrev_b32 v207, 10, v207
    v_mad_u32_u24 v206, v207, 24, v206
    v_add_u32 v207, 12, v6
    v_mul_u32_u24 v1, 37, v207
    v_lshrrev_b32 v1, 10, v1
    v_mad_u32_u24 v207, v1, 24, v207
    v_add_u32 v120, 16, v6
    v_mul_u32_u24 v1, 37, v120
    v_lshrrev_b32 v1, 10, v1
    v_mad_u32_u24 v120, v1, 24, v120
    v_add_u32 v121, 20, v6
    v_mul_u32_u24 v1, 37, v121
    v_lshrrev_b32 v1, 10, v1
    v_mad_u32_u24 v121, v1, 24, v121
    v_add_u32 v92, 24, v6
    v_mul_u32_u24 v93, 37, v92
    v_lshrrev_b32 v93, 10, v93
    v_mad_u32_u24 v92, v93, 24, v92
    v_add_u32 v93, 28, v6
    v_mul_u32_u24 v1, 37, v93
    v_lshrrev_b32 v1, 10, v1
    v_mad_u32_u24 v93, v1, 24, v93
    v_add_u32 v31, 32, v6
    v_mul_u32_u24 v30, 37, v31
    v_lshrrev_b32 v30, 10, v30
    v_mad_u32_u24 v31, v30, 24, v31
    s_waitcnt lgkmcnt(0)
    s_sext_i32_i16 s84, s82
    s_ashr_i32 s85, s82, 16
    s_max_i32 s84, s84, s85
    s_sext_i32_i16 s85, s83
    s_max_i32 s84, s84, s85
    s_ashr_i32 s85, s83, 16
    s_max_i32 s84, s84, s85
    s_cmp_gt_i32 s84, 16492
    s_cbranch_scc1 L_slow
    s_lshl_b32 s84, s68, 4
    buffer_load_dwordx4 v99, s[32:35], s92 offen offset:1024 lds
    v_add_u32 v30, 36, v6
    v_mul_u32_u24 v1, 37, v30
    v_lshrrev_b32 v1, 10, v1
    v_mad_u32_u24 v30, v1, 24, v30
    v_add_u32 v138, 40, v6
    v_mul_u32_u24 v1, 37, v138
    v_lshrrev_b32 v1, 10, v1
    s_lshr_b64 s[82:83], s[82:83], s84
    s_lshl_b32 s82, s82, 16
    buffer_load_dwordx4 v8, s[32:35], s92 offen offset:2048 lds
    s_add_u32 m0, s90, 12288
    s_mov_b32 s92, 36864
    v_mad_u32_u24 v138, v1, 24, v138
    v_add_u32 v1, 44, v6
    v_mul_u32_u24 v2, 37, v1
    v_lshrrev_b32 v2, 10, v2
    v_mad_u32_u24 v1, v2, 24, v1
    s_mov_b32 s84, 0x41b8aa3b
    s_mov_b32 s46, 20480
    buffer_load_dwordx4 v87, s[32:35], s92 offen offset:0 lds
    v_lshl_add_u32 v2, v9, 4, v71
    v_mul_u32_u24 v6, 37, v2
    v_lshrrev_b32 v6, 10, v6
    v_mad_u32_u24 v2, v6, 24, v2
    v_mov_b32 v22, 336
    v_cmp_gt_u32 vcc, 3, v9
    v_mov_b32 v6, s82
    v_min_f32 v6, 0x40930000, v6
    v_cndmask_b32 v2, v22, v2, vcc
    v_sub_u32 v2, s101, v2
    v_max_f32 v6, 0xc2c80000, v6
    v_mul_f32 v6, 0x3fb8aa3b, v6
    v_exp_f32 v6, v6
    s_waitcnt vmcnt(16)
    v_lshl_or_b32 v20, v21, 16, v20
    s_mov_b32 s47, 0
    s_mov_b32 s57, s72
    buffer_load_dwordx4 v99, s[32:35], s92 offen offset:1024 lds
    v_cvt_pk_bf16_f32 v6, v6, v6
    v_lshlrev_b32 v6, 16, v6
    v_mul_f32 v6, 0x4038aa3b, v6
    s_waitcnt vmcnt(15)
    v_lshl_or_b32 v28, v35, 16, v28
    v_readfirstlane_b32 s55, v6
    v_add_f32 v6, v6, v6
    s_waitcnt vmcnt(13)
    v_lshl_or_b32 v29, v10, 16, v29
    v_readfirstlane_b32 s52, v6
    v_cmp_gt_u32 vcc, 16, v3
    v_mov_b32 v21, 0
    v_mov_b32 v22, 0
    v_cndmask_b32 v23, 0, v20, vcc
    v_cndmask_b32 v20, 0, v20, vcc
    v_mov_b32 v35, 0
    v_mfma_f32_16x16x16_bf16 v[12:15], v[22:23], v[32:33], 0
    s_mov_b32 s58, 0
    v_mul_u32_u24 v6, 5120, v9
    v_add_u32 v6, v7, v6
    v_mfma_f32_16x16x16_bf16 v[16:19], v[20:21], v[32:33], 0
    s_mov_b32 s59, 0
    v_mov_b32 v7, 0xc138aa3b
    v_and_b32 v10, 8, v5
    v_mfma_f32_16x16x16_bf16 v[24:27], v[20:21], v[34:35], 0
    s_mov_b32 s60, 0
    v_max_f32 v12, 0, v12
    v_max_f32 v13, 0, v13
    v_max_f32 v14, 0, v14
    v_max_f32 v16, 0, v16
    v_max_f32 v17, 0, v17
    v_max_f32 v18, 0, v18
    v_max_f32 v19, 0, v19
    v_cvt_pk_bf16_f32 v16, v16, v17
    v_cvt_pk_bf16_f32 v17, v18, v19
    v_max_f32 v15, 0, v15
    v_cvt_pk_bf16_f32 v12, v12, v13
    v_mfma_f32_16x16x16_bf16 v[20:23], v[28:29], v[16:17], 0
    s_mov_b32 s65, -1
    v_cvt_pk_bf16_f32 v13, v14, v15
    v_max_f32 v24, 0, v24
    v_max_f32 v25, 0, v25
    v_mfma_f32_16x16x16_bf16 v[16:19], v[28:29], v[12:13], 0
    s_mov_b32 s61, 1
    v_max_f32 v26, 0, v26
    v_max_f32 v27, 0, v27
    v_cvt_pk_bf16_f32 v24, v24, v25
    v_cvt_pk_bf16_f32 v25, v26, v27
    v_cvt_pk_bf16_f32 v20, v20, v20
    v_lshlrev_b32 v20, 16, v20
    v_mfma_f32_16x16x16_bf16 v[12:15], v[28:29], v[24:25], 0
    s_movk_i32 s4, 112
    v_mul_f32 v20, 0xbfb8aa3b, v20
    v_cvt_pk_bf16_f32 v16, v16, v16
    v_exp_f32 v20, v20
    v_lshlrev_b32 v16, 16, v16
    v_add_f32 v20, 1.0, v20
    v_rcp_f32 v20, v20
    v_mul_f32 v16, 0xbfb8aa3b, v16
    v_cvt_pk_bf16_f32 v20, v20, v20
    v_lshlrev_b32 v20, 16, v20
    v_fma_f32 v20, v20, s84, v7
    s_mov_b32 s5, 0
    s_mov_b32 s6, 0
    ds_write_b32 v6, v20 offset:44032
    v_exp_f32 v16, v16
    v_cvt_pk_bf16_f32 v12, v12, v12
    v_add_f32 v16, 1.0, v16
    v_rcp_f32 v16, v16
    v_lshlrev_b32 v12, 16, v12
    v_cvt_pk_bf16_f32 v16, v16, v16
    v_lshlrev_b32 v16, 16, v16
    v_fma_f32 v16, v16, s84, v7
    s_mov_b32 s12, 0
    s_mov_b32 s64, 3
    ds_write_b32 v6, v16 offset:44036
    v_mul_f32 v12, 0xbfb8aa3b, v12
    v_exp_f32 v12, v12
    v_add_u32 v10, v10, v5
    v_add_f32 v12, 1.0, v12
    v_rcp_f32 v12, v12
    v_mul_u32_u24 v10, 96, v10
    v_cvt_pk_bf16_f32 v12, v12, v12
    v_lshlrev_b32 v12, 16, v12
    v_fma_f32 v12, v12, s84, v7
    s_mov_b32 s10, 81924
    s_mov_b32 s11, 0x20000
    ds_write_b32 v6, v12 offset:44040
    v_add_u32 v10, s90, v10
    v_lshl_add_u32 v97, v9, 4, v10
    v_lshl_add_u32 v96, v9, 3, v10
    v_lshlrev_b32 v29, 4, v9
    v_add_u32 v29, 4608, v29
    v_mul_u32_u24 v6, 5120, v131
    v_mad_u32_u24 v6, v11, s86, v6
    v_and_b32 v28, 7, v5
    v_xor_b32 v122, v28, v9
    v_lshl_add_u32 v10, v122, 4, v6
    v_xor_b32 v7, 64, v10
    v_add_u32 v137, 40960, v10
    v_xor_b32 v136, 64, v137
    v_add_u32 v6, 61440, v6
    v_add_u32 v122, s93, v9
    v_xor_b32 v122, v28, v122
    v_lshl_add_u32 v135, v122, 4, v6
    v_lshrrev_b32 v122, 1, v9
    v_add3_u32 v122, v122, s93, 4
    v_xor_b32 v122, v28, v122
    v_lshl_add_u32 v122, v122, 4, v6
    v_and_b32 v6, 1, v9
    v_lshl_add_u32 v134, v6, 3, v122
    v_lshlrev_b32 v6, 4, v3
    s_add_u32 s93, s54, 20480
    v_add_u32 v133, s93, v6
    v_add_u32 v129, 81920, v6
    s_lshr_b32 s93, s68, 1
    s_lshl_b32 s93, s93, 10
    s_add_u32 s93, s93, s94
    v_add_u32 v130, s93, v129
    s_mul_i32 s93, s68, 7168
    s_add_u32 s93, s93, 135168
    s_waitcnt lgkmcnt(0)
    s_barrier
    ds_read_b32 v209, v187
    v_mul_u32_u24 v6, 1792, v9
    v_add_u32 v122, s93, v6
    v_mul_u32_u24 v6, 112, v5
    v_add_u32 v28, v6, v122
    v_subrev_u32 v28, 28672, v28
    v_cmp_eq_u32 vcc, 0, v131
    v_add_u32 v6, 16, v122
    v_mov_b32 v123, 0
    v_cndmask_b32 v132, v4, v122, vcc
    v_cmp_eq_u32 vcc, 3, v11
    v_mov_b32 v122, 0
    buffer_load_dwordx4 v8, s[32:35], s92 offen offset:2048 lds
    s_add_u32 m0, s90, 24576
    s_mov_b32 s92, 73728
    ds_read_b32 v210, v175
    v_cndmask_b32 v132, v132, v6, vcc
    v_mul_u32_u24 v6, 1792, v131
    v_lshl_add_u32 v6, v9, 3, v6
    v_lshl_add_u32 v6, v11, 1, v6
    v_add_u32 v6, s93, v6
    v_cmp_gt_u32 vcc, 3, v9
    s_add_u32 s93, s69, 1
    s_mul_i32 s94, s93, 58255
    ds_read_b32 v208, v98
    v_cndmask_b32 v131, v4, v6, vcc
    s_lshr_b32 s94, s94, 22
    s_mul_i32 s94, s94, s63
    s_mul_i32 s56, s93, s62
    s_add_u32 s56, s56, s94
    s_and_b32 s94, s68, 1
    s_mul_i32 s94, s94, -2304
    s_sub_u32 s93, s71, 1
    s_cmp_eq_u32 s68, 0
    buffer_load_dwordx4 v87, s[32:35], s92 offen offset:0 lds
    s_cselect_b32 s13, s93, -1
    s_cmp_gt_u32 s73, 20
    s_cselect_b32 s13, s13, -1
    s_and_b32 s93, s2, -8
    s_sub_u32 s93, 81920, s93
    s_sub_u32 s8, s38, s93
    s_subb_u32 s9, s39, 0
    s_lshr_b32 s93, s68, 1
    s_mul_i32 s93, s93, 30720
    s_add_u32 s93, s93, s94
    ds_read_b32 v211, v2 offset:672
    buffer_load_dwordx4 v99, s[32:35], s92 offen offset:1024 lds
    v_add_u32 v50, s93, v97
    v_add_u32 v11, s93, v96
    s_lshr_b32 s93, s68, 1
    s_mul_i32 s93, s93, 5120
    s_lshl_b32 s94, s97, 4
    s_add_u32 s93, s93, s94
    v_add_u32 v2, s93, v29
    v_cmp_eq_u32 vcc, 0, v5
    s_mov_b32 s39, 0x00010001
    v_sub_u32 v192, v187, v204
    v_cndmask_b32 v2, v4, v2, vcc
    ds_read_b32 v192, v192 offset:336
    v_sub_u32 v193, v187, v205
    v_sub_u32 v194, v187, v206
    v_sub_u32 v195, v187, v207
    v_sub_u32 v188, v187, v120
    v_sub_u32 v189, v187, v121
    ds_read_b32 v193, v193 offset:336
    v_sub_u32 v190, v187, v92
    buffer_load_dwordx4 v8, s[32:35], s92 offen offset:2048 lds
    s_add_u32 m0, s90, 36864
    s_mov_b32 s92, 110592
    ds_read_b32 v194, v194 offset:336
    v_sub_u32 v191, v187, v93
    v_sub_u32 v184, v187, v31
    v_sub_u32 v185, v187, v30
    v_sub_u32 v186, v187, v138
    v_sub_u32 v187, v187, v1
    s_waitcnt vmcnt(9)
    s_barrier
    ds_read_b32 v195, v195 offset:336
    v_sub_u32 v180, v175, v204
    v_sub_u32 v181, v175, v205
    v_sub_u32 v182, v175, v206
    v_sub_u32 v183, v175, v207
    v_sub_u32 v176, v175, v120
    ds_read_b32 v188, v188 offset:336
    v_sub_u32 v177, v175, v121
    v_sub_u32 v178, v175, v92
    v_sub_u32 v179, v175, v93
    v_sub_u32 v172, v175, v31
    v_sub_u32 v173, v175, v30
    ds_read_b32 v189, v189 offset:336
    v_sub_u32 v174, v175, v138
    v_sub_u32 v175, v175, v1
    buffer_load_dwordx4 v87, s[32:35], s92 offen offset:0 lds
    ds_read_b32 v190, v190 offset:336
    v_sub_u32 v204, v98, v204
    v_sub_u32 v205, v98, v205
    v_sub_u32 v206, v98, v206
    v_sub_u32 v207, v98, v207
    v_sub_u32 v200, v98, v120
    ds_read_b32 v191, v191 offset:336
    v_sub_u32 v201, v98, v121
    v_sub_u32 v202, v98, v92
    v_sub_u32 v203, v98, v93
    v_sub_u32 v196, v98, v31
    v_sub_u32 v197, v98, v30
    ds_read_b32 v184, v184 offset:336
    buffer_load_dwordx4 v99, s[32:35], s92 offen offset:1024 lds
    v_sub_u32 v198, v98, v138
    v_sub_u32 v199, v98, v1
    ds_read_b32 v185, v185 offset:336
    ds_read_b32 v186, v186 offset:336
    ds_read_b32 v187, v187 offset:336
    buffer_load_dwordx4 v8, s[32:35], s92 offen offset:2048 lds
    s_add_u32 m0, s90, 49152
    s_mov_b32 s92, 147456
    s_waitcnt vmcnt(9)
    ds_read_b64_tr_b16 a[0:1], v37 offset:0
    ds_read_b64_tr_b16 a[2:3], v37 offset:768
    ds_read_b64_tr_b16 a[24:25], v37 offset:32
    ds_read_b64_tr_b16 a[26:27], v37 offset:800
    ds_read_b64_tr_b16 a[48:49], v37 offset:64
    ds_read_b64_tr_b16 a[50:51], v37 offset:832
    ds_read_b128 v[32:35], v10 offset:40960
    ds_read_b128 v[24:27], v10 offset:42496
    buffer_load_dwordx4 v87, s[32:35], s92 offen offset:0 lds
    ds_read_b128 v[20:23], v10 offset:0
    ds_read_b128 v[12:15], v10 offset:1536
    ds_read_b128 v[80:83], v10 offset:3072
    ds_read_b32 v180, v180 offset:336
    buffer_load_dwordx4 v99, s[32:35], s92 offen offset:1024 lds
    ds_read_b32 v181, v181 offset:336
    ds_read_b32 v182, v182 offset:336
    s_waitcnt lgkmcnt(7)
    v_mfma_f32_16x16x32_bf16 v[16:19], a[0:3], v[32:35], 0
    ds_read_b128 v[228:231], v10 offset:41088
    v_mfma_f32_16x16x32_bf16 v[88:91], a[24:27], v[32:35], 0
    ds_read_b128 v[116:119], v10 offset:42624
    v_mfma_f32_16x16x32_bf16 v[72:75], a[48:51], v[32:35], 0
    s_waitcnt vmcnt(8) lgkmcnt(6)
    buffer_load_dwordx4 v8, s[32:35], s92 offen offset:2048 lds
    ds_read_b64_tr_b16 a[4:5], v37 offset:12288
    v_mfma_f32_16x16x32_bf16 v[56:59], a[0:3], v[24:27], 0
    s_add_u32 m0, s90, 61440
    ds_read_b64_tr_b16 a[6:7], v37 offset:13056
    v_mfma_f32_16x16x32_bf16 v[108:111], a[24:27], v[24:27], 0
    s_mov_b32 s92, 184320
    ds_read_b64_tr_b16 a[28:29], v37 offset:12320
    v_mfma_f32_16x16x32_bf16 v[40:43], a[48:51], v[24:27], 0
    ds_read_b64_tr_b16 a[30:31], v37 offset:13088
    v_mfma_f32_16x16x32_bf16 v[30:33], a[0:3], v[20:23], 0
    ds_read_b64_tr_b16 a[52:53], v37 offset:12352
    v_mfma_f32_16x16x32_bf16 v[152:155], a[24:27], v[20:23], 0
    buffer_load_dwordx4 v87, s[32:35], s92 offen offset:0 lds
    ds_read_b64_tr_b16 a[54:55], v37 offset:13120
    v_mfma_f32_16x16x32_bf16 v[104:107], a[48:51], v[20:23], 0
    ds_read_b128 v[148:151], v10 offset:128
    v_mfma_f32_16x16x32_bf16 v[24:27], a[0:3], v[12:15], 0
    ds_read_b128 v[52:55], v10 offset:1664
    v_mfma_f32_16x16x32_bf16 v[44:47], a[24:27], v[12:15], 0
    ds_read_b128 v[60:63], v10 offset:3200
    v_mfma_f32_16x16x32_bf16 v[112:115], a[48:51], v[12:15], 0
    s_waitcnt lgkmcnt(8)
    ds_read_b128 v[144:147], v7 offset:41088
    v_mfma_f32_16x16x32_bf16 v[12:15], a[0:3], v[80:83], 0
    buffer_load_dwordx4 v99, s[32:35], s92 offen offset:1024 lds
    ds_read_b128 v[76:79], v7 offset:42624
    v_mfma_f32_16x16x32_bf16 v[140:143], a[24:27], v[80:83], 0
    ds_read_b128 v[20:23], v7 offset:128
    v_mfma_f32_16x16x32_bf16 v[100:103], a[48:51], v[80:83], 0
    ds_read_b128 v[80:83], v7 offset:1664
    ds_read_b128 v[156:159], v7 offset:3200
    ds_read_b128 v[232:235], v7 offset:40960
    buffer_load_dwordx4 v8, s[32:35], s92 offen offset:2048 lds
    s_add_u32 m0, s90, 0
    s_mov_b32 s92, 384
    s_waitcnt vmcnt(9)
    ds_read_b64_tr_b16 a[8:9], v37 offset:24576
    ds_read_b64_tr_b16 a[10:11], v37 offset:25344
    ds_read_b64_tr_b16 a[32:33], v37 offset:24608
    ds_read_b64_tr_b16 a[34:35], v37 offset:25376
    ds_read_b64_tr_b16 a[56:57], v37 offset:24640
    ds_read_b64_tr_b16 a[58:59], v37 offset:25408
    ds_read_b128 v[224:227], v7 offset:42496
    ds_read_b32 v183, v183 offset:336
    buffer_load_dwordx4 v87, s[32:35], s92 offen offset:0 lds
    ds_read_b32 v176, v176 offset:336
    ds_read_b32 v177, v177 offset:336
    s_waitcnt lgkmcnt(10)
    v_mfma_f32_16x16x32_bf16 v[16:19], a[4:7], v[232:235], v[16:19]
    v_mfma_f32_16x16x32_bf16 v[88:91], a[28:31], v[232:235], v[88:91]
    s_waitcnt lgkmcnt(8)
    ds_read_b32 v178, v178 offset:336
    v_mfma_f32_16x16x32_bf16 v[16:19], a[8:11], v[228:231], v[16:19]
    s_waitcnt lgkmcnt(7)
    buffer_load_dwordx4 v99, s[32:35], s92 offen offset:1024 lds
    v_mfma_f32_16x16x32_bf16 v[88:91], a[32:35], v[228:231], v[88:91]
    ds_read_b128 v[168:171], v7 offset:0
    v_mfma_f32_16x16x32_bf16 v[72:75], a[52:55], v[232:235], v[72:75]
    s_waitcnt lgkmcnt(5)
    ds_read_b32 v179, v179 offset:336
    v_mfma_f32_16x16x32_bf16 v[72:75], a[56:59], v[228:231], v[72:75]
    v_mfma_f32_16x16x32_bf16 v[56:59], a[4:7], v[224:227], v[56:59]
    ds_read_b32 v172, v172 offset:336
    v_mfma_f32_16x16x32_bf16 v[56:59], a[8:11], v[116:119], v[56:59]
    buffer_load_dwordx4 v8, s[32:35], s92 offen offset:2048 lds
    v_mfma_f32_16x16x32_bf16 v[108:111], a[28:31], v[224:227], v[108:111]
    s_waitcnt vmcnt(9)
    s_add_u32 m0, s90, 12288
    ds_read_b64_tr_b16 a[12:13], v37 offset:36864
    v_mfma_f32_16x16x32_bf16 v[108:111], a[32:35], v[116:119], v[108:111]
    s_mov_b32 s92, 37248
    ds_read_b64_tr_b16 a[14:15], v37 offset:37632
    v_mfma_f32_16x16x32_bf16 v[40:43], a[52:55], v[224:227], v[40:43]
    ds_read_b64_tr_b16 a[36:37], v37 offset:36896
    v_mfma_f32_16x16x32_bf16 v[40:43], a[56:59], v[116:119], v[40:43]
    s_waitcnt lgkmcnt(5)
    ds_read_b64_tr_b16 a[38:39], v37 offset:37664
    buffer_load_dwordx4 v87, s[32:35], s92 offen offset:0 lds
    v_mfma_f32_16x16x32_bf16 v[30:33], a[4:7], v[168:171], v[30:33]
    ds_read_b64_tr_b16 a[60:61], v37 offset:36928
    v_mfma_f32_16x16x32_bf16 v[30:33], a[8:11], v[148:151], v[30:33]
    ds_read_b64_tr_b16 a[62:63], v37 offset:37696
    v_mfma_f32_16x16x32_bf16 v[152:155], a[28:31], v[168:171], v[152:155]
    ds_read_b128 v[116:119], v7 offset:1536
    v_mfma_f32_16x16x32_bf16 v[152:155], a[32:35], v[148:151], v[152:155]
    ds_read_b32 v173, v173 offset:336
    v_mfma_f32_16x16x32_bf16 v[104:107], a[52:55], v[168:171], v[104:107]
    buffer_load_dwordx4 v99, s[32:35], s92 offen offset:1024 lds
    v_mfma_f32_16x16x32_bf16 v[104:107], a[56:59], v[148:151], v[104:107]
    s_waitcnt lgkmcnt(6)
    ds_read_b32 v174, v174 offset:336
    v_mfma_f32_16x16x32_bf16 v[16:19], a[12:15], v[144:147], v[16:19]
    v_mfma_f32_16x16x32_bf16 v[56:59], a[12:15], v[76:79], v[56:59]
    s_waitcnt lgkmcnt(5)
    ds_read_b32 v175, v175 offset:336
    v_mfma_f32_16x16x32_bf16 v[88:91], a[36:39], v[144:147], v[88:91]
    v_mfma_f32_16x16x32_bf16 v[108:111], a[36:39], v[76:79], v[108:111]
    ds_read_b128 v[168:171], v7 offset:3072
    buffer_load_dwordx4 v8, s[32:35], s92 offen offset:2048 lds
    v_mfma_f32_16x16x32_bf16 v[30:33], a[12:15], v[20:23], v[30:33]
    s_waitcnt vmcnt(9) lgkmcnt(5)
    s_add_u32 m0, s90, 24576
    ds_read_b64_tr_b16 a[16:17], v37 offset:49152
    v_mfma_f32_16x16x32_bf16 v[72:75], a[60:63], v[144:147], v[72:75]
    s_mov_b32 s92, 74112
    ds_read_b64_tr_b16 a[18:19], v37 offset:49920
    v_mfma_f32_16x16x32_bf16 v[40:43], a[60:63], v[76:79], v[40:43]
    ds_read_b64_tr_b16 a[40:41], v37 offset:49184
    v_mfma_f32_16x16x32_bf16 v[152:155], a[36:39], v[20:23], v[152:155]
    ds_read_b64_tr_b16 a[42:43], v37 offset:49952
    v_mfma_f32_16x16x32_bf16 v[104:107], a[60:63], v[20:23], v[104:107]
    s_waitcnt lgkmcnt(6)
    ds_read_b64_tr_b16 a[64:65], v37 offset:49216
    buffer_load_dwordx4 v87, s[32:35], s92 offen offset:0 lds
    v_mfma_f32_16x16x32_bf16 v[24:27], a[4:7], v[116:119], v[24:27]
    ds_read_b64_tr_b16 a[66:67], v37 offset:49984
    v_mfma_f32_16x16x32_bf16 v[24:27], a[8:11], v[52:55], v[24:27]
    ds_read_b32 v204, v204 offset:336
    v_mfma_f32_16x16x32_bf16 v[24:27], a[12:15], v[80:83], v[24:27]
    v_mfma_f32_16x16x32_bf16 v[44:47], a[28:31], v[116:119], v[44:47]
    ds_read_b128 v[148:151], v7 offset:41216
    v_mfma_f32_16x16x32_bf16 v[44:47], a[32:35], v[52:55], v[44:47]
    ds_read_b128 v[76:79], v7 offset:42752
    buffer_load_dwordx4 v99, s[32:35], s92 offen offset:1024 lds
    v_mfma_f32_16x16x32_bf16 v[44:47], a[36:39], v[80:83], v[44:47]
    ds_read_b128 v[20:23], v7 offset:256
    v_mfma_f32_16x16x32_bf16 v[112:115], a[52:55], v[116:119], v[112:115]
    ds_read_b128 v[116:119], v7 offset:1792
    v_mfma_f32_16x16x32_bf16 v[112:115], a[56:59], v[52:55], v[112:115]
    ds_read_b128 v[52:55], v7 offset:3328
    v_mfma_f32_16x16x32_bf16 v[112:115], a[60:63], v[80:83], v[112:115]
    s_waitcnt lgkmcnt(7)
    ds_read_b128 v[144:147], v10 offset:41216
    v_mfma_f32_16x16x32_bf16 v[12:15], a[4:7], v[168:171], v[12:15]
    ds_read_b128 v[80:83], v10 offset:42752
    buffer_load_dwordx4 v8, s[32:35], s92 offen offset:2048 lds
    v_mfma_f32_16x16x32_bf16 v[12:15], a[8:11], v[60:63], v[12:15]
    s_waitcnt vmcnt(9)
    s_add_u32 m0, s90, 36864
    ds_read_b64_tr_b16 a[20:21], v37 offset:61440
    v_mfma_f32_16x16x32_bf16 v[12:15], a[12:15], v[156:159], v[12:15]
    s_mov_b32 s92, 110976
    ds_read_b64_tr_b16 a[22:23], v37 offset:62208
    v_mfma_f32_16x16x32_bf16 v[140:143], a[28:31], v[168:171], v[140:143]
    ds_read_b64_tr_b16 a[44:45], v37 offset:61472
    v_mfma_f32_16x16x32_bf16 v[140:143], a[32:35], v[60:63], v[140:143]
    ds_read_b64_tr_b16 a[46:47], v37 offset:62240
    v_mfma_f32_16x16x32_bf16 v[140:143], a[36:39], v[156:159], v[140:143]
    ds_read_b64_tr_b16 a[68:69], v37 offset:61504
    buffer_load_dwordx4 v87, s[32:35], s92 offen offset:0 lds
    v_mfma_f32_16x16x32_bf16 v[100:103], a[52:55], v[168:171], v[100:103]
    ds_read_b64_tr_b16 a[70:71], v37 offset:62272
    v_mfma_f32_16x16x32_bf16 v[100:103], a[56:59], v[60:63], v[100:103]
    ds_read_b128 v[60:63], v10 offset:256
    v_mfma_f32_16x16x32_bf16 v[100:103], a[60:63], v[156:159], v[100:103]
    s_waitcnt lgkmcnt(8)
    ds_read_b32 v205, v205 offset:336
    v_mfma_f32_16x16x32_bf16 v[16:19], a[16:19], v[144:147], v[16:19]
    v_mfma_f32_16x16x32_bf16 v[88:91], a[40:43], v[144:147], v[88:91]
    ds_read_b32 v206, v206 offset:336
    buffer_load_dwordx4 v99, s[32:35], s92 offen offset:1024 lds
    v_mfma_f32_16x16x32_bf16 v[72:75], a[64:67], v[144:147], v[72:75]
    s_waitcnt lgkmcnt(7)
    v_mfma_f32_16x16x32_bf16 v[16:19], a[20:23], v[148:151], v[16:19]
    ds_read_b128 v[144:147], v10 offset:1792
    v_mfma_f32_16x16x32_bf16 v[56:59], a[16:19], v[80:83], v[56:59]
    s_waitcnt lgkmcnt(6)
    s_nop 0
    ds_read_b32 v207, v207 offset:336
    s_nop 0
    v_mfma_f32_16x16x32_bf16 v[88:91], a[44:47], v[148:151], v[88:91]
    s_nop 0
    v_cvt_pk_f16_f32 v16, v16, v17
    v_cvt_pk_f16_f32 v17, v18, v19
    v_mfma_f32_16x16x32_bf16 v[56:59], a[20:23], v[76:79], v[56:59]
    s_waitcnt lgkmcnt(5)
    ds_read_b32 v200, v200 offset:336
    buffer_load_dwordx4 v8, s[32:35], s92 offen offset:2048 lds
    v_mfma_f32_16x16x32_bf16 v[72:75], a[68:71], v[148:151], v[72:75]
    s_add_u32 m0, s90, 49152
    v_pk_fma_f16 v84, v16, v16, s39
    v_pk_fmac_f16 v84, v17, v17
    v_mfma_f32_16x16x32_bf16 v[108:111], a[40:43], v[80:83], v[108:111]
    s_waitcnt vmcnt(9)
    s_mov_b32 s92, 147840
    ds_read_b64_tr_b16 a[72:73], v37 offset:0
    v_cvt_pk_f16_f32 v18, v88, v89
    v_mfma_f32_16x16x32_bf16 v[108:111], a[44:47], v[76:79], v[108:111]
    ds_read_b64_tr_b16 a[74:75], v37 offset:768
    v_cvt_pk_f16_f32 v19, v90, v91
    v_mfma_f32_16x16x32_bf16 v[40:43], a[64:67], v[80:83], v[40:43]
    ds_read_b64_tr_b16 a[96:97], v37 offset:32
    v_pk_fmac_f16 v84, v18, v18
    v_mfma_f32_16x16x32_bf16 v[40:43], a[68:71], v[76:79], v[40:43]
    s_waitcnt lgkmcnt(6)
    ds_read_b64_tr_b16 a[98:99], v37 offset:800
    buffer_load_dwordx4 v87, s[32:35], s92 offen offset:0 lds
    v_mfma_f32_16x16x32_bf16 v[30:33], a[16:19], v[60:63], v[30:33]
    ds_read_b64_tr_b16 a[120:121], v37 offset:64
    v_pk_fmac_f16 v84, v19, v19
    v_mfma_f32_16x16x32_bf16 v[30:33], a[20:23], v[20:23], v[30:33]
    ds_read_b64_tr_b16 a[122:123], v37 offset:832
    v_cvt_pk_f16_f32 v92, v72, v73
    v_mfma_f32_16x16x32_bf16 v[152:155], a[40:43], v[60:63], v[152:155]
    ds_read_b128 v[76:79], v10 offset:3328
    v_cvt_pk_f16_f32 v93, v74, v75
    v_mfma_f32_16x16x32_bf16 v[152:155], a[44:47], v[20:23], v[152:155]
    ds_read_b128 v[148:151], v7 offset:40960
    v_pk_fmac_f16 v84, v92, v92
    v_mfma_f32_16x16x32_bf16 v[104:107], a[64:67], v[60:63], v[104:107]
    ds_read_b128 v[80:83], v7 offset:42496
    buffer_load_dwordx4 v99, s[32:35], s92 offen offset:1024 lds
    v_mfma_f32_16x16x32_bf16 v[104:107], a[68:71], v[20:23], v[104:107]
    s_waitcnt lgkmcnt(8)
    ds_read_b128 v[60:63], v7 offset:0
    v_pk_fmac_f16 v84, v93, v93
    v_mfma_f32_16x16x32_bf16 v[24:27], a[16:19], v[144:147], v[24:27]
    ds_read_b128 v[20:23], v7 offset:1536
    v_cvt_pk_f16_f32 v56, v56, v57
    v_mfma_f32_16x16x32_bf16 v[24:27], a[20:23], v[116:119], v[24:27]
    ds_read_b128 v[236:239], v7 offset:3072
    v_cvt_pk_f16_f32 v57, v58, v59
    v_mfma_f32_16x16x32_bf16 v[44:47], a[40:43], v[144:147], v[44:47]
    ds_read_b128 v[72:75], v10 offset:40960
    v_pk_fma_f16 v86, v56, v56, s39
    v_mfma_f32_16x16x32_bf16 v[44:47], a[44:47], v[116:119], v[44:47]
    ds_read_b128 v[88:91], v10 offset:42496
    buffer_load_dwordx4 v8, s[32:35], s92 offen offset:2048 lds
    v_mfma_f32_16x16x32_bf16 v[112:115], a[64:67], v[144:147], v[112:115]
    s_waitcnt vmcnt(9)
    s_add_u32 m0, s90, 61440
    ds_read_b64_tr_b16 a[76:77], v37 offset:12288
    v_pk_fmac_f16 v86, v57, v57
    v_mfma_f32_16x16x32_bf16 v[112:115], a[68:71], v[116:119], v[112:115]
    s_waitcnt lgkmcnt(8)
    s_mov_b32 s92, 184704
    ds_read_b64_tr_b16 a[78:79], v37 offset:13056
    v_cvt_pk_f16_f32 v58, v108, v109
    v_mfma_f32_16x16x32_bf16 v[12:15], a[16:19], v[76:79], v[12:15]
    ds_read_b64_tr_b16 a[100:101], v37 offset:12320
    v_cvt_pk_f16_f32 v59, v110, v111
    v_mfma_f32_16x16x32_bf16 v[12:15], a[20:23], v[52:55], v[12:15]
    ds_read_b64_tr_b16 a[102:103], v37 offset:13088
    v_pk_fmac_f16 v86, v58, v58
    v_mfma_f32_16x16x32_bf16 v[140:143], a[40:43], v[76:79], v[140:143]
    ds_read_b64_tr_b16 a[124:125], v37 offset:12352
    buffer_load_dwordx4 v87, s[32:35], s92 offen offset:0 lds
    v_mfma_f32_16x16x32_bf16 v[140:143], a[44:47], v[52:55], v[140:143]
    ds_read_b64_tr_b16 a[126:127], v37 offset:13120
    v_pk_fmac_f16 v86, v59, v59
    v_mfma_f32_16x16x32_bf16 v[100:103], a[64:67], v[76:79], v[100:103]
    ds_read_b128 v[144:147], v10 offset:0
    v_cvt_pk_f16_f32 v40, v40, v41
    v_mfma_f32_16x16x32_bf16 v[100:103], a[68:71], v[52:55], v[100:103]
    s_waitcnt lgkmcnt(8)
    ds_read_b32 v201, v201 offset:336
    v_cvt_pk_f16_f32 v41, v42, v43
    v_mfma_f32_16x16x32_bf16 v[76:79], a[72:75], v[72:75], 0
    v_pk_fmac_f16 v86, v40, v40
    v_pk_fmac_f16 v86, v41, v41
    v_mfma_f32_16x16x32_bf16 v[232:235], a[96:99], v[72:75], 0
    ds_read_b32 v202, v202 offset:336
    buffer_load_dwordx4 v99, s[32:35], s92 offen offset:1024 lds
    v_mfma_f32_16x16x32_bf16 v[52:55], a[120:123], v[72:75], 0
    s_waitcnt lgkmcnt(7)
    v_cvt_pk_f16_f32 v116, v30, v31
    v_cvt_pk_f16_f32 v117, v32, v33
    v_mfma_f32_16x16x32_bf16 v[76:79], a[76:79], v[148:151], v[76:79]
    ds_read_b128 v[108:111], v10 offset:1536
    v_pk_fma_f16 v68, v116, v116, s39
    v_mfma_f32_16x16x32_bf16 v[72:75], a[72:75], v[88:91], 0
    s_waitcnt lgkmcnt(6)
    ds_read_b32 v203, v203 offset:336
    v_pk_fmac_f16 v68, v117, v117
    v_mfma_f32_16x16x32_bf16 v[232:235], a[100:103], v[148:151], v[232:235]
    v_cvt_pk_f16_f32 v118, v152, v153
    v_cvt_pk_f16_f32 v119, v154, v155
    v_mfma_f32_16x16x32_bf16 v[72:75], a[76:79], v[80:83], v[72:75]
    s_waitcnt lgkmcnt(5)
    ds_read_b32 v196, v196 offset:336
    buffer_load_dwordx4 v8, s[32:35], s92 offen offset:2048 lds
    v_mfma_f32_16x16x32_bf16 v[52:55], a[124:127], v[148:151], v[52:55]
    s_add_u32 m0, s90, 0
    v_pk_fmac_f16 v68, v118, v118
    v_pk_fmac_f16 v68, v119, v119
    v_mfma_f32_16x16x32_bf16 v[228:231], a[96:99], v[88:91], 0
    s_waitcnt vmcnt(9)
    s_mov_b32 s92, 768
    ds_read_b64_tr_b16 a[80:81], v37 offset:24576
    v_cvt_pk_f16_f32 v152, v104, v105
    v_mfma_f32_16x16x32_bf16 v[228:231], a[100:103], v[80:83], v[228:231]
    ds_read_b64_tr_b16 a[82:83], v37 offset:25344
    v_cvt_pk_f16_f32 v153, v106, v107
    v_mfma_f32_16x16x32_bf16 v[224:227], a[120:123], v[88:91], 0
    ds_read_b64_tr_b16 a[104:105], v37 offset:24608
    v_pk_fmac_f16 v68, v152, v152
    v_mfma_f32_16x16x32_bf16 v[224:227], a[124:127], v[80:83], v[224:227]
    s_waitcnt lgkmcnt(6)
    ds_read_b64_tr_b16 a[106:107], v37 offset:25376
    buffer_load_dwordx4 v87, s[32:35], s92 offen offset:0 lds
    v_mfma_f32_16x16x32_bf16 v[80:83], a[72:75], v[144:147], 0
    ds_read_b64_tr_b16 a[128:129], v37 offset:24640
    v_pk_fmac_f16 v68, v153, v153
    v_mfma_f32_16x16x32_bf16 v[80:83], a[76:79], v[60:63], v[80:83]
    ds_read_b64_tr_b16 a[130:131], v37 offset:25408
    v_cvt_pk_f16_f32 v24, v24, v25
    v_mfma_f32_16x16x32_bf16 v[156:159], a[96:99], v[144:147], 0
    ds_read_b128 v[244:247], v10 offset:3072
    v_cvt_pk_f16_f32 v25, v26, v27
    v_mfma_f32_16x16x32_bf16 v[156:159], a[100:103], v[60:63], v[156:159]
    ds_read_b128 v[104:107], v10 offset:41088
    v_pk_fma_f16 v70, v24, v24, s39
    v_mfma_f32_16x16x32_bf16 v[88:91], a[120:123], v[144:147], 0
    ds_read_b32 v197, v197 offset:336
    buffer_load_dwordx4 v99, s[32:35], s92 offen offset:1024 lds
    v_mfma_f32_16x16x32_bf16 v[88:91], a[124:127], v[60:63], v[88:91]
    s_waitcnt lgkmcnt(8)
    v_pk_fmac_f16 v70, v25, v25
    v_cvt_pk_f16_f32 v26, v44, v45
    v_mfma_f32_16x16x32_bf16 v[32:35], a[72:75], v[108:111], 0
    ds_read_b128 v[60:63], v10 offset:42624
    v_cvt_pk_f16_f32 v27, v46, v47
    v_mfma_f32_16x16x32_bf16 v[32:35], a[76:79], v[20:23], v[32:35]
    ds_read_b32 v198, v198 offset:336
    v_pk_fmac_f16 v70, v26, v26
    v_mfma_f32_16x16x32_bf16 v[168:171], a[96:99], v[108:111], 0
    v_pk_fmac_f16 v70, v27, v27
    v_cvt_pk_f16_f32 v146, v112, v113
    v_mfma_f32_16x16x32_bf16 v[168:171], a[100:103], v[20:23], v[168:171]
    s_waitcnt vmcnt(8)
    ds_read_b128 v[44:47], v10 offset:128
    buffer_load_dwordx4 v8, s[32:35], s92 offen offset:2048 lds
    v_cvt_pk_f16_f32 v147, v114, v115
    v_pk_fmac_f16 v70, v146, v146
    s_add_u32 m0, s90, 12288
    s_mov_b32 s92, 37632
    ds_read_b64_tr_b16 a[84:85], v37 offset:36864
    v_pk_fmac_f16 v70, v147, v147
    v_mfma_f32_16x16x32_bf16 v[148:151], a[120:123], v[108:111], 0
    ds_read_b64_tr_b16 a[86:87], v37 offset:37632
    v_cvt_pk_f16_f32 v108, v12, v13
    v_mfma_f32_16x16x32_bf16 v[148:151], a[124:127], v[20:23], v[148:151]
    s_waitcnt lgkmcnt(5)
    ds_read_b64_tr_b16 a[108:109], v37 offset:36896
    v_cvt_pk_f16_f32 v109, v14, v15
    v_mfma_f32_16x16x32_bf16 v[112:115], a[72:75], v[244:247], 0
    ds_read_b64_tr_b16 a[110:111], v37 offset:37664
    v_pk_fma_f16 v36, v108, v108, s39
    v_mfma_f32_16x16x32_bf16 v[112:115], a[76:79], v[236:239], v[112:115]
    buffer_load_dwordx4 v87, s[32:35], s92 offen offset:0 lds
    ds_read_b64_tr_b16 a[132:133], v37 offset:36928
    v_mfma_f32_16x16x32_bf16 v[12:15], a[96:99], v[244:247], 0
    ds_read_b64_tr_b16 a[134:135], v37 offset:37696
    v_pk_fmac_f16 v36, v109, v109
    v_mfma_f32_16x16x32_bf16 v[12:15], a[100:103], v[236:239], v[12:15]
    ds_read_b128 v[20:23], v10 offset:1664
    v_cvt_pk_f16_f32 v110, v140, v141
    v_mfma_f32_16x16x32_bf16 v[76:79], a[80:83], v[104:107], v[76:79]
    ds_read_b128 v[240:243], v10 offset:3200
    v_cvt_pk_f16_f32 v111, v142, v143
    v_mfma_f32_16x16x32_bf16 v[232:235], a[104:107], v[104:107], v[232:235]
    ds_read_b32 v199, v199 offset:336
    v_pk_fmac_f16 v36, v110, v110
    v_mfma_f32_16x16x32_bf16 v[52:55], a[128:131], v[104:107], v[52:55]
    s_waitcnt lgkmcnt(8)
    buffer_load_dwordx4 v99, s[32:35], s92 offen offset:1024 lds
    v_pk_fmac_f16 v36, v111, v111
    v_mfma_f32_16x16x32_bf16 v[72:75], a[80:83], v[60:63], v[72:75]
    ds_read_b128 v[104:107], v7 offset:41088
    v_cvt_pk_f16_f32 v140, v100, v101
    v_mfma_f32_16x16x32_bf16 v[228:231], a[104:107], v[60:63], v[228:231]
    v_cvt_pk_f16_f32 v141, v102, v103
    v_pk_fmac_f16 v36, v140, v140
    v_mfma_f32_16x16x32_bf16 v[224:227], a[128:131], v[60:63], v[224:227]
    ds_read_b128 v[100:103], v7 offset:42624
    v_pk_fmac_f16 v36, v141, v141
    v_mfma_f32_16x16x32_bf16 v[60:63], a[120:123], v[244:247], 0
    v_mov_b32 v38, 0
    v_mov_b32 v39, 0
    v_mfma_f32_16x16x32_bf16 v[60:63], a[124:127], v[236:239], v[60:63]
    s_waitcnt vmcnt(8)
    buffer_load_dwordx4 v8, s[32:35], s92 offen offset:2048 lds
    ds_read_b64_tr_b16 a[88:89], v37 offset:49152
    v_mfma_f32_16x16x32_bf16 v[80:83], a[80:83], v[44:47], v[80:83]
    s_add_u32 m0, s90, 24576
    ds_read_b64_tr_b16 a[90:91], v37 offset:49920
    v_mov_b32 v1, 0xf149f2ca
    v_mfma_f32_16x16x32_bf16 v[156:159], a[104:107], v[44:47], v[156:159]
    s_mov_b32 s92, 74496
    ds_read_b64_tr_b16 a[112:113], v37 offset:49184
    v_mfma_f32_16x16x32_bf16 v[88:91], a[128:131], v[44:47], v[88:91]
    s_waitcnt lgkmcnt(5)
    ds_read_b64_tr_b16 a[114:115], v37 offset:49952
    v_mfma_f32_16x16x32_bf16 v[32:35], a[80:83], v[20:23], v[32:35]
    ds_read_b64_tr_b16 a[136:137], v37 offset:49216
    v_mfma_f32_16x16x32_bf16 v[168:171], a[104:107], v[20:23], v[168:171]
    buffer_load_dwordx4 v87, s[32:35], s92 offen offset:0 lds
    ds_read_b64_tr_b16 a[138:139], v37 offset:49984
    v_mfma_f32_16x16x32_bf16 v[148:151], a[128:131], v[20:23], v[148:151]
    ds_read_b128 v[44:47], v7 offset:128
    v_mfma_f32_16x16x32_bf16 v[112:115], a[80:83], v[240:243], v[112:115]
    ds_read_b128 v[20:23], v7 offset:1664
    v_mfma_f32_16x16x32_bf16 v[12:15], a[104:107], v[240:243], v[12:15]
    ds_read_b128 v[236:239], v7 offset:3200
    v_mfma_f32_16x16x32_bf16 v[60:63], a[128:131], v[240:243], v[60:63]
    s_waitcnt lgkmcnt(8)
    s_cmp_ge_u32 s2, 247
    s_cbranch_scc1 L_maskF
L_nomaskF:
    v_mfma_f32_16x16x32_bf16 v[76:79], a[84:87], v[104:107], v[76:79]
    buffer_load_dwordx4 v99, s[32:35], s92 offen offset:1024 lds
    ds_read_b128 v[240:243], v10 offset:41216
    v_mfma_f32_16x16x32_bf16 v[232:235], a[108:111], v[104:107], v[232:235]
    v_readlane_b32 s84, v211, 48
    v_cmp_gt_u32 vcc, 16, v3
    v_mfma_f32_16x16x32_bf16 v[52:55], a[132:135], v[104:107], v[52:55]
    s_nop 0
    v_cndmask_b32 v208, v1, v208, vcc
    v_cndmask_b32 v209, v1, v209, vcc
    v_mfma_f32_16x16x32_bf16 v[72:75], a[84:87], v[100:103], v[72:75]
    ds_read_b128 v[104:107], v10 offset:42752
    v_cndmask_b32 v210, v1, v210, vcc
    v_mfma_f32_16x16x32_bf16 v[228:231], a[108:111], v[100:103], v[228:231]
    v_cmp_gt_u32 vcc, 49, v3
    v_mfma_f32_16x16x32_bf16 v[224:227], a[132:135], v[100:103], v[224:227]
    s_waitcnt vmcnt(8) lgkmcnt(4)
    buffer_load_dwordx4 v8, s[32:35], s92 offen offset:2048 lds
    ds_read_b64_tr_b16 a[92:93], v37 offset:61440
    v_mfma_f32_16x16x32_bf16 v[80:83], a[84:87], v[44:47], v[80:83]
    s_add_u32 m0, s90, 36864
    ds_read_b64_tr_b16 a[94:95], v37 offset:62208
    v_cndmask_b32 v211, v1, v211, vcc
    v_mfma_f32_16x16x32_bf16 v[156:159], a[108:111], v[44:47], v[156:159]
    s_mov_b32 s92, 111360
    ds_read_b64_tr_b16 a[116:117], v37 offset:61472
    v_mfma_f32_16x16x32_bf16 v[88:91], a[132:135], v[44:47], v[88:91]
    s_waitcnt lgkmcnt(5)
    s_mov_b32 s53, s47
    ds_read_b64_tr_b16 a[118:119], v37 offset:62240
    v_mfma_f32_16x16x32_bf16 v[32:35], a[84:87], v[20:23], v[32:35]
    s_mov_b32 s47, s46
    ds_read_b64_tr_b16 a[140:141], v37 offset:61504
    v_mfma_f32_16x16x32_bf16 v[168:171], a[108:111], v[20:23], v[168:171]
    s_mov_b32 s46, s45
    buffer_load_dwordx4 v87, s[32:35], s92 offen offset:0 lds
    ds_read_b64_tr_b16 a[142:143], v37 offset:62272
    v_mfma_f32_16x16x32_bf16 v[148:151], a[132:135], v[20:23], v[148:151]
    s_mov_b32 s45, s44
    ds_read_b128 v[44:47], v10 offset:256
    v_mfma_f32_16x16x32_bf16 v[112:115], a[84:87], v[236:239], v[112:115]
    s_mov_b32 s44, s53
    ds_read_b128 v[20:23], v10 offset:1792
    v_mov_b32 v30, 0
    v_mfma_f32_16x16x32_bf16 v[12:15], a[108:111], v[236:239], v[12:15]
    s_sub_u32 s48, s44, s46
    ds_read_b128 v[100:103], v10 offset:3328
    v_mov_b32 v31, 0
    v_mfma_f32_16x16x32_bf16 v[60:63], a[132:135], v[236:239], v[60:63]
    s_waitcnt lgkmcnt(8)
    s_sub_u32 s49, s46, s45
    v_mov_b32 v9, 0
    v_add_u32 v1, 28672, v28
    v_mfma_f32_16x16x32_bf16 v[76:79], a[88:91], v[240:243], v[76:79]
    s_sub_u32 s50, s45, s44
    buffer_load_dwordx4 v99, s[32:35], s92 offen offset:1024 lds
    ds_read_b128 v[236:239], v7 offset:41216
    v_mfma_f32_16x16x32_bf16 v[232:235], a[112:115], v[240:243], v[232:235]
    s_sub_u32 s51, s46, s47
    v_add_u32 v137, s48, v137
    v_add_u32 v136, s48, v136
    v_mfma_f32_16x16x32_bf16 v[52:55], a[136:139], v[240:243], v[52:55]
    s_mov_b32 s60, s59
    ds_write2_b64 v1, v[30:31], v[30:31] offset0:2 offset1:3
    v_mfma_f32_16x16x32_bf16 v[72:75], a[88:91], v[104:107], v[72:75]
    s_mov_b32 s59, s58
    v_add_u32 v135, s49, v135
    v_add_u32 v134, s49, v134
    v_mfma_f32_16x16x32_bf16 v[228:231], a[112:115], v[104:107], v[228:231]
    s_mov_b32 s58, s57
    buffer_load_dwordx4 v8, s[32:35], s92 offen offset:2048 lds
    v_add_u32 v137, s50, v137
    v_mfma_f32_16x16x32_bf16 v[224:227], a[136:139], v[104:107], v[224:227]
    s_waitcnt vmcnt(9) lgkmcnt(3)
    s_add_u32 m0, s90, 49152
    ds_read_b64_tr_b16 a[144:145], v139 offset:0
    v_add_u32 v136, s50, v136
    v_mfma_f32_16x16x32_bf16 v[80:83], a[88:91], v[44:47], v[80:83]
    s_mov_b32 s92, 148224
    ds_read_b64_tr_b16 a[146:147], v139 offset:768
    v_add_u32 v135, s48, v135
    v_mfma_f32_16x16x32_bf16 v[156:159], a[112:115], v[44:47], v[156:159]
    s_mov_b32 s57, s56
    ds_read_b64_tr_b16 a[168:169], v139 offset:8
    v_add_u32 v134, s48, v134
    v_mfma_f32_16x16x32_bf16 v[88:91], a[136:139], v[44:47], v[88:91]
    s_mov_b32 s7, s6
    ds_read_b64_tr_b16 a[170:171], v139 offset:776
    v_add_u32 v133, s51, v133
    v_mfma_f32_16x16x32_bf16 v[32:35], a[88:91], v[20:23], v[32:35]
    s_mov_b32 s6, s5
    ds_read_b64_tr_b16 a[192:193], v37 offset:64
    buffer_load_dwordx4 v87, s[32:35], s92 offen offset:0 lds
    v_mfma_f32_16x16x32_bf16 v[168:171], a[112:115], v[20:23], v[168:171]
    s_mov_b32 s5, s4
    ds_read_b64_tr_b16 a[194:195], v37 offset:832
    v_mfma_f32_16x16x32_bf16 v[148:151], a[136:139], v[20:23], v[148:151]
    s_waitcnt lgkmcnt(6)
    s_sub_u32 s14, s6, s7
    ds_read_b128 v[104:107], v7 offset:42752
    v_add_u32 v132, s14, v132
    v_mfma_f32_16x16x32_bf16 v[112:115], a[88:91], v[100:103], v[112:115]
    s_add_u32 s61, s61, 1
    ds_read_b128 v[44:47], v7 offset:256
    v_add_u32 v131, s14, v131
    v_mfma_f32_16x16x32_bf16 v[12:15], a[112:115], v[100:103], v[12:15]
    s_add_u32 s12, s12, 20
    ds_read_b128 v[20:23], v7 offset:1792
    v_mfma_f32_16x16x32_bf16 v[60:63], a[136:139], v[100:103], v[60:63]
    s_max_u32 s12, s12, s61
    buffer_load_dwordx4 v99, s[32:35], s92 offen offset:1024 lds
    ds_read_b128 v[100:103], v7 offset:3328
    v_mfma_f32_16x16x32_bf16 v[76:79], a[92:95], v[236:239], v[76:79]
    s_add_u32 s65, s65, 1
    v_mfma_f32_16x16x32_bf16 v[232:235], a[116:119], v[236:239], v[232:235]
    s_cmp_ge_i32 s65, 2
    s_nop 0
    v_mfma_f32_16x16x32_bf16 v[52:55], a[140:143], v[236:239], v[52:55]
    s_waitcnt vmcnt(8)
    s_cselect_b32 s30, 100270464, 0
    ds_read_b128 v[236:239], v10 offset:40960
    v_cvt_pk_f16_f32 v76, v76, v77
    v_cvt_pk_f16_f32 v77, v78, v79
    v_pk_fma_f16 v85, v76, v76, s39
    v_pk_fmac_f16 v85, v77, v77
    v_cvt_pk_f16_f32 v78, v232, v233
    v_cvt_pk_f16_f32 v79, v234, v235
    v_pk_fmac_f16 v85, v78, v78
    s_add_u32 s67, s46, s54
    ds_read_b64_tr_b16 a[148:149], v139 offset:12288
    s_waitcnt lgkmcnt(5)
    v_mfma_f32_16x16x32_bf16 v[72:75], a[92:95], v[104:107], v[72:75]
    buffer_load_dwordx4 v8, s[32:35], s92 offen offset:2048 lds
    ds_read_b64_tr_b16 a[150:151], v139 offset:13056
    v_mfma_f32_16x16x32_bf16 v[228:231], a[116:119], v[104:107], v[228:231]
    s_add_u32 m0, s90, 61440
    v_pk_fmac_f16 v85, v79, v79
    v_cvt_pk_f16_f32 v98, v52, v53
    v_mfma_f32_16x16x32_bf16 v[224:227], a[140:143], v[104:107], v[224:227]
    s_waitcnt lgkmcnt(4)
    s_mov_b32 s92, 185088
    ds_read_b64_tr_b16 a[172:173], v139 offset:12296
    v_cvt_pk_f16_f32 v72, v72, v73
    v_mfma_f32_16x16x32_bf16 v[80:83], a[92:95], v[44:47], v[80:83]
    ds_read_b64_tr_b16 a[174:175], v139 offset:13064
    v_cvt_pk_f16_f32 v73, v74, v75
    v_mfma_f32_16x16x32_bf16 v[156:159], a[116:119], v[44:47], v[156:159]
    ds_read_b64_tr_b16 a[196:197], v37 offset:12352
    buffer_load_dwordx4 v87, s[32:35], s92 offen offset:0 lds
    v_mfma_f32_16x16x32_bf16 v[88:91], a[140:143], v[44:47], v[88:91]
    ds_read_b64_tr_b16 a[198:199], v37 offset:13120
    v_pk_fma_f16 v87, v72, v72, s39
    v_mfma_f32_16x16x32_bf16 v[32:35], a[92:95], v[20:23], v[32:35]
    ds_read_b128 v[232:235], v7 offset:40960
    v_pk_fmac_f16 v87, v73, v73
    v_mfma_f32_16x16x32_bf16 v[168:171], a[116:119], v[20:23], v[168:171]
    ds_read_b128 v[104:107], v10 offset:41088
    v_cvt_pk_f16_f32 v74, v228, v229
    v_mfma_f32_16x16x32_bf16 v[148:151], a[140:143], v[20:23], v[148:151]
    s_waitcnt lgkmcnt(7)
    ds_read_b128 v[44:47], v7 offset:41088
    v_cvt_pk_f16_f32 v75, v230, v231
    v_mfma_f32_16x16x32_bf16 v[112:115], a[92:95], v[100:103], v[112:115]
    buffer_load_dwordx4 v99, s[32:35], s92 offen offset:1024 lds
    ds_read_b128 v[20:23], v10 offset:41216
    v_mfma_f32_16x16x32_bf16 v[12:15], a[116:119], v[100:103], v[12:15]
    v_pk_fmac_f16 v87, v74, v74
    v_pk_fmac_f16 v87, v75, v75
    v_mfma_f32_16x16x32_bf16 v[60:63], a[140:143], v[100:103], v[60:63]
    ds_read_b128 v[100:103], v7 offset:41216
    v_cvt_pk_f16_f32 v42, v224, v225
    v_cvt_pk_f16_f32 v43, v226, v227
    v_pk_fmac_f16 v87, v42, v42
    v_pk_fmac_f16 v87, v43, v43
    v_cvt_pk_f16_f32 v32, v32, v33
    v_cvt_pk_f16_f32 v33, v34, v35
    v_pk_fma_f16 v71, v32, v32, s39
    v_pk_fmac_f16 v71, v33, v33
    v_cvt_pk_f16_f32 v34, v168, v169
    v_cvt_pk_f16_f32 v35, v170, v171
    s_waitcnt vmcnt(8)
    ds_read_b64_tr_b16 a[152:153], v139 offset:24576
    buffer_load_dwordx4 v8, s[32:35], s92 offen offset:2048 lds
    s_add_u32 m0, s90, 0
    s_mov_b32 s92, 0
    ds_read_b64_tr_b16 a[154:155], v139 offset:25344
    v_pk_fmac_f16 v71, v34, v34
    v_pk_fmac_f16 v71, v35, v35
    v_cvt_pk_f16_f32 v148, v148, v149
    ds_read_b64_tr_b16 a[176:177], v139 offset:24584
    v_cvt_pk_f16_f32 v149, v150, v151
    v_pk_fmac_f16 v71, v148, v148
    v_pk_fmac_f16 v71, v149, v149
    ds_read_b64_tr_b16 a[178:179], v139 offset:25352
    v_cvt_pk_f16_f32 v80, v80, v81
    ds_read_b64_tr_b16 a[200:201], v37 offset:24640
    buffer_load_dwordx4 v0, s[76:79], s92 offen offset:0 lds
    ds_read_b64_tr_b16 a[202:203], v37 offset:25408
    v_cvt_pk_f16_f32 v81, v82, v83
    v_pk_fma_f16 v69, v80, v80, s39
    v_pk_fmac_f16 v69, v81, v81
    v_cvt_pk_f16_f32 v82, v156, v157
    v_cvt_pk_f16_f32 v83, v158, v159
    v_pk_fmac_f16 v69, v82, v82
    v_pk_fmac_f16 v69, v83, v83
    v_cvt_pk_f16_f32 v154, v88, v89
    v_cvt_pk_f16_f32 v155, v90, v91
    v_pk_fmac_f16 v69, v154, v154
    v_pk_fmac_f16 v69, v155, v155
    v_cvt_pk_f16_f32 v99, v54, v55
    v_pk_fmac_f16 v85, v98, v98
    v_mfma_f32_16x16x32_f16 v[52:55], v[212:215], v[68:71], 0
    buffer_load_dwordx4 v166, s[76:79], s92 offen offset:1024 lds
    v_pk_fmac_f16 v85, v99, v99
    v_mov_b32 v171, 0
    v_mov_b32 v167, 0
    v_mfma_f32_16x16x32_f16 v[68:71], v[212:215], v[84:87], 0
    s_nop 0
    v_mov_b32 v163, 0
    v_mov_b32 v159, 0
    v_mov_b32 v150, 0
    v_mov_b32 v151, 0
    v_mov_b32 v144, 0
    v_mov_b32 v145, 0
    v_mov_b32 v138, 0
    v_or3_b32 v123, v123, v68, v69
    v_rsq_f32 v68, v68
    v_rsq_f32 v69, v69
    v_mul_f32 v68, s52, v68
    v_cvt_pk_f16_f32 v68, v68, v69
    s_waitcnt vmcnt(8)
    ds_read_b64_tr_b16 a[156:157], v139 offset:36864
    buffer_load_dwordx4 v162, s[76:79], s92 offen offset:2048 lds
    s_add_u32 m0, s90, 12288
    s_mov_b32 s92, 12288
    ds_read_b64_tr_b16 a[158:159], v139 offset:37632
    v_or3_b32 v123, v123, v70, v71
    v_rsq_f32 v70, v70
    ds_read_b64_tr_b16 a[180:181], v139 offset:36872
    v_rsq_f32 v71, v71
    v_mul_f32 v70, s52, v70
    ds_read_b64_tr_b16 a[182:183], v139 offset:37640
    v_cvt_pk_f16_f32 v70, v70, v71
    ds_read_b64_tr_b16 a[204:205], v37 offset:36928
    s_waitcnt lgkmcnt(5)
    buffer_load_dwordx4 v0, s[76:79], s92 offen offset:0 lds
    ds_read_b64_tr_b16 a[206:207], v37 offset:37696
    v_pk_mul_f16 v16, v16, v68 op_sel:[0,0] op_sel_hi:[1,0]
    v_pk_mul_f16 v17, v17, v68 op_sel:[0,0] op_sel_hi:[1,0]
    v_pk_mul_f16 v18, v18, v68 op_sel:[0,0] op_sel_hi:[1,0]
    v_pk_mul_f16 v19, v19, v68 op_sel:[0,0] op_sel_hi:[1,0]
    v_pk_mul_f16 v92, v92, v68 op_sel:[0,0] op_sel_hi:[1,0]
    v_pk_mul_f16 v93, v93, v68 op_sel:[0,0] op_sel_hi:[1,0]
    v_pk_mul_f16 v76, v76, v68 op_sel:[0,1] op_sel_hi:[1,1]
    v_pk_mul_f16 v77, v77, v68 op_sel:[0,1] op_sel_hi:[1,1]
    v_pk_mul_f16 v78, v78, v68 op_sel:[0,1] op_sel_hi:[1,1]
    v_pk_mul_f16 v79, v79, v68 op_sel:[0,1] op_sel_hi:[1,1]
    v_pk_mul_f16 v98, v98, v68 op_sel:[0,1] op_sel_hi:[1,1]
    v_pk_mul_f16 v99, v99, v68 op_sel:[0,1] op_sel_hi:[1,1]
    v_fma_mix_f32 v8, v16, v76, 0 op_sel:[0,0,0] op_sel_hi:[1,1,0]
    v_fma_mix_f32 v8, v16, v76, v8 op_sel:[1,1,0] op_sel_hi:[1,1,0]
    v_fma_mix_f32 v8, v17, v77, v8 op_sel:[0,0,0] op_sel_hi:[1,1,0]
    buffer_load_dwordx4 v166, s[76:79], s92 offen offset:1024 lds
    ds_write_b128 v1, v[76:79]
    v_fma_mix_f32 v8, v17, v77, v8 op_sel:[1,1,0] op_sel_hi:[1,1,0]
    v_fma_mix_f32 v8, v18, v78, v8 op_sel:[0,0,0] op_sel_hi:[1,1,0]
    v_fma_mix_f32 v8, v18, v78, v8 op_sel:[1,1,0] op_sel_hi:[1,1,0]
    v_fma_mix_f32 v8, v19, v79, v8 op_sel:[0,0,0] op_sel_hi:[1,1,0]
    v_fma_mix_f32 v8, v19, v79, v8 op_sel:[1,1,0] op_sel_hi:[1,1,0]
    v_fma_mix_f32 v8, v92, v98, v8 op_sel:[0,0,0] op_sel_hi:[1,1,0]
    v_fma_mix_f32 v8, v92, v98, v8 op_sel:[1,1,0] op_sel_hi:[1,1,0]
    v_fma_mix_f32 v8, v93, v99, v8 op_sel:[0,0,0] op_sel_hi:[1,1,0]
    v_fma_mix_f32 v8, v93, v99, v8 op_sel:[1,1,0] op_sel_hi:[1,1,0]
    v_mov_b32 v120, v8
    s_waitcnt vmcnt(8)
    ds_read_b64_tr_b16 a[160:161], v139 offset:49152
    buffer_load_dwordx4 v162, s[76:79], s92 offen offset:2048 lds
    s_add_u32 m0, s90, 24576
    s_mov_b32 s92, 24576
    ds_read_b64_tr_b16 a[162:163], v139 offset:49920
    v_permlane32_swap_b32 v120, v8
    v_add_f32 v8, v120, v8
    ds_read_b64_tr_b16 a[184:185], v139 offset:49160
    v_mov_b32 v120, v8
    v_or3_b32 v123, v123, v52, v53
    v_rsq_f32 v52, v52
    ds_read_b64_tr_b16 a[186:187], v139 offset:49928
    v_permlane16_swap_b32 v120, v8
    ds_read_b64_tr_b16 a[208:209], v37 offset:49216
    buffer_load_dwordx4 v0, s[76:79], s92 offen offset:0 lds
    ds_read_b64_tr_b16 a[210:211], v37 offset:49984
    v_add_f32 v8, v120, v8
    ds_write_b128 v1, v[16:19] offset:32
    v_rsq_f32 v53, v53
    v_mul_f32 v52, s52, v52
    v_cvt_pk_f16_f32 v52, v52, v53
    v_or3_b32 v123, v123, v54, v55
    v_rsq_f32 v54, v54
    buffer_load_dwordx4 v166, s[76:79], s92 offen offset:1024 lds
    ds_write2_b64 v1, v[98:99], v[30:31] offset0:6 offset1:7
    v_rsq_f32 v55, v55
    v_mul_f32 v54, s52, v54
    v_cvt_pk_f16_f32 v54, v54, v55
    v_pk_mul_f16 v80, v80, v52 op_sel:[0,1] op_sel_hi:[1,1]
    v_pk_mul_f16 v81, v81, v52 op_sel:[0,1] op_sel_hi:[1,1]
    v_pk_mul_f16 v82, v82, v52 op_sel:[0,1] op_sel_hi:[1,1]
    v_pk_mul_f16 v83, v83, v52 op_sel:[0,1] op_sel_hi:[1,1]
    ds_write2_b64 v1, v[30:31], v[92:93] offset0:8 offset1:9
    buffer_load_dwordx4 v162, s[76:79], s92 offen offset:2048 lds
    s_add_u32 m0, s90, 36864
    s_mov_b32 s92, 36864
    v_pk_mul_f16 v154, v154, v52 op_sel:[0,1] op_sel_hi:[1,1]
    v_pk_mul_f16 v155, v155, v52 op_sel:[0,1] op_sel_hi:[1,1]
    v_pk_mul_f16 v116, v116, v52 op_sel:[0,0] op_sel_hi:[1,0]
    v_pk_mul_f16 v117, v117, v52 op_sel:[0,0] op_sel_hi:[1,0]
    v_pk_mul_f16 v118, v118, v52 op_sel:[0,0] op_sel_hi:[1,0]
    s_waitcnt vmcnt(9)
    ds_read_b64_tr_b16 a[164:165], v139 offset:61440
    v_pk_mul_f16 v119, v119, v52 op_sel:[0,0] op_sel_hi:[1,0]
    v_pk_mul_f16 v152, v152, v52 op_sel:[0,0] op_sel_hi:[1,0]
    v_pk_mul_f16 v153, v153, v52 op_sel:[0,0] op_sel_hi:[1,0]
    v_mfma_f32_16x16x32_f16 v[76:79], v[80:83], v[116:119], v[204:207]
    s_waitcnt lgkmcnt(2)
    ds_read_b64_tr_b16 a[166:167], v139 offset:62208
    buffer_load_dwordx4 v0, s[76:79], s92 offen offset:0 lds
    v_mfma_f32_16x16x32_f16 v[76:79], v[152:155], v[150:153], v[76:79]
    ds_read_b64_tr_b16 a[188:189], v139 offset:61448
    v_pk_mul_f16 v32, v32, v54 op_sel:[0,1] op_sel_hi:[1,1]
    v_mfma_f32_16x16x32_bf16 v[16:19], a[144:147], v[236:239], 0
    ds_read_b64_tr_b16 a[190:191], v139 offset:62216
    v_pk_mul_f16 v33, v33, v54 op_sel:[0,1] op_sel_hi:[1,1]
    v_mfma_f32_16x16x32_bf16 v[16:19], a[148:151], v[232:235], v[16:19]
    ds_read_b64_tr_b16 a[212:213], v37 offset:61504
    v_pk_mul_f16 v34, v34, v54 op_sel:[0,1] op_sel_hi:[1,1]
    v_mfma_f32_16x16x32_bf16 v[16:19], a[152:155], v[104:107], v[16:19]
    ds_read_b64_tr_b16 a[214:215], v37 offset:62272
    v_pk_mul_f16 v35, v35, v54 op_sel:[0,1] op_sel_hi:[1,1]
    v_mfma_f32_16x16x32_bf16 v[16:19], a[156:159], v[44:47], v[16:19]
    v_pk_mul_f16 v148, v148, v54 op_sel:[0,1] op_sel_hi:[1,1]
    v_pk_mul_f16 v149, v149, v54 op_sel:[0,1] op_sel_hi:[1,1]
    v_mfma_f32_16x16x32_bf16 v[16:19], a[160:163], v[20:23], v[16:19]
    buffer_load_dwordx4 v166, s[76:79], s92 offen offset:1024 lds
    v_pk_mul_f16 v24, v24, v54 op_sel:[0,0] op_sel_hi:[1,0]
    v_pk_mul_f16 v25, v25, v54 op_sel:[0,0] op_sel_hi:[1,0]
    v_pk_mul_f16 v26, v26, v54 op_sel:[0,0] op_sel_hi:[1,0]
    v_pk_mul_f16 v27, v27, v54 op_sel:[0,0] op_sel_hi:[1,0]
    v_pk_mul_f16 v146, v146, v54 op_sel:[0,0] op_sel_hi:[1,0]
    v_pk_mul_f16 v147, v147, v54 op_sel:[0,0] op_sel_hi:[1,0]
    v_mov_b32 v139, 0
    v_add_f32 v8, s84, v8
    v_exp_f32 v8, v8
    s_waitcnt lgkmcnt(4)
    v_mfma_f32_16x16x32_bf16 v[16:19], a[164:167], v[100:103], v[16:19]
    ds_read_b128 v[228:231], v10 offset:3072
    v_cvt_pk_bf16_f32 v8, v8, 0
    v_mfma_f32_16x16x32_bf16 v[88:91], a[168:171], v[236:239], 0
    s_nop 0
    buffer_load_dwordx4 v162, s[76:79], s92 offen offset:2048 lds
    ds_read_b128 v[224:227], v7 offset:3072
    v_mfma_f32_16x16x32_bf16 v[88:91], a[172:175], v[232:235], v[88:91]
    s_add_u32 m0, s90, 49152
    v_cvt_pk_bf16_f32 v30, v16, v17
    v_cvt_pk_bf16_f32 v31, v18, v19
    v_mfma_f32_16x16x32_bf16 v[88:91], a[176:179], v[104:107], v[88:91]
    s_mov_b32 s92, 49152
    ds_write_b64 v28, v[30:31] offset:28752
    v_mfma_f32_16x16x32_bf16 v[88:91], a[180:183], v[44:47], v[88:91]
    v_cmp_gt_u32 vcc, 16, v3
    v_cvt_pk_f16_f32 v112, v112, v113
    v_mfma_f32_16x16x32_bf16 v[88:91], a[184:187], v[20:23], v[88:91]
    s_waitcnt lgkmcnt(3)
    ds_read_b128 v[84:87], v10 offset:3200
    v_cndmask_b32 v8, 0, v8, vcc
    v_mfma_f32_16x16x32_bf16 v[88:91], a[188:191], v[100:103], v[88:91]
    buffer_load_dwordx4 v0, s[76:79], s92 offen offset:0 lds
    ds_read_b128 v[52:55], v7 offset:3200
    v_mfma_f32_16x16x32_bf16 v[16:19], a[192:195], v[236:239], 0
    v_cvt_pk_f16_f32 v113, v114, v115
    v_pk_fma_f16 v37, v112, v112, s39
    v_mfma_f32_16x16x32_bf16 v[16:19], a[196:199], v[232:235], v[16:19]
    ds_write_b64 v1, v[8:9] offset:88
    v_mfma_f32_16x16x32_bf16 v[16:19], a[200:203], v[104:107], v[16:19]
    v_cvt_pk_bf16_f32 v88, v88, v89
    v_cvt_pk_bf16_f32 v89, v90, v91
    v_mfma_f32_16x16x32_bf16 v[16:19], a[204:207], v[44:47], v[16:19]
    ds_read_b128 v[44:47], v10 offset:3328
    v_pk_fmac_f16 v37, v113, v113
    v_mfma_f32_16x16x32_bf16 v[16:19], a[208:211], v[20:23], v[16:19]
    buffer_load_dwordx4 v166, s[76:79], s92 offen offset:1024 lds
    ds_read_b128 v[20:23], v7 offset:3328
    v_mfma_f32_16x16x32_bf16 v[16:19], a[212:215], v[100:103], v[16:19]
    v_cvt_pk_f16_f32 v114, v12, v13
    v_cvt_pk_f16_f32 v115, v14, v15
    v_mfma_f32_16x16x32_f16 v[12:15], v[32:35], v[116:119], v[200:203]
    v_pk_fmac_f16 v37, v114, v114
    v_pk_fmac_f16 v37, v115, v115
    v_mfma_f32_16x16x32_f16 v[12:15], v[146:149], v[150:153], v[12:15]
    s_waitcnt lgkmcnt(4)
    s_nop 0
    v_cvt_pk_bf16_f32 v90, v16, v17
    v_cvt_pk_bf16_f32 v91, v18, v19
    v_mfma_f32_16x16x32_bf16 v[16:19], v[228:231], a[144:147], 0
    ds_write_b128 v28, v[88:91] offset:28768
    v_mfma_f32_16x16x32_bf16 v[16:19], v[224:227], a[148:151], v[16:19]
    buffer_load_dwordx4 v162, s[76:79], s92 offen offset:2048 lds
    v_cvt_pk_f16_f32 v142, v60, v61
    v_mfma_f32_16x16x32_bf16 v[16:19], v[84:87], a[152:155], v[16:19]
    s_waitcnt lgkmcnt(3)
    s_add_u32 m0, s90, 61440
    v_cvt_pk_f16_f32 v143, v62, v63
    v_pk_fmac_f16 v37, v142, v142
    v_mfma_f32_16x16x32_bf16 v[16:19], v[52:55], a[156:159], v[16:19]
    s_waitcnt lgkmcnt(2)
    s_mov_b32 s92, 61440
    ds_read_b128 v[104:107], v132 offset:0
    v_pk_fmac_f16 v37, v143, v143
    v_mfma_f32_16x16x32_bf16 v[16:19], v[44:47], a[160:163], v[16:19]
    s_waitcnt lgkmcnt(2)
    ds_read_b128 v[88:91], v132 offset:16
    v_pk_mul_f16 v56, v56, v70 op_sel:[0,0] op_sel_hi:[1,0]
    v_mfma_f32_16x16x32_bf16 v[16:19], v[20:23], a[164:167], v[16:19]
    s_nop 0
    buffer_load_dwordx4 v0, s[76:79], s92 offen offset:0 lds
    ds_read_b128 v[60:63], v132 offset:48
    v_mfma_f32_16x16x32_bf16 v[100:103], v[228:231], a[168:171], 0
    s_nop 0
    v_exp_f32 v76, v76
    v_mfma_f32_16x16x32_bf16 v[100:103], v[224:227], a[172:175], v[100:103]
    s_nop 0
    v_cvt_pk_bf16_f32 v164, v16, v17
    v_cvt_pk_bf16_f32 v165, v18, v19
    v_mfma_f32_16x16x32_bf16 v[100:103], v[84:87], a[176:179], v[100:103]
    v_exp_f32 v77, v77
    v_mfma_f32_16x16x32_bf16 v[100:103], v[52:55], a[180:183], v[100:103]
    v_exp_f32 v78, v78
    v_mfma_f32_16x16x32_bf16 v[100:103], v[44:47], a[184:187], v[100:103]
    buffer_load_dwordx4 v166, s[76:79], s92 offen offset:1024 lds
    v_cvt_pk_bf16_f32 v76, v76, v77
    v_mfma_f32_16x16x32_bf16 v[100:103], v[20:23], a[188:191], v[100:103]
    s_nop 0
    v_exp_f32 v79, v79
    v_mfma_f32_16x16x32_bf16 v[16:19], v[228:231], a[192:195], 0
    s_nop 0
    v_cvt_pk_bf16_f32 v77, v78, v79
    v_pk_mul_f16 v57, v57, v70 op_sel:[0,0] op_sel_hi:[1,0]
    v_mfma_f32_16x16x32_bf16 v[16:19], v[224:227], a[196:199], v[16:19]
    s_nop 0
    v_cvt_pk_bf16_f32 v160, v100, v101
    v_cvt_pk_bf16_f32 v161, v102, v103
    v_mfma_f32_16x16x32_bf16 v[16:19], v[84:87], a[200:203], v[16:19]
    v_exp_f32 v12, v12
    v_mfma_f32_16x16x32_bf16 v[16:19], v[52:55], a[204:207], v[16:19]
    buffer_load_dwordx4 v162, s[76:79], s92 offen offset:2048 lds
    ds_read_u16 v166, v131 offset:80
    v_mfma_f32_16x16x32_bf16 v[16:19], v[44:47], a[208:211], v[16:19]
    s_add_u32 m0, s54, 20480
    ds_read_u16 v162, v131 offset:96
    v_pk_mul_f16 v58, v58, v70 op_sel:[0,0] op_sel_hi:[1,0]
    v_mfma_f32_16x16x32_bf16 v[16:19], v[20:23], a[212:215], v[16:19]
    s_waitcnt lgkmcnt(2)
    ds_read_u16 v158, v131 offset:104
    v_pk_mul_f16 v59, v59, v70 op_sel:[0,0] op_sel_hi:[1,0]
    v_mfma_f32_16x16x32_f16 v[232:235], v[104:107], v[116:119], v[208:211]
    s_nop 0
    v_exp_f32 v13, v13
    v_mfma_f32_16x16x32_f16 v[232:235], v[88:91], v[80:83], v[232:235]
    s_nop 0
    v_cvt_pk_bf16_f32 v156, v16, v17
    v_cvt_pk_bf16_f32 v157, v18, v19
    v_mfma_f32_16x16x32_f16 v[232:235], v[60:63], v[152:155], v[232:235]
    buffer_load_dwordx4 v128, s[24:27], s56 offen nt lds
    v_cvt_pk_bf16_f32 v78, v12, v13
    v_mfma_f32_16x16x32_f16 v[16:19], v[104:107], v[24:27], v[208:211]
    s_add_u32 m0, s54, 21504
    ds_read_b128 v[44:47], v10 offset:42496
    v_pk_mul_f16 v40, v40, v70 op_sel:[0,0] op_sel_hi:[1,0]
    v_mfma_f32_16x16x32_f16 v[16:19], v[88:91], v[32:35], v[16:19]
    ds_read_b128 v[20:23], v7 offset:42496
    v_pk_mul_f16 v41, v41, v70 op_sel:[0,0] op_sel_hi:[1,0]
    v_mfma_f32_16x16x32_f16 v[16:19], v[60:63], v[146:149], v[16:19]
    ds_read_b128 v[244:247], v10 offset:42624
    v_pk_mul_f16 v72, v72, v70 op_sel:[0,1] op_sel_hi:[1,1]
    v_mfma_f32_16x16x32_f16 v[224:227], v[212:215], v[36:39], 0
    ds_read_b128 v[240:243], v7 offset:42624
    v_pk_mul_f16 v73, v73, v70 op_sel:[0,1] op_sel_hi:[1,1]
    v_mfma_f32_16x16x32_f16 v[84:87], v[80:83], v[24:27], v[192:195]
    buffer_load_dwordx4 v127, s[24:27], s56 offen nt lds
    ds_read_b128 v[236:239], v10 offset:42752
    v_mfma_f32_16x16x32_f16 v[84:87], v[152:155], v[144:147], v[84:87]
    s_add_u32 m0, s54, 22528
    v_mov_b32_dpp v235, v19 quad_perm:[0,1,2,3] row_mask:0x2 bank_mask:0xf
    v_or3_b32 v123, v123, v224, v225
    v_mfma_f32_16x16x32_f16 v[36:39], v[32:35], v[24:27], v[188:191]
    ds_read_b128 v[100:103], v7 offset:42752
    v_pk_mul_f16 v74, v74, v70 op_sel:[0,1] op_sel_hi:[1,1]
    v_mfma_f32_16x16x32_f16 v[36:39], v[146:149], v[144:147], v[36:39]
    s_waitcnt lgkmcnt(5)
    v_rsq_f32 v224, v224
    v_rsq_f32 v225, v225
    v_mul_f32 v224, s52, v224
    v_cvt_pk_f16_f32 v224, v224, v225
    v_pk_mul_f16 v112, v112, v224 op_sel:[0,1] op_sel_hi:[1,1]
    v_mfma_f32_16x16x32_bf16 v[52:55], a[144:147], v[44:47], 0
    s_waitcnt lgkmcnt(4)
    buffer_load_dwordx4 v126, s[24:27], s56 offen nt lds
    v_pk_mul_f16 v113, v113, v224 op_sel:[0,1] op_sel_hi:[1,1]
    v_mfma_f32_16x16x32_bf16 v[52:55], a[148:151], v[20:23], v[52:55]
    s_waitcnt lgkmcnt(3)
    s_add_u32 m0, s54, 23552
    v_pk_mul_f16 v114, v114, v224 op_sel:[0,1] op_sel_hi:[1,1]
    v_pk_mul_f16 v115, v115, v224 op_sel:[0,1] op_sel_hi:[1,1]
    v_mfma_f32_16x16x32_bf16 v[52:55], a[152:155], v[244:247], v[52:55]
    s_waitcnt lgkmcnt(2)
    v_pk_mul_f16 v142, v142, v224 op_sel:[0,1] op_sel_hi:[1,1]
    v_pk_mul_f16 v143, v143, v224 op_sel:[0,1] op_sel_hi:[1,1]
    v_mfma_f32_16x16x32_bf16 v[52:55], a[156:159], v[240:243], v[52:55]
    s_waitcnt lgkmcnt(1)
    v_pk_mul_f16 v108, v108, v224 op_sel:[0,0] op_sel_hi:[1,0]
    v_pk_mul_f16 v109, v109, v224 op_sel:[0,0] op_sel_hi:[1,0]
    v_pk_mul_f16 v110, v110, v224 op_sel:[0,0] op_sel_hi:[1,0]
    v_mfma_f32_16x16x32_bf16 v[52:55], a[160:163], v[236:239], v[52:55]
    s_waitcnt lgkmcnt(0)
    v_pk_mul_f16 v111, v111, v224 op_sel:[0,0] op_sel_hi:[1,0]
    v_pk_mul_f16 v140, v140, v224 op_sel:[0,0] op_sel_hi:[1,0]
    v_pk_mul_f16 v141, v141, v224 op_sel:[0,0] op_sel_hi:[1,0]
    v_exp_f32 v14, v14
    v_mfma_f32_16x16x32_bf16 v[52:55], a[164:167], v[100:103], v[52:55]
    buffer_load_dwordx4 v125, s[24:27], s56 offen nt lds
    v_pk_mul_f16 v75, v75, v70 op_sel:[0,1] op_sel_hi:[1,1]
    v_mfma_f32_16x16x32_f16 v[224:227], v[112:115], v[116:119], v[196:199]
    s_add_u32 m0, s54, 24576
    v_exp_f32 v15, v15
    v_mfma_f32_16x16x32_f16 v[224:227], v[140:143], v[150:153], v[224:227]
    s_nop 0
    v_cvt_pk_bf16_f32 v79, v14, v15
    v_cvt_pk_bf16_f32 v120, v52, v53
    v_mfma_f32_16x16x32_f16 v[12:15], v[104:107], v[108:111], v[208:211]
    v_exp_f32 v232, v232
    v_mfma_f32_16x16x32_f16 v[12:15], v[88:91], v[112:115], v[12:15]
    buffer_load_dwordx4 v124, s[24:27], s56 offen nt lds
    v_cvt_pk_bf16_f32 v170, v232, 0
    v_mfma_f32_16x16x32_f16 v[12:15], v[60:63], v[140:143], v[12:15]
    s_cmp_lt_u32 s61, s71
    ds_read_b128 v[116:119], v10 offset:0
    v_cvt_pk_bf16_f32 v121, v54, v55
    v_mfma_f32_16x16x32_f16 v[52:55], v[112:115], v[24:27], v[184:187]
    s_cselect_b32 s15, s61, s12
    ds_read_b128 v[228:231], v7 offset:0
    v_pk_mul_f16 v42, v42, v70 op_sel:[0,1] op_sel_hi:[1,1]
    v_mfma_f32_16x16x32_f16 v[52:55], v[140:143], v[144:147], v[52:55]
    s_cselect_b32 s56, s69, s70
    ds_read_b128 v[104:107], v10 offset:128
    v_mov_b32_dpp v235, v15 quad_perm:[0,1,2,3] row_mask:0x4 bank_mask:0xf
    v_mfma_f32_16x16x32_bf16 v[24:27], a[168:171], v[44:47], 0
    s_add_u32 s56, s56, s15
    ds_read_b128 v[60:63], v7 offset:128
    v_pk_mul_f16 v43, v43, v70 op_sel:[0,1] op_sel_hi:[1,1]
    v_mfma_f32_16x16x32_bf16 v[24:27], a[172:175], v[20:23], v[24:27]
    s_mul_i32 s53, s56, 58255
    ds_read_b128 v[68:71], v10 offset:256
    v_fma_mix_f32 v12, v56, v72, 0 op_sel:[0,0,0] op_sel_hi:[1,1,0]
    v_mfma_f32_16x16x32_bf16 v[24:27], a[176:179], v[244:247], v[24:27]
    s_lshr_b32 s53, s53, 22
    ds_read_b128 v[88:91], v7 offset:256
    v_fma_mix_f32 v12, v56, v72, v12 op_sel:[1,1,0] op_sel_hi:[1,1,0]
    v_mfma_f32_16x16x32_bf16 v[24:27], a[180:183], v[240:243], v[24:27]
    s_mul_i32 s53, s53, s63
    v_exp_f32 v235, v235
    v_mfma_f32_16x16x32_bf16 v[24:27], a[184:187], v[236:239], v[24:27]
    s_mul_i32 s56, s56, s62
    v_cvt_pk_bf16_f32 v235, v235, v235
    v_fma_mix_f32 v12, v57, v73, v12 op_sel:[0,0,0] op_sel_hi:[1,1,0]
    v_mfma_f32_16x16x32_bf16 v[24:27], a[188:191], v[100:103], v[24:27]
    s_add_u32 s56, s56, s53
    ds_write_b16 v131, v235 offset:64
    v_mfma_f32_16x16x32_bf16 v[232:235], a[192:195], v[44:47], 0
    s_mul_i32 s4, s15, 112
    ds_read_b128 v[44:47], v132 offset:48
    v_fma_mix_f32 v12, v57, v73, v12 op_sel:[1,1,0] op_sel_hi:[1,1,0]
    v_mfma_f32_16x16x32_bf16 v[232:235], a[196:199], v[20:23], v[232:235]
    s_cmp_ge_u32 s15, 16
    ds_read_b128 v[20:23], v132 offset:64
    v_cvt_pk_bf16_f32 v24, v24, v25
    v_mfma_f32_16x16x32_bf16 v[232:235], a[200:203], v[244:247], v[232:235]
    s_cselect_b32 s53, -30464, 0
    v_exp_f32 v224, v224
    v_mfma_f32_16x16x32_bf16 v[232:235], a[204:207], v[240:243], v[232:235]
    s_add_u32 s4, s4, s53
    v_exp_f32 v225, v225
    v_mfma_f32_16x16x32_bf16 v[232:235], a[208:211], v[236:239], v[232:235]
    s_cmp_lt_u32 s15, s73
    v_exp_f32 v226, v226
    v_mfma_f32_16x16x32_bf16 v[232:235], a[212:215], v[100:103], v[232:235]
    s_waitcnt lgkmcnt(3)
    s_cselect_b32 s26, 100270464, 0
    v_exp_f32 v227, v227
    v_mfma_f32_16x16x32_bf16 v[100:103], v[116:119], a[144:147], 0
    s_cselect_b32 s56, s56, 0
    v_cvt_pk_bf16_f32 v168, v224, v225
    v_cvt_pk_bf16_f32 v169, v226, v227
    v_mfma_f32_16x16x32_bf16 v[100:103], v[228:231], a[148:151], v[100:103]
    s_cselect_b32 s4, s4, -1
    v_exp_f32 v84, v84
    v_mfma_f32_16x16x32_bf16 v[100:103], v[104:107], a[152:155], v[100:103]
    s_cselect_b32 s15, s15, 0
    v_exp_f32 v85, v85
    v_mfma_f32_16x16x32_bf16 v[100:103], v[60:63], a[156:159], v[100:103]
    s_cselect_b32 s13, s13, -1
    v_exp_f32 v86, v86
    v_mfma_f32_16x16x32_bf16 v[100:103], v[68:71], a[160:163], v[100:103]
    s_waitcnt vmcnt(5)
    s_bitset1_b32 s64, s15
    v_exp_f32 v87, v87
    v_mfma_f32_16x16x32_bf16 v[100:103], v[88:91], a[164:167], v[100:103]
    s_barrier
    v_cvt_pk_bf16_f32 v224, v84, v85
    v_cvt_pk_bf16_f32 v225, v86, v87
    v_mfma_f32_16x16x32_bf16 v[84:87], v[116:119], a[168:171], 0
    v_exp_f32 v36, v36
    v_mfma_f32_16x16x32_bf16 v[84:87], v[228:231], a[172:175], v[84:87]
    s_lshl_b32 s93, s68, 10
    v_exp_f32 v37, v37
    v_mfma_f32_16x16x32_bf16 v[84:87], v[104:107], a[176:179], v[84:87]
    s_mov_b32 s53, s47
    v_exp_f32 v38, v38
    v_mfma_f32_16x16x32_bf16 v[84:87], v[60:63], a[180:183], v[84:87]
    s_mov_b32 s47, s46
    v_exp_f32 v39, v39
    v_mfma_f32_16x16x32_bf16 v[84:87], v[68:71], a[184:187], v[84:87]
    s_mov_b32 s46, s45
    v_cvt_pk_bf16_f32 v226, v36, v37
    v_cvt_pk_bf16_f32 v227, v38, v39
    v_mfma_f32_16x16x32_bf16 v[84:87], v[88:91], a[188:191], v[84:87]
    s_mov_b32 s45, s44
    ds_read_b128 v[240:243], v50 offset:0
    v_cvt_pk_bf16_f32 v25, v26, v27
    v_exp_f32 v52, v52
    v_exp_f32 v53, v53
    v_exp_f32 v54, v54
    v_exp_f32 v55, v55
    v_exp_f32 v17, v17
    v_mfma_f32_16x16x32_bf16 v[36:39], v[116:119], a[192:195], 0
    s_mov_b32 s44, s53
    ds_read_b64 v[116:117], v11 offset:64
    v_cvt_pk_bf16_f32 v26, v232, v233
    v_mfma_f32_16x16x32_bf16 v[36:39], v[228:231], a[196:199], v[36:39]
    s_sub_u32 s48, s44, s46
    ds_read_b128 v[236:239], v50 offset:3072
    v_cvt_pk_bf16_f32 v27, v234, v235
    v_mfma_f32_16x16x32_bf16 v[36:39], v[104:107], a[200:203], v[36:39]
    s_sub_u32 s49, s46, s45
    ds_read_b64 v[118:119], v11 offset:3136
    v_cvt_pk_bf16_f32 v0, v100, v101
    v_mfma_f32_16x16x32_bf16 v[36:39], v[60:63], a[204:207], v[36:39]
    ds_read_b128 v[60:63], v50 offset:6144
    v_cvt_pk_bf16_f32 v1, v102, v103
    v_mfma_f32_16x16x32_bf16 v[36:39], v[68:71], a[208:211], v[36:39]
    ds_read_b64 v[68:69], v11 offset:6208
    v_cvt_pk_bf16_f32 v8, v84, v85
    v_mfma_f32_16x16x32_bf16 v[36:39], v[88:91], a[212:215], v[36:39]
    ds_read_b128 v[88:91], v50 offset:9216
    v_cvt_pk_bf16_f32 v9, v86, v87
    v_mfma_f32_16x16x32_bf16 v[104:107], v[220:223], v[76:79], 0
    ds_read_b64 v[70:71], v11 offset:9280
    v_fma_mix_f32 v12, v58, v74, v12 op_sel:[0,0,0] op_sel_hi:[1,1,0]
    v_mfma_f32_16x16x32_bf16 v[104:107], v[220:223], v[168:171], v[104:107]
    s_nop 0
    ds_read_b128 v[232:235], v50 offset:12288
    v_cvt_pk_bf16_f32 v4, v36, v37
    v_mfma_f32_16x16x32_f16 v[100:103], v[80:83], v[108:111], v[180:183]
    ds_read_b64 v[84:85], v11 offset:12352
    v_cvt_pk_bf16_f32 v5, v38, v39
    v_mfma_f32_16x16x32_f16 v[100:103], v[152:155], v[138:141], v[100:103]
    ds_read_b128 v[80:83], v50 offset:15360
    v_fma_mix_f32 v12, v58, v74, v12 op_sel:[1,1,0] op_sel_hi:[1,1,0]
    v_mfma_f32_16x16x32_f16 v[36:39], v[32:35], v[108:111], v[176:179]
    ds_read_b64 v[86:87], v11 offset:15424
    v_fma_mix_f32 v12, v59, v75, v12 op_sel:[0,0,0] op_sel_hi:[1,1,0]
    v_mfma_f32_16x16x32_f16 v[36:39], v[146:149], v[138:141], v[36:39]
    ds_read_b128 v[228:231], v50 offset:18432
    v_fma_mix_f32 v12, v59, v75, v12 op_sel:[1,1,0] op_sel_hi:[1,1,0]
    v_mfma_f32_16x16x32_f16 v[32:35], v[112:115], v[108:111], v[172:175]
    ds_read_b64 v[152:153], v11 offset:18496
    v_fma_mix_f32 v12, v40, v42, v12 op_sel:[0,0,0] op_sel_hi:[1,1,0]
    v_mfma_f32_16x16x32_f16 v[32:35], v[140:143], v[138:141], v[32:35]
    s_waitcnt lgkmcnt(8)
    ds_read_b128 v[108:111], v50 offset:21504
    v_fma_mix_f32 v12, v40, v42, v12 op_sel:[1,1,0] op_sel_hi:[1,1,0]
    v_mfma_f32_16x16x32_bf16 v[112:115], v[240:243], v[220:223], 0
    ds_read_b64 v[154:155], v11 offset:21568
    v_fma_mix_f32 v12, v41, v43, v12 op_sel:[0,0,0] op_sel_hi:[1,1,0]
    v_mfma_f32_16x16x32_bf16 v[112:115], v[236:239], v[220:223], v[112:115]
    ds_read_b128 v[140:143], v50 offset:24576
    v_fma_mix_f32 v12, v41, v43, v12 op_sel:[1,1,0] op_sel_hi:[1,1,0]
    v_mfma_f32_16x16x32_bf16 v[112:115], v[60:63], v[220:223], v[112:115]
    s_waitcnt lgkmcnt(8)
    ds_read_b64 v[60:61], v11 offset:24640
    v_mov_b32 v6, v12
    v_mfma_f32_16x16x32_bf16 v[112:115], v[88:91], v[220:223], v[112:115]
    ds_read_b128 v[88:91], v50 offset:27648
    v_and_b32 v147, 0xb8000000, v123
    v_mfma_f32_16x16x32_bf16 v[112:115], v[116:119], v[220:223], v[112:115]
    ds_read_b64 v[62:63], v11 offset:27712
    v_cmp_ne_u32 s[94:95], 0, v147
    v_mfma_f32_16x16x32_bf16 v[112:115], v[68:71], v[220:223], v[112:115]
    s_add_u32 m0, s67, 0
    ds_read_b128 v[68:71], v50 offset:30720
    v_add_u32 v146, s93, v129
    v_mfma_f32_16x16x32_bf16 v[116:119], v[232:235], v[220:223], 0
    s_waitcnt lgkmcnt(8)
    s_or_b32 s94, s94, s95
    ds_read_b64 v[48:49], v11 offset:30784
    v_mov_b32 v147, s94
    v_mfma_f32_16x16x32_bf16 v[116:119], v[80:83], v[220:223], v[116:119]
    s_lshl_b32 s95, s68, 2
    ds_read_b128 v[80:83], v50 offset:33792
    v_mul_f32 v112, 0xbbaaaaab, v112
    v_mfma_f32_16x16x32_bf16 v[116:119], v[228:231], v[220:223], v[116:119]
    s_waitcnt lgkmcnt(8)
    ds_read_b64 v[50:51], v11 offset:33856
    v_mul_f32 v113, 0xbbaaaaab, v113
    v_mfma_f32_16x16x32_bf16 v[116:119], v[108:111], v[220:223], v[116:119]
    ds_read_b128 v[108:111], v10 offset:1536
    v_mul_f32 v114, 0xbbaaaaab, v114
    v_mfma_f32_16x16x32_bf16 v[116:119], v[84:87], v[220:223], v[116:119]
    s_waitcnt lgkmcnt(8)
    ds_read_b128 v[84:87], v7 offset:1536
    v_mul_f32 v115, 0xbbaaaaab, v115
    v_mfma_f32_16x16x32_bf16 v[116:119], v[152:155], v[220:223], v[116:119]
    ds_write_b128 v2, v[112:115] offset:0
    v_mfma_f32_16x16x32_bf16 v[112:115], v[140:143], v[220:223], 0
    s_waitcnt lgkmcnt(7)
    v_rcp_f32 v104, v104
    v_mfma_f32_16x16x32_bf16 v[112:115], v[88:91], v[220:223], v[112:115]
    s_waitcnt lgkmcnt(6)
    v_permlane32_swap_b32 v6, v12
    v_mfma_f32_16x16x32_bf16 v[112:115], v[68:71], v[220:223], v[112:115]
    s_waitcnt lgkmcnt(4)
    ds_read_b128 v[68:71], v10 offset:1664
    v_add_f32 v12, v6, v12
    v_mov_b32 v6, v12
    v_mul_f32 v116, 0xbbaaaaab, v116
    v_mfma_f32_16x16x32_bf16 v[112:115], v[80:83], v[220:223], v[112:115]
    ds_read_b128 v[80:83], v7 offset:1664
    v_mul_f32 v117, 0xbbaaaaab, v117
    v_mfma_f32_16x16x32_bf16 v[112:115], v[60:63], v[220:223], v[112:115]
    s_waitcnt lgkmcnt(4)
    ds_read_b128 v[88:91], v10 offset:1792
    v_mul_f32 v118, 0xbbaaaaab, v118
    v_mfma_f32_16x16x32_bf16 v[112:115], v[48:51], v[220:223], v[112:115]
    ds_read_b128 v[48:51], v7 offset:1792
    v_mul_f32 v119, 0xbbaaaaab, v119
    v_mfma_f32_16x16x32_bf16 v[60:63], v[108:111], a[144:147], 0
    s_waitcnt lgkmcnt(4)
    ds_write_b128 v2, v[116:119] offset:128
    v_mfma_f32_16x16x32_bf16 v[60:63], v[84:87], a[148:151], v[60:63]
    s_waitcnt lgkmcnt(4)
    v_permlane16_swap_b32 v6, v12
    v_add_f32 v12, v6, v12
    v_add_f32 v12, s84, v12
    v_exp_f32 v12, v12
    v_mul_f32 v112, 0xbbaaaaab, v112
    v_cvt_pk_bf16_f32 v12, v12, 0
    v_cmp_gt_u32 vcc, 16, v3
    v_mul_f32 v113, 0xbbaaaaab, v113
    v_mfma_f32_16x16x32_bf16 v[60:63], v[68:71], a[152:155], v[60:63]
    s_waitcnt lgkmcnt(3)
    v_cndmask_b32 v12, 0, v12, vcc
    v_mul_f32 v114, 0xbbaaaaab, v114
    v_mul_f32 v115, 0xbbaaaaab, v115
    v_mov_b32 v13, s95
    v_mfma_f32_16x16x32_bf16 v[60:63], v[80:83], a[156:159], v[60:63]
    s_waitcnt lgkmcnt(1)
    ds_write_b128 v2, v[112:115] offset:256
    v_mfma_f32_16x16x32_bf16 v[60:63], v[88:91], a[160:163], v[60:63]
    s_barrier
    buffer_load_dwordx4 v128, s[24:27], s56 offen nt lds
    v_add_u32 v137, s48, v137
    v_mfma_f32_16x16x32_bf16 v[60:63], v[48:51], a[164:167], v[60:63]
    s_add_u32 m0, s67, 1024
    v_exp_f32 v100, v100
    v_mfma_f32_16x16x32_bf16 v[112:115], v[108:111], a[168:171], 0
    s_nop 0
    buffer_load_dwordx4 v127, s[24:27], s56 offen nt lds
    v_add_u32 v136, s48, v136
    v_mfma_f32_16x16x32_bf16 v[112:115], v[84:87], a[172:175], v[112:115]
    s_add_u32 m0, s67, 2048
    v_cvt_pk_bf16_f32 v2, v60, v61
    v_cvt_pk_bf16_f32 v3, v62, v63
    v_mfma_f32_16x16x32_bf16 v[112:115], v[68:71], a[176:179], v[112:115]
    buffer_load_dwordx4 v126, s[24:27], s56 offen nt lds
    v_mfma_f32_16x16x32_bf16 v[112:115], v[80:83], a[180:183], v[112:115]
    s_add_u32 m0, s67, 3072
    v_exp_f32 v101, v101
    v_mfma_f32_16x16x32_bf16 v[112:115], v[88:91], a[184:187], v[112:115]
    buffer_load_dwordx4 v125, s[24:27], s56 offen nt lds
    v_cvt_pk_bf16_f32 v16, v100, v101
    v_mfma_f32_16x16x32_bf16 v[112:115], v[48:51], a[188:191], v[112:115]
    s_waitcnt lgkmcnt(0)
    s_add_u32 m0, s67, 4096
    v_exp_f32 v102, v102
    v_mfma_f32_16x16x32_bf16 v[60:63], v[0:3], v[76:79], 0
    s_barrier
    buffer_load_dwordx4 v124, s[24:27], s56 offen nt lds
    v_mfma_f32_16x16x32_bf16 v[60:63], v[164:167], v[168:171], v[60:63]
    s_nop 0
    v_cvt_pk_bf16_f32 v10, v112, v113
    v_cvt_pk_bf16_f32 v11, v114, v115
    v_mfma_f32_16x16x32_bf16 v[140:143], v[108:111], a[192:195], 0
    ds_read_b128 v[112:115], v97 offset:24576
    v_mfma_f32_16x16x32_bf16 v[140:143], v[84:87], a[196:199], v[140:143]
    s_nop 0
    ds_read_b64 v[116:117], v96 offset:24640
    v_mul_f32 v60, v60, v104
    v_mfma_f32_16x16x32_bf16 v[140:143], v[68:71], a[200:203], v[140:143]
    ds_read_b128 v[68:71], v29 offset:256
    v_mul_f32 v61, v61, v104
    v_mfma_f32_16x16x32_bf16 v[140:143], v[80:83], a[204:207], v[140:143]
    ds_read_b128 v[84:87], v97 offset:25344
    v_cvt_pk_bf16_f32 v80, v60, v61
    v_mfma_f32_16x16x32_bf16 v[140:143], v[88:91], a[208:211], v[140:143]
    ds_read_b64 v[88:89], v96 offset:25408
    v_mul_f32 v62, v62, v104
    v_mfma_f32_16x16x32_bf16 v[140:143], v[48:51], a[212:215], v[140:143]
    ds_read_b128 v[48:51], v29 offset:320
    v_mul_f32 v63, v63, v104
    v_mfma_f32_16x16x32_bf16 v[108:111], v[8:11], v[76:79], 0
    s_nop 0
    v_exp_f32 v103, v103
    v_mfma_f32_16x16x32_bf16 v[108:111], v[160:163], v[168:171], v[108:111]
    s_nop 0
    v_cvt_pk_bf16_f32 v81, v62, v63
    v_cvt_pk_bf16_f32 v6, v140, v141
    v_mfma_f32_16x16x32_bf16 v[60:63], v[44:47], v[0:3], 0
    s_nop 0
    ds_write_b64 v135, v[80:81] offset:0
    v_mfma_f32_16x16x32_bf16 v[60:63], v[20:23], v[164:167], v[60:63]
    s_nop 0
    v_mul_f32 v108, v108, v104
    v_mul_f32 v109, v109, v104
    v_mfma_f32_16x16x32_bf16 v[152:155], v[44:47], v[8:11], 0
    v_cvt_pk_bf16_f32 v82, v108, v109
    v_mul_f32 v110, v110, v104
    v_mfma_f32_16x16x32_bf16 v[152:155], v[20:23], v[160:163], v[152:155]
    s_waitcnt lgkmcnt(3)
    v_mul_f32 v111, v111, v104
    v_cvt_pk_bf16_f32 v83, v110, v111
    v_mfma_f32_16x16x16_bf16 v[108:111], v[112:113], v[94:95], v[68:71]
    ds_write_b64 v135, v[82:83] offset:8
    v_mfma_f32_16x16x16_bf16 v[80:83], v[114:115], v[94:95], v[68:71]
    s_nop 0
    v_cvt_pk_bf16_f32 v7, v142, v143
    v_mov_b32_dpp v63, v155 quad_perm:[0,1,2,3] row_mask:0x2 bank_mask:0xf
    v_mfma_f32_16x16x16_bf16 v[140:143], v[116:117], v[94:95], v[68:71]
    s_waitcnt lgkmcnt(2)
    s_nop 0
    v_cvt_pk_bf16_f32 v108, v108, v109
    v_accvgpr_write_b32 a224, v108
    v_mfma_f32_16x16x16_bf16 v[116:119], v[84:85], v[94:95], v[48:51]
    ds_write_b32 v13, v147 offset:14848
    v_mfma_f32_16x16x16_bf16 v[68:71], v[86:87], v[94:95], v[48:51]
    v_cvt_pk_bf16_f32 v110, v110, v111
    v_accvgpr_write_b32 a225, v110
    v_mfma_f32_16x16x16_bf16 v[84:87], v[88:89], v[94:95], v[48:51]
    v_cvt_pk_bf16_f32 v80, v80, v81
    v_accvgpr_write_b32 a248, v80
    v_cvt_pk_bf16_f32 v82, v82, v83
    v_mfma_f32_16x16x32_bf16 v[48:51], v[4:7], v[76:79], 0
    v_accvgpr_write_b32 a249, v82
    v_cvt_pk_bf16_f32 v240, v140, v141
    v_mfma_f32_16x16x32_bf16 v[48:51], v[156:159], v[168:171], v[48:51]
    v_cvt_pk_bf16_f32 v168, v52, v53
    v_cvt_pk_bf16_f32 v169, v54, v55
    v_mfma_f32_16x16x32_bf16 v[76:79], v[44:47], v[4:7], 0
    ds_read_b128 v[110:113], v97 offset:49152
    v_cvt_pk_bf16_f32 v170, v17, 0
    v_mfma_f32_16x16x32_bf16 v[76:79], v[20:23], v[156:159], v[76:79]
    s_nop 0
    ds_read_b64 v[114:115], v96 offset:49216
    v_mul_f32 v48, v48, v104
    v_mfma_f32_16x16x32_bf16 v[44:47], v[220:223], v[224:227], 0
    ds_read_b128 v[80:83], v29 offset:5248
    v_mul_f32 v49, v49, v104
    v_mfma_f32_16x16x32_bf16 v[44:47], v[220:223], v[168:171], v[44:47]
    ds_read_b128 v[88:91], v97 offset:49920
    v_cvt_pk_bf16_f32 v30, v48, v49
    v_mfma_f32_16x16x32_bf16 v[20:23], v[0:3], v[224:227], 0
    ds_write_b32 v134, v30 offset:0
    v_mfma_f32_16x16x32_bf16 v[20:23], v[164:167], v[168:171], v[20:23]
    ds_read_b64 v[92:93], v96 offset:49984
    v_mul_f32 v50, v50, v104
    v_mfma_f32_16x16x32_bf16 v[52:55], v[8:11], v[224:227], 0
    ds_read_b128 v[228:231], v29 offset:5312
    v_mul_f32 v51, v51, v104
    v_mfma_f32_16x16x32_bf16 v[52:55], v[160:163], v[168:171], v[52:55]
    ds_read_b128 v[104:107], v97 offset:12288
    v_cvt_pk_bf16_f32 v31, v50, v51
    v_mfma_f32_16x16x32_bf16 v[48:51], v[4:7], v[224:227], 0
    ds_write_b32 v134, v31 offset:4
    v_mfma_f32_16x16x32_bf16 v[48:51], v[156:159], v[168:171], v[48:51]
    ds_read_b64 v[108:109], v96 offset:12352
    v_cvt_pk_bf16_f32 v241, v142, v143
    v_cvt_pk_bf16_f32 v116, v116, v117
    v_accvgpr_write_b32 a226, v116
    v_cvt_pk_bf16_f32 v118, v118, v119
    v_accvgpr_write_b32 a227, v118
    v_cvt_pk_bf16_f32 v68, v68, v69
    v_accvgpr_write_b32 a250, v68
    v_cvt_pk_bf16_f32 v70, v70, v71
    v_accvgpr_write_b32 a251, v70
    v_cvt_pk_bf16_f32 v242, v84, v85
    v_cvt_pk_bf16_f32 v243, v86, v87
    s_waitcnt lgkmcnt(5)
    v_mfma_f32_16x16x16_bf16 v[224:227], v[110:111], v[94:95], v[80:83]
    ds_read_b128 v[68:71], v29 offset:128
    v_mov_b32_dpp v63, v79 quad_perm:[0,1,2,3] row_mask:0x4 bank_mask:0xf
    v_mfma_f32_16x16x16_bf16 v[140:143], v[112:113], v[94:95], v[80:83]
    ds_read_b128 v[84:87], v97 offset:13056
    v_cvt_pk_bf16_f32 v63, v63, v63
    v_mfma_f32_16x16x16_bf16 v[76:79], v[114:115], v[94:95], v[80:83]
    s_waitcnt lgkmcnt(5)
    ds_write_b16 v131, v63
    v_mfma_f32_16x16x16_bf16 v[60:63], v[88:89], v[94:95], v[228:231]
    ds_read_b64 v[88:89], v96 offset:13120
    v_mov_b32 v18, 0
    v_mfma_f32_16x16x16_bf16 v[116:119], v[90:91], v[94:95], v[228:231]
    ds_read_b128 v[152:155], v29 offset:192
    v_mov_b32 v19, 0
    v_mfma_f32_16x16x16_bf16 v[80:83], v[92:93], v[94:95], v[228:231]
    ds_read_b128 v[110:113], v97 offset:61440
    v_mov_b32 v13, 0
    v_add_u32 v15, 0, v28
    v_cvt_pk_bf16_f32 v224, v224, v225
    v_accvgpr_write_b32 a232, v224
    v_cvt_pk_bf16_f32 v226, v226, v227
    v_accvgpr_write_b32 a233, v226
    v_cvt_pk_bf16_f32 v224, v140, v141
    v_cvt_pk_bf16_f32 v225, v142, v143
    v_cvt_pk_bf16_f32 v248, v76, v77
    v_cvt_pk_bf16_f32 v249, v78, v79
    v_cvt_pk_bf16_f32 v60, v60, v61
    v_accvgpr_write_b32 a234, v60
    v_cvt_pk_bf16_f32 v62, v62, v63
    v_accvgpr_write_b32 a235, v62
    s_waitcnt lgkmcnt(5)
    v_mfma_f32_16x16x16_bf16 v[60:63], v[104:105], v[94:95], v[68:71]
    ds_read_b64 v[114:115], v96 offset:61504
    v_cvt_pk_bf16_f32 v226, v116, v117
    v_mfma_f32_16x16x16_bf16 v[140:143], v[106:107], v[94:95], v[68:71]
    ds_read_b128 v[76:79], v29 offset:5376
    v_cvt_pk_bf16_f32 v227, v118, v119
    v_mfma_f32_16x16x16_bf16 v[116:119], v[108:109], v[94:95], v[68:71]
    s_waitcnt lgkmcnt(3)
    ds_read_b128 v[104:107], v97 offset:62208
    v_cvt_pk_bf16_f32 v250, v80, v81
    v_cvt_pk_bf16_f32 v251, v82, v83
    v_cvt_pk_bf16_f32 v60, v60, v61
    v_accvgpr_write_b32 a220, v60
    v_cvt_pk_bf16_f32 v62, v62, v63
    v_mfma_f32_16x16x16_bf16 v[80:83], v[84:85], v[94:95], v[152:155]
    ds_read_b64 v[108:109], v96 offset:62272
    v_accvgpr_write_b32 a221, v62
    v_mfma_f32_16x16x16_bf16 v[68:71], v[86:87], v[94:95], v[152:155]
    ds_read_b128 v[84:87], v29 offset:5440
    v_cvt_pk_bf16_f32 v140, v140, v141
    v_mfma_f32_16x16x16_bf16 v[60:63], v[88:89], v[94:95], v[152:155]
    ds_read_b128 v[88:91], v97 offset:36864
    v_accvgpr_write_b32 a244, v140
    v_cvt_pk_bf16_f32 v142, v142, v143
    v_accvgpr_write_b32 a245, v142
    v_cvt_pk_bf16_f32 v236, v116, v117
    v_cvt_pk_bf16_f32 v237, v118, v119
    v_cvt_pk_bf16_f32 v80, v80, v81
    v_accvgpr_write_b32 a222, v80
    v_cvt_pk_bf16_f32 v82, v82, v83
    v_accvgpr_write_b32 a223, v82
    v_cvt_pk_bf16_f32 v68, v68, v69
    v_accvgpr_write_b32 a246, v68
    v_cvt_pk_bf16_f32 v70, v70, v71
    v_accvgpr_write_b32 a247, v70
    v_cvt_pk_bf16_f32 v238, v60, v61
    s_waitcnt lgkmcnt(4)
    v_mfma_f32_16x16x16_bf16 v[68:71], v[110:111], v[94:95], v[76:79]
    ds_read_b64 v[92:93], v96 offset:36928
    v_cvt_pk_bf16_f32 v239, v62, v63
    v_mfma_f32_16x16x16_bf16 v[60:63], v[112:113], v[94:95], v[76:79]
    ds_read_b128 v[80:83], v29 offset:5120
    v_cvt_pk_bf16_f32 v17, v102, v103
    v_mfma_f32_16x16x16_bf16 v[100:103], v[114:115], v[94:95], v[76:79]
    s_waitcnt lgkmcnt(3)
    ds_read_b128 v[112:115], v97 offset:37632
    v_cvt_pk_bf16_f32 v68, v68, v69
    v_accvgpr_write_b32 a236, v68
    v_cvt_pk_bf16_f32 v70, v70, v71
    v_accvgpr_write_b32 a237, v70
    v_cvt_pk_bf16_f32 v228, v60, v61
    v_mfma_f32_16x16x16_bf16 v[76:79], v[104:105], v[94:95], v[84:87]
    ds_read_b64 v[116:117], v96 offset:37696
    v_cvt_pk_bf16_f32 v229, v62, v63
    v_mfma_f32_16x16x16_bf16 v[68:71], v[106:107], v[94:95], v[84:87]
    ds_read_b128 v[104:107], v29 offset:5184
    v_cvt_pk_bf16_f32 v252, v100, v101
    v_mfma_f32_16x16x16_bf16 v[60:63], v[108:109], v[94:95], v[84:87]
    ds_read_b128 v[98:101], v97 offset:0
    v_cvt_pk_bf16_f32 v253, v102, v103
    v_cvt_pk_bf16_f32 v76, v76, v77
    v_accvgpr_write_b32 a238, v76
    v_cvt_pk_bf16_f32 v78, v78, v79
    v_accvgpr_write_b32 a239, v78
    v_cvt_pk_bf16_f32 v230, v68, v69
    v_cvt_pk_bf16_f32 v231, v70, v71
    v_cvt_pk_bf16_f32 v254, v60, v61
    v_cvt_pk_bf16_f32 v255, v62, v63
    ds_read_b64 v[102:103], v96 offset:64
    v_rcp_f32 v44, v44
    s_waitcnt lgkmcnt(5)
    v_mfma_f32_16x16x16_bf16 v[68:71], v[88:89], v[94:95], v[80:83]
    ds_read_b128 v[60:63], v29 offset:0
    v_mul_f32 v20, v20, v44
    v_mfma_f32_16x16x16_bf16 v[76:79], v[90:91], v[94:95], v[80:83]
    ds_read_b128 v[88:91], v97 offset:768
    v_mul_f32 v21, v21, v44
    v_mfma_f32_16x16x16_bf16 v[108:111], v[92:93], v[94:95], v[80:83]
    s_waitcnt lgkmcnt(4)
    ds_read_b64 v[92:93], v96 offset:832
    v_cvt_pk_bf16_f32 v68, v68, v69
    v_accvgpr_write_b32 a228, v68
    v_cvt_pk_bf16_f32 v70, v70, v71
    v_accvgpr_write_b32 a229, v70
    v_cvt_pk_bf16_f32 v76, v76, v77
    v_mfma_f32_16x16x16_bf16 v[80:83], v[112:113], v[94:95], v[104:107]
    ds_read_b128 v[84:87], v29 offset:64
    v_accvgpr_write_b32 a252, v76
    v_mfma_f32_16x16x16_bf16 v[68:71], v[114:115], v[94:95], v[104:107]
    v_cvt_pk_bf16_f32 v78, v78, v79
    v_accvgpr_write_b32 a253, v78
    v_mfma_f32_16x16x16_bf16 v[76:79], v[116:117], v[94:95], v[104:107]
    v_cvt_pk_bf16_f32 v244, v108, v109
    v_cvt_pk_bf16_f32 v245, v110, v111
    v_cvt_pk_bf16_f32 v80, v80, v81
    v_accvgpr_write_b32 a230, v80
    v_cvt_pk_bf16_f32 v82, v82, v83
    v_accvgpr_write_b32 a231, v82
    v_cvt_pk_bf16_f32 v68, v68, v69
    v_accvgpr_write_b32 a254, v68
    v_cvt_pk_bf16_f32 v70, v70, v71
    v_accvgpr_write_b32 a255, v70
    v_cvt_pk_bf16_f32 v246, v76, v77
    s_waitcnt lgkmcnt(3)
    v_mfma_f32_16x16x16_bf16 v[68:71], v[98:99], v[94:95], v[60:63]
    v_cvt_pk_bf16_f32 v247, v78, v79
    v_cvt_pk_bf16_f32 v20, v20, v21
    v_mfma_f32_16x16x16_bf16 v[96:99], v[100:101], v[94:95], v[60:63]
    s_waitcnt vmcnt(5) lgkmcnt(1)
    ds_write_b32 v135, v20 offset:1536
    v_mfma_f32_16x16x16_bf16 v[80:83], v[102:103], v[94:95], v[60:63]
    s_waitcnt lgkmcnt(1)
    s_barrier
    v_cvt_pk_bf16_f32 v68, v68, v69
    v_accvgpr_write_b32 a216, v68
    v_cvt_pk_bf16_f32 v70, v70, v71
    v_accvgpr_write_b32 a217, v70
    v_cvt_pk_bf16_f32 v96, v96, v97
    v_accvgpr_write_b32 a240, v96
    v_mfma_f32_16x16x16_bf16 v[76:79], v[88:89], v[94:95], v[84:87]
    ds_read_b128 v[60:63], v122 offset:14848
    v_cvt_pk_bf16_f32 v98, v98, v99
    v_mfma_f32_16x16x16_bf16 v[68:71], v[90:91], v[94:95], v[84:87]
    ds_write_b128 v146, v[64:67] offset:6144
    v_mfma_f32_16x16x16_bf16 v[64:67], v[92:93], v[94:95], v[84:87]
    v_accvgpr_write_b32 a241, v98
    v_cvt_pk_bf16_f32 v232, v80, v81
    v_cvt_pk_bf16_f32 v233, v82, v83
    v_cvt_pk_bf16_f32 v76, v76, v77
    v_accvgpr_write_b32 a218, v76
    v_cvt_pk_bf16_f32 v78, v78, v79
    ds_write_b128 v15, v[72:75]
    v_accvgpr_write_b32 a219, v78
    v_cvt_pk_bf16_f32 v68, v68, v69
    v_accvgpr_write_b32 a242, v68
    v_cvt_pk_bf16_f32 v70, v70, v71
    v_accvgpr_write_b32 a243, v70
    v_cvt_pk_bf16_f32 v234, v64, v65
    v_cvt_pk_bf16_f32 v235, v66, v67
    v_mul_f32 v22, v22, v44
    ds_write2_b64 v15, v[18:19], v[18:19] offset0:2 offset1:3
    s_waitcnt lgkmcnt(2)
    v_or3_b32 v60, v60, v61, v62
    v_or_b32 v60, v60, v63
    v_mul_f32 v23, v23, v44
    v_readfirstlane_b32 s75, v60
    v_cvt_pk_bf16_f32 v21, v22, v23
    v_mul_f32 v52, v52, v44
    v_mul_f32 v53, v53, v44
    v_cvt_pk_bf16_f32 v22, v52, v53
    ds_write_b128 v15, v[56:59] offset:32
    v_mul_f32 v54, v54, v44
    v_mul_f32 v55, v55, v44
    v_cvt_pk_bf16_f32 v23, v54, v55
    v_mul_f32 v48, v48, v44
    v_mul_f32 v49, v49, v44
    v_cvt_pk_bf16_f32 v154, v48, v49
    v_mul_f32 v50, v50, v44
    v_mul_f32 v51, v51, v44
    ds_write2_b64 v15, v[42:43], v[18:19] offset0:6 offset1:7
    v_cvt_pk_bf16_f32 v155, v50, v51
    v_exp_f32 v36, v36
    v_exp_f32 v37, v37
    v_exp_f32 v38, v38
    v_exp_f32 v39, v39
    ds_write2_b64 v15, v[18:19], v[40:41] offset0:8 offset1:9
    v_cvt_pk_bf16_f32 v18, v36, v37
    v_cvt_pk_bf16_f32 v19, v38, v39
    v_exp_f32 v32, v32
    v_exp_f32 v33, v33
    v_exp_f32 v34, v34
    ds_write_b64 v15, v[12:13] offset:88
    v_exp_f32 v35, v35
    v_cvt_pk_bf16_f32 v168, v32, v33
    v_cvt_pk_bf16_f32 v169, v34, v35
    v_exp_f32 v14, v14
    ds_write_b64 v28, v[120:121] offset:80
    v_cvt_pk_bf16_f32 v170, v14, 0
    v_mfma_f32_16x16x32_bf16 v[12:15], v[220:223], v[16:19], 0
    s_nop 0
    v_mfma_f32_16x16x32_bf16 v[12:15], v[220:223], v[168:171], v[12:15]
    ds_write_b128 v28, v[24:27] offset:96
    v_mfma_f32_16x16x32_bf16 v[72:75], v[0:3], v[16:19], 0
    v_mfma_f32_16x16x32_bf16 v[72:75], v[164:167], v[168:171], v[72:75]
    v_mfma_f32_16x16x32_bf16 v[0:3], v[8:11], v[16:19], 0
    ds_read_b128 v[146:149], v137 offset:0
    v_mfma_f32_16x16x32_bf16 v[0:3], v[160:163], v[168:171], v[0:3]
    ds_read_b128 v[88:91], v136 offset:0
    v_mfma_f32_16x16x32_bf16 v[8:11], v[4:7], v[16:19], 0
    ds_read_b128 v[108:111], v137 offset:128
    v_mfma_f32_16x16x32_bf16 v[8:11], v[156:159], v[168:171], v[8:11]
    ds_read_b128 v[116:119], v136 offset:128
    ds_read_b128 v[60:63], v137 offset:256
    ds_read_b128 v[64:67], v136 offset:256
    ds_read_b128 v[68:71], v137 offset:1536
    ds_read_b128 v[100:103], v136 offset:1536
    ds_read_b128 v[80:83], v137 offset:1664
    s_waitcnt lgkmcnt(8)
    v_mfma_f32_16x16x32_bf16 v[30:33], a[0:3], v[146:149], 0
    ds_read_b128 v[76:79], v136 offset:1792
    s_waitcnt lgkmcnt(0)
    s_cmp_lg_u32 s75, 0
    s_cbranch_scc1 L_slow
.p2align 6
L_loopF0:
    v_mfma_f32_16x16x32_bf16 v[30:33], a[4:7], v[88:91], v[30:33]
    ds_write_b32 v135, v21 offset:1540
    v_mfma_f32_16x16x32_bf16 v[30:33], a[8:11], v[108:111], v[30:33]
    v_rcp_f32 v12, v12
    v_mfma_f32_16x16x32_bf16 v[30:33], a[12:15], v[116:119], v[30:33]
    v_mul_f32 v72, v72, v12
    v_mul_f32 v73, v73, v12
    v_mfma_f32_16x16x32_bf16 v[30:33], a[16:19], v[60:63], v[30:33]
    v_cvt_pk_bf16_f32 v4, v72, v73
    v_mul_f32 v74, v74, v12
    v_mfma_f32_16x16x32_bf16 v[30:33], a[20:23], v[64:67], v[30:33]
    ds_write_b64 v135, v[22:23] offset:1544
    v_mfma_f32_16x16x32_bf16 v[20:23], v[146:149], a[168:171], 0
    v_mul_f32 v75, v75, v12
    v_cvt_pk_bf16_f32 v5, v74, v75
    v_mfma_f32_16x16x32_bf16 v[20:23], v[88:91], a[172:175], v[20:23]
    v_mul_f32 v0, v0, v12
    v_mul_f32 v1, v1, v12
    v_mfma_f32_16x16x32_bf16 v[20:23], v[108:111], a[176:179], v[20:23]
    ds_read_b128 v[72:75], v136 offset:1664
    v_cvt_pk_bf16_f32 v6, v0, v1
    v_mfma_f32_16x16x32_bf16 v[20:23], v[116:119], a[180:183], v[20:23]
    v_mul_f32 v2, v2, v12
    v_mul_f32 v3, v3, v12
    v_mfma_f32_16x16x32_bf16 v[20:23], v[60:63], a[184:187], v[20:23]
    v_cvt_pk_bf16_f32 v7, v2, v3
    v_mul_f32 v8, v8, v12
    v_mfma_f32_16x16x32_bf16 v[20:23], v[64:67], a[188:191], v[20:23]
    ds_read_b128 v[112:115], v137 offset:1792
    v_mul_f32 v9, v9, v12
    v_mfma_f32_16x16x32_bf16 v[0:3], a[120:123], v[146:149], 0
    v_cvt_pk_bf16_f32 v152, v8, v9
    v_mul_f32 v10, v10, v12
    v_mfma_f32_16x16x32_bf16 v[0:3], a[124:127], v[88:91], v[0:3]
    v_mul_f32 v11, v11, v12
    v_cvt_pk_bf16_f32 v153, v10, v11
    v_mfma_f32_16x16x32_bf16 v[0:3], a[128:131], v[108:111], v[0:3]
    v_fmac_f32 v28, v39, v39
    v_fmac_f32 v28, v96, v96
    v_mfma_f32_16x16x32_bf16 v[0:3], a[132:135], v[116:119], v[0:3]
    ds_write_b64 v134, v[154:155] offset:1536
    v_mfma_f32_16x16x32_bf16 v[0:3], a[136:139], v[60:63], v[0:3]
    v_fmac_f32 v28, v97, v97
    v_fmac_f32 v28, v98, v98
    v_mfma_f32_16x16x32_bf16 v[0:3], a[140:143], v[64:67], v[0:3]
    v_fmac_f32 v28, v99, v99
    v_fma_f32 v29, v56, v56, s42
    v_mfma_f32_16x16x32_bf16 v[12:15], a[48:51], v[146:149], 0
    v_fmac_f32 v29, v57, v57
    v_fmac_f32 v29, v58, v58
    v_mfma_f32_16x16x32_bf16 v[12:15], a[52:55], v[88:91], v[12:15]
    ds_write_b64 v135, v[4:5] offset:3072
    v_mfma_f32_16x16x32_bf16 v[12:15], a[56:59], v[108:111], v[12:15]
    v_fmac_f32 v29, v59, v59
    v_fmac_f32 v29, v140, v140
    v_mfma_f32_16x16x32_bf16 v[12:15], a[60:63], v[116:119], v[12:15]
    v_fmac_f32 v29, v141, v141
    v_fmac_f32 v29, v142, v142
    v_mfma_f32_16x16x32_bf16 v[12:15], a[64:67], v[60:63], v[12:15]
    v_fmac_f32 v29, v143, v143
    v_fmac_f32 v29, v104, v104
    v_mfma_f32_16x16x32_bf16 v[12:15], a[68:71], v[64:67], v[12:15]
    ds_write_b64 v135, v[6:7] offset:3080
    v_mfma_f32_16x16x32_bf16 v[4:7], a[24:27], v[146:149], 0
    v_fmac_f32 v29, v105, v105
    v_fmac_f32 v29, v106, v106
    v_mfma_f32_16x16x32_bf16 v[4:7], a[28:31], v[88:91], v[4:7]
    v_fmac_f32 v29, v107, v107
    v_fma_f32 v154, v52, v52, s42
    v_mfma_f32_16x16x32_bf16 v[4:7], a[32:35], v[108:111], v[4:7]
    v_fmac_f32 v154, v53, v53
    v_fmac_f32 v154, v54, v54
    v_mfma_f32_16x16x32_bf16 v[4:7], a[36:39], v[116:119], v[4:7]
    ds_write_b32 v134, v152 offset:3072
    v_mfma_f32_16x16x32_bf16 v[4:7], a[40:43], v[60:63], v[4:7]
    v_fmac_f32 v154, v55, v55
    v_fmac_f32 v154, v84, v84
    v_mfma_f32_16x16x32_bf16 v[4:7], a[44:47], v[64:67], v[4:7]
    v_fmac_f32 v154, v85, v85
    v_fmac_f32 v154, v86, v86
    v_mfma_f32_16x16x32_bf16 v[8:11], v[146:149], a[192:195], 0
    v_fmac_f32 v154, v87, v87
    v_fmac_f32 v154, v48, v48
    v_mfma_f32_16x16x32_bf16 v[8:11], v[88:91], a[196:199], v[8:11]
    s_waitcnt vmcnt(10)
    ds_write_b32 v134, v153 offset:3076
    v_mfma_f32_16x16x32_bf16 v[8:11], v[108:111], a[200:203], v[8:11]
    v_fmac_f32 v154, v49, v49
    v_fmac_f32 v154, v50, v50
    v_mfma_f32_16x16x32_bf16 v[8:11], v[116:119], a[204:207], v[8:11]
    v_fmac_f32 v154, v51, v51
    v_cvt_pk_bf16_f32 v28, v28, v29
    v_mfma_f32_16x16x32_bf16 v[8:11], v[60:63], a[208:211], v[8:11]
    v_cvt_pk_bf16_f32 v29, v154, v122
    v_add_u32 v135, s49, v135
    v_mfma_f32_16x16x32_bf16 v[8:11], v[64:67], a[212:215], v[8:11]
    ds_write_b64 v130, v[28:29]
    v_mfma_f32_16x16x32_bf16 v[40:43], a[72:75], v[146:149], 0
    v_add_u32 v134, s49, v134
    v_cvt_pk_f16_f32 v28, v30, v31
    v_mfma_f32_16x16x32_bf16 v[40:43], a[76:79], v[88:91], v[40:43]
    v_cvt_pk_f16_f32 v29, v32, v33
    v_pk_fma_f16 v32, v28, v28, s39
    v_mfma_f32_16x16x32_bf16 v[40:43], a[80:83], v[108:111], v[40:43]
    v_pk_fmac_f16 v32, v29, v29
    v_cvt_pk_f16_f32 v154, v0, v1
    v_mfma_f32_16x16x32_bf16 v[40:43], a[84:87], v[116:119], v[40:43]
    v_cvt_pk_f16_f32 v155, v2, v3
    v_cvt_pk_f16_f32 v30, v4, v5
    v_mfma_f32_16x16x32_bf16 v[40:43], a[88:91], v[60:63], v[40:43]
    v_cvt_pk_f16_f32 v31, v6, v7
    v_pk_fmac_f16 v32, v30, v30
    v_mfma_f32_16x16x32_bf16 v[40:43], a[92:95], v[64:67], v[40:43]
    v_pk_fmac_f16 v32, v31, v31
    v_cvt_pk_bf16_f32 v4, v8, v9
    v_mfma_f32_16x16x32_bf16 v[0:3], a[96:99], v[146:149], 0
    v_cvt_pk_bf16_f32 v5, v10, v11
    v_cvt_pk_f16_f32 v152, v12, v13
    v_mfma_f32_16x16x32_bf16 v[0:3], a[100:103], v[88:91], v[0:3]
    s_waitcnt lgkmcnt(0)
    v_cvt_pk_f16_f32 v153, v14, v15
    v_pk_fmac_f16 v32, v152, v152
    v_mfma_f32_16x16x32_bf16 v[0:3], a[104:107], v[108:111], v[0:3]
    s_barrier
    ds_read_b128 v[8:11], v129 offset:0
    v_pk_fmac_f16 v32, v153, v153
    v_mfma_f32_16x16x32_bf16 v[0:3], a[108:111], v[116:119], v[0:3]
    ds_read_b128 v[44:47], v129 offset:1024
    v_cvt_pk_f16_f32 v12, v40, v41
    v_mfma_f32_16x16x32_bf16 v[0:3], a[112:115], v[60:63], v[0:3]
    v_cvt_pk_f16_f32 v13, v42, v43
    v_pk_fma_f16 v33, v12, v12, s39
    v_mfma_f32_16x16x32_bf16 v[0:3], a[116:119], v[64:67], v[0:3]
    v_pk_fmac_f16 v33, v13, v13
    s_nop 0
    v_mfma_f32_16x16x32_bf16 v[40:43], v[146:149], a[144:147], 0
    s_nop 2
    v_mfma_f32_16x16x32_bf16 v[40:43], v[88:91], a[148:151], v[40:43]
    s_nop 0
    v_cvt_pk_f16_f32 v14, v0, v1
    v_cvt_pk_f16_f32 v15, v2, v3
    v_mfma_f32_16x16x32_bf16 v[40:43], v[108:111], a[152:155], v[40:43]
    v_pk_fmac_f16 v33, v14, v14
    v_pk_fmac_f16 v33, v15, v15
    v_mfma_f32_16x16x32_bf16 v[40:43], v[116:119], a[156:159], v[40:43]
    v_pk_fmac_f16 v33, v154, v154
    v_pk_fmac_f16 v33, v155, v155
    v_mfma_f32_16x16x32_bf16 v[40:43], v[60:63], a[160:163], v[40:43]
    v_mfma_f32_16x16x32_bf16 v[40:43], v[64:67], a[164:167], v[40:43]
    s_waitcnt lgkmcnt(1)
    v_readfirstlane_b32 s12, v9
    v_mfma_f32_16x16x32_bf16 v[88:91], v[216:219], v[8:11], 0
    s_waitcnt lgkmcnt(0)
    s_nop 1
    v_mfma_f32_16x16x32_bf16 v[88:91], v[216:219], v[44:47], v[88:91]
    s_lshr_b32 s12, s12, 23
    v_cvt_pk_bf16_f32 v0, v40, v41
    v_cvt_pk_bf16_f32 v1, v42, v43
    v_mfma_f32_16x16x32_bf16 v[60:63], a[24:27], v[68:71], 0
    s_nop 1
    v_mfma_f32_16x16x32_bf16 v[60:63], a[28:31], v[100:103], v[60:63]
    s_nop 0
    v_rsq_f32 v88, v88
    v_mfma_f32_16x16x32_bf16 v[60:63], a[32:35], v[80:83], v[60:63]
    v_rsq_f32 v89, v89
    v_mfma_f32_16x16x32_bf16 v[60:63], a[36:39], v[72:75], v[60:63]
    v_rsq_f32 v90, v90
    v_mfma_f32_16x16x32_bf16 v[60:63], a[40:43], v[112:115], v[60:63]
    v_mul_f32 v88, s43, v88
    v_mul_f32 v89, s43, v89
    v_mfma_f32_16x16x32_bf16 v[60:63], a[44:47], v[76:79], v[60:63]
    v_mul_f32 v90, s43, v90
    v_mul_f32 v56, v56, v89
    v_mfma_f32_16x16x32_bf16 v[40:43], a[96:99], v[68:71], 0
    v_mul_f32 v57, v57, v89
    v_cvt_pk_bf16_f32 v44, v56, v57
    v_mfma_f32_16x16x32_bf16 v[40:43], a[100:103], v[100:103], v[40:43]
    ds_write_b32 v135, v44 offset:1536
    v_mfma_f32_16x16x32_bf16 v[40:43], a[104:107], v[80:83], v[40:43]
    v_mul_f32 v58, v58, v89
    v_mul_f32 v59, v59, v89
    v_mfma_f32_16x16x32_bf16 v[40:43], a[108:111], v[72:75], v[40:43]
    v_cvt_pk_bf16_f32 v45, v58, v59
    v_mul_f32 v140, v140, v89
    v_mfma_f32_16x16x32_bf16 v[40:43], a[112:115], v[112:115], v[40:43]
    v_mul_f32 v141, v141, v89
    v_cvt_pk_bf16_f32 v46, v140, v141
    v_mfma_f32_16x16x32_bf16 v[40:43], a[116:119], v[76:79], v[40:43]
    s_nop 0
    ds_write_b32 v135, v45 offset:1540
    v_mfma_f32_16x16x32_bf16 v[146:149], v[68:71], a[168:171], 0
    s_nop 0
    v_mul_f32 v142, v142, v89
    v_mul_f32 v143, v143, v89
    v_mfma_f32_16x16x32_bf16 v[146:149], v[100:103], a[172:175], v[146:149]
    s_nop 0
    v_cvt_pk_f16_f32 v10, v40, v41
    v_cvt_pk_f16_f32 v11, v42, v43
    v_mfma_f32_16x16x32_bf16 v[146:149], v[80:83], a[176:179], v[146:149]
    v_cvt_pk_bf16_f32 v47, v142, v143
    v_mul_f32 v104, v104, v89
    v_mfma_f32_16x16x32_bf16 v[146:149], v[72:75], a[180:183], v[146:149]
    ds_write_b64 v135, v[46:47] offset:1544
    v_mfma_f32_16x16x32_bf16 v[146:149], v[112:115], a[184:187], v[146:149]
    s_sub_u32 s50, s45, s44
    v_mul_f32 v105, v105, v89
    v_cvt_pk_bf16_f32 v8, v104, v105
    v_mfma_f32_16x16x32_bf16 v[146:149], v[76:79], a[188:191], v[146:149]
    s_sub_u32 s51, s46, s47
    v_mul_f32 v106, v106, v89
    v_mul_f32 v107, v107, v89
    v_mfma_f32_16x16x32_bf16 v[40:43], a[48:51], v[68:71], 0
    s_mov_b32 s60, s59
    v_cvt_pk_bf16_f32 v9, v106, v107
    v_mul_f32 v92, v92, v88
    v_mfma_f32_16x16x32_bf16 v[40:43], a[52:55], v[100:103], v[40:43]
    s_mov_b32 s59, s58
    ds_write_b32 v134, v9 offset:1540
    v_mfma_f32_16x16x32_bf16 v[40:43], a[56:59], v[80:83], v[40:43]
    s_mov_b32 s58, s57
    v_cvt_pk_bf16_f32 v26, v146, v147
    v_cvt_pk_bf16_f32 v27, v148, v149
    v_mfma_f32_16x16x32_bf16 v[40:43], a[60:63], v[72:75], v[40:43]
    s_mov_b32 s57, s56
    v_mul_f32 v93, v93, v88
    v_cvt_pk_bf16_f32 v16, v92, v93
    v_mfma_f32_16x16x32_bf16 v[40:43], a[64:67], v[112:115], v[40:43]
    s_mov_b32 s7, s6
    v_mul_f32 v94, v94, v88
    v_mul_f32 v95, v95, v88
    v_mfma_f32_16x16x32_bf16 v[40:43], a[68:71], v[76:79], v[40:43]
    s_mov_b32 s6, s5
    ds_write_b32 v134, v8 offset:1536
    v_mfma_f32_16x16x32_bf16 v[64:67], a[72:75], v[68:71], 0
    s_mov_b32 s5, s4
    v_cvt_pk_bf16_f32 v17, v94, v95
    v_mul_f32 v36, v36, v88
    v_mfma_f32_16x16x32_bf16 v[64:67], a[76:79], v[100:103], v[64:67]
    s_sub_u32 s14, s6, s7
    v_cvt_pk_f16_f32 v146, v40, v41
    v_cvt_pk_f16_f32 v147, v42, v43
    v_mfma_f32_16x16x32_bf16 v[64:67], a[80:83], v[80:83], v[64:67]
    s_add_u32 s61, s61, 1
    v_mul_f32 v37, v37, v88
    v_cvt_pk_bf16_f32 v18, v36, v37
    v_mfma_f32_16x16x32_bf16 v[64:67], a[84:87], v[72:75], v[64:67]
    s_add_u32 s12, s12, 20
    ds_write_b64 v135, v[16:17] offset:0
    v_mfma_f32_16x16x32_bf16 v[64:67], a[88:91], v[112:115], v[64:67]
    s_max_u32 s12, s12, s61
    v_mul_f32 v38, v38, v88
    v_mul_f32 v39, v39, v88
    v_mfma_f32_16x16x32_bf16 v[64:67], a[92:95], v[76:79], v[64:67]
    s_cmp_lt_u32 s61, s71
    v_cvt_pk_bf16_f32 v19, v38, v39
    v_mul_f32 v96, v96, v88
    v_mfma_f32_16x16x32_bf16 v[92:95], a[120:123], v[68:71], 0
    s_cselect_b32 s15, s61, s12
    ds_read_b128 v[40:43], v136 offset:3072
    v_mul_f32 v97, v97, v88
    v_mfma_f32_16x16x32_bf16 v[92:95], a[124:127], v[100:103], v[92:95]
    s_cselect_b32 s56, s69, s70
    ds_read_b128 v[44:47], v136 offset:3200
    v_cvt_pk_bf16_f32 v2, v96, v97
    v_mfma_f32_16x16x32_bf16 v[92:95], a[128:131], v[80:83], v[92:95]
    s_add_u32 s56, s56, s15
    v_mul_f32 v98, v98, v88
    v_mul_f32 v99, v99, v88
    v_mfma_f32_16x16x32_bf16 v[92:95], a[132:135], v[72:75], v[92:95]
    s_mul_i32 s53, s56, 58255
    v_cvt_pk_bf16_f32 v3, v98, v99
    v_cvt_pk_f16_f32 v8, v64, v65
    v_mfma_f32_16x16x32_bf16 v[92:95], a[136:139], v[112:115], v[92:95]
    s_lshr_b32 s53, s53, 22
    ds_read_b128 v[36:39], v136 offset:3328
    v_cvt_pk_f16_f32 v9, v66, v67
    v_mfma_f32_16x16x32_bf16 v[92:95], a[140:143], v[76:79], v[92:95]
    s_mul_i32 s53, s53, s63
    v_pk_fma_f16 v35, v8, v8, s39
    v_pk_fmac_f16 v35, v9, v9
    v_mfma_f32_16x16x32_bf16 v[64:67], v[68:71], a[144:147], 0
    s_mul_i32 s56, s56, s62
    v_pk_fmac_f16 v35, v10, v10
    v_pk_fmac_f16 v35, v11, v11
    v_mfma_f32_16x16x32_bf16 v[64:67], v[100:103], a[148:151], v[64:67]
    s_add_u32 s56, s56, s53
    v_cvt_pk_f16_f32 v148, v92, v93
    v_cvt_pk_f16_f32 v149, v94, v95
    v_mfma_f32_16x16x32_bf16 v[64:67], v[80:83], a[152:155], v[64:67]
    s_mul_i32 s4, s15, 112
    ds_write_b64 v135, v[18:19] offset:8
    v_mfma_f32_16x16x32_bf16 v[64:67], v[72:75], a[156:159], v[64:67]
    s_cmp_ge_u32 s15, 16
    v_pk_fmac_f16 v35, v148, v148
    v_pk_fmac_f16 v35, v149, v149
    v_mfma_f32_16x16x32_bf16 v[64:67], v[112:115], a[160:163], v[64:67]
    s_cselect_b32 s53, -30464, 0
    v_cvt_pk_f16_f32 v18, v60, v61
    v_cvt_pk_f16_f32 v19, v62, v63
    v_mfma_f32_16x16x32_bf16 v[64:67], v[76:79], a[164:167], v[64:67]
    s_add_u32 s4, s4, s53
    v_mul_f32 v52, v52, v90
    v_mul_f32 v53, v53, v90
    v_mfma_f32_16x16x32_bf16 v[92:95], a[0:3], v[68:71], 0
    s_cmp_lt_u32 s15, s73
    ds_write_b64 v134, v[2:3] offset:0
    v_mfma_f32_16x16x32_bf16 v[92:95], a[4:7], v[100:103], v[92:95]
    s_cselect_b32 s26, 100270464, 0
    v_cvt_pk_bf16_f32 v2, v64, v65
    v_cvt_pk_bf16_f32 v3, v66, v67
    v_mfma_f32_16x16x32_bf16 v[92:95], a[8:11], v[80:83], v[92:95]
    s_cselect_b32 s56, s56, 0
    v_cvt_pk_bf16_f32 v104, v52, v53
    v_mul_f32 v54, v54, v90
    v_mfma_f32_16x16x32_bf16 v[92:95], a[12:15], v[72:75], v[92:95]
    s_cselect_b32 s4, s4, -1
    ds_read_b128 v[60:63], v137 offset:3072
    v_mul_f32 v55, v55, v90
    v_mfma_f32_16x16x32_bf16 v[92:95], a[16:19], v[112:115], v[92:95]
    s_cselect_b32 s15, s15, 0
    ds_read_b128 v[64:67], v137 offset:3200
    v_cvt_pk_bf16_f32 v105, v54, v55
    v_mfma_f32_16x16x32_bf16 v[92:95], a[20:23], v[76:79], v[92:95]
    s_cselect_b32 s13, s13, -1
    ds_read_b128 v[52:55], v137 offset:3328
    v_mul_f32 v84, v84, v90
    v_mfma_f32_16x16x32_bf16 v[56:59], v[68:71], a[192:195], 0
    s_bitset1_b32 s64, s15
    v_mul_f32 v85, v85, v90
    v_cvt_pk_bf16_f32 v106, v84, v85
    v_mfma_f32_16x16x32_bf16 v[56:59], v[100:103], a[196:199], v[56:59]
    s_add_u32 s65, s65, 1
    v_cvt_pk_f16_f32 v16, v92, v93
    v_cvt_pk_f16_f32 v17, v94, v95
    v_mfma_f32_16x16x32_bf16 v[56:59], v[80:83], a[200:203], v[56:59]
    s_cmp_ge_i32 s65, 2
    v_pk_fma_f16 v34, v16, v16, s39
    v_pk_fmac_f16 v34, v17, v17
    v_mfma_f32_16x16x32_bf16 v[56:59], v[72:75], a[204:207], v[56:59]
    s_cselect_b32 s30, 100270464, 0
    ds_write_b64 v135, v[104:105] offset:3072
    v_mfma_f32_16x16x32_bf16 v[56:59], v[112:115], a[208:211], v[56:59]
    s_add_u32 s67, s46, s54
    v_pk_fmac_f16 v34, v18, v18
    v_pk_fmac_f16 v34, v19, v19
    v_mfma_f32_16x16x32_bf16 v[56:59], v[76:79], a[212:215], v[56:59]
    s_waitcnt lgkmcnt(3)
    v_pk_fmac_f16 v34, v146, v146
    v_pk_fmac_f16 v34, v147, v147
    v_mfma_f32_16x16x32_bf16 v[80:83], a[72:75], v[60:63], 0
    s_add_u32 m0, s67, 0
    v_mul_f32 v86, v86, v90
    v_mul_f32 v87, v87, v90
    v_mfma_f32_16x16x32_bf16 v[80:83], a[76:79], v[40:43], v[80:83]
    s_waitcnt lgkmcnt(1)
    ds_write_b32 v135, v106 offset:3080
    v_mfma_f32_16x16x32_bf16 v[80:83], a[80:83], v[64:67], v[80:83]
    v_cvt_pk_bf16_f32 v107, v86, v87
    v_mul_f32 v48, v48, v90
    v_mfma_f32_16x16x32_bf16 v[80:83], a[84:87], v[44:47], v[80:83]
    v_mul_f32 v49, v49, v90
    v_cvt_pk_bf16_f32 v104, v48, v49
    v_mfma_f32_16x16x32_bf16 v[80:83], a[88:91], v[52:55], v[80:83]
    v_mul_f32 v50, v50, v90
    v_mul_f32 v51, v51, v90
    v_mfma_f32_16x16x32_bf16 v[80:83], a[92:95], v[36:39], v[80:83]
    s_nop 0
    ds_write_b32 v135, v107 offset:3084
    v_mfma_f32_16x16x32_bf16 v[92:95], a[120:123], v[60:63], 0
    s_nop 0
    v_cvt_pk_bf16_f32 v105, v50, v51
    v_cvt_pk_bf16_f32 v6, v56, v57
    v_mfma_f32_16x16x32_bf16 v[92:95], a[124:127], v[40:43], v[92:95]
    s_nop 0
    v_cvt_pk_f16_f32 v48, v80, v81
    v_cvt_pk_f16_f32 v49, v82, v83
    v_mfma_f32_16x16x32_bf16 v[92:95], a[128:131], v[64:67], v[92:95]
    v_cvt_pk_bf16_f32 v7, v58, v59
    v_add_u32 v137, s50, v137
    v_mfma_f32_16x16x32_bf16 v[92:95], a[132:135], v[44:47], v[92:95]
    ds_write_b32 v134, v104 offset:3072
    v_mfma_f32_16x16x32_bf16 v[92:95], a[136:139], v[52:55], v[92:95]
    v_add_u32 v136, s50, v136
    v_add_u32 v135, s48, v135
    v_mfma_f32_16x16x32_bf16 v[92:95], a[140:143], v[36:39], v[92:95]
    v_add_u32 v133, s51, v133
    v_add_u32 v132, s14, v132
    v_mfma_f32_16x16x32_f16 v[88:91], v[212:215], v[32:35], 0
    s_nop 0
    v_pk_fma_f16 v33, v48, v48, s39
    v_pk_fmac_f16 v33, v49, v49
    v_mfma_f32_16x16x32_bf16 v[84:87], v[60:63], a[168:171], 0
    s_nop 0
    ds_write_b32 v134, v105 offset:3076
    v_mfma_f32_16x16x32_bf16 v[84:87], v[40:43], a[172:175], v[84:87]
    s_waitcnt vmcnt(0)
    v_or3_b32 v123, v123, v88, v89
    v_or3_b32 v123, v123, v90, v91
    v_mfma_f32_16x16x32_bf16 v[84:87], v[64:67], a[176:179], v[84:87]
    v_rsq_f32 v88, v88
    v_mfma_f32_16x16x32_bf16 v[84:87], v[44:47], a[180:183], v[84:87]
    v_rsq_f32 v89, v89
    v_mfma_f32_16x16x32_bf16 v[84:87], v[52:55], a[184:187], v[84:87]
    v_mul_f32 v88, s52, v88
    v_cvt_pk_f16_f32 v88, v88, v89
    v_mfma_f32_16x16x32_bf16 v[84:87], v[36:39], a[188:191], v[84:87]
    v_rsq_f32 v90, v90
    v_mfma_f32_16x16x32_bf16 v[76:79], a[24:27], v[60:63], 0
    v_rsq_f32 v91, v91
    v_mfma_f32_16x16x32_bf16 v[76:79], a[28:31], v[40:43], v[76:79]
    v_mul_f32 v90, s52, v90
    v_cvt_pk_f16_f32 v90, v90, v91
    v_mfma_f32_16x16x32_bf16 v[76:79], a[32:35], v[64:67], v[76:79]
    s_waitcnt lgkmcnt(0)
    v_pk_mul_f16 v12, v12, v88 op_sel:[0,1] op_sel_hi:[1,1]
    v_pk_mul_f16 v13, v13, v88 op_sel:[0,1] op_sel_hi:[1,1]
    v_mfma_f32_16x16x32_bf16 v[76:79], a[36:39], v[44:47], v[76:79]
    s_barrier
    v_pk_mul_f16 v14, v14, v88 op_sel:[0,1] op_sel_hi:[1,1]
    v_pk_mul_f16 v15, v15, v88 op_sel:[0,1] op_sel_hi:[1,1]
    v_mfma_f32_16x16x32_bf16 v[76:79], a[40:43], v[52:55], v[76:79]
    s_cmp_ge_u32 s61, s13
    v_pk_mul_f16 v154, v154, v88 op_sel:[0,1] op_sel_hi:[1,1]
    v_pk_mul_f16 v155, v155, v88 op_sel:[0,1] op_sel_hi:[1,1]
    v_mfma_f32_16x16x32_bf16 v[76:79], a[44:47], v[36:39], v[76:79]
    s_cbranch_scc1 L_atomF0
L_atomrF0:
    v_mfma_f32_16x16x32_bf16 v[140:143], v[60:63], a[144:147], 0
    v_pk_mul_f16 v8, v8, v90 op_sel:[0,1] op_sel_hi:[1,1]
    v_pk_mul_f16 v9, v9, v90 op_sel:[0,1] op_sel_hi:[1,1]
    v_mfma_f32_16x16x32_bf16 v[140:143], v[40:43], a[148:151], v[140:143]
    v_pk_mul_f16 v10, v10, v90 op_sel:[0,1] op_sel_hi:[1,1]
    v_pk_mul_f16 v11, v11, v90 op_sel:[0,1] op_sel_hi:[1,1]
    v_mfma_f32_16x16x32_bf16 v[140:143], v[64:67], a[152:155], v[140:143]
    v_pk_mul_f16 v148, v148, v90 op_sel:[0,1] op_sel_hi:[1,1]
    v_pk_mul_f16 v149, v149, v90 op_sel:[0,1] op_sel_hi:[1,1]
    v_mfma_f32_16x16x32_bf16 v[140:143], v[44:47], a[156:159], v[140:143]
    v_pk_mul_f16 v28, v28, v88 op_sel:[0,0] op_sel_hi:[1,0]
    v_pk_mul_f16 v29, v29, v88 op_sel:[0,0] op_sel_hi:[1,0]
    v_mfma_f32_16x16x32_bf16 v[140:143], v[52:55], a[160:163], v[140:143]
    ds_read_b128 v[80:83], v137 offset:0
    v_pk_mul_f16 v30, v30, v88 op_sel:[0,0] op_sel_hi:[1,0]
    v_mfma_f32_16x16x32_bf16 v[140:143], v[36:39], a[164:167], v[140:143]
    v_pk_mul_f16 v31, v31, v88 op_sel:[0,0] op_sel_hi:[1,0]
    v_pk_mul_f16 v152, v152, v88 op_sel:[0,0] op_sel_hi:[1,0]
    v_mfma_f32_16x16x32_bf16 v[96:99], a[0:3], v[60:63], 0
    ds_read_b128 v[68:71], v132 offset:0
    v_pk_mul_f16 v153, v153, v88 op_sel:[0,0] op_sel_hi:[1,0]
    v_mfma_f32_16x16x32_bf16 v[96:99], a[4:7], v[40:43], v[96:99]
    ds_read_b128 v[104:107], v133 offset:0
    v_cvt_pk_f16_f32 v58, v76, v77
    v_mfma_f32_16x16x32_bf16 v[96:99], a[8:11], v[64:67], v[96:99]
    v_cvt_pk_f16_f32 v59, v78, v79
    v_add_u32 v134, s48, v134
    v_mfma_f32_16x16x32_bf16 v[96:99], a[12:15], v[44:47], v[96:99]
    ds_read_b128 v[76:79], v132 offset:16
    v_add_u32 v131, s14, v131
    v_mfma_f32_16x16x32_bf16 v[96:99], a[16:19], v[52:55], v[96:99]
    v_pk_mul_f16 v16, v16, v90 op_sel:[0,0] op_sel_hi:[1,0]
    v_pk_mul_f16 v17, v17, v90 op_sel:[0,0] op_sel_hi:[1,0]
    v_mfma_f32_16x16x32_bf16 v[96:99], a[20:23], v[36:39], v[96:99]
    v_pk_mul_f16 v18, v18, v90 op_sel:[0,0] op_sel_hi:[1,0]
    v_pk_mul_f16 v19, v19, v90 op_sel:[0,0] op_sel_hi:[1,0]
    v_mfma_f32_16x16x32_bf16 v[100:103], a[48:51], v[60:63], 0
    v_pk_mul_f16 v146, v146, v90 op_sel:[0,0] op_sel_hi:[1,0]
    v_pk_mul_f16 v147, v147, v90 op_sel:[0,0] op_sel_hi:[1,0]
    v_mfma_f32_16x16x32_bf16 v[100:103], a[52:55], v[40:43], v[100:103]
    s_nop 0
    ds_read_b128 v[88:91], v136 offset:128
    v_cvt_pk_f16_f32 v56, v96, v97
    v_mfma_f32_16x16x32_bf16 v[100:103], a[56:59], v[64:67], v[100:103]
    ds_read_b128 v[72:75], v132 offset:48
    v_cvt_pk_f16_f32 v57, v98, v99
    v_mfma_f32_16x16x32_bf16 v[100:103], a[60:63], v[44:47], v[100:103]
    ds_read_b128 v[96:99], v133 offset:2048
    v_pk_fma_f16 v32, v56, v56, s39
    v_mfma_f32_16x16x32_bf16 v[100:103], a[64:67], v[52:55], v[100:103]
    v_pk_fmac_f16 v32, v57, v57
    v_pk_fmac_f16 v32, v58, v58
    v_mfma_f32_16x16x32_bf16 v[100:103], a[68:71], v[36:39], v[100:103]
    v_pk_fmac_f16 v32, v59, v59
    v_cvt_pk_bf16_f32 v164, v140, v141
    v_mfma_f32_16x16x32_bf16 v[116:119], a[96:99], v[60:63], 0
    s_waitcnt lgkmcnt(3)
    ds_read_b128 v[108:111], v133 offset:1024
    buffer_load_dwordx4 v128, s[24:27], s56 offen nt lds
    v_mfma_f32_16x16x32_bf16 v[116:119], a[100:103], v[40:43], v[116:119]
    s_nop 0
    v_cvt_pk_f16_f32 v140, v100, v101
    v_cvt_pk_f16_f32 v141, v102, v103
    v_mfma_f32_16x16x32_bf16 v[116:119], a[104:107], v[64:67], v[116:119]
    ds_read_b128 v[100:103], v137 offset:256
    v_pk_fmac_f16 v32, v140, v140
    v_mfma_f32_16x16x32_bf16 v[116:119], a[108:111], v[44:47], v[116:119]
    ds_read_u16 v166, v131 offset:80
    v_pk_fmac_f16 v32, v141, v141
    v_mfma_f32_16x16x32_bf16 v[116:119], a[112:115], v[52:55], v[116:119]
    ds_read_u16 v162, v131 offset:96
    v_cvt_pk_bf16_f32 v165, v142, v143
    v_mfma_f32_16x16x32_bf16 v[116:119], a[116:119], v[36:39], v[116:119]
    ds_read_u16 v158, v131 offset:104
    v_cvt_pk_f16_f32 v142, v92, v93
    v_mfma_f32_16x16x32_bf16 v[112:115], v[60:63], a[192:195], 0
    ds_read_b128 v[60:63], v136 offset:0
    v_cvt_pk_f16_f32 v143, v94, v95
    v_mfma_f32_16x16x32_bf16 v[112:115], v[40:43], a[196:199], v[112:115]
    s_nop 0
    ds_read_b128 v[40:43], v133 offset:3072
    v_cvt_pk_f16_f32 v50, v116, v117
    v_mfma_f32_16x16x32_bf16 v[112:115], v[64:67], a[200:203], v[112:115]
    s_add_u32 m0, s67, 1024
    ds_read_b128 v[64:67], v137 offset:128
    v_cvt_pk_f16_f32 v51, v118, v119
    v_mfma_f32_16x16x32_bf16 v[112:115], v[44:47], a[204:207], v[112:115]
    s_waitcnt lgkmcnt(7)
    buffer_store_dwordx4 v[104:107], v128, s[28:31], s60 offen sc1
    buffer_load_dwordx4 v127, s[24:27], s56 offen nt lds
    ds_read_b128 v[44:47], v136 offset:256
    v_pk_fmac_f16 v33, v50, v50
    v_pk_fmac_f16 v33, v51, v51
    v_mfma_f32_16x16x32_bf16 v[112:115], v[52:55], a[208:211], v[112:115]
    v_pk_fmac_f16 v33, v142, v142
    v_pk_fmac_f16 v33, v143, v143
    v_mfma_f32_16x16x32_bf16 v[112:115], v[36:39], a[212:215], v[112:115]
    v_cvt_pk_bf16_f32 v24, v20, v21
    v_cvt_pk_bf16_f32 v25, v22, v23
    v_mfma_f32_16x16x32_f16 v[20:23], v[212:215], v[32:35], 0
    s_nop 0
    v_cvt_pk_bf16_f32 v160, v84, v85
    v_cvt_pk_bf16_f32 v161, v86, v87
    v_mfma_f32_16x16x32_f16 v[32:35], v[8:11], v[28:31], v[200:203]
    s_nop 0
    v_cvt_pk_bf16_f32 v156, v112, v113
    v_cvt_pk_bf16_f32 v157, v114, v115
    v_mfma_f32_16x16x32_f16 v[32:35], v[146:149], v[150:153], v[32:35]
    s_add_u32 m0, s67, 2048
    v_or3_b32 v123, v123, v20, v21
    v_mfma_f32_16x16x32_bf16 v[36:39], a[240:243], v[80:83], 0
    s_waitcnt lgkmcnt(2)
    ds_read_b128 v[52:55], v133 offset:4096
    v_mfma_f32_16x16x32_bf16 v[36:39], a[244:247], v[60:63], v[36:39]
    s_waitcnt lgkmcnt(2)
    buffer_store_dwordx4 v[108:111], v127, s[28:31], s60 offen sc1
    buffer_load_dwordx4 v126, s[24:27], s56 offen nt lds
    v_rsq_f32 v20, v20
    v_mfma_f32_16x16x32_bf16 v[36:39], a[248:251], v[64:67], v[36:39]
    v_rsq_f32 v21, v21
    v_mfma_f32_16x16x32_bf16 v[36:39], a[252:255], v[88:91], v[36:39]
    v_exp_f32 v32, v32
    v_mfma_f32_16x16x32_bf16 v[36:39], v[224:227], v[100:103], v[36:39]
    s_waitcnt lgkmcnt(1)
    v_exp_f32 v33, v33
    v_mfma_f32_16x16x32_bf16 v[36:39], v[228:231], v[44:47], v[36:39]
    v_mul_f32 v20, s52, v20
    v_cvt_pk_f16_f32 v20, v20, v21
    v_mfma_f32_16x16x32_bf16 v[92:95], a[216:219], v[80:83], 0
    v_pk_mul_f16 v56, v56, v20 op_sel:[0,0] op_sel_hi:[1,0]
    v_pk_mul_f16 v57, v57, v20 op_sel:[0,0] op_sel_hi:[1,0]
    v_mfma_f32_16x16x32_bf16 v[92:95], a[220:223], v[60:63], v[92:95]
    v_pk_mul_f16 v58, v58, v20 op_sel:[0,0] op_sel_hi:[1,0]
    v_pk_mul_f16 v59, v59, v20 op_sel:[0,0] op_sel_hi:[1,0]
    v_mfma_f32_16x16x32_bf16 v[92:95], a[224:227], v[64:67], v[92:95]
    v_pk_mul_f16 v140, v140, v20 op_sel:[0,0] op_sel_hi:[1,0]
    v_pk_mul_f16 v141, v141, v20 op_sel:[0,0] op_sel_hi:[1,0]
    v_mfma_f32_16x16x32_bf16 v[92:95], a[228:231], v[88:91], v[92:95]
    v_pk_mul_f16 v48, v48, v20 op_sel:[0,1] op_sel_hi:[1,1]
    v_pk_mul_f16 v49, v49, v20 op_sel:[0,1] op_sel_hi:[1,1]
    v_mfma_f32_16x16x32_bf16 v[92:95], a[232:235], v[100:103], v[92:95]
    v_pk_mul_f16 v50, v50, v20 op_sel:[0,1] op_sel_hi:[1,1]
    v_pk_mul_f16 v51, v51, v20 op_sel:[0,1] op_sel_hi:[1,1]
    v_mfma_f32_16x16x32_bf16 v[92:95], a[236:239], v[44:47], v[92:95]
    s_add_u32 m0, s67, 3072
    buffer_store_dwordx4 v[96:99], v126, s[28:31], s60 offen sc1
    v_pk_mul_f16 v142, v142, v20 op_sel:[0,1] op_sel_hi:[1,1]
    v_pk_mul_f16 v143, v143, v20 op_sel:[0,1] op_sel_hi:[1,1]
    v_exp_f32 v34, v34
    v_mfma_f32_16x16x32_f16 v[20:23], v[68:71], v[28:31], v[208:211]
    v_exp_f32 v35, v35
    v_mfma_f32_16x16x32_f16 v[20:23], v[76:79], v[12:15], v[20:23]
    v_cvt_pk_bf16_f32 v32, v32, v33
    v_cvt_pk_bf16_f32 v33, v34, v35
    v_mfma_f32_16x16x32_f16 v[20:23], v[72:75], v[152:155], v[20:23]
    s_nop 0
    buffer_load_dwordx4 v125, s[24:27], s56 offen nt lds
    v_mfma_f32_16x16x32_f16 v[84:87], v[48:51], v[28:31], v[196:199]
    s_add_u32 m0, s67, 4096
    s_nop 1
    v_mfma_f32_16x16x32_f16 v[84:87], v[140:143], v[150:153], v[84:87]
    s_nop 0
    v_exp_f32 v20, v20
    v_mfma_f32_16x16x32_f16 v[104:107], v[12:15], v[28:31], v[204:207]
    s_nop 0
    v_cvt_pk_bf16_f32 v170, v20, 0
    s_nop 0
    v_mfma_f32_16x16x32_f16 v[104:107], v[152:155], v[150:153], v[104:107]
    s_nop 0
    v_exp_f32 v84, v84
    v_mfma_f32_16x16x32_bf16 v[96:99], v[232:235], v[80:83], 0
    s_waitcnt lgkmcnt(0)
    buffer_store_dwordx4 v[40:43], v125, s[28:31], s60 offen sc1
    buffer_load_dwordx4 v124, s[24:27], s56 offen nt lds
    v_exp_f32 v85, v85
    v_mfma_f32_16x16x32_bf16 v[96:99], v[236:239], v[60:63], v[96:99]
    v_exp_f32 v104, v104
    v_mfma_f32_16x16x32_bf16 v[96:99], v[240:243], v[64:67], v[96:99]
    v_exp_f32 v105, v105
    v_mfma_f32_16x16x32_bf16 v[96:99], v[244:247], v[88:91], v[96:99]
    v_exp_f32 v106, v106
    v_mfma_f32_16x16x32_bf16 v[96:99], v[248:251], v[100:103], v[96:99]
    v_exp_f32 v107, v107
    v_mfma_f32_16x16x32_bf16 v[96:99], v[252:255], v[44:47], v[96:99]
    v_cvt_pk_bf16_f32 v30, v104, v105
    v_cvt_pk_bf16_f32 v31, v106, v107
    v_mfma_f32_16x16x32_f16 v[40:43], v[12:15], v[16:19], v[192:195]
    v_exp_f32 v86, v86
    v_mfma_f32_16x16x32_f16 v[40:43], v[152:155], v[144:147], v[40:43]
    v_exp_f32 v87, v87
    v_mfma_f32_16x16x32_f16 v[44:47], v[48:51], v[16:19], v[184:187]
    buffer_store_dwordx4 v[52:55], v124, s[28:31], s60 offen sc1
    v_cvt_pk_bf16_f32 v168, v84, v85
    v_cvt_pk_bf16_f32 v169, v86, v87
    s_nop 0
    v_mfma_f32_16x16x32_f16 v[44:47], v[140:143], v[144:147], v[44:47]
    s_mov_b32 s53, s47
    v_exp_f32 v40, v40
    v_mfma_f32_16x16x32_f16 v[60:63], v[48:51], v[56:59], v[172:175]
    s_mov_b32 s47, s46
    v_exp_f32 v41, v41
    v_mfma_f32_16x16x32_f16 v[60:63], v[140:143], v[138:141], v[60:63]
    s_mov_b32 s46, s45
    v_exp_f32 v42, v42
    v_mfma_f32_16x16x32_f16 v[64:67], v[68:71], v[56:59], v[208:211]
    s_mov_b32 s45, s44
    v_exp_f32 v43, v43
    v_mfma_f32_16x16x32_f16 v[64:67], v[76:79], v[48:51], v[64:67]
    s_mov_b32 s44, s53
    v_cvt_pk_bf16_f32 v20, v40, v41
    v_cvt_pk_bf16_f32 v21, v42, v43
    v_mfma_f32_16x16x32_f16 v[64:67], v[72:75], v[140:143], v[64:67]
    s_sub_u32 s48, s44, s46
    ds_read_b128 v[40:43], v136 offset:1536
    v_mfma_f32_16x16x32_f16 v[84:87], v[68:71], v[16:19], v[208:211]
    s_sub_u32 s49, s46, s45
    ds_read_b128 v[52:55], v137 offset:1792
    v_fma_f32 v28, v92, v92, s42
    v_mfma_f32_16x16x32_f16 v[84:87], v[76:79], v[8:11], v[84:87]
    s_cmp_lg_u32 s5, -1
    ds_read_b128 v[80:83], v137 offset:1664
    v_fmac_f32 v28, v93, v93
    v_mfma_f32_16x16x32_f16 v[84:87], v[72:75], v[146:149], v[84:87]
    s_nop 0
    v_exp_f32 v44, v44
    v_mfma_f32_16x16x32_bf16 v[68:71], v[220:223], v[30:33], 0
    s_nop 0
    v_exp_f32 v45, v45
    v_mfma_f32_16x16x32_bf16 v[68:71], v[220:223], v[168:171], v[68:71]
    s_nop 0
    ds_read_b128 v[76:79], v137 offset:1536
    v_mov_b32_dpp v23, v87 quad_perm:[0,1,2,3] row_mask:0x2 bank_mask:0xf
    v_mfma_f32_16x16x32_bf16 v[104:107], v[0:3], v[30:33], 0
    ds_read_b128 v[86:89], v136 offset:1664
    v_mov_b32_dpp v23, v67 quad_perm:[0,1,2,3] row_mask:0x4 bank_mask:0xf
    v_mfma_f32_16x16x32_bf16 v[104:107], v[164:167], v[168:171], v[104:107]
    v_exp_f32 v46, v46
    v_mfma_f32_16x16x32_bf16 v[72:75], v[24:27], v[30:33], 0
    v_exp_f32 v47, v47
    v_mfma_f32_16x16x32_bf16 v[72:75], v[160:163], v[168:171], v[72:75]
    v_exp_f32 v85, v85
    v_mfma_f32_16x16x32_bf16 v[116:119], v[4:7], v[30:33], 0
    ds_read_b128 v[30:33], v136 offset:1792
    v_fmac_f32 v28, v94, v94
    v_mfma_f32_16x16x32_bf16 v[116:119], v[156:159], v[168:171], v[116:119]
    v_exp_f32 v23, v23
    v_mfma_f32_16x16x32_f16 v[108:111], v[12:15], v[56:59], v[180:183]
    v_cvt_pk_bf16_f32 v23, v23, v23
    v_cvt_pk_bf16_f32 v168, v44, v45
    v_mfma_f32_16x16x32_f16 v[108:111], v[152:155], v[138:141], v[108:111]
    v_rcp_f32 v68, v68
    v_mfma_f32_16x16x32_f16 v[152:155], v[8:11], v[56:59], v[176:179]
    ds_write_b16 v131, v23 offset:64
    v_mfma_f32_16x16x32_f16 v[152:155], v[146:149], v[138:141], v[152:155]
    s_waitcnt lgkmcnt(2)
    v_mul_f32 v104, v104, v68
    v_mul_f32 v105, v105, v68
    v_mfma_f32_16x16x32_bf16 v[56:59], a[216:219], v[76:79], 0
    v_cvt_pk_bf16_f32 v12, v104, v105
    v_mul_f32 v106, v106, v68
    v_mfma_f32_16x16x32_bf16 v[56:59], a[220:223], v[40:43], v[56:59]
    ds_read_b128 v[100:103], v132 offset:48
    v_mul_f32 v107, v107, v68
    v_mfma_f32_16x16x32_bf16 v[56:59], a[224:227], v[80:83], v[56:59]
    ds_read_b128 v[140:143], v132 offset:64
    v_cvt_pk_bf16_f32 v13, v106, v107
    v_mfma_f32_16x16x32_bf16 v[56:59], a[228:231], v[86:89], v[56:59]
    v_mul_f32 v72, v72, v68
    v_mul_f32 v73, v73, v68
    v_mfma_f32_16x16x32_bf16 v[56:59], a[232:235], v[52:55], v[56:59]
    s_waitcnt lgkmcnt(3)
    v_cvt_pk_bf16_f32 v14, v72, v73
    v_mul_f32 v74, v74, v68
    v_mfma_f32_16x16x32_bf16 v[56:59], a[236:239], v[30:33], v[56:59]
    v_mul_f32 v75, v75, v68
    v_cvt_pk_bf16_f32 v15, v74, v75
    v_mfma_f32_16x16x32_bf16 v[104:107], v[232:235], v[76:79], 0
    ds_write_b64 v135, v[12:13] offset:0
    v_mfma_f32_16x16x32_bf16 v[104:107], v[236:239], v[40:43], v[104:107]
    v_mul_f32 v116, v116, v68
    v_mul_f32 v117, v117, v68
    v_mfma_f32_16x16x32_bf16 v[104:107], v[240:243], v[80:83], v[104:107]
    v_cvt_pk_bf16_f32 v22, v116, v117
    v_mul_f32 v118, v118, v68
    v_mfma_f32_16x16x32_bf16 v[104:107], v[244:247], v[86:89], v[104:107]
    ds_read_b128 v[72:75], v137 offset:3200
    v_mul_f32 v119, v119, v68
    v_mfma_f32_16x16x32_bf16 v[104:107], v[248:251], v[52:55], v[104:107]
    v_cvt_pk_bf16_f32 v23, v118, v119
    v_cvt_pk_bf16_f32 v169, v46, v47
    v_mfma_f32_16x16x32_bf16 v[104:107], v[252:255], v[30:33], v[104:107]
    s_waitcnt lgkmcnt(2)
    v_cvt_pk_bf16_f32 v170, v85, 0
    v_fmac_f32 v28, v95, v95
    v_mfma_f32_16x16x32_bf16 v[44:47], v[100:103], v[0:3], 0
    v_exp_f32 v60, v60
    v_mfma_f32_16x16x32_bf16 v[44:47], v[140:143], v[164:167], v[44:47]
    ds_write_b64 v135, v[14:15] offset:8
    v_mfma_f32_16x16x32_bf16 v[12:15], v[100:103], v[24:27], 0
    v_exp_f32 v61, v61
    v_mfma_f32_16x16x32_bf16 v[12:15], v[140:143], v[160:163], v[12:15]
    v_exp_f32 v62, v62
    v_mfma_f32_16x16x32_bf16 v[68:71], v[100:103], v[4:7], 0
    s_nop 0
    ds_read_b128 v[116:119], v137 offset:3072
    v_fmac_f32 v28, v36, v36
    v_mfma_f32_16x16x32_bf16 v[68:71], v[140:143], v[156:159], v[68:71]
    s_nop 0
    ds_read_b128 v[100:103], v136 offset:3072
    v_mov_b32_dpp v47, v15 quad_perm:[0,1,2,3] row_mask:0x2 bank_mask:0xf
    v_mfma_f32_16x16x32_bf16 v[140:143], a[240:243], v[76:79], 0
    ds_read_b128 v[12:15], v136 offset:3200
    v_fmac_f32 v28, v37, v37
    v_mfma_f32_16x16x32_bf16 v[140:143], a[244:247], v[40:43], v[140:143]
    ds_read_b128 v[40:43], v137 offset:3328
    v_mov_b32_dpp v47, v71 quad_perm:[0,1,2,3] row_mask:0x4 bank_mask:0xf
    v_mfma_f32_16x16x32_bf16 v[140:143], a[248:251], v[80:83], v[140:143]
    ds_read_b128 v[80:83], v136 offset:3328
    v_cvt_pk_bf16_f32 v47, v47, v47
    v_mfma_f32_16x16x32_bf16 v[140:143], a[252:255], v[86:89], v[140:143]
    v_exp_f32 v63, v63
    v_mfma_f32_16x16x32_bf16 v[140:143], v[224:227], v[52:55], v[140:143]
    v_exp_f32 v66, v66
    v_mfma_f32_16x16x32_bf16 v[140:143], v[228:231], v[30:33], v[140:143]
    v_exp_f32 v152, v152
    v_mfma_f32_16x16x32_f16 v[30:33], v[8:11], v[16:19], v[188:191]
    ds_write_b32 v134, v22 offset:0
    v_mfma_f32_16x16x32_f16 v[30:33], v[146:149], v[144:147], v[30:33]
    s_waitcnt lgkmcnt(5)
    v_exp_f32 v153, v153
    v_mfma_f32_16x16x32_bf16 v[84:87], a[240:243], v[116:119], 0
    s_waitcnt lgkmcnt(4)
    v_exp_f32 v154, v154
    v_mfma_f32_16x16x32_bf16 v[84:87], a[244:247], v[100:103], v[84:87]
    v_exp_f32 v155, v155
    v_mfma_f32_16x16x32_bf16 v[84:87], a[248:251], v[72:75], v[84:87]
    s_waitcnt lgkmcnt(2)
    ds_write_b32 v134, v23 offset:4
    v_mfma_f32_16x16x32_bf16 v[84:87], a[252:255], v[12:15], v[84:87]
    v_cvt_pk_bf16_f32 v34, v152, v153
    v_cvt_pk_bf16_f32 v35, v154, v155
    v_mfma_f32_16x16x32_bf16 v[84:87], v[224:227], v[40:43], v[84:87]
    s_waitcnt lgkmcnt(2)
    v_exp_f32 v30, v30
    v_mfma_f32_16x16x32_bf16 v[84:87], v[228:231], v[80:83], v[84:87]
    v_exp_f32 v31, v31
    v_mfma_f32_16x16x32_bf16 v[52:55], a[216:219], v[116:119], 0
    ds_write_b16 v131, v47
    v_mfma_f32_16x16x32_bf16 v[52:55], a[220:223], v[100:103], v[52:55]
    v_exp_f32 v32, v32
    v_mfma_f32_16x16x32_bf16 v[52:55], a[224:227], v[72:75], v[52:55]
    v_exp_f32 v33, v33
    v_mfma_f32_16x16x32_bf16 v[52:55], a[228:231], v[12:15], v[52:55]
    v_cvt_pk_bf16_f32 v22, v30, v31
    v_cvt_pk_bf16_f32 v23, v32, v33
    v_mfma_f32_16x16x32_bf16 v[52:55], a[232:235], v[40:43], v[52:55]
    v_exp_f32 v108, v108
    v_mfma_f32_16x16x32_bf16 v[52:55], a[236:239], v[80:83], v[52:55]
    v_exp_f32 v109, v109
    v_mfma_f32_16x16x32_bf16 v[152:155], v[220:223], v[20:23], 0
    v_exp_f32 v110, v110
    v_mfma_f32_16x16x32_bf16 v[152:155], v[220:223], v[168:171], v[152:155]
    s_nop 0
    v_exp_f32 v111, v111
    v_mfma_f32_16x16x32_bf16 v[8:11], v[0:3], v[20:23], 0
    s_nop 0
    v_cvt_pk_bf16_f32 v32, v108, v109
    v_cvt_pk_bf16_f32 v33, v110, v111
    v_mfma_f32_16x16x32_bf16 v[8:11], v[164:167], v[168:171], v[8:11]
    s_nop 0
    v_rcp_f32 v152, v152
    v_mfma_f32_16x16x32_bf16 v[44:47], v[24:27], v[20:23], 0
    v_add_u32 v137, s48, v137
    v_add_u32 v136, s48, v136
    v_mfma_f32_16x16x32_bf16 v[44:47], v[160:163], v[168:171], v[44:47]
    s_nop 0
    ds_read_b128 v[146:149], v137 offset:0
    v_mul_f32 v8, v8, v152
    v_mfma_f32_16x16x32_bf16 v[16:19], v[4:7], v[20:23], 0
    ds_read_b128 v[88:91], v136 offset:0
    v_mul_f32 v9, v9, v152
    v_mfma_f32_16x16x32_bf16 v[16:19], v[156:159], v[168:171], v[16:19]
    ds_read_b128 v[108:111], v137 offset:128
    v_cvt_pk_bf16_f32 v168, v60, v61
    v_mfma_f32_16x16x32_bf16 v[48:51], v[232:235], v[116:119], 0
    ds_read_b128 v[116:119], v136 offset:128
    v_cvt_pk_bf16_f32 v169, v62, v63
    v_mfma_f32_16x16x32_bf16 v[48:51], v[236:239], v[100:103], v[48:51]
    ds_read_b128 v[60:63], v137 offset:256
    v_cvt_pk_bf16_f32 v170, v66, 0
    v_mfma_f32_16x16x32_bf16 v[48:51], v[240:243], v[72:75], v[48:51]
    ds_read_b128 v[64:67], v136 offset:256
    v_cvt_pk_bf16_f32 v20, v8, v9
    v_mfma_f32_16x16x32_bf16 v[48:51], v[244:247], v[12:15], v[48:51]
    v_mul_f32 v10, v10, v152
    v_mul_f32 v11, v11, v152
    v_mfma_f32_16x16x32_bf16 v[48:51], v[248:251], v[40:43], v[48:51]
    ds_read_b128 v[100:103], v136 offset:1536
    v_cvt_pk_bf16_f32 v21, v10, v11
    v_mfma_f32_16x16x32_bf16 v[48:51], v[252:255], v[80:83], v[48:51]
    ds_read_b128 v[80:83], v137 offset:1664
    v_mul_f32 v44, v44, v152
    v_mfma_f32_16x16x32_bf16 v[12:15], v[220:223], v[32:35], 0
    ds_read_b128 v[68:71], v137 offset:1536
    v_mul_f32 v45, v45, v152
    v_mfma_f32_16x16x32_bf16 v[12:15], v[220:223], v[168:171], v[12:15]
    ds_read_b128 v[76:79], v136 offset:1792
    v_cvt_pk_bf16_f32 v22, v44, v45
    v_mfma_f32_16x16x32_bf16 v[72:75], v[0:3], v[32:35], 0
    v_mul_f32 v46, v46, v152
    v_mul_f32 v47, v47, v152
    v_mfma_f32_16x16x32_bf16 v[72:75], v[164:167], v[168:171], v[72:75]
    v_cvt_pk_bf16_f32 v23, v46, v47
    v_mul_f32 v16, v16, v152
    v_mfma_f32_16x16x32_bf16 v[0:3], v[24:27], v[32:35], 0
    v_mul_f32 v17, v17, v152
    v_cvt_pk_bf16_f32 v154, v16, v17
    v_mfma_f32_16x16x32_bf16 v[0:3], v[160:163], v[168:171], v[0:3]
    ds_write_b32 v135, v20 offset:1536
    v_mfma_f32_16x16x32_bf16 v[8:11], v[4:7], v[32:35], 0
    v_mul_f32 v18, v18, v152
    v_mul_f32 v19, v19, v152
    v_mfma_f32_16x16x32_bf16 v[8:11], v[156:159], v[168:171], v[8:11]
    s_waitcnt lgkmcnt(4)
    v_cvt_pk_bf16_f32 v155, v18, v19
    v_fmac_f32 v28, v38, v38
    v_mfma_f32_16x16x32_bf16 v[30:33], a[0:3], v[146:149], 0
    s_cbranch_scc1 L_loopF0
L_tailF:
    ds_write_b32 v135, v21 offset:1540
    v_rcp_f32 v12, v12
    s_mov_b32 s30, 100270464
    s_mul_i32 s89, s68, 7168
    ds_write_b64 v135, v[22:23] offset:1544
    v_mul_f32 v72, v72, v12
    v_mul_f32 v73, v73, v12
    v_cvt_pk_bf16_f32 v4, v72, v73
    s_add_u32 s89, s89, 135168
    s_movk_i32 s90, 112
    ds_write_b64 v134, v[154:155] offset:1536
    v_mul_f32 v74, v74, v12
    v_mul_f32 v75, v75, v12
    v_cvt_pk_bf16_f32 v5, v74, v75
    v_mul_f32 v0, v0, v12
    v_mul_f32 v1, v1, v12
    v_cvt_pk_bf16_f32 v6, v0, v1
    v_mul_f32 v2, v2, v12
    v_mul_f32 v3, v3, v12
    v_cvt_pk_bf16_f32 v7, v2, v3
    v_mul_f32 v8, v8, v12
    v_mul_f32 v9, v9, v12
    v_cvt_pk_bf16_f32 v8, v8, v9
    v_mul_f32 v10, v10, v12
    v_mul_f32 v11, v11, v12
    v_cvt_pk_bf16_f32 v9, v10, v11
    s_lshr_b32 s91, s64, 16
    s_lshl_b32 s92, s68, 10
    ds_write_b64 v135, v[4:5] offset:3072
    v_fmac_f32 v28, v39, v39
    s_sub_u32 s84, s45, s44
    s_sub_u32 s85, s46, s45
    ds_write_b64 v135, v[6:7] offset:3080
    v_fmac_f32 v28, v96, v96
    v_fmac_f32 v28, v97, v97
    v_fmac_f32 v28, v98, v98
    s_sub_u32 s86, s44, s45
    s_sub_u32 s93, s44, s47
    ds_write_b32 v134, v8 offset:3072
    ds_write_b32 v134, v9 offset:3076
    v_fmac_f32 v28, v99, v99
    v_fma_f32 v131, v56, v56, s42
    v_fmac_f32 v131, v57, v57
    v_fmac_f32 v131, v58, v58
    v_fmac_f32 v131, v59, v59
    v_fmac_f32 v131, v140, v140
    v_fmac_f32 v131, v141, v141
    v_fmac_f32 v131, v142, v142
    v_fmac_f32 v131, v143, v143
    v_fmac_f32 v131, v104, v104
    v_fmac_f32 v131, v105, v105
    v_fmac_f32 v131, v106, v106
    v_fmac_f32 v131, v107, v107
    v_fma_f32 v121, v52, v52, s42
    v_fmac_f32 v121, v53, v53
    v_fmac_f32 v121, v54, v54
    v_fmac_f32 v121, v55, v55
    v_fmac_f32 v121, v84, v84
    v_fmac_f32 v121, v85, v85
    v_fmac_f32 v121, v86, v86
    v_fmac_f32 v121, v87, v87
    v_fmac_f32 v121, v48, v48
    v_fmac_f32 v121, v49, v49
    v_fmac_f32 v121, v50, v50
    v_fmac_f32 v121, v51, v51
    v_cvt_pk_bf16_f32 v120, v28, v131
    v_cvt_pk_bf16_f32 v121, v121, v122
    s_sub_u32 s94, s45, s47
    s_sub_u32 s95, s46, s47
    ds_write_b64 v130, v[120:121]
    v_mbcnt_lo_u32_b32 v131, -1, 0
    v_mbcnt_hi_u32_b32 v131, -1, v131
    v_and_b32 v120, 15, v131
    v_lshrrev_b32 v131, 4, v131
    v_mul_u32_u24 v131, 1792, v131
    v_add_u32 v131, s89, v131
    v_mad_u32_u24 v132, v120, s90, v131
    v_lshrrev_b32 v121, v120, s64
    v_and_b32 v121, 1, v121
    v_cmp_eq_u32 vcc, 1, v121
    v_mad_u32_u24 v122, v120, s90, v131
    v_lshrrev_b32 v120, v120, s91
    v_cndmask_b32 v132, v131, v132, vcc
    v_and_b32 v120, 1, v120
    v_subrev_u32 v122, 28672, v122
    v_cmp_eq_u32 vcc, 1, v120
    ds_read_b128 v[20:23], v132 offset:64
    ds_read_b128 v[16:19], v132 offset:80
    v_cndmask_b32 v122, v131, v122, vcc
    v_add_u32 v131, s92, v129
    s_waitcnt lgkmcnt(2)
    s_barrier
    ds_read_b128 v[114:117], v132
    v_add_u32 v29, s84, v137
    ds_read_b64 v[118:119], v132 offset:16
    ds_read_b128 v[4:7], v131 offset:6144
    v_add_u32 v28, s84, v136
    v_add_u32 v121, s85, v135
    ds_read_b128 v[8:11], v129 offset:0
    v_add_u32 v120, s85, v134
    ds_read_b128 v[0:3], v129 offset:1024
    v_add_u32 v138, s86, v135
    v_add_u32 v132, s86, v134
    v_add_u32 v131, s93, v133
    v_add_u32 v139, s94, v133
    s_waitcnt lgkmcnt(6)
    v_mfma_f32_16x16x32_bf16 v[12:15], v[220:223], v[20:23], 0
    s_waitcnt lgkmcnt(5)
    ds_read_b128 v[76:79], v29 offset:1536
    ds_read_b128 v[72:75], v28 offset:1536
    v_mfma_f32_16x16x32_bf16 v[12:15], v[220:223], v[16:19], v[12:15]
    s_waitcnt lgkmcnt(3)
    ds_read_b128 v[68:71], v29 offset:1664
    v_lshlrev_b32 v80, 16, v114
    v_and_b32 v114, 0xffff0000, v114
    v_lshlrev_b32 v81, 16, v115
    v_and_b32 v115, 0xffff0000, v115
    v_lshlrev_b32 v82, 16, v116
    v_and_b32 v116, 0xffff0000, v116
    v_rcp_f32 v12, v12
    v_lshlrev_b32 v83, 16, v117
    v_mfma_f32_16x16x32_bf16 v[16:19], v[216:219], v[8:11], 0
    s_waitcnt lgkmcnt(3)
    ds_read_b128 v[64:67], v28 offset:1664
    ds_read_b128 v[44:47], v29 offset:1792
    v_mfma_f32_16x16x32_bf16 v[16:19], v[216:219], v[0:3], v[16:19]
    s_waitcnt lgkmcnt(4)
    ds_read_b128 v[40:43], v28 offset:1792
    v_mul_f32 v80, v80, v12
    v_mul_f32 v114, v114, v12
    v_cvt_pk_bf16_f32 v80, v80, v114
    v_mul_f32 v81, v81, v12
    v_mfma_f32_16x16x32_bf16 v[8:11], a[216:219], v[76:79], 0
    s_waitcnt lgkmcnt(4)
    v_mul_f32 v115, v115, v12
    v_cvt_pk_bf16_f32 v81, v81, v115
    v_mfma_f32_16x16x32_bf16 v[8:11], a[220:223], v[72:75], v[8:11]
    s_waitcnt lgkmcnt(3)
    ds_read_b128 v[112:115], v29 offset:0
    ds_read_b128 v[108:111], v28 offset:0
    v_mfma_f32_16x16x32_bf16 v[8:11], a[224:227], v[68:71], v[8:11]
    s_waitcnt lgkmcnt(4)
    ds_read_b128 v[60:63], v29 offset:128
    v_mul_f32 v82, v82, v12
    v_mul_f32 v116, v116, v12
    v_cvt_pk_bf16_f32 v82, v82, v116
    v_and_b32 v117, 0xffff0000, v117
    v_mul_f32 v83, v83, v12
    v_mfma_f32_16x16x32_bf16 v[8:11], a[228:231], v[64:67], v[8:11]
    s_waitcnt lgkmcnt(4)
    ds_read_b128 v[32:35], v28 offset:128
    ds_read_b128 v[20:23], v29 offset:256
    v_mfma_f32_16x16x32_bf16 v[8:11], a[232:235], v[44:47], v[8:11]
    s_waitcnt lgkmcnt(5)
    ds_read_b128 v[0:3], v28 offset:256
    v_mul_f32 v117, v117, v12
    v_mfma_f32_16x16x32_bf16 v[8:11], a[236:239], v[40:43], v[8:11]
    v_cvt_pk_bf16_f32 v83, v83, v117
    v_lshlrev_b32 v19, 16, v118
    v_mfma_f32_16x16x32_bf16 v[24:27], a[240:243], v[76:79], 0
    ds_write_b128 v138, v[80:83] offset:0
    v_mfma_f32_16x16x32_bf16 v[24:27], a[244:247], v[72:75], v[24:27]
    v_and_b32 v118, 0xffff0000, v118
    v_mul_f32 v19, v19, v12
    v_mfma_f32_16x16x32_bf16 v[24:27], a[248:251], v[68:71], v[24:27]
    v_mul_f32 v118, v118, v12
    v_cvt_pk_bf16_f32 v30, v19, v118
    v_mfma_f32_16x16x32_bf16 v[24:27], a[252:255], v[64:67], v[24:27]
    v_lshlrev_b32 v19, 16, v119
    v_and_b32 v119, 0xffff0000, v119
    v_mfma_f32_16x16x32_bf16 v[24:27], v[224:227], v[44:47], v[24:27]
    v_mul_f32 v19, v19, v12
    v_mul_f32 v119, v119, v12
    v_mfma_f32_16x16x32_bf16 v[24:27], v[228:231], v[40:43], v[24:27]
    v_cvt_pk_bf16_f32 v31, v19, v119
    v_lshrrev_b32 v19, 0, v7
    v_mfma_f32_16x16x32_bf16 v[12:15], v[232:235], v[76:79], 0
    ds_write_b64 v132, v[30:31] offset:0
    v_mfma_f32_16x16x32_bf16 v[12:15], v[236:239], v[72:75], v[12:15]
    v_lshrrev_b32 v19, v19, s64
    v_and_b32 v19, 1, v19
    v_mfma_f32_16x16x32_bf16 v[12:15], v[240:243], v[68:71], v[12:15]
    v_cmp_eq_u32 vcc, 1, v19
    v_lshrrev_b32 v19, 8, v7
    v_mfma_f32_16x16x32_bf16 v[12:15], v[244:247], v[64:67], v[12:15]
    v_cndmask_b32 v4, 2.0, v4, vcc
    v_lshrrev_b32 v19, v19, s64
    v_mfma_f32_16x16x32_bf16 v[12:15], v[248:251], v[44:47], v[12:15]
    v_and_b32 v19, 1, v19
    v_cmp_eq_u32 vcc, 1, v19
    v_mfma_f32_16x16x32_bf16 v[12:15], v[252:255], v[40:43], v[12:15]
    s_waitcnt lgkmcnt(1)
    v_cndmask_b32 v5, 2.0, v5, vcc
    v_lshrrev_b32 v7, 16, v7
    v_mfma_f32_16x16x32_bf16 v[68:71], a[216:219], v[112:115], 0
    v_lshrrev_b32 v7, v7, s64
    v_and_b32 v7, 1, v7
    v_mfma_f32_16x16x32_bf16 v[68:71], a[220:223], v[108:111], v[68:71]
    ds_read_b128 v[100:103], v29 offset:3072
    ds_read_b128 v[88:91], v28 offset:3072
    v_mfma_f32_16x16x32_bf16 v[68:71], a[224:227], v[60:63], v[68:71]
    ds_read_b128 v[80:83], v29 offset:3200
    v_cmp_eq_u32 vcc, 1, v7
    v_mfma_f32_16x16x32_bf16 v[68:71], a[228:231], v[32:35], v[68:71]
    ds_read_b128 v[76:79], v28 offset:3200
    v_cndmask_b32 v6, 2.0, v6, vcc
    v_mfma_f32_16x16x32_bf16 v[68:71], a[232:235], v[20:23], v[68:71]
    ds_read_b128 v[64:67], v29 offset:3328
    v_add_u32 v7, s95, v133
    v_mfma_f32_16x16x32_bf16 v[68:71], a[236:239], v[0:3], v[68:71]
    ds_read_b128 v[28:31], v28 offset:3328
    v_fma_f32 v133, v8, v8, s42
    v_mfma_f32_16x16x32_bf16 v[44:47], a[240:243], v[112:115], 0
    v_rsq_f32 v16, v16
    v_mfma_f32_16x16x32_bf16 v[44:47], a[244:247], v[108:111], v[44:47]
    v_mul_f32 v16, s43, v16
    v_mul_f32 v92, v92, v16
    v_mfma_f32_16x16x32_bf16 v[44:47], a[248:251], v[60:63], v[44:47]
    v_mul_f32 v93, v93, v16
    v_cvt_pk_bf16_f32 v72, v92, v93
    v_mfma_f32_16x16x32_bf16 v[44:47], a[252:255], v[32:35], v[44:47]
    v_mul_f32 v94, v94, v16
    v_mul_f32 v95, v95, v16
    v_mfma_f32_16x16x32_bf16 v[44:47], v[224:227], v[20:23], v[44:47]
    v_cvt_pk_bf16_f32 v73, v94, v95
    v_mul_f32 v36, v36, v16
    v_mfma_f32_16x16x32_bf16 v[44:47], v[228:231], v[0:3], v[44:47]
    v_mul_f32 v37, v37, v16
    v_cvt_pk_bf16_f32 v74, v36, v37
    v_mfma_f32_16x16x32_bf16 v[40:43], v[232:235], v[112:115], 0
    v_mul_f32 v38, v38, v16
    v_mul_f32 v39, v39, v16
    v_mfma_f32_16x16x32_bf16 v[40:43], v[236:239], v[108:111], v[40:43]
    v_cvt_pk_bf16_f32 v75, v38, v39
    v_mul_f32 v96, v96, v16
    v_mfma_f32_16x16x32_bf16 v[40:43], v[240:243], v[60:63], v[40:43]
    ds_write_b128 v121, v[72:75] offset:0
    v_mfma_f32_16x16x32_bf16 v[40:43], v[244:247], v[32:35], v[40:43]
    v_mul_f32 v97, v97, v16
    v_cvt_pk_bf16_f32 v96, v96, v97
    v_mfma_f32_16x16x32_bf16 v[40:43], v[248:251], v[20:23], v[40:43]
    v_mul_f32 v98, v98, v16
    v_mul_f32 v99, v99, v16
    v_mfma_f32_16x16x32_bf16 v[40:43], v[252:255], v[0:3], v[40:43]
    s_waitcnt lgkmcnt(1)
    v_cvt_pk_bf16_f32 v97, v98, v99
    v_fma_f32 v38, v68, v68, s42
    v_mfma_f32_16x16x32_bf16 v[20:23], a[216:219], v[100:103], 0
    ds_write_b64 v120, v[96:97] offset:0
    v_mfma_f32_16x16x32_bf16 v[20:23], a[220:223], v[88:91], v[20:23]
    ds_read_b128 v[60:63], v122 offset:64
    v_fmac_f32 v38, v69, v69
    v_mfma_f32_16x16x32_bf16 v[20:23], a[224:227], v[80:83], v[20:23]
    ds_read_b128 v[0:3], v122 offset:80
    v_fmac_f32 v38, v70, v70
    v_mfma_f32_16x16x32_bf16 v[20:23], a[228:231], v[76:79], v[20:23]
    ds_read_b128 v[32:35], v122
    v_fmac_f32 v38, v71, v71
    v_mfma_f32_16x16x32_bf16 v[20:23], a[232:235], v[64:67], v[20:23]
    ds_read_b64 v[36:37], v122 offset:16
    v_fmac_f32 v38, v44, v44
    v_mfma_f32_16x16x32_bf16 v[20:23], a[236:239], v[28:31], v[20:23]
    v_rsq_f32 v17, v17
    v_mfma_f32_16x16x32_bf16 v[96:99], a[240:243], v[100:103], 0
    v_mul_f32 v17, s43, v17
    v_mul_f32 v56, v56, v17
    v_mfma_f32_16x16x32_bf16 v[96:99], a[244:247], v[88:91], v[96:99]
    v_mul_f32 v57, v57, v17
    v_cvt_pk_bf16_f32 v56, v56, v57
    v_mfma_f32_16x16x32_bf16 v[96:99], a[248:251], v[80:83], v[96:99]
    v_mul_f32 v58, v58, v17
    v_mul_f32 v59, v59, v17
    v_mfma_f32_16x16x32_bf16 v[96:99], a[252:255], v[76:79], v[96:99]
    v_cvt_pk_bf16_f32 v57, v58, v59
    v_mul_f32 v140, v140, v17
    v_mfma_f32_16x16x32_bf16 v[96:99], v[224:227], v[64:67], v[96:99]
    v_mul_f32 v141, v141, v17
    v_cvt_pk_bf16_f32 v58, v140, v141
    v_mfma_f32_16x16x32_bf16 v[96:99], v[228:231], v[28:31], v[96:99]
    v_mul_f32 v142, v142, v17
    v_mul_f32 v143, v143, v17
    v_mfma_f32_16x16x32_bf16 v[72:75], v[232:235], v[100:103], 0
    v_cvt_pk_bf16_f32 v59, v142, v143
    v_mul_f32 v104, v104, v17
    v_mfma_f32_16x16x32_bf16 v[72:75], v[236:239], v[88:91], v[72:75]
    ds_write_b128 v121, v[56:59] offset:1536
    v_mfma_f32_16x16x32_bf16 v[72:75], v[240:243], v[80:83], v[72:75]
    v_mul_f32 v105, v105, v17
    v_cvt_pk_bf16_f32 v104, v104, v105
    v_mfma_f32_16x16x32_bf16 v[72:75], v[244:247], v[76:79], v[72:75]
    v_mul_f32 v106, v106, v17
    v_mul_f32 v107, v107, v17
    v_mfma_f32_16x16x32_bf16 v[72:75], v[248:251], v[64:67], v[72:75]
    v_cvt_pk_bf16_f32 v105, v106, v107
    v_fmac_f32 v38, v45, v45
    v_mfma_f32_16x16x32_bf16 v[72:75], v[252:255], v[28:31], v[72:75]
    s_waitcnt lgkmcnt(1)
    ds_write_b64 v120, v[104:105] offset:1536
    v_mfma_f32_16x16x32_bf16 v[28:31], v[220:223], v[60:63], 0
    v_rsq_f32 v18, v18
    v_mfma_f32_16x16x32_bf16 v[28:31], v[220:223], v[0:3], v[28:31]
    v_mul_f32 v18, s43, v18
    v_mul_f32 v52, v52, v18
    v_mul_f32 v53, v53, v18
    v_cvt_pk_bf16_f32 v0, v52, v53
    v_mul_f32 v54, v54, v18
    v_mul_f32 v55, v55, v18
    v_cvt_pk_bf16_f32 v1, v54, v55
    v_mul_f32 v84, v84, v18
    v_mul_f32 v85, v85, v18
    v_cvt_pk_bf16_f32 v2, v84, v85
    v_mul_f32 v86, v86, v18
    v_mul_f32 v87, v87, v18
    v_cvt_pk_bf16_f32 v3, v86, v87
    v_mul_f32 v48, v48, v18
    v_mul_f32 v49, v49, v18
    v_cvt_pk_bf16_f32 v48, v48, v49
    v_mul_f32 v50, v50, v18
    v_mul_f32 v51, v51, v18
    v_cvt_pk_bf16_f32 v49, v50, v51
    ds_write_b128 v121, v[0:3] offset:3072
    v_fmac_f32 v38, v46, v46
    v_fmac_f32 v38, v47, v47
    v_fmac_f32 v38, v40, v40
    v_fmac_f32 v38, v41, v41
    ds_write_b64 v120, v[48:49] offset:3072
    v_fmac_f32 v38, v42, v42
    v_fmac_f32 v38, v43, v43
    v_fmac_f32 v133, v9, v9
    v_fmac_f32 v133, v10, v10
    v_fmac_f32 v133, v11, v11
    v_fmac_f32 v133, v24, v24
    v_fmac_f32 v133, v25, v25
    v_fmac_f32 v133, v26, v26
    v_fmac_f32 v133, v27, v27
    v_fmac_f32 v133, v12, v12
    v_fmac_f32 v133, v13, v13
    v_fmac_f32 v133, v14, v14
    v_fmac_f32 v133, v15, v15
    v_cvt_pk_bf16_f32 v38, v38, v133
    v_fma_f32 v133, v20, v20, s42
    v_fmac_f32 v133, v21, v21
    v_fmac_f32 v133, v22, v22
    v_fmac_f32 v133, v23, v23
    v_fmac_f32 v133, v96, v96
    v_fmac_f32 v133, v97, v97
    v_fmac_f32 v133, v98, v98
    v_fmac_f32 v133, v99, v99
    v_fmac_f32 v133, v72, v72
    v_fmac_f32 v133, v73, v73
    v_fmac_f32 v133, v74, v74
    v_fmac_f32 v133, v75, v75
    v_cvt_pk_bf16_f32 v39, v133, v133
    ds_write_b64 v130, v[38:39] offset:2048
    v_rcp_f32 v28, v28
    v_lshlrev_b32 v133, 16, v32
    v_and_b32 v32, 0xffff0000, v32
    v_mul_f32 v133, v133, v28
    v_mul_f32 v32, v32, v28
    v_cvt_pk_bf16_f32 v16, v133, v32
    v_lshlrev_b32 v32, 16, v33
    v_and_b32 v33, 0xffff0000, v33
    v_mul_f32 v32, v32, v28
    v_mul_f32 v33, v33, v28
    v_cvt_pk_bf16_f32 v17, v32, v33
    v_lshlrev_b32 v133, 16, v34
    v_and_b32 v34, 0xffff0000, v34
    v_mul_f32 v133, v133, v28
    v_mul_f32 v34, v34, v28
    v_cvt_pk_bf16_f32 v18, v133, v34
    v_lshlrev_b32 v19, 16, v35
    v_and_b32 v35, 0xffff0000, v35
    v_mul_f32 v19, v19, v28
    v_mul_f32 v35, v35, v28
    v_cvt_pk_bf16_f32 v19, v19, v35
    v_lshlrev_b32 v133, 16, v36
    v_and_b32 v36, 0xffff0000, v36
    v_mul_f32 v133, v133, v28
    v_mul_f32 v36, v36, v28
    v_cvt_pk_bf16_f32 v0, v133, v36
    v_lshlrev_b32 v133, 16, v37
    v_and_b32 v37, 0xffff0000, v37
    v_mul_f32 v133, v133, v28
    v_mul_f32 v37, v37, v28
    v_cvt_pk_bf16_f32 v1, v133, v37
    s_waitcnt lgkmcnt(0)
    s_barrier
    ds_write_b128 v138, v[16:19] offset:1536
    v_and_b32 v123, 0xb8000000, v123
    v_mov_b32 v121, 0x3f803f80
    v_cmp_ne_u32 vcc, 0, v123
    s_nop 0
    ds_write_b64 v132, v[0:1] offset:1536
    v_cndmask_b32 v121, 0, v121, vcc
    ds_read_b128 v[36:39], v7 offset:0
    ds_read_b128 v[0:3], v7 offset:1024
    ds_read_b128 v[28:31], v7 offset:2048
    ds_read_b128 v[108:111], v7 offset:3072
    ds_read_b128 v[80:83], v7 offset:4096
    s_waitcnt lgkmcnt(5)
    s_barrier
    s_waitcnt lgkmcnt(4)
    buffer_store_dwordx4 v[36:39], v128, s[28:31], s59 offen sc1
    ds_read_b128 v[32:35], v129 offset:2048
    ds_read_b128 v[16:19], v129 offset:3072
    ds_read_b128 v[104:107], v137 offset:1536
    ds_read_b128 v[100:103], v136 offset:1536
    ds_read_b128 v[92:95], v137 offset:1664
    ds_read_b128 v[84:87], v136 offset:1664
    ds_read_b128 v[76:79], v137 offset:1792
    s_waitcnt lgkmcnt(9)
    buffer_store_dwordx4 v[0:3], v127, s[28:31], s59 offen sc1
    ds_read_b128 v[36:39], v136 offset:1792
    s_waitcnt lgkmcnt(7)
    v_mfma_f32_16x16x32_bf16 v[0:3], v[216:219], v[32:35], 0
    s_waitcnt lgkmcnt(6)
    v_mfma_f32_16x16x32_bf16 v[0:3], v[216:219], v[16:19], v[0:3]
    s_waitcnt lgkmcnt(5)
    v_mfma_f32_16x16x32_bf16 v[16:19], a[216:219], v[104:107], 0
    s_waitcnt lgkmcnt(4)
    v_mfma_f32_16x16x32_bf16 v[16:19], a[220:223], v[100:103], v[16:19]
    s_waitcnt lgkmcnt(3)
    ds_read_b128 v[64:67], v137 offset:0
    ds_read_b128 v[60:63], v136 offset:0
    v_mfma_f32_16x16x32_bf16 v[16:19], a[224:227], v[92:95], v[16:19]
    s_waitcnt lgkmcnt(4)
    ds_read_b128 v[56:59], v137 offset:128
    v_mfma_f32_16x16x32_bf16 v[16:19], a[228:231], v[84:87], v[16:19]
    s_waitcnt lgkmcnt(4)
    buffer_store_dwordx4 v[28:31], v126, s[28:31], s59 offen sc1
    ds_read_b128 v[52:55], v136 offset:128
    v_rsq_f32 v0, v0
    v_mfma_f32_16x16x32_bf16 v[16:19], a[232:235], v[76:79], v[16:19]
    s_waitcnt lgkmcnt(4)
    ds_read_b128 v[48:51], v137 offset:256
    ds_read_b128 v[32:35], v136 offset:256
    v_mfma_f32_16x16x32_bf16 v[16:19], a[236:239], v[36:39], v[16:19]
    v_rsq_f32 v1, v1
    v_mfma_f32_16x16x32_bf16 v[28:31], a[240:243], v[104:107], 0
    v_mul_f32 v0, s43, v0
    v_mul_f32 v1, s43, v1
    v_mfma_f32_16x16x32_bf16 v[28:31], a[244:247], v[100:103], v[28:31]
    v_rsq_f32 v2, v2
    v_mfma_f32_16x16x32_bf16 v[28:31], a[248:251], v[92:95], v[28:31]
    v_mul_f32 v2, s43, v2
    v_mul_f32 v20, v20, v2
    v_mfma_f32_16x16x32_bf16 v[28:31], a[252:255], v[84:87], v[28:31]
    buffer_store_dwordx4 v[108:111], v125, s[28:31], s59 offen sc1
    v_mul_f32 v21, v21, v2
    v_cvt_pk_bf16_f32 v88, v20, v21
    v_mul_f32 v22, v22, v2
    v_mul_f32 v23, v23, v2
    v_mfma_f32_16x16x32_bf16 v[28:31], v[224:227], v[76:79], v[28:31]
    v_cvt_pk_bf16_f32 v89, v22, v23
    v_mul_f32 v96, v96, v2
    v_mfma_f32_16x16x32_bf16 v[28:31], v[228:231], v[36:39], v[28:31]
    v_mul_f32 v97, v97, v2
    v_cvt_pk_bf16_f32 v90, v96, v97
    v_mfma_f32_16x16x32_bf16 v[20:23], v[232:235], v[104:107], 0
    v_mul_f32 v98, v98, v2
    v_mul_f32 v99, v99, v2
    v_mfma_f32_16x16x32_bf16 v[20:23], v[236:239], v[100:103], v[20:23]
    v_cvt_pk_bf16_f32 v91, v98, v99
    v_mul_f32 v72, v72, v2
    v_mfma_f32_16x16x32_bf16 v[20:23], v[240:243], v[92:95], v[20:23]
    ds_write_b128 v135, v[88:91] offset:3072
    v_mfma_f32_16x16x32_bf16 v[20:23], v[244:247], v[84:87], v[20:23]
    buffer_store_dwordx4 v[80:83], v124, s[28:31], s59 offen sc1
    v_mul_f32 v73, v73, v2
    v_cvt_pk_bf16_f32 v136, v72, v73
    v_mul_f32 v74, v74, v2
    v_mul_f32 v75, v75, v2
    v_mfma_f32_16x16x32_bf16 v[20:23], v[248:251], v[76:79], v[20:23]
    v_cvt_pk_bf16_f32 v137, v74, v75
    v_mul_f32 v68, v68, v0
    v_mfma_f32_16x16x32_bf16 v[20:23], v[252:255], v[36:39], v[20:23]
    s_waitcnt lgkmcnt(1)
    ds_write_b64 v134, v[136:137] offset:3072
    v_mfma_f32_16x16x32_bf16 v[36:39], a[216:219], v[64:67], 0
    v_mul_f32 v69, v69, v0
    v_cvt_pk_bf16_f32 v68, v68, v69
    v_mfma_f32_16x16x32_bf16 v[36:39], a[220:223], v[60:63], v[36:39]
    v_mul_f32 v70, v70, v0
    v_mul_f32 v71, v71, v0
    v_mfma_f32_16x16x32_bf16 v[36:39], a[224:227], v[56:59], v[36:39]
    v_cvt_pk_bf16_f32 v69, v70, v71
    v_mul_f32 v44, v44, v0
    v_mfma_f32_16x16x32_bf16 v[36:39], a[228:231], v[52:55], v[36:39]
    v_mul_f32 v45, v45, v0
    v_cvt_pk_bf16_f32 v70, v44, v45
    v_mfma_f32_16x16x32_bf16 v[36:39], a[232:235], v[48:51], v[36:39]
    v_mul_f32 v46, v46, v0
    v_mul_f32 v47, v47, v0
    v_mfma_f32_16x16x32_bf16 v[36:39], a[236:239], v[32:35], v[36:39]
    v_cvt_pk_bf16_f32 v71, v46, v47
    v_mul_f32 v40, v40, v0
    v_mfma_f32_16x16x32_bf16 v[44:47], a[240:243], v[64:67], 0
    ds_write_b128 v135, v[68:71] offset:0
    v_mfma_f32_16x16x32_bf16 v[44:47], a[244:247], v[60:63], v[44:47]
    v_mul_f32 v41, v41, v0
    v_cvt_pk_bf16_f32 v2, v40, v41
    v_mfma_f32_16x16x32_bf16 v[44:47], a[248:251], v[56:59], v[44:47]
    v_mul_f32 v42, v42, v0
    v_mul_f32 v43, v43, v0
    v_mfma_f32_16x16x32_bf16 v[44:47], a[252:255], v[52:55], v[44:47]
    v_cvt_pk_bf16_f32 v3, v42, v43
    v_fma_f32 v7, v16, v16, s42
    v_mfma_f32_16x16x32_bf16 v[44:47], v[224:227], v[48:51], v[44:47]
    ds_write_b64 v134, v[2:3] offset:0
    v_mfma_f32_16x16x32_bf16 v[44:47], v[228:231], v[32:35], v[44:47]
    v_fmac_f32 v7, v17, v17
    v_fmac_f32 v7, v18, v18
    v_mfma_f32_16x16x32_bf16 v[40:43], v[232:235], v[64:67], 0
    v_fmac_f32 v7, v19, v19
    v_fmac_f32 v7, v28, v28
    v_mfma_f32_16x16x32_bf16 v[40:43], v[236:239], v[60:63], v[40:43]
    v_fmac_f32 v7, v29, v29
    v_fmac_f32 v7, v30, v30
    v_mfma_f32_16x16x32_bf16 v[40:43], v[240:243], v[56:59], v[40:43]
    v_fmac_f32 v7, v31, v31
    v_fmac_f32 v7, v20, v20
    v_mfma_f32_16x16x32_bf16 v[40:43], v[244:247], v[52:55], v[40:43]
    v_fmac_f32 v7, v21, v21
    v_fmac_f32 v7, v22, v22
    v_mfma_f32_16x16x32_bf16 v[40:43], v[248:251], v[48:51], v[40:43]
    v_fmac_f32 v7, v23, v23
    v_fma_f32 v133, v36, v36, s42
    v_mfma_f32_16x16x32_bf16 v[40:43], v[252:255], v[32:35], v[40:43]
    s_nop 0
    v_fmac_f32 v133, v37, v37
    v_fmac_f32 v133, v38, v38
    v_fmac_f32 v133, v39, v39
    v_fmac_f32 v133, v44, v44
    v_fmac_f32 v133, v45, v45
    v_fmac_f32 v133, v46, v46
    v_fmac_f32 v133, v47, v47
    v_fmac_f32 v133, v40, v40
    v_fmac_f32 v133, v41, v41
    v_fmac_f32 v133, v42, v42
    v_fmac_f32 v133, v43, v43
    v_cvt_pk_bf16_f32 v120, v133, v7
    ds_write_b64 v130, v[120:121] offset:4096
    v_mul_f32 v8, v8, v1
    v_mul_f32 v9, v9, v1
    v_cvt_pk_bf16_f32 v8, v8, v9
    v_mul_f32 v10, v10, v1
    v_mul_f32 v11, v11, v1
    v_cvt_pk_bf16_f32 v9, v10, v11
    v_mul_f32 v24, v24, v1
    v_mul_f32 v25, v25, v1
    v_cvt_pk_bf16_f32 v10, v24, v25
    v_mul_f32 v26, v26, v1
    v_mul_f32 v27, v27, v1
    v_cvt_pk_bf16_f32 v11, v26, v27
    v_mul_f32 v12, v12, v1
    v_mul_f32 v13, v13, v1
    v_cvt_pk_bf16_f32 v136, v12, v13
    v_mul_f32 v14, v14, v1
    v_mul_f32 v15, v15, v1
    v_cvt_pk_bf16_f32 v137, v14, v15
    ds_write_b128 v135, v[8:11] offset:1536
    s_waitcnt lgkmcnt(1)
    s_barrier
    ds_write_b64 v134, v[136:137] offset:1536
    ds_read_b128 v[8:11], v129 offset:4096
    ds_read_b128 v[0:3], v129 offset:5120
    s_waitcnt lgkmcnt(2)
    s_barrier
    s_waitcnt lgkmcnt(1)
    v_mfma_f32_16x16x32_bf16 v[24:27], v[216:219], v[8:11], 0
    s_waitcnt lgkmcnt(0)
    ds_read_b128 v[48:51], v139 offset:0
    ds_read_b128 v[32:35], v139 offset:1024
    v_mfma_f32_16x16x32_bf16 v[24:27], v[216:219], v[0:3], v[24:27]
    s_nop 0
    ds_read_b128 v[12:15], v139 offset:2048
    s_nop 2
    ds_read_b128 v[8:11], v139 offset:3072
    s_nop 1
    v_rsq_f32 v24, v24
    ds_read_b128 v[0:3], v139 offset:4096
    v_mul_f32 v24, s43, v24
    v_mul_f32 v36, v36, v24
    v_mul_f32 v37, v37, v24
    v_cvt_pk_bf16_f32 v36, v36, v37
    v_mul_f32 v38, v38, v24
    v_mul_f32 v39, v39, v24
    v_cvt_pk_bf16_f32 v37, v38, v39
    v_mul_f32 v44, v44, v24
    v_mul_f32 v45, v45, v24
    s_waitcnt lgkmcnt(4)
    buffer_store_dwordx4 v[48:51], v128, s[28:31], s58 offen sc1
    v_cvt_pk_bf16_f32 v38, v44, v45
    v_mul_f32 v46, v46, v24
    v_mul_f32 v47, v47, v24
    v_cvt_pk_bf16_f32 v39, v46, v47
    v_mul_f32 v40, v40, v24
    v_mul_f32 v41, v41, v24
    v_cvt_pk_bf16_f32 v128, v40, v41
    v_mul_f32 v42, v42, v24
    v_mul_f32 v43, v43, v24
    v_cvt_pk_bf16_f32 v129, v42, v43
    ds_write_b128 v138, v[36:39] offset:0
    v_rsq_f32 v25, v25
    v_cmp_neq_f32 vcc, 0, v26
    v_mul_f32 v25, s43, v25
    s_waitcnt lgkmcnt(1)
    buffer_store_dwordx4 v[32:35], v127, s[28:31], s58 offen sc1
    ds_write_b64 v132, v[128:129] offset:0
    v_mul_f32 v16, v16, v25
    v_mul_f32 v17, v17, v25
    v_cvt_pk_bf16_f32 v16, v16, v17
    v_mul_f32 v18, v18, v25
    v_mul_f32 v19, v19, v25
    v_cvt_pk_bf16_f32 v17, v18, v19
    v_mul_f32 v28, v28, v25
    v_mul_f32 v29, v29, v25
    v_cvt_pk_bf16_f32 v18, v28, v29
    v_mul_f32 v30, v30, v25
    v_mul_f32 v31, v31, v25
    v_cvt_pk_bf16_f32 v19, v30, v31
    v_mul_f32 v20, v20, v25
    v_mul_f32 v21, v21, v25
    v_cvt_pk_bf16_f32 v128, v20, v21
    v_mul_f32 v22, v22, v25
    v_mul_f32 v23, v23, v25
    v_cvt_pk_bf16_f32 v129, v22, v23
    buffer_store_dwordx4 v[12:15], v126, s[28:31], s58 offen sc1
    ds_write_b128 v138, v[16:19] offset:1536
    ds_write_b64 v132, v[128:129] offset:1536
    buffer_store_dwordx4 v[8:11], v125, s[28:31], s58 offen sc1
    s_waitcnt lgkmcnt(0)
    s_barrier
    buffer_store_dwordx4 v[0:3], v124, s[28:31], s58 offen sc1
    ds_read_b128 v[12:15], v131 offset:0
    ds_read_b128 v[8:11], v131 offset:1024
    ds_read_b128 v[0:3], v131 offset:2048
    s_waitcnt lgkmcnt(2)
    buffer_store_dwordx4 v[12:15], v4, s[28:31], 0 offen sc1
    s_waitcnt lgkmcnt(0)
    buffer_store_dwordx4 v[8:11], v5, s[28:31], 0 offen sc1
    buffer_store_dwordx4 v[0:3], v6, s[28:31], 0 offen sc1
    s_nop 4
    s_cbranch_vccnz L_slow
L_end:
    s_endpgm
L_slow:
    s_waitcnt vmcnt(0) lgkmcnt(0)
    s_nop 15
    s_barrier
    s_lshr_b32 s66, s64, 20
    v_mbcnt_lo_u32_b32 v170, -1, 0
    v_mbcnt_hi_u32_b32 v170, -1, v170
    s_load_dwordx16 s[4:19], s[0:1], 0
    s_load_dwordx4 s[20:23], s[0:1], 64
    s_load_dwordx2 s[38:39], s[0:1], 80
    s_lshr_b32 s88, s2, 3
    s_lshl2_add_u32 s88, s88, s68
    v_lshlrev_b32 v17, 7, v170
    s_mul_i32 s89, s88, 576
    s_mul_i32 s88, s88, 1728
    v_min_u32 v16, 1664, v17
    v_min_u32 v7, 512, v17
    s_mov_b32 s34, 221184
    s_mov_b32 s35, 0x20000
    s_mov_b32 s78, 73728
    s_mov_b32 s79, 0x20000
    v_and_b32 v158, 15, v170
    v_lshrrev_b32 v5, 4, v170
    v_lshrrev_b32 v24, 2, v158
    v_and_b32 v131, 3, v158
    s_mul_i32 s87, s68, 192
    v_mad_u32_u24 v19, v158, 12, s87
    v_lshlrev_b32 v6, 1, v158
    v_lshlrev_b32 v4, 1, v24
    v_lshl_add_u32 v4, v5, 5, v4
    s_movk_i32 s86, 384
    s_mov_b32 s26, 100270464
    s_mov_b32 s27, 0x20000
    s_mov_b32 s30, 0
    s_mov_b32 s31, 0x20000
    s_mul_i32 s96, s68, 288
    s_and_b32 s97, s68, 1
    s_lshl_b32 s97, s97, 2
    s_mov_b32 s98, 193536
    s_waitcnt lgkmcnt(0)
    s_mov_b32 s24, s4
    s_mov_b32 s25, s5
    s_mov_b32 s32, s6
    s_mov_b32 s33, s7
    s_mov_b32 s76, s8
    s_mov_b32 s77, s9
    buffer_load_dword a254, v16, s[32:35], s88 offen
    buffer_load_dword a253, v7, s[76:79], s89 offen
    s_load_dwordx2 s[82:83], s[10:11], 0
    s_movk_i32 s18, 676
    s_mov_b32 s19, 0x20000
    buffer_load_dwordx3 v[28:30], v19, s[16:19], 0 offen
    s_mov_b32 s99, 589824
    v_add_u32 v7, s96, v170
    v_mul_u32_u24 v129, 2731, v7
    v_mul_u32_u24 v11, 6242, v7
    v_lshrrev_b32 v129, 16, v129
    s_lshr_b32 s94, s2, 3
    s_mul_i32 s70, s94, 168
    global_load_ushort v16, v6, s[12:13]
    v_lshrrev_b32 v11, 20, v11
    v_and_or_b32 v8, v129, 3, s97
    v_xor_b32 v8, v7, v8
    v_lshl_add_u32 v128, v8, 4, s99
    v_mad_u32_u24 v128, v11, s98, v128
    s_mul_i32 s69, s2, 20
    s_lshl3_add_u32 s69, s94, s69
    global_load_ushort v17, v6, s[12:13] offset:32
    v_add_u32 v10, 64, v7
    v_mul_u32_u24 v31, 2731, v10
    v_mul_u32_u24 v6, 6242, v10
    v_lshrrev_b32 v31, 16, v31
    v_lshrrev_b32 v6, 20, v6
    s_add_u32 s70, s70, 140
    s_movk_i32 s62, 2688
    global_load_ushort v160, v4, s[14:15] offset:0
    v_and_or_b32 v9, v31, 3, s97
    v_xor_b32 v9, v10, v9
    v_lshl_add_u32 v127, v9, 4, s99
    v_mad_u32_u24 v127, v6, s98, v127
    v_add_u32 v130, 128, v7
    s_movk_i32 s71, 20
    s_movk_i32 s73, 28
    global_load_ushort v162, v4, s[14:15] offset:8
    v_mul_u32_u24 v163, 2731, v130
    v_mul_u32_u24 v18, 6242, v130
    v_lshrrev_b32 v163, 16, v163
    v_lshrrev_b32 v18, 20, v18
    v_and_or_b32 v10, v163, 3, s97
    s_mov_b32 s93, 1769472
    s_mul_i32 s54, s68, 5120
    global_load_ushort v161, v4, s[14:15] offset:16
    v_xor_b32 v10, v130, v10
    v_lshl_add_u32 v126, v10, 4, s99
    v_mad_u32_u24 v126, v18, s98, v126
    v_add_u32 v27, 192, v7
    v_mul_u32_u24 v25, 2731, v27
    s_mov_b32 s63, 1180032
    s_mul_i32 s95, s68, -44
    global_load_ushort v130, v4, s[14:15] offset:24
    v_mul_u32_u24 v4, 6242, v27
    v_lshrrev_b32 v25, 16, v25
    v_lshrrev_b32 v4, 20, v4
    v_and_or_b32 v26, v25, 3, s97
    v_xor_b32 v26, v27, v26
    v_lshl_add_u32 v125, v26, 4, s99
    v_mad_u32_u24 v125, v4, s98, v125
    v_add_u32 v26, 256, v7
    v_mul_u32_u24 v156, 2731, v26
    v_mul_u32_u24 v7, 6242, v26
    v_lshrrev_b32 v156, 16, v156
    v_lshrrev_b32 v7, 20, v7
    v_and_or_b32 v124, v156, 3, s97
    v_xor_b32 v124, v26, v124
    v_lshl_add_u32 v124, v124, 4, s99
    v_mad_u32_u24 v124, v7, s98, v124
    s_cmp_ge_u32 s2, 240
    s_cbranch_scc1 L_bndS
L_bndrS:
    s_mul_i32 s94, s69, 58255
    s_lshr_b32 s94, s94, 22
    s_mul_i32 s94, s94, s63
    s_mul_i32 s72, s69, s62
    s_add_u32 s72, s72, s94
    v_lshl_or_b32 v157, v170, 4, 2.0
    s_sub_u32 s94, s73, 1
    s_max_u32 s94, s94, 20
    s_movk_i32 s99, -24
    s_add_u32 m0, s54, 0
    v_and_b32 v18, -4, v163
    s_mul_i32 s85, s68, 96
    s_sub_u32 s100, s85, 1024
    buffer_load_dwordx4 v128, s[24:27], s72 offen nt lds
    s_add_u32 m0, s54, 1024
    v_mad_u32_u24 v11, v18, 3, v163
    v_add_u32 v11, s95, v11
    v_mad_i32_i24 v10, v163, s99, v10
    v_med3_u32 v18, v11, 20, s94
    v_add_u32 v18, s70, v18
    v_add_u32 v163, s69, v11
    s_sub_u32 s87, s85, 2048
    s_movk_i32 s91, 1152
    buffer_load_dwordx4 v127, s[24:27], s72 offen nt lds
    v_cmp_gt_u32 vcc, s71, v11
    v_lshl_add_u32 v10, v10, 4, s93
    s_add_u32 m0, s54, 43008
    v_cndmask_b32 v163, v18, v163, vcc
    v_mul_u32_u24 v18, 58255, v163
    v_mad_u32_u24 v10, v163, s62, v10
    v_lshrrev_b32 v18, 22, v18
    v_mad_u32_u24 v10, v18, s63, v10
    s_mul_i32 s90, s68, 3072
    s_add_u32 s90, s90, 61440
    buffer_load_dwordx4 v10, s[24:27], 0 offen  lds
    v_lshlrev_b32 v11, 16, v11
    s_add_u32 m0, s54, 2048
    v_and_b32 v163, -4, v31
    v_mad_u32_u24 v18, v163, 3, v31
    v_add_u32 v18, s95, v18
    v_mad_i32_i24 v9, v31, s99, v9
    v_med3_u32 v163, v18, 20, s94
    s_mov_b32 s28, s22
    s_mov_b32 s29, s23
    buffer_load_dwordx4 v126, s[24:27], s72 offen nt lds
    v_add_u32 v163, s70, v163
    v_add_u32 v31, s69, v18
    v_cmp_gt_u32 vcc, s71, v18
    v_lshl_add_u32 v9, v9, 4, s93
    s_add_u32 m0, s54, 41984
    v_cndmask_b32 v31, v163, v31, vcc
    v_mul_u32_u24 v163, 58255, v31
    v_mad_u32_u24 v9, v31, s62, v9
    v_lshrrev_b32 v163, 22, v163
    v_mad_u32_u24 v9, v163, s63, v9
    s_mov_b32 s41, 0x2a8cbccc
    s_mov_b32 s42, 0x38fba882
    buffer_load_dwordx4 v9, s[24:27], 0 offen  lds
    v_lshl_or_b32 v11, v18, 8, v11
    s_add_u32 m0, s54, 3072
    v_cmp_gt_u32 vcc, 32, v170
    v_and_b32 v31, -4, v129
    v_mad_u32_u24 v18, v31, 3, v129
    v_cndmask_b32 v124, v157, v124, vcc
    v_add_u32 v18, s95, v18
    s_mov_b32 s43, 0x415db3d7
    s_mov_b32 s44, 61440
    buffer_load_dwordx4 v125, s[24:27], s72 offen nt lds
    s_add_u32 m0, s54, 4096
    v_mad_i32_i24 v8, v129, s99, v8
    v_med3_u32 v31, v18, 20, s94
    v_add_u32 v31, s70, v31
    v_add_u32 v129, s69, v18
    v_cmp_gt_u32 vcc, s71, v18
    v_lshl_add_u32 v8, v8, 4, s93
    s_mul_i32 s93, s68, 6
    s_lshl_b32 s94, s97, 1
    buffer_load_dwordx4 v124, s[24:27], s72 offen nt lds
    v_cndmask_b32 v129, v31, v129, vcc
    v_mul_u32_u24 v31, 58255, v129
    v_mad_u32_u24 v8, v129, s62, v8
    v_lshrrev_b32 v31, 22, v31
    v_mad_u32_u24 v8, v31, s63, v8
    s_add_u32 m0, s54, 40960
    v_lshl_or_b32 v11, v18, 0, v11
    s_mov_b32 s45, 40960
    s_mov_b32 s46, 20480
    buffer_load_dwordx4 v8, s[24:27], 0 offen nt lds
    v_mul_u32_u24 v27, 10923, v170
    v_lshrrev_b32 v149, 17, v27
    v_lshrrev_b32 v27, 16, v27
    v_mad_i32_i24 v163, v27, -6, v170
    v_bitop3_b32 v149, v149, v27, 4 bitop3:0x28
    v_lshl_add_u32 v163, v163, 4, s85
    v_mul_u32_u24 v149, 3, v149
    v_xor_b32 v27, v27, v149
    v_mad_u32_u24 v149, v27, s91, v163
    v_add_u32 v18, 64, v170
    v_mul_u32_u24 v129, 10923, v18
    v_lshrrev_b32 v121, 17, v129
    v_lshrrev_b32 v129, 16, v129
    v_mad_i32_i24 v31, v129, -6, v18
    v_bitop3_b32 v121, v121, v129, 4 bitop3:0x28
    v_lshl_add_u32 v31, v31, 4, s100
    v_mul_u32_u24 v121, 3, v121
    v_xor_b32 v129, v129, v121
    v_mad_u32_u24 v121, v129, s91, v31
    v_add_u32 v18, 128, v170
    v_mul_u32_u24 v25, 10923, v18
    v_lshrrev_b32 v26, 17, v25
    v_lshrrev_b32 v25, 16, v25
    v_mad_i32_i24 v18, v25, -6, v18
    v_bitop3_b32 v26, v26, v25, 4 bitop3:0x28
    v_lshl_add_u32 v18, v18, 4, s87
    v_mul_u32_u24 v26, 3, v26
    v_xor_b32 v25, v25, v26
    v_mad_u32_u24 v26, v25, s91, v18
    v_mad_u32_u24 v27, v27, s86, v163
    v_mad_u32_u24 v146, v129, s86, v31
    v_mad_u32_u24 v78, v25, s86, v18
    s_add_u32 m0, s90, 0
    s_mov_b32 s92, 0
    buffer_load_dwordx4 v149, s[32:35], s92 offen offset:0 lds
    v_mov_b32 v18, 0x3f803f80
    v_cmp_eq_u32 vcc, 0, v131
    v_and_b32 v25, 1, v170
    v_lshlrev_b32 v25, 4, v25
    v_cndmask_b32 v220, 0, v18, vcc
    v_cndmask_b32 v221, 0, v18, vcc
    v_cndmask_b32 v222, 0, v18, vcc
    v_cndmask_b32 v223, 0, v18, vcc
    v_mov_b32 v18, 0x3f80
    v_lshlrev_b32 v18, v25, v18
    v_cmp_gt_u32 vcc, 2, v131
    v_mov_b32 v171, 0
    v_mov_b32 v167, 0
    v_cndmask_b32 v216, 0, v18, vcc
    v_cndmask_b32 v218, 0, v18, vcc
    v_cmp_le_u32 vcc, 2, v131
    v_mov_b32 v163, 0
    v_mov_b32 v159, 0
    v_cndmask_b32 v217, 0, v18, vcc
    v_cndmask_b32 v219, 0, v18, vcc
    v_cmp_eq_u32 vcc, v5, v24
    v_mov_b32 v150, 0
    v_mov_b32 v151, 0
    v_cndmask_b32 v168, 0, v216, vcc
    v_cndmask_b32 v169, 0, v217, vcc
    v_mov_b32 v144, 0
    v_mov_b32 v145, 0
    v_mov_b32 v138, 0
    v_mov_b32 v139, 0
    v_lshrrev_b32 v25, 1, v5
    v_lshl_add_u32 v18, v5, 2, v24
    v_lshl_add_u32 v18, v25, 3, v18
    v_mul_u32_u24 v18, 96, v18
    v_add_u32 v18, s90, v18
    v_lshl_add_u32 v6, v131, 4, v18
    v_lshl_add_u32 v7, v131, 3, v18
    s_waitcnt lgkmcnt(0)
    s_lshl_b32 s84, s68, 4
    s_lshr_b64 s[82:83], s[82:83], s84
    s_lshl_b32 s82, s82, 16
    v_mov_b32 v4, s82
    v_min_f32 v4, 0x40930000, v4
    v_max_f32 v4, 0xc2c80000, v4
    v_mul_f32 v4, 0x3fb8aa3b, v4
    v_exp_f32 v4, v4
    v_mov_b32 v18, 0
    v_cvt_pk_bf16_f32 v4, v4, v4
    v_lshlrev_b32 v4, 16, v4
    v_mul_f32 v4, 0x4038aa3b, v4
    v_mov_b32 v31, 0
    v_readfirstlane_b32 s55, v4
    v_add_f32 v4, v4, v4
    v_mul_u32_u24 v132, 5120, v5
    v_readfirstlane_b32 s52, v4
    v_add_u32 v132, v19, v132
    s_mov_b32 s84, 0x41b8aa3b
    v_mov_b32 v156, 0xc138aa3b
    v_mul_u32_u24 v4, 5120, v24
    v_mad_u32_u24 v4, v131, s86, v4
    v_and_b32 v19, 7, v158
    v_xor_b32 v25, v19, v5
    v_lshl_add_u32 v148, v25, 4, v4
    v_xor_b32 v147, 64, v148
    v_add_u32 v137, 40960, v148
    s_mov_b32 s47, 0
    s_mov_b32 s57, s72
    buffer_load_dwordx4 v121, s[32:35], s92 offen offset:1024 lds
    v_xor_b32 v136, 64, v137
    v_add_u32 v4, 61440, v4
    v_add_u32 v25, s93, v5
    v_xor_b32 v25, v19, v25
    v_lshl_add_u32 v135, v25, 4, v4
    v_lshrrev_b32 v25, 1, v5
    v_add3_u32 v25, v25, s93, 4
    s_add_u32 s93, s54, 20480
    s_mov_b32 s58, 0
    buffer_load_dwordx4 v26, s[32:35], s92 offen offset:2048 lds
    s_add_u32 m0, s90, 12288
    s_mov_b32 s92, 36864
    v_xor_b32 v25, v19, v25
    v_lshl_add_u32 v25, v25, 4, v4
    v_and_b32 v4, 1, v5
    v_lshl_add_u32 v134, v4, 3, v25
    v_lshlrev_b32 v4, 4, v170
    s_mov_b32 s59, 0
    s_mov_b32 s60, 0
    buffer_load_dwordx4 v149, s[32:35], s92 offen offset:0 lds
    s_waitcnt vmcnt(16)
    v_lshl_or_b32 v16, v17, 16, v16
    v_cmp_gt_u32 vcc, 16, v170
    v_mov_b32 v17, 0
    v_add_u32 v133, s93, v4
    v_cndmask_b32 v19, 0, v16, vcc
    v_cndmask_b32 v16, 0, v16, vcc
    v_add_u32 v129, 81920, v4
    v_mfma_f32_16x16x16_bf16 v[0:3], v[18:19], v[28:29], 0
    s_waitcnt vmcnt(14)
    s_lshr_b32 s93, s68, 1
    v_lshl_or_b32 v160, v162, 16, v160
    v_mul_u32_u24 v4, 1792, v5
    v_mfma_f32_16x16x16_bf16 v[12:15], v[16:17], v[28:29], 0
    s_lshl_b32 s93, s93, 10
    v_mov_b32 v122, 0
    v_mul_u32_u24 v76, 48, v24
    v_mfma_f32_16x16x16_bf16 v[20:23], v[16:17], v[30:31], 0
    s_waitcnt vmcnt(12)
    s_add_u32 s93, s93, s94
    buffer_load_dwordx4 v121, s[32:35], s92 offen offset:1024 lds
    v_lshl_or_b32 v161, v130, 16, v161
    v_max_f32 v0, 0, v0
    v_max_f32 v12, 0, v12
    v_max_f32 v13, 0, v13
    v_max_f32 v14, 0, v14
    v_max_f32 v15, 0, v15
    v_cvt_pk_bf16_f32 v12, v12, v13
    v_cvt_pk_bf16_f32 v13, v14, v15
    v_max_f32 v1, 0, v1
    v_max_f32 v2, 0, v2
    v_mfma_f32_16x16x16_bf16 v[16:19], v[160:161], v[12:13], 0
    s_mov_b32 s65, -1
    v_max_f32 v3, 0, v3
    v_cvt_pk_bf16_f32 v0, v0, v1
    v_cvt_pk_bf16_f32 v1, v2, v3
    v_max_f32 v20, 0, v20
    v_max_f32 v21, 0, v21
    v_mfma_f32_16x16x16_bf16 v[12:15], v[160:161], v[0:1], 0
    s_mov_b32 s61, 1
    v_max_f32 v22, 0, v22
    v_max_f32 v23, 0, v23
    v_cvt_pk_bf16_f32 v20, v20, v21
    v_cvt_pk_bf16_f32 v21, v22, v23
    v_cvt_pk_bf16_f32 v16, v16, v16
    v_lshlrev_b32 v16, 16, v16
    v_mfma_f32_16x16x16_bf16 v[0:3], v[160:161], v[20:21], 0
    s_movk_i32 s4, 112
    v_mul_f32 v16, 0xbfb8aa3b, v16
    v_cvt_pk_bf16_f32 v12, v12, v12
    v_exp_f32 v16, v16
    v_lshlrev_b32 v12, 16, v12
    v_add_f32 v16, 1.0, v16
    v_rcp_f32 v16, v16
    v_mul_f32 v12, 0xbfb8aa3b, v12
    v_cvt_pk_bf16_f32 v16, v16, v16
    v_lshlrev_b32 v16, 16, v16
    v_fma_f32 v16, v16, s84, v156
    s_mov_b32 s5, 0
    s_mov_b32 s6, 0
    ds_write_b32 v132, v16 offset:44032
    v_exp_f32 v12, v12
    v_cvt_pk_bf16_f32 v0, v0, v0
    v_add_f32 v12, 1.0, v12
    v_rcp_f32 v12, v12
    v_lshlrev_b32 v0, 16, v0
    v_cvt_pk_bf16_f32 v12, v12, v12
    v_lshlrev_b32 v12, 16, v12
    v_fma_f32 v12, v12, s84, v156
    s_mov_b32 s12, 0
    s_mov_b32 s64, 3
    ds_write_b32 v132, v12 offset:44036
    v_mul_f32 v0, 0xbfb8aa3b, v0
    v_exp_f32 v0, v0
    v_add_u32 v130, s93, v129
    v_add_f32 v0, 1.0, v0
    v_rcp_f32 v0, v0
    s_mul_i32 s93, s68, 7168
    v_cvt_pk_bf16_f32 v0, v0, v0
    v_lshlrev_b32 v0, 16, v0
    v_fma_f32 v0, v0, s84, v156
    s_add_u32 s93, s93, 135168
    s_mov_b32 s10, 81924
    ds_write_b32 v132, v0 offset:44040
    v_add_u32 v25, s93, v4
    v_mul_u32_u24 v4, 112, v158
    v_add_u32 v156, v4, v25
    v_subrev_u32 v156, 28672, v156
    v_cmp_eq_u32 vcc, 0, v24
    v_add_u32 v4, 16, v25
    s_mov_b32 s11, 0x20000
    v_cndmask_b32 v132, v157, v25, vcc
    v_cmp_eq_u32 vcc, 3, v131
    s_add_u32 s101, s54, 44032
    v_lshl_add_u32 v76, v131, 2, v76
    v_cndmask_b32 v132, v132, v4, vcc
    v_mul_u32_u24 v4, 1792, v24
    v_lshl_add_u32 v4, v5, 3, v4
    v_lshl_add_u32 v4, v131, 1, v4
    v_add_u32 v4, s93, v4
    v_cmp_gt_u32 vcc, 3, v5
    v_mov_b32 v123, v4
    s_add_u32 s93, s69, 1
    v_cndmask_b32 v131, v157, v4, vcc
    s_mul_i32 s94, s93, 58255
    s_lshr_b32 s94, s94, 22
    s_mul_i32 s94, s94, s63
    s_mul_i32 s56, s93, s62
    s_add_u32 s56, s56, s94
    s_sub_u32 s93, s71, 1
    s_cmp_eq_u32 s68, 0
    s_cselect_b32 s13, s93, -1
    s_cmp_gt_u32 s73, 20
    s_cselect_b32 s13, s13, -1
    s_and_b32 s93, s2, -8
    s_sub_u32 s93, 81920, s93
    s_sub_u32 s8, s38, s93
    s_waitcnt lgkmcnt(0)
    s_barrier
    s_subb_u32 s9, s39, 0
    s_mov_b32 s39, 0x00010001
    v_mul_u32_u24 v79, 48, v5
    v_add_u32 v174, 0, v76
    v_mul_u32_u24 v4, 37, v174
    v_lshrrev_b32 v4, 10, v4
    v_mad_u32_u24 v174, v4, 24, v174
    v_add_u32 v174, s101, v174
    v_add_u32 v77, 16, v76
    v_mul_u32_u24 v4, 37, v77
    v_lshrrev_b32 v4, 10, v4
    v_mad_u32_u24 v77, v4, 24, v77
    v_add_u32 v77, s101, v77
    v_add_u32 v4, 32, v76
    v_mul_u32_u24 v120, 37, v4
    v_lshrrev_b32 v120, 10, v120
    v_mad_u32_u24 v4, v120, 24, v4
    v_add_u32 v4, s101, v4
    v_add_u32 v173, 0, v79
    v_mul_u32_u24 v120, 37, v173
    v_lshrrev_b32 v120, 10, v120
    v_mad_u32_u24 v173, v120, 24, v173
    v_add_u32 v172, 4, v79
    v_mul_u32_u24 v120, 37, v172
    v_lshrrev_b32 v120, 10, v120
    v_mad_u32_u24 v172, v120, 24, v172
    v_add_u32 v165, 8, v79
    v_mul_u32_u24 v120, 37, v165
    v_lshrrev_b32 v120, 10, v120
    v_mad_u32_u24 v165, v120, 24, v165
    v_add_u32 v166, 12, v79
    v_mul_u32_u24 v120, 37, v166
    v_lshrrev_b32 v120, 10, v120
    v_mad_u32_u24 v166, v120, 24, v166
    v_add_u32 v164, 16, v79
    v_mul_u32_u24 v120, 37, v164
    v_lshrrev_b32 v120, 10, v120
    v_mad_u32_u24 v164, v120, 24, v164
    v_add_u32 v161, 20, v79
    v_mul_u32_u24 v120, 37, v161
    v_lshrrev_b32 v120, 10, v120
    v_mad_u32_u24 v161, v120, 24, v161
    v_add_u32 v162, 24, v79
    v_mul_u32_u24 v120, 37, v162
    v_lshrrev_b32 v120, 10, v120
    v_mad_u32_u24 v162, v120, 24, v162
    v_add_u32 v25, 28, v79
    v_mul_u32_u24 v24, 37, v25
    v_lshrrev_b32 v24, 10, v24
    v_mad_u32_u24 v25, v24, 24, v25
    v_add_u32 v160, 32, v79
    v_mul_u32_u24 v24, 37, v160
    v_lshrrev_b32 v24, 10, v24
    v_mad_u32_u24 v160, v24, 24, v160
    v_add_u32 v24, 36, v79
    v_mul_u32_u24 v120, 37, v24
    v_lshrrev_b32 v120, 10, v120
    v_mad_u32_u24 v24, v120, 24, v24
    v_add_u32 v120, 40, v79
    v_mul_u32_u24 v175, 37, v120
    v_lshrrev_b32 v175, 10, v175
    v_mad_u32_u24 v120, v175, 24, v120
    v_add_u32 v175, 44, v79
    v_mul_u32_u24 v79, 37, v175
    v_lshrrev_b32 v79, 10, v79
    s_lshr_b32 s93, s68, 1
    s_mul_i32 s93, s93, 30720
    buffer_load_dwordx4 v26, s[32:35], s92 offen offset:2048 lds
    s_add_u32 m0, s90, 24576
    s_mov_b32 s92, 73728
    ds_read_b32 v208, v174
    v_mad_u32_u24 v175, v79, 24, v175
    v_lshl_add_u32 v79, v5, 4, v76
    v_mul_u32_u24 v209, 37, v79
    v_lshrrev_b32 v209, 10, v209
    v_mad_u32_u24 v79, v209, 24, v79
    v_mov_b32 v205, 336
    v_cmp_gt_u32 vcc, 3, v5
    v_sub_u32 v204, v174, v173
    s_and_b32 s94, s68, 1
    v_cndmask_b32 v79, v205, v79, vcc
    v_sub_u32 v79, s101, v79
    s_mul_i32 s94, s94, -2304
    s_add_u32 s93, s93, s94
    ds_read_b32 v204, v204 offset:336
    v_sub_u32 v205, v174, v172
    v_sub_u32 v206, v174, v165
    v_sub_u32 v207, v174, v166
    v_sub_u32 v200, v174, v164
    s_lshl_b32 s94, s97, 4
    buffer_load_dwordx4 v149, s[32:35], s92 offen offset:0 lds
    ds_read_b32 v205, v205 offset:336
    v_sub_u32 v201, v174, v161
    v_sub_u32 v202, v174, v162
    v_sub_u32 v203, v174, v25
    v_sub_u32 v196, v174, v160
    v_sub_u32 v197, v174, v24
    ds_read_b32 v206, v206 offset:336
    buffer_load_dwordx4 v121, s[32:35], s92 offen offset:1024 lds
    v_sub_u32 v198, v174, v120
    v_sub_u32 v199, v174, v175
    v_sub_u32 v192, v77, v173
    v_sub_u32 v193, v77, v172
    ds_read_b32 v207, v207 offset:336
    v_sub_u32 v194, v77, v165
    v_sub_u32 v195, v77, v166
    v_sub_u32 v188, v77, v164
    v_sub_u32 v189, v77, v161
    v_sub_u32 v190, v77, v162
    ds_read_b32 v200, v200 offset:336
    v_sub_u32 v191, v77, v25
    v_sub_u32 v184, v77, v160
    v_sub_u32 v185, v77, v24
    v_sub_u32 v186, v77, v120
    v_sub_u32 v187, v77, v175
    ds_read_b32 v201, v201 offset:336
    buffer_load_dwordx4 v26, s[32:35], s92 offen offset:2048 lds
    s_add_u32 m0, s90, 36864
    s_mov_b32 s92, 110592
    v_sub_u32 v180, v4, v173
    v_sub_u32 v181, v4, v172
    ds_read_b32 v202, v202 offset:336
    v_sub_u32 v182, v4, v165
    v_sub_u32 v183, v4, v166
    v_sub_u32 v176, v4, v164
    v_sub_u32 v177, v4, v161
    v_sub_u32 v178, v4, v162
    s_waitcnt vmcnt(9)
    s_barrier
    ds_read_b32 v203, v203 offset:336
    v_sub_u32 v179, v4, v25
    v_sub_u32 v172, v4, v160
    v_sub_u32 v173, v4, v24
    v_sub_u32 v174, v4, v120
    v_sub_u32 v175, v4, v175
    ds_read_b32 v196, v196 offset:336
    v_mov_b32 v120, 0xf149f2ca
    v_and_b32 v25, 8, v158
    v_add_u32 v25, v25, v158
    v_mul_u32_u24 v25, 96, v25
    v_add_u32 v25, s90, v25
    ds_read_b32 v197, v197 offset:336
    buffer_load_dwordx4 v149, s[32:35], s92 offen offset:0 lds
    v_lshl_add_u32 v24, v5, 4, v25
    v_lshl_add_u32 v19, v5, 3, v25
    v_add_u32 v17, s93, v24
    v_add_u32 v16, s93, v19
    s_lshr_b32 s93, s68, 1
    s_mul_i32 s93, s93, 5120
    ds_read_b32 v198, v198 offset:336
    v_lshlrev_b32 v18, 4, v5
    v_add_u32 v18, 4608, v18
    s_add_u32 s93, s93, s94
    v_add_u32 v25, s93, v18
    v_cmp_eq_u32 vcc, 0, v158
    ds_read_b32 v199, v199 offset:336
    s_nop 0
    v_cndmask_b32 v25, v157, v25, vcc
    buffer_load_dwordx4 v121, s[32:35], s92 offen offset:1024 lds
    ds_read_b32 v211, v79 offset:672
    ds_read_b32 v192, v192 offset:336
    ds_read_b32 v193, v193 offset:336
    ds_read_b32 v194, v194 offset:336
    buffer_load_dwordx4 v26, s[32:35], s92 offen offset:2048 lds
    s_add_u32 m0, s90, 49152
    s_mov_b32 s92, 147456
    ds_read_b32 v195, v195 offset:336
    ds_read_b32 v188, v188 offset:336
    ds_read_b32 v189, v189 offset:336
    buffer_load_dwordx4 v149, s[32:35], s92 offen offset:0 lds
    ds_read_b32 v190, v190 offset:336
    ds_read_b32 v191, v191 offset:336
    ds_read_b32 v184, v184 offset:336
    buffer_load_dwordx4 v121, s[32:35], s92 offen offset:1024 lds
    ds_read_b32 v185, v185 offset:336
    ds_read_b32 v186, v186 offset:336
    ds_read_b32 v187, v187 offset:336
    ds_read_b32 v209, v77
    buffer_load_dwordx4 v26, s[32:35], s92 offen offset:2048 lds
    s_add_u32 m0, s90, 61440
    s_mov_b32 s92, 184320
    ds_read_b32 v180, v180 offset:336
    ds_read_b32 v181, v181 offset:336
    ds_read_b32 v182, v182 offset:336
    buffer_load_dwordx4 v149, s[32:35], s92 offen offset:0 lds
    ds_read_b32 v183, v183 offset:336
    ds_read_b32 v176, v176 offset:336
    ds_read_b32 v177, v177 offset:336
    buffer_load_dwordx4 v121, s[32:35], s92 offen offset:1024 lds
    ds_read_b32 v178, v178 offset:336
    ds_read_b32 v179, v179 offset:336
    ds_read_b32 v172, v172 offset:336
    ds_read_b32 v173, v173 offset:336
    buffer_load_dwordx4 v26, s[32:35], s92 offen offset:2048 lds
    ds_read_b32 v174, v174 offset:336
    ds_read_b32 v175, v175 offset:336
    ds_read_b32 v210, v4
    s_waitcnt vmcnt(15)
    ds_read_b64_tr_b16 a[0:1], v7 offset:0
    ds_read_b64_tr_b16 a[2:3], v7 offset:768
    ds_read_b64_tr_b16 a[24:25], v7 offset:32
    ds_read_b64_tr_b16 a[26:27], v7 offset:800
    ds_read_b64_tr_b16 a[48:49], v7 offset:64
    ds_read_b64_tr_b16 a[50:51], v7 offset:832
    s_add_u32 m0, s90, 0
    s_mov_b32 s92, 384
    s_waitcnt vmcnt(12)
    ds_read_b64_tr_b16 a[4:5], v7 offset:12288
    ds_read_b64_tr_b16 a[6:7], v7 offset:13056
    ds_read_b64_tr_b16 a[28:29], v7 offset:12320
    ds_read_b64_tr_b16 a[30:31], v7 offset:13088
    ds_read_b64_tr_b16 a[52:53], v7 offset:12352
    ds_read_b64_tr_b16 a[54:55], v7 offset:13120
    s_waitcnt vmcnt(9)
    ds_read_b64_tr_b16 a[8:9], v7 offset:24576
    ds_read_b64_tr_b16 a[10:11], v7 offset:25344
    ds_read_b64_tr_b16 a[32:33], v7 offset:24608
    s_waitcnt lgkmcnt(15)
    s_cmp_ge_u32 s2, 247
    s_cbranch_scc1 L_maskS
L_nomaskS:
    v_cmp_gt_u32 vcc, 16, v170
    v_readlane_b32 s84, v211, 48
    ds_read_b64_tr_b16 a[34:35], v7 offset:25376
    v_cndmask_b32 v208, v120, v208, vcc
    v_cndmask_b32 v209, v120, v209, vcc
    v_cndmask_b32 v210, v120, v210, vcc
    v_cmp_gt_u32 vcc, 49, v170
    ds_read_b64_tr_b16 a[56:57], v7 offset:24640
    s_waitcnt lgkmcnt(10)
    buffer_load_dwordx4 v149, s[32:35], s92 offen offset:0 lds
    ds_read_b64_tr_b16 a[58:59], v7 offset:25408
    v_cndmask_b32 v211, v120, v211, vcc
    s_waitcnt vmcnt(7)
    ds_read_b64_tr_b16 a[12:13], v7 offset:36864
    ds_read_b64_tr_b16 a[14:15], v7 offset:37632
    buffer_load_dwordx4 v121, s[32:35], s92 offen offset:1024 lds
    ds_read_b64_tr_b16 a[36:37], v7 offset:36896
    ds_read_b64_tr_b16 a[38:39], v7 offset:37664
    ds_read_b64_tr_b16 a[60:61], v7 offset:36928
    ds_read_b64_tr_b16 a[62:63], v7 offset:37696
    buffer_load_dwordx4 v26, s[32:35], s92 offen offset:2048 lds
    s_add_u32 m0, s90, 12288
    s_mov_b32 s92, 37248
    ds_read_b128 v[60:63], v148 offset:40960
    ds_read_b128 v[56:59], v147 offset:40960
    s_waitcnt lgkmcnt(10)
    buffer_load_dwordx4 v149, s[32:35], s92 offen offset:0 lds
    ds_read_b128 v[52:55], v148 offset:41088
    ds_read_b128 v[48:51], v147 offset:41088
    buffer_load_dwordx4 v121, s[32:35], s92 offen offset:1024 lds
    ds_read_b128 v[40:43], v148 offset:41216
    ds_read_b128 v[0:3], v147 offset:41216
    buffer_load_dwordx4 v26, s[32:35], s92 offen offset:2048 lds
    s_add_u32 m0, s90, 24576
    s_mov_b32 s92, 74112
    s_waitcnt vmcnt(9)
    ds_read_b64_tr_b16 a[16:17], v7 offset:49152
    ds_read_b64_tr_b16 a[18:19], v7 offset:49920
    ds_read_b64_tr_b16 a[40:41], v7 offset:49184
    ds_read_b64_tr_b16 a[42:43], v7 offset:49952
    ds_read_b64_tr_b16 a[64:65], v7 offset:49216
    ds_read_b64_tr_b16 a[66:67], v7 offset:49984
    s_waitcnt lgkmcnt(6)
    buffer_load_dwordx4 v149, s[32:35], s92 offen offset:0 lds
    buffer_load_dwordx4 v121, s[32:35], s92 offen offset:1024 lds
    buffer_load_dwordx4 v26, s[32:35], s92 offen offset:2048 lds
    s_add_u32 m0, s90, 36864
    s_mov_b32 s92, 110976
    s_waitcnt vmcnt(9)
    ds_read_b64_tr_b16 a[20:21], v7 offset:61440
    ds_read_b64_tr_b16 a[22:23], v7 offset:62208
    v_mfma_f32_16x16x32_bf16 v[68:71], a[0:3], v[60:63], 0
    ds_read_b64_tr_b16 a[44:45], v7 offset:61472
    v_mfma_f32_16x16x32_bf16 v[68:71], a[4:7], v[56:59], v[68:71]
    ds_read_b64_tr_b16 a[46:47], v7 offset:62240
    v_mfma_f32_16x16x32_bf16 v[68:71], a[8:11], v[52:55], v[68:71]
    ds_read_b64_tr_b16 a[68:69], v7 offset:61504
    v_mfma_f32_16x16x32_bf16 v[68:71], a[12:15], v[48:51], v[68:71]
    s_waitcnt lgkmcnt(5)
    ds_read_b64_tr_b16 a[70:71], v7 offset:62272
    v_mfma_f32_16x16x32_bf16 v[68:71], a[16:19], v[40:43], v[68:71]
    ds_read_b128 v[44:47], v148 offset:42496
    ds_read_b128 v[36:39], v147 offset:42496
    ds_read_b128 v[32:35], v148 offset:42624
    ds_read_b128 v[28:31], v147 offset:42624
    s_waitcnt lgkmcnt(7)
    v_mfma_f32_16x16x32_bf16 v[68:71], a[20:23], v[0:3], v[68:71]
    ds_read_b128 v[20:23], v148 offset:42752
    s_nop 0
    v_mfma_f32_16x16x32_bf16 v[92:95], a[24:27], v[60:63], 0
    s_nop 0
    ds_read_b128 v[12:15], v147 offset:42752
    s_nop 0
    v_mfma_f32_16x16x32_bf16 v[92:95], a[28:31], v[56:59], v[92:95]
    s_nop 0
    v_fma_f32 v170, v68, v68, s41
    v_fmac_f32 v170, v69, v69
    v_mfma_f32_16x16x32_bf16 v[92:95], a[32:35], v[52:55], v[92:95]
    v_fmac_f32 v170, v70, v70
    v_fmac_f32 v170, v71, v71
    v_mfma_f32_16x16x32_bf16 v[92:95], a[36:39], v[48:51], v[92:95]
    v_mfma_f32_16x16x32_bf16 v[92:95], a[40:43], v[40:43], v[92:95]
    s_waitcnt lgkmcnt(4)
    buffer_load_dwordx4 v149, s[32:35], s92 offen offset:0 lds
    v_mfma_f32_16x16x32_bf16 v[92:95], a[44:47], v[0:3], v[92:95]
    s_nop 1
    v_mfma_f32_16x16x32_bf16 v[88:91], a[48:51], v[60:63], 0
    s_nop 2
    v_mfma_f32_16x16x32_bf16 v[88:91], a[52:55], v[56:59], v[88:91]
    s_nop 0
    v_fmac_f32 v170, v92, v92
    v_fmac_f32 v170, v93, v93
    v_mfma_f32_16x16x32_bf16 v[88:91], a[56:59], v[52:55], v[88:91]
    v_fmac_f32 v170, v94, v94
    v_fmac_f32 v170, v95, v95
    v_mfma_f32_16x16x32_bf16 v[88:91], a[60:63], v[48:51], v[88:91]
    buffer_load_dwordx4 v121, s[32:35], s92 offen offset:1024 lds
    v_mfma_f32_16x16x32_bf16 v[88:91], a[64:67], v[40:43], v[88:91]
    v_mfma_f32_16x16x32_bf16 v[88:91], a[68:71], v[0:3], v[88:91]
    s_nop 0
    v_mfma_f32_16x16x32_bf16 v[0:3], a[0:3], v[44:47], 0
    s_nop 2
    v_mfma_f32_16x16x32_bf16 v[0:3], a[4:7], v[36:39], v[0:3]
    s_waitcnt lgkmcnt(0)
    s_nop 0
    v_fmac_f32 v170, v88, v88
    v_fmac_f32 v170, v89, v89
    v_mfma_f32_16x16x32_bf16 v[0:3], a[8:11], v[32:35], v[0:3]
    v_fmac_f32 v170, v90, v90
    v_fmac_f32 v170, v91, v91
    v_mfma_f32_16x16x32_bf16 v[0:3], a[12:15], v[28:31], v[0:3]
    s_waitcnt vmcnt(8)
    buffer_load_dwordx4 v26, s[32:35], s92 offen offset:2048 lds
    ds_read_b64_tr_b16 a[72:73], v7 offset:0
    v_mfma_f32_16x16x32_bf16 v[0:3], a[16:19], v[20:23], v[0:3]
    s_add_u32 m0, s90, 49152
    ds_read_b64_tr_b16 a[74:75], v7 offset:768
    v_mfma_f32_16x16x32_bf16 v[0:3], a[20:23], v[12:15], v[0:3]
    s_mov_b32 s92, 147840
    ds_read_b64_tr_b16 a[96:97], v7 offset:32
    v_mfma_f32_16x16x32_bf16 v[56:59], a[24:27], v[44:47], 0
    ds_read_b64_tr_b16 a[98:99], v7 offset:800
    v_mfma_f32_16x16x32_bf16 v[56:59], a[28:31], v[36:39], v[56:59]
    ds_read_b64_tr_b16 a[120:121], v7 offset:64
    buffer_load_dwordx4 v149, s[32:35], s92 offen offset:0 lds
    v_mfma_f32_16x16x32_bf16 v[56:59], a[32:35], v[32:35], v[56:59]
    ds_read_b64_tr_b16 a[122:123], v7 offset:832
    v_fma_f32 v120, v0, v0, s41
    v_mfma_f32_16x16x32_bf16 v[56:59], a[36:39], v[28:31], v[56:59]
    ds_read_b128 v[100:103], v148 offset:40960
    v_fmac_f32 v120, v1, v1
    v_mfma_f32_16x16x32_bf16 v[56:59], a[40:43], v[20:23], v[56:59]
    ds_read_b128 v[64:67], v147 offset:40960
    v_fmac_f32 v120, v2, v2
    v_mfma_f32_16x16x32_bf16 v[56:59], a[44:47], v[12:15], v[56:59]
    ds_read_b128 v[52:55], v148 offset:41088
    v_fmac_f32 v120, v3, v3
    v_mfma_f32_16x16x32_bf16 v[40:43], a[48:51], v[44:47], 0
    ds_read_b128 v[48:51], v147 offset:41088
    buffer_load_dwordx4 v121, s[32:35], s92 offen offset:1024 lds
    v_mfma_f32_16x16x32_bf16 v[40:43], a[52:55], v[36:39], v[40:43]
    s_nop 0
    ds_read_b128 v[44:47], v148 offset:41216
    v_fmac_f32 v120, v56, v56
    v_mfma_f32_16x16x32_bf16 v[40:43], a[56:59], v[32:35], v[40:43]
    ds_read_b128 v[32:35], v147 offset:41216
    v_fmac_f32 v120, v57, v57
    v_mfma_f32_16x16x32_bf16 v[40:43], a[60:63], v[28:31], v[40:43]
    v_fmac_f32 v120, v58, v58
    v_fmac_f32 v120, v59, v59
    v_mfma_f32_16x16x32_bf16 v[40:43], a[64:67], v[20:23], v[40:43]
    v_mfma_f32_16x16x32_bf16 v[40:43], a[68:71], v[12:15], v[40:43]
    s_waitcnt vmcnt(8)
    buffer_load_dwordx4 v26, s[32:35], s92 offen offset:2048 lds
    ds_read_b64_tr_b16 a[76:77], v7 offset:12288
    s_add_u32 m0, s90, 61440
    s_mov_b32 s92, 184704
    ds_read_b64_tr_b16 a[78:79], v7 offset:13056
    s_nop 0
    ds_read_b64_tr_b16 a[100:101], v7 offset:12320
    v_fmac_f32 v120, v40, v40
    ds_read_b64_tr_b16 a[102:103], v7 offset:13088
    v_fmac_f32 v120, v41, v41
    ds_read_b64_tr_b16 a[124:125], v7 offset:12352
    v_fmac_f32 v120, v42, v42
    ds_read_b64_tr_b16 a[126:127], v7 offset:13120
    v_fmac_f32 v120, v43, v43
    buffer_load_dwordx4 v149, s[32:35], s92 offen offset:0 lds
    buffer_load_dwordx4 v121, s[32:35], s92 offen offset:1024 lds
    buffer_load_dwordx4 v26, s[32:35], s92 offen offset:2048 lds
    s_add_u32 m0, s90, 0
    s_mov_b32 s92, 768
    s_waitcnt vmcnt(9)
    ds_read_b64_tr_b16 a[80:81], v7 offset:24576
    ds_read_b64_tr_b16 a[82:83], v7 offset:25344
    ds_read_b64_tr_b16 a[104:105], v7 offset:24608
    ds_read_b64_tr_b16 a[106:107], v7 offset:25376
    ds_read_b64_tr_b16 a[128:129], v7 offset:24640
    ds_read_b64_tr_b16 a[130:131], v7 offset:25408
    s_waitcnt lgkmcnt(6)
    buffer_load_dwordx4 v149, s[32:35], s92 offen offset:0 lds
    buffer_load_dwordx4 v121, s[32:35], s92 offen offset:1024 lds
    buffer_load_dwordx4 v26, s[32:35], s92 offen offset:2048 lds
    s_add_u32 m0, s90, 12288
    s_mov_b32 s92, 37632
    s_waitcnt vmcnt(9)
    ds_read_b64_tr_b16 a[84:85], v7 offset:36864
    ds_read_b64_tr_b16 a[86:87], v7 offset:37632
    ds_read_b64_tr_b16 a[108:109], v7 offset:36896
    ds_read_b64_tr_b16 a[110:111], v7 offset:37664
    ds_read_b64_tr_b16 a[132:133], v7 offset:36928
    ds_read_b64_tr_b16 a[134:135], v7 offset:37696
    buffer_load_dwordx4 v149, s[32:35], s92 offen offset:0 lds
    buffer_load_dwordx4 v121, s[32:35], s92 offen offset:1024 lds
    buffer_load_dwordx4 v26, s[32:35], s92 offen offset:2048 lds
    s_add_u32 m0, s90, 24576
    s_mov_b32 s92, 74496
    s_waitcnt vmcnt(9)
    ds_read_b64_tr_b16 a[88:89], v7 offset:49152
    ds_read_b64_tr_b16 a[90:91], v7 offset:49920
    ds_read_b64_tr_b16 a[112:113], v7 offset:49184
    ds_read_b64_tr_b16 a[114:115], v7 offset:49952
    ds_read_b64_tr_b16 a[136:137], v7 offset:49216
    ds_read_b64_tr_b16 a[138:139], v7 offset:49984
    s_waitcnt lgkmcnt(6)
    buffer_load_dwordx4 v149, s[32:35], s92 offen offset:0 lds
    buffer_load_dwordx4 v121, s[32:35], s92 offen offset:1024 lds
    buffer_load_dwordx4 v26, s[32:35], s92 offen offset:2048 lds
    s_add_u32 m0, s90, 36864
    s_mov_b32 s92, 111360
    s_waitcnt vmcnt(9)
    ds_read_b64_tr_b16 a[92:93], v7 offset:61440
    ds_read_b64_tr_b16 a[94:95], v7 offset:62208
    v_mfma_f32_16x16x32_bf16 v[36:39], a[72:75], v[100:103], 0
    ds_read_b64_tr_b16 a[116:117], v7 offset:61472
    v_mfma_f32_16x16x32_bf16 v[36:39], a[76:79], v[64:67], v[36:39]
    ds_read_b64_tr_b16 a[118:119], v7 offset:62240
    v_mfma_f32_16x16x32_bf16 v[36:39], a[80:83], v[52:55], v[36:39]
    ds_read_b64_tr_b16 a[140:141], v7 offset:61504
    v_mfma_f32_16x16x32_bf16 v[36:39], a[84:87], v[48:51], v[36:39]
    s_waitcnt lgkmcnt(5)
    buffer_load_dwordx4 v149, s[32:35], s92 offen offset:0 lds
    ds_read_b64_tr_b16 a[142:143], v7 offset:62272
    v_mfma_f32_16x16x32_bf16 v[36:39], a[88:91], v[44:47], v[36:39]
    ds_read_b128 v[96:99], v148 offset:42496
    ds_read_b128 v[80:83], v147 offset:42496
    ds_read_b128 v[28:31], v148 offset:42624
    ds_read_b128 v[20:23], v147 offset:42624
    s_waitcnt lgkmcnt(7)
    v_mfma_f32_16x16x32_bf16 v[36:39], a[92:95], v[32:35], v[36:39]
    buffer_load_dwordx4 v121, s[32:35], s92 offen offset:1024 lds
    ds_read_b128 v[60:63], v148 offset:42752
    v_mfma_f32_16x16x32_bf16 v[84:87], a[96:99], v[100:103], 0
    s_nop 1
    ds_read_b128 v[12:15], v147 offset:42752
    v_mfma_f32_16x16x32_bf16 v[84:87], a[100:103], v[64:67], v[84:87]
    s_nop 0
    v_fma_f32 v4, v36, v36, s41
    v_fmac_f32 v4, v37, v37
    v_mfma_f32_16x16x32_bf16 v[84:87], a[104:107], v[52:55], v[84:87]
    v_fmac_f32 v4, v38, v38
    v_fmac_f32 v4, v39, v39
    v_mfma_f32_16x16x32_bf16 v[84:87], a[108:111], v[48:51], v[84:87]
    v_mfma_f32_16x16x32_bf16 v[84:87], a[112:115], v[44:47], v[84:87]
    s_waitcnt vmcnt(8) lgkmcnt(4)
    buffer_load_dwordx4 v26, s[32:35], s92 offen offset:2048 lds
    ds_read_b64_tr_b16 a[144:145], v6 offset:0
    v_mfma_f32_16x16x32_bf16 v[84:87], a[116:119], v[32:35], v[84:87]
    s_add_u32 m0, s90, 49152
    ds_read_b64_tr_b16 a[146:147], v6 offset:768
    v_mfma_f32_16x16x32_bf16 v[72:75], a[120:123], v[100:103], 0
    s_mov_b32 s92, 148224
    s_nop 0
    ds_read_b64_tr_b16 a[168:169], v6 offset:8
    v_mfma_f32_16x16x32_bf16 v[72:75], a[124:127], v[64:67], v[72:75]
    s_nop 0
    v_fmac_f32 v4, v84, v84
    v_fmac_f32 v4, v85, v85
    v_mfma_f32_16x16x32_bf16 v[72:75], a[128:131], v[52:55], v[72:75]
    ds_read_b64_tr_b16 a[170:171], v6 offset:776
    v_fmac_f32 v4, v86, v86
    v_mfma_f32_16x16x32_bf16 v[72:75], a[132:135], v[48:51], v[72:75]
    buffer_load_dwordx4 v149, s[32:35], s92 offen offset:0 lds
    ds_read_b64_tr_b16 a[192:193], v7 offset:64
    v_mfma_f32_16x16x32_bf16 v[72:75], a[136:139], v[44:47], v[72:75]
    ds_read_b64_tr_b16 a[194:195], v7 offset:832
    v_fmac_f32 v4, v87, v87
    v_mfma_f32_16x16x32_bf16 v[72:75], a[140:143], v[32:35], v[72:75]
    s_nop 0
    v_mfma_f32_16x16x32_bf16 v[52:55], a[72:75], v[96:99], 0
    s_nop 2
    v_mfma_f32_16x16x32_bf16 v[52:55], a[76:79], v[80:83], v[52:55]
    s_waitcnt lgkmcnt(5)
    s_nop 0
    v_fmac_f32 v4, v72, v72
    v_fmac_f32 v4, v73, v73
    v_mfma_f32_16x16x32_bf16 v[52:55], a[80:83], v[28:31], v[52:55]
    buffer_load_dwordx4 v121, s[32:35], s92 offen offset:1024 lds
    v_fmac_f32 v4, v74, v74
    v_mfma_f32_16x16x32_bf16 v[52:55], a[84:87], v[20:23], v[52:55]
    v_fmac_f32 v4, v75, v75
    v_cvt_pk_bf16_f32 v170, v170, v4
    v_mfma_f32_16x16x32_bf16 v[52:55], a[88:91], v[60:63], v[52:55]
    v_mfma_f32_16x16x32_bf16 v[52:55], a[92:95], v[12:15], v[52:55]
    ds_read_b128 v[64:67], v148 offset:40960
    v_mfma_f32_16x16x32_bf16 v[48:51], a[96:99], v[96:99], 0
    ds_read_b128 v[32:35], v147 offset:40960
    v_mfma_f32_16x16x32_bf16 v[48:51], a[100:103], v[80:83], v[48:51]
    s_waitcnt vmcnt(8)
    buffer_load_dwordx4 v26, s[32:35], s92 offen offset:2048 lds
    ds_read_b64_tr_b16 a[148:149], v6 offset:12288
    v_mfma_f32_16x16x32_bf16 v[48:51], a[104:107], v[28:31], v[48:51]
    s_add_u32 m0, s90, 61440
    v_fma_f32 v79, v52, v52, s41
    v_fmac_f32 v79, v53, v53
    v_mfma_f32_16x16x32_bf16 v[48:51], a[108:111], v[20:23], v[48:51]
    s_mov_b32 s92, 185088
    ds_read_b64_tr_b16 a[150:151], v6 offset:13056
    v_fmac_f32 v79, v54, v54
    v_mfma_f32_16x16x32_bf16 v[48:51], a[112:115], v[60:63], v[48:51]
    ds_read_b64_tr_b16 a[172:173], v6 offset:12296
    v_fmac_f32 v79, v55, v55
    v_mfma_f32_16x16x32_bf16 v[48:51], a[116:119], v[12:15], v[48:51]
    ds_read_b64_tr_b16 a[174:175], v6 offset:13064
    v_mfma_f32_16x16x32_bf16 v[44:47], a[120:123], v[96:99], 0
    s_nop 0
    buffer_load_dwordx4 v149, s[32:35], s92 offen offset:0 lds
    ds_read_b64_tr_b16 a[196:197], v7 offset:12352
    v_mfma_f32_16x16x32_bf16 v[44:47], a[124:127], v[80:83], v[44:47]
    s_nop 0
    ds_read_b64_tr_b16 a[198:199], v7 offset:13120
    v_fmac_f32 v79, v48, v48
    v_mfma_f32_16x16x32_bf16 v[44:47], a[128:131], v[28:31], v[44:47]
    ds_read_b128 v[28:31], v148 offset:41088
    v_fmac_f32 v79, v49, v49
    v_mfma_f32_16x16x32_bf16 v[44:47], a[132:135], v[20:23], v[44:47]
    ds_read_b128 v[20:23], v147 offset:41088
    v_fmac_f32 v79, v50, v50
    v_mfma_f32_16x16x32_bf16 v[44:47], a[136:139], v[60:63], v[44:47]
    ds_read_b128 v[60:63], v148 offset:41216
    v_fmac_f32 v79, v51, v51
    v_mfma_f32_16x16x32_bf16 v[44:47], a[140:143], v[12:15], v[44:47]
    s_nop 0
    buffer_load_dwordx4 v121, s[32:35], s92 offen offset:1024 lds
    ds_read_b128 v[12:15], v147 offset:41216
    v_mfma_f32_16x16x16_bf16 v[80:83], v[216:217], v[170:171], 0
    s_nop 0
    v_mov_b32 v254, 0
    v_mov_b32 v255, 0
    v_mov_b32 v253, 0
    v_fmac_f32 v79, v44, v44
    v_fmac_f32 v79, v45, v45
    v_fmac_f32 v79, v46, v46
    v_fmac_f32 v79, v47, v47
    v_rsq_f32 v80, v80
    v_rsq_f32 v81, v81
    v_mul_f32 v80, s55, v80
    v_mul_f32 v81, 0.5, v81
    v_mul_f32 v68, v68, v80
    buffer_load_dwordx4 v26, s[32:35], s92 offen offset:2048 lds
    s_add_u32 m0, s90, 0
    s_mov_b32 s92, 0
    s_waitcnt vmcnt(9)
    ds_read_b64_tr_b16 a[152:153], v6 offset:24576
    v_mul_f32 v69, v69, v80
    v_cvt_pk_f16_f32 v68, v68, v69
    v_mul_f32 v70, v70, v80
    ds_read_b64_tr_b16 a[154:155], v6 offset:25344
    v_mul_f32 v71, v71, v80
    v_cvt_pk_f16_f32 v69, v70, v71
    v_mul_f32 v92, v92, v80
    ds_read_b64_tr_b16 a[176:177], v6 offset:24584
    v_mul_f32 v93, v93, v80
    v_cvt_pk_f16_f32 v70, v92, v93
    s_waitcnt lgkmcnt(3)
    buffer_load_dwordx4 v27, s[76:79], s92 offen offset:0 lds
    ds_read_b64_tr_b16 a[178:179], v6 offset:25352
    v_mul_f32 v94, v94, v80
    v_mul_f32 v95, v95, v80
    v_cvt_pk_f16_f32 v71, v94, v95
    ds_read_b64_tr_b16 a[200:201], v7 offset:24640
    v_mul_f32 v88, v88, v80
    ds_read_b64_tr_b16 a[202:203], v7 offset:25408
    v_mul_f32 v89, v89, v80
    v_cvt_pk_f16_f32 v76, v88, v89
    v_mul_f32 v90, v90, v80
    v_mul_f32 v91, v91, v80
    v_cvt_pk_f16_f32 v77, v90, v91
    v_mul_f32 v36, v36, v81
    buffer_load_dwordx4 v146, s[76:79], s92 offen offset:1024 lds
    v_mul_f32 v37, v37, v81
    v_cvt_pk_f16_f32 v36, v36, v37
    v_mul_f32 v38, v38, v81
    v_mul_f32 v39, v39, v81
    v_cvt_pk_f16_f32 v37, v38, v39
    v_mul_f32 v84, v84, v81
    v_mul_f32 v85, v85, v81
    v_cvt_pk_f16_f32 v38, v84, v85
    v_mul_f32 v86, v86, v81
    v_mul_f32 v87, v87, v81
    v_cvt_pk_f16_f32 v39, v86, v87
    v_mul_f32 v72, v72, v81
    v_mul_f32 v73, v73, v81
    v_cvt_pk_f16_f32 v4, v72, v73
    v_mul_f32 v74, v74, v81
    v_mul_f32 v75, v75, v81
    v_cvt_pk_f16_f32 v5, v74, v75
    buffer_load_dwordx4 v78, s[76:79], s92 offen offset:2048 lds
    s_add_u32 m0, s90, 12288
    s_mov_b32 s92, 12288
    s_waitcnt vmcnt(9)
    ds_read_b64_tr_b16 a[156:157], v6 offset:36864
    v_fma_mix_f32 v252, v68, v36, 0 op_sel:[0,0,0] op_sel_hi:[1,1,0]
    v_fma_mix_f32 v252, v68, v36, v252 op_sel:[1,1,0] op_sel_hi:[1,1,0]
    v_fma_mix_f32 v252, v69, v37, v252 op_sel:[0,0,0] op_sel_hi:[1,1,0]
    ds_read_b64_tr_b16 a[158:159], v6 offset:37632
    v_fma_mix_f32 v252, v69, v37, v252 op_sel:[1,1,0] op_sel_hi:[1,1,0]
    v_fma_mix_f32 v252, v70, v38, v252 op_sel:[0,0,0] op_sel_hi:[1,1,0]
    v_fma_mix_f32 v252, v70, v38, v252 op_sel:[1,1,0] op_sel_hi:[1,1,0]
    ds_read_b64_tr_b16 a[180:181], v6 offset:36872
    v_fma_mix_f32 v252, v71, v39, v252 op_sel:[0,0,0] op_sel_hi:[1,1,0]
    v_fma_mix_f32 v252, v71, v39, v252 op_sel:[1,1,0] op_sel_hi:[1,1,0]
    buffer_load_dwordx4 v27, s[76:79], s92 offen offset:0 lds
    ds_read_b64_tr_b16 a[182:183], v6 offset:37640
    v_fma_mix_f32 v252, v76, v4, v252 op_sel:[0,0,0] op_sel_hi:[1,1,0]
    v_fma_mix_f32 v252, v76, v4, v252 op_sel:[1,1,0] op_sel_hi:[1,1,0]
    v_fma_mix_f32 v252, v77, v5, v252 op_sel:[0,0,0] op_sel_hi:[1,1,0]
    ds_read_b64_tr_b16 a[204:205], v7 offset:36928
    v_fma_mix_f32 v252, v77, v5, v252 op_sel:[1,1,0] op_sel_hi:[1,1,0]
    ds_read_b64_tr_b16 a[206:207], v7 offset:37696
    v_mov_b32 v26, v252
    v_add_u32 v149, 28672, v156
    ds_write_b128 v149, v[36:39]
    buffer_load_dwordx4 v146, s[76:79], s92 offen offset:1024 lds
    v_permlane32_swap_b32 v26, v252
    v_add_f32 v252, v26, v252
    v_mov_b32 v26, v252
    v_cvt_pk_bf16_f32 v170, v120, v79
    s_nop 0
    v_permlane16_swap_b32 v26, v252
    v_mfma_f32_16x16x16_bf16 v[36:39], v[216:217], v[170:171], 0
    s_waitcnt vmcnt(8)
    ds_write2_b64 v149, v[254:255], v[254:255] offset0:2 offset1:3
    v_add_f32 v252, v26, v252
    buffer_load_dwordx4 v78, s[76:79], s92 offen offset:2048 lds
    s_add_u32 m0, s90, 24576
    s_mov_b32 s92, 24576
    v_and_b32 v26, 0xffff0000, v252
    v_sub_f32 v252, v252, v26
    ds_read_b64_tr_b16 a[160:161], v6 offset:49152
    v_cvt_pk_bf16_f32 v252, v252, v26
    v_rsq_f32 v36, v36
    ds_read_b64_tr_b16 a[162:163], v6 offset:49920
    v_rsq_f32 v37, v37
    v_mul_f32 v36, s55, v36
    s_waitcnt lgkmcnt(3)
    buffer_load_dwordx4 v27, s[76:79], s92 offen offset:0 lds
    ds_read_b64_tr_b16 a[184:185], v6 offset:49160
    v_mul_f32 v37, 0.5, v37
    v_mul_f32 v0, v0, v36
    v_mul_f32 v1, v1, v36
    ds_read_b64_tr_b16 a[186:187], v6 offset:49928
    v_cvt_pk_f16_f32 v0, v0, v1
    v_mul_f32 v2, v2, v36
    v_mul_f32 v3, v3, v36
    ds_read_b64_tr_b16 a[208:209], v7 offset:49216
    v_cvt_pk_f16_f32 v1, v2, v3
    ds_read_b64_tr_b16 a[210:211], v7 offset:49984
    v_mul_f32 v56, v56, v36
    buffer_load_dwordx4 v146, s[76:79], s92 offen offset:1024 lds
    ds_write_b128 v149, v[68:71] offset:32
    v_mul_f32 v57, v57, v36
    v_cvt_pk_f16_f32 v2, v56, v57
    v_mul_f32 v58, v58, v36
    v_mul_f32 v59, v59, v36
    v_cvt_pk_f16_f32 v3, v58, v59
    v_mul_f32 v40, v40, v36
    v_mul_f32 v41, v41, v36
    v_cvt_pk_f16_f32 v120, v40, v41
    ds_write2_b64 v149, v[4:5], v[254:255] offset0:6 offset1:7
    buffer_load_dwordx4 v78, s[76:79], s92 offen offset:2048 lds
    s_add_u32 m0, s90, 36864
    s_mov_b32 s92, 36864
    v_mul_f32 v42, v42, v36
    v_mul_f32 v43, v43, v36
    v_cvt_pk_f16_f32 v121, v42, v43
    v_mul_f32 v52, v52, v37
    v_mul_f32 v53, v53, v37
    s_waitcnt vmcnt(9)
    ds_read_b64_tr_b16 a[164:165], v6 offset:61440
    v_cvt_pk_f16_f32 v4, v52, v53
    v_mul_f32 v54, v54, v37
    v_mul_f32 v55, v55, v37
    ds_read_b64_tr_b16 a[166:167], v6 offset:62208
    v_mfma_f32_16x16x32_bf16 v[40:43], a[144:147], v[64:67], 0
    buffer_load_dwordx4 v27, s[76:79], s92 offen offset:0 lds
    ds_read_b64_tr_b16 a[188:189], v6 offset:61448
    v_mfma_f32_16x16x32_bf16 v[40:43], a[148:151], v[32:35], v[40:43]
    v_cvt_pk_f16_f32 v5, v54, v55
    v_mul_f32 v48, v48, v37
    v_mfma_f32_16x16x32_bf16 v[40:43], a[152:155], v[28:31], v[40:43]
    ds_read_b64_tr_b16 a[190:191], v6 offset:62216
    v_mul_f32 v49, v49, v37
    v_mfma_f32_16x16x32_bf16 v[40:43], a[156:159], v[20:23], v[40:43]
    s_waitcnt lgkmcnt(4)
    ds_read_b64_tr_b16 a[212:213], v7 offset:61504
    v_cvt_pk_f16_f32 v6, v48, v49
    v_mfma_f32_16x16x32_bf16 v[40:43], a[160:163], v[60:63], v[40:43]
    ds_read_b64_tr_b16 a[214:215], v7 offset:62272
    v_mul_f32 v50, v50, v37
    v_mul_f32 v51, v51, v37
    v_cvt_pk_f16_f32 v7, v50, v51
    buffer_load_dwordx4 v146, s[76:79], s92 offen offset:1024 lds
    ds_write2_b64 v149, v[254:255], v[76:77] offset0:8 offset1:9
    v_mul_f32 v44, v44, v37
    v_mul_f32 v45, v45, v37
    v_cvt_pk_f16_f32 v254, v44, v45
    v_mul_f32 v46, v46, v37
    s_waitcnt lgkmcnt(5)
    v_mfma_f32_16x16x32_bf16 v[40:43], a[164:167], v[12:15], v[40:43]
    v_mul_f32 v47, v47, v37
    v_cvt_pk_f16_f32 v255, v46, v47
    v_mfma_f32_16x16x32_bf16 v[52:55], a[168:171], v[64:67], 0
    buffer_load_dwordx4 v78, s[76:79], s92 offen offset:2048 lds
    ds_read_b128 v[48:51], v148 offset:42496
    v_mfma_f32_16x16x32_bf16 v[52:55], a[172:175], v[32:35], v[52:55]
    s_add_u32 m0, s90, 49152
    v_fma_mix_f32 v26, v0, v4, 0 op_sel:[0,0,0] op_sel_hi:[1,1,0]
    v_fma_mix_f32 v26, v0, v4, v26 op_sel:[1,1,0] op_sel_hi:[1,1,0]
    v_mfma_f32_16x16x32_bf16 v[52:55], a[176:179], v[28:31], v[52:55]
    s_mov_b32 s92, 49152
    ds_write_b64 v149, v[252:253] offset:88
    v_mfma_f32_16x16x32_bf16 v[52:55], a[180:183], v[20:23], v[52:55]
    s_lshl_b32 s93, s68, 10
    v_fma_mix_f32 v26, v1, v5, v26 op_sel:[0,0,0] op_sel_hi:[1,1,0]
    v_fma_mix_f32 v26, v1, v5, v26 op_sel:[1,1,0] op_sel_hi:[1,1,0]
    v_mfma_f32_16x16x32_bf16 v[52:55], a[184:187], v[60:63], v[52:55]
    s_waitcnt lgkmcnt(3)
    s_mov_b32 s53, s47
    ds_read_b128 v[44:47], v147 offset:42496
    v_fma_mix_f32 v26, v2, v6, v26 op_sel:[0,0,0] op_sel_hi:[1,1,0]
    v_mfma_f32_16x16x32_bf16 v[52:55], a[188:191], v[12:15], v[52:55]
    s_mov_b32 s47, s46
    buffer_load_dwordx4 v27, s[76:79], s92 offen offset:0 lds
    ds_read_b128 v[36:39], v148 offset:42624
    v_mfma_f32_16x16x32_bf16 v[56:59], a[192:195], v[64:67], 0
    s_mov_b32 s46, s45
    v_fma_mix_f32 v26, v2, v6, v26 op_sel:[1,1,0] op_sel_hi:[1,1,0]
    v_fma_mix_f32 v26, v3, v7, v26 op_sel:[0,0,0] op_sel_hi:[1,1,0]
    v_mfma_f32_16x16x32_bf16 v[56:59], a[196:199], v[32:35], v[56:59]
    s_mov_b32 s45, s44
    ds_read_b128 v[32:35], v147 offset:42624
    v_fma_mix_f32 v26, v3, v7, v26 op_sel:[1,1,0] op_sel_hi:[1,1,0]
    v_mfma_f32_16x16x32_bf16 v[56:59], a[200:203], v[28:31], v[56:59]
    s_mov_b32 s44, s53
    ds_read_b128 v[28:31], v148 offset:42752
    v_fma_mix_f32 v26, v120, v254, v26 op_sel:[0,0,0] op_sel_hi:[1,1,0]
    v_mfma_f32_16x16x32_bf16 v[56:59], a[204:207], v[20:23], v[56:59]
    s_sub_u32 s48, s44, s46
    ds_read_b128 v[20:23], v147 offset:42752
    v_fma_mix_f32 v26, v120, v254, v26 op_sel:[1,1,0] op_sel_hi:[1,1,0]
    v_mfma_f32_16x16x32_bf16 v[56:59], a[208:211], v[60:63], v[56:59]
    s_sub_u32 s49, s46, s45
    buffer_load_dwordx4 v146, s[76:79], s92 offen offset:1024 lds
    v_fma_mix_f32 v26, v121, v255, v26 op_sel:[0,0,0] op_sel_hi:[1,1,0]
    v_mfma_f32_16x16x32_bf16 v[56:59], a[212:215], v[12:15], v[56:59]
    s_waitcnt lgkmcnt(5)
    v_fma_mix_f32 v26, v121, v255, v26 op_sel:[1,1,0] op_sel_hi:[1,1,0]
    v_mov_b32 v147, v26
    v_mfma_f32_16x16x32_bf16 v[12:15], a[144:147], v[48:51], 0
    s_waitcnt lgkmcnt(4)
    v_permlane32_swap_b32 v147, v26
    v_add_f32 v26, v147, v26
    v_mfma_f32_16x16x32_bf16 v[12:15], a[148:151], v[44:47], v[12:15]
    s_waitcnt lgkmcnt(3)
    v_mov_b32 v147, v26
    v_cvt_pk_bf16_f32 v148, v40, v41
    v_cvt_pk_bf16_f32 v149, v42, v43
    v_mfma_f32_16x16x32_bf16 v[12:15], a[152:155], v[36:39], v[12:15]
    s_waitcnt lgkmcnt(2)
    ds_write_b64 v156, v[148:149] offset:28752
    buffer_load_dwordx4 v78, s[76:79], s92 offen offset:2048 lds
    s_add_u32 m0, s90, 61440
    v_mfma_f32_16x16x32_bf16 v[12:15], a[156:159], v[32:35], v[12:15]
    s_waitcnt lgkmcnt(2)
    s_mov_b32 s92, 61440
    v_permlane16_swap_b32 v147, v26
    v_mfma_f32_16x16x32_bf16 v[12:15], a[160:163], v[28:31], v[12:15]
    s_waitcnt lgkmcnt(1)
    v_add_f32 v26, v147, v26
    v_and_b32 v147, 0xffff0000, v26
    v_mfma_f32_16x16x32_bf16 v[12:15], a[164:167], v[20:23], v[12:15]
    v_sub_f32 v26, v26, v147
    v_cvt_pk_bf16_f32 v26, v26, v147
    v_mfma_f32_16x16x32_bf16 v[40:43], a[168:171], v[48:51], 0
    v_cvt_pk_bf16_f32 v52, v52, v53
    v_cvt_pk_bf16_f32 v53, v54, v55
    v_mfma_f32_16x16x32_bf16 v[40:43], a[172:175], v[44:47], v[40:43]
    buffer_load_dwordx4 v27, s[76:79], s92 offen offset:0 lds
    v_cvt_pk_bf16_f32 v54, v56, v57
    v_mfma_f32_16x16x32_bf16 v[40:43], a[176:179], v[36:39], v[40:43]
    v_cvt_pk_bf16_f32 v55, v58, v59
    v_cvt_pk_bf16_f32 v246, v12, v13
    v_mfma_f32_16x16x32_bf16 v[40:43], a[180:183], v[32:35], v[40:43]
    ds_write_b128 v156, v[52:55] offset:28768
    v_mfma_f32_16x16x32_bf16 v[40:43], a[184:187], v[28:31], v[40:43]
    v_cvt_pk_bf16_f32 v247, v14, v15
    v_add_u32 v27, s93, v129
    v_mfma_f32_16x16x32_bf16 v[40:43], a[188:191], v[20:23], v[40:43]
    buffer_load_dwordx4 v146, s[76:79], s92 offen offset:1024 lds
    v_add_u32 v137, s48, v137
    v_mfma_f32_16x16x32_bf16 v[12:15], a[192:195], v[48:51], 0
    s_nop 0
    v_add_u32 v136, s48, v136
    s_nop 0
    v_mfma_f32_16x16x32_bf16 v[12:15], a[196:199], v[44:47], v[12:15]
    s_nop 0
    v_cvt_pk_bf16_f32 v76, v40, v41
    v_cvt_pk_bf16_f32 v77, v42, v43
    v_mfma_f32_16x16x32_bf16 v[12:15], a[200:203], v[36:39], v[12:15]
    v_mfma_f32_16x16x32_bf16 v[12:15], a[204:207], v[32:35], v[12:15]
    v_mfma_f32_16x16x32_bf16 v[12:15], a[208:211], v[28:31], v[12:15]
    buffer_load_dwordx4 v78, s[76:79], s92 offen offset:2048 lds
    v_mfma_f32_16x16x32_bf16 v[12:15], a[212:215], v[20:23], v[12:15]
    s_add_u32 m0, s54, 20480
    s_nop 6
    v_cvt_pk_bf16_f32 v78, v12, v13
    v_cvt_pk_bf16_f32 v79, v14, v15
    buffer_load_dwordx4 v128, s[24:27], s56 offen nt lds
    s_add_u32 m0, s54, 21504
    s_nop 0
    buffer_load_dwordx4 v127, s[24:27], s56 offen nt lds
    s_add_u32 m0, s54, 22528
    s_nop 0
    buffer_load_dwordx4 v126, s[24:27], s56 offen nt lds
    s_add_u32 m0, s54, 23552
    s_nop 0
    buffer_load_dwordx4 v125, s[24:27], s56 offen nt lds
    s_add_u32 m0, s54, 24576
    s_nop 0
    buffer_load_dwordx4 v124, s[24:27], s56 offen nt lds
    s_waitcnt vmcnt(5)
    s_barrier
    ds_read_b128 v[36:39], v17 offset:0
    ds_read_b64 v[12:13], v16 offset:64
    ds_read_b128 v[20:23], v17 offset:3072
    ds_read_b64 v[14:15], v16 offset:3136
    ds_read_b128 v[48:51], v17 offset:6144
    ds_read_b64 v[40:41], v16 offset:6208
    ds_read_b128 v[32:35], v17 offset:9216
    ds_read_b64 v[42:43], v16 offset:9280
    ds_read_b128 v[44:47], v17 offset:12288
    ds_read_b64 v[52:53], v16 offset:12352
    ds_read_b128 v[28:31], v17 offset:15360
    ds_read_b64 v[54:55], v16 offset:15424
    s_waitcnt lgkmcnt(11)
    v_mfma_f32_16x16x32_bf16 v[56:59], v[36:39], v[220:223], 0
    s_waitcnt lgkmcnt(9)
    ds_read_b128 v[36:39], v17 offset:18432
    v_mfma_f32_16x16x32_bf16 v[56:59], v[20:23], v[220:223], v[56:59]
    s_waitcnt lgkmcnt(8)
    ds_read_b64 v[20:21], v16 offset:18496
    ds_read_b128 v[60:63], v17 offset:21504
    v_mfma_f32_16x16x32_bf16 v[56:59], v[48:51], v[220:223], v[56:59]
    s_waitcnt lgkmcnt(8)
    ds_read_b64 v[22:23], v16 offset:21568
    ds_read_b128 v[48:51], v17 offset:24576
    v_mfma_f32_16x16x32_bf16 v[56:59], v[32:35], v[220:223], v[56:59]
    ds_read_b64 v[32:33], v16 offset:24640
    v_mfma_f32_16x16x32_bf16 v[56:59], v[12:15], v[220:223], v[56:59]
    s_waitcnt lgkmcnt(9)
    ds_read_b128 v[12:15], v17 offset:27648
    v_mfma_f32_16x16x32_bf16 v[56:59], v[40:43], v[220:223], v[56:59]
    ds_read_b64 v[34:35], v16 offset:27712
    v_mfma_f32_16x16x32_bf16 v[40:43], v[44:47], v[220:223], 0
    s_waitcnt lgkmcnt(8)
    ds_read_b128 v[44:47], v17 offset:30720
    v_mfma_f32_16x16x32_bf16 v[40:43], v[28:31], v[220:223], v[40:43]
    s_waitcnt lgkmcnt(8)
    s_nop 0
    ds_read_b64 v[28:29], v16 offset:30784
    v_mul_f32 v56, 0xbbaaaaab, v56
    v_mfma_f32_16x16x32_bf16 v[40:43], v[36:39], v[220:223], v[40:43]
    s_waitcnt lgkmcnt(7)
    ds_read_b128 v[36:39], v17 offset:33792
    v_mul_f32 v57, 0xbbaaaaab, v57
    v_mul_f32 v58, 0xbbaaaaab, v58
    v_mul_f32 v59, 0xbbaaaaab, v59
    v_mfma_f32_16x16x32_bf16 v[40:43], v[60:63], v[220:223], v[40:43]
    ds_write_b128 v25, v[56:59] offset:0
    v_mfma_f32_16x16x32_bf16 v[40:43], v[52:55], v[220:223], v[40:43]
    s_waitcnt lgkmcnt(6)
    v_mfma_f32_16x16x32_bf16 v[40:43], v[20:23], v[220:223], v[40:43]
    v_mfma_f32_16x16x32_bf16 v[20:23], v[48:51], v[220:223], 0
    s_waitcnt lgkmcnt(4)
    ds_read_b64 v[30:31], v16 offset:33856
    s_nop 0
    v_mfma_f32_16x16x32_bf16 v[20:23], v[12:15], v[220:223], v[20:23]
    s_waitcnt lgkmcnt(4)
    s_nop 0
    ds_read_b128 v[12:15], v24 offset:0
    v_mul_f32 v40, 0xbbaaaaab, v40
    v_mfma_f32_16x16x32_bf16 v[20:23], v[44:47], v[220:223], v[20:23]
    s_waitcnt lgkmcnt(3)
    ds_read_b64 v[16:17], v19 offset:64
    v_mul_f32 v41, 0xbbaaaaab, v41
    v_mul_f32 v42, 0xbbaaaaab, v42
    v_mul_f32 v43, 0xbbaaaaab, v43
    v_mfma_f32_16x16x32_bf16 v[20:23], v[36:39], v[220:223], v[20:23]
    ds_write_b128 v25, v[40:43] offset:128
    v_mfma_f32_16x16x32_bf16 v[20:23], v[32:35], v[220:223], v[20:23]
    ds_read_b128 v[70:73], v24 offset:768
    ds_read_b64 v[74:75], v19 offset:832
    ds_read_b128 v[64:67], v24 offset:12288
    s_waitcnt lgkmcnt(6)
    v_mfma_f32_16x16x32_bf16 v[20:23], v[28:31], v[220:223], v[20:23]
    s_nop 0
    ds_read_b64 v[68:69], v19 offset:12352
    s_nop 0
    ds_read_b128 v[104:107], v24 offset:13056
    s_nop 2
    ds_read_b64 v[108:109], v19 offset:13120
    v_mul_f32 v20, 0xbbaaaaab, v20
    v_mul_f32 v21, 0xbbaaaaab, v21
    v_mul_f32 v22, 0xbbaaaaab, v22
    v_mul_f32 v23, 0xbbaaaaab, v23
    ds_write_b128 v25, v[20:23] offset:256
    s_waitcnt lgkmcnt(0)
    s_barrier
    ds_read_b128 v[40:43], v18 offset:0
    ds_read_b128 v[28:31], v18 offset:64
    ds_read_b128 v[36:39], v18 offset:128
    ds_read_b128 v[56:59], v18 offset:192
    s_waitcnt lgkmcnt(3)
    v_mfma_f32_16x16x16_bf16 v[32:35], v[12:13], v[168:169], v[40:43]
    v_mfma_f32_16x16x16_bf16 v[20:23], v[14:15], v[168:169], v[40:43]
    s_nop 2
    v_mfma_f32_16x16x16_bf16 v[60:63], v[16:17], v[168:169], v[40:43]
    s_waitcnt lgkmcnt(0)
    s_nop 0
    ds_read_b128 v[12:15], v24 offset:24576
    v_cvt_pk_bf16_f32 v32, v32, v33
    v_mfma_f32_16x16x16_bf16 v[52:55], v[70:71], v[168:169], v[28:31]
    ds_read_b64 v[16:17], v19 offset:24640
    v_accvgpr_write_b32 a216, v32
    v_mfma_f32_16x16x16_bf16 v[44:47], v[72:73], v[168:169], v[28:31]
    ds_read_b128 v[48:51], v18 offset:256
    v_cvt_pk_bf16_f32 v34, v34, v35
    v_mfma_f32_16x16x16_bf16 v[40:43], v[74:75], v[168:169], v[28:31]
    ds_read_b128 v[98:101], v24 offset:25344
    v_accvgpr_write_b32 a217, v34
    v_mfma_f32_16x16x16_bf16 v[84:87], v[64:65], v[168:169], v[36:39]
    ds_read_b64 v[102:103], v19 offset:25408
    v_cvt_pk_bf16_f32 v20, v20, v21
    v_mfma_f32_16x16x16_bf16 v[32:35], v[66:67], v[168:169], v[36:39]
    ds_read_b128 v[80:83], v18 offset:320
    v_accvgpr_write_b32 a240, v20
    v_mfma_f32_16x16x16_bf16 v[28:31], v[68:69], v[168:169], v[36:39]
    ds_read_b128 v[92:95], v24 offset:36864
    v_cvt_pk_bf16_f32 v22, v22, v23
    v_mfma_f32_16x16x16_bf16 v[68:71], v[104:105], v[168:169], v[56:59]
    ds_read_b64 v[96:97], v19 offset:36928
    v_accvgpr_write_b32 a241, v22
    v_mfma_f32_16x16x16_bf16 v[36:39], v[106:107], v[168:169], v[56:59]
    ds_read_b128 v[64:67], v18 offset:5120
    v_cvt_pk_bf16_f32 v232, v60, v61
    v_mfma_f32_16x16x16_bf16 v[20:23], v[108:109], v[168:169], v[56:59]
    s_waitcnt lgkmcnt(6)
    ds_read_b128 v[110:113], v24 offset:37632
    v_cvt_pk_bf16_f32 v233, v62, v63
    v_cvt_pk_bf16_f32 v52, v52, v53
    v_accvgpr_write_b32 a218, v52
    v_cvt_pk_bf16_f32 v54, v54, v55
    v_accvgpr_write_b32 a219, v54
    v_cvt_pk_bf16_f32 v44, v44, v45
    v_mfma_f32_16x16x16_bf16 v[88:91], v[12:13], v[168:169], v[48:51]
    ds_read_b64 v[114:115], v19 offset:37696
    v_accvgpr_write_b32 a242, v44
    v_mfma_f32_16x16x16_bf16 v[56:59], v[14:15], v[168:169], v[48:51]
    ds_read_b128 v[60:63], v18 offset:5184
    v_cvt_pk_bf16_f32 v46, v46, v47
    v_mfma_f32_16x16x16_bf16 v[52:55], v[16:17], v[168:169], v[48:51]
    s_waitcnt lgkmcnt(6)
    ds_read_b128 v[12:15], v24 offset:49152
    v_accvgpr_write_b32 a243, v46
    v_cvt_pk_bf16_f32 v234, v40, v41
    v_cvt_pk_bf16_f32 v235, v42, v43
    v_mfma_f32_16x16x16_bf16 v[48:51], v[98:99], v[168:169], v[80:83]
    ds_read_b64 v[16:17], v19 offset:49216
    v_cvt_pk_bf16_f32 v84, v84, v85
    v_mfma_f32_16x16x16_bf16 v[44:47], v[100:101], v[168:169], v[80:83]
    ds_read_b128 v[72:75], v18 offset:5248
    v_accvgpr_write_b32 a220, v84
    v_mfma_f32_16x16x16_bf16 v[40:43], v[102:103], v[168:169], v[80:83]
    s_waitcnt lgkmcnt(6)
    ds_read_b128 v[104:107], v24 offset:49920
    v_cvt_pk_bf16_f32 v86, v86, v87
    v_accvgpr_write_b32 a221, v86
    v_cvt_pk_bf16_f32 v32, v32, v33
    v_accvgpr_write_b32 a244, v32
    v_cvt_pk_bf16_f32 v34, v34, v35
    v_accvgpr_write_b32 a245, v34
    v_cvt_pk_bf16_f32 v236, v28, v29
    v_cvt_pk_bf16_f32 v237, v30, v31
    v_mfma_f32_16x16x16_bf16 v[84:87], v[92:93], v[168:169], v[64:67]
    ds_read_b64 v[108:109], v19 offset:49984
    v_cvt_pk_bf16_f32 v68, v68, v69
    v_mfma_f32_16x16x16_bf16 v[28:31], v[94:95], v[168:169], v[64:67]
    ds_read_b128 v[100:103], v18 offset:5312
    v_accvgpr_write_b32 a222, v68
    v_mfma_f32_16x16x16_bf16 v[32:35], v[96:97], v[168:169], v[64:67]
    s_waitcnt lgkmcnt(5)
    ds_read_b128 v[92:95], v24 offset:61440
    v_cvt_pk_bf16_f32 v70, v70, v71
    v_accvgpr_write_b32 a223, v70
    v_cvt_pk_bf16_f32 v36, v36, v37
    v_accvgpr_write_b32 a246, v36
    v_cvt_pk_bf16_f32 v38, v38, v39
    v_accvgpr_write_b32 a247, v38
    v_cvt_pk_bf16_f32 v238, v20, v21
    v_cvt_pk_bf16_f32 v239, v22, v23
    v_mfma_f32_16x16x16_bf16 v[36:39], v[110:111], v[168:169], v[60:63]
    ds_read_b64 v[96:97], v19 offset:61504
    v_cvt_pk_bf16_f32 v88, v88, v89
    v_mfma_f32_16x16x16_bf16 v[68:71], v[112:113], v[168:169], v[60:63]
    ds_read_b128 v[80:83], v18 offset:5376
    v_accvgpr_write_b32 a224, v88
    v_mfma_f32_16x16x16_bf16 v[64:67], v[114:115], v[168:169], v[60:63]
    s_waitcnt lgkmcnt(5)
    ds_read_b128 v[20:23], v24 offset:62208
    v_cvt_pk_bf16_f32 v90, v90, v91
    v_accvgpr_write_b32 a225, v90
    v_cvt_pk_bf16_f32 v56, v56, v57
    v_accvgpr_write_b32 a248, v56
    v_cvt_pk_bf16_f32 v58, v58, v59
    v_accvgpr_write_b32 a249, v58
    v_cvt_pk_bf16_f32 v240, v52, v53
    v_cvt_pk_bf16_f32 v241, v54, v55
    v_mfma_f32_16x16x16_bf16 v[60:63], v[12:13], v[168:169], v[72:75]
    ds_read_b64 v[24:25], v19 offset:62272
    v_cvt_pk_bf16_f32 v48, v48, v49
    v_mfma_f32_16x16x16_bf16 v[56:59], v[14:15], v[168:169], v[72:75]
    ds_read_b128 v[12:15], v18 offset:5440
    v_accvgpr_write_b32 a226, v48
    v_mfma_f32_16x16x16_bf16 v[52:55], v[16:17], v[168:169], v[72:75]
    s_waitcnt lgkmcnt(5)
    ds_read_b128 v[16:19], v137 offset:0
    v_cvt_pk_bf16_f32 v50, v50, v51
    v_accvgpr_write_b32 a227, v50
    v_cvt_pk_bf16_f32 v44, v44, v45
    v_accvgpr_write_b32 a250, v44
    v_cvt_pk_bf16_f32 v46, v46, v47
    v_accvgpr_write_b32 a251, v46
    v_cvt_pk_bf16_f32 v242, v40, v41
    v_cvt_pk_bf16_f32 v243, v42, v43
    v_mfma_f32_16x16x16_bf16 v[48:51], v[104:105], v[168:169], v[100:103]
    ds_read_b128 v[146:149], v136 offset:0
    v_cvt_pk_bf16_f32 v84, v84, v85
    v_mfma_f32_16x16x16_bf16 v[40:43], v[106:107], v[168:169], v[100:103]
    ds_read_b128 v[72:75], v137 offset:128
    v_accvgpr_write_b32 a228, v84
    v_mfma_f32_16x16x16_bf16 v[44:47], v[108:109], v[168:169], v[100:103]
    s_waitcnt lgkmcnt(5)
    ds_read_b128 v[88:91], v136 offset:128
    v_cvt_pk_bf16_f32 v86, v86, v87
    v_accvgpr_write_b32 a229, v86
    v_cvt_pk_bf16_f32 v28, v28, v29
    v_accvgpr_write_b32 a252, v28
    v_cvt_pk_bf16_f32 v30, v30, v31
    v_accvgpr_write_b32 a253, v30
    v_cvt_pk_bf16_f32 v244, v32, v33
    v_cvt_pk_bf16_f32 v245, v34, v35
    v_mfma_f32_16x16x16_bf16 v[32:35], v[92:93], v[168:169], v[80:83]
    s_waitcnt vmcnt(0) lgkmcnt(4)
    s_barrier
    ds_write_b128 v27, v[8:11] offset:6144
    v_mfma_f32_16x16x16_bf16 v[8:11], v[94:95], v[168:169], v[80:83]
    v_cvt_pk_bf16_f32 v36, v36, v37
    v_accvgpr_write_b32 a230, v36
    v_mfma_f32_16x16x16_bf16 v[28:31], v[96:97], v[168:169], v[80:83]
    s_waitcnt lgkmcnt(4)
    v_cvt_pk_bf16_f32 v38, v38, v39
    v_accvgpr_write_b32 a231, v38
    v_cvt_pk_bf16_f32 v68, v68, v69
    v_mfma_f32_16x16x32_bf16 v[36:39], a[0:3], v[16:19], 0
    s_waitcnt lgkmcnt(3)
    ds_write_b64 v156, v[246:247] offset:80
    v_mfma_f32_16x16x32_bf16 v[36:39], a[4:7], v[146:149], v[36:39]
    s_waitcnt lgkmcnt(3)
    v_accvgpr_write_b32 a254, v68
    v_cvt_pk_bf16_f32 v70, v70, v71
    v_mfma_f32_16x16x32_bf16 v[36:39], a[8:11], v[72:75], v[36:39]
    s_waitcnt lgkmcnt(2)
    ds_write_b128 v156, v[76:79] offset:96
    v_mfma_f32_16x16x32_bf16 v[36:39], a[12:15], v[88:91], v[36:39]
    v_accvgpr_write_b32 a255, v70
    v_cvt_pk_bf16_f32 v246, v64, v65
    v_cvt_pk_bf16_f32 v247, v66, v67
    v_cvt_pk_bf16_f32 v60, v60, v61
    v_accvgpr_write_b32 a232, v60
    v_cvt_pk_bf16_f32 v62, v62, v63
    v_accvgpr_write_b32 a233, v62
    v_cvt_pk_bf16_f32 v224, v56, v57
    v_cvt_pk_bf16_f32 v225, v58, v59
    v_cvt_pk_bf16_f32 v248, v52, v53
    v_cvt_pk_bf16_f32 v249, v54, v55
    v_cvt_pk_bf16_f32 v48, v48, v49
    v_accvgpr_write_b32 a234, v48
    v_cvt_pk_bf16_f32 v50, v50, v51
    v_accvgpr_write_b32 a235, v50
    v_cvt_pk_bf16_f32 v226, v40, v41
    v_cvt_pk_bf16_f32 v227, v42, v43
    v_cvt_pk_bf16_f32 v250, v44, v45
    v_cvt_pk_bf16_f32 v251, v46, v47
    v_cvt_pk_bf16_f32 v32, v32, v33
    v_accvgpr_write_b32 a236, v32
    v_cvt_pk_bf16_f32 v34, v34, v35
    v_accvgpr_write_b32 a237, v34
    v_cvt_pk_bf16_f32 v228, v8, v9
    v_cvt_pk_bf16_f32 v229, v10, v11
    v_cvt_pk_bf16_f32 v252, v28, v29
    v_cvt_pk_bf16_f32 v253, v30, v31
    v_mov_b32 v230, 0
    v_mov_b32 v231, 0
    v_mov_b32 v27, 0
    v_add_u32 v170, 0, v156
    ds_write_b128 v170, v[4:7]
    v_add_u32 v135, s49, v135
    v_add_u32 v134, s49, v134
    ds_write2_b64 v170, v[230:231], v[230:231] offset0:2 offset1:3
    ds_write_b128 v170, v[0:3] offset:32
    ds_write2_b64 v170, v[254:255], v[230:231] offset0:6 offset1:7
    ds_write2_b64 v170, v[230:231], v[120:121] offset0:8 offset1:9
    ds_write_b64 v170, v[26:27] offset:88
    ds_read_b128 v[76:79], v137 offset:256
    ds_read_b128 v[56:59], v136 offset:256
    s_waitcnt lgkmcnt(1)
    v_mfma_f32_16x16x32_bf16 v[36:39], a[16:19], v[76:79], v[36:39]
    s_waitcnt lgkmcnt(0)
    v_mfma_f32_16x16x32_bf16 v[36:39], a[20:23], v[56:59], v[36:39]
    s_nop 0
    v_mfma_f32_16x16x16_bf16 v[8:11], v[20:21], v[168:169], v[12:15]
    s_nop 3
    v_mfma_f32_16x16x16_bf16 v[4:7], v[22:23], v[168:169], v[12:15]
    s_nop 0
    v_fma_f32 v121, v36, v36, s41
    v_fmac_f32 v121, v37, v37
    v_mfma_f32_16x16x16_bf16 v[0:3], v[24:25], v[168:169], v[12:15]
    v_cvt_pk_bf16_f32 v8, v8, v9
    v_accvgpr_write_b32 a238, v8
    v_cvt_pk_bf16_f32 v10, v10, v11
    v_mfma_f32_16x16x32_bf16 v[48:51], a[24:27], v[16:19], 0
    v_accvgpr_write_b32 a239, v10
    v_cvt_pk_bf16_f32 v230, v4, v5
    v_mfma_f32_16x16x32_bf16 v[48:51], a[28:31], v[146:149], v[48:51]
    v_cvt_pk_bf16_f32 v231, v6, v7
    v_cvt_pk_bf16_f32 v254, v0, v1
    v_mfma_f32_16x16x32_bf16 v[48:51], a[32:35], v[72:75], v[48:51]
    v_cvt_pk_bf16_f32 v255, v2, v3
    v_fmac_f32 v121, v38, v38
    v_mfma_f32_16x16x32_bf16 v[48:51], a[36:39], v[88:91], v[48:51]
    v_fmac_f32 v121, v39, v39
    v_mfma_f32_16x16x32_bf16 v[48:51], a[40:43], v[76:79], v[48:51]
    v_mfma_f32_16x16x32_bf16 v[48:51], a[44:47], v[56:59], v[48:51]
    s_nop 1
    v_mfma_f32_16x16x32_bf16 v[40:43], a[48:51], v[16:19], 0
    s_nop 2
    v_mfma_f32_16x16x32_bf16 v[40:43], a[52:55], v[146:149], v[40:43]
    s_nop 0
    v_fmac_f32 v121, v48, v48
    v_fmac_f32 v121, v49, v49
    v_mfma_f32_16x16x32_bf16 v[40:43], a[56:59], v[72:75], v[40:43]
    v_fmac_f32 v121, v50, v50
    v_fmac_f32 v121, v51, v51
    v_mfma_f32_16x16x32_bf16 v[40:43], a[60:63], v[88:91], v[40:43]
    v_mfma_f32_16x16x32_bf16 v[40:43], a[64:67], v[76:79], v[40:43]
    v_mfma_f32_16x16x32_bf16 v[40:43], a[68:71], v[56:59], v[40:43]
    s_nop 1
    v_mfma_f32_16x16x32_bf16 v[28:31], a[72:75], v[16:19], 0
    s_nop 2
    v_mfma_f32_16x16x32_bf16 v[28:31], a[76:79], v[146:149], v[28:31]
    s_nop 0
    v_fmac_f32 v121, v40, v40
    v_fmac_f32 v121, v41, v41
    v_mfma_f32_16x16x32_bf16 v[28:31], a[80:83], v[72:75], v[28:31]
    v_fmac_f32 v121, v42, v42
    v_fmac_f32 v121, v43, v43
    v_mfma_f32_16x16x32_bf16 v[28:31], a[84:87], v[88:91], v[28:31]
    v_mfma_f32_16x16x32_bf16 v[28:31], a[88:91], v[76:79], v[28:31]
    v_mfma_f32_16x16x32_bf16 v[28:31], a[92:95], v[56:59], v[28:31]
    s_nop 1
    v_mfma_f32_16x16x32_bf16 v[32:35], a[96:99], v[16:19], 0
    s_nop 2
    v_mfma_f32_16x16x32_bf16 v[32:35], a[100:103], v[146:149], v[32:35]
    s_nop 0
    v_fma_f32 v120, v28, v28, s41
    v_fmac_f32 v120, v29, v29
    v_mfma_f32_16x16x32_bf16 v[32:35], a[104:107], v[72:75], v[32:35]
    v_fmac_f32 v120, v30, v30
    v_fmac_f32 v120, v31, v31
    v_mfma_f32_16x16x32_bf16 v[32:35], a[108:111], v[88:91], v[32:35]
    v_mfma_f32_16x16x32_bf16 v[32:35], a[112:115], v[76:79], v[32:35]
    v_mfma_f32_16x16x32_bf16 v[32:35], a[116:119], v[56:59], v[32:35]
    s_nop 1
    v_mfma_f32_16x16x32_bf16 v[20:23], a[120:123], v[16:19], 0
    s_nop 2
    v_mfma_f32_16x16x32_bf16 v[20:23], a[124:127], v[146:149], v[20:23]
    s_nop 0
    v_fmac_f32 v120, v32, v32
    v_fmac_f32 v120, v33, v33
    v_mfma_f32_16x16x32_bf16 v[20:23], a[128:131], v[72:75], v[20:23]
    v_fmac_f32 v120, v34, v34
    v_fmac_f32 v120, v35, v35
    v_mfma_f32_16x16x32_bf16 v[20:23], a[132:135], v[88:91], v[20:23]
    v_mfma_f32_16x16x32_bf16 v[20:23], a[136:139], v[76:79], v[20:23]
    v_mfma_f32_16x16x32_bf16 v[20:23], a[140:143], v[56:59], v[20:23]
    s_nop 1
    v_mfma_f32_16x16x32_bf16 v[8:11], v[16:19], a[144:147], 0
    s_nop 2
    v_mfma_f32_16x16x32_bf16 v[8:11], v[146:149], a[148:151], v[8:11]
    s_nop 0
    v_fmac_f32 v120, v20, v20
    v_fmac_f32 v120, v21, v21
    v_mfma_f32_16x16x32_bf16 v[8:11], v[72:75], a[152:155], v[8:11]
    v_fmac_f32 v120, v22, v22
    v_fmac_f32 v120, v23, v23
    v_mfma_f32_16x16x32_bf16 v[8:11], v[88:91], a[156:159], v[8:11]
    v_cvt_pk_bf16_f32 v170, v121, v120
    v_mfma_f32_16x16x32_bf16 v[8:11], v[76:79], a[160:163], v[8:11]
    ds_read_b128 v[104:107], v137 offset:1536
    v_mfma_f32_16x16x32_bf16 v[8:11], v[56:59], a[164:167], v[8:11]
    s_nop 0
    ds_read_b128 v[100:103], v136 offset:1536
    s_nop 0
    v_mfma_f32_16x16x16_bf16 v[24:27], v[216:217], v[170:171], 0
    s_nop 0
    ds_read_b128 v[44:47], v137 offset:1664
    s_nop 1
    v_cvt_pk_bf16_f32 v0, v8, v9
    v_mfma_f32_16x16x32_bf16 v[4:7], v[16:19], a[168:171], 0
    ds_read_b128 v[84:87], v136 offset:1664
    v_cvt_pk_bf16_f32 v1, v10, v11
    v_mfma_f32_16x16x32_bf16 v[4:7], v[146:149], a[172:175], v[4:7]
    ds_read_b128 v[68:71], v137 offset:1792
    v_mfma_f32_16x16x32_bf16 v[4:7], v[72:75], a[176:179], v[4:7]
    ds_read_b128 v[64:67], v136 offset:1792
    v_mfma_f32_16x16x32_bf16 v[4:7], v[88:91], a[180:183], v[4:7]
    v_rsq_f32 v24, v24
    v_mfma_f32_16x16x32_bf16 v[4:7], v[76:79], a[184:187], v[4:7]
    v_rsq_f32 v25, v25
    v_mfma_f32_16x16x32_bf16 v[4:7], v[56:59], a[188:191], v[4:7]
    v_mul_f32 v24, s55, v24
    v_mul_f32 v25, 0.5, v25
    v_mfma_f32_16x16x32_bf16 v[12:15], v[16:19], a[192:195], 0
    s_nop 0
    v_mul_f32 v36, v36, v24
    v_mul_f32 v37, v37, v24
    v_mfma_f32_16x16x32_bf16 v[12:15], v[146:149], a[196:199], v[12:15]
    s_nop 0
    v_cvt_pk_bf16_f32 v8, v4, v5
    v_cvt_pk_bf16_f32 v9, v6, v7
    v_mfma_f32_16x16x32_bf16 v[12:15], v[72:75], a[200:203], v[12:15]
    v_cvt_pk_f16_f32 v4, v36, v37
    v_mul_f32 v38, v38, v24
    v_mfma_f32_16x16x32_bf16 v[12:15], v[88:91], a[204:207], v[12:15]
    v_mul_f32 v39, v39, v24
    v_cvt_pk_f16_f32 v5, v38, v39
    v_mfma_f32_16x16x32_bf16 v[12:15], v[76:79], a[208:211], v[12:15]
    v_mul_f32 v48, v48, v24
    v_mul_f32 v49, v49, v24
    v_mfma_f32_16x16x32_bf16 v[12:15], v[56:59], a[212:215], v[12:15]
    s_waitcnt lgkmcnt(0)
    v_cvt_pk_f16_f32 v6, v48, v49
    v_mul_f32 v50, v50, v24
    v_mfma_f32_16x16x32_bf16 v[16:19], a[0:3], v[104:107], 0
    v_mul_f32 v51, v51, v24
    v_cvt_pk_f16_f32 v7, v50, v51
    v_mfma_f32_16x16x32_bf16 v[16:19], a[4:7], v[100:103], v[16:19]
    v_mul_f32 v40, v40, v24
    v_mul_f32 v41, v41, v24
    v_mfma_f32_16x16x32_bf16 v[16:19], a[8:11], v[44:47], v[16:19]
    v_cvt_pk_f16_f32 v152, v40, v41
    v_mul_f32 v42, v42, v24
    v_mfma_f32_16x16x32_bf16 v[16:19], a[12:15], v[84:87], v[16:19]
    v_mul_f32 v43, v43, v24
    v_cvt_pk_f16_f32 v153, v42, v43
    v_mfma_f32_16x16x32_bf16 v[16:19], a[16:19], v[68:71], v[16:19]
    v_mul_f32 v28, v28, v25
    v_mul_f32 v29, v29, v25
    v_mfma_f32_16x16x32_bf16 v[16:19], a[20:23], v[64:67], v[16:19]
    v_cvt_pk_f16_f32 v28, v28, v29
    v_mul_f32 v30, v30, v25
    v_mfma_f32_16x16x32_bf16 v[60:63], a[24:27], v[104:107], 0
    v_mul_f32 v31, v31, v25
    v_cvt_pk_f16_f32 v29, v30, v31
    v_mfma_f32_16x16x32_bf16 v[60:63], a[28:31], v[100:103], v[60:63]
    v_mul_f32 v32, v32, v25
    v_mul_f32 v33, v33, v25
    v_mfma_f32_16x16x32_bf16 v[60:63], a[32:35], v[44:47], v[60:63]
    v_cvt_pk_f16_f32 v30, v32, v33
    v_mul_f32 v34, v34, v25
    v_mfma_f32_16x16x32_bf16 v[60:63], a[36:39], v[84:87], v[60:63]
    v_mul_f32 v35, v35, v25
    v_cvt_pk_f16_f32 v31, v34, v35
    v_mfma_f32_16x16x32_bf16 v[60:63], a[40:43], v[68:71], v[60:63]
    v_mul_f32 v20, v20, v25
    v_mul_f32 v21, v21, v25
    v_mfma_f32_16x16x32_bf16 v[60:63], a[44:47], v[64:67], v[60:63]
    v_cvt_pk_f16_f32 v154, v20, v21
    v_mul_f32 v22, v22, v25
    v_mfma_f32_16x16x32_bf16 v[36:39], a[48:51], v[104:107], 0
    v_mul_f32 v23, v23, v25
    v_cvt_pk_f16_f32 v155, v22, v23
    v_mfma_f32_16x16x32_bf16 v[36:39], a[52:55], v[100:103], v[36:39]
    v_cvt_pk_bf16_f32 v20, v12, v13
    v_cvt_pk_bf16_f32 v21, v14, v15
    v_mfma_f32_16x16x32_bf16 v[36:39], a[56:59], v[44:47], v[36:39]
    v_fma_f32 v2, v16, v16, s41
    v_fmac_f32 v2, v17, v17
    v_mfma_f32_16x16x32_bf16 v[36:39], a[60:63], v[84:87], v[36:39]
    v_fmac_f32 v2, v18, v18
    v_fmac_f32 v2, v19, v19
    v_mfma_f32_16x16x32_bf16 v[36:39], a[64:67], v[68:71], v[36:39]
    v_fmac_f32 v2, v60, v60
    v_fmac_f32 v2, v61, v61
    v_mfma_f32_16x16x32_bf16 v[36:39], a[68:71], v[64:67], v[36:39]
    v_fmac_f32 v2, v62, v62
    v_fmac_f32 v2, v63, v63
    v_mfma_f32_16x16x32_bf16 v[52:55], a[72:75], v[104:107], 0
    s_nop 2
    v_mfma_f32_16x16x32_bf16 v[52:55], a[76:79], v[100:103], v[52:55]
    s_nop 0
    v_fmac_f32 v2, v36, v36
    v_fmac_f32 v2, v37, v37
    v_mfma_f32_16x16x32_bf16 v[52:55], a[80:83], v[44:47], v[52:55]
    v_fmac_f32 v2, v38, v38
    v_fmac_f32 v2, v39, v39
    v_mfma_f32_16x16x32_bf16 v[52:55], a[84:87], v[84:87], v[52:55]
    v_mfma_f32_16x16x32_bf16 v[52:55], a[88:91], v[68:71], v[52:55]
    v_mfma_f32_16x16x32_bf16 v[52:55], a[92:95], v[64:67], v[52:55]
    s_nop 1
    v_mfma_f32_16x16x32_bf16 v[12:15], a[96:99], v[104:107], 0
    s_nop 2
    v_mfma_f32_16x16x32_bf16 v[12:15], a[100:103], v[100:103], v[12:15]
    s_nop 0
    v_fma_f32 v3, v52, v52, s41
    v_fmac_f32 v3, v53, v53
    v_mfma_f32_16x16x32_bf16 v[12:15], a[104:107], v[44:47], v[12:15]
    v_fmac_f32 v3, v54, v54
    v_fmac_f32 v3, v55, v55
    v_mfma_f32_16x16x32_bf16 v[12:15], a[108:111], v[84:87], v[12:15]
    v_mfma_f32_16x16x32_bf16 v[12:15], a[112:115], v[68:71], v[12:15]
    v_mfma_f32_16x16x32_bf16 v[12:15], a[116:119], v[64:67], v[12:15]
    s_sub_u32 s50, s45, s44
    v_add_u32 v135, s48, v135
    v_add_u32 v134, s48, v134
    v_mfma_f32_16x16x32_bf16 v[48:51], a[120:123], v[104:107], 0
    s_sub_u32 s51, s46, s47
    v_add_u32 v133, s51, v133
    v_mfma_f32_16x16x32_bf16 v[48:51], a[124:127], v[100:103], v[48:51]
    s_mov_b32 s60, s59
    v_fmac_f32 v3, v12, v12
    v_fmac_f32 v3, v13, v13
    v_mfma_f32_16x16x32_bf16 v[48:51], a[128:131], v[44:47], v[48:51]
    s_mov_b32 s59, s58
    v_fmac_f32 v3, v14, v14
    v_fmac_f32 v3, v15, v15
    v_mfma_f32_16x16x32_bf16 v[48:51], a[132:135], v[84:87], v[48:51]
    s_mov_b32 s58, s57
    v_mfma_f32_16x16x32_bf16 v[48:51], a[136:139], v[68:71], v[48:51]
    s_mov_b32 s57, s56
    v_mfma_f32_16x16x32_bf16 v[48:51], a[140:143], v[64:67], v[48:51]
    s_mov_b32 s7, s6
    s_nop 0
    v_mfma_f32_16x16x32_bf16 v[24:27], v[104:107], a[144:147], 0
    s_mov_b32 s6, s5
    s_nop 1
    v_mfma_f32_16x16x32_bf16 v[24:27], v[100:103], a[148:151], v[24:27]
    s_mov_b32 s5, s4
    v_fmac_f32 v3, v48, v48
    v_fmac_f32 v3, v49, v49
    v_mfma_f32_16x16x32_bf16 v[24:27], v[44:47], a[152:155], v[24:27]
    s_sub_u32 s14, s6, s7
    v_fmac_f32 v3, v50, v50
    v_fmac_f32 v3, v51, v51
    v_mfma_f32_16x16x32_bf16 v[24:27], v[84:87], a[156:159], v[24:27]
    s_add_u32 s61, s61, 1
    v_cvt_pk_bf16_f32 v170, v2, v3
    v_add_u32 v132, s14, v132
    v_mfma_f32_16x16x32_bf16 v[24:27], v[68:71], a[160:163], v[24:27]
    s_ff1_i32_b32 s15, s66
    ds_read_b128 v[96:99], v137 offset:3072
    v_add_u32 v131, s14, v131
    v_mfma_f32_16x16x32_bf16 v[24:27], v[64:67], a[164:167], v[24:27]
    s_cmp_lg_u32 s66, 0
    ds_read_b128 v[92:95], v136 offset:3072
    v_add_u32 v123, s14, v123
    v_mfma_f32_16x16x16_bf16 v[40:43], v[216:217], v[170:171], 0
    s_cselect_b32 s12, s15, s12
    ds_read_b128 v[88:91], v137 offset:3200
    s_nop 1
    v_cvt_pk_bf16_f32 v2, v24, v25
    v_mfma_f32_16x16x32_bf16 v[72:75], v[104:107], a[168:171], 0
    s_cmp_lt_u32 s61, s71
    ds_read_b128 v[80:83], v136 offset:3200
    v_cvt_pk_bf16_f32 v3, v26, v27
    v_mfma_f32_16x16x32_bf16 v[72:75], v[100:103], a[172:175], v[72:75]
    s_cselect_b32 s15, 31, s15
    ds_read_b128 v[56:59], v137 offset:3328
    v_add_u32 v137, s50, v137
    v_mfma_f32_16x16x32_bf16 v[72:75], v[44:47], a[176:179], v[72:75]
    s_bitset0_b32 s66, s15
    ds_read_b128 v[24:27], v136 offset:3328
    v_add_u32 v136, s50, v136
    v_mfma_f32_16x16x32_bf16 v[72:75], v[84:87], a[180:183], v[72:75]
    s_add_u32 s12, s12, 20
    v_rsq_f32 v40, v40
    v_mfma_f32_16x16x32_bf16 v[72:75], v[68:71], a[184:187], v[72:75]
    s_max_u32 s12, s12, s61
    v_rsq_f32 v41, v41
    v_mfma_f32_16x16x32_bf16 v[72:75], v[64:67], a[188:191], v[72:75]
    s_cmp_lt_u32 s61, s71
    v_mul_f32 v40, s55, v40
    v_mul_f32 v41, 0.5, v41
    v_mfma_f32_16x16x32_bf16 v[32:35], v[104:107], a[192:195], 0
    s_cselect_b32 s15, s61, s12
    v_mul_f32 v16, v16, v40
    v_mul_f32 v17, v17, v40
    v_mfma_f32_16x16x32_bf16 v[32:35], v[100:103], a[196:199], v[32:35]
    s_cselect_b32 s56, s69, s70
    v_cvt_pk_bf16_f32 v10, v72, v73
    v_cvt_pk_bf16_f32 v11, v74, v75
    v_mfma_f32_16x16x32_bf16 v[32:35], v[44:47], a[200:203], v[32:35]
    s_add_u32 s56, s56, s15
    v_cvt_pk_f16_f32 v44, v16, v17
    v_mul_f32 v18, v18, v40
    v_mfma_f32_16x16x32_bf16 v[32:35], v[84:87], a[204:207], v[32:35]
    s_mul_i32 s53, s56, 58255
    v_mul_f32 v19, v19, v40
    v_cvt_pk_f16_f32 v45, v18, v19
    v_mfma_f32_16x16x32_bf16 v[32:35], v[68:71], a[208:211], v[32:35]
    s_waitcnt lgkmcnt(0)
    s_lshr_b32 s53, s53, 22
    v_mul_f32 v60, v60, v40
    v_mul_f32 v61, v61, v40
    v_mfma_f32_16x16x32_bf16 v[32:35], v[64:67], a[212:215], v[32:35]
    s_barrier
    v_cvt_pk_f16_f32 v46, v60, v61
    v_mul_f32 v62, v62, v40
    v_mfma_f32_16x16x32_bf16 v[16:19], a[0:3], v[96:99], 0
    s_mul_i32 s53, s53, s63
    v_mul_f32 v63, v63, v40
    v_cvt_pk_f16_f32 v47, v62, v63
    v_mfma_f32_16x16x32_bf16 v[16:19], a[4:7], v[92:95], v[16:19]
    s_mul_i32 s56, s56, s62
    v_mul_f32 v36, v36, v40
    v_mul_f32 v37, v37, v40
    v_mfma_f32_16x16x32_bf16 v[16:19], a[8:11], v[88:91], v[16:19]
    s_add_u32 s56, s56, s53
    v_cvt_pk_f16_f32 v146, v36, v37
    v_mul_f32 v38, v38, v40
    v_mfma_f32_16x16x32_bf16 v[16:19], a[12:15], v[80:83], v[16:19]
    s_mul_i32 s4, s15, 112
    v_mul_f32 v39, v39, v40
    v_cvt_pk_f16_f32 v147, v38, v39
    v_mfma_f32_16x16x32_bf16 v[16:19], a[16:19], v[56:59], v[16:19]
    s_cmp_ge_u32 s15, 16
    v_mul_f32 v52, v52, v41
    v_mul_f32 v53, v53, v41
    v_mfma_f32_16x16x32_bf16 v[16:19], a[20:23], v[24:27], v[16:19]
    s_cselect_b32 s53, -30464, 0
    v_cvt_pk_f16_f32 v72, v52, v53
    v_mul_f32 v54, v54, v41
    v_mfma_f32_16x16x32_bf16 v[36:39], a[24:27], v[96:99], 0
    s_add_u32 s4, s4, s53
    v_mul_f32 v55, v55, v41
    v_cvt_pk_f16_f32 v73, v54, v55
    v_mfma_f32_16x16x32_bf16 v[36:39], a[28:31], v[92:95], v[36:39]
    s_cmp_lt_u32 s15, s73
    v_mul_f32 v12, v12, v41
    v_mul_f32 v13, v13, v41
    v_mfma_f32_16x16x32_bf16 v[36:39], a[32:35], v[88:91], v[36:39]
    s_cselect_b32 s26, 100270464, 0
    v_cvt_pk_f16_f32 v74, v12, v13
    v_mul_f32 v14, v14, v41
    v_mfma_f32_16x16x32_bf16 v[36:39], a[36:39], v[80:83], v[36:39]
    s_cselect_b32 s56, s56, 0
    v_mul_f32 v15, v15, v41
    v_cvt_pk_f16_f32 v75, v14, v15
    v_mfma_f32_16x16x32_bf16 v[36:39], a[40:43], v[56:59], v[36:39]
    s_cselect_b32 s4, s4, -1
    v_mul_f32 v48, v48, v41
    v_mul_f32 v49, v49, v41
    v_mfma_f32_16x16x32_bf16 v[36:39], a[44:47], v[24:27], v[36:39]
    s_cselect_b32 s15, s15, 0
    v_cvt_pk_f16_f32 v148, v48, v49
    v_mul_f32 v50, v50, v41
    v_mfma_f32_16x16x32_bf16 v[12:15], a[48:51], v[96:99], 0
    s_cselect_b32 s13, s13, -1
    v_mul_f32 v51, v51, v41
    v_cvt_pk_f16_f32 v149, v50, v51
    v_mfma_f32_16x16x32_bf16 v[12:15], a[52:55], v[92:95], v[12:15]
    s_bitset1_b32 s64, s15
    v_cvt_pk_bf16_f32 v22, v32, v33
    v_cvt_pk_bf16_f32 v23, v34, v35
    v_mfma_f32_16x16x32_bf16 v[12:15], a[56:59], v[88:91], v[12:15]
    s_add_u32 s65, s65, 1
    v_fma_f32 v156, v16, v16, s41
    v_fmac_f32 v156, v17, v17
    v_mfma_f32_16x16x32_bf16 v[12:15], a[60:63], v[80:83], v[12:15]
    s_cmp_ge_i32 s65, 2
    v_fmac_f32 v156, v18, v18
    v_fmac_f32 v156, v19, v19
    v_mfma_f32_16x16x32_bf16 v[12:15], a[64:67], v[56:59], v[12:15]
    s_cselect_b32 s30, 100270464, 0
    v_fmac_f32 v156, v36, v36
    v_fmac_f32 v156, v37, v37
    v_mfma_f32_16x16x32_bf16 v[12:15], a[68:71], v[24:27], v[12:15]
    s_add_u32 s67, s46, s54
    v_fmac_f32 v156, v38, v38
    v_fmac_f32 v156, v39, v39
    v_mfma_f32_16x16x32_bf16 v[64:67], a[72:75], v[96:99], 0
    s_add_u32 m0, s67, 0
    v_and_b32 v120, -8, v123
    v_mfma_f32_16x16x32_bf16 v[64:67], a[76:79], v[92:95], v[64:67]
    buffer_load_dwordx4 v128, s[24:27], s56 offen nt lds
    v_fmac_f32 v156, v12, v12
    v_mfma_f32_16x16x32_bf16 v[64:67], a[80:83], v[88:91], v[64:67]
    s_add_u32 m0, s67, 1024
    v_fmac_f32 v156, v13, v13
    v_fmac_f32 v156, v14, v14
    v_mfma_f32_16x16x32_bf16 v[64:67], a[84:87], v[80:83], v[64:67]
    buffer_load_dwordx4 v127, s[24:27], s56 offen nt lds
    v_fmac_f32 v156, v15, v15
    v_mfma_f32_16x16x32_bf16 v[64:67], a[88:91], v[56:59], v[64:67]
    s_add_u32 m0, s67, 2048
    v_mfma_f32_16x16x32_bf16 v[64:67], a[92:95], v[24:27], v[64:67]
    buffer_load_dwordx4 v126, s[24:27], s56 offen nt lds
    v_mfma_f32_16x16x32_bf16 v[32:35], a[96:99], v[96:99], 0
    s_add_u32 m0, s67, 3072
    s_nop 1
    v_mfma_f32_16x16x32_bf16 v[32:35], a[100:103], v[92:95], v[32:35]
    s_nop 0
    buffer_load_dwordx4 v125, s[24:27], s56 offen nt lds
    v_fma_f32 v121, v64, v64, s41
    v_mfma_f32_16x16x32_bf16 v[32:35], a[104:107], v[88:91], v[32:35]
    s_add_u32 m0, s67, 4096
    v_fmac_f32 v121, v65, v65
    v_fmac_f32 v121, v66, v66
    v_mfma_f32_16x16x32_bf16 v[32:35], a[108:111], v[80:83], v[32:35]
    buffer_load_dwordx4 v124, s[24:27], s56 offen nt lds
    v_fmac_f32 v121, v67, v67
    v_mfma_f32_16x16x32_bf16 v[32:35], a[112:115], v[56:59], v[32:35]
    v_mfma_f32_16x16x32_bf16 v[32:35], a[116:119], v[24:27], v[32:35]
    s_nop 1
    v_mfma_f32_16x16x32_bf16 v[40:43], a[120:123], v[96:99], 0
    s_nop 2
    v_mfma_f32_16x16x32_bf16 v[40:43], a[124:127], v[92:95], v[40:43]
    s_mov_b32 s53, s47
    v_fmac_f32 v121, v32, v32
    v_fmac_f32 v121, v33, v33
    v_mfma_f32_16x16x32_bf16 v[40:43], a[128:131], v[88:91], v[40:43]
    s_mov_b32 s47, s46
    v_fmac_f32 v121, v34, v34
    v_fmac_f32 v121, v35, v35
    v_mfma_f32_16x16x32_bf16 v[40:43], a[132:135], v[80:83], v[40:43]
    s_mov_b32 s46, s45
    v_mfma_f32_16x16x32_bf16 v[40:43], a[136:139], v[56:59], v[40:43]
    s_mov_b32 s45, s44
    v_mfma_f32_16x16x32_bf16 v[40:43], a[140:143], v[24:27], v[40:43]
    s_mov_b32 s44, s53
    s_nop 0
    v_mfma_f32_16x16x32_bf16 v[68:71], v[96:99], a[144:147], 0
    s_sub_u32 s48, s44, s46
    v_add_u32 v137, s48, v137
    v_add_u32 v136, s48, v136
    v_mfma_f32_16x16x32_bf16 v[68:71], v[92:95], a[148:151], v[68:71]
    s_sub_u32 s49, s46, s45
    v_fmac_f32 v121, v40, v40
    v_fmac_f32 v121, v41, v41
    v_mfma_f32_16x16x32_bf16 v[68:71], v[88:91], a[152:155], v[68:71]
    v_fmac_f32 v121, v42, v42
    v_fmac_f32 v121, v43, v43
    v_mfma_f32_16x16x32_bf16 v[68:71], v[80:83], a[156:159], v[68:71]
    v_cvt_pk_bf16_f32 v170, v156, v121
    v_mfma_f32_16x16x32_bf16 v[68:71], v[56:59], a[160:163], v[68:71]
    ds_read_b128 v[60:63], v132 offset:0
    v_mfma_f32_16x16x32_bf16 v[68:71], v[24:27], a[164:167], v[68:71]
    s_nop 0
    ds_read_b128 v[52:55], v132 offset:16
    s_nop 0
    v_mfma_f32_16x16x16_bf16 v[76:79], v[216:217], v[170:171], 0
    s_nop 0
    ds_read_b128 v[48:51], v132 offset:48
    s_nop 1
    v_cvt_pk_bf16_f32 v164, v68, v69
    v_mfma_f32_16x16x32_bf16 v[84:87], v[96:99], a[168:171], 0
    v_cvt_pk_bf16_f32 v165, v70, v71
    v_mfma_f32_16x16x32_bf16 v[84:87], v[92:95], a[172:175], v[84:87]
    v_rsq_f32 v76, v76
    v_mfma_f32_16x16x32_bf16 v[84:87], v[88:91], a[176:179], v[84:87]
    v_rsq_f32 v77, v77
    v_mfma_f32_16x16x32_bf16 v[84:87], v[80:83], a[180:183], v[84:87]
    v_mul_f32 v76, s55, v76
    v_mul_f32 v77, 0.5, v77
    v_mfma_f32_16x16x32_bf16 v[84:87], v[56:59], a[184:187], v[84:87]
    v_mul_f32 v64, v64, v77
    v_mul_f32 v65, v65, v77
    v_mfma_f32_16x16x32_bf16 v[84:87], v[24:27], a[188:191], v[84:87]
    v_cvt_pk_f16_f32 v64, v64, v65
    v_mul_f32 v66, v66, v77
    v_mfma_f32_16x16x32_bf16 v[68:71], v[96:99], a[192:195], 0
    s_nop 0
    v_mul_f32 v67, v67, v77
    v_cvt_pk_f16_f32 v65, v66, v67
    v_mfma_f32_16x16x32_bf16 v[68:71], v[92:95], a[196:199], v[68:71]
    s_nop 0
    v_cvt_pk_bf16_f32 v160, v84, v85
    v_cvt_pk_bf16_f32 v161, v86, v87
    v_mfma_f32_16x16x32_bf16 v[68:71], v[88:91], a[200:203], v[68:71]
    v_mul_f32 v32, v32, v77
    v_mul_f32 v33, v33, v77
    v_mfma_f32_16x16x32_bf16 v[68:71], v[80:83], a[204:207], v[68:71]
    v_cvt_pk_f16_f32 v66, v32, v33
    v_mul_f32 v34, v34, v77
    v_mfma_f32_16x16x32_bf16 v[68:71], v[56:59], a[208:211], v[68:71]
    v_mul_f32 v35, v35, v77
    v_cvt_pk_f16_f32 v67, v34, v35
    v_mfma_f32_16x16x32_bf16 v[68:71], v[24:27], a[212:215], v[68:71]
    v_mul_f32 v40, v40, v77
    v_mul_f32 v41, v41, v77
    v_mfma_f32_16x16x32_f16 v[32:35], v[28:31], v[4:7], v[204:207]
    ds_read_u16 v166, v131 offset:80
    v_cvt_pk_f16_f32 v142, v40, v41
    v_mfma_f32_16x16x32_f16 v[32:35], v[152:155], v[150:153], v[32:35]
    ds_read_u16 v162, v131 offset:96
    v_mul_f32 v42, v42, v77
    v_mfma_f32_16x16x32_f16 v[24:27], v[72:75], v[4:7], v[200:203]
    ds_read_u16 v158, v131 offset:104
    v_mul_f32 v43, v43, v77
    v_mfma_f32_16x16x32_f16 v[24:27], v[146:149], v[150:153], v[24:27]
    s_waitcnt lgkmcnt(3)
    ds_read_b32 v120, v120 offset:64
    v_cvt_pk_f16_f32 v143, v42, v43
    v_mfma_f32_16x16x32_f16 v[56:59], v[60:63], v[4:7], v[208:211]
    v_mul_f32 v16, v16, v76
    v_mul_f32 v17, v17, v76
    v_mfma_f32_16x16x32_f16 v[56:59], v[52:55], v[28:31], v[56:59]
    v_cvt_pk_f16_f32 v16, v16, v17
    v_mul_f32 v18, v18, v76
    v_mfma_f32_16x16x32_f16 v[56:59], v[48:51], v[152:155], v[56:59]
    v_mul_f32 v19, v19, v76
    v_cvt_pk_f16_f32 v17, v18, v19
    v_mfma_f32_16x16x32_f16 v[40:43], v[60:63], v[44:47], v[208:211]
    v_mul_f32 v36, v36, v76
    v_mul_f32 v37, v37, v76
    v_mfma_f32_16x16x32_f16 v[40:43], v[52:55], v[72:75], v[40:43]
    v_cvt_pk_f16_f32 v18, v36, v37
    v_mul_f32 v38, v38, v76
    v_mfma_f32_16x16x32_f16 v[40:43], v[48:51], v[146:149], v[40:43]
    v_mul_f32 v39, v39, v76
    v_cvt_pk_f16_f32 v19, v38, v39
    v_mfma_f32_16x16x32_f16 v[36:39], v[28:31], v[44:47], v[192:195]
    v_mul_f32 v12, v12, v76
    v_mul_f32 v13, v13, v76
    v_mfma_f32_16x16x32_f16 v[36:39], v[152:155], v[144:147], v[36:39]
    v_cvt_pk_f16_f32 v140, v12, v13
    v_mul_f32 v14, v14, v76
    v_mul_f32 v15, v15, v76
    v_cvt_pk_f16_f32 v141, v14, v15
    v_mfma_f32_16x16x32_f16 v[12:15], v[64:67], v[4:7], v[196:199]
    v_cvt_pk_bf16_f32 v156, v68, v69
    v_cvt_pk_bf16_f32 v157, v70, v71
    v_mfma_f32_16x16x32_f16 v[12:15], v[140:143], v[150:153], v[12:15]
    v_max3_f32 v121, v32, v33, v34
    v_max3_f32 v121, v121, v35, v24
    v_mfma_f32_16x16x32_f16 v[4:7], v[60:63], v[16:19], v[208:211]
    s_nop 0
    v_max3_f32 v121, v121, v25, v26
    v_mov_b32_dpp v59, v43 quad_perm:[0,1,2,3] row_mask:0x2 bank_mask:0xf
    v_mfma_f32_16x16x32_f16 v[4:7], v[52:55], v[64:67], v[4:7]
    s_nop 0
    v_max3_f32 v121, v121, v27, v12
    v_max3_f32 v121, v121, v13, v14
    v_mfma_f32_16x16x32_f16 v[4:7], v[48:51], v[140:143], v[4:7]
    v_max3_f32 v121, v121, v15, v56
    v_mov_b32 v57, v121
    v_mfma_f32_16x16x32_f16 v[52:55], v[72:75], v[44:47], v[188:191]
    s_nop 0
    v_permlane32_swap_b32 v57, v121
    v_mfma_f32_16x16x32_f16 v[52:55], v[146:149], v[144:147], v[52:55]
    v_max_f32 v121, v57, v121
    v_mov_b32 v57, v121
    v_mfma_f32_16x16x32_f16 v[48:51], v[64:67], v[44:47], v[184:187]
    s_nop 0
    v_permlane16_swap_b32 v57, v121
    v_mfma_f32_16x16x32_f16 v[48:51], v[140:143], v[144:147], v[48:51]
    v_max_f32 v121, v57, v121
    v_sub_f32 v32, v32, v121
    v_sub_f32 v33, v33, v121
    v_sub_f32 v34, v34, v121
    v_sub_f32 v35, v35, v121
    v_sub_f32 v24, v24, v121
    v_sub_f32 v25, v25, v121
    v_sub_f32 v26, v26, v121
    v_sub_f32 v27, v27, v121
    v_sub_f32 v12, v12, v121
    v_sub_f32 v13, v13, v121
    v_sub_f32 v14, v14, v121
    v_sub_f32 v15, v15, v121
    v_sub_f32 v56, v56, v121
    v_exp_f32 v32, v32
    v_exp_f32 v33, v33
    v_exp_f32 v34, v34
    v_exp_f32 v35, v35
    v_cvt_pk_bf16_f32 v60, v32, v33
    v_cvt_pk_bf16_f32 v61, v34, v35
    v_exp_f32 v24, v24
    v_exp_f32 v25, v25
    v_exp_f32 v26, v26
    v_exp_f32 v27, v27
    v_cvt_pk_bf16_f32 v62, v24, v25
    v_cvt_pk_bf16_f32 v63, v26, v27
    v_exp_f32 v12, v12
    v_exp_f32 v13, v13
    v_exp_f32 v14, v14
    v_exp_f32 v15, v15
    v_cvt_pk_bf16_f32 v168, v12, v13
    v_cvt_pk_bf16_f32 v169, v14, v15
    v_exp_f32 v56, v56
    v_mov_b32_dpp v59, v7 quad_perm:[0,1,2,3] row_mask:0x4 bank_mask:0xf
    v_cvt_pk_bf16_f32 v170, v56, 0
    v_mfma_f32_16x16x32_bf16 v[44:47], v[220:223], v[60:63], 0
    s_waitcnt lgkmcnt(0)
    v_and_b32 v121, 0xffff0000, v120
    v_lshlrev_b32 v120, 16, v120
    v_mfma_f32_16x16x32_bf16 v[44:47], v[220:223], v[168:171], v[44:47]
    v_add_f32 v120, v120, v121
    v_add_f32 v120, v120, v211
    v_mfma_f32_16x16x32_bf16 v[12:15], v[0:3], v[60:63], 0
    s_nop 0
    v_mov_b32_dpp v59, v120 quad_perm:[0,1,2,3] row_mask:0x8 bank_mask:0xf
    v_mov_b32 v4, v59
    v_mfma_f32_16x16x32_bf16 v[12:15], v[164:167], v[168:171], v[12:15]
    s_nop 0
    v_max_f32_dpp v4, v4, v4 row_ror:8 row_mask:0xf bank_mask:0xf
    v_max3_f32 v121, v36, v37, v38
    v_mfma_f32_16x16x32_bf16 v[24:27], v[8:11], v[60:63], 0
    v_max_f32_dpp v4, v4, v4 row_ror:4 row_mask:0xf bank_mask:0xf
    v_max3_f32 v121, v121, v39, v52
    v_mfma_f32_16x16x32_bf16 v[24:27], v[160:163], v[168:171], v[24:27]
    v_max_f32_dpp v4, v4, v4 row_ror:2 row_mask:0xf bank_mask:0xf
    v_max3_f32 v121, v121, v53, v54
    v_mfma_f32_16x16x32_bf16 v[32:35], v[20:23], v[60:63], 0
    v_max_f32_dpp v4, v4, v4 row_ror:1 row_mask:0xf bank_mask:0xf
    v_mov_b32 v120, v4
    v_mfma_f32_16x16x32_bf16 v[32:35], v[156:159], v[168:171], v[32:35]
    s_nop 0
    v_permlane32_swap_b32 v120, v4
    v_max_f32 v4, v120, v4
    v_mov_b32 v120, v4
    v_rcp_f32 v44, v44
    v_max3_f32 v121, v121, v55, v48
    v_permlane16_swap_b32 v120, v4
    v_max_f32 v4, v120, v4
    v_sub_f32 v59, v59, v4
    v_exp_f32 v59, v59
    v_mul_f32 v12, v12, v44
    v_cvt_pk_bf16_f32 v59, v59, v59
    ds_write_b16 v123, v59 offset:64
    v_mul_f32 v13, v13, v44
    v_cvt_pk_bf16_f32 v68, v12, v13
    ds_read_b128 v[60:63], v132 offset:48
    v_mul_f32 v14, v14, v44
    v_mul_f32 v15, v15, v44
    v_cvt_pk_bf16_f32 v69, v14, v15
    ds_read_b128 v[56:59], v132 offset:64
    v_mfma_f32_16x16x32_f16 v[12:15], v[28:31], v[16:19], v[180:183]
    v_mul_f32 v24, v24, v44
    v_mul_f32 v25, v25, v44
    v_mfma_f32_16x16x32_f16 v[12:15], v[152:155], v[138:141], v[12:15]
    ds_write_b64 v135, v[68:69] offset:0
    v_mfma_f32_16x16x32_f16 v[28:31], v[72:75], v[16:19], v[176:179]
    v_cvt_pk_bf16_f32 v70, v24, v25
    v_mul_f32 v26, v26, v44
    v_mfma_f32_16x16x32_f16 v[28:31], v[146:149], v[138:141], v[28:31]
    v_mul_f32 v27, v27, v44
    v_cvt_pk_bf16_f32 v71, v26, v27
    v_mfma_f32_16x16x32_f16 v[24:27], v[64:67], v[16:19], v[172:175]
    ds_write_b64 v135, v[70:71] offset:8
    v_mfma_f32_16x16x32_f16 v[24:27], v[140:143], v[138:141], v[24:27]
    s_waitcnt lgkmcnt(3)
    v_mul_f32 v32, v32, v44
    v_mul_f32 v33, v33, v44
    v_cvt_pk_bf16_f32 v146, v32, v33
    v_mul_f32 v34, v34, v44
    v_mfma_f32_16x16x32_bf16 v[16:19], v[60:63], v[0:3], 0
    s_waitcnt lgkmcnt(2)
    v_mul_f32 v35, v35, v44
    v_cvt_pk_bf16_f32 v147, v34, v35
    v_max3_f32 v121, v121, v49, v50
    v_max3_f32 v121, v121, v51, v41
    v_mfma_f32_16x16x32_bf16 v[16:19], v[56:59], v[164:167], v[16:19]
    ds_write_b64 v134, v[146:147] offset:0
    v_mfma_f32_16x16x32_bf16 v[44:47], v[60:63], v[8:11], 0
    v_mov_b32 v146, v121
    v_max3_f32 v120, v12, v13, v14
    v_mfma_f32_16x16x32_bf16 v[44:47], v[56:59], v[160:163], v[44:47]
    v_permlane32_swap_b32 v146, v121
    v_mfma_f32_16x16x32_bf16 v[32:35], v[60:63], v[20:23], 0
    v_max_f32 v121, v146, v121
    v_mov_b32 v146, v121
    v_mfma_f32_16x16x32_bf16 v[32:35], v[56:59], v[156:159], v[32:35]
    s_nop 0
    v_permlane16_swap_b32 v146, v121
    v_max_f32 v121, v146, v121
    v_sub_f32 v36, v36, v121
    v_sub_f32 v37, v37, v121
    v_sub_f32 v38, v38, v121
    v_sub_f32 v39, v39, v121
    v_sub_f32 v52, v52, v121
    v_sub_f32 v53, v53, v121
    v_sub_f32 v54, v54, v121
    v_sub_f32 v55, v55, v121
    v_sub_f32 v48, v48, v121
    v_sub_f32 v49, v49, v121
    v_sub_f32 v50, v50, v121
    v_sub_f32 v51, v51, v121
    v_sub_f32 v41, v41, v121
    v_exp_f32 v36, v36
    v_exp_f32 v37, v37
    v_exp_f32 v38, v38
    v_exp_f32 v39, v39
    v_cvt_pk_bf16_f32 v36, v36, v37
    v_cvt_pk_bf16_f32 v37, v38, v39
    v_exp_f32 v52, v52
    v_exp_f32 v53, v53
    v_exp_f32 v54, v54
    v_exp_f32 v55, v55
    v_cvt_pk_bf16_f32 v38, v52, v53
    v_cvt_pk_bf16_f32 v39, v54, v55
    v_exp_f32 v48, v48
    v_exp_f32 v49, v49
    v_exp_f32 v50, v50
    v_exp_f32 v51, v51
    v_cvt_pk_bf16_f32 v168, v48, v49
    v_cvt_pk_bf16_f32 v169, v50, v51
    v_exp_f32 v41, v41
    v_mov_b32_dpp v19, v47 quad_perm:[0,1,2,3] row_mask:0x2 bank_mask:0xf
    v_cvt_pk_bf16_f32 v170, v41, 0
    v_mfma_f32_16x16x32_bf16 v[44:47], v[220:223], v[36:39], 0
    v_mov_b32_dpp v19, v35 quad_perm:[0,1,2,3] row_mask:0x4 bank_mask:0xf
    v_cvt_pk_bf16_f32 v19, v19, v19
    v_mfma_f32_16x16x32_bf16 v[44:47], v[220:223], v[168:171], v[44:47]
    ds_write_b16 v131, v19
    v_mfma_f32_16x16x32_bf16 v[32:35], v[0:3], v[36:39], 0
    ds_read_b128 v[16:19], v137 offset:0
    v_max3_f32 v120, v120, v15, v28
    v_mfma_f32_16x16x32_bf16 v[32:35], v[164:167], v[168:171], v[32:35]
    ds_read_b128 v[146:149], v136 offset:0
    v_max3_f32 v120, v120, v29, v30
    v_mfma_f32_16x16x32_bf16 v[48:51], v[8:11], v[36:39], 0
    ds_read_b128 v[72:75], v137 offset:128
    v_max3_f32 v120, v120, v31, v24
    v_mfma_f32_16x16x32_bf16 v[48:51], v[160:163], v[168:171], v[48:51]
    ds_read_b128 v[88:91], v136 offset:128
    v_max3_f32 v120, v120, v25, v26
    v_mfma_f32_16x16x32_bf16 v[40:43], v[20:23], v[36:39], 0
    ds_read_b128 v[76:79], v137 offset:256
    v_max3_f32 v120, v120, v27, v6
    v_mfma_f32_16x16x32_bf16 v[40:43], v[156:159], v[168:171], v[40:43]
    ds_read_b128 v[56:59], v136 offset:256
    v_mov_b32 v121, v120
    v_rcp_f32 v44, v44
    s_nop 0
    v_mul_f32 v32, v32, v44
    v_mul_f32 v33, v33, v44
    v_cvt_pk_bf16_f32 v32, v32, v33
    v_mul_f32 v34, v34, v44
    v_mul_f32 v35, v35, v44
    v_cvt_pk_bf16_f32 v33, v34, v35
    v_mul_f32 v48, v48, v44
    v_mul_f32 v49, v49, v44
    v_cvt_pk_bf16_f32 v34, v48, v49
    v_mul_f32 v50, v50, v44
    s_waitcnt lgkmcnt(5)
    v_mfma_f32_16x16x32_bf16 v[36:39], a[0:3], v[16:19], 0
    ds_write_b64 v135, v[32:33] offset:1536
    v_mul_f32 v51, v51, v44
    v_cvt_pk_bf16_f32 v35, v50, v51
    v_mul_f32 v40, v40, v44
    v_mul_f32 v41, v41, v44
    v_cvt_pk_bf16_f32 v4, v40, v41
    v_mul_f32 v42, v42, v44
    v_mul_f32 v43, v43, v44
    v_cvt_pk_bf16_f32 v5, v42, v43
    ds_write_b64 v135, v[34:35] offset:1544
    v_permlane32_swap_b32 v121, v120
    v_max_f32 v120, v121, v120
    v_mov_b32 v121, v120
    s_nop 0
    ds_write_b64 v134, v[4:5] offset:1536
    v_permlane16_swap_b32 v121, v120
    v_max_f32 v120, v121, v120
    v_sub_f32 v12, v12, v120
    v_sub_f32 v13, v13, v120
    v_sub_f32 v14, v14, v120
    v_sub_f32 v15, v15, v120
    v_sub_f32 v28, v28, v120
    v_sub_f32 v29, v29, v120
    v_sub_f32 v30, v30, v120
    v_sub_f32 v31, v31, v120
    v_sub_f32 v24, v24, v120
    v_sub_f32 v25, v25, v120
    v_sub_f32 v26, v26, v120
    v_sub_f32 v27, v27, v120
    v_sub_f32 v6, v6, v120
    v_exp_f32 v12, v12
    v_exp_f32 v13, v13
    v_exp_f32 v14, v14
    v_exp_f32 v15, v15
    v_cvt_pk_bf16_f32 v12, v12, v13
    v_cvt_pk_bf16_f32 v13, v14, v15
    v_exp_f32 v28, v28
    v_exp_f32 v29, v29
    v_exp_f32 v30, v30
    v_exp_f32 v31, v31
    v_cvt_pk_bf16_f32 v14, v28, v29
    v_cvt_pk_bf16_f32 v15, v30, v31
    v_exp_f32 v24, v24
    v_exp_f32 v25, v25
    v_exp_f32 v26, v26
    v_exp_f32 v27, v27
    v_cvt_pk_bf16_f32 v168, v24, v25
    v_cvt_pk_bf16_f32 v169, v26, v27
    v_exp_f32 v6, v6
    s_nop 0
    v_cvt_pk_bf16_f32 v170, v6, 0
    v_mfma_f32_16x16x32_bf16 v[152:155], v[220:223], v[12:15], 0
    s_nop 0
    v_mfma_f32_16x16x32_bf16 v[152:155], v[220:223], v[168:171], v[152:155]
    s_nop 1
    v_mfma_f32_16x16x32_bf16 v[4:7], v[0:3], v[12:15], 0
    s_nop 2
    v_mfma_f32_16x16x32_bf16 v[4:7], v[164:167], v[168:171], v[4:7]
    s_nop 0
    v_rcp_f32 v152, v152
    v_mfma_f32_16x16x32_bf16 v[0:3], v[8:11], v[12:15], 0
    s_nop 2
    v_mfma_f32_16x16x32_bf16 v[0:3], v[160:163], v[168:171], v[0:3]
    s_nop 0
    v_mul_f32 v4, v4, v152
    v_mul_f32 v5, v5, v152
    v_mfma_f32_16x16x32_bf16 v[8:11], v[20:23], v[12:15], 0
    v_cvt_pk_bf16_f32 v12, v4, v5
    v_mul_f32 v6, v6, v152
    v_mfma_f32_16x16x32_bf16 v[8:11], v[156:159], v[168:171], v[8:11]
    v_mul_f32 v7, v7, v152
    v_cvt_pk_bf16_f32 v13, v6, v7
    s_waitcnt lgkmcnt(0)
.p2align 6
L_loopS0:
    v_mfma_f32_16x16x32_bf16 v[36:39], a[4:7], v[146:149], v[36:39]
    ds_write_b64 v135, v[12:13] offset:3072
    v_mfma_f32_16x16x32_bf16 v[36:39], a[8:11], v[72:75], v[36:39]
    v_mul_f32 v0, v0, v152
    v_mul_f32 v1, v1, v152
    v_mfma_f32_16x16x32_bf16 v[36:39], a[12:15], v[88:91], v[36:39]
    v_cvt_pk_bf16_f32 v14, v0, v1
    v_mul_f32 v2, v2, v152
    v_mfma_f32_16x16x32_bf16 v[36:39], a[16:19], v[76:79], v[36:39]
    v_mul_f32 v3, v3, v152
    v_cvt_pk_bf16_f32 v15, v2, v3
    v_mfma_f32_16x16x32_bf16 v[36:39], a[20:23], v[56:59], v[36:39]
    ds_write_b64 v135, v[14:15] offset:3080
    v_mfma_f32_16x16x32_bf16 v[12:15], a[24:27], v[16:19], 0
    v_mul_f32 v8, v8, v152
    v_mul_f32 v9, v9, v152
    v_mfma_f32_16x16x32_bf16 v[12:15], a[28:31], v[146:149], v[12:15]
    v_cvt_pk_bf16_f32 v8, v8, v9
    v_mul_f32 v10, v10, v152
    v_mfma_f32_16x16x32_bf16 v[12:15], a[32:35], v[72:75], v[12:15]
    v_mul_f32 v11, v11, v152
    v_cvt_pk_bf16_f32 v9, v10, v11
    v_mfma_f32_16x16x32_bf16 v[12:15], a[36:39], v[88:91], v[12:15]
    ds_write_b64 v134, v[8:9] offset:3072
    v_mfma_f32_16x16x32_bf16 v[12:15], a[40:43], v[76:79], v[12:15]
    v_fma_f32 v170, v40, v40, s42
    v_fmac_f32 v170, v41, v41
    v_mfma_f32_16x16x32_bf16 v[12:15], a[44:47], v[56:59], v[12:15]
    v_fmac_f32 v170, v42, v42
    v_fmac_f32 v170, v43, v43
    v_mfma_f32_16x16x32_bf16 v[152:155], a[48:51], v[16:19], 0
    v_fmac_f32 v170, v140, v140
    v_fmac_f32 v170, v141, v141
    v_mfma_f32_16x16x32_bf16 v[152:155], a[52:55], v[146:149], v[152:155]
    v_fmac_f32 v170, v142, v142
    v_fmac_f32 v170, v143, v143
    v_mfma_f32_16x16x32_bf16 v[152:155], a[56:59], v[72:75], v[152:155]
    s_waitcnt vmcnt(10)
    v_fmac_f32 v170, v44, v44
    v_fmac_f32 v170, v45, v45
    v_mfma_f32_16x16x32_bf16 v[152:155], a[60:63], v[88:91], v[152:155]
    v_fmac_f32 v170, v46, v46
    v_fmac_f32 v170, v47, v47
    v_mfma_f32_16x16x32_bf16 v[152:155], a[64:67], v[76:79], v[152:155]
    v_cvt_pk_bf16_f32 v0, v92, v93
    v_cvt_pk_bf16_f32 v1, v170, v122
    v_mfma_f32_16x16x32_bf16 v[152:155], a[68:71], v[56:59], v[152:155]
    ds_write_b64 v130, v[0:1]
    v_mfma_f32_16x16x32_bf16 v[60:63], a[72:75], v[16:19], 0
    v_add_u32 v135, s49, v135
    v_add_u32 v134, s49, v134
    v_mfma_f32_16x16x32_bf16 v[60:63], a[76:79], v[146:149], v[60:63]
    v_fma_f32 v170, v36, v36, s41
    v_fmac_f32 v170, v37, v37
    v_mfma_f32_16x16x32_bf16 v[60:63], a[80:83], v[72:75], v[60:63]
    v_fmac_f32 v170, v38, v38
    v_fmac_f32 v170, v39, v39
    v_mfma_f32_16x16x32_bf16 v[60:63], a[84:87], v[88:91], v[60:63]
    v_fmac_f32 v170, v12, v12
    v_fmac_f32 v170, v13, v13
    v_mfma_f32_16x16x32_bf16 v[60:63], a[88:91], v[76:79], v[60:63]
    v_fmac_f32 v170, v14, v14
    v_fmac_f32 v170, v15, v15
    v_mfma_f32_16x16x32_bf16 v[60:63], a[92:95], v[56:59], v[60:63]
    v_fmac_f32 v170, v152, v152
    v_fmac_f32 v170, v153, v153
    v_mfma_f32_16x16x32_bf16 v[92:95], a[96:99], v[16:19], 0
    v_fmac_f32 v170, v154, v154
    v_fmac_f32 v170, v155, v155
    v_mfma_f32_16x16x32_bf16 v[92:95], a[100:103], v[146:149], v[92:95]
    s_waitcnt lgkmcnt(0)
    s_nop 0
    v_fma_f32 v0, v60, v60, s41
    v_fmac_f32 v0, v61, v61
    v_mfma_f32_16x16x32_bf16 v[92:95], a[104:107], v[72:75], v[92:95]
    s_barrier
    ds_read_b128 v[8:11], v129 offset:0
    v_fmac_f32 v0, v62, v62
    v_mfma_f32_16x16x32_bf16 v[92:95], a[108:111], v[88:91], v[92:95]
    ds_read_b128 v[64:67], v129 offset:1024
    v_fmac_f32 v0, v63, v63
    v_mfma_f32_16x16x32_bf16 v[92:95], a[112:115], v[76:79], v[92:95]
    v_mfma_f32_16x16x32_bf16 v[92:95], a[116:119], v[56:59], v[92:95]
    s_nop 1
    v_mfma_f32_16x16x32_bf16 v[80:83], a[120:123], v[16:19], 0
    s_nop 2
    v_mfma_f32_16x16x32_bf16 v[80:83], a[124:127], v[146:149], v[80:83]
    s_nop 0
    v_fmac_f32 v0, v92, v92
    v_fmac_f32 v0, v93, v93
    v_mfma_f32_16x16x32_bf16 v[80:83], a[128:131], v[72:75], v[80:83]
    v_fmac_f32 v0, v94, v94
    v_fmac_f32 v0, v95, v95
    v_mfma_f32_16x16x32_bf16 v[80:83], a[132:135], v[88:91], v[80:83]
    v_mfma_f32_16x16x32_bf16 v[80:83], a[136:139], v[76:79], v[80:83]
    v_mfma_f32_16x16x32_bf16 v[80:83], a[140:143], v[56:59], v[80:83]
    s_waitcnt lgkmcnt(1)
    v_readfirstlane_b32 s12, v9
    v_mfma_f32_16x16x32_bf16 v[84:87], v[216:219], v[8:11], 0
    s_waitcnt lgkmcnt(0)
    s_nop 1
    v_mfma_f32_16x16x32_bf16 v[84:87], v[216:219], v[64:67], v[84:87]
    s_lshr_b32 s12, s12, 23
    v_fmac_f32 v0, v80, v80
    v_fmac_f32 v0, v81, v81
    v_mfma_f32_16x16x32_bf16 v[8:11], v[16:19], a[144:147], 0
    v_fmac_f32 v0, v82, v82
    v_fmac_f32 v0, v83, v83
    v_mfma_f32_16x16x32_bf16 v[8:11], v[146:149], a[148:151], v[8:11]
    s_nop 0
    v_rsq_f32 v84, v84
    v_mfma_f32_16x16x32_bf16 v[8:11], v[72:75], a[152:155], v[8:11]
    v_rsq_f32 v85, v85
    v_mfma_f32_16x16x32_bf16 v[8:11], v[88:91], a[156:159], v[8:11]
    v_rsq_f32 v86, v86
    v_mfma_f32_16x16x32_bf16 v[8:11], v[76:79], a[160:163], v[8:11]
    ds_read_b128 v[64:67], v137 offset:1536
    v_mul_f32 v84, s43, v84
    v_mfma_f32_16x16x32_bf16 v[8:11], v[56:59], a[164:167], v[8:11]
    ds_read_b128 v[68:71], v136 offset:1536
    v_mul_f32 v85, s43, v85
    v_mfma_f32_16x16x32_bf16 v[48:51], v[16:19], a[168:171], 0
    ds_read_b128 v[52:55], v137 offset:1664
    v_mul_f32 v86, s43, v86
    v_mfma_f32_16x16x32_bf16 v[48:51], v[146:149], a[172:175], v[48:51]
    ds_read_b128 v[96:99], v136 offset:1664
    v_cvt_pk_bf16_f32 v170, v170, v0
    v_mfma_f32_16x16x32_bf16 v[48:51], v[72:75], a[176:179], v[48:51]
    ds_read_b128 v[108:111], v137 offset:1792
    v_cvt_pk_bf16_f32 v0, v8, v9
    v_mfma_f32_16x16x32_bf16 v[48:51], v[88:91], a[180:183], v[48:51]
    ds_read_b128 v[104:107], v136 offset:1792
    v_cvt_pk_bf16_f32 v1, v10, v11
    v_mfma_f32_16x16x32_bf16 v[48:51], v[76:79], a[184:187], v[48:51]
    v_mul_f32 v32, v32, v84
    v_mul_f32 v33, v33, v84
    v_mfma_f32_16x16x32_bf16 v[48:51], v[56:59], a[188:191], v[48:51]
    s_nop 0
    v_cvt_pk_bf16_f32 v2, v32, v33
    v_mul_f32 v34, v34, v84
    v_mfma_f32_16x16x16_bf16 v[118:121], v[216:217], v[170:171], 0
    s_nop 0
    v_mul_f32 v35, v35, v84
    v_cvt_pk_bf16_f32 v3, v34, v35
    v_mul_f32 v4, v4, v84
    v_cvt_pk_bf16_f32 v8, v48, v49
    v_mfma_f32_16x16x32_bf16 v[32:35], v[16:19], a[192:195], 0
    ds_write_b64 v135, v[2:3] offset:0
    v_mfma_f32_16x16x32_bf16 v[32:35], v[146:149], a[196:199], v[32:35]
    v_rsq_f32 v118, v118
    v_mfma_f32_16x16x32_bf16 v[32:35], v[72:75], a[200:203], v[32:35]
    v_rsq_f32 v119, v119
    v_mfma_f32_16x16x32_bf16 v[32:35], v[88:91], a[204:207], v[32:35]
    v_mul_f32 v118, s55, v118
    v_mul_f32 v119, 0.5, v119
    v_mfma_f32_16x16x32_bf16 v[32:35], v[76:79], a[208:211], v[32:35]
    v_cvt_pk_bf16_f32 v9, v50, v51
    v_mul_f32 v36, v36, v118
    v_mfma_f32_16x16x32_bf16 v[32:35], v[56:59], a[212:215], v[32:35]
    s_waitcnt lgkmcnt(1)
    v_mul_f32 v37, v37, v118
    v_cvt_pk_f16_f32 v76, v36, v37
    v_mfma_f32_16x16x32_bf16 v[146:149], a[0:3], v[64:67], 0
    v_mul_f32 v38, v38, v118
    v_mul_f32 v39, v39, v118
    v_mfma_f32_16x16x32_bf16 v[146:149], a[4:7], v[68:71], v[146:149]
    v_cvt_pk_f16_f32 v77, v38, v39
    v_mul_f32 v12, v12, v118
    v_mfma_f32_16x16x32_bf16 v[146:149], a[8:11], v[52:55], v[146:149]
    v_mul_f32 v13, v13, v118
    v_cvt_pk_f16_f32 v78, v12, v13
    v_mfma_f32_16x16x32_bf16 v[146:149], a[12:15], v[96:99], v[146:149]
    v_mul_f32 v14, v14, v118
    v_mul_f32 v15, v15, v118
    v_mfma_f32_16x16x32_bf16 v[146:149], a[16:19], v[108:111], v[146:149]
    v_cvt_pk_f16_f32 v79, v14, v15
    v_mul_f32 v152, v152, v118
    v_mfma_f32_16x16x32_bf16 v[146:149], a[20:23], v[104:107], v[146:149]
    v_mul_f32 v153, v153, v118
    v_cvt_pk_f16_f32 v152, v152, v153
    v_mfma_f32_16x16x32_bf16 v[36:39], a[24:27], v[64:67], 0
    v_mul_f32 v154, v154, v118
    v_mul_f32 v155, v155, v118
    v_mfma_f32_16x16x32_bf16 v[36:39], a[28:31], v[68:71], v[36:39]
    v_cvt_pk_f16_f32 v153, v154, v155
    v_mul_f32 v60, v60, v119
    v_mfma_f32_16x16x32_bf16 v[36:39], a[32:35], v[52:55], v[36:39]
    v_mul_f32 v61, v61, v119
    v_cvt_pk_f16_f32 v16, v60, v61
    v_mfma_f32_16x16x32_bf16 v[36:39], a[36:39], v[96:99], v[36:39]
    v_mul_f32 v62, v62, v119
    v_mul_f32 v63, v63, v119
    v_mfma_f32_16x16x32_bf16 v[36:39], a[40:43], v[108:111], v[36:39]
    v_cvt_pk_f16_f32 v17, v62, v63
    v_mul_f32 v92, v92, v119
    v_mfma_f32_16x16x32_bf16 v[36:39], a[44:47], v[104:107], v[36:39]
    v_mul_f32 v93, v93, v119
    v_cvt_pk_f16_f32 v18, v92, v93
    v_mfma_f32_16x16x32_bf16 v[72:75], a[48:51], v[64:67], 0
    v_mul_f32 v94, v94, v119
    v_mul_f32 v95, v95, v119
    v_mfma_f32_16x16x32_bf16 v[72:75], a[52:55], v[68:71], v[72:75]
    v_cvt_pk_f16_f32 v19, v94, v95
    v_mul_f32 v80, v80, v119
    v_mfma_f32_16x16x32_bf16 v[72:75], a[56:59], v[52:55], v[72:75]
    v_mul_f32 v81, v81, v119
    v_cvt_pk_f16_f32 v154, v80, v81
    v_mfma_f32_16x16x32_bf16 v[72:75], a[60:63], v[96:99], v[72:75]
    v_mul_f32 v82, v82, v119
    v_mul_f32 v83, v83, v119
    v_mfma_f32_16x16x32_bf16 v[72:75], a[64:67], v[108:111], v[72:75]
    v_cvt_pk_f16_f32 v155, v82, v83
    v_cvt_pk_bf16_f32 v12, v32, v33
    v_mfma_f32_16x16x32_bf16 v[72:75], a[68:71], v[104:107], v[72:75]
    v_cvt_pk_bf16_f32 v13, v34, v35
    v_mul_f32 v5, v5, v84
    v_mfma_f32_16x16x32_bf16 v[32:35], a[72:75], v[64:67], 0
    v_cvt_pk_bf16_f32 v4, v4, v5
    v_mul_f32 v6, v6, v84
    v_mfma_f32_16x16x32_bf16 v[32:35], a[76:79], v[68:71], v[32:35]
    v_mul_f32 v7, v7, v84
    v_cvt_pk_bf16_f32 v5, v6, v7
    v_mfma_f32_16x16x32_bf16 v[32:35], a[80:83], v[52:55], v[32:35]
    ds_write_b64 v135, v[4:5] offset:8
    v_mfma_f32_16x16x32_bf16 v[32:35], a[84:87], v[96:99], v[32:35]
    v_mul_f32 v24, v24, v84
    v_mul_f32 v25, v25, v84
    v_mfma_f32_16x16x32_bf16 v[32:35], a[88:91], v[108:111], v[32:35]
    v_cvt_pk_bf16_f32 v2, v24, v25
    v_mul_f32 v26, v26, v84
    v_mfma_f32_16x16x32_bf16 v[32:35], a[92:95], v[104:107], v[32:35]
    v_mul_f32 v27, v27, v84
    v_cvt_pk_bf16_f32 v3, v26, v27
    v_mfma_f32_16x16x32_bf16 v[4:7], a[96:99], v[64:67], 0
    ds_write_b64 v134, v[2:3] offset:0
    v_mfma_f32_16x16x32_bf16 v[4:7], a[100:103], v[68:71], v[4:7]
    v_fma_f32 v2, v146, v146, s41
    v_fmac_f32 v2, v147, v147
    v_mfma_f32_16x16x32_bf16 v[4:7], a[104:107], v[52:55], v[4:7]
    v_fmac_f32 v2, v148, v148
    v_fmac_f32 v2, v149, v149
    v_mfma_f32_16x16x32_bf16 v[4:7], a[108:111], v[96:99], v[4:7]
    v_fmac_f32 v2, v36, v36
    v_fmac_f32 v2, v37, v37
    v_mfma_f32_16x16x32_bf16 v[4:7], a[112:115], v[108:111], v[4:7]
    v_fmac_f32 v2, v38, v38
    v_fmac_f32 v2, v39, v39
    v_mfma_f32_16x16x32_bf16 v[4:7], a[116:119], v[104:107], v[4:7]
    v_fmac_f32 v2, v72, v72
    v_fmac_f32 v2, v73, v73
    v_mfma_f32_16x16x32_bf16 v[24:27], a[120:123], v[64:67], 0
    v_fmac_f32 v2, v74, v74
    v_fmac_f32 v2, v75, v75
    v_mfma_f32_16x16x32_bf16 v[24:27], a[124:127], v[68:71], v[24:27]
    v_mul_f32 v28, v28, v85
    v_mul_f32 v29, v29, v85
    v_mfma_f32_16x16x32_bf16 v[24:27], a[128:131], v[52:55], v[24:27]
    v_cvt_pk_bf16_f32 v88, v28, v29
    v_mul_f32 v30, v30, v85
    v_mfma_f32_16x16x32_bf16 v[24:27], a[132:135], v[96:99], v[24:27]
    v_mul_f32 v31, v31, v85
    v_cvt_pk_bf16_f32 v89, v30, v31
    v_mfma_f32_16x16x32_bf16 v[24:27], a[136:139], v[108:111], v[24:27]
    ds_write_b64 v135, v[88:89] offset:1536
    v_mfma_f32_16x16x32_bf16 v[24:27], a[140:143], v[104:107], v[24:27]
    v_mul_f32 v20, v20, v85
    v_mul_f32 v21, v21, v85
    v_mfma_f32_16x16x32_bf16 v[60:63], v[64:67], a[144:147], 0
    v_cvt_pk_bf16_f32 v90, v20, v21
    v_mul_f32 v22, v22, v85
    v_mfma_f32_16x16x32_bf16 v[60:63], v[68:71], a[148:151], v[60:63]
    v_mul_f32 v23, v23, v85
    v_cvt_pk_bf16_f32 v91, v22, v23
    v_mfma_f32_16x16x32_bf16 v[60:63], v[52:55], a[152:155], v[60:63]
    ds_write_b64 v135, v[90:91] offset:1544
    v_mfma_f32_16x16x32_bf16 v[60:63], v[96:99], a[156:159], v[60:63]
    v_mul_f32 v114, v114, v85
    v_mul_f32 v115, v115, v85
    v_mfma_f32_16x16x32_bf16 v[60:63], v[108:111], a[160:163], v[60:63]
    ds_read_b128 v[88:91], v137 offset:3072
    v_cvt_pk_bf16_f32 v10, v114, v115
    v_mfma_f32_16x16x32_bf16 v[60:63], v[104:107], a[164:167], v[60:63]
    ds_read_b128 v[56:59], v136 offset:3072
    v_mul_f32 v116, v116, v85
    v_mfma_f32_16x16x32_bf16 v[92:95], v[64:67], a[168:171], 0
    ds_read_b128 v[80:83], v137 offset:3200
    v_mul_f32 v117, v117, v85
    v_mfma_f32_16x16x32_bf16 v[92:95], v[68:71], a[172:175], v[92:95]
    ds_read_b128 v[28:31], v136 offset:3200
    v_cvt_pk_bf16_f32 v11, v116, v117
    v_mfma_f32_16x16x32_bf16 v[92:95], v[52:55], a[176:179], v[92:95]
    ds_write_b64 v134, v[10:11] offset:1536
    v_mfma_f32_16x16x32_bf16 v[92:95], v[96:99], a[180:183], v[92:95]
    v_fma_f32 v3, v32, v32, s41
    v_fmac_f32 v3, v33, v33
    v_mfma_f32_16x16x32_bf16 v[92:95], v[108:111], a[184:187], v[92:95]
    ds_read_b128 v[48:51], v137 offset:3328
    v_fmac_f32 v3, v34, v34
    v_mfma_f32_16x16x32_bf16 v[92:95], v[104:107], a[188:191], v[92:95]
    ds_read_b128 v[20:23], v136 offset:3328
    v_fmac_f32 v3, v35, v35
    v_mfma_f32_16x16x32_bf16 v[112:115], v[64:67], a[192:195], 0
    v_fmac_f32 v3, v4, v4
    v_fmac_f32 v3, v5, v5
    v_mfma_f32_16x16x32_bf16 v[112:115], v[68:71], a[196:199], v[112:115]
    s_sub_u32 s50, s45, s44
    v_fmac_f32 v3, v6, v6
    v_fmac_f32 v3, v7, v7
    v_mfma_f32_16x16x32_bf16 v[112:115], v[52:55], a[200:203], v[112:115]
    s_sub_u32 s51, s46, s47
    v_fmac_f32 v3, v24, v24
    v_fmac_f32 v3, v25, v25
    v_mfma_f32_16x16x32_bf16 v[112:115], v[96:99], a[204:207], v[112:115]
    s_mov_b32 s60, s59
    v_fmac_f32 v3, v26, v26
    v_fmac_f32 v3, v27, v27
    v_mfma_f32_16x16x32_bf16 v[112:115], v[108:111], a[208:211], v[112:115]
    s_mov_b32 s59, s58
    v_cvt_pk_bf16_f32 v170, v2, v3
    v_cvt_pk_bf16_f32 v2, v60, v61
    v_mfma_f32_16x16x32_bf16 v[112:115], v[104:107], a[212:215], v[112:115]
    s_mov_b32 s58, s57
    v_cvt_pk_bf16_f32 v3, v62, v63
    v_cvt_pk_bf16_f32 v10, v92, v93
    v_mfma_f32_16x16x16_bf16 v[60:63], v[216:217], v[170:171], 0
    s_waitcnt lgkmcnt(2)
    s_mov_b32 s57, s56
    v_cvt_pk_bf16_f32 v11, v94, v95
    v_mul_f32 v40, v40, v86
    v_mul_f32 v41, v41, v86
    v_cvt_pk_bf16_f32 v14, v112, v113
    v_mfma_f32_16x16x32_bf16 v[92:95], a[0:3], v[88:91], 0
    s_mov_b32 s7, s6
    v_cvt_pk_bf16_f32 v15, v114, v115
    v_cvt_pk_bf16_f32 v40, v40, v41
    v_mfma_f32_16x16x32_bf16 v[92:95], a[4:7], v[56:59], v[92:95]
    s_mov_b32 s6, s5
    v_rsq_f32 v60, v60
    v_mfma_f32_16x16x32_bf16 v[92:95], a[8:11], v[80:83], v[92:95]
    s_mov_b32 s5, s4
    v_rsq_f32 v61, v61
    v_mfma_f32_16x16x32_bf16 v[92:95], a[12:15], v[28:31], v[92:95]
    s_waitcnt lgkmcnt(0)
    s_sub_u32 s14, s6, s7
    v_mul_f32 v60, s55, v60
    v_mul_f32 v61, 0.5, v61
    v_mfma_f32_16x16x32_bf16 v[92:95], a[16:19], v[48:51], v[92:95]
    s_add_u32 s61, s61, 1
    v_mul_f32 v146, v146, v60
    v_mul_f32 v147, v147, v60
    v_mfma_f32_16x16x32_bf16 v[92:95], a[20:23], v[20:23], v[92:95]
    s_ff1_i32_b32 s15, s66
    v_cvt_pk_f16_f32 v96, v146, v147
    v_mul_f32 v148, v148, v60
    v_mfma_f32_16x16x32_bf16 v[64:67], a[24:27], v[88:91], 0
    s_cmp_lg_u32 s66, 0
    v_mul_f32 v149, v149, v60
    v_cvt_pk_f16_f32 v97, v148, v149
    v_mfma_f32_16x16x32_bf16 v[64:67], a[28:31], v[56:59], v[64:67]
    s_cselect_b32 s12, s15, s12
    v_mul_f32 v36, v36, v60
    v_mul_f32 v37, v37, v60
    v_mfma_f32_16x16x32_bf16 v[64:67], a[32:35], v[80:83], v[64:67]
    s_cmp_lt_u32 s61, s71
    v_cvt_pk_f16_f32 v98, v36, v37
    v_mul_f32 v38, v38, v60
    v_mfma_f32_16x16x32_bf16 v[64:67], a[36:39], v[28:31], v[64:67]
    s_cselect_b32 s15, 31, s15
    v_mul_f32 v39, v39, v60
    v_cvt_pk_f16_f32 v99, v38, v39
    v_mfma_f32_16x16x32_bf16 v[64:67], a[40:43], v[48:51], v[64:67]
    s_bitset0_b32 s66, s15
    v_mul_f32 v72, v72, v60
    v_mul_f32 v73, v73, v60
    v_mfma_f32_16x16x32_bf16 v[64:67], a[44:47], v[20:23], v[64:67]
    s_add_u32 s12, s12, 20
    v_cvt_pk_f16_f32 v146, v72, v73
    v_mul_f32 v74, v74, v60
    v_mfma_f32_16x16x32_bf16 v[68:71], a[48:51], v[88:91], 0
    s_max_u32 s12, s12, s61
    v_mul_f32 v75, v75, v60
    v_cvt_pk_f16_f32 v147, v74, v75
    v_mfma_f32_16x16x32_bf16 v[68:71], a[52:55], v[56:59], v[68:71]
    s_cmp_lt_u32 s61, s71
    v_mul_f32 v32, v32, v61
    v_mul_f32 v33, v33, v61
    v_mfma_f32_16x16x32_bf16 v[68:71], a[56:59], v[80:83], v[68:71]
    s_cselect_b32 s15, s61, s12
    v_cvt_pk_f16_f32 v36, v32, v33
    v_mul_f32 v34, v34, v61
    v_mfma_f32_16x16x32_bf16 v[68:71], a[60:63], v[28:31], v[68:71]
    s_cselect_b32 s56, s69, s70
    v_mul_f32 v35, v35, v61
    v_cvt_pk_f16_f32 v37, v34, v35
    v_mfma_f32_16x16x32_bf16 v[68:71], a[64:67], v[48:51], v[68:71]
    s_add_u32 s56, s56, s15
    v_mul_f32 v4, v4, v61
    v_mul_f32 v5, v5, v61
    v_mfma_f32_16x16x32_bf16 v[68:71], a[68:71], v[20:23], v[68:71]
    s_mul_i32 s53, s56, 58255
    v_cvt_pk_f16_f32 v38, v4, v5
    v_mul_f32 v6, v6, v61
    v_mfma_f32_16x16x32_bf16 v[72:75], a[72:75], v[88:91], 0
    s_lshr_b32 s53, s53, 22
    v_mul_f32 v7, v7, v61
    v_cvt_pk_f16_f32 v39, v6, v7
    v_mfma_f32_16x16x32_bf16 v[72:75], a[76:79], v[56:59], v[72:75]
    s_mul_i32 s53, s53, s63
    v_mul_f32 v24, v24, v61
    v_mul_f32 v25, v25, v61
    v_mfma_f32_16x16x32_bf16 v[72:75], a[80:83], v[80:83], v[72:75]
    s_mul_i32 s56, s56, s62
    v_cvt_pk_f16_f32 v148, v24, v25
    v_mul_f32 v26, v26, v61
    v_mfma_f32_16x16x32_bf16 v[72:75], a[84:87], v[28:31], v[72:75]
    s_add_u32 s56, s56, s53
    v_mul_f32 v27, v27, v61
    v_cvt_pk_f16_f32 v149, v26, v27
    v_mfma_f32_16x16x32_bf16 v[72:75], a[88:91], v[48:51], v[72:75]
    s_mul_i32 s4, s15, 112
    v_mul_f32 v42, v42, v86
    v_mul_f32 v43, v43, v86
    v_mfma_f32_16x16x32_bf16 v[72:75], a[92:95], v[20:23], v[72:75]
    s_cmp_ge_u32 s15, 16
    v_cvt_pk_bf16_f32 v41, v42, v43
    v_mul_f32 v140, v140, v86
    v_mfma_f32_16x16x32_bf16 v[4:7], a[96:99], v[88:91], 0
    s_cselect_b32 s53, -30464, 0
    ds_write_b64 v135, v[40:41] offset:3072
    v_mfma_f32_16x16x32_bf16 v[4:7], a[100:103], v[56:59], v[4:7]
    s_add_u32 s4, s4, s53
    v_mul_f32 v141, v141, v86
    v_cvt_pk_bf16_f32 v42, v140, v141
    v_mfma_f32_16x16x32_bf16 v[4:7], a[104:107], v[80:83], v[4:7]
    s_cmp_lt_u32 s15, s73
    v_mul_f32 v142, v142, v86
    v_mul_f32 v143, v143, v86
    v_mfma_f32_16x16x32_bf16 v[4:7], a[108:111], v[28:31], v[4:7]
    s_cselect_b32 s26, 100270464, 0
    v_cvt_pk_bf16_f32 v43, v142, v143
    v_mul_f32 v44, v44, v86
    v_mfma_f32_16x16x32_bf16 v[4:7], a[112:115], v[48:51], v[4:7]
    s_cselect_b32 s56, s56, 0
    ds_write_b64 v135, v[42:43] offset:3080
    v_mfma_f32_16x16x32_bf16 v[4:7], a[116:119], v[20:23], v[4:7]
    s_cselect_b32 s4, s4, -1
    v_mul_f32 v45, v45, v86
    v_cvt_pk_bf16_f32 v44, v44, v45
    v_mul_f32 v46, v46, v86
    v_mul_f32 v47, v47, v86
    v_cvt_pk_bf16_f32 v45, v46, v47
    s_cselect_b32 s15, s15, 0
    s_cselect_b32 s13, s13, -1
    ds_write_b64 v134, v[44:45] offset:3072
    v_fma_f32 v120, v92, v92, s41
    v_fmac_f32 v120, v93, v93
    v_fmac_f32 v120, v94, v94
    v_fmac_f32 v120, v95, v95
    v_mfma_f32_16x16x32_bf16 v[24:27], a[120:123], v[88:91], 0
    s_waitcnt vmcnt(0)
    v_fmac_f32 v120, v64, v64
    v_fmac_f32 v120, v65, v65
    v_mfma_f32_16x16x32_bf16 v[24:27], a[124:127], v[56:59], v[24:27]
    s_bitset1_b32 s64, s15
    v_fmac_f32 v120, v66, v66
    v_fmac_f32 v120, v67, v67
    v_mfma_f32_16x16x32_bf16 v[24:27], a[128:131], v[80:83], v[24:27]
    s_add_u32 s65, s65, 1
    v_fmac_f32 v120, v68, v68
    v_fmac_f32 v120, v69, v69
    v_mfma_f32_16x16x32_bf16 v[24:27], a[132:135], v[28:31], v[24:27]
    s_cmp_ge_i32 s65, 2
    v_fmac_f32 v120, v70, v70
    v_fmac_f32 v120, v71, v71
    v_mfma_f32_16x16x32_bf16 v[24:27], a[136:139], v[48:51], v[24:27]
    s_cselect_b32 s30, 100270464, 0
    v_fma_f32 v121, v72, v72, s41
    v_fmac_f32 v121, v73, v73
    v_mfma_f32_16x16x32_bf16 v[24:27], a[140:143], v[20:23], v[24:27]
    s_add_u32 s67, s46, s54
    v_fmac_f32 v121, v74, v74
    v_fmac_f32 v121, v75, v75
    v_mfma_f32_16x16x32_bf16 v[32:35], v[88:91], a[144:147], 0
    s_waitcnt lgkmcnt(0)
    s_add_u32 m0, s67, 0
    v_fmac_f32 v121, v4, v4
    v_fmac_f32 v121, v5, v5
    v_mfma_f32_16x16x32_bf16 v[32:35], v[56:59], a[148:151], v[32:35]
    s_barrier
    v_fmac_f32 v121, v6, v6
    v_fmac_f32 v121, v7, v7
    v_mfma_f32_16x16x32_bf16 v[32:35], v[80:83], a[152:155], v[32:35]
    s_cmp_ge_u32 s61, s13
    v_fmac_f32 v121, v24, v24
    v_fmac_f32 v121, v25, v25
    v_mfma_f32_16x16x32_bf16 v[32:35], v[28:31], a[156:159], v[32:35]
    s_cbranch_scc1 L_atomS0
L_atomrS0:
    v_mfma_f32_16x16x32_bf16 v[32:35], v[48:51], a[160:163], v[32:35]
    v_fmac_f32 v121, v26, v26
    v_fmac_f32 v121, v27, v27
    v_mfma_f32_16x16x32_bf16 v[32:35], v[20:23], a[164:167], v[32:35]
    v_cvt_pk_bf16_f32 v170, v120, v121
    v_add_u32 v137, s50, v137
    v_mfma_f32_16x16x32_bf16 v[40:43], v[88:91], a[168:171], 0
    ds_read_b128 v[60:63], v137 offset:0
    v_add_u32 v136, s50, v136
    v_mfma_f32_16x16x32_bf16 v[40:43], v[56:59], a[172:175], v[40:43]
    s_nop 0
    ds_read_b128 v[84:87], v136 offset:0
    v_cvt_pk_bf16_f32 v164, v32, v33
    v_mfma_f32_16x16x32_bf16 v[40:43], v[80:83], a[176:179], v[40:43]
    ds_read_b128 v[52:55], v137 offset:128
    v_cvt_pk_bf16_f32 v165, v34, v35
    v_mfma_f32_16x16x32_bf16 v[40:43], v[28:31], a[180:183], v[40:43]
    ds_read_b128 v[112:115], v136 offset:128
    v_add_u32 v135, s48, v135
    v_mfma_f32_16x16x32_bf16 v[40:43], v[48:51], a[184:187], v[40:43]
    ds_read_b128 v[108:111], v137 offset:256
    v_add_u32 v134, s48, v134
    v_mfma_f32_16x16x32_bf16 v[40:43], v[20:23], a[188:191], v[40:43]
    s_nop 0
    ds_read_b128 v[104:107], v136 offset:256
    v_add_u32 v133, s51, v133
    v_mfma_f32_16x16x16_bf16 v[118:121], v[216:217], v[170:171], 0
    s_nop 0
    v_add_u32 v132, s14, v132
    v_add_u32 v131, s14, v131
    v_add_u32 v123, s14, v123
    v_cvt_pk_bf16_f32 v160, v40, v41
    v_mfma_f32_16x16x32_bf16 v[100:103], v[88:91], a[192:195], 0
    v_cvt_pk_bf16_f32 v161, v42, v43
    v_and_b32 v116, -8, v123
    v_mfma_f32_16x16x32_bf16 v[100:103], v[56:59], a[196:199], v[100:103]
    v_rsq_f32 v118, v118
    v_mfma_f32_16x16x32_bf16 v[100:103], v[80:83], a[200:203], v[100:103]
    v_rsq_f32 v119, v119
    v_mfma_f32_16x16x32_bf16 v[100:103], v[28:31], a[204:207], v[100:103]
    ds_read_b128 v[28:31], v132 offset:0
    v_mul_f32 v118, s55, v118
    v_mfma_f32_16x16x32_bf16 v[100:103], v[48:51], a[208:211], v[100:103]
    ds_read_b128 v[48:51], v132 offset:16
    v_mul_f32 v119, 0.5, v119
    v_mfma_f32_16x16x32_bf16 v[100:103], v[20:23], a[212:215], v[100:103]
    s_waitcnt lgkmcnt(3)
    ds_read_b128 v[20:23], v132 offset:48
    v_mul_f32 v72, v72, v119
    v_mfma_f32_16x16x32_bf16 v[32:35], a[216:219], v[60:63], 0
    ds_read_b128 v[88:91], v133 offset:0
    v_mul_f32 v73, v73, v119
    v_mfma_f32_16x16x32_bf16 v[32:35], a[220:223], v[84:87], v[32:35]
    v_cvt_pk_f16_f32 v40, v72, v73
    v_mul_f32 v74, v74, v119
    v_mfma_f32_16x16x32_bf16 v[32:35], a[224:227], v[52:55], v[32:35]
    v_mul_f32 v75, v75, v119
    v_cvt_pk_f16_f32 v41, v74, v75
    v_mfma_f32_16x16x32_bf16 v[32:35], a[228:231], v[112:115], v[32:35]
    v_mul_f32 v4, v4, v119
    v_mul_f32 v5, v5, v119
    v_mfma_f32_16x16x32_bf16 v[32:35], a[232:235], v[108:111], v[32:35]
    s_waitcnt lgkmcnt(4)
    v_cvt_pk_f16_f32 v42, v4, v5
    v_mul_f32 v6, v6, v119
    v_mfma_f32_16x16x32_bf16 v[32:35], a[236:239], v[104:107], v[32:35]
    v_mul_f32 v7, v7, v119
    v_cvt_pk_f16_f32 v43, v6, v7
    v_mfma_f32_16x16x32_bf16 v[4:7], a[240:243], v[60:63], 0
    v_mul_f32 v24, v24, v119
    v_mul_f32 v25, v25, v119
    v_mfma_f32_16x16x32_bf16 v[4:7], a[244:247], v[84:87], v[4:7]
    v_cvt_pk_f16_f32 v142, v24, v25
    v_mul_f32 v26, v26, v119
    v_mfma_f32_16x16x32_bf16 v[4:7], a[248:251], v[52:55], v[4:7]
    v_mul_f32 v27, v27, v119
    v_cvt_pk_f16_f32 v143, v26, v27
    v_mfma_f32_16x16x32_bf16 v[4:7], a[252:255], v[112:115], v[4:7]
    s_waitcnt lgkmcnt(0)
    buffer_load_dwordx4 v128, s[24:27], s56 offen nt lds
    v_mul_f32 v92, v92, v118
    v_mfma_f32_16x16x32_bf16 v[4:7], v[224:227], v[108:111], v[4:7]
    v_mul_f32 v93, v93, v118
    v_cvt_pk_f16_f32 v44, v92, v93
    v_mfma_f32_16x16x32_bf16 v[4:7], v[228:231], v[104:107], v[4:7]
    v_mul_f32 v94, v94, v118
    v_mul_f32 v95, v95, v118
    v_mfma_f32_16x16x32_bf16 v[24:27], v[232:235], v[60:63], 0
    v_cvt_pk_f16_f32 v45, v94, v95
    v_mul_f32 v64, v64, v118
    v_mfma_f32_16x16x32_bf16 v[24:27], v[236:239], v[84:87], v[24:27]
    v_mul_f32 v65, v65, v118
    v_cvt_pk_f16_f32 v46, v64, v65
    v_mfma_f32_16x16x32_bf16 v[24:27], v[240:243], v[52:55], v[24:27]
    v_mul_f32 v66, v66, v118
    v_mul_f32 v67, v67, v118
    v_mfma_f32_16x16x32_bf16 v[24:27], v[244:247], v[112:115], v[24:27]
    v_cvt_pk_f16_f32 v47, v66, v67
    v_mul_f32 v68, v68, v118
    v_mfma_f32_16x16x32_bf16 v[24:27], v[248:251], v[108:111], v[24:27]
    buffer_store_dwordx4 v[88:91], v128, s[28:31], s60 offen sc1
    v_mul_f32 v69, v69, v118
    v_cvt_pk_f16_f32 v140, v68, v69
    v_mul_f32 v70, v70, v118
    v_mul_f32 v71, v71, v118
    v_mfma_f32_16x16x32_bf16 v[24:27], v[252:255], v[104:107], v[24:27]
    s_add_u32 m0, s67, 1024
    v_cvt_pk_f16_f32 v141, v70, v71
    v_cvt_pk_bf16_f32 v156, v100, v101
    v_mfma_f32_16x16x32_f16 v[112:115], v[16:19], v[76:79], v[204:207]
    ds_read_u16 v166, v131 offset:80
    v_cvt_pk_bf16_f32 v157, v102, v103
    v_mfma_f32_16x16x32_f16 v[112:115], v[152:155], v[150:153], v[112:115]
    ds_read_u16 v162, v131 offset:96
    v_mfma_f32_16x16x32_f16 v[108:111], v[36:39], v[76:79], v[200:203]
    s_nop 0
    ds_read_u16 v158, v131 offset:104
    s_nop 0
    v_mfma_f32_16x16x32_f16 v[108:111], v[146:149], v[150:153], v[108:111]
    s_nop 0
    ds_read_b32 v116, v116 offset:64
    v_max3_f32 v120, v112, v113, v114
    v_mfma_f32_16x16x32_f16 v[104:107], v[40:43], v[76:79], v[196:199]
    ds_read_b128 v[68:71], v133 offset:1024
    v_mfma_f32_16x16x32_f16 v[104:107], v[140:143], v[150:153], v[104:107]
    s_nop 0
    ds_read_b128 v[72:75], v137 offset:1536
    v_max3_f32 v120, v120, v115, v108
    v_mfma_f32_16x16x32_f16 v[88:91], v[28:31], v[76:79], v[208:211]
    ds_read_b128 v[76:79], v136 offset:1536
    v_max3_f32 v120, v120, v109, v110
    v_mfma_f32_16x16x32_f16 v[88:91], v[48:51], v[16:19], v[88:91]
    ds_read_b128 v[60:63], v137 offset:1664
    v_max3_f32 v120, v120, v111, v104
    v_mfma_f32_16x16x32_f16 v[88:91], v[20:23], v[152:155], v[88:91]
    ds_read_b128 v[56:59], v136 offset:1664
    v_max3_f32 v120, v120, v105, v106
    v_mfma_f32_16x16x32_f16 v[92:95], v[28:31], v[96:99], v[208:211]
    ds_read_b128 v[64:67], v137 offset:1792
    s_nop 0
    v_mfma_f32_16x16x32_f16 v[92:95], v[48:51], v[36:39], v[92:95]
    s_nop 0
    ds_read_b128 v[80:83], v136 offset:1792
    v_max3_f32 v120, v120, v107, v88
    v_mfma_f32_16x16x32_f16 v[92:95], v[20:23], v[146:149], v[92:95]
    v_mov_b32 v121, v120
    v_mfma_f32_16x16x32_f16 v[84:87], v[28:31], v[44:47], v[208:211]
    s_nop 0
    v_permlane32_swap_b32 v121, v120
    v_mfma_f32_16x16x32_f16 v[84:87], v[48:51], v[40:43], v[84:87]
    s_waitcnt lgkmcnt(6)
    buffer_load_dwordx4 v127, s[24:27], s56 offen nt lds
    v_max_f32 v120, v121, v120
    v_mfma_f32_16x16x32_f16 v[84:87], v[20:23], v[140:143], v[84:87]
    s_waitcnt lgkmcnt(5)
    v_mov_b32 v121, v120
    v_mov_b32_dpp v91, v95 quad_perm:[0,1,2,3] row_mask:0x2 bank_mask:0xf
    v_mfma_f32_16x16x32_bf16 v[28:31], a[216:219], v[72:75], 0
    s_waitcnt lgkmcnt(4)
    v_permlane16_swap_b32 v121, v120
    v_mfma_f32_16x16x32_bf16 v[28:31], a[220:223], v[76:79], v[28:31]
    s_waitcnt lgkmcnt(3)
    v_max_f32 v120, v121, v120
    v_sub_f32 v112, v112, v120
    v_mfma_f32_16x16x32_bf16 v[28:31], a[224:227], v[60:63], v[28:31]
    s_waitcnt lgkmcnt(2)
    v_sub_f32 v113, v113, v120
    v_sub_f32 v114, v114, v120
    v_mfma_f32_16x16x32_bf16 v[28:31], a[228:231], v[56:59], v[28:31]
    s_waitcnt lgkmcnt(1)
    v_sub_f32 v115, v115, v120
    v_sub_f32 v108, v108, v120
    v_mfma_f32_16x16x32_bf16 v[28:31], a[232:235], v[64:67], v[28:31]
    s_waitcnt lgkmcnt(0)
    v_sub_f32 v109, v109, v120
    v_sub_f32 v110, v110, v120
    v_mfma_f32_16x16x32_bf16 v[28:31], a[236:239], v[80:83], v[28:31]
    buffer_store_dwordx4 v[68:71], v127, s[28:31], s60 offen sc1
    ds_read_b128 v[100:103], v133 offset:2048
    v_sub_f32 v111, v111, v120
    v_sub_f32 v104, v104, v120
    v_sub_f32 v105, v105, v120
    v_mfma_f32_16x16x32_f16 v[48:51], v[16:19], v[96:99], v[192:195]
    s_add_u32 m0, s67, 2048
    v_sub_f32 v106, v106, v120
    v_sub_f32 v107, v107, v120
    v_mfma_f32_16x16x32_f16 v[48:51], v[152:155], v[144:147], v[48:51]
    v_sub_f32 v88, v88, v120
    v_mov_b32_dpp v91, v87 quad_perm:[0,1,2,3] row_mask:0x4 bank_mask:0xf
    v_mfma_f32_16x16x32_f16 v[68:71], v[36:39], v[96:99], v[188:191]
    v_exp_f32 v112, v112
    v_mfma_f32_16x16x32_f16 v[68:71], v[146:149], v[144:147], v[68:71]
    v_exp_f32 v113, v113
    v_mfma_f32_16x16x32_f16 v[52:55], v[40:43], v[96:99], v[184:187]
    v_exp_f32 v114, v114
    v_mfma_f32_16x16x32_f16 v[52:55], v[140:143], v[144:147], v[52:55]
    v_exp_f32 v115, v115
    v_mfma_f32_16x16x32_bf16 v[20:23], a[240:243], v[72:75], 0
    v_cvt_pk_bf16_f32 v96, v112, v113
    v_cvt_pk_bf16_f32 v97, v114, v115
    v_mfma_f32_16x16x32_bf16 v[20:23], a[244:247], v[76:79], v[20:23]
    v_exp_f32 v108, v108
    v_mfma_f32_16x16x32_bf16 v[20:23], a[248:251], v[60:63], v[20:23]
    s_waitcnt lgkmcnt(0)
    buffer_load_dwordx4 v126, s[24:27], s56 offen nt lds
    v_and_b32 v120, 0xffff0000, v116
    v_mfma_f32_16x16x32_bf16 v[20:23], a[252:255], v[56:59], v[20:23]
    v_exp_f32 v109, v109
    v_mfma_f32_16x16x32_bf16 v[20:23], v[224:227], v[64:67], v[20:23]
    v_exp_f32 v110, v110
    v_mfma_f32_16x16x32_bf16 v[20:23], v[228:231], v[80:83], v[20:23]
    s_mov_b32 s53, s47
    v_exp_f32 v111, v111
    v_cvt_pk_bf16_f32 v98, v108, v109
    v_cvt_pk_bf16_f32 v99, v110, v111
    v_exp_f32 v104, v104
    v_exp_f32 v105, v105
    v_exp_f32 v106, v106
    v_exp_f32 v107, v107
    v_cvt_pk_bf16_f32 v168, v104, v105
    v_cvt_pk_bf16_f32 v169, v106, v107
    v_exp_f32 v88, v88
    v_lshlrev_b32 v116, 16, v116
    v_cvt_pk_bf16_f32 v170, v88, 0
    v_mfma_f32_16x16x32_bf16 v[112:115], v[220:223], v[96:99], 0
    s_add_u32 m0, s67, 3072
    buffer_store_dwordx4 v[100:103], v126, s[28:31], s60 offen sc1
    v_add_f32 v116, v116, v120
    v_add_f32 v116, v116, v211
    v_max3_f32 v120, v48, v49, v50
    v_max3_f32 v120, v120, v51, v68
    v_mfma_f32_16x16x32_bf16 v[112:115], v[220:223], v[168:171], v[112:115]
    s_mov_b32 s47, s46
    v_mov_b32_dpp v91, v116 quad_perm:[0,1,2,3] row_mask:0x8 bank_mask:0xf
    v_mov_b32 v121, v91
    v_mfma_f32_16x16x32_bf16 v[108:111], v[0:3], v[96:99], 0
    s_mov_b32 s46, s45
    v_max_f32_dpp v121, v121, v121 row_ror:8 row_mask:0xf bank_mask:0xf
    v_max3_f32 v120, v120, v69, v70
    v_mfma_f32_16x16x32_bf16 v[108:111], v[164:167], v[168:171], v[108:111]
    s_mov_b32 s45, s44
    v_max_f32_dpp v121, v121, v121 row_ror:4 row_mask:0xf bank_mask:0xf
    v_max3_f32 v120, v120, v71, v52
    v_mfma_f32_16x16x32_bf16 v[104:107], v[8:11], v[96:99], 0
    s_mov_b32 s44, s53
    v_max_f32_dpp v121, v121, v121 row_ror:2 row_mask:0xf bank_mask:0xf
    v_max3_f32 v120, v120, v53, v54
    v_mfma_f32_16x16x32_bf16 v[104:107], v[160:163], v[168:171], v[104:107]
    s_sub_u32 s48, s44, s46
    v_max_f32_dpp v121, v121, v121 row_ror:1 row_mask:0xf bank_mask:0xf
    v_mov_b32 v84, v121
    v_mfma_f32_16x16x32_bf16 v[100:103], v[12:15], v[96:99], 0
    s_sub_u32 s49, s46, s45
    v_permlane32_swap_b32 v84, v121
    v_mfma_f32_16x16x32_bf16 v[100:103], v[156:159], v[168:171], v[100:103]
    v_max_f32 v121, v84, v121
    v_mov_b32 v84, v121
    v_rcp_f32 v112, v112
    v_max3_f32 v120, v120, v55, v93
    v_permlane16_swap_b32 v84, v121
    v_max_f32 v121, v84, v121
    v_sub_f32 v91, v91, v121
    v_exp_f32 v91, v91
    v_mul_f32 v108, v108, v112
    v_cvt_pk_bf16_f32 v91, v91, v91
    ds_write_b16 v123, v91 offset:64
    v_mul_f32 v109, v109, v112
    v_cvt_pk_bf16_f32 v88, v108, v109
    ds_read_b128 v[94:97], v132 offset:48
    v_mul_f32 v110, v110, v112
    v_mul_f32 v111, v111, v112
    v_cvt_pk_bf16_f32 v89, v110, v111
    ds_read_b128 v[108:111], v132 offset:64
    v_mfma_f32_16x16x32_bf16 v[114:117], v[232:235], v[72:75], 0
    v_mul_f32 v104, v104, v112
    v_mul_f32 v105, v105, v112
    v_mfma_f32_16x16x32_bf16 v[114:117], v[236:239], v[76:79], v[114:117]
    ds_write_b64 v135, v[88:89] offset:0
    v_mfma_f32_16x16x32_bf16 v[114:117], v[240:243], v[60:63], v[114:117]
    v_cvt_pk_bf16_f32 v90, v104, v105
    v_mul_f32 v106, v106, v112
    v_mfma_f32_16x16x32_bf16 v[114:117], v[244:247], v[56:59], v[114:117]
    v_mul_f32 v107, v107, v112
    v_cvt_pk_bf16_f32 v91, v106, v107
    v_mfma_f32_16x16x32_bf16 v[114:117], v[248:251], v[64:67], v[114:117]
    ds_write_b64 v135, v[90:91] offset:8
    v_mfma_f32_16x16x32_bf16 v[114:117], v[252:255], v[80:83], v[114:117]
    s_waitcnt lgkmcnt(3)
    v_mul_f32 v100, v100, v112
    v_mul_f32 v101, v101, v112
    v_cvt_pk_bf16_f32 v168, v100, v101
    v_mul_f32 v102, v102, v112
    v_mfma_f32_16x16x32_bf16 v[72:75], v[94:97], v[0:3], 0
    s_waitcnt lgkmcnt(2)
    v_mul_f32 v103, v103, v112
    v_cvt_pk_bf16_f32 v169, v102, v103
    v_mov_b32 v170, v120
    v_fma_f32 v92, v32, v32, s42
    v_mfma_f32_16x16x32_bf16 v[72:75], v[108:111], v[164:167], v[72:75]
    ds_write_b64 v134, v[168:169] offset:0
    v_mfma_f32_16x16x32_bf16 v[88:91], v[94:97], v[8:11], 0
    v_permlane32_swap_b32 v170, v120
    v_mfma_f32_16x16x32_bf16 v[88:91], v[108:111], v[160:163], v[88:91]
    v_max_f32 v120, v170, v120
    v_mov_b32 v170, v120
    v_mfma_f32_16x16x32_bf16 v[76:79], v[94:97], v[12:15], 0
    s_nop 0
    v_permlane16_swap_b32 v170, v120
    v_mfma_f32_16x16x32_bf16 v[76:79], v[108:111], v[156:159], v[76:79]
    ds_read_b128 v[60:63], v133 offset:3072
    v_max_f32 v120, v170, v120
    v_sub_f32 v48, v48, v120
    v_sub_f32 v49, v49, v120
    v_sub_f32 v50, v50, v120
    v_sub_f32 v51, v51, v120
    v_sub_f32 v68, v68, v120
    v_sub_f32 v69, v69, v120
    v_sub_f32 v70, v70, v120
    v_sub_f32 v71, v71, v120
    v_sub_f32 v52, v52, v120
    v_sub_f32 v53, v53, v120
    v_sub_f32 v54, v54, v120
    v_sub_f32 v55, v55, v120
    v_sub_f32 v93, v93, v120
    v_exp_f32 v48, v48
    v_exp_f32 v49, v49
    v_exp_f32 v50, v50
    v_exp_f32 v51, v51
    v_cvt_pk_bf16_f32 v56, v48, v49
    v_cvt_pk_bf16_f32 v57, v50, v51
    v_exp_f32 v68, v68
    v_exp_f32 v69, v69
    v_exp_f32 v70, v70
    v_exp_f32 v71, v71
    v_cvt_pk_bf16_f32 v58, v68, v69
    v_cvt_pk_bf16_f32 v59, v70, v71
    v_exp_f32 v52, v52
    v_exp_f32 v53, v53
    v_exp_f32 v54, v54
    v_exp_f32 v55, v55
    v_cvt_pk_bf16_f32 v168, v52, v53
    v_cvt_pk_bf16_f32 v169, v54, v55
    v_exp_f32 v93, v93
    v_mov_b32_dpp v75, v91 quad_perm:[0,1,2,3] row_mask:0x2 bank_mask:0xf
    v_cvt_pk_bf16_f32 v170, v93, 0
    v_mfma_f32_16x16x32_bf16 v[88:91], v[220:223], v[56:59], 0
    s_waitcnt lgkmcnt(0)
    buffer_load_dwordx4 v125, s[24:27], s56 offen nt lds
    ds_read_b128 v[64:67], v137 offset:3072
    v_mfma_f32_16x16x32_bf16 v[88:91], v[220:223], v[168:171], v[88:91]
    v_mov_b32_dpp v75, v79 quad_perm:[0,1,2,3] row_mask:0x4 bank_mask:0xf
    v_cvt_pk_bf16_f32 v75, v75, v75
    v_mfma_f32_16x16x32_bf16 v[76:79], v[0:3], v[56:59], 0
    ds_write_b16 v131, v75
    v_mfma_f32_16x16x32_bf16 v[76:79], v[164:167], v[168:171], v[76:79]
    ds_read_b128 v[72:75], v136 offset:3072
    v_fmac_f32 v92, v33, v33
    v_mfma_f32_16x16x32_bf16 v[80:83], v[8:11], v[56:59], 0
    ds_read_b128 v[48:51], v137 offset:3200
    v_fmac_f32 v92, v34, v34
    v_mfma_f32_16x16x32_bf16 v[80:83], v[160:163], v[168:171], v[80:83]
    ds_read_b128 v[68:71], v136 offset:3200
    v_fmac_f32 v92, v35, v35
    v_mfma_f32_16x16x32_bf16 v[52:55], v[12:15], v[56:59], 0
    ds_read_b128 v[56:59], v137 offset:3328
    v_add_u32 v137, s48, v137
    v_mfma_f32_16x16x32_bf16 v[52:55], v[156:159], v[168:171], v[52:55]
    buffer_store_dwordx4 v[60:63], v125, s[28:31], s60 offen sc1
    ds_read_b128 v[94:97], v136 offset:3328
    v_rcp_f32 v88, v88
    v_add_u32 v136, s48, v136
    v_mfma_f32_16x16x32_f16 v[60:63], v[16:19], v[44:47], v[180:183]
    s_add_u32 m0, s67, 4096
    ds_read_b128 v[16:19], v133 offset:4096
    v_mul_f32 v76, v76, v88
    v_mfma_f32_16x16x32_f16 v[60:63], v[152:155], v[138:141], v[60:63]
    s_cmp_lg_u32 s5, -1
    v_mul_f32 v77, v77, v88
    v_cvt_pk_bf16_f32 v76, v76, v77
    v_mfma_f32_16x16x32_f16 v[152:155], v[36:39], v[44:47], v[176:179]
    v_mul_f32 v78, v78, v88
    v_mul_f32 v79, v79, v88
    v_mfma_f32_16x16x32_f16 v[152:155], v[146:149], v[138:141], v[152:155]
    v_cvt_pk_bf16_f32 v77, v78, v79
    v_mul_f32 v80, v80, v88
    v_mfma_f32_16x16x32_f16 v[36:39], v[40:43], v[44:47], v[172:175]
    ds_write_b64 v135, v[76:77] offset:1536
    v_mfma_f32_16x16x32_f16 v[36:39], v[140:143], v[138:141], v[36:39]
    s_waitcnt lgkmcnt(4)
    v_mul_f32 v81, v81, v88
    v_cvt_pk_bf16_f32 v78, v80, v81
    v_mfma_f32_16x16x32_bf16 v[40:43], a[216:219], v[64:67], 0
    v_mul_f32 v82, v82, v88
    v_mul_f32 v83, v83, v88
    v_mfma_f32_16x16x32_bf16 v[40:43], a[220:223], v[72:75], v[40:43]
    v_cvt_pk_bf16_f32 v79, v82, v83
    v_mul_f32 v52, v52, v88
    v_mfma_f32_16x16x32_bf16 v[40:43], a[224:227], v[48:51], v[40:43]
    ds_write_b64 v135, v[78:79] offset:1544
    v_mfma_f32_16x16x32_bf16 v[40:43], a[228:231], v[68:71], v[40:43]
    s_waitcnt lgkmcnt(2)
    buffer_load_dwordx4 v124, s[24:27], s56 offen nt lds
    v_mul_f32 v53, v53, v88
    v_mfma_f32_16x16x32_bf16 v[40:43], a[232:235], v[56:59], v[40:43]
    v_cvt_pk_bf16_f32 v168, v52, v53
    v_mul_f32 v54, v54, v88
    v_mfma_f32_16x16x32_bf16 v[40:43], a[236:239], v[94:97], v[40:43]
    v_mul_f32 v55, v55, v88
    v_cvt_pk_bf16_f32 v169, v54, v55
    v_mfma_f32_16x16x32_bf16 v[140:143], a[240:243], v[64:67], 0
    ds_write_b64 v134, v[168:169] offset:1536
    v_mfma_f32_16x16x32_bf16 v[140:143], a[244:247], v[72:75], v[140:143]
    v_max3_f32 v168, v60, v61, v62
    v_max3_f32 v168, v168, v63, v152
    v_mfma_f32_16x16x32_bf16 v[140:143], a[248:251], v[48:51], v[140:143]
    v_max3_f32 v168, v168, v153, v154
    v_max3_f32 v168, v168, v155, v36
    v_mfma_f32_16x16x32_bf16 v[140:143], a[252:255], v[68:71], v[140:143]
    v_max3_f32 v168, v168, v37, v38
    v_max3_f32 v168, v168, v39, v86
    v_mfma_f32_16x16x32_bf16 v[140:143], v[224:227], v[56:59], v[140:143]
    buffer_store_dwordx4 v[16:19], v124, s[28:31], s60 offen sc1
    v_mov_b32 v169, v168
    v_fmac_f32 v92, v4, v4
    v_fmac_f32 v92, v5, v5
    v_fmac_f32 v92, v6, v6
    v_mfma_f32_16x16x32_bf16 v[140:143], v[228:231], v[94:97], v[140:143]
    ds_read_b128 v[16:19], v137 offset:0
    v_fmac_f32 v92, v7, v7
    v_mfma_f32_16x16x32_bf16 v[44:47], v[232:235], v[64:67], 0
    ds_read_b128 v[146:149], v136 offset:0
    v_fmac_f32 v92, v24, v24
    v_mfma_f32_16x16x32_bf16 v[44:47], v[236:239], v[72:75], v[44:47]
    ds_read_b128 v[72:75], v137 offset:128
    v_fmac_f32 v92, v25, v25
    v_mfma_f32_16x16x32_bf16 v[44:47], v[240:243], v[48:51], v[44:47]
    ds_read_b128 v[88:91], v136 offset:128
    v_fmac_f32 v92, v26, v26
    v_mfma_f32_16x16x32_bf16 v[44:47], v[244:247], v[68:71], v[44:47]
    ds_read_b128 v[76:79], v137 offset:256
    v_fmac_f32 v92, v27, v27
    v_mfma_f32_16x16x32_bf16 v[44:47], v[248:251], v[56:59], v[44:47]
    ds_read_b128 v[56:59], v136 offset:256
    v_fma_f32 v93, v28, v28, s42
    v_mfma_f32_16x16x32_bf16 v[44:47], v[252:255], v[94:97], v[44:47]
    v_permlane32_swap_b32 v169, v168
    v_max_f32 v168, v169, v168
    v_mov_b32 v169, v168
    v_fmac_f32 v93, v29, v29
    v_fmac_f32 v93, v30, v30
    v_permlane16_swap_b32 v169, v168
    v_max_f32 v168, v169, v168
    v_sub_f32 v60, v60, v168
    v_sub_f32 v61, v61, v168
    v_sub_f32 v62, v62, v168
    v_sub_f32 v63, v63, v168
    v_sub_f32 v152, v152, v168
    v_sub_f32 v153, v153, v168
    v_sub_f32 v154, v154, v168
    v_sub_f32 v155, v155, v168
    v_sub_f32 v36, v36, v168
    v_sub_f32 v37, v37, v168
    v_sub_f32 v38, v38, v168
    v_sub_f32 v39, v39, v168
    v_sub_f32 v86, v86, v168
    v_exp_f32 v60, v60
    v_exp_f32 v61, v61
    v_exp_f32 v62, v62
    v_exp_f32 v63, v63
    v_cvt_pk_bf16_f32 v60, v60, v61
    v_cvt_pk_bf16_f32 v61, v62, v63
    v_exp_f32 v152, v152
    v_exp_f32 v153, v153
    v_exp_f32 v154, v154
    v_exp_f32 v155, v155
    v_cvt_pk_bf16_f32 v62, v152, v153
    v_cvt_pk_bf16_f32 v63, v154, v155
    v_exp_f32 v36, v36
    v_exp_f32 v37, v37
    v_exp_f32 v38, v38
    v_exp_f32 v39, v39
    v_cvt_pk_bf16_f32 v168, v36, v37
    v_cvt_pk_bf16_f32 v169, v38, v39
    v_exp_f32 v86, v86
    v_fmac_f32 v93, v31, v31
    v_cvt_pk_bf16_f32 v170, v86, 0
    v_mfma_f32_16x16x32_bf16 v[152:155], v[220:223], v[60:63], 0
    v_fmac_f32 v93, v20, v20
    v_fmac_f32 v93, v21, v21
    v_mfma_f32_16x16x32_bf16 v[152:155], v[220:223], v[168:171], v[152:155]
    v_fmac_f32 v93, v22, v22
    v_fmac_f32 v93, v23, v23
    v_mfma_f32_16x16x32_bf16 v[36:39], v[0:3], v[60:63], 0
    s_nop 0
    v_fmac_f32 v93, v114, v114
    v_fmac_f32 v93, v115, v115
    v_mfma_f32_16x16x32_bf16 v[36:39], v[164:167], v[168:171], v[36:39]
    s_nop 0
    v_rcp_f32 v152, v152
    v_mfma_f32_16x16x32_bf16 v[0:3], v[8:11], v[60:63], 0
    s_nop 0
    v_fmac_f32 v93, v116, v116
    v_fmac_f32 v93, v117, v117
    v_mfma_f32_16x16x32_bf16 v[0:3], v[160:163], v[168:171], v[0:3]
    s_nop 0
    v_mul_f32 v36, v36, v152
    v_mul_f32 v37, v37, v152
    v_mfma_f32_16x16x32_bf16 v[8:11], v[12:15], v[60:63], 0
    v_cvt_pk_bf16_f32 v12, v36, v37
    v_mul_f32 v38, v38, v152
    v_mfma_f32_16x16x32_bf16 v[8:11], v[156:159], v[168:171], v[8:11]
    s_waitcnt lgkmcnt(0)
    v_mul_f32 v39, v39, v152
    v_cvt_pk_bf16_f32 v13, v38, v39
    v_mfma_f32_16x16x32_bf16 v[36:39], a[0:3], v[16:19], 0
    s_cbranch_scc1 L_loopS0
    ds_write_b64 v135, v[12:13] offset:3072
    v_mul_f32 v0, v0, v152
    v_mul_f32 v1, v1, v152
    v_cvt_pk_bf16_f32 v14, v0, v1
    v_mul_f32 v2, v2, v152
    v_mul_f32 v3, v3, v152
    v_cvt_pk_bf16_f32 v15, v2, v3
    v_mul_f32 v8, v8, v152
    v_mul_f32 v9, v9, v152
    v_cvt_pk_bf16_f32 v8, v8, v9
    v_mul_f32 v10, v10, v152
    v_mul_f32 v11, v11, v152
    v_cvt_pk_bf16_f32 v9, v10, v11
    s_mov_b32 s30, 100270464
    s_mul_i32 s89, s68, 7168
    ds_write_b64 v135, v[14:15] offset:3080
    v_fma_f32 v113, v40, v40, s42
    s_add_u32 s89, s89, 135168
    s_movk_i32 s90, 112
    ds_write_b64 v134, v[8:9] offset:3072
    v_fmac_f32 v113, v41, v41
    v_fmac_f32 v113, v42, v42
    v_fmac_f32 v113, v43, v43
    v_fmac_f32 v113, v140, v140
    v_fmac_f32 v113, v141, v141
    v_fmac_f32 v113, v142, v142
    v_fmac_f32 v113, v143, v143
    v_fmac_f32 v113, v44, v44
    v_fmac_f32 v113, v45, v45
    v_fmac_f32 v113, v46, v46
    v_fmac_f32 v113, v47, v47
    v_cvt_pk_bf16_f32 v112, v92, v93
    v_cvt_pk_bf16_f32 v113, v113, v122
    s_lshr_b32 s91, s64, 16
    s_lshl_b32 s92, s68, 10
    ds_write_b64 v130, v[112:113]
    v_mbcnt_lo_u32_b32 v131, -1, 0
    v_mbcnt_hi_u32_b32 v131, -1, v131
    v_and_b32 v132, 15, v131
    v_lshrrev_b32 v131, 4, v131
    v_mul_u32_u24 v118, 1792, v131
    v_add_u32 v118, s89, v118
    v_mad_u32_u24 v131, v132, s90, v118
    v_lshrrev_b32 v119, v132, s64
    v_and_b32 v119, 1, v119
    v_cmp_eq_u32 vcc, 1, v119
    v_mad_u32_u24 v119, v132, s90, v118
    v_lshrrev_b32 v132, v132, s91
    v_cndmask_b32 v131, v118, v131, vcc
    v_and_b32 v132, 1, v132
    v_subrev_u32 v119, 28672, v119
    v_cmp_eq_u32 vcc, 1, v132
    s_sub_u32 s84, s45, s44
    s_sub_u32 s85, s46, s45
    ds_read_b128 v[48:51], v131 offset:64
    ds_read_b128 v[36:39], v131 offset:80
    v_cndmask_b32 v119, v118, v119, vcc
    v_add_u32 v118, s92, v129
    s_waitcnt lgkmcnt(2)
    s_barrier
    s_sub_u32 s86, s44, s45
    ds_read_b128 v[86:89], v131
    v_add_u32 v139, s84, v137
    s_sub_u32 s93, s44, s47
    s_sub_u32 s94, s45, s47
    ds_read_b64 v[90:91], v131 offset:16
    ds_read_b128 v[8:11], v118 offset:6144
    v_add_u32 v138, s84, v136
    v_add_u32 v118, s85, v135
    s_sub_u32 s95, s46, s47
    ds_read_b128 v[16:19], v129 offset:0
    v_add_u32 v63, s85, v134
    ds_read_b128 v[0:3], v129 offset:1024
    v_add_u32 v112, s86, v135
    v_add_u32 v132, s86, v134
    v_add_u32 v131, s93, v133
    v_add_u32 v113, s94, v133
    s_waitcnt lgkmcnt(6)
    v_mfma_f32_16x16x32_bf16 v[12:15], v[220:223], v[48:51], 0
    s_waitcnt lgkmcnt(5)
    ds_read_b128 v[80:83], v139 offset:1536
    ds_read_b128 v[76:79], v138 offset:1536
    v_mfma_f32_16x16x32_bf16 v[12:15], v[220:223], v[36:39], v[12:15]
    s_waitcnt lgkmcnt(3)
    ds_read_b128 v[72:75], v139 offset:1664
    v_lshlrev_b32 v92, 16, v86
    v_and_b32 v86, 0xffff0000, v86
    v_lshlrev_b32 v93, 16, v87
    v_and_b32 v87, 0xffff0000, v87
    v_lshlrev_b32 v94, 16, v88
    v_and_b32 v88, 0xffff0000, v88
    v_rcp_f32 v12, v12
    v_lshlrev_b32 v95, 16, v89
    v_mfma_f32_16x16x32_bf16 v[64:67], v[216:219], v[16:19], 0
    s_waitcnt lgkmcnt(3)
    ds_read_b128 v[68:71], v138 offset:1664
    ds_read_b128 v[48:51], v139 offset:1792
    v_mfma_f32_16x16x32_bf16 v[64:67], v[216:219], v[0:3], v[64:67]
    s_waitcnt lgkmcnt(4)
    ds_read_b128 v[16:19], v138 offset:1792
    v_mul_f32 v92, v92, v12
    v_mul_f32 v86, v86, v12
    v_cvt_pk_bf16_f32 v92, v92, v86
    v_mul_f32 v93, v93, v12
    v_mfma_f32_16x16x32_bf16 v[0:3], a[216:219], v[80:83], 0
    s_waitcnt lgkmcnt(4)
    v_mul_f32 v87, v87, v12
    v_cvt_pk_bf16_f32 v93, v93, v87
    v_mfma_f32_16x16x32_bf16 v[0:3], a[220:223], v[76:79], v[0:3]
    s_waitcnt lgkmcnt(3)
    ds_read_b128 v[108:111], v139 offset:0
    ds_read_b128 v[104:107], v138 offset:0
    v_mfma_f32_16x16x32_bf16 v[0:3], a[224:227], v[72:75], v[0:3]
    s_waitcnt lgkmcnt(4)
    ds_read_b128 v[96:99], v139 offset:128
    v_mul_f32 v94, v94, v12
    v_mul_f32 v88, v88, v12
    v_cvt_pk_bf16_f32 v94, v94, v88
    v_and_b32 v89, 0xffff0000, v89
    v_mul_f32 v95, v95, v12
    v_mfma_f32_16x16x32_bf16 v[0:3], a[228:231], v[68:71], v[0:3]
    s_waitcnt lgkmcnt(4)
    ds_read_b128 v[84:87], v138 offset:128
    ds_read_b128 v[56:59], v139 offset:256
    v_mfma_f32_16x16x32_bf16 v[0:3], a[232:235], v[48:51], v[0:3]
    s_waitcnt lgkmcnt(5)
    ds_read_b128 v[36:39], v138 offset:256
    v_mul_f32 v89, v89, v12
    v_mfma_f32_16x16x32_bf16 v[0:3], a[236:239], v[16:19], v[0:3]
    v_cvt_pk_bf16_f32 v95, v95, v89
    v_lshlrev_b32 v67, 16, v90
    v_mfma_f32_16x16x32_bf16 v[52:55], a[240:243], v[80:83], 0
    ds_write_b128 v112, v[92:95] offset:0
    v_mfma_f32_16x16x32_bf16 v[52:55], a[244:247], v[76:79], v[52:55]
    v_and_b32 v90, 0xffff0000, v90
    v_mul_f32 v67, v67, v12
    v_mfma_f32_16x16x32_bf16 v[52:55], a[248:251], v[72:75], v[52:55]
    v_mul_f32 v90, v90, v12
    v_cvt_pk_bf16_f32 v60, v67, v90
    v_mfma_f32_16x16x32_bf16 v[52:55], a[252:255], v[68:71], v[52:55]
    v_lshlrev_b32 v67, 16, v91
    v_and_b32 v91, 0xffff0000, v91
    v_mfma_f32_16x16x32_bf16 v[52:55], v[224:227], v[48:51], v[52:55]
    v_mul_f32 v67, v67, v12
    v_mul_f32 v91, v91, v12
    v_mfma_f32_16x16x32_bf16 v[52:55], v[228:231], v[16:19], v[52:55]
    v_cvt_pk_bf16_f32 v61, v67, v91
    v_lshrrev_b32 v67, 0, v11
    v_mfma_f32_16x16x32_bf16 v[12:15], v[232:235], v[80:83], 0
    ds_write_b64 v132, v[60:61] offset:0
    v_mfma_f32_16x16x32_bf16 v[12:15], v[236:239], v[76:79], v[12:15]
    v_lshrrev_b32 v67, v67, s64
    v_and_b32 v67, 1, v67
    v_mfma_f32_16x16x32_bf16 v[12:15], v[240:243], v[72:75], v[12:15]
    v_cmp_eq_u32 vcc, 1, v67
    v_lshrrev_b32 v67, 8, v11
    v_mfma_f32_16x16x32_bf16 v[12:15], v[244:247], v[68:71], v[12:15]
    v_cndmask_b32 v8, 2.0, v8, vcc
    v_lshrrev_b32 v67, v67, s64
    v_mfma_f32_16x16x32_bf16 v[12:15], v[248:251], v[48:51], v[12:15]
    v_and_b32 v67, 1, v67
    v_cmp_eq_u32 vcc, 1, v67
    v_mfma_f32_16x16x32_bf16 v[12:15], v[252:255], v[16:19], v[12:15]
    s_waitcnt lgkmcnt(1)
    v_cndmask_b32 v9, 2.0, v9, vcc
    v_lshrrev_b32 v11, 16, v11
    v_mfma_f32_16x16x32_bf16 v[72:75], a[216:219], v[108:111], 0
    v_lshrrev_b32 v11, v11, s64
    v_and_b32 v11, 1, v11
    v_mfma_f32_16x16x32_bf16 v[72:75], a[220:223], v[104:107], v[72:75]
    ds_read_b128 v[100:103], v139 offset:3072
    ds_read_b128 v[92:95], v138 offset:3072
    v_mfma_f32_16x16x32_bf16 v[72:75], a[224:227], v[96:99], v[72:75]
    ds_read_b128 v[88:91], v139 offset:3200
    v_cmp_eq_u32 vcc, 1, v11
    v_mfma_f32_16x16x32_bf16 v[72:75], a[228:231], v[84:87], v[72:75]
    ds_read_b128 v[80:83], v138 offset:3200
    v_cndmask_b32 v10, 2.0, v10, vcc
    v_mfma_f32_16x16x32_bf16 v[72:75], a[232:235], v[56:59], v[72:75]
    ds_read_b128 v[76:79], v139 offset:3328
    v_add_u32 v11, s95, v133
    v_mfma_f32_16x16x32_bf16 v[72:75], a[236:239], v[36:39], v[72:75]
    ds_read_b128 v[16:19], v138 offset:3328
    v_fma_f32 v133, v0, v0, s42
    v_mfma_f32_16x16x32_bf16 v[48:51], a[240:243], v[108:111], 0
    v_rsq_f32 v64, v64
    v_mfma_f32_16x16x32_bf16 v[48:51], a[244:247], v[104:107], v[48:51]
    v_mul_f32 v64, s43, v64
    v_mul_f32 v32, v32, v64
    v_mfma_f32_16x16x32_bf16 v[48:51], a[248:251], v[96:99], v[48:51]
    v_mul_f32 v33, v33, v64
    v_cvt_pk_bf16_f32 v32, v32, v33
    v_mfma_f32_16x16x32_bf16 v[48:51], a[252:255], v[84:87], v[48:51]
    v_mul_f32 v34, v34, v64
    v_mul_f32 v35, v35, v64
    v_mfma_f32_16x16x32_bf16 v[48:51], v[224:227], v[56:59], v[48:51]
    v_cvt_pk_bf16_f32 v33, v34, v35
    v_mul_f32 v4, v4, v64
    v_mfma_f32_16x16x32_bf16 v[48:51], v[228:231], v[36:39], v[48:51]
    v_mul_f32 v5, v5, v64
    v_cvt_pk_bf16_f32 v34, v4, v5
    v_mfma_f32_16x16x32_bf16 v[68:71], v[232:235], v[108:111], 0
    v_mul_f32 v6, v6, v64
    v_mul_f32 v7, v7, v64
    v_mfma_f32_16x16x32_bf16 v[68:71], v[236:239], v[104:107], v[68:71]
    v_cvt_pk_bf16_f32 v35, v6, v7
    v_mul_f32 v24, v24, v64
    v_mfma_f32_16x16x32_bf16 v[68:71], v[240:243], v[96:99], v[68:71]
    ds_write_b128 v118, v[32:35] offset:0
    v_mfma_f32_16x16x32_bf16 v[68:71], v[244:247], v[84:87], v[68:71]
    v_mul_f32 v25, v25, v64
    v_cvt_pk_bf16_f32 v24, v24, v25
    v_mfma_f32_16x16x32_bf16 v[68:71], v[248:251], v[56:59], v[68:71]
    v_mul_f32 v26, v26, v64
    v_mul_f32 v27, v27, v64
    v_mfma_f32_16x16x32_bf16 v[68:71], v[252:255], v[36:39], v[68:71]
    s_waitcnt lgkmcnt(1)
    v_cvt_pk_bf16_f32 v25, v26, v27
    v_fma_f32 v62, v72, v72, s42
    v_mfma_f32_16x16x32_bf16 v[84:87], a[216:219], v[100:103], 0
    ds_write_b64 v63, v[24:25] offset:0
    v_mfma_f32_16x16x32_bf16 v[84:87], a[220:223], v[92:95], v[84:87]
    ds_read_b128 v[24:27], v119 offset:64
    v_fmac_f32 v62, v73, v73
    v_mfma_f32_16x16x32_bf16 v[84:87], a[224:227], v[88:91], v[84:87]
    ds_read_b128 v[4:7], v119 offset:80
    v_fmac_f32 v62, v74, v74
    v_mfma_f32_16x16x32_bf16 v[84:87], a[228:231], v[80:83], v[84:87]
    ds_read_b128 v[56:59], v119
    v_fmac_f32 v62, v75, v75
    v_mfma_f32_16x16x32_bf16 v[84:87], a[232:235], v[76:79], v[84:87]
    ds_read_b64 v[60:61], v119 offset:16
    v_fmac_f32 v62, v48, v48
    v_mfma_f32_16x16x32_bf16 v[84:87], a[236:239], v[16:19], v[84:87]
    v_rsq_f32 v65, v65
    v_mfma_f32_16x16x32_bf16 v[96:99], a[240:243], v[100:103], 0
    v_mul_f32 v65, s43, v65
    v_mul_f32 v28, v28, v65
    v_mfma_f32_16x16x32_bf16 v[96:99], a[244:247], v[92:95], v[96:99]
    v_mul_f32 v29, v29, v65
    v_cvt_pk_bf16_f32 v28, v28, v29
    v_mfma_f32_16x16x32_bf16 v[96:99], a[248:251], v[88:91], v[96:99]
    v_mul_f32 v30, v30, v65
    v_mul_f32 v31, v31, v65
    v_mfma_f32_16x16x32_bf16 v[96:99], a[252:255], v[80:83], v[96:99]
    v_cvt_pk_bf16_f32 v29, v30, v31
    v_mul_f32 v20, v20, v65
    v_mfma_f32_16x16x32_bf16 v[96:99], v[224:227], v[76:79], v[96:99]
    v_mul_f32 v21, v21, v65
    v_cvt_pk_bf16_f32 v30, v20, v21
    v_mfma_f32_16x16x32_bf16 v[96:99], v[228:231], v[16:19], v[96:99]
    v_mul_f32 v22, v22, v65
    v_mul_f32 v23, v23, v65
    v_mfma_f32_16x16x32_bf16 v[36:39], v[232:235], v[100:103], 0
    v_cvt_pk_bf16_f32 v31, v22, v23
    v_mul_f32 v114, v114, v65
    v_mfma_f32_16x16x32_bf16 v[36:39], v[236:239], v[92:95], v[36:39]
    ds_write_b128 v118, v[28:31] offset:1536
    v_mfma_f32_16x16x32_bf16 v[36:39], v[240:243], v[88:91], v[36:39]
    v_mul_f32 v115, v115, v65
    v_cvt_pk_bf16_f32 v114, v114, v115
    v_mfma_f32_16x16x32_bf16 v[36:39], v[244:247], v[80:83], v[36:39]
    v_mul_f32 v116, v116, v65
    v_mul_f32 v117, v117, v65
    v_mfma_f32_16x16x32_bf16 v[36:39], v[248:251], v[76:79], v[36:39]
    v_cvt_pk_bf16_f32 v115, v116, v117
    v_fmac_f32 v62, v49, v49
    v_mfma_f32_16x16x32_bf16 v[36:39], v[252:255], v[16:19], v[36:39]
    s_waitcnt lgkmcnt(1)
    ds_write_b64 v63, v[114:115] offset:1536
    v_mfma_f32_16x16x32_bf16 v[16:19], v[220:223], v[24:27], 0
    v_rsq_f32 v66, v66
    v_mfma_f32_16x16x32_bf16 v[16:19], v[220:223], v[4:7], v[16:19]
    v_mul_f32 v66, s43, v66
    v_mul_f32 v40, v40, v66
    v_mul_f32 v41, v41, v66
    v_cvt_pk_bf16_f32 v4, v40, v41
    v_mul_f32 v42, v42, v66
    v_mul_f32 v43, v43, v66
    v_cvt_pk_bf16_f32 v5, v42, v43
    v_mul_f32 v140, v140, v66
    v_mul_f32 v141, v141, v66
    v_cvt_pk_bf16_f32 v6, v140, v141
    v_mul_f32 v142, v142, v66
    v_mul_f32 v143, v143, v66
    v_cvt_pk_bf16_f32 v7, v142, v143
    v_mul_f32 v44, v44, v66
    v_mul_f32 v45, v45, v66
    v_cvt_pk_bf16_f32 v44, v44, v45
    v_mul_f32 v46, v46, v66
    v_mul_f32 v47, v47, v66
    v_cvt_pk_bf16_f32 v45, v46, v47
    ds_write_b128 v118, v[4:7] offset:3072
    v_fmac_f32 v62, v50, v50
    v_fmac_f32 v62, v51, v51
    v_fmac_f32 v62, v68, v68
    v_fmac_f32 v62, v69, v69
    ds_write_b64 v63, v[44:45] offset:3072
    v_fmac_f32 v62, v70, v70
    v_fmac_f32 v62, v71, v71
    v_fmac_f32 v133, v1, v1
    v_fmac_f32 v133, v2, v2
    v_fmac_f32 v133, v3, v3
    v_fmac_f32 v133, v52, v52
    v_fmac_f32 v133, v53, v53
    v_fmac_f32 v133, v54, v54
    v_fmac_f32 v133, v55, v55
    v_fmac_f32 v133, v12, v12
    v_fmac_f32 v133, v13, v13
    v_fmac_f32 v133, v14, v14
    v_fmac_f32 v133, v15, v15
    v_cvt_pk_bf16_f32 v62, v62, v133
    v_fma_f32 v63, v84, v84, s42
    v_fmac_f32 v63, v85, v85
    v_fmac_f32 v63, v86, v86
    v_fmac_f32 v63, v87, v87
    v_fmac_f32 v63, v96, v96
    v_fmac_f32 v63, v97, v97
    v_fmac_f32 v63, v98, v98
    v_fmac_f32 v63, v99, v99
    v_fmac_f32 v63, v36, v36
    v_fmac_f32 v63, v37, v37
    v_fmac_f32 v63, v38, v38
    v_fmac_f32 v63, v39, v39
    v_cvt_pk_bf16_f32 v63, v63, v63
    ds_write_b64 v130, v[62:63] offset:2048
    v_rcp_f32 v16, v16
    v_lshlrev_b32 v133, 16, v56
    v_and_b32 v56, 0xffff0000, v56
    v_mul_f32 v133, v133, v16
    v_mul_f32 v56, v56, v16
    v_cvt_pk_bf16_f32 v4, v133, v56
    v_lshlrev_b32 v56, 16, v57
    v_and_b32 v57, 0xffff0000, v57
    v_mul_f32 v56, v56, v16
    v_mul_f32 v57, v57, v16
    v_cvt_pk_bf16_f32 v5, v56, v57
    v_lshlrev_b32 v133, 16, v58
    v_and_b32 v58, 0xffff0000, v58
    v_mul_f32 v133, v133, v16
    v_mul_f32 v58, v58, v16
    v_cvt_pk_bf16_f32 v6, v133, v58
    v_lshlrev_b32 v7, 16, v59
    v_and_b32 v59, 0xffff0000, v59
    v_mul_f32 v7, v7, v16
    v_mul_f32 v59, v59, v16
    v_cvt_pk_bf16_f32 v7, v7, v59
    v_lshlrev_b32 v133, 16, v60
    v_and_b32 v60, 0xffff0000, v60
    v_mul_f32 v133, v133, v16
    v_mul_f32 v60, v60, v16
    v_cvt_pk_bf16_f32 v138, v133, v60
    v_lshlrev_b32 v133, 16, v61
    v_and_b32 v61, 0xffff0000, v61
    v_mul_f32 v133, v133, v16
    v_mul_f32 v61, v61, v16
    v_cvt_pk_bf16_f32 v139, v133, v61
    s_waitcnt lgkmcnt(0)
    s_barrier
    ds_write_b128 v112, v[4:7] offset:1536
    v_mov_b32 v115, 0
    ds_write_b64 v132, v[138:139] offset:1536
    ds_read_b128 v[32:35], v11 offset:0
    ds_read_b128 v[4:7], v11 offset:1024
    ds_read_b128 v[24:27], v11 offset:2048
    ds_read_b128 v[20:23], v11 offset:3072
    ds_read_b128 v[80:83], v11 offset:4096
    s_waitcnt lgkmcnt(5)
    s_barrier
    s_waitcnt lgkmcnt(4)
    buffer_store_dwordx4 v[32:35], v128, s[28:31], s59 offen sc1
    ds_read_b128 v[28:31], v129 offset:2048
    ds_read_b128 v[16:19], v129 offset:3072
    ds_read_b128 v[104:107], v137 offset:1536
    ds_read_b128 v[100:103], v136 offset:1536
    ds_read_b128 v[92:95], v137 offset:1664
    ds_read_b128 v[88:91], v136 offset:1664
    ds_read_b128 v[76:79], v137 offset:1792
    s_waitcnt lgkmcnt(9)
    buffer_store_dwordx4 v[4:7], v127, s[28:31], s59 offen sc1
    ds_read_b128 v[40:43], v136 offset:1792
    s_waitcnt lgkmcnt(7)
    v_mfma_f32_16x16x32_bf16 v[4:7], v[216:219], v[28:31], 0
    s_waitcnt lgkmcnt(6)
    v_mfma_f32_16x16x32_bf16 v[4:7], v[216:219], v[16:19], v[4:7]
    s_waitcnt lgkmcnt(5)
    v_mfma_f32_16x16x32_bf16 v[16:19], a[216:219], v[104:107], 0
    s_waitcnt lgkmcnt(4)
    v_mfma_f32_16x16x32_bf16 v[16:19], a[220:223], v[100:103], v[16:19]
    s_waitcnt lgkmcnt(3)
    ds_read_b128 v[64:67], v137 offset:0
    ds_read_b128 v[60:63], v136 offset:0
    v_mfma_f32_16x16x32_bf16 v[16:19], a[224:227], v[92:95], v[16:19]
    s_waitcnt lgkmcnt(4)
    ds_read_b128 v[56:59], v137 offset:128
    v_mfma_f32_16x16x32_bf16 v[16:19], a[228:231], v[88:91], v[16:19]
    s_waitcnt lgkmcnt(4)
    buffer_store_dwordx4 v[24:27], v126, s[28:31], s59 offen sc1
    ds_read_b128 v[44:47], v136 offset:128
    v_rsq_f32 v4, v4
    v_mfma_f32_16x16x32_bf16 v[16:19], a[232:235], v[76:79], v[16:19]
    s_waitcnt lgkmcnt(4)
    ds_read_b128 v[32:35], v137 offset:256
    ds_read_b128 v[24:27], v136 offset:256
    v_mfma_f32_16x16x32_bf16 v[16:19], a[236:239], v[40:43], v[16:19]
    v_rsq_f32 v5, v5
    v_mfma_f32_16x16x32_bf16 v[28:31], a[240:243], v[104:107], 0
    v_mul_f32 v4, s43, v4
    v_mul_f32 v5, s43, v5
    v_mfma_f32_16x16x32_bf16 v[28:31], a[244:247], v[100:103], v[28:31]
    v_rsq_f32 v6, v6
    v_mfma_f32_16x16x32_bf16 v[28:31], a[248:251], v[92:95], v[28:31]
    v_mul_f32 v6, s43, v6
    v_mul_f32 v84, v84, v6
    v_mfma_f32_16x16x32_bf16 v[28:31], a[252:255], v[88:91], v[28:31]
    buffer_store_dwordx4 v[20:23], v125, s[28:31], s59 offen sc1
    v_mul_f32 v85, v85, v6
    v_cvt_pk_bf16_f32 v84, v84, v85
    v_mul_f32 v86, v86, v6
    v_mul_f32 v87, v87, v6
    v_mfma_f32_16x16x32_bf16 v[28:31], v[224:227], v[76:79], v[28:31]
    v_cvt_pk_bf16_f32 v85, v86, v87
    v_mul_f32 v96, v96, v6
    v_mfma_f32_16x16x32_bf16 v[28:31], v[228:231], v[40:43], v[28:31]
    v_mul_f32 v97, v97, v6
    v_cvt_pk_bf16_f32 v86, v96, v97
    v_mfma_f32_16x16x32_bf16 v[20:23], v[232:235], v[104:107], 0
    v_mul_f32 v98, v98, v6
    v_mul_f32 v99, v99, v6
    v_mfma_f32_16x16x32_bf16 v[20:23], v[236:239], v[100:103], v[20:23]
    v_cvt_pk_bf16_f32 v87, v98, v99
    v_mul_f32 v36, v36, v6
    v_mfma_f32_16x16x32_bf16 v[20:23], v[240:243], v[92:95], v[20:23]
    ds_write_b128 v135, v[84:87] offset:3072
    v_mfma_f32_16x16x32_bf16 v[20:23], v[244:247], v[88:91], v[20:23]
    buffer_store_dwordx4 v[80:83], v124, s[28:31], s59 offen sc1
    v_mul_f32 v37, v37, v6
    v_cvt_pk_bf16_f32 v36, v36, v37
    v_mul_f32 v38, v38, v6
    v_mul_f32 v39, v39, v6
    v_mfma_f32_16x16x32_bf16 v[20:23], v[248:251], v[76:79], v[20:23]
    v_cvt_pk_bf16_f32 v37, v38, v39
    v_mul_f32 v72, v72, v4
    v_mfma_f32_16x16x32_bf16 v[20:23], v[252:255], v[40:43], v[20:23]
    s_waitcnt lgkmcnt(1)
    ds_write_b64 v134, v[36:37] offset:3072
    v_mfma_f32_16x16x32_bf16 v[36:39], a[216:219], v[64:67], 0
    v_mul_f32 v73, v73, v4
    v_cvt_pk_bf16_f32 v40, v72, v73
    v_mfma_f32_16x16x32_bf16 v[36:39], a[220:223], v[60:63], v[36:39]
    v_mul_f32 v74, v74, v4
    v_mul_f32 v75, v75, v4
    v_mfma_f32_16x16x32_bf16 v[36:39], a[224:227], v[56:59], v[36:39]
    v_cvt_pk_bf16_f32 v41, v74, v75
    v_mul_f32 v48, v48, v4
    v_mfma_f32_16x16x32_bf16 v[36:39], a[228:231], v[44:47], v[36:39]
    v_mul_f32 v49, v49, v4
    v_cvt_pk_bf16_f32 v42, v48, v49
    v_mfma_f32_16x16x32_bf16 v[36:39], a[232:235], v[32:35], v[36:39]
    v_mul_f32 v50, v50, v4
    v_mul_f32 v51, v51, v4
    v_mfma_f32_16x16x32_bf16 v[36:39], a[236:239], v[24:27], v[36:39]
    v_cvt_pk_bf16_f32 v43, v50, v51
    v_mul_f32 v68, v68, v4
    v_mfma_f32_16x16x32_bf16 v[48:51], a[240:243], v[64:67], 0
    ds_write_b128 v135, v[40:43] offset:0
    v_mfma_f32_16x16x32_bf16 v[48:51], a[244:247], v[60:63], v[48:51]
    v_mul_f32 v69, v69, v4
    v_cvt_pk_bf16_f32 v6, v68, v69
    v_mfma_f32_16x16x32_bf16 v[48:51], a[248:251], v[56:59], v[48:51]
    v_mul_f32 v70, v70, v4
    v_mul_f32 v71, v71, v4
    v_mfma_f32_16x16x32_bf16 v[48:51], a[252:255], v[44:47], v[48:51]
    v_cvt_pk_bf16_f32 v7, v70, v71
    v_fma_f32 v11, v16, v16, s42
    v_mfma_f32_16x16x32_bf16 v[48:51], v[224:227], v[32:35], v[48:51]
    ds_write_b64 v134, v[6:7] offset:0
    v_mfma_f32_16x16x32_bf16 v[48:51], v[228:231], v[24:27], v[48:51]
    v_fmac_f32 v11, v17, v17
    v_fmac_f32 v11, v18, v18
    v_mfma_f32_16x16x32_bf16 v[40:43], v[232:235], v[64:67], 0
    v_fmac_f32 v11, v19, v19
    v_fmac_f32 v11, v28, v28
    v_mfma_f32_16x16x32_bf16 v[40:43], v[236:239], v[60:63], v[40:43]
    v_fmac_f32 v11, v29, v29
    v_fmac_f32 v11, v30, v30
    v_mfma_f32_16x16x32_bf16 v[40:43], v[240:243], v[56:59], v[40:43]
    v_fmac_f32 v11, v31, v31
    v_fmac_f32 v11, v20, v20
    v_mfma_f32_16x16x32_bf16 v[40:43], v[244:247], v[44:47], v[40:43]
    v_fmac_f32 v11, v21, v21
    v_fmac_f32 v11, v22, v22
    v_mfma_f32_16x16x32_bf16 v[40:43], v[248:251], v[32:35], v[40:43]
    v_fmac_f32 v11, v23, v23
    v_fma_f32 v114, v36, v36, s42
    v_mfma_f32_16x16x32_bf16 v[40:43], v[252:255], v[24:27], v[40:43]
    s_nop 0
    v_fmac_f32 v114, v37, v37
    v_fmac_f32 v114, v38, v38
    v_fmac_f32 v114, v39, v39
    v_fmac_f32 v114, v48, v48
    v_fmac_f32 v114, v49, v49
    v_fmac_f32 v114, v50, v50
    v_fmac_f32 v114, v51, v51
    v_fmac_f32 v114, v40, v40
    v_fmac_f32 v114, v41, v41
    v_fmac_f32 v114, v42, v42
    v_fmac_f32 v114, v43, v43
    v_cvt_pk_bf16_f32 v114, v114, v11
    ds_write_b64 v130, v[114:115] offset:4096
    v_mul_f32 v0, v0, v5
    v_mul_f32 v1, v1, v5
    v_cvt_pk_bf16_f32 v0, v0, v1
    v_mul_f32 v2, v2, v5
    v_mul_f32 v3, v3, v5
    v_cvt_pk_bf16_f32 v1, v2, v3
    v_mul_f32 v52, v52, v5
    v_mul_f32 v53, v53, v5
    v_cvt_pk_bf16_f32 v2, v52, v53
    v_mul_f32 v54, v54, v5
    v_mul_f32 v55, v55, v5
    v_cvt_pk_bf16_f32 v3, v54, v55
    v_mul_f32 v12, v12, v5
    v_mul_f32 v13, v13, v5
    v_cvt_pk_bf16_f32 v114, v12, v13
    v_mul_f32 v14, v14, v5
    v_mul_f32 v15, v15, v5
    v_cvt_pk_bf16_f32 v115, v14, v15
    ds_write_b128 v135, v[0:3] offset:1536
    s_waitcnt lgkmcnt(1)
    s_barrier
    ds_write_b64 v134, v[114:115] offset:1536
    ds_read_b128 v[4:7], v129 offset:4096
    ds_read_b128 v[0:3], v129 offset:5120
    s_waitcnt lgkmcnt(2)
    s_barrier
    s_waitcnt lgkmcnt(1)
    v_mfma_f32_16x16x32_bf16 v[24:27], v[216:219], v[4:7], 0
    s_waitcnt lgkmcnt(0)
    ds_read_b128 v[44:47], v113 offset:0
    ds_read_b128 v[32:35], v113 offset:1024
    v_mfma_f32_16x16x32_bf16 v[24:27], v[216:219], v[0:3], v[24:27]
    s_nop 0
    ds_read_b128 v[12:15], v113 offset:2048
    s_nop 2
    ds_read_b128 v[4:7], v113 offset:3072
    s_nop 1
    v_rsq_f32 v24, v24
    ds_read_b128 v[0:3], v113 offset:4096
    v_mul_f32 v24, s43, v24
    v_mul_f32 v36, v36, v24
    v_mul_f32 v37, v37, v24
    v_cvt_pk_bf16_f32 v36, v36, v37
    v_mul_f32 v38, v38, v24
    v_mul_f32 v39, v39, v24
    v_cvt_pk_bf16_f32 v37, v38, v39
    v_mul_f32 v48, v48, v24
    v_mul_f32 v49, v49, v24
    s_waitcnt lgkmcnt(4)
    buffer_store_dwordx4 v[44:47], v128, s[28:31], s58 offen sc1
    v_cvt_pk_bf16_f32 v38, v48, v49
    v_mul_f32 v50, v50, v24
    v_mul_f32 v51, v51, v24
    v_cvt_pk_bf16_f32 v39, v50, v51
    v_mul_f32 v40, v40, v24
    v_mul_f32 v41, v41, v24
    v_cvt_pk_bf16_f32 v26, v40, v41
    v_mul_f32 v42, v42, v24
    v_mul_f32 v43, v43, v24
    v_cvt_pk_bf16_f32 v27, v42, v43
    ds_write_b128 v112, v[36:39] offset:0
    v_rsq_f32 v25, v25
    s_nop 0
    v_mul_f32 v25, s43, v25
    s_waitcnt lgkmcnt(1)
    buffer_store_dwordx4 v[32:35], v127, s[28:31], s58 offen sc1
    ds_write_b64 v132, v[26:27] offset:0
    v_mul_f32 v16, v16, v25
    v_mul_f32 v17, v17, v25
    v_cvt_pk_bf16_f32 v16, v16, v17
    v_mul_f32 v18, v18, v25
    v_mul_f32 v19, v19, v25
    v_cvt_pk_bf16_f32 v17, v18, v19
    v_mul_f32 v28, v28, v25
    v_mul_f32 v29, v29, v25
    v_cvt_pk_bf16_f32 v18, v28, v29
    v_mul_f32 v30, v30, v25
    v_mul_f32 v31, v31, v25
    v_cvt_pk_bf16_f32 v19, v30, v31
    v_mul_f32 v20, v20, v25
    v_mul_f32 v21, v21, v25
    v_cvt_pk_bf16_f32 v128, v20, v21
    v_mul_f32 v22, v22, v25
    v_mul_f32 v23, v23, v25
    v_cvt_pk_bf16_f32 v129, v22, v23
    buffer_store_dwordx4 v[12:15], v126, s[28:31], s58 offen sc1
    ds_write_b128 v112, v[16:19] offset:1536
    ds_write_b64 v132, v[128:129] offset:1536
    buffer_store_dwordx4 v[4:7], v125, s[28:31], s58 offen sc1
    s_waitcnt lgkmcnt(0)
    s_barrier
    buffer_store_dwordx4 v[0:3], v124, s[28:31], s58 offen sc1
    ds_read_b128 v[12:15], v131 offset:0
    ds_read_b128 v[4:7], v131 offset:1024
    ds_read_b128 v[0:3], v131 offset:2048
    s_waitcnt lgkmcnt(2)
    buffer_store_dwordx4 v[12:15], v8, s[28:31], 0 offen sc1
    s_waitcnt lgkmcnt(0)
    buffer_store_dwordx4 v[4:7], v9, s[28:31], 0 offen sc1
    buffer_store_dwordx4 v[0:3], v10, s[28:31], 0 offen sc1
    s_endpgm
L_bndF:
    s_movk_i32 s73, 24
    s_sub_u32 s70, s70, 20
    s_cmp_lt_u32 s2, 247
    s_cbranch_scc1 L_bndrF
    s_movk_i32 s73, 20
    s_movk_i32 s71, 18
    s_movk_i32 s70, -20
    s_mov_b32 s74, 0
    s_cmp_lt_u32 s2, 251
    s_cbranch_scc1 L_bndcF
    s_sub_u32 s94, s2, 251
    s_mul_i32 s69, s94, 18
    s_mov_b32 s74, 25239312
    s_sub_u32 s93, s93, 1373568
    v_cmp_le_u32 vcc, 4, v67
    v_add_u32 v0, 98896896, v128
    v_subrev_u32 v1, 1373568, v128
    v_cndmask_b32 v128, v0, v1, vcc
    v_cmp_le_u32 vcc, 4, v23
    v_add_u32 v0, 98896896, v127
    v_subrev_u32 v1, 1373568, v127
    v_cndmask_b32 v127, v0, v1, vcc
    v_cmp_le_u32 vcc, 4, v6
    v_add_u32 v0, 98896896, v126
    v_subrev_u32 v1, 1373568, v126
    v_cndmask_b32 v126, v0, v1, vcc
    v_cmp_le_u32 vcc, 4, v130
    v_add_u32 v0, 98896896, v125
    v_subrev_u32 v1, 1373568, v125
    v_cndmask_b32 v125, v0, v1, vcc
    v_cmp_le_u32 vcc, 4, v4
    v_add_u32 v0, 98896896, v124
    v_subrev_u32 v1, 1373568, v124
    v_cndmask_b32 v124, v0, v1, vcc
    s_cmp_lt_u32 s2, 255
    s_cbranch_scc1 L_bndrF
L_bndcF:
    s_sub_u32 s94, s2, 247
    s_mul_i32 s69, s94, 18
    s_mov_b32 s62, 1373568
    s_add_u32 s74, s74, 345744
    s_sub_u32 s93, s93, 2688
    v_mad_i32_i24 v0, v67, -7, v22
    v_cmp_le_u32 vcc, 4, v0
    v_add_u32 v0, 193536, v128
    v_subrev_u32 v1, 2688, v128
    v_cndmask_b32 v128, v0, v1, vcc
    v_mad_i32_i24 v0, v23, -7, v65
    v_cmp_le_u32 vcc, 4, v0
    v_add_u32 v0, 193536, v127
    v_subrev_u32 v1, 2688, v127
    v_cndmask_b32 v127, v0, v1, vcc
    v_mad_i32_i24 v0, v6, -7, v31
    v_cmp_le_u32 vcc, 4, v0
    v_add_u32 v0, 193536, v126
    v_subrev_u32 v1, 2688, v126
    v_cndmask_b32 v126, v0, v1, vcc
    v_mad_i32_i24 v0, v130, -7, v66
    v_cmp_le_u32 vcc, 4, v0
    v_add_u32 v0, 193536, v125
    v_subrev_u32 v1, 2688, v125
    v_cndmask_b32 v125, v0, v1, vcc
    v_mad_i32_i24 v0, v4, -7, v129
    v_cmp_le_u32 vcc, 4, v0
    v_add_u32 v0, 193536, v124
    v_subrev_u32 v1, 2688, v124
    v_cndmask_b32 v124, v0, v1, vcc
    s_cmp_eq_u32 s2, 255
    s_cselect_b32 s62, 0, s62
    s_cselect_b32 s69, 0, s69
    s_cselect_b32 s71, 2, s71
    s_branch L_bndrF
L_maskF:
    s_add_u32 s20, s20, s74
    s_addc_u32 s21, s21, 0
    s_mov_b32 s22, 4802
    s_mov_b32 s23, 0x20000
    s_mov_b32 s85, 0x3fb8aa3b
    s_waitcnt vmcnt(0)
    v_lshrrev_b32 v30, 2, v71
    v_add_u32 v30, 0, v30
    v_mul_u32_u24 v30, 98, v30
    v_mad_u32_u24 v31, v9, 24, v30
    buffer_load_ushort v138, v31, s[20:23], 0 offen offset:0
    buffer_load_ushort v85, v31, s[20:23], 0 offen offset:2
    buffer_load_ushort v144, v31, s[20:23], 0 offen offset:4
    buffer_load_ushort v43, v31, s[20:23], 0 offen offset:6
    buffer_load_ushort v142, v31, s[20:23], 0 offen offset:8
    buffer_load_ushort v154, v31, s[20:23], 0 offen offset:10
    buffer_load_ushort v120, v31, s[20:23], 0 offen offset:12
    buffer_load_ushort v42, v31, s[20:23], 0 offen offset:14
    buffer_load_ushort v98, v31, s[20:23], 0 offen offset:16
    buffer_load_ushort v121, v31, s[20:23], 0 offen offset:18
    buffer_load_ushort v143, v31, s[20:23], 0 offen offset:20
    buffer_load_ushort v145, v31, s[20:23], 0 offen offset:22
    buffer_load_ushort v69, v30, s[20:23], 0 offen offset:96
    s_waitcnt vmcnt(0)
    v_lshlrev_b32 v138, 16, v138
    v_fmac_f32 v204, s85, v138
    v_lshlrev_b32 v85, 16, v85
    v_fmac_f32 v205, s85, v85
    v_lshlrev_b32 v144, 16, v144
    v_fmac_f32 v206, s85, v144
    v_lshlrev_b32 v43, 16, v43
    v_fmac_f32 v207, s85, v43
    v_lshlrev_b32 v142, 16, v142
    v_fmac_f32 v200, s85, v142
    v_lshlrev_b32 v154, 16, v154
    v_fmac_f32 v201, s85, v154
    v_lshlrev_b32 v120, 16, v120
    v_fmac_f32 v202, s85, v120
    v_lshlrev_b32 v42, 16, v42
    v_fmac_f32 v203, s85, v42
    v_lshlrev_b32 v98, 16, v98
    v_fmac_f32 v196, s85, v98
    v_lshlrev_b32 v121, 16, v121
    v_fmac_f32 v197, s85, v121
    v_lshlrev_b32 v143, 16, v143
    v_fmac_f32 v198, s85, v143
    v_lshlrev_b32 v145, 16, v145
    v_fmac_f32 v199, s85, v145
    v_lshlrev_b32 v69, 16, v69
    v_fmac_f32 v208, s85, v69
    v_lshrrev_b32 v30, 2, v71
    v_add_u32 v30, 4, v30
    v_mul_u32_u24 v30, 98, v30
    v_mad_u32_u24 v31, v9, 24, v30
    buffer_load_ushort v138, v31, s[20:23], 0 offen offset:0
    buffer_load_ushort v85, v31, s[20:23], 0 offen offset:2
    buffer_load_ushort v144, v31, s[20:23], 0 offen offset:4
    buffer_load_ushort v43, v31, s[20:23], 0 offen offset:6
    buffer_load_ushort v142, v31, s[20:23], 0 offen offset:8
    buffer_load_ushort v154, v31, s[20:23], 0 offen offset:10
    buffer_load_ushort v120, v31, s[20:23], 0 offen offset:12
    buffer_load_ushort v42, v31, s[20:23], 0 offen offset:14
    buffer_load_ushort v98, v31, s[20:23], 0 offen offset:16
    buffer_load_ushort v121, v31, s[20:23], 0 offen offset:18
    buffer_load_ushort v143, v31, s[20:23], 0 offen offset:20
    buffer_load_ushort v145, v31, s[20:23], 0 offen offset:22
    buffer_load_ushort v69, v30, s[20:23], 0 offen offset:96
    s_waitcnt vmcnt(0)
    v_lshlrev_b32 v138, 16, v138
    v_fmac_f32 v192, s85, v138
    v_lshlrev_b32 v85, 16, v85
    v_fmac_f32 v193, s85, v85
    v_lshlrev_b32 v144, 16, v144
    v_fmac_f32 v194, s85, v144
    v_lshlrev_b32 v43, 16, v43
    v_fmac_f32 v195, s85, v43
    v_lshlrev_b32 v142, 16, v142
    v_fmac_f32 v188, s85, v142
    v_lshlrev_b32 v154, 16, v154
    v_fmac_f32 v189, s85, v154
    v_lshlrev_b32 v120, 16, v120
    v_fmac_f32 v190, s85, v120
    v_lshlrev_b32 v42, 16, v42
    v_fmac_f32 v191, s85, v42
    v_lshlrev_b32 v98, 16, v98
    v_fmac_f32 v184, s85, v98
    v_lshlrev_b32 v121, 16, v121
    v_fmac_f32 v185, s85, v121
    v_lshlrev_b32 v143, 16, v143
    v_fmac_f32 v186, s85, v143
    v_lshlrev_b32 v145, 16, v145
    v_fmac_f32 v187, s85, v145
    v_lshlrev_b32 v69, 16, v69
    v_fmac_f32 v209, s85, v69
    v_lshrrev_b32 v30, 2, v71
    v_add_u32 v30, 8, v30
    v_mul_u32_u24 v30, 98, v30
    v_mad_u32_u24 v31, v9, 24, v30
    buffer_load_ushort v138, v31, s[20:23], 0 offen offset:0
    buffer_load_ushort v85, v31, s[20:23], 0 offen offset:2
    buffer_load_ushort v144, v31, s[20:23], 0 offen offset:4
    buffer_load_ushort v43, v31, s[20:23], 0 offen offset:6
    buffer_load_ushort v142, v31, s[20:23], 0 offen offset:8
    buffer_load_ushort v154, v31, s[20:23], 0 offen offset:10
    buffer_load_ushort v120, v31, s[20:23], 0 offen offset:12
    buffer_load_ushort v42, v31, s[20:23], 0 offen offset:14
    buffer_load_ushort v98, v31, s[20:23], 0 offen offset:16
    buffer_load_ushort v121, v31, s[20:23], 0 offen offset:18
    buffer_load_ushort v143, v31, s[20:23], 0 offen offset:20
    buffer_load_ushort v145, v31, s[20:23], 0 offen offset:22
    buffer_load_ushort v69, v30, s[20:23], 0 offen offset:96
    s_waitcnt vmcnt(0)
    v_lshlrev_b32 v138, 16, v138
    v_fmac_f32 v180, s85, v138
    v_lshlrev_b32 v85, 16, v85
    v_fmac_f32 v181, s85, v85
    v_lshlrev_b32 v144, 16, v144
    v_fmac_f32 v182, s85, v144
    v_lshlrev_b32 v43, 16, v43
    v_fmac_f32 v183, s85, v43
    v_lshlrev_b32 v142, 16, v142
    v_fmac_f32 v176, s85, v142
    v_lshlrev_b32 v154, 16, v154
    v_fmac_f32 v177, s85, v154
    v_lshlrev_b32 v120, 16, v120
    v_fmac_f32 v178, s85, v120
    v_lshlrev_b32 v42, 16, v42
    v_fmac_f32 v179, s85, v42
    v_lshlrev_b32 v98, 16, v98
    v_fmac_f32 v172, s85, v98
    v_lshlrev_b32 v121, 16, v121
    v_fmac_f32 v173, s85, v121
    v_lshlrev_b32 v143, 16, v143
    v_fmac_f32 v174, s85, v143
    v_lshlrev_b32 v145, 16, v145
    v_fmac_f32 v175, s85, v145
    v_lshlrev_b32 v69, 16, v69
    v_fmac_f32 v210, s85, v69
    v_lshrrev_b32 v30, 2, v71
    v_lshl_add_u32 v30, v9, 2, v30
    v_cmp_gt_u32 vcc, 3, v9
    v_mov_b32 v31, 48
    s_nop 1
    v_cndmask_b32 v30, v31, v30, vcc
    v_add_u32 v30, 2352, v30
    v_lshlrev_b32 v30, 1, v30
    buffer_load_ushort v138, v30, s[20:23], 0 offen
    s_waitcnt vmcnt(0)
    v_lshlrev_b32 v138, 16, v138
    v_fmac_f32 v211, s85, v138
    s_branch L_nomaskF
L_atomF0:
    v_mov_b32 v122, 0x800000
    buffer_atomic_add v122, v129, s[8:11], 0 offen sc0 sc1
    s_branch L_atomrF0
L_bndS:
    s_movk_i32 s73, 24
    s_sub_u32 s70, s70, 20
    s_cmp_lt_u32 s2, 247
    s_cbranch_scc1 L_bndrS
    s_movk_i32 s73, 20
    s_movk_i32 s71, 18
    s_movk_i32 s70, -20
    s_mov_b32 s74, 0
    s_cmp_lt_u32 s2, 251
    s_cbranch_scc1 L_bndcS
    s_sub_u32 s94, s2, 251
    s_mul_i32 s69, s94, 18
    s_mov_b32 s74, 25239312
    s_sub_u32 s93, s93, 1373568
    v_cmp_le_u32 vcc, 4, v11
    v_add_u32 v26, 98896896, v128
    v_subrev_u32 v27, 1373568, v128
    v_cndmask_b32 v128, v26, v27, vcc
    v_cmp_le_u32 vcc, 4, v6
    v_add_u32 v26, 98896896, v127
    v_subrev_u32 v27, 1373568, v127
    v_cndmask_b32 v127, v26, v27, vcc
    v_cmp_le_u32 vcc, 4, v18
    v_add_u32 v26, 98896896, v126
    v_subrev_u32 v27, 1373568, v126
    v_cndmask_b32 v126, v26, v27, vcc
    v_cmp_le_u32 vcc, 4, v4
    v_add_u32 v26, 98896896, v125
    v_subrev_u32 v27, 1373568, v125
    v_cndmask_b32 v125, v26, v27, vcc
    v_cmp_le_u32 vcc, 4, v7
    v_add_u32 v26, 98896896, v124
    v_subrev_u32 v27, 1373568, v124
    v_cndmask_b32 v124, v26, v27, vcc
    s_cmp_lt_u32 s2, 255
    s_cbranch_scc1 L_bndrS
L_bndcS:
    s_sub_u32 s94, s2, 247
    s_mul_i32 s69, s94, 18
    s_mov_b32 s62, 1373568
    s_add_u32 s74, s74, 345744
    s_sub_u32 s93, s93, 2688
    v_mad_i32_i24 v26, v11, -7, v129
    v_cmp_le_u32 vcc, 4, v26
    v_add_u32 v26, 193536, v128
    v_subrev_u32 v27, 2688, v128
    v_cndmask_b32 v128, v26, v27, vcc
    v_mad_i32_i24 v26, v6, -7, v31
    v_cmp_le_u32 vcc, 4, v26
    v_add_u32 v26, 193536, v127
    v_subrev_u32 v27, 2688, v127
    v_cndmask_b32 v127, v26, v27, vcc
    v_mad_i32_i24 v26, v18, -7, v163
    v_cmp_le_u32 vcc, 4, v26
    v_add_u32 v26, 193536, v126
    v_subrev_u32 v27, 2688, v126
    v_cndmask_b32 v126, v26, v27, vcc
    v_mad_i32_i24 v26, v4, -7, v25
    v_cmp_le_u32 vcc, 4, v26
    v_add_u32 v26, 193536, v125
    v_subrev_u32 v27, 2688, v125
    v_cndmask_b32 v125, v26, v27, vcc
    v_mad_i32_i24 v26, v7, -7, v156
    v_cmp_le_u32 vcc, 4, v26
    v_add_u32 v26, 193536, v124
    v_subrev_u32 v27, 2688, v124
    v_cndmask_b32 v124, v26, v27, vcc
    s_cmp_eq_u32 s2, 255
    s_cselect_b32 s62, 0, s62
    s_cselect_b32 s69, 0, s69
    s_cselect_b32 s71, 2, s71
    s_branch L_bndrS
L_maskS:
    s_add_u32 s20, s20, s74
    s_addc_u32 s21, s21, 0
    s_mov_b32 s22, 4802
    s_mov_b32 s23, 0x20000
    s_mov_b32 s85, 0x3fb8aa3b
    s_waitcnt vmcnt(0)
    v_lshrrev_b32 v160, 2, v76
    v_add_u32 v160, 0, v160
    v_mul_u32_u24 v160, 98, v160
    v_mad_u32_u24 v161, v5, 24, v160
    buffer_load_ushort v79, v161, s[20:23], 0 offen offset:0
    buffer_load_ushort v3, v161, s[20:23], 0 offen offset:2
    buffer_load_ushort v2, v161, s[20:23], 0 offen offset:4
    buffer_load_ushort v1, v161, s[20:23], 0 offen offset:6
    buffer_load_ushort v4, v161, s[20:23], 0 offen offset:8
    buffer_load_ushort v166, v161, s[20:23], 0 offen offset:10
    buffer_load_ushort v164, v161, s[20:23], 0 offen offset:12
    buffer_load_ushort v162, v161, s[20:23], 0 offen offset:14
    buffer_load_ushort v165, v161, s[20:23], 0 offen offset:16
    buffer_load_ushort v0, v161, s[20:23], 0 offen offset:18
    buffer_load_ushort v158, v161, s[20:23], 0 offen offset:20
    buffer_load_ushort v77, v161, s[20:23], 0 offen offset:22
    buffer_load_ushort v157, v160, s[20:23], 0 offen offset:96
    s_waitcnt vmcnt(0)
    v_lshlrev_b32 v79, 16, v79
    v_fmac_f32 v204, s85, v79
    v_lshlrev_b32 v3, 16, v3
    v_fmac_f32 v205, s85, v3
    v_lshlrev_b32 v2, 16, v2
    v_fmac_f32 v206, s85, v2
    v_lshlrev_b32 v1, 16, v1
    v_fmac_f32 v207, s85, v1
    v_lshlrev_b32 v4, 16, v4
    v_fmac_f32 v200, s85, v4
    v_lshlrev_b32 v166, 16, v166
    v_fmac_f32 v201, s85, v166
    v_lshlrev_b32 v164, 16, v164
    v_fmac_f32 v202, s85, v164
    v_lshlrev_b32 v162, 16, v162
    v_fmac_f32 v203, s85, v162
    v_lshlrev_b32 v165, 16, v165
    v_fmac_f32 v196, s85, v165
    v_lshlrev_b32 v0, 16, v0
    v_fmac_f32 v197, s85, v0
    v_lshlrev_b32 v158, 16, v158
    v_fmac_f32 v198, s85, v158
    v_lshlrev_b32 v77, 16, v77
    v_fmac_f32 v199, s85, v77
    v_lshlrev_b32 v157, 16, v157
    v_fmac_f32 v208, s85, v157
    v_lshrrev_b32 v160, 2, v76
    v_add_u32 v160, 4, v160
    v_mul_u32_u24 v160, 98, v160
    v_mad_u32_u24 v161, v5, 24, v160
    buffer_load_ushort v79, v161, s[20:23], 0 offen offset:0
    buffer_load_ushort v3, v161, s[20:23], 0 offen offset:2
    buffer_load_ushort v2, v161, s[20:23], 0 offen offset:4
    buffer_load_ushort v1, v161, s[20:23], 0 offen offset:6
    buffer_load_ushort v4, v161, s[20:23], 0 offen offset:8
    buffer_load_ushort v166, v161, s[20:23], 0 offen offset:10
    buffer_load_ushort v164, v161, s[20:23], 0 offen offset:12
    buffer_load_ushort v162, v161, s[20:23], 0 offen offset:14
    buffer_load_ushort v165, v161, s[20:23], 0 offen offset:16
    buffer_load_ushort v0, v161, s[20:23], 0 offen offset:18
    buffer_load_ushort v158, v161, s[20:23], 0 offen offset:20
    buffer_load_ushort v77, v161, s[20:23], 0 offen offset:22
    buffer_load_ushort v157, v160, s[20:23], 0 offen offset:96
    s_waitcnt vmcnt(0)
    v_lshlrev_b32 v79, 16, v79
    v_fmac_f32 v192, s85, v79
    v_lshlrev_b32 v3, 16, v3
    v_fmac_f32 v193, s85, v3
    v_lshlrev_b32 v2, 16, v2
    v_fmac_f32 v194, s85, v2
    v_lshlrev_b32 v1, 16, v1
    v_fmac_f32 v195, s85, v1
    v_lshlrev_b32 v4, 16, v4
    v_fmac_f32 v188, s85, v4
    v_lshlrev_b32 v166, 16, v166
    v_fmac_f32 v189, s85, v166
    v_lshlrev_b32 v164, 16, v164
    v_fmac_f32 v190, s85, v164
    v_lshlrev_b32 v162, 16, v162
    v_fmac_f32 v191, s85, v162
    v_lshlrev_b32 v165, 16, v165
    v_fmac_f32 v184, s85, v165
    v_lshlrev_b32 v0, 16, v0
    v_fmac_f32 v185, s85, v0
    v_lshlrev_b32 v158, 16, v158
    v_fmac_f32 v186, s85, v158
    v_lshlrev_b32 v77, 16, v77
    v_fmac_f32 v187, s85, v77
    v_lshlrev_b32 v157, 16, v157
    v_fmac_f32 v209, s85, v157
    v_lshrrev_b32 v160, 2, v76
    v_add_u32 v160, 8, v160
    v_mul_u32_u24 v160, 98, v160
    v_mad_u32_u24 v161, v5, 24, v160
    buffer_load_ushort v79, v161, s[20:23], 0 offen offset:0
    buffer_load_ushort v3, v161, s[20:23], 0 offen offset:2
    buffer_load_ushort v2, v161, s[20:23], 0 offen offset:4
    buffer_load_ushort v1, v161, s[20:23], 0 offen offset:6
    buffer_load_ushort v4, v161, s[20:23], 0 offen offset:8
    buffer_load_ushort v166, v161, s[20:23], 0 offen offset:10
    buffer_load_ushort v164, v161, s[20:23], 0 offen offset:12
    buffer_load_ushort v162, v161, s[20:23], 0 offen offset:14
    buffer_load_ushort v165, v161, s[20:23], 0 offen offset:16
    buffer_load_ushort v0, v161, s[20:23], 0 offen offset:18
    buffer_load_ushort v158, v161, s[20:23], 0 offen offset:20
    buffer_load_ushort v77, v161, s[20:23], 0 offen offset:22
    buffer_load_ushort v157, v160, s[20:23], 0 offen offset:96
    s_waitcnt vmcnt(0)
    v_lshlrev_b32 v79, 16, v79
    v_fmac_f32 v180, s85, v79
    v_lshlrev_b32 v3, 16, v3
    v_fmac_f32 v181, s85, v3
    v_lshlrev_b32 v2, 16, v2
    v_fmac_f32 v182, s85, v2
    v_lshlrev_b32 v1, 16, v1
    v_fmac_f32 v183, s85, v1
    v_lshlrev_b32 v4, 16, v4
    v_fmac_f32 v176, s85, v4
    v_lshlrev_b32 v166, 16, v166
    v_fmac_f32 v177, s85, v166
    v_lshlrev_b32 v164, 16, v164
    v_fmac_f32 v178, s85, v164
    v_lshlrev_b32 v162, 16, v162
    v_fmac_f32 v179, s85, v162
    v_lshlrev_b32 v165, 16, v165
    v_fmac_f32 v172, s85, v165
    v_lshlrev_b32 v0, 16, v0
    v_fmac_f32 v173, s85, v0
    v_lshlrev_b32 v158, 16, v158
    v_fmac_f32 v174, s85, v158
    v_lshlrev_b32 v77, 16, v77
    v_fmac_f32 v175, s85, v77
    v_lshlrev_b32 v157, 16, v157
    v_fmac_f32 v210, s85, v157
    v_lshrrev_b32 v160, 2, v76
    v_lshl_add_u32 v160, v5, 2, v160
    v_cmp_gt_u32 vcc, 3, v5
    v_mov_b32 v161, 48
    s_nop 1
    v_cndmask_b32 v160, v161, v160, vcc
    v_add_u32 v160, 2352, v160
    v_lshlrev_b32 v160, 1, v160
    buffer_load_ushort v79, v160, s[20:23], 0 offen
    s_waitcnt vmcnt(0)
    v_lshlrev_b32 v79, 16, v79
    v_fmac_f32 v211, s85, v79
    s_branch L_nomaskS
L_atomS0:
    v_mov_b32 v122, 0x800000
    buffer_atomic_add v122, v129, s[8:11], 0 offen sc0 sc1
    s_branch L_atomrS0
.section .rodata,"a"
.p2align 6
.amdhsa_kernel standalone__window_attn_swin_v2__vision_kernel
  .amdhsa_next_free_vgpr 512
  .amdhsa_next_free_sgpr 102
  .amdhsa_accum_offset 256
  .amdhsa_group_segment_fixed_size 0
  .amdhsa_kernarg_size 96
  .amdhsa_user_sgpr_count 2
  .amdhsa_user_sgpr_kernarg_segment_ptr 1
  .amdhsa_system_sgpr_workgroup_id_x 1
.end_amdhsa_kernel
```

```asm
; @launch grid=(256,1,1) block=(256,1,1) lds=163840
.amdgcn_target "amdgcn-amd-amdhsa--gfx950"
.text
.globl standalone__window_attn_swin_v2__vision_kernel
.p2align 8
.type standalone__window_attn_swin_v2__vision_kernel,@function
standalone__window_attn_swin_v2__vision_kernel:
    v_lshrrev_b32 v0, 6, v0
    s_cmp_ge_u32 s2, 256
    s_cbranch_scc1 L_end
    v_readfirstlane_b32 s68, v0
    s_mov_b32 s64, 0
    s_nop 0
    v_mbcnt_lo_u32_b32 v2, -1, 0
    v_mbcnt_hi_u32_b32 v2, -1, v2
    s_load_dwordx16 s[4:19], s[0:1], 0
    s_load_dwordx4 s[20:23], s[0:1], 64
    s_load_dwordx2 s[38:39], s[0:1], 80
    s_lshr_b32 s88, s2, 3
    s_lshl2_add_u32 s88, s88, s68
    v_lshlrev_b32 v0, 7, v2
    s_getpc_b64 s[80:81]
    s_lshl_b32 s84, s88, 8
    v_and_b32 v1, 128, v0
    v_add_u32 v1, s84, v1
    v_min_u32 v1, L_slow-standalone__window_attn_swin_v2__vision_kernel-256, v1
    s_mul_i32 s89, s88, 576
    s_mul_i32 s88, s88, 1728
    global_load_dword a255, v1, s[80:81]
    v_min_u32 v8, 1664, v0
    v_min_u32 v4, 512, v0
    s_mov_b32 s34, 221184
    s_mov_b32 s35, 0x20000
    s_mov_b32 s78, 73728
    s_mov_b32 s79, 0x20000
    v_and_b32 v19, 15, v2
    v_lshrrev_b32 v9, 4, v2
    v_lshrrev_b32 v11, 2, v19
    v_and_b32 v10, 3, v19
    s_mul_i32 s87, s68, 192
    v_mad_u32_u24 v7, v19, 12, s87
    v_lshlrev_b32 v39, 1, v19
    v_lshlrev_b32 v6, 1, v11
    v_lshl_add_u32 v6, v9, 5, v6
    s_movk_i32 s86, 384
    s_mov_b32 s26, 100270464
    s_mov_b32 s27, 0x20000
    s_mov_b32 s30, 0
    s_mov_b32 s31, 0x20000
    s_waitcnt lgkmcnt(0)
    s_mov_b32 s24, s4
    s_mov_b32 s25, s5
    s_mov_b32 s32, s6
    s_mov_b32 s33, s7
    s_mov_b32 s76, s8
    s_mov_b32 s77, s9
    buffer_load_dword a254, v8, s[32:35], s88 offen
    buffer_load_dword a253, v4, s[76:79], s89 offen
    s_load_dwordx2 s[82:83], s[10:11], 0
    s_movk_i32 s18, 676
    s_mov_b32 s19, 0x20000
    buffer_load_dwordx3 v[36:38], v7, s[16:19], 0 offen
    s_mul_i32 s96, s68, 288
    s_and_b32 s97, s68, 1
    s_lshl_b32 s97, s97, 2
    s_mov_b32 s98, 193536
    s_mov_b32 s99, 589824
    global_load_ushort v24, v39, s[12:13]
    v_add_u32 v8, s96, v2
    v_mul_u32_u24 v64, 2731, v8
    v_mul_u32_u24 v89, 6242, v8
    v_lshrrev_b32 v64, 16, v64
    v_lshrrev_b32 v89, 20, v89
    s_lshr_b32 s94, s2, 3
    s_mul_i32 s70, s94, 168
    global_load_ushort v25, v39, s[12:13] offset:32
    v_and_or_b32 v5, v64, 3, s97
    v_xor_b32 v5, v8, v5
    v_lshl_add_u32 v128, v5, 4, s99
    v_mad_u32_u24 v128, v89, s98, v128
    v_add_u32 v17, 64, v8
    s_mul_i32 s69, s2, 20
    s_lshl3_add_u32 s69, s94, s69
    global_load_ushort v90, v6, s[14:15] offset:0
    v_mul_u32_u24 v16, 2731, v17
    v_mul_u32_u24 v4, 6242, v17
    v_lshrrev_b32 v16, 16, v16
    v_lshrrev_b32 v4, 20, v4
    v_and_or_b32 v65, v16, 3, s97
    s_add_u32 s70, s70, 140
    s_movk_i32 s62, 2688
    global_load_ushort v39, v6, s[14:15] offset:8
    v_xor_b32 v65, v17, v65
    v_lshl_add_u32 v127, v65, 4, s99
    v_mad_u32_u24 v127, v4, s98, v127
    v_add_u32 v18, 128, v8
    v_mul_u32_u24 v26, 2731, v18
    s_movk_i32 s71, 20
    s_movk_i32 s73, 28
    global_load_ushort v91, v6, s[14:15] offset:16
    v_mul_u32_u24 v27, 6242, v18
    v_lshrrev_b32 v26, 16, v26
    v_lshrrev_b32 v27, 20, v27
    v_and_or_b32 v17, v26, 3, s97
    v_xor_b32 v17, v18, v17
    s_mov_b32 s93, 1769472
    s_mul_i32 s54, s68, 5120
    global_load_ushort v6, v6, s[14:15] offset:24
    v_lshl_add_u32 v126, v17, 4, s99
    v_mad_u32_u24 v126, v27, s98, v126
    v_add_u32 v1, 192, v8
    v_mul_u32_u24 v88, 2731, v1
    v_mul_u32_u24 v0, 6242, v1
    v_lshrrev_b32 v88, 16, v88
    v_lshrrev_b32 v0, 20, v0
    v_and_or_b32 v18, v88, 3, s97
    v_xor_b32 v18, v1, v18
    v_lshl_add_u32 v125, v18, 4, s99
    v_mad_u32_u24 v125, v0, s98, v125
    v_add_u32 v1, 256, v8
    v_mul_u32_u24 v8, 2731, v1
    v_mul_u32_u24 v18, 6242, v1
    v_lshrrev_b32 v8, 16, v8
    v_lshrrev_b32 v18, 20, v18
    v_and_or_b32 v124, v8, 3, s97
    v_xor_b32 v124, v1, v124
    v_lshl_add_u32 v124, v124, 4, s99
    v_mad_u32_u24 v124, v18, s98, v124
    s_cmp_ge_u32 s2, 240
    s_cbranch_scc1 L_bndF
L_bndrF:
    s_mov_b32 s63, 1180032
    s_mul_i32 s94, s69, 58255
    s_lshr_b32 s94, s94, 22
    s_mul_i32 s94, s94, s63
    s_mul_i32 s72, s69, s62
    s_add_u32 s72, s72, s94
    v_lshl_or_b32 v18, v2, 4, 2.0
    s_sub_u32 s94, s73, 1
    s_max_u32 s94, s94, 20
    s_mul_i32 s95, s68, -44
    s_movk_i32 s99, -24
    s_add_u32 m0, s54, 0
    v_and_b32 v8, -4, v26
    s_mul_i32 s85, s68, 96
    s_sub_u32 s100, s85, 1024
    buffer_load_dwordx4 v128, s[24:27], s72 offen nt lds
    s_add_u32 m0, s54, 1024
    v_mad_u32_u24 v4, v8, 3, v26
    v_add_u32 v4, s95, v4
    v_mad_i32_i24 v66, v26, s99, v17
    v_med3_u32 v8, v4, 20, s94
    v_add_u32 v8, s70, v8
    v_add_u32 v17, s69, v4
    s_sub_u32 s87, s85, 2048
    s_movk_i32 s91, 1152
    buffer_load_dwordx4 v127, s[24:27], s72 offen nt lds
    v_cmp_gt_u32 vcc, s71, v4
    v_lshl_add_u32 v66, v66, 4, s93
    s_add_u32 m0, s54, 43008
    v_cndmask_b32 v17, v8, v17, vcc
    v_mul_u32_u24 v8, 58255, v17
    v_mad_u32_u24 v66, v17, s62, v66
    v_lshrrev_b32 v8, 22, v8
    v_mad_u32_u24 v66, v8, s63, v66
    s_mul_i32 s90, s68, 3072
    s_add_u32 s90, s90, 61440
    buffer_load_dwordx4 v66, s[24:27], 0 offen  lds
    v_lshlrev_b32 v67, 16, v4
    s_add_u32 m0, s54, 2048
    v_and_b32 v8, -4, v16
    v_mad_u32_u24 v4, v8, 3, v16
    v_add_u32 v4, s95, v4
    v_mad_i32_i24 v65, v16, s99, v65
    v_med3_u32 v8, v4, 20, s94
    s_add_u32 s101, s54, 44032
    s_mov_b32 s28, s22
    buffer_load_dwordx4 v126, s[24:27], s72 offen nt lds
    v_add_u32 v8, s70, v8
    v_add_u32 v16, s69, v4
    v_cmp_gt_u32 vcc, s71, v4
    v_lshl_add_u32 v65, v65, 4, s93
    s_add_u32 m0, s54, 41984
    v_cndmask_b32 v16, v8, v16, vcc
    v_mul_u32_u24 v8, 58255, v16
    v_mad_u32_u24 v65, v16, s62, v65
    v_lshrrev_b32 v8, 22, v8
    v_mad_u32_u24 v65, v8, s63, v65
    s_mov_b32 s29, s23
    s_mov_b32 s41, 0x2a8cbccc
    buffer_load_dwordx4 v65, s[24:27], 0 offen  lds
    v_lshl_or_b32 v67, v4, 8, v67
    s_add_u32 m0, s54, 3072
    v_cmp_gt_u32 vcc, 32, v2
    v_and_b32 v4, -4, v64
    v_mad_u32_u24 v8, v4, 3, v64
    v_cndmask_b32 v124, v18, v124, vcc
    v_add_u32 v8, s95, v8
    s_mov_b32 s42, 0x38fba882
    s_mov_b32 s43, 0x415db3d7
    buffer_load_dwordx4 v125, s[24:27], s72 offen nt lds
    s_add_u32 m0, s54, 4096
    v_mad_i32_i24 v64, v64, s99, v5
    v_med3_u32 v4, v8, 20, s94
    v_add_u32 v4, s70, v4
    v_add_u32 v5, s69, v8
    v_cmp_gt_u32 vcc, s71, v8
    v_lshl_add_u32 v64, v64, 4, s93
    s_mul_i32 s93, s68, 6
    s_lshl_b32 s94, s97, 1
    buffer_load_dwordx4 v124, s[24:27], s72 offen nt lds
    v_cndmask_b32 v5, v4, v5, vcc
    v_mul_u32_u24 v4, 58255, v5
    v_mad_u32_u24 v64, v5, s62, v64
    v_lshrrev_b32 v4, 22, v4
    v_mad_u32_u24 v64, v4, s63, v64
    s_add_u32 m0, s54, 40960
    v_lshl_or_b32 v67, v8, 0, v67
    s_mov_b32 s44, 61440
    s_mov_b32 s45, 40960
    buffer_load_dwordx4 v64, s[24:27], 0 offen nt lds
    v_mul_u32_u24 v4, 10923, v2
    v_lshrrev_b32 v83, 17, v4
    v_lshrrev_b32 v4, 16, v4
    v_mad_i32_i24 v27, v4, -6, v2
    v_bitop3_b32 v83, v83, v4, 4 bitop3:0x28
    v_lshl_add_u32 v27, v27, 4, s85
    v_mul_u32_u24 v83, 3, v83
    v_xor_b32 v4, v4, v83
    v_mad_u32_u24 v83, v4, s91, v27
    v_add_u32 v5, 64, v2
    v_mul_u32_u24 v26, 10923, v5
    v_lshrrev_b32 v97, 17, v26
    v_lshrrev_b32 v26, 16, v26
    v_mad_i32_i24 v5, v26, -6, v5
    v_bitop3_b32 v97, v97, v26, 4 bitop3:0x28
    v_lshl_add_u32 v5, v5, 4, s100
    v_mul_u32_u24 v97, 3, v97
    v_xor_b32 v26, v26, v97
    v_mad_u32_u24 v97, v26, s91, v5
    v_add_u32 v17, 128, v2
    v_mul_u32_u24 v16, 10923, v17
    v_lshrrev_b32 v8, 17, v16
    v_lshrrev_b32 v16, 16, v16
    v_mad_i32_i24 v17, v16, -6, v17
    v_bitop3_b32 v8, v8, v16, 4 bitop3:0x28
    v_lshl_add_u32 v17, v17, 4, s87
    v_mul_u32_u24 v8, 3, v8
    v_xor_b32 v16, v16, v8
    v_mad_u32_u24 v8, v16, s91, v17
    v_mad_u32_u24 v4, v4, s86, v27
    v_mad_u32_u24 v166, v26, s86, v5
    v_mad_u32_u24 v28, v16, s86, v17
    s_add_u32 m0, s90, 0
    s_mov_b32 s92, 0
    buffer_load_dwordx4 v83, s[32:35], s92 offen offset:0 lds
    v_lshrrev_b32 v16, 1, v9
    v_lshl_add_u32 v5, v9, 2, v11
    v_lshl_add_u32 v5, v16, 3, v5
    v_mul_u32_u24 v5, 96, v5
    v_add_u32 v5, s90, v5
    v_lshl_add_u32 v139, v10, 4, v5
    v_lshl_add_u32 v17, v10, 3, v5
    v_mov_b32 v5, 0x3f803f80
    v_cmp_eq_u32 vcc, 0, v10
    v_and_b32 v16, 1, v2
    v_lshlrev_b32 v16, 4, v16
    v_cndmask_b32 v220, 0, v5, vcc
    v_cndmask_b32 v221, 0, v5, vcc
    v_cndmask_b32 v222, 0, v5, vcc
    v_cndmask_b32 v223, 0, v5, vcc
    v_mov_b32 v5, 0x3f80
    v_lshlrev_b32 v219, v16, v5
    v_cmp_gt_u32 vcc, 2, v10
    v_mov_b32 v16, 0x44004400
    v_mul_u32_u24 v51, 48, v11
    v_cndmask_b32 v216, 0, v219, vcc
    v_cndmask_b32 v218, 0, v219, vcc
    v_cmp_le_u32 vcc, 2, v10
    v_lshl_add_u32 v51, v10, 2, v51
    v_mul_u32_u24 v5, 48, v9
    v_cndmask_b32 v217, 0, v219, vcc
    v_cndmask_b32 v219, 0, v219, vcc
    v_cmp_eq_u32 vcc, v9, v11
    v_add_u32 v96, 0, v51
    v_mul_u32_u24 v26, 37, v96
    v_cndmask_b32 v98, 0, v216, vcc
    v_cndmask_b32 v99, 0, v217, vcc
    v_cmp_eq_u32 vcc, 0, v10
    v_lshrrev_b32 v26, 10, v26
    v_mad_u32_u24 v96, v26, 24, v96
    v_cndmask_b32 v212, 0, v16, vcc
    v_cmp_eq_u32 vcc, 1, v10
    v_add_u32 v96, s101, v96
    v_add_u32 v187, 16, v51
    v_cndmask_b32 v213, 0, v16, vcc
    v_cmp_eq_u32 vcc, 2, v10
    v_mul_u32_u24 v215, 37, v187
    v_lshrrev_b32 v215, 10, v215
    v_cndmask_b32 v214, 0, v16, vcc
    v_cmp_eq_u32 vcc, 3, v10
    v_mad_u32_u24 v187, v215, 24, v187
    v_add_u32 v187, s101, v187
    v_cndmask_b32 v215, 0, v16, vcc
    v_add_u32 v175, 32, v51
    v_mul_u32_u24 v16, 37, v175
    v_lshrrev_b32 v16, 10, v16
    v_mad_u32_u24 v175, v16, 24, v175
    v_add_u32 v175, s101, v175
    v_add_u32 v16, 0, v5
    v_mul_u32_u24 v26, 37, v16
    v_lshrrev_b32 v26, 10, v26
    v_mad_u32_u24 v16, v26, 24, v16
    v_add_u32 v1, 4, v5
    v_mul_u32_u24 v0, 37, v1
    v_lshrrev_b32 v0, 10, v0
    v_mad_u32_u24 v1, v0, 24, v1
    v_add_u32 v3, 8, v5
    v_mul_u32_u24 v0, 37, v3
    v_lshrrev_b32 v0, 10, v0
    v_mad_u32_u24 v3, v0, 24, v3
    v_add_u32 v207, 12, v5
    v_mul_u32_u24 v0, 37, v207
    v_lshrrev_b32 v0, 10, v0
    v_mad_u32_u24 v207, v0, 24, v207
    v_add_u32 v0, 16, v5
    v_mul_u32_u24 v26, 37, v0
    v_lshrrev_b32 v26, 10, v26
    v_mad_u32_u24 v0, v26, 24, v0
    v_add_u32 v88, 20, v5
    v_mul_u32_u24 v89, 37, v88
    v_lshrrev_b32 v89, 10, v89
    v_mad_u32_u24 v88, v89, 24, v88
    v_add_u32 v89, 24, v5
    v_mul_u32_u24 v26, 37, v89
    v_lshrrev_b32 v26, 10, v26
    v_mad_u32_u24 v89, v26, 24, v89
    v_add_u32 v203, 28, v5
    v_mul_u32_u24 v26, 37, v203
    v_lshrrev_b32 v26, 10, v26
    v_mad_u32_u24 v203, v26, 24, v203
    v_add_u32 v31, 32, v5
    v_mul_u32_u24 v26, 37, v31
    v_lshrrev_b32 v26, 10, v26
    v_mad_u32_u24 v31, v26, 24, v31
    s_waitcnt lgkmcnt(0)
    s_sext_i32_i16 s84, s82
    s_ashr_i32 s85, s82, 16
    s_max_i32 s84, s84, s85
    s_sext_i32_i16 s85, s83
    s_max_i32 s84, s84, s85
    s_ashr_i32 s85, s83, 16
    s_max_i32 s84, s84, s85
    s_cmp_gt_i32 s84, 16492
    s_cbranch_scc1 L_slow
    s_lshl_b32 s84, s68, 4
    buffer_load_dwordx4 v97, s[32:35], s92 offen offset:1024 lds
    v_add_u32 v30, 36, v5
    v_mul_u32_u24 v29, 37, v30
    v_lshrrev_b32 v29, 10, v29
    v_mad_u32_u24 v30, v29, 24, v30
    v_add_u32 v138, 40, v5
    v_mul_u32_u24 v29, 37, v138
    v_lshrrev_b32 v29, 10, v29
    s_lshr_b64 s[82:83], s[82:83], s84
    s_lshl_b32 s82, s82, 16
    buffer_load_dwordx4 v8, s[32:35], s92 offen offset:2048 lds
    s_add_u32 m0, s90, 12288
    s_mov_b32 s92, 36864
    v_mad_u32_u24 v138, v29, 24, v138
    v_add_u32 v5, 44, v5
    v_mul_u32_u24 v29, 37, v5
    v_lshrrev_b32 v29, 10, v29
    v_mad_u32_u24 v5, v29, 24, v5
    s_mov_b32 s84, 0x41b8aa3b
    s_mov_b32 s46, 20480
    buffer_load_dwordx4 v83, s[32:35], s92 offen offset:0 lds
    v_lshl_add_u32 v120, v9, 4, v51
    v_mul_u32_u24 v29, 37, v120
    v_lshrrev_b32 v29, 10, v29
    v_mad_u32_u24 v120, v29, 24, v120
    v_mov_b32 v26, 336
    v_cmp_gt_u32 vcc, 3, v9
    v_mov_b32 v29, s82
    v_min_f32 v29, 0x40930000, v29
    v_cndmask_b32 v120, v26, v120, vcc
    v_sub_u32 v120, s101, v120
    v_max_f32 v29, 0xc2c80000, v29
    v_mul_f32 v29, 0x3fb8aa3b, v29
    v_exp_f32 v29, v29
    s_waitcnt vmcnt(16)
    v_lshl_or_b32 v24, v25, 16, v24
    s_mov_b32 s47, 0
    s_mov_b32 s57, s72
    buffer_load_dwordx4 v97, s[32:35], s92 offen offset:1024 lds
    v_cvt_pk_bf16_f32 v29, v29, v29
    v_lshlrev_b32 v29, 16, v29
    v_mul_f32 v29, 0x4038aa3b, v29
    s_waitcnt vmcnt(15)
    v_lshl_or_b32 v90, v39, 16, v90
    v_readfirstlane_b32 s55, v29
    v_add_f32 v29, v29, v29
    s_waitcnt vmcnt(13)
    v_lshl_or_b32 v91, v6, 16, v91
    v_readfirstlane_b32 s52, v29
    v_cmp_gt_u32 vcc, 16, v2
    v_mov_b32 v25, 0
    v_mov_b32 v26, 0
    v_cndmask_b32 v27, 0, v24, vcc
    v_cndmask_b32 v24, 0, v24, vcc
    v_mov_b32 v39, 0
    v_mfma_f32_16x16x16_bf16 v[12:15], v[26:27], v[36:37], 0
    s_mov_b32 s58, 0
    v_mul_u32_u24 v6, 5120, v9
    v_add_u32 v6, v7, v6
    v_mfma_f32_16x16x16_bf16 v[20:23], v[24:25], v[36:37], 0
    s_mov_b32 s59, 0
    v_mov_b32 v7, 0xc138aa3b
    v_and_b32 v29, 8, v19
    v_mfma_f32_16x16x16_bf16 v[32:35], v[24:25], v[38:39], 0
    s_mov_b32 s60, 0
    v_max_f32 v12, 0, v12
    v_max_f32 v13, 0, v13
    v_max_f32 v14, 0, v14
    v_max_f32 v20, 0, v20
    v_max_f32 v21, 0, v21
    v_max_f32 v22, 0, v22
    v_max_f32 v23, 0, v23
    v_cvt_pk_bf16_f32 v20, v20, v21
    v_cvt_pk_bf16_f32 v21, v22, v23
    v_max_f32 v15, 0, v15
    v_cvt_pk_bf16_f32 v12, v12, v13
    v_mfma_f32_16x16x16_bf16 v[24:27], v[90:91], v[20:21], 0
    s_mov_b32 s65, -1
    v_cvt_pk_bf16_f32 v13, v14, v15
    v_max_f32 v32, 0, v32
    v_max_f32 v33, 0, v33
    v_mfma_f32_16x16x16_bf16 v[20:23], v[90:91], v[12:13], 0
    s_mov_b32 s61, 1
    v_max_f32 v34, 0, v34
    v_max_f32 v35, 0, v35
    v_cvt_pk_bf16_f32 v32, v32, v33
    v_cvt_pk_bf16_f32 v33, v34, v35
    v_cvt_pk_bf16_f32 v24, v24, v24
    v_lshlrev_b32 v24, 16, v24
    v_mfma_f32_16x16x16_bf16 v[12:15], v[90:91], v[32:33], 0
    s_movk_i32 s4, 112
    v_mul_f32 v24, 0xbfb8aa3b, v24
    v_cvt_pk_bf16_f32 v20, v20, v20
    v_exp_f32 v24, v24
    v_lshlrev_b32 v20, 16, v20
    v_add_f32 v24, 1.0, v24
    v_rcp_f32 v24, v24
    v_mul_f32 v20, 0xbfb8aa3b, v20
    v_cvt_pk_bf16_f32 v24, v24, v24
    v_lshlrev_b32 v24, 16, v24
    v_fma_f32 v24, v24, s84, v7
    s_mov_b32 s5, 0
    s_mov_b32 s6, 0
    ds_write_b32 v6, v24 offset:44032
    v_exp_f32 v20, v20
    v_cvt_pk_bf16_f32 v12, v12, v12
    v_add_f32 v20, 1.0, v20
    v_rcp_f32 v20, v20
    v_lshlrev_b32 v12, 16, v12
    v_cvt_pk_bf16_f32 v20, v20, v20
    v_lshlrev_b32 v20, 16, v20
    v_fma_f32 v20, v20, s84, v7
    s_mov_b32 s12, 0
    s_mov_b32 s64, 3
    ds_write_b32 v6, v20 offset:44036
    v_mul_f32 v12, 0xbfb8aa3b, v12
    v_exp_f32 v12, v12
    v_add_u32 v29, v29, v19
    v_add_f32 v12, 1.0, v12
    v_rcp_f32 v12, v12
    v_mul_u32_u24 v29, 96, v29
    v_cvt_pk_bf16_f32 v12, v12, v12
    v_lshlrev_b32 v12, 16, v12
    v_fma_f32 v12, v12, s84, v7
    s_mov_b32 s10, 81924
    s_mov_b32 s11, 0x20000
    ds_write_b32 v6, v12 offset:44040
    v_add_u32 v29, s90, v29
    v_lshl_add_u32 v91, v9, 4, v29
    v_lshl_add_u32 v90, v9, 3, v29
    v_lshlrev_b32 v121, 4, v9
    v_add_u32 v121, 4608, v121
    v_mul_u32_u24 v131, 5120, v11
    v_mad_u32_u24 v131, v10, s86, v131
    v_and_b32 v29, 7, v19
    v_xor_b32 v122, v29, v9
    v_lshl_add_u32 v7, v122, 4, v131
    v_xor_b32 v6, 64, v7
    v_add_u32 v137, 40960, v7
    v_xor_b32 v136, 64, v137
    v_add_u32 v131, 61440, v131
    v_add_u32 v122, s93, v9
    v_xor_b32 v122, v29, v122
    v_lshl_add_u32 v135, v122, 4, v131
    v_lshrrev_b32 v122, 1, v9
    v_add3_u32 v122, v122, s93, 4
    v_xor_b32 v122, v29, v122
    v_lshl_add_u32 v122, v122, 4, v131
    v_and_b32 v131, 1, v9
    v_lshl_add_u32 v134, v131, 3, v122
    v_lshlrev_b32 v29, 4, v2
    s_add_u32 s93, s54, 20480
    v_add_u32 v133, s93, v29
    v_add_u32 v129, 81920, v29
    s_lshr_b32 s93, s68, 1
    s_lshl_b32 s93, s93, 10
    s_add_u32 s93, s93, s94
    v_add_u32 v130, s93, v129
    s_mul_i32 s93, s68, 7168
    s_add_u32 s93, s93, 135168
    s_waitcnt lgkmcnt(0)
    s_barrier
    ds_read_b32 v209, v187
    v_mul_u32_u24 v131, 1792, v9
    v_add_u32 v122, s93, v131
    v_mul_u32_u24 v131, 112, v19
    v_add_u32 v29, v131, v122
    v_subrev_u32 v29, 28672, v29
    v_cmp_eq_u32 vcc, 0, v11
    v_add_u32 v131, 16, v122
    v_mov_b32 v123, 0
    v_cndmask_b32 v132, v18, v122, vcc
    v_cmp_eq_u32 vcc, 3, v10
    v_mov_b32 v122, 0
    s_mov_b32 s30, 100270464
    buffer_load_dwordx4 v8, s[32:35], s92 offen offset:2048 lds
    s_add_u32 m0, s90, 24576
    s_mov_b32 s92, 73728
    ds_read_b32 v210, v175
    v_cndmask_b32 v132, v132, v131, vcc
    v_mul_u32_u24 v131, 1792, v11
    v_lshl_add_u32 v131, v9, 3, v131
    v_lshl_add_u32 v131, v10, 1, v131
    v_add_u32 v131, s93, v131
    v_cmp_gt_u32 vcc, 3, v9
    s_add_u32 s93, s69, 1
    s_mul_i32 s94, s93, 58255
    ds_read_b32 v208, v96
    v_cndmask_b32 v131, v18, v131, vcc
    s_lshr_b32 s94, s94, 22
    s_mul_i32 s94, s94, s63
    s_mul_i32 s56, s93, s62
    s_add_u32 s56, s56, s94
    s_and_b32 s94, s68, 1
    s_mul_i32 s94, s94, -2304
    s_sub_u32 s93, s71, 1
    s_cmp_eq_u32 s68, 0
    buffer_load_dwordx4 v83, s[32:35], s92 offen offset:0 lds
    s_cselect_b32 s13, s93, -1
    s_cmp_gt_u32 s73, 20
    s_cselect_b32 s13, s13, -1
    s_and_b32 s93, s2, -8
    s_sub_u32 s93, 81920, s93
    s_sub_u32 s8, s38, s93
    s_subb_u32 s9, s39, 0
    s_lshr_b32 s93, s68, 1
    s_mul_i32 s93, s93, 30720
    s_add_u32 s93, s93, s94
    ds_read_b32 v211, v120 offset:672
    buffer_load_dwordx4 v97, s[32:35], s92 offen offset:1024 lds
    v_add_u32 v11, s93, v91
    v_add_u32 v10, s93, v90
    s_lshr_b32 s93, s68, 1
    s_mul_i32 s93, s93, 5120
    s_lshl_b32 s94, s97, 4
    s_add_u32 s93, s93, s94
    v_add_u32 v120, s93, v121
    v_cmp_eq_u32 vcc, 0, v19
    s_mov_b32 s39, 0x00010001
    v_sub_u32 v192, v187, v16
    v_cndmask_b32 v120, v18, v120, vcc
    ds_read_b32 v192, v192 offset:336
    v_sub_u32 v193, v187, v1
    v_sub_u32 v194, v187, v3
    v_sub_u32 v195, v187, v207
    v_sub_u32 v188, v187, v0
    v_sub_u32 v189, v187, v88
    ds_read_b32 v193, v193 offset:336
    v_sub_u32 v190, v187, v89
    buffer_load_dwordx4 v8, s[32:35], s92 offen offset:2048 lds
    s_add_u32 m0, s90, 36864
    s_mov_b32 s92, 110592
    ds_read_b32 v194, v194 offset:336
    v_sub_u32 v191, v187, v203
    v_sub_u32 v184, v187, v31
    v_sub_u32 v185, v187, v30
    v_sub_u32 v186, v187, v138
    v_sub_u32 v187, v187, v5
    s_waitcnt vmcnt(9)
    s_barrier
    ds_read_b32 v195, v195 offset:336
    v_sub_u32 v180, v175, v16
    v_sub_u32 v181, v175, v1
    v_sub_u32 v182, v175, v3
    v_sub_u32 v183, v175, v207
    v_sub_u32 v176, v175, v0
    ds_read_b32 v188, v188 offset:336
    v_sub_u32 v177, v175, v88
    v_sub_u32 v178, v175, v89
    v_sub_u32 v179, v175, v203
    v_sub_u32 v172, v175, v31
    v_sub_u32 v173, v175, v30
    ds_read_b32 v189, v189 offset:336
    v_sub_u32 v174, v175, v138
    v_sub_u32 v175, v175, v5
    buffer_load_dwordx4 v83, s[32:35], s92 offen offset:0 lds
    ds_read_b32 v190, v190 offset:336
    v_sub_u32 v204, v96, v16
    v_sub_u32 v205, v96, v1
    v_sub_u32 v206, v96, v3
    v_sub_u32 v207, v96, v207
    v_sub_u32 v200, v96, v0
    ds_read_b32 v191, v191 offset:336
    v_sub_u32 v201, v96, v88
    v_sub_u32 v202, v96, v89
    v_sub_u32 v203, v96, v203
    v_sub_u32 v196, v96, v31
    v_sub_u32 v197, v96, v30
    ds_read_b32 v184, v184 offset:336
    buffer_load_dwordx4 v97, s[32:35], s92 offen offset:1024 lds
    v_sub_u32 v198, v96, v138
    v_sub_u32 v199, v96, v5
    ds_read_b32 v185, v185 offset:336
    ds_read_b32 v186, v186 offset:336
    ds_read_b32 v187, v187 offset:336
    buffer_load_dwordx4 v8, s[32:35], s92 offen offset:2048 lds
    s_add_u32 m0, s90, 49152
    s_mov_b32 s92, 147456
    s_waitcnt vmcnt(9)
    ds_read_b64_tr_b16 a[0:1], v17 offset:0
    ds_read_b64_tr_b16 a[2:3], v17 offset:768
    ds_read_b64_tr_b16 a[24:25], v17 offset:32
    ds_read_b64_tr_b16 a[26:27], v17 offset:800
    ds_read_b64_tr_b16 a[48:49], v17 offset:64
    ds_read_b64_tr_b16 a[50:51], v17 offset:832
    ds_read_b128 v[36:39], v7 offset:40960
    ds_read_b128 v[32:35], v7 offset:42496
    buffer_load_dwordx4 v83, s[32:35], s92 offen offset:0 lds
    ds_read_b128 v[24:27], v7 offset:0
    ds_read_b128 v[12:15], v7 offset:1536
    ds_read_b128 v[76:79], v7 offset:3072
    ds_read_b32 v180, v180 offset:336
    buffer_load_dwordx4 v97, s[32:35], s92 offen offset:1024 lds
    ds_read_b32 v181, v181 offset:336
    ds_read_b32 v182, v182 offset:336
    s_waitcnt lgkmcnt(7)
    v_mfma_f32_16x16x32_bf16 v[20:23], a[0:3], v[36:39], 0
    ds_read_b128 v[168:171], v7 offset:41088
    v_mfma_f32_16x16x32_bf16 v[84:87], a[24:27], v[36:39], 0
    ds_read_b128 v[108:111], v7 offset:42624
    v_mfma_f32_16x16x32_bf16 v[72:75], a[48:51], v[36:39], 0
    s_waitcnt vmcnt(8) lgkmcnt(6)
    buffer_load_dwordx4 v8, s[32:35], s92 offen offset:2048 lds
    ds_read_b64_tr_b16 a[4:5], v17 offset:12288
    v_mfma_f32_16x16x32_bf16 v[56:59], a[0:3], v[32:35], 0
    s_add_u32 m0, s90, 61440
    ds_read_b64_tr_b16 a[6:7], v17 offset:13056
    v_mfma_f32_16x16x32_bf16 v[104:107], a[24:27], v[32:35], 0
    s_mov_b32 s92, 184320
    ds_read_b64_tr_b16 a[28:29], v17 offset:12320
    v_mfma_f32_16x16x32_bf16 v[40:43], a[48:51], v[32:35], 0
    ds_read_b64_tr_b16 a[30:31], v17 offset:13088
    v_mfma_f32_16x16x32_bf16 v[30:33], a[0:3], v[24:27], 0
    ds_read_b64_tr_b16 a[52:53], v17 offset:12352
    v_mfma_f32_16x16x32_bf16 v[148:151], a[24:27], v[24:27], 0
    buffer_load_dwordx4 v83, s[32:35], s92 offen offset:0 lds
    ds_read_b64_tr_b16 a[54:55], v17 offset:13120
    v_mfma_f32_16x16x32_bf16 v[100:103], a[48:51], v[24:27], 0
    ds_read_b128 v[144:147], v7 offset:128
    v_mfma_f32_16x16x32_bf16 v[24:27], a[0:3], v[12:15], 0
    ds_read_b128 v[52:55], v7 offset:1664
    v_mfma_f32_16x16x32_bf16 v[44:47], a[24:27], v[12:15], 0
    ds_read_b128 v[68:71], v7 offset:3200
    v_mfma_f32_16x16x32_bf16 v[112:115], a[48:51], v[12:15], 0
    s_waitcnt lgkmcnt(8)
    ds_read_b128 v[116:119], v6 offset:41088
    v_mfma_f32_16x16x32_bf16 v[12:15], a[0:3], v[76:79], 0
    buffer_load_dwordx4 v97, s[32:35], s92 offen offset:1024 lds
    ds_read_b128 v[60:63], v6 offset:42624
    v_mfma_f32_16x16x32_bf16 v[140:143], a[24:27], v[76:79], 0
    ds_read_b128 v[36:39], v6 offset:128
    v_mfma_f32_16x16x32_bf16 v[92:95], a[48:51], v[76:79], 0
    ds_read_b128 v[76:79], v6 offset:1664
    ds_read_b128 v[152:155], v6 offset:3200
    ds_read_b128 v[224:227], v6 offset:40960
    buffer_load_dwordx4 v8, s[32:35], s92 offen offset:2048 lds
    s_add_u32 m0, s90, 0
    s_mov_b32 s92, 384
    s_waitcnt vmcnt(9)
    ds_read_b64_tr_b16 a[8:9], v17 offset:24576
    ds_read_b64_tr_b16 a[10:11], v17 offset:25344
    ds_read_b64_tr_b16 a[32:33], v17 offset:24608
    ds_read_b64_tr_b16 a[34:35], v17 offset:25376
    ds_read_b64_tr_b16 a[56:57], v17 offset:24640
    ds_read_b64_tr_b16 a[58:59], v17 offset:25408
    ds_read_b128 v[160:163], v6 offset:42496
    ds_read_b32 v183, v183 offset:336
    buffer_load_dwordx4 v83, s[32:35], s92 offen offset:0 lds
    ds_read_b32 v176, v176 offset:336
    ds_read_b32 v177, v177 offset:336
    s_waitcnt lgkmcnt(10)
    v_mfma_f32_16x16x32_bf16 v[20:23], a[4:7], v[224:227], v[20:23]
    v_mfma_f32_16x16x32_bf16 v[84:87], a[28:31], v[224:227], v[84:87]
    s_waitcnt lgkmcnt(8)
    ds_read_b32 v178, v178 offset:336
    v_mfma_f32_16x16x32_bf16 v[20:23], a[8:11], v[168:171], v[20:23]
    s_waitcnt lgkmcnt(7)
    buffer_load_dwordx4 v97, s[32:35], s92 offen offset:1024 lds
    v_mfma_f32_16x16x32_bf16 v[84:87], a[32:35], v[168:171], v[84:87]
    ds_read_b128 v[156:159], v6 offset:0
    v_mfma_f32_16x16x32_bf16 v[72:75], a[52:55], v[224:227], v[72:75]
    s_waitcnt lgkmcnt(5)
    ds_read_b32 v179, v179 offset:336
    v_mfma_f32_16x16x32_bf16 v[72:75], a[56:59], v[168:171], v[72:75]
    v_mfma_f32_16x16x32_bf16 v[56:59], a[4:7], v[160:163], v[56:59]
    ds_read_b32 v172, v172 offset:336
    v_mfma_f32_16x16x32_bf16 v[56:59], a[8:11], v[108:111], v[56:59]
    buffer_load_dwordx4 v8, s[32:35], s92 offen offset:2048 lds
    v_mfma_f32_16x16x32_bf16 v[104:107], a[28:31], v[160:163], v[104:107]
    s_waitcnt vmcnt(9)
    s_add_u32 m0, s90, 12288
    ds_read_b64_tr_b16 a[12:13], v17 offset:36864
    v_mfma_f32_16x16x32_bf16 v[104:107], a[32:35], v[108:111], v[104:107]
    s_mov_b32 s92, 37248
    ds_read_b64_tr_b16 a[14:15], v17 offset:37632
    v_mfma_f32_16x16x32_bf16 v[40:43], a[52:55], v[160:163], v[40:43]
    ds_read_b64_tr_b16 a[36:37], v17 offset:36896
    v_mfma_f32_16x16x32_bf16 v[40:43], a[56:59], v[108:111], v[40:43]
    s_waitcnt lgkmcnt(5)
    ds_read_b64_tr_b16 a[38:39], v17 offset:37664
    buffer_load_dwordx4 v83, s[32:35], s92 offen offset:0 lds
    v_mfma_f32_16x16x32_bf16 v[30:33], a[4:7], v[156:159], v[30:33]
    ds_read_b64_tr_b16 a[60:61], v17 offset:36928
    v_mfma_f32_16x16x32_bf16 v[30:33], a[8:11], v[144:147], v[30:33]
    ds_read_b64_tr_b16 a[62:63], v17 offset:37696
    v_mfma_f32_16x16x32_bf16 v[148:151], a[28:31], v[156:159], v[148:151]
    ds_read_b128 v[108:111], v6 offset:1536
    v_mfma_f32_16x16x32_bf16 v[148:151], a[32:35], v[144:147], v[148:151]
    ds_read_b32 v173, v173 offset:336
    v_mfma_f32_16x16x32_bf16 v[100:103], a[52:55], v[156:159], v[100:103]
    buffer_load_dwordx4 v97, s[32:35], s92 offen offset:1024 lds
    v_mfma_f32_16x16x32_bf16 v[100:103], a[56:59], v[144:147], v[100:103]
    s_waitcnt lgkmcnt(6)
    ds_read_b32 v174, v174 offset:336
    v_mfma_f32_16x16x32_bf16 v[20:23], a[12:15], v[116:119], v[20:23]
    v_mfma_f32_16x16x32_bf16 v[56:59], a[12:15], v[60:63], v[56:59]
    s_waitcnt lgkmcnt(5)
    ds_read_b32 v175, v175 offset:336
    v_mfma_f32_16x16x32_bf16 v[84:87], a[36:39], v[116:119], v[84:87]
    v_mfma_f32_16x16x32_bf16 v[104:107], a[36:39], v[60:63], v[104:107]
    ds_read_b128 v[156:159], v6 offset:3072
    buffer_load_dwordx4 v8, s[32:35], s92 offen offset:2048 lds
    v_mfma_f32_16x16x32_bf16 v[30:33], a[12:15], v[36:39], v[30:33]
    s_waitcnt vmcnt(9) lgkmcnt(5)
    s_add_u32 m0, s90, 24576
    ds_read_b64_tr_b16 a[16:17], v17 offset:49152
    v_mfma_f32_16x16x32_bf16 v[72:75], a[60:63], v[116:119], v[72:75]
    s_mov_b32 s92, 74112
    ds_read_b64_tr_b16 a[18:19], v17 offset:49920
    v_mfma_f32_16x16x32_bf16 v[40:43], a[60:63], v[60:63], v[40:43]
    ds_read_b64_tr_b16 a[40:41], v17 offset:49184
    v_mfma_f32_16x16x32_bf16 v[148:151], a[36:39], v[36:39], v[148:151]
    ds_read_b64_tr_b16 a[42:43], v17 offset:49952
    v_mfma_f32_16x16x32_bf16 v[100:103], a[60:63], v[36:39], v[100:103]
    s_waitcnt lgkmcnt(6)
    ds_read_b64_tr_b16 a[64:65], v17 offset:49216
    buffer_load_dwordx4 v83, s[32:35], s92 offen offset:0 lds
    v_mfma_f32_16x16x32_bf16 v[24:27], a[4:7], v[108:111], v[24:27]
    ds_read_b64_tr_b16 a[66:67], v17 offset:49984
    v_mfma_f32_16x16x32_bf16 v[24:27], a[8:11], v[52:55], v[24:27]
    ds_read_b32 v204, v204 offset:336
    v_mfma_f32_16x16x32_bf16 v[24:27], a[12:15], v[76:79], v[24:27]
    v_mfma_f32_16x16x32_bf16 v[44:47], a[28:31], v[108:111], v[44:47]
    ds_read_b128 v[116:119], v6 offset:41216
    v_mfma_f32_16x16x32_bf16 v[44:47], a[32:35], v[52:55], v[44:47]
    ds_read_b128 v[60:63], v6 offset:42752
    buffer_load_dwordx4 v97, s[32:35], s92 offen offset:1024 lds
    v_mfma_f32_16x16x32_bf16 v[44:47], a[36:39], v[76:79], v[44:47]
    ds_read_b128 v[36:39], v6 offset:256
    v_mfma_f32_16x16x32_bf16 v[112:115], a[52:55], v[108:111], v[112:115]
    ds_read_b128 v[108:111], v6 offset:1792
    v_mfma_f32_16x16x32_bf16 v[112:115], a[56:59], v[52:55], v[112:115]
    ds_read_b128 v[52:55], v6 offset:3328
    v_mfma_f32_16x16x32_bf16 v[112:115], a[60:63], v[76:79], v[112:115]
    s_waitcnt lgkmcnt(7)
    ds_read_b128 v[144:147], v7 offset:41216
    v_mfma_f32_16x16x32_bf16 v[12:15], a[4:7], v[156:159], v[12:15]
    ds_read_b128 v[76:79], v7 offset:42752
    buffer_load_dwordx4 v8, s[32:35], s92 offen offset:2048 lds
    v_mfma_f32_16x16x32_bf16 v[12:15], a[8:11], v[68:71], v[12:15]
    s_waitcnt vmcnt(9)
    s_add_u32 m0, s90, 36864
    ds_read_b64_tr_b16 a[20:21], v17 offset:61440
    v_mfma_f32_16x16x32_bf16 v[12:15], a[12:15], v[152:155], v[12:15]
    s_mov_b32 s92, 110976
    ds_read_b64_tr_b16 a[22:23], v17 offset:62208
    v_mfma_f32_16x16x32_bf16 v[140:143], a[28:31], v[156:159], v[140:143]
    ds_read_b64_tr_b16 a[44:45], v17 offset:61472
    v_mfma_f32_16x16x32_bf16 v[140:143], a[32:35], v[68:71], v[140:143]
    ds_read_b64_tr_b16 a[46:47], v17 offset:62240
    v_mfma_f32_16x16x32_bf16 v[140:143], a[36:39], v[152:155], v[140:143]
    ds_read_b64_tr_b16 a[68:69], v17 offset:61504
    buffer_load_dwordx4 v83, s[32:35], s92 offen offset:0 lds
    v_mfma_f32_16x16x32_bf16 v[92:95], a[52:55], v[156:159], v[92:95]
    ds_read_b64_tr_b16 a[70:71], v17 offset:62272
    v_mfma_f32_16x16x32_bf16 v[92:95], a[56:59], v[68:71], v[92:95]
    ds_read_b128 v[68:71], v7 offset:256
    v_mfma_f32_16x16x32_bf16 v[92:95], a[60:63], v[152:155], v[92:95]
    s_waitcnt lgkmcnt(8)
    ds_read_b32 v205, v205 offset:336
    v_mfma_f32_16x16x32_bf16 v[20:23], a[16:19], v[144:147], v[20:23]
    v_mfma_f32_16x16x32_bf16 v[84:87], a[40:43], v[144:147], v[84:87]
    ds_read_b32 v206, v206 offset:336
    buffer_load_dwordx4 v97, s[32:35], s92 offen offset:1024 lds
    v_mfma_f32_16x16x32_bf16 v[72:75], a[64:67], v[144:147], v[72:75]
    s_waitcnt lgkmcnt(7)
    v_mfma_f32_16x16x32_bf16 v[20:23], a[20:23], v[116:119], v[20:23]
    ds_read_b128 v[144:147], v7 offset:1792
    v_mfma_f32_16x16x32_bf16 v[56:59], a[16:19], v[76:79], v[56:59]
    s_waitcnt lgkmcnt(6)
    s_nop 0
    ds_read_b32 v207, v207 offset:336
    s_nop 0
    v_mfma_f32_16x16x32_bf16 v[84:87], a[44:47], v[116:119], v[84:87]
    s_nop 0
    v_cvt_pk_f16_f32 v20, v20, v21
    v_cvt_pk_f16_f32 v21, v22, v23
    v_mfma_f32_16x16x32_bf16 v[56:59], a[20:23], v[60:63], v[56:59]
    s_waitcnt lgkmcnt(5)
    ds_read_b32 v200, v200 offset:336
    buffer_load_dwordx4 v8, s[32:35], s92 offen offset:2048 lds
    v_mfma_f32_16x16x32_bf16 v[72:75], a[68:71], v[116:119], v[72:75]
    s_add_u32 m0, s90, 49152
    v_pk_fma_f16 v80, v20, v20, s39
    v_pk_fmac_f16 v80, v21, v21
    v_mfma_f32_16x16x32_bf16 v[104:107], a[40:43], v[76:79], v[104:107]
    s_waitcnt vmcnt(9)
    s_mov_b32 s92, 147840
    ds_read_b64_tr_b16 a[72:73], v17 offset:0
    v_cvt_pk_f16_f32 v22, v84, v85
    v_mfma_f32_16x16x32_bf16 v[104:107], a[44:47], v[60:63], v[104:107]
    ds_read_b64_tr_b16 a[74:75], v17 offset:768
    v_cvt_pk_f16_f32 v23, v86, v87
    v_mfma_f32_16x16x32_bf16 v[40:43], a[64:67], v[76:79], v[40:43]
    ds_read_b64_tr_b16 a[96:97], v17 offset:32
    v_pk_fmac_f16 v80, v22, v22
    v_mfma_f32_16x16x32_bf16 v[40:43], a[68:71], v[60:63], v[40:43]
    s_waitcnt lgkmcnt(6)
    ds_read_b64_tr_b16 a[98:99], v17 offset:800
    buffer_load_dwordx4 v83, s[32:35], s92 offen offset:0 lds
    v_mfma_f32_16x16x32_bf16 v[30:33], a[16:19], v[68:71], v[30:33]
    ds_read_b64_tr_b16 a[120:121], v17 offset:64
    v_pk_fmac_f16 v80, v23, v23
    v_mfma_f32_16x16x32_bf16 v[30:33], a[20:23], v[36:39], v[30:33]
    ds_read_b64_tr_b16 a[122:123], v17 offset:832
    v_cvt_pk_f16_f32 v88, v72, v73
    v_mfma_f32_16x16x32_bf16 v[148:151], a[40:43], v[68:71], v[148:151]
    ds_read_b128 v[60:63], v7 offset:3328
    v_cvt_pk_f16_f32 v89, v74, v75
    v_mfma_f32_16x16x32_bf16 v[148:151], a[44:47], v[36:39], v[148:151]
    ds_read_b128 v[116:119], v6 offset:40960
    v_pk_fmac_f16 v80, v88, v88
    v_mfma_f32_16x16x32_bf16 v[100:103], a[64:67], v[68:71], v[100:103]
    ds_read_b128 v[76:79], v6 offset:42496
    buffer_load_dwordx4 v97, s[32:35], s92 offen offset:1024 lds
    v_mfma_f32_16x16x32_bf16 v[100:103], a[68:71], v[36:39], v[100:103]
    s_waitcnt lgkmcnt(8)
    ds_read_b128 v[68:71], v6 offset:0
    v_pk_fmac_f16 v80, v89, v89
    v_mfma_f32_16x16x32_bf16 v[24:27], a[16:19], v[144:147], v[24:27]
    ds_read_b128 v[36:39], v6 offset:1536
    v_cvt_pk_f16_f32 v56, v56, v57
    v_mfma_f32_16x16x32_bf16 v[24:27], a[20:23], v[108:111], v[24:27]
    ds_read_b128 v[228:231], v6 offset:3072
    v_cvt_pk_f16_f32 v57, v58, v59
    v_mfma_f32_16x16x32_bf16 v[44:47], a[40:43], v[144:147], v[44:47]
    ds_read_b128 v[72:75], v7 offset:40960
    v_pk_fma_f16 v82, v56, v56, s39
    v_mfma_f32_16x16x32_bf16 v[44:47], a[44:47], v[108:111], v[44:47]
    ds_read_b128 v[84:87], v7 offset:42496
    buffer_load_dwordx4 v8, s[32:35], s92 offen offset:2048 lds
    v_mfma_f32_16x16x32_bf16 v[112:115], a[64:67], v[144:147], v[112:115]
    s_waitcnt vmcnt(9)
    s_add_u32 m0, s90, 61440
    ds_read_b64_tr_b16 a[76:77], v17 offset:12288
    v_pk_fmac_f16 v82, v57, v57
    v_mfma_f32_16x16x32_bf16 v[112:115], a[68:71], v[108:111], v[112:115]
    s_waitcnt lgkmcnt(8)
    s_mov_b32 s92, 184704
    ds_read_b64_tr_b16 a[78:79], v17 offset:13056
    v_cvt_pk_f16_f32 v58, v104, v105
    v_mfma_f32_16x16x32_bf16 v[12:15], a[16:19], v[60:63], v[12:15]
    ds_read_b64_tr_b16 a[100:101], v17 offset:12320
    v_cvt_pk_f16_f32 v59, v106, v107
    v_mfma_f32_16x16x32_bf16 v[12:15], a[20:23], v[52:55], v[12:15]
    ds_read_b64_tr_b16 a[102:103], v17 offset:13088
    v_pk_fmac_f16 v82, v58, v58
    v_mfma_f32_16x16x32_bf16 v[140:143], a[40:43], v[60:63], v[140:143]
    ds_read_b64_tr_b16 a[124:125], v17 offset:12352
    buffer_load_dwordx4 v83, s[32:35], s92 offen offset:0 lds
    v_mfma_f32_16x16x32_bf16 v[140:143], a[44:47], v[52:55], v[140:143]
    ds_read_b64_tr_b16 a[126:127], v17 offset:13120
    v_pk_fmac_f16 v82, v59, v59
    v_mfma_f32_16x16x32_bf16 v[92:95], a[64:67], v[60:63], v[92:95]
    ds_read_b128 v[144:147], v7 offset:0
    v_cvt_pk_f16_f32 v40, v40, v41
    v_mfma_f32_16x16x32_bf16 v[92:95], a[68:71], v[52:55], v[92:95]
    s_waitcnt lgkmcnt(8)
    ds_read_b32 v201, v201 offset:336
    v_cvt_pk_f16_f32 v41, v42, v43
    v_mfma_f32_16x16x32_bf16 v[60:63], a[72:75], v[72:75], 0
    v_pk_fmac_f16 v82, v40, v40
    v_pk_fmac_f16 v82, v41, v41
    v_mfma_f32_16x16x32_bf16 v[224:227], a[96:99], v[72:75], 0
    ds_read_b32 v202, v202 offset:336
    buffer_load_dwordx4 v97, s[32:35], s92 offen offset:1024 lds
    v_mfma_f32_16x16x32_bf16 v[52:55], a[120:123], v[72:75], 0
    s_waitcnt lgkmcnt(7)
    v_cvt_pk_f16_f32 v104, v30, v31
    v_cvt_pk_f16_f32 v105, v32, v33
    v_mfma_f32_16x16x32_bf16 v[60:63], a[76:79], v[116:119], v[60:63]
    ds_read_b128 v[108:111], v7 offset:1536
    v_pk_fma_f16 v48, v104, v104, s39
    v_mfma_f32_16x16x32_bf16 v[72:75], a[72:75], v[84:87], 0
    s_waitcnt lgkmcnt(6)
    ds_read_b32 v203, v203 offset:336
    v_pk_fmac_f16 v48, v105, v105
    v_mfma_f32_16x16x32_bf16 v[224:227], a[100:103], v[116:119], v[224:227]
    v_cvt_pk_f16_f32 v106, v148, v149
    v_cvt_pk_f16_f32 v107, v150, v151
    v_mfma_f32_16x16x32_bf16 v[72:75], a[76:79], v[76:79], v[72:75]
    s_waitcnt lgkmcnt(5)
    ds_read_b32 v196, v196 offset:336
    buffer_load_dwordx4 v8, s[32:35], s92 offen offset:2048 lds
    v_mfma_f32_16x16x32_bf16 v[52:55], a[124:127], v[116:119], v[52:55]
    s_add_u32 m0, s90, 0
    v_pk_fmac_f16 v48, v106, v106
    v_pk_fmac_f16 v48, v107, v107
    v_mfma_f32_16x16x32_bf16 v[168:171], a[96:99], v[84:87], 0
    s_waitcnt vmcnt(9)
    s_mov_b32 s92, 768
    ds_read_b64_tr_b16 a[80:81], v17 offset:24576
    v_cvt_pk_f16_f32 v152, v100, v101
    v_mfma_f32_16x16x32_bf16 v[168:171], a[100:103], v[76:79], v[168:171]
    ds_read_b64_tr_b16 a[82:83], v17 offset:25344
    v_cvt_pk_f16_f32 v153, v102, v103
    v_mfma_f32_16x16x32_bf16 v[160:163], a[120:123], v[84:87], 0
    ds_read_b64_tr_b16 a[104:105], v17 offset:24608
    v_pk_fmac_f16 v48, v152, v152
    v_mfma_f32_16x16x32_bf16 v[160:163], a[124:127], v[76:79], v[160:163]
    s_waitcnt lgkmcnt(6)
    ds_read_b64_tr_b16 a[106:107], v17 offset:25376
    buffer_load_dwordx4 v83, s[32:35], s92 offen offset:0 lds
    v_mfma_f32_16x16x32_bf16 v[76:79], a[72:75], v[144:147], 0
    ds_read_b64_tr_b16 a[128:129], v17 offset:24640
    v_pk_fmac_f16 v48, v153, v153
    v_mfma_f32_16x16x32_bf16 v[76:79], a[76:79], v[68:71], v[76:79]
    ds_read_b64_tr_b16 a[130:131], v17 offset:25408
    v_cvt_pk_f16_f32 v24, v24, v25
    v_mfma_f32_16x16x32_bf16 v[116:119], a[96:99], v[144:147], 0
    ds_read_b128 v[236:239], v7 offset:3072
    v_cvt_pk_f16_f32 v25, v26, v27
    v_mfma_f32_16x16x32_bf16 v[116:119], a[100:103], v[68:71], v[116:119]
    ds_read_b128 v[100:103], v7 offset:41088
    v_pk_fma_f16 v50, v24, v24, s39
    v_mfma_f32_16x16x32_bf16 v[84:87], a[120:123], v[144:147], 0
    ds_read_b32 v197, v197 offset:336
    buffer_load_dwordx4 v97, s[32:35], s92 offen offset:1024 lds
    v_mfma_f32_16x16x32_bf16 v[84:87], a[124:127], v[68:71], v[84:87]
    s_waitcnt lgkmcnt(8)
    v_pk_fmac_f16 v50, v25, v25
    v_cvt_pk_f16_f32 v26, v44, v45
    v_mfma_f32_16x16x32_bf16 v[32:35], a[72:75], v[108:111], 0
    ds_read_b128 v[68:71], v7 offset:42624
    v_cvt_pk_f16_f32 v27, v46, v47
    v_mfma_f32_16x16x32_bf16 v[32:35], a[76:79], v[36:39], v[32:35]
    ds_read_b32 v198, v198 offset:336
    v_pk_fmac_f16 v50, v26, v26
    v_mfma_f32_16x16x32_bf16 v[156:159], a[96:99], v[108:111], 0
    v_pk_fmac_f16 v50, v27, v27
    v_cvt_pk_f16_f32 v146, v112, v113
    v_mfma_f32_16x16x32_bf16 v[156:159], a[100:103], v[36:39], v[156:159]
    s_waitcnt vmcnt(8)
    ds_read_b128 v[44:47], v7 offset:128
    buffer_load_dwordx4 v8, s[32:35], s92 offen offset:2048 lds
    v_cvt_pk_f16_f32 v147, v114, v115
    v_pk_fmac_f16 v50, v146, v146
    s_add_u32 m0, s90, 12288
    s_mov_b32 s92, 37632
    ds_read_b64_tr_b16 a[84:85], v17 offset:36864
    v_pk_fmac_f16 v50, v147, v147
    v_mfma_f32_16x16x32_bf16 v[148:151], a[120:123], v[108:111], 0
    ds_read_b64_tr_b16 a[86:87], v17 offset:37632
    v_cvt_pk_f16_f32 v108, v12, v13
    v_mfma_f32_16x16x32_bf16 v[148:151], a[124:127], v[36:39], v[148:151]
    s_waitcnt lgkmcnt(5)
    ds_read_b64_tr_b16 a[108:109], v17 offset:36896
    v_cvt_pk_f16_f32 v109, v14, v15
    v_mfma_f32_16x16x32_bf16 v[112:115], a[72:75], v[236:239], 0
    ds_read_b64_tr_b16 a[110:111], v17 offset:37664
    v_pk_fma_f16 v16, v108, v108, s39
    v_mfma_f32_16x16x32_bf16 v[112:115], a[76:79], v[228:231], v[112:115]
    buffer_load_dwordx4 v83, s[32:35], s92 offen offset:0 lds
    ds_read_b64_tr_b16 a[132:133], v17 offset:36928
    v_mfma_f32_16x16x32_bf16 v[12:15], a[96:99], v[236:239], 0
    ds_read_b64_tr_b16 a[134:135], v17 offset:37696
    v_pk_fmac_f16 v16, v109, v109
    v_mfma_f32_16x16x32_bf16 v[12:15], a[100:103], v[228:231], v[12:15]
    ds_read_b128 v[36:39], v7 offset:1664
    v_cvt_pk_f16_f32 v110, v140, v141
    v_mfma_f32_16x16x32_bf16 v[60:63], a[80:83], v[100:103], v[60:63]
    ds_read_b128 v[232:235], v7 offset:3200
    v_cvt_pk_f16_f32 v111, v142, v143
    v_mfma_f32_16x16x32_bf16 v[224:227], a[104:107], v[100:103], v[224:227]
    ds_read_b32 v199, v199 offset:336
    v_pk_fmac_f16 v16, v110, v110
    v_mfma_f32_16x16x32_bf16 v[52:55], a[128:131], v[100:103], v[52:55]
    s_waitcnt lgkmcnt(8)
    buffer_load_dwordx4 v97, s[32:35], s92 offen offset:1024 lds
    v_pk_fmac_f16 v16, v111, v111
    v_mfma_f32_16x16x32_bf16 v[72:75], a[80:83], v[68:71], v[72:75]
    ds_read_b128 v[100:103], v6 offset:41088
    v_cvt_pk_f16_f32 v140, v92, v93
    v_mfma_f32_16x16x32_bf16 v[168:171], a[104:107], v[68:71], v[168:171]
    v_cvt_pk_f16_f32 v141, v94, v95
    v_pk_fmac_f16 v16, v140, v140
    v_mfma_f32_16x16x32_bf16 v[160:163], a[128:131], v[68:71], v[160:163]
    ds_read_b128 v[92:95], v6 offset:42624
    v_pk_fmac_f16 v16, v141, v141
    v_mfma_f32_16x16x32_bf16 v[68:71], a[120:123], v[236:239], 0
    v_mov_b32 v18, 0
    v_mov_b32 v19, 0
    v_mfma_f32_16x16x32_bf16 v[68:71], a[124:127], v[228:231], v[68:71]
    s_waitcnt vmcnt(8)
    buffer_load_dwordx4 v8, s[32:35], s92 offen offset:2048 lds
    ds_read_b64_tr_b16 a[88:89], v17 offset:49152
    v_mfma_f32_16x16x32_bf16 v[76:79], a[80:83], v[44:47], v[76:79]
    s_add_u32 m0, s90, 24576
    ds_read_b64_tr_b16 a[90:91], v17 offset:49920
    v_mov_b32 v5, 0xf149f2ca
    v_mfma_f32_16x16x32_bf16 v[116:119], a[104:107], v[44:47], v[116:119]
    s_mov_b32 s92, 74496
    ds_read_b64_tr_b16 a[112:113], v17 offset:49184
    v_mfma_f32_16x16x32_bf16 v[84:87], a[128:131], v[44:47], v[84:87]
    s_waitcnt lgkmcnt(5)
    ds_read_b64_tr_b16 a[114:115], v17 offset:49952
    v_mfma_f32_16x16x32_bf16 v[32:35], a[80:83], v[36:39], v[32:35]
    ds_read_b64_tr_b16 a[136:137], v17 offset:49216
    v_mfma_f32_16x16x32_bf16 v[156:159], a[104:107], v[36:39], v[156:159]
    buffer_load_dwordx4 v83, s[32:35], s92 offen offset:0 lds
    ds_read_b64_tr_b16 a[138:139], v17 offset:49984
    v_mfma_f32_16x16x32_bf16 v[148:151], a[128:131], v[36:39], v[148:151]
    ds_read_b128 v[44:47], v6 offset:128
    v_mfma_f32_16x16x32_bf16 v[112:115], a[80:83], v[232:235], v[112:115]
    ds_read_b128 v[36:39], v6 offset:1664
    v_mfma_f32_16x16x32_bf16 v[12:15], a[104:107], v[232:235], v[12:15]
    ds_read_b128 v[228:231], v6 offset:3200
    v_mfma_f32_16x16x32_bf16 v[68:71], a[128:131], v[232:235], v[68:71]
    s_waitcnt lgkmcnt(8)
    s_cmp_ge_u32 s2, 247
    s_cbranch_scc1 L_maskF
L_nomaskF:
    v_mfma_f32_16x16x32_bf16 v[60:63], a[84:87], v[100:103], v[60:63]
    buffer_load_dwordx4 v97, s[32:35], s92 offen offset:1024 lds
    ds_read_b128 v[232:235], v7 offset:41216
    v_mfma_f32_16x16x32_bf16 v[224:227], a[108:111], v[100:103], v[224:227]
    v_readlane_b32 s84, v211, 48
    v_cmp_gt_u32 vcc, 16, v2
    v_mfma_f32_16x16x32_bf16 v[52:55], a[132:135], v[100:103], v[52:55]
    s_nop 0
    v_cndmask_b32 v208, v5, v208, vcc
    v_cndmask_b32 v209, v5, v209, vcc
    v_mfma_f32_16x16x32_bf16 v[72:75], a[84:87], v[92:95], v[72:75]
    ds_read_b128 v[100:103], v7 offset:42752
    v_cndmask_b32 v210, v5, v210, vcc
    v_mfma_f32_16x16x32_bf16 v[168:171], a[108:111], v[92:95], v[168:171]
    v_cmp_gt_u32 vcc, 49, v2
    v_mfma_f32_16x16x32_bf16 v[160:163], a[132:135], v[92:95], v[160:163]
    s_waitcnt vmcnt(8) lgkmcnt(4)
    buffer_load_dwordx4 v8, s[32:35], s92 offen offset:2048 lds
    ds_read_b64_tr_b16 a[92:93], v17 offset:61440
    v_mfma_f32_16x16x32_bf16 v[76:79], a[84:87], v[44:47], v[76:79]
    s_add_u32 m0, s90, 36864
    ds_read_b64_tr_b16 a[94:95], v17 offset:62208
    v_cndmask_b32 v211, v5, v211, vcc
    v_mfma_f32_16x16x32_bf16 v[116:119], a[108:111], v[44:47], v[116:119]
    s_mov_b32 s92, 111360
    ds_read_b64_tr_b16 a[116:117], v17 offset:61472
    v_mfma_f32_16x16x32_bf16 v[84:87], a[132:135], v[44:47], v[84:87]
    s_waitcnt lgkmcnt(5)
    s_mov_b32 s53, s47
    ds_read_b64_tr_b16 a[118:119], v17 offset:62240
    v_mfma_f32_16x16x32_bf16 v[32:35], a[84:87], v[36:39], v[32:35]
    s_mov_b32 s47, s46
    ds_read_b64_tr_b16 a[140:141], v17 offset:61504
    v_mfma_f32_16x16x32_bf16 v[156:159], a[108:111], v[36:39], v[156:159]
    s_mov_b32 s46, s45
    buffer_load_dwordx4 v83, s[32:35], s92 offen offset:0 lds
    ds_read_b64_tr_b16 a[142:143], v17 offset:62272
    v_mfma_f32_16x16x32_bf16 v[148:151], a[132:135], v[36:39], v[148:151]
    s_mov_b32 s45, s44
    ds_read_b128 v[44:47], v7 offset:256
    v_mfma_f32_16x16x32_bf16 v[112:115], a[84:87], v[228:231], v[112:115]
    s_mov_b32 s44, s53
    ds_read_b128 v[36:39], v7 offset:1792
    v_mov_b32 v30, 0
    v_mfma_f32_16x16x32_bf16 v[12:15], a[108:111], v[228:231], v[12:15]
    s_sub_u32 s48, s44, s46
    ds_read_b128 v[92:95], v7 offset:3328
    v_mov_b32 v31, 0
    v_mfma_f32_16x16x32_bf16 v[68:71], a[132:135], v[228:231], v[68:71]
    s_waitcnt lgkmcnt(8)
    s_sub_u32 s49, s46, s45
    v_mov_b32 v9, 0
    v_add_u32 v5, 28672, v29
    v_mfma_f32_16x16x32_bf16 v[60:63], a[88:91], v[232:235], v[60:63]
    s_sub_u32 s50, s45, s44
    buffer_load_dwordx4 v97, s[32:35], s92 offen offset:1024 lds
    ds_read_b128 v[228:231], v6 offset:41216
    v_mfma_f32_16x16x32_bf16 v[224:227], a[112:115], v[232:235], v[224:227]
    s_sub_u32 s51, s46, s47
    v_add_u32 v137, s48, v137
    v_add_u32 v136, s48, v136
    v_mfma_f32_16x16x32_bf16 v[52:55], a[136:139], v[232:235], v[52:55]
    s_mov_b32 s60, s59
    ds_write2_b64 v5, v[30:31], v[30:31] offset0:2 offset1:3
    v_mfma_f32_16x16x32_bf16 v[72:75], a[88:91], v[100:103], v[72:75]
    s_mov_b32 s59, s58
    v_add_u32 v135, s49, v135
    v_add_u32 v134, s49, v134
    v_mfma_f32_16x16x32_bf16 v[168:171], a[112:115], v[100:103], v[168:171]
    s_mov_b32 s58, s57
    buffer_load_dwordx4 v8, s[32:35], s92 offen offset:2048 lds
    v_add_u32 v137, s50, v137
    v_mfma_f32_16x16x32_bf16 v[160:163], a[136:139], v[100:103], v[160:163]
    s_waitcnt vmcnt(9) lgkmcnt(3)
    s_add_u32 m0, s90, 49152
    ds_read_b64_tr_b16 a[144:145], v139 offset:0
    v_add_u32 v136, s50, v136
    v_mfma_f32_16x16x32_bf16 v[76:79], a[88:91], v[44:47], v[76:79]
    s_mov_b32 s92, 148224
    ds_read_b64_tr_b16 a[146:147], v139 offset:768
    v_add_u32 v135, s48, v135
    v_mfma_f32_16x16x32_bf16 v[116:119], a[112:115], v[44:47], v[116:119]
    s_mov_b32 s57, s56
    ds_read_b64_tr_b16 a[168:169], v139 offset:8
    v_add_u32 v134, s48, v134
    v_mfma_f32_16x16x32_bf16 v[84:87], a[136:139], v[44:47], v[84:87]
    s_mov_b32 s7, s6
    ds_read_b64_tr_b16 a[170:171], v139 offset:776
    v_add_u32 v133, s51, v133
    v_mfma_f32_16x16x32_bf16 v[32:35], a[88:91], v[36:39], v[32:35]
    s_mov_b32 s6, s5
    ds_read_b64_tr_b16 a[192:193], v17 offset:64
    buffer_load_dwordx4 v83, s[32:35], s92 offen offset:0 lds
    v_mfma_f32_16x16x32_bf16 v[156:159], a[112:115], v[36:39], v[156:159]
    s_mov_b32 s5, s4
    ds_read_b64_tr_b16 a[194:195], v17 offset:832
    v_mfma_f32_16x16x32_bf16 v[148:151], a[136:139], v[36:39], v[148:151]
    s_waitcnt lgkmcnt(6)
    s_sub_u32 s14, s6, s7
    ds_read_b128 v[100:103], v6 offset:42752
    v_add_u32 v132, s14, v132
    v_mfma_f32_16x16x32_bf16 v[112:115], a[88:91], v[92:95], v[112:115]
    s_add_u32 s61, s61, 1
    ds_read_b128 v[44:47], v6 offset:256
    v_add_u32 v131, s14, v131
    v_mfma_f32_16x16x32_bf16 v[12:15], a[112:115], v[92:95], v[12:15]
    s_add_u32 s12, s12, 20
    ds_read_b128 v[36:39], v6 offset:1792
    v_mfma_f32_16x16x32_bf16 v[68:71], a[136:139], v[92:95], v[68:71]
    s_max_u32 s12, s12, s61
    buffer_load_dwordx4 v97, s[32:35], s92 offen offset:1024 lds
    ds_read_b128 v[92:95], v6 offset:3328
    v_mfma_f32_16x16x32_bf16 v[60:63], a[92:95], v[228:231], v[60:63]
    s_add_u32 s65, s65, 1
    v_mfma_f32_16x16x32_bf16 v[224:227], a[116:119], v[228:231], v[224:227]
    s_add_u32 s67, s46, s54
    s_nop 0
    v_mfma_f32_16x16x32_bf16 v[52:55], a[140:143], v[228:231], v[52:55]
    s_waitcnt vmcnt(8) lgkmcnt(3)
    s_nop 0
    ds_read_b128 v[232:235], v7 offset:40960
    v_cvt_pk_f16_f32 v60, v60, v61
    v_cvt_pk_f16_f32 v61, v62, v63
    v_pk_fma_f16 v81, v60, v60, s39
    v_pk_fmac_f16 v81, v61, v61
    v_cvt_pk_f16_f32 v62, v224, v225
    v_cvt_pk_f16_f32 v63, v226, v227
    v_pk_fmac_f16 v81, v62, v62
    ds_read_b64_tr_b16 a[148:149], v139 offset:12288
    v_mfma_f32_16x16x32_bf16 v[72:75], a[92:95], v[100:103], v[72:75]
    buffer_load_dwordx4 v8, s[32:35], s92 offen offset:2048 lds
    ds_read_b64_tr_b16 a[150:151], v139 offset:13056
    v_mfma_f32_16x16x32_bf16 v[168:171], a[116:119], v[100:103], v[168:171]
    s_add_u32 m0, s90, 61440
    v_pk_fmac_f16 v81, v63, v63
    v_cvt_pk_f16_f32 v96, v52, v53
    v_mfma_f32_16x16x32_bf16 v[160:163], a[140:143], v[100:103], v[160:163]
    s_waitcnt lgkmcnt(4)
    s_mov_b32 s92, 185088
    ds_read_b64_tr_b16 a[172:173], v139 offset:12296
    v_cvt_pk_f16_f32 v72, v72, v73
    v_mfma_f32_16x16x32_bf16 v[76:79], a[92:95], v[44:47], v[76:79]
    ds_read_b64_tr_b16 a[174:175], v139 offset:13064
    v_cvt_pk_f16_f32 v73, v74, v75
    v_mfma_f32_16x16x32_bf16 v[116:119], a[116:119], v[44:47], v[116:119]
    ds_read_b64_tr_b16 a[196:197], v17 offset:12352
    buffer_load_dwordx4 v83, s[32:35], s92 offen offset:0 lds
    v_mfma_f32_16x16x32_bf16 v[84:87], a[140:143], v[44:47], v[84:87]
    ds_read_b64_tr_b16 a[198:199], v17 offset:13120
    v_pk_fma_f16 v83, v72, v72, s39
    v_mfma_f32_16x16x32_bf16 v[32:35], a[92:95], v[36:39], v[32:35]
    ds_read_b128 v[228:231], v6 offset:40960
    v_pk_fmac_f16 v83, v73, v73
    v_mfma_f32_16x16x32_bf16 v[156:159], a[116:119], v[36:39], v[156:159]
    ds_read_b128 v[100:103], v7 offset:41088
    v_cvt_pk_f16_f32 v74, v168, v169
    v_mfma_f32_16x16x32_bf16 v[148:151], a[140:143], v[36:39], v[148:151]
    s_waitcnt lgkmcnt(7)
    ds_read_b128 v[44:47], v6 offset:41088
    v_cvt_pk_f16_f32 v75, v170, v171
    v_mfma_f32_16x16x32_bf16 v[112:115], a[92:95], v[92:95], v[112:115]
    buffer_load_dwordx4 v97, s[32:35], s92 offen offset:1024 lds
    ds_read_b128 v[36:39], v7 offset:41216
    v_mfma_f32_16x16x32_bf16 v[12:15], a[116:119], v[92:95], v[12:15]
    v_pk_fmac_f16 v83, v74, v74
    v_pk_fmac_f16 v83, v75, v75
    v_mfma_f32_16x16x32_bf16 v[68:71], a[140:143], v[92:95], v[68:71]
    ds_read_b128 v[92:95], v6 offset:41216
    v_cvt_pk_f16_f32 v42, v160, v161
    v_cvt_pk_f16_f32 v43, v162, v163
    v_pk_fmac_f16 v83, v42, v42
    v_pk_fmac_f16 v83, v43, v43
    v_cvt_pk_f16_f32 v32, v32, v33
    v_cvt_pk_f16_f32 v33, v34, v35
    v_pk_fma_f16 v51, v32, v32, s39
    v_pk_fmac_f16 v51, v33, v33
    v_cvt_pk_f16_f32 v34, v156, v157
    v_cvt_pk_f16_f32 v35, v158, v159
    s_waitcnt vmcnt(8)
    ds_read_b64_tr_b16 a[152:153], v139 offset:24576
    buffer_load_dwordx4 v8, s[32:35], s92 offen offset:2048 lds
    s_add_u32 m0, s90, 0
    s_mov_b32 s92, 0
    ds_read_b64_tr_b16 a[154:155], v139 offset:25344
    v_pk_fmac_f16 v51, v34, v34
    v_pk_fmac_f16 v51, v35, v35
    v_cvt_pk_f16_f32 v148, v148, v149
    ds_read_b64_tr_b16 a[176:177], v139 offset:24584
    v_cvt_pk_f16_f32 v149, v150, v151
    v_pk_fmac_f16 v51, v148, v148
    v_pk_fmac_f16 v51, v149, v149
    ds_read_b64_tr_b16 a[178:179], v139 offset:25352
    v_cvt_pk_f16_f32 v76, v76, v77
    ds_read_b64_tr_b16 a[200:201], v17 offset:24640
    buffer_load_dwordx4 v4, s[76:79], s92 offen offset:0 lds
    ds_read_b64_tr_b16 a[202:203], v17 offset:25408
    v_cvt_pk_f16_f32 v77, v78, v79
    v_pk_fma_f16 v49, v76, v76, s39
    v_pk_fmac_f16 v49, v77, v77
    v_cvt_pk_f16_f32 v78, v116, v117
    v_cvt_pk_f16_f32 v79, v118, v119
    v_pk_fmac_f16 v49, v78, v78
    v_pk_fmac_f16 v49, v79, v79
    v_cvt_pk_f16_f32 v154, v84, v85
    v_cvt_pk_f16_f32 v155, v86, v87
    v_pk_fmac_f16 v49, v154, v154
    v_pk_fmac_f16 v49, v155, v155
    v_cvt_pk_f16_f32 v97, v54, v55
    v_pk_fmac_f16 v81, v96, v96
    v_mfma_f32_16x16x32_f16 v[52:55], v[212:215], v[48:51], 0
    buffer_load_dwordx4 v166, s[76:79], s92 offen offset:1024 lds
    v_pk_fmac_f16 v81, v97, v97
    v_mov_b32 v171, 0
    v_mov_b32 v167, 0
    v_mfma_f32_16x16x32_f16 v[48:51], v[212:215], v[80:83], 0
    s_nop 0
    v_mov_b32 v163, 0
    v_mov_b32 v159, 0
    v_mov_b32 v150, 0
    v_mov_b32 v151, 0
    v_mov_b32 v144, 0
    v_mov_b32 v145, 0
    v_mov_b32 v138, 0
    v_or3_b32 v123, v123, v48, v49
    v_rsq_f32 v48, v48
    v_rsq_f32 v49, v49
    v_mul_f32 v48, s52, v48
    v_cvt_pk_f16_f32 v48, v48, v49
    s_waitcnt vmcnt(8)
    ds_read_b64_tr_b16 a[156:157], v139 offset:36864
    buffer_load_dwordx4 v28, s[76:79], s92 offen offset:2048 lds
    s_add_u32 m0, s90, 12288
    s_mov_b32 s92, 12288
    ds_read_b64_tr_b16 a[158:159], v139 offset:37632
    v_or3_b32 v123, v123, v50, v51
    v_rsq_f32 v50, v50
    ds_read_b64_tr_b16 a[180:181], v139 offset:36872
    v_rsq_f32 v51, v51
    v_mul_f32 v50, s52, v50
    ds_read_b64_tr_b16 a[182:183], v139 offset:37640
    v_cvt_pk_f16_f32 v50, v50, v51
    ds_read_b64_tr_b16 a[204:205], v17 offset:36928
    s_waitcnt lgkmcnt(5)
    buffer_load_dwordx4 v4, s[76:79], s92 offen offset:0 lds
    ds_read_b64_tr_b16 a[206:207], v17 offset:37696
    v_pk_mul_f16 v20, v20, v48 op_sel:[0,0] op_sel_hi:[1,0]
    v_pk_mul_f16 v21, v21, v48 op_sel:[0,0] op_sel_hi:[1,0]
    v_pk_mul_f16 v22, v22, v48 op_sel:[0,0] op_sel_hi:[1,0]
    v_pk_mul_f16 v23, v23, v48 op_sel:[0,0] op_sel_hi:[1,0]
    v_pk_mul_f16 v88, v88, v48 op_sel:[0,0] op_sel_hi:[1,0]
    v_pk_mul_f16 v89, v89, v48 op_sel:[0,0] op_sel_hi:[1,0]
    v_pk_mul_f16 v60, v60, v48 op_sel:[0,1] op_sel_hi:[1,1]
    v_pk_mul_f16 v61, v61, v48 op_sel:[0,1] op_sel_hi:[1,1]
    v_pk_mul_f16 v62, v62, v48 op_sel:[0,1] op_sel_hi:[1,1]
    v_pk_mul_f16 v63, v63, v48 op_sel:[0,1] op_sel_hi:[1,1]
    v_pk_mul_f16 v96, v96, v48 op_sel:[0,1] op_sel_hi:[1,1]
    v_pk_mul_f16 v97, v97, v48 op_sel:[0,1] op_sel_hi:[1,1]
    v_fma_mix_f32 v8, v20, v60, 0 op_sel:[0,0,0] op_sel_hi:[1,1,0]
    v_fma_mix_f32 v8, v20, v60, v8 op_sel:[1,1,0] op_sel_hi:[1,1,0]
    v_fma_mix_f32 v8, v21, v61, v8 op_sel:[0,0,0] op_sel_hi:[1,1,0]
    buffer_load_dwordx4 v166, s[76:79], s92 offen offset:1024 lds
    ds_write_b128 v5, v[60:63]
    v_fma_mix_f32 v8, v21, v61, v8 op_sel:[1,1,0] op_sel_hi:[1,1,0]
    v_fma_mix_f32 v8, v22, v62, v8 op_sel:[0,0,0] op_sel_hi:[1,1,0]
    v_fma_mix_f32 v8, v22, v62, v8 op_sel:[1,1,0] op_sel_hi:[1,1,0]
    v_fma_mix_f32 v8, v23, v63, v8 op_sel:[0,0,0] op_sel_hi:[1,1,0]
    v_fma_mix_f32 v8, v23, v63, v8 op_sel:[1,1,0] op_sel_hi:[1,1,0]
    v_fma_mix_f32 v8, v88, v96, v8 op_sel:[0,0,0] op_sel_hi:[1,1,0]
    v_fma_mix_f32 v8, v88, v96, v8 op_sel:[1,1,0] op_sel_hi:[1,1,0]
    v_fma_mix_f32 v8, v89, v97, v8 op_sel:[0,0,0] op_sel_hi:[1,1,0]
    v_fma_mix_f32 v8, v89, v97, v8 op_sel:[1,1,0] op_sel_hi:[1,1,0]
    v_mov_b32 v142, v8
    s_waitcnt vmcnt(8)
    ds_read_b64_tr_b16 a[160:161], v139 offset:49152
    buffer_load_dwordx4 v28, s[76:79], s92 offen offset:2048 lds
    s_add_u32 m0, s90, 24576
    s_mov_b32 s92, 24576
    ds_read_b64_tr_b16 a[162:163], v139 offset:49920
    v_permlane32_swap_b32 v142, v8
    v_add_f32 v8, v142, v8
    ds_read_b64_tr_b16 a[184:185], v139 offset:49160
    v_mov_b32 v142, v8
    v_or3_b32 v123, v123, v52, v53
    v_rsq_f32 v52, v52
    ds_read_b64_tr_b16 a[186:187], v139 offset:49928
    v_permlane16_swap_b32 v142, v8
    ds_read_b64_tr_b16 a[208:209], v17 offset:49216
    buffer_load_dwordx4 v4, s[76:79], s92 offen offset:0 lds
    ds_read_b64_tr_b16 a[210:211], v17 offset:49984
    v_add_f32 v8, v142, v8
    ds_write_b128 v5, v[20:23] offset:32
    v_rsq_f32 v53, v53
    v_mul_f32 v52, s52, v52
    v_cvt_pk_f16_f32 v52, v52, v53
    v_or3_b32 v123, v123, v54, v55
    v_rsq_f32 v54, v54
    buffer_load_dwordx4 v166, s[76:79], s92 offen offset:1024 lds
    ds_write2_b64 v5, v[96:97], v[30:31] offset0:6 offset1:7
    v_rsq_f32 v55, v55
    v_mul_f32 v54, s52, v54
    v_cvt_pk_f16_f32 v54, v54, v55
    v_pk_mul_f16 v76, v76, v52 op_sel:[0,1] op_sel_hi:[1,1]
    v_pk_mul_f16 v77, v77, v52 op_sel:[0,1] op_sel_hi:[1,1]
    v_pk_mul_f16 v78, v78, v52 op_sel:[0,1] op_sel_hi:[1,1]
    v_pk_mul_f16 v79, v79, v52 op_sel:[0,1] op_sel_hi:[1,1]
    ds_write2_b64 v5, v[30:31], v[88:89] offset0:8 offset1:9
    buffer_load_dwordx4 v28, s[76:79], s92 offen offset:2048 lds
    s_add_u32 m0, s90, 36864
    s_mov_b32 s92, 36864
    v_pk_mul_f16 v154, v154, v52 op_sel:[0,1] op_sel_hi:[1,1]
    v_pk_mul_f16 v155, v155, v52 op_sel:[0,1] op_sel_hi:[1,1]
    v_pk_mul_f16 v104, v104, v52 op_sel:[0,0] op_sel_hi:[1,0]
    v_pk_mul_f16 v105, v105, v52 op_sel:[0,0] op_sel_hi:[1,0]
    v_pk_mul_f16 v106, v106, v52 op_sel:[0,0] op_sel_hi:[1,0]
    s_waitcnt vmcnt(9)
    ds_read_b64_tr_b16 a[164:165], v139 offset:61440
    v_pk_mul_f16 v107, v107, v52 op_sel:[0,0] op_sel_hi:[1,0]
    v_pk_mul_f16 v152, v152, v52 op_sel:[0,0] op_sel_hi:[1,0]
    v_pk_mul_f16 v153, v153, v52 op_sel:[0,0] op_sel_hi:[1,0]
    v_mfma_f32_16x16x32_f16 v[84:87], v[76:79], v[104:107], v[204:207]
    s_waitcnt lgkmcnt(2)
    ds_read_b64_tr_b16 a[166:167], v139 offset:62208
    buffer_load_dwordx4 v4, s[76:79], s92 offen offset:0 lds
    v_mfma_f32_16x16x32_f16 v[84:87], v[152:155], v[150:153], v[84:87]
    ds_read_b64_tr_b16 a[188:189], v139 offset:61448
    v_pk_mul_f16 v32, v32, v54 op_sel:[0,1] op_sel_hi:[1,1]
    v_mfma_f32_16x16x32_bf16 v[20:23], a[144:147], v[232:235], 0
    ds_read_b64_tr_b16 a[190:191], v139 offset:62216
    v_pk_mul_f16 v33, v33, v54 op_sel:[0,1] op_sel_hi:[1,1]
    v_mfma_f32_16x16x32_bf16 v[20:23], a[148:151], v[228:231], v[20:23]
    ds_read_b64_tr_b16 a[212:213], v17 offset:61504
    v_pk_mul_f16 v34, v34, v54 op_sel:[0,1] op_sel_hi:[1,1]
    v_mfma_f32_16x16x32_bf16 v[20:23], a[152:155], v[100:103], v[20:23]
    ds_read_b64_tr_b16 a[214:215], v17 offset:62272
    v_pk_mul_f16 v35, v35, v54 op_sel:[0,1] op_sel_hi:[1,1]
    v_mfma_f32_16x16x32_bf16 v[20:23], a[156:159], v[44:47], v[20:23]
    v_pk_mul_f16 v148, v148, v54 op_sel:[0,1] op_sel_hi:[1,1]
    v_pk_mul_f16 v149, v149, v54 op_sel:[0,1] op_sel_hi:[1,1]
    v_mfma_f32_16x16x32_bf16 v[20:23], a[160:163], v[36:39], v[20:23]
    buffer_load_dwordx4 v166, s[76:79], s92 offen offset:1024 lds
    v_pk_mul_f16 v24, v24, v54 op_sel:[0,0] op_sel_hi:[1,0]
    v_pk_mul_f16 v25, v25, v54 op_sel:[0,0] op_sel_hi:[1,0]
    v_pk_mul_f16 v26, v26, v54 op_sel:[0,0] op_sel_hi:[1,0]
    v_pk_mul_f16 v27, v27, v54 op_sel:[0,0] op_sel_hi:[1,0]
    v_pk_mul_f16 v146, v146, v54 op_sel:[0,0] op_sel_hi:[1,0]
    v_pk_mul_f16 v147, v147, v54 op_sel:[0,0] op_sel_hi:[1,0]
    v_mov_b32 v139, 0
    v_add_f32 v8, s84, v8
    v_exp_f32 v8, v8
    s_waitcnt lgkmcnt(4)
    v_mfma_f32_16x16x32_bf16 v[20:23], a[164:167], v[92:95], v[20:23]
    ds_read_b128 v[224:227], v7 offset:3072
    v_cvt_pk_bf16_f32 v8, v8, 0
    v_mfma_f32_16x16x32_bf16 v[80:83], a[168:171], v[232:235], 0
    s_nop 0
    buffer_load_dwordx4 v28, s[76:79], s92 offen offset:2048 lds
    ds_read_b128 v[116:119], v6 offset:3072
    v_mfma_f32_16x16x32_bf16 v[80:83], a[172:175], v[228:231], v[80:83]
    s_add_u32 m0, s90, 49152
    v_cvt_pk_bf16_f32 v30, v20, v21
    v_cvt_pk_bf16_f32 v31, v22, v23
    v_mfma_f32_16x16x32_bf16 v[80:83], a[176:179], v[100:103], v[80:83]
    s_mov_b32 s92, 49152
    ds_write_b64 v29, v[30:31] offset:28752
    v_mfma_f32_16x16x32_bf16 v[80:83], a[180:183], v[44:47], v[80:83]
    v_cmp_gt_u32 vcc, 16, v2
    v_cvt_pk_f16_f32 v112, v112, v113
    v_mfma_f32_16x16x32_bf16 v[80:83], a[184:187], v[36:39], v[80:83]
    s_waitcnt lgkmcnt(3)
    ds_read_b128 v[60:63], v7 offset:3200
    v_cndmask_b32 v8, 0, v8, vcc
    v_mfma_f32_16x16x32_bf16 v[80:83], a[188:191], v[92:95], v[80:83]
    buffer_load_dwordx4 v4, s[76:79], s92 offen offset:0 lds
    ds_read_b128 v[52:55], v6 offset:3200
    v_mfma_f32_16x16x32_bf16 v[20:23], a[192:195], v[232:235], 0
    v_cvt_pk_f16_f32 v113, v114, v115
    v_pk_fma_f16 v17, v112, v112, s39
    v_mfma_f32_16x16x32_bf16 v[20:23], a[196:199], v[228:231], v[20:23]
    ds_write_b64 v5, v[8:9] offset:88
    v_mfma_f32_16x16x32_bf16 v[20:23], a[200:203], v[100:103], v[20:23]
    v_cvt_pk_bf16_f32 v80, v80, v81
    v_cvt_pk_bf16_f32 v81, v82, v83
    v_mfma_f32_16x16x32_bf16 v[20:23], a[204:207], v[44:47], v[20:23]
    ds_read_b128 v[44:47], v7 offset:3328
    v_pk_fmac_f16 v17, v113, v113
    v_mfma_f32_16x16x32_bf16 v[20:23], a[208:211], v[36:39], v[20:23]
    buffer_load_dwordx4 v166, s[76:79], s92 offen offset:1024 lds
    ds_read_b128 v[36:39], v6 offset:3328
    v_mfma_f32_16x16x32_bf16 v[20:23], a[212:215], v[92:95], v[20:23]
    v_cvt_pk_f16_f32 v114, v12, v13
    v_cvt_pk_f16_f32 v115, v14, v15
    v_mfma_f32_16x16x32_f16 v[12:15], v[32:35], v[104:107], v[200:203]
    v_pk_fmac_f16 v17, v114, v114
    v_pk_fmac_f16 v17, v115, v115
    v_mfma_f32_16x16x32_f16 v[12:15], v[146:149], v[150:153], v[12:15]
    s_waitcnt lgkmcnt(4)
    s_nop 0
    v_cvt_pk_bf16_f32 v82, v20, v21
    v_cvt_pk_bf16_f32 v83, v22, v23
    v_mfma_f32_16x16x32_bf16 v[20:23], v[224:227], a[144:147], 0
    ds_write_b128 v29, v[80:83] offset:28768
    v_mfma_f32_16x16x32_bf16 v[20:23], v[116:119], a[148:151], v[20:23]
    buffer_load_dwordx4 v28, s[76:79], s92 offen offset:2048 lds
    v_cvt_pk_f16_f32 v142, v68, v69
    v_mfma_f32_16x16x32_bf16 v[20:23], v[60:63], a[152:155], v[20:23]
    s_waitcnt lgkmcnt(3)
    s_add_u32 m0, s90, 61440
    v_cvt_pk_f16_f32 v143, v70, v71
    v_pk_fmac_f16 v17, v142, v142
    v_mfma_f32_16x16x32_bf16 v[20:23], v[52:55], a[156:159], v[20:23]
    s_waitcnt lgkmcnt(2)
    s_mov_b32 s92, 61440
    ds_read_b128 v[100:103], v132 offset:0
    v_pk_fmac_f16 v17, v143, v143
    v_mfma_f32_16x16x32_bf16 v[20:23], v[44:47], a[160:163], v[20:23]
    s_waitcnt lgkmcnt(2)
    ds_read_b128 v[92:95], v132 offset:16
    v_pk_mul_f16 v56, v56, v50 op_sel:[0,0] op_sel_hi:[1,0]
    v_mfma_f32_16x16x32_bf16 v[20:23], v[36:39], a[164:167], v[20:23]
    s_nop 0
    buffer_load_dwordx4 v4, s[76:79], s92 offen offset:0 lds
    ds_read_b128 v[68:71], v132 offset:48
    v_mfma_f32_16x16x32_bf16 v[80:83], v[224:227], a[168:171], 0
    s_nop 0
    v_exp_f32 v84, v84
    v_mfma_f32_16x16x32_bf16 v[80:83], v[116:119], a[172:175], v[80:83]
    s_nop 0
    v_cvt_pk_bf16_f32 v164, v20, v21
    v_cvt_pk_bf16_f32 v165, v22, v23
    v_mfma_f32_16x16x32_bf16 v[80:83], v[60:63], a[176:179], v[80:83]
    v_exp_f32 v85, v85
    v_mfma_f32_16x16x32_bf16 v[80:83], v[52:55], a[180:183], v[80:83]
    v_exp_f32 v86, v86
    v_mfma_f32_16x16x32_bf16 v[80:83], v[44:47], a[184:187], v[80:83]
    buffer_load_dwordx4 v166, s[76:79], s92 offen offset:1024 lds
    v_cvt_pk_bf16_f32 v84, v84, v85
    v_mfma_f32_16x16x32_bf16 v[80:83], v[36:39], a[188:191], v[80:83]
    s_nop 0
    v_exp_f32 v87, v87
    v_mfma_f32_16x16x32_bf16 v[20:23], v[224:227], a[192:195], 0
    s_nop 0
    v_cvt_pk_bf16_f32 v85, v86, v87
    v_pk_mul_f16 v57, v57, v50 op_sel:[0,0] op_sel_hi:[1,0]
    v_mfma_f32_16x16x32_bf16 v[20:23], v[116:119], a[196:199], v[20:23]
    s_nop 0
    v_cvt_pk_bf16_f32 v160, v80, v81
    v_cvt_pk_bf16_f32 v161, v82, v83
    v_mfma_f32_16x16x32_bf16 v[20:23], v[60:63], a[200:203], v[20:23]
    v_exp_f32 v12, v12
    v_mfma_f32_16x16x32_bf16 v[20:23], v[52:55], a[204:207], v[20:23]
    buffer_load_dwordx4 v28, s[76:79], s92 offen offset:2048 lds
    ds_read_u16 v166, v131 offset:80
    v_mfma_f32_16x16x32_bf16 v[20:23], v[44:47], a[208:211], v[20:23]
    s_add_u32 m0, s54, 20480
    ds_read_u16 v162, v131 offset:96
    v_pk_mul_f16 v58, v58, v50 op_sel:[0,0] op_sel_hi:[1,0]
    v_mfma_f32_16x16x32_bf16 v[20:23], v[36:39], a[212:215], v[20:23]
    s_waitcnt lgkmcnt(2)
    ds_read_u16 v158, v131 offset:104
    v_pk_mul_f16 v59, v59, v50 op_sel:[0,0] op_sel_hi:[1,0]
    v_mfma_f32_16x16x32_f16 v[52:55], v[100:103], v[104:107], v[208:211]
    s_nop 0
    v_exp_f32 v13, v13
    v_mfma_f32_16x16x32_f16 v[52:55], v[92:95], v[76:79], v[52:55]
    s_nop 0
    v_cvt_pk_bf16_f32 v156, v20, v21
    v_cvt_pk_bf16_f32 v157, v22, v23
    v_mfma_f32_16x16x32_f16 v[52:55], v[68:71], v[152:155], v[52:55]
    buffer_load_dwordx4 v128, s[24:27], s56 offen nt lds
    v_cvt_pk_bf16_f32 v86, v12, v13
    v_mfma_f32_16x16x32_f16 v[44:47], v[100:103], v[24:27], v[208:211]
    s_add_u32 m0, s54, 21504
    ds_read_b128 v[20:23], v7 offset:42496
    v_pk_mul_f16 v40, v40, v50 op_sel:[0,0] op_sel_hi:[1,0]
    v_mfma_f32_16x16x32_f16 v[44:47], v[92:95], v[32:35], v[44:47]
    ds_read_b128 v[244:247], v6 offset:42496
    v_pk_mul_f16 v41, v41, v50 op_sel:[0,0] op_sel_hi:[1,0]
    v_mfma_f32_16x16x32_f16 v[44:47], v[68:71], v[146:149], v[44:47]
    ds_read_b128 v[240:243], v7 offset:42624
    v_pk_mul_f16 v72, v72, v50 op_sel:[0,1] op_sel_hi:[1,1]
    v_mfma_f32_16x16x32_f16 v[80:83], v[212:215], v[16:19], 0
    ds_read_b128 v[236:239], v6 offset:42624
    v_pk_mul_f16 v73, v73, v50 op_sel:[0,1] op_sel_hi:[1,1]
    v_mfma_f32_16x16x32_f16 v[16:19], v[76:79], v[24:27], v[192:195]
    buffer_load_dwordx4 v127, s[24:27], s56 offen nt lds
    ds_read_b128 v[232:235], v7 offset:42752
    v_mfma_f32_16x16x32_f16 v[16:19], v[152:155], v[144:147], v[16:19]
    s_add_u32 m0, s54, 22528
    v_mov_b32_dpp v55, v47 quad_perm:[0,1,2,3] row_mask:0x2 bank_mask:0xf
    v_or3_b32 v123, v123, v80, v81
    v_mfma_f32_16x16x32_f16 v[36:39], v[32:35], v[24:27], v[188:191]
    ds_read_b128 v[224:227], v6 offset:42752
    v_pk_mul_f16 v74, v74, v50 op_sel:[0,1] op_sel_hi:[1,1]
    v_mfma_f32_16x16x32_f16 v[36:39], v[146:149], v[144:147], v[36:39]
    s_waitcnt lgkmcnt(5)
    v_rsq_f32 v80, v80
    v_rsq_f32 v81, v81
    v_mul_f32 v80, s52, v80
    v_cvt_pk_f16_f32 v80, v80, v81
    v_pk_mul_f16 v112, v112, v80 op_sel:[0,1] op_sel_hi:[1,1]
    v_mfma_f32_16x16x32_bf16 v[60:63], a[144:147], v[20:23], 0
    s_waitcnt lgkmcnt(4)
    buffer_load_dwordx4 v126, s[24:27], s56 offen nt lds
    v_pk_mul_f16 v113, v113, v80 op_sel:[0,1] op_sel_hi:[1,1]
    v_mfma_f32_16x16x32_bf16 v[60:63], a[148:151], v[244:247], v[60:63]
    s_waitcnt lgkmcnt(3)
    s_add_u32 m0, s54, 23552
    v_pk_mul_f16 v114, v114, v80 op_sel:[0,1] op_sel_hi:[1,1]
    v_pk_mul_f16 v115, v115, v80 op_sel:[0,1] op_sel_hi:[1,1]
    v_mfma_f32_16x16x32_bf16 v[60:63], a[152:155], v[240:243], v[60:63]
    s_waitcnt lgkmcnt(2)
    v_pk_mul_f16 v142, v142, v80 op_sel:[0,1] op_sel_hi:[1,1]
    v_pk_mul_f16 v143, v143, v80 op_sel:[0,1] op_sel_hi:[1,1]
    v_mfma_f32_16x16x32_bf16 v[60:63], a[156:159], v[236:239], v[60:63]
    s_waitcnt lgkmcnt(1)
    v_pk_mul_f16 v108, v108, v80 op_sel:[0,0] op_sel_hi:[1,0]
    v_pk_mul_f16 v109, v109, v80 op_sel:[0,0] op_sel_hi:[1,0]
    v_pk_mul_f16 v110, v110, v80 op_sel:[0,0] op_sel_hi:[1,0]
    v_mfma_f32_16x16x32_bf16 v[60:63], a[160:163], v[232:235], v[60:63]
    s_waitcnt lgkmcnt(0)
    v_pk_mul_f16 v111, v111, v80 op_sel:[0,0] op_sel_hi:[1,0]
    v_pk_mul_f16 v140, v140, v80 op_sel:[0,0] op_sel_hi:[1,0]
    v_pk_mul_f16 v141, v141, v80 op_sel:[0,0] op_sel_hi:[1,0]
    v_exp_f32 v14, v14
    v_mfma_f32_16x16x32_bf16 v[60:63], a[164:167], v[224:227], v[60:63]
    buffer_load_dwordx4 v125, s[24:27], s56 offen nt lds
    v_pk_mul_f16 v75, v75, v50 op_sel:[0,1] op_sel_hi:[1,1]
    v_mfma_f32_16x16x32_f16 v[80:83], v[112:115], v[104:107], v[196:199]
    s_add_u32 m0, s54, 24576
    v_exp_f32 v15, v15
    v_mfma_f32_16x16x32_f16 v[80:83], v[140:143], v[150:153], v[80:83]
    s_nop 0
    v_cvt_pk_bf16_f32 v87, v14, v15
    v_cvt_pk_bf16_f32 v30, v60, v61
    v_mfma_f32_16x16x32_f16 v[12:15], v[100:103], v[108:111], v[208:211]
    v_exp_f32 v52, v52
    v_mfma_f32_16x16x32_f16 v[12:15], v[92:95], v[112:115], v[12:15]
    buffer_load_dwordx4 v124, s[24:27], s56 offen nt lds
    v_cvt_pk_bf16_f32 v170, v52, 0
    v_mfma_f32_16x16x32_f16 v[12:15], v[68:71], v[140:143], v[12:15]
    s_cmp_lt_u32 s61, s71
    ds_read_b128 v[116:119], v7 offset:0
    v_cvt_pk_bf16_f32 v31, v62, v63
    v_mfma_f32_16x16x32_f16 v[68:71], v[112:115], v[24:27], v[184:187]
    s_cselect_b32 s15, s61, s12
    ds_read_b128 v[228:231], v6 offset:0
    v_pk_mul_f16 v42, v42, v50 op_sel:[0,1] op_sel_hi:[1,1]
    v_mfma_f32_16x16x32_f16 v[68:71], v[140:143], v[144:147], v[68:71]
    s_cselect_b32 s56, s69, s70
    ds_read_b128 v[104:107], v7 offset:128
    v_mov_b32_dpp v55, v15 quad_perm:[0,1,2,3] row_mask:0x4 bank_mask:0xf
    v_mfma_f32_16x16x32_bf16 v[24:27], a[168:171], v[20:23], 0
    s_add_u32 s56, s56, s15
    ds_read_b128 v[60:63], v6 offset:128
    v_pk_mul_f16 v43, v43, v50 op_sel:[0,1] op_sel_hi:[1,1]
    v_mfma_f32_16x16x32_bf16 v[24:27], a[172:175], v[244:247], v[24:27]
    s_mul_i32 s53, s56, 58255
    buffer_load_dword v28, v126, s[28:31], s72 offen nt
    ds_read_b128 v[92:95], v7 offset:256
    v_mfma_f32_16x16x32_bf16 v[24:27], a[176:179], v[240:243], v[24:27]
    s_lshr_b32 s53, s53, 22
    v_exp_f32 v55, v55
    v_mfma_f32_16x16x32_bf16 v[24:27], a[180:183], v[236:239], v[24:27]
    s_mul_i32 s53, s53, s63
    ds_read_b128 v[48:51], v6 offset:256
    v_cvt_pk_bf16_f32 v55, v55, v55
    v_mfma_f32_16x16x32_bf16 v[24:27], a[184:187], v[232:235], v[24:27]
    s_mul_i32 s56, s56, s62
    ds_write_b16 v131, v55 offset:64
    v_mfma_f32_16x16x32_bf16 v[24:27], a[188:191], v[224:227], v[24:27]
    s_add_u32 s56, s56, s53
    ds_read_b128 v[52:55], v132 offset:48
    v_fma_mix_f32 v12, v56, v72, 0 op_sel:[0,0,0] op_sel_hi:[1,1,0]
    v_mfma_f32_16x16x32_bf16 v[100:103], a[192:195], v[20:23], 0
    s_mul_i32 s4, s15, 112
    ds_read_b128 v[20:23], v132 offset:64
    v_fma_mix_f32 v12, v56, v72, v12 op_sel:[1,1,0] op_sel_hi:[1,1,0]
    v_mfma_f32_16x16x32_bf16 v[100:103], a[196:199], v[244:247], v[100:103]
    s_cmp_ge_u32 s15, 16
    v_exp_f32 v80, v80
    v_mfma_f32_16x16x32_bf16 v[100:103], a[200:203], v[240:243], v[100:103]
    s_cselect_b32 s53, -30464, 0
    v_exp_f32 v81, v81
    v_mfma_f32_16x16x32_bf16 v[100:103], a[204:207], v[236:239], v[100:103]
    s_add_u32 s4, s4, s53
    v_exp_f32 v82, v82
    v_mfma_f32_16x16x32_bf16 v[100:103], a[208:211], v[232:235], v[100:103]
    s_cmp_lt_u32 s15, s73
    v_exp_f32 v83, v83
    v_mfma_f32_16x16x32_bf16 v[100:103], a[212:215], v[224:227], v[100:103]
    s_waitcnt lgkmcnt(4)
    s_cselect_b32 s26, 100270464, 0
    v_cvt_pk_bf16_f32 v168, v80, v81
    v_cvt_pk_bf16_f32 v169, v82, v83
    v_mfma_f32_16x16x32_bf16 v[80:83], v[116:119], a[144:147], 0
    s_cselect_b32 s56, s56, 0
    v_exp_f32 v16, v16
    v_mfma_f32_16x16x32_bf16 v[80:83], v[228:231], a[148:151], v[80:83]
    s_cselect_b32 s4, s4, -1
    v_exp_f32 v17, v17
    v_mfma_f32_16x16x32_bf16 v[80:83], v[104:107], a[152:155], v[80:83]
    s_cselect_b32 s15, s15, 0
    v_exp_f32 v18, v18
    v_mfma_f32_16x16x32_bf16 v[80:83], v[60:63], a[156:159], v[80:83]
    s_cselect_b32 s13, s13, -1
    v_exp_f32 v19, v19
    v_mfma_f32_16x16x32_bf16 v[80:83], v[92:95], a[160:163], v[80:83]
    s_waitcnt lgkmcnt(0)
    s_bitset1_b32 s64, s15
    v_cvt_pk_bf16_f32 v224, v16, v17
    v_cvt_pk_bf16_f32 v225, v18, v19
    v_mfma_f32_16x16x32_bf16 v[80:83], v[48:51], a[164:167], v[80:83]
    s_waitcnt vmcnt(6)
    s_cmp_ge_i32 s65, 2
    v_exp_f32 v36, v36
    v_exp_f32 v37, v37
    s_cselect_b32 s30, 100270464, 0
    v_mfma_f32_16x16x32_bf16 v[16:19], v[116:119], a[168:171], 0
    s_barrier
    v_exp_f32 v38, v38
    v_mfma_f32_16x16x32_bf16 v[16:19], v[228:231], a[172:175], v[16:19]
    s_lshl_b32 s93, s68, 10
    v_exp_f32 v39, v39
    v_mfma_f32_16x16x32_bf16 v[16:19], v[104:107], a[176:179], v[16:19]
    s_mov_b32 s53, s47
    v_cvt_pk_bf16_f32 v226, v36, v37
    v_cvt_pk_bf16_f32 v227, v38, v39
    v_mfma_f32_16x16x32_bf16 v[16:19], v[60:63], a[180:183], v[16:19]
    s_mov_b32 s47, s46
    v_exp_f32 v68, v68
    v_mfma_f32_16x16x32_bf16 v[16:19], v[92:95], a[184:187], v[16:19]
    s_mov_b32 s46, s45
    v_exp_f32 v69, v69
    v_mfma_f32_16x16x32_bf16 v[16:19], v[48:51], a[188:191], v[16:19]
    s_mov_b32 s45, s44
    ds_read_b128 v[236:239], v11 offset:0
    v_cvt_pk_bf16_f32 v24, v24, v25
    v_exp_f32 v70, v70
    v_exp_f32 v71, v71
    v_exp_f32 v45, v45
    v_mfma_f32_16x16x32_bf16 v[36:39], v[116:119], a[192:195], 0
    s_mov_b32 s44, s53
    ds_read_b64 v[116:117], v10 offset:64
    v_cvt_pk_bf16_f32 v25, v26, v27
    v_mfma_f32_16x16x32_bf16 v[36:39], v[228:231], a[196:199], v[36:39]
    s_sub_u32 s48, s44, s46
    ds_read_b128 v[232:235], v11 offset:3072
    v_cvt_pk_bf16_f32 v26, v100, v101
    v_mfma_f32_16x16x32_bf16 v[36:39], v[104:107], a[200:203], v[36:39]
    s_sub_u32 s49, s46, s45
    ds_read_b64 v[118:119], v10 offset:3136
    v_cvt_pk_bf16_f32 v27, v102, v103
    v_mfma_f32_16x16x32_bf16 v[36:39], v[60:63], a[204:207], v[36:39]
    ds_read_b128 v[60:63], v11 offset:6144
    v_cvt_pk_bf16_f32 v0, v80, v81
    v_mfma_f32_16x16x32_bf16 v[36:39], v[92:95], a[208:211], v[36:39]
    ds_read_b64 v[100:101], v10 offset:6208
    v_cvt_pk_bf16_f32 v1, v82, v83
    v_mfma_f32_16x16x32_bf16 v[36:39], v[48:51], a[212:215], v[36:39]
    ds_read_b128 v[80:83], v11 offset:9216
    v_cvt_pk_bf16_f32 v8, v16, v17
    v_mfma_f32_16x16x32_bf16 v[92:95], v[220:223], v[84:87], 0
    ds_read_b64 v[102:103], v10 offset:9280
    v_cvt_pk_bf16_f32 v9, v18, v19
    v_mfma_f32_16x16x32_bf16 v[92:95], v[220:223], v[168:171], v[92:95]
    s_nop 0
    ds_read_b128 v[48:51], v11 offset:12288
    v_cvt_pk_bf16_f32 v4, v36, v37
    v_mfma_f32_16x16x32_f16 v[16:19], v[76:79], v[108:111], v[180:183]
    ds_read_b64 v[104:105], v10 offset:12352
    v_cvt_pk_bf16_f32 v5, v38, v39
    v_mfma_f32_16x16x32_f16 v[16:19], v[152:155], v[138:141], v[16:19]
    ds_read_b128 v[76:79], v11 offset:15360
    v_fma_mix_f32 v12, v57, v73, v12 op_sel:[0,0,0] op_sel_hi:[1,1,0]
    v_mfma_f32_16x16x32_f16 v[36:39], v[32:35], v[108:111], v[176:179]
    ds_read_b64 v[106:107], v10 offset:15424
    v_fma_mix_f32 v12, v57, v73, v12 op_sel:[1,1,0] op_sel_hi:[1,1,0]
    v_mfma_f32_16x16x32_f16 v[36:39], v[146:149], v[138:141], v[36:39]
    ds_read_b128 v[228:231], v11 offset:18432
    v_fma_mix_f32 v12, v58, v74, v12 op_sel:[0,0,0] op_sel_hi:[1,1,0]
    v_mfma_f32_16x16x32_f16 v[32:35], v[112:115], v[108:111], v[172:175]
    ds_read_b64 v[152:153], v10 offset:18496
    v_fma_mix_f32 v12, v58, v74, v12 op_sel:[1,1,0] op_sel_hi:[1,1,0]
    v_mfma_f32_16x16x32_f16 v[32:35], v[140:143], v[138:141], v[32:35]
    s_waitcnt lgkmcnt(8)
    ds_read_b128 v[108:111], v11 offset:21504
    v_fma_mix_f32 v12, v59, v75, v12 op_sel:[0,0,0] op_sel_hi:[1,1,0]
    v_mfma_f32_16x16x32_bf16 v[112:115], v[236:239], v[220:223], 0
    ds_read_b64 v[154:155], v10 offset:21568
    v_fma_mix_f32 v12, v59, v75, v12 op_sel:[1,1,0] op_sel_hi:[1,1,0]
    v_mfma_f32_16x16x32_bf16 v[112:115], v[232:235], v[220:223], v[112:115]
    ds_read_b128 v[140:143], v11 offset:24576
    v_fma_mix_f32 v12, v40, v42, v12 op_sel:[0,0,0] op_sel_hi:[1,1,0]
    v_mfma_f32_16x16x32_bf16 v[112:115], v[60:63], v[220:223], v[112:115]
    s_waitcnt lgkmcnt(8)
    ds_read_b64 v[60:61], v10 offset:24640
    v_fma_mix_f32 v12, v40, v42, v12 op_sel:[1,1,0] op_sel_hi:[1,1,0]
    v_mfma_f32_16x16x32_bf16 v[112:115], v[80:83], v[220:223], v[112:115]
    ds_read_b128 v[80:83], v11 offset:27648
    v_fma_mix_f32 v12, v41, v43, v12 op_sel:[0,0,0] op_sel_hi:[1,1,0]
    v_mfma_f32_16x16x32_bf16 v[112:115], v[116:119], v[220:223], v[112:115]
    ds_read_b64 v[62:63], v10 offset:27712
    v_fma_mix_f32 v12, v41, v43, v12 op_sel:[1,1,0] op_sel_hi:[1,1,0]
    v_mfma_f32_16x16x32_bf16 v[112:115], v[100:103], v[220:223], v[112:115]
    s_add_u32 m0, s67, 0
    ds_read_b128 v[100:103], v11 offset:30720
    v_mov_b32 v3, v12
    v_mfma_f32_16x16x32_bf16 v[116:119], v[48:51], v[220:223], 0
    s_waitcnt lgkmcnt(8)
    ds_read_b64 v[48:49], v10 offset:30784
    v_and_b32 v13, 0xb8000000, v123
    v_mfma_f32_16x16x32_bf16 v[116:119], v[76:79], v[220:223], v[116:119]
    ds_read_b128 v[76:79], v11 offset:33792
    v_mul_f32 v112, 0xbbaaaaab, v112
    v_mfma_f32_16x16x32_bf16 v[116:119], v[228:231], v[220:223], v[116:119]
    s_waitcnt lgkmcnt(8)
    ds_read_b64 v[50:51], v10 offset:33856
    v_mul_f32 v113, 0xbbaaaaab, v113
    v_mfma_f32_16x16x32_bf16 v[116:119], v[108:111], v[220:223], v[116:119]
    ds_read_b128 v[108:111], v7 offset:1536
    v_mul_f32 v114, 0xbbaaaaab, v114
    v_mfma_f32_16x16x32_bf16 v[116:119], v[104:107], v[220:223], v[116:119]
    s_waitcnt lgkmcnt(8)
    ds_read_b128 v[104:107], v6 offset:1536
    v_mul_f32 v115, 0xbbaaaaab, v115
    v_mfma_f32_16x16x32_bf16 v[116:119], v[152:155], v[220:223], v[116:119]
    ds_write_b128 v120, v[112:115] offset:0
    v_mfma_f32_16x16x32_bf16 v[112:115], v[140:143], v[220:223], 0
    s_waitcnt lgkmcnt(7)
    v_rcp_f32 v92, v92
    v_mfma_f32_16x16x32_bf16 v[112:115], v[80:83], v[220:223], v[112:115]
    s_waitcnt lgkmcnt(6)
    v_permlane32_swap_b32 v3, v12
    v_mfma_f32_16x16x32_bf16 v[112:115], v[100:103], v[220:223], v[112:115]
    s_waitcnt lgkmcnt(4)
    ds_read_b128 v[100:103], v7 offset:1664
    v_add_f32 v12, v3, v12
    v_mov_b32 v3, v12
    v_mul_f32 v116, 0xbbaaaaab, v116
    v_mfma_f32_16x16x32_bf16 v[112:115], v[76:79], v[220:223], v[112:115]
    ds_read_b128 v[80:83], v6 offset:1664
    v_mul_f32 v117, 0xbbaaaaab, v117
    v_mfma_f32_16x16x32_bf16 v[112:115], v[60:63], v[220:223], v[112:115]
    s_waitcnt lgkmcnt(4)
    ds_read_b128 v[76:79], v7 offset:1792
    v_mul_f32 v118, 0xbbaaaaab, v118
    v_mfma_f32_16x16x32_bf16 v[112:115], v[48:51], v[220:223], v[112:115]
    ds_read_b128 v[48:51], v6 offset:1792
    v_mul_f32 v119, 0xbbaaaaab, v119
    v_mfma_f32_16x16x32_bf16 v[60:63], v[108:111], a[144:147], 0
    s_waitcnt lgkmcnt(4)
    ds_write_b128 v120, v[116:119] offset:128
    v_mfma_f32_16x16x32_bf16 v[60:63], v[104:107], a[148:151], v[60:63]
    s_waitcnt lgkmcnt(4)
    v_permlane16_swap_b32 v3, v12
    v_add_f32 v12, v3, v12
    v_add_f32 v12, s84, v12
    v_exp_f32 v12, v12
    v_mul_f32 v112, 0xbbaaaaab, v112
    v_cvt_pk_bf16_f32 v12, v12, 0
    v_cmp_gt_u32 vcc, 16, v2
    v_mul_f32 v113, 0xbbaaaaab, v113
    v_mfma_f32_16x16x32_bf16 v[60:63], v[100:103], a[152:155], v[60:63]
    s_waitcnt lgkmcnt(3)
    v_cndmask_b32 v12, 0, v12, vcc
    v_mul_f32 v114, 0xbbaaaaab, v114
    v_mul_f32 v115, 0xbbaaaaab, v115
    v_cmp_ne_u32 s[94:95], 0, v13
    v_mfma_f32_16x16x32_bf16 v[60:63], v[80:83], a[156:159], v[60:63]
    s_waitcnt lgkmcnt(1)
    ds_write_b128 v120, v[112:115] offset:256
    v_mfma_f32_16x16x32_bf16 v[60:63], v[76:79], a[160:163], v[60:63]
    s_barrier
    buffer_load_dwordx4 v128, s[24:27], s56 offen nt lds
    v_add_u32 v15, s93, v129
    v_mfma_f32_16x16x32_bf16 v[60:63], v[48:51], a[164:167], v[60:63]
    s_or_b32 s94, s94, s95
    v_mov_b32 v13, s94
    v_add_u32 v137, s48, v137
    v_mfma_f32_16x16x32_bf16 v[112:115], v[108:111], a[168:171], 0
    s_lshl_b32 s95, s68, 2
    v_mov_b32 v120, s95
    v_add_u32 v136, s48, v136
    v_mfma_f32_16x16x32_bf16 v[112:115], v[104:107], a[172:175], v[112:115]
    s_add_u32 m0, s67, 1024
    v_cvt_pk_bf16_f32 v2, v60, v61
    v_cvt_pk_bf16_f32 v3, v62, v63
    v_mfma_f32_16x16x32_bf16 v[112:115], v[100:103], a[176:179], v[112:115]
    buffer_load_dwordx4 v127, s[24:27], s56 offen nt lds
    v_mfma_f32_16x16x32_bf16 v[112:115], v[80:83], a[180:183], v[112:115]
    s_add_u32 m0, s67, 2048
    v_exp_f32 v16, v16
    v_mfma_f32_16x16x32_bf16 v[112:115], v[76:79], a[184:187], v[112:115]
    buffer_load_dwordx4 v126, s[24:27], s56 offen nt lds
    v_mfma_f32_16x16x32_bf16 v[112:115], v[48:51], a[188:191], v[112:115]
    s_waitcnt lgkmcnt(0)
    s_add_u32 m0, s67, 3072
    v_exp_f32 v17, v17
    v_mfma_f32_16x16x32_bf16 v[60:63], v[0:3], v[84:87], 0
    s_barrier
    buffer_load_dwordx4 v125, s[24:27], s56 offen nt lds
    v_cvt_pk_bf16_f32 v16, v16, v17
    v_mfma_f32_16x16x32_bf16 v[60:63], v[164:167], v[168:171], v[60:63]
    s_add_u32 m0, s67, 4096
    v_cvt_pk_bf16_f32 v10, v112, v113
    v_cvt_pk_bf16_f32 v11, v114, v115
    v_mfma_f32_16x16x32_bf16 v[112:115], v[108:111], a[192:195], 0
    ds_read_b128 v[228:231], v91 offset:24576
    buffer_load_dwordx4 v124, s[24:27], s56 offen nt lds
    v_mfma_f32_16x16x32_bf16 v[112:115], v[104:107], a[196:199], v[112:115]
    ds_read_b64 v[232:233], v90 offset:24640
    v_mul_f32 v60, v60, v92
    v_mfma_f32_16x16x32_bf16 v[112:115], v[100:103], a[200:203], v[112:115]
    ds_read_b128 v[108:111], v121 offset:256
    v_mul_f32 v61, v61, v92
    v_mfma_f32_16x16x32_bf16 v[112:115], v[80:83], a[204:207], v[112:115]
    ds_read_b128 v[100:103], v91 offset:25344
    v_cvt_pk_bf16_f32 v80, v60, v61
    v_mfma_f32_16x16x32_bf16 v[112:115], v[76:79], a[208:211], v[112:115]
    ds_read_b64 v[104:105], v90 offset:25408
    v_mul_f32 v62, v62, v92
    v_mfma_f32_16x16x32_bf16 v[112:115], v[48:51], a[212:215], v[112:115]
    ds_read_b128 v[48:51], v121 offset:320
    v_mul_f32 v63, v63, v92
    v_mfma_f32_16x16x32_bf16 v[76:79], v[8:11], v[84:87], 0
    s_nop 0
    v_exp_f32 v18, v18
    v_mfma_f32_16x16x32_bf16 v[76:79], v[160:163], v[168:171], v[76:79]
    s_nop 0
    v_cvt_pk_bf16_f32 v81, v62, v63
    v_cvt_pk_bf16_f32 v6, v112, v113
    v_mfma_f32_16x16x32_bf16 v[60:63], v[52:55], v[0:3], 0
    s_nop 0
    ds_write_b64 v135, v[80:81] offset:0
    v_mfma_f32_16x16x32_bf16 v[60:63], v[20:23], v[164:167], v[60:63]
    s_nop 0
    v_mul_f32 v76, v76, v92
    v_mul_f32 v77, v77, v92
    v_mfma_f32_16x16x32_bf16 v[116:119], v[52:55], v[8:11], 0
    v_cvt_pk_bf16_f32 v82, v76, v77
    v_mul_f32 v78, v78, v92
    v_mfma_f32_16x16x32_bf16 v[116:119], v[20:23], v[160:163], v[116:119]
    s_waitcnt lgkmcnt(3)
    v_mul_f32 v79, v79, v92
    v_cvt_pk_bf16_f32 v83, v78, v79
    v_mfma_f32_16x16x16_bf16 v[76:79], v[228:229], v[98:99], v[108:111]
    ds_write_b64 v135, v[82:83] offset:8
    v_mfma_f32_16x16x16_bf16 v[80:83], v[230:231], v[98:99], v[108:111]
    s_nop 0
    v_cvt_pk_bf16_f32 v7, v114, v115
    v_mov_b32_dpp v63, v119 quad_perm:[0,1,2,3] row_mask:0x2 bank_mask:0xf
    v_mfma_f32_16x16x16_bf16 v[116:119], v[232:233], v[98:99], v[108:111]
    s_waitcnt lgkmcnt(2)
    s_nop 0
    v_cvt_pk_bf16_f32 v76, v76, v77
    v_accvgpr_write_b32 a224, v76
    v_mfma_f32_16x16x16_bf16 v[112:115], v[100:101], v[98:99], v[48:51]
    ds_write_b32 v120, v13 offset:14848
    v_mfma_f32_16x16x16_bf16 v[108:111], v[102:103], v[98:99], v[48:51]
    v_cvt_pk_bf16_f32 v78, v78, v79
    v_accvgpr_write_b32 a225, v78
    v_mfma_f32_16x16x16_bf16 v[76:79], v[104:105], v[98:99], v[48:51]
    v_cvt_pk_bf16_f32 v80, v80, v81
    v_accvgpr_write_b32 a248, v80
    v_cvt_pk_bf16_f32 v82, v82, v83
    v_mfma_f32_16x16x32_bf16 v[48:51], v[4:7], v[84:87], 0
    v_accvgpr_write_b32 a249, v82
    v_cvt_pk_bf16_f32 v240, v116, v117
    v_mfma_f32_16x16x32_bf16 v[48:51], v[156:159], v[168:171], v[48:51]
    v_cvt_pk_bf16_f32 v168, v68, v69
    v_cvt_pk_bf16_f32 v169, v70, v71
    v_mfma_f32_16x16x32_bf16 v[80:83], v[52:55], v[4:7], 0
    ds_read_b128 v[84:87], v91 offset:49152
    v_cvt_pk_bf16_f32 v170, v45, 0
    v_mfma_f32_16x16x32_bf16 v[80:83], v[20:23], v[156:159], v[80:83]
    s_nop 0
    ds_read_b64 v[88:89], v90 offset:49216
    v_mul_f32 v48, v48, v92
    v_mfma_f32_16x16x32_bf16 v[44:47], v[220:223], v[224:227], 0
    ds_read_b128 v[68:71], v121 offset:5248
    v_mul_f32 v49, v49, v92
    v_mfma_f32_16x16x32_bf16 v[44:47], v[220:223], v[168:171], v[44:47]
    ds_read_b128 v[102:105], v91 offset:49920
    v_cvt_pk_bf16_f32 v96, v48, v49
    v_mfma_f32_16x16x32_bf16 v[20:23], v[0:3], v[224:227], 0
    ds_write_b32 v134, v96 offset:0
    v_mfma_f32_16x16x32_bf16 v[20:23], v[164:167], v[168:171], v[20:23]
    ds_read_b64 v[106:107], v90 offset:49984
    v_mul_f32 v50, v50, v92
    v_mfma_f32_16x16x32_bf16 v[52:55], v[8:11], v[224:227], 0
    ds_read_b128 v[140:143], v121 offset:5312
    v_mul_f32 v51, v51, v92
    v_mfma_f32_16x16x32_bf16 v[52:55], v[160:163], v[168:171], v[52:55]
    ds_read_b128 v[92:95], v91 offset:12288
    v_cvt_pk_bf16_f32 v97, v50, v51
    v_mfma_f32_16x16x32_bf16 v[48:51], v[4:7], v[224:227], 0
    ds_write_b32 v134, v97 offset:4
    v_mfma_f32_16x16x32_bf16 v[48:51], v[156:159], v[168:171], v[48:51]
    ds_read_b64 v[96:97], v90 offset:12352
    v_cvt_pk_bf16_f32 v241, v118, v119
    v_cvt_pk_bf16_f32 v112, v112, v113
    v_accvgpr_write_b32 a226, v112
    v_cvt_pk_bf16_f32 v114, v114, v115
    v_accvgpr_write_b32 a227, v114
    v_cvt_pk_bf16_f32 v108, v108, v109
    v_accvgpr_write_b32 a250, v108
    v_cvt_pk_bf16_f32 v110, v110, v111
    v_accvgpr_write_b32 a251, v110
    v_cvt_pk_bf16_f32 v242, v76, v77
    v_cvt_pk_bf16_f32 v243, v78, v79
    s_waitcnt lgkmcnt(5)
    v_mfma_f32_16x16x16_bf16 v[112:115], v[84:85], v[98:99], v[68:71]
    ds_read_b128 v[76:79], v121 offset:128
    v_mov_b32_dpp v63, v83 quad_perm:[0,1,2,3] row_mask:0x4 bank_mask:0xf
    v_mfma_f32_16x16x16_bf16 v[108:111], v[86:87], v[98:99], v[68:71]
    ds_read_b128 v[84:87], v91 offset:13056
    v_cvt_pk_bf16_f32 v63, v63, v63
    v_mfma_f32_16x16x16_bf16 v[80:83], v[88:89], v[98:99], v[68:71]
    s_waitcnt lgkmcnt(5)
    ds_write_b16 v131, v63
    v_mfma_f32_16x16x16_bf16 v[60:63], v[102:103], v[98:99], v[140:143]
    ds_read_b64 v[88:89], v90 offset:13120
    v_mov_b32 v146, 0
    v_mfma_f32_16x16x16_bf16 v[100:103], v[104:105], v[98:99], v[140:143]
    ds_read_b128 v[116:119], v121 offset:192
    v_mov_b32 v147, 0
    v_mfma_f32_16x16x16_bf16 v[68:71], v[106:107], v[98:99], v[140:143]
    ds_read_b128 v[104:107], v91 offset:61440
    v_mov_b32 v13, 0
    v_add_u32 v120, 0, v29
    v_cvt_pk_bf16_f32 v112, v112, v113
    v_accvgpr_write_b32 a232, v112
    v_cvt_pk_bf16_f32 v114, v114, v115
    v_accvgpr_write_b32 a233, v114
    v_cvt_pk_bf16_f32 v224, v108, v109
    v_cvt_pk_bf16_f32 v225, v110, v111
    v_cvt_pk_bf16_f32 v248, v80, v81
    v_cvt_pk_bf16_f32 v249, v82, v83
    v_cvt_pk_bf16_f32 v60, v60, v61
    v_accvgpr_write_b32 a234, v60
    v_cvt_pk_bf16_f32 v62, v62, v63
    v_accvgpr_write_b32 a235, v62
    s_waitcnt lgkmcnt(5)
    v_mfma_f32_16x16x16_bf16 v[60:63], v[92:93], v[98:99], v[76:79]
    ds_read_b64 v[108:109], v90 offset:61504
    v_cvt_pk_bf16_f32 v226, v100, v101
    v_mfma_f32_16x16x16_bf16 v[112:115], v[94:95], v[98:99], v[76:79]
    ds_read_b128 v[80:83], v121 offset:5376
    v_cvt_pk_bf16_f32 v227, v102, v103
    v_mfma_f32_16x16x16_bf16 v[100:103], v[96:97], v[98:99], v[76:79]
    s_waitcnt lgkmcnt(3)
    ds_read_b128 v[230:233], v91 offset:62208
    v_cvt_pk_bf16_f32 v250, v68, v69
    v_cvt_pk_bf16_f32 v251, v70, v71
    v_cvt_pk_bf16_f32 v60, v60, v61
    v_accvgpr_write_b32 a220, v60
    v_cvt_pk_bf16_f32 v62, v62, v63
    v_mfma_f32_16x16x16_bf16 v[76:79], v[84:85], v[98:99], v[116:119]
    ds_read_b64 v[234:235], v90 offset:62272
    v_accvgpr_write_b32 a221, v62
    v_mfma_f32_16x16x16_bf16 v[68:71], v[86:87], v[98:99], v[116:119]
    ds_read_b128 v[92:95], v121 offset:5440
    v_cvt_pk_bf16_f32 v112, v112, v113
    v_mfma_f32_16x16x16_bf16 v[60:63], v[88:89], v[98:99], v[116:119]
    ds_read_b128 v[84:87], v91 offset:36864
    v_accvgpr_write_b32 a244, v112
    v_cvt_pk_bf16_f32 v114, v114, v115
    v_accvgpr_write_b32 a245, v114
    v_cvt_pk_bf16_f32 v236, v100, v101
    v_cvt_pk_bf16_f32 v237, v102, v103
    v_cvt_pk_bf16_f32 v76, v76, v77
    v_accvgpr_write_b32 a222, v76
    v_cvt_pk_bf16_f32 v78, v78, v79
    v_accvgpr_write_b32 a223, v78
    v_cvt_pk_bf16_f32 v68, v68, v69
    v_accvgpr_write_b32 a246, v68
    v_cvt_pk_bf16_f32 v70, v70, v71
    v_accvgpr_write_b32 a247, v70
    v_cvt_pk_bf16_f32 v238, v60, v61
    s_waitcnt lgkmcnt(4)
    v_mfma_f32_16x16x16_bf16 v[76:79], v[104:105], v[98:99], v[80:83]
    ds_read_b64 v[88:89], v90 offset:36928
    v_cvt_pk_bf16_f32 v239, v62, v63
    v_mfma_f32_16x16x16_bf16 v[68:71], v[106:107], v[98:99], v[80:83]
    ds_read_b128 v[60:63], v121 offset:5120
    v_mfma_f32_16x16x16_bf16 v[104:107], v[108:109], v[98:99], v[80:83]
    s_waitcnt lgkmcnt(3)
    s_nop 0
    ds_read_b128 v[112:115], v91 offset:37632
    v_cvt_pk_bf16_f32 v76, v76, v77
    v_accvgpr_write_b32 a236, v76
    v_cvt_pk_bf16_f32 v78, v78, v79
    v_accvgpr_write_b32 a237, v78
    v_cvt_pk_bf16_f32 v228, v68, v69
    v_mfma_f32_16x16x16_bf16 v[80:83], v[230:231], v[98:99], v[92:95]
    ds_read_b64 v[116:117], v90 offset:37696
    v_cvt_pk_bf16_f32 v229, v70, v71
    v_mfma_f32_16x16x16_bf16 v[76:79], v[232:233], v[98:99], v[92:95]
    ds_read_b128 v[108:111], v121 offset:5184
    v_cvt_pk_bf16_f32 v252, v104, v105
    v_mfma_f32_16x16x16_bf16 v[68:71], v[234:235], v[98:99], v[92:95]
    ds_read_b128 v[100:103], v91 offset:0
    v_cvt_pk_bf16_f32 v253, v106, v107
    v_cvt_pk_bf16_f32 v80, v80, v81
    v_accvgpr_write_b32 a238, v80
    v_cvt_pk_bf16_f32 v82, v82, v83
    v_accvgpr_write_b32 a239, v82
    v_cvt_pk_bf16_f32 v230, v76, v77
    v_cvt_pk_bf16_f32 v231, v78, v79
    v_cvt_pk_bf16_f32 v254, v68, v69
    v_cvt_pk_bf16_f32 v255, v70, v71
    ds_read_b64 v[104:105], v90 offset:64
    v_rcp_f32 v44, v44
    s_waitcnt lgkmcnt(5)
    v_mfma_f32_16x16x16_bf16 v[80:83], v[84:85], v[98:99], v[60:63]
    ds_read_b128 v[68:71], v121 offset:0
    v_mul_f32 v20, v20, v44
    v_mfma_f32_16x16x16_bf16 v[76:79], v[86:87], v[98:99], v[60:63]
    ds_read_b128 v[92:95], v91 offset:768
    v_mul_f32 v21, v21, v44
    v_mfma_f32_16x16x16_bf16 v[84:87], v[88:89], v[98:99], v[60:63]
    s_waitcnt lgkmcnt(4)
    ds_read_b64 v[96:97], v90 offset:832
    v_cvt_pk_bf16_f32 v80, v80, v81
    v_accvgpr_write_b32 a228, v80
    v_cvt_pk_bf16_f32 v82, v82, v83
    v_accvgpr_write_b32 a229, v82
    v_cvt_pk_bf16_f32 v76, v76, v77
    v_mfma_f32_16x16x16_bf16 v[80:83], v[112:113], v[98:99], v[108:111]
    ds_read_b128 v[88:91], v121 offset:64
    v_accvgpr_write_b32 a252, v76
    v_mfma_f32_16x16x16_bf16 v[60:63], v[114:115], v[98:99], v[108:111]
    v_cvt_pk_bf16_f32 v78, v78, v79
    v_accvgpr_write_b32 a253, v78
    v_mfma_f32_16x16x16_bf16 v[76:79], v[116:117], v[98:99], v[108:111]
    v_cvt_pk_bf16_f32 v244, v84, v85
    v_cvt_pk_bf16_f32 v245, v86, v87
    v_cvt_pk_bf16_f32 v80, v80, v81
    v_accvgpr_write_b32 a230, v80
    v_cvt_pk_bf16_f32 v82, v82, v83
    v_accvgpr_write_b32 a231, v82
    v_cvt_pk_bf16_f32 v60, v60, v61
    v_accvgpr_write_b32 a254, v60
    v_cvt_pk_bf16_f32 v62, v62, v63
    v_accvgpr_write_b32 a255, v62
    v_cvt_pk_bf16_f32 v246, v76, v77
    s_waitcnt lgkmcnt(3)
    v_mfma_f32_16x16x16_bf16 v[60:63], v[100:101], v[98:99], v[68:71]
    v_cvt_pk_bf16_f32 v247, v78, v79
    v_cvt_pk_bf16_f32 v20, v20, v21
    v_mfma_f32_16x16x16_bf16 v[84:87], v[102:103], v[98:99], v[68:71]
    s_waitcnt vmcnt(5) lgkmcnt(1)
    ds_write_b32 v135, v20 offset:1536
    v_mfma_f32_16x16x16_bf16 v[80:83], v[104:105], v[98:99], v[68:71]
    s_waitcnt lgkmcnt(1)
    s_barrier
    v_cvt_pk_bf16_f32 v60, v60, v61
    v_accvgpr_write_b32 a216, v60
    v_cvt_pk_bf16_f32 v62, v62, v63
    v_accvgpr_write_b32 a217, v62
    v_cvt_pk_bf16_f32 v84, v84, v85
    v_accvgpr_write_b32 a240, v84
    v_mfma_f32_16x16x16_bf16 v[76:79], v[92:93], v[98:99], v[88:91]
    ds_read_b128 v[60:63], v122 offset:14848
    v_cvt_pk_bf16_f32 v86, v86, v87
    v_mfma_f32_16x16x16_bf16 v[68:71], v[94:95], v[98:99], v[88:91]
    ds_write_b128 v15, v[64:67] offset:6144
    v_mfma_f32_16x16x16_bf16 v[64:67], v[96:97], v[98:99], v[88:91]
    v_accvgpr_write_b32 a241, v86
    v_cvt_pk_bf16_f32 v232, v80, v81
    v_cvt_pk_bf16_f32 v233, v82, v83
    v_cvt_pk_bf16_f32 v76, v76, v77
    v_accvgpr_write_b32 a218, v76
    v_cvt_pk_bf16_f32 v78, v78, v79
    ds_write_b128 v120, v[72:75]
    v_accvgpr_write_b32 a219, v78
    v_cvt_pk_bf16_f32 v68, v68, v69
    v_accvgpr_write_b32 a242, v68
    v_cvt_pk_bf16_f32 v70, v70, v71
    v_accvgpr_write_b32 a243, v70
    v_cvt_pk_bf16_f32 v234, v64, v65
    v_cvt_pk_bf16_f32 v235, v66, v67
    v_mul_f32 v22, v22, v44
    ds_write2_b64 v120, v[146:147], v[146:147] offset0:2 offset1:3
    s_waitcnt lgkmcnt(2)
    v_or3_b32 v60, v60, v61, v62
    v_or_b32 v60, v60, v63
    v_mul_f32 v23, v23, v44
    v_readfirstlane_b32 s75, v60
    v_cvt_pk_bf16_f32 v21, v22, v23
    v_mul_f32 v52, v52, v44
    v_mul_f32 v53, v53, v44
    v_cvt_pk_bf16_f32 v22, v52, v53
    ds_write_b128 v120, v[56:59] offset:32
    v_mul_f32 v54, v54, v44
    v_mul_f32 v55, v55, v44
    v_cvt_pk_bf16_f32 v23, v54, v55
    v_mul_f32 v48, v48, v44
    v_mul_f32 v49, v49, v44
    v_cvt_pk_bf16_f32 v154, v48, v49
    v_mul_f32 v50, v50, v44
    v_mul_f32 v51, v51, v44
    ds_write2_b64 v120, v[42:43], v[146:147] offset0:6 offset1:7
    v_cvt_pk_bf16_f32 v155, v50, v51
    v_exp_f32 v19, v19
    v_exp_f32 v36, v36
    v_cvt_pk_bf16_f32 v17, v18, v19
    v_exp_f32 v37, v37
    ds_write2_b64 v120, v[146:147], v[40:41] offset0:8 offset1:9
    v_exp_f32 v38, v38
    v_exp_f32 v39, v39
    v_cvt_pk_bf16_f32 v18, v36, v37
    v_cvt_pk_bf16_f32 v19, v38, v39
    v_exp_f32 v32, v32
    ds_write_b64 v120, v[12:13] offset:88
    v_exp_f32 v33, v33
    v_exp_f32 v34, v34
    v_exp_f32 v35, v35
    ds_write_b64 v29, v[30:31] offset:80
    v_cvt_pk_bf16_f32 v168, v32, v33
    v_cvt_pk_bf16_f32 v169, v34, v35
    v_exp_f32 v14, v14
    ds_write_b128 v29, v[24:27] offset:96
    v_cvt_pk_bf16_f32 v170, v14, 0
    v_mfma_f32_16x16x32_bf16 v[12:15], v[220:223], v[16:19], 0
    s_nop 0
    v_mfma_f32_16x16x32_bf16 v[12:15], v[220:223], v[168:171], v[12:15]
    ds_read_b128 v[146:149], v137 offset:0
    v_mfma_f32_16x16x32_bf16 v[72:75], v[0:3], v[16:19], 0
    ds_read_b128 v[88:91], v136 offset:0
    v_mfma_f32_16x16x32_bf16 v[72:75], v[164:167], v[168:171], v[72:75]
    ds_read_b128 v[108:111], v137 offset:128
    v_mfma_f32_16x16x32_bf16 v[0:3], v[8:11], v[16:19], 0
    ds_read_b128 v[116:119], v136 offset:128
    v_mfma_f32_16x16x32_bf16 v[0:3], v[160:163], v[168:171], v[0:3]
    ds_read_b128 v[60:63], v137 offset:256
    v_mfma_f32_16x16x32_bf16 v[8:11], v[4:7], v[16:19], 0
    ds_read_b128 v[64:67], v136 offset:256
    v_mfma_f32_16x16x32_bf16 v[8:11], v[156:159], v[168:171], v[8:11]
    ds_read_b128 v[68:71], v137 offset:1536
    ds_read_b128 v[100:103], v136 offset:1536
    ds_read_b128 v[80:83], v137 offset:1664
    s_waitcnt lgkmcnt(8)
    v_mfma_f32_16x16x32_bf16 v[30:33], a[0:3], v[146:149], 0
    ds_read_b128 v[76:79], v136 offset:1792
    s_waitcnt lgkmcnt(0)
    s_cmp_lg_u32 s75, 0
    s_cbranch_scc0 L_loopF0
    s_branch L_slow
L_atomF0:
    v_mov_b32 v122, 0x800000
    buffer_atomic_add v122, v129, s[8:11], 0 offen sc0 sc1
    s_branch L_atomrF0
.p2align 6
L_loopF0:
    v_mfma_f32_16x16x32_bf16 v[30:33], a[4:7], v[88:91], v[30:33]
    ds_write_b32 v135, v21 offset:1540
    v_mfma_f32_16x16x32_bf16 v[30:33], a[8:11], v[108:111], v[30:33]
    v_rcp_f32 v12, v12
    v_mfma_f32_16x16x32_bf16 v[30:33], a[12:15], v[116:119], v[30:33]
    v_mul_f32 v72, v72, v12
    v_mul_f32 v73, v73, v12
    v_mfma_f32_16x16x32_bf16 v[30:33], a[16:19], v[60:63], v[30:33]
    v_cvt_pk_bf16_f32 v4, v72, v73
    v_mul_f32 v74, v74, v12
    v_mfma_f32_16x16x32_bf16 v[30:33], a[20:23], v[64:67], v[30:33]
    ds_write_b64 v135, v[22:23] offset:1544
    v_mfma_f32_16x16x32_bf16 v[20:23], v[146:149], a[168:171], 0
    v_mul_f32 v75, v75, v12
    v_cvt_pk_bf16_f32 v5, v74, v75
    v_mfma_f32_16x16x32_bf16 v[20:23], v[88:91], a[172:175], v[20:23]
    v_mul_f32 v0, v0, v12
    v_mul_f32 v1, v1, v12
    v_mfma_f32_16x16x32_bf16 v[20:23], v[108:111], a[176:179], v[20:23]
    ds_read_b128 v[72:75], v136 offset:1664
    v_cvt_pk_bf16_f32 v6, v0, v1
    v_mfma_f32_16x16x32_bf16 v[20:23], v[116:119], a[180:183], v[20:23]
    v_mul_f32 v2, v2, v12
    v_mul_f32 v3, v3, v12
    v_mfma_f32_16x16x32_bf16 v[20:23], v[60:63], a[184:187], v[20:23]
    v_cvt_pk_bf16_f32 v7, v2, v3
    v_mul_f32 v8, v8, v12
    v_mfma_f32_16x16x32_bf16 v[20:23], v[64:67], a[188:191], v[20:23]
    ds_read_b128 v[112:115], v137 offset:1792
    v_mul_f32 v9, v9, v12
    v_mfma_f32_16x16x32_bf16 v[0:3], a[120:123], v[146:149], 0
    v_cvt_pk_bf16_f32 v152, v8, v9
    v_mul_f32 v10, v10, v12
    v_mfma_f32_16x16x32_bf16 v[0:3], a[124:127], v[88:91], v[0:3]
    v_mul_f32 v11, v11, v12
    v_cvt_pk_bf16_f32 v153, v10, v11
    v_mfma_f32_16x16x32_bf16 v[0:3], a[128:131], v[108:111], v[0:3]
    v_fmac_f32 v28, v39, v39
    v_fmac_f32 v28, v96, v96
    v_mfma_f32_16x16x32_bf16 v[0:3], a[132:135], v[116:119], v[0:3]
    ds_write_b64 v134, v[154:155] offset:1536
    v_mfma_f32_16x16x32_bf16 v[0:3], a[136:139], v[60:63], v[0:3]
    v_fmac_f32 v28, v97, v97
    v_fmac_f32 v28, v98, v98
    v_mfma_f32_16x16x32_bf16 v[0:3], a[140:143], v[64:67], v[0:3]
    v_fmac_f32 v28, v99, v99
    v_fma_f32 v29, v56, v56, s42
    v_mfma_f32_16x16x32_bf16 v[12:15], a[48:51], v[146:149], 0
    v_fmac_f32 v29, v57, v57
    v_fmac_f32 v29, v58, v58
    v_mfma_f32_16x16x32_bf16 v[12:15], a[52:55], v[88:91], v[12:15]
    ds_write_b64 v135, v[4:5] offset:3072
    v_mfma_f32_16x16x32_bf16 v[12:15], a[56:59], v[108:111], v[12:15]
    v_fmac_f32 v29, v59, v59
    v_fmac_f32 v29, v140, v140
    v_mfma_f32_16x16x32_bf16 v[12:15], a[60:63], v[116:119], v[12:15]
    v_fmac_f32 v29, v141, v141
    v_fmac_f32 v29, v142, v142
    v_mfma_f32_16x16x32_bf16 v[12:15], a[64:67], v[60:63], v[12:15]
    v_fmac_f32 v29, v143, v143
    v_fmac_f32 v29, v104, v104
    v_mfma_f32_16x16x32_bf16 v[12:15], a[68:71], v[64:67], v[12:15]
    ds_write_b64 v135, v[6:7] offset:3080
    v_mfma_f32_16x16x32_bf16 v[4:7], a[24:27], v[146:149], 0
    v_fmac_f32 v29, v105, v105
    v_fmac_f32 v29, v106, v106
    v_mfma_f32_16x16x32_bf16 v[4:7], a[28:31], v[88:91], v[4:7]
    v_fmac_f32 v29, v107, v107
    v_fma_f32 v154, v52, v52, s42
    v_mfma_f32_16x16x32_bf16 v[4:7], a[32:35], v[108:111], v[4:7]
    v_fmac_f32 v154, v53, v53
    v_fmac_f32 v154, v54, v54
    v_mfma_f32_16x16x32_bf16 v[4:7], a[36:39], v[116:119], v[4:7]
    ds_write_b32 v134, v152 offset:3072
    v_mfma_f32_16x16x32_bf16 v[4:7], a[40:43], v[60:63], v[4:7]
    v_fmac_f32 v154, v55, v55
    v_fmac_f32 v154, v84, v84
    v_mfma_f32_16x16x32_bf16 v[4:7], a[44:47], v[64:67], v[4:7]
    v_fmac_f32 v154, v85, v85
    v_fmac_f32 v154, v86, v86
    v_mfma_f32_16x16x32_bf16 v[8:11], v[146:149], a[192:195], 0
    v_fmac_f32 v154, v87, v87
    v_fmac_f32 v154, v48, v48
    v_mfma_f32_16x16x32_bf16 v[8:11], v[88:91], a[196:199], v[8:11]
    s_waitcnt vmcnt(10)
    ds_write_b32 v134, v153 offset:3076
    v_mfma_f32_16x16x32_bf16 v[8:11], v[108:111], a[200:203], v[8:11]
    v_fmac_f32 v154, v49, v49
    v_fmac_f32 v154, v50, v50
    v_mfma_f32_16x16x32_bf16 v[8:11], v[116:119], a[204:207], v[8:11]
    v_fmac_f32 v154, v51, v51
    v_cvt_pk_bf16_f32 v28, v28, v29
    v_mfma_f32_16x16x32_bf16 v[8:11], v[60:63], a[208:211], v[8:11]
    v_cvt_pk_bf16_f32 v29, v154, v122
    v_add_u32 v135, s49, v135
    v_mfma_f32_16x16x32_bf16 v[8:11], v[64:67], a[212:215], v[8:11]
    ds_write_b64 v130, v[28:29]
    v_mfma_f32_16x16x32_bf16 v[40:43], a[72:75], v[146:149], 0
    v_add_u32 v134, s49, v134
    v_cvt_pk_f16_f32 v28, v30, v31
    v_mfma_f32_16x16x32_bf16 v[40:43], a[76:79], v[88:91], v[40:43]
    v_cvt_pk_f16_f32 v29, v32, v33
    v_pk_fma_f16 v32, v28, v28, s39
    v_mfma_f32_16x16x32_bf16 v[40:43], a[80:83], v[108:111], v[40:43]
    v_pk_fmac_f16 v32, v29, v29
    v_cvt_pk_f16_f32 v154, v0, v1
    v_mfma_f32_16x16x32_bf16 v[40:43], a[84:87], v[116:119], v[40:43]
    v_cvt_pk_f16_f32 v155, v2, v3
    v_cvt_pk_f16_f32 v30, v4, v5
    v_mfma_f32_16x16x32_bf16 v[40:43], a[88:91], v[60:63], v[40:43]
    v_cvt_pk_f16_f32 v31, v6, v7
    v_pk_fmac_f16 v32, v30, v30
    v_mfma_f32_16x16x32_bf16 v[40:43], a[92:95], v[64:67], v[40:43]
    v_pk_fmac_f16 v32, v31, v31
    v_cvt_pk_bf16_f32 v4, v8, v9
    v_mfma_f32_16x16x32_bf16 v[0:3], a[96:99], v[146:149], 0
    v_cvt_pk_bf16_f32 v5, v10, v11
    v_cvt_pk_f16_f32 v152, v12, v13
    v_mfma_f32_16x16x32_bf16 v[0:3], a[100:103], v[88:91], v[0:3]
    s_waitcnt lgkmcnt(0)
    v_cvt_pk_f16_f32 v153, v14, v15
    v_pk_fmac_f16 v32, v152, v152
    v_mfma_f32_16x16x32_bf16 v[0:3], a[104:107], v[108:111], v[0:3]
    s_barrier
    ds_read_b128 v[8:11], v129 offset:0
    v_pk_fmac_f16 v32, v153, v153
    v_mfma_f32_16x16x32_bf16 v[0:3], a[108:111], v[116:119], v[0:3]
    ds_read_b128 v[44:47], v129 offset:1024
    v_cvt_pk_f16_f32 v12, v40, v41
    v_mfma_f32_16x16x32_bf16 v[0:3], a[112:115], v[60:63], v[0:3]
    v_cvt_pk_f16_f32 v13, v42, v43
    v_pk_fma_f16 v33, v12, v12, s39
    v_mfma_f32_16x16x32_bf16 v[0:3], a[116:119], v[64:67], v[0:3]
    v_pk_fmac_f16 v33, v13, v13
    s_nop 0
    v_mfma_f32_16x16x32_bf16 v[40:43], v[146:149], a[144:147], 0
    s_nop 2
    v_mfma_f32_16x16x32_bf16 v[40:43], v[88:91], a[148:151], v[40:43]
    s_nop 0
    v_cvt_pk_f16_f32 v14, v0, v1
    v_cvt_pk_f16_f32 v15, v2, v3
    v_mfma_f32_16x16x32_bf16 v[40:43], v[108:111], a[152:155], v[40:43]
    v_pk_fmac_f16 v33, v14, v14
    v_pk_fmac_f16 v33, v15, v15
    v_mfma_f32_16x16x32_bf16 v[40:43], v[116:119], a[156:159], v[40:43]
    v_pk_fmac_f16 v33, v154, v154
    v_pk_fmac_f16 v33, v155, v155
    v_mfma_f32_16x16x32_bf16 v[40:43], v[60:63], a[160:163], v[40:43]
    v_mfma_f32_16x16x32_bf16 v[40:43], v[64:67], a[164:167], v[40:43]
    s_waitcnt lgkmcnt(1)
    v_readfirstlane_b32 s12, v9
    v_mfma_f32_16x16x32_bf16 v[88:91], v[216:219], v[8:11], 0
    s_waitcnt lgkmcnt(0)
    s_nop 1
    v_mfma_f32_16x16x32_bf16 v[88:91], v[216:219], v[44:47], v[88:91]
    s_lshr_b32 s12, s12, 23
    v_cvt_pk_bf16_f32 v0, v40, v41
    v_cvt_pk_bf16_f32 v1, v42, v43
    v_mfma_f32_16x16x32_bf16 v[60:63], a[24:27], v[68:71], 0
    s_nop 1
    v_mfma_f32_16x16x32_bf16 v[60:63], a[28:31], v[100:103], v[60:63]
    s_nop 0
    v_rsq_f32 v88, v88
    v_mfma_f32_16x16x32_bf16 v[60:63], a[32:35], v[80:83], v[60:63]
    v_rsq_f32 v89, v89
    v_mfma_f32_16x16x32_bf16 v[60:63], a[36:39], v[72:75], v[60:63]
    v_rsq_f32 v90, v90
    v_mfma_f32_16x16x32_bf16 v[60:63], a[40:43], v[112:115], v[60:63]
    v_mul_f32 v88, s43, v88
    v_mul_f32 v89, s43, v89
    v_mfma_f32_16x16x32_bf16 v[60:63], a[44:47], v[76:79], v[60:63]
    v_mul_f32 v90, s43, v90
    v_mul_f32 v56, v56, v89
    v_mfma_f32_16x16x32_bf16 v[40:43], a[96:99], v[68:71], 0
    v_mul_f32 v57, v57, v89
    v_cvt_pk_bf16_f32 v44, v56, v57
    v_mfma_f32_16x16x32_bf16 v[40:43], a[100:103], v[100:103], v[40:43]
    ds_write_b32 v135, v44 offset:1536
    v_mfma_f32_16x16x32_bf16 v[40:43], a[104:107], v[80:83], v[40:43]
    v_mul_f32 v58, v58, v89
    v_mul_f32 v59, v59, v89
    v_mfma_f32_16x16x32_bf16 v[40:43], a[108:111], v[72:75], v[40:43]
    v_cvt_pk_bf16_f32 v45, v58, v59
    v_mul_f32 v140, v140, v89
    v_mfma_f32_16x16x32_bf16 v[40:43], a[112:115], v[112:115], v[40:43]
    v_mul_f32 v141, v141, v89
    v_cvt_pk_bf16_f32 v46, v140, v141
    v_mfma_f32_16x16x32_bf16 v[40:43], a[116:119], v[76:79], v[40:43]
    s_nop 0
    ds_write_b32 v135, v45 offset:1540
    v_mfma_f32_16x16x32_bf16 v[146:149], v[68:71], a[168:171], 0
    s_nop 0
    v_mul_f32 v142, v142, v89
    v_mul_f32 v143, v143, v89
    v_mfma_f32_16x16x32_bf16 v[146:149], v[100:103], a[172:175], v[146:149]
    s_nop 0
    v_cvt_pk_f16_f32 v10, v40, v41
    v_cvt_pk_f16_f32 v11, v42, v43
    v_mfma_f32_16x16x32_bf16 v[146:149], v[80:83], a[176:179], v[146:149]
    v_cvt_pk_bf16_f32 v47, v142, v143
    v_mul_f32 v104, v104, v89
    v_mfma_f32_16x16x32_bf16 v[146:149], v[72:75], a[180:183], v[146:149]
    ds_write_b64 v135, v[46:47] offset:1544
    v_mfma_f32_16x16x32_bf16 v[146:149], v[112:115], a[184:187], v[146:149]
    s_sub_u32 s50, s45, s44
    v_mul_f32 v105, v105, v89
    v_cvt_pk_bf16_f32 v8, v104, v105
    v_mfma_f32_16x16x32_bf16 v[146:149], v[76:79], a[188:191], v[146:149]
    s_sub_u32 s51, s46, s47
    v_mul_f32 v106, v106, v89
    v_mul_f32 v107, v107, v89
    v_mfma_f32_16x16x32_bf16 v[40:43], a[48:51], v[68:71], 0
    s_mov_b32 s60, s59
    v_cvt_pk_bf16_f32 v9, v106, v107
    v_mul_f32 v92, v92, v88
    v_mfma_f32_16x16x32_bf16 v[40:43], a[52:55], v[100:103], v[40:43]
    s_mov_b32 s59, s58
    ds_write_b32 v134, v9 offset:1540
    v_mfma_f32_16x16x32_bf16 v[40:43], a[56:59], v[80:83], v[40:43]
    s_mov_b32 s58, s57
    v_cvt_pk_bf16_f32 v26, v146, v147
    v_cvt_pk_bf16_f32 v27, v148, v149
    v_mfma_f32_16x16x32_bf16 v[40:43], a[60:63], v[72:75], v[40:43]
    s_mov_b32 s57, s56
    v_mul_f32 v93, v93, v88
    v_cvt_pk_bf16_f32 v16, v92, v93
    v_mfma_f32_16x16x32_bf16 v[40:43], a[64:67], v[112:115], v[40:43]
    s_mov_b32 s7, s6
    v_mul_f32 v94, v94, v88
    v_mul_f32 v95, v95, v88
    v_mfma_f32_16x16x32_bf16 v[40:43], a[68:71], v[76:79], v[40:43]
    s_mov_b32 s6, s5
    ds_write_b32 v134, v8 offset:1536
    v_mfma_f32_16x16x32_bf16 v[64:67], a[72:75], v[68:71], 0
    s_mov_b32 s5, s4
    v_cvt_pk_bf16_f32 v17, v94, v95
    v_mul_f32 v36, v36, v88
    v_mfma_f32_16x16x32_bf16 v[64:67], a[76:79], v[100:103], v[64:67]
    s_sub_u32 s14, s6, s7
    v_cvt_pk_f16_f32 v146, v40, v41
    v_cvt_pk_f16_f32 v147, v42, v43
    v_mfma_f32_16x16x32_bf16 v[64:67], a[80:83], v[80:83], v[64:67]
    s_add_u32 s61, s61, 1
    v_mul_f32 v37, v37, v88
    v_cvt_pk_bf16_f32 v18, v36, v37
    v_mfma_f32_16x16x32_bf16 v[64:67], a[84:87], v[72:75], v[64:67]
    s_add_u32 s12, s12, 20
    ds_write_b64 v135, v[16:17] offset:0
    v_mfma_f32_16x16x32_bf16 v[64:67], a[88:91], v[112:115], v[64:67]
    s_max_u32 s12, s12, s61
    v_mul_f32 v38, v38, v88
    v_mul_f32 v39, v39, v88
    v_mfma_f32_16x16x32_bf16 v[64:67], a[92:95], v[76:79], v[64:67]
    s_cmp_lt_u32 s61, s71
    v_cvt_pk_bf16_f32 v19, v38, v39
    v_mul_f32 v96, v96, v88
    v_mfma_f32_16x16x32_bf16 v[92:95], a[120:123], v[68:71], 0
    s_cselect_b32 s15, s61, s12
    ds_read_b128 v[40:43], v136 offset:3072
    v_mul_f32 v97, v97, v88
    v_mfma_f32_16x16x32_bf16 v[92:95], a[124:127], v[100:103], v[92:95]
    s_cselect_b32 s56, s69, s70
    ds_read_b128 v[44:47], v136 offset:3200
    v_cvt_pk_bf16_f32 v2, v96, v97
    v_mfma_f32_16x16x32_bf16 v[92:95], a[128:131], v[80:83], v[92:95]
    s_add_u32 s56, s56, s15
    v_mul_f32 v98, v98, v88
    v_mul_f32 v99, v99, v88
    v_mfma_f32_16x16x32_bf16 v[92:95], a[132:135], v[72:75], v[92:95]
    s_mul_i32 s53, s56, 58255
    v_cvt_pk_bf16_f32 v3, v98, v99
    v_cvt_pk_f16_f32 v8, v64, v65
    v_mfma_f32_16x16x32_bf16 v[92:95], a[136:139], v[112:115], v[92:95]
    s_lshr_b32 s53, s53, 22
    ds_read_b128 v[36:39], v136 offset:3328
    v_cvt_pk_f16_f32 v9, v66, v67
    v_mfma_f32_16x16x32_bf16 v[92:95], a[140:143], v[76:79], v[92:95]
    s_mul_i32 s53, s53, s63
    v_pk_fma_f16 v35, v8, v8, s39
    v_pk_fmac_f16 v35, v9, v9
    v_mfma_f32_16x16x32_bf16 v[64:67], v[68:71], a[144:147], 0
    s_mul_i32 s56, s56, s62
    v_pk_fmac_f16 v35, v10, v10
    v_pk_fmac_f16 v35, v11, v11
    v_mfma_f32_16x16x32_bf16 v[64:67], v[100:103], a[148:151], v[64:67]
    s_add_u32 s56, s56, s53
    v_cvt_pk_f16_f32 v148, v92, v93
    v_cvt_pk_f16_f32 v149, v94, v95
    v_mfma_f32_16x16x32_bf16 v[64:67], v[80:83], a[152:155], v[64:67]
    s_mul_i32 s4, s15, 112
    ds_write_b64 v135, v[18:19] offset:8
    v_mfma_f32_16x16x32_bf16 v[64:67], v[72:75], a[156:159], v[64:67]
    s_cmp_ge_u32 s15, 16
    v_pk_fmac_f16 v35, v148, v148
    v_pk_fmac_f16 v35, v149, v149
    v_mfma_f32_16x16x32_bf16 v[64:67], v[112:115], a[160:163], v[64:67]
    s_cselect_b32 s53, -30464, 0
    v_cvt_pk_f16_f32 v18, v60, v61
    v_cvt_pk_f16_f32 v19, v62, v63
    v_mfma_f32_16x16x32_bf16 v[64:67], v[76:79], a[164:167], v[64:67]
    s_add_u32 s4, s4, s53
    v_mul_f32 v52, v52, v90
    v_mul_f32 v53, v53, v90
    v_mfma_f32_16x16x32_bf16 v[92:95], a[0:3], v[68:71], 0
    s_cmp_lt_u32 s15, s73
    ds_write_b64 v134, v[2:3] offset:0
    v_mfma_f32_16x16x32_bf16 v[92:95], a[4:7], v[100:103], v[92:95]
    s_cselect_b32 s26, 100270464, 0
    v_cvt_pk_bf16_f32 v2, v64, v65
    v_cvt_pk_bf16_f32 v3, v66, v67
    v_mfma_f32_16x16x32_bf16 v[92:95], a[8:11], v[80:83], v[92:95]
    s_cselect_b32 s56, s56, 0
    v_cvt_pk_bf16_f32 v104, v52, v53
    v_mul_f32 v54, v54, v90
    v_mfma_f32_16x16x32_bf16 v[92:95], a[12:15], v[72:75], v[92:95]
    s_cselect_b32 s4, s4, -1
    ds_read_b128 v[60:63], v137 offset:3072
    v_mul_f32 v55, v55, v90
    v_mfma_f32_16x16x32_bf16 v[92:95], a[16:19], v[112:115], v[92:95]
    s_cselect_b32 s15, s15, 0
    ds_read_b128 v[64:67], v137 offset:3200
    v_cvt_pk_bf16_f32 v105, v54, v55
    v_mfma_f32_16x16x32_bf16 v[92:95], a[20:23], v[76:79], v[92:95]
    s_cselect_b32 s13, s13, -1
    ds_read_b128 v[52:55], v137 offset:3328
    v_mul_f32 v84, v84, v90
    v_mfma_f32_16x16x32_bf16 v[56:59], v[68:71], a[192:195], 0
    s_bitset1_b32 s64, s15
    v_mul_f32 v85, v85, v90
    v_cvt_pk_bf16_f32 v106, v84, v85
    v_mfma_f32_16x16x32_bf16 v[56:59], v[100:103], a[196:199], v[56:59]
    s_add_u32 s65, s65, 1
    v_cvt_pk_f16_f32 v16, v92, v93
    v_cvt_pk_f16_f32 v17, v94, v95
    v_mfma_f32_16x16x32_bf16 v[56:59], v[80:83], a[200:203], v[56:59]
    s_cmp_ge_i32 s65, 2
    v_pk_fma_f16 v34, v16, v16, s39
    v_pk_fmac_f16 v34, v17, v17
    v_mfma_f32_16x16x32_bf16 v[56:59], v[72:75], a[204:207], v[56:59]
    s_cselect_b32 s30, 100270464, 0
    ds_write_b64 v135, v[104:105] offset:3072
    v_mfma_f32_16x16x32_bf16 v[56:59], v[112:115], a[208:211], v[56:59]
    s_add_u32 s67, s46, s54
    v_pk_fmac_f16 v34, v18, v18
    v_pk_fmac_f16 v34, v19, v19
    v_mfma_f32_16x16x32_bf16 v[56:59], v[76:79], a[212:215], v[56:59]
    s_waitcnt lgkmcnt(3)
    v_pk_fmac_f16 v34, v146, v146
    v_pk_fmac_f16 v34, v147, v147
    v_mfma_f32_16x16x32_bf16 v[80:83], a[72:75], v[60:63], 0
    s_add_u32 m0, s67, 0
    v_mul_f32 v86, v86, v90
    v_mul_f32 v87, v87, v90
    v_mfma_f32_16x16x32_bf16 v[80:83], a[76:79], v[40:43], v[80:83]
    s_waitcnt lgkmcnt(1)
    ds_write_b32 v135, v106 offset:3080
    v_mfma_f32_16x16x32_bf16 v[80:83], a[80:83], v[64:67], v[80:83]
    v_cvt_pk_bf16_f32 v107, v86, v87
    v_mul_f32 v48, v48, v90
    v_mfma_f32_16x16x32_bf16 v[80:83], a[84:87], v[44:47], v[80:83]
    v_mul_f32 v49, v49, v90
    v_cvt_pk_bf16_f32 v104, v48, v49
    v_mfma_f32_16x16x32_bf16 v[80:83], a[88:91], v[52:55], v[80:83]
    v_mul_f32 v50, v50, v90
    v_mul_f32 v51, v51, v90
    v_mfma_f32_16x16x32_bf16 v[80:83], a[92:95], v[36:39], v[80:83]
    s_nop 0
    ds_write_b32 v135, v107 offset:3084
    v_mfma_f32_16x16x32_bf16 v[92:95], a[120:123], v[60:63], 0
    s_nop 0
    v_cvt_pk_bf16_f32 v105, v50, v51
    v_cvt_pk_bf16_f32 v6, v56, v57
    v_mfma_f32_16x16x32_bf16 v[92:95], a[124:127], v[40:43], v[92:95]
    s_nop 0
    v_cvt_pk_f16_f32 v48, v80, v81
    v_cvt_pk_f16_f32 v49, v82, v83
    v_mfma_f32_16x16x32_bf16 v[92:95], a[128:131], v[64:67], v[92:95]
    v_cvt_pk_bf16_f32 v7, v58, v59
    v_add_u32 v137, s50, v137
    v_mfma_f32_16x16x32_bf16 v[92:95], a[132:135], v[44:47], v[92:95]
    ds_write_b32 v134, v104 offset:3072
    v_mfma_f32_16x16x32_bf16 v[92:95], a[136:139], v[52:55], v[92:95]
    v_add_u32 v136, s50, v136
    v_add_u32 v135, s48, v135
    v_mfma_f32_16x16x32_bf16 v[92:95], a[140:143], v[36:39], v[92:95]
    v_add_u32 v133, s51, v133
    v_add_u32 v132, s14, v132
    v_mfma_f32_16x16x32_f16 v[88:91], v[212:215], v[32:35], 0
    s_nop 0
    v_pk_fma_f16 v33, v48, v48, s39
    v_pk_fmac_f16 v33, v49, v49
    v_mfma_f32_16x16x32_bf16 v[84:87], v[60:63], a[168:171], 0
    s_nop 0
    ds_write_b32 v134, v105 offset:3076
    v_mfma_f32_16x16x32_bf16 v[84:87], v[40:43], a[172:175], v[84:87]
    s_waitcnt vmcnt(0)
    v_or3_b32 v123, v123, v88, v89
    v_or3_b32 v123, v123, v90, v91
    v_mfma_f32_16x16x32_bf16 v[84:87], v[64:67], a[176:179], v[84:87]
    v_rsq_f32 v88, v88
    v_mfma_f32_16x16x32_bf16 v[84:87], v[44:47], a[180:183], v[84:87]
    v_rsq_f32 v89, v89
    v_mfma_f32_16x16x32_bf16 v[84:87], v[52:55], a[184:187], v[84:87]
    v_mul_f32 v88, s52, v88
    v_cvt_pk_f16_f32 v88, v88, v89
    v_mfma_f32_16x16x32_bf16 v[84:87], v[36:39], a[188:191], v[84:87]
    v_rsq_f32 v90, v90
    v_mfma_f32_16x16x32_bf16 v[76:79], a[24:27], v[60:63], 0
    v_rsq_f32 v91, v91
    v_mfma_f32_16x16x32_bf16 v[76:79], a[28:31], v[40:43], v[76:79]
    v_mul_f32 v90, s52, v90
    v_cvt_pk_f16_f32 v90, v90, v91
    v_mfma_f32_16x16x32_bf16 v[76:79], a[32:35], v[64:67], v[76:79]
    s_waitcnt lgkmcnt(0)
    v_pk_mul_f16 v12, v12, v88 op_sel:[0,1] op_sel_hi:[1,1]
    v_pk_mul_f16 v13, v13, v88 op_sel:[0,1] op_sel_hi:[1,1]
    v_mfma_f32_16x16x32_bf16 v[76:79], a[36:39], v[44:47], v[76:79]
    s_barrier
    v_pk_mul_f16 v14, v14, v88 op_sel:[0,1] op_sel_hi:[1,1]
    v_pk_mul_f16 v15, v15, v88 op_sel:[0,1] op_sel_hi:[1,1]
    v_mfma_f32_16x16x32_bf16 v[76:79], a[40:43], v[52:55], v[76:79]
    s_cmp_ge_u32 s61, s13
    v_pk_mul_f16 v154, v154, v88 op_sel:[0,1] op_sel_hi:[1,1]
    v_pk_mul_f16 v155, v155, v88 op_sel:[0,1] op_sel_hi:[1,1]
    v_mfma_f32_16x16x32_bf16 v[76:79], a[44:47], v[36:39], v[76:79]
    s_cbranch_scc1 L_atomF0
L_atomrF0:
    v_mfma_f32_16x16x32_bf16 v[140:143], v[60:63], a[144:147], 0
    v_pk_mul_f16 v8, v8, v90 op_sel:[0,1] op_sel_hi:[1,1]
    v_pk_mul_f16 v9, v9, v90 op_sel:[0,1] op_sel_hi:[1,1]
    v_mfma_f32_16x16x32_bf16 v[140:143], v[40:43], a[148:151], v[140:143]
    v_pk_mul_f16 v10, v10, v90 op_sel:[0,1] op_sel_hi:[1,1]
    v_pk_mul_f16 v11, v11, v90 op_sel:[0,1] op_sel_hi:[1,1]
    v_mfma_f32_16x16x32_bf16 v[140:143], v[64:67], a[152:155], v[140:143]
    v_pk_mul_f16 v148, v148, v90 op_sel:[0,1] op_sel_hi:[1,1]
    v_pk_mul_f16 v149, v149, v90 op_sel:[0,1] op_sel_hi:[1,1]
    v_mfma_f32_16x16x32_bf16 v[140:143], v[44:47], a[156:159], v[140:143]
    v_pk_mul_f16 v28, v28, v88 op_sel:[0,0] op_sel_hi:[1,0]
    v_pk_mul_f16 v29, v29, v88 op_sel:[0,0] op_sel_hi:[1,0]
    v_mfma_f32_16x16x32_bf16 v[140:143], v[52:55], a[160:163], v[140:143]
    ds_read_b128 v[80:83], v137 offset:0
    v_pk_mul_f16 v30, v30, v88 op_sel:[0,0] op_sel_hi:[1,0]
    v_mfma_f32_16x16x32_bf16 v[140:143], v[36:39], a[164:167], v[140:143]
    v_pk_mul_f16 v31, v31, v88 op_sel:[0,0] op_sel_hi:[1,0]
    v_pk_mul_f16 v152, v152, v88 op_sel:[0,0] op_sel_hi:[1,0]
    v_mfma_f32_16x16x32_bf16 v[96:99], a[0:3], v[60:63], 0
    ds_read_b128 v[68:71], v132 offset:0
    v_pk_mul_f16 v153, v153, v88 op_sel:[0,0] op_sel_hi:[1,0]
    v_mfma_f32_16x16x32_bf16 v[96:99], a[4:7], v[40:43], v[96:99]
    ds_read_b128 v[104:107], v133 offset:0
    v_cvt_pk_f16_f32 v58, v76, v77
    v_mfma_f32_16x16x32_bf16 v[96:99], a[8:11], v[64:67], v[96:99]
    v_cvt_pk_f16_f32 v59, v78, v79
    v_add_u32 v134, s48, v134
    v_mfma_f32_16x16x32_bf16 v[96:99], a[12:15], v[44:47], v[96:99]
    ds_read_b128 v[76:79], v132 offset:16
    v_add_u32 v131, s14, v131
    v_mfma_f32_16x16x32_bf16 v[96:99], a[16:19], v[52:55], v[96:99]
    v_pk_mul_f16 v16, v16, v90 op_sel:[0,0] op_sel_hi:[1,0]
    v_pk_mul_f16 v17, v17, v90 op_sel:[0,0] op_sel_hi:[1,0]
    v_mfma_f32_16x16x32_bf16 v[96:99], a[20:23], v[36:39], v[96:99]
    v_pk_mul_f16 v18, v18, v90 op_sel:[0,0] op_sel_hi:[1,0]
    v_pk_mul_f16 v19, v19, v90 op_sel:[0,0] op_sel_hi:[1,0]
    v_mfma_f32_16x16x32_bf16 v[100:103], a[48:51], v[60:63], 0
    v_pk_mul_f16 v146, v146, v90 op_sel:[0,0] op_sel_hi:[1,0]
    v_pk_mul_f16 v147, v147, v90 op_sel:[0,0] op_sel_hi:[1,0]
    v_mfma_f32_16x16x32_bf16 v[100:103], a[52:55], v[40:43], v[100:103]
    s_nop 0
    ds_read_b128 v[88:91], v136 offset:128
    v_cvt_pk_f16_f32 v56, v96, v97
    v_mfma_f32_16x16x32_bf16 v[100:103], a[56:59], v[64:67], v[100:103]
    ds_read_b128 v[72:75], v132 offset:48
    v_cvt_pk_f16_f32 v57, v98, v99
    v_mfma_f32_16x16x32_bf16 v[100:103], a[60:63], v[44:47], v[100:103]
    ds_read_b128 v[96:99], v133 offset:2048
    v_pk_fma_f16 v32, v56, v56, s39
    v_mfma_f32_16x16x32_bf16 v[100:103], a[64:67], v[52:55], v[100:103]
    v_pk_fmac_f16 v32, v57, v57
    v_pk_fmac_f16 v32, v58, v58
    v_mfma_f32_16x16x32_bf16 v[100:103], a[68:71], v[36:39], v[100:103]
    v_pk_fmac_f16 v32, v59, v59
    v_cvt_pk_bf16_f32 v164, v140, v141
    v_mfma_f32_16x16x32_bf16 v[116:119], a[96:99], v[60:63], 0
    s_waitcnt lgkmcnt(3)
    ds_read_b128 v[108:111], v133 offset:1024
    buffer_load_dwordx4 v128, s[24:27], s56 offen nt lds
    v_mfma_f32_16x16x32_bf16 v[116:119], a[100:103], v[40:43], v[116:119]
    s_nop 0
    v_cvt_pk_f16_f32 v140, v100, v101
    v_cvt_pk_f16_f32 v141, v102, v103
    v_mfma_f32_16x16x32_bf16 v[116:119], a[104:107], v[64:67], v[116:119]
    ds_read_b128 v[100:103], v137 offset:256
    v_pk_fmac_f16 v32, v140, v140
    v_mfma_f32_16x16x32_bf16 v[116:119], a[108:111], v[44:47], v[116:119]
    ds_read_u16 v166, v131 offset:80
    v_pk_fmac_f16 v32, v141, v141
    v_mfma_f32_16x16x32_bf16 v[116:119], a[112:115], v[52:55], v[116:119]
    ds_read_u16 v162, v131 offset:96
    v_cvt_pk_bf16_f32 v165, v142, v143
    v_mfma_f32_16x16x32_bf16 v[116:119], a[116:119], v[36:39], v[116:119]
    ds_read_u16 v158, v131 offset:104
    v_cvt_pk_f16_f32 v142, v92, v93
    v_mfma_f32_16x16x32_bf16 v[112:115], v[60:63], a[192:195], 0
    ds_read_b128 v[60:63], v136 offset:0
    v_cvt_pk_f16_f32 v143, v94, v95
    v_mfma_f32_16x16x32_bf16 v[112:115], v[40:43], a[196:199], v[112:115]
    s_nop 0
    ds_read_b128 v[40:43], v133 offset:3072
    v_cvt_pk_f16_f32 v50, v116, v117
    v_mfma_f32_16x16x32_bf16 v[112:115], v[64:67], a[200:203], v[112:115]
    s_add_u32 m0, s67, 1024
    ds_read_b128 v[64:67], v137 offset:128
    v_cvt_pk_f16_f32 v51, v118, v119
    v_mfma_f32_16x16x32_bf16 v[112:115], v[44:47], a[204:207], v[112:115]
    s_waitcnt lgkmcnt(7)
    buffer_store_dwordx4 v[104:107], v128, s[28:31], s60 offen sc1
    buffer_load_dwordx4 v127, s[24:27], s56 offen nt lds
    ds_read_b128 v[44:47], v136 offset:256
    v_pk_fmac_f16 v33, v50, v50
    v_pk_fmac_f16 v33, v51, v51
    v_mfma_f32_16x16x32_bf16 v[112:115], v[52:55], a[208:211], v[112:115]
    v_pk_fmac_f16 v33, v142, v142
    v_pk_fmac_f16 v33, v143, v143
    v_mfma_f32_16x16x32_bf16 v[112:115], v[36:39], a[212:215], v[112:115]
    v_cvt_pk_bf16_f32 v24, v20, v21
    v_cvt_pk_bf16_f32 v25, v22, v23
    v_mfma_f32_16x16x32_f16 v[20:23], v[212:215], v[32:35], 0
    s_nop 0
    v_cvt_pk_bf16_f32 v160, v84, v85
    v_cvt_pk_bf16_f32 v161, v86, v87
    v_mfma_f32_16x16x32_f16 v[32:35], v[8:11], v[28:31], v[200:203]
    s_nop 0
    v_cvt_pk_bf16_f32 v156, v112, v113
    v_cvt_pk_bf16_f32 v157, v114, v115
    v_mfma_f32_16x16x32_f16 v[32:35], v[146:149], v[150:153], v[32:35]
    s_add_u32 m0, s67, 2048
    v_or3_b32 v123, v123, v20, v21
    v_mfma_f32_16x16x32_bf16 v[36:39], a[240:243], v[80:83], 0
    s_waitcnt lgkmcnt(2)
    ds_read_b128 v[52:55], v133 offset:4096
    v_mfma_f32_16x16x32_bf16 v[36:39], a[244:247], v[60:63], v[36:39]
    s_waitcnt lgkmcnt(2)
    buffer_store_dwordx4 v[108:111], v127, s[28:31], s60 offen sc1
    buffer_load_dwordx4 v126, s[24:27], s56 offen nt lds
    v_rsq_f32 v20, v20
    v_mfma_f32_16x16x32_bf16 v[36:39], a[248:251], v[64:67], v[36:39]
    v_rsq_f32 v21, v21
    v_mfma_f32_16x16x32_bf16 v[36:39], a[252:255], v[88:91], v[36:39]
    v_exp_f32 v32, v32
    v_mfma_f32_16x16x32_bf16 v[36:39], v[224:227], v[100:103], v[36:39]
    s_waitcnt lgkmcnt(1)
    v_exp_f32 v33, v33
    v_mfma_f32_16x16x32_bf16 v[36:39], v[228:231], v[44:47], v[36:39]
    v_mul_f32 v20, s52, v20
    v_cvt_pk_f16_f32 v20, v20, v21
    v_mfma_f32_16x16x32_bf16 v[92:95], a[216:219], v[80:83], 0
    v_pk_mul_f16 v56, v56, v20 op_sel:[0,0] op_sel_hi:[1,0]
    v_pk_mul_f16 v57, v57, v20 op_sel:[0,0] op_sel_hi:[1,0]
    v_mfma_f32_16x16x32_bf16 v[92:95], a[220:223], v[60:63], v[92:95]
    v_pk_mul_f16 v58, v58, v20 op_sel:[0,0] op_sel_hi:[1,0]
    v_pk_mul_f16 v59, v59, v20 op_sel:[0,0] op_sel_hi:[1,0]
    v_mfma_f32_16x16x32_bf16 v[92:95], a[224:227], v[64:67], v[92:95]
    v_pk_mul_f16 v140, v140, v20 op_sel:[0,0] op_sel_hi:[1,0]
    v_pk_mul_f16 v141, v141, v20 op_sel:[0,0] op_sel_hi:[1,0]
    v_mfma_f32_16x16x32_bf16 v[92:95], a[228:231], v[88:91], v[92:95]
    v_pk_mul_f16 v48, v48, v20 op_sel:[0,1] op_sel_hi:[1,1]
    v_pk_mul_f16 v49, v49, v20 op_sel:[0,1] op_sel_hi:[1,1]
    v_mfma_f32_16x16x32_bf16 v[92:95], a[232:235], v[100:103], v[92:95]
    v_pk_mul_f16 v50, v50, v20 op_sel:[0,1] op_sel_hi:[1,1]
    v_pk_mul_f16 v51, v51, v20 op_sel:[0,1] op_sel_hi:[1,1]
    v_mfma_f32_16x16x32_bf16 v[92:95], a[236:239], v[44:47], v[92:95]
    s_add_u32 m0, s67, 3072
    buffer_store_dwordx4 v[96:99], v126, s[28:31], s60 offen sc1
    v_pk_mul_f16 v142, v142, v20 op_sel:[0,1] op_sel_hi:[1,1]
    v_pk_mul_f16 v143, v143, v20 op_sel:[0,1] op_sel_hi:[1,1]
    v_exp_f32 v34, v34
    v_mfma_f32_16x16x32_f16 v[20:23], v[68:71], v[28:31], v[208:211]
    v_exp_f32 v35, v35
    v_mfma_f32_16x16x32_f16 v[20:23], v[76:79], v[12:15], v[20:23]
    v_cvt_pk_bf16_f32 v32, v32, v33
    v_cvt_pk_bf16_f32 v33, v34, v35
    v_mfma_f32_16x16x32_f16 v[20:23], v[72:75], v[152:155], v[20:23]
    s_nop 0
    buffer_load_dwordx4 v125, s[24:27], s56 offen nt lds
    v_mfma_f32_16x16x32_f16 v[84:87], v[48:51], v[28:31], v[196:199]
    s_add_u32 m0, s67, 4096
    s_nop 1
    v_mfma_f32_16x16x32_f16 v[84:87], v[140:143], v[150:153], v[84:87]
    s_nop 0
    v_exp_f32 v20, v20
    v_mfma_f32_16x16x32_f16 v[104:107], v[12:15], v[28:31], v[204:207]
    s_nop 0
    v_cvt_pk_bf16_f32 v170, v20, 0
    s_nop 0
    v_mfma_f32_16x16x32_f16 v[104:107], v[152:155], v[150:153], v[104:107]
    s_nop 0
    v_exp_f32 v84, v84
    v_mfma_f32_16x16x32_bf16 v[96:99], v[232:235], v[80:83], 0
    s_waitcnt lgkmcnt(0)
    buffer_store_dwordx4 v[40:43], v125, s[28:31], s60 offen sc1
    buffer_load_dwordx4 v124, s[24:27], s56 offen nt lds
    v_exp_f32 v85, v85
    v_mfma_f32_16x16x32_bf16 v[96:99], v[236:239], v[60:63], v[96:99]
    v_exp_f32 v104, v104
    v_mfma_f32_16x16x32_bf16 v[96:99], v[240:243], v[64:67], v[96:99]
    v_exp_f32 v105, v105
    v_mfma_f32_16x16x32_bf16 v[96:99], v[244:247], v[88:91], v[96:99]
    v_exp_f32 v106, v106
    v_mfma_f32_16x16x32_bf16 v[96:99], v[248:251], v[100:103], v[96:99]
    v_exp_f32 v107, v107
    v_mfma_f32_16x16x32_bf16 v[96:99], v[252:255], v[44:47], v[96:99]
    v_cvt_pk_bf16_f32 v30, v104, v105
    v_cvt_pk_bf16_f32 v31, v106, v107
    v_mfma_f32_16x16x32_f16 v[40:43], v[12:15], v[16:19], v[192:195]
    v_exp_f32 v86, v86
    v_mfma_f32_16x16x32_f16 v[40:43], v[152:155], v[144:147], v[40:43]
    v_exp_f32 v87, v87
    v_mfma_f32_16x16x32_f16 v[44:47], v[48:51], v[16:19], v[184:187]
    buffer_store_dwordx4 v[52:55], v124, s[28:31], s60 offen sc1
    v_cvt_pk_bf16_f32 v168, v84, v85
    v_cvt_pk_bf16_f32 v169, v86, v87
    s_nop 0
    v_mfma_f32_16x16x32_f16 v[44:47], v[140:143], v[144:147], v[44:47]
    s_mov_b32 s53, s47
    v_exp_f32 v40, v40
    v_mfma_f32_16x16x32_f16 v[60:63], v[48:51], v[56:59], v[172:175]
    s_mov_b32 s47, s46
    v_exp_f32 v41, v41
    v_mfma_f32_16x16x32_f16 v[60:63], v[140:143], v[138:141], v[60:63]
    s_mov_b32 s46, s45
    v_exp_f32 v42, v42
    v_mfma_f32_16x16x32_f16 v[64:67], v[68:71], v[56:59], v[208:211]
    s_mov_b32 s45, s44
    v_exp_f32 v43, v43
    v_mfma_f32_16x16x32_f16 v[64:67], v[76:79], v[48:51], v[64:67]
    s_mov_b32 s44, s53
    v_cvt_pk_bf16_f32 v20, v40, v41
    v_cvt_pk_bf16_f32 v21, v42, v43
    v_mfma_f32_16x16x32_f16 v[64:67], v[72:75], v[140:143], v[64:67]
    s_sub_u32 s48, s44, s46
    ds_read_b128 v[40:43], v136 offset:1536
    v_mfma_f32_16x16x32_f16 v[84:87], v[68:71], v[16:19], v[208:211]
    s_sub_u32 s49, s46, s45
    ds_read_b128 v[52:55], v137 offset:1792
    v_fma_f32 v28, v92, v92, s42
    v_mfma_f32_16x16x32_f16 v[84:87], v[76:79], v[8:11], v[84:87]
    s_cmp_lg_u32 s5, -1
    ds_read_b128 v[80:83], v137 offset:1664
    v_fmac_f32 v28, v93, v93
    v_mfma_f32_16x16x32_f16 v[84:87], v[72:75], v[146:149], v[84:87]
    s_nop 0
    v_exp_f32 v44, v44
    v_mfma_f32_16x16x32_bf16 v[68:71], v[220:223], v[30:33], 0
    s_nop 0
    v_exp_f32 v45, v45
    v_mfma_f32_16x16x32_bf16 v[68:71], v[220:223], v[168:171], v[68:71]
    s_nop 0
    ds_read_b128 v[76:79], v137 offset:1536
    v_mov_b32_dpp v23, v87 quad_perm:[0,1,2,3] row_mask:0x2 bank_mask:0xf
    v_mfma_f32_16x16x32_bf16 v[104:107], v[0:3], v[30:33], 0
    ds_read_b128 v[86:89], v136 offset:1664
    v_mov_b32_dpp v23, v67 quad_perm:[0,1,2,3] row_mask:0x4 bank_mask:0xf
    v_mfma_f32_16x16x32_bf16 v[104:107], v[164:167], v[168:171], v[104:107]
    v_exp_f32 v46, v46
    v_mfma_f32_16x16x32_bf16 v[72:75], v[24:27], v[30:33], 0
    v_exp_f32 v47, v47
    v_mfma_f32_16x16x32_bf16 v[72:75], v[160:163], v[168:171], v[72:75]
    v_exp_f32 v85, v85
    v_mfma_f32_16x16x32_bf16 v[116:119], v[4:7], v[30:33], 0
    ds_read_b128 v[30:33], v136 offset:1792
    v_fmac_f32 v28, v94, v94
    v_mfma_f32_16x16x32_bf16 v[116:119], v[156:159], v[168:171], v[116:119]
    v_exp_f32 v23, v23
    v_mfma_f32_16x16x32_f16 v[108:111], v[12:15], v[56:59], v[180:183]
    v_cvt_pk_bf16_f32 v23, v23, v23
    v_cvt_pk_bf16_f32 v168, v44, v45
    v_mfma_f32_16x16x32_f16 v[108:111], v[152:155], v[138:141], v[108:111]
    v_rcp_f32 v68, v68
    v_mfma_f32_16x16x32_f16 v[152:155], v[8:11], v[56:59], v[176:179]
    ds_write_b16 v131, v23 offset:64
    v_mfma_f32_16x16x32_f16 v[152:155], v[146:149], v[138:141], v[152:155]
    s_waitcnt lgkmcnt(2)
    v_mul_f32 v104, v104, v68
    v_mul_f32 v105, v105, v68
    v_mfma_f32_16x16x32_bf16 v[56:59], a[216:219], v[76:79], 0
    v_cvt_pk_bf16_f32 v12, v104, v105
    v_mul_f32 v106, v106, v68
    v_mfma_f32_16x16x32_bf16 v[56:59], a[220:223], v[40:43], v[56:59]
    ds_read_b128 v[100:103], v132 offset:48
    v_mul_f32 v107, v107, v68
    v_mfma_f32_16x16x32_bf16 v[56:59], a[224:227], v[80:83], v[56:59]
    ds_read_b128 v[140:143], v132 offset:64
    v_cvt_pk_bf16_f32 v13, v106, v107
    v_mfma_f32_16x16x32_bf16 v[56:59], a[228:231], v[86:89], v[56:59]
    v_mul_f32 v72, v72, v68
    v_mul_f32 v73, v73, v68
    v_mfma_f32_16x16x32_bf16 v[56:59], a[232:235], v[52:55], v[56:59]
    s_waitcnt lgkmcnt(3)
    v_cvt_pk_bf16_f32 v14, v72, v73
    v_mul_f32 v74, v74, v68
    v_mfma_f32_16x16x32_bf16 v[56:59], a[236:239], v[30:33], v[56:59]
    v_mul_f32 v75, v75, v68
    v_cvt_pk_bf16_f32 v15, v74, v75
    v_mfma_f32_16x16x32_bf16 v[104:107], v[232:235], v[76:79], 0
    ds_write_b64 v135, v[12:13] offset:0
    v_mfma_f32_16x16x32_bf16 v[104:107], v[236:239], v[40:43], v[104:107]
    v_mul_f32 v116, v116, v68
    v_mul_f32 v117, v117, v68
    v_mfma_f32_16x16x32_bf16 v[104:107], v[240:243], v[80:83], v[104:107]
    v_cvt_pk_bf16_f32 v22, v116, v117
    v_mul_f32 v118, v118, v68
    v_mfma_f32_16x16x32_bf16 v[104:107], v[244:247], v[86:89], v[104:107]
    ds_read_b128 v[72:75], v137 offset:3200
    v_mul_f32 v119, v119, v68
    v_mfma_f32_16x16x32_bf16 v[104:107], v[248:251], v[52:55], v[104:107]
    v_cvt_pk_bf16_f32 v23, v118, v119
    v_cvt_pk_bf16_f32 v169, v46, v47
    v_mfma_f32_16x16x32_bf16 v[104:107], v[252:255], v[30:33], v[104:107]
    s_waitcnt lgkmcnt(2)
    v_cvt_pk_bf16_f32 v170, v85, 0
    v_fmac_f32 v28, v95, v95
    v_mfma_f32_16x16x32_bf16 v[44:47], v[100:103], v[0:3], 0
    v_exp_f32 v60, v60
    v_mfma_f32_16x16x32_bf16 v[44:47], v[140:143], v[164:167], v[44:47]
    ds_write_b64 v135, v[14:15] offset:8
    v_mfma_f32_16x16x32_bf16 v[12:15], v[100:103], v[24:27], 0
    v_exp_f32 v61, v61
    v_mfma_f32_16x16x32_bf16 v[12:15], v[140:143], v[160:163], v[12:15]
    v_exp_f32 v62, v62
    v_mfma_f32_16x16x32_bf16 v[68:71], v[100:103], v[4:7], 0
    s_nop 0
    ds_read_b128 v[116:119], v137 offset:3072
    v_fmac_f32 v28, v36, v36
    v_mfma_f32_16x16x32_bf16 v[68:71], v[140:143], v[156:159], v[68:71]
    s_nop 0
    ds_read_b128 v[100:103], v136 offset:3072
    v_mov_b32_dpp v47, v15 quad_perm:[0,1,2,3] row_mask:0x2 bank_mask:0xf
    v_mfma_f32_16x16x32_bf16 v[140:143], a[240:243], v[76:79], 0
    ds_read_b128 v[12:15], v136 offset:3200
    v_fmac_f32 v28, v37, v37
    v_mfma_f32_16x16x32_bf16 v[140:143], a[244:247], v[40:43], v[140:143]
    ds_read_b128 v[40:43], v137 offset:3328
    v_mov_b32_dpp v47, v71 quad_perm:[0,1,2,3] row_mask:0x4 bank_mask:0xf
    v_mfma_f32_16x16x32_bf16 v[140:143], a[248:251], v[80:83], v[140:143]
    ds_read_b128 v[80:83], v136 offset:3328
    v_cvt_pk_bf16_f32 v47, v47, v47
    v_mfma_f32_16x16x32_bf16 v[140:143], a[252:255], v[86:89], v[140:143]
    v_exp_f32 v63, v63
    v_mfma_f32_16x16x32_bf16 v[140:143], v[224:227], v[52:55], v[140:143]
    v_exp_f32 v66, v66
    v_mfma_f32_16x16x32_bf16 v[140:143], v[228:231], v[30:33], v[140:143]
    v_exp_f32 v152, v152
    v_mfma_f32_16x16x32_f16 v[30:33], v[8:11], v[16:19], v[188:191]
    ds_write_b32 v134, v22 offset:0
    v_mfma_f32_16x16x32_f16 v[30:33], v[146:149], v[144:147], v[30:33]
    s_waitcnt lgkmcnt(5)
    v_exp_f32 v153, v153
    v_mfma_f32_16x16x32_bf16 v[84:87], a[240:243], v[116:119], 0
    s_waitcnt lgkmcnt(4)
    v_exp_f32 v154, v154
    v_mfma_f32_16x16x32_bf16 v[84:87], a[244:247], v[100:103], v[84:87]
    v_exp_f32 v155, v155
    v_mfma_f32_16x16x32_bf16 v[84:87], a[248:251], v[72:75], v[84:87]
    s_waitcnt lgkmcnt(2)
    ds_write_b32 v134, v23 offset:4
    v_mfma_f32_16x16x32_bf16 v[84:87], a[252:255], v[12:15], v[84:87]
    v_cvt_pk_bf16_f32 v34, v152, v153
    v_cvt_pk_bf16_f32 v35, v154, v155
    v_mfma_f32_16x16x32_bf16 v[84:87], v[224:227], v[40:43], v[84:87]
    s_waitcnt lgkmcnt(2)
    v_exp_f32 v30, v30
    v_mfma_f32_16x16x32_bf16 v[84:87], v[228:231], v[80:83], v[84:87]
    v_exp_f32 v31, v31
    v_mfma_f32_16x16x32_bf16 v[52:55], a[216:219], v[116:119], 0
    ds_write_b16 v131, v47
    v_mfma_f32_16x16x32_bf16 v[52:55], a[220:223], v[100:103], v[52:55]
    v_exp_f32 v32, v32
    v_mfma_f32_16x16x32_bf16 v[52:55], a[224:227], v[72:75], v[52:55]
    v_exp_f32 v33, v33
    v_mfma_f32_16x16x32_bf16 v[52:55], a[228:231], v[12:15], v[52:55]
    v_cvt_pk_bf16_f32 v22, v30, v31
    v_cvt_pk_bf16_f32 v23, v32, v33
    v_mfma_f32_16x16x32_bf16 v[52:55], a[232:235], v[40:43], v[52:55]
    v_exp_f32 v108, v108
    v_mfma_f32_16x16x32_bf16 v[52:55], a[236:239], v[80:83], v[52:55]
    v_exp_f32 v109, v109
    v_mfma_f32_16x16x32_bf16 v[152:155], v[220:223], v[20:23], 0
    v_exp_f32 v110, v110
    v_mfma_f32_16x16x32_bf16 v[152:155], v[220:223], v[168:171], v[152:155]
    s_nop 0
    v_exp_f32 v111, v111
    v_mfma_f32_16x16x32_bf16 v[8:11], v[0:3], v[20:23], 0
    s_nop 0
    v_cvt_pk_bf16_f32 v32, v108, v109
    v_cvt_pk_bf16_f32 v33, v110, v111
    v_mfma_f32_16x16x32_bf16 v[8:11], v[164:167], v[168:171], v[8:11]
    s_nop 0
    v_rcp_f32 v152, v152
    v_mfma_f32_16x16x32_bf16 v[44:47], v[24:27], v[20:23], 0
    v_add_u32 v137, s48, v137
    v_add_u32 v136, s48, v136
    v_mfma_f32_16x16x32_bf16 v[44:47], v[160:163], v[168:171], v[44:47]
    s_nop 0
    ds_read_b128 v[146:149], v137 offset:0
    v_mul_f32 v8, v8, v152
    v_mfma_f32_16x16x32_bf16 v[16:19], v[4:7], v[20:23], 0
    ds_read_b128 v[88:91], v136 offset:0
    v_mul_f32 v9, v9, v152
    v_mfma_f32_16x16x32_bf16 v[16:19], v[156:159], v[168:171], v[16:19]
    ds_read_b128 v[108:111], v137 offset:128
    v_cvt_pk_bf16_f32 v168, v60, v61
    v_mfma_f32_16x16x32_bf16 v[48:51], v[232:235], v[116:119], 0
    ds_read_b128 v[116:119], v136 offset:128
    v_cvt_pk_bf16_f32 v169, v62, v63
    v_mfma_f32_16x16x32_bf16 v[48:51], v[236:239], v[100:103], v[48:51]
    ds_read_b128 v[60:63], v137 offset:256
    v_cvt_pk_bf16_f32 v170, v66, 0
    v_mfma_f32_16x16x32_bf16 v[48:51], v[240:243], v[72:75], v[48:51]
    ds_read_b128 v[64:67], v136 offset:256
    v_cvt_pk_bf16_f32 v20, v8, v9
    v_mfma_f32_16x16x32_bf16 v[48:51], v[244:247], v[12:15], v[48:51]
    v_mul_f32 v10, v10, v152
    v_mul_f32 v11, v11, v152
    v_mfma_f32_16x16x32_bf16 v[48:51], v[248:251], v[40:43], v[48:51]
    ds_read_b128 v[100:103], v136 offset:1536
    v_cvt_pk_bf16_f32 v21, v10, v11
    v_mfma_f32_16x16x32_bf16 v[48:51], v[252:255], v[80:83], v[48:51]
    ds_read_b128 v[80:83], v137 offset:1664
    v_mul_f32 v44, v44, v152
    v_mfma_f32_16x16x32_bf16 v[12:15], v[220:223], v[32:35], 0
    ds_read_b128 v[68:71], v137 offset:1536
    v_mul_f32 v45, v45, v152
    v_mfma_f32_16x16x32_bf16 v[12:15], v[220:223], v[168:171], v[12:15]
    ds_read_b128 v[76:79], v136 offset:1792
    v_cvt_pk_bf16_f32 v22, v44, v45
    v_mfma_f32_16x16x32_bf16 v[72:75], v[0:3], v[32:35], 0
    v_mul_f32 v46, v46, v152
    v_mul_f32 v47, v47, v152
    v_mfma_f32_16x16x32_bf16 v[72:75], v[164:167], v[168:171], v[72:75]
    v_cvt_pk_bf16_f32 v23, v46, v47
    v_mul_f32 v16, v16, v152
    v_mfma_f32_16x16x32_bf16 v[0:3], v[24:27], v[32:35], 0
    v_mul_f32 v17, v17, v152
    v_cvt_pk_bf16_f32 v154, v16, v17
    v_mfma_f32_16x16x32_bf16 v[0:3], v[160:163], v[168:171], v[0:3]
    ds_write_b32 v135, v20 offset:1536
    v_mfma_f32_16x16x32_bf16 v[8:11], v[4:7], v[32:35], 0
    v_mul_f32 v18, v18, v152
    v_mul_f32 v19, v19, v152
    v_mfma_f32_16x16x32_bf16 v[8:11], v[156:159], v[168:171], v[8:11]
    s_waitcnt lgkmcnt(4)
    v_cvt_pk_bf16_f32 v155, v18, v19
    v_fmac_f32 v28, v38, v38
    v_mfma_f32_16x16x32_bf16 v[30:33], a[0:3], v[146:149], 0
    s_cbranch_scc1 L_loopF0
L_tailF:
    ds_write_b32 v135, v21 offset:1540
    v_rcp_f32 v12, v12
    s_mov_b32 s30, 100270464
    s_mul_i32 s89, s68, 7168
    ds_write_b64 v135, v[22:23] offset:1544
    v_mul_f32 v72, v72, v12
    v_mul_f32 v73, v73, v12
    v_cvt_pk_bf16_f32 v4, v72, v73
    s_add_u32 s89, s89, 135168
    s_movk_i32 s90, 112
    ds_write_b64 v134, v[154:155] offset:1536
    v_mul_f32 v74, v74, v12
    v_mul_f32 v75, v75, v12
    v_cvt_pk_bf16_f32 v5, v74, v75
    v_mul_f32 v0, v0, v12
    v_mul_f32 v1, v1, v12
    v_cvt_pk_bf16_f32 v6, v0, v1
    v_mul_f32 v2, v2, v12
    v_mul_f32 v3, v3, v12
    v_cvt_pk_bf16_f32 v7, v2, v3
    v_mul_f32 v8, v8, v12
    v_mul_f32 v9, v9, v12
    v_cvt_pk_bf16_f32 v8, v8, v9
    v_mul_f32 v10, v10, v12
    v_mul_f32 v11, v11, v12
    v_cvt_pk_bf16_f32 v9, v10, v11
    s_lshr_b32 s91, s64, 16
    s_lshl_b32 s92, s68, 10
    ds_write_b64 v135, v[4:5] offset:3072
    v_fmac_f32 v28, v39, v39
    s_sub_u32 s84, s45, s44
    s_sub_u32 s85, s46, s45
    ds_write_b64 v135, v[6:7] offset:3080
    v_fmac_f32 v28, v96, v96
    v_fmac_f32 v28, v97, v97
    v_fmac_f32 v28, v98, v98
    s_sub_u32 s86, s44, s45
    s_sub_u32 s93, s44, s47
    ds_write_b32 v134, v8 offset:3072
    ds_write_b32 v134, v9 offset:3076
    v_fmac_f32 v28, v99, v99
    v_fma_f32 v131, v56, v56, s42
    v_fmac_f32 v131, v57, v57
    v_fmac_f32 v131, v58, v58
    v_fmac_f32 v131, v59, v59
    v_fmac_f32 v131, v140, v140
    v_fmac_f32 v131, v141, v141
    v_fmac_f32 v131, v142, v142
    v_fmac_f32 v131, v143, v143
    v_fmac_f32 v131, v104, v104
    v_fmac_f32 v131, v105, v105
    v_fmac_f32 v131, v106, v106
    v_fmac_f32 v131, v107, v107
    v_fma_f32 v121, v52, v52, s42
    v_fmac_f32 v121, v53, v53
    v_fmac_f32 v121, v54, v54
    v_fmac_f32 v121, v55, v55
    v_fmac_f32 v121, v84, v84
    v_fmac_f32 v121, v85, v85
    v_fmac_f32 v121, v86, v86
    v_fmac_f32 v121, v87, v87
    v_fmac_f32 v121, v48, v48
    v_fmac_f32 v121, v49, v49
    v_fmac_f32 v121, v50, v50
    v_fmac_f32 v121, v51, v51
    v_cvt_pk_bf16_f32 v120, v28, v131
    v_cvt_pk_bf16_f32 v121, v121, v122
    s_sub_u32 s94, s45, s47
    s_sub_u32 s95, s46, s47
    ds_write_b64 v130, v[120:121]
    v_mbcnt_lo_u32_b32 v131, -1, 0
    v_mbcnt_hi_u32_b32 v131, -1, v131
    v_and_b32 v120, 15, v131
    v_lshrrev_b32 v131, 4, v131
    v_mul_u32_u24 v131, 1792, v131
    v_add_u32 v131, s89, v131
    v_mad_u32_u24 v132, v120, s90, v131
    v_lshrrev_b32 v121, v120, s64
    v_and_b32 v121, 1, v121
    v_cmp_eq_u32 vcc, 1, v121
    v_mad_u32_u24 v122, v120, s90, v131
    v_lshrrev_b32 v120, v120, s91
    v_cndmask_b32 v132, v131, v132, vcc
    v_and_b32 v120, 1, v120
    v_subrev_u32 v122, 28672, v122
    v_cmp_eq_u32 vcc, 1, v120
    ds_read_b128 v[20:23], v132 offset:64
    ds_read_b128 v[16:19], v132 offset:80
    v_cndmask_b32 v122, v131, v122, vcc
    v_add_u32 v131, s92, v129
    s_waitcnt lgkmcnt(2)
    s_barrier
    ds_read_b128 v[114:117], v132
    v_add_u32 v29, s84, v137
    ds_read_b64 v[118:119], v132 offset:16
    ds_read_b128 v[4:7], v131 offset:6144
    v_add_u32 v28, s84, v136
    v_add_u32 v121, s85, v135
    ds_read_b128 v[8:11], v129 offset:0
    v_add_u32 v120, s85, v134
    ds_read_b128 v[0:3], v129 offset:1024
    v_add_u32 v138, s86, v135
    v_add_u32 v132, s86, v134
    v_add_u32 v131, s93, v133
    v_add_u32 v139, s94, v133
    s_waitcnt lgkmcnt(6)
    v_mfma_f32_16x16x32_bf16 v[12:15], v[220:223], v[20:23], 0
    s_waitcnt lgkmcnt(5)
    ds_read_b128 v[76:79], v29 offset:1536
    ds_read_b128 v[72:75], v28 offset:1536
    v_mfma_f32_16x16x32_bf16 v[12:15], v[220:223], v[16:19], v[12:15]
    s_waitcnt lgkmcnt(3)
    ds_read_b128 v[68:71], v29 offset:1664
    v_lshlrev_b32 v80, 16, v114
    v_and_b32 v114, 0xffff0000, v114
    v_lshlrev_b32 v81, 16, v115
    v_and_b32 v115, 0xffff0000, v115
    v_lshlrev_b32 v82, 16, v116
    v_and_b32 v116, 0xffff0000, v116
    v_rcp_f32 v12, v12
    v_lshlrev_b32 v83, 16, v117
    v_mfma_f32_16x16x32_bf16 v[16:19], v[216:219], v[8:11], 0
    s_waitcnt lgkmcnt(3)
    ds_read_b128 v[64:67], v28 offset:1664
    ds_read_b128 v[44:47], v29 offset:1792
    v_mfma_f32_16x16x32_bf16 v[16:19], v[216:219], v[0:3], v[16:19]
    s_waitcnt lgkmcnt(4)
    ds_read_b128 v[40:43], v28 offset:1792
    v_mul_f32 v80, v80, v12
    v_mul_f32 v114, v114, v12
    v_cvt_pk_bf16_f32 v80, v80, v114
    v_mul_f32 v81, v81, v12
    v_mfma_f32_16x16x32_bf16 v[8:11], a[216:219], v[76:79], 0
    s_waitcnt lgkmcnt(4)
    v_mul_f32 v115, v115, v12
    v_cvt_pk_bf16_f32 v81, v81, v115
    v_mfma_f32_16x16x32_bf16 v[8:11], a[220:223], v[72:75], v[8:11]
    s_waitcnt lgkmcnt(3)
    ds_read_b128 v[112:115], v29 offset:0
    ds_read_b128 v[108:111], v28 offset:0
    v_mfma_f32_16x16x32_bf16 v[8:11], a[224:227], v[68:71], v[8:11]
    s_waitcnt lgkmcnt(4)
    ds_read_b128 v[60:63], v29 offset:128
    v_mul_f32 v82, v82, v12
    v_mul_f32 v116, v116, v12
    v_cvt_pk_bf16_f32 v82, v82, v116
    v_and_b32 v117, 0xffff0000, v117
    v_mul_f32 v83, v83, v12
    v_mfma_f32_16x16x32_bf16 v[8:11], a[228:231], v[64:67], v[8:11]
    s_waitcnt lgkmcnt(4)
    ds_read_b128 v[32:35], v28 offset:128
    ds_read_b128 v[20:23], v29 offset:256
    v_mfma_f32_16x16x32_bf16 v[8:11], a[232:235], v[44:47], v[8:11]
    s_waitcnt lgkmcnt(5)
    ds_read_b128 v[0:3], v28 offset:256
    v_mul_f32 v117, v117, v12
    v_mfma_f32_16x16x32_bf16 v[8:11], a[236:239], v[40:43], v[8:11]
    v_cvt_pk_bf16_f32 v83, v83, v117
    v_lshlrev_b32 v19, 16, v118
    v_mfma_f32_16x16x32_bf16 v[24:27], a[240:243], v[76:79], 0
    ds_write_b128 v138, v[80:83] offset:0
    v_mfma_f32_16x16x32_bf16 v[24:27], a[244:247], v[72:75], v[24:27]
    v_and_b32 v118, 0xffff0000, v118
    v_mul_f32 v19, v19, v12
    v_mfma_f32_16x16x32_bf16 v[24:27], a[248:251], v[68:71], v[24:27]
    v_mul_f32 v118, v118, v12
    v_cvt_pk_bf16_f32 v30, v19, v118
    v_mfma_f32_16x16x32_bf16 v[24:27], a[252:255], v[64:67], v[24:27]
    v_lshlrev_b32 v19, 16, v119
    v_and_b32 v119, 0xffff0000, v119
    v_mfma_f32_16x16x32_bf16 v[24:27], v[224:227], v[44:47], v[24:27]
    v_mul_f32 v19, v19, v12
    v_mul_f32 v119, v119, v12
    v_mfma_f32_16x16x32_bf16 v[24:27], v[228:231], v[40:43], v[24:27]
    v_cvt_pk_bf16_f32 v31, v19, v119
    v_lshrrev_b32 v19, 0, v7
    v_mfma_f32_16x16x32_bf16 v[12:15], v[232:235], v[76:79], 0
    ds_write_b64 v132, v[30:31] offset:0
    v_mfma_f32_16x16x32_bf16 v[12:15], v[236:239], v[72:75], v[12:15]
    v_lshrrev_b32 v19, v19, s64
    v_and_b32 v19, 1, v19
    v_mfma_f32_16x16x32_bf16 v[12:15], v[240:243], v[68:71], v[12:15]
    v_cmp_eq_u32 vcc, 1, v19
    v_lshrrev_b32 v19, 8, v7
    v_mfma_f32_16x16x32_bf16 v[12:15], v[244:247], v[64:67], v[12:15]
    v_cndmask_b32 v4, 2.0, v4, vcc
    v_lshrrev_b32 v19, v19, s64
    v_mfma_f32_16x16x32_bf16 v[12:15], v[248:251], v[44:47], v[12:15]
    v_and_b32 v19, 1, v19
    v_cmp_eq_u32 vcc, 1, v19
    v_mfma_f32_16x16x32_bf16 v[12:15], v[252:255], v[40:43], v[12:15]
    s_waitcnt lgkmcnt(1)
    v_cndmask_b32 v5, 2.0, v5, vcc
    v_lshrrev_b32 v7, 16, v7
    v_mfma_f32_16x16x32_bf16 v[68:71], a[216:219], v[112:115], 0
    v_lshrrev_b32 v7, v7, s64
    v_and_b32 v7, 1, v7
    v_mfma_f32_16x16x32_bf16 v[68:71], a[220:223], v[108:111], v[68:71]
    ds_read_b128 v[100:103], v29 offset:3072
    ds_read_b128 v[88:91], v28 offset:3072
    v_mfma_f32_16x16x32_bf16 v[68:71], a[224:227], v[60:63], v[68:71]
    ds_read_b128 v[80:83], v29 offset:3200
    v_cmp_eq_u32 vcc, 1, v7
    v_mfma_f32_16x16x32_bf16 v[68:71], a[228:231], v[32:35], v[68:71]
    ds_read_b128 v[76:79], v28 offset:3200
    v_cndmask_b32 v6, 2.0, v6, vcc
    v_mfma_f32_16x16x32_bf16 v[68:71], a[232:235], v[20:23], v[68:71]
    ds_read_b128 v[64:67], v29 offset:3328
    v_add_u32 v7, s95, v133
    v_mfma_f32_16x16x32_bf16 v[68:71], a[236:239], v[0:3], v[68:71]
    ds_read_b128 v[28:31], v28 offset:3328
    v_fma_f32 v133, v8, v8, s42
    v_mfma_f32_16x16x32_bf16 v[44:47], a[240:243], v[112:115], 0
    v_rsq_f32 v16, v16
    v_mfma_f32_16x16x32_bf16 v[44:47], a[244:247], v[108:111], v[44:47]
    v_mul_f32 v16, s43, v16
    v_mul_f32 v92, v92, v16
    v_mfma_f32_16x16x32_bf16 v[44:47], a[248:251], v[60:63], v[44:47]
    v_mul_f32 v93, v93, v16
    v_cvt_pk_bf16_f32 v72, v92, v93
    v_mfma_f32_16x16x32_bf16 v[44:47], a[252:255], v[32:35], v[44:47]
    v_mul_f32 v94, v94, v16
    v_mul_f32 v95, v95, v16
    v_mfma_f32_16x16x32_bf16 v[44:47], v[224:227], v[20:23], v[44:47]
    v_cvt_pk_bf16_f32 v73, v94, v95
    v_mul_f32 v36, v36, v16
    v_mfma_f32_16x16x32_bf16 v[44:47], v[228:231], v[0:3], v[44:47]
    v_mul_f32 v37, v37, v16
    v_cvt_pk_bf16_f32 v74, v36, v37
    v_mfma_f32_16x16x32_bf16 v[40:43], v[232:235], v[112:115], 0
    v_mul_f32 v38, v38, v16
    v_mul_f32 v39, v39, v16
    v_mfma_f32_16x16x32_bf16 v[40:43], v[236:239], v[108:111], v[40:43]
    v_cvt_pk_bf16_f32 v75, v38, v39
    v_mul_f32 v96, v96, v16
    v_mfma_f32_16x16x32_bf16 v[40:43], v[240:243], v[60:63], v[40:43]
    ds_write_b128 v121, v[72:75] offset:0
    v_mfma_f32_16x16x32_bf16 v[40:43], v[244:247], v[32:35], v[40:43]
    v_mul_f32 v97, v97, v16
    v_cvt_pk_bf16_f32 v96, v96, v97
    v_mfma_f32_16x16x32_bf16 v[40:43], v[248:251], v[20:23], v[40:43]
    v_mul_f32 v98, v98, v16
    v_mul_f32 v99, v99, v16
    v_mfma_f32_16x16x32_bf16 v[40:43], v[252:255], v[0:3], v[40:43]
    s_waitcnt lgkmcnt(1)
    v_cvt_pk_bf16_f32 v97, v98, v99
    v_fma_f32 v38, v68, v68, s42
    v_mfma_f32_16x16x32_bf16 v[20:23], a[216:219], v[100:103], 0
    ds_write_b64 v120, v[96:97] offset:0
    v_mfma_f32_16x16x32_bf16 v[20:23], a[220:223], v[88:91], v[20:23]
    ds_read_b128 v[60:63], v122 offset:64
    v_fmac_f32 v38, v69, v69
    v_mfma_f32_16x16x32_bf16 v[20:23], a[224:227], v[80:83], v[20:23]
    ds_read_b128 v[0:3], v122 offset:80
    v_fmac_f32 v38, v70, v70
    v_mfma_f32_16x16x32_bf16 v[20:23], a[228:231], v[76:79], v[20:23]
    ds_read_b128 v[32:35], v122
    v_fmac_f32 v38, v71, v71
    v_mfma_f32_16x16x32_bf16 v[20:23], a[232:235], v[64:67], v[20:23]
    ds_read_b64 v[36:37], v122 offset:16
    v_fmac_f32 v38, v44, v44
    v_mfma_f32_16x16x32_bf16 v[20:23], a[236:239], v[28:31], v[20:23]
    v_rsq_f32 v17, v17
    v_mfma_f32_16x16x32_bf16 v[96:99], a[240:243], v[100:103], 0
    v_mul_f32 v17, s43, v17
    v_mul_f32 v56, v56, v17
    v_mfma_f32_16x16x32_bf16 v[96:99], a[244:247], v[88:91], v[96:99]
    v_mul_f32 v57, v57, v17
    v_cvt_pk_bf16_f32 v56, v56, v57
    v_mfma_f32_16x16x32_bf16 v[96:99], a[248:251], v[80:83], v[96:99]
    v_mul_f32 v58, v58, v17
    v_mul_f32 v59, v59, v17
    v_mfma_f32_16x16x32_bf16 v[96:99], a[252:255], v[76:79], v[96:99]
    v_cvt_pk_bf16_f32 v57, v58, v59
    v_mul_f32 v140, v140, v17
    v_mfma_f32_16x16x32_bf16 v[96:99], v[224:227], v[64:67], v[96:99]
    v_mul_f32 v141, v141, v17
    v_cvt_pk_bf16_f32 v58, v140, v141
    v_mfma_f32_16x16x32_bf16 v[96:99], v[228:231], v[28:31], v[96:99]
    v_mul_f32 v142, v142, v17
    v_mul_f32 v143, v143, v17
    v_mfma_f32_16x16x32_bf16 v[72:75], v[232:235], v[100:103], 0
    v_cvt_pk_bf16_f32 v59, v142, v143
    v_mul_f32 v104, v104, v17
    v_mfma_f32_16x16x32_bf16 v[72:75], v[236:239], v[88:91], v[72:75]
    ds_write_b128 v121, v[56:59] offset:1536
    v_mfma_f32_16x16x32_bf16 v[72:75], v[240:243], v[80:83], v[72:75]
    v_mul_f32 v105, v105, v17
    v_cvt_pk_bf16_f32 v104, v104, v105
    v_mfma_f32_16x16x32_bf16 v[72:75], v[244:247], v[76:79], v[72:75]
    v_mul_f32 v106, v106, v17
    v_mul_f32 v107, v107, v17
    v_mfma_f32_16x16x32_bf16 v[72:75], v[248:251], v[64:67], v[72:75]
    v_cvt_pk_bf16_f32 v105, v106, v107
    v_fmac_f32 v38, v45, v45
    v_mfma_f32_16x16x32_bf16 v[72:75], v[252:255], v[28:31], v[72:75]
    s_waitcnt lgkmcnt(1)
    ds_write_b64 v120, v[104:105] offset:1536
    v_mfma_f32_16x16x32_bf16 v[28:31], v[220:223], v[60:63], 0
    v_rsq_f32 v18, v18
    v_mfma_f32_16x16x32_bf16 v[28:31], v[220:223], v[0:3], v[28:31]
    v_mul_f32 v18, s43, v18
    v_mul_f32 v52, v52, v18
    v_mul_f32 v53, v53, v18
    v_cvt_pk_bf16_f32 v0, v52, v53
    v_mul_f32 v54, v54, v18
    v_mul_f32 v55, v55, v18
    v_cvt_pk_bf16_f32 v1, v54, v55
    v_mul_f32 v84, v84, v18
    v_mul_f32 v85, v85, v18
    v_cvt_pk_bf16_f32 v2, v84, v85
    v_mul_f32 v86, v86, v18
    v_mul_f32 v87, v87, v18
    v_cvt_pk_bf16_f32 v3, v86, v87
    v_mul_f32 v48, v48, v18
    v_mul_f32 v49, v49, v18
    v_cvt_pk_bf16_f32 v48, v48, v49
    v_mul_f32 v50, v50, v18
    v_mul_f32 v51, v51, v18
    v_cvt_pk_bf16_f32 v49, v50, v51
    ds_write_b128 v121, v[0:3] offset:3072
    v_fmac_f32 v38, v46, v46
    v_fmac_f32 v38, v47, v47
    v_fmac_f32 v38, v40, v40
    v_fmac_f32 v38, v41, v41
    ds_write_b64 v120, v[48:49] offset:3072
    v_fmac_f32 v38, v42, v42
    v_fmac_f32 v38, v43, v43
    v_fmac_f32 v133, v9, v9
    v_fmac_f32 v133, v10, v10
    v_fmac_f32 v133, v11, v11
    v_fmac_f32 v133, v24, v24
    v_fmac_f32 v133, v25, v25
    v_fmac_f32 v133, v26, v26
    v_fmac_f32 v133, v27, v27
    v_fmac_f32 v133, v12, v12
    v_fmac_f32 v133, v13, v13
    v_fmac_f32 v133, v14, v14
    v_fmac_f32 v133, v15, v15
    v_cvt_pk_bf16_f32 v38, v38, v133
    v_fma_f32 v133, v20, v20, s42
    v_fmac_f32 v133, v21, v21
    v_fmac_f32 v133, v22, v22
    v_fmac_f32 v133, v23, v23
    v_fmac_f32 v133, v96, v96
    v_fmac_f32 v133, v97, v97
    v_fmac_f32 v133, v98, v98
    v_fmac_f32 v133, v99, v99
    v_fmac_f32 v133, v72, v72
    v_fmac_f32 v133, v73, v73
    v_fmac_f32 v133, v74, v74
    v_fmac_f32 v133, v75, v75
    v_cvt_pk_bf16_f32 v39, v133, v133
    ds_write_b64 v130, v[38:39] offset:2048
    v_rcp_f32 v28, v28
    v_lshlrev_b32 v133, 16, v32
    v_and_b32 v32, 0xffff0000, v32
    v_mul_f32 v133, v133, v28
    v_mul_f32 v32, v32, v28
    v_cvt_pk_bf16_f32 v16, v133, v32
    v_lshlrev_b32 v32, 16, v33
    v_and_b32 v33, 0xffff0000, v33
    v_mul_f32 v32, v32, v28
    v_mul_f32 v33, v33, v28
    v_cvt_pk_bf16_f32 v17, v32, v33
    v_lshlrev_b32 v133, 16, v34
    v_and_b32 v34, 0xffff0000, v34
    v_mul_f32 v133, v133, v28
    v_mul_f32 v34, v34, v28
    v_cvt_pk_bf16_f32 v18, v133, v34
    v_lshlrev_b32 v19, 16, v35
    v_and_b32 v35, 0xffff0000, v35
    v_mul_f32 v19, v19, v28
    v_mul_f32 v35, v35, v28
    v_cvt_pk_bf16_f32 v19, v19, v35
    v_lshlrev_b32 v133, 16, v36
    v_and_b32 v36, 0xffff0000, v36
    v_mul_f32 v133, v133, v28
    v_mul_f32 v36, v36, v28
    v_cvt_pk_bf16_f32 v0, v133, v36
    v_lshlrev_b32 v133, 16, v37
    v_and_b32 v37, 0xffff0000, v37
    v_mul_f32 v133, v133, v28
    v_mul_f32 v37, v37, v28
    v_cvt_pk_bf16_f32 v1, v133, v37
    s_waitcnt lgkmcnt(0)
    s_barrier
    ds_write_b128 v138, v[16:19] offset:1536
    v_and_b32 v123, 0xb8000000, v123
    v_mov_b32 v121, 0x3f803f80
    v_cmp_ne_u32 vcc, 0, v123
    s_nop 0
    ds_write_b64 v132, v[0:1] offset:1536
    v_cndmask_b32 v121, 0, v121, vcc
    ds_read_b128 v[36:39], v7 offset:0
    ds_read_b128 v[0:3], v7 offset:1024
    ds_read_b128 v[28:31], v7 offset:2048
    ds_read_b128 v[108:111], v7 offset:3072
    ds_read_b128 v[80:83], v7 offset:4096
    s_waitcnt lgkmcnt(5)
    s_barrier
    s_waitcnt lgkmcnt(4)
    buffer_store_dwordx4 v[36:39], v128, s[28:31], s59 offen sc1
    ds_read_b128 v[32:35], v129 offset:2048
    ds_read_b128 v[16:19], v129 offset:3072
    ds_read_b128 v[104:107], v137 offset:1536
    ds_read_b128 v[100:103], v136 offset:1536
    ds_read_b128 v[92:95], v137 offset:1664
    ds_read_b128 v[84:87], v136 offset:1664
    ds_read_b128 v[76:79], v137 offset:1792
    s_waitcnt lgkmcnt(9)
    buffer_store_dwordx4 v[0:3], v127, s[28:31], s59 offen sc1
    ds_read_b128 v[36:39], v136 offset:1792
    s_waitcnt lgkmcnt(7)
    v_mfma_f32_16x16x32_bf16 v[0:3], v[216:219], v[32:35], 0
    s_waitcnt lgkmcnt(6)
    v_mfma_f32_16x16x32_bf16 v[0:3], v[216:219], v[16:19], v[0:3]
    s_waitcnt lgkmcnt(5)
    v_mfma_f32_16x16x32_bf16 v[16:19], a[216:219], v[104:107], 0
    s_waitcnt lgkmcnt(4)
    v_mfma_f32_16x16x32_bf16 v[16:19], a[220:223], v[100:103], v[16:19]
    s_waitcnt lgkmcnt(3)
    ds_read_b128 v[64:67], v137 offset:0
    ds_read_b128 v[60:63], v136 offset:0
    v_mfma_f32_16x16x32_bf16 v[16:19], a[224:227], v[92:95], v[16:19]
    s_waitcnt lgkmcnt(4)
    ds_read_b128 v[56:59], v137 offset:128
    v_mfma_f32_16x16x32_bf16 v[16:19], a[228:231], v[84:87], v[16:19]
    s_waitcnt lgkmcnt(4)
    buffer_store_dwordx4 v[28:31], v126, s[28:31], s59 offen sc1
    ds_read_b128 v[52:55], v136 offset:128
    v_rsq_f32 v0, v0
    v_mfma_f32_16x16x32_bf16 v[16:19], a[232:235], v[76:79], v[16:19]
    s_waitcnt lgkmcnt(4)
    ds_read_b128 v[48:51], v137 offset:256
    ds_read_b128 v[32:35], v136 offset:256
    v_mfma_f32_16x16x32_bf16 v[16:19], a[236:239], v[36:39], v[16:19]
    v_rsq_f32 v1, v1
    v_mfma_f32_16x16x32_bf16 v[28:31], a[240:243], v[104:107], 0
    v_mul_f32 v0, s43, v0
    v_mul_f32 v1, s43, v1
    v_mfma_f32_16x16x32_bf16 v[28:31], a[244:247], v[100:103], v[28:31]
    v_rsq_f32 v2, v2
    v_mfma_f32_16x16x32_bf16 v[28:31], a[248:251], v[92:95], v[28:31]
    v_mul_f32 v2, s43, v2
    v_mul_f32 v20, v20, v2
    v_mfma_f32_16x16x32_bf16 v[28:31], a[252:255], v[84:87], v[28:31]
    buffer_store_dwordx4 v[108:111], v125, s[28:31], s59 offen sc1
    v_mul_f32 v21, v21, v2
    v_cvt_pk_bf16_f32 v88, v20, v21
    v_mul_f32 v22, v22, v2
    v_mul_f32 v23, v23, v2
    v_mfma_f32_16x16x32_bf16 v[28:31], v[224:227], v[76:79], v[28:31]
    v_cvt_pk_bf16_f32 v89, v22, v23
    v_mul_f32 v96, v96, v2
    v_mfma_f32_16x16x32_bf16 v[28:31], v[228:231], v[36:39], v[28:31]
    v_mul_f32 v97, v97, v2
    v_cvt_pk_bf16_f32 v90, v96, v97
    v_mfma_f32_16x16x32_bf16 v[20:23], v[232:235], v[104:107], 0
    v_mul_f32 v98, v98, v2
    v_mul_f32 v99, v99, v2
    v_mfma_f32_16x16x32_bf16 v[20:23], v[236:239], v[100:103], v[20:23]
    v_cvt_pk_bf16_f32 v91, v98, v99
    v_mul_f32 v72, v72, v2
    v_mfma_f32_16x16x32_bf16 v[20:23], v[240:243], v[92:95], v[20:23]
    ds_write_b128 v135, v[88:91] offset:3072
    v_mfma_f32_16x16x32_bf16 v[20:23], v[244:247], v[84:87], v[20:23]
    buffer_store_dwordx4 v[80:83], v124, s[28:31], s59 offen sc1
    v_mul_f32 v73, v73, v2
    v_cvt_pk_bf16_f32 v136, v72, v73
    v_mul_f32 v74, v74, v2
    v_mul_f32 v75, v75, v2
    v_mfma_f32_16x16x32_bf16 v[20:23], v[248:251], v[76:79], v[20:23]
    v_cvt_pk_bf16_f32 v137, v74, v75
    v_mul_f32 v68, v68, v0
    v_mfma_f32_16x16x32_bf16 v[20:23], v[252:255], v[36:39], v[20:23]
    s_waitcnt lgkmcnt(1)
    ds_write_b64 v134, v[136:137] offset:3072
    v_mfma_f32_16x16x32_bf16 v[36:39], a[216:219], v[64:67], 0
    v_mul_f32 v69, v69, v0
    v_cvt_pk_bf16_f32 v68, v68, v69
    v_mfma_f32_16x16x32_bf16 v[36:39], a[220:223], v[60:63], v[36:39]
    v_mul_f32 v70, v70, v0
    v_mul_f32 v71, v71, v0
    v_mfma_f32_16x16x32_bf16 v[36:39], a[224:227], v[56:59], v[36:39]
    v_cvt_pk_bf16_f32 v69, v70, v71
    v_mul_f32 v44, v44, v0
    v_mfma_f32_16x16x32_bf16 v[36:39], a[228:231], v[52:55], v[36:39]
    v_mul_f32 v45, v45, v0
    v_cvt_pk_bf16_f32 v70, v44, v45
    v_mfma_f32_16x16x32_bf16 v[36:39], a[232:235], v[48:51], v[36:39]
    v_mul_f32 v46, v46, v0
    v_mul_f32 v47, v47, v0
    v_mfma_f32_16x16x32_bf16 v[36:39], a[236:239], v[32:35], v[36:39]
    v_cvt_pk_bf16_f32 v71, v46, v47
    v_mul_f32 v40, v40, v0
    v_mfma_f32_16x16x32_bf16 v[44:47], a[240:243], v[64:67], 0
    ds_write_b128 v135, v[68:71] offset:0
    v_mfma_f32_16x16x32_bf16 v[44:47], a[244:247], v[60:63], v[44:47]
    v_mul_f32 v41, v41, v0
    v_cvt_pk_bf16_f32 v2, v40, v41
    v_mfma_f32_16x16x32_bf16 v[44:47], a[248:251], v[56:59], v[44:47]
    v_mul_f32 v42, v42, v0
    v_mul_f32 v43, v43, v0
    v_mfma_f32_16x16x32_bf16 v[44:47], a[252:255], v[52:55], v[44:47]
    v_cvt_pk_bf16_f32 v3, v42, v43
    v_fma_f32 v7, v16, v16, s42
    v_mfma_f32_16x16x32_bf16 v[44:47], v[224:227], v[48:51], v[44:47]
    ds_write_b64 v134, v[2:3] offset:0
    v_mfma_f32_16x16x32_bf16 v[44:47], v[228:231], v[32:35], v[44:47]
    v_fmac_f32 v7, v17, v17
    v_fmac_f32 v7, v18, v18
    v_mfma_f32_16x16x32_bf16 v[40:43], v[232:235], v[64:67], 0
    v_fmac_f32 v7, v19, v19
    v_fmac_f32 v7, v28, v28
    v_mfma_f32_16x16x32_bf16 v[40:43], v[236:239], v[60:63], v[40:43]
    v_fmac_f32 v7, v29, v29
    v_fmac_f32 v7, v30, v30
    v_mfma_f32_16x16x32_bf16 v[40:43], v[240:243], v[56:59], v[40:43]
    v_fmac_f32 v7, v31, v31
    v_fmac_f32 v7, v20, v20
    v_mfma_f32_16x16x32_bf16 v[40:43], v[244:247], v[52:55], v[40:43]
    v_fmac_f32 v7, v21, v21
    v_fmac_f32 v7, v22, v22
    v_mfma_f32_16x16x32_bf16 v[40:43], v[248:251], v[48:51], v[40:43]
    v_fmac_f32 v7, v23, v23
    v_fma_f32 v133, v36, v36, s42
    v_mfma_f32_16x16x32_bf16 v[40:43], v[252:255], v[32:35], v[40:43]
    s_nop 0
    v_fmac_f32 v133, v37, v37
    v_fmac_f32 v133, v38, v38
    v_fmac_f32 v133, v39, v39
    v_fmac_f32 v133, v44, v44
    v_fmac_f32 v133, v45, v45
    v_fmac_f32 v133, v46, v46
    v_fmac_f32 v133, v47, v47
    v_fmac_f32 v133, v40, v40
    v_fmac_f32 v133, v41, v41
    v_fmac_f32 v133, v42, v42
    v_fmac_f32 v133, v43, v43
    v_cvt_pk_bf16_f32 v120, v133, v7
    ds_write_b64 v130, v[120:121] offset:4096
    v_mul_f32 v8, v8, v1
    v_mul_f32 v9, v9, v1
    v_cvt_pk_bf16_f32 v8, v8, v9
    v_mul_f32 v10, v10, v1
    v_mul_f32 v11, v11, v1
    v_cvt_pk_bf16_f32 v9, v10, v11
    v_mul_f32 v24, v24, v1
    v_mul_f32 v25, v25, v1
    v_cvt_pk_bf16_f32 v10, v24, v25
    v_mul_f32 v26, v26, v1
    v_mul_f32 v27, v27, v1
    v_cvt_pk_bf16_f32 v11, v26, v27
    v_mul_f32 v12, v12, v1
    v_mul_f32 v13, v13, v1
    v_cvt_pk_bf16_f32 v136, v12, v13
    v_mul_f32 v14, v14, v1
    v_mul_f32 v15, v15, v1
    v_cvt_pk_bf16_f32 v137, v14, v15
    ds_write_b128 v135, v[8:11] offset:1536
    s_waitcnt lgkmcnt(1)
    s_barrier
    ds_write_b64 v134, v[136:137] offset:1536
    ds_read_b128 v[8:11], v129 offset:4096
    ds_read_b128 v[0:3], v129 offset:5120
    s_waitcnt lgkmcnt(2)
    s_barrier
    s_waitcnt lgkmcnt(1)
    v_mfma_f32_16x16x32_bf16 v[24:27], v[216:219], v[8:11], 0
    s_waitcnt lgkmcnt(0)
    ds_read_b128 v[48:51], v139 offset:0
    ds_read_b128 v[32:35], v139 offset:1024
    v_mfma_f32_16x16x32_bf16 v[24:27], v[216:219], v[0:3], v[24:27]
    s_nop 0
    ds_read_b128 v[12:15], v139 offset:2048
    s_nop 2
    ds_read_b128 v[8:11], v139 offset:3072
    s_nop 1
    v_rsq_f32 v24, v24
    ds_read_b128 v[0:3], v139 offset:4096
    v_mul_f32 v24, s43, v24
    v_mul_f32 v36, v36, v24
    v_mul_f32 v37, v37, v24
    v_cvt_pk_bf16_f32 v36, v36, v37
    v_mul_f32 v38, v38, v24
    v_mul_f32 v39, v39, v24
    v_cvt_pk_bf16_f32 v37, v38, v39
    v_mul_f32 v44, v44, v24
    v_mul_f32 v45, v45, v24
    s_waitcnt lgkmcnt(4)
    buffer_store_dwordx4 v[48:51], v128, s[28:31], s58 offen sc1
    v_cvt_pk_bf16_f32 v38, v44, v45
    v_mul_f32 v46, v46, v24
    v_mul_f32 v47, v47, v24
    v_cvt_pk_bf16_f32 v39, v46, v47
    v_mul_f32 v40, v40, v24
    v_mul_f32 v41, v41, v24
    v_cvt_pk_bf16_f32 v128, v40, v41
    v_mul_f32 v42, v42, v24
    v_mul_f32 v43, v43, v24
    v_cvt_pk_bf16_f32 v129, v42, v43
    ds_write_b128 v138, v[36:39] offset:0
    v_rsq_f32 v25, v25
    v_cmp_neq_f32 vcc, 0, v26
    v_mul_f32 v25, s43, v25
    s_waitcnt lgkmcnt(1)
    buffer_store_dwordx4 v[32:35], v127, s[28:31], s58 offen sc1
    ds_write_b64 v132, v[128:129] offset:0
    v_mul_f32 v16, v16, v25
    v_mul_f32 v17, v17, v25
    v_cvt_pk_bf16_f32 v16, v16, v17
    v_mul_f32 v18, v18, v25
    v_mul_f32 v19, v19, v25
    v_cvt_pk_bf16_f32 v17, v18, v19
    v_mul_f32 v28, v28, v25
    v_mul_f32 v29, v29, v25
    v_cvt_pk_bf16_f32 v18, v28, v29
    v_mul_f32 v30, v30, v25
    v_mul_f32 v31, v31, v25
    v_cvt_pk_bf16_f32 v19, v30, v31
    v_mul_f32 v20, v20, v25
    v_mul_f32 v21, v21, v25
    v_cvt_pk_bf16_f32 v128, v20, v21
    v_mul_f32 v22, v22, v25
    v_mul_f32 v23, v23, v25
    v_cvt_pk_bf16_f32 v129, v22, v23
    buffer_store_dwordx4 v[12:15], v126, s[28:31], s58 offen sc1
    ds_write_b128 v138, v[16:19] offset:1536
    ds_write_b64 v132, v[128:129] offset:1536
    buffer_store_dwordx4 v[8:11], v125, s[28:31], s58 offen sc1
    s_waitcnt lgkmcnt(0)
    s_barrier
    buffer_store_dwordx4 v[0:3], v124, s[28:31], s58 offen sc1
    ds_read_b128 v[12:15], v131 offset:0
    ds_read_b128 v[8:11], v131 offset:1024
    ds_read_b128 v[0:3], v131 offset:2048
    s_waitcnt lgkmcnt(2)
    buffer_store_dwordx4 v[12:15], v4, s[28:31], 0 offen sc1
    s_waitcnt lgkmcnt(0)
    buffer_store_dwordx4 v[8:11], v5, s[28:31], 0 offen sc1
    buffer_store_dwordx4 v[0:3], v6, s[28:31], 0 offen sc1
    s_nop 4
    s_cbranch_vccnz L_slow
L_end:
    s_endpgm
L_slow:
    s_waitcnt vmcnt(0) lgkmcnt(0)
    s_nop 15
    s_barrier
    s_lshr_b32 s66, s64, 20
    v_mbcnt_lo_u32_b32 v170, -1, 0
    v_mbcnt_hi_u32_b32 v170, -1, v170
    s_load_dwordx16 s[4:19], s[0:1], 0
    s_load_dwordx4 s[20:23], s[0:1], 64
    s_load_dwordx2 s[38:39], s[0:1], 80
    s_lshr_b32 s88, s2, 3
    s_lshl2_add_u32 s88, s88, s68
    v_lshlrev_b32 v17, 7, v170
    s_mul_i32 s89, s88, 576
    s_mul_i32 s88, s88, 1728
    v_min_u32 v16, 1664, v17
    v_min_u32 v7, 512, v17
    s_mov_b32 s34, 221184
    s_mov_b32 s35, 0x20000
    s_mov_b32 s78, 73728
    s_mov_b32 s79, 0x20000
    v_and_b32 v158, 15, v170
    v_lshrrev_b32 v5, 4, v170
    v_lshrrev_b32 v24, 2, v158
    v_and_b32 v131, 3, v158
    s_mul_i32 s87, s68, 192
    v_mad_u32_u24 v19, v158, 12, s87
    v_lshlrev_b32 v6, 1, v158
    v_lshlrev_b32 v4, 1, v24
    v_lshl_add_u32 v4, v5, 5, v4
    s_movk_i32 s86, 384
    s_mov_b32 s26, 100270464
    s_mov_b32 s27, 0x20000
    s_mov_b32 s30, 0
    s_mov_b32 s31, 0x20000
    s_mul_i32 s96, s68, 288
    s_and_b32 s97, s68, 1
    s_lshl_b32 s97, s97, 2
    s_mov_b32 s98, 193536
    s_waitcnt lgkmcnt(0)
    s_mov_b32 s24, s4
    s_mov_b32 s25, s5
    s_mov_b32 s32, s6
    s_mov_b32 s33, s7
    s_mov_b32 s76, s8
    s_mov_b32 s77, s9
    buffer_load_dword a254, v16, s[32:35], s88 offen
    buffer_load_dword a253, v7, s[76:79], s89 offen
    s_load_dwordx2 s[82:83], s[10:11], 0
    s_movk_i32 s18, 676
    s_mov_b32 s19, 0x20000
    buffer_load_dwordx3 v[28:30], v19, s[16:19], 0 offen
    s_mov_b32 s99, 589824
    v_add_u32 v7, s96, v170
    v_mul_u32_u24 v129, 2731, v7
    v_mul_u32_u24 v11, 6242, v7
    v_lshrrev_b32 v129, 16, v129
    s_lshr_b32 s94, s2, 3
    s_mul_i32 s70, s94, 168
    global_load_ushort v16, v6, s[12:13]
    v_lshrrev_b32 v11, 20, v11
    v_and_or_b32 v8, v129, 3, s97
    v_xor_b32 v8, v7, v8
    v_lshl_add_u32 v128, v8, 4, s99
    v_mad_u32_u24 v128, v11, s98, v128
    s_mul_i32 s69, s2, 20
    s_lshl3_add_u32 s69, s94, s69
    global_load_ushort v17, v6, s[12:13] offset:32
    v_add_u32 v10, 64, v7
    v_mul_u32_u24 v31, 2731, v10
    v_mul_u32_u24 v6, 6242, v10
    v_lshrrev_b32 v31, 16, v31
    v_lshrrev_b32 v6, 20, v6
    s_add_u32 s70, s70, 140
    s_movk_i32 s62, 2688
    global_load_ushort v160, v4, s[14:15] offset:0
    v_and_or_b32 v9, v31, 3, s97
    v_xor_b32 v9, v10, v9
    v_lshl_add_u32 v127, v9, 4, s99
    v_mad_u32_u24 v127, v6, s98, v127
    v_add_u32 v130, 128, v7
    s_movk_i32 s71, 20
    s_movk_i32 s73, 28
    global_load_ushort v162, v4, s[14:15] offset:8
    v_mul_u32_u24 v163, 2731, v130
    v_mul_u32_u24 v18, 6242, v130
    v_lshrrev_b32 v163, 16, v163
    v_lshrrev_b32 v18, 20, v18
    v_and_or_b32 v10, v163, 3, s97
    s_mov_b32 s93, 1769472
    s_mul_i32 s54, s68, 5120
    global_load_ushort v161, v4, s[14:15] offset:16
    v_xor_b32 v10, v130, v10
    v_lshl_add_u32 v126, v10, 4, s99
    v_mad_u32_u24 v126, v18, s98, v126
    v_add_u32 v27, 192, v7
    v_mul_u32_u24 v25, 2731, v27
    s_mov_b32 s63, 1180032
    s_mul_i32 s95, s68, -44
    global_load_ushort v130, v4, s[14:15] offset:24
    v_mul_u32_u24 v4, 6242, v27
    v_lshrrev_b32 v25, 16, v25
    v_lshrrev_b32 v4, 20, v4
    v_and_or_b32 v26, v25, 3, s97
    v_xor_b32 v26, v27, v26
    v_lshl_add_u32 v125, v26, 4, s99
    v_mad_u32_u24 v125, v4, s98, v125
    v_add_u32 v26, 256, v7
    v_mul_u32_u24 v156, 2731, v26
    v_mul_u32_u24 v7, 6242, v26
    v_lshrrev_b32 v156, 16, v156
    v_lshrrev_b32 v7, 20, v7
    v_and_or_b32 v124, v156, 3, s97
    v_xor_b32 v124, v26, v124
    v_lshl_add_u32 v124, v124, 4, s99
    v_mad_u32_u24 v124, v7, s98, v124
    s_cmp_ge_u32 s2, 240
    s_cbranch_scc1 L_bndS
L_bndrS:
    s_mul_i32 s94, s69, 58255
    s_lshr_b32 s94, s94, 22
    s_mul_i32 s94, s94, s63
    s_mul_i32 s72, s69, s62
    s_add_u32 s72, s72, s94
    v_lshl_or_b32 v157, v170, 4, 2.0
    s_sub_u32 s94, s73, 1
    s_max_u32 s94, s94, 20
    s_movk_i32 s99, -24
    s_add_u32 m0, s54, 0
    v_and_b32 v18, -4, v163
    s_mul_i32 s85, s68, 96
    s_sub_u32 s100, s85, 1024
    buffer_load_dwordx4 v128, s[24:27], s72 offen nt lds
    s_add_u32 m0, s54, 1024
    v_mad_u32_u24 v11, v18, 3, v163
    v_add_u32 v11, s95, v11
    v_mad_i32_i24 v10, v163, s99, v10
    v_med3_u32 v18, v11, 20, s94
    v_add_u32 v18, s70, v18
    v_add_u32 v163, s69, v11
    s_sub_u32 s87, s85, 2048
    s_movk_i32 s91, 1152
    buffer_load_dwordx4 v127, s[24:27], s72 offen nt lds
    v_cmp_gt_u32 vcc, s71, v11
    v_lshl_add_u32 v10, v10, 4, s93
    s_add_u32 m0, s54, 43008
    v_cndmask_b32 v163, v18, v163, vcc
    v_mul_u32_u24 v18, 58255, v163
    v_mad_u32_u24 v10, v163, s62, v10
    v_lshrrev_b32 v18, 22, v18
    v_mad_u32_u24 v10, v18, s63, v10
    s_mul_i32 s90, s68, 3072
    s_add_u32 s90, s90, 61440
    buffer_load_dwordx4 v10, s[24:27], 0 offen  lds
    v_lshlrev_b32 v11, 16, v11
    s_add_u32 m0, s54, 2048
    v_and_b32 v163, -4, v31
    v_mad_u32_u24 v18, v163, 3, v31
    v_add_u32 v18, s95, v18
    v_mad_i32_i24 v9, v31, s99, v9
    v_med3_u32 v163, v18, 20, s94
    s_mov_b32 s28, s22
    s_mov_b32 s29, s23
    buffer_load_dwordx4 v126, s[24:27], s72 offen nt lds
    v_add_u32 v163, s70, v163
    v_add_u32 v31, s69, v18
    v_cmp_gt_u32 vcc, s71, v18
    v_lshl_add_u32 v9, v9, 4, s93
    s_add_u32 m0, s54, 41984
    v_cndmask_b32 v31, v163, v31, vcc
    v_mul_u32_u24 v163, 58255, v31
    v_mad_u32_u24 v9, v31, s62, v9
    v_lshrrev_b32 v163, 22, v163
    v_mad_u32_u24 v9, v163, s63, v9
    s_mov_b32 s41, 0x2a8cbccc
    s_mov_b32 s42, 0x38fba882
    buffer_load_dwordx4 v9, s[24:27], 0 offen  lds
    v_lshl_or_b32 v11, v18, 8, v11
    s_add_u32 m0, s54, 3072
    v_cmp_gt_u32 vcc, 32, v170
    v_and_b32 v31, -4, v129
    v_mad_u32_u24 v18, v31, 3, v129
    v_cndmask_b32 v124, v157, v124, vcc
    v_add_u32 v18, s95, v18
    s_mov_b32 s43, 0x415db3d7
    s_mov_b32 s44, 61440
    buffer_load_dwordx4 v125, s[24:27], s72 offen nt lds
    s_add_u32 m0, s54, 4096
    v_mad_i32_i24 v8, v129, s99, v8
    v_med3_u32 v31, v18, 20, s94
    v_add_u32 v31, s70, v31
    v_add_u32 v129, s69, v18
    v_cmp_gt_u32 vcc, s71, v18
    v_lshl_add_u32 v8, v8, 4, s93
    s_mul_i32 s93, s68, 6
    s_lshl_b32 s94, s97, 1
    buffer_load_dwordx4 v124, s[24:27], s72 offen nt lds
    v_cndmask_b32 v129, v31, v129, vcc
    v_mul_u32_u24 v31, 58255, v129
    v_mad_u32_u24 v8, v129, s62, v8
    v_lshrrev_b32 v31, 22, v31
    v_mad_u32_u24 v8, v31, s63, v8
    s_add_u32 m0, s54, 40960
    v_lshl_or_b32 v11, v18, 0, v11
    s_mov_b32 s45, 40960
    s_mov_b32 s46, 20480
    buffer_load_dwordx4 v8, s[24:27], 0 offen nt lds
    v_mul_u32_u24 v27, 10923, v170
    v_lshrrev_b32 v149, 17, v27
    v_lshrrev_b32 v27, 16, v27
    v_mad_i32_i24 v163, v27, -6, v170
    v_bitop3_b32 v149, v149, v27, 4 bitop3:0x28
    v_lshl_add_u32 v163, v163, 4, s85
    v_mul_u32_u24 v149, 3, v149
    v_xor_b32 v27, v27, v149
    v_mad_u32_u24 v149, v27, s91, v163
    v_add_u32 v18, 64, v170
    v_mul_u32_u24 v129, 10923, v18
    v_lshrrev_b32 v121, 17, v129
    v_lshrrev_b32 v129, 16, v129
    v_mad_i32_i24 v31, v129, -6, v18
    v_bitop3_b32 v121, v121, v129, 4 bitop3:0x28
    v_lshl_add_u32 v31, v31, 4, s100
    v_mul_u32_u24 v121, 3, v121
    v_xor_b32 v129, v129, v121
    v_mad_u32_u24 v121, v129, s91, v31
    v_add_u32 v18, 128, v170
    v_mul_u32_u24 v25, 10923, v18
    v_lshrrev_b32 v26, 17, v25
    v_lshrrev_b32 v25, 16, v25
    v_mad_i32_i24 v18, v25, -6, v18
    v_bitop3_b32 v26, v26, v25, 4 bitop3:0x28
    v_lshl_add_u32 v18, v18, 4, s87
    v_mul_u32_u24 v26, 3, v26
    v_xor_b32 v25, v25, v26
    v_mad_u32_u24 v26, v25, s91, v18
    v_mad_u32_u24 v27, v27, s86, v163
    v_mad_u32_u24 v146, v129, s86, v31
    v_mad_u32_u24 v78, v25, s86, v18
    s_add_u32 m0, s90, 0
    s_mov_b32 s92, 0
    buffer_load_dwordx4 v149, s[32:35], s92 offen offset:0 lds
    v_mov_b32 v18, 0x3f803f80
    v_cmp_eq_u32 vcc, 0, v131
    v_and_b32 v25, 1, v170
    v_lshlrev_b32 v25, 4, v25
    v_cndmask_b32 v220, 0, v18, vcc
    v_cndmask_b32 v221, 0, v18, vcc
    v_cndmask_b32 v222, 0, v18, vcc
    v_cndmask_b32 v223, 0, v18, vcc
    v_mov_b32 v18, 0x3f80
    v_lshlrev_b32 v18, v25, v18
    v_cmp_gt_u32 vcc, 2, v131
    v_mov_b32 v171, 0
    v_mov_b32 v167, 0
    v_cndmask_b32 v216, 0, v18, vcc
    v_cndmask_b32 v218, 0, v18, vcc
    v_cmp_le_u32 vcc, 2, v131
    v_mov_b32 v163, 0
    v_mov_b32 v159, 0
    v_cndmask_b32 v217, 0, v18, vcc
    v_cndmask_b32 v219, 0, v18, vcc
    v_cmp_eq_u32 vcc, v5, v24
    v_mov_b32 v150, 0
    v_mov_b32 v151, 0
    v_cndmask_b32 v168, 0, v216, vcc
    v_cndmask_b32 v169, 0, v217, vcc
    v_mov_b32 v144, 0
    v_mov_b32 v145, 0
    v_mov_b32 v138, 0
    v_mov_b32 v139, 0
    v_lshrrev_b32 v25, 1, v5
    v_lshl_add_u32 v18, v5, 2, v24
    v_lshl_add_u32 v18, v25, 3, v18
    v_mul_u32_u24 v18, 96, v18
    v_add_u32 v18, s90, v18
    v_lshl_add_u32 v6, v131, 4, v18
    v_lshl_add_u32 v7, v131, 3, v18
    s_waitcnt lgkmcnt(0)
    s_lshl_b32 s84, s68, 4
    s_lshr_b64 s[82:83], s[82:83], s84
    s_lshl_b32 s82, s82, 16
    v_mov_b32 v4, s82
    v_min_f32 v4, 0x40930000, v4
    v_max_f32 v4, 0xc2c80000, v4
    v_mul_f32 v4, 0x3fb8aa3b, v4
    v_exp_f32 v4, v4
    v_mov_b32 v18, 0
    v_cvt_pk_bf16_f32 v4, v4, v4
    v_lshlrev_b32 v4, 16, v4
    v_mul_f32 v4, 0x4038aa3b, v4
    v_mov_b32 v31, 0
    v_readfirstlane_b32 s55, v4
    v_add_f32 v4, v4, v4
    v_mul_u32_u24 v132, 5120, v5
    v_readfirstlane_b32 s52, v4
    v_add_u32 v132, v19, v132
    s_mov_b32 s84, 0x41b8aa3b
    v_mov_b32 v156, 0xc138aa3b
    v_mul_u32_u24 v4, 5120, v24
    v_mad_u32_u24 v4, v131, s86, v4
    v_and_b32 v19, 7, v158
    v_xor_b32 v25, v19, v5
    v_lshl_add_u32 v148, v25, 4, v4
    v_xor_b32 v147, 64, v148
    v_add_u32 v137, 40960, v148
    s_mov_b32 s47, 0
    s_mov_b32 s57, s72
    buffer_load_dwordx4 v121, s[32:35], s92 offen offset:1024 lds
    v_xor_b32 v136, 64, v137
    v_add_u32 v4, 61440, v4
    v_add_u32 v25, s93, v5
    v_xor_b32 v25, v19, v25
    v_lshl_add_u32 v135, v25, 4, v4
    v_lshrrev_b32 v25, 1, v5
    v_add3_u32 v25, v25, s93, 4
    s_add_u32 s93, s54, 20480
    s_mov_b32 s58, 0
    buffer_load_dwordx4 v26, s[32:35], s92 offen offset:2048 lds
    s_add_u32 m0, s90, 12288
    s_mov_b32 s92, 36864
    v_xor_b32 v25, v19, v25
    v_lshl_add_u32 v25, v25, 4, v4
    v_and_b32 v4, 1, v5
    v_lshl_add_u32 v134, v4, 3, v25
    v_lshlrev_b32 v4, 4, v170
    s_mov_b32 s59, 0
    s_mov_b32 s60, 0
    buffer_load_dwordx4 v149, s[32:35], s92 offen offset:0 lds
    s_waitcnt vmcnt(16)
    v_lshl_or_b32 v16, v17, 16, v16
    v_cmp_gt_u32 vcc, 16, v170
    v_mov_b32 v17, 0
    v_add_u32 v133, s93, v4
    v_cndmask_b32 v19, 0, v16, vcc
    v_cndmask_b32 v16, 0, v16, vcc
    v_add_u32 v129, 81920, v4
    v_mfma_f32_16x16x16_bf16 v[0:3], v[18:19], v[28:29], 0
    s_waitcnt vmcnt(14)
    s_lshr_b32 s93, s68, 1
    v_lshl_or_b32 v160, v162, 16, v160
    v_mul_u32_u24 v4, 1792, v5
    v_mfma_f32_16x16x16_bf16 v[12:15], v[16:17], v[28:29], 0
    s_lshl_b32 s93, s93, 10
    v_mov_b32 v122, 0
    v_mul_u32_u24 v76, 48, v24
    v_mfma_f32_16x16x16_bf16 v[20:23], v[16:17], v[30:31], 0
    s_waitcnt vmcnt(12)
    s_add_u32 s93, s93, s94
    buffer_load_dwordx4 v121, s[32:35], s92 offen offset:1024 lds
    v_lshl_or_b32 v161, v130, 16, v161
    v_max_f32 v0, 0, v0
    v_max_f32 v12, 0, v12
    v_max_f32 v13, 0, v13
    v_max_f32 v14, 0, v14
    v_max_f32 v15, 0, v15
    v_cvt_pk_bf16_f32 v12, v12, v13
    v_cvt_pk_bf16_f32 v13, v14, v15
    v_max_f32 v1, 0, v1
    v_max_f32 v2, 0, v2
    v_mfma_f32_16x16x16_bf16 v[16:19], v[160:161], v[12:13], 0
    s_mov_b32 s65, -1
    v_max_f32 v3, 0, v3
    v_cvt_pk_bf16_f32 v0, v0, v1
    v_cvt_pk_bf16_f32 v1, v2, v3
    v_max_f32 v20, 0, v20
    v_max_f32 v21, 0, v21
    v_mfma_f32_16x16x16_bf16 v[12:15], v[160:161], v[0:1], 0
    s_mov_b32 s61, 1
    v_max_f32 v22, 0, v22
    v_max_f32 v23, 0, v23
    v_cvt_pk_bf16_f32 v20, v20, v21
    v_cvt_pk_bf16_f32 v21, v22, v23
    v_cvt_pk_bf16_f32 v16, v16, v16
    v_lshlrev_b32 v16, 16, v16
    v_mfma_f32_16x16x16_bf16 v[0:3], v[160:161], v[20:21], 0
    s_movk_i32 s4, 112
    v_mul_f32 v16, 0xbfb8aa3b, v16
    v_cvt_pk_bf16_f32 v12, v12, v12
    v_exp_f32 v16, v16
    v_lshlrev_b32 v12, 16, v12
    v_add_f32 v16, 1.0, v16
    v_rcp_f32 v16, v16
    v_mul_f32 v12, 0xbfb8aa3b, v12
    v_cvt_pk_bf16_f32 v16, v16, v16
    v_lshlrev_b32 v16, 16, v16
    v_fma_f32 v16, v16, s84, v156
    s_mov_b32 s5, 0
    s_mov_b32 s6, 0
    ds_write_b32 v132, v16 offset:44032
    v_exp_f32 v12, v12
    v_cvt_pk_bf16_f32 v0, v0, v0
    v_add_f32 v12, 1.0, v12
    v_rcp_f32 v12, v12
    v_lshlrev_b32 v0, 16, v0
    v_cvt_pk_bf16_f32 v12, v12, v12
    v_lshlrev_b32 v12, 16, v12
    v_fma_f32 v12, v12, s84, v156
    s_mov_b32 s12, 0
    s_mov_b32 s64, 3
    ds_write_b32 v132, v12 offset:44036
    v_mul_f32 v0, 0xbfb8aa3b, v0
    v_exp_f32 v0, v0
    v_add_u32 v130, s93, v129
    v_add_f32 v0, 1.0, v0
    v_rcp_f32 v0, v0
    s_mul_i32 s93, s68, 7168
    v_cvt_pk_bf16_f32 v0, v0, v0
    v_lshlrev_b32 v0, 16, v0
    v_fma_f32 v0, v0, s84, v156
    s_add_u32 s93, s93, 135168
    s_mov_b32 s10, 81924
    ds_write_b32 v132, v0 offset:44040
    v_add_u32 v25, s93, v4
    v_mul_u32_u24 v4, 112, v158
    v_add_u32 v156, v4, v25
    v_subrev_u32 v156, 28672, v156
    v_cmp_eq_u32 vcc, 0, v24
    v_add_u32 v4, 16, v25
    s_mov_b32 s11, 0x20000
    v_cndmask_b32 v132, v157, v25, vcc
    v_cmp_eq_u32 vcc, 3, v131
    s_add_u32 s101, s54, 44032
    v_lshl_add_u32 v76, v131, 2, v76
    v_cndmask_b32 v132, v132, v4, vcc
    v_mul_u32_u24 v4, 1792, v24
    v_lshl_add_u32 v4, v5, 3, v4
    v_lshl_add_u32 v4, v131, 1, v4
    v_add_u32 v4, s93, v4
    v_cmp_gt_u32 vcc, 3, v5
    v_mov_b32 v123, v4
    s_add_u32 s93, s69, 1
    v_cndmask_b32 v131, v157, v4, vcc
    s_mul_i32 s94, s93, 58255
    s_lshr_b32 s94, s94, 22
    s_mul_i32 s94, s94, s63
    s_mul_i32 s56, s93, s62
    s_add_u32 s56, s56, s94
    s_sub_u32 s93, s71, 1
    s_cmp_eq_u32 s68, 0
    s_cselect_b32 s13, s93, -1
    s_cmp_gt_u32 s73, 20
    s_cselect_b32 s13, s13, -1
    s_and_b32 s93, s2, -8
    s_sub_u32 s93, 81920, s93
    s_sub_u32 s8, s38, s93
    s_waitcnt lgkmcnt(0)
    s_barrier
    s_subb_u32 s9, s39, 0
    s_mov_b32 s39, 0x00010001
    v_mul_u32_u24 v79, 48, v5
    v_add_u32 v174, 0, v76
    v_mul_u32_u24 v4, 37, v174
    v_lshrrev_b32 v4, 10, v4
    v_mad_u32_u24 v174, v4, 24, v174
    v_add_u32 v174, s101, v174
    v_add_u32 v77, 16, v76
    v_mul_u32_u24 v4, 37, v77
    v_lshrrev_b32 v4, 10, v4
    v_mad_u32_u24 v77, v4, 24, v77
    v_add_u32 v77, s101, v77
    v_add_u32 v4, 32, v76
    v_mul_u32_u24 v120, 37, v4
    v_lshrrev_b32 v120, 10, v120
    v_mad_u32_u24 v4, v120, 24, v4
    v_add_u32 v4, s101, v4
    v_add_u32 v173, 0, v79
    v_mul_u32_u24 v120, 37, v173
    v_lshrrev_b32 v120, 10, v120
    v_mad_u32_u24 v173, v120, 24, v173
    v_add_u32 v172, 4, v79
    v_mul_u32_u24 v120, 37, v172
    v_lshrrev_b32 v120, 10, v120
    v_mad_u32_u24 v172, v120, 24, v172
    v_add_u32 v165, 8, v79
    v_mul_u32_u24 v120, 37, v165
    v_lshrrev_b32 v120, 10, v120
    v_mad_u32_u24 v165, v120, 24, v165
    v_add_u32 v166, 12, v79
    v_mul_u32_u24 v120, 37, v166
    v_lshrrev_b32 v120, 10, v120
    v_mad_u32_u24 v166, v120, 24, v166
    v_add_u32 v164, 16, v79
    v_mul_u32_u24 v120, 37, v164
    v_lshrrev_b32 v120, 10, v120
    v_mad_u32_u24 v164, v120, 24, v164
    v_add_u32 v161, 20, v79
    v_mul_u32_u24 v120, 37, v161
    v_lshrrev_b32 v120, 10, v120
    v_mad_u32_u24 v161, v120, 24, v161
    v_add_u32 v162, 24, v79
    v_mul_u32_u24 v120, 37, v162
    v_lshrrev_b32 v120, 10, v120
    v_mad_u32_u24 v162, v120, 24, v162
    v_add_u32 v25, 28, v79
    v_mul_u32_u24 v24, 37, v25
    v_lshrrev_b32 v24, 10, v24
    v_mad_u32_u24 v25, v24, 24, v25
    v_add_u32 v160, 32, v79
    v_mul_u32_u24 v24, 37, v160
    v_lshrrev_b32 v24, 10, v24
    v_mad_u32_u24 v160, v24, 24, v160
    v_add_u32 v24, 36, v79
    v_mul_u32_u24 v120, 37, v24
    v_lshrrev_b32 v120, 10, v120
    v_mad_u32_u24 v24, v120, 24, v24
    v_add_u32 v120, 40, v79
    v_mul_u32_u24 v175, 37, v120
    v_lshrrev_b32 v175, 10, v175
    v_mad_u32_u24 v120, v175, 24, v120
    v_add_u32 v175, 44, v79
    v_mul_u32_u24 v79, 37, v175
    v_lshrrev_b32 v79, 10, v79
    s_lshr_b32 s93, s68, 1
    s_mul_i32 s93, s93, 30720
    buffer_load_dwordx4 v26, s[32:35], s92 offen offset:2048 lds
    s_add_u32 m0, s90, 24576
    s_mov_b32 s92, 73728
    ds_read_b32 v208, v174
    v_mad_u32_u24 v175, v79, 24, v175
    v_lshl_add_u32 v79, v5, 4, v76
    v_mul_u32_u24 v209, 37, v79
    v_lshrrev_b32 v209, 10, v209
    v_mad_u32_u24 v79, v209, 24, v79
    v_mov_b32 v205, 336
    v_cmp_gt_u32 vcc, 3, v5
    v_sub_u32 v204, v174, v173
    s_and_b32 s94, s68, 1
    v_cndmask_b32 v79, v205, v79, vcc
    v_sub_u32 v79, s101, v79
    s_mul_i32 s94, s94, -2304
    s_add_u32 s93, s93, s94
    ds_read_b32 v204, v204 offset:336
    v_sub_u32 v205, v174, v172
    v_sub_u32 v206, v174, v165
    v_sub_u32 v207, v174, v166
    v_sub_u32 v200, v174, v164
    s_lshl_b32 s94, s97, 4
    buffer_load_dwordx4 v149, s[32:35], s92 offen offset:0 lds
    ds_read_b32 v205, v205 offset:336
    v_sub_u32 v201, v174, v161
    v_sub_u32 v202, v174, v162
    v_sub_u32 v203, v174, v25
    v_sub_u32 v196, v174, v160
    v_sub_u32 v197, v174, v24
    ds_read_b32 v206, v206 offset:336
    buffer_load_dwordx4 v121, s[32:35], s92 offen offset:1024 lds
    v_sub_u32 v198, v174, v120
    v_sub_u32 v199, v174, v175
    v_sub_u32 v192, v77, v173
    v_sub_u32 v193, v77, v172
    ds_read_b32 v207, v207 offset:336
    v_sub_u32 v194, v77, v165
    v_sub_u32 v195, v77, v166
    v_sub_u32 v188, v77, v164
    v_sub_u32 v189, v77, v161
    v_sub_u32 v190, v77, v162
    ds_read_b32 v200, v200 offset:336
    v_sub_u32 v191, v77, v25
    v_sub_u32 v184, v77, v160
    v_sub_u32 v185, v77, v24
    v_sub_u32 v186, v77, v120
    v_sub_u32 v187, v77, v175
    ds_read_b32 v201, v201 offset:336
    buffer_load_dwordx4 v26, s[32:35], s92 offen offset:2048 lds
    s_add_u32 m0, s90, 36864
    s_mov_b32 s92, 110592
    v_sub_u32 v180, v4, v173
    v_sub_u32 v181, v4, v172
    ds_read_b32 v202, v202 offset:336
    v_sub_u32 v182, v4, v165
    v_sub_u32 v183, v4, v166
    v_sub_u32 v176, v4, v164
    v_sub_u32 v177, v4, v161
    v_sub_u32 v178, v4, v162
    s_waitcnt vmcnt(9)
    s_barrier
    ds_read_b32 v203, v203 offset:336
    v_sub_u32 v179, v4, v25
    v_sub_u32 v172, v4, v160
    v_sub_u32 v173, v4, v24
    v_sub_u32 v174, v4, v120
    v_sub_u32 v175, v4, v175
    ds_read_b32 v196, v196 offset:336
    v_mov_b32 v120, 0xf149f2ca
    v_and_b32 v25, 8, v158
    v_add_u32 v25, v25, v158
    v_mul_u32_u24 v25, 96, v25
    v_add_u32 v25, s90, v25
    ds_read_b32 v197, v197 offset:336
    buffer_load_dwordx4 v149, s[32:35], s92 offen offset:0 lds
    v_lshl_add_u32 v24, v5, 4, v25
    v_lshl_add_u32 v19, v5, 3, v25
    v_add_u32 v17, s93, v24
    v_add_u32 v16, s93, v19
    s_lshr_b32 s93, s68, 1
    s_mul_i32 s93, s93, 5120
    ds_read_b32 v198, v198 offset:336
    v_lshlrev_b32 v18, 4, v5
    v_add_u32 v18, 4608, v18
    s_add_u32 s93, s93, s94
    v_add_u32 v25, s93, v18
    v_cmp_eq_u32 vcc, 0, v158
    ds_read_b32 v199, v199 offset:336
    s_nop 0
    v_cndmask_b32 v25, v157, v25, vcc
    buffer_load_dwordx4 v121, s[32:35], s92 offen offset:1024 lds
    ds_read_b32 v211, v79 offset:672
    ds_read_b32 v192, v192 offset:336
    ds_read_b32 v193, v193 offset:336
    ds_read_b32 v194, v194 offset:336
    buffer_load_dwordx4 v26, s[32:35], s92 offen offset:2048 lds
    s_add_u32 m0, s90, 49152
    s_mov_b32 s92, 147456
    ds_read_b32 v195, v195 offset:336
    ds_read_b32 v188, v188 offset:336
    ds_read_b32 v189, v189 offset:336
    buffer_load_dwordx4 v149, s[32:35], s92 offen offset:0 lds
    ds_read_b32 v190, v190 offset:336
    ds_read_b32 v191, v191 offset:336
    ds_read_b32 v184, v184 offset:336
    buffer_load_dwordx4 v121, s[32:35], s92 offen offset:1024 lds
    ds_read_b32 v185, v185 offset:336
    ds_read_b32 v186, v186 offset:336
    ds_read_b32 v187, v187 offset:336
    ds_read_b32 v209, v77
    buffer_load_dwordx4 v26, s[32:35], s92 offen offset:2048 lds
    s_add_u32 m0, s90, 61440
    s_mov_b32 s92, 184320
    ds_read_b32 v180, v180 offset:336
    ds_read_b32 v181, v181 offset:336
    ds_read_b32 v182, v182 offset:336
    buffer_load_dwordx4 v149, s[32:35], s92 offen offset:0 lds
    ds_read_b32 v183, v183 offset:336
    ds_read_b32 v176, v176 offset:336
    ds_read_b32 v177, v177 offset:336
    buffer_load_dwordx4 v121, s[32:35], s92 offen offset:1024 lds
    ds_read_b32 v178, v178 offset:336
    ds_read_b32 v179, v179 offset:336
    ds_read_b32 v172, v172 offset:336
    ds_read_b32 v173, v173 offset:336
    buffer_load_dwordx4 v26, s[32:35], s92 offen offset:2048 lds
    ds_read_b32 v174, v174 offset:336
    ds_read_b32 v175, v175 offset:336
    ds_read_b32 v210, v4
    s_waitcnt vmcnt(15)
    ds_read_b64_tr_b16 a[0:1], v7 offset:0
    ds_read_b64_tr_b16 a[2:3], v7 offset:768
    ds_read_b64_tr_b16 a[24:25], v7 offset:32
    ds_read_b64_tr_b16 a[26:27], v7 offset:800
    ds_read_b64_tr_b16 a[48:49], v7 offset:64
    ds_read_b64_tr_b16 a[50:51], v7 offset:832
    s_add_u32 m0, s90, 0
    s_mov_b32 s92, 384
    s_waitcnt vmcnt(12)
    ds_read_b64_tr_b16 a[4:5], v7 offset:12288
    ds_read_b64_tr_b16 a[6:7], v7 offset:13056
    ds_read_b64_tr_b16 a[28:29], v7 offset:12320
    ds_read_b64_tr_b16 a[30:31], v7 offset:13088
    ds_read_b64_tr_b16 a[52:53], v7 offset:12352
    ds_read_b64_tr_b16 a[54:55], v7 offset:13120
    s_waitcnt vmcnt(9)
    ds_read_b64_tr_b16 a[8:9], v7 offset:24576
    ds_read_b64_tr_b16 a[10:11], v7 offset:25344
    ds_read_b64_tr_b16 a[32:33], v7 offset:24608
    s_waitcnt lgkmcnt(15)
    s_cmp_ge_u32 s2, 247
    s_cbranch_scc1 L_maskS
L_nomaskS:
    v_cmp_gt_u32 vcc, 16, v170
    v_readlane_b32 s84, v211, 48
    ds_read_b64_tr_b16 a[34:35], v7 offset:25376
    v_cndmask_b32 v208, v120, v208, vcc
    v_cndmask_b32 v209, v120, v209, vcc
    v_cndmask_b32 v210, v120, v210, vcc
    v_cmp_gt_u32 vcc, 49, v170
    ds_read_b64_tr_b16 a[56:57], v7 offset:24640
    s_waitcnt lgkmcnt(10)
    buffer_load_dwordx4 v149, s[32:35], s92 offen offset:0 lds
    ds_read_b64_tr_b16 a[58:59], v7 offset:25408
    v_cndmask_b32 v211, v120, v211, vcc
    s_waitcnt vmcnt(7)
    ds_read_b64_tr_b16 a[12:13], v7 offset:36864
    ds_read_b64_tr_b16 a[14:15], v7 offset:37632
    buffer_load_dwordx4 v121, s[32:35], s92 offen offset:1024 lds
    ds_read_b64_tr_b16 a[36:37], v7 offset:36896
    ds_read_b64_tr_b16 a[38:39], v7 offset:37664
    ds_read_b64_tr_b16 a[60:61], v7 offset:36928
    ds_read_b64_tr_b16 a[62:63], v7 offset:37696
    buffer_load_dwordx4 v26, s[32:35], s92 offen offset:2048 lds
    s_add_u32 m0, s90, 12288
    s_mov_b32 s92, 37248
    ds_read_b128 v[60:63], v148 offset:40960
    ds_read_b128 v[56:59], v147 offset:40960
    s_waitcnt lgkmcnt(10)
    buffer_load_dwordx4 v149, s[32:35], s92 offen offset:0 lds
    ds_read_b128 v[52:55], v148 offset:41088
    ds_read_b128 v[48:51], v147 offset:41088
    buffer_load_dwordx4 v121, s[32:35], s92 offen offset:1024 lds
    ds_read_b128 v[40:43], v148 offset:41216
    ds_read_b128 v[0:3], v147 offset:41216
    buffer_load_dwordx4 v26, s[32:35], s92 offen offset:2048 lds
    s_add_u32 m0, s90, 24576
    s_mov_b32 s92, 74112
    s_waitcnt vmcnt(9)
    ds_read_b64_tr_b16 a[16:17], v7 offset:49152
    ds_read_b64_tr_b16 a[18:19], v7 offset:49920
    ds_read_b64_tr_b16 a[40:41], v7 offset:49184
    ds_read_b64_tr_b16 a[42:43], v7 offset:49952
    ds_read_b64_tr_b16 a[64:65], v7 offset:49216
    ds_read_b64_tr_b16 a[66:67], v7 offset:49984
    s_waitcnt lgkmcnt(6)
    buffer_load_dwordx4 v149, s[32:35], s92 offen offset:0 lds
    buffer_load_dwordx4 v121, s[32:35], s92 offen offset:1024 lds
    buffer_load_dwordx4 v26, s[32:35], s92 offen offset:2048 lds
    s_add_u32 m0, s90, 36864
    s_mov_b32 s92, 110976
    s_waitcnt vmcnt(9)
    ds_read_b64_tr_b16 a[20:21], v7 offset:61440
    ds_read_b64_tr_b16 a[22:23], v7 offset:62208
    v_mfma_f32_16x16x32_bf16 v[68:71], a[0:3], v[60:63], 0
    ds_read_b64_tr_b16 a[44:45], v7 offset:61472
    v_mfma_f32_16x16x32_bf16 v[68:71], a[4:7], v[56:59], v[68:71]
    ds_read_b64_tr_b16 a[46:47], v7 offset:62240
    v_mfma_f32_16x16x32_bf16 v[68:71], a[8:11], v[52:55], v[68:71]
    ds_read_b64_tr_b16 a[68:69], v7 offset:61504
    v_mfma_f32_16x16x32_bf16 v[68:71], a[12:15], v[48:51], v[68:71]
    s_waitcnt lgkmcnt(5)
    ds_read_b64_tr_b16 a[70:71], v7 offset:62272
    v_mfma_f32_16x16x32_bf16 v[68:71], a[16:19], v[40:43], v[68:71]
    ds_read_b128 v[44:47], v148 offset:42496
    ds_read_b128 v[36:39], v147 offset:42496
    ds_read_b128 v[32:35], v148 offset:42624
    ds_read_b128 v[28:31], v147 offset:42624
    s_waitcnt lgkmcnt(7)
    v_mfma_f32_16x16x32_bf16 v[68:71], a[20:23], v[0:3], v[68:71]
    ds_read_b128 v[20:23], v148 offset:42752
    s_nop 0
    v_mfma_f32_16x16x32_bf16 v[92:95], a[24:27], v[60:63], 0
    s_nop 0
    ds_read_b128 v[12:15], v147 offset:42752
    s_nop 0
    v_mfma_f32_16x16x32_bf16 v[92:95], a[28:31], v[56:59], v[92:95]
    s_nop 0
    v_fma_f32 v170, v68, v68, s41
    v_fmac_f32 v170, v69, v69
    v_mfma_f32_16x16x32_bf16 v[92:95], a[32:35], v[52:55], v[92:95]
    v_fmac_f32 v170, v70, v70
    v_fmac_f32 v170, v71, v71
    v_mfma_f32_16x16x32_bf16 v[92:95], a[36:39], v[48:51], v[92:95]
    v_mfma_f32_16x16x32_bf16 v[92:95], a[40:43], v[40:43], v[92:95]
    s_waitcnt lgkmcnt(4)
    buffer_load_dwordx4 v149, s[32:35], s92 offen offset:0 lds
    v_mfma_f32_16x16x32_bf16 v[92:95], a[44:47], v[0:3], v[92:95]
    s_nop 1
    v_mfma_f32_16x16x32_bf16 v[88:91], a[48:51], v[60:63], 0
    s_nop 2
    v_mfma_f32_16x16x32_bf16 v[88:91], a[52:55], v[56:59], v[88:91]
    s_nop 0
    v_fmac_f32 v170, v92, v92
    v_fmac_f32 v170, v93, v93
    v_mfma_f32_16x16x32_bf16 v[88:91], a[56:59], v[52:55], v[88:91]
    v_fmac_f32 v170, v94, v94
    v_fmac_f32 v170, v95, v95
    v_mfma_f32_16x16x32_bf16 v[88:91], a[60:63], v[48:51], v[88:91]
    buffer_load_dwordx4 v121, s[32:35], s92 offen offset:1024 lds
    v_mfma_f32_16x16x32_bf16 v[88:91], a[64:67], v[40:43], v[88:91]
    v_mfma_f32_16x16x32_bf16 v[88:91], a[68:71], v[0:3], v[88:91]
    s_nop 0
    v_mfma_f32_16x16x32_bf16 v[0:3], a[0:3], v[44:47], 0
    s_nop 2
    v_mfma_f32_16x16x32_bf16 v[0:3], a[4:7], v[36:39], v[0:3]
    s_waitcnt lgkmcnt(0)
    s_nop 0
    v_fmac_f32 v170, v88, v88
    v_fmac_f32 v170, v89, v89
    v_mfma_f32_16x16x32_bf16 v[0:3], a[8:11], v[32:35], v[0:3]
    v_fmac_f32 v170, v90, v90
    v_fmac_f32 v170, v91, v91
    v_mfma_f32_16x16x32_bf16 v[0:3], a[12:15], v[28:31], v[0:3]
    s_waitcnt vmcnt(8)
    buffer_load_dwordx4 v26, s[32:35], s92 offen offset:2048 lds
    ds_read_b64_tr_b16 a[72:73], v7 offset:0
    v_mfma_f32_16x16x32_bf16 v[0:3], a[16:19], v[20:23], v[0:3]
    s_add_u32 m0, s90, 49152
    ds_read_b64_tr_b16 a[74:75], v7 offset:768
    v_mfma_f32_16x16x32_bf16 v[0:3], a[20:23], v[12:15], v[0:3]
    s_mov_b32 s92, 147840
    ds_read_b64_tr_b16 a[96:97], v7 offset:32
    v_mfma_f32_16x16x32_bf16 v[56:59], a[24:27], v[44:47], 0
    ds_read_b64_tr_b16 a[98:99], v7 offset:800
    v_mfma_f32_16x16x32_bf16 v[56:59], a[28:31], v[36:39], v[56:59]
    ds_read_b64_tr_b16 a[120:121], v7 offset:64
    buffer_load_dwordx4 v149, s[32:35], s92 offen offset:0 lds
    v_mfma_f32_16x16x32_bf16 v[56:59], a[32:35], v[32:35], v[56:59]
    ds_read_b64_tr_b16 a[122:123], v7 offset:832
    v_fma_f32 v120, v0, v0, s41
    v_mfma_f32_16x16x32_bf16 v[56:59], a[36:39], v[28:31], v[56:59]
    ds_read_b128 v[100:103], v148 offset:40960
    v_fmac_f32 v120, v1, v1
    v_mfma_f32_16x16x32_bf16 v[56:59], a[40:43], v[20:23], v[56:59]
    ds_read_b128 v[64:67], v147 offset:40960
    v_fmac_f32 v120, v2, v2
    v_mfma_f32_16x16x32_bf16 v[56:59], a[44:47], v[12:15], v[56:59]
    ds_read_b128 v[52:55], v148 offset:41088
    v_fmac_f32 v120, v3, v3
    v_mfma_f32_16x16x32_bf16 v[40:43], a[48:51], v[44:47], 0
    ds_read_b128 v[48:51], v147 offset:41088
    buffer_load_dwordx4 v121, s[32:35], s92 offen offset:1024 lds
    v_mfma_f32_16x16x32_bf16 v[40:43], a[52:55], v[36:39], v[40:43]
    s_nop 0
    ds_read_b128 v[44:47], v148 offset:41216
    v_fmac_f32 v120, v56, v56
    v_mfma_f32_16x16x32_bf16 v[40:43], a[56:59], v[32:35], v[40:43]
    ds_read_b128 v[32:35], v147 offset:41216
    v_fmac_f32 v120, v57, v57
    v_mfma_f32_16x16x32_bf16 v[40:43], a[60:63], v[28:31], v[40:43]
    v_fmac_f32 v120, v58, v58
    v_fmac_f32 v120, v59, v59
    v_mfma_f32_16x16x32_bf16 v[40:43], a[64:67], v[20:23], v[40:43]
    v_mfma_f32_16x16x32_bf16 v[40:43], a[68:71], v[12:15], v[40:43]
    s_waitcnt vmcnt(8)
    buffer_load_dwordx4 v26, s[32:35], s92 offen offset:2048 lds
    ds_read_b64_tr_b16 a[76:77], v7 offset:12288
    s_add_u32 m0, s90, 61440
    s_mov_b32 s92, 184704
    ds_read_b64_tr_b16 a[78:79], v7 offset:13056
    s_nop 0
    ds_read_b64_tr_b16 a[100:101], v7 offset:12320
    v_fmac_f32 v120, v40, v40
    ds_read_b64_tr_b16 a[102:103], v7 offset:13088
    v_fmac_f32 v120, v41, v41
    ds_read_b64_tr_b16 a[124:125], v7 offset:12352
    v_fmac_f32 v120, v42, v42
    ds_read_b64_tr_b16 a[126:127], v7 offset:13120
    v_fmac_f32 v120, v43, v43
    buffer_load_dwordx4 v149, s[32:35], s92 offen offset:0 lds
    buffer_load_dwordx4 v121, s[32:35], s92 offen offset:1024 lds
    buffer_load_dwordx4 v26, s[32:35], s92 offen offset:2048 lds
    s_add_u32 m0, s90, 0
    s_mov_b32 s92, 768
    s_waitcnt vmcnt(9)
    ds_read_b64_tr_b16 a[80:81], v7 offset:24576
    ds_read_b64_tr_b16 a[82:83], v7 offset:25344
    ds_read_b64_tr_b16 a[104:105], v7 offset:24608
    ds_read_b64_tr_b16 a[106:107], v7 offset:25376
    ds_read_b64_tr_b16 a[128:129], v7 offset:24640
    ds_read_b64_tr_b16 a[130:131], v7 offset:25408
    s_waitcnt lgkmcnt(6)
    buffer_load_dwordx4 v149, s[32:35], s92 offen offset:0 lds
    buffer_load_dwordx4 v121, s[32:35], s92 offen offset:1024 lds
    buffer_load_dwordx4 v26, s[32:35], s92 offen offset:2048 lds
    s_add_u32 m0, s90, 12288
    s_mov_b32 s92, 37632
    s_waitcnt vmcnt(9)
    ds_read_b64_tr_b16 a[84:85], v7 offset:36864
    ds_read_b64_tr_b16 a[86:87], v7 offset:37632
    ds_read_b64_tr_b16 a[108:109], v7 offset:36896
    ds_read_b64_tr_b16 a[110:111], v7 offset:37664
    ds_read_b64_tr_b16 a[132:133], v7 offset:36928
    ds_read_b64_tr_b16 a[134:135], v7 offset:37696
    buffer_load_dwordx4 v149, s[32:35], s92 offen offset:0 lds
    buffer_load_dwordx4 v121, s[32:35], s92 offen offset:1024 lds
    buffer_load_dwordx4 v26, s[32:35], s92 offen offset:2048 lds
    s_add_u32 m0, s90, 24576
    s_mov_b32 s92, 74496
    s_waitcnt vmcnt(9)
    ds_read_b64_tr_b16 a[88:89], v7 offset:49152
    ds_read_b64_tr_b16 a[90:91], v7 offset:49920
    ds_read_b64_tr_b16 a[112:113], v7 offset:49184
    ds_read_b64_tr_b16 a[114:115], v7 offset:49952
    ds_read_b64_tr_b16 a[136:137], v7 offset:49216
    ds_read_b64_tr_b16 a[138:139], v7 offset:49984
    s_waitcnt lgkmcnt(6)
    buffer_load_dwordx4 v149, s[32:35], s92 offen offset:0 lds
    buffer_load_dwordx4 v121, s[32:35], s92 offen offset:1024 lds
    buffer_load_dwordx4 v26, s[32:35], s92 offen offset:2048 lds
    s_add_u32 m0, s90, 36864
    s_mov_b32 s92, 111360
    s_waitcnt vmcnt(9)
    ds_read_b64_tr_b16 a[92:93], v7 offset:61440
    ds_read_b64_tr_b16 a[94:95], v7 offset:62208
    v_mfma_f32_16x16x32_bf16 v[36:39], a[72:75], v[100:103], 0
    ds_read_b64_tr_b16 a[116:117], v7 offset:61472
    v_mfma_f32_16x16x32_bf16 v[36:39], a[76:79], v[64:67], v[36:39]
    ds_read_b64_tr_b16 a[118:119], v7 offset:62240
    v_mfma_f32_16x16x32_bf16 v[36:39], a[80:83], v[52:55], v[36:39]
    ds_read_b64_tr_b16 a[140:141], v7 offset:61504
    v_mfma_f32_16x16x32_bf16 v[36:39], a[84:87], v[48:51], v[36:39]
    s_waitcnt lgkmcnt(5)
    buffer_load_dwordx4 v149, s[32:35], s92 offen offset:0 lds
    ds_read_b64_tr_b16 a[142:143], v7 offset:62272
    v_mfma_f32_16x16x32_bf16 v[36:39], a[88:91], v[44:47], v[36:39]
    ds_read_b128 v[96:99], v148 offset:42496
    ds_read_b128 v[80:83], v147 offset:42496
    ds_read_b128 v[28:31], v148 offset:42624
    ds_read_b128 v[20:23], v147 offset:42624
    s_waitcnt lgkmcnt(7)
    v_mfma_f32_16x16x32_bf16 v[36:39], a[92:95], v[32:35], v[36:39]
    buffer_load_dwordx4 v121, s[32:35], s92 offen offset:1024 lds
    ds_read_b128 v[60:63], v148 offset:42752
    v_mfma_f32_16x16x32_bf16 v[84:87], a[96:99], v[100:103], 0
    s_nop 1
    ds_read_b128 v[12:15], v147 offset:42752
    v_mfma_f32_16x16x32_bf16 v[84:87], a[100:103], v[64:67], v[84:87]
    s_nop 0
    v_fma_f32 v4, v36, v36, s41
    v_fmac_f32 v4, v37, v37
    v_mfma_f32_16x16x32_bf16 v[84:87], a[104:107], v[52:55], v[84:87]
    v_fmac_f32 v4, v38, v38
    v_fmac_f32 v4, v39, v39
    v_mfma_f32_16x16x32_bf16 v[84:87], a[108:111], v[48:51], v[84:87]
    v_mfma_f32_16x16x32_bf16 v[84:87], a[112:115], v[44:47], v[84:87]
    s_waitcnt vmcnt(8) lgkmcnt(4)
    buffer_load_dwordx4 v26, s[32:35], s92 offen offset:2048 lds
    ds_read_b64_tr_b16 a[144:145], v6 offset:0
    v_mfma_f32_16x16x32_bf16 v[84:87], a[116:119], v[32:35], v[84:87]
    s_add_u32 m0, s90, 49152
    ds_read_b64_tr_b16 a[146:147], v6 offset:768
    v_mfma_f32_16x16x32_bf16 v[72:75], a[120:123], v[100:103], 0
    s_mov_b32 s92, 148224
    s_nop 0
    ds_read_b64_tr_b16 a[168:169], v6 offset:8
    v_mfma_f32_16x16x32_bf16 v[72:75], a[124:127], v[64:67], v[72:75]
    s_nop 0
    v_fmac_f32 v4, v84, v84
    v_fmac_f32 v4, v85, v85
    v_mfma_f32_16x16x32_bf16 v[72:75], a[128:131], v[52:55], v[72:75]
    ds_read_b64_tr_b16 a[170:171], v6 offset:776
    v_fmac_f32 v4, v86, v86
    v_mfma_f32_16x16x32_bf16 v[72:75], a[132:135], v[48:51], v[72:75]
    buffer_load_dwordx4 v149, s[32:35], s92 offen offset:0 lds
    ds_read_b64_tr_b16 a[192:193], v7 offset:64
    v_mfma_f32_16x16x32_bf16 v[72:75], a[136:139], v[44:47], v[72:75]
    ds_read_b64_tr_b16 a[194:195], v7 offset:832
    v_fmac_f32 v4, v87, v87
    v_mfma_f32_16x16x32_bf16 v[72:75], a[140:143], v[32:35], v[72:75]
    s_nop 0
    v_mfma_f32_16x16x32_bf16 v[52:55], a[72:75], v[96:99], 0
    s_nop 2
    v_mfma_f32_16x16x32_bf16 v[52:55], a[76:79], v[80:83], v[52:55]
    s_waitcnt lgkmcnt(5)
    s_nop 0
    v_fmac_f32 v4, v72, v72
    v_fmac_f32 v4, v73, v73
    v_mfma_f32_16x16x32_bf16 v[52:55], a[80:83], v[28:31], v[52:55]
    buffer_load_dwordx4 v121, s[32:35], s92 offen offset:1024 lds
    v_fmac_f32 v4, v74, v74
    v_mfma_f32_16x16x32_bf16 v[52:55], a[84:87], v[20:23], v[52:55]
    v_fmac_f32 v4, v75, v75
    v_cvt_pk_bf16_f32 v170, v170, v4
    v_mfma_f32_16x16x32_bf16 v[52:55], a[88:91], v[60:63], v[52:55]
    v_mfma_f32_16x16x32_bf16 v[52:55], a[92:95], v[12:15], v[52:55]
    ds_read_b128 v[64:67], v148 offset:40960
    v_mfma_f32_16x16x32_bf16 v[48:51], a[96:99], v[96:99], 0
    ds_read_b128 v[32:35], v147 offset:40960
    v_mfma_f32_16x16x32_bf16 v[48:51], a[100:103], v[80:83], v[48:51]
    s_waitcnt vmcnt(8)
    buffer_load_dwordx4 v26, s[32:35], s92 offen offset:2048 lds
    ds_read_b64_tr_b16 a[148:149], v6 offset:12288
    v_mfma_f32_16x16x32_bf16 v[48:51], a[104:107], v[28:31], v[48:51]
    s_add_u32 m0, s90, 61440
    v_fma_f32 v79, v52, v52, s41
    v_fmac_f32 v79, v53, v53
    v_mfma_f32_16x16x32_bf16 v[48:51], a[108:111], v[20:23], v[48:51]
    s_mov_b32 s92, 185088
    ds_read_b64_tr_b16 a[150:151], v6 offset:13056
    v_fmac_f32 v79, v54, v54
    v_mfma_f32_16x16x32_bf16 v[48:51], a[112:115], v[60:63], v[48:51]
    ds_read_b64_tr_b16 a[172:173], v6 offset:12296
    v_fmac_f32 v79, v55, v55
    v_mfma_f32_16x16x32_bf16 v[48:51], a[116:119], v[12:15], v[48:51]
    ds_read_b64_tr_b16 a[174:175], v6 offset:13064
    v_mfma_f32_16x16x32_bf16 v[44:47], a[120:123], v[96:99], 0
    s_nop 0
    buffer_load_dwordx4 v149, s[32:35], s92 offen offset:0 lds
    ds_read_b64_tr_b16 a[196:197], v7 offset:12352
    v_mfma_f32_16x16x32_bf16 v[44:47], a[124:127], v[80:83], v[44:47]
    s_nop 0
    ds_read_b64_tr_b16 a[198:199], v7 offset:13120
    v_fmac_f32 v79, v48, v48
    v_mfma_f32_16x16x32_bf16 v[44:47], a[128:131], v[28:31], v[44:47]
    ds_read_b128 v[28:31], v148 offset:41088
    v_fmac_f32 v79, v49, v49
    v_mfma_f32_16x16x32_bf16 v[44:47], a[132:135], v[20:23], v[44:47]
    ds_read_b128 v[20:23], v147 offset:41088
    v_fmac_f32 v79, v50, v50
    v_mfma_f32_16x16x32_bf16 v[44:47], a[136:139], v[60:63], v[44:47]
    ds_read_b128 v[60:63], v148 offset:41216
    v_fmac_f32 v79, v51, v51
    v_mfma_f32_16x16x32_bf16 v[44:47], a[140:143], v[12:15], v[44:47]
    s_nop 0
    buffer_load_dwordx4 v121, s[32:35], s92 offen offset:1024 lds
    ds_read_b128 v[12:15], v147 offset:41216
    v_mfma_f32_16x16x16_bf16 v[80:83], v[216:217], v[170:171], 0
    s_nop 0
    v_mov_b32 v254, 0
    v_mov_b32 v255, 0
    v_mov_b32 v253, 0
    v_fmac_f32 v79, v44, v44
    v_fmac_f32 v79, v45, v45
    v_fmac_f32 v79, v46, v46
    v_fmac_f32 v79, v47, v47
    v_rsq_f32 v80, v80
    v_rsq_f32 v81, v81
    v_mul_f32 v80, s55, v80
    v_mul_f32 v81, 0.5, v81
    v_mul_f32 v68, v68, v80
    buffer_load_dwordx4 v26, s[32:35], s92 offen offset:2048 lds
    s_add_u32 m0, s90, 0
    s_mov_b32 s92, 0
    s_waitcnt vmcnt(9)
    ds_read_b64_tr_b16 a[152:153], v6 offset:24576
    v_mul_f32 v69, v69, v80
    v_cvt_pk_f16_f32 v68, v68, v69
    v_mul_f32 v70, v70, v80
    ds_read_b64_tr_b16 a[154:155], v6 offset:25344
    v_mul_f32 v71, v71, v80
    v_cvt_pk_f16_f32 v69, v70, v71
    v_mul_f32 v92, v92, v80
    ds_read_b64_tr_b16 a[176:177], v6 offset:24584
    v_mul_f32 v93, v93, v80
    v_cvt_pk_f16_f32 v70, v92, v93
    s_waitcnt lgkmcnt(3)
    buffer_load_dwordx4 v27, s[76:79], s92 offen offset:0 lds
    ds_read_b64_tr_b16 a[178:179], v6 offset:25352
    v_mul_f32 v94, v94, v80
    v_mul_f32 v95, v95, v80
    v_cvt_pk_f16_f32 v71, v94, v95
    ds_read_b64_tr_b16 a[200:201], v7 offset:24640
    v_mul_f32 v88, v88, v80
    ds_read_b64_tr_b16 a[202:203], v7 offset:25408
    v_mul_f32 v89, v89, v80
    v_cvt_pk_f16_f32 v76, v88, v89
    v_mul_f32 v90, v90, v80
    v_mul_f32 v91, v91, v80
    v_cvt_pk_f16_f32 v77, v90, v91
    v_mul_f32 v36, v36, v81
    buffer_load_dwordx4 v146, s[76:79], s92 offen offset:1024 lds
    v_mul_f32 v37, v37, v81
    v_cvt_pk_f16_f32 v36, v36, v37
    v_mul_f32 v38, v38, v81
    v_mul_f32 v39, v39, v81
    v_cvt_pk_f16_f32 v37, v38, v39
    v_mul_f32 v84, v84, v81
    v_mul_f32 v85, v85, v81
    v_cvt_pk_f16_f32 v38, v84, v85
    v_mul_f32 v86, v86, v81
    v_mul_f32 v87, v87, v81
    v_cvt_pk_f16_f32 v39, v86, v87
    v_mul_f32 v72, v72, v81
    v_mul_f32 v73, v73, v81
    v_cvt_pk_f16_f32 v4, v72, v73
    v_mul_f32 v74, v74, v81
    v_mul_f32 v75, v75, v81
    v_cvt_pk_f16_f32 v5, v74, v75
    buffer_load_dwordx4 v78, s[76:79], s92 offen offset:2048 lds
    s_add_u32 m0, s90, 12288
    s_mov_b32 s92, 12288
    s_waitcnt vmcnt(9)
    ds_read_b64_tr_b16 a[156:157], v6 offset:36864
    v_fma_mix_f32 v252, v68, v36, 0 op_sel:[0,0,0] op_sel_hi:[1,1,0]
    v_fma_mix_f32 v252, v68, v36, v252 op_sel:[1,1,0] op_sel_hi:[1,1,0]
    v_fma_mix_f32 v252, v69, v37, v252 op_sel:[0,0,0] op_sel_hi:[1,1,0]
    ds_read_b64_tr_b16 a[158:159], v6 offset:37632
    v_fma_mix_f32 v252, v69, v37, v252 op_sel:[1,1,0] op_sel_hi:[1,1,0]
    v_fma_mix_f32 v252, v70, v38, v252 op_sel:[0,0,0] op_sel_hi:[1,1,0]
    v_fma_mix_f32 v252, v70, v38, v252 op_sel:[1,1,0] op_sel_hi:[1,1,0]
    ds_read_b64_tr_b16 a[180:181], v6 offset:36872
    v_fma_mix_f32 v252, v71, v39, v252 op_sel:[0,0,0] op_sel_hi:[1,1,0]
    v_fma_mix_f32 v252, v71, v39, v252 op_sel:[1,1,0] op_sel_hi:[1,1,0]
    buffer_load_dwordx4 v27, s[76:79], s92 offen offset:0 lds
    ds_read_b64_tr_b16 a[182:183], v6 offset:37640
    v_fma_mix_f32 v252, v76, v4, v252 op_sel:[0,0,0] op_sel_hi:[1,1,0]
    v_fma_mix_f32 v252, v76, v4, v252 op_sel:[1,1,0] op_sel_hi:[1,1,0]
    v_fma_mix_f32 v252, v77, v5, v252 op_sel:[0,0,0] op_sel_hi:[1,1,0]
    ds_read_b64_tr_b16 a[204:205], v7 offset:36928
    v_fma_mix_f32 v252, v77, v5, v252 op_sel:[1,1,0] op_sel_hi:[1,1,0]
    ds_read_b64_tr_b16 a[206:207], v7 offset:37696
    v_mov_b32 v26, v252
    v_add_u32 v149, 28672, v156
    ds_write_b128 v149, v[36:39]
    buffer_load_dwordx4 v146, s[76:79], s92 offen offset:1024 lds
    v_permlane32_swap_b32 v26, v252
    v_add_f32 v252, v26, v252
    v_mov_b32 v26, v252
    v_cvt_pk_bf16_f32 v170, v120, v79
    s_nop 0
    v_permlane16_swap_b32 v26, v252
    v_mfma_f32_16x16x16_bf16 v[36:39], v[216:217], v[170:171], 0
    s_waitcnt vmcnt(8)
    ds_write2_b64 v149, v[254:255], v[254:255] offset0:2 offset1:3
    v_add_f32 v252, v26, v252
    buffer_load_dwordx4 v78, s[76:79], s92 offen offset:2048 lds
    s_add_u32 m0, s90, 24576
    s_mov_b32 s92, 24576
    v_and_b32 v26, 0xffff0000, v252
    v_sub_f32 v252, v252, v26
    ds_read_b64_tr_b16 a[160:161], v6 offset:49152
    v_cvt_pk_bf16_f32 v252, v252, v26
    v_rsq_f32 v36, v36
    ds_read_b64_tr_b16 a[162:163], v6 offset:49920
    v_rsq_f32 v37, v37
    v_mul_f32 v36, s55, v36
    s_waitcnt lgkmcnt(3)
    buffer_load_dwordx4 v27, s[76:79], s92 offen offset:0 lds
    ds_read_b64_tr_b16 a[184:185], v6 offset:49160
    v_mul_f32 v37, 0.5, v37
    v_mul_f32 v0, v0, v36
    v_mul_f32 v1, v1, v36
    ds_read_b64_tr_b16 a[186:187], v6 offset:49928
    v_cvt_pk_f16_f32 v0, v0, v1
    v_mul_f32 v2, v2, v36
    v_mul_f32 v3, v3, v36
    ds_read_b64_tr_b16 a[208:209], v7 offset:49216
    v_cvt_pk_f16_f32 v1, v2, v3
    ds_read_b64_tr_b16 a[210:211], v7 offset:49984
    v_mul_f32 v56, v56, v36
    buffer_load_dwordx4 v146, s[76:79], s92 offen offset:1024 lds
    ds_write_b128 v149, v[68:71] offset:32
    v_mul_f32 v57, v57, v36
    v_cvt_pk_f16_f32 v2, v56, v57
    v_mul_f32 v58, v58, v36
    v_mul_f32 v59, v59, v36
    v_cvt_pk_f16_f32 v3, v58, v59
    v_mul_f32 v40, v40, v36
    v_mul_f32 v41, v41, v36
    v_cvt_pk_f16_f32 v120, v40, v41
    ds_write2_b64 v149, v[4:5], v[254:255] offset0:6 offset1:7
    buffer_load_dwordx4 v78, s[76:79], s92 offen offset:2048 lds
    s_add_u32 m0, s90, 36864
    s_mov_b32 s92, 36864
    v_mul_f32 v42, v42, v36
    v_mul_f32 v43, v43, v36
    v_cvt_pk_f16_f32 v121, v42, v43
    v_mul_f32 v52, v52, v37
    v_mul_f32 v53, v53, v37
    s_waitcnt vmcnt(9)
    ds_read_b64_tr_b16 a[164:165], v6 offset:61440
    v_cvt_pk_f16_f32 v4, v52, v53
    v_mul_f32 v54, v54, v37
    v_mul_f32 v55, v55, v37
    ds_read_b64_tr_b16 a[166:167], v6 offset:62208
    v_mfma_f32_16x16x32_bf16 v[40:43], a[144:147], v[64:67], 0
    buffer_load_dwordx4 v27, s[76:79], s92 offen offset:0 lds
    ds_read_b64_tr_b16 a[188:189], v6 offset:61448
    v_mfma_f32_16x16x32_bf16 v[40:43], a[148:151], v[32:35], v[40:43]
    v_cvt_pk_f16_f32 v5, v54, v55
    v_mul_f32 v48, v48, v37
    v_mfma_f32_16x16x32_bf16 v[40:43], a[152:155], v[28:31], v[40:43]
    ds_read_b64_tr_b16 a[190:191], v6 offset:62216
    v_mul_f32 v49, v49, v37
    v_mfma_f32_16x16x32_bf16 v[40:43], a[156:159], v[20:23], v[40:43]
    s_waitcnt lgkmcnt(4)
    ds_read_b64_tr_b16 a[212:213], v7 offset:61504
    v_cvt_pk_f16_f32 v6, v48, v49
    v_mfma_f32_16x16x32_bf16 v[40:43], a[160:163], v[60:63], v[40:43]
    ds_read_b64_tr_b16 a[214:215], v7 offset:62272
    v_mul_f32 v50, v50, v37
    v_mul_f32 v51, v51, v37
    v_cvt_pk_f16_f32 v7, v50, v51
    buffer_load_dwordx4 v146, s[76:79], s92 offen offset:1024 lds
    ds_write2_b64 v149, v[254:255], v[76:77] offset0:8 offset1:9
    v_mul_f32 v44, v44, v37
    v_mul_f32 v45, v45, v37
    v_cvt_pk_f16_f32 v254, v44, v45
    v_mul_f32 v46, v46, v37
    s_waitcnt lgkmcnt(5)
    v_mfma_f32_16x16x32_bf16 v[40:43], a[164:167], v[12:15], v[40:43]
    v_mul_f32 v47, v47, v37
    v_cvt_pk_f16_f32 v255, v46, v47
    v_mfma_f32_16x16x32_bf16 v[52:55], a[168:171], v[64:67], 0
    buffer_load_dwordx4 v78, s[76:79], s92 offen offset:2048 lds
    ds_read_b128 v[48:51], v148 offset:42496
    v_mfma_f32_16x16x32_bf16 v[52:55], a[172:175], v[32:35], v[52:55]
    s_add_u32 m0, s90, 49152
    v_fma_mix_f32 v26, v0, v4, 0 op_sel:[0,0,0] op_sel_hi:[1,1,0]
    v_fma_mix_f32 v26, v0, v4, v26 op_sel:[1,1,0] op_sel_hi:[1,1,0]
    v_mfma_f32_16x16x32_bf16 v[52:55], a[176:179], v[28:31], v[52:55]
    s_mov_b32 s92, 49152
    ds_write_b64 v149, v[252:253] offset:88
    v_mfma_f32_16x16x32_bf16 v[52:55], a[180:183], v[20:23], v[52:55]
    s_lshl_b32 s93, s68, 10
    v_fma_mix_f32 v26, v1, v5, v26 op_sel:[0,0,0] op_sel_hi:[1,1,0]
    v_fma_mix_f32 v26, v1, v5, v26 op_sel:[1,1,0] op_sel_hi:[1,1,0]
    v_mfma_f32_16x16x32_bf16 v[52:55], a[184:187], v[60:63], v[52:55]
    s_waitcnt lgkmcnt(3)
    s_mov_b32 s53, s47
    ds_read_b128 v[44:47], v147 offset:42496
    v_fma_mix_f32 v26, v2, v6, v26 op_sel:[0,0,0] op_sel_hi:[1,1,0]
    v_mfma_f32_16x16x32_bf16 v[52:55], a[188:191], v[12:15], v[52:55]
    s_mov_b32 s47, s46
    buffer_load_dwordx4 v27, s[76:79], s92 offen offset:0 lds
    ds_read_b128 v[36:39], v148 offset:42624
    v_mfma_f32_16x16x32_bf16 v[56:59], a[192:195], v[64:67], 0
    s_mov_b32 s46, s45
    v_fma_mix_f32 v26, v2, v6, v26 op_sel:[1,1,0] op_sel_hi:[1,1,0]
    v_fma_mix_f32 v26, v3, v7, v26 op_sel:[0,0,0] op_sel_hi:[1,1,0]
    v_mfma_f32_16x16x32_bf16 v[56:59], a[196:199], v[32:35], v[56:59]
    s_mov_b32 s45, s44
    ds_read_b128 v[32:35], v147 offset:42624
    v_fma_mix_f32 v26, v3, v7, v26 op_sel:[1,1,0] op_sel_hi:[1,1,0]
    v_mfma_f32_16x16x32_bf16 v[56:59], a[200:203], v[28:31], v[56:59]
    s_mov_b32 s44, s53
    ds_read_b128 v[28:31], v148 offset:42752
    v_fma_mix_f32 v26, v120, v254, v26 op_sel:[0,0,0] op_sel_hi:[1,1,0]
    v_mfma_f32_16x16x32_bf16 v[56:59], a[204:207], v[20:23], v[56:59]
    s_sub_u32 s48, s44, s46
    ds_read_b128 v[20:23], v147 offset:42752
    v_fma_mix_f32 v26, v120, v254, v26 op_sel:[1,1,0] op_sel_hi:[1,1,0]
    v_mfma_f32_16x16x32_bf16 v[56:59], a[208:211], v[60:63], v[56:59]
    s_sub_u32 s49, s46, s45
    buffer_load_dwordx4 v146, s[76:79], s92 offen offset:1024 lds
    v_fma_mix_f32 v26, v121, v255, v26 op_sel:[0,0,0] op_sel_hi:[1,1,0]
    v_mfma_f32_16x16x32_bf16 v[56:59], a[212:215], v[12:15], v[56:59]
    s_waitcnt lgkmcnt(5)
    v_fma_mix_f32 v26, v121, v255, v26 op_sel:[1,1,0] op_sel_hi:[1,1,0]
    v_mov_b32 v147, v26
    v_mfma_f32_16x16x32_bf16 v[12:15], a[144:147], v[48:51], 0
    s_waitcnt lgkmcnt(4)
    v_permlane32_swap_b32 v147, v26
    v_add_f32 v26, v147, v26
    v_mfma_f32_16x16x32_bf16 v[12:15], a[148:151], v[44:47], v[12:15]
    s_waitcnt lgkmcnt(3)
    v_mov_b32 v147, v26
    v_cvt_pk_bf16_f32 v148, v40, v41
    v_cvt_pk_bf16_f32 v149, v42, v43
    v_mfma_f32_16x16x32_bf16 v[12:15], a[152:155], v[36:39], v[12:15]
    s_waitcnt lgkmcnt(2)
    ds_write_b64 v156, v[148:149] offset:28752
    buffer_load_dwordx4 v78, s[76:79], s92 offen offset:2048 lds
    s_add_u32 m0, s90, 61440
    v_mfma_f32_16x16x32_bf16 v[12:15], a[156:159], v[32:35], v[12:15]
    s_waitcnt lgkmcnt(2)
    s_mov_b32 s92, 61440
    v_permlane16_swap_b32 v147, v26
    v_mfma_f32_16x16x32_bf16 v[12:15], a[160:163], v[28:31], v[12:15]
    s_waitcnt lgkmcnt(1)
    v_add_f32 v26, v147, v26
    v_and_b32 v147, 0xffff0000, v26
    v_mfma_f32_16x16x32_bf16 v[12:15], a[164:167], v[20:23], v[12:15]
    v_sub_f32 v26, v26, v147
    v_cvt_pk_bf16_f32 v26, v26, v147
    v_mfma_f32_16x16x32_bf16 v[40:43], a[168:171], v[48:51], 0
    v_cvt_pk_bf16_f32 v52, v52, v53
    v_cvt_pk_bf16_f32 v53, v54, v55
    v_mfma_f32_16x16x32_bf16 v[40:43], a[172:175], v[44:47], v[40:43]
    buffer_load_dwordx4 v27, s[76:79], s92 offen offset:0 lds
    v_cvt_pk_bf16_f32 v54, v56, v57
    v_mfma_f32_16x16x32_bf16 v[40:43], a[176:179], v[36:39], v[40:43]
    v_cvt_pk_bf16_f32 v55, v58, v59
    v_cvt_pk_bf16_f32 v246, v12, v13
    v_mfma_f32_16x16x32_bf16 v[40:43], a[180:183], v[32:35], v[40:43]
    ds_write_b128 v156, v[52:55] offset:28768
    v_mfma_f32_16x16x32_bf16 v[40:43], a[184:187], v[28:31], v[40:43]
    v_cvt_pk_bf16_f32 v247, v14, v15
    v_add_u32 v27, s93, v129
    v_mfma_f32_16x16x32_bf16 v[40:43], a[188:191], v[20:23], v[40:43]
    buffer_load_dwordx4 v146, s[76:79], s92 offen offset:1024 lds
    v_add_u32 v137, s48, v137
    v_mfma_f32_16x16x32_bf16 v[12:15], a[192:195], v[48:51], 0
    s_nop 0
    v_add_u32 v136, s48, v136
    s_nop 0
    v_mfma_f32_16x16x32_bf16 v[12:15], a[196:199], v[44:47], v[12:15]
    s_nop 0
    v_cvt_pk_bf16_f32 v76, v40, v41
    v_cvt_pk_bf16_f32 v77, v42, v43
    v_mfma_f32_16x16x32_bf16 v[12:15], a[200:203], v[36:39], v[12:15]
    v_mfma_f32_16x16x32_bf16 v[12:15], a[204:207], v[32:35], v[12:15]
    v_mfma_f32_16x16x32_bf16 v[12:15], a[208:211], v[28:31], v[12:15]
    buffer_load_dwordx4 v78, s[76:79], s92 offen offset:2048 lds
    v_mfma_f32_16x16x32_bf16 v[12:15], a[212:215], v[20:23], v[12:15]
    s_add_u32 m0, s54, 20480
    s_nop 6
    v_cvt_pk_bf16_f32 v78, v12, v13
    v_cvt_pk_bf16_f32 v79, v14, v15
    buffer_load_dwordx4 v128, s[24:27], s56 offen nt lds
    s_add_u32 m0, s54, 21504
    s_nop 0
    buffer_load_dwordx4 v127, s[24:27], s56 offen nt lds
    s_add_u32 m0, s54, 22528
    s_nop 0
    buffer_load_dwordx4 v126, s[24:27], s56 offen nt lds
    s_add_u32 m0, s54, 23552
    s_nop 0
    buffer_load_dwordx4 v125, s[24:27], s56 offen nt lds
    s_add_u32 m0, s54, 24576
    s_nop 0
    buffer_load_dwordx4 v124, s[24:27], s56 offen nt lds
    s_waitcnt vmcnt(5)
    s_barrier
    ds_read_b128 v[36:39], v17 offset:0
    ds_read_b64 v[12:13], v16 offset:64
    ds_read_b128 v[20:23], v17 offset:3072
    ds_read_b64 v[14:15], v16 offset:3136
    ds_read_b128 v[48:51], v17 offset:6144
    ds_read_b64 v[40:41], v16 offset:6208
    ds_read_b128 v[32:35], v17 offset:9216
    ds_read_b64 v[42:43], v16 offset:9280
    ds_read_b128 v[44:47], v17 offset:12288
    ds_read_b64 v[52:53], v16 offset:12352
    ds_read_b128 v[28:31], v17 offset:15360
    ds_read_b64 v[54:55], v16 offset:15424
    s_waitcnt lgkmcnt(11)
    v_mfma_f32_16x16x32_bf16 v[56:59], v[36:39], v[220:223], 0
    s_waitcnt lgkmcnt(9)
    ds_read_b128 v[36:39], v17 offset:18432
    v_mfma_f32_16x16x32_bf16 v[56:59], v[20:23], v[220:223], v[56:59]
    s_waitcnt lgkmcnt(8)
    ds_read_b64 v[20:21], v16 offset:18496
    ds_read_b128 v[60:63], v17 offset:21504
    v_mfma_f32_16x16x32_bf16 v[56:59], v[48:51], v[220:223], v[56:59]
    s_waitcnt lgkmcnt(8)
    ds_read_b64 v[22:23], v16 offset:21568
    ds_read_b128 v[48:51], v17 offset:24576
    v_mfma_f32_16x16x32_bf16 v[56:59], v[32:35], v[220:223], v[56:59]
    ds_read_b64 v[32:33], v16 offset:24640
    v_mfma_f32_16x16x32_bf16 v[56:59], v[12:15], v[220:223], v[56:59]
    s_waitcnt lgkmcnt(9)
    ds_read_b128 v[12:15], v17 offset:27648
    v_mfma_f32_16x16x32_bf16 v[56:59], v[40:43], v[220:223], v[56:59]
    ds_read_b64 v[34:35], v16 offset:27712
    v_mfma_f32_16x16x32_bf16 v[40:43], v[44:47], v[220:223], 0
    s_waitcnt lgkmcnt(8)
    ds_read_b128 v[44:47], v17 offset:30720
    v_mfma_f32_16x16x32_bf16 v[40:43], v[28:31], v[220:223], v[40:43]
    s_waitcnt lgkmcnt(8)
    s_nop 0
    ds_read_b64 v[28:29], v16 offset:30784
    v_mul_f32 v56, 0xbbaaaaab, v56
    v_mfma_f32_16x16x32_bf16 v[40:43], v[36:39], v[220:223], v[40:43]
    s_waitcnt lgkmcnt(7)
    ds_read_b128 v[36:39], v17 offset:33792
    v_mul_f32 v57, 0xbbaaaaab, v57
    v_mul_f32 v58, 0xbbaaaaab, v58
    v_mul_f32 v59, 0xbbaaaaab, v59
    v_mfma_f32_16x16x32_bf16 v[40:43], v[60:63], v[220:223], v[40:43]
    ds_write_b128 v25, v[56:59] offset:0
    v_mfma_f32_16x16x32_bf16 v[40:43], v[52:55], v[220:223], v[40:43]
    s_waitcnt lgkmcnt(6)
    v_mfma_f32_16x16x32_bf16 v[40:43], v[20:23], v[220:223], v[40:43]
    v_mfma_f32_16x16x32_bf16 v[20:23], v[48:51], v[220:223], 0
    s_waitcnt lgkmcnt(4)
    ds_read_b64 v[30:31], v16 offset:33856
    s_nop 0
    v_mfma_f32_16x16x32_bf16 v[20:23], v[12:15], v[220:223], v[20:23]
    s_waitcnt lgkmcnt(4)
    s_nop 0
    ds_read_b128 v[12:15], v24 offset:0
    v_mul_f32 v40, 0xbbaaaaab, v40
    v_mfma_f32_16x16x32_bf16 v[20:23], v[44:47], v[220:223], v[20:23]
    s_waitcnt lgkmcnt(3)
    ds_read_b64 v[16:17], v19 offset:64
    v_mul_f32 v41, 0xbbaaaaab, v41
    v_mul_f32 v42, 0xbbaaaaab, v42
    v_mul_f32 v43, 0xbbaaaaab, v43
    v_mfma_f32_16x16x32_bf16 v[20:23], v[36:39], v[220:223], v[20:23]
    ds_write_b128 v25, v[40:43] offset:128
    v_mfma_f32_16x16x32_bf16 v[20:23], v[32:35], v[220:223], v[20:23]
    ds_read_b128 v[70:73], v24 offset:768
    ds_read_b64 v[74:75], v19 offset:832
    ds_read_b128 v[64:67], v24 offset:12288
    s_waitcnt lgkmcnt(6)
    v_mfma_f32_16x16x32_bf16 v[20:23], v[28:31], v[220:223], v[20:23]
    s_nop 0
    ds_read_b64 v[68:69], v19 offset:12352
    s_nop 0
    ds_read_b128 v[104:107], v24 offset:13056
    s_nop 2
    ds_read_b64 v[108:109], v19 offset:13120
    v_mul_f32 v20, 0xbbaaaaab, v20
    v_mul_f32 v21, 0xbbaaaaab, v21
    v_mul_f32 v22, 0xbbaaaaab, v22
    v_mul_f32 v23, 0xbbaaaaab, v23
    ds_write_b128 v25, v[20:23] offset:256
    s_waitcnt lgkmcnt(0)
    s_barrier
    ds_read_b128 v[40:43], v18 offset:0
    ds_read_b128 v[28:31], v18 offset:64
    ds_read_b128 v[36:39], v18 offset:128
    ds_read_b128 v[56:59], v18 offset:192
    s_waitcnt lgkmcnt(3)
    v_mfma_f32_16x16x16_bf16 v[32:35], v[12:13], v[168:169], v[40:43]
    v_mfma_f32_16x16x16_bf16 v[20:23], v[14:15], v[168:169], v[40:43]
    s_nop 2
    v_mfma_f32_16x16x16_bf16 v[60:63], v[16:17], v[168:169], v[40:43]
    s_waitcnt lgkmcnt(0)
    s_nop 0
    ds_read_b128 v[12:15], v24 offset:24576
    v_cvt_pk_bf16_f32 v32, v32, v33
    v_mfma_f32_16x16x16_bf16 v[52:55], v[70:71], v[168:169], v[28:31]
    ds_read_b64 v[16:17], v19 offset:24640
    v_accvgpr_write_b32 a216, v32
    v_mfma_f32_16x16x16_bf16 v[44:47], v[72:73], v[168:169], v[28:31]
    ds_read_b128 v[48:51], v18 offset:256
    v_cvt_pk_bf16_f32 v34, v34, v35
    v_mfma_f32_16x16x16_bf16 v[40:43], v[74:75], v[168:169], v[28:31]
    ds_read_b128 v[98:101], v24 offset:25344
    v_accvgpr_write_b32 a217, v34
    v_mfma_f32_16x16x16_bf16 v[84:87], v[64:65], v[168:169], v[36:39]
    ds_read_b64 v[102:103], v19 offset:25408
    v_cvt_pk_bf16_f32 v20, v20, v21
    v_mfma_f32_16x16x16_bf16 v[32:35], v[66:67], v[168:169], v[36:39]
    ds_read_b128 v[80:83], v18 offset:320
    v_accvgpr_write_b32 a240, v20
    v_mfma_f32_16x16x16_bf16 v[28:31], v[68:69], v[168:169], v[36:39]
    ds_read_b128 v[92:95], v24 offset:36864
    v_cvt_pk_bf16_f32 v22, v22, v23
    v_mfma_f32_16x16x16_bf16 v[68:71], v[104:105], v[168:169], v[56:59]
    ds_read_b64 v[96:97], v19 offset:36928
    v_accvgpr_write_b32 a241, v22
    v_mfma_f32_16x16x16_bf16 v[36:39], v[106:107], v[168:169], v[56:59]
    ds_read_b128 v[64:67], v18 offset:5120
    v_cvt_pk_bf16_f32 v232, v60, v61
    v_mfma_f32_16x16x16_bf16 v[20:23], v[108:109], v[168:169], v[56:59]
    s_waitcnt lgkmcnt(6)
    ds_read_b128 v[110:113], v24 offset:37632
    v_cvt_pk_bf16_f32 v233, v62, v63
    v_cvt_pk_bf16_f32 v52, v52, v53
    v_accvgpr_write_b32 a218, v52
    v_cvt_pk_bf16_f32 v54, v54, v55
    v_accvgpr_write_b32 a219, v54
    v_cvt_pk_bf16_f32 v44, v44, v45
    v_mfma_f32_16x16x16_bf16 v[88:91], v[12:13], v[168:169], v[48:51]
    ds_read_b64 v[114:115], v19 offset:37696
    v_accvgpr_write_b32 a242, v44
    v_mfma_f32_16x16x16_bf16 v[56:59], v[14:15], v[168:169], v[48:51]
    ds_read_b128 v[60:63], v18 offset:5184
    v_cvt_pk_bf16_f32 v46, v46, v47
    v_mfma_f32_16x16x16_bf16 v[52:55], v[16:17], v[168:169], v[48:51]
    s_waitcnt lgkmcnt(6)
    ds_read_b128 v[12:15], v24 offset:49152
    v_accvgpr_write_b32 a243, v46
    v_cvt_pk_bf16_f32 v234, v40, v41
    v_cvt_pk_bf16_f32 v235, v42, v43
    v_mfma_f32_16x16x16_bf16 v[48:51], v[98:99], v[168:169], v[80:83]
    ds_read_b64 v[16:17], v19 offset:49216
    v_cvt_pk_bf16_f32 v84, v84, v85
    v_mfma_f32_16x16x16_bf16 v[44:47], v[100:101], v[168:169], v[80:83]
    ds_read_b128 v[72:75], v18 offset:5248
    v_accvgpr_write_b32 a220, v84
    v_mfma_f32_16x16x16_bf16 v[40:43], v[102:103], v[168:169], v[80:83]
    s_waitcnt lgkmcnt(6)
    ds_read_b128 v[104:107], v24 offset:49920
    v_cvt_pk_bf16_f32 v86, v86, v87
    v_accvgpr_write_b32 a221, v86
    v_cvt_pk_bf16_f32 v32, v32, v33
    v_accvgpr_write_b32 a244, v32
    v_cvt_pk_bf16_f32 v34, v34, v35
    v_accvgpr_write_b32 a245, v34
    v_cvt_pk_bf16_f32 v236, v28, v29
    v_cvt_pk_bf16_f32 v237, v30, v31
    v_mfma_f32_16x16x16_bf16 v[84:87], v[92:93], v[168:169], v[64:67]
    ds_read_b64 v[108:109], v19 offset:49984
    v_cvt_pk_bf16_f32 v68, v68, v69
    v_mfma_f32_16x16x16_bf16 v[28:31], v[94:95], v[168:169], v[64:67]
    ds_read_b128 v[100:103], v18 offset:5312
    v_accvgpr_write_b32 a222, v68
    v_mfma_f32_16x16x16_bf16 v[32:35], v[96:97], v[168:169], v[64:67]
    s_waitcnt lgkmcnt(5)
    ds_read_b128 v[92:95], v24 offset:61440
    v_cvt_pk_bf16_f32 v70, v70, v71
    v_accvgpr_write_b32 a223, v70
    v_cvt_pk_bf16_f32 v36, v36, v37
    v_accvgpr_write_b32 a246, v36
    v_cvt_pk_bf16_f32 v38, v38, v39
    v_accvgpr_write_b32 a247, v38
    v_cvt_pk_bf16_f32 v238, v20, v21
    v_cvt_pk_bf16_f32 v239, v22, v23
    v_mfma_f32_16x16x16_bf16 v[36:39], v[110:111], v[168:169], v[60:63]
    ds_read_b64 v[96:97], v19 offset:61504
    v_cvt_pk_bf16_f32 v88, v88, v89
    v_mfma_f32_16x16x16_bf16 v[68:71], v[112:113], v[168:169], v[60:63]
    ds_read_b128 v[80:83], v18 offset:5376
    v_accvgpr_write_b32 a224, v88
    v_mfma_f32_16x16x16_bf16 v[64:67], v[114:115], v[168:169], v[60:63]
    s_waitcnt lgkmcnt(5)
    ds_read_b128 v[20:23], v24 offset:62208
    v_cvt_pk_bf16_f32 v90, v90, v91
    v_accvgpr_write_b32 a225, v90
    v_cvt_pk_bf16_f32 v56, v56, v57
    v_accvgpr_write_b32 a248, v56
    v_cvt_pk_bf16_f32 v58, v58, v59
    v_accvgpr_write_b32 a249, v58
    v_cvt_pk_bf16_f32 v240, v52, v53
    v_cvt_pk_bf16_f32 v241, v54, v55
    v_mfma_f32_16x16x16_bf16 v[60:63], v[12:13], v[168:169], v[72:75]
    ds_read_b64 v[24:25], v19 offset:62272
    v_cvt_pk_bf16_f32 v48, v48, v49
    v_mfma_f32_16x16x16_bf16 v[56:59], v[14:15], v[168:169], v[72:75]
    ds_read_b128 v[12:15], v18 offset:5440
    v_accvgpr_write_b32 a226, v48
    v_mfma_f32_16x16x16_bf16 v[52:55], v[16:17], v[168:169], v[72:75]
    s_waitcnt lgkmcnt(5)
    ds_read_b128 v[16:19], v137 offset:0
    v_cvt_pk_bf16_f32 v50, v50, v51
    v_accvgpr_write_b32 a227, v50
    v_cvt_pk_bf16_f32 v44, v44, v45
    v_accvgpr_write_b32 a250, v44
    v_cvt_pk_bf16_f32 v46, v46, v47
    v_accvgpr_write_b32 a251, v46
    v_cvt_pk_bf16_f32 v242, v40, v41
    v_cvt_pk_bf16_f32 v243, v42, v43
    v_mfma_f32_16x16x16_bf16 v[48:51], v[104:105], v[168:169], v[100:103]
    ds_read_b128 v[146:149], v136 offset:0
    v_cvt_pk_bf16_f32 v84, v84, v85
    v_mfma_f32_16x16x16_bf16 v[40:43], v[106:107], v[168:169], v[100:103]
    ds_read_b128 v[72:75], v137 offset:128
    v_accvgpr_write_b32 a228, v84
    v_mfma_f32_16x16x16_bf16 v[44:47], v[108:109], v[168:169], v[100:103]
    s_waitcnt lgkmcnt(5)
    ds_read_b128 v[88:91], v136 offset:128
    v_cvt_pk_bf16_f32 v86, v86, v87
    v_accvgpr_write_b32 a229, v86
    v_cvt_pk_bf16_f32 v28, v28, v29
    v_accvgpr_write_b32 a252, v28
    v_cvt_pk_bf16_f32 v30, v30, v31
    v_accvgpr_write_b32 a253, v30
    v_cvt_pk_bf16_f32 v244, v32, v33
    v_cvt_pk_bf16_f32 v245, v34, v35
    v_mfma_f32_16x16x16_bf16 v[32:35], v[92:93], v[168:169], v[80:83]
    s_waitcnt vmcnt(0) lgkmcnt(4)
    s_barrier
    ds_write_b128 v27, v[8:11] offset:6144
    v_mfma_f32_16x16x16_bf16 v[8:11], v[94:95], v[168:169], v[80:83]
    v_cvt_pk_bf16_f32 v36, v36, v37
    v_accvgpr_write_b32 a230, v36
    v_mfma_f32_16x16x16_bf16 v[28:31], v[96:97], v[168:169], v[80:83]
    s_waitcnt lgkmcnt(4)
    v_cvt_pk_bf16_f32 v38, v38, v39
    v_accvgpr_write_b32 a231, v38
    v_cvt_pk_bf16_f32 v68, v68, v69
    v_mfma_f32_16x16x32_bf16 v[36:39], a[0:3], v[16:19], 0
    s_waitcnt lgkmcnt(3)
    ds_write_b64 v156, v[246:247] offset:80
    v_mfma_f32_16x16x32_bf16 v[36:39], a[4:7], v[146:149], v[36:39]
    s_waitcnt lgkmcnt(3)
    v_accvgpr_write_b32 a254, v68
    v_cvt_pk_bf16_f32 v70, v70, v71
    v_mfma_f32_16x16x32_bf16 v[36:39], a[8:11], v[72:75], v[36:39]
    s_waitcnt lgkmcnt(2)
    ds_write_b128 v156, v[76:79] offset:96
    v_mfma_f32_16x16x32_bf16 v[36:39], a[12:15], v[88:91], v[36:39]
    v_accvgpr_write_b32 a255, v70
    v_cvt_pk_bf16_f32 v246, v64, v65
    v_cvt_pk_bf16_f32 v247, v66, v67
    v_cvt_pk_bf16_f32 v60, v60, v61
    v_accvgpr_write_b32 a232, v60
    v_cvt_pk_bf16_f32 v62, v62, v63
    v_accvgpr_write_b32 a233, v62
    v_cvt_pk_bf16_f32 v224, v56, v57
    v_cvt_pk_bf16_f32 v225, v58, v59
    v_cvt_pk_bf16_f32 v248, v52, v53
    v_cvt_pk_bf16_f32 v249, v54, v55
    v_cvt_pk_bf16_f32 v48, v48, v49
    v_accvgpr_write_b32 a234, v48
    v_cvt_pk_bf16_f32 v50, v50, v51
    v_accvgpr_write_b32 a235, v50
    v_cvt_pk_bf16_f32 v226, v40, v41
    v_cvt_pk_bf16_f32 v227, v42, v43
    v_cvt_pk_bf16_f32 v250, v44, v45
    v_cvt_pk_bf16_f32 v251, v46, v47
    v_cvt_pk_bf16_f32 v32, v32, v33
    v_accvgpr_write_b32 a236, v32
    v_cvt_pk_bf16_f32 v34, v34, v35
    v_accvgpr_write_b32 a237, v34
    v_cvt_pk_bf16_f32 v228, v8, v9
    v_cvt_pk_bf16_f32 v229, v10, v11
    v_cvt_pk_bf16_f32 v252, v28, v29
    v_cvt_pk_bf16_f32 v253, v30, v31
    v_mov_b32 v230, 0
    v_mov_b32 v231, 0
    v_mov_b32 v27, 0
    v_add_u32 v170, 0, v156
    ds_write_b128 v170, v[4:7]
    v_add_u32 v135, s49, v135
    v_add_u32 v134, s49, v134
    ds_write2_b64 v170, v[230:231], v[230:231] offset0:2 offset1:3
    ds_write_b128 v170, v[0:3] offset:32
    ds_write2_b64 v170, v[254:255], v[230:231] offset0:6 offset1:7
    ds_write2_b64 v170, v[230:231], v[120:121] offset0:8 offset1:9
    ds_write_b64 v170, v[26:27] offset:88
    ds_read_b128 v[76:79], v137 offset:256
    ds_read_b128 v[56:59], v136 offset:256
    s_waitcnt lgkmcnt(1)
    v_mfma_f32_16x16x32_bf16 v[36:39], a[16:19], v[76:79], v[36:39]
    s_waitcnt lgkmcnt(0)
    v_mfma_f32_16x16x32_bf16 v[36:39], a[20:23], v[56:59], v[36:39]
    s_nop 0
    v_mfma_f32_16x16x16_bf16 v[8:11], v[20:21], v[168:169], v[12:15]
    s_nop 3
    v_mfma_f32_16x16x16_bf16 v[4:7], v[22:23], v[168:169], v[12:15]
    s_nop 0
    v_fma_f32 v121, v36, v36, s41
    v_fmac_f32 v121, v37, v37
    v_mfma_f32_16x16x16_bf16 v[0:3], v[24:25], v[168:169], v[12:15]
    v_cvt_pk_bf16_f32 v8, v8, v9
    v_accvgpr_write_b32 a238, v8
    v_cvt_pk_bf16_f32 v10, v10, v11
    v_mfma_f32_16x16x32_bf16 v[48:51], a[24:27], v[16:19], 0
    v_accvgpr_write_b32 a239, v10
    v_cvt_pk_bf16_f32 v230, v4, v5
    v_mfma_f32_16x16x32_bf16 v[48:51], a[28:31], v[146:149], v[48:51]
    v_cvt_pk_bf16_f32 v231, v6, v7
    v_cvt_pk_bf16_f32 v254, v0, v1
    v_mfma_f32_16x16x32_bf16 v[48:51], a[32:35], v[72:75], v[48:51]
    v_cvt_pk_bf16_f32 v255, v2, v3
    v_fmac_f32 v121, v38, v38
    v_mfma_f32_16x16x32_bf16 v[48:51], a[36:39], v[88:91], v[48:51]
    v_fmac_f32 v121, v39, v39
    v_mfma_f32_16x16x32_bf16 v[48:51], a[40:43], v[76:79], v[48:51]
    v_mfma_f32_16x16x32_bf16 v[48:51], a[44:47], v[56:59], v[48:51]
    s_nop 1
    v_mfma_f32_16x16x32_bf16 v[40:43], a[48:51], v[16:19], 0
    s_nop 2
    v_mfma_f32_16x16x32_bf16 v[40:43], a[52:55], v[146:149], v[40:43]
    s_nop 0
    v_fmac_f32 v121, v48, v48
    v_fmac_f32 v121, v49, v49
    v_mfma_f32_16x16x32_bf16 v[40:43], a[56:59], v[72:75], v[40:43]
    v_fmac_f32 v121, v50, v50
    v_fmac_f32 v121, v51, v51
    v_mfma_f32_16x16x32_bf16 v[40:43], a[60:63], v[88:91], v[40:43]
    v_mfma_f32_16x16x32_bf16 v[40:43], a[64:67], v[76:79], v[40:43]
    v_mfma_f32_16x16x32_bf16 v[40:43], a[68:71], v[56:59], v[40:43]
    s_nop 1
    v_mfma_f32_16x16x32_bf16 v[28:31], a[72:75], v[16:19], 0
    s_nop 2
    v_mfma_f32_16x16x32_bf16 v[28:31], a[76:79], v[146:149], v[28:31]
    s_nop 0
    v_fmac_f32 v121, v40, v40
    v_fmac_f32 v121, v41, v41
    v_mfma_f32_16x16x32_bf16 v[28:31], a[80:83], v[72:75], v[28:31]
    v_fmac_f32 v121, v42, v42
    v_fmac_f32 v121, v43, v43
    v_mfma_f32_16x16x32_bf16 v[28:31], a[84:87], v[88:91], v[28:31]
    v_mfma_f32_16x16x32_bf16 v[28:31], a[88:91], v[76:79], v[28:31]
    v_mfma_f32_16x16x32_bf16 v[28:31], a[92:95], v[56:59], v[28:31]
    s_nop 1
    v_mfma_f32_16x16x32_bf16 v[32:35], a[96:99], v[16:19], 0
    s_nop 2
    v_mfma_f32_16x16x32_bf16 v[32:35], a[100:103], v[146:149], v[32:35]
    s_nop 0
    v_fma_f32 v120, v28, v28, s41
    v_fmac_f32 v120, v29, v29
    v_mfma_f32_16x16x32_bf16 v[32:35], a[104:107], v[72:75], v[32:35]
    v_fmac_f32 v120, v30, v30
    v_fmac_f32 v120, v31, v31
    v_mfma_f32_16x16x32_bf16 v[32:35], a[108:111], v[88:91], v[32:35]
    v_mfma_f32_16x16x32_bf16 v[32:35], a[112:115], v[76:79], v[32:35]
    v_mfma_f32_16x16x32_bf16 v[32:35], a[116:119], v[56:59], v[32:35]
    s_nop 1
    v_mfma_f32_16x16x32_bf16 v[20:23], a[120:123], v[16:19], 0
    s_nop 2
    v_mfma_f32_16x16x32_bf16 v[20:23], a[124:127], v[146:149], v[20:23]
    s_nop 0
    v_fmac_f32 v120, v32, v32
    v_fmac_f32 v120, v33, v33
    v_mfma_f32_16x16x32_bf16 v[20:23], a[128:131], v[72:75], v[20:23]
    v_fmac_f32 v120, v34, v34
    v_fmac_f32 v120, v35, v35
    v_mfma_f32_16x16x32_bf16 v[20:23], a[132:135], v[88:91], v[20:23]
    v_mfma_f32_16x16x32_bf16 v[20:23], a[136:139], v[76:79], v[20:23]
    v_mfma_f32_16x16x32_bf16 v[20:23], a[140:143], v[56:59], v[20:23]
    s_nop 1
    v_mfma_f32_16x16x32_bf16 v[8:11], v[16:19], a[144:147], 0
    s_nop 2
    v_mfma_f32_16x16x32_bf16 v[8:11], v[146:149], a[148:151], v[8:11]
    s_nop 0
    v_fmac_f32 v120, v20, v20
    v_fmac_f32 v120, v21, v21
    v_mfma_f32_16x16x32_bf16 v[8:11], v[72:75], a[152:155], v[8:11]
    v_fmac_f32 v120, v22, v22
    v_fmac_f32 v120, v23, v23
    v_mfma_f32_16x16x32_bf16 v[8:11], v[88:91], a[156:159], v[8:11]
    v_cvt_pk_bf16_f32 v170, v121, v120
    v_mfma_f32_16x16x32_bf16 v[8:11], v[76:79], a[160:163], v[8:11]
    ds_read_b128 v[104:107], v137 offset:1536
    v_mfma_f32_16x16x32_bf16 v[8:11], v[56:59], a[164:167], v[8:11]
    s_nop 0
    ds_read_b128 v[100:103], v136 offset:1536
    s_nop 0
    v_mfma_f32_16x16x16_bf16 v[24:27], v[216:217], v[170:171], 0
    s_nop 0
    ds_read_b128 v[44:47], v137 offset:1664
    s_nop 1
    v_cvt_pk_bf16_f32 v0, v8, v9
    v_mfma_f32_16x16x32_bf16 v[4:7], v[16:19], a[168:171], 0
    ds_read_b128 v[84:87], v136 offset:1664
    v_cvt_pk_bf16_f32 v1, v10, v11
    v_mfma_f32_16x16x32_bf16 v[4:7], v[146:149], a[172:175], v[4:7]
    ds_read_b128 v[68:71], v137 offset:1792
    v_mfma_f32_16x16x32_bf16 v[4:7], v[72:75], a[176:179], v[4:7]
    ds_read_b128 v[64:67], v136 offset:1792
    v_mfma_f32_16x16x32_bf16 v[4:7], v[88:91], a[180:183], v[4:7]
    v_rsq_f32 v24, v24
    v_mfma_f32_16x16x32_bf16 v[4:7], v[76:79], a[184:187], v[4:7]
    v_rsq_f32 v25, v25
    v_mfma_f32_16x16x32_bf16 v[4:7], v[56:59], a[188:191], v[4:7]
    v_mul_f32 v24, s55, v24
    v_mul_f32 v25, 0.5, v25
    v_mfma_f32_16x16x32_bf16 v[12:15], v[16:19], a[192:195], 0
    s_nop 0
    v_mul_f32 v36, v36, v24
    v_mul_f32 v37, v37, v24
    v_mfma_f32_16x16x32_bf16 v[12:15], v[146:149], a[196:199], v[12:15]
    s_nop 0
    v_cvt_pk_bf16_f32 v8, v4, v5
    v_cvt_pk_bf16_f32 v9, v6, v7
    v_mfma_f32_16x16x32_bf16 v[12:15], v[72:75], a[200:203], v[12:15]
    v_cvt_pk_f16_f32 v4, v36, v37
    v_mul_f32 v38, v38, v24
    v_mfma_f32_16x16x32_bf16 v[12:15], v[88:91], a[204:207], v[12:15]
    v_mul_f32 v39, v39, v24
    v_cvt_pk_f16_f32 v5, v38, v39
    v_mfma_f32_16x16x32_bf16 v[12:15], v[76:79], a[208:211], v[12:15]
    v_mul_f32 v48, v48, v24
    v_mul_f32 v49, v49, v24
    v_mfma_f32_16x16x32_bf16 v[12:15], v[56:59], a[212:215], v[12:15]
    s_waitcnt lgkmcnt(0)
    v_cvt_pk_f16_f32 v6, v48, v49
    v_mul_f32 v50, v50, v24
    v_mfma_f32_16x16x32_bf16 v[16:19], a[0:3], v[104:107], 0
    v_mul_f32 v51, v51, v24
    v_cvt_pk_f16_f32 v7, v50, v51
    v_mfma_f32_16x16x32_bf16 v[16:19], a[4:7], v[100:103], v[16:19]
    v_mul_f32 v40, v40, v24
    v_mul_f32 v41, v41, v24
    v_mfma_f32_16x16x32_bf16 v[16:19], a[8:11], v[44:47], v[16:19]
    v_cvt_pk_f16_f32 v152, v40, v41
    v_mul_f32 v42, v42, v24
    v_mfma_f32_16x16x32_bf16 v[16:19], a[12:15], v[84:87], v[16:19]
    v_mul_f32 v43, v43, v24
    v_cvt_pk_f16_f32 v153, v42, v43
    v_mfma_f32_16x16x32_bf16 v[16:19], a[16:19], v[68:71], v[16:19]
    v_mul_f32 v28, v28, v25
    v_mul_f32 v29, v29, v25
    v_mfma_f32_16x16x32_bf16 v[16:19], a[20:23], v[64:67], v[16:19]
    v_cvt_pk_f16_f32 v28, v28, v29
    v_mul_f32 v30, v30, v25
    v_mfma_f32_16x16x32_bf16 v[60:63], a[24:27], v[104:107], 0
    v_mul_f32 v31, v31, v25
    v_cvt_pk_f16_f32 v29, v30, v31
    v_mfma_f32_16x16x32_bf16 v[60:63], a[28:31], v[100:103], v[60:63]
    v_mul_f32 v32, v32, v25
    v_mul_f32 v33, v33, v25
    v_mfma_f32_16x16x32_bf16 v[60:63], a[32:35], v[44:47], v[60:63]
    v_cvt_pk_f16_f32 v30, v32, v33
    v_mul_f32 v34, v34, v25
    v_mfma_f32_16x16x32_bf16 v[60:63], a[36:39], v[84:87], v[60:63]
    v_mul_f32 v35, v35, v25
    v_cvt_pk_f16_f32 v31, v34, v35
    v_mfma_f32_16x16x32_bf16 v[60:63], a[40:43], v[68:71], v[60:63]
    v_mul_f32 v20, v20, v25
    v_mul_f32 v21, v21, v25
    v_mfma_f32_16x16x32_bf16 v[60:63], a[44:47], v[64:67], v[60:63]
    v_cvt_pk_f16_f32 v154, v20, v21
    v_mul_f32 v22, v22, v25
    v_mfma_f32_16x16x32_bf16 v[36:39], a[48:51], v[104:107], 0
    v_mul_f32 v23, v23, v25
    v_cvt_pk_f16_f32 v155, v22, v23
    v_mfma_f32_16x16x32_bf16 v[36:39], a[52:55], v[100:103], v[36:39]
    v_cvt_pk_bf16_f32 v20, v12, v13
    v_cvt_pk_bf16_f32 v21, v14, v15
    v_mfma_f32_16x16x32_bf16 v[36:39], a[56:59], v[44:47], v[36:39]
    v_fma_f32 v2, v16, v16, s41
    v_fmac_f32 v2, v17, v17
    v_mfma_f32_16x16x32_bf16 v[36:39], a[60:63], v[84:87], v[36:39]
    v_fmac_f32 v2, v18, v18
    v_fmac_f32 v2, v19, v19
    v_mfma_f32_16x16x32_bf16 v[36:39], a[64:67], v[68:71], v[36:39]
    v_fmac_f32 v2, v60, v60
    v_fmac_f32 v2, v61, v61
    v_mfma_f32_16x16x32_bf16 v[36:39], a[68:71], v[64:67], v[36:39]
    v_fmac_f32 v2, v62, v62
    v_fmac_f32 v2, v63, v63
    v_mfma_f32_16x16x32_bf16 v[52:55], a[72:75], v[104:107], 0
    s_nop 2
    v_mfma_f32_16x16x32_bf16 v[52:55], a[76:79], v[100:103], v[52:55]
    s_nop 0
    v_fmac_f32 v2, v36, v36
    v_fmac_f32 v2, v37, v37
    v_mfma_f32_16x16x32_bf16 v[52:55], a[80:83], v[44:47], v[52:55]
    v_fmac_f32 v2, v38, v38
    v_fmac_f32 v2, v39, v39
    v_mfma_f32_16x16x32_bf16 v[52:55], a[84:87], v[84:87], v[52:55]
    v_mfma_f32_16x16x32_bf16 v[52:55], a[88:91], v[68:71], v[52:55]
    v_mfma_f32_16x16x32_bf16 v[52:55], a[92:95], v[64:67], v[52:55]
    s_nop 1
    v_mfma_f32_16x16x32_bf16 v[12:15], a[96:99], v[104:107], 0
    s_nop 2
    v_mfma_f32_16x16x32_bf16 v[12:15], a[100:103], v[100:103], v[12:15]
    s_nop 0
    v_fma_f32 v3, v52, v52, s41
    v_fmac_f32 v3, v53, v53
    v_mfma_f32_16x16x32_bf16 v[12:15], a[104:107], v[44:47], v[12:15]
    v_fmac_f32 v3, v54, v54
    v_fmac_f32 v3, v55, v55
    v_mfma_f32_16x16x32_bf16 v[12:15], a[108:111], v[84:87], v[12:15]
    v_mfma_f32_16x16x32_bf16 v[12:15], a[112:115], v[68:71], v[12:15]
    v_mfma_f32_16x16x32_bf16 v[12:15], a[116:119], v[64:67], v[12:15]
    s_sub_u32 s50, s45, s44
    v_add_u32 v135, s48, v135
    v_add_u32 v134, s48, v134
    v_mfma_f32_16x16x32_bf16 v[48:51], a[120:123], v[104:107], 0
    s_sub_u32 s51, s46, s47
    v_add_u32 v133, s51, v133
    v_mfma_f32_16x16x32_bf16 v[48:51], a[124:127], v[100:103], v[48:51]
    s_mov_b32 s60, s59
    v_fmac_f32 v3, v12, v12
    v_fmac_f32 v3, v13, v13
    v_mfma_f32_16x16x32_bf16 v[48:51], a[128:131], v[44:47], v[48:51]
    s_mov_b32 s59, s58
    v_fmac_f32 v3, v14, v14
    v_fmac_f32 v3, v15, v15
    v_mfma_f32_16x16x32_bf16 v[48:51], a[132:135], v[84:87], v[48:51]
    s_mov_b32 s58, s57
    v_mfma_f32_16x16x32_bf16 v[48:51], a[136:139], v[68:71], v[48:51]
    s_mov_b32 s57, s56
    v_mfma_f32_16x16x32_bf16 v[48:51], a[140:143], v[64:67], v[48:51]
    s_mov_b32 s7, s6
    s_nop 0
    v_mfma_f32_16x16x32_bf16 v[24:27], v[104:107], a[144:147], 0
    s_mov_b32 s6, s5
    s_nop 1
    v_mfma_f32_16x16x32_bf16 v[24:27], v[100:103], a[148:151], v[24:27]
    s_mov_b32 s5, s4
    v_fmac_f32 v3, v48, v48
    v_fmac_f32 v3, v49, v49
    v_mfma_f32_16x16x32_bf16 v[24:27], v[44:47], a[152:155], v[24:27]
    s_sub_u32 s14, s6, s7
    v_fmac_f32 v3, v50, v50
    v_fmac_f32 v3, v51, v51
    v_mfma_f32_16x16x32_bf16 v[24:27], v[84:87], a[156:159], v[24:27]
    s_add_u32 s61, s61, 1
    v_cvt_pk_bf16_f32 v170, v2, v3
    v_add_u32 v132, s14, v132
    v_mfma_f32_16x16x32_bf16 v[24:27], v[68:71], a[160:163], v[24:27]
    s_ff1_i32_b32 s15, s66
    ds_read_b128 v[96:99], v137 offset:3072
    v_add_u32 v131, s14, v131
    v_mfma_f32_16x16x32_bf16 v[24:27], v[64:67], a[164:167], v[24:27]
    s_cmp_lg_u32 s66, 0
    ds_read_b128 v[92:95], v136 offset:3072
    v_add_u32 v123, s14, v123
    v_mfma_f32_16x16x16_bf16 v[40:43], v[216:217], v[170:171], 0
    s_cselect_b32 s12, s15, s12
    ds_read_b128 v[88:91], v137 offset:3200
    s_nop 1
    v_cvt_pk_bf16_f32 v2, v24, v25
    v_mfma_f32_16x16x32_bf16 v[72:75], v[104:107], a[168:171], 0
    s_cmp_lt_u32 s61, s71
    ds_read_b128 v[80:83], v136 offset:3200
    v_cvt_pk_bf16_f32 v3, v26, v27
    v_mfma_f32_16x16x32_bf16 v[72:75], v[100:103], a[172:175], v[72:75]
    s_cselect_b32 s15, 31, s15
    ds_read_b128 v[56:59], v137 offset:3328
    v_add_u32 v137, s50, v137
    v_mfma_f32_16x16x32_bf16 v[72:75], v[44:47], a[176:179], v[72:75]
    s_bitset0_b32 s66, s15
    ds_read_b128 v[24:27], v136 offset:3328
    v_add_u32 v136, s50, v136
    v_mfma_f32_16x16x32_bf16 v[72:75], v[84:87], a[180:183], v[72:75]
    s_add_u32 s12, s12, 20
    v_rsq_f32 v40, v40
    v_mfma_f32_16x16x32_bf16 v[72:75], v[68:71], a[184:187], v[72:75]
    s_max_u32 s12, s12, s61
    v_rsq_f32 v41, v41
    v_mfma_f32_16x16x32_bf16 v[72:75], v[64:67], a[188:191], v[72:75]
    s_cmp_lt_u32 s61, s71
    v_mul_f32 v40, s55, v40
    v_mul_f32 v41, 0.5, v41
    v_mfma_f32_16x16x32_bf16 v[32:35], v[104:107], a[192:195], 0
    s_cselect_b32 s15, s61, s12
    v_mul_f32 v16, v16, v40
    v_mul_f32 v17, v17, v40
    v_mfma_f32_16x16x32_bf16 v[32:35], v[100:103], a[196:199], v[32:35]
    s_cselect_b32 s56, s69, s70
    v_cvt_pk_bf16_f32 v10, v72, v73
    v_cvt_pk_bf16_f32 v11, v74, v75
    v_mfma_f32_16x16x32_bf16 v[32:35], v[44:47], a[200:203], v[32:35]
    s_add_u32 s56, s56, s15
    v_cvt_pk_f16_f32 v44, v16, v17
    v_mul_f32 v18, v18, v40
    v_mfma_f32_16x16x32_bf16 v[32:35], v[84:87], a[204:207], v[32:35]
    s_mul_i32 s53, s56, 58255
    v_mul_f32 v19, v19, v40
    v_cvt_pk_f16_f32 v45, v18, v19
    v_mfma_f32_16x16x32_bf16 v[32:35], v[68:71], a[208:211], v[32:35]
    s_waitcnt lgkmcnt(0)
    s_lshr_b32 s53, s53, 22
    v_mul_f32 v60, v60, v40
    v_mul_f32 v61, v61, v40
    v_mfma_f32_16x16x32_bf16 v[32:35], v[64:67], a[212:215], v[32:35]
    s_barrier
    v_cvt_pk_f16_f32 v46, v60, v61
    v_mul_f32 v62, v62, v40
    v_mfma_f32_16x16x32_bf16 v[16:19], a[0:3], v[96:99], 0
    s_mul_i32 s53, s53, s63
    v_mul_f32 v63, v63, v40
    v_cvt_pk_f16_f32 v47, v62, v63
    v_mfma_f32_16x16x32_bf16 v[16:19], a[4:7], v[92:95], v[16:19]
    s_mul_i32 s56, s56, s62
    v_mul_f32 v36, v36, v40
    v_mul_f32 v37, v37, v40
    v_mfma_f32_16x16x32_bf16 v[16:19], a[8:11], v[88:91], v[16:19]
    s_add_u32 s56, s56, s53
    v_cvt_pk_f16_f32 v146, v36, v37
    v_mul_f32 v38, v38, v40
    v_mfma_f32_16x16x32_bf16 v[16:19], a[12:15], v[80:83], v[16:19]
    s_mul_i32 s4, s15, 112
    v_mul_f32 v39, v39, v40
    v_cvt_pk_f16_f32 v147, v38, v39
    v_mfma_f32_16x16x32_bf16 v[16:19], a[16:19], v[56:59], v[16:19]
    s_cmp_ge_u32 s15, 16
    v_mul_f32 v52, v52, v41
    v_mul_f32 v53, v53, v41
    v_mfma_f32_16x16x32_bf16 v[16:19], a[20:23], v[24:27], v[16:19]
    s_cselect_b32 s53, -30464, 0
    v_cvt_pk_f16_f32 v72, v52, v53
    v_mul_f32 v54, v54, v41
    v_mfma_f32_16x16x32_bf16 v[36:39], a[24:27], v[96:99], 0
    s_add_u32 s4, s4, s53
    v_mul_f32 v55, v55, v41
    v_cvt_pk_f16_f32 v73, v54, v55
    v_mfma_f32_16x16x32_bf16 v[36:39], a[28:31], v[92:95], v[36:39]
    s_cmp_lt_u32 s15, s73
    v_mul_f32 v12, v12, v41
    v_mul_f32 v13, v13, v41
    v_mfma_f32_16x16x32_bf16 v[36:39], a[32:35], v[88:91], v[36:39]
    s_cselect_b32 s26, 100270464, 0
    v_cvt_pk_f16_f32 v74, v12, v13
    v_mul_f32 v14, v14, v41
    v_mfma_f32_16x16x32_bf16 v[36:39], a[36:39], v[80:83], v[36:39]
    s_cselect_b32 s56, s56, 0
    v_mul_f32 v15, v15, v41
    v_cvt_pk_f16_f32 v75, v14, v15
    v_mfma_f32_16x16x32_bf16 v[36:39], a[40:43], v[56:59], v[36:39]
    s_cselect_b32 s4, s4, -1
    v_mul_f32 v48, v48, v41
    v_mul_f32 v49, v49, v41
    v_mfma_f32_16x16x32_bf16 v[36:39], a[44:47], v[24:27], v[36:39]
    s_cselect_b32 s15, s15, 0
    v_cvt_pk_f16_f32 v148, v48, v49
    v_mul_f32 v50, v50, v41
    v_mfma_f32_16x16x32_bf16 v[12:15], a[48:51], v[96:99], 0
    s_cselect_b32 s13, s13, -1
    v_mul_f32 v51, v51, v41
    v_cvt_pk_f16_f32 v149, v50, v51
    v_mfma_f32_16x16x32_bf16 v[12:15], a[52:55], v[92:95], v[12:15]
    s_bitset1_b32 s64, s15
    v_cvt_pk_bf16_f32 v22, v32, v33
    v_cvt_pk_bf16_f32 v23, v34, v35
    v_mfma_f32_16x16x32_bf16 v[12:15], a[56:59], v[88:91], v[12:15]
    s_add_u32 s65, s65, 1
    v_fma_f32 v156, v16, v16, s41
    v_fmac_f32 v156, v17, v17
    v_mfma_f32_16x16x32_bf16 v[12:15], a[60:63], v[80:83], v[12:15]
    s_cmp_ge_i32 s65, 2
    v_fmac_f32 v156, v18, v18
    v_fmac_f32 v156, v19, v19
    v_mfma_f32_16x16x32_bf16 v[12:15], a[64:67], v[56:59], v[12:15]
    s_cselect_b32 s30, 100270464, 0
    v_fmac_f32 v156, v36, v36
    v_fmac_f32 v156, v37, v37
    v_mfma_f32_16x16x32_bf16 v[12:15], a[68:71], v[24:27], v[12:15]
    s_add_u32 s67, s46, s54
    v_fmac_f32 v156, v38, v38
    v_fmac_f32 v156, v39, v39
    v_mfma_f32_16x16x32_bf16 v[64:67], a[72:75], v[96:99], 0
    s_add_u32 m0, s67, 0
    v_and_b32 v120, -8, v123
    v_mfma_f32_16x16x32_bf16 v[64:67], a[76:79], v[92:95], v[64:67]
    buffer_load_dwordx4 v128, s[24:27], s56 offen nt lds
    v_fmac_f32 v156, v12, v12
    v_mfma_f32_16x16x32_bf16 v[64:67], a[80:83], v[88:91], v[64:67]
    s_add_u32 m0, s67, 1024
    v_fmac_f32 v156, v13, v13
    v_fmac_f32 v156, v14, v14
    v_mfma_f32_16x16x32_bf16 v[64:67], a[84:87], v[80:83], v[64:67]
    buffer_load_dwordx4 v127, s[24:27], s56 offen nt lds
    v_fmac_f32 v156, v15, v15
    v_mfma_f32_16x16x32_bf16 v[64:67], a[88:91], v[56:59], v[64:67]
    s_add_u32 m0, s67, 2048
    v_mfma_f32_16x16x32_bf16 v[64:67], a[92:95], v[24:27], v[64:67]
    buffer_load_dwordx4 v126, s[24:27], s56 offen nt lds
    v_mfma_f32_16x16x32_bf16 v[32:35], a[96:99], v[96:99], 0
    s_add_u32 m0, s67, 3072
    s_nop 1
    v_mfma_f32_16x16x32_bf16 v[32:35], a[100:103], v[92:95], v[32:35]
    s_nop 0
    buffer_load_dwordx4 v125, s[24:27], s56 offen nt lds
    v_fma_f32 v121, v64, v64, s41
    v_mfma_f32_16x16x32_bf16 v[32:35], a[104:107], v[88:91], v[32:35]
    s_add_u32 m0, s67, 4096
    v_fmac_f32 v121, v65, v65
    v_fmac_f32 v121, v66, v66
    v_mfma_f32_16x16x32_bf16 v[32:35], a[108:111], v[80:83], v[32:35]
    buffer_load_dwordx4 v124, s[24:27], s56 offen nt lds
    v_fmac_f32 v121, v67, v67
    v_mfma_f32_16x16x32_bf16 v[32:35], a[112:115], v[56:59], v[32:35]
    v_mfma_f32_16x16x32_bf16 v[32:35], a[116:119], v[24:27], v[32:35]
    s_nop 1
    v_mfma_f32_16x16x32_bf16 v[40:43], a[120:123], v[96:99], 0
    s_nop 2
    v_mfma_f32_16x16x32_bf16 v[40:43], a[124:127], v[92:95], v[40:43]
    s_mov_b32 s53, s47
    v_fmac_f32 v121, v32, v32
    v_fmac_f32 v121, v33, v33
    v_mfma_f32_16x16x32_bf16 v[40:43], a[128:131], v[88:91], v[40:43]
    s_mov_b32 s47, s46
    v_fmac_f32 v121, v34, v34
    v_fmac_f32 v121, v35, v35
    v_mfma_f32_16x16x32_bf16 v[40:43], a[132:135], v[80:83], v[40:43]
    s_mov_b32 s46, s45
    v_mfma_f32_16x16x32_bf16 v[40:43], a[136:139], v[56:59], v[40:43]
    s_mov_b32 s45, s44
    v_mfma_f32_16x16x32_bf16 v[40:43], a[140:143], v[24:27], v[40:43]
    s_mov_b32 s44, s53
    s_nop 0
    v_mfma_f32_16x16x32_bf16 v[68:71], v[96:99], a[144:147], 0
    s_sub_u32 s48, s44, s46
    v_add_u32 v137, s48, v137
    v_add_u32 v136, s48, v136
    v_mfma_f32_16x16x32_bf16 v[68:71], v[92:95], a[148:151], v[68:71]
    s_sub_u32 s49, s46, s45
    v_fmac_f32 v121, v40, v40
    v_fmac_f32 v121, v41, v41
    v_mfma_f32_16x16x32_bf16 v[68:71], v[88:91], a[152:155], v[68:71]
    v_fmac_f32 v121, v42, v42
    v_fmac_f32 v121, v43, v43
    v_mfma_f32_16x16x32_bf16 v[68:71], v[80:83], a[156:159], v[68:71]
    v_cvt_pk_bf16_f32 v170, v156, v121
    v_mfma_f32_16x16x32_bf16 v[68:71], v[56:59], a[160:163], v[68:71]
    ds_read_b128 v[60:63], v132 offset:0
    v_mfma_f32_16x16x32_bf16 v[68:71], v[24:27], a[164:167], v[68:71]
    s_nop 0
    ds_read_b128 v[52:55], v132 offset:16
    s_nop 0
    v_mfma_f32_16x16x16_bf16 v[76:79], v[216:217], v[170:171], 0
    s_nop 0
    ds_read_b128 v[48:51], v132 offset:48
    s_nop 1
    v_cvt_pk_bf16_f32 v164, v68, v69
    v_mfma_f32_16x16x32_bf16 v[84:87], v[96:99], a[168:171], 0
    v_cvt_pk_bf16_f32 v165, v70, v71
    v_mfma_f32_16x16x32_bf16 v[84:87], v[92:95], a[172:175], v[84:87]
    v_rsq_f32 v76, v76
    v_mfma_f32_16x16x32_bf16 v[84:87], v[88:91], a[176:179], v[84:87]
    v_rsq_f32 v77, v77
    v_mfma_f32_16x16x32_bf16 v[84:87], v[80:83], a[180:183], v[84:87]
    v_mul_f32 v76, s55, v76
    v_mul_f32 v77, 0.5, v77
    v_mfma_f32_16x16x32_bf16 v[84:87], v[56:59], a[184:187], v[84:87]
    v_mul_f32 v64, v64, v77
    v_mul_f32 v65, v65, v77
    v_mfma_f32_16x16x32_bf16 v[84:87], v[24:27], a[188:191], v[84:87]
    v_cvt_pk_f16_f32 v64, v64, v65
    v_mul_f32 v66, v66, v77
    v_mfma_f32_16x16x32_bf16 v[68:71], v[96:99], a[192:195], 0
    s_nop 0
    v_mul_f32 v67, v67, v77
    v_cvt_pk_f16_f32 v65, v66, v67
    v_mfma_f32_16x16x32_bf16 v[68:71], v[92:95], a[196:199], v[68:71]
    s_nop 0
    v_cvt_pk_bf16_f32 v160, v84, v85
    v_cvt_pk_bf16_f32 v161, v86, v87
    v_mfma_f32_16x16x32_bf16 v[68:71], v[88:91], a[200:203], v[68:71]
    v_mul_f32 v32, v32, v77
    v_mul_f32 v33, v33, v77
    v_mfma_f32_16x16x32_bf16 v[68:71], v[80:83], a[204:207], v[68:71]
    v_cvt_pk_f16_f32 v66, v32, v33
    v_mul_f32 v34, v34, v77
    v_mfma_f32_16x16x32_bf16 v[68:71], v[56:59], a[208:211], v[68:71]
    v_mul_f32 v35, v35, v77
    v_cvt_pk_f16_f32 v67, v34, v35
    v_mfma_f32_16x16x32_bf16 v[68:71], v[24:27], a[212:215], v[68:71]
    v_mul_f32 v40, v40, v77
    v_mul_f32 v41, v41, v77
    v_mfma_f32_16x16x32_f16 v[32:35], v[28:31], v[4:7], v[204:207]
    ds_read_u16 v166, v131 offset:80
    v_cvt_pk_f16_f32 v142, v40, v41
    v_mfma_f32_16x16x32_f16 v[32:35], v[152:155], v[150:153], v[32:35]
    ds_read_u16 v162, v131 offset:96
    v_mul_f32 v42, v42, v77
    v_mfma_f32_16x16x32_f16 v[24:27], v[72:75], v[4:7], v[200:203]
    ds_read_u16 v158, v131 offset:104
    v_mul_f32 v43, v43, v77
    v_mfma_f32_16x16x32_f16 v[24:27], v[146:149], v[150:153], v[24:27]
    s_waitcnt lgkmcnt(3)
    ds_read_b32 v120, v120 offset:64
    v_cvt_pk_f16_f32 v143, v42, v43
    v_mfma_f32_16x16x32_f16 v[56:59], v[60:63], v[4:7], v[208:211]
    v_mul_f32 v16, v16, v76
    v_mul_f32 v17, v17, v76
    v_mfma_f32_16x16x32_f16 v[56:59], v[52:55], v[28:31], v[56:59]
    v_cvt_pk_f16_f32 v16, v16, v17
    v_mul_f32 v18, v18, v76
    v_mfma_f32_16x16x32_f16 v[56:59], v[48:51], v[152:155], v[56:59]
    v_mul_f32 v19, v19, v76
    v_cvt_pk_f16_f32 v17, v18, v19
    v_mfma_f32_16x16x32_f16 v[40:43], v[60:63], v[44:47], v[208:211]
    v_mul_f32 v36, v36, v76
    v_mul_f32 v37, v37, v76
    v_mfma_f32_16x16x32_f16 v[40:43], v[52:55], v[72:75], v[40:43]
    v_cvt_pk_f16_f32 v18, v36, v37
    v_mul_f32 v38, v38, v76
    v_mfma_f32_16x16x32_f16 v[40:43], v[48:51], v[146:149], v[40:43]
    v_mul_f32 v39, v39, v76
    v_cvt_pk_f16_f32 v19, v38, v39
    v_mfma_f32_16x16x32_f16 v[36:39], v[28:31], v[44:47], v[192:195]
    v_mul_f32 v12, v12, v76
    v_mul_f32 v13, v13, v76
    v_mfma_f32_16x16x32_f16 v[36:39], v[152:155], v[144:147], v[36:39]
    v_cvt_pk_f16_f32 v140, v12, v13
    v_mul_f32 v14, v14, v76
    v_mul_f32 v15, v15, v76
    v_cvt_pk_f16_f32 v141, v14, v15
    v_mfma_f32_16x16x32_f16 v[12:15], v[64:67], v[4:7], v[196:199]
    v_cvt_pk_bf16_f32 v156, v68, v69
    v_cvt_pk_bf16_f32 v157, v70, v71
    v_mfma_f32_16x16x32_f16 v[12:15], v[140:143], v[150:153], v[12:15]
    v_max3_f32 v121, v32, v33, v34
    v_max3_f32 v121, v121, v35, v24
    v_mfma_f32_16x16x32_f16 v[4:7], v[60:63], v[16:19], v[208:211]
    s_nop 0
    v_max3_f32 v121, v121, v25, v26
    v_mov_b32_dpp v59, v43 quad_perm:[0,1,2,3] row_mask:0x2 bank_mask:0xf
    v_mfma_f32_16x16x32_f16 v[4:7], v[52:55], v[64:67], v[4:7]
    s_nop 0
    v_max3_f32 v121, v121, v27, v12
    v_max3_f32 v121, v121, v13, v14
    v_mfma_f32_16x16x32_f16 v[4:7], v[48:51], v[140:143], v[4:7]
    v_max3_f32 v121, v121, v15, v56
    v_mov_b32 v57, v121
    v_mfma_f32_16x16x32_f16 v[52:55], v[72:75], v[44:47], v[188:191]
    s_nop 0
    v_permlane32_swap_b32 v57, v121
    v_mfma_f32_16x16x32_f16 v[52:55], v[146:149], v[144:147], v[52:55]
    v_max_f32 v121, v57, v121
    v_mov_b32 v57, v121
    v_mfma_f32_16x16x32_f16 v[48:51], v[64:67], v[44:47], v[184:187]
    s_nop 0
    v_permlane16_swap_b32 v57, v121
    v_mfma_f32_16x16x32_f16 v[48:51], v[140:143], v[144:147], v[48:51]
    v_max_f32 v121, v57, v121
    v_sub_f32 v32, v32, v121
    v_sub_f32 v33, v33, v121
    v_sub_f32 v34, v34, v121
    v_sub_f32 v35, v35, v121
    v_sub_f32 v24, v24, v121
    v_sub_f32 v25, v25, v121
    v_sub_f32 v26, v26, v121
    v_sub_f32 v27, v27, v121
    v_sub_f32 v12, v12, v121
    v_sub_f32 v13, v13, v121
    v_sub_f32 v14, v14, v121
    v_sub_f32 v15, v15, v121
    v_sub_f32 v56, v56, v121
    v_exp_f32 v32, v32
    v_exp_f32 v33, v33
    v_exp_f32 v34, v34
    v_exp_f32 v35, v35
    v_cvt_pk_bf16_f32 v60, v32, v33
    v_cvt_pk_bf16_f32 v61, v34, v35
    v_exp_f32 v24, v24
    v_exp_f32 v25, v25
    v_exp_f32 v26, v26
    v_exp_f32 v27, v27
    v_cvt_pk_bf16_f32 v62, v24, v25
    v_cvt_pk_bf16_f32 v63, v26, v27
    v_exp_f32 v12, v12
    v_exp_f32 v13, v13
    v_exp_f32 v14, v14
    v_exp_f32 v15, v15
    v_cvt_pk_bf16_f32 v168, v12, v13
    v_cvt_pk_bf16_f32 v169, v14, v15
    v_exp_f32 v56, v56
    v_mov_b32_dpp v59, v7 quad_perm:[0,1,2,3] row_mask:0x4 bank_mask:0xf
    v_cvt_pk_bf16_f32 v170, v56, 0
    v_mfma_f32_16x16x32_bf16 v[44:47], v[220:223], v[60:63], 0
    s_waitcnt lgkmcnt(0)
    v_and_b32 v121, 0xffff0000, v120
    v_lshlrev_b32 v120, 16, v120
    v_mfma_f32_16x16x32_bf16 v[44:47], v[220:223], v[168:171], v[44:47]
    v_add_f32 v120, v120, v121
    v_add_f32 v120, v120, v211
    v_mfma_f32_16x16x32_bf16 v[12:15], v[0:3], v[60:63], 0
    s_nop 0
    v_mov_b32_dpp v59, v120 quad_perm:[0,1,2,3] row_mask:0x8 bank_mask:0xf
    v_mov_b32 v4, v59
    v_mfma_f32_16x16x32_bf16 v[12:15], v[164:167], v[168:171], v[12:15]
    s_nop 0
    v_max_f32_dpp v4, v4, v4 row_ror:8 row_mask:0xf bank_mask:0xf
    v_max3_f32 v121, v36, v37, v38
    v_mfma_f32_16x16x32_bf16 v[24:27], v[8:11], v[60:63], 0
    v_max_f32_dpp v4, v4, v4 row_ror:4 row_mask:0xf bank_mask:0xf
    v_max3_f32 v121, v121, v39, v52
    v_mfma_f32_16x16x32_bf16 v[24:27], v[160:163], v[168:171], v[24:27]
    v_max_f32_dpp v4, v4, v4 row_ror:2 row_mask:0xf bank_mask:0xf
    v_max3_f32 v121, v121, v53, v54
    v_mfma_f32_16x16x32_bf16 v[32:35], v[20:23], v[60:63], 0
    v_max_f32_dpp v4, v4, v4 row_ror:1 row_mask:0xf bank_mask:0xf
    v_mov_b32 v120, v4
    v_mfma_f32_16x16x32_bf16 v[32:35], v[156:159], v[168:171], v[32:35]
    s_nop 0
    v_permlane32_swap_b32 v120, v4
    v_max_f32 v4, v120, v4
    v_mov_b32 v120, v4
    v_rcp_f32 v44, v44
    v_max3_f32 v121, v121, v55, v48
    v_permlane16_swap_b32 v120, v4
    v_max_f32 v4, v120, v4
    v_sub_f32 v59, v59, v4
    v_exp_f32 v59, v59
    v_mul_f32 v12, v12, v44
    v_cvt_pk_bf16_f32 v59, v59, v59
    ds_write_b16 v123, v59 offset:64
    v_mul_f32 v13, v13, v44
    v_cvt_pk_bf16_f32 v68, v12, v13
    ds_read_b128 v[60:63], v132 offset:48
    v_mul_f32 v14, v14, v44
    v_mul_f32 v15, v15, v44
    v_cvt_pk_bf16_f32 v69, v14, v15
    ds_read_b128 v[56:59], v132 offset:64
    v_mfma_f32_16x16x32_f16 v[12:15], v[28:31], v[16:19], v[180:183]
    v_mul_f32 v24, v24, v44
    v_mul_f32 v25, v25, v44
    v_mfma_f32_16x16x32_f16 v[12:15], v[152:155], v[138:141], v[12:15]
    ds_write_b64 v135, v[68:69] offset:0
    v_mfma_f32_16x16x32_f16 v[28:31], v[72:75], v[16:19], v[176:179]
    v_cvt_pk_bf16_f32 v70, v24, v25
    v_mul_f32 v26, v26, v44
    v_mfma_f32_16x16x32_f16 v[28:31], v[146:149], v[138:141], v[28:31]
    v_mul_f32 v27, v27, v44
    v_cvt_pk_bf16_f32 v71, v26, v27
    v_mfma_f32_16x16x32_f16 v[24:27], v[64:67], v[16:19], v[172:175]
    ds_write_b64 v135, v[70:71] offset:8
    v_mfma_f32_16x16x32_f16 v[24:27], v[140:143], v[138:141], v[24:27]
    s_waitcnt lgkmcnt(3)
    v_mul_f32 v32, v32, v44
    v_mul_f32 v33, v33, v44
    v_cvt_pk_bf16_f32 v146, v32, v33
    v_mul_f32 v34, v34, v44
    v_mfma_f32_16x16x32_bf16 v[16:19], v[60:63], v[0:3], 0
    s_waitcnt lgkmcnt(2)
    v_mul_f32 v35, v35, v44
    v_cvt_pk_bf16_f32 v147, v34, v35
    v_max3_f32 v121, v121, v49, v50
    v_max3_f32 v121, v121, v51, v41
    v_mfma_f32_16x16x32_bf16 v[16:19], v[56:59], v[164:167], v[16:19]
    ds_write_b64 v134, v[146:147] offset:0
    v_mfma_f32_16x16x32_bf16 v[44:47], v[60:63], v[8:11], 0
    v_mov_b32 v146, v121
    v_max3_f32 v120, v12, v13, v14
    v_mfma_f32_16x16x32_bf16 v[44:47], v[56:59], v[160:163], v[44:47]
    v_permlane32_swap_b32 v146, v121
    v_mfma_f32_16x16x32_bf16 v[32:35], v[60:63], v[20:23], 0
    v_max_f32 v121, v146, v121
    v_mov_b32 v146, v121
    v_mfma_f32_16x16x32_bf16 v[32:35], v[56:59], v[156:159], v[32:35]
    s_nop 0
    v_permlane16_swap_b32 v146, v121
    v_max_f32 v121, v146, v121
    v_sub_f32 v36, v36, v121
    v_sub_f32 v37, v37, v121
    v_sub_f32 v38, v38, v121
    v_sub_f32 v39, v39, v121
    v_sub_f32 v52, v52, v121
    v_sub_f32 v53, v53, v121
    v_sub_f32 v54, v54, v121
    v_sub_f32 v55, v55, v121
    v_sub_f32 v48, v48, v121
    v_sub_f32 v49, v49, v121
    v_sub_f32 v50, v50, v121
    v_sub_f32 v51, v51, v121
    v_sub_f32 v41, v41, v121
    v_exp_f32 v36, v36
    v_exp_f32 v37, v37
    v_exp_f32 v38, v38
    v_exp_f32 v39, v39
    v_cvt_pk_bf16_f32 v36, v36, v37
    v_cvt_pk_bf16_f32 v37, v38, v39
    v_exp_f32 v52, v52
    v_exp_f32 v53, v53
    v_exp_f32 v54, v54
    v_exp_f32 v55, v55
    v_cvt_pk_bf16_f32 v38, v52, v53
    v_cvt_pk_bf16_f32 v39, v54, v55
    v_exp_f32 v48, v48
    v_exp_f32 v49, v49
    v_exp_f32 v50, v50
    v_exp_f32 v51, v51
    v_cvt_pk_bf16_f32 v168, v48, v49
    v_cvt_pk_bf16_f32 v169, v50, v51
    v_exp_f32 v41, v41
    v_mov_b32_dpp v19, v47 quad_perm:[0,1,2,3] row_mask:0x2 bank_mask:0xf
    v_cvt_pk_bf16_f32 v170, v41, 0
    v_mfma_f32_16x16x32_bf16 v[44:47], v[220:223], v[36:39], 0
    v_mov_b32_dpp v19, v35 quad_perm:[0,1,2,3] row_mask:0x4 bank_mask:0xf
    v_cvt_pk_bf16_f32 v19, v19, v19
    v_mfma_f32_16x16x32_bf16 v[44:47], v[220:223], v[168:171], v[44:47]
    ds_write_b16 v131, v19
    v_mfma_f32_16x16x32_bf16 v[32:35], v[0:3], v[36:39], 0
    ds_read_b128 v[16:19], v137 offset:0
    v_max3_f32 v120, v120, v15, v28
    v_mfma_f32_16x16x32_bf16 v[32:35], v[164:167], v[168:171], v[32:35]
    ds_read_b128 v[146:149], v136 offset:0
    v_max3_f32 v120, v120, v29, v30
    v_mfma_f32_16x16x32_bf16 v[48:51], v[8:11], v[36:39], 0
    ds_read_b128 v[72:75], v137 offset:128
    v_max3_f32 v120, v120, v31, v24
    v_mfma_f32_16x16x32_bf16 v[48:51], v[160:163], v[168:171], v[48:51]
    ds_read_b128 v[88:91], v136 offset:128
    v_max3_f32 v120, v120, v25, v26
    v_mfma_f32_16x16x32_bf16 v[40:43], v[20:23], v[36:39], 0
    ds_read_b128 v[76:79], v137 offset:256
    v_max3_f32 v120, v120, v27, v6
    v_mfma_f32_16x16x32_bf16 v[40:43], v[156:159], v[168:171], v[40:43]
    ds_read_b128 v[56:59], v136 offset:256
    v_mov_b32 v121, v120
    v_rcp_f32 v44, v44
    s_nop 0
    v_mul_f32 v32, v32, v44
    v_mul_f32 v33, v33, v44
    v_cvt_pk_bf16_f32 v32, v32, v33
    v_mul_f32 v34, v34, v44
    v_mul_f32 v35, v35, v44
    v_cvt_pk_bf16_f32 v33, v34, v35
    v_mul_f32 v48, v48, v44
    v_mul_f32 v49, v49, v44
    v_cvt_pk_bf16_f32 v34, v48, v49
    v_mul_f32 v50, v50, v44
    s_waitcnt lgkmcnt(5)
    v_mfma_f32_16x16x32_bf16 v[36:39], a[0:3], v[16:19], 0
    ds_write_b64 v135, v[32:33] offset:1536
    v_mul_f32 v51, v51, v44
    v_cvt_pk_bf16_f32 v35, v50, v51
    v_mul_f32 v40, v40, v44
    v_mul_f32 v41, v41, v44
    v_cvt_pk_bf16_f32 v4, v40, v41
    v_mul_f32 v42, v42, v44
    v_mul_f32 v43, v43, v44
    v_cvt_pk_bf16_f32 v5, v42, v43
    ds_write_b64 v135, v[34:35] offset:1544
    v_permlane32_swap_b32 v121, v120
    v_max_f32 v120, v121, v120
    v_mov_b32 v121, v120
    s_nop 0
    ds_write_b64 v134, v[4:5] offset:1536
    v_permlane16_swap_b32 v121, v120
    v_max_f32 v120, v121, v120
    v_sub_f32 v12, v12, v120
    v_sub_f32 v13, v13, v120
    v_sub_f32 v14, v14, v120
    v_sub_f32 v15, v15, v120
    v_sub_f32 v28, v28, v120
    v_sub_f32 v29, v29, v120
    v_sub_f32 v30, v30, v120
    v_sub_f32 v31, v31, v120
    v_sub_f32 v24, v24, v120
    v_sub_f32 v25, v25, v120
    v_sub_f32 v26, v26, v120
    v_sub_f32 v27, v27, v120
    v_sub_f32 v6, v6, v120
    v_exp_f32 v12, v12
    v_exp_f32 v13, v13
    v_exp_f32 v14, v14
    v_exp_f32 v15, v15
    v_cvt_pk_bf16_f32 v12, v12, v13
    v_cvt_pk_bf16_f32 v13, v14, v15
    v_exp_f32 v28, v28
    v_exp_f32 v29, v29
    v_exp_f32 v30, v30
    v_exp_f32 v31, v31
    v_cvt_pk_bf16_f32 v14, v28, v29
    v_cvt_pk_bf16_f32 v15, v30, v31
    v_exp_f32 v24, v24
    v_exp_f32 v25, v25
    v_exp_f32 v26, v26
    v_exp_f32 v27, v27
    v_cvt_pk_bf16_f32 v168, v24, v25
    v_cvt_pk_bf16_f32 v169, v26, v27
    v_exp_f32 v6, v6
    s_nop 0
    v_cvt_pk_bf16_f32 v170, v6, 0
    v_mfma_f32_16x16x32_bf16 v[152:155], v[220:223], v[12:15], 0
    s_nop 0
    v_mfma_f32_16x16x32_bf16 v[152:155], v[220:223], v[168:171], v[152:155]
    s_nop 1
    v_mfma_f32_16x16x32_bf16 v[4:7], v[0:3], v[12:15], 0
    s_nop 2
    v_mfma_f32_16x16x32_bf16 v[4:7], v[164:167], v[168:171], v[4:7]
    s_nop 0
    v_rcp_f32 v152, v152
    v_mfma_f32_16x16x32_bf16 v[0:3], v[8:11], v[12:15], 0
    s_nop 2
    v_mfma_f32_16x16x32_bf16 v[0:3], v[160:163], v[168:171], v[0:3]
    s_nop 0
    v_mul_f32 v4, v4, v152
    v_mul_f32 v5, v5, v152
    v_mfma_f32_16x16x32_bf16 v[8:11], v[20:23], v[12:15], 0
    v_cvt_pk_bf16_f32 v12, v4, v5
    v_mul_f32 v6, v6, v152
    v_mfma_f32_16x16x32_bf16 v[8:11], v[156:159], v[168:171], v[8:11]
    v_mul_f32 v7, v7, v152
    v_cvt_pk_bf16_f32 v13, v6, v7
    s_waitcnt lgkmcnt(0)
.p2align 6
L_loopS0:
    v_mfma_f32_16x16x32_bf16 v[36:39], a[4:7], v[146:149], v[36:39]
    ds_write_b64 v135, v[12:13] offset:3072
    v_mfma_f32_16x16x32_bf16 v[36:39], a[8:11], v[72:75], v[36:39]
    v_mul_f32 v0, v0, v152
    v_mul_f32 v1, v1, v152
    v_mfma_f32_16x16x32_bf16 v[36:39], a[12:15], v[88:91], v[36:39]
    v_cvt_pk_bf16_f32 v14, v0, v1
    v_mul_f32 v2, v2, v152
    v_mfma_f32_16x16x32_bf16 v[36:39], a[16:19], v[76:79], v[36:39]
    v_mul_f32 v3, v3, v152
    v_cvt_pk_bf16_f32 v15, v2, v3
    v_mfma_f32_16x16x32_bf16 v[36:39], a[20:23], v[56:59], v[36:39]
    ds_write_b64 v135, v[14:15] offset:3080
    v_mfma_f32_16x16x32_bf16 v[12:15], a[24:27], v[16:19], 0
    v_mul_f32 v8, v8, v152
    v_mul_f32 v9, v9, v152
    v_mfma_f32_16x16x32_bf16 v[12:15], a[28:31], v[146:149], v[12:15]
    v_cvt_pk_bf16_f32 v8, v8, v9
    v_mul_f32 v10, v10, v152
    v_mfma_f32_16x16x32_bf16 v[12:15], a[32:35], v[72:75], v[12:15]
    v_mul_f32 v11, v11, v152
    v_cvt_pk_bf16_f32 v9, v10, v11
    v_mfma_f32_16x16x32_bf16 v[12:15], a[36:39], v[88:91], v[12:15]
    ds_write_b64 v134, v[8:9] offset:3072
    v_mfma_f32_16x16x32_bf16 v[12:15], a[40:43], v[76:79], v[12:15]
    v_fma_f32 v170, v40, v40, s42
    v_fmac_f32 v170, v41, v41
    v_mfma_f32_16x16x32_bf16 v[12:15], a[44:47], v[56:59], v[12:15]
    v_fmac_f32 v170, v42, v42
    v_fmac_f32 v170, v43, v43
    v_mfma_f32_16x16x32_bf16 v[152:155], a[48:51], v[16:19], 0
    v_fmac_f32 v170, v140, v140
    v_fmac_f32 v170, v141, v141
    v_mfma_f32_16x16x32_bf16 v[152:155], a[52:55], v[146:149], v[152:155]
    v_fmac_f32 v170, v142, v142
    v_fmac_f32 v170, v143, v143
    v_mfma_f32_16x16x32_bf16 v[152:155], a[56:59], v[72:75], v[152:155]
    s_waitcnt vmcnt(10)
    v_fmac_f32 v170, v44, v44
    v_fmac_f32 v170, v45, v45
    v_mfma_f32_16x16x32_bf16 v[152:155], a[60:63], v[88:91], v[152:155]
    v_fmac_f32 v170, v46, v46
    v_fmac_f32 v170, v47, v47
    v_mfma_f32_16x16x32_bf16 v[152:155], a[64:67], v[76:79], v[152:155]
    v_cvt_pk_bf16_f32 v0, v92, v93
    v_cvt_pk_bf16_f32 v1, v170, v122
    v_mfma_f32_16x16x32_bf16 v[152:155], a[68:71], v[56:59], v[152:155]
    ds_write_b64 v130, v[0:1]
    v_mfma_f32_16x16x32_bf16 v[60:63], a[72:75], v[16:19], 0
    v_add_u32 v135, s49, v135
    v_add_u32 v134, s49, v134
    v_mfma_f32_16x16x32_bf16 v[60:63], a[76:79], v[146:149], v[60:63]
    v_fma_f32 v170, v36, v36, s41
    v_fmac_f32 v170, v37, v37
    v_mfma_f32_16x16x32_bf16 v[60:63], a[80:83], v[72:75], v[60:63]
    v_fmac_f32 v170, v38, v38
    v_fmac_f32 v170, v39, v39
    v_mfma_f32_16x16x32_bf16 v[60:63], a[84:87], v[88:91], v[60:63]
    v_fmac_f32 v170, v12, v12
    v_fmac_f32 v170, v13, v13
    v_mfma_f32_16x16x32_bf16 v[60:63], a[88:91], v[76:79], v[60:63]
    v_fmac_f32 v170, v14, v14
    v_fmac_f32 v170, v15, v15
    v_mfma_f32_16x16x32_bf16 v[60:63], a[92:95], v[56:59], v[60:63]
    v_fmac_f32 v170, v152, v152
    v_fmac_f32 v170, v153, v153
    v_mfma_f32_16x16x32_bf16 v[92:95], a[96:99], v[16:19], 0
    v_fmac_f32 v170, v154, v154
    v_fmac_f32 v170, v155, v155
    v_mfma_f32_16x16x32_bf16 v[92:95], a[100:103], v[146:149], v[92:95]
    s_waitcnt lgkmcnt(0)
    s_nop 0
    v_fma_f32 v0, v60, v60, s41
    v_fmac_f32 v0, v61, v61
    v_mfma_f32_16x16x32_bf16 v[92:95], a[104:107], v[72:75], v[92:95]
    s_barrier
    ds_read_b128 v[8:11], v129 offset:0
    v_fmac_f32 v0, v62, v62
    v_mfma_f32_16x16x32_bf16 v[92:95], a[108:111], v[88:91], v[92:95]
    ds_read_b128 v[64:67], v129 offset:1024
    v_fmac_f32 v0, v63, v63
    v_mfma_f32_16x16x32_bf16 v[92:95], a[112:115], v[76:79], v[92:95]
    v_mfma_f32_16x16x32_bf16 v[92:95], a[116:119], v[56:59], v[92:95]
    s_nop 1
    v_mfma_f32_16x16x32_bf16 v[80:83], a[120:123], v[16:19], 0
    s_nop 2
    v_mfma_f32_16x16x32_bf16 v[80:83], a[124:127], v[146:149], v[80:83]
    s_nop 0
    v_fmac_f32 v0, v92, v92
    v_fmac_f32 v0, v93, v93
    v_mfma_f32_16x16x32_bf16 v[80:83], a[128:131], v[72:75], v[80:83]
    v_fmac_f32 v0, v94, v94
    v_fmac_f32 v0, v95, v95
    v_mfma_f32_16x16x32_bf16 v[80:83], a[132:135], v[88:91], v[80:83]
    v_mfma_f32_16x16x32_bf16 v[80:83], a[136:139], v[76:79], v[80:83]
    v_mfma_f32_16x16x32_bf16 v[80:83], a[140:143], v[56:59], v[80:83]
    s_waitcnt lgkmcnt(1)
    v_readfirstlane_b32 s12, v9
    v_mfma_f32_16x16x32_bf16 v[84:87], v[216:219], v[8:11], 0
    s_waitcnt lgkmcnt(0)
    s_nop 1
    v_mfma_f32_16x16x32_bf16 v[84:87], v[216:219], v[64:67], v[84:87]
    s_lshr_b32 s12, s12, 23
    v_fmac_f32 v0, v80, v80
    v_fmac_f32 v0, v81, v81
    v_mfma_f32_16x16x32_bf16 v[8:11], v[16:19], a[144:147], 0
    v_fmac_f32 v0, v82, v82
    v_fmac_f32 v0, v83, v83
    v_mfma_f32_16x16x32_bf16 v[8:11], v[146:149], a[148:151], v[8:11]
    s_nop 0
    v_rsq_f32 v84, v84
    v_mfma_f32_16x16x32_bf16 v[8:11], v[72:75], a[152:155], v[8:11]
    v_rsq_f32 v85, v85
    v_mfma_f32_16x16x32_bf16 v[8:11], v[88:91], a[156:159], v[8:11]
    v_rsq_f32 v86, v86
    v_mfma_f32_16x16x32_bf16 v[8:11], v[76:79], a[160:163], v[8:11]
    ds_read_b128 v[64:67], v137 offset:1536
    v_mul_f32 v84, s43, v84
    v_mfma_f32_16x16x32_bf16 v[8:11], v[56:59], a[164:167], v[8:11]
    ds_read_b128 v[68:71], v136 offset:1536
    v_mul_f32 v85, s43, v85
    v_mfma_f32_16x16x32_bf16 v[48:51], v[16:19], a[168:171], 0
    ds_read_b128 v[52:55], v137 offset:1664
    v_mul_f32 v86, s43, v86
    v_mfma_f32_16x16x32_bf16 v[48:51], v[146:149], a[172:175], v[48:51]
    ds_read_b128 v[96:99], v136 offset:1664
    v_cvt_pk_bf16_f32 v170, v170, v0
    v_mfma_f32_16x16x32_bf16 v[48:51], v[72:75], a[176:179], v[48:51]
    ds_read_b128 v[108:111], v137 offset:1792
    v_cvt_pk_bf16_f32 v0, v8, v9
    v_mfma_f32_16x16x32_bf16 v[48:51], v[88:91], a[180:183], v[48:51]
    ds_read_b128 v[104:107], v136 offset:1792
    v_cvt_pk_bf16_f32 v1, v10, v11
    v_mfma_f32_16x16x32_bf16 v[48:51], v[76:79], a[184:187], v[48:51]
    v_mul_f32 v32, v32, v84
    v_mul_f32 v33, v33, v84
    v_mfma_f32_16x16x32_bf16 v[48:51], v[56:59], a[188:191], v[48:51]
    s_nop 0
    v_cvt_pk_bf16_f32 v2, v32, v33
    v_mul_f32 v34, v34, v84
    v_mfma_f32_16x16x16_bf16 v[118:121], v[216:217], v[170:171], 0
    s_nop 0
    v_mul_f32 v35, v35, v84
    v_cvt_pk_bf16_f32 v3, v34, v35
    v_mul_f32 v4, v4, v84
    v_cvt_pk_bf16_f32 v8, v48, v49
    v_mfma_f32_16x16x32_bf16 v[32:35], v[16:19], a[192:195], 0
    ds_write_b64 v135, v[2:3] offset:0
    v_mfma_f32_16x16x32_bf16 v[32:35], v[146:149], a[196:199], v[32:35]
    v_rsq_f32 v118, v118
    v_mfma_f32_16x16x32_bf16 v[32:35], v[72:75], a[200:203], v[32:35]
    v_rsq_f32 v119, v119
    v_mfma_f32_16x16x32_bf16 v[32:35], v[88:91], a[204:207], v[32:35]
    v_mul_f32 v118, s55, v118
    v_mul_f32 v119, 0.5, v119
    v_mfma_f32_16x16x32_bf16 v[32:35], v[76:79], a[208:211], v[32:35]
    v_cvt_pk_bf16_f32 v9, v50, v51
    v_mul_f32 v36, v36, v118
    v_mfma_f32_16x16x32_bf16 v[32:35], v[56:59], a[212:215], v[32:35]
    s_waitcnt lgkmcnt(1)
    v_mul_f32 v37, v37, v118
    v_cvt_pk_f16_f32 v76, v36, v37
    v_mfma_f32_16x16x32_bf16 v[146:149], a[0:3], v[64:67], 0
    v_mul_f32 v38, v38, v118
    v_mul_f32 v39, v39, v118
    v_mfma_f32_16x16x32_bf16 v[146:149], a[4:7], v[68:71], v[146:149]
    v_cvt_pk_f16_f32 v77, v38, v39
    v_mul_f32 v12, v12, v118
    v_mfma_f32_16x16x32_bf16 v[146:149], a[8:11], v[52:55], v[146:149]
    v_mul_f32 v13, v13, v118
    v_cvt_pk_f16_f32 v78, v12, v13
    v_mfma_f32_16x16x32_bf16 v[146:149], a[12:15], v[96:99], v[146:149]
    v_mul_f32 v14, v14, v118
    v_mul_f32 v15, v15, v118
    v_mfma_f32_16x16x32_bf16 v[146:149], a[16:19], v[108:111], v[146:149]
    v_cvt_pk_f16_f32 v79, v14, v15
    v_mul_f32 v152, v152, v118
    v_mfma_f32_16x16x32_bf16 v[146:149], a[20:23], v[104:107], v[146:149]
    v_mul_f32 v153, v153, v118
    v_cvt_pk_f16_f32 v152, v152, v153
    v_mfma_f32_16x16x32_bf16 v[36:39], a[24:27], v[64:67], 0
    v_mul_f32 v154, v154, v118
    v_mul_f32 v155, v155, v118
    v_mfma_f32_16x16x32_bf16 v[36:39], a[28:31], v[68:71], v[36:39]
    v_cvt_pk_f16_f32 v153, v154, v155
    v_mul_f32 v60, v60, v119
    v_mfma_f32_16x16x32_bf16 v[36:39], a[32:35], v[52:55], v[36:39]
    v_mul_f32 v61, v61, v119
    v_cvt_pk_f16_f32 v16, v60, v61
    v_mfma_f32_16x16x32_bf16 v[36:39], a[36:39], v[96:99], v[36:39]
    v_mul_f32 v62, v62, v119
    v_mul_f32 v63, v63, v119
    v_mfma_f32_16x16x32_bf16 v[36:39], a[40:43], v[108:111], v[36:39]
    v_cvt_pk_f16_f32 v17, v62, v63
    v_mul_f32 v92, v92, v119
    v_mfma_f32_16x16x32_bf16 v[36:39], a[44:47], v[104:107], v[36:39]
    v_mul_f32 v93, v93, v119
    v_cvt_pk_f16_f32 v18, v92, v93
    v_mfma_f32_16x16x32_bf16 v[72:75], a[48:51], v[64:67], 0
    v_mul_f32 v94, v94, v119
    v_mul_f32 v95, v95, v119
    v_mfma_f32_16x16x32_bf16 v[72:75], a[52:55], v[68:71], v[72:75]
    v_cvt_pk_f16_f32 v19, v94, v95
    v_mul_f32 v80, v80, v119
    v_mfma_f32_16x16x32_bf16 v[72:75], a[56:59], v[52:55], v[72:75]
    v_mul_f32 v81, v81, v119
    v_cvt_pk_f16_f32 v154, v80, v81
    v_mfma_f32_16x16x32_bf16 v[72:75], a[60:63], v[96:99], v[72:75]
    v_mul_f32 v82, v82, v119
    v_mul_f32 v83, v83, v119
    v_mfma_f32_16x16x32_bf16 v[72:75], a[64:67], v[108:111], v[72:75]
    v_cvt_pk_f16_f32 v155, v82, v83
    v_cvt_pk_bf16_f32 v12, v32, v33
    v_mfma_f32_16x16x32_bf16 v[72:75], a[68:71], v[104:107], v[72:75]
    v_cvt_pk_bf16_f32 v13, v34, v35
    v_mul_f32 v5, v5, v84
    v_mfma_f32_16x16x32_bf16 v[32:35], a[72:75], v[64:67], 0
    v_cvt_pk_bf16_f32 v4, v4, v5
    v_mul_f32 v6, v6, v84
    v_mfma_f32_16x16x32_bf16 v[32:35], a[76:79], v[68:71], v[32:35]
    v_mul_f32 v7, v7, v84
    v_cvt_pk_bf16_f32 v5, v6, v7
    v_mfma_f32_16x16x32_bf16 v[32:35], a[80:83], v[52:55], v[32:35]
    ds_write_b64 v135, v[4:5] offset:8
    v_mfma_f32_16x16x32_bf16 v[32:35], a[84:87], v[96:99], v[32:35]
    v_mul_f32 v24, v24, v84
    v_mul_f32 v25, v25, v84
    v_mfma_f32_16x16x32_bf16 v[32:35], a[88:91], v[108:111], v[32:35]
    v_cvt_pk_bf16_f32 v2, v24, v25
    v_mul_f32 v26, v26, v84
    v_mfma_f32_16x16x32_bf16 v[32:35], a[92:95], v[104:107], v[32:35]
    v_mul_f32 v27, v27, v84
    v_cvt_pk_bf16_f32 v3, v26, v27
    v_mfma_f32_16x16x32_bf16 v[4:7], a[96:99], v[64:67], 0
    ds_write_b64 v134, v[2:3] offset:0
    v_mfma_f32_16x16x32_bf16 v[4:7], a[100:103], v[68:71], v[4:7]
    v_fma_f32 v2, v146, v146, s41
    v_fmac_f32 v2, v147, v147
    v_mfma_f32_16x16x32_bf16 v[4:7], a[104:107], v[52:55], v[4:7]
    v_fmac_f32 v2, v148, v148
    v_fmac_f32 v2, v149, v149
    v_mfma_f32_16x16x32_bf16 v[4:7], a[108:111], v[96:99], v[4:7]
    v_fmac_f32 v2, v36, v36
    v_fmac_f32 v2, v37, v37
    v_mfma_f32_16x16x32_bf16 v[4:7], a[112:115], v[108:111], v[4:7]
    v_fmac_f32 v2, v38, v38
    v_fmac_f32 v2, v39, v39
    v_mfma_f32_16x16x32_bf16 v[4:7], a[116:119], v[104:107], v[4:7]
    v_fmac_f32 v2, v72, v72
    v_fmac_f32 v2, v73, v73
    v_mfma_f32_16x16x32_bf16 v[24:27], a[120:123], v[64:67], 0
    v_fmac_f32 v2, v74, v74
    v_fmac_f32 v2, v75, v75
    v_mfma_f32_16x16x32_bf16 v[24:27], a[124:127], v[68:71], v[24:27]
    v_mul_f32 v28, v28, v85
    v_mul_f32 v29, v29, v85
    v_mfma_f32_16x16x32_bf16 v[24:27], a[128:131], v[52:55], v[24:27]
    v_cvt_pk_bf16_f32 v88, v28, v29
    v_mul_f32 v30, v30, v85
    v_mfma_f32_16x16x32_bf16 v[24:27], a[132:135], v[96:99], v[24:27]
    v_mul_f32 v31, v31, v85
    v_cvt_pk_bf16_f32 v89, v30, v31
    v_mfma_f32_16x16x32_bf16 v[24:27], a[136:139], v[108:111], v[24:27]
    ds_write_b64 v135, v[88:89] offset:1536
    v_mfma_f32_16x16x32_bf16 v[24:27], a[140:143], v[104:107], v[24:27]
    v_mul_f32 v20, v20, v85
    v_mul_f32 v21, v21, v85
    v_mfma_f32_16x16x32_bf16 v[60:63], v[64:67], a[144:147], 0
    v_cvt_pk_bf16_f32 v90, v20, v21
    v_mul_f32 v22, v22, v85
    v_mfma_f32_16x16x32_bf16 v[60:63], v[68:71], a[148:151], v[60:63]
    v_mul_f32 v23, v23, v85
    v_cvt_pk_bf16_f32 v91, v22, v23
    v_mfma_f32_16x16x32_bf16 v[60:63], v[52:55], a[152:155], v[60:63]
    ds_write_b64 v135, v[90:91] offset:1544
    v_mfma_f32_16x16x32_bf16 v[60:63], v[96:99], a[156:159], v[60:63]
    v_mul_f32 v114, v114, v85
    v_mul_f32 v115, v115, v85
    v_mfma_f32_16x16x32_bf16 v[60:63], v[108:111], a[160:163], v[60:63]
    ds_read_b128 v[88:91], v137 offset:3072
    v_cvt_pk_bf16_f32 v10, v114, v115
    v_mfma_f32_16x16x32_bf16 v[60:63], v[104:107], a[164:167], v[60:63]
    ds_read_b128 v[56:59], v136 offset:3072
    v_mul_f32 v116, v116, v85
    v_mfma_f32_16x16x32_bf16 v[92:95], v[64:67], a[168:171], 0
    ds_read_b128 v[80:83], v137 offset:3200
    v_mul_f32 v117, v117, v85
    v_mfma_f32_16x16x32_bf16 v[92:95], v[68:71], a[172:175], v[92:95]
    ds_read_b128 v[28:31], v136 offset:3200
    v_cvt_pk_bf16_f32 v11, v116, v117
    v_mfma_f32_16x16x32_bf16 v[92:95], v[52:55], a[176:179], v[92:95]
    ds_write_b64 v134, v[10:11] offset:1536
    v_mfma_f32_16x16x32_bf16 v[92:95], v[96:99], a[180:183], v[92:95]
    v_fma_f32 v3, v32, v32, s41
    v_fmac_f32 v3, v33, v33
    v_mfma_f32_16x16x32_bf16 v[92:95], v[108:111], a[184:187], v[92:95]
    ds_read_b128 v[48:51], v137 offset:3328
    v_fmac_f32 v3, v34, v34
    v_mfma_f32_16x16x32_bf16 v[92:95], v[104:107], a[188:191], v[92:95]
    ds_read_b128 v[20:23], v136 offset:3328
    v_fmac_f32 v3, v35, v35
    v_mfma_f32_16x16x32_bf16 v[112:115], v[64:67], a[192:195], 0
    v_fmac_f32 v3, v4, v4
    v_fmac_f32 v3, v5, v5
    v_mfma_f32_16x16x32_bf16 v[112:115], v[68:71], a[196:199], v[112:115]
    s_sub_u32 s50, s45, s44
    v_fmac_f32 v3, v6, v6
    v_fmac_f32 v3, v7, v7
    v_mfma_f32_16x16x32_bf16 v[112:115], v[52:55], a[200:203], v[112:115]
    s_sub_u32 s51, s46, s47
    v_fmac_f32 v3, v24, v24
    v_fmac_f32 v3, v25, v25
    v_mfma_f32_16x16x32_bf16 v[112:115], v[96:99], a[204:207], v[112:115]
    s_mov_b32 s60, s59
    v_fmac_f32 v3, v26, v26
    v_fmac_f32 v3, v27, v27
    v_mfma_f32_16x16x32_bf16 v[112:115], v[108:111], a[208:211], v[112:115]
    s_mov_b32 s59, s58
    v_cvt_pk_bf16_f32 v170, v2, v3
    v_cvt_pk_bf16_f32 v2, v60, v61
    v_mfma_f32_16x16x32_bf16 v[112:115], v[104:107], a[212:215], v[112:115]
    s_mov_b32 s58, s57
    v_cvt_pk_bf16_f32 v3, v62, v63
    v_cvt_pk_bf16_f32 v10, v92, v93
    v_mfma_f32_16x16x16_bf16 v[60:63], v[216:217], v[170:171], 0
    s_waitcnt lgkmcnt(2)
    s_mov_b32 s57, s56
    v_cvt_pk_bf16_f32 v11, v94, v95
    v_mul_f32 v40, v40, v86
    v_mul_f32 v41, v41, v86
    v_cvt_pk_bf16_f32 v14, v112, v113
    v_mfma_f32_16x16x32_bf16 v[92:95], a[0:3], v[88:91], 0
    s_mov_b32 s7, s6
    v_cvt_pk_bf16_f32 v15, v114, v115
    v_cvt_pk_bf16_f32 v40, v40, v41
    v_mfma_f32_16x16x32_bf16 v[92:95], a[4:7], v[56:59], v[92:95]
    s_mov_b32 s6, s5
    v_rsq_f32 v60, v60
    v_mfma_f32_16x16x32_bf16 v[92:95], a[8:11], v[80:83], v[92:95]
    s_mov_b32 s5, s4
    v_rsq_f32 v61, v61
    v_mfma_f32_16x16x32_bf16 v[92:95], a[12:15], v[28:31], v[92:95]
    s_waitcnt lgkmcnt(0)
    s_sub_u32 s14, s6, s7
    v_mul_f32 v60, s55, v60
    v_mul_f32 v61, 0.5, v61
    v_mfma_f32_16x16x32_bf16 v[92:95], a[16:19], v[48:51], v[92:95]
    s_add_u32 s61, s61, 1
    v_mul_f32 v146, v146, v60
    v_mul_f32 v147, v147, v60
    v_mfma_f32_16x16x32_bf16 v[92:95], a[20:23], v[20:23], v[92:95]
    s_ff1_i32_b32 s15, s66
    v_cvt_pk_f16_f32 v96, v146, v147
    v_mul_f32 v148, v148, v60
    v_mfma_f32_16x16x32_bf16 v[64:67], a[24:27], v[88:91], 0
    s_cmp_lg_u32 s66, 0
    v_mul_f32 v149, v149, v60
    v_cvt_pk_f16_f32 v97, v148, v149
    v_mfma_f32_16x16x32_bf16 v[64:67], a[28:31], v[56:59], v[64:67]
    s_cselect_b32 s12, s15, s12
    v_mul_f32 v36, v36, v60
    v_mul_f32 v37, v37, v60
    v_mfma_f32_16x16x32_bf16 v[64:67], a[32:35], v[80:83], v[64:67]
    s_cmp_lt_u32 s61, s71
    v_cvt_pk_f16_f32 v98, v36, v37
    v_mul_f32 v38, v38, v60
    v_mfma_f32_16x16x32_bf16 v[64:67], a[36:39], v[28:31], v[64:67]
    s_cselect_b32 s15, 31, s15
    v_mul_f32 v39, v39, v60
    v_cvt_pk_f16_f32 v99, v38, v39
    v_mfma_f32_16x16x32_bf16 v[64:67], a[40:43], v[48:51], v[64:67]
    s_bitset0_b32 s66, s15
    v_mul_f32 v72, v72, v60
    v_mul_f32 v73, v73, v60
    v_mfma_f32_16x16x32_bf16 v[64:67], a[44:47], v[20:23], v[64:67]
    s_add_u32 s12, s12, 20
    v_cvt_pk_f16_f32 v146, v72, v73
    v_mul_f32 v74, v74, v60
    v_mfma_f32_16x16x32_bf16 v[68:71], a[48:51], v[88:91], 0
    s_max_u32 s12, s12, s61
    v_mul_f32 v75, v75, v60
    v_cvt_pk_f16_f32 v147, v74, v75
    v_mfma_f32_16x16x32_bf16 v[68:71], a[52:55], v[56:59], v[68:71]
    s_cmp_lt_u32 s61, s71
    v_mul_f32 v32, v32, v61
    v_mul_f32 v33, v33, v61
    v_mfma_f32_16x16x32_bf16 v[68:71], a[56:59], v[80:83], v[68:71]
    s_cselect_b32 s15, s61, s12
    v_cvt_pk_f16_f32 v36, v32, v33
    v_mul_f32 v34, v34, v61
    v_mfma_f32_16x16x32_bf16 v[68:71], a[60:63], v[28:31], v[68:71]
    s_cselect_b32 s56, s69, s70
    v_mul_f32 v35, v35, v61
    v_cvt_pk_f16_f32 v37, v34, v35
    v_mfma_f32_16x16x32_bf16 v[68:71], a[64:67], v[48:51], v[68:71]
    s_add_u32 s56, s56, s15
    v_mul_f32 v4, v4, v61
    v_mul_f32 v5, v5, v61
    v_mfma_f32_16x16x32_bf16 v[68:71], a[68:71], v[20:23], v[68:71]
    s_mul_i32 s53, s56, 58255
    v_cvt_pk_f16_f32 v38, v4, v5
    v_mul_f32 v6, v6, v61
    v_mfma_f32_16x16x32_bf16 v[72:75], a[72:75], v[88:91], 0
    s_lshr_b32 s53, s53, 22
    v_mul_f32 v7, v7, v61
    v_cvt_pk_f16_f32 v39, v6, v7
    v_mfma_f32_16x16x32_bf16 v[72:75], a[76:79], v[56:59], v[72:75]
    s_mul_i32 s53, s53, s63
    v_mul_f32 v24, v24, v61
    v_mul_f32 v25, v25, v61
    v_mfma_f32_16x16x32_bf16 v[72:75], a[80:83], v[80:83], v[72:75]
    s_mul_i32 s56, s56, s62
    v_cvt_pk_f16_f32 v148, v24, v25
    v_mul_f32 v26, v26, v61
    v_mfma_f32_16x16x32_bf16 v[72:75], a[84:87], v[28:31], v[72:75]
    s_add_u32 s56, s56, s53
    v_mul_f32 v27, v27, v61
    v_cvt_pk_f16_f32 v149, v26, v27
    v_mfma_f32_16x16x32_bf16 v[72:75], a[88:91], v[48:51], v[72:75]
    s_mul_i32 s4, s15, 112
    v_mul_f32 v42, v42, v86
    v_mul_f32 v43, v43, v86
    v_mfma_f32_16x16x32_bf16 v[72:75], a[92:95], v[20:23], v[72:75]
    s_cmp_ge_u32 s15, 16
    v_cvt_pk_bf16_f32 v41, v42, v43
    v_mul_f32 v140, v140, v86
    v_mfma_f32_16x16x32_bf16 v[4:7], a[96:99], v[88:91], 0
    s_cselect_b32 s53, -30464, 0
    ds_write_b64 v135, v[40:41] offset:3072
    v_mfma_f32_16x16x32_bf16 v[4:7], a[100:103], v[56:59], v[4:7]
    s_add_u32 s4, s4, s53
    v_mul_f32 v141, v141, v86
    v_cvt_pk_bf16_f32 v42, v140, v141
    v_mfma_f32_16x16x32_bf16 v[4:7], a[104:107], v[80:83], v[4:7]
    s_cmp_lt_u32 s15, s73
    v_mul_f32 v142, v142, v86
    v_mul_f32 v143, v143, v86
    v_mfma_f32_16x16x32_bf16 v[4:7], a[108:111], v[28:31], v[4:7]
    s_cselect_b32 s26, 100270464, 0
    v_cvt_pk_bf16_f32 v43, v142, v143
    v_mul_f32 v44, v44, v86
    v_mfma_f32_16x16x32_bf16 v[4:7], a[112:115], v[48:51], v[4:7]
    s_cselect_b32 s56, s56, 0
    ds_write_b64 v135, v[42:43] offset:3080
    v_mfma_f32_16x16x32_bf16 v[4:7], a[116:119], v[20:23], v[4:7]
    s_cselect_b32 s4, s4, -1
    v_mul_f32 v45, v45, v86
    v_cvt_pk_bf16_f32 v44, v44, v45
    v_mul_f32 v46, v46, v86
    v_mul_f32 v47, v47, v86
    v_cvt_pk_bf16_f32 v45, v46, v47
    s_cselect_b32 s15, s15, 0
    s_cselect_b32 s13, s13, -1
    ds_write_b64 v134, v[44:45] offset:3072
    v_fma_f32 v120, v92, v92, s41
    v_fmac_f32 v120, v93, v93
    v_fmac_f32 v120, v94, v94
    v_fmac_f32 v120, v95, v95
    v_mfma_f32_16x16x32_bf16 v[24:27], a[120:123], v[88:91], 0
    s_waitcnt vmcnt(0)
    v_fmac_f32 v120, v64, v64
    v_fmac_f32 v120, v65, v65
    v_mfma_f32_16x16x32_bf16 v[24:27], a[124:127], v[56:59], v[24:27]
    s_bitset1_b32 s64, s15
    v_fmac_f32 v120, v66, v66
    v_fmac_f32 v120, v67, v67
    v_mfma_f32_16x16x32_bf16 v[24:27], a[128:131], v[80:83], v[24:27]
    s_add_u32 s65, s65, 1
    v_fmac_f32 v120, v68, v68
    v_fmac_f32 v120, v69, v69
    v_mfma_f32_16x16x32_bf16 v[24:27], a[132:135], v[28:31], v[24:27]
    s_cmp_ge_i32 s65, 2
    v_fmac_f32 v120, v70, v70
    v_fmac_f32 v120, v71, v71
    v_mfma_f32_16x16x32_bf16 v[24:27], a[136:139], v[48:51], v[24:27]
    s_cselect_b32 s30, 100270464, 0
    v_fma_f32 v121, v72, v72, s41
    v_fmac_f32 v121, v73, v73
    v_mfma_f32_16x16x32_bf16 v[24:27], a[140:143], v[20:23], v[24:27]
    s_add_u32 s67, s46, s54
    v_fmac_f32 v121, v74, v74
    v_fmac_f32 v121, v75, v75
    v_mfma_f32_16x16x32_bf16 v[32:35], v[88:91], a[144:147], 0
    s_waitcnt lgkmcnt(0)
    s_add_u32 m0, s67, 0
    v_fmac_f32 v121, v4, v4
    v_fmac_f32 v121, v5, v5
    v_mfma_f32_16x16x32_bf16 v[32:35], v[56:59], a[148:151], v[32:35]
    s_barrier
    v_fmac_f32 v121, v6, v6
    v_fmac_f32 v121, v7, v7
    v_mfma_f32_16x16x32_bf16 v[32:35], v[80:83], a[152:155], v[32:35]
    s_cmp_ge_u32 s61, s13
    v_fmac_f32 v121, v24, v24
    v_fmac_f32 v121, v25, v25
    v_mfma_f32_16x16x32_bf16 v[32:35], v[28:31], a[156:159], v[32:35]
    s_cbranch_scc1 L_atomS0
L_atomrS0:
    v_mfma_f32_16x16x32_bf16 v[32:35], v[48:51], a[160:163], v[32:35]
    v_fmac_f32 v121, v26, v26
    v_fmac_f32 v121, v27, v27
    v_mfma_f32_16x16x32_bf16 v[32:35], v[20:23], a[164:167], v[32:35]
    v_cvt_pk_bf16_f32 v170, v120, v121
    v_add_u32 v137, s50, v137
    v_mfma_f32_16x16x32_bf16 v[40:43], v[88:91], a[168:171], 0
    ds_read_b128 v[60:63], v137 offset:0
    v_add_u32 v136, s50, v136
    v_mfma_f32_16x16x32_bf16 v[40:43], v[56:59], a[172:175], v[40:43]
    s_nop 0
    ds_read_b128 v[84:87], v136 offset:0
    v_cvt_pk_bf16_f32 v164, v32, v33
    v_mfma_f32_16x16x32_bf16 v[40:43], v[80:83], a[176:179], v[40:43]
    ds_read_b128 v[52:55], v137 offset:128
    v_cvt_pk_bf16_f32 v165, v34, v35
    v_mfma_f32_16x16x32_bf16 v[40:43], v[28:31], a[180:183], v[40:43]
    ds_read_b128 v[112:115], v136 offset:128
    v_add_u32 v135, s48, v135
    v_mfma_f32_16x16x32_bf16 v[40:43], v[48:51], a[184:187], v[40:43]
    ds_read_b128 v[108:111], v137 offset:256
    v_add_u32 v134, s48, v134
    v_mfma_f32_16x16x32_bf16 v[40:43], v[20:23], a[188:191], v[40:43]
    s_nop 0
    ds_read_b128 v[104:107], v136 offset:256
    v_add_u32 v133, s51, v133
    v_mfma_f32_16x16x16_bf16 v[118:121], v[216:217], v[170:171], 0
    s_nop 0
    v_add_u32 v132, s14, v132
    v_add_u32 v131, s14, v131
    v_add_u32 v123, s14, v123
    v_cvt_pk_bf16_f32 v160, v40, v41
    v_mfma_f32_16x16x32_bf16 v[100:103], v[88:91], a[192:195], 0
    v_cvt_pk_bf16_f32 v161, v42, v43
    v_and_b32 v116, -8, v123
    v_mfma_f32_16x16x32_bf16 v[100:103], v[56:59], a[196:199], v[100:103]
    v_rsq_f32 v118, v118
    v_mfma_f32_16x16x32_bf16 v[100:103], v[80:83], a[200:203], v[100:103]
    v_rsq_f32 v119, v119
    v_mfma_f32_16x16x32_bf16 v[100:103], v[28:31], a[204:207], v[100:103]
    ds_read_b128 v[28:31], v132 offset:0
    v_mul_f32 v118, s55, v118
    v_mfma_f32_16x16x32_bf16 v[100:103], v[48:51], a[208:211], v[100:103]
    ds_read_b128 v[48:51], v132 offset:16
    v_mul_f32 v119, 0.5, v119
    v_mfma_f32_16x16x32_bf16 v[100:103], v[20:23], a[212:215], v[100:103]
    s_waitcnt lgkmcnt(3)
    ds_read_b128 v[20:23], v132 offset:48
    v_mul_f32 v72, v72, v119
    v_mfma_f32_16x16x32_bf16 v[32:35], a[216:219], v[60:63], 0
    ds_read_b128 v[88:91], v133 offset:0
    v_mul_f32 v73, v73, v119
    v_mfma_f32_16x16x32_bf16 v[32:35], a[220:223], v[84:87], v[32:35]
    v_cvt_pk_f16_f32 v40, v72, v73
    v_mul_f32 v74, v74, v119
    v_mfma_f32_16x16x32_bf16 v[32:35], a[224:227], v[52:55], v[32:35]
    v_mul_f32 v75, v75, v119
    v_cvt_pk_f16_f32 v41, v74, v75
    v_mfma_f32_16x16x32_bf16 v[32:35], a[228:231], v[112:115], v[32:35]
    v_mul_f32 v4, v4, v119
    v_mul_f32 v5, v5, v119
    v_mfma_f32_16x16x32_bf16 v[32:35], a[232:235], v[108:111], v[32:35]
    s_waitcnt lgkmcnt(4)
    v_cvt_pk_f16_f32 v42, v4, v5
    v_mul_f32 v6, v6, v119
    v_mfma_f32_16x16x32_bf16 v[32:35], a[236:239], v[104:107], v[32:35]
    v_mul_f32 v7, v7, v119
    v_cvt_pk_f16_f32 v43, v6, v7
    v_mfma_f32_16x16x32_bf16 v[4:7], a[240:243], v[60:63], 0
    v_mul_f32 v24, v24, v119
    v_mul_f32 v25, v25, v119
    v_mfma_f32_16x16x32_bf16 v[4:7], a[244:247], v[84:87], v[4:7]
    v_cvt_pk_f16_f32 v142, v24, v25
    v_mul_f32 v26, v26, v119
    v_mfma_f32_16x16x32_bf16 v[4:7], a[248:251], v[52:55], v[4:7]
    v_mul_f32 v27, v27, v119
    v_cvt_pk_f16_f32 v143, v26, v27
    v_mfma_f32_16x16x32_bf16 v[4:7], a[252:255], v[112:115], v[4:7]
    s_waitcnt lgkmcnt(0)
    buffer_load_dwordx4 v128, s[24:27], s56 offen nt lds
    v_mul_f32 v92, v92, v118
    v_mfma_f32_16x16x32_bf16 v[4:7], v[224:227], v[108:111], v[4:7]
    v_mul_f32 v93, v93, v118
    v_cvt_pk_f16_f32 v44, v92, v93
    v_mfma_f32_16x16x32_bf16 v[4:7], v[228:231], v[104:107], v[4:7]
    v_mul_f32 v94, v94, v118
    v_mul_f32 v95, v95, v118
    v_mfma_f32_16x16x32_bf16 v[24:27], v[232:235], v[60:63], 0
    v_cvt_pk_f16_f32 v45, v94, v95
    v_mul_f32 v64, v64, v118
    v_mfma_f32_16x16x32_bf16 v[24:27], v[236:239], v[84:87], v[24:27]
    v_mul_f32 v65, v65, v118
    v_cvt_pk_f16_f32 v46, v64, v65
    v_mfma_f32_16x16x32_bf16 v[24:27], v[240:243], v[52:55], v[24:27]
    v_mul_f32 v66, v66, v118
    v_mul_f32 v67, v67, v118
    v_mfma_f32_16x16x32_bf16 v[24:27], v[244:247], v[112:115], v[24:27]
    v_cvt_pk_f16_f32 v47, v66, v67
    v_mul_f32 v68, v68, v118
    v_mfma_f32_16x16x32_bf16 v[24:27], v[248:251], v[108:111], v[24:27]
    buffer_store_dwordx4 v[88:91], v128, s[28:31], s60 offen sc1
    v_mul_f32 v69, v69, v118
    v_cvt_pk_f16_f32 v140, v68, v69
    v_mul_f32 v70, v70, v118
    v_mul_f32 v71, v71, v118
    v_mfma_f32_16x16x32_bf16 v[24:27], v[252:255], v[104:107], v[24:27]
    s_add_u32 m0, s67, 1024
    v_cvt_pk_f16_f32 v141, v70, v71
    v_cvt_pk_bf16_f32 v156, v100, v101
    v_mfma_f32_16x16x32_f16 v[112:115], v[16:19], v[76:79], v[204:207]
    ds_read_u16 v166, v131 offset:80
    v_cvt_pk_bf16_f32 v157, v102, v103
    v_mfma_f32_16x16x32_f16 v[112:115], v[152:155], v[150:153], v[112:115]
    ds_read_u16 v162, v131 offset:96
    v_mfma_f32_16x16x32_f16 v[108:111], v[36:39], v[76:79], v[200:203]
    s_nop 0
    ds_read_u16 v158, v131 offset:104
    s_nop 0
    v_mfma_f32_16x16x32_f16 v[108:111], v[146:149], v[150:153], v[108:111]
    s_nop 0
    ds_read_b32 v116, v116 offset:64
    v_max3_f32 v120, v112, v113, v114
    v_mfma_f32_16x16x32_f16 v[104:107], v[40:43], v[76:79], v[196:199]
    ds_read_b128 v[68:71], v133 offset:1024
    v_mfma_f32_16x16x32_f16 v[104:107], v[140:143], v[150:153], v[104:107]
    s_nop 0
    ds_read_b128 v[72:75], v137 offset:1536
    v_max3_f32 v120, v120, v115, v108
    v_mfma_f32_16x16x32_f16 v[88:91], v[28:31], v[76:79], v[208:211]
    ds_read_b128 v[76:79], v136 offset:1536
    v_max3_f32 v120, v120, v109, v110
    v_mfma_f32_16x16x32_f16 v[88:91], v[48:51], v[16:19], v[88:91]
    ds_read_b128 v[60:63], v137 offset:1664
    v_max3_f32 v120, v120, v111, v104
    v_mfma_f32_16x16x32_f16 v[88:91], v[20:23], v[152:155], v[88:91]
    ds_read_b128 v[56:59], v136 offset:1664
    v_max3_f32 v120, v120, v105, v106
    v_mfma_f32_16x16x32_f16 v[92:95], v[28:31], v[96:99], v[208:211]
    ds_read_b128 v[64:67], v137 offset:1792
    s_nop 0
    v_mfma_f32_16x16x32_f16 v[92:95], v[48:51], v[36:39], v[92:95]
    s_nop 0
    ds_read_b128 v[80:83], v136 offset:1792
    v_max3_f32 v120, v120, v107, v88
    v_mfma_f32_16x16x32_f16 v[92:95], v[20:23], v[146:149], v[92:95]
    v_mov_b32 v121, v120
    v_mfma_f32_16x16x32_f16 v[84:87], v[28:31], v[44:47], v[208:211]
    s_nop 0
    v_permlane32_swap_b32 v121, v120
    v_mfma_f32_16x16x32_f16 v[84:87], v[48:51], v[40:43], v[84:87]
    s_waitcnt lgkmcnt(6)
    buffer_load_dwordx4 v127, s[24:27], s56 offen nt lds
    v_max_f32 v120, v121, v120
    v_mfma_f32_16x16x32_f16 v[84:87], v[20:23], v[140:143], v[84:87]
    s_waitcnt lgkmcnt(5)
    v_mov_b32 v121, v120
    v_mov_b32_dpp v91, v95 quad_perm:[0,1,2,3] row_mask:0x2 bank_mask:0xf
    v_mfma_f32_16x16x32_bf16 v[28:31], a[216:219], v[72:75], 0
    s_waitcnt lgkmcnt(4)
    v_permlane16_swap_b32 v121, v120
    v_mfma_f32_16x16x32_bf16 v[28:31], a[220:223], v[76:79], v[28:31]
    s_waitcnt lgkmcnt(3)
    v_max_f32 v120, v121, v120
    v_sub_f32 v112, v112, v120
    v_mfma_f32_16x16x32_bf16 v[28:31], a[224:227], v[60:63], v[28:31]
    s_waitcnt lgkmcnt(2)
    v_sub_f32 v113, v113, v120
    v_sub_f32 v114, v114, v120
    v_mfma_f32_16x16x32_bf16 v[28:31], a[228:231], v[56:59], v[28:31]
    s_waitcnt lgkmcnt(1)
    v_sub_f32 v115, v115, v120
    v_sub_f32 v108, v108, v120
    v_mfma_f32_16x16x32_bf16 v[28:31], a[232:235], v[64:67], v[28:31]
    s_waitcnt lgkmcnt(0)
    v_sub_f32 v109, v109, v120
    v_sub_f32 v110, v110, v120
    v_mfma_f32_16x16x32_bf16 v[28:31], a[236:239], v[80:83], v[28:31]
    buffer_store_dwordx4 v[68:71], v127, s[28:31], s60 offen sc1
    ds_read_b128 v[100:103], v133 offset:2048
    v_sub_f32 v111, v111, v120
    v_sub_f32 v104, v104, v120
    v_sub_f32 v105, v105, v120
    v_mfma_f32_16x16x32_f16 v[48:51], v[16:19], v[96:99], v[192:195]
    s_add_u32 m0, s67, 2048
    v_sub_f32 v106, v106, v120
    v_sub_f32 v107, v107, v120
    v_mfma_f32_16x16x32_f16 v[48:51], v[152:155], v[144:147], v[48:51]
    v_sub_f32 v88, v88, v120
    v_mov_b32_dpp v91, v87 quad_perm:[0,1,2,3] row_mask:0x4 bank_mask:0xf
    v_mfma_f32_16x16x32_f16 v[68:71], v[36:39], v[96:99], v[188:191]
    v_exp_f32 v112, v112
    v_mfma_f32_16x16x32_f16 v[68:71], v[146:149], v[144:147], v[68:71]
    v_exp_f32 v113, v113
    v_mfma_f32_16x16x32_f16 v[52:55], v[40:43], v[96:99], v[184:187]
    v_exp_f32 v114, v114
    v_mfma_f32_16x16x32_f16 v[52:55], v[140:143], v[144:147], v[52:55]
    v_exp_f32 v115, v115
    v_mfma_f32_16x16x32_bf16 v[20:23], a[240:243], v[72:75], 0
    v_cvt_pk_bf16_f32 v96, v112, v113
    v_cvt_pk_bf16_f32 v97, v114, v115
    v_mfma_f32_16x16x32_bf16 v[20:23], a[244:247], v[76:79], v[20:23]
    v_exp_f32 v108, v108
    v_mfma_f32_16x16x32_bf16 v[20:23], a[248:251], v[60:63], v[20:23]
    s_waitcnt lgkmcnt(0)
    buffer_load_dwordx4 v126, s[24:27], s56 offen nt lds
    v_and_b32 v120, 0xffff0000, v116
    v_mfma_f32_16x16x32_bf16 v[20:23], a[252:255], v[56:59], v[20:23]
    v_exp_f32 v109, v109
    v_mfma_f32_16x16x32_bf16 v[20:23], v[224:227], v[64:67], v[20:23]
    v_exp_f32 v110, v110
    v_mfma_f32_16x16x32_bf16 v[20:23], v[228:231], v[80:83], v[20:23]
    s_mov_b32 s53, s47
    v_exp_f32 v111, v111
    v_cvt_pk_bf16_f32 v98, v108, v109
    v_cvt_pk_bf16_f32 v99, v110, v111
    v_exp_f32 v104, v104
    v_exp_f32 v105, v105
    v_exp_f32 v106, v106
    v_exp_f32 v107, v107
    v_cvt_pk_bf16_f32 v168, v104, v105
    v_cvt_pk_bf16_f32 v169, v106, v107
    v_exp_f32 v88, v88
    v_lshlrev_b32 v116, 16, v116
    v_cvt_pk_bf16_f32 v170, v88, 0
    v_mfma_f32_16x16x32_bf16 v[112:115], v[220:223], v[96:99], 0
    s_add_u32 m0, s67, 3072
    buffer_store_dwordx4 v[100:103], v126, s[28:31], s60 offen sc1
    v_add_f32 v116, v116, v120
    v_add_f32 v116, v116, v211
    v_max3_f32 v120, v48, v49, v50
    v_max3_f32 v120, v120, v51, v68
    v_mfma_f32_16x16x32_bf16 v[112:115], v[220:223], v[168:171], v[112:115]
    s_mov_b32 s47, s46
    v_mov_b32_dpp v91, v116 quad_perm:[0,1,2,3] row_mask:0x8 bank_mask:0xf
    v_mov_b32 v121, v91
    v_mfma_f32_16x16x32_bf16 v[108:111], v[0:3], v[96:99], 0
    s_mov_b32 s46, s45
    v_max_f32_dpp v121, v121, v121 row_ror:8 row_mask:0xf bank_mask:0xf
    v_max3_f32 v120, v120, v69, v70
    v_mfma_f32_16x16x32_bf16 v[108:111], v[164:167], v[168:171], v[108:111]
    s_mov_b32 s45, s44
    v_max_f32_dpp v121, v121, v121 row_ror:4 row_mask:0xf bank_mask:0xf
    v_max3_f32 v120, v120, v71, v52
    v_mfma_f32_16x16x32_bf16 v[104:107], v[8:11], v[96:99], 0
    s_mov_b32 s44, s53
    v_max_f32_dpp v121, v121, v121 row_ror:2 row_mask:0xf bank_mask:0xf
    v_max3_f32 v120, v120, v53, v54
    v_mfma_f32_16x16x32_bf16 v[104:107], v[160:163], v[168:171], v[104:107]
    s_sub_u32 s48, s44, s46
    v_max_f32_dpp v121, v121, v121 row_ror:1 row_mask:0xf bank_mask:0xf
    v_mov_b32 v84, v121
    v_mfma_f32_16x16x32_bf16 v[100:103], v[12:15], v[96:99], 0
    s_sub_u32 s49, s46, s45
    v_permlane32_swap_b32 v84, v121
    v_mfma_f32_16x16x32_bf16 v[100:103], v[156:159], v[168:171], v[100:103]
    v_max_f32 v121, v84, v121
    v_mov_b32 v84, v121
    v_rcp_f32 v112, v112
    v_max3_f32 v120, v120, v55, v93
    v_permlane16_swap_b32 v84, v121
    v_max_f32 v121, v84, v121
    v_sub_f32 v91, v91, v121
    v_exp_f32 v91, v91
    v_mul_f32 v108, v108, v112
    v_cvt_pk_bf16_f32 v91, v91, v91
    ds_write_b16 v123, v91 offset:64
    v_mul_f32 v109, v109, v112
    v_cvt_pk_bf16_f32 v88, v108, v109
    ds_read_b128 v[94:97], v132 offset:48
    v_mul_f32 v110, v110, v112
    v_mul_f32 v111, v111, v112
    v_cvt_pk_bf16_f32 v89, v110, v111
    ds_read_b128 v[108:111], v132 offset:64
    v_mfma_f32_16x16x32_bf16 v[114:117], v[232:235], v[72:75], 0
    v_mul_f32 v104, v104, v112
    v_mul_f32 v105, v105, v112
    v_mfma_f32_16x16x32_bf16 v[114:117], v[236:239], v[76:79], v[114:117]
    ds_write_b64 v135, v[88:89] offset:0
    v_mfma_f32_16x16x32_bf16 v[114:117], v[240:243], v[60:63], v[114:117]
    v_cvt_pk_bf16_f32 v90, v104, v105
    v_mul_f32 v106, v106, v112
    v_mfma_f32_16x16x32_bf16 v[114:117], v[244:247], v[56:59], v[114:117]
    v_mul_f32 v107, v107, v112
    v_cvt_pk_bf16_f32 v91, v106, v107
    v_mfma_f32_16x16x32_bf16 v[114:117], v[248:251], v[64:67], v[114:117]
    ds_write_b64 v135, v[90:91] offset:8
    v_mfma_f32_16x16x32_bf16 v[114:117], v[252:255], v[80:83], v[114:117]
    s_waitcnt lgkmcnt(3)
    v_mul_f32 v100, v100, v112
    v_mul_f32 v101, v101, v112
    v_cvt_pk_bf16_f32 v168, v100, v101
    v_mul_f32 v102, v102, v112
    v_mfma_f32_16x16x32_bf16 v[72:75], v[94:97], v[0:3], 0
    s_waitcnt lgkmcnt(2)
    v_mul_f32 v103, v103, v112
    v_cvt_pk_bf16_f32 v169, v102, v103
    v_mov_b32 v170, v120
    v_fma_f32 v92, v32, v32, s42
    v_mfma_f32_16x16x32_bf16 v[72:75], v[108:111], v[164:167], v[72:75]
    ds_write_b64 v134, v[168:169] offset:0
    v_mfma_f32_16x16x32_bf16 v[88:91], v[94:97], v[8:11], 0
    v_permlane32_swap_b32 v170, v120
    v_mfma_f32_16x16x32_bf16 v[88:91], v[108:111], v[160:163], v[88:91]
    v_max_f32 v120, v170, v120
    v_mov_b32 v170, v120
    v_mfma_f32_16x16x32_bf16 v[76:79], v[94:97], v[12:15], 0
    s_nop 0
    v_permlane16_swap_b32 v170, v120
    v_mfma_f32_16x16x32_bf16 v[76:79], v[108:111], v[156:159], v[76:79]
    ds_read_b128 v[60:63], v133 offset:3072
    v_max_f32 v120, v170, v120
    v_sub_f32 v48, v48, v120
    v_sub_f32 v49, v49, v120
    v_sub_f32 v50, v50, v120
    v_sub_f32 v51, v51, v120
    v_sub_f32 v68, v68, v120
    v_sub_f32 v69, v69, v120
    v_sub_f32 v70, v70, v120
    v_sub_f32 v71, v71, v120
    v_sub_f32 v52, v52, v120
    v_sub_f32 v53, v53, v120
    v_sub_f32 v54, v54, v120
    v_sub_f32 v55, v55, v120
    v_sub_f32 v93, v93, v120
    v_exp_f32 v48, v48
    v_exp_f32 v49, v49
    v_exp_f32 v50, v50
    v_exp_f32 v51, v51
    v_cvt_pk_bf16_f32 v56, v48, v49
    v_cvt_pk_bf16_f32 v57, v50, v51
    v_exp_f32 v68, v68
    v_exp_f32 v69, v69
    v_exp_f32 v70, v70
    v_exp_f32 v71, v71
    v_cvt_pk_bf16_f32 v58, v68, v69
    v_cvt_pk_bf16_f32 v59, v70, v71
    v_exp_f32 v52, v52
    v_exp_f32 v53, v53
    v_exp_f32 v54, v54
    v_exp_f32 v55, v55
    v_cvt_pk_bf16_f32 v168, v52, v53
    v_cvt_pk_bf16_f32 v169, v54, v55
    v_exp_f32 v93, v93
    v_mov_b32_dpp v75, v91 quad_perm:[0,1,2,3] row_mask:0x2 bank_mask:0xf
    v_cvt_pk_bf16_f32 v170, v93, 0
    v_mfma_f32_16x16x32_bf16 v[88:91], v[220:223], v[56:59], 0
    s_waitcnt lgkmcnt(0)
    buffer_load_dwordx4 v125, s[24:27], s56 offen nt lds
    ds_read_b128 v[64:67], v137 offset:3072
    v_mfma_f32_16x16x32_bf16 v[88:91], v[220:223], v[168:171], v[88:91]
    v_mov_b32_dpp v75, v79 quad_perm:[0,1,2,3] row_mask:0x4 bank_mask:0xf
    v_cvt_pk_bf16_f32 v75, v75, v75
    v_mfma_f32_16x16x32_bf16 v[76:79], v[0:3], v[56:59], 0
    ds_write_b16 v131, v75
    v_mfma_f32_16x16x32_bf16 v[76:79], v[164:167], v[168:171], v[76:79]
    ds_read_b128 v[72:75], v136 offset:3072
    v_fmac_f32 v92, v33, v33
    v_mfma_f32_16x16x32_bf16 v[80:83], v[8:11], v[56:59], 0
    ds_read_b128 v[48:51], v137 offset:3200
    v_fmac_f32 v92, v34, v34
    v_mfma_f32_16x16x32_bf16 v[80:83], v[160:163], v[168:171], v[80:83]
    ds_read_b128 v[68:71], v136 offset:3200
    v_fmac_f32 v92, v35, v35
    v_mfma_f32_16x16x32_bf16 v[52:55], v[12:15], v[56:59], 0
    ds_read_b128 v[56:59], v137 offset:3328
    v_add_u32 v137, s48, v137
    v_mfma_f32_16x16x32_bf16 v[52:55], v[156:159], v[168:171], v[52:55]
    buffer_store_dwordx4 v[60:63], v125, s[28:31], s60 offen sc1
    ds_read_b128 v[94:97], v136 offset:3328
    v_rcp_f32 v88, v88
    v_add_u32 v136, s48, v136
    v_mfma_f32_16x16x32_f16 v[60:63], v[16:19], v[44:47], v[180:183]
    s_add_u32 m0, s67, 4096
    ds_read_b128 v[16:19], v133 offset:4096
    v_mul_f32 v76, v76, v88
    v_mfma_f32_16x16x32_f16 v[60:63], v[152:155], v[138:141], v[60:63]
    s_cmp_lg_u32 s5, -1
    v_mul_f32 v77, v77, v88
    v_cvt_pk_bf16_f32 v76, v76, v77
    v_mfma_f32_16x16x32_f16 v[152:155], v[36:39], v[44:47], v[176:179]
    v_mul_f32 v78, v78, v88
    v_mul_f32 v79, v79, v88
    v_mfma_f32_16x16x32_f16 v[152:155], v[146:149], v[138:141], v[152:155]
    v_cvt_pk_bf16_f32 v77, v78, v79
    v_mul_f32 v80, v80, v88
    v_mfma_f32_16x16x32_f16 v[36:39], v[40:43], v[44:47], v[172:175]
    ds_write_b64 v135, v[76:77] offset:1536
    v_mfma_f32_16x16x32_f16 v[36:39], v[140:143], v[138:141], v[36:39]
    s_waitcnt lgkmcnt(4)
    v_mul_f32 v81, v81, v88
    v_cvt_pk_bf16_f32 v78, v80, v81
    v_mfma_f32_16x16x32_bf16 v[40:43], a[216:219], v[64:67], 0
    v_mul_f32 v82, v82, v88
    v_mul_f32 v83, v83, v88
    v_mfma_f32_16x16x32_bf16 v[40:43], a[220:223], v[72:75], v[40:43]
    v_cvt_pk_bf16_f32 v79, v82, v83
    v_mul_f32 v52, v52, v88
    v_mfma_f32_16x16x32_bf16 v[40:43], a[224:227], v[48:51], v[40:43]
    ds_write_b64 v135, v[78:79] offset:1544
    v_mfma_f32_16x16x32_bf16 v[40:43], a[228:231], v[68:71], v[40:43]
    s_waitcnt lgkmcnt(2)
    buffer_load_dwordx4 v124, s[24:27], s56 offen nt lds
    v_mul_f32 v53, v53, v88
    v_mfma_f32_16x16x32_bf16 v[40:43], a[232:235], v[56:59], v[40:43]
    v_cvt_pk_bf16_f32 v168, v52, v53
    v_mul_f32 v54, v54, v88
    v_mfma_f32_16x16x32_bf16 v[40:43], a[236:239], v[94:97], v[40:43]
    v_mul_f32 v55, v55, v88
    v_cvt_pk_bf16_f32 v169, v54, v55
    v_mfma_f32_16x16x32_bf16 v[140:143], a[240:243], v[64:67], 0
    ds_write_b64 v134, v[168:169] offset:1536
    v_mfma_f32_16x16x32_bf16 v[140:143], a[244:247], v[72:75], v[140:143]
    v_max3_f32 v168, v60, v61, v62
    v_max3_f32 v168, v168, v63, v152
    v_mfma_f32_16x16x32_bf16 v[140:143], a[248:251], v[48:51], v[140:143]
    v_max3_f32 v168, v168, v153, v154
    v_max3_f32 v168, v168, v155, v36
    v_mfma_f32_16x16x32_bf16 v[140:143], a[252:255], v[68:71], v[140:143]
    v_max3_f32 v168, v168, v37, v38
    v_max3_f32 v168, v168, v39, v86
    v_mfma_f32_16x16x32_bf16 v[140:143], v[224:227], v[56:59], v[140:143]
    buffer_store_dwordx4 v[16:19], v124, s[28:31], s60 offen sc1
    v_mov_b32 v169, v168
    v_fmac_f32 v92, v4, v4
    v_fmac_f32 v92, v5, v5
    v_fmac_f32 v92, v6, v6
    v_mfma_f32_16x16x32_bf16 v[140:143], v[228:231], v[94:97], v[140:143]
    ds_read_b128 v[16:19], v137 offset:0
    v_fmac_f32 v92, v7, v7
    v_mfma_f32_16x16x32_bf16 v[44:47], v[232:235], v[64:67], 0
    ds_read_b128 v[146:149], v136 offset:0
    v_fmac_f32 v92, v24, v24
    v_mfma_f32_16x16x32_bf16 v[44:47], v[236:239], v[72:75], v[44:47]
    ds_read_b128 v[72:75], v137 offset:128
    v_fmac_f32 v92, v25, v25
    v_mfma_f32_16x16x32_bf16 v[44:47], v[240:243], v[48:51], v[44:47]
    ds_read_b128 v[88:91], v136 offset:128
    v_fmac_f32 v92, v26, v26
    v_mfma_f32_16x16x32_bf16 v[44:47], v[244:247], v[68:71], v[44:47]
    ds_read_b128 v[76:79], v137 offset:256
    v_fmac_f32 v92, v27, v27
    v_mfma_f32_16x16x32_bf16 v[44:47], v[248:251], v[56:59], v[44:47]
    ds_read_b128 v[56:59], v136 offset:256
    v_fma_f32 v93, v28, v28, s42
    v_mfma_f32_16x16x32_bf16 v[44:47], v[252:255], v[94:97], v[44:47]
    v_permlane32_swap_b32 v169, v168
    v_max_f32 v168, v169, v168
    v_mov_b32 v169, v168
    v_fmac_f32 v93, v29, v29
    v_fmac_f32 v93, v30, v30
    v_permlane16_swap_b32 v169, v168
    v_max_f32 v168, v169, v168
    v_sub_f32 v60, v60, v168
    v_sub_f32 v61, v61, v168
    v_sub_f32 v62, v62, v168
    v_sub_f32 v63, v63, v168
    v_sub_f32 v152, v152, v168
    v_sub_f32 v153, v153, v168
    v_sub_f32 v154, v154, v168
    v_sub_f32 v155, v155, v168
    v_sub_f32 v36, v36, v168
    v_sub_f32 v37, v37, v168
    v_sub_f32 v38, v38, v168
    v_sub_f32 v39, v39, v168
    v_sub_f32 v86, v86, v168
    v_exp_f32 v60, v60
    v_exp_f32 v61, v61
    v_exp_f32 v62, v62
    v_exp_f32 v63, v63
    v_cvt_pk_bf16_f32 v60, v60, v61
    v_cvt_pk_bf16_f32 v61, v62, v63
    v_exp_f32 v152, v152
    v_exp_f32 v153, v153
    v_exp_f32 v154, v154
    v_exp_f32 v155, v155
    v_cvt_pk_bf16_f32 v62, v152, v153
    v_cvt_pk_bf16_f32 v63, v154, v155
    v_exp_f32 v36, v36
    v_exp_f32 v37, v37
    v_exp_f32 v38, v38
    v_exp_f32 v39, v39
    v_cvt_pk_bf16_f32 v168, v36, v37
    v_cvt_pk_bf16_f32 v169, v38, v39
    v_exp_f32 v86, v86
    v_fmac_f32 v93, v31, v31
    v_cvt_pk_bf16_f32 v170, v86, 0
    v_mfma_f32_16x16x32_bf16 v[152:155], v[220:223], v[60:63], 0
    v_fmac_f32 v93, v20, v20
    v_fmac_f32 v93, v21, v21
    v_mfma_f32_16x16x32_bf16 v[152:155], v[220:223], v[168:171], v[152:155]
    v_fmac_f32 v93, v22, v22
    v_fmac_f32 v93, v23, v23
    v_mfma_f32_16x16x32_bf16 v[36:39], v[0:3], v[60:63], 0
    s_nop 0
    v_fmac_f32 v93, v114, v114
    v_fmac_f32 v93, v115, v115
    v_mfma_f32_16x16x32_bf16 v[36:39], v[164:167], v[168:171], v[36:39]
    s_nop 0
    v_rcp_f32 v152, v152
    v_mfma_f32_16x16x32_bf16 v[0:3], v[8:11], v[60:63], 0
    s_nop 0
    v_fmac_f32 v93, v116, v116
    v_fmac_f32 v93, v117, v117
    v_mfma_f32_16x16x32_bf16 v[0:3], v[160:163], v[168:171], v[0:3]
    s_nop 0
    v_mul_f32 v36, v36, v152
    v_mul_f32 v37, v37, v152
    v_mfma_f32_16x16x32_bf16 v[8:11], v[12:15], v[60:63], 0
    v_cvt_pk_bf16_f32 v12, v36, v37
    v_mul_f32 v38, v38, v152
    v_mfma_f32_16x16x32_bf16 v[8:11], v[156:159], v[168:171], v[8:11]
    s_waitcnt lgkmcnt(0)
    v_mul_f32 v39, v39, v152
    v_cvt_pk_bf16_f32 v13, v38, v39
    v_mfma_f32_16x16x32_bf16 v[36:39], a[0:3], v[16:19], 0
    s_cbranch_scc1 L_loopS0
    ds_write_b64 v135, v[12:13] offset:3072
    v_mul_f32 v0, v0, v152
    v_mul_f32 v1, v1, v152
    v_cvt_pk_bf16_f32 v14, v0, v1
    v_mul_f32 v2, v2, v152
    v_mul_f32 v3, v3, v152
    v_cvt_pk_bf16_f32 v15, v2, v3
    v_mul_f32 v8, v8, v152
    v_mul_f32 v9, v9, v152
    v_cvt_pk_bf16_f32 v8, v8, v9
    v_mul_f32 v10, v10, v152
    v_mul_f32 v11, v11, v152
    v_cvt_pk_bf16_f32 v9, v10, v11
    s_mov_b32 s30, 100270464
    s_mul_i32 s89, s68, 7168
    ds_write_b64 v135, v[14:15] offset:3080
    v_fma_f32 v113, v40, v40, s42
    s_add_u32 s89, s89, 135168
    s_movk_i32 s90, 112
    ds_write_b64 v134, v[8:9] offset:3072
    v_fmac_f32 v113, v41, v41
    v_fmac_f32 v113, v42, v42
    v_fmac_f32 v113, v43, v43
    v_fmac_f32 v113, v140, v140
    v_fmac_f32 v113, v141, v141
    v_fmac_f32 v113, v142, v142
    v_fmac_f32 v113, v143, v143
    v_fmac_f32 v113, v44, v44
    v_fmac_f32 v113, v45, v45
    v_fmac_f32 v113, v46, v46
    v_fmac_f32 v113, v47, v47
    v_cvt_pk_bf16_f32 v112, v92, v93
    v_cvt_pk_bf16_f32 v113, v113, v122
    s_lshr_b32 s91, s64, 16
    s_lshl_b32 s92, s68, 10
    ds_write_b64 v130, v[112:113]
    v_mbcnt_lo_u32_b32 v131, -1, 0
    v_mbcnt_hi_u32_b32 v131, -1, v131
    v_and_b32 v132, 15, v131
    v_lshrrev_b32 v131, 4, v131
    v_mul_u32_u24 v118, 1792, v131
    v_add_u32 v118, s89, v118
    v_mad_u32_u24 v131, v132, s90, v118
    v_lshrrev_b32 v119, v132, s64
    v_and_b32 v119, 1, v119
    v_cmp_eq_u32 vcc, 1, v119
    v_mad_u32_u24 v119, v132, s90, v118
    v_lshrrev_b32 v132, v132, s91
    v_cndmask_b32 v131, v118, v131, vcc
    v_and_b32 v132, 1, v132
    v_subrev_u32 v119, 28672, v119
    v_cmp_eq_u32 vcc, 1, v132
    s_sub_u32 s84, s45, s44
    s_sub_u32 s85, s46, s45
    ds_read_b128 v[48:51], v131 offset:64
    ds_read_b128 v[36:39], v131 offset:80
    v_cndmask_b32 v119, v118, v119, vcc
    v_add_u32 v118, s92, v129
    s_waitcnt lgkmcnt(2)
    s_barrier
    s_sub_u32 s86, s44, s45
    ds_read_b128 v[86:89], v131
    v_add_u32 v139, s84, v137
    s_sub_u32 s93, s44, s47
    s_sub_u32 s94, s45, s47
    ds_read_b64 v[90:91], v131 offset:16
    ds_read_b128 v[8:11], v118 offset:6144
    v_add_u32 v138, s84, v136
    v_add_u32 v118, s85, v135
    s_sub_u32 s95, s46, s47
    ds_read_b128 v[16:19], v129 offset:0
    v_add_u32 v63, s85, v134
    ds_read_b128 v[0:3], v129 offset:1024
    v_add_u32 v112, s86, v135
    v_add_u32 v132, s86, v134
    v_add_u32 v131, s93, v133
    v_add_u32 v113, s94, v133
    s_waitcnt lgkmcnt(6)
    v_mfma_f32_16x16x32_bf16 v[12:15], v[220:223], v[48:51], 0
    s_waitcnt lgkmcnt(5)
    ds_read_b128 v[80:83], v139 offset:1536
    ds_read_b128 v[76:79], v138 offset:1536
    v_mfma_f32_16x16x32_bf16 v[12:15], v[220:223], v[36:39], v[12:15]
    s_waitcnt lgkmcnt(3)
    ds_read_b128 v[72:75], v139 offset:1664
    v_lshlrev_b32 v92, 16, v86
    v_and_b32 v86, 0xffff0000, v86
    v_lshlrev_b32 v93, 16, v87
    v_and_b32 v87, 0xffff0000, v87
    v_lshlrev_b32 v94, 16, v88
    v_and_b32 v88, 0xffff0000, v88
    v_rcp_f32 v12, v12
    v_lshlrev_b32 v95, 16, v89
    v_mfma_f32_16x16x32_bf16 v[64:67], v[216:219], v[16:19], 0
    s_waitcnt lgkmcnt(3)
    ds_read_b128 v[68:71], v138 offset:1664
    ds_read_b128 v[48:51], v139 offset:1792
    v_mfma_f32_16x16x32_bf16 v[64:67], v[216:219], v[0:3], v[64:67]
    s_waitcnt lgkmcnt(4)
    ds_read_b128 v[16:19], v138 offset:1792
    v_mul_f32 v92, v92, v12
    v_mul_f32 v86, v86, v12
    v_cvt_pk_bf16_f32 v92, v92, v86
    v_mul_f32 v93, v93, v12
    v_mfma_f32_16x16x32_bf16 v[0:3], a[216:219], v[80:83], 0
    s_waitcnt lgkmcnt(4)
    v_mul_f32 v87, v87, v12
    v_cvt_pk_bf16_f32 v93, v93, v87
    v_mfma_f32_16x16x32_bf16 v[0:3], a[220:223], v[76:79], v[0:3]
    s_waitcnt lgkmcnt(3)
    ds_read_b128 v[108:111], v139 offset:0
    ds_read_b128 v[104:107], v138 offset:0
    v_mfma_f32_16x16x32_bf16 v[0:3], a[224:227], v[72:75], v[0:3]
    s_waitcnt lgkmcnt(4)
    ds_read_b128 v[96:99], v139 offset:128
    v_mul_f32 v94, v94, v12
    v_mul_f32 v88, v88, v12
    v_cvt_pk_bf16_f32 v94, v94, v88
    v_and_b32 v89, 0xffff0000, v89
    v_mul_f32 v95, v95, v12
    v_mfma_f32_16x16x32_bf16 v[0:3], a[228:231], v[68:71], v[0:3]
    s_waitcnt lgkmcnt(4)
    ds_read_b128 v[84:87], v138 offset:128
    ds_read_b128 v[56:59], v139 offset:256
    v_mfma_f32_16x16x32_bf16 v[0:3], a[232:235], v[48:51], v[0:3]
    s_waitcnt lgkmcnt(5)
    ds_read_b128 v[36:39], v138 offset:256
    v_mul_f32 v89, v89, v12
    v_mfma_f32_16x16x32_bf16 v[0:3], a[236:239], v[16:19], v[0:3]
    v_cvt_pk_bf16_f32 v95, v95, v89
    v_lshlrev_b32 v67, 16, v90
    v_mfma_f32_16x16x32_bf16 v[52:55], a[240:243], v[80:83], 0
    ds_write_b128 v112, v[92:95] offset:0
    v_mfma_f32_16x16x32_bf16 v[52:55], a[244:247], v[76:79], v[52:55]
    v_and_b32 v90, 0xffff0000, v90
    v_mul_f32 v67, v67, v12
    v_mfma_f32_16x16x32_bf16 v[52:55], a[248:251], v[72:75], v[52:55]
    v_mul_f32 v90, v90, v12
    v_cvt_pk_bf16_f32 v60, v67, v90
    v_mfma_f32_16x16x32_bf16 v[52:55], a[252:255], v[68:71], v[52:55]
    v_lshlrev_b32 v67, 16, v91
    v_and_b32 v91, 0xffff0000, v91
    v_mfma_f32_16x16x32_bf16 v[52:55], v[224:227], v[48:51], v[52:55]
    v_mul_f32 v67, v67, v12
    v_mul_f32 v91, v91, v12
    v_mfma_f32_16x16x32_bf16 v[52:55], v[228:231], v[16:19], v[52:55]
    v_cvt_pk_bf16_f32 v61, v67, v91
    v_lshrrev_b32 v67, 0, v11
    v_mfma_f32_16x16x32_bf16 v[12:15], v[232:235], v[80:83], 0
    ds_write_b64 v132, v[60:61] offset:0
    v_mfma_f32_16x16x32_bf16 v[12:15], v[236:239], v[76:79], v[12:15]
    v_lshrrev_b32 v67, v67, s64
    v_and_b32 v67, 1, v67
    v_mfma_f32_16x16x32_bf16 v[12:15], v[240:243], v[72:75], v[12:15]
    v_cmp_eq_u32 vcc, 1, v67
    v_lshrrev_b32 v67, 8, v11
    v_mfma_f32_16x16x32_bf16 v[12:15], v[244:247], v[68:71], v[12:15]
    v_cndmask_b32 v8, 2.0, v8, vcc
    v_lshrrev_b32 v67, v67, s64
    v_mfma_f32_16x16x32_bf16 v[12:15], v[248:251], v[48:51], v[12:15]
    v_and_b32 v67, 1, v67
    v_cmp_eq_u32 vcc, 1, v67
    v_mfma_f32_16x16x32_bf16 v[12:15], v[252:255], v[16:19], v[12:15]
    s_waitcnt lgkmcnt(1)
    v_cndmask_b32 v9, 2.0, v9, vcc
    v_lshrrev_b32 v11, 16, v11
    v_mfma_f32_16x16x32_bf16 v[72:75], a[216:219], v[108:111], 0
    v_lshrrev_b32 v11, v11, s64
    v_and_b32 v11, 1, v11
    v_mfma_f32_16x16x32_bf16 v[72:75], a[220:223], v[104:107], v[72:75]
    ds_read_b128 v[100:103], v139 offset:3072
    ds_read_b128 v[92:95], v138 offset:3072
    v_mfma_f32_16x16x32_bf16 v[72:75], a[224:227], v[96:99], v[72:75]
    ds_read_b128 v[88:91], v139 offset:3200
    v_cmp_eq_u32 vcc, 1, v11
    v_mfma_f32_16x16x32_bf16 v[72:75], a[228:231], v[84:87], v[72:75]
    ds_read_b128 v[80:83], v138 offset:3200
    v_cndmask_b32 v10, 2.0, v10, vcc
    v_mfma_f32_16x16x32_bf16 v[72:75], a[232:235], v[56:59], v[72:75]
    ds_read_b128 v[76:79], v139 offset:3328
    v_add_u32 v11, s95, v133
    v_mfma_f32_16x16x32_bf16 v[72:75], a[236:239], v[36:39], v[72:75]
    ds_read_b128 v[16:19], v138 offset:3328
    v_fma_f32 v133, v0, v0, s42
    v_mfma_f32_16x16x32_bf16 v[48:51], a[240:243], v[108:111], 0
    v_rsq_f32 v64, v64
    v_mfma_f32_16x16x32_bf16 v[48:51], a[244:247], v[104:107], v[48:51]
    v_mul_f32 v64, s43, v64
    v_mul_f32 v32, v32, v64
    v_mfma_f32_16x16x32_bf16 v[48:51], a[248:251], v[96:99], v[48:51]
    v_mul_f32 v33, v33, v64
    v_cvt_pk_bf16_f32 v32, v32, v33
    v_mfma_f32_16x16x32_bf16 v[48:51], a[252:255], v[84:87], v[48:51]
    v_mul_f32 v34, v34, v64
    v_mul_f32 v35, v35, v64
    v_mfma_f32_16x16x32_bf16 v[48:51], v[224:227], v[56:59], v[48:51]
    v_cvt_pk_bf16_f32 v33, v34, v35
    v_mul_f32 v4, v4, v64
    v_mfma_f32_16x16x32_bf16 v[48:51], v[228:231], v[36:39], v[48:51]
    v_mul_f32 v5, v5, v64
    v_cvt_pk_bf16_f32 v34, v4, v5
    v_mfma_f32_16x16x32_bf16 v[68:71], v[232:235], v[108:111], 0
    v_mul_f32 v6, v6, v64
    v_mul_f32 v7, v7, v64
    v_mfma_f32_16x16x32_bf16 v[68:71], v[236:239], v[104:107], v[68:71]
    v_cvt_pk_bf16_f32 v35, v6, v7
    v_mul_f32 v24, v24, v64
    v_mfma_f32_16x16x32_bf16 v[68:71], v[240:243], v[96:99], v[68:71]
    ds_write_b128 v118, v[32:35] offset:0
    v_mfma_f32_16x16x32_bf16 v[68:71], v[244:247], v[84:87], v[68:71]
    v_mul_f32 v25, v25, v64
    v_cvt_pk_bf16_f32 v24, v24, v25
    v_mfma_f32_16x16x32_bf16 v[68:71], v[248:251], v[56:59], v[68:71]
    v_mul_f32 v26, v26, v64
    v_mul_f32 v27, v27, v64
    v_mfma_f32_16x16x32_bf16 v[68:71], v[252:255], v[36:39], v[68:71]
    s_waitcnt lgkmcnt(1)
    v_cvt_pk_bf16_f32 v25, v26, v27
    v_fma_f32 v62, v72, v72, s42
    v_mfma_f32_16x16x32_bf16 v[84:87], a[216:219], v[100:103], 0
    ds_write_b64 v63, v[24:25] offset:0
    v_mfma_f32_16x16x32_bf16 v[84:87], a[220:223], v[92:95], v[84:87]
    ds_read_b128 v[24:27], v119 offset:64
    v_fmac_f32 v62, v73, v73
    v_mfma_f32_16x16x32_bf16 v[84:87], a[224:227], v[88:91], v[84:87]
    ds_read_b128 v[4:7], v119 offset:80
    v_fmac_f32 v62, v74, v74
    v_mfma_f32_16x16x32_bf16 v[84:87], a[228:231], v[80:83], v[84:87]
    ds_read_b128 v[56:59], v119
    v_fmac_f32 v62, v75, v75
    v_mfma_f32_16x16x32_bf16 v[84:87], a[232:235], v[76:79], v[84:87]
    ds_read_b64 v[60:61], v119 offset:16
    v_fmac_f32 v62, v48, v48
    v_mfma_f32_16x16x32_bf16 v[84:87], a[236:239], v[16:19], v[84:87]
    v_rsq_f32 v65, v65
    v_mfma_f32_16x16x32_bf16 v[96:99], a[240:243], v[100:103], 0
    v_mul_f32 v65, s43, v65
    v_mul_f32 v28, v28, v65
    v_mfma_f32_16x16x32_bf16 v[96:99], a[244:247], v[92:95], v[96:99]
    v_mul_f32 v29, v29, v65
    v_cvt_pk_bf16_f32 v28, v28, v29
    v_mfma_f32_16x16x32_bf16 v[96:99], a[248:251], v[88:91], v[96:99]
    v_mul_f32 v30, v30, v65
    v_mul_f32 v31, v31, v65
    v_mfma_f32_16x16x32_bf16 v[96:99], a[252:255], v[80:83], v[96:99]
    v_cvt_pk_bf16_f32 v29, v30, v31
    v_mul_f32 v20, v20, v65
    v_mfma_f32_16x16x32_bf16 v[96:99], v[224:227], v[76:79], v[96:99]
    v_mul_f32 v21, v21, v65
    v_cvt_pk_bf16_f32 v30, v20, v21
    v_mfma_f32_16x16x32_bf16 v[96:99], v[228:231], v[16:19], v[96:99]
    v_mul_f32 v22, v22, v65
    v_mul_f32 v23, v23, v65
    v_mfma_f32_16x16x32_bf16 v[36:39], v[232:235], v[100:103], 0
    v_cvt_pk_bf16_f32 v31, v22, v23
    v_mul_f32 v114, v114, v65
    v_mfma_f32_16x16x32_bf16 v[36:39], v[236:239], v[92:95], v[36:39]
    ds_write_b128 v118, v[28:31] offset:1536
    v_mfma_f32_16x16x32_bf16 v[36:39], v[240:243], v[88:91], v[36:39]
    v_mul_f32 v115, v115, v65
    v_cvt_pk_bf16_f32 v114, v114, v115
    v_mfma_f32_16x16x32_bf16 v[36:39], v[244:247], v[80:83], v[36:39]
    v_mul_f32 v116, v116, v65
    v_mul_f32 v117, v117, v65
    v_mfma_f32_16x16x32_bf16 v[36:39], v[248:251], v[76:79], v[36:39]
    v_cvt_pk_bf16_f32 v115, v116, v117
    v_fmac_f32 v62, v49, v49
    v_mfma_f32_16x16x32_bf16 v[36:39], v[252:255], v[16:19], v[36:39]
    s_waitcnt lgkmcnt(1)
    ds_write_b64 v63, v[114:115] offset:1536
    v_mfma_f32_16x16x32_bf16 v[16:19], v[220:223], v[24:27], 0
    v_rsq_f32 v66, v66
    v_mfma_f32_16x16x32_bf16 v[16:19], v[220:223], v[4:7], v[16:19]
    v_mul_f32 v66, s43, v66
    v_mul_f32 v40, v40, v66
    v_mul_f32 v41, v41, v66
    v_cvt_pk_bf16_f32 v4, v40, v41
    v_mul_f32 v42, v42, v66
    v_mul_f32 v43, v43, v66
    v_cvt_pk_bf16_f32 v5, v42, v43
    v_mul_f32 v140, v140, v66
    v_mul_f32 v141, v141, v66
    v_cvt_pk_bf16_f32 v6, v140, v141
    v_mul_f32 v142, v142, v66
    v_mul_f32 v143, v143, v66
    v_cvt_pk_bf16_f32 v7, v142, v143
    v_mul_f32 v44, v44, v66
    v_mul_f32 v45, v45, v66
    v_cvt_pk_bf16_f32 v44, v44, v45
    v_mul_f32 v46, v46, v66
    v_mul_f32 v47, v47, v66
    v_cvt_pk_bf16_f32 v45, v46, v47
    ds_write_b128 v118, v[4:7] offset:3072
    v_fmac_f32 v62, v50, v50
    v_fmac_f32 v62, v51, v51
    v_fmac_f32 v62, v68, v68
    v_fmac_f32 v62, v69, v69
    ds_write_b64 v63, v[44:45] offset:3072
    v_fmac_f32 v62, v70, v70
    v_fmac_f32 v62, v71, v71
    v_fmac_f32 v133, v1, v1
    v_fmac_f32 v133, v2, v2
    v_fmac_f32 v133, v3, v3
    v_fmac_f32 v133, v52, v52
    v_fmac_f32 v133, v53, v53
    v_fmac_f32 v133, v54, v54
    v_fmac_f32 v133, v55, v55
    v_fmac_f32 v133, v12, v12
    v_fmac_f32 v133, v13, v13
    v_fmac_f32 v133, v14, v14
    v_fmac_f32 v133, v15, v15
    v_cvt_pk_bf16_f32 v62, v62, v133
    v_fma_f32 v63, v84, v84, s42
    v_fmac_f32 v63, v85, v85
    v_fmac_f32 v63, v86, v86
    v_fmac_f32 v63, v87, v87
    v_fmac_f32 v63, v96, v96
    v_fmac_f32 v63, v97, v97
    v_fmac_f32 v63, v98, v98
    v_fmac_f32 v63, v99, v99
    v_fmac_f32 v63, v36, v36
    v_fmac_f32 v63, v37, v37
    v_fmac_f32 v63, v38, v38
    v_fmac_f32 v63, v39, v39
    v_cvt_pk_bf16_f32 v63, v63, v63
    ds_write_b64 v130, v[62:63] offset:2048
    v_rcp_f32 v16, v16
    v_lshlrev_b32 v133, 16, v56
    v_and_b32 v56, 0xffff0000, v56
    v_mul_f32 v133, v133, v16
    v_mul_f32 v56, v56, v16
    v_cvt_pk_bf16_f32 v4, v133, v56
    v_lshlrev_b32 v56, 16, v57
    v_and_b32 v57, 0xffff0000, v57
    v_mul_f32 v56, v56, v16
    v_mul_f32 v57, v57, v16
    v_cvt_pk_bf16_f32 v5, v56, v57
    v_lshlrev_b32 v133, 16, v58
    v_and_b32 v58, 0xffff0000, v58
    v_mul_f32 v133, v133, v16
    v_mul_f32 v58, v58, v16
    v_cvt_pk_bf16_f32 v6, v133, v58
    v_lshlrev_b32 v7, 16, v59
    v_and_b32 v59, 0xffff0000, v59
    v_mul_f32 v7, v7, v16
    v_mul_f32 v59, v59, v16
    v_cvt_pk_bf16_f32 v7, v7, v59
    v_lshlrev_b32 v133, 16, v60
    v_and_b32 v60, 0xffff0000, v60
    v_mul_f32 v133, v133, v16
    v_mul_f32 v60, v60, v16
    v_cvt_pk_bf16_f32 v138, v133, v60
    v_lshlrev_b32 v133, 16, v61
    v_and_b32 v61, 0xffff0000, v61
    v_mul_f32 v133, v133, v16
    v_mul_f32 v61, v61, v16
    v_cvt_pk_bf16_f32 v139, v133, v61
    s_waitcnt lgkmcnt(0)
    s_barrier
    ds_write_b128 v112, v[4:7] offset:1536
    v_mov_b32 v115, 0
    ds_write_b64 v132, v[138:139] offset:1536
    ds_read_b128 v[32:35], v11 offset:0
    ds_read_b128 v[4:7], v11 offset:1024
    ds_read_b128 v[24:27], v11 offset:2048
    ds_read_b128 v[20:23], v11 offset:3072
    ds_read_b128 v[80:83], v11 offset:4096
    s_waitcnt lgkmcnt(5)
    s_barrier
    s_waitcnt lgkmcnt(4)
    buffer_store_dwordx4 v[32:35], v128, s[28:31], s59 offen sc1
    ds_read_b128 v[28:31], v129 offset:2048
    ds_read_b128 v[16:19], v129 offset:3072
    ds_read_b128 v[104:107], v137 offset:1536
    ds_read_b128 v[100:103], v136 offset:1536
    ds_read_b128 v[92:95], v137 offset:1664
    ds_read_b128 v[88:91], v136 offset:1664
    ds_read_b128 v[76:79], v137 offset:1792
    s_waitcnt lgkmcnt(9)
    buffer_store_dwordx4 v[4:7], v127, s[28:31], s59 offen sc1
    ds_read_b128 v[40:43], v136 offset:1792
    s_waitcnt lgkmcnt(7)
    v_mfma_f32_16x16x32_bf16 v[4:7], v[216:219], v[28:31], 0
    s_waitcnt lgkmcnt(6)
    v_mfma_f32_16x16x32_bf16 v[4:7], v[216:219], v[16:19], v[4:7]
    s_waitcnt lgkmcnt(5)
    v_mfma_f32_16x16x32_bf16 v[16:19], a[216:219], v[104:107], 0
    s_waitcnt lgkmcnt(4)
    v_mfma_f32_16x16x32_bf16 v[16:19], a[220:223], v[100:103], v[16:19]
    s_waitcnt lgkmcnt(3)
    ds_read_b128 v[64:67], v137 offset:0
    ds_read_b128 v[60:63], v136 offset:0
    v_mfma_f32_16x16x32_bf16 v[16:19], a[224:227], v[92:95], v[16:19]
    s_waitcnt lgkmcnt(4)
    ds_read_b128 v[56:59], v137 offset:128
    v_mfma_f32_16x16x32_bf16 v[16:19], a[228:231], v[88:91], v[16:19]
    s_waitcnt lgkmcnt(4)
    buffer_store_dwordx4 v[24:27], v126, s[28:31], s59 offen sc1
    ds_read_b128 v[44:47], v136 offset:128
    v_rsq_f32 v4, v4
    v_mfma_f32_16x16x32_bf16 v[16:19], a[232:235], v[76:79], v[16:19]
    s_waitcnt lgkmcnt(4)
    ds_read_b128 v[32:35], v137 offset:256
    ds_read_b128 v[24:27], v136 offset:256
    v_mfma_f32_16x16x32_bf16 v[16:19], a[236:239], v[40:43], v[16:19]
    v_rsq_f32 v5, v5
    v_mfma_f32_16x16x32_bf16 v[28:31], a[240:243], v[104:107], 0
    v_mul_f32 v4, s43, v4
    v_mul_f32 v5, s43, v5
    v_mfma_f32_16x16x32_bf16 v[28:31], a[244:247], v[100:103], v[28:31]
    v_rsq_f32 v6, v6
    v_mfma_f32_16x16x32_bf16 v[28:31], a[248:251], v[92:95], v[28:31]
    v_mul_f32 v6, s43, v6
    v_mul_f32 v84, v84, v6
    v_mfma_f32_16x16x32_bf16 v[28:31], a[252:255], v[88:91], v[28:31]
    buffer_store_dwordx4 v[20:23], v125, s[28:31], s59 offen sc1
    v_mul_f32 v85, v85, v6
    v_cvt_pk_bf16_f32 v84, v84, v85
    v_mul_f32 v86, v86, v6
    v_mul_f32 v87, v87, v6
    v_mfma_f32_16x16x32_bf16 v[28:31], v[224:227], v[76:79], v[28:31]
    v_cvt_pk_bf16_f32 v85, v86, v87
    v_mul_f32 v96, v96, v6
    v_mfma_f32_16x16x32_bf16 v[28:31], v[228:231], v[40:43], v[28:31]
    v_mul_f32 v97, v97, v6
    v_cvt_pk_bf16_f32 v86, v96, v97
    v_mfma_f32_16x16x32_bf16 v[20:23], v[232:235], v[104:107], 0
    v_mul_f32 v98, v98, v6
    v_mul_f32 v99, v99, v6
    v_mfma_f32_16x16x32_bf16 v[20:23], v[236:239], v[100:103], v[20:23]
    v_cvt_pk_bf16_f32 v87, v98, v99
    v_mul_f32 v36, v36, v6
    v_mfma_f32_16x16x32_bf16 v[20:23], v[240:243], v[92:95], v[20:23]
    ds_write_b128 v135, v[84:87] offset:3072
    v_mfma_f32_16x16x32_bf16 v[20:23], v[244:247], v[88:91], v[20:23]
    buffer_store_dwordx4 v[80:83], v124, s[28:31], s59 offen sc1
    v_mul_f32 v37, v37, v6
    v_cvt_pk_bf16_f32 v36, v36, v37
    v_mul_f32 v38, v38, v6
    v_mul_f32 v39, v39, v6
    v_mfma_f32_16x16x32_bf16 v[20:23], v[248:251], v[76:79], v[20:23]
    v_cvt_pk_bf16_f32 v37, v38, v39
    v_mul_f32 v72, v72, v4
    v_mfma_f32_16x16x32_bf16 v[20:23], v[252:255], v[40:43], v[20:23]
    s_waitcnt lgkmcnt(1)
    ds_write_b64 v134, v[36:37] offset:3072
    v_mfma_f32_16x16x32_bf16 v[36:39], a[216:219], v[64:67], 0
    v_mul_f32 v73, v73, v4
    v_cvt_pk_bf16_f32 v40, v72, v73
    v_mfma_f32_16x16x32_bf16 v[36:39], a[220:223], v[60:63], v[36:39]
    v_mul_f32 v74, v74, v4
    v_mul_f32 v75, v75, v4
    v_mfma_f32_16x16x32_bf16 v[36:39], a[224:227], v[56:59], v[36:39]
    v_cvt_pk_bf16_f32 v41, v74, v75
    v_mul_f32 v48, v48, v4
    v_mfma_f32_16x16x32_bf16 v[36:39], a[228:231], v[44:47], v[36:39]
    v_mul_f32 v49, v49, v4
    v_cvt_pk_bf16_f32 v42, v48, v49
    v_mfma_f32_16x16x32_bf16 v[36:39], a[232:235], v[32:35], v[36:39]
    v_mul_f32 v50, v50, v4
    v_mul_f32 v51, v51, v4
    v_mfma_f32_16x16x32_bf16 v[36:39], a[236:239], v[24:27], v[36:39]
    v_cvt_pk_bf16_f32 v43, v50, v51
    v_mul_f32 v68, v68, v4
    v_mfma_f32_16x16x32_bf16 v[48:51], a[240:243], v[64:67], 0
    ds_write_b128 v135, v[40:43] offset:0
    v_mfma_f32_16x16x32_bf16 v[48:51], a[244:247], v[60:63], v[48:51]
    v_mul_f32 v69, v69, v4
    v_cvt_pk_bf16_f32 v6, v68, v69
    v_mfma_f32_16x16x32_bf16 v[48:51], a[248:251], v[56:59], v[48:51]
    v_mul_f32 v70, v70, v4
    v_mul_f32 v71, v71, v4
    v_mfma_f32_16x16x32_bf16 v[48:51], a[252:255], v[44:47], v[48:51]
    v_cvt_pk_bf16_f32 v7, v70, v71
    v_fma_f32 v11, v16, v16, s42
    v_mfma_f32_16x16x32_bf16 v[48:51], v[224:227], v[32:35], v[48:51]
    ds_write_b64 v134, v[6:7] offset:0
    v_mfma_f32_16x16x32_bf16 v[48:51], v[228:231], v[24:27], v[48:51]
    v_fmac_f32 v11, v17, v17
    v_fmac_f32 v11, v18, v18
    v_mfma_f32_16x16x32_bf16 v[40:43], v[232:235], v[64:67], 0
    v_fmac_f32 v11, v19, v19
    v_fmac_f32 v11, v28, v28
    v_mfma_f32_16x16x32_bf16 v[40:43], v[236:239], v[60:63], v[40:43]
    v_fmac_f32 v11, v29, v29
    v_fmac_f32 v11, v30, v30
    v_mfma_f32_16x16x32_bf16 v[40:43], v[240:243], v[56:59], v[40:43]
    v_fmac_f32 v11, v31, v31
    v_fmac_f32 v11, v20, v20
    v_mfma_f32_16x16x32_bf16 v[40:43], v[244:247], v[44:47], v[40:43]
    v_fmac_f32 v11, v21, v21
    v_fmac_f32 v11, v22, v22
    v_mfma_f32_16x16x32_bf16 v[40:43], v[248:251], v[32:35], v[40:43]
    v_fmac_f32 v11, v23, v23
    v_fma_f32 v114, v36, v36, s42
    v_mfma_f32_16x16x32_bf16 v[40:43], v[252:255], v[24:27], v[40:43]
    s_nop 0
    v_fmac_f32 v114, v37, v37
    v_fmac_f32 v114, v38, v38
    v_fmac_f32 v114, v39, v39
    v_fmac_f32 v114, v48, v48
    v_fmac_f32 v114, v49, v49
    v_fmac_f32 v114, v50, v50
    v_fmac_f32 v114, v51, v51
    v_fmac_f32 v114, v40, v40
    v_fmac_f32 v114, v41, v41
    v_fmac_f32 v114, v42, v42
    v_fmac_f32 v114, v43, v43
    v_cvt_pk_bf16_f32 v114, v114, v11
    ds_write_b64 v130, v[114:115] offset:4096
    v_mul_f32 v0, v0, v5
    v_mul_f32 v1, v1, v5
    v_cvt_pk_bf16_f32 v0, v0, v1
    v_mul_f32 v2, v2, v5
    v_mul_f32 v3, v3, v5
    v_cvt_pk_bf16_f32 v1, v2, v3
    v_mul_f32 v52, v52, v5
    v_mul_f32 v53, v53, v5
    v_cvt_pk_bf16_f32 v2, v52, v53
    v_mul_f32 v54, v54, v5
    v_mul_f32 v55, v55, v5
    v_cvt_pk_bf16_f32 v3, v54, v55
    v_mul_f32 v12, v12, v5
    v_mul_f32 v13, v13, v5
    v_cvt_pk_bf16_f32 v114, v12, v13
    v_mul_f32 v14, v14, v5
    v_mul_f32 v15, v15, v5
    v_cvt_pk_bf16_f32 v115, v14, v15
    ds_write_b128 v135, v[0:3] offset:1536
    s_waitcnt lgkmcnt(1)
    s_barrier
    ds_write_b64 v134, v[114:115] offset:1536
    ds_read_b128 v[4:7], v129 offset:4096
    ds_read_b128 v[0:3], v129 offset:5120
    s_waitcnt lgkmcnt(2)
    s_barrier
    s_waitcnt lgkmcnt(1)
    v_mfma_f32_16x16x32_bf16 v[24:27], v[216:219], v[4:7], 0
    s_waitcnt lgkmcnt(0)
    ds_read_b128 v[44:47], v113 offset:0
    ds_read_b128 v[32:35], v113 offset:1024
    v_mfma_f32_16x16x32_bf16 v[24:27], v[216:219], v[0:3], v[24:27]
    s_nop 0
    ds_read_b128 v[12:15], v113 offset:2048
    s_nop 2
    ds_read_b128 v[4:7], v113 offset:3072
    s_nop 1
    v_rsq_f32 v24, v24
    ds_read_b128 v[0:3], v113 offset:4096
    v_mul_f32 v24, s43, v24
    v_mul_f32 v36, v36, v24
    v_mul_f32 v37, v37, v24
    v_cvt_pk_bf16_f32 v36, v36, v37
    v_mul_f32 v38, v38, v24
    v_mul_f32 v39, v39, v24
    v_cvt_pk_bf16_f32 v37, v38, v39
    v_mul_f32 v48, v48, v24
    v_mul_f32 v49, v49, v24
    s_waitcnt lgkmcnt(4)
    buffer_store_dwordx4 v[44:47], v128, s[28:31], s58 offen sc1
    v_cvt_pk_bf16_f32 v38, v48, v49
    v_mul_f32 v50, v50, v24
    v_mul_f32 v51, v51, v24
    v_cvt_pk_bf16_f32 v39, v50, v51
    v_mul_f32 v40, v40, v24
    v_mul_f32 v41, v41, v24
    v_cvt_pk_bf16_f32 v26, v40, v41
    v_mul_f32 v42, v42, v24
    v_mul_f32 v43, v43, v24
    v_cvt_pk_bf16_f32 v27, v42, v43
    ds_write_b128 v112, v[36:39] offset:0
    v_rsq_f32 v25, v25
    s_nop 0
    v_mul_f32 v25, s43, v25
    s_waitcnt lgkmcnt(1)
    buffer_store_dwordx4 v[32:35], v127, s[28:31], s58 offen sc1
    ds_write_b64 v132, v[26:27] offset:0
    v_mul_f32 v16, v16, v25
    v_mul_f32 v17, v17, v25
    v_cvt_pk_bf16_f32 v16, v16, v17
    v_mul_f32 v18, v18, v25
    v_mul_f32 v19, v19, v25
    v_cvt_pk_bf16_f32 v17, v18, v19
    v_mul_f32 v28, v28, v25
    v_mul_f32 v29, v29, v25
    v_cvt_pk_bf16_f32 v18, v28, v29
    v_mul_f32 v30, v30, v25
    v_mul_f32 v31, v31, v25
    v_cvt_pk_bf16_f32 v19, v30, v31
    v_mul_f32 v20, v20, v25
    v_mul_f32 v21, v21, v25
    v_cvt_pk_bf16_f32 v128, v20, v21
    v_mul_f32 v22, v22, v25
    v_mul_f32 v23, v23, v25
    v_cvt_pk_bf16_f32 v129, v22, v23
    buffer_store_dwordx4 v[12:15], v126, s[28:31], s58 offen sc1
    ds_write_b128 v112, v[16:19] offset:1536
    ds_write_b64 v132, v[128:129] offset:1536
    buffer_store_dwordx4 v[4:7], v125, s[28:31], s58 offen sc1
    s_waitcnt lgkmcnt(0)
    s_barrier
    buffer_store_dwordx4 v[0:3], v124, s[28:31], s58 offen sc1
    ds_read_b128 v[12:15], v131 offset:0
    ds_read_b128 v[4:7], v131 offset:1024
    ds_read_b128 v[0:3], v131 offset:2048
    s_waitcnt lgkmcnt(2)
    buffer_store_dwordx4 v[12:15], v8, s[28:31], 0 offen sc1
    s_waitcnt lgkmcnt(0)
    buffer_store_dwordx4 v[4:7], v9, s[28:31], 0 offen sc1
    buffer_store_dwordx4 v[0:3], v10, s[28:31], 0 offen sc1
    s_endpgm
L_bndF:
    s_movk_i32 s73, 24
    s_sub_u32 s70, s70, 20
    s_cmp_lt_u32 s2, 247
    s_cbranch_scc1 L_bndrF
    s_movk_i32 s73, 20
    s_movk_i32 s71, 18
    s_movk_i32 s70, -20
    s_mov_b32 s74, 0
    s_cmp_lt_u32 s2, 251
    s_cbranch_scc1 L_bndcF
    s_sub_u32 s94, s2, 251
    s_mul_i32 s69, s94, 18
    s_mov_b32 s74, 25239312
    s_sub_u32 s93, s93, 1373568
    v_cmp_le_u32 vcc, 4, v89
    v_add_u32 v66, 98896896, v128
    v_subrev_u32 v67, 1373568, v128
    v_cndmask_b32 v128, v66, v67, vcc
    v_cmp_le_u32 vcc, 4, v4
    v_add_u32 v66, 98896896, v127
    v_subrev_u32 v67, 1373568, v127
    v_cndmask_b32 v127, v66, v67, vcc
    v_cmp_le_u32 vcc, 4, v27
    v_add_u32 v66, 98896896, v126
    v_subrev_u32 v67, 1373568, v126
    v_cndmask_b32 v126, v66, v67, vcc
    v_cmp_le_u32 vcc, 4, v0
    v_add_u32 v66, 98896896, v125
    v_subrev_u32 v67, 1373568, v125
    v_cndmask_b32 v125, v66, v67, vcc
    v_cmp_le_u32 vcc, 4, v18
    v_add_u32 v66, 98896896, v124
    v_subrev_u32 v67, 1373568, v124
    v_cndmask_b32 v124, v66, v67, vcc
    s_cmp_lt_u32 s2, 255
    s_cbranch_scc1 L_bndrF
L_bndcF:
    s_sub_u32 s94, s2, 247
    s_mul_i32 s69, s94, 18
    s_mov_b32 s62, 1373568
    s_add_u32 s74, s74, 345744
    s_sub_u32 s93, s93, 2688
    v_mad_i32_i24 v66, v89, -7, v64
    v_cmp_le_u32 vcc, 4, v66
    v_add_u32 v66, 193536, v128
    v_subrev_u32 v67, 2688, v128
    v_cndmask_b32 v128, v66, v67, vcc
    v_mad_i32_i24 v66, v4, -7, v16
    v_cmp_le_u32 vcc, 4, v66
    v_add_u32 v66, 193536, v127
    v_subrev_u32 v67, 2688, v127
    v_cndmask_b32 v127, v66, v67, vcc
    v_mad_i32_i24 v66, v27, -7, v26
    v_cmp_le_u32 vcc, 4, v66
    v_add_u32 v66, 193536, v126
    v_subrev_u32 v67, 2688, v126
    v_cndmask_b32 v126, v66, v67, vcc
    v_mad_i32_i24 v66, v0, -7, v88
    v_cmp_le_u32 vcc, 4, v66
    v_add_u32 v66, 193536, v125
    v_subrev_u32 v67, 2688, v125
    v_cndmask_b32 v125, v66, v67, vcc
    v_mad_i32_i24 v66, v18, -7, v8
    v_cmp_le_u32 vcc, 4, v66
    v_add_u32 v66, 193536, v124
    v_subrev_u32 v67, 2688, v124
    v_cndmask_b32 v124, v66, v67, vcc
    s_cmp_eq_u32 s2, 255
    s_cselect_b32 s62, 0, s62
    s_cselect_b32 s69, 0, s69
    s_cselect_b32 s71, 2, s71
    s_branch L_bndrF
L_maskF:
    s_add_u32 s20, s20, s74
    s_addc_u32 s21, s21, 0
    s_mov_b32 s22, 4802
    s_mov_b32 s23, 0x20000
    s_mov_b32 s85, 0x3fb8aa3b
    s_waitcnt vmcnt(0)
    v_lshrrev_b32 v154, 2, v51
    v_add_u32 v154, 0, v154
    v_mul_u32_u24 v154, 98, v154
    v_mad_u32_u24 v155, v9, 24, v154
    buffer_load_ushort v81, v155, s[20:23], 0 offen offset:0
    buffer_load_ushort v144, v155, s[20:23], 0 offen offset:2
    buffer_load_ushort v31, v155, s[20:23], 0 offen offset:4
    buffer_load_ushort v142, v155, s[20:23], 0 offen offset:6
    buffer_load_ushort v0, v155, s[20:23], 0 offen offset:8
    buffer_load_ushort v43, v155, s[20:23], 0 offen offset:10
    buffer_load_ushort v30, v155, s[20:23], 0 offen offset:12
    buffer_load_ushort v96, v155, s[20:23], 0 offen offset:14
    buffer_load_ushort v49, v155, s[20:23], 0 offen offset:16
    buffer_load_ushort v143, v155, s[20:23], 0 offen offset:18
    buffer_load_ushort v145, v155, s[20:23], 0 offen offset:20
    buffer_load_ushort v42, v155, s[20:23], 0 offen offset:22
    buffer_load_ushort v138, v154, s[20:23], 0 offen offset:96
    s_waitcnt vmcnt(0)
    v_lshlrev_b32 v81, 16, v81
    v_fmac_f32 v204, s85, v81
    v_lshlrev_b32 v144, 16, v144
    v_fmac_f32 v205, s85, v144
    v_lshlrev_b32 v31, 16, v31
    v_fmac_f32 v206, s85, v31
    v_lshlrev_b32 v142, 16, v142
    v_fmac_f32 v207, s85, v142
    v_lshlrev_b32 v0, 16, v0
    v_fmac_f32 v200, s85, v0
    v_lshlrev_b32 v43, 16, v43
    v_fmac_f32 v201, s85, v43
    v_lshlrev_b32 v30, 16, v30
    v_fmac_f32 v202, s85, v30
    v_lshlrev_b32 v96, 16, v96
    v_fmac_f32 v203, s85, v96
    v_lshlrev_b32 v49, 16, v49
    v_fmac_f32 v196, s85, v49
    v_lshlrev_b32 v143, 16, v143
    v_fmac_f32 v197, s85, v143
    v_lshlrev_b32 v145, 16, v145
    v_fmac_f32 v198, s85, v145
    v_lshlrev_b32 v42, 16, v42
    v_fmac_f32 v199, s85, v42
    v_lshlrev_b32 v138, 16, v138
    v_fmac_f32 v208, s85, v138
    v_lshrrev_b32 v154, 2, v51
    v_add_u32 v154, 4, v154
    v_mul_u32_u24 v154, 98, v154
    v_mad_u32_u24 v155, v9, 24, v154
    buffer_load_ushort v81, v155, s[20:23], 0 offen offset:0
    buffer_load_ushort v144, v155, s[20:23], 0 offen offset:2
    buffer_load_ushort v31, v155, s[20:23], 0 offen offset:4
    buffer_load_ushort v142, v155, s[20:23], 0 offen offset:6
    buffer_load_ushort v0, v155, s[20:23], 0 offen offset:8
    buffer_load_ushort v43, v155, s[20:23], 0 offen offset:10
    buffer_load_ushort v30, v155, s[20:23], 0 offen offset:12
    buffer_load_ushort v96, v155, s[20:23], 0 offen offset:14
    buffer_load_ushort v49, v155, s[20:23], 0 offen offset:16
    buffer_load_ushort v143, v155, s[20:23], 0 offen offset:18
    buffer_load_ushort v145, v155, s[20:23], 0 offen offset:20
    buffer_load_ushort v42, v155, s[20:23], 0 offen offset:22
    buffer_load_ushort v138, v154, s[20:23], 0 offen offset:96
    s_waitcnt vmcnt(0)
    v_lshlrev_b32 v81, 16, v81
    v_fmac_f32 v192, s85, v81
    v_lshlrev_b32 v144, 16, v144
    v_fmac_f32 v193, s85, v144
    v_lshlrev_b32 v31, 16, v31
    v_fmac_f32 v194, s85, v31
    v_lshlrev_b32 v142, 16, v142
    v_fmac_f32 v195, s85, v142
    v_lshlrev_b32 v0, 16, v0
    v_fmac_f32 v188, s85, v0
    v_lshlrev_b32 v43, 16, v43
    v_fmac_f32 v189, s85, v43
    v_lshlrev_b32 v30, 16, v30
    v_fmac_f32 v190, s85, v30
    v_lshlrev_b32 v96, 16, v96
    v_fmac_f32 v191, s85, v96
    v_lshlrev_b32 v49, 16, v49
    v_fmac_f32 v184, s85, v49
    v_lshlrev_b32 v143, 16, v143
    v_fmac_f32 v185, s85, v143
    v_lshlrev_b32 v145, 16, v145
    v_fmac_f32 v186, s85, v145
    v_lshlrev_b32 v42, 16, v42
    v_fmac_f32 v187, s85, v42
    v_lshlrev_b32 v138, 16, v138
    v_fmac_f32 v209, s85, v138
    v_lshrrev_b32 v154, 2, v51
    v_add_u32 v154, 8, v154
    v_mul_u32_u24 v154, 98, v154
    v_mad_u32_u24 v155, v9, 24, v154
    buffer_load_ushort v81, v155, s[20:23], 0 offen offset:0
    buffer_load_ushort v144, v155, s[20:23], 0 offen offset:2
    buffer_load_ushort v31, v155, s[20:23], 0 offen offset:4
    buffer_load_ushort v142, v155, s[20:23], 0 offen offset:6
    buffer_load_ushort v0, v155, s[20:23], 0 offen offset:8
    buffer_load_ushort v43, v155, s[20:23], 0 offen offset:10
    buffer_load_ushort v30, v155, s[20:23], 0 offen offset:12
    buffer_load_ushort v96, v155, s[20:23], 0 offen offset:14
    buffer_load_ushort v49, v155, s[20:23], 0 offen offset:16
    buffer_load_ushort v143, v155, s[20:23], 0 offen offset:18
    buffer_load_ushort v145, v155, s[20:23], 0 offen offset:20
    buffer_load_ushort v42, v155, s[20:23], 0 offen offset:22
    buffer_load_ushort v138, v154, s[20:23], 0 offen offset:96
    s_waitcnt vmcnt(0)
    v_lshlrev_b32 v81, 16, v81
    v_fmac_f32 v180, s85, v81
    v_lshlrev_b32 v144, 16, v144
    v_fmac_f32 v181, s85, v144
    v_lshlrev_b32 v31, 16, v31
    v_fmac_f32 v182, s85, v31
    v_lshlrev_b32 v142, 16, v142
    v_fmac_f32 v183, s85, v142
    v_lshlrev_b32 v0, 16, v0
    v_fmac_f32 v176, s85, v0
    v_lshlrev_b32 v43, 16, v43
    v_fmac_f32 v177, s85, v43
    v_lshlrev_b32 v30, 16, v30
    v_fmac_f32 v178, s85, v30
    v_lshlrev_b32 v96, 16, v96
    v_fmac_f32 v179, s85, v96
    v_lshlrev_b32 v49, 16, v49
    v_fmac_f32 v172, s85, v49
    v_lshlrev_b32 v143, 16, v143
    v_fmac_f32 v173, s85, v143
    v_lshlrev_b32 v145, 16, v145
    v_fmac_f32 v174, s85, v145
    v_lshlrev_b32 v42, 16, v42
    v_fmac_f32 v175, s85, v42
    v_lshlrev_b32 v138, 16, v138
    v_fmac_f32 v210, s85, v138
    v_lshrrev_b32 v154, 2, v51
    v_lshl_add_u32 v154, v9, 2, v154
    v_cmp_gt_u32 vcc, 3, v9
    v_mov_b32 v155, 48
    s_nop 1
    v_cndmask_b32 v154, v155, v154, vcc
    v_add_u32 v154, 2352, v154
    v_lshlrev_b32 v154, 1, v154
    buffer_load_ushort v81, v154, s[20:23], 0 offen
    s_waitcnt vmcnt(0)
    v_lshlrev_b32 v81, 16, v81
    v_fmac_f32 v211, s85, v81
    s_branch L_nomaskF
L_bndS:
    s_movk_i32 s73, 24
    s_sub_u32 s70, s70, 20
    s_cmp_lt_u32 s2, 247
    s_cbranch_scc1 L_bndrS
    s_movk_i32 s73, 20
    s_movk_i32 s71, 18
    s_movk_i32 s70, -20
    s_mov_b32 s74, 0
    s_cmp_lt_u32 s2, 251
    s_cbranch_scc1 L_bndcS
    s_sub_u32 s94, s2, 251
    s_mul_i32 s69, s94, 18
    s_mov_b32 s74, 25239312
    s_sub_u32 s93, s93, 1373568
    v_cmp_le_u32 vcc, 4, v11
    v_add_u32 v26, 98896896, v128
    v_subrev_u32 v27, 1373568, v128
    v_cndmask_b32 v128, v26, v27, vcc
    v_cmp_le_u32 vcc, 4, v6
    v_add_u32 v26, 98896896, v127
    v_subrev_u32 v27, 1373568, v127
    v_cndmask_b32 v127, v26, v27, vcc
    v_cmp_le_u32 vcc, 4, v18
    v_add_u32 v26, 98896896, v126
    v_subrev_u32 v27, 1373568, v126
    v_cndmask_b32 v126, v26, v27, vcc
    v_cmp_le_u32 vcc, 4, v4
    v_add_u32 v26, 98896896, v125
    v_subrev_u32 v27, 1373568, v125
    v_cndmask_b32 v125, v26, v27, vcc
    v_cmp_le_u32 vcc, 4, v7
    v_add_u32 v26, 98896896, v124
    v_subrev_u32 v27, 1373568, v124
    v_cndmask_b32 v124, v26, v27, vcc
    s_cmp_lt_u32 s2, 255
    s_cbranch_scc1 L_bndrS
L_bndcS:
    s_sub_u32 s94, s2, 247
    s_mul_i32 s69, s94, 18
    s_mov_b32 s62, 1373568
    s_add_u32 s74, s74, 345744
    s_sub_u32 s93, s93, 2688
    v_mad_i32_i24 v26, v11, -7, v129
    v_cmp_le_u32 vcc, 4, v26
    v_add_u32 v26, 193536, v128
    v_subrev_u32 v27, 2688, v128
    v_cndmask_b32 v128, v26, v27, vcc
    v_mad_i32_i24 v26, v6, -7, v31
    v_cmp_le_u32 vcc, 4, v26
    v_add_u32 v26, 193536, v127
    v_subrev_u32 v27, 2688, v127
    v_cndmask_b32 v127, v26, v27, vcc
    v_mad_i32_i24 v26, v18, -7, v163
    v_cmp_le_u32 vcc, 4, v26
    v_add_u32 v26, 193536, v126
    v_subrev_u32 v27, 2688, v126
    v_cndmask_b32 v126, v26, v27, vcc
    v_mad_i32_i24 v26, v4, -7, v25
    v_cmp_le_u32 vcc, 4, v26
    v_add_u32 v26, 193536, v125
    v_subrev_u32 v27, 2688, v125
    v_cndmask_b32 v125, v26, v27, vcc
    v_mad_i32_i24 v26, v7, -7, v156
    v_cmp_le_u32 vcc, 4, v26
    v_add_u32 v26, 193536, v124
    v_subrev_u32 v27, 2688, v124
    v_cndmask_b32 v124, v26, v27, vcc
    s_cmp_eq_u32 s2, 255
    s_cselect_b32 s62, 0, s62
    s_cselect_b32 s69, 0, s69
    s_cselect_b32 s71, 2, s71
    s_branch L_bndrS
L_maskS:
    s_add_u32 s20, s20, s74
    s_addc_u32 s21, s21, 0
    s_mov_b32 s22, 4802
    s_mov_b32 s23, 0x20000
    s_mov_b32 s85, 0x3fb8aa3b
    s_waitcnt vmcnt(0)
    v_lshrrev_b32 v160, 2, v76
    v_add_u32 v160, 0, v160
    v_mul_u32_u24 v160, 98, v160
    v_mad_u32_u24 v161, v5, 24, v160
    buffer_load_ushort v79, v161, s[20:23], 0 offen offset:0
    buffer_load_ushort v3, v161, s[20:23], 0 offen offset:2
    buffer_load_ushort v2, v161, s[20:23], 0 offen offset:4
    buffer_load_ushort v1, v161, s[20:23], 0 offen offset:6
    buffer_load_ushort v4, v161, s[20:23], 0 offen offset:8
    buffer_load_ushort v166, v161, s[20:23], 0 offen offset:10
    buffer_load_ushort v164, v161, s[20:23], 0 offen offset:12
    buffer_load_ushort v162, v161, s[20:23], 0 offen offset:14
    buffer_load_ushort v165, v161, s[20:23], 0 offen offset:16
    buffer_load_ushort v0, v161, s[20:23], 0 offen offset:18
    buffer_load_ushort v158, v161, s[20:23], 0 offen offset:20
    buffer_load_ushort v77, v161, s[20:23], 0 offen offset:22
    buffer_load_ushort v157, v160, s[20:23], 0 offen offset:96
    s_waitcnt vmcnt(0)
    v_lshlrev_b32 v79, 16, v79
    v_fmac_f32 v204, s85, v79
    v_lshlrev_b32 v3, 16, v3
    v_fmac_f32 v205, s85, v3
    v_lshlrev_b32 v2, 16, v2
    v_fmac_f32 v206, s85, v2
    v_lshlrev_b32 v1, 16, v1
    v_fmac_f32 v207, s85, v1
    v_lshlrev_b32 v4, 16, v4
    v_fmac_f32 v200, s85, v4
    v_lshlrev_b32 v166, 16, v166
    v_fmac_f32 v201, s85, v166
    v_lshlrev_b32 v164, 16, v164
    v_fmac_f32 v202, s85, v164
    v_lshlrev_b32 v162, 16, v162
    v_fmac_f32 v203, s85, v162
    v_lshlrev_b32 v165, 16, v165
    v_fmac_f32 v196, s85, v165
    v_lshlrev_b32 v0, 16, v0
    v_fmac_f32 v197, s85, v0
    v_lshlrev_b32 v158, 16, v158
    v_fmac_f32 v198, s85, v158
    v_lshlrev_b32 v77, 16, v77
    v_fmac_f32 v199, s85, v77
    v_lshlrev_b32 v157, 16, v157
    v_fmac_f32 v208, s85, v157
    v_lshrrev_b32 v160, 2, v76
    v_add_u32 v160, 4, v160
    v_mul_u32_u24 v160, 98, v160
    v_mad_u32_u24 v161, v5, 24, v160
    buffer_load_ushort v79, v161, s[20:23], 0 offen offset:0
    buffer_load_ushort v3, v161, s[20:23], 0 offen offset:2
    buffer_load_ushort v2, v161, s[20:23], 0 offen offset:4
    buffer_load_ushort v1, v161, s[20:23], 0 offen offset:6
    buffer_load_ushort v4, v161, s[20:23], 0 offen offset:8
    buffer_load_ushort v166, v161, s[20:23], 0 offen offset:10
    buffer_load_ushort v164, v161, s[20:23], 0 offen offset:12
    buffer_load_ushort v162, v161, s[20:23], 0 offen offset:14
    buffer_load_ushort v165, v161, s[20:23], 0 offen offset:16
    buffer_load_ushort v0, v161, s[20:23], 0 offen offset:18
    buffer_load_ushort v158, v161, s[20:23], 0 offen offset:20
    buffer_load_ushort v77, v161, s[20:23], 0 offen offset:22
    buffer_load_ushort v157, v160, s[20:23], 0 offen offset:96
    s_waitcnt vmcnt(0)
    v_lshlrev_b32 v79, 16, v79
    v_fmac_f32 v192, s85, v79
    v_lshlrev_b32 v3, 16, v3
    v_fmac_f32 v193, s85, v3
    v_lshlrev_b32 v2, 16, v2
    v_fmac_f32 v194, s85, v2
    v_lshlrev_b32 v1, 16, v1
    v_fmac_f32 v195, s85, v1
    v_lshlrev_b32 v4, 16, v4
    v_fmac_f32 v188, s85, v4
    v_lshlrev_b32 v166, 16, v166
    v_fmac_f32 v189, s85, v166
    v_lshlrev_b32 v164, 16, v164
    v_fmac_f32 v190, s85, v164
    v_lshlrev_b32 v162, 16, v162
    v_fmac_f32 v191, s85, v162
    v_lshlrev_b32 v165, 16, v165
    v_fmac_f32 v184, s85, v165
    v_lshlrev_b32 v0, 16, v0
    v_fmac_f32 v185, s85, v0
    v_lshlrev_b32 v158, 16, v158
    v_fmac_f32 v186, s85, v158
    v_lshlrev_b32 v77, 16, v77
    v_fmac_f32 v187, s85, v77
    v_lshlrev_b32 v157, 16, v157
    v_fmac_f32 v209, s85, v157
    v_lshrrev_b32 v160, 2, v76
    v_add_u32 v160, 8, v160
    v_mul_u32_u24 v160, 98, v160
    v_mad_u32_u24 v161, v5, 24, v160
    buffer_load_ushort v79, v161, s[20:23], 0 offen offset:0
    buffer_load_ushort v3, v161, s[20:23], 0 offen offset:2
    buffer_load_ushort v2, v161, s[20:23], 0 offen offset:4
    buffer_load_ushort v1, v161, s[20:23], 0 offen offset:6
    buffer_load_ushort v4, v161, s[20:23], 0 offen offset:8
    buffer_load_ushort v166, v161, s[20:23], 0 offen offset:10
    buffer_load_ushort v164, v161, s[20:23], 0 offen offset:12
    buffer_load_ushort v162, v161, s[20:23], 0 offen offset:14
    buffer_load_ushort v165, v161, s[20:23], 0 offen offset:16
    buffer_load_ushort v0, v161, s[20:23], 0 offen offset:18
    buffer_load_ushort v158, v161, s[20:23], 0 offen offset:20
    buffer_load_ushort v77, v161, s[20:23], 0 offen offset:22
    buffer_load_ushort v157, v160, s[20:23], 0 offen offset:96
    s_waitcnt vmcnt(0)
    v_lshlrev_b32 v79, 16, v79
    v_fmac_f32 v180, s85, v79
    v_lshlrev_b32 v3, 16, v3
    v_fmac_f32 v181, s85, v3
    v_lshlrev_b32 v2, 16, v2
    v_fmac_f32 v182, s85, v2
    v_lshlrev_b32 v1, 16, v1
    v_fmac_f32 v183, s85, v1
    v_lshlrev_b32 v4, 16, v4
    v_fmac_f32 v176, s85, v4
    v_lshlrev_b32 v166, 16, v166
    v_fmac_f32 v177, s85, v166
    v_lshlrev_b32 v164, 16, v164
    v_fmac_f32 v178, s85, v164
    v_lshlrev_b32 v162, 16, v162
    v_fmac_f32 v179, s85, v162
    v_lshlrev_b32 v165, 16, v165
    v_fmac_f32 v172, s85, v165
    v_lshlrev_b32 v0, 16, v0
    v_fmac_f32 v173, s85, v0
    v_lshlrev_b32 v158, 16, v158
    v_fmac_f32 v174, s85, v158
    v_lshlrev_b32 v77, 16, v77
    v_fmac_f32 v175, s85, v77
    v_lshlrev_b32 v157, 16, v157
    v_fmac_f32 v210, s85, v157
    v_lshrrev_b32 v160, 2, v76
    v_lshl_add_u32 v160, v5, 2, v160
    v_cmp_gt_u32 vcc, 3, v5
    v_mov_b32 v161, 48
    s_nop 1
    v_cndmask_b32 v160, v161, v160, vcc
    v_add_u32 v160, 2352, v160
    v_lshlrev_b32 v160, 1, v160
    buffer_load_ushort v79, v160, s[20:23], 0 offen
    s_waitcnt vmcnt(0)
    v_lshlrev_b32 v79, 16, v79
    v_fmac_f32 v211, s85, v79
    s_branch L_nomaskS
L_atomS0:
    v_mov_b32 v122, 0x800000
    buffer_atomic_add v122, v129, s[8:11], 0 offen sc0 sc1
    s_branch L_atomrS0
.section .rodata,"a"
.p2align 6
.amdhsa_kernel standalone__window_attn_swin_v2__vision_kernel
  .amdhsa_next_free_vgpr 512
  .amdhsa_next_free_sgpr 102
  .amdhsa_accum_offset 256
  .amdhsa_group_segment_fixed_size 0
  .amdhsa_kernarg_size 96
  .amdhsa_user_sgpr_count 2
  .amdhsa_user_sgpr_kernarg_segment_ptr 1
  .amdhsa_system_sgpr_workgroup_id_x 1
.end_amdhsa_kernel
```

```asm
; @launch grid=(256,1,1) block=(256,1,1) lds=163840
.amdgcn_target "amdgcn-amd-amdhsa--gfx950"
.text
.globl standalone__window_attn_swin_v2__vision_kernel
.p2align 8
.type standalone__window_attn_swin_v2__vision_kernel,@function
standalone__window_attn_swin_v2__vision_kernel:
    v_lshrrev_b32 v0, 6, v0
    s_cmp_ge_u32 s2, 256
    s_cbranch_scc1 L_end
    v_readfirstlane_b32 s68, v0
    s_mov_b32 s64, 0
    s_nop 0
    v_mbcnt_lo_u32_b32 v2, -1, 0
    v_mbcnt_hi_u32_b32 v2, -1, v2
    s_load_dwordx16 s[4:19], s[0:1], 0
    s_load_dwordx4 s[20:23], s[0:1], 64
    s_load_dwordx2 s[38:39], s[0:1], 80
    s_lshr_b32 s88, s2, 3
    s_lshl2_add_u32 s88, s88, s68
    v_lshlrev_b32 v0, 7, v2
    s_getpc_b64 s[80:81]
    s_mul_i32 s84, s88, 288
    v_min_u32 v1, 256, v0
    v_add_u32 v1, s84, v1
    v_min_u32 v1, L_slow-standalone__window_attn_swin_v2__vision_kernel-256, v1
    s_mul_i32 s89, s88, 576
    s_mul_i32 s88, s88, 1728
    global_load_dword a255, v1, s[80:81]
    v_min_u32 v8, 1664, v0
    v_min_u32 v4, 512, v0
    s_mov_b32 s34, 221184
    s_mov_b32 s35, 0x20000
    s_mov_b32 s78, 73728
    s_mov_b32 s79, 0x20000
    v_and_b32 v19, 15, v2
    v_lshrrev_b32 v9, 4, v2
    v_lshrrev_b32 v11, 2, v19
    v_and_b32 v10, 3, v19
    s_mul_i32 s87, s68, 192
    v_mad_u32_u24 v7, v19, 12, s87
    v_lshlrev_b32 v39, 1, v19
    v_lshlrev_b32 v6, 1, v11
    v_lshl_add_u32 v6, v9, 5, v6
    s_movk_i32 s86, 384
    s_mov_b32 s26, 100270464
    s_mov_b32 s27, 0x20000
    s_mov_b32 s30, 0
    s_mov_b32 s31, 0x20000
    s_waitcnt lgkmcnt(0)
    s_mov_b32 s24, s4
    s_mov_b32 s25, s5
    s_mov_b32 s32, s6
    s_mov_b32 s33, s7
    s_mov_b32 s76, s8
    s_mov_b32 s77, s9
    buffer_load_dword a254, v8, s[32:35], s88 offen
    buffer_load_dword a253, v4, s[76:79], s89 offen
    s_load_dwordx2 s[82:83], s[10:11], 0
    s_movk_i32 s18, 676
    s_mov_b32 s19, 0x20000
    buffer_load_dwordx3 v[36:38], v7, s[16:19], 0 offen
    s_mul_i32 s96, s68, 288
    s_and_b32 s97, s68, 1
    s_lshl_b32 s97, s97, 2
    s_mov_b32 s98, 193536
    s_mov_b32 s99, 589824
    global_load_ushort v24, v39, s[12:13]
    v_add_u32 v8, s96, v2
    v_mul_u32_u24 v64, 2731, v8
    v_mul_u32_u24 v89, 6242, v8
    v_lshrrev_b32 v64, 16, v64
    v_lshrrev_b32 v89, 20, v89
    s_lshr_b32 s94, s2, 3
    s_mul_i32 s70, s94, 168
    global_load_ushort v25, v39, s[12:13] offset:32
    v_and_or_b32 v5, v64, 3, s97
    v_xor_b32 v5, v8, v5
    v_lshl_add_u32 v128, v5, 4, s99
    v_mad_u32_u24 v128, v89, s98, v128
    v_add_u32 v17, 64, v8
    s_mul_i32 s69, s2, 20
    s_lshl3_add_u32 s69, s94, s69
    global_load_ushort v90, v6, s[14:15] offset:0
    v_mul_u32_u24 v16, 2731, v17
    v_mul_u32_u24 v4, 6242, v17
    v_lshrrev_b32 v16, 16, v16
    v_lshrrev_b32 v4, 20, v4
    v_and_or_b32 v65, v16, 3, s97
    s_add_u32 s70, s70, 140
    s_movk_i32 s62, 2688
    global_load_ushort v39, v6, s[14:15] offset:8
    v_xor_b32 v65, v17, v65
    v_lshl_add_u32 v127, v65, 4, s99
    v_mad_u32_u24 v127, v4, s98, v127
    v_add_u32 v18, 128, v8
    v_mul_u32_u24 v26, 2731, v18
    s_movk_i32 s71, 20
    s_movk_i32 s73, 28
    global_load_ushort v91, v6, s[14:15] offset:16
    v_mul_u32_u24 v27, 6242, v18
    v_lshrrev_b32 v26, 16, v26
    v_lshrrev_b32 v27, 20, v27
    v_and_or_b32 v17, v26, 3, s97
    v_xor_b32 v17, v18, v17
    s_mov_b32 s93, 1769472
    s_mul_i32 s54, s68, 5120
    global_load_ushort v6, v6, s[14:15] offset:24
    v_lshl_add_u32 v126, v17, 4, s99
    v_mad_u32_u24 v126, v27, s98, v126
    v_add_u32 v1, 192, v8
    v_mul_u32_u24 v88, 2731, v1
    v_mul_u32_u24 v0, 6242, v1
    v_lshrrev_b32 v88, 16, v88
    v_lshrrev_b32 v0, 20, v0
    v_and_or_b32 v18, v88, 3, s97
    v_xor_b32 v18, v1, v18
    v_lshl_add_u32 v125, v18, 4, s99
    v_mad_u32_u24 v125, v0, s98, v125
    v_add_u32 v1, 256, v8
    v_mul_u32_u24 v8, 2731, v1
    v_mul_u32_u24 v18, 6242, v1
    v_lshrrev_b32 v8, 16, v8
    v_lshrrev_b32 v18, 20, v18
    v_and_or_b32 v124, v8, 3, s97
    v_xor_b32 v124, v1, v124
    v_lshl_add_u32 v124, v124, 4, s99
    v_mad_u32_u24 v124, v18, s98, v124
    s_cmp_ge_u32 s2, 240
    s_cbranch_scc1 L_bndF
L_bndrF:
    s_mov_b32 s63, 1180032
    s_mul_i32 s94, s69, 58255
    s_lshr_b32 s94, s94, 22
    s_mul_i32 s94, s94, s63
    s_mul_i32 s72, s69, s62
    s_add_u32 s72, s72, s94
    v_lshl_or_b32 v18, v2, 4, 2.0
    s_sub_u32 s94, s73, 1
    s_max_u32 s94, s94, 20
    s_mul_i32 s95, s68, -44
    s_movk_i32 s99, -24
    s_add_u32 m0, s54, 0
    v_and_b32 v8, -4, v26
    s_mul_i32 s85, s68, 96
    s_sub_u32 s100, s85, 1024
    buffer_load_dwordx4 v128, s[24:27], s72 offen nt lds
    s_add_u32 m0, s54, 1024
    v_mad_u32_u24 v4, v8, 3, v26
    v_add_u32 v4, s95, v4
    v_mad_i32_i24 v66, v26, s99, v17
    v_med3_u32 v8, v4, 20, s94
    v_add_u32 v8, s70, v8
    v_add_u32 v17, s69, v4
    s_sub_u32 s87, s85, 2048
    s_movk_i32 s91, 1152
    buffer_load_dwordx4 v127, s[24:27], s72 offen nt lds
    v_cmp_gt_u32 vcc, s71, v4
    v_lshl_add_u32 v66, v66, 4, s93
    s_add_u32 m0, s54, 43008
    v_cndmask_b32 v17, v8, v17, vcc
    v_mul_u32_u24 v8, 58255, v17
    v_mad_u32_u24 v66, v17, s62, v66
    v_lshrrev_b32 v8, 22, v8
    v_mad_u32_u24 v66, v8, s63, v66
    s_mul_i32 s90, s68, 3072
    s_add_u32 s90, s90, 61440
    buffer_load_dwordx4 v66, s[24:27], 0 offen  lds
    v_lshlrev_b32 v67, 16, v4
    s_add_u32 m0, s54, 2048
    v_and_b32 v8, -4, v16
    v_mad_u32_u24 v4, v8, 3, v16
    v_add_u32 v4, s95, v4
    v_mad_i32_i24 v65, v16, s99, v65
    v_med3_u32 v8, v4, 20, s94
    s_add_u32 s101, s54, 44032
    s_mov_b32 s28, s22
    buffer_load_dwordx4 v126, s[24:27], s72 offen nt lds
    v_add_u32 v8, s70, v8
    v_add_u32 v16, s69, v4
    v_cmp_gt_u32 vcc, s71, v4
    v_lshl_add_u32 v65, v65, 4, s93
    s_add_u32 m0, s54, 41984
    v_cndmask_b32 v16, v8, v16, vcc
    v_mul_u32_u24 v8, 58255, v16
    v_mad_u32_u24 v65, v16, s62, v65
    v_lshrrev_b32 v8, 22, v8
    v_mad_u32_u24 v65, v8, s63, v65
    s_mov_b32 s29, s23
    s_mov_b32 s41, 0x2a8cbccc
    buffer_load_dwordx4 v65, s[24:27], 0 offen  lds
    v_lshl_or_b32 v67, v4, 8, v67
    s_add_u32 m0, s54, 3072
    v_cmp_gt_u32 vcc, 32, v2
    v_and_b32 v4, -4, v64
    v_mad_u32_u24 v8, v4, 3, v64
    v_cndmask_b32 v124, v18, v124, vcc
    v_add_u32 v8, s95, v8
    s_mov_b32 s42, 0x38fba882
    s_mov_b32 s43, 0x415db3d7
    buffer_load_dwordx4 v125, s[24:27], s72 offen nt lds
    s_add_u32 m0, s54, 4096
    v_mad_i32_i24 v64, v64, s99, v5
    v_med3_u32 v4, v8, 20, s94
    v_add_u32 v4, s70, v4
    v_add_u32 v5, s69, v8
    v_cmp_gt_u32 vcc, s71, v8
    v_lshl_add_u32 v64, v64, 4, s93
    s_mul_i32 s93, s68, 6
    s_lshl_b32 s94, s97, 1
    buffer_load_dwordx4 v124, s[24:27], s72 offen nt lds
    v_cndmask_b32 v5, v4, v5, vcc
    v_mul_u32_u24 v4, 58255, v5
    v_mad_u32_u24 v64, v5, s62, v64
    v_lshrrev_b32 v4, 22, v4
    v_mad_u32_u24 v64, v4, s63, v64
    s_add_u32 m0, s54, 40960
    v_lshl_or_b32 v67, v8, 0, v67
    s_mov_b32 s44, 61440
    s_mov_b32 s45, 40960
    buffer_load_dwordx4 v64, s[24:27], 0 offen nt lds
    v_mul_u32_u24 v4, 10923, v2
    v_lshrrev_b32 v83, 17, v4
    v_lshrrev_b32 v4, 16, v4
    v_mad_i32_i24 v27, v4, -6, v2
    v_bitop3_b32 v83, v83, v4, 4 bitop3:0x28
    v_lshl_add_u32 v27, v27, 4, s85
    v_mul_u32_u24 v83, 3, v83
    v_xor_b32 v4, v4, v83
    v_mad_u32_u24 v83, v4, s91, v27
    v_add_u32 v5, 64, v2
    v_mul_u32_u24 v26, 10923, v5
    v_lshrrev_b32 v97, 17, v26
    v_lshrrev_b32 v26, 16, v26
    v_mad_i32_i24 v5, v26, -6, v5
    v_bitop3_b32 v97, v97, v26, 4 bitop3:0x28
    v_lshl_add_u32 v5, v5, 4, s100
    v_mul_u32_u24 v97, 3, v97
    v_xor_b32 v26, v26, v97
    v_mad_u32_u24 v97, v26, s91, v5
    v_add_u32 v17, 128, v2
    v_mul_u32_u24 v16, 10923, v17
    v_lshrrev_b32 v8, 17, v16
    v_lshrrev_b32 v16, 16, v16
    v_mad_i32_i24 v17, v16, -6, v17
    v_bitop3_b32 v8, v8, v16, 4 bitop3:0x28
    v_lshl_add_u32 v17, v17, 4, s87
    v_mul_u32_u24 v8, 3, v8
    v_xor_b32 v16, v16, v8
    v_mad_u32_u24 v8, v16, s91, v17
    v_mad_u32_u24 v4, v4, s86, v27
    v_mad_u32_u24 v166, v26, s86, v5
    v_mad_u32_u24 v28, v16, s86, v17
    s_add_u32 m0, s90, 0
    s_mov_b32 s92, 0
    buffer_load_dwordx4 v83, s[32:35], s92 offen offset:0 lds
    v_lshrrev_b32 v16, 1, v9
    v_lshl_add_u32 v5, v9, 2, v11
    v_lshl_add_u32 v5, v16, 3, v5
    v_mul_u32_u24 v5, 96, v5
    v_add_u32 v5, s90, v5
    v_lshl_add_u32 v139, v10, 4, v5
    v_lshl_add_u32 v17, v10, 3, v5
    v_mov_b32 v5, 0x3f803f80
    v_cmp_eq_u32 vcc, 0, v10
    v_and_b32 v16, 1, v2
    v_lshlrev_b32 v16, 4, v16
    v_cndmask_b32 v220, 0, v5, vcc
    v_cndmask_b32 v221, 0, v5, vcc
    v_cndmask_b32 v222, 0, v5, vcc
    v_cndmask_b32 v223, 0, v5, vcc
    v_mov_b32 v5, 0x3f80
    v_lshlrev_b32 v219, v16, v5
    v_cmp_gt_u32 vcc, 2, v10
    v_mov_b32 v16, 0x44004400
    v_mul_u32_u24 v51, 48, v11
    v_cndmask_b32 v216, 0, v219, vcc
    v_cndmask_b32 v218, 0, v219, vcc
    v_cmp_le_u32 vcc, 2, v10
    v_lshl_add_u32 v51, v10, 2, v51
    v_mul_u32_u24 v5, 48, v9
    v_cndmask_b32 v217, 0, v219, vcc
    v_cndmask_b32 v219, 0, v219, vcc
    v_cmp_eq_u32 vcc, v9, v11
    v_add_u32 v96, 0, v51
    v_mul_u32_u24 v26, 37, v96
    v_cndmask_b32 v98, 0, v216, vcc
    v_cndmask_b32 v99, 0, v217, vcc
    v_cmp_eq_u32 vcc, 0, v10
    v_lshrrev_b32 v26, 10, v26
    v_mad_u32_u24 v96, v26, 24, v96
    v_cndmask_b32 v212, 0, v16, vcc
    v_cmp_eq_u32 vcc, 1, v10
    v_add_u32 v96, s101, v96
    v_add_u32 v187, 16, v51
    v_cndmask_b32 v213, 0, v16, vcc
    v_cmp_eq_u32 vcc, 2, v10
    v_mul_u32_u24 v215, 37, v187
    v_lshrrev_b32 v215, 10, v215
    v_cndmask_b32 v214, 0, v16, vcc
    v_cmp_eq_u32 vcc, 3, v10
    v_mad_u32_u24 v187, v215, 24, v187
    v_add_u32 v187, s101, v187
    v_cndmask_b32 v215, 0, v16, vcc
    v_add_u32 v175, 32, v51
    v_mul_u32_u24 v16, 37, v175
    v_lshrrev_b32 v16, 10, v16
    v_mad_u32_u24 v175, v16, 24, v175
    v_add_u32 v175, s101, v175
    v_add_u32 v16, 0, v5
    v_mul_u32_u24 v26, 37, v16
    v_lshrrev_b32 v26, 10, v26
    v_mad_u32_u24 v16, v26, 24, v16
    v_add_u32 v1, 4, v5
    v_mul_u32_u24 v0, 37, v1
    v_lshrrev_b32 v0, 10, v0
    v_mad_u32_u24 v1, v0, 24, v1
    v_add_u32 v3, 8, v5
    v_mul_u32_u24 v0, 37, v3
    v_lshrrev_b32 v0, 10, v0
    v_mad_u32_u24 v3, v0, 24, v3
    v_add_u32 v207, 12, v5
    v_mul_u32_u24 v0, 37, v207
    v_lshrrev_b32 v0, 10, v0
    v_mad_u32_u24 v207, v0, 24, v207
    v_add_u32 v0, 16, v5
    v_mul_u32_u24 v26, 37, v0
    v_lshrrev_b32 v26, 10, v26
    v_mad_u32_u24 v0, v26, 24, v0
    v_add_u32 v88, 20, v5
    v_mul_u32_u24 v89, 37, v88
    v_lshrrev_b32 v89, 10, v89
    v_mad_u32_u24 v88, v89, 24, v88
    v_add_u32 v89, 24, v5
    v_mul_u32_u24 v26, 37, v89
    v_lshrrev_b32 v26, 10, v26
    v_mad_u32_u24 v89, v26, 24, v89
    v_add_u32 v203, 28, v5
    v_mul_u32_u24 v26, 37, v203
    v_lshrrev_b32 v26, 10, v26
    v_mad_u32_u24 v203, v26, 24, v203
    v_add_u32 v31, 32, v5
    v_mul_u32_u24 v26, 37, v31
    v_lshrrev_b32 v26, 10, v26
    v_mad_u32_u24 v31, v26, 24, v31
    s_waitcnt lgkmcnt(0)
    s_sext_i32_i16 s84, s82
    s_ashr_i32 s85, s82, 16
    s_max_i32 s84, s84, s85
    s_sext_i32_i16 s85, s83
    s_max_i32 s84, s84, s85
    s_ashr_i32 s85, s83, 16
    s_max_i32 s84, s84, s85
    s_cmp_gt_i32 s84, 16492
    s_cbranch_scc1 L_slow
    s_lshl_b32 s84, s68, 4
    buffer_load_dwordx4 v97, s[32:35], s92 offen offset:1024 lds
    v_add_u32 v30, 36, v5
    v_mul_u32_u24 v29, 37, v30
    v_lshrrev_b32 v29, 10, v29
    v_mad_u32_u24 v30, v29, 24, v30
    v_add_u32 v138, 40, v5
    v_mul_u32_u24 v29, 37, v138
    v_lshrrev_b32 v29, 10, v29
    s_lshr_b64 s[82:83], s[82:83], s84
    s_lshl_b32 s82, s82, 16
    buffer_load_dwordx4 v8, s[32:35], s92 offen offset:2048 lds
    s_add_u32 m0, s90, 12288
    s_mov_b32 s92, 36864
    v_mad_u32_u24 v138, v29, 24, v138
    v_add_u32 v5, 44, v5
    v_mul_u32_u24 v29, 37, v5
    v_lshrrev_b32 v29, 10, v29
    v_mad_u32_u24 v5, v29, 24, v5
    s_mov_b32 s84, 0x41b8aa3b
    s_mov_b32 s46, 20480
    buffer_load_dwordx4 v83, s[32:35], s92 offen offset:0 lds
    v_lshl_add_u32 v120, v9, 4, v51
    v_mul_u32_u24 v29, 37, v120
    v_lshrrev_b32 v29, 10, v29
    v_mad_u32_u24 v120, v29, 24, v120
    v_mov_b32 v26, 336
    v_cmp_gt_u32 vcc, 3, v9
    v_mov_b32 v29, s82
    v_min_f32 v29, 0x40930000, v29
    v_cndmask_b32 v120, v26, v120, vcc
    v_sub_u32 v120, s101, v120
    v_max_f32 v29, 0xc2c80000, v29
    v_mul_f32 v29, 0x3fb8aa3b, v29
    v_exp_f32 v29, v29
    s_waitcnt vmcnt(16)
    v_lshl_or_b32 v24, v25, 16, v24
    s_mov_b32 s47, 0
    s_mov_b32 s57, s72
    buffer_load_dwordx4 v97, s[32:35], s92 offen offset:1024 lds
    v_cvt_pk_bf16_f32 v29, v29, v29
    v_lshlrev_b32 v29, 16, v29
    v_mul_f32 v29, 0x4038aa3b, v29
    s_waitcnt vmcnt(15)
    v_lshl_or_b32 v90, v39, 16, v90
    v_readfirstlane_b32 s55, v29
    v_add_f32 v29, v29, v29
    s_waitcnt vmcnt(13)
    v_lshl_or_b32 v91, v6, 16, v91
    v_readfirstlane_b32 s52, v29
    v_cmp_gt_u32 vcc, 16, v2
    v_mov_b32 v25, 0
    v_mov_b32 v26, 0
    v_cndmask_b32 v27, 0, v24, vcc
    v_cndmask_b32 v24, 0, v24, vcc
    v_mov_b32 v39, 0
    v_mfma_f32_16x16x16_bf16 v[12:15], v[26:27], v[36:37], 0
    s_mov_b32 s58, 0
    v_mul_u32_u24 v6, 5120, v9
    v_add_u32 v6, v7, v6
    v_mfma_f32_16x16x16_bf16 v[20:23], v[24:25], v[36:37], 0
    s_mov_b32 s59, 0
    v_mov_b32 v7, 0xc138aa3b
    v_and_b32 v29, 8, v19
    v_mfma_f32_16x16x16_bf16 v[32:35], v[24:25], v[38:39], 0
    s_mov_b32 s60, 0
    v_max_f32 v12, 0, v12
    v_max_f32 v13, 0, v13
    v_max_f32 v14, 0, v14
    v_max_f32 v20, 0, v20
    v_max_f32 v21, 0, v21
    v_max_f32 v22, 0, v22
    v_max_f32 v23, 0, v23
    v_cvt_pk_bf16_f32 v20, v20, v21
    v_cvt_pk_bf16_f32 v21, v22, v23
    v_max_f32 v15, 0, v15
    v_cvt_pk_bf16_f32 v12, v12, v13
    v_mfma_f32_16x16x16_bf16 v[24:27], v[90:91], v[20:21], 0
    s_mov_b32 s65, -1
    v_cvt_pk_bf16_f32 v13, v14, v15
    v_max_f32 v32, 0, v32
    v_max_f32 v33, 0, v33
    v_mfma_f32_16x16x16_bf16 v[20:23], v[90:91], v[12:13], 0
    s_mov_b32 s61, 1
    v_max_f32 v34, 0, v34
    v_max_f32 v35, 0, v35
    v_cvt_pk_bf16_f32 v32, v32, v33
    v_cvt_pk_bf16_f32 v33, v34, v35
    v_cvt_pk_bf16_f32 v24, v24, v24
    v_lshlrev_b32 v24, 16, v24
    v_mfma_f32_16x16x16_bf16 v[12:15], v[90:91], v[32:33], 0
    s_movk_i32 s4, 112
    v_mul_f32 v24, 0xbfb8aa3b, v24
    v_cvt_pk_bf16_f32 v20, v20, v20
    v_exp_f32 v24, v24
    v_lshlrev_b32 v20, 16, v20
    v_add_f32 v24, 1.0, v24
    v_rcp_f32 v24, v24
    v_mul_f32 v20, 0xbfb8aa3b, v20
    v_cvt_pk_bf16_f32 v24, v24, v24
    v_lshlrev_b32 v24, 16, v24
    v_fma_f32 v24, v24, s84, v7
    s_mov_b32 s5, 0
    s_mov_b32 s6, 0
    ds_write_b32 v6, v24 offset:44032
    v_exp_f32 v20, v20
    v_cvt_pk_bf16_f32 v12, v12, v12
    v_add_f32 v20, 1.0, v20
    v_rcp_f32 v20, v20
    v_lshlrev_b32 v12, 16, v12
    v_cvt_pk_bf16_f32 v20, v20, v20
    v_lshlrev_b32 v20, 16, v20
    v_fma_f32 v20, v20, s84, v7
    s_mov_b32 s12, 0
    s_mov_b32 s64, 3
    ds_write_b32 v6, v20 offset:44036
    v_mul_f32 v12, 0xbfb8aa3b, v12
    v_exp_f32 v12, v12
    v_add_u32 v29, v29, v19
    v_add_f32 v12, 1.0, v12
    v_rcp_f32 v12, v12
    v_mul_u32_u24 v29, 96, v29
    v_cvt_pk_bf16_f32 v12, v12, v12
    v_lshlrev_b32 v12, 16, v12
    v_fma_f32 v12, v12, s84, v7
    s_mov_b32 s10, 81924
    s_mov_b32 s11, 0x20000
    ds_write_b32 v6, v12 offset:44040
    v_add_u32 v29, s90, v29
    v_lshl_add_u32 v91, v9, 4, v29
    v_lshl_add_u32 v90, v9, 3, v29
    v_lshlrev_b32 v121, 4, v9
    v_add_u32 v121, 4608, v121
    v_mul_u32_u24 v131, 5120, v11
    v_mad_u32_u24 v131, v10, s86, v131
    v_and_b32 v29, 7, v19
    v_xor_b32 v122, v29, v9
    v_lshl_add_u32 v7, v122, 4, v131
    v_xor_b32 v6, 64, v7
    v_add_u32 v137, 40960, v7
    v_xor_b32 v136, 64, v137
    v_add_u32 v131, 61440, v131
    v_add_u32 v122, s93, v9
    v_xor_b32 v122, v29, v122
    v_lshl_add_u32 v135, v122, 4, v131
    v_lshrrev_b32 v122, 1, v9
    v_add3_u32 v122, v122, s93, 4
    v_xor_b32 v122, v29, v122
    v_lshl_add_u32 v122, v122, 4, v131
    v_and_b32 v131, 1, v9
    v_lshl_add_u32 v134, v131, 3, v122
    v_lshlrev_b32 v29, 4, v2
    s_add_u32 s93, s54, 20480
    v_add_u32 v133, s93, v29
    v_add_u32 v129, 81920, v29
    s_lshr_b32 s93, s68, 1
    s_lshl_b32 s93, s93, 10
    s_add_u32 s93, s93, s94
    v_add_u32 v130, s93, v129
    s_mul_i32 s93, s68, 7168
    s_add_u32 s93, s93, 135168
    s_waitcnt lgkmcnt(0)
    s_barrier
    ds_read_b32 v209, v187
    v_mul_u32_u24 v131, 1792, v9
    v_add_u32 v122, s93, v131
    v_mul_u32_u24 v131, 112, v19
    v_add_u32 v29, v131, v122
    v_subrev_u32 v29, 28672, v29
    v_cmp_eq_u32 vcc, 0, v11
    v_add_u32 v131, 16, v122
    v_mov_b32 v123, 0
    v_cndmask_b32 v132, v18, v122, vcc
    v_cmp_eq_u32 vcc, 3, v10
    v_mov_b32 v122, 0
    s_mov_b32 s30, 100270464
    buffer_load_dwordx4 v8, s[32:35], s92 offen offset:2048 lds
    s_add_u32 m0, s90, 24576
    s_mov_b32 s92, 73728
    ds_read_b32 v210, v175
    v_cndmask_b32 v132, v132, v131, vcc
    v_mul_u32_u24 v131, 1792, v11
    v_lshl_add_u32 v131, v9, 3, v131
    v_lshl_add_u32 v131, v10, 1, v131
    v_add_u32 v131, s93, v131
    v_cmp_gt_u32 vcc, 3, v9
    s_add_u32 s93, s69, 1
    s_mul_i32 s94, s93, 58255
    ds_read_b32 v208, v96
    v_cndmask_b32 v131, v18, v131, vcc
    s_lshr_b32 s94, s94, 22
    s_mul_i32 s94, s94, s63
    s_mul_i32 s56, s93, s62
    s_add_u32 s56, s56, s94
    s_and_b32 s94, s68, 1
    s_mul_i32 s94, s94, -2304
    s_sub_u32 s93, s71, 1
    s_cmp_eq_u32 s68, 0
    buffer_load_dwordx4 v83, s[32:35], s92 offen offset:0 lds
    s_cselect_b32 s13, s93, -1
    s_cmp_gt_u32 s73, 20
    s_cselect_b32 s13, s13, -1
    s_and_b32 s93, s2, -8
    s_sub_u32 s93, 81920, s93
    s_sub_u32 s8, s38, s93
    s_subb_u32 s9, s39, 0
    s_lshr_b32 s93, s68, 1
    s_mul_i32 s93, s93, 30720
    s_add_u32 s93, s93, s94
    ds_read_b32 v211, v120 offset:672
    buffer_load_dwordx4 v97, s[32:35], s92 offen offset:1024 lds
    v_add_u32 v11, s93, v91
    v_add_u32 v10, s93, v90
    s_lshr_b32 s93, s68, 1
    s_mul_i32 s93, s93, 5120
    s_lshl_b32 s94, s97, 4
    s_add_u32 s93, s93, s94
    v_add_u32 v120, s93, v121
    v_cmp_eq_u32 vcc, 0, v19
    s_mov_b32 s39, 0x00010001
    v_sub_u32 v192, v187, v16
    v_cndmask_b32 v120, v18, v120, vcc
    ds_read_b32 v192, v192 offset:336
    v_sub_u32 v193, v187, v1
    v_sub_u32 v194, v187, v3
    v_sub_u32 v195, v187, v207
    v_sub_u32 v188, v187, v0
    v_sub_u32 v189, v187, v88
    ds_read_b32 v193, v193 offset:336
    v_sub_u32 v190, v187, v89
    buffer_load_dwordx4 v8, s[32:35], s92 offen offset:2048 lds
    s_add_u32 m0, s90, 36864
    s_mov_b32 s92, 110592
    ds_read_b32 v194, v194 offset:336
    v_sub_u32 v191, v187, v203
    v_sub_u32 v184, v187, v31
    v_sub_u32 v185, v187, v30
    v_sub_u32 v186, v187, v138
    v_sub_u32 v187, v187, v5
    s_mov_b64 exec, 0
    s_cmp_eq_u32 s68, 2
    s_cbranch_scc1 L_pga
    s_cmp_eq_u32 s68, 3
    s_cbranch_scc1 L_pg2
    s_cmp_eq_u32 s68, 1
    s_cbranch_scc1 L_pg1
    s_branch L_pg0
.p2align 12
L_main:
    s_mov_b64 exec, -1
    s_waitcnt vmcnt(9)
    s_barrier
    ds_read_b32 v195, v195 offset:336
    v_sub_u32 v180, v175, v16
    v_sub_u32 v181, v175, v1
    v_sub_u32 v182, v175, v3
    v_sub_u32 v183, v175, v207
    v_sub_u32 v176, v175, v0
    ds_read_b32 v188, v188 offset:336
    v_sub_u32 v177, v175, v88
    v_sub_u32 v178, v175, v89
    v_sub_u32 v179, v175, v203
    v_sub_u32 v172, v175, v31
    v_sub_u32 v173, v175, v30
    ds_read_b32 v189, v189 offset:336
    v_sub_u32 v174, v175, v138
    v_sub_u32 v175, v175, v5
    buffer_load_dwordx4 v83, s[32:35], s92 offen offset:0 lds
    ds_read_b32 v190, v190 offset:336
    v_sub_u32 v204, v96, v16
    v_sub_u32 v205, v96, v1
    v_sub_u32 v206, v96, v3
    v_sub_u32 v207, v96, v207
    v_sub_u32 v200, v96, v0
    ds_read_b32 v191, v191 offset:336
    v_sub_u32 v201, v96, v88
    v_sub_u32 v202, v96, v89
    v_sub_u32 v203, v96, v203
    v_sub_u32 v196, v96, v31
    v_sub_u32 v197, v96, v30
    ds_read_b32 v184, v184 offset:336
    buffer_load_dwordx4 v97, s[32:35], s92 offen offset:1024 lds
    v_sub_u32 v198, v96, v138
    v_sub_u32 v199, v96, v5
    ds_read_b32 v185, v185 offset:336
    ds_read_b32 v186, v186 offset:336
    ds_read_b32 v187, v187 offset:336
    buffer_load_dwordx4 v8, s[32:35], s92 offen offset:2048 lds
    s_add_u32 m0, s90, 49152
    s_mov_b32 s92, 147456
    s_waitcnt vmcnt(9)
    ds_read_b64_tr_b16 a[0:1], v17 offset:0
    ds_read_b64_tr_b16 a[2:3], v17 offset:768
    ds_read_b64_tr_b16 a[24:25], v17 offset:32
    ds_read_b64_tr_b16 a[26:27], v17 offset:800
    ds_read_b64_tr_b16 a[48:49], v17 offset:64
    ds_read_b64_tr_b16 a[50:51], v17 offset:832
    ds_read_b128 v[36:39], v7 offset:40960
    ds_read_b128 v[32:35], v7 offset:42496
    buffer_load_dwordx4 v83, s[32:35], s92 offen offset:0 lds
    ds_read_b128 v[24:27], v7 offset:0
    ds_read_b128 v[12:15], v7 offset:1536
    ds_read_b128 v[76:79], v7 offset:3072
    ds_read_b32 v180, v180 offset:336
    buffer_load_dwordx4 v97, s[32:35], s92 offen offset:1024 lds
    ds_read_b32 v181, v181 offset:336
    ds_read_b32 v182, v182 offset:336
    s_waitcnt lgkmcnt(7)
    v_mfma_f32_16x16x32_bf16 v[20:23], a[0:3], v[36:39], 0
    ds_read_b128 v[168:171], v7 offset:41088
    v_mfma_f32_16x16x32_bf16 v[84:87], a[24:27], v[36:39], 0
    ds_read_b128 v[108:111], v7 offset:42624
    v_mfma_f32_16x16x32_bf16 v[72:75], a[48:51], v[36:39], 0
    s_waitcnt vmcnt(8) lgkmcnt(6)
    buffer_load_dwordx4 v8, s[32:35], s92 offen offset:2048 lds
    ds_read_b64_tr_b16 a[4:5], v17 offset:12288
    v_mfma_f32_16x16x32_bf16 v[56:59], a[0:3], v[32:35], 0
    s_add_u32 m0, s90, 61440
    ds_read_b64_tr_b16 a[6:7], v17 offset:13056
    v_mfma_f32_16x16x32_bf16 v[104:107], a[24:27], v[32:35], 0
    s_mov_b32 s92, 184320
    ds_read_b64_tr_b16 a[28:29], v17 offset:12320
    v_mfma_f32_16x16x32_bf16 v[40:43], a[48:51], v[32:35], 0
    ds_read_b64_tr_b16 a[30:31], v17 offset:13088
    v_mfma_f32_16x16x32_bf16 v[30:33], a[0:3], v[24:27], 0
    ds_read_b64_tr_b16 a[52:53], v17 offset:12352
    v_mfma_f32_16x16x32_bf16 v[148:151], a[24:27], v[24:27], 0
    buffer_load_dwordx4 v83, s[32:35], s92 offen offset:0 lds
    ds_read_b64_tr_b16 a[54:55], v17 offset:13120
    v_mfma_f32_16x16x32_bf16 v[100:103], a[48:51], v[24:27], 0
    ds_read_b128 v[144:147], v7 offset:128
    v_mfma_f32_16x16x32_bf16 v[24:27], a[0:3], v[12:15], 0
    ds_read_b128 v[52:55], v7 offset:1664
    v_mfma_f32_16x16x32_bf16 v[44:47], a[24:27], v[12:15], 0
    ds_read_b128 v[68:71], v7 offset:3200
    v_mfma_f32_16x16x32_bf16 v[112:115], a[48:51], v[12:15], 0
    s_waitcnt lgkmcnt(8)
    ds_read_b128 v[116:119], v6 offset:41088
    v_mfma_f32_16x16x32_bf16 v[12:15], a[0:3], v[76:79], 0
    buffer_load_dwordx4 v97, s[32:35], s92 offen offset:1024 lds
    ds_read_b128 v[60:63], v6 offset:42624
    v_mfma_f32_16x16x32_bf16 v[140:143], a[24:27], v[76:79], 0
    ds_read_b128 v[36:39], v6 offset:128
    v_mfma_f32_16x16x32_bf16 v[92:95], a[48:51], v[76:79], 0
    ds_read_b128 v[76:79], v6 offset:1664
    ds_read_b128 v[152:155], v6 offset:3200
    ds_read_b128 v[224:227], v6 offset:40960
    buffer_load_dwordx4 v8, s[32:35], s92 offen offset:2048 lds
    s_add_u32 m0, s90, 0
    s_mov_b32 s92, 384
    s_waitcnt vmcnt(9)
    ds_read_b64_tr_b16 a[8:9], v17 offset:24576
    ds_read_b64_tr_b16 a[10:11], v17 offset:25344
    ds_read_b64_tr_b16 a[32:33], v17 offset:24608
    ds_read_b64_tr_b16 a[34:35], v17 offset:25376
    ds_read_b64_tr_b16 a[56:57], v17 offset:24640
    ds_read_b64_tr_b16 a[58:59], v17 offset:25408
    ds_read_b128 v[160:163], v6 offset:42496
    ds_read_b32 v183, v183 offset:336
    buffer_load_dwordx4 v83, s[32:35], s92 offen offset:0 lds
    ds_read_b32 v176, v176 offset:336
    ds_read_b32 v177, v177 offset:336
    s_waitcnt lgkmcnt(10)
    v_mfma_f32_16x16x32_bf16 v[20:23], a[4:7], v[224:227], v[20:23]
    v_mfma_f32_16x16x32_bf16 v[84:87], a[28:31], v[224:227], v[84:87]
    s_waitcnt lgkmcnt(8)
    ds_read_b32 v178, v178 offset:336
    v_mfma_f32_16x16x32_bf16 v[20:23], a[8:11], v[168:171], v[20:23]
    s_waitcnt lgkmcnt(7)
    buffer_load_dwordx4 v97, s[32:35], s92 offen offset:1024 lds
    v_mfma_f32_16x16x32_bf16 v[84:87], a[32:35], v[168:171], v[84:87]
    ds_read_b128 v[156:159], v6 offset:0
    v_mfma_f32_16x16x32_bf16 v[72:75], a[52:55], v[224:227], v[72:75]
    s_waitcnt lgkmcnt(5)
    ds_read_b32 v179, v179 offset:336
    v_mfma_f32_16x16x32_bf16 v[72:75], a[56:59], v[168:171], v[72:75]
    v_mfma_f32_16x16x32_bf16 v[56:59], a[4:7], v[160:163], v[56:59]
    ds_read_b32 v172, v172 offset:336
    v_mfma_f32_16x16x32_bf16 v[56:59], a[8:11], v[108:111], v[56:59]
    buffer_load_dwordx4 v8, s[32:35], s92 offen offset:2048 lds
    v_mfma_f32_16x16x32_bf16 v[104:107], a[28:31], v[160:163], v[104:107]
    s_waitcnt vmcnt(9)
    s_add_u32 m0, s90, 12288
    ds_read_b64_tr_b16 a[12:13], v17 offset:36864
    v_mfma_f32_16x16x32_bf16 v[104:107], a[32:35], v[108:111], v[104:107]
    s_mov_b32 s92, 37248
    ds_read_b64_tr_b16 a[14:15], v17 offset:37632
    v_mfma_f32_16x16x32_bf16 v[40:43], a[52:55], v[160:163], v[40:43]
    ds_read_b64_tr_b16 a[36:37], v17 offset:36896
    v_mfma_f32_16x16x32_bf16 v[40:43], a[56:59], v[108:111], v[40:43]
    s_waitcnt lgkmcnt(5)
    ds_read_b64_tr_b16 a[38:39], v17 offset:37664
    buffer_load_dwordx4 v83, s[32:35], s92 offen offset:0 lds
    v_mfma_f32_16x16x32_bf16 v[30:33], a[4:7], v[156:159], v[30:33]
    ds_read_b64_tr_b16 a[60:61], v17 offset:36928
    v_mfma_f32_16x16x32_bf16 v[30:33], a[8:11], v[144:147], v[30:33]
    ds_read_b64_tr_b16 a[62:63], v17 offset:37696
    v_mfma_f32_16x16x32_bf16 v[148:151], a[28:31], v[156:159], v[148:151]
    ds_read_b128 v[108:111], v6 offset:1536
    v_mfma_f32_16x16x32_bf16 v[148:151], a[32:35], v[144:147], v[148:151]
    ds_read_b32 v173, v173 offset:336
    v_mfma_f32_16x16x32_bf16 v[100:103], a[52:55], v[156:159], v[100:103]
    buffer_load_dwordx4 v97, s[32:35], s92 offen offset:1024 lds
    v_mfma_f32_16x16x32_bf16 v[100:103], a[56:59], v[144:147], v[100:103]
    s_waitcnt lgkmcnt(6)
    ds_read_b32 v174, v174 offset:336
    v_mfma_f32_16x16x32_bf16 v[20:23], a[12:15], v[116:119], v[20:23]
    v_mfma_f32_16x16x32_bf16 v[56:59], a[12:15], v[60:63], v[56:59]
    s_waitcnt lgkmcnt(5)
    ds_read_b32 v175, v175 offset:336
    v_mfma_f32_16x16x32_bf16 v[84:87], a[36:39], v[116:119], v[84:87]
    v_mfma_f32_16x16x32_bf16 v[104:107], a[36:39], v[60:63], v[104:107]
    ds_read_b128 v[156:159], v6 offset:3072
    buffer_load_dwordx4 v8, s[32:35], s92 offen offset:2048 lds
    v_mfma_f32_16x16x32_bf16 v[30:33], a[12:15], v[36:39], v[30:33]
    s_waitcnt vmcnt(9) lgkmcnt(5)
    s_add_u32 m0, s90, 24576
    ds_read_b64_tr_b16 a[16:17], v17 offset:49152
    v_mfma_f32_16x16x32_bf16 v[72:75], a[60:63], v[116:119], v[72:75]
    s_mov_b32 s92, 74112
    ds_read_b64_tr_b16 a[18:19], v17 offset:49920
    v_mfma_f32_16x16x32_bf16 v[40:43], a[60:63], v[60:63], v[40:43]
    ds_read_b64_tr_b16 a[40:41], v17 offset:49184
    v_mfma_f32_16x16x32_bf16 v[148:151], a[36:39], v[36:39], v[148:151]
    ds_read_b64_tr_b16 a[42:43], v17 offset:49952
    v_mfma_f32_16x16x32_bf16 v[100:103], a[60:63], v[36:39], v[100:103]
    s_waitcnt lgkmcnt(6)
    ds_read_b64_tr_b16 a[64:65], v17 offset:49216
    buffer_load_dwordx4 v83, s[32:35], s92 offen offset:0 lds
    v_mfma_f32_16x16x32_bf16 v[24:27], a[4:7], v[108:111], v[24:27]
    ds_read_b64_tr_b16 a[66:67], v17 offset:49984
    v_mfma_f32_16x16x32_bf16 v[24:27], a[8:11], v[52:55], v[24:27]
    ds_read_b32 v204, v204 offset:336
    v_mfma_f32_16x16x32_bf16 v[24:27], a[12:15], v[76:79], v[24:27]
    v_mfma_f32_16x16x32_bf16 v[44:47], a[28:31], v[108:111], v[44:47]
    ds_read_b128 v[116:119], v6 offset:41216
    v_mfma_f32_16x16x32_bf16 v[44:47], a[32:35], v[52:55], v[44:47]
    ds_read_b128 v[60:63], v6 offset:42752
    buffer_load_dwordx4 v97, s[32:35], s92 offen offset:1024 lds
    v_mfma_f32_16x16x32_bf16 v[44:47], a[36:39], v[76:79], v[44:47]
    ds_read_b128 v[36:39], v6 offset:256
    v_mfma_f32_16x16x32_bf16 v[112:115], a[52:55], v[108:111], v[112:115]
    ds_read_b128 v[108:111], v6 offset:1792
    v_mfma_f32_16x16x32_bf16 v[112:115], a[56:59], v[52:55], v[112:115]
    ds_read_b128 v[52:55], v6 offset:3328
    v_mfma_f32_16x16x32_bf16 v[112:115], a[60:63], v[76:79], v[112:115]
    s_waitcnt lgkmcnt(7)
    ds_read_b128 v[144:147], v7 offset:41216
    v_mfma_f32_16x16x32_bf16 v[12:15], a[4:7], v[156:159], v[12:15]
    ds_read_b128 v[76:79], v7 offset:42752
    buffer_load_dwordx4 v8, s[32:35], s92 offen offset:2048 lds
    v_mfma_f32_16x16x32_bf16 v[12:15], a[8:11], v[68:71], v[12:15]
    s_waitcnt vmcnt(9)
    s_add_u32 m0, s90, 36864
    ds_read_b64_tr_b16 a[20:21], v17 offset:61440
    v_mfma_f32_16x16x32_bf16 v[12:15], a[12:15], v[152:155], v[12:15]
    s_mov_b32 s92, 110976
    ds_read_b64_tr_b16 a[22:23], v17 offset:62208
    v_mfma_f32_16x16x32_bf16 v[140:143], a[28:31], v[156:159], v[140:143]
    ds_read_b64_tr_b16 a[44:45], v17 offset:61472
    v_mfma_f32_16x16x32_bf16 v[140:143], a[32:35], v[68:71], v[140:143]
    ds_read_b64_tr_b16 a[46:47], v17 offset:62240
    v_mfma_f32_16x16x32_bf16 v[140:143], a[36:39], v[152:155], v[140:143]
    ds_read_b64_tr_b16 a[68:69], v17 offset:61504
    buffer_load_dwordx4 v83, s[32:35], s92 offen offset:0 lds
    v_mfma_f32_16x16x32_bf16 v[92:95], a[52:55], v[156:159], v[92:95]
    ds_read_b64_tr_b16 a[70:71], v17 offset:62272
    v_mfma_f32_16x16x32_bf16 v[92:95], a[56:59], v[68:71], v[92:95]
    ds_read_b128 v[68:71], v7 offset:256
    v_mfma_f32_16x16x32_bf16 v[92:95], a[60:63], v[152:155], v[92:95]
    s_waitcnt lgkmcnt(8)
    ds_read_b32 v205, v205 offset:336
    v_mfma_f32_16x16x32_bf16 v[20:23], a[16:19], v[144:147], v[20:23]
    v_mfma_f32_16x16x32_bf16 v[84:87], a[40:43], v[144:147], v[84:87]
    ds_read_b32 v206, v206 offset:336
    buffer_load_dwordx4 v97, s[32:35], s92 offen offset:1024 lds
    v_mfma_f32_16x16x32_bf16 v[72:75], a[64:67], v[144:147], v[72:75]
    s_waitcnt lgkmcnt(7)
    v_mfma_f32_16x16x32_bf16 v[20:23], a[20:23], v[116:119], v[20:23]
    ds_read_b128 v[144:147], v7 offset:1792
    v_mfma_f32_16x16x32_bf16 v[56:59], a[16:19], v[76:79], v[56:59]
    s_waitcnt lgkmcnt(6)
    s_nop 0
    ds_read_b32 v207, v207 offset:336
    s_nop 0
    v_mfma_f32_16x16x32_bf16 v[84:87], a[44:47], v[116:119], v[84:87]
    s_nop 0
    v_cvt_pk_f16_f32 v20, v20, v21
    v_cvt_pk_f16_f32 v21, v22, v23
    v_mfma_f32_16x16x32_bf16 v[56:59], a[20:23], v[60:63], v[56:59]
    s_waitcnt lgkmcnt(5)
    ds_read_b32 v200, v200 offset:336
    buffer_load_dwordx4 v8, s[32:35], s92 offen offset:2048 lds
    v_mfma_f32_16x16x32_bf16 v[72:75], a[68:71], v[116:119], v[72:75]
    s_add_u32 m0, s90, 49152
    v_pk_fma_f16 v80, v20, v20, s39
    v_pk_fmac_f16 v80, v21, v21
    v_mfma_f32_16x16x32_bf16 v[104:107], a[40:43], v[76:79], v[104:107]
    s_waitcnt vmcnt(9)
    s_mov_b32 s92, 147840
    ds_read_b64_tr_b16 a[72:73], v17 offset:0
    v_cvt_pk_f16_f32 v22, v84, v85
    v_mfma_f32_16x16x32_bf16 v[104:107], a[44:47], v[60:63], v[104:107]
    ds_read_b64_tr_b16 a[74:75], v17 offset:768
    v_cvt_pk_f16_f32 v23, v86, v87
    v_mfma_f32_16x16x32_bf16 v[40:43], a[64:67], v[76:79], v[40:43]
    ds_read_b64_tr_b16 a[96:97], v17 offset:32
    v_pk_fmac_f16 v80, v22, v22
    v_mfma_f32_16x16x32_bf16 v[40:43], a[68:71], v[60:63], v[40:43]
    s_waitcnt lgkmcnt(6)
    ds_read_b64_tr_b16 a[98:99], v17 offset:800
    buffer_load_dwordx4 v83, s[32:35], s92 offen offset:0 lds
    v_mfma_f32_16x16x32_bf16 v[30:33], a[16:19], v[68:71], v[30:33]
    ds_read_b64_tr_b16 a[120:121], v17 offset:64
    v_pk_fmac_f16 v80, v23, v23
    v_mfma_f32_16x16x32_bf16 v[30:33], a[20:23], v[36:39], v[30:33]
    ds_read_b64_tr_b16 a[122:123], v17 offset:832
    v_cvt_pk_f16_f32 v88, v72, v73
    v_mfma_f32_16x16x32_bf16 v[148:151], a[40:43], v[68:71], v[148:151]
    ds_read_b128 v[60:63], v7 offset:3328
    v_cvt_pk_f16_f32 v89, v74, v75
    v_mfma_f32_16x16x32_bf16 v[148:151], a[44:47], v[36:39], v[148:151]
    ds_read_b128 v[116:119], v6 offset:40960
    v_pk_fmac_f16 v80, v88, v88
    v_mfma_f32_16x16x32_bf16 v[100:103], a[64:67], v[68:71], v[100:103]
    ds_read_b128 v[76:79], v6 offset:42496
    buffer_load_dwordx4 v97, s[32:35], s92 offen offset:1024 lds
    v_mfma_f32_16x16x32_bf16 v[100:103], a[68:71], v[36:39], v[100:103]
    s_waitcnt lgkmcnt(8)
    ds_read_b128 v[68:71], v6 offset:0
    v_pk_fmac_f16 v80, v89, v89
    v_mfma_f32_16x16x32_bf16 v[24:27], a[16:19], v[144:147], v[24:27]
    ds_read_b128 v[36:39], v6 offset:1536
    v_cvt_pk_f16_f32 v56, v56, v57
    v_mfma_f32_16x16x32_bf16 v[24:27], a[20:23], v[108:111], v[24:27]
    ds_read_b128 v[228:231], v6 offset:3072
    v_cvt_pk_f16_f32 v57, v58, v59
    v_mfma_f32_16x16x32_bf16 v[44:47], a[40:43], v[144:147], v[44:47]
    ds_read_b128 v[72:75], v7 offset:40960
    v_pk_fma_f16 v82, v56, v56, s39
    v_mfma_f32_16x16x32_bf16 v[44:47], a[44:47], v[108:111], v[44:47]
    ds_read_b128 v[84:87], v7 offset:42496
    buffer_load_dwordx4 v8, s[32:35], s92 offen offset:2048 lds
    v_mfma_f32_16x16x32_bf16 v[112:115], a[64:67], v[144:147], v[112:115]
    s_waitcnt vmcnt(9)
    s_add_u32 m0, s90, 61440
    ds_read_b64_tr_b16 a[76:77], v17 offset:12288
    v_pk_fmac_f16 v82, v57, v57
    v_mfma_f32_16x16x32_bf16 v[112:115], a[68:71], v[108:111], v[112:115]
    s_waitcnt lgkmcnt(8)
    s_mov_b32 s92, 184704
    ds_read_b64_tr_b16 a[78:79], v17 offset:13056
    v_cvt_pk_f16_f32 v58, v104, v105
    v_mfma_f32_16x16x32_bf16 v[12:15], a[16:19], v[60:63], v[12:15]
    ds_read_b64_tr_b16 a[100:101], v17 offset:12320
    v_cvt_pk_f16_f32 v59, v106, v107
    v_mfma_f32_16x16x32_bf16 v[12:15], a[20:23], v[52:55], v[12:15]
    ds_read_b64_tr_b16 a[102:103], v17 offset:13088
    v_pk_fmac_f16 v82, v58, v58
    v_mfma_f32_16x16x32_bf16 v[140:143], a[40:43], v[60:63], v[140:143]
    ds_read_b64_tr_b16 a[124:125], v17 offset:12352
    buffer_load_dwordx4 v83, s[32:35], s92 offen offset:0 lds
    v_mfma_f32_16x16x32_bf16 v[140:143], a[44:47], v[52:55], v[140:143]
    ds_read_b64_tr_b16 a[126:127], v17 offset:13120
    v_pk_fmac_f16 v82, v59, v59
    v_mfma_f32_16x16x32_bf16 v[92:95], a[64:67], v[60:63], v[92:95]
    ds_read_b128 v[144:147], v7 offset:0
    v_cvt_pk_f16_f32 v40, v40, v41
    v_mfma_f32_16x16x32_bf16 v[92:95], a[68:71], v[52:55], v[92:95]
    s_waitcnt lgkmcnt(8)
    ds_read_b32 v201, v201 offset:336
    v_cvt_pk_f16_f32 v41, v42, v43
    v_mfma_f32_16x16x32_bf16 v[60:63], a[72:75], v[72:75], 0
    v_pk_fmac_f16 v82, v40, v40
    v_pk_fmac_f16 v82, v41, v41
    v_mfma_f32_16x16x32_bf16 v[224:227], a[96:99], v[72:75], 0
    ds_read_b32 v202, v202 offset:336
    buffer_load_dwordx4 v97, s[32:35], s92 offen offset:1024 lds
    v_mfma_f32_16x16x32_bf16 v[52:55], a[120:123], v[72:75], 0
    s_waitcnt lgkmcnt(7)
    v_cvt_pk_f16_f32 v104, v30, v31
    v_cvt_pk_f16_f32 v105, v32, v33
    v_mfma_f32_16x16x32_bf16 v[60:63], a[76:79], v[116:119], v[60:63]
    ds_read_b128 v[108:111], v7 offset:1536
    v_pk_fma_f16 v48, v104, v104, s39
    v_mfma_f32_16x16x32_bf16 v[72:75], a[72:75], v[84:87], 0
    s_waitcnt lgkmcnt(6)
    ds_read_b32 v203, v203 offset:336
    v_pk_fmac_f16 v48, v105, v105
    v_mfma_f32_16x16x32_bf16 v[224:227], a[100:103], v[116:119], v[224:227]
    v_cvt_pk_f16_f32 v106, v148, v149
    v_cvt_pk_f16_f32 v107, v150, v151
    v_mfma_f32_16x16x32_bf16 v[72:75], a[76:79], v[76:79], v[72:75]
    s_waitcnt lgkmcnt(5)
    ds_read_b32 v196, v196 offset:336
    buffer_load_dwordx4 v8, s[32:35], s92 offen offset:2048 lds
    v_mfma_f32_16x16x32_bf16 v[52:55], a[124:127], v[116:119], v[52:55]
    s_add_u32 m0, s90, 0
    v_pk_fmac_f16 v48, v106, v106
    v_pk_fmac_f16 v48, v107, v107
    v_mfma_f32_16x16x32_bf16 v[168:171], a[96:99], v[84:87], 0
    s_waitcnt vmcnt(9)
    s_mov_b32 s92, 768
    ds_read_b64_tr_b16 a[80:81], v17 offset:24576
    v_cvt_pk_f16_f32 v152, v100, v101
    v_mfma_f32_16x16x32_bf16 v[168:171], a[100:103], v[76:79], v[168:171]
    ds_read_b64_tr_b16 a[82:83], v17 offset:25344
    v_cvt_pk_f16_f32 v153, v102, v103
    v_mfma_f32_16x16x32_bf16 v[160:163], a[120:123], v[84:87], 0
    ds_read_b64_tr_b16 a[104:105], v17 offset:24608
    v_pk_fmac_f16 v48, v152, v152
    v_mfma_f32_16x16x32_bf16 v[160:163], a[124:127], v[76:79], v[160:163]
    s_waitcnt lgkmcnt(6)
    ds_read_b64_tr_b16 a[106:107], v17 offset:25376
    buffer_load_dwordx4 v83, s[32:35], s92 offen offset:0 lds
    v_mfma_f32_16x16x32_bf16 v[76:79], a[72:75], v[144:147], 0
    ds_read_b64_tr_b16 a[128:129], v17 offset:24640
    v_pk_fmac_f16 v48, v153, v153
    v_mfma_f32_16x16x32_bf16 v[76:79], a[76:79], v[68:71], v[76:79]
    ds_read_b64_tr_b16 a[130:131], v17 offset:25408
    v_cvt_pk_f16_f32 v24, v24, v25
    v_mfma_f32_16x16x32_bf16 v[116:119], a[96:99], v[144:147], 0
    ds_read_b128 v[236:239], v7 offset:3072
    v_cvt_pk_f16_f32 v25, v26, v27
    v_mfma_f32_16x16x32_bf16 v[116:119], a[100:103], v[68:71], v[116:119]
    ds_read_b128 v[100:103], v7 offset:41088
    v_pk_fma_f16 v50, v24, v24, s39
    v_mfma_f32_16x16x32_bf16 v[84:87], a[120:123], v[144:147], 0
    ds_read_b32 v197, v197 offset:336
    buffer_load_dwordx4 v97, s[32:35], s92 offen offset:1024 lds
    v_mfma_f32_16x16x32_bf16 v[84:87], a[124:127], v[68:71], v[84:87]
    s_waitcnt lgkmcnt(8)
    v_pk_fmac_f16 v50, v25, v25
    v_cvt_pk_f16_f32 v26, v44, v45
    v_mfma_f32_16x16x32_bf16 v[32:35], a[72:75], v[108:111], 0
    ds_read_b128 v[68:71], v7 offset:42624
    v_cvt_pk_f16_f32 v27, v46, v47
    v_mfma_f32_16x16x32_bf16 v[32:35], a[76:79], v[36:39], v[32:35]
    ds_read_b32 v198, v198 offset:336
    v_pk_fmac_f16 v50, v26, v26
    v_mfma_f32_16x16x32_bf16 v[156:159], a[96:99], v[108:111], 0
    v_pk_fmac_f16 v50, v27, v27
    v_cvt_pk_f16_f32 v146, v112, v113
    v_mfma_f32_16x16x32_bf16 v[156:159], a[100:103], v[36:39], v[156:159]
    s_waitcnt vmcnt(8)
    ds_read_b128 v[44:47], v7 offset:128
    buffer_load_dwordx4 v8, s[32:35], s92 offen offset:2048 lds
    v_cvt_pk_f16_f32 v147, v114, v115
    v_pk_fmac_f16 v50, v146, v146
    s_add_u32 m0, s90, 12288
    s_mov_b32 s92, 37632
    ds_read_b64_tr_b16 a[84:85], v17 offset:36864
    v_pk_fmac_f16 v50, v147, v147
    v_mfma_f32_16x16x32_bf16 v[148:151], a[120:123], v[108:111], 0
    ds_read_b64_tr_b16 a[86:87], v17 offset:37632
    v_cvt_pk_f16_f32 v108, v12, v13
    v_mfma_f32_16x16x32_bf16 v[148:151], a[124:127], v[36:39], v[148:151]
    s_waitcnt lgkmcnt(5)
    ds_read_b64_tr_b16 a[108:109], v17 offset:36896
    v_cvt_pk_f16_f32 v109, v14, v15
    v_mfma_f32_16x16x32_bf16 v[112:115], a[72:75], v[236:239], 0
    ds_read_b64_tr_b16 a[110:111], v17 offset:37664
    v_pk_fma_f16 v16, v108, v108, s39
    v_mfma_f32_16x16x32_bf16 v[112:115], a[76:79], v[228:231], v[112:115]
    buffer_load_dwordx4 v83, s[32:35], s92 offen offset:0 lds
    ds_read_b64_tr_b16 a[132:133], v17 offset:36928
    v_mfma_f32_16x16x32_bf16 v[12:15], a[96:99], v[236:239], 0
    ds_read_b64_tr_b16 a[134:135], v17 offset:37696
    v_pk_fmac_f16 v16, v109, v109
    v_mfma_f32_16x16x32_bf16 v[12:15], a[100:103], v[228:231], v[12:15]
    ds_read_b128 v[36:39], v7 offset:1664
    v_cvt_pk_f16_f32 v110, v140, v141
    v_mfma_f32_16x16x32_bf16 v[60:63], a[80:83], v[100:103], v[60:63]
    ds_read_b128 v[232:235], v7 offset:3200
    v_cvt_pk_f16_f32 v111, v142, v143
    v_mfma_f32_16x16x32_bf16 v[224:227], a[104:107], v[100:103], v[224:227]
    ds_read_b32 v199, v199 offset:336
    v_pk_fmac_f16 v16, v110, v110
    v_mfma_f32_16x16x32_bf16 v[52:55], a[128:131], v[100:103], v[52:55]
    s_waitcnt lgkmcnt(8)
    buffer_load_dwordx4 v97, s[32:35], s92 offen offset:1024 lds
    v_pk_fmac_f16 v16, v111, v111
    v_mfma_f32_16x16x32_bf16 v[72:75], a[80:83], v[68:71], v[72:75]
    ds_read_b128 v[100:103], v6 offset:41088
    v_cvt_pk_f16_f32 v140, v92, v93
    v_mfma_f32_16x16x32_bf16 v[168:171], a[104:107], v[68:71], v[168:171]
    v_cvt_pk_f16_f32 v141, v94, v95
    v_pk_fmac_f16 v16, v140, v140
    v_mfma_f32_16x16x32_bf16 v[160:163], a[128:131], v[68:71], v[160:163]
    ds_read_b128 v[92:95], v6 offset:42624
    v_pk_fmac_f16 v16, v141, v141
    v_mfma_f32_16x16x32_bf16 v[68:71], a[120:123], v[236:239], 0
    v_mov_b32 v18, 0
    v_mov_b32 v19, 0
    v_mfma_f32_16x16x32_bf16 v[68:71], a[124:127], v[228:231], v[68:71]
    s_waitcnt vmcnt(8)
    buffer_load_dwordx4 v8, s[32:35], s92 offen offset:2048 lds
    ds_read_b64_tr_b16 a[88:89], v17 offset:49152
    v_mfma_f32_16x16x32_bf16 v[76:79], a[80:83], v[44:47], v[76:79]
    s_add_u32 m0, s90, 24576
    ds_read_b64_tr_b16 a[90:91], v17 offset:49920
    v_mov_b32 v5, 0xf149f2ca
    v_mfma_f32_16x16x32_bf16 v[116:119], a[104:107], v[44:47], v[116:119]
    s_mov_b32 s92, 74496
    ds_read_b64_tr_b16 a[112:113], v17 offset:49184
    v_mfma_f32_16x16x32_bf16 v[84:87], a[128:131], v[44:47], v[84:87]
    s_waitcnt lgkmcnt(5)
    ds_read_b64_tr_b16 a[114:115], v17 offset:49952
    v_mfma_f32_16x16x32_bf16 v[32:35], a[80:83], v[36:39], v[32:35]
    ds_read_b64_tr_b16 a[136:137], v17 offset:49216
    v_mfma_f32_16x16x32_bf16 v[156:159], a[104:107], v[36:39], v[156:159]
    buffer_load_dwordx4 v83, s[32:35], s92 offen offset:0 lds
    ds_read_b64_tr_b16 a[138:139], v17 offset:49984
    v_mfma_f32_16x16x32_bf16 v[148:151], a[128:131], v[36:39], v[148:151]
    ds_read_b128 v[44:47], v6 offset:128
    v_mfma_f32_16x16x32_bf16 v[112:115], a[80:83], v[232:235], v[112:115]
    ds_read_b128 v[36:39], v6 offset:1664
    v_mfma_f32_16x16x32_bf16 v[12:15], a[104:107], v[232:235], v[12:15]
    ds_read_b128 v[228:231], v6 offset:3200
    v_mfma_f32_16x16x32_bf16 v[68:71], a[128:131], v[232:235], v[68:71]
    s_waitcnt lgkmcnt(8)
    s_cmp_ge_u32 s2, 247
    s_cbranch_scc1 L_maskF
L_nomaskF:
    v_mfma_f32_16x16x32_bf16 v[60:63], a[84:87], v[100:103], v[60:63]
    buffer_load_dwordx4 v97, s[32:35], s92 offen offset:1024 lds
    ds_read_b128 v[232:235], v7 offset:41216
    v_mfma_f32_16x16x32_bf16 v[224:227], a[108:111], v[100:103], v[224:227]
    v_readlane_b32 s84, v211, 48
    v_cmp_gt_u32 vcc, 16, v2
    v_mfma_f32_16x16x32_bf16 v[52:55], a[132:135], v[100:103], v[52:55]
    s_nop 0
    v_cndmask_b32 v208, v5, v208, vcc
    v_cndmask_b32 v209, v5, v209, vcc
    v_mfma_f32_16x16x32_bf16 v[72:75], a[84:87], v[92:95], v[72:75]
    ds_read_b128 v[100:103], v7 offset:42752
    v_cndmask_b32 v210, v5, v210, vcc
    v_mfma_f32_16x16x32_bf16 v[168:171], a[108:111], v[92:95], v[168:171]
    v_cmp_gt_u32 vcc, 49, v2
    v_mfma_f32_16x16x32_bf16 v[160:163], a[132:135], v[92:95], v[160:163]
    s_waitcnt vmcnt(8) lgkmcnt(4)
    buffer_load_dwordx4 v8, s[32:35], s92 offen offset:2048 lds
    ds_read_b64_tr_b16 a[92:93], v17 offset:61440
    v_mfma_f32_16x16x32_bf16 v[76:79], a[84:87], v[44:47], v[76:79]
    s_add_u32 m0, s90, 36864
    ds_read_b64_tr_b16 a[94:95], v17 offset:62208
    v_cndmask_b32 v211, v5, v211, vcc
    v_mfma_f32_16x16x32_bf16 v[116:119], a[108:111], v[44:47], v[116:119]
    s_mov_b32 s92, 111360
    ds_read_b64_tr_b16 a[116:117], v17 offset:61472
    v_mfma_f32_16x16x32_bf16 v[84:87], a[132:135], v[44:47], v[84:87]
    s_waitcnt lgkmcnt(5)
    s_mov_b32 s53, s47
    ds_read_b64_tr_b16 a[118:119], v17 offset:62240
    v_mfma_f32_16x16x32_bf16 v[32:35], a[84:87], v[36:39], v[32:35]
    s_mov_b32 s47, s46
    ds_read_b64_tr_b16 a[140:141], v17 offset:61504
    v_mfma_f32_16x16x32_bf16 v[156:159], a[108:111], v[36:39], v[156:159]
    s_mov_b32 s46, s45
    buffer_load_dwordx4 v83, s[32:35], s92 offen offset:0 lds
    ds_read_b64_tr_b16 a[142:143], v17 offset:62272
    v_mfma_f32_16x16x32_bf16 v[148:151], a[132:135], v[36:39], v[148:151]
    s_mov_b32 s45, s44
    ds_read_b128 v[44:47], v7 offset:256
    v_mfma_f32_16x16x32_bf16 v[112:115], a[84:87], v[228:231], v[112:115]
    s_mov_b32 s44, s53
    ds_read_b128 v[36:39], v7 offset:1792
    v_mov_b32 v30, 0
    v_mfma_f32_16x16x32_bf16 v[12:15], a[108:111], v[228:231], v[12:15]
    s_sub_u32 s48, s44, s46
    ds_read_b128 v[92:95], v7 offset:3328
    v_mov_b32 v31, 0
    v_mfma_f32_16x16x32_bf16 v[68:71], a[132:135], v[228:231], v[68:71]
    s_waitcnt lgkmcnt(8)
    s_sub_u32 s49, s46, s45
    v_mov_b32 v9, 0
    v_add_u32 v5, 28672, v29
    v_mfma_f32_16x16x32_bf16 v[60:63], a[88:91], v[232:235], v[60:63]
    s_sub_u32 s50, s45, s44
    buffer_load_dwordx4 v97, s[32:35], s92 offen offset:1024 lds
    ds_read_b128 v[228:231], v6 offset:41216
    v_mfma_f32_16x16x32_bf16 v[224:227], a[112:115], v[232:235], v[224:227]
    s_sub_u32 s51, s46, s47
    v_add_u32 v137, s48, v137
    v_add_u32 v136, s48, v136
    v_mfma_f32_16x16x32_bf16 v[52:55], a[136:139], v[232:235], v[52:55]
    s_mov_b32 s60, s59
    ds_write2_b64 v5, v[30:31], v[30:31] offset0:2 offset1:3
    v_mfma_f32_16x16x32_bf16 v[72:75], a[88:91], v[100:103], v[72:75]
    s_mov_b32 s59, s58
    v_add_u32 v135, s49, v135
    v_add_u32 v134, s49, v134
    v_mfma_f32_16x16x32_bf16 v[168:171], a[112:115], v[100:103], v[168:171]
    s_mov_b32 s58, s57
    buffer_load_dwordx4 v8, s[32:35], s92 offen offset:2048 lds
    v_add_u32 v137, s50, v137
    v_mfma_f32_16x16x32_bf16 v[160:163], a[136:139], v[100:103], v[160:163]
    s_waitcnt vmcnt(9) lgkmcnt(3)
    s_add_u32 m0, s90, 49152
    ds_read_b64_tr_b16 a[144:145], v139 offset:0
    v_add_u32 v136, s50, v136
    v_mfma_f32_16x16x32_bf16 v[76:79], a[88:91], v[44:47], v[76:79]
    s_mov_b32 s92, 148224
    ds_read_b64_tr_b16 a[146:147], v139 offset:768
    v_add_u32 v135, s48, v135
    v_mfma_f32_16x16x32_bf16 v[116:119], a[112:115], v[44:47], v[116:119]
    s_mov_b32 s57, s56
    ds_read_b64_tr_b16 a[168:169], v139 offset:8
    v_add_u32 v134, s48, v134
    v_mfma_f32_16x16x32_bf16 v[84:87], a[136:139], v[44:47], v[84:87]
    s_mov_b32 s7, s6
    ds_read_b64_tr_b16 a[170:171], v139 offset:776
    v_add_u32 v133, s51, v133
    v_mfma_f32_16x16x32_bf16 v[32:35], a[88:91], v[36:39], v[32:35]
    s_mov_b32 s6, s5
    ds_read_b64_tr_b16 a[192:193], v17 offset:64
    buffer_load_dwordx4 v83, s[32:35], s92 offen offset:0 lds
    v_mfma_f32_16x16x32_bf16 v[156:159], a[112:115], v[36:39], v[156:159]
    s_mov_b32 s5, s4
    ds_read_b64_tr_b16 a[194:195], v17 offset:832
    v_mfma_f32_16x16x32_bf16 v[148:151], a[136:139], v[36:39], v[148:151]
    s_waitcnt lgkmcnt(6)
    s_sub_u32 s14, s6, s7
    ds_read_b128 v[100:103], v6 offset:42752
    v_add_u32 v132, s14, v132
    v_mfma_f32_16x16x32_bf16 v[112:115], a[88:91], v[92:95], v[112:115]
    s_add_u32 s61, s61, 1
    ds_read_b128 v[44:47], v6 offset:256
    v_add_u32 v131, s14, v131
    v_mfma_f32_16x16x32_bf16 v[12:15], a[112:115], v[92:95], v[12:15]
    s_add_u32 s12, s12, 20
    ds_read_b128 v[36:39], v6 offset:1792
    v_mfma_f32_16x16x32_bf16 v[68:71], a[136:139], v[92:95], v[68:71]
    s_max_u32 s12, s12, s61
    buffer_load_dwordx4 v97, s[32:35], s92 offen offset:1024 lds
    ds_read_b128 v[92:95], v6 offset:3328
    v_mfma_f32_16x16x32_bf16 v[60:63], a[92:95], v[228:231], v[60:63]
L_pg0:
    s_cbranch_execz L_main
    s_add_u32 s65, s65, 1
    v_mfma_f32_16x16x32_bf16 v[224:227], a[116:119], v[228:231], v[224:227]
    s_add_u32 s67, s46, s54
    s_nop 0
    v_mfma_f32_16x16x32_bf16 v[52:55], a[140:143], v[228:231], v[52:55]
    s_waitcnt vmcnt(8) lgkmcnt(3)
    s_nop 0
    ds_read_b128 v[232:235], v7 offset:40960
    v_cvt_pk_f16_f32 v60, v60, v61
    v_cvt_pk_f16_f32 v61, v62, v63
    v_pk_fma_f16 v81, v60, v60, s39
    v_pk_fmac_f16 v81, v61, v61
    v_cvt_pk_f16_f32 v62, v224, v225
    v_cvt_pk_f16_f32 v63, v226, v227
    v_pk_fmac_f16 v81, v62, v62
    ds_read_b64_tr_b16 a[148:149], v139 offset:12288
    v_mfma_f32_16x16x32_bf16 v[72:75], a[92:95], v[100:103], v[72:75]
    buffer_load_dwordx4 v8, s[32:35], s92 offen offset:2048 lds
    ds_read_b64_tr_b16 a[150:151], v139 offset:13056
    v_mfma_f32_16x16x32_bf16 v[168:171], a[116:119], v[100:103], v[168:171]
    s_add_u32 m0, s90, 61440
    v_pk_fmac_f16 v81, v63, v63
    v_cvt_pk_f16_f32 v96, v52, v53
    v_mfma_f32_16x16x32_bf16 v[160:163], a[140:143], v[100:103], v[160:163]
    s_waitcnt lgkmcnt(4)
    s_mov_b32 s92, 185088
    ds_read_b64_tr_b16 a[172:173], v139 offset:12296
    v_cvt_pk_f16_f32 v72, v72, v73
    v_mfma_f32_16x16x32_bf16 v[76:79], a[92:95], v[44:47], v[76:79]
    ds_read_b64_tr_b16 a[174:175], v139 offset:13064
    v_cvt_pk_f16_f32 v73, v74, v75
    v_mfma_f32_16x16x32_bf16 v[116:119], a[116:119], v[44:47], v[116:119]
    ds_read_b64_tr_b16 a[196:197], v17 offset:12352
    buffer_load_dwordx4 v83, s[32:35], s92 offen offset:0 lds
    v_mfma_f32_16x16x32_bf16 v[84:87], a[140:143], v[44:47], v[84:87]
    ds_read_b64_tr_b16 a[198:199], v17 offset:13120
    v_pk_fma_f16 v83, v72, v72, s39
    v_mfma_f32_16x16x32_bf16 v[32:35], a[92:95], v[36:39], v[32:35]
    ds_read_b128 v[228:231], v6 offset:40960
    v_pk_fmac_f16 v83, v73, v73
    v_mfma_f32_16x16x32_bf16 v[156:159], a[116:119], v[36:39], v[156:159]
    ds_read_b128 v[100:103], v7 offset:41088
    v_cvt_pk_f16_f32 v74, v168, v169
    v_mfma_f32_16x16x32_bf16 v[148:151], a[140:143], v[36:39], v[148:151]
    s_waitcnt lgkmcnt(7)
    ds_read_b128 v[44:47], v6 offset:41088
    v_cvt_pk_f16_f32 v75, v170, v171
    v_mfma_f32_16x16x32_bf16 v[112:115], a[92:95], v[92:95], v[112:115]
    buffer_load_dwordx4 v97, s[32:35], s92 offen offset:1024 lds
    ds_read_b128 v[36:39], v7 offset:41216
    v_mfma_f32_16x16x32_bf16 v[12:15], a[116:119], v[92:95], v[12:15]
    v_pk_fmac_f16 v83, v74, v74
    v_pk_fmac_f16 v83, v75, v75
    v_mfma_f32_16x16x32_bf16 v[68:71], a[140:143], v[92:95], v[68:71]
    ds_read_b128 v[92:95], v6 offset:41216
    v_cvt_pk_f16_f32 v42, v160, v161
    v_cvt_pk_f16_f32 v43, v162, v163
    v_pk_fmac_f16 v83, v42, v42
    v_pk_fmac_f16 v83, v43, v43
    v_cvt_pk_f16_f32 v32, v32, v33
    v_cvt_pk_f16_f32 v33, v34, v35
    v_pk_fma_f16 v51, v32, v32, s39
    v_pk_fmac_f16 v51, v33, v33
    v_cvt_pk_f16_f32 v34, v156, v157
    v_cvt_pk_f16_f32 v35, v158, v159
    s_waitcnt vmcnt(8)
    ds_read_b64_tr_b16 a[152:153], v139 offset:24576
    buffer_load_dwordx4 v8, s[32:35], s92 offen offset:2048 lds
    s_add_u32 m0, s90, 0
    s_mov_b32 s92, 0
    ds_read_b64_tr_b16 a[154:155], v139 offset:25344
    v_pk_fmac_f16 v51, v34, v34
    v_pk_fmac_f16 v51, v35, v35
    v_cvt_pk_f16_f32 v148, v148, v149
    ds_read_b64_tr_b16 a[176:177], v139 offset:24584
    v_cvt_pk_f16_f32 v149, v150, v151
    v_pk_fmac_f16 v51, v148, v148
    v_pk_fmac_f16 v51, v149, v149
    ds_read_b64_tr_b16 a[178:179], v139 offset:25352
    v_cvt_pk_f16_f32 v76, v76, v77
    ds_read_b64_tr_b16 a[200:201], v17 offset:24640
    buffer_load_dwordx4 v4, s[76:79], s92 offen offset:0 lds
    ds_read_b64_tr_b16 a[202:203], v17 offset:25408
    v_cvt_pk_f16_f32 v77, v78, v79
    v_pk_fma_f16 v49, v76, v76, s39
    v_pk_fmac_f16 v49, v77, v77
    v_cvt_pk_f16_f32 v78, v116, v117
    v_cvt_pk_f16_f32 v79, v118, v119
    v_pk_fmac_f16 v49, v78, v78
    v_pk_fmac_f16 v49, v79, v79
    v_cvt_pk_f16_f32 v154, v84, v85
    v_cvt_pk_f16_f32 v155, v86, v87
    v_pk_fmac_f16 v49, v154, v154
    v_pk_fmac_f16 v49, v155, v155
    v_cvt_pk_f16_f32 v97, v54, v55
    v_pk_fmac_f16 v81, v96, v96
    v_mfma_f32_16x16x32_f16 v[52:55], v[212:215], v[48:51], 0
    buffer_load_dwordx4 v166, s[76:79], s92 offen offset:1024 lds
    v_pk_fmac_f16 v81, v97, v97
    v_mov_b32 v171, 0
    v_mov_b32 v167, 0
    v_mfma_f32_16x16x32_f16 v[48:51], v[212:215], v[80:83], 0
    s_nop 0
    v_mov_b32 v163, 0
    v_mov_b32 v159, 0
    v_mov_b32 v150, 0
    v_mov_b32 v151, 0
    v_mov_b32 v144, 0
    v_mov_b32 v145, 0
    v_mov_b32 v138, 0
    v_or3_b32 v123, v123, v48, v49
    v_rsq_f32 v48, v48
    v_rsq_f32 v49, v49
    v_mul_f32 v48, s52, v48
    v_cvt_pk_f16_f32 v48, v48, v49
    s_waitcnt vmcnt(8)
    ds_read_b64_tr_b16 a[156:157], v139 offset:36864
    buffer_load_dwordx4 v28, s[76:79], s92 offen offset:2048 lds
    s_add_u32 m0, s90, 12288
    s_mov_b32 s92, 12288
    ds_read_b64_tr_b16 a[158:159], v139 offset:37632
    v_or3_b32 v123, v123, v50, v51
    v_rsq_f32 v50, v50
    ds_read_b64_tr_b16 a[180:181], v139 offset:36872
    v_rsq_f32 v51, v51
    v_mul_f32 v50, s52, v50
    ds_read_b64_tr_b16 a[182:183], v139 offset:37640
    v_cvt_pk_f16_f32 v50, v50, v51
    ds_read_b64_tr_b16 a[204:205], v17 offset:36928
    s_waitcnt lgkmcnt(5)
    buffer_load_dwordx4 v4, s[76:79], s92 offen offset:0 lds
    ds_read_b64_tr_b16 a[206:207], v17 offset:37696
    v_pk_mul_f16 v20, v20, v48 op_sel:[0,0] op_sel_hi:[1,0]
    v_pk_mul_f16 v21, v21, v48 op_sel:[0,0] op_sel_hi:[1,0]
    v_pk_mul_f16 v22, v22, v48 op_sel:[0,0] op_sel_hi:[1,0]
    v_pk_mul_f16 v23, v23, v48 op_sel:[0,0] op_sel_hi:[1,0]
    v_pk_mul_f16 v88, v88, v48 op_sel:[0,0] op_sel_hi:[1,0]
    v_pk_mul_f16 v89, v89, v48 op_sel:[0,0] op_sel_hi:[1,0]
    v_pk_mul_f16 v60, v60, v48 op_sel:[0,1] op_sel_hi:[1,1]
    v_pk_mul_f16 v61, v61, v48 op_sel:[0,1] op_sel_hi:[1,1]
    v_pk_mul_f16 v62, v62, v48 op_sel:[0,1] op_sel_hi:[1,1]
    v_pk_mul_f16 v63, v63, v48 op_sel:[0,1] op_sel_hi:[1,1]
    v_pk_mul_f16 v96, v96, v48 op_sel:[0,1] op_sel_hi:[1,1]
    v_pk_mul_f16 v97, v97, v48 op_sel:[0,1] op_sel_hi:[1,1]
    v_fma_mix_f32 v8, v20, v60, 0 op_sel:[0,0,0] op_sel_hi:[1,1,0]
    v_fma_mix_f32 v8, v20, v60, v8 op_sel:[1,1,0] op_sel_hi:[1,1,0]
    v_fma_mix_f32 v8, v21, v61, v8 op_sel:[0,0,0] op_sel_hi:[1,1,0]
    buffer_load_dwordx4 v166, s[76:79], s92 offen offset:1024 lds
    ds_write_b128 v5, v[60:63]
    v_fma_mix_f32 v8, v21, v61, v8 op_sel:[1,1,0] op_sel_hi:[1,1,0]
    v_fma_mix_f32 v8, v22, v62, v8 op_sel:[0,0,0] op_sel_hi:[1,1,0]
    v_fma_mix_f32 v8, v22, v62, v8 op_sel:[1,1,0] op_sel_hi:[1,1,0]
    v_fma_mix_f32 v8, v23, v63, v8 op_sel:[0,0,0] op_sel_hi:[1,1,0]
    v_fma_mix_f32 v8, v23, v63, v8 op_sel:[1,1,0] op_sel_hi:[1,1,0]
    v_fma_mix_f32 v8, v88, v96, v8 op_sel:[0,0,0] op_sel_hi:[1,1,0]
    v_fma_mix_f32 v8, v88, v96, v8 op_sel:[1,1,0] op_sel_hi:[1,1,0]
    v_fma_mix_f32 v8, v89, v97, v8 op_sel:[0,0,0] op_sel_hi:[1,1,0]
    v_fma_mix_f32 v8, v89, v97, v8 op_sel:[1,1,0] op_sel_hi:[1,1,0]
    v_mov_b32 v142, v8
    s_waitcnt vmcnt(8)
    ds_read_b64_tr_b16 a[160:161], v139 offset:49152
    buffer_load_dwordx4 v28, s[76:79], s92 offen offset:2048 lds
    s_add_u32 m0, s90, 24576
    s_mov_b32 s92, 24576
    ds_read_b64_tr_b16 a[162:163], v139 offset:49920
    v_permlane32_swap_b32 v142, v8
    v_add_f32 v8, v142, v8
    ds_read_b64_tr_b16 a[184:185], v139 offset:49160
    v_mov_b32 v142, v8
    v_or3_b32 v123, v123, v52, v53
    v_rsq_f32 v52, v52
    ds_read_b64_tr_b16 a[186:187], v139 offset:49928
    v_permlane16_swap_b32 v142, v8
    ds_read_b64_tr_b16 a[208:209], v17 offset:49216
    buffer_load_dwordx4 v4, s[76:79], s92 offen offset:0 lds
    ds_read_b64_tr_b16 a[210:211], v17 offset:49984
    v_add_f32 v8, v142, v8
    ds_write_b128 v5, v[20:23] offset:32
    v_rsq_f32 v53, v53
    v_mul_f32 v52, s52, v52
    v_cvt_pk_f16_f32 v52, v52, v53
    v_or3_b32 v123, v123, v54, v55
    v_rsq_f32 v54, v54
    buffer_load_dwordx4 v166, s[76:79], s92 offen offset:1024 lds
    ds_write2_b64 v5, v[96:97], v[30:31] offset0:6 offset1:7
    v_rsq_f32 v55, v55
    v_mul_f32 v54, s52, v54
    v_cvt_pk_f16_f32 v54, v54, v55
    v_pk_mul_f16 v76, v76, v52 op_sel:[0,1] op_sel_hi:[1,1]
    v_pk_mul_f16 v77, v77, v52 op_sel:[0,1] op_sel_hi:[1,1]
    v_pk_mul_f16 v78, v78, v52 op_sel:[0,1] op_sel_hi:[1,1]
    v_pk_mul_f16 v79, v79, v52 op_sel:[0,1] op_sel_hi:[1,1]
    ds_write2_b64 v5, v[30:31], v[88:89] offset0:8 offset1:9
    buffer_load_dwordx4 v28, s[76:79], s92 offen offset:2048 lds
    s_add_u32 m0, s90, 36864
    s_mov_b32 s92, 36864
    v_pk_mul_f16 v154, v154, v52 op_sel:[0,1] op_sel_hi:[1,1]
    v_pk_mul_f16 v155, v155, v52 op_sel:[0,1] op_sel_hi:[1,1]
    v_pk_mul_f16 v104, v104, v52 op_sel:[0,0] op_sel_hi:[1,0]
    v_pk_mul_f16 v105, v105, v52 op_sel:[0,0] op_sel_hi:[1,0]
    v_pk_mul_f16 v106, v106, v52 op_sel:[0,0] op_sel_hi:[1,0]
    s_waitcnt vmcnt(9)
    ds_read_b64_tr_b16 a[164:165], v139 offset:61440
    v_pk_mul_f16 v107, v107, v52 op_sel:[0,0] op_sel_hi:[1,0]
    v_pk_mul_f16 v152, v152, v52 op_sel:[0,0] op_sel_hi:[1,0]
    v_pk_mul_f16 v153, v153, v52 op_sel:[0,0] op_sel_hi:[1,0]
    v_mfma_f32_16x16x32_f16 v[84:87], v[76:79], v[104:107], v[204:207]
    s_waitcnt lgkmcnt(2)
    ds_read_b64_tr_b16 a[166:167], v139 offset:62208
    buffer_load_dwordx4 v4, s[76:79], s92 offen offset:0 lds
    v_mfma_f32_16x16x32_f16 v[84:87], v[152:155], v[150:153], v[84:87]
    ds_read_b64_tr_b16 a[188:189], v139 offset:61448
    v_pk_mul_f16 v32, v32, v54 op_sel:[0,1] op_sel_hi:[1,1]
    v_mfma_f32_16x16x32_bf16 v[20:23], a[144:147], v[232:235], 0
    ds_read_b64_tr_b16 a[190:191], v139 offset:62216
    v_pk_mul_f16 v33, v33, v54 op_sel:[0,1] op_sel_hi:[1,1]
    v_mfma_f32_16x16x32_bf16 v[20:23], a[148:151], v[228:231], v[20:23]
    ds_read_b64_tr_b16 a[212:213], v17 offset:61504
    v_pk_mul_f16 v34, v34, v54 op_sel:[0,1] op_sel_hi:[1,1]
    v_mfma_f32_16x16x32_bf16 v[20:23], a[152:155], v[100:103], v[20:23]
    ds_read_b64_tr_b16 a[214:215], v17 offset:62272
    v_pk_mul_f16 v35, v35, v54 op_sel:[0,1] op_sel_hi:[1,1]
    v_mfma_f32_16x16x32_bf16 v[20:23], a[156:159], v[44:47], v[20:23]
    v_pk_mul_f16 v148, v148, v54 op_sel:[0,1] op_sel_hi:[1,1]
    v_pk_mul_f16 v149, v149, v54 op_sel:[0,1] op_sel_hi:[1,1]
    v_mfma_f32_16x16x32_bf16 v[20:23], a[160:163], v[36:39], v[20:23]
    buffer_load_dwordx4 v166, s[76:79], s92 offen offset:1024 lds
    v_pk_mul_f16 v24, v24, v54 op_sel:[0,0] op_sel_hi:[1,0]
    v_pk_mul_f16 v25, v25, v54 op_sel:[0,0] op_sel_hi:[1,0]
    v_pk_mul_f16 v26, v26, v54 op_sel:[0,0] op_sel_hi:[1,0]
    v_pk_mul_f16 v27, v27, v54 op_sel:[0,0] op_sel_hi:[1,0]
    v_pk_mul_f16 v146, v146, v54 op_sel:[0,0] op_sel_hi:[1,0]
    v_pk_mul_f16 v147, v147, v54 op_sel:[0,0] op_sel_hi:[1,0]
    v_mov_b32 v139, 0
    v_add_f32 v8, s84, v8
    v_exp_f32 v8, v8
    s_waitcnt lgkmcnt(4)
    v_mfma_f32_16x16x32_bf16 v[20:23], a[164:167], v[92:95], v[20:23]
    ds_read_b128 v[224:227], v7 offset:3072
    v_cvt_pk_bf16_f32 v8, v8, 0
    v_mfma_f32_16x16x32_bf16 v[80:83], a[168:171], v[232:235], 0
    s_nop 0
    buffer_load_dwordx4 v28, s[76:79], s92 offen offset:2048 lds
    ds_read_b128 v[116:119], v6 offset:3072
    v_mfma_f32_16x16x32_bf16 v[80:83], a[172:175], v[228:231], v[80:83]
    s_add_u32 m0, s90, 49152
    v_cvt_pk_bf16_f32 v30, v20, v21
    v_cvt_pk_bf16_f32 v31, v22, v23
    v_mfma_f32_16x16x32_bf16 v[80:83], a[176:179], v[100:103], v[80:83]
    s_mov_b32 s92, 49152
    ds_write_b64 v29, v[30:31] offset:28752
    v_mfma_f32_16x16x32_bf16 v[80:83], a[180:183], v[44:47], v[80:83]
    v_cmp_gt_u32 vcc, 16, v2
    v_cvt_pk_f16_f32 v112, v112, v113
    v_mfma_f32_16x16x32_bf16 v[80:83], a[184:187], v[36:39], v[80:83]
    s_waitcnt lgkmcnt(3)
    ds_read_b128 v[60:63], v7 offset:3200
    v_cndmask_b32 v8, 0, v8, vcc
    v_mfma_f32_16x16x32_bf16 v[80:83], a[188:191], v[92:95], v[80:83]
    buffer_load_dwordx4 v4, s[76:79], s92 offen offset:0 lds
    ds_read_b128 v[52:55], v6 offset:3200
    v_mfma_f32_16x16x32_bf16 v[20:23], a[192:195], v[232:235], 0
    v_cvt_pk_f16_f32 v113, v114, v115
    v_pk_fma_f16 v17, v112, v112, s39
    v_mfma_f32_16x16x32_bf16 v[20:23], a[196:199], v[228:231], v[20:23]
    ds_write_b64 v5, v[8:9] offset:88
    v_mfma_f32_16x16x32_bf16 v[20:23], a[200:203], v[100:103], v[20:23]
    v_cvt_pk_bf16_f32 v80, v80, v81
    v_cvt_pk_bf16_f32 v81, v82, v83
    v_mfma_f32_16x16x32_bf16 v[20:23], a[204:207], v[44:47], v[20:23]
    ds_read_b128 v[44:47], v7 offset:3328
    v_pk_fmac_f16 v17, v113, v113
    v_mfma_f32_16x16x32_bf16 v[20:23], a[208:211], v[36:39], v[20:23]
    buffer_load_dwordx4 v166, s[76:79], s92 offen offset:1024 lds
    ds_read_b128 v[36:39], v6 offset:3328
    v_mfma_f32_16x16x32_bf16 v[20:23], a[212:215], v[92:95], v[20:23]
    v_cvt_pk_f16_f32 v114, v12, v13
    v_cvt_pk_f16_f32 v115, v14, v15
    v_mfma_f32_16x16x32_f16 v[12:15], v[32:35], v[104:107], v[200:203]
    v_pk_fmac_f16 v17, v114, v114
    v_pk_fmac_f16 v17, v115, v115
    v_mfma_f32_16x16x32_f16 v[12:15], v[146:149], v[150:153], v[12:15]
    s_waitcnt lgkmcnt(4)
    s_nop 0
    v_cvt_pk_bf16_f32 v82, v20, v21
    v_cvt_pk_bf16_f32 v83, v22, v23
    v_mfma_f32_16x16x32_bf16 v[20:23], v[224:227], a[144:147], 0
    ds_write_b128 v29, v[80:83] offset:28768
    v_mfma_f32_16x16x32_bf16 v[20:23], v[116:119], a[148:151], v[20:23]
    buffer_load_dwordx4 v28, s[76:79], s92 offen offset:2048 lds
    v_cvt_pk_f16_f32 v142, v68, v69
    v_mfma_f32_16x16x32_bf16 v[20:23], v[60:63], a[152:155], v[20:23]
    s_waitcnt lgkmcnt(3)
    s_add_u32 m0, s90, 61440
    v_cvt_pk_f16_f32 v143, v70, v71
    v_pk_fmac_f16 v17, v142, v142
    v_mfma_f32_16x16x32_bf16 v[20:23], v[52:55], a[156:159], v[20:23]
    s_waitcnt lgkmcnt(2)
    s_mov_b32 s92, 61440
    ds_read_b128 v[100:103], v132 offset:0
    v_pk_fmac_f16 v17, v143, v143
    v_mfma_f32_16x16x32_bf16 v[20:23], v[44:47], a[160:163], v[20:23]
    s_waitcnt lgkmcnt(2)
    ds_read_b128 v[92:95], v132 offset:16
    v_pk_mul_f16 v56, v56, v50 op_sel:[0,0] op_sel_hi:[1,0]
    v_mfma_f32_16x16x32_bf16 v[20:23], v[36:39], a[164:167], v[20:23]
    s_nop 0
    buffer_load_dwordx4 v4, s[76:79], s92 offen offset:0 lds
    ds_read_b128 v[68:71], v132 offset:48
    v_mfma_f32_16x16x32_bf16 v[80:83], v[224:227], a[168:171], 0
    s_nop 0
    v_exp_f32 v84, v84
    v_mfma_f32_16x16x32_bf16 v[80:83], v[116:119], a[172:175], v[80:83]
    s_nop 0
    v_cvt_pk_bf16_f32 v164, v20, v21
    v_cvt_pk_bf16_f32 v165, v22, v23
    v_mfma_f32_16x16x32_bf16 v[80:83], v[60:63], a[176:179], v[80:83]
    v_exp_f32 v85, v85
    v_mfma_f32_16x16x32_bf16 v[80:83], v[52:55], a[180:183], v[80:83]
    v_exp_f32 v86, v86
    v_mfma_f32_16x16x32_bf16 v[80:83], v[44:47], a[184:187], v[80:83]
    buffer_load_dwordx4 v166, s[76:79], s92 offen offset:1024 lds
    v_cvt_pk_bf16_f32 v84, v84, v85
    v_mfma_f32_16x16x32_bf16 v[80:83], v[36:39], a[188:191], v[80:83]
    s_nop 0
    v_exp_f32 v87, v87
    v_mfma_f32_16x16x32_bf16 v[20:23], v[224:227], a[192:195], 0
    s_nop 0
    v_cvt_pk_bf16_f32 v85, v86, v87
    v_pk_mul_f16 v57, v57, v50 op_sel:[0,0] op_sel_hi:[1,0]
    v_mfma_f32_16x16x32_bf16 v[20:23], v[116:119], a[196:199], v[20:23]
    s_nop 0
    v_cvt_pk_bf16_f32 v160, v80, v81
    v_cvt_pk_bf16_f32 v161, v82, v83
    v_mfma_f32_16x16x32_bf16 v[20:23], v[60:63], a[200:203], v[20:23]
    v_exp_f32 v12, v12
    v_mfma_f32_16x16x32_bf16 v[20:23], v[52:55], a[204:207], v[20:23]
    buffer_load_dwordx4 v28, s[76:79], s92 offen offset:2048 lds
    ds_read_u16 v166, v131 offset:80
    v_mfma_f32_16x16x32_bf16 v[20:23], v[44:47], a[208:211], v[20:23]
    s_add_u32 m0, s54, 20480
    ds_read_u16 v162, v131 offset:96
    v_pk_mul_f16 v58, v58, v50 op_sel:[0,0] op_sel_hi:[1,0]
    v_mfma_f32_16x16x32_bf16 v[20:23], v[36:39], a[212:215], v[20:23]
    s_waitcnt lgkmcnt(2)
    ds_read_u16 v158, v131 offset:104
    v_pk_mul_f16 v59, v59, v50 op_sel:[0,0] op_sel_hi:[1,0]
    v_mfma_f32_16x16x32_f16 v[52:55], v[100:103], v[104:107], v[208:211]
    s_nop 0
    v_exp_f32 v13, v13
    v_mfma_f32_16x16x32_f16 v[52:55], v[92:95], v[76:79], v[52:55]
    s_nop 0
    v_cvt_pk_bf16_f32 v156, v20, v21
    v_cvt_pk_bf16_f32 v157, v22, v23
    v_mfma_f32_16x16x32_f16 v[52:55], v[68:71], v[152:155], v[52:55]
    buffer_load_dwordx4 v128, s[24:27], s56 offen nt lds
    v_cvt_pk_bf16_f32 v86, v12, v13
    v_mfma_f32_16x16x32_f16 v[44:47], v[100:103], v[24:27], v[208:211]
    s_add_u32 m0, s54, 21504
    ds_read_b128 v[20:23], v7 offset:42496
    v_pk_mul_f16 v40, v40, v50 op_sel:[0,0] op_sel_hi:[1,0]
    v_mfma_f32_16x16x32_f16 v[44:47], v[92:95], v[32:35], v[44:47]
    ds_read_b128 v[244:247], v6 offset:42496
    v_pk_mul_f16 v41, v41, v50 op_sel:[0,0] op_sel_hi:[1,0]
    v_mfma_f32_16x16x32_f16 v[44:47], v[68:71], v[146:149], v[44:47]
    ds_read_b128 v[240:243], v7 offset:42624
    v_pk_mul_f16 v72, v72, v50 op_sel:[0,1] op_sel_hi:[1,1]
    v_mfma_f32_16x16x32_f16 v[80:83], v[212:215], v[16:19], 0
    ds_read_b128 v[236:239], v6 offset:42624
    v_pk_mul_f16 v73, v73, v50 op_sel:[0,1] op_sel_hi:[1,1]
    v_mfma_f32_16x16x32_f16 v[16:19], v[76:79], v[24:27], v[192:195]
    buffer_load_dwordx4 v127, s[24:27], s56 offen nt lds
    ds_read_b128 v[232:235], v7 offset:42752
    v_mfma_f32_16x16x32_f16 v[16:19], v[152:155], v[144:147], v[16:19]
    s_add_u32 m0, s54, 22528
    v_mov_b32_dpp v55, v47 quad_perm:[0,1,2,3] row_mask:0x2 bank_mask:0xf
    v_or3_b32 v123, v123, v80, v81
    v_mfma_f32_16x16x32_f16 v[36:39], v[32:35], v[24:27], v[188:191]
    ds_read_b128 v[224:227], v6 offset:42752
    v_pk_mul_f16 v74, v74, v50 op_sel:[0,1] op_sel_hi:[1,1]
    v_mfma_f32_16x16x32_f16 v[36:39], v[146:149], v[144:147], v[36:39]
    s_waitcnt lgkmcnt(5)
    v_rsq_f32 v80, v80
    v_rsq_f32 v81, v81
    v_mul_f32 v80, s52, v80
    v_cvt_pk_f16_f32 v80, v80, v81
    v_pk_mul_f16 v112, v112, v80 op_sel:[0,1] op_sel_hi:[1,1]
    v_mfma_f32_16x16x32_bf16 v[60:63], a[144:147], v[20:23], 0
    s_waitcnt lgkmcnt(4)
    buffer_load_dwordx4 v126, s[24:27], s56 offen nt lds
    v_pk_mul_f16 v113, v113, v80 op_sel:[0,1] op_sel_hi:[1,1]
    v_mfma_f32_16x16x32_bf16 v[60:63], a[148:151], v[244:247], v[60:63]
    s_waitcnt lgkmcnt(3)
    s_add_u32 m0, s54, 23552
    v_pk_mul_f16 v114, v114, v80 op_sel:[0,1] op_sel_hi:[1,1]
    v_pk_mul_f16 v115, v115, v80 op_sel:[0,1] op_sel_hi:[1,1]
    v_mfma_f32_16x16x32_bf16 v[60:63], a[152:155], v[240:243], v[60:63]
    s_waitcnt lgkmcnt(2)
    v_pk_mul_f16 v142, v142, v80 op_sel:[0,1] op_sel_hi:[1,1]
    v_pk_mul_f16 v143, v143, v80 op_sel:[0,1] op_sel_hi:[1,1]
    v_mfma_f32_16x16x32_bf16 v[60:63], a[156:159], v[236:239], v[60:63]
    s_waitcnt lgkmcnt(1)
    v_pk_mul_f16 v108, v108, v80 op_sel:[0,0] op_sel_hi:[1,0]
    v_pk_mul_f16 v109, v109, v80 op_sel:[0,0] op_sel_hi:[1,0]
    v_pk_mul_f16 v110, v110, v80 op_sel:[0,0] op_sel_hi:[1,0]
    v_mfma_f32_16x16x32_bf16 v[60:63], a[160:163], v[232:235], v[60:63]
    s_waitcnt lgkmcnt(0)
    v_pk_mul_f16 v111, v111, v80 op_sel:[0,0] op_sel_hi:[1,0]
    v_pk_mul_f16 v140, v140, v80 op_sel:[0,0] op_sel_hi:[1,0]
    v_pk_mul_f16 v141, v141, v80 op_sel:[0,0] op_sel_hi:[1,0]
    v_exp_f32 v14, v14
    v_mfma_f32_16x16x32_bf16 v[60:63], a[164:167], v[224:227], v[60:63]
    buffer_load_dwordx4 v125, s[24:27], s56 offen nt lds
    v_pk_mul_f16 v75, v75, v50 op_sel:[0,1] op_sel_hi:[1,1]
    v_mfma_f32_16x16x32_f16 v[80:83], v[112:115], v[104:107], v[196:199]
    s_add_u32 m0, s54, 24576
    v_exp_f32 v15, v15
    v_mfma_f32_16x16x32_f16 v[80:83], v[140:143], v[150:153], v[80:83]
    s_nop 0
    v_cvt_pk_bf16_f32 v87, v14, v15
    v_cvt_pk_bf16_f32 v30, v60, v61
    v_mfma_f32_16x16x32_f16 v[12:15], v[100:103], v[108:111], v[208:211]
    v_exp_f32 v52, v52
    v_mfma_f32_16x16x32_f16 v[12:15], v[92:95], v[112:115], v[12:15]
    buffer_load_dwordx4 v124, s[24:27], s56 offen nt lds
    v_cvt_pk_bf16_f32 v170, v52, 0
    v_mfma_f32_16x16x32_f16 v[12:15], v[68:71], v[140:143], v[12:15]
    s_cmp_lt_u32 s61, s71
    ds_read_b128 v[116:119], v7 offset:0
    v_cvt_pk_bf16_f32 v31, v62, v63
    v_mfma_f32_16x16x32_f16 v[68:71], v[112:115], v[24:27], v[184:187]
    s_cselect_b32 s15, s61, s12
    ds_read_b128 v[228:231], v6 offset:0
    v_pk_mul_f16 v42, v42, v50 op_sel:[0,1] op_sel_hi:[1,1]
    v_mfma_f32_16x16x32_f16 v[68:71], v[140:143], v[144:147], v[68:71]
    s_cselect_b32 s56, s69, s70
    ds_read_b128 v[104:107], v7 offset:128
    v_mov_b32_dpp v55, v15 quad_perm:[0,1,2,3] row_mask:0x4 bank_mask:0xf
    v_mfma_f32_16x16x32_bf16 v[24:27], a[168:171], v[20:23], 0
    s_add_u32 s56, s56, s15
    ds_read_b128 v[60:63], v6 offset:128
    v_pk_mul_f16 v43, v43, v50 op_sel:[0,1] op_sel_hi:[1,1]
    v_mfma_f32_16x16x32_bf16 v[24:27], a[172:175], v[244:247], v[24:27]
    s_mul_i32 s53, s56, 58255
    buffer_load_dword v28, v126, s[28:31], s72 offen nt
    ds_read_b128 v[92:95], v7 offset:256
    v_mfma_f32_16x16x32_bf16 v[24:27], a[176:179], v[240:243], v[24:27]
    s_lshr_b32 s53, s53, 22
    v_exp_f32 v55, v55
    v_mfma_f32_16x16x32_bf16 v[24:27], a[180:183], v[236:239], v[24:27]
    s_mul_i32 s53, s53, s63
    ds_read_b128 v[48:51], v6 offset:256
    v_cvt_pk_bf16_f32 v55, v55, v55
    v_mfma_f32_16x16x32_bf16 v[24:27], a[184:187], v[232:235], v[24:27]
    s_mul_i32 s56, s56, s62
    ds_write_b16 v131, v55 offset:64
    v_mfma_f32_16x16x32_bf16 v[24:27], a[188:191], v[224:227], v[24:27]
    s_add_u32 s56, s56, s53
    ds_read_b128 v[52:55], v132 offset:48
    v_fma_mix_f32 v12, v56, v72, 0 op_sel:[0,0,0] op_sel_hi:[1,1,0]
    v_mfma_f32_16x16x32_bf16 v[100:103], a[192:195], v[20:23], 0
    s_mul_i32 s4, s15, 112
    ds_read_b128 v[20:23], v132 offset:64
    v_fma_mix_f32 v12, v56, v72, v12 op_sel:[1,1,0] op_sel_hi:[1,1,0]
    v_mfma_f32_16x16x32_bf16 v[100:103], a[196:199], v[244:247], v[100:103]
    s_cmp_ge_u32 s15, 16
    v_exp_f32 v80, v80
    v_mfma_f32_16x16x32_bf16 v[100:103], a[200:203], v[240:243], v[100:103]
    s_cselect_b32 s53, -30464, 0
    v_exp_f32 v81, v81
    v_mfma_f32_16x16x32_bf16 v[100:103], a[204:207], v[236:239], v[100:103]
    s_add_u32 s4, s4, s53
    v_exp_f32 v82, v82
    v_mfma_f32_16x16x32_bf16 v[100:103], a[208:211], v[232:235], v[100:103]
    s_cmp_lt_u32 s15, s73
    v_exp_f32 v83, v83
    v_mfma_f32_16x16x32_bf16 v[100:103], a[212:215], v[224:227], v[100:103]
    s_waitcnt lgkmcnt(4)
    s_cselect_b32 s26, 100270464, 0
    v_cvt_pk_bf16_f32 v168, v80, v81
    v_cvt_pk_bf16_f32 v169, v82, v83
    v_mfma_f32_16x16x32_bf16 v[80:83], v[116:119], a[144:147], 0
    s_cselect_b32 s56, s56, 0
    v_exp_f32 v16, v16
    v_mfma_f32_16x16x32_bf16 v[80:83], v[228:231], a[148:151], v[80:83]
    s_cselect_b32 s4, s4, -1
    v_exp_f32 v17, v17
    v_mfma_f32_16x16x32_bf16 v[80:83], v[104:107], a[152:155], v[80:83]
    s_cselect_b32 s15, s15, 0
    v_exp_f32 v18, v18
    v_mfma_f32_16x16x32_bf16 v[80:83], v[60:63], a[156:159], v[80:83]
    s_cselect_b32 s13, s13, -1
    v_exp_f32 v19, v19
    v_mfma_f32_16x16x32_bf16 v[80:83], v[92:95], a[160:163], v[80:83]
    s_waitcnt lgkmcnt(0)
    s_bitset1_b32 s64, s15
    v_cvt_pk_bf16_f32 v224, v16, v17
    v_cvt_pk_bf16_f32 v225, v18, v19
    v_mfma_f32_16x16x32_bf16 v[80:83], v[48:51], a[164:167], v[80:83]
    s_waitcnt vmcnt(6)
    s_cmp_ge_i32 s65, 2
    v_exp_f32 v36, v36
    v_exp_f32 v37, v37
    s_cselect_b32 s30, 100270464, 0
    v_mfma_f32_16x16x32_bf16 v[16:19], v[116:119], a[168:171], 0
    s_barrier
    v_exp_f32 v38, v38
    v_mfma_f32_16x16x32_bf16 v[16:19], v[228:231], a[172:175], v[16:19]
    s_lshl_b32 s93, s68, 10
    v_exp_f32 v39, v39
    v_mfma_f32_16x16x32_bf16 v[16:19], v[104:107], a[176:179], v[16:19]
    s_mov_b32 s53, s47
    v_cvt_pk_bf16_f32 v226, v36, v37
    v_cvt_pk_bf16_f32 v227, v38, v39
    v_mfma_f32_16x16x32_bf16 v[16:19], v[60:63], a[180:183], v[16:19]
    s_mov_b32 s47, s46
    v_exp_f32 v68, v68
    v_mfma_f32_16x16x32_bf16 v[16:19], v[92:95], a[184:187], v[16:19]
    s_mov_b32 s46, s45
    v_exp_f32 v69, v69
    v_mfma_f32_16x16x32_bf16 v[16:19], v[48:51], a[188:191], v[16:19]
    s_mov_b32 s45, s44
    ds_read_b128 v[236:239], v11 offset:0
    v_cvt_pk_bf16_f32 v24, v24, v25
    v_exp_f32 v70, v70
    v_exp_f32 v71, v71
    v_exp_f32 v45, v45
    v_mfma_f32_16x16x32_bf16 v[36:39], v[116:119], a[192:195], 0
    s_mov_b32 s44, s53
    ds_read_b64 v[116:117], v10 offset:64
    v_cvt_pk_bf16_f32 v25, v26, v27
    v_mfma_f32_16x16x32_bf16 v[36:39], v[228:231], a[196:199], v[36:39]
    s_sub_u32 s48, s44, s46
    ds_read_b128 v[232:235], v11 offset:3072
    v_cvt_pk_bf16_f32 v26, v100, v101
    v_mfma_f32_16x16x32_bf16 v[36:39], v[104:107], a[200:203], v[36:39]
    s_sub_u32 s49, s46, s45
    ds_read_b64 v[118:119], v10 offset:3136
    v_cvt_pk_bf16_f32 v27, v102, v103
    v_mfma_f32_16x16x32_bf16 v[36:39], v[60:63], a[204:207], v[36:39]
    ds_read_b128 v[60:63], v11 offset:6144
    v_cvt_pk_bf16_f32 v0, v80, v81
    v_mfma_f32_16x16x32_bf16 v[36:39], v[92:95], a[208:211], v[36:39]
    ds_read_b64 v[100:101], v10 offset:6208
    v_cvt_pk_bf16_f32 v1, v82, v83
    v_mfma_f32_16x16x32_bf16 v[36:39], v[48:51], a[212:215], v[36:39]
    ds_read_b128 v[80:83], v11 offset:9216
    v_cvt_pk_bf16_f32 v8, v16, v17
    v_mfma_f32_16x16x32_bf16 v[92:95], v[220:223], v[84:87], 0
    ds_read_b64 v[102:103], v10 offset:9280
    v_cvt_pk_bf16_f32 v9, v18, v19
    v_mfma_f32_16x16x32_bf16 v[92:95], v[220:223], v[168:171], v[92:95]
    s_nop 0
    ds_read_b128 v[48:51], v11 offset:12288
    v_cvt_pk_bf16_f32 v4, v36, v37
    v_mfma_f32_16x16x32_f16 v[16:19], v[76:79], v[108:111], v[180:183]
    ds_read_b64 v[104:105], v10 offset:12352
    v_cvt_pk_bf16_f32 v5, v38, v39
    v_mfma_f32_16x16x32_f16 v[16:19], v[152:155], v[138:141], v[16:19]
    ds_read_b128 v[76:79], v11 offset:15360
    v_fma_mix_f32 v12, v57, v73, v12 op_sel:[0,0,0] op_sel_hi:[1,1,0]
    v_mfma_f32_16x16x32_f16 v[36:39], v[32:35], v[108:111], v[176:179]
    ds_read_b64 v[106:107], v10 offset:15424
    v_fma_mix_f32 v12, v57, v73, v12 op_sel:[1,1,0] op_sel_hi:[1,1,0]
    v_mfma_f32_16x16x32_f16 v[36:39], v[146:149], v[138:141], v[36:39]
    ds_read_b128 v[228:231], v11 offset:18432
    v_fma_mix_f32 v12, v58, v74, v12 op_sel:[0,0,0] op_sel_hi:[1,1,0]
    v_mfma_f32_16x16x32_f16 v[32:35], v[112:115], v[108:111], v[172:175]
    ds_read_b64 v[152:153], v10 offset:18496
    v_fma_mix_f32 v12, v58, v74, v12 op_sel:[1,1,0] op_sel_hi:[1,1,0]
    v_mfma_f32_16x16x32_f16 v[32:35], v[140:143], v[138:141], v[32:35]
    s_waitcnt lgkmcnt(8)
    ds_read_b128 v[108:111], v11 offset:21504
    v_fma_mix_f32 v12, v59, v75, v12 op_sel:[0,0,0] op_sel_hi:[1,1,0]
    v_mfma_f32_16x16x32_bf16 v[112:115], v[236:239], v[220:223], 0
    ds_read_b64 v[154:155], v10 offset:21568
    v_fma_mix_f32 v12, v59, v75, v12 op_sel:[1,1,0] op_sel_hi:[1,1,0]
    v_mfma_f32_16x16x32_bf16 v[112:115], v[232:235], v[220:223], v[112:115]
    ds_read_b128 v[140:143], v11 offset:24576
    v_fma_mix_f32 v12, v40, v42, v12 op_sel:[0,0,0] op_sel_hi:[1,1,0]
    v_mfma_f32_16x16x32_bf16 v[112:115], v[60:63], v[220:223], v[112:115]
    s_waitcnt lgkmcnt(8)
    ds_read_b64 v[60:61], v10 offset:24640
    v_fma_mix_f32 v12, v40, v42, v12 op_sel:[1,1,0] op_sel_hi:[1,1,0]
    v_mfma_f32_16x16x32_bf16 v[112:115], v[80:83], v[220:223], v[112:115]
    ds_read_b128 v[80:83], v11 offset:27648
    v_fma_mix_f32 v12, v41, v43, v12 op_sel:[0,0,0] op_sel_hi:[1,1,0]
    v_mfma_f32_16x16x32_bf16 v[112:115], v[116:119], v[220:223], v[112:115]
    ds_read_b64 v[62:63], v10 offset:27712
    v_fma_mix_f32 v12, v41, v43, v12 op_sel:[1,1,0] op_sel_hi:[1,1,0]
    v_mfma_f32_16x16x32_bf16 v[112:115], v[100:103], v[220:223], v[112:115]
L_pg1:
    s_cbranch_execz L_main
    s_add_u32 m0, s67, 0
    ds_read_b128 v[100:103], v11 offset:30720
    v_mov_b32 v3, v12
    v_mfma_f32_16x16x32_bf16 v[116:119], v[48:51], v[220:223], 0
    s_waitcnt lgkmcnt(8)
    ds_read_b64 v[48:49], v10 offset:30784
    v_and_b32 v13, 0xb8000000, v123
    v_mfma_f32_16x16x32_bf16 v[116:119], v[76:79], v[220:223], v[116:119]
    ds_read_b128 v[76:79], v11 offset:33792
    v_mul_f32 v112, 0xbbaaaaab, v112
    v_mfma_f32_16x16x32_bf16 v[116:119], v[228:231], v[220:223], v[116:119]
    s_waitcnt lgkmcnt(8)
    ds_read_b64 v[50:51], v10 offset:33856
    v_mul_f32 v113, 0xbbaaaaab, v113
    v_mfma_f32_16x16x32_bf16 v[116:119], v[108:111], v[220:223], v[116:119]
    ds_read_b128 v[108:111], v7 offset:1536
    v_mul_f32 v114, 0xbbaaaaab, v114
    v_mfma_f32_16x16x32_bf16 v[116:119], v[104:107], v[220:223], v[116:119]
    s_waitcnt lgkmcnt(8)
    ds_read_b128 v[104:107], v6 offset:1536
    v_mul_f32 v115, 0xbbaaaaab, v115
    v_mfma_f32_16x16x32_bf16 v[116:119], v[152:155], v[220:223], v[116:119]
    ds_write_b128 v120, v[112:115] offset:0
    v_mfma_f32_16x16x32_bf16 v[112:115], v[140:143], v[220:223], 0
    s_waitcnt lgkmcnt(7)
    v_rcp_f32 v92, v92
    v_mfma_f32_16x16x32_bf16 v[112:115], v[80:83], v[220:223], v[112:115]
    s_waitcnt lgkmcnt(6)
    v_permlane32_swap_b32 v3, v12
    v_mfma_f32_16x16x32_bf16 v[112:115], v[100:103], v[220:223], v[112:115]
    s_waitcnt lgkmcnt(4)
    ds_read_b128 v[100:103], v7 offset:1664
    v_add_f32 v12, v3, v12
    v_mov_b32 v3, v12
    v_mul_f32 v116, 0xbbaaaaab, v116
    v_mfma_f32_16x16x32_bf16 v[112:115], v[76:79], v[220:223], v[112:115]
    ds_read_b128 v[80:83], v6 offset:1664
    v_mul_f32 v117, 0xbbaaaaab, v117
    v_mfma_f32_16x16x32_bf16 v[112:115], v[60:63], v[220:223], v[112:115]
    s_waitcnt lgkmcnt(4)
    ds_read_b128 v[76:79], v7 offset:1792
    v_mul_f32 v118, 0xbbaaaaab, v118
    v_mfma_f32_16x16x32_bf16 v[112:115], v[48:51], v[220:223], v[112:115]
    ds_read_b128 v[48:51], v6 offset:1792
    v_mul_f32 v119, 0xbbaaaaab, v119
    v_mfma_f32_16x16x32_bf16 v[60:63], v[108:111], a[144:147], 0
    s_waitcnt lgkmcnt(4)
    ds_write_b128 v120, v[116:119] offset:128
    v_mfma_f32_16x16x32_bf16 v[60:63], v[104:107], a[148:151], v[60:63]
    s_waitcnt lgkmcnt(4)
    v_permlane16_swap_b32 v3, v12
    v_add_f32 v12, v3, v12
    v_add_f32 v12, s84, v12
    v_exp_f32 v12, v12
    v_mul_f32 v112, 0xbbaaaaab, v112
    v_cvt_pk_bf16_f32 v12, v12, 0
    v_cmp_gt_u32 vcc, 16, v2
    v_mul_f32 v113, 0xbbaaaaab, v113
    v_mfma_f32_16x16x32_bf16 v[60:63], v[100:103], a[152:155], v[60:63]
    s_waitcnt lgkmcnt(3)
    v_cndmask_b32 v12, 0, v12, vcc
    v_mul_f32 v114, 0xbbaaaaab, v114
    v_mul_f32 v115, 0xbbaaaaab, v115
    v_cmp_ne_u32 s[94:95], 0, v13
    v_mfma_f32_16x16x32_bf16 v[60:63], v[80:83], a[156:159], v[60:63]
    s_waitcnt lgkmcnt(1)
    ds_write_b128 v120, v[112:115] offset:256
    v_mfma_f32_16x16x32_bf16 v[60:63], v[76:79], a[160:163], v[60:63]
    s_barrier
    buffer_load_dwordx4 v128, s[24:27], s56 offen nt lds
    v_add_u32 v15, s93, v129
    v_mfma_f32_16x16x32_bf16 v[60:63], v[48:51], a[164:167], v[60:63]
    s_or_b32 s94, s94, s95
    v_mov_b32 v13, s94
    v_add_u32 v137, s48, v137
    v_mfma_f32_16x16x32_bf16 v[112:115], v[108:111], a[168:171], 0
    s_lshl_b32 s95, s68, 2
    v_mov_b32 v120, s95
    v_add_u32 v136, s48, v136
    v_mfma_f32_16x16x32_bf16 v[112:115], v[104:107], a[172:175], v[112:115]
    s_add_u32 m0, s67, 1024
    v_cvt_pk_bf16_f32 v2, v60, v61
    v_cvt_pk_bf16_f32 v3, v62, v63
    v_mfma_f32_16x16x32_bf16 v[112:115], v[100:103], a[176:179], v[112:115]
    buffer_load_dwordx4 v127, s[24:27], s56 offen nt lds
    v_mfma_f32_16x16x32_bf16 v[112:115], v[80:83], a[180:183], v[112:115]
    s_add_u32 m0, s67, 2048
    v_exp_f32 v16, v16
    v_mfma_f32_16x16x32_bf16 v[112:115], v[76:79], a[184:187], v[112:115]
    buffer_load_dwordx4 v126, s[24:27], s56 offen nt lds
    v_mfma_f32_16x16x32_bf16 v[112:115], v[48:51], a[188:191], v[112:115]
    s_waitcnt lgkmcnt(0)
    s_add_u32 m0, s67, 3072
    v_exp_f32 v17, v17
    v_mfma_f32_16x16x32_bf16 v[60:63], v[0:3], v[84:87], 0
    s_barrier
    buffer_load_dwordx4 v125, s[24:27], s56 offen nt lds
    v_cvt_pk_bf16_f32 v16, v16, v17
    v_mfma_f32_16x16x32_bf16 v[60:63], v[164:167], v[168:171], v[60:63]
    s_add_u32 m0, s67, 4096
    v_cvt_pk_bf16_f32 v10, v112, v113
    v_cvt_pk_bf16_f32 v11, v114, v115
    v_mfma_f32_16x16x32_bf16 v[112:115], v[108:111], a[192:195], 0
    ds_read_b128 v[228:231], v91 offset:24576
    buffer_load_dwordx4 v124, s[24:27], s56 offen nt lds
    v_mfma_f32_16x16x32_bf16 v[112:115], v[104:107], a[196:199], v[112:115]
    ds_read_b64 v[232:233], v90 offset:24640
    v_mul_f32 v60, v60, v92
    v_mfma_f32_16x16x32_bf16 v[112:115], v[100:103], a[200:203], v[112:115]
    ds_read_b128 v[108:111], v121 offset:256
    v_mul_f32 v61, v61, v92
    v_mfma_f32_16x16x32_bf16 v[112:115], v[80:83], a[204:207], v[112:115]
    ds_read_b128 v[100:103], v91 offset:25344
    v_cvt_pk_bf16_f32 v80, v60, v61
    v_mfma_f32_16x16x32_bf16 v[112:115], v[76:79], a[208:211], v[112:115]
    ds_read_b64 v[104:105], v90 offset:25408
    v_mul_f32 v62, v62, v92
    v_mfma_f32_16x16x32_bf16 v[112:115], v[48:51], a[212:215], v[112:115]
    ds_read_b128 v[48:51], v121 offset:320
    v_mul_f32 v63, v63, v92
    v_mfma_f32_16x16x32_bf16 v[76:79], v[8:11], v[84:87], 0
    s_nop 0
    v_exp_f32 v18, v18
    v_mfma_f32_16x16x32_bf16 v[76:79], v[160:163], v[168:171], v[76:79]
    s_nop 0
    v_cvt_pk_bf16_f32 v81, v62, v63
    v_cvt_pk_bf16_f32 v6, v112, v113
    v_mfma_f32_16x16x32_bf16 v[60:63], v[52:55], v[0:3], 0
    s_nop 0
    ds_write_b64 v135, v[80:81] offset:0
    v_mfma_f32_16x16x32_bf16 v[60:63], v[20:23], v[164:167], v[60:63]
    s_nop 0
    v_mul_f32 v76, v76, v92
    v_mul_f32 v77, v77, v92
    v_mfma_f32_16x16x32_bf16 v[116:119], v[52:55], v[8:11], 0
    v_cvt_pk_bf16_f32 v82, v76, v77
    v_mul_f32 v78, v78, v92
    v_mfma_f32_16x16x32_bf16 v[116:119], v[20:23], v[160:163], v[116:119]
    s_waitcnt lgkmcnt(3)
    v_mul_f32 v79, v79, v92
    v_cvt_pk_bf16_f32 v83, v78, v79
    v_mfma_f32_16x16x16_bf16 v[76:79], v[228:229], v[98:99], v[108:111]
    ds_write_b64 v135, v[82:83] offset:8
    v_mfma_f32_16x16x16_bf16 v[80:83], v[230:231], v[98:99], v[108:111]
    s_nop 0
    v_cvt_pk_bf16_f32 v7, v114, v115
    v_mov_b32_dpp v63, v119 quad_perm:[0,1,2,3] row_mask:0x2 bank_mask:0xf
    v_mfma_f32_16x16x16_bf16 v[116:119], v[232:233], v[98:99], v[108:111]
    s_waitcnt lgkmcnt(2)
    s_nop 0
    v_cvt_pk_bf16_f32 v76, v76, v77
    v_accvgpr_write_b32 a224, v76
    v_mfma_f32_16x16x16_bf16 v[112:115], v[100:101], v[98:99], v[48:51]
    ds_write_b32 v120, v13 offset:14848
    v_mfma_f32_16x16x16_bf16 v[108:111], v[102:103], v[98:99], v[48:51]
    v_cvt_pk_bf16_f32 v78, v78, v79
    v_accvgpr_write_b32 a225, v78
    v_mfma_f32_16x16x16_bf16 v[76:79], v[104:105], v[98:99], v[48:51]
    v_cvt_pk_bf16_f32 v80, v80, v81
    v_accvgpr_write_b32 a248, v80
    v_cvt_pk_bf16_f32 v82, v82, v83
    v_mfma_f32_16x16x32_bf16 v[48:51], v[4:7], v[84:87], 0
    v_accvgpr_write_b32 a249, v82
    v_cvt_pk_bf16_f32 v240, v116, v117
    v_mfma_f32_16x16x32_bf16 v[48:51], v[156:159], v[168:171], v[48:51]
    v_cvt_pk_bf16_f32 v168, v68, v69
    v_cvt_pk_bf16_f32 v169, v70, v71
    v_mfma_f32_16x16x32_bf16 v[80:83], v[52:55], v[4:7], 0
    ds_read_b128 v[84:87], v91 offset:49152
    v_cvt_pk_bf16_f32 v170, v45, 0
    v_mfma_f32_16x16x32_bf16 v[80:83], v[20:23], v[156:159], v[80:83]
    s_nop 0
    ds_read_b64 v[88:89], v90 offset:49216
    v_mul_f32 v48, v48, v92
    v_mfma_f32_16x16x32_bf16 v[44:47], v[220:223], v[224:227], 0
    ds_read_b128 v[68:71], v121 offset:5248
    v_mul_f32 v49, v49, v92
    v_mfma_f32_16x16x32_bf16 v[44:47], v[220:223], v[168:171], v[44:47]
    ds_read_b128 v[102:105], v91 offset:49920
    v_cvt_pk_bf16_f32 v96, v48, v49
    v_mfma_f32_16x16x32_bf16 v[20:23], v[0:3], v[224:227], 0
    ds_write_b32 v134, v96 offset:0
    v_mfma_f32_16x16x32_bf16 v[20:23], v[164:167], v[168:171], v[20:23]
    ds_read_b64 v[106:107], v90 offset:49984
    v_mul_f32 v50, v50, v92
    v_mfma_f32_16x16x32_bf16 v[52:55], v[8:11], v[224:227], 0
    ds_read_b128 v[140:143], v121 offset:5312
    v_mul_f32 v51, v51, v92
    v_mfma_f32_16x16x32_bf16 v[52:55], v[160:163], v[168:171], v[52:55]
    ds_read_b128 v[92:95], v91 offset:12288
    v_cvt_pk_bf16_f32 v97, v50, v51
    v_mfma_f32_16x16x32_bf16 v[48:51], v[4:7], v[224:227], 0
    ds_write_b32 v134, v97 offset:4
    v_mfma_f32_16x16x32_bf16 v[48:51], v[156:159], v[168:171], v[48:51]
    ds_read_b64 v[96:97], v90 offset:12352
    v_cvt_pk_bf16_f32 v241, v118, v119
    v_cvt_pk_bf16_f32 v112, v112, v113
    v_accvgpr_write_b32 a226, v112
    v_cvt_pk_bf16_f32 v114, v114, v115
    v_accvgpr_write_b32 a227, v114
    v_cvt_pk_bf16_f32 v108, v108, v109
    v_accvgpr_write_b32 a250, v108
    v_cvt_pk_bf16_f32 v110, v110, v111
    v_accvgpr_write_b32 a251, v110
    v_cvt_pk_bf16_f32 v242, v76, v77
    v_cvt_pk_bf16_f32 v243, v78, v79
    s_waitcnt lgkmcnt(5)
    v_mfma_f32_16x16x16_bf16 v[112:115], v[84:85], v[98:99], v[68:71]
    ds_read_b128 v[76:79], v121 offset:128
    v_mov_b32_dpp v63, v83 quad_perm:[0,1,2,3] row_mask:0x4 bank_mask:0xf
    v_mfma_f32_16x16x16_bf16 v[108:111], v[86:87], v[98:99], v[68:71]
    ds_read_b128 v[84:87], v91 offset:13056
    v_cvt_pk_bf16_f32 v63, v63, v63
    v_mfma_f32_16x16x16_bf16 v[80:83], v[88:89], v[98:99], v[68:71]
    s_waitcnt lgkmcnt(5)
    ds_write_b16 v131, v63
    v_mfma_f32_16x16x16_bf16 v[60:63], v[102:103], v[98:99], v[140:143]
    ds_read_b64 v[88:89], v90 offset:13120
    v_mov_b32 v146, 0
    v_mfma_f32_16x16x16_bf16 v[100:103], v[104:105], v[98:99], v[140:143]
    ds_read_b128 v[116:119], v121 offset:192
    v_mov_b32 v147, 0
    v_mfma_f32_16x16x16_bf16 v[68:71], v[106:107], v[98:99], v[140:143]
    ds_read_b128 v[104:107], v91 offset:61440
    v_mov_b32 v13, 0
    v_add_u32 v120, 0, v29
    v_cvt_pk_bf16_f32 v112, v112, v113
    v_accvgpr_write_b32 a232, v112
    v_cvt_pk_bf16_f32 v114, v114, v115
    v_accvgpr_write_b32 a233, v114
    v_cvt_pk_bf16_f32 v224, v108, v109
    v_cvt_pk_bf16_f32 v225, v110, v111
    v_cvt_pk_bf16_f32 v248, v80, v81
    v_cvt_pk_bf16_f32 v249, v82, v83
    v_cvt_pk_bf16_f32 v60, v60, v61
    v_accvgpr_write_b32 a234, v60
    v_cvt_pk_bf16_f32 v62, v62, v63
    v_accvgpr_write_b32 a235, v62
    s_waitcnt lgkmcnt(5)
    v_mfma_f32_16x16x16_bf16 v[60:63], v[92:93], v[98:99], v[76:79]
    ds_read_b64 v[108:109], v90 offset:61504
    v_cvt_pk_bf16_f32 v226, v100, v101
    v_mfma_f32_16x16x16_bf16 v[112:115], v[94:95], v[98:99], v[76:79]
    ds_read_b128 v[80:83], v121 offset:5376
    v_cvt_pk_bf16_f32 v227, v102, v103
    v_mfma_f32_16x16x16_bf16 v[100:103], v[96:97], v[98:99], v[76:79]
    s_waitcnt lgkmcnt(3)
    ds_read_b128 v[230:233], v91 offset:62208
    v_cvt_pk_bf16_f32 v250, v68, v69
    v_cvt_pk_bf16_f32 v251, v70, v71
    v_cvt_pk_bf16_f32 v60, v60, v61
    v_accvgpr_write_b32 a220, v60
    v_cvt_pk_bf16_f32 v62, v62, v63
    v_mfma_f32_16x16x16_bf16 v[76:79], v[84:85], v[98:99], v[116:119]
    ds_read_b64 v[234:235], v90 offset:62272
    v_accvgpr_write_b32 a221, v62
    v_mfma_f32_16x16x16_bf16 v[68:71], v[86:87], v[98:99], v[116:119]
    ds_read_b128 v[92:95], v121 offset:5440
    v_cvt_pk_bf16_f32 v112, v112, v113
    v_mfma_f32_16x16x16_bf16 v[60:63], v[88:89], v[98:99], v[116:119]
    ds_read_b128 v[84:87], v91 offset:36864
    v_accvgpr_write_b32 a244, v112
    v_cvt_pk_bf16_f32 v114, v114, v115
    v_accvgpr_write_b32 a245, v114
    v_cvt_pk_bf16_f32 v236, v100, v101
    v_cvt_pk_bf16_f32 v237, v102, v103
    v_cvt_pk_bf16_f32 v76, v76, v77
    v_accvgpr_write_b32 a222, v76
    v_cvt_pk_bf16_f32 v78, v78, v79
    v_accvgpr_write_b32 a223, v78
    v_cvt_pk_bf16_f32 v68, v68, v69
    v_accvgpr_write_b32 a246, v68
    v_cvt_pk_bf16_f32 v70, v70, v71
    v_accvgpr_write_b32 a247, v70
    v_cvt_pk_bf16_f32 v238, v60, v61
    s_waitcnt lgkmcnt(4)
    v_mfma_f32_16x16x16_bf16 v[76:79], v[104:105], v[98:99], v[80:83]
    ds_read_b64 v[88:89], v90 offset:36928
    v_cvt_pk_bf16_f32 v239, v62, v63
    v_mfma_f32_16x16x16_bf16 v[68:71], v[106:107], v[98:99], v[80:83]
    ds_read_b128 v[60:63], v121 offset:5120
    v_mfma_f32_16x16x16_bf16 v[104:107], v[108:109], v[98:99], v[80:83]
    s_waitcnt lgkmcnt(3)
    s_nop 0
    ds_read_b128 v[112:115], v91 offset:37632
    v_cvt_pk_bf16_f32 v76, v76, v77
    v_accvgpr_write_b32 a236, v76
    v_cvt_pk_bf16_f32 v78, v78, v79
    v_accvgpr_write_b32 a237, v78
    v_cvt_pk_bf16_f32 v228, v68, v69
    v_mfma_f32_16x16x16_bf16 v[80:83], v[230:231], v[98:99], v[92:95]
    ds_read_b64 v[116:117], v90 offset:37696
    v_cvt_pk_bf16_f32 v229, v70, v71
    v_mfma_f32_16x16x16_bf16 v[76:79], v[232:233], v[98:99], v[92:95]
    ds_read_b128 v[108:111], v121 offset:5184
    v_cvt_pk_bf16_f32 v252, v104, v105
    v_mfma_f32_16x16x16_bf16 v[68:71], v[234:235], v[98:99], v[92:95]
    ds_read_b128 v[100:103], v91 offset:0
    v_cvt_pk_bf16_f32 v253, v106, v107
    v_cvt_pk_bf16_f32 v80, v80, v81
    v_accvgpr_write_b32 a238, v80
    v_cvt_pk_bf16_f32 v82, v82, v83
    v_accvgpr_write_b32 a239, v82
    v_cvt_pk_bf16_f32 v230, v76, v77
    v_cvt_pk_bf16_f32 v231, v78, v79
    v_cvt_pk_bf16_f32 v254, v68, v69
    v_cvt_pk_bf16_f32 v255, v70, v71
    ds_read_b64 v[104:105], v90 offset:64
    v_rcp_f32 v44, v44
    s_waitcnt lgkmcnt(5)
    v_mfma_f32_16x16x16_bf16 v[80:83], v[84:85], v[98:99], v[60:63]
    ds_read_b128 v[68:71], v121 offset:0
    v_mul_f32 v20, v20, v44
    v_mfma_f32_16x16x16_bf16 v[76:79], v[86:87], v[98:99], v[60:63]
    ds_read_b128 v[92:95], v91 offset:768
    v_mul_f32 v21, v21, v44
    v_mfma_f32_16x16x16_bf16 v[84:87], v[88:89], v[98:99], v[60:63]
    s_waitcnt lgkmcnt(4)
    ds_read_b64 v[96:97], v90 offset:832
    v_cvt_pk_bf16_f32 v80, v80, v81
    v_accvgpr_write_b32 a228, v80
    v_cvt_pk_bf16_f32 v82, v82, v83
    v_accvgpr_write_b32 a229, v82
    v_cvt_pk_bf16_f32 v76, v76, v77
    v_mfma_f32_16x16x16_bf16 v[80:83], v[112:113], v[98:99], v[108:111]
    ds_read_b128 v[88:91], v121 offset:64
    v_accvgpr_write_b32 a252, v76
    v_mfma_f32_16x16x16_bf16 v[60:63], v[114:115], v[98:99], v[108:111]
    v_cvt_pk_bf16_f32 v78, v78, v79
    v_accvgpr_write_b32 a253, v78
    v_mfma_f32_16x16x16_bf16 v[76:79], v[116:117], v[98:99], v[108:111]
    v_cvt_pk_bf16_f32 v244, v84, v85
    v_cvt_pk_bf16_f32 v245, v86, v87
    v_cvt_pk_bf16_f32 v80, v80, v81
    v_accvgpr_write_b32 a230, v80
    v_cvt_pk_bf16_f32 v82, v82, v83
    v_accvgpr_write_b32 a231, v82
    v_cvt_pk_bf16_f32 v60, v60, v61
    v_accvgpr_write_b32 a254, v60
    v_cvt_pk_bf16_f32 v62, v62, v63
    v_accvgpr_write_b32 a255, v62
    v_cvt_pk_bf16_f32 v246, v76, v77
    s_waitcnt lgkmcnt(3)
    v_mfma_f32_16x16x16_bf16 v[60:63], v[100:101], v[98:99], v[68:71]
    v_cvt_pk_bf16_f32 v247, v78, v79
    v_cvt_pk_bf16_f32 v20, v20, v21
    v_mfma_f32_16x16x16_bf16 v[84:87], v[102:103], v[98:99], v[68:71]
    s_waitcnt vmcnt(5) lgkmcnt(1)
    ds_write_b32 v135, v20 offset:1536
    v_mfma_f32_16x16x16_bf16 v[80:83], v[104:105], v[98:99], v[68:71]
    s_waitcnt lgkmcnt(1)
    s_barrier
    v_cvt_pk_bf16_f32 v60, v60, v61
    v_accvgpr_write_b32 a216, v60
    v_cvt_pk_bf16_f32 v62, v62, v63
    v_accvgpr_write_b32 a217, v62
    v_cvt_pk_bf16_f32 v84, v84, v85
    v_accvgpr_write_b32 a240, v84
    v_mfma_f32_16x16x16_bf16 v[76:79], v[92:93], v[98:99], v[88:91]
    ds_read_b128 v[60:63], v122 offset:14848
    v_cvt_pk_bf16_f32 v86, v86, v87
    v_mfma_f32_16x16x16_bf16 v[68:71], v[94:95], v[98:99], v[88:91]
    ds_write_b128 v15, v[64:67] offset:6144
    v_mfma_f32_16x16x16_bf16 v[64:67], v[96:97], v[98:99], v[88:91]
    v_accvgpr_write_b32 a241, v86
    v_cvt_pk_bf16_f32 v232, v80, v81
    v_cvt_pk_bf16_f32 v233, v82, v83
    v_cvt_pk_bf16_f32 v76, v76, v77
    v_accvgpr_write_b32 a218, v76
    v_cvt_pk_bf16_f32 v78, v78, v79
    ds_write_b128 v120, v[72:75]
    v_accvgpr_write_b32 a219, v78
    v_cvt_pk_bf16_f32 v68, v68, v69
    v_accvgpr_write_b32 a242, v68
    v_cvt_pk_bf16_f32 v70, v70, v71
    v_accvgpr_write_b32 a243, v70
    v_cvt_pk_bf16_f32 v234, v64, v65
    v_cvt_pk_bf16_f32 v235, v66, v67
    v_mul_f32 v22, v22, v44
    ds_write2_b64 v120, v[146:147], v[146:147] offset0:2 offset1:3
    s_waitcnt lgkmcnt(2)
    v_or3_b32 v60, v60, v61, v62
    v_or_b32 v60, v60, v63
    v_mul_f32 v23, v23, v44
    v_readfirstlane_b32 s75, v60
    v_cvt_pk_bf16_f32 v21, v22, v23
    v_mul_f32 v52, v52, v44
    v_mul_f32 v53, v53, v44
    v_cvt_pk_bf16_f32 v22, v52, v53
    ds_write_b128 v120, v[56:59] offset:32
    v_mul_f32 v54, v54, v44
    v_mul_f32 v55, v55, v44
    v_cvt_pk_bf16_f32 v23, v54, v55
    v_mul_f32 v48, v48, v44
    v_mul_f32 v49, v49, v44
    v_cvt_pk_bf16_f32 v154, v48, v49
    v_mul_f32 v50, v50, v44
    v_mul_f32 v51, v51, v44
    ds_write2_b64 v120, v[42:43], v[146:147] offset0:6 offset1:7
    v_cvt_pk_bf16_f32 v155, v50, v51
    v_exp_f32 v19, v19
    v_exp_f32 v36, v36
    v_cvt_pk_bf16_f32 v17, v18, v19
    v_exp_f32 v37, v37
    ds_write2_b64 v120, v[146:147], v[40:41] offset0:8 offset1:9
    v_exp_f32 v38, v38
    v_exp_f32 v39, v39
    v_cvt_pk_bf16_f32 v18, v36, v37
    v_cvt_pk_bf16_f32 v19, v38, v39
    v_exp_f32 v32, v32
    ds_write_b64 v120, v[12:13] offset:88
    v_exp_f32 v33, v33
    v_exp_f32 v34, v34
    v_exp_f32 v35, v35
    ds_write_b64 v29, v[30:31] offset:80
    v_cvt_pk_bf16_f32 v168, v32, v33
    v_cvt_pk_bf16_f32 v169, v34, v35
    v_exp_f32 v14, v14
    ds_write_b128 v29, v[24:27] offset:96
    v_cvt_pk_bf16_f32 v170, v14, 0
    v_mfma_f32_16x16x32_bf16 v[12:15], v[220:223], v[16:19], 0
    s_nop 0
    v_mfma_f32_16x16x32_bf16 v[12:15], v[220:223], v[168:171], v[12:15]
    ds_read_b128 v[146:149], v137 offset:0
    v_mfma_f32_16x16x32_bf16 v[72:75], v[0:3], v[16:19], 0
    ds_read_b128 v[88:91], v136 offset:0
    v_mfma_f32_16x16x32_bf16 v[72:75], v[164:167], v[168:171], v[72:75]
    ds_read_b128 v[108:111], v137 offset:128
    v_mfma_f32_16x16x32_bf16 v[0:3], v[8:11], v[16:19], 0
    ds_read_b128 v[116:119], v136 offset:128
    v_mfma_f32_16x16x32_bf16 v[0:3], v[160:163], v[168:171], v[0:3]
    ds_read_b128 v[60:63], v137 offset:256
    v_mfma_f32_16x16x32_bf16 v[8:11], v[4:7], v[16:19], 0
    ds_read_b128 v[64:67], v136 offset:256
    v_mfma_f32_16x16x32_bf16 v[8:11], v[156:159], v[168:171], v[8:11]
    ds_read_b128 v[68:71], v137 offset:1536
    ds_read_b128 v[100:103], v136 offset:1536
    ds_read_b128 v[80:83], v137 offset:1664
    s_waitcnt lgkmcnt(8)
    v_mfma_f32_16x16x32_bf16 v[30:33], a[0:3], v[146:149], 0
    ds_read_b128 v[76:79], v136 offset:1792
    s_waitcnt lgkmcnt(0)
    s_cmp_lg_u32 s75, 0
    s_cbranch_scc0 L_loopF0
    s_branch L_slow
.fill 570, 4, 0xbf800000
L_atomF0:
    s_cbranch_execz L_main
    v_mov_b32 v122, 0x800000
    buffer_atomic_add v122, v129, s[8:11], 0 offen sc0 sc1
    s_branch L_atomF0r
.p2align 6
L_loopF0:
    v_mfma_f32_16x16x32_bf16 v[30:33], a[4:7], v[88:91], v[30:33]
    ds_write_b32 v135, v21 offset:1540
    v_mfma_f32_16x16x32_bf16 v[30:33], a[8:11], v[108:111], v[30:33]
    v_rcp_f32 v12, v12
    v_mfma_f32_16x16x32_bf16 v[30:33], a[12:15], v[116:119], v[30:33]
    v_mul_f32 v72, v72, v12
    v_mul_f32 v73, v73, v12
    v_mfma_f32_16x16x32_bf16 v[30:33], a[16:19], v[60:63], v[30:33]
    v_cvt_pk_bf16_f32 v4, v72, v73
    v_mul_f32 v74, v74, v12
    v_mfma_f32_16x16x32_bf16 v[30:33], a[20:23], v[64:67], v[30:33]
    ds_write_b64 v135, v[22:23] offset:1544
    v_mfma_f32_16x16x32_bf16 v[20:23], v[146:149], a[168:171], 0
    v_mul_f32 v75, v75, v12
    v_cvt_pk_bf16_f32 v5, v74, v75
    v_mfma_f32_16x16x32_bf16 v[20:23], v[88:91], a[172:175], v[20:23]
    v_mul_f32 v0, v0, v12
    v_mul_f32 v1, v1, v12
    v_mfma_f32_16x16x32_bf16 v[20:23], v[108:111], a[176:179], v[20:23]
    ds_read_b128 v[72:75], v136 offset:1664
    v_cvt_pk_bf16_f32 v6, v0, v1
    v_mfma_f32_16x16x32_bf16 v[20:23], v[116:119], a[180:183], v[20:23]
    v_mul_f32 v2, v2, v12
    v_mul_f32 v3, v3, v12
    v_mfma_f32_16x16x32_bf16 v[20:23], v[60:63], a[184:187], v[20:23]
    v_cvt_pk_bf16_f32 v7, v2, v3
    v_mul_f32 v8, v8, v12
    v_mfma_f32_16x16x32_bf16 v[20:23], v[64:67], a[188:191], v[20:23]
    ds_read_b128 v[112:115], v137 offset:1792
    v_mul_f32 v9, v9, v12
    v_mfma_f32_16x16x32_bf16 v[0:3], a[120:123], v[146:149], 0
    v_cvt_pk_bf16_f32 v152, v8, v9
    v_mul_f32 v10, v10, v12
    v_mfma_f32_16x16x32_bf16 v[0:3], a[124:127], v[88:91], v[0:3]
    v_mul_f32 v11, v11, v12
    v_cvt_pk_bf16_f32 v153, v10, v11
    v_mfma_f32_16x16x32_bf16 v[0:3], a[128:131], v[108:111], v[0:3]
    v_fmac_f32 v28, v39, v39
    v_fmac_f32 v28, v96, v96
    v_mfma_f32_16x16x32_bf16 v[0:3], a[132:135], v[116:119], v[0:3]
    ds_write_b64 v134, v[154:155] offset:1536
    v_mfma_f32_16x16x32_bf16 v[0:3], a[136:139], v[60:63], v[0:3]
    v_fmac_f32 v28, v97, v97
    v_fmac_f32 v28, v98, v98
    v_mfma_f32_16x16x32_bf16 v[0:3], a[140:143], v[64:67], v[0:3]
    v_fmac_f32 v28, v99, v99
    v_fma_f32 v29, v56, v56, s42
    v_mfma_f32_16x16x32_bf16 v[12:15], a[48:51], v[146:149], 0
    v_fmac_f32 v29, v57, v57
    v_fmac_f32 v29, v58, v58
    v_mfma_f32_16x16x32_bf16 v[12:15], a[52:55], v[88:91], v[12:15]
    ds_write_b64 v135, v[4:5] offset:3072
    v_mfma_f32_16x16x32_bf16 v[12:15], a[56:59], v[108:111], v[12:15]
    v_fmac_f32 v29, v59, v59
    v_fmac_f32 v29, v140, v140
    v_mfma_f32_16x16x32_bf16 v[12:15], a[60:63], v[116:119], v[12:15]
    v_fmac_f32 v29, v141, v141
    v_fmac_f32 v29, v142, v142
    v_mfma_f32_16x16x32_bf16 v[12:15], a[64:67], v[60:63], v[12:15]
    v_fmac_f32 v29, v143, v143
    v_fmac_f32 v29, v104, v104
    v_mfma_f32_16x16x32_bf16 v[12:15], a[68:71], v[64:67], v[12:15]
    ds_write_b64 v135, v[6:7] offset:3080
    v_mfma_f32_16x16x32_bf16 v[4:7], a[24:27], v[146:149], 0
    v_fmac_f32 v29, v105, v105
    v_fmac_f32 v29, v106, v106
    v_mfma_f32_16x16x32_bf16 v[4:7], a[28:31], v[88:91], v[4:7]
    v_fmac_f32 v29, v107, v107
    v_fma_f32 v154, v52, v52, s42
    v_mfma_f32_16x16x32_bf16 v[4:7], a[32:35], v[108:111], v[4:7]
    v_fmac_f32 v154, v53, v53
    v_fmac_f32 v154, v54, v54
    v_mfma_f32_16x16x32_bf16 v[4:7], a[36:39], v[116:119], v[4:7]
    ds_write_b32 v134, v152 offset:3072
    v_mfma_f32_16x16x32_bf16 v[4:7], a[40:43], v[60:63], v[4:7]
    v_fmac_f32 v154, v55, v55
    v_fmac_f32 v154, v84, v84
    v_mfma_f32_16x16x32_bf16 v[4:7], a[44:47], v[64:67], v[4:7]
    v_fmac_f32 v154, v85, v85
    v_fmac_f32 v154, v86, v86
    v_mfma_f32_16x16x32_bf16 v[8:11], v[146:149], a[192:195], 0
    v_fmac_f32 v154, v87, v87
    v_fmac_f32 v154, v48, v48
    v_mfma_f32_16x16x32_bf16 v[8:11], v[88:91], a[196:199], v[8:11]
    s_waitcnt vmcnt(10)
    ds_write_b32 v134, v153 offset:3076
    v_mfma_f32_16x16x32_bf16 v[8:11], v[108:111], a[200:203], v[8:11]
    v_fmac_f32 v154, v49, v49
    v_fmac_f32 v154, v50, v50
    v_mfma_f32_16x16x32_bf16 v[8:11], v[116:119], a[204:207], v[8:11]
    v_fmac_f32 v154, v51, v51
    v_cvt_pk_bf16_f32 v28, v28, v29
    v_mfma_f32_16x16x32_bf16 v[8:11], v[60:63], a[208:211], v[8:11]
    v_cvt_pk_bf16_f32 v29, v154, v122
    v_add_u32 v135, s49, v135
    v_mfma_f32_16x16x32_bf16 v[8:11], v[64:67], a[212:215], v[8:11]
    ds_write_b64 v130, v[28:29]
    v_mfma_f32_16x16x32_bf16 v[40:43], a[72:75], v[146:149], 0
    v_add_u32 v134, s49, v134
    v_cvt_pk_f16_f32 v28, v30, v31
    v_mfma_f32_16x16x32_bf16 v[40:43], a[76:79], v[88:91], v[40:43]
    v_cvt_pk_f16_f32 v29, v32, v33
    v_pk_fma_f16 v32, v28, v28, s39
    v_mfma_f32_16x16x32_bf16 v[40:43], a[80:83], v[108:111], v[40:43]
    v_pk_fmac_f16 v32, v29, v29
    v_cvt_pk_f16_f32 v154, v0, v1
    v_mfma_f32_16x16x32_bf16 v[40:43], a[84:87], v[116:119], v[40:43]
    v_cvt_pk_f16_f32 v155, v2, v3
    v_cvt_pk_f16_f32 v30, v4, v5
    v_mfma_f32_16x16x32_bf16 v[40:43], a[88:91], v[60:63], v[40:43]
    v_cvt_pk_f16_f32 v31, v6, v7
    v_pk_fmac_f16 v32, v30, v30
    v_mfma_f32_16x16x32_bf16 v[40:43], a[92:95], v[64:67], v[40:43]
    v_pk_fmac_f16 v32, v31, v31
    v_cvt_pk_bf16_f32 v4, v8, v9
    v_mfma_f32_16x16x32_bf16 v[0:3], a[96:99], v[146:149], 0
    v_cvt_pk_bf16_f32 v5, v10, v11
    v_cvt_pk_f16_f32 v152, v12, v13
    v_mfma_f32_16x16x32_bf16 v[0:3], a[100:103], v[88:91], v[0:3]
    s_waitcnt lgkmcnt(0)
    v_cvt_pk_f16_f32 v153, v14, v15
    v_pk_fmac_f16 v32, v152, v152
    v_mfma_f32_16x16x32_bf16 v[0:3], a[104:107], v[108:111], v[0:3]
    s_barrier
    ds_read_b128 v[8:11], v129 offset:0
    v_pk_fmac_f16 v32, v153, v153
    v_mfma_f32_16x16x32_bf16 v[0:3], a[108:111], v[116:119], v[0:3]
    ds_read_b128 v[44:47], v129 offset:1024
    v_cvt_pk_f16_f32 v12, v40, v41
    v_mfma_f32_16x16x32_bf16 v[0:3], a[112:115], v[60:63], v[0:3]
    v_cvt_pk_f16_f32 v13, v42, v43
    v_pk_fma_f16 v33, v12, v12, s39
    v_mfma_f32_16x16x32_bf16 v[0:3], a[116:119], v[64:67], v[0:3]
    v_pk_fmac_f16 v33, v13, v13
    s_nop 0
    v_mfma_f32_16x16x32_bf16 v[40:43], v[146:149], a[144:147], 0
    s_nop 2
    v_mfma_f32_16x16x32_bf16 v[40:43], v[88:91], a[148:151], v[40:43]
    s_nop 0
    v_cvt_pk_f16_f32 v14, v0, v1
    v_cvt_pk_f16_f32 v15, v2, v3
    v_mfma_f32_16x16x32_bf16 v[40:43], v[108:111], a[152:155], v[40:43]
    v_pk_fmac_f16 v33, v14, v14
    v_pk_fmac_f16 v33, v15, v15
    v_mfma_f32_16x16x32_bf16 v[40:43], v[116:119], a[156:159], v[40:43]
    v_pk_fmac_f16 v33, v154, v154
    v_pk_fmac_f16 v33, v155, v155
    v_mfma_f32_16x16x32_bf16 v[40:43], v[60:63], a[160:163], v[40:43]
    v_mfma_f32_16x16x32_bf16 v[40:43], v[64:67], a[164:167], v[40:43]
    s_waitcnt lgkmcnt(1)
    v_readfirstlane_b32 s12, v9
    v_mfma_f32_16x16x32_bf16 v[88:91], v[216:219], v[8:11], 0
    s_waitcnt lgkmcnt(0)
    s_nop 1
    v_mfma_f32_16x16x32_bf16 v[88:91], v[216:219], v[44:47], v[88:91]
    s_lshr_b32 s12, s12, 23
    v_cvt_pk_bf16_f32 v0, v40, v41
    v_cvt_pk_bf16_f32 v1, v42, v43
    v_mfma_f32_16x16x32_bf16 v[60:63], a[24:27], v[68:71], 0
    s_nop 1
    v_mfma_f32_16x16x32_bf16 v[60:63], a[28:31], v[100:103], v[60:63]
    s_nop 0
    v_rsq_f32 v88, v88
    v_mfma_f32_16x16x32_bf16 v[60:63], a[32:35], v[80:83], v[60:63]
    v_rsq_f32 v89, v89
    v_mfma_f32_16x16x32_bf16 v[60:63], a[36:39], v[72:75], v[60:63]
    v_rsq_f32 v90, v90
    v_mfma_f32_16x16x32_bf16 v[60:63], a[40:43], v[112:115], v[60:63]
    v_mul_f32 v88, s43, v88
    v_mul_f32 v89, s43, v89
    v_mfma_f32_16x16x32_bf16 v[60:63], a[44:47], v[76:79], v[60:63]
    v_mul_f32 v90, s43, v90
    v_mul_f32 v56, v56, v89
    v_mfma_f32_16x16x32_bf16 v[40:43], a[96:99], v[68:71], 0
    v_mul_f32 v57, v57, v89
    v_cvt_pk_bf16_f32 v44, v56, v57
    v_mfma_f32_16x16x32_bf16 v[40:43], a[100:103], v[100:103], v[40:43]
    ds_write_b32 v135, v44 offset:1536
    v_mfma_f32_16x16x32_bf16 v[40:43], a[104:107], v[80:83], v[40:43]
    v_mul_f32 v58, v58, v89
    v_mul_f32 v59, v59, v89
    v_mfma_f32_16x16x32_bf16 v[40:43], a[108:111], v[72:75], v[40:43]
    v_cvt_pk_bf16_f32 v45, v58, v59
    v_mul_f32 v140, v140, v89
    v_mfma_f32_16x16x32_bf16 v[40:43], a[112:115], v[112:115], v[40:43]
    v_mul_f32 v141, v141, v89
    v_cvt_pk_bf16_f32 v46, v140, v141
    v_mfma_f32_16x16x32_bf16 v[40:43], a[116:119], v[76:79], v[40:43]
    s_nop 0
    ds_write_b32 v135, v45 offset:1540
    v_mfma_f32_16x16x32_bf16 v[146:149], v[68:71], a[168:171], 0
    s_nop 0
    v_mul_f32 v142, v142, v89
    v_mul_f32 v143, v143, v89
    v_mfma_f32_16x16x32_bf16 v[146:149], v[100:103], a[172:175], v[146:149]
    s_nop 0
    v_cvt_pk_f16_f32 v10, v40, v41
    v_cvt_pk_f16_f32 v11, v42, v43
    v_mfma_f32_16x16x32_bf16 v[146:149], v[80:83], a[176:179], v[146:149]
    v_cvt_pk_bf16_f32 v47, v142, v143
    v_mul_f32 v104, v104, v89
    v_mfma_f32_16x16x32_bf16 v[146:149], v[72:75], a[180:183], v[146:149]
    ds_write_b64 v135, v[46:47] offset:1544
    v_mfma_f32_16x16x32_bf16 v[146:149], v[112:115], a[184:187], v[146:149]
    s_sub_u32 s50, s45, s44
    v_mul_f32 v105, v105, v89
    v_cvt_pk_bf16_f32 v8, v104, v105
    v_mfma_f32_16x16x32_bf16 v[146:149], v[76:79], a[188:191], v[146:149]
    s_sub_u32 s51, s46, s47
    v_mul_f32 v106, v106, v89
    v_mul_f32 v107, v107, v89
    v_mfma_f32_16x16x32_bf16 v[40:43], a[48:51], v[68:71], 0
    s_mov_b32 s60, s59
    v_cvt_pk_bf16_f32 v9, v106, v107
    v_mul_f32 v92, v92, v88
    v_mfma_f32_16x16x32_bf16 v[40:43], a[52:55], v[100:103], v[40:43]
    s_mov_b32 s59, s58
    ds_write_b32 v134, v9 offset:1540
    v_mfma_f32_16x16x32_bf16 v[40:43], a[56:59], v[80:83], v[40:43]
    s_mov_b32 s58, s57
    v_cvt_pk_bf16_f32 v26, v146, v147
    v_cvt_pk_bf16_f32 v27, v148, v149
    v_mfma_f32_16x16x32_bf16 v[40:43], a[60:63], v[72:75], v[40:43]
    s_mov_b32 s57, s56
    v_mul_f32 v93, v93, v88
    v_cvt_pk_bf16_f32 v16, v92, v93
    v_mfma_f32_16x16x32_bf16 v[40:43], a[64:67], v[112:115], v[40:43]
    s_mov_b32 s7, s6
    v_mul_f32 v94, v94, v88
    v_mul_f32 v95, v95, v88
    v_mfma_f32_16x16x32_bf16 v[40:43], a[68:71], v[76:79], v[40:43]
    s_mov_b32 s6, s5
    ds_write_b32 v134, v8 offset:1536
    v_mfma_f32_16x16x32_bf16 v[64:67], a[72:75], v[68:71], 0
    s_mov_b32 s5, s4
    v_cvt_pk_bf16_f32 v17, v94, v95
    v_mul_f32 v36, v36, v88
    v_mfma_f32_16x16x32_bf16 v[64:67], a[76:79], v[100:103], v[64:67]
    s_sub_u32 s14, s6, s7
    v_cvt_pk_f16_f32 v146, v40, v41
    v_cvt_pk_f16_f32 v147, v42, v43
    v_mfma_f32_16x16x32_bf16 v[64:67], a[80:83], v[80:83], v[64:67]
    s_add_u32 s61, s61, 1
    v_mul_f32 v37, v37, v88
    v_cvt_pk_bf16_f32 v18, v36, v37
    v_mfma_f32_16x16x32_bf16 v[64:67], a[84:87], v[72:75], v[64:67]
    s_add_u32 s12, s12, 20
    ds_write_b64 v135, v[16:17] offset:0
    v_mfma_f32_16x16x32_bf16 v[64:67], a[88:91], v[112:115], v[64:67]
    s_max_u32 s12, s12, s61
    v_mul_f32 v38, v38, v88
    v_mul_f32 v39, v39, v88
    v_mfma_f32_16x16x32_bf16 v[64:67], a[92:95], v[76:79], v[64:67]
    s_cmp_lt_u32 s61, s71
    v_cvt_pk_bf16_f32 v19, v38, v39
    v_mul_f32 v96, v96, v88
    v_mfma_f32_16x16x32_bf16 v[92:95], a[120:123], v[68:71], 0
    s_cselect_b32 s15, s61, s12
    ds_read_b128 v[40:43], v136 offset:3072
    v_mul_f32 v97, v97, v88
    v_mfma_f32_16x16x32_bf16 v[92:95], a[124:127], v[100:103], v[92:95]
    s_cselect_b32 s56, s69, s70
    ds_read_b128 v[44:47], v136 offset:3200
    v_cvt_pk_bf16_f32 v2, v96, v97
    v_mfma_f32_16x16x32_bf16 v[92:95], a[128:131], v[80:83], v[92:95]
    s_add_u32 s56, s56, s15
    v_mul_f32 v98, v98, v88
    v_mul_f32 v99, v99, v88
    v_mfma_f32_16x16x32_bf16 v[92:95], a[132:135], v[72:75], v[92:95]
    s_mul_i32 s53, s56, 58255
    v_cvt_pk_bf16_f32 v3, v98, v99
    v_cvt_pk_f16_f32 v8, v64, v65
    v_mfma_f32_16x16x32_bf16 v[92:95], a[136:139], v[112:115], v[92:95]
    s_lshr_b32 s53, s53, 22
    ds_read_b128 v[36:39], v136 offset:3328
    v_cvt_pk_f16_f32 v9, v66, v67
    v_mfma_f32_16x16x32_bf16 v[92:95], a[140:143], v[76:79], v[92:95]
    s_mul_i32 s53, s53, s63
    v_pk_fma_f16 v35, v8, v8, s39
    v_pk_fmac_f16 v35, v9, v9
    v_mfma_f32_16x16x32_bf16 v[64:67], v[68:71], a[144:147], 0
    s_mul_i32 s56, s56, s62
    v_pk_fmac_f16 v35, v10, v10
    v_pk_fmac_f16 v35, v11, v11
    v_mfma_f32_16x16x32_bf16 v[64:67], v[100:103], a[148:151], v[64:67]
    s_add_u32 s56, s56, s53
    v_cvt_pk_f16_f32 v148, v92, v93
    v_cvt_pk_f16_f32 v149, v94, v95
    v_mfma_f32_16x16x32_bf16 v[64:67], v[80:83], a[152:155], v[64:67]
    s_mul_i32 s4, s15, 112
    ds_write_b64 v135, v[18:19] offset:8
    v_mfma_f32_16x16x32_bf16 v[64:67], v[72:75], a[156:159], v[64:67]
    s_cmp_ge_u32 s15, 16
    v_pk_fmac_f16 v35, v148, v148
    v_pk_fmac_f16 v35, v149, v149
    v_mfma_f32_16x16x32_bf16 v[64:67], v[112:115], a[160:163], v[64:67]
    s_cselect_b32 s53, -30464, 0
    v_cvt_pk_f16_f32 v18, v60, v61
    v_cvt_pk_f16_f32 v19, v62, v63
    v_mfma_f32_16x16x32_bf16 v[64:67], v[76:79], a[164:167], v[64:67]
    s_add_u32 s4, s4, s53
    v_mul_f32 v52, v52, v90
    v_mul_f32 v53, v53, v90
    v_mfma_f32_16x16x32_bf16 v[92:95], a[0:3], v[68:71], 0
    s_cmp_lt_u32 s15, s73
    ds_write_b64 v134, v[2:3] offset:0
    v_mfma_f32_16x16x32_bf16 v[92:95], a[4:7], v[100:103], v[92:95]
    s_cselect_b32 s26, 100270464, 0
    v_cvt_pk_bf16_f32 v2, v64, v65
    v_cvt_pk_bf16_f32 v3, v66, v67
    v_mfma_f32_16x16x32_bf16 v[92:95], a[8:11], v[80:83], v[92:95]
    s_cselect_b32 s56, s56, 0
    v_cvt_pk_bf16_f32 v104, v52, v53
    v_mul_f32 v54, v54, v90
    v_mfma_f32_16x16x32_bf16 v[92:95], a[12:15], v[72:75], v[92:95]
    s_cselect_b32 s4, s4, -1
    ds_read_b128 v[60:63], v137 offset:3072
    v_mul_f32 v55, v55, v90
    v_mfma_f32_16x16x32_bf16 v[92:95], a[16:19], v[112:115], v[92:95]
    s_cselect_b32 s15, s15, 0
    ds_read_b128 v[64:67], v137 offset:3200
    v_cvt_pk_bf16_f32 v105, v54, v55
    v_mfma_f32_16x16x32_bf16 v[92:95], a[20:23], v[76:79], v[92:95]
    s_cselect_b32 s13, s13, -1
    ds_read_b128 v[52:55], v137 offset:3328
    v_mul_f32 v84, v84, v90
    v_mfma_f32_16x16x32_bf16 v[56:59], v[68:71], a[192:195], 0
    s_bitset1_b32 s64, s15
    v_mul_f32 v85, v85, v90
    v_cvt_pk_bf16_f32 v106, v84, v85
    v_mfma_f32_16x16x32_bf16 v[56:59], v[100:103], a[196:199], v[56:59]
    s_add_u32 s65, s65, 1
    v_cvt_pk_f16_f32 v16, v92, v93
    v_cvt_pk_f16_f32 v17, v94, v95
    v_mfma_f32_16x16x32_bf16 v[56:59], v[80:83], a[200:203], v[56:59]
    s_cmp_ge_i32 s65, 2
    v_pk_fma_f16 v34, v16, v16, s39
    v_pk_fmac_f16 v34, v17, v17
    v_mfma_f32_16x16x32_bf16 v[56:59], v[72:75], a[204:207], v[56:59]
    s_cselect_b32 s30, 100270464, 0
    ds_write_b64 v135, v[104:105] offset:3072
    v_mfma_f32_16x16x32_bf16 v[56:59], v[112:115], a[208:211], v[56:59]
    s_add_u32 s67, s46, s54
    v_pk_fmac_f16 v34, v18, v18
    v_pk_fmac_f16 v34, v19, v19
    v_mfma_f32_16x16x32_bf16 v[56:59], v[76:79], a[212:215], v[56:59]
    s_waitcnt lgkmcnt(3)
    v_pk_fmac_f16 v34, v146, v146
    v_pk_fmac_f16 v34, v147, v147
    v_mfma_f32_16x16x32_bf16 v[80:83], a[72:75], v[60:63], 0
    s_add_u32 m0, s67, 0
    v_mul_f32 v86, v86, v90
    v_mul_f32 v87, v87, v90
    v_mfma_f32_16x16x32_bf16 v[80:83], a[76:79], v[40:43], v[80:83]
    s_waitcnt lgkmcnt(1)
    ds_write_b32 v135, v106 offset:3080
    v_mfma_f32_16x16x32_bf16 v[80:83], a[80:83], v[64:67], v[80:83]
    v_cvt_pk_bf16_f32 v107, v86, v87
    v_mul_f32 v48, v48, v90
    v_mfma_f32_16x16x32_bf16 v[80:83], a[84:87], v[44:47], v[80:83]
    v_mul_f32 v49, v49, v90
    v_cvt_pk_bf16_f32 v104, v48, v49
    v_mfma_f32_16x16x32_bf16 v[80:83], a[88:91], v[52:55], v[80:83]
    v_mul_f32 v50, v50, v90
    v_mul_f32 v51, v51, v90
    v_mfma_f32_16x16x32_bf16 v[80:83], a[92:95], v[36:39], v[80:83]
    s_nop 0
    ds_write_b32 v135, v107 offset:3084
    v_mfma_f32_16x16x32_bf16 v[92:95], a[120:123], v[60:63], 0
    s_nop 0
    v_cvt_pk_bf16_f32 v105, v50, v51
    v_cvt_pk_bf16_f32 v6, v56, v57
    v_mfma_f32_16x16x32_bf16 v[92:95], a[124:127], v[40:43], v[92:95]
    s_nop 0
    v_cvt_pk_f16_f32 v48, v80, v81
    v_cvt_pk_f16_f32 v49, v82, v83
    v_mfma_f32_16x16x32_bf16 v[92:95], a[128:131], v[64:67], v[92:95]
    v_cvt_pk_bf16_f32 v7, v58, v59
    v_add_u32 v137, s50, v137
    v_mfma_f32_16x16x32_bf16 v[92:95], a[132:135], v[44:47], v[92:95]
    ds_write_b32 v134, v104 offset:3072
    v_mfma_f32_16x16x32_bf16 v[92:95], a[136:139], v[52:55], v[92:95]
    v_add_u32 v136, s50, v136
    v_add_u32 v135, s48, v135
    v_mfma_f32_16x16x32_bf16 v[92:95], a[140:143], v[36:39], v[92:95]
    v_add_u32 v133, s51, v133
    v_add_u32 v132, s14, v132
    v_mfma_f32_16x16x32_f16 v[88:91], v[212:215], v[32:35], 0
    s_nop 0
    v_pk_fma_f16 v33, v48, v48, s39
    v_pk_fmac_f16 v33, v49, v49
    v_mfma_f32_16x16x32_bf16 v[84:87], v[60:63], a[168:171], 0
    s_nop 0
    ds_write_b32 v134, v105 offset:3076
    v_mfma_f32_16x16x32_bf16 v[84:87], v[40:43], a[172:175], v[84:87]
    s_waitcnt vmcnt(0)
    v_or3_b32 v123, v123, v88, v89
    v_or3_b32 v123, v123, v90, v91
    v_mfma_f32_16x16x32_bf16 v[84:87], v[64:67], a[176:179], v[84:87]
    v_rsq_f32 v88, v88
    v_mfma_f32_16x16x32_bf16 v[84:87], v[44:47], a[180:183], v[84:87]
    v_rsq_f32 v89, v89
    v_mfma_f32_16x16x32_bf16 v[84:87], v[52:55], a[184:187], v[84:87]
    v_mul_f32 v88, s52, v88
    v_cvt_pk_f16_f32 v88, v88, v89
    v_mfma_f32_16x16x32_bf16 v[84:87], v[36:39], a[188:191], v[84:87]
    v_rsq_f32 v90, v90
    v_mfma_f32_16x16x32_bf16 v[76:79], a[24:27], v[60:63], 0
    v_rsq_f32 v91, v91
    v_mfma_f32_16x16x32_bf16 v[76:79], a[28:31], v[40:43], v[76:79]
    v_mul_f32 v90, s52, v90
    v_cvt_pk_f16_f32 v90, v90, v91
    v_mfma_f32_16x16x32_bf16 v[76:79], a[32:35], v[64:67], v[76:79]
    s_waitcnt lgkmcnt(0)
    v_pk_mul_f16 v12, v12, v88 op_sel:[0,1] op_sel_hi:[1,1]
    v_pk_mul_f16 v13, v13, v88 op_sel:[0,1] op_sel_hi:[1,1]
    v_mfma_f32_16x16x32_bf16 v[76:79], a[36:39], v[44:47], v[76:79]
    s_barrier
    v_pk_mul_f16 v14, v14, v88 op_sel:[0,1] op_sel_hi:[1,1]
    v_pk_mul_f16 v15, v15, v88 op_sel:[0,1] op_sel_hi:[1,1]
    v_mfma_f32_16x16x32_bf16 v[76:79], a[40:43], v[52:55], v[76:79]
    s_cmp_ge_u32 s61, s13
    v_pk_mul_f16 v154, v154, v88 op_sel:[0,1] op_sel_hi:[1,1]
    v_pk_mul_f16 v155, v155, v88 op_sel:[0,1] op_sel_hi:[1,1]
    v_mfma_f32_16x16x32_bf16 v[76:79], a[44:47], v[36:39], v[76:79]
L_pga:
    s_cbranch_scc1 L_atomF0
L_atomF0r:
    v_mfma_f32_16x16x32_bf16 v[140:143], v[60:63], a[144:147], 0
    v_pk_mul_f16 v8, v8, v90 op_sel:[0,1] op_sel_hi:[1,1]
    v_pk_mul_f16 v9, v9, v90 op_sel:[0,1] op_sel_hi:[1,1]
    v_mfma_f32_16x16x32_bf16 v[140:143], v[40:43], a[148:151], v[140:143]
    v_pk_mul_f16 v10, v10, v90 op_sel:[0,1] op_sel_hi:[1,1]
    v_pk_mul_f16 v11, v11, v90 op_sel:[0,1] op_sel_hi:[1,1]
    v_mfma_f32_16x16x32_bf16 v[140:143], v[64:67], a[152:155], v[140:143]
    v_pk_mul_f16 v148, v148, v90 op_sel:[0,1] op_sel_hi:[1,1]
    v_pk_mul_f16 v149, v149, v90 op_sel:[0,1] op_sel_hi:[1,1]
    v_mfma_f32_16x16x32_bf16 v[140:143], v[44:47], a[156:159], v[140:143]
    v_pk_mul_f16 v28, v28, v88 op_sel:[0,0] op_sel_hi:[1,0]
    v_pk_mul_f16 v29, v29, v88 op_sel:[0,0] op_sel_hi:[1,0]
    v_mfma_f32_16x16x32_bf16 v[140:143], v[52:55], a[160:163], v[140:143]
    ds_read_b128 v[80:83], v137 offset:0
    v_pk_mul_f16 v30, v30, v88 op_sel:[0,0] op_sel_hi:[1,0]
    v_mfma_f32_16x16x32_bf16 v[140:143], v[36:39], a[164:167], v[140:143]
    v_pk_mul_f16 v31, v31, v88 op_sel:[0,0] op_sel_hi:[1,0]
    v_pk_mul_f16 v152, v152, v88 op_sel:[0,0] op_sel_hi:[1,0]
    v_mfma_f32_16x16x32_bf16 v[96:99], a[0:3], v[60:63], 0
    ds_read_b128 v[68:71], v132 offset:0
    v_pk_mul_f16 v153, v153, v88 op_sel:[0,0] op_sel_hi:[1,0]
    v_mfma_f32_16x16x32_bf16 v[96:99], a[4:7], v[40:43], v[96:99]
    ds_read_b128 v[104:107], v133 offset:0
    v_cvt_pk_f16_f32 v58, v76, v77
    v_mfma_f32_16x16x32_bf16 v[96:99], a[8:11], v[64:67], v[96:99]
    v_cvt_pk_f16_f32 v59, v78, v79
    v_add_u32 v134, s48, v134
    v_mfma_f32_16x16x32_bf16 v[96:99], a[12:15], v[44:47], v[96:99]
    ds_read_b128 v[76:79], v132 offset:16
    v_add_u32 v131, s14, v131
    v_mfma_f32_16x16x32_bf16 v[96:99], a[16:19], v[52:55], v[96:99]
    v_pk_mul_f16 v16, v16, v90 op_sel:[0,0] op_sel_hi:[1,0]
    v_pk_mul_f16 v17, v17, v90 op_sel:[0,0] op_sel_hi:[1,0]
    v_mfma_f32_16x16x32_bf16 v[96:99], a[20:23], v[36:39], v[96:99]
    v_pk_mul_f16 v18, v18, v90 op_sel:[0,0] op_sel_hi:[1,0]
    v_pk_mul_f16 v19, v19, v90 op_sel:[0,0] op_sel_hi:[1,0]
    v_mfma_f32_16x16x32_bf16 v[100:103], a[48:51], v[60:63], 0
    v_pk_mul_f16 v146, v146, v90 op_sel:[0,0] op_sel_hi:[1,0]
    v_pk_mul_f16 v147, v147, v90 op_sel:[0,0] op_sel_hi:[1,0]
    v_mfma_f32_16x16x32_bf16 v[100:103], a[52:55], v[40:43], v[100:103]
    s_nop 0
    ds_read_b128 v[88:91], v136 offset:128
    v_cvt_pk_f16_f32 v56, v96, v97
    v_mfma_f32_16x16x32_bf16 v[100:103], a[56:59], v[64:67], v[100:103]
    ds_read_b128 v[72:75], v132 offset:48
    v_cvt_pk_f16_f32 v57, v98, v99
    v_mfma_f32_16x16x32_bf16 v[100:103], a[60:63], v[44:47], v[100:103]
    ds_read_b128 v[96:99], v133 offset:2048
    v_pk_fma_f16 v32, v56, v56, s39
    v_mfma_f32_16x16x32_bf16 v[100:103], a[64:67], v[52:55], v[100:103]
    v_pk_fmac_f16 v32, v57, v57
    v_pk_fmac_f16 v32, v58, v58
    v_mfma_f32_16x16x32_bf16 v[100:103], a[68:71], v[36:39], v[100:103]
    v_pk_fmac_f16 v32, v59, v59
    v_cvt_pk_bf16_f32 v164, v140, v141
    v_mfma_f32_16x16x32_bf16 v[116:119], a[96:99], v[60:63], 0
    s_waitcnt lgkmcnt(3)
    ds_read_b128 v[108:111], v133 offset:1024
    buffer_load_dwordx4 v128, s[24:27], s56 offen nt lds
    v_mfma_f32_16x16x32_bf16 v[116:119], a[100:103], v[40:43], v[116:119]
    s_nop 0
    v_cvt_pk_f16_f32 v140, v100, v101
    v_cvt_pk_f16_f32 v141, v102, v103
    v_mfma_f32_16x16x32_bf16 v[116:119], a[104:107], v[64:67], v[116:119]
    ds_read_b128 v[100:103], v137 offset:256
    v_pk_fmac_f16 v32, v140, v140
    v_mfma_f32_16x16x32_bf16 v[116:119], a[108:111], v[44:47], v[116:119]
    ds_read_u16 v166, v131 offset:80
    v_pk_fmac_f16 v32, v141, v141
    v_mfma_f32_16x16x32_bf16 v[116:119], a[112:115], v[52:55], v[116:119]
    ds_read_u16 v162, v131 offset:96
    v_cvt_pk_bf16_f32 v165, v142, v143
    v_mfma_f32_16x16x32_bf16 v[116:119], a[116:119], v[36:39], v[116:119]
    ds_read_u16 v158, v131 offset:104
    v_cvt_pk_f16_f32 v142, v92, v93
    v_mfma_f32_16x16x32_bf16 v[112:115], v[60:63], a[192:195], 0
    ds_read_b128 v[60:63], v136 offset:0
    v_cvt_pk_f16_f32 v143, v94, v95
    v_mfma_f32_16x16x32_bf16 v[112:115], v[40:43], a[196:199], v[112:115]
    s_nop 0
    ds_read_b128 v[40:43], v133 offset:3072
    v_cvt_pk_f16_f32 v50, v116, v117
    v_mfma_f32_16x16x32_bf16 v[112:115], v[64:67], a[200:203], v[112:115]
    s_add_u32 m0, s67, 1024
    ds_read_b128 v[64:67], v137 offset:128
    v_cvt_pk_f16_f32 v51, v118, v119
    v_mfma_f32_16x16x32_bf16 v[112:115], v[44:47], a[204:207], v[112:115]
    s_waitcnt lgkmcnt(7)
    buffer_store_dwordx4 v[104:107], v128, s[28:31], s60 offen sc1
    buffer_load_dwordx4 v127, s[24:27], s56 offen nt lds
    ds_read_b128 v[44:47], v136 offset:256
    v_pk_fmac_f16 v33, v50, v50
    v_pk_fmac_f16 v33, v51, v51
    v_mfma_f32_16x16x32_bf16 v[112:115], v[52:55], a[208:211], v[112:115]
    v_pk_fmac_f16 v33, v142, v142
    v_pk_fmac_f16 v33, v143, v143
    v_mfma_f32_16x16x32_bf16 v[112:115], v[36:39], a[212:215], v[112:115]
    v_cvt_pk_bf16_f32 v24, v20, v21
    v_cvt_pk_bf16_f32 v25, v22, v23
    v_mfma_f32_16x16x32_f16 v[20:23], v[212:215], v[32:35], 0
    s_nop 0
    v_cvt_pk_bf16_f32 v160, v84, v85
    v_cvt_pk_bf16_f32 v161, v86, v87
    v_mfma_f32_16x16x32_f16 v[32:35], v[8:11], v[28:31], v[200:203]
    s_nop 0
    v_cvt_pk_bf16_f32 v156, v112, v113
    v_cvt_pk_bf16_f32 v157, v114, v115
    v_mfma_f32_16x16x32_f16 v[32:35], v[146:149], v[150:153], v[32:35]
    s_add_u32 m0, s67, 2048
    v_or3_b32 v123, v123, v20, v21
    v_mfma_f32_16x16x32_bf16 v[36:39], a[240:243], v[80:83], 0
    s_waitcnt lgkmcnt(2)
    ds_read_b128 v[52:55], v133 offset:4096
    v_mfma_f32_16x16x32_bf16 v[36:39], a[244:247], v[60:63], v[36:39]
    s_waitcnt lgkmcnt(2)
    buffer_store_dwordx4 v[108:111], v127, s[28:31], s60 offen sc1
    buffer_load_dwordx4 v126, s[24:27], s56 offen nt lds
    v_rsq_f32 v20, v20
    v_mfma_f32_16x16x32_bf16 v[36:39], a[248:251], v[64:67], v[36:39]
    v_rsq_f32 v21, v21
    v_mfma_f32_16x16x32_bf16 v[36:39], a[252:255], v[88:91], v[36:39]
    v_exp_f32 v32, v32
    v_mfma_f32_16x16x32_bf16 v[36:39], v[224:227], v[100:103], v[36:39]
    s_waitcnt lgkmcnt(1)
    v_exp_f32 v33, v33
    v_mfma_f32_16x16x32_bf16 v[36:39], v[228:231], v[44:47], v[36:39]
    v_mul_f32 v20, s52, v20
    v_cvt_pk_f16_f32 v20, v20, v21
    v_mfma_f32_16x16x32_bf16 v[92:95], a[216:219], v[80:83], 0
    v_pk_mul_f16 v56, v56, v20 op_sel:[0,0] op_sel_hi:[1,0]
    v_pk_mul_f16 v57, v57, v20 op_sel:[0,0] op_sel_hi:[1,0]
    v_mfma_f32_16x16x32_bf16 v[92:95], a[220:223], v[60:63], v[92:95]
    v_pk_mul_f16 v58, v58, v20 op_sel:[0,0] op_sel_hi:[1,0]
    v_pk_mul_f16 v59, v59, v20 op_sel:[0,0] op_sel_hi:[1,0]
    v_mfma_f32_16x16x32_bf16 v[92:95], a[224:227], v[64:67], v[92:95]
    v_pk_mul_f16 v140, v140, v20 op_sel:[0,0] op_sel_hi:[1,0]
    v_pk_mul_f16 v141, v141, v20 op_sel:[0,0] op_sel_hi:[1,0]
    v_mfma_f32_16x16x32_bf16 v[92:95], a[228:231], v[88:91], v[92:95]
    v_pk_mul_f16 v48, v48, v20 op_sel:[0,1] op_sel_hi:[1,1]
    v_pk_mul_f16 v49, v49, v20 op_sel:[0,1] op_sel_hi:[1,1]
    v_mfma_f32_16x16x32_bf16 v[92:95], a[232:235], v[100:103], v[92:95]
    v_pk_mul_f16 v50, v50, v20 op_sel:[0,1] op_sel_hi:[1,1]
    v_pk_mul_f16 v51, v51, v20 op_sel:[0,1] op_sel_hi:[1,1]
    v_mfma_f32_16x16x32_bf16 v[92:95], a[236:239], v[44:47], v[92:95]
    s_add_u32 m0, s67, 3072
    buffer_store_dwordx4 v[96:99], v126, s[28:31], s60 offen sc1
    v_pk_mul_f16 v142, v142, v20 op_sel:[0,1] op_sel_hi:[1,1]
    v_pk_mul_f16 v143, v143, v20 op_sel:[0,1] op_sel_hi:[1,1]
    v_exp_f32 v34, v34
    v_mfma_f32_16x16x32_f16 v[20:23], v[68:71], v[28:31], v[208:211]
    v_exp_f32 v35, v35
    v_mfma_f32_16x16x32_f16 v[20:23], v[76:79], v[12:15], v[20:23]
    v_cvt_pk_bf16_f32 v32, v32, v33
    v_cvt_pk_bf16_f32 v33, v34, v35
    v_mfma_f32_16x16x32_f16 v[20:23], v[72:75], v[152:155], v[20:23]
    s_nop 0
    buffer_load_dwordx4 v125, s[24:27], s56 offen nt lds
    v_mfma_f32_16x16x32_f16 v[84:87], v[48:51], v[28:31], v[196:199]
    s_add_u32 m0, s67, 4096
    s_nop 1
    v_mfma_f32_16x16x32_f16 v[84:87], v[140:143], v[150:153], v[84:87]
    s_nop 0
    v_exp_f32 v20, v20
    v_mfma_f32_16x16x32_f16 v[104:107], v[12:15], v[28:31], v[204:207]
    s_nop 0
    v_cvt_pk_bf16_f32 v170, v20, 0
    s_nop 0
    v_mfma_f32_16x16x32_f16 v[104:107], v[152:155], v[150:153], v[104:107]
    s_nop 0
    v_exp_f32 v84, v84
    v_mfma_f32_16x16x32_bf16 v[96:99], v[232:235], v[80:83], 0
    s_waitcnt lgkmcnt(0)
    buffer_store_dwordx4 v[40:43], v125, s[28:31], s60 offen sc1
    buffer_load_dwordx4 v124, s[24:27], s56 offen nt lds
    v_exp_f32 v85, v85
    v_mfma_f32_16x16x32_bf16 v[96:99], v[236:239], v[60:63], v[96:99]
    v_exp_f32 v104, v104
    v_mfma_f32_16x16x32_bf16 v[96:99], v[240:243], v[64:67], v[96:99]
    v_exp_f32 v105, v105
    v_mfma_f32_16x16x32_bf16 v[96:99], v[244:247], v[88:91], v[96:99]
    v_exp_f32 v106, v106
    v_mfma_f32_16x16x32_bf16 v[96:99], v[248:251], v[100:103], v[96:99]
    v_exp_f32 v107, v107
    v_mfma_f32_16x16x32_bf16 v[96:99], v[252:255], v[44:47], v[96:99]
    v_cvt_pk_bf16_f32 v30, v104, v105
    v_cvt_pk_bf16_f32 v31, v106, v107
    v_mfma_f32_16x16x32_f16 v[40:43], v[12:15], v[16:19], v[192:195]
    v_exp_f32 v86, v86
    v_mfma_f32_16x16x32_f16 v[40:43], v[152:155], v[144:147], v[40:43]
    v_exp_f32 v87, v87
    v_mfma_f32_16x16x32_f16 v[44:47], v[48:51], v[16:19], v[184:187]
    buffer_store_dwordx4 v[52:55], v124, s[28:31], s60 offen sc1
    v_cvt_pk_bf16_f32 v168, v84, v85
    v_cvt_pk_bf16_f32 v169, v86, v87
    s_nop 0
    v_mfma_f32_16x16x32_f16 v[44:47], v[140:143], v[144:147], v[44:47]
    s_mov_b32 s53, s47
    v_exp_f32 v40, v40
    v_mfma_f32_16x16x32_f16 v[60:63], v[48:51], v[56:59], v[172:175]
    s_mov_b32 s47, s46
    v_exp_f32 v41, v41
    v_mfma_f32_16x16x32_f16 v[60:63], v[140:143], v[138:141], v[60:63]
    s_mov_b32 s46, s45
    v_exp_f32 v42, v42
    v_mfma_f32_16x16x32_f16 v[64:67], v[68:71], v[56:59], v[208:211]
    s_mov_b32 s45, s44
    v_exp_f32 v43, v43
    v_mfma_f32_16x16x32_f16 v[64:67], v[76:79], v[48:51], v[64:67]
    s_mov_b32 s44, s53
    v_cvt_pk_bf16_f32 v20, v40, v41
    v_cvt_pk_bf16_f32 v21, v42, v43
    v_mfma_f32_16x16x32_f16 v[64:67], v[72:75], v[140:143], v[64:67]
    s_sub_u32 s48, s44, s46
    ds_read_b128 v[40:43], v136 offset:1536
    v_mfma_f32_16x16x32_f16 v[84:87], v[68:71], v[16:19], v[208:211]
    s_sub_u32 s49, s46, s45
    ds_read_b128 v[52:55], v137 offset:1792
    v_fma_f32 v28, v92, v92, s42
    v_mfma_f32_16x16x32_f16 v[84:87], v[76:79], v[8:11], v[84:87]
    s_cmp_lg_u32 s5, -1
    ds_read_b128 v[80:83], v137 offset:1664
    v_fmac_f32 v28, v93, v93
    v_mfma_f32_16x16x32_f16 v[84:87], v[72:75], v[146:149], v[84:87]
    s_nop 0
    v_exp_f32 v44, v44
    v_mfma_f32_16x16x32_bf16 v[68:71], v[220:223], v[30:33], 0
    s_nop 0
    v_exp_f32 v45, v45
    v_mfma_f32_16x16x32_bf16 v[68:71], v[220:223], v[168:171], v[68:71]
    s_nop 0
    ds_read_b128 v[76:79], v137 offset:1536
    v_mov_b32_dpp v23, v87 quad_perm:[0,1,2,3] row_mask:0x2 bank_mask:0xf
    v_mfma_f32_16x16x32_bf16 v[104:107], v[0:3], v[30:33], 0
    ds_read_b128 v[86:89], v136 offset:1664
    v_mov_b32_dpp v23, v67 quad_perm:[0,1,2,3] row_mask:0x4 bank_mask:0xf
    v_mfma_f32_16x16x32_bf16 v[104:107], v[164:167], v[168:171], v[104:107]
    v_exp_f32 v46, v46
    v_mfma_f32_16x16x32_bf16 v[72:75], v[24:27], v[30:33], 0
    v_exp_f32 v47, v47
    v_mfma_f32_16x16x32_bf16 v[72:75], v[160:163], v[168:171], v[72:75]
    v_exp_f32 v85, v85
    v_mfma_f32_16x16x32_bf16 v[116:119], v[4:7], v[30:33], 0
    ds_read_b128 v[30:33], v136 offset:1792
    v_fmac_f32 v28, v94, v94
    v_mfma_f32_16x16x32_bf16 v[116:119], v[156:159], v[168:171], v[116:119]
    v_exp_f32 v23, v23
    v_mfma_f32_16x16x32_f16 v[108:111], v[12:15], v[56:59], v[180:183]
    v_cvt_pk_bf16_f32 v23, v23, v23
    v_cvt_pk_bf16_f32 v168, v44, v45
    v_mfma_f32_16x16x32_f16 v[108:111], v[152:155], v[138:141], v[108:111]
    v_rcp_f32 v68, v68
    v_mfma_f32_16x16x32_f16 v[152:155], v[8:11], v[56:59], v[176:179]
    ds_write_b16 v131, v23 offset:64
    v_mfma_f32_16x16x32_f16 v[152:155], v[146:149], v[138:141], v[152:155]
    s_waitcnt lgkmcnt(2)
    v_mul_f32 v104, v104, v68
    v_mul_f32 v105, v105, v68
    v_mfma_f32_16x16x32_bf16 v[56:59], a[216:219], v[76:79], 0
    v_cvt_pk_bf16_f32 v12, v104, v105
    v_mul_f32 v106, v106, v68
    v_mfma_f32_16x16x32_bf16 v[56:59], a[220:223], v[40:43], v[56:59]
    ds_read_b128 v[100:103], v132 offset:48
    v_mul_f32 v107, v107, v68
    v_mfma_f32_16x16x32_bf16 v[56:59], a[224:227], v[80:83], v[56:59]
    ds_read_b128 v[140:143], v132 offset:64
    v_cvt_pk_bf16_f32 v13, v106, v107
    v_mfma_f32_16x16x32_bf16 v[56:59], a[228:231], v[86:89], v[56:59]
    v_mul_f32 v72, v72, v68
    v_mul_f32 v73, v73, v68
    v_mfma_f32_16x16x32_bf16 v[56:59], a[232:235], v[52:55], v[56:59]
    s_waitcnt lgkmcnt(3)
    v_cvt_pk_bf16_f32 v14, v72, v73
    v_mul_f32 v74, v74, v68
    v_mfma_f32_16x16x32_bf16 v[56:59], a[236:239], v[30:33], v[56:59]
    v_mul_f32 v75, v75, v68
    v_cvt_pk_bf16_f32 v15, v74, v75
    v_mfma_f32_16x16x32_bf16 v[104:107], v[232:235], v[76:79], 0
    ds_write_b64 v135, v[12:13] offset:0
    v_mfma_f32_16x16x32_bf16 v[104:107], v[236:239], v[40:43], v[104:107]
    v_mul_f32 v116, v116, v68
    v_mul_f32 v117, v117, v68
    v_mfma_f32_16x16x32_bf16 v[104:107], v[240:243], v[80:83], v[104:107]
    v_cvt_pk_bf16_f32 v22, v116, v117
    v_mul_f32 v118, v118, v68
    v_mfma_f32_16x16x32_bf16 v[104:107], v[244:247], v[86:89], v[104:107]
    ds_read_b128 v[72:75], v137 offset:3200
    v_mul_f32 v119, v119, v68
    v_mfma_f32_16x16x32_bf16 v[104:107], v[248:251], v[52:55], v[104:107]
    v_cvt_pk_bf16_f32 v23, v118, v119
    v_cvt_pk_bf16_f32 v169, v46, v47
    v_mfma_f32_16x16x32_bf16 v[104:107], v[252:255], v[30:33], v[104:107]
    s_waitcnt lgkmcnt(2)
    v_cvt_pk_bf16_f32 v170, v85, 0
    v_fmac_f32 v28, v95, v95
    v_mfma_f32_16x16x32_bf16 v[44:47], v[100:103], v[0:3], 0
    v_exp_f32 v60, v60
    v_mfma_f32_16x16x32_bf16 v[44:47], v[140:143], v[164:167], v[44:47]
    ds_write_b64 v135, v[14:15] offset:8
    v_mfma_f32_16x16x32_bf16 v[12:15], v[100:103], v[24:27], 0
    v_exp_f32 v61, v61
    v_mfma_f32_16x16x32_bf16 v[12:15], v[140:143], v[160:163], v[12:15]
    v_exp_f32 v62, v62
    v_mfma_f32_16x16x32_bf16 v[68:71], v[100:103], v[4:7], 0
    s_nop 0
    ds_read_b128 v[116:119], v137 offset:3072
    v_fmac_f32 v28, v36, v36
    v_mfma_f32_16x16x32_bf16 v[68:71], v[140:143], v[156:159], v[68:71]
    s_nop 0
    ds_read_b128 v[100:103], v136 offset:3072
    v_mov_b32_dpp v47, v15 quad_perm:[0,1,2,3] row_mask:0x2 bank_mask:0xf
    v_mfma_f32_16x16x32_bf16 v[140:143], a[240:243], v[76:79], 0
    ds_read_b128 v[12:15], v136 offset:3200
    v_fmac_f32 v28, v37, v37
    v_mfma_f32_16x16x32_bf16 v[140:143], a[244:247], v[40:43], v[140:143]
    ds_read_b128 v[40:43], v137 offset:3328
    v_mov_b32_dpp v47, v71 quad_perm:[0,1,2,3] row_mask:0x4 bank_mask:0xf
    v_mfma_f32_16x16x32_bf16 v[140:143], a[248:251], v[80:83], v[140:143]
    ds_read_b128 v[80:83], v136 offset:3328
    v_cvt_pk_bf16_f32 v47, v47, v47
    v_mfma_f32_16x16x32_bf16 v[140:143], a[252:255], v[86:89], v[140:143]
    v_exp_f32 v63, v63
    v_mfma_f32_16x16x32_bf16 v[140:143], v[224:227], v[52:55], v[140:143]
    v_exp_f32 v66, v66
    v_mfma_f32_16x16x32_bf16 v[140:143], v[228:231], v[30:33], v[140:143]
    v_exp_f32 v152, v152
    v_mfma_f32_16x16x32_f16 v[30:33], v[8:11], v[16:19], v[188:191]
    ds_write_b32 v134, v22 offset:0
    v_mfma_f32_16x16x32_f16 v[30:33], v[146:149], v[144:147], v[30:33]
    s_waitcnt lgkmcnt(5)
    v_exp_f32 v153, v153
    v_mfma_f32_16x16x32_bf16 v[84:87], a[240:243], v[116:119], 0
    s_waitcnt lgkmcnt(4)
    v_exp_f32 v154, v154
    v_mfma_f32_16x16x32_bf16 v[84:87], a[244:247], v[100:103], v[84:87]
    v_exp_f32 v155, v155
    v_mfma_f32_16x16x32_bf16 v[84:87], a[248:251], v[72:75], v[84:87]
    s_waitcnt lgkmcnt(2)
    ds_write_b32 v134, v23 offset:4
    v_mfma_f32_16x16x32_bf16 v[84:87], a[252:255], v[12:15], v[84:87]
    v_cvt_pk_bf16_f32 v34, v152, v153
    v_cvt_pk_bf16_f32 v35, v154, v155
    v_mfma_f32_16x16x32_bf16 v[84:87], v[224:227], v[40:43], v[84:87]
    s_waitcnt lgkmcnt(2)
    v_exp_f32 v30, v30
    v_mfma_f32_16x16x32_bf16 v[84:87], v[228:231], v[80:83], v[84:87]
    v_exp_f32 v31, v31
    v_mfma_f32_16x16x32_bf16 v[52:55], a[216:219], v[116:119], 0
    ds_write_b16 v131, v47
    v_mfma_f32_16x16x32_bf16 v[52:55], a[220:223], v[100:103], v[52:55]
    v_exp_f32 v32, v32
    v_mfma_f32_16x16x32_bf16 v[52:55], a[224:227], v[72:75], v[52:55]
    v_exp_f32 v33, v33
    v_mfma_f32_16x16x32_bf16 v[52:55], a[228:231], v[12:15], v[52:55]
    v_cvt_pk_bf16_f32 v22, v30, v31
    v_cvt_pk_bf16_f32 v23, v32, v33
    v_mfma_f32_16x16x32_bf16 v[52:55], a[232:235], v[40:43], v[52:55]
    v_exp_f32 v108, v108
    v_mfma_f32_16x16x32_bf16 v[52:55], a[236:239], v[80:83], v[52:55]
    v_exp_f32 v109, v109
    v_mfma_f32_16x16x32_bf16 v[152:155], v[220:223], v[20:23], 0
    v_exp_f32 v110, v110
    v_mfma_f32_16x16x32_bf16 v[152:155], v[220:223], v[168:171], v[152:155]
    s_nop 0
    v_exp_f32 v111, v111
    v_mfma_f32_16x16x32_bf16 v[8:11], v[0:3], v[20:23], 0
    s_nop 0
    v_cvt_pk_bf16_f32 v32, v108, v109
    v_cvt_pk_bf16_f32 v33, v110, v111
    v_mfma_f32_16x16x32_bf16 v[8:11], v[164:167], v[168:171], v[8:11]
    s_nop 0
    v_rcp_f32 v152, v152
    v_mfma_f32_16x16x32_bf16 v[44:47], v[24:27], v[20:23], 0
    v_add_u32 v137, s48, v137
    v_add_u32 v136, s48, v136
    v_mfma_f32_16x16x32_bf16 v[44:47], v[160:163], v[168:171], v[44:47]
    s_nop 0
    ds_read_b128 v[146:149], v137 offset:0
    v_mul_f32 v8, v8, v152
    v_mfma_f32_16x16x32_bf16 v[16:19], v[4:7], v[20:23], 0
    ds_read_b128 v[88:91], v136 offset:0
    v_mul_f32 v9, v9, v152
    v_mfma_f32_16x16x32_bf16 v[16:19], v[156:159], v[168:171], v[16:19]
    ds_read_b128 v[108:111], v137 offset:128
    v_cvt_pk_bf16_f32 v168, v60, v61
    v_mfma_f32_16x16x32_bf16 v[48:51], v[232:235], v[116:119], 0
    ds_read_b128 v[116:119], v136 offset:128
    v_cvt_pk_bf16_f32 v169, v62, v63
    v_mfma_f32_16x16x32_bf16 v[48:51], v[236:239], v[100:103], v[48:51]
    ds_read_b128 v[60:63], v137 offset:256
    v_cvt_pk_bf16_f32 v170, v66, 0
    v_mfma_f32_16x16x32_bf16 v[48:51], v[240:243], v[72:75], v[48:51]
    ds_read_b128 v[64:67], v136 offset:256
    v_cvt_pk_bf16_f32 v20, v8, v9
    v_mfma_f32_16x16x32_bf16 v[48:51], v[244:247], v[12:15], v[48:51]
    v_mul_f32 v10, v10, v152
    v_mul_f32 v11, v11, v152
    v_mfma_f32_16x16x32_bf16 v[48:51], v[248:251], v[40:43], v[48:51]
    ds_read_b128 v[100:103], v136 offset:1536
    v_cvt_pk_bf16_f32 v21, v10, v11
    v_mfma_f32_16x16x32_bf16 v[48:51], v[252:255], v[80:83], v[48:51]
    ds_read_b128 v[80:83], v137 offset:1664
    v_mul_f32 v44, v44, v152
    v_mfma_f32_16x16x32_bf16 v[12:15], v[220:223], v[32:35], 0
    ds_read_b128 v[68:71], v137 offset:1536
    v_mul_f32 v45, v45, v152
    v_mfma_f32_16x16x32_bf16 v[12:15], v[220:223], v[168:171], v[12:15]
    ds_read_b128 v[76:79], v136 offset:1792
    v_cvt_pk_bf16_f32 v22, v44, v45
    v_mfma_f32_16x16x32_bf16 v[72:75], v[0:3], v[32:35], 0
    v_mul_f32 v46, v46, v152
    v_mul_f32 v47, v47, v152
    v_mfma_f32_16x16x32_bf16 v[72:75], v[164:167], v[168:171], v[72:75]
    v_cvt_pk_bf16_f32 v23, v46, v47
    v_mul_f32 v16, v16, v152
    v_mfma_f32_16x16x32_bf16 v[0:3], v[24:27], v[32:35], 0
    v_mul_f32 v17, v17, v152
    v_cvt_pk_bf16_f32 v154, v16, v17
    v_mfma_f32_16x16x32_bf16 v[0:3], v[160:163], v[168:171], v[0:3]
    ds_write_b32 v135, v20 offset:1536
    v_mfma_f32_16x16x32_bf16 v[8:11], v[4:7], v[32:35], 0
    v_mul_f32 v18, v18, v152
    v_mul_f32 v19, v19, v152
    v_mfma_f32_16x16x32_bf16 v[8:11], v[156:159], v[168:171], v[8:11]
    s_waitcnt lgkmcnt(4)
    v_cvt_pk_bf16_f32 v155, v18, v19
    v_fmac_f32 v28, v38, v38
    v_mfma_f32_16x16x32_bf16 v[30:33], a[0:3], v[146:149], 0
    s_cbranch_scc1 L_loopF0
    ds_write_b32 v135, v21 offset:1540
    v_rcp_f32 v12, v12
    s_mov_b32 s30, 100270464
    s_mul_i32 s89, s68, 7168
    ds_write_b64 v135, v[22:23] offset:1544
    v_mul_f32 v72, v72, v12
    v_mul_f32 v73, v73, v12
    v_cvt_pk_bf16_f32 v4, v72, v73
    s_add_u32 s89, s89, 135168
    s_movk_i32 s90, 112
    ds_write_b64 v134, v[154:155] offset:1536
    v_mul_f32 v74, v74, v12
    v_mul_f32 v75, v75, v12
    v_cvt_pk_bf16_f32 v5, v74, v75
    v_mul_f32 v0, v0, v12
    v_mul_f32 v1, v1, v12
    v_cvt_pk_bf16_f32 v6, v0, v1
    v_mul_f32 v2, v2, v12
    v_mul_f32 v3, v3, v12
    v_cvt_pk_bf16_f32 v7, v2, v3
    v_mul_f32 v8, v8, v12
    v_mul_f32 v9, v9, v12
    v_cvt_pk_bf16_f32 v8, v8, v9
    v_mul_f32 v10, v10, v12
    v_mul_f32 v11, v11, v12
    v_cvt_pk_bf16_f32 v9, v10, v11
    s_lshr_b32 s91, s64, 16
    s_lshl_b32 s92, s68, 10
    ds_write_b64 v135, v[4:5] offset:3072
    v_fmac_f32 v28, v39, v39
    s_sub_u32 s84, s45, s44
    s_sub_u32 s85, s46, s45
    ds_write_b64 v135, v[6:7] offset:3080
    v_fmac_f32 v28, v96, v96
    v_fmac_f32 v28, v97, v97
    v_fmac_f32 v28, v98, v98
    s_sub_u32 s86, s44, s45
    s_sub_u32 s93, s44, s47
    ds_write_b32 v134, v8 offset:3072
    ds_write_b32 v134, v9 offset:3076
    v_fmac_f32 v28, v99, v99
    v_fma_f32 v131, v56, v56, s42
    v_fmac_f32 v131, v57, v57
    v_fmac_f32 v131, v58, v58
    v_fmac_f32 v131, v59, v59
    v_fmac_f32 v131, v140, v140
    v_fmac_f32 v131, v141, v141
    v_fmac_f32 v131, v142, v142
    v_fmac_f32 v131, v143, v143
    v_fmac_f32 v131, v104, v104
    v_fmac_f32 v131, v105, v105
    v_fmac_f32 v131, v106, v106
    v_fmac_f32 v131, v107, v107
    v_fma_f32 v121, v52, v52, s42
    v_fmac_f32 v121, v53, v53
    v_fmac_f32 v121, v54, v54
    v_fmac_f32 v121, v55, v55
    v_fmac_f32 v121, v84, v84
    v_fmac_f32 v121, v85, v85
    v_fmac_f32 v121, v86, v86
    v_fmac_f32 v121, v87, v87
    v_fmac_f32 v121, v48, v48
    v_fmac_f32 v121, v49, v49
    v_fmac_f32 v121, v50, v50
    v_fmac_f32 v121, v51, v51
    v_cvt_pk_bf16_f32 v120, v28, v131
    v_cvt_pk_bf16_f32 v121, v121, v122
    s_sub_u32 s94, s45, s47
    s_sub_u32 s95, s46, s47
    ds_write_b64 v130, v[120:121]
    v_mbcnt_lo_u32_b32 v131, -1, 0
    v_mbcnt_hi_u32_b32 v131, -1, v131
    v_and_b32 v120, 15, v131
    v_lshrrev_b32 v131, 4, v131
    v_mul_u32_u24 v131, 1792, v131
    v_add_u32 v131, s89, v131
    v_mad_u32_u24 v132, v120, s90, v131
    v_lshrrev_b32 v121, v120, s64
    v_and_b32 v121, 1, v121
    v_cmp_eq_u32 vcc, 1, v121
    v_mad_u32_u24 v122, v120, s90, v131
    v_lshrrev_b32 v120, v120, s91
    v_cndmask_b32 v132, v131, v132, vcc
    v_and_b32 v120, 1, v120
    v_subrev_u32 v122, 28672, v122
    v_cmp_eq_u32 vcc, 1, v120
    ds_read_b128 v[20:23], v132 offset:64
    ds_read_b128 v[16:19], v132 offset:80
    v_cndmask_b32 v122, v131, v122, vcc
    v_add_u32 v131, s92, v129
    s_waitcnt lgkmcnt(2)
    s_barrier
    ds_read_b128 v[114:117], v132
    v_add_u32 v29, s84, v137
    ds_read_b64 v[118:119], v132 offset:16
    ds_read_b128 v[4:7], v131 offset:6144
    v_add_u32 v28, s84, v136
    v_add_u32 v121, s85, v135
    ds_read_b128 v[8:11], v129 offset:0
    v_add_u32 v120, s85, v134
    ds_read_b128 v[0:3], v129 offset:1024
    v_add_u32 v138, s86, v135
    v_add_u32 v132, s86, v134
    v_add_u32 v131, s93, v133
    v_add_u32 v139, s94, v133
    s_waitcnt lgkmcnt(6)
    v_mfma_f32_16x16x32_bf16 v[12:15], v[220:223], v[20:23], 0
    s_waitcnt lgkmcnt(5)
    ds_read_b128 v[76:79], v29 offset:1536
    ds_read_b128 v[72:75], v28 offset:1536
    v_mfma_f32_16x16x32_bf16 v[12:15], v[220:223], v[16:19], v[12:15]
    s_waitcnt lgkmcnt(3)
    ds_read_b128 v[68:71], v29 offset:1664
    v_lshlrev_b32 v80, 16, v114
    v_and_b32 v114, 0xffff0000, v114
    v_lshlrev_b32 v81, 16, v115
    v_and_b32 v115, 0xffff0000, v115
    v_lshlrev_b32 v82, 16, v116
    v_and_b32 v116, 0xffff0000, v116
    v_rcp_f32 v12, v12
    v_lshlrev_b32 v83, 16, v117
    v_mfma_f32_16x16x32_bf16 v[16:19], v[216:219], v[8:11], 0
    s_waitcnt lgkmcnt(3)
    ds_read_b128 v[64:67], v28 offset:1664
    ds_read_b128 v[44:47], v29 offset:1792
    v_mfma_f32_16x16x32_bf16 v[16:19], v[216:219], v[0:3], v[16:19]
    s_waitcnt lgkmcnt(4)
    ds_read_b128 v[40:43], v28 offset:1792
    v_mul_f32 v80, v80, v12
    v_mul_f32 v114, v114, v12
    v_cvt_pk_bf16_f32 v80, v80, v114
    v_mul_f32 v81, v81, v12
    v_mfma_f32_16x16x32_bf16 v[8:11], a[216:219], v[76:79], 0
    s_waitcnt lgkmcnt(4)
    v_mul_f32 v115, v115, v12
    v_cvt_pk_bf16_f32 v81, v81, v115
    v_mfma_f32_16x16x32_bf16 v[8:11], a[220:223], v[72:75], v[8:11]
    s_waitcnt lgkmcnt(3)
    ds_read_b128 v[112:115], v29 offset:0
    ds_read_b128 v[108:111], v28 offset:0
    v_mfma_f32_16x16x32_bf16 v[8:11], a[224:227], v[68:71], v[8:11]
    s_waitcnt lgkmcnt(4)
    ds_read_b128 v[60:63], v29 offset:128
    v_mul_f32 v82, v82, v12
    v_mul_f32 v116, v116, v12
    v_cvt_pk_bf16_f32 v82, v82, v116
    v_and_b32 v117, 0xffff0000, v117
    v_mul_f32 v83, v83, v12
    v_mfma_f32_16x16x32_bf16 v[8:11], a[228:231], v[64:67], v[8:11]
    s_waitcnt lgkmcnt(4)
    ds_read_b128 v[32:35], v28 offset:128
    ds_read_b128 v[20:23], v29 offset:256
    v_mfma_f32_16x16x32_bf16 v[8:11], a[232:235], v[44:47], v[8:11]
    s_waitcnt lgkmcnt(5)
    ds_read_b128 v[0:3], v28 offset:256
    v_mul_f32 v117, v117, v12
    v_mfma_f32_16x16x32_bf16 v[8:11], a[236:239], v[40:43], v[8:11]
    v_cvt_pk_bf16_f32 v83, v83, v117
    v_lshlrev_b32 v19, 16, v118
    v_mfma_f32_16x16x32_bf16 v[24:27], a[240:243], v[76:79], 0
    ds_write_b128 v138, v[80:83] offset:0
    v_mfma_f32_16x16x32_bf16 v[24:27], a[244:247], v[72:75], v[24:27]
    v_and_b32 v118, 0xffff0000, v118
    v_mul_f32 v19, v19, v12
    v_mfma_f32_16x16x32_bf16 v[24:27], a[248:251], v[68:71], v[24:27]
    v_mul_f32 v118, v118, v12
    v_cvt_pk_bf16_f32 v30, v19, v118
    v_mfma_f32_16x16x32_bf16 v[24:27], a[252:255], v[64:67], v[24:27]
    v_lshlrev_b32 v19, 16, v119
    v_and_b32 v119, 0xffff0000, v119
    v_mfma_f32_16x16x32_bf16 v[24:27], v[224:227], v[44:47], v[24:27]
    v_mul_f32 v19, v19, v12
    v_mul_f32 v119, v119, v12
    v_mfma_f32_16x16x32_bf16 v[24:27], v[228:231], v[40:43], v[24:27]
    v_cvt_pk_bf16_f32 v31, v19, v119
    v_lshrrev_b32 v19, 0, v7
    v_mfma_f32_16x16x32_bf16 v[12:15], v[232:235], v[76:79], 0
    ds_write_b64 v132, v[30:31] offset:0
    v_mfma_f32_16x16x32_bf16 v[12:15], v[236:239], v[72:75], v[12:15]
    v_lshrrev_b32 v19, v19, s64
    v_and_b32 v19, 1, v19
    v_mfma_f32_16x16x32_bf16 v[12:15], v[240:243], v[68:71], v[12:15]
    v_cmp_eq_u32 vcc, 1, v19
    v_lshrrev_b32 v19, 8, v7
    v_mfma_f32_16x16x32_bf16 v[12:15], v[244:247], v[64:67], v[12:15]
    v_cndmask_b32 v4, 2.0, v4, vcc
    v_lshrrev_b32 v19, v19, s64
    v_mfma_f32_16x16x32_bf16 v[12:15], v[248:251], v[44:47], v[12:15]
    v_and_b32 v19, 1, v19
    v_cmp_eq_u32 vcc, 1, v19
    v_mfma_f32_16x16x32_bf16 v[12:15], v[252:255], v[40:43], v[12:15]
    s_waitcnt lgkmcnt(1)
    v_cndmask_b32 v5, 2.0, v5, vcc
    v_lshrrev_b32 v7, 16, v7
    v_mfma_f32_16x16x32_bf16 v[68:71], a[216:219], v[112:115], 0
    v_lshrrev_b32 v7, v7, s64
    v_and_b32 v7, 1, v7
    v_mfma_f32_16x16x32_bf16 v[68:71], a[220:223], v[108:111], v[68:71]
    ds_read_b128 v[100:103], v29 offset:3072
    ds_read_b128 v[88:91], v28 offset:3072
    v_mfma_f32_16x16x32_bf16 v[68:71], a[224:227], v[60:63], v[68:71]
    ds_read_b128 v[80:83], v29 offset:3200
    v_cmp_eq_u32 vcc, 1, v7
    v_mfma_f32_16x16x32_bf16 v[68:71], a[228:231], v[32:35], v[68:71]
    ds_read_b128 v[76:79], v28 offset:3200
    v_cndmask_b32 v6, 2.0, v6, vcc
    v_mfma_f32_16x16x32_bf16 v[68:71], a[232:235], v[20:23], v[68:71]
L_pg2:
    s_cbranch_execz L_main
    ds_read_b128 v[64:67], v29 offset:3328
    v_add_u32 v7, s95, v133
    v_mfma_f32_16x16x32_bf16 v[68:71], a[236:239], v[0:3], v[68:71]
    ds_read_b128 v[28:31], v28 offset:3328
    v_fma_f32 v133, v8, v8, s42
    v_mfma_f32_16x16x32_bf16 v[44:47], a[240:243], v[112:115], 0
    v_rsq_f32 v16, v16
    v_mfma_f32_16x16x32_bf16 v[44:47], a[244:247], v[108:111], v[44:47]
    v_mul_f32 v16, s43, v16
    v_mul_f32 v92, v92, v16
    v_mfma_f32_16x16x32_bf16 v[44:47], a[248:251], v[60:63], v[44:47]
    v_mul_f32 v93, v93, v16
    v_cvt_pk_bf16_f32 v72, v92, v93
    v_mfma_f32_16x16x32_bf16 v[44:47], a[252:255], v[32:35], v[44:47]
    v_mul_f32 v94, v94, v16
    v_mul_f32 v95, v95, v16
    v_mfma_f32_16x16x32_bf16 v[44:47], v[224:227], v[20:23], v[44:47]
    v_cvt_pk_bf16_f32 v73, v94, v95
    v_mul_f32 v36, v36, v16
    v_mfma_f32_16x16x32_bf16 v[44:47], v[228:231], v[0:3], v[44:47]
    v_mul_f32 v37, v37, v16
    v_cvt_pk_bf16_f32 v74, v36, v37
    v_mfma_f32_16x16x32_bf16 v[40:43], v[232:235], v[112:115], 0
    v_mul_f32 v38, v38, v16
    v_mul_f32 v39, v39, v16
    v_mfma_f32_16x16x32_bf16 v[40:43], v[236:239], v[108:111], v[40:43]
    v_cvt_pk_bf16_f32 v75, v38, v39
    v_mul_f32 v96, v96, v16
    v_mfma_f32_16x16x32_bf16 v[40:43], v[240:243], v[60:63], v[40:43]
    ds_write_b128 v121, v[72:75] offset:0
    v_mfma_f32_16x16x32_bf16 v[40:43], v[244:247], v[32:35], v[40:43]
    v_mul_f32 v97, v97, v16
    v_cvt_pk_bf16_f32 v96, v96, v97
    v_mfma_f32_16x16x32_bf16 v[40:43], v[248:251], v[20:23], v[40:43]
    v_mul_f32 v98, v98, v16
    v_mul_f32 v99, v99, v16
    v_mfma_f32_16x16x32_bf16 v[40:43], v[252:255], v[0:3], v[40:43]
    s_waitcnt lgkmcnt(1)
    v_cvt_pk_bf16_f32 v97, v98, v99
    v_fma_f32 v38, v68, v68, s42
    v_mfma_f32_16x16x32_bf16 v[20:23], a[216:219], v[100:103], 0
    ds_write_b64 v120, v[96:97] offset:0
    v_mfma_f32_16x16x32_bf16 v[20:23], a[220:223], v[88:91], v[20:23]
    ds_read_b128 v[60:63], v122 offset:64
    v_fmac_f32 v38, v69, v69
    v_mfma_f32_16x16x32_bf16 v[20:23], a[224:227], v[80:83], v[20:23]
    ds_read_b128 v[0:3], v122 offset:80
    v_fmac_f32 v38, v70, v70
    v_mfma_f32_16x16x32_bf16 v[20:23], a[228:231], v[76:79], v[20:23]
    ds_read_b128 v[32:35], v122
    v_fmac_f32 v38, v71, v71
    v_mfma_f32_16x16x32_bf16 v[20:23], a[232:235], v[64:67], v[20:23]
    ds_read_b64 v[36:37], v122 offset:16
    v_fmac_f32 v38, v44, v44
    v_mfma_f32_16x16x32_bf16 v[20:23], a[236:239], v[28:31], v[20:23]
    v_rsq_f32 v17, v17
    v_mfma_f32_16x16x32_bf16 v[96:99], a[240:243], v[100:103], 0
    v_mul_f32 v17, s43, v17
    v_mul_f32 v56, v56, v17
    v_mfma_f32_16x16x32_bf16 v[96:99], a[244:247], v[88:91], v[96:99]
    v_mul_f32 v57, v57, v17
    v_cvt_pk_bf16_f32 v56, v56, v57
    v_mfma_f32_16x16x32_bf16 v[96:99], a[248:251], v[80:83], v[96:99]
    v_mul_f32 v58, v58, v17
    v_mul_f32 v59, v59, v17
    v_mfma_f32_16x16x32_bf16 v[96:99], a[252:255], v[76:79], v[96:99]
    v_cvt_pk_bf16_f32 v57, v58, v59
    v_mul_f32 v140, v140, v17
    v_mfma_f32_16x16x32_bf16 v[96:99], v[224:227], v[64:67], v[96:99]
    v_mul_f32 v141, v141, v17
    v_cvt_pk_bf16_f32 v58, v140, v141
    v_mfma_f32_16x16x32_bf16 v[96:99], v[228:231], v[28:31], v[96:99]
    v_mul_f32 v142, v142, v17
    v_mul_f32 v143, v143, v17
    v_mfma_f32_16x16x32_bf16 v[72:75], v[232:235], v[100:103], 0
    v_cvt_pk_bf16_f32 v59, v142, v143
    v_mul_f32 v104, v104, v17
    v_mfma_f32_16x16x32_bf16 v[72:75], v[236:239], v[88:91], v[72:75]
    ds_write_b128 v121, v[56:59] offset:1536
    v_mfma_f32_16x16x32_bf16 v[72:75], v[240:243], v[80:83], v[72:75]
    v_mul_f32 v105, v105, v17
    v_cvt_pk_bf16_f32 v104, v104, v105
    v_mfma_f32_16x16x32_bf16 v[72:75], v[244:247], v[76:79], v[72:75]
    v_mul_f32 v106, v106, v17
    v_mul_f32 v107, v107, v17
    v_mfma_f32_16x16x32_bf16 v[72:75], v[248:251], v[64:67], v[72:75]
    v_cvt_pk_bf16_f32 v105, v106, v107
    v_fmac_f32 v38, v45, v45
    v_mfma_f32_16x16x32_bf16 v[72:75], v[252:255], v[28:31], v[72:75]
    s_waitcnt lgkmcnt(1)
    ds_write_b64 v120, v[104:105] offset:1536
    v_mfma_f32_16x16x32_bf16 v[28:31], v[220:223], v[60:63], 0
    v_rsq_f32 v18, v18
    v_mfma_f32_16x16x32_bf16 v[28:31], v[220:223], v[0:3], v[28:31]
    v_mul_f32 v18, s43, v18
    v_mul_f32 v52, v52, v18
    v_mul_f32 v53, v53, v18
    v_cvt_pk_bf16_f32 v0, v52, v53
    v_mul_f32 v54, v54, v18
    v_mul_f32 v55, v55, v18
    v_cvt_pk_bf16_f32 v1, v54, v55
    v_mul_f32 v84, v84, v18
    v_mul_f32 v85, v85, v18
    v_cvt_pk_bf16_f32 v2, v84, v85
    v_mul_f32 v86, v86, v18
    v_mul_f32 v87, v87, v18
    v_cvt_pk_bf16_f32 v3, v86, v87
    v_mul_f32 v48, v48, v18
    v_mul_f32 v49, v49, v18
    v_cvt_pk_bf16_f32 v48, v48, v49
    v_mul_f32 v50, v50, v18
    v_mul_f32 v51, v51, v18
    v_cvt_pk_bf16_f32 v49, v50, v51
    ds_write_b128 v121, v[0:3] offset:3072
    v_fmac_f32 v38, v46, v46
    v_fmac_f32 v38, v47, v47
    v_fmac_f32 v38, v40, v40
    v_fmac_f32 v38, v41, v41
    ds_write_b64 v120, v[48:49] offset:3072
    v_fmac_f32 v38, v42, v42
    v_fmac_f32 v38, v43, v43
    v_fmac_f32 v133, v9, v9
    v_fmac_f32 v133, v10, v10
    v_fmac_f32 v133, v11, v11
    v_fmac_f32 v133, v24, v24
    v_fmac_f32 v133, v25, v25
    v_fmac_f32 v133, v26, v26
    v_fmac_f32 v133, v27, v27
    v_fmac_f32 v133, v12, v12
    v_fmac_f32 v133, v13, v13
    v_fmac_f32 v133, v14, v14
    v_fmac_f32 v133, v15, v15
    v_cvt_pk_bf16_f32 v38, v38, v133
    v_fma_f32 v133, v20, v20, s42
    v_fmac_f32 v133, v21, v21
    v_fmac_f32 v133, v22, v22
    v_fmac_f32 v133, v23, v23
    v_fmac_f32 v133, v96, v96
    v_fmac_f32 v133, v97, v97
    v_fmac_f32 v133, v98, v98
    v_fmac_f32 v133, v99, v99
    v_fmac_f32 v133, v72, v72
    v_fmac_f32 v133, v73, v73
    v_fmac_f32 v133, v74, v74
    v_fmac_f32 v133, v75, v75
    v_cvt_pk_bf16_f32 v39, v133, v133
    ds_write_b64 v130, v[38:39] offset:2048
    v_rcp_f32 v28, v28
    v_lshlrev_b32 v133, 16, v32
    v_and_b32 v32, 0xffff0000, v32
    v_mul_f32 v133, v133, v28
    v_mul_f32 v32, v32, v28
    v_cvt_pk_bf16_f32 v16, v133, v32
    v_lshlrev_b32 v32, 16, v33
    v_and_b32 v33, 0xffff0000, v33
    v_mul_f32 v32, v32, v28
    v_mul_f32 v33, v33, v28
    v_cvt_pk_bf16_f32 v17, v32, v33
    v_lshlrev_b32 v133, 16, v34
    v_and_b32 v34, 0xffff0000, v34
    v_mul_f32 v133, v133, v28
    v_mul_f32 v34, v34, v28
    v_cvt_pk_bf16_f32 v18, v133, v34
    v_lshlrev_b32 v19, 16, v35
    v_and_b32 v35, 0xffff0000, v35
    v_mul_f32 v19, v19, v28
    v_mul_f32 v35, v35, v28
    v_cvt_pk_bf16_f32 v19, v19, v35
    v_lshlrev_b32 v133, 16, v36
    v_and_b32 v36, 0xffff0000, v36
    v_mul_f32 v133, v133, v28
    v_mul_f32 v36, v36, v28
    v_cvt_pk_bf16_f32 v0, v133, v36
    v_lshlrev_b32 v133, 16, v37
    v_and_b32 v37, 0xffff0000, v37
    v_mul_f32 v133, v133, v28
    v_mul_f32 v37, v37, v28
    v_cvt_pk_bf16_f32 v1, v133, v37
    s_waitcnt lgkmcnt(0)
    s_barrier
    ds_write_b128 v138, v[16:19] offset:1536
    v_and_b32 v123, 0xb8000000, v123
    v_mov_b32 v121, 0x3f803f80
    v_cmp_ne_u32 vcc, 0, v123
    s_nop 0
    ds_write_b64 v132, v[0:1] offset:1536
    v_cndmask_b32 v121, 0, v121, vcc
    ds_read_b128 v[36:39], v7 offset:0
    ds_read_b128 v[0:3], v7 offset:1024
    ds_read_b128 v[28:31], v7 offset:2048
    ds_read_b128 v[108:111], v7 offset:3072
    ds_read_b128 v[80:83], v7 offset:4096
    s_waitcnt lgkmcnt(5)
    s_barrier
    s_waitcnt lgkmcnt(4)
    buffer_store_dwordx4 v[36:39], v128, s[28:31], s59 offen sc1
    ds_read_b128 v[32:35], v129 offset:2048
    ds_read_b128 v[16:19], v129 offset:3072
    ds_read_b128 v[104:107], v137 offset:1536
    ds_read_b128 v[100:103], v136 offset:1536
    ds_read_b128 v[92:95], v137 offset:1664
    ds_read_b128 v[84:87], v136 offset:1664
    ds_read_b128 v[76:79], v137 offset:1792
    s_waitcnt lgkmcnt(9)
    buffer_store_dwordx4 v[0:3], v127, s[28:31], s59 offen sc1
    ds_read_b128 v[36:39], v136 offset:1792
    s_waitcnt lgkmcnt(7)
    v_mfma_f32_16x16x32_bf16 v[0:3], v[216:219], v[32:35], 0
    s_waitcnt lgkmcnt(6)
    v_mfma_f32_16x16x32_bf16 v[0:3], v[216:219], v[16:19], v[0:3]
    s_waitcnt lgkmcnt(5)
    v_mfma_f32_16x16x32_bf16 v[16:19], a[216:219], v[104:107], 0
    s_waitcnt lgkmcnt(4)
    v_mfma_f32_16x16x32_bf16 v[16:19], a[220:223], v[100:103], v[16:19]
    s_waitcnt lgkmcnt(3)
    ds_read_b128 v[64:67], v137 offset:0
    ds_read_b128 v[60:63], v136 offset:0
    v_mfma_f32_16x16x32_bf16 v[16:19], a[224:227], v[92:95], v[16:19]
    s_waitcnt lgkmcnt(4)
    ds_read_b128 v[56:59], v137 offset:128
    v_mfma_f32_16x16x32_bf16 v[16:19], a[228:231], v[84:87], v[16:19]
    s_waitcnt lgkmcnt(4)
    buffer_store_dwordx4 v[28:31], v126, s[28:31], s59 offen sc1
    ds_read_b128 v[52:55], v136 offset:128
    v_rsq_f32 v0, v0
    v_mfma_f32_16x16x32_bf16 v[16:19], a[232:235], v[76:79], v[16:19]
    s_waitcnt lgkmcnt(4)
    ds_read_b128 v[48:51], v137 offset:256
    ds_read_b128 v[32:35], v136 offset:256
    v_mfma_f32_16x16x32_bf16 v[16:19], a[236:239], v[36:39], v[16:19]
    v_rsq_f32 v1, v1
    v_mfma_f32_16x16x32_bf16 v[28:31], a[240:243], v[104:107], 0
    v_mul_f32 v0, s43, v0
    v_mul_f32 v1, s43, v1
    v_mfma_f32_16x16x32_bf16 v[28:31], a[244:247], v[100:103], v[28:31]
    v_rsq_f32 v2, v2
    v_mfma_f32_16x16x32_bf16 v[28:31], a[248:251], v[92:95], v[28:31]
    v_mul_f32 v2, s43, v2
    v_mul_f32 v20, v20, v2
    v_mfma_f32_16x16x32_bf16 v[28:31], a[252:255], v[84:87], v[28:31]
    buffer_store_dwordx4 v[108:111], v125, s[28:31], s59 offen sc1
    v_mul_f32 v21, v21, v2
    v_cvt_pk_bf16_f32 v88, v20, v21
    v_mul_f32 v22, v22, v2
    v_mul_f32 v23, v23, v2
    v_mfma_f32_16x16x32_bf16 v[28:31], v[224:227], v[76:79], v[28:31]
    v_cvt_pk_bf16_f32 v89, v22, v23
    v_mul_f32 v96, v96, v2
    v_mfma_f32_16x16x32_bf16 v[28:31], v[228:231], v[36:39], v[28:31]
    v_mul_f32 v97, v97, v2
    v_cvt_pk_bf16_f32 v90, v96, v97
    v_mfma_f32_16x16x32_bf16 v[20:23], v[232:235], v[104:107], 0
    v_mul_f32 v98, v98, v2
    v_mul_f32 v99, v99, v2
    v_mfma_f32_16x16x32_bf16 v[20:23], v[236:239], v[100:103], v[20:23]
    v_cvt_pk_bf16_f32 v91, v98, v99
    v_mul_f32 v72, v72, v2
    v_mfma_f32_16x16x32_bf16 v[20:23], v[240:243], v[92:95], v[20:23]
    ds_write_b128 v135, v[88:91] offset:3072
    v_mfma_f32_16x16x32_bf16 v[20:23], v[244:247], v[84:87], v[20:23]
    buffer_store_dwordx4 v[80:83], v124, s[28:31], s59 offen sc1
    v_mul_f32 v73, v73, v2
    v_cvt_pk_bf16_f32 v136, v72, v73
    v_mul_f32 v74, v74, v2
    v_mul_f32 v75, v75, v2
    v_mfma_f32_16x16x32_bf16 v[20:23], v[248:251], v[76:79], v[20:23]
    v_cvt_pk_bf16_f32 v137, v74, v75
    v_mul_f32 v68, v68, v0
    v_mfma_f32_16x16x32_bf16 v[20:23], v[252:255], v[36:39], v[20:23]
    s_waitcnt lgkmcnt(1)
    ds_write_b64 v134, v[136:137] offset:3072
    v_mfma_f32_16x16x32_bf16 v[36:39], a[216:219], v[64:67], 0
    v_mul_f32 v69, v69, v0
    v_cvt_pk_bf16_f32 v68, v68, v69
    v_mfma_f32_16x16x32_bf16 v[36:39], a[220:223], v[60:63], v[36:39]
    v_mul_f32 v70, v70, v0
    v_mul_f32 v71, v71, v0
    v_mfma_f32_16x16x32_bf16 v[36:39], a[224:227], v[56:59], v[36:39]
    v_cvt_pk_bf16_f32 v69, v70, v71
    v_mul_f32 v44, v44, v0
    v_mfma_f32_16x16x32_bf16 v[36:39], a[228:231], v[52:55], v[36:39]
    v_mul_f32 v45, v45, v0
    v_cvt_pk_bf16_f32 v70, v44, v45
    v_mfma_f32_16x16x32_bf16 v[36:39], a[232:235], v[48:51], v[36:39]
    v_mul_f32 v46, v46, v0
    v_mul_f32 v47, v47, v0
    v_mfma_f32_16x16x32_bf16 v[36:39], a[236:239], v[32:35], v[36:39]
    v_cvt_pk_bf16_f32 v71, v46, v47
    v_mul_f32 v40, v40, v0
    v_mfma_f32_16x16x32_bf16 v[44:47], a[240:243], v[64:67], 0
    ds_write_b128 v135, v[68:71] offset:0
    v_mfma_f32_16x16x32_bf16 v[44:47], a[244:247], v[60:63], v[44:47]
    v_mul_f32 v41, v41, v0
    v_cvt_pk_bf16_f32 v2, v40, v41
    v_mfma_f32_16x16x32_bf16 v[44:47], a[248:251], v[56:59], v[44:47]
    v_mul_f32 v42, v42, v0
    v_mul_f32 v43, v43, v0
    v_mfma_f32_16x16x32_bf16 v[44:47], a[252:255], v[52:55], v[44:47]
    v_cvt_pk_bf16_f32 v3, v42, v43
    v_fma_f32 v7, v16, v16, s42
    v_mfma_f32_16x16x32_bf16 v[44:47], v[224:227], v[48:51], v[44:47]
    ds_write_b64 v134, v[2:3] offset:0
    v_mfma_f32_16x16x32_bf16 v[44:47], v[228:231], v[32:35], v[44:47]
    v_fmac_f32 v7, v17, v17
    v_fmac_f32 v7, v18, v18
    v_mfma_f32_16x16x32_bf16 v[40:43], v[232:235], v[64:67], 0
    v_fmac_f32 v7, v19, v19
    v_fmac_f32 v7, v28, v28
    v_mfma_f32_16x16x32_bf16 v[40:43], v[236:239], v[60:63], v[40:43]
    v_fmac_f32 v7, v29, v29
    v_fmac_f32 v7, v30, v30
    v_mfma_f32_16x16x32_bf16 v[40:43], v[240:243], v[56:59], v[40:43]
    v_fmac_f32 v7, v31, v31
    v_fmac_f32 v7, v20, v20
    v_mfma_f32_16x16x32_bf16 v[40:43], v[244:247], v[52:55], v[40:43]
    v_fmac_f32 v7, v21, v21
    v_fmac_f32 v7, v22, v22
    v_mfma_f32_16x16x32_bf16 v[40:43], v[248:251], v[48:51], v[40:43]
    v_fmac_f32 v7, v23, v23
    v_fma_f32 v133, v36, v36, s42
    v_mfma_f32_16x16x32_bf16 v[40:43], v[252:255], v[32:35], v[40:43]
    s_nop 0
    v_fmac_f32 v133, v37, v37
    v_fmac_f32 v133, v38, v38
    v_fmac_f32 v133, v39, v39
    v_fmac_f32 v133, v44, v44
    v_fmac_f32 v133, v45, v45
    v_fmac_f32 v133, v46, v46
    v_fmac_f32 v133, v47, v47
    v_fmac_f32 v133, v40, v40
    v_fmac_f32 v133, v41, v41
    v_fmac_f32 v133, v42, v42
    v_fmac_f32 v133, v43, v43
    v_cvt_pk_bf16_f32 v120, v133, v7
    ds_write_b64 v130, v[120:121] offset:4096
    v_mul_f32 v8, v8, v1
    v_mul_f32 v9, v9, v1
    v_cvt_pk_bf16_f32 v8, v8, v9
    v_mul_f32 v10, v10, v1
    v_mul_f32 v11, v11, v1
    v_cvt_pk_bf16_f32 v9, v10, v11
    v_mul_f32 v24, v24, v1
    v_mul_f32 v25, v25, v1
    v_cvt_pk_bf16_f32 v10, v24, v25
    v_mul_f32 v26, v26, v1
    v_mul_f32 v27, v27, v1
    v_cvt_pk_bf16_f32 v11, v26, v27
    v_mul_f32 v12, v12, v1
    v_mul_f32 v13, v13, v1
    v_cvt_pk_bf16_f32 v136, v12, v13
    v_mul_f32 v14, v14, v1
    v_mul_f32 v15, v15, v1
    v_cvt_pk_bf16_f32 v137, v14, v15
    ds_write_b128 v135, v[8:11] offset:1536
    s_waitcnt lgkmcnt(1)
    s_barrier
    ds_write_b64 v134, v[136:137] offset:1536
    ds_read_b128 v[8:11], v129 offset:4096
    ds_read_b128 v[0:3], v129 offset:5120
    s_waitcnt lgkmcnt(2)
    s_barrier
    s_waitcnt lgkmcnt(1)
    v_mfma_f32_16x16x32_bf16 v[24:27], v[216:219], v[8:11], 0
    s_waitcnt lgkmcnt(0)
    ds_read_b128 v[48:51], v139 offset:0
    ds_read_b128 v[32:35], v139 offset:1024
    v_mfma_f32_16x16x32_bf16 v[24:27], v[216:219], v[0:3], v[24:27]
    s_nop 0
    ds_read_b128 v[12:15], v139 offset:2048
    s_nop 2
    ds_read_b128 v[8:11], v139 offset:3072
    s_nop 1
    v_rsq_f32 v24, v24
    ds_read_b128 v[0:3], v139 offset:4096
    v_mul_f32 v24, s43, v24
    v_mul_f32 v36, v36, v24
    v_mul_f32 v37, v37, v24
    v_cvt_pk_bf16_f32 v36, v36, v37
    v_mul_f32 v38, v38, v24
    v_mul_f32 v39, v39, v24
    v_cvt_pk_bf16_f32 v37, v38, v39
    v_mul_f32 v44, v44, v24
    v_mul_f32 v45, v45, v24
    s_waitcnt lgkmcnt(4)
    buffer_store_dwordx4 v[48:51], v128, s[28:31], s58 offen sc1
    v_cvt_pk_bf16_f32 v38, v44, v45
    v_mul_f32 v46, v46, v24
    v_mul_f32 v47, v47, v24
    v_cvt_pk_bf16_f32 v39, v46, v47
    v_mul_f32 v40, v40, v24
    v_mul_f32 v41, v41, v24
    v_cvt_pk_bf16_f32 v128, v40, v41
    v_mul_f32 v42, v42, v24
    v_mul_f32 v43, v43, v24
    v_cvt_pk_bf16_f32 v129, v42, v43
    ds_write_b128 v138, v[36:39] offset:0
    v_rsq_f32 v25, v25
    v_cmp_neq_f32 vcc, 0, v26
    v_mul_f32 v25, s43, v25
    s_waitcnt lgkmcnt(1)
    buffer_store_dwordx4 v[32:35], v127, s[28:31], s58 offen sc1
    ds_write_b64 v132, v[128:129] offset:0
    v_mul_f32 v16, v16, v25
    v_mul_f32 v17, v17, v25
    v_cvt_pk_bf16_f32 v16, v16, v17
    v_mul_f32 v18, v18, v25
    v_mul_f32 v19, v19, v25
    v_cvt_pk_bf16_f32 v17, v18, v19
    v_mul_f32 v28, v28, v25
    v_mul_f32 v29, v29, v25
    v_cvt_pk_bf16_f32 v18, v28, v29
    v_mul_f32 v30, v30, v25
    v_mul_f32 v31, v31, v25
    v_cvt_pk_bf16_f32 v19, v30, v31
    v_mul_f32 v20, v20, v25
    v_mul_f32 v21, v21, v25
    v_cvt_pk_bf16_f32 v128, v20, v21
    v_mul_f32 v22, v22, v25
    v_mul_f32 v23, v23, v25
    v_cvt_pk_bf16_f32 v129, v22, v23
    buffer_store_dwordx4 v[12:15], v126, s[28:31], s58 offen sc1
    ds_write_b128 v138, v[16:19] offset:1536
    ds_write_b64 v132, v[128:129] offset:1536
    buffer_store_dwordx4 v[8:11], v125, s[28:31], s58 offen sc1
    s_waitcnt lgkmcnt(0)
    s_barrier
    buffer_store_dwordx4 v[0:3], v124, s[28:31], s58 offen sc1
    ds_read_b128 v[12:15], v131 offset:0
    ds_read_b128 v[8:11], v131 offset:1024
    ds_read_b128 v[0:3], v131 offset:2048
    s_waitcnt lgkmcnt(2)
    buffer_store_dwordx4 v[12:15], v4, s[28:31], 0 offen sc1
    s_waitcnt lgkmcnt(0)
    buffer_store_dwordx4 v[8:11], v5, s[28:31], 0 offen sc1
    buffer_store_dwordx4 v[0:3], v6, s[28:31], 0 offen sc1
    s_nop 4
    s_cbranch_vccnz L_slow
L_end:
    s_endpgm
L_slow:
    s_waitcnt vmcnt(0) lgkmcnt(0)
    s_nop 15
    s_barrier
    s_lshr_b32 s66, s64, 20
    v_mbcnt_lo_u32_b32 v170, -1, 0
    v_mbcnt_hi_u32_b32 v170, -1, v170
    s_load_dwordx16 s[4:19], s[0:1], 0
    s_load_dwordx4 s[20:23], s[0:1], 64
    s_load_dwordx2 s[38:39], s[0:1], 80
    s_lshr_b32 s88, s2, 3
    s_lshl2_add_u32 s88, s88, s68
    v_lshlrev_b32 v17, 7, v170
    s_mul_i32 s89, s88, 576
    s_mul_i32 s88, s88, 1728
    v_min_u32 v16, 1664, v17
    v_min_u32 v7, 512, v17
    s_mov_b32 s34, 221184
    s_mov_b32 s35, 0x20000
    s_mov_b32 s78, 73728
    s_mov_b32 s79, 0x20000
    v_and_b32 v158, 15, v170
    v_lshrrev_b32 v5, 4, v170
    v_lshrrev_b32 v24, 2, v158
    v_and_b32 v131, 3, v158
    s_mul_i32 s87, s68, 192
    v_mad_u32_u24 v19, v158, 12, s87
    v_lshlrev_b32 v6, 1, v158
    v_lshlrev_b32 v4, 1, v24
    v_lshl_add_u32 v4, v5, 5, v4
    s_movk_i32 s86, 384
    s_mov_b32 s26, 100270464
    s_mov_b32 s27, 0x20000
    s_mov_b32 s30, 0
    s_mov_b32 s31, 0x20000
    s_mul_i32 s96, s68, 288
    s_and_b32 s97, s68, 1
    s_lshl_b32 s97, s97, 2
    s_mov_b32 s98, 193536
    s_waitcnt lgkmcnt(0)
    s_mov_b32 s24, s4
    s_mov_b32 s25, s5
    s_mov_b32 s32, s6
    s_mov_b32 s33, s7
    s_mov_b32 s76, s8
    s_mov_b32 s77, s9
    buffer_load_dword a254, v16, s[32:35], s88 offen
    buffer_load_dword a253, v7, s[76:79], s89 offen
    s_load_dwordx2 s[82:83], s[10:11], 0
    s_movk_i32 s18, 676
    s_mov_b32 s19, 0x20000
    buffer_load_dwordx3 v[28:30], v19, s[16:19], 0 offen
    s_mov_b32 s99, 589824
    v_add_u32 v7, s96, v170
    v_mul_u32_u24 v129, 2731, v7
    v_mul_u32_u24 v11, 6242, v7
    v_lshrrev_b32 v129, 16, v129
    s_lshr_b32 s94, s2, 3
    s_mul_i32 s70, s94, 168
    global_load_ushort v16, v6, s[12:13]
    v_lshrrev_b32 v11, 20, v11
    v_and_or_b32 v8, v129, 3, s97
    v_xor_b32 v8, v7, v8
    v_lshl_add_u32 v128, v8, 4, s99
    v_mad_u32_u24 v128, v11, s98, v128
    s_mul_i32 s69, s2, 20
    s_lshl3_add_u32 s69, s94, s69
    global_load_ushort v17, v6, s[12:13] offset:32
    v_add_u32 v10, 64, v7
    v_mul_u32_u24 v31, 2731, v10
    v_mul_u32_u24 v6, 6242, v10
    v_lshrrev_b32 v31, 16, v31
    v_lshrrev_b32 v6, 20, v6
    s_add_u32 s70, s70, 140
    s_movk_i32 s62, 2688
    global_load_ushort v160, v4, s[14:15] offset:0
    v_and_or_b32 v9, v31, 3, s97
    v_xor_b32 v9, v10, v9
    v_lshl_add_u32 v127, v9, 4, s99
    v_mad_u32_u24 v127, v6, s98, v127
    v_add_u32 v130, 128, v7
    s_movk_i32 s71, 20
    s_movk_i32 s73, 28
    global_load_ushort v162, v4, s[14:15] offset:8
    v_mul_u32_u24 v163, 2731, v130
    v_mul_u32_u24 v18, 6242, v130
    v_lshrrev_b32 v163, 16, v163
    v_lshrrev_b32 v18, 20, v18
    v_and_or_b32 v10, v163, 3, s97
    s_mov_b32 s93, 1769472
    s_mul_i32 s54, s68, 5120
    global_load_ushort v161, v4, s[14:15] offset:16
    v_xor_b32 v10, v130, v10
    v_lshl_add_u32 v126, v10, 4, s99
    v_mad_u32_u24 v126, v18, s98, v126
    v_add_u32 v27, 192, v7
    v_mul_u32_u24 v25, 2731, v27
    s_mov_b32 s63, 1180032
    s_mul_i32 s95, s68, -44
    global_load_ushort v130, v4, s[14:15] offset:24
    v_mul_u32_u24 v4, 6242, v27
    v_lshrrev_b32 v25, 16, v25
    v_lshrrev_b32 v4, 20, v4
    v_and_or_b32 v26, v25, 3, s97
    v_xor_b32 v26, v27, v26
    v_lshl_add_u32 v125, v26, 4, s99
    v_mad_u32_u24 v125, v4, s98, v125
    v_add_u32 v26, 256, v7
    v_mul_u32_u24 v156, 2731, v26
    v_mul_u32_u24 v7, 6242, v26
    v_lshrrev_b32 v156, 16, v156
    v_lshrrev_b32 v7, 20, v7
    v_and_or_b32 v124, v156, 3, s97
    v_xor_b32 v124, v26, v124
    v_lshl_add_u32 v124, v124, 4, s99
    v_mad_u32_u24 v124, v7, s98, v124
    s_cmp_ge_u32 s2, 240
    s_cbranch_scc1 L_bndS
L_bndrS:
    s_mul_i32 s94, s69, 58255
    s_lshr_b32 s94, s94, 22
    s_mul_i32 s94, s94, s63
    s_mul_i32 s72, s69, s62
    s_add_u32 s72, s72, s94
    v_lshl_or_b32 v157, v170, 4, 2.0
    s_sub_u32 s94, s73, 1
    s_max_u32 s94, s94, 20
    s_movk_i32 s99, -24
    s_add_u32 m0, s54, 0
    v_and_b32 v18, -4, v163
    s_mul_i32 s85, s68, 96
    s_sub_u32 s100, s85, 1024
    buffer_load_dwordx4 v128, s[24:27], s72 offen nt lds
    s_add_u32 m0, s54, 1024
    v_mad_u32_u24 v11, v18, 3, v163
    v_add_u32 v11, s95, v11
    v_mad_i32_i24 v10, v163, s99, v10
    v_med3_u32 v18, v11, 20, s94
    v_add_u32 v18, s70, v18
    v_add_u32 v163, s69, v11
    s_sub_u32 s87, s85, 2048
    s_movk_i32 s91, 1152
    buffer_load_dwordx4 v127, s[24:27], s72 offen nt lds
    v_cmp_gt_u32 vcc, s71, v11
    v_lshl_add_u32 v10, v10, 4, s93
    s_add_u32 m0, s54, 43008
    v_cndmask_b32 v163, v18, v163, vcc
    v_mul_u32_u24 v18, 58255, v163
    v_mad_u32_u24 v10, v163, s62, v10
    v_lshrrev_b32 v18, 22, v18
    v_mad_u32_u24 v10, v18, s63, v10
    s_mul_i32 s90, s68, 3072
    s_add_u32 s90, s90, 61440
    buffer_load_dwordx4 v10, s[24:27], 0 offen  lds
    v_lshlrev_b32 v11, 16, v11
    s_add_u32 m0, s54, 2048
    v_and_b32 v163, -4, v31
    v_mad_u32_u24 v18, v163, 3, v31
    v_add_u32 v18, s95, v18
    v_mad_i32_i24 v9, v31, s99, v9
    v_med3_u32 v163, v18, 20, s94
    s_mov_b32 s28, s22
    s_mov_b32 s29, s23
    buffer_load_dwordx4 v126, s[24:27], s72 offen nt lds
    v_add_u32 v163, s70, v163
    v_add_u32 v31, s69, v18
    v_cmp_gt_u32 vcc, s71, v18
    v_lshl_add_u32 v9, v9, 4, s93
    s_add_u32 m0, s54, 41984
    v_cndmask_b32 v31, v163, v31, vcc
    v_mul_u32_u24 v163, 58255, v31
    v_mad_u32_u24 v9, v31, s62, v9
    v_lshrrev_b32 v163, 22, v163
    v_mad_u32_u24 v9, v163, s63, v9
    s_mov_b32 s41, 0x2a8cbccc
    s_mov_b32 s42, 0x38fba882
    buffer_load_dwordx4 v9, s[24:27], 0 offen  lds
    v_lshl_or_b32 v11, v18, 8, v11
    s_add_u32 m0, s54, 3072
    v_cmp_gt_u32 vcc, 32, v170
    v_and_b32 v31, -4, v129
    v_mad_u32_u24 v18, v31, 3, v129
    v_cndmask_b32 v124, v157, v124, vcc
    v_add_u32 v18, s95, v18
    s_mov_b32 s43, 0x415db3d7
    s_mov_b32 s44, 61440
    buffer_load_dwordx4 v125, s[24:27], s72 offen nt lds
    s_add_u32 m0, s54, 4096
    v_mad_i32_i24 v8, v129, s99, v8
    v_med3_u32 v31, v18, 20, s94
    v_add_u32 v31, s70, v31
    v_add_u32 v129, s69, v18
    v_cmp_gt_u32 vcc, s71, v18
    v_lshl_add_u32 v8, v8, 4, s93
    s_mul_i32 s93, s68, 6
    s_lshl_b32 s94, s97, 1
    buffer_load_dwordx4 v124, s[24:27], s72 offen nt lds
    v_cndmask_b32 v129, v31, v129, vcc
    v_mul_u32_u24 v31, 58255, v129
    v_mad_u32_u24 v8, v129, s62, v8
    v_lshrrev_b32 v31, 22, v31
    v_mad_u32_u24 v8, v31, s63, v8
    s_add_u32 m0, s54, 40960
    v_lshl_or_b32 v11, v18, 0, v11
    s_mov_b32 s45, 40960
    s_mov_b32 s46, 20480
    buffer_load_dwordx4 v8, s[24:27], 0 offen nt lds
    v_mul_u32_u24 v27, 10923, v170
    v_lshrrev_b32 v149, 17, v27
    v_lshrrev_b32 v27, 16, v27
    v_mad_i32_i24 v163, v27, -6, v170
    v_bitop3_b32 v149, v149, v27, 4 bitop3:0x28
    v_lshl_add_u32 v163, v163, 4, s85
    v_mul_u32_u24 v149, 3, v149
    v_xor_b32 v27, v27, v149
    v_mad_u32_u24 v149, v27, s91, v163
    v_add_u32 v18, 64, v170
    v_mul_u32_u24 v129, 10923, v18
    v_lshrrev_b32 v121, 17, v129
    v_lshrrev_b32 v129, 16, v129
    v_mad_i32_i24 v31, v129, -6, v18
    v_bitop3_b32 v121, v121, v129, 4 bitop3:0x28
    v_lshl_add_u32 v31, v31, 4, s100
    v_mul_u32_u24 v121, 3, v121
    v_xor_b32 v129, v129, v121
    v_mad_u32_u24 v121, v129, s91, v31
    v_add_u32 v18, 128, v170
    v_mul_u32_u24 v25, 10923, v18
    v_lshrrev_b32 v26, 17, v25
    v_lshrrev_b32 v25, 16, v25
    v_mad_i32_i24 v18, v25, -6, v18
    v_bitop3_b32 v26, v26, v25, 4 bitop3:0x28
    v_lshl_add_u32 v18, v18, 4, s87
    v_mul_u32_u24 v26, 3, v26
    v_xor_b32 v25, v25, v26
    v_mad_u32_u24 v26, v25, s91, v18
    v_mad_u32_u24 v27, v27, s86, v163
    v_mad_u32_u24 v146, v129, s86, v31
    v_mad_u32_u24 v78, v25, s86, v18
    s_add_u32 m0, s90, 0
    s_mov_b32 s92, 0
    buffer_load_dwordx4 v149, s[32:35], s92 offen offset:0 lds
    v_mov_b32 v18, 0x3f803f80
    v_cmp_eq_u32 vcc, 0, v131
    v_and_b32 v25, 1, v170
    v_lshlrev_b32 v25, 4, v25
    v_cndmask_b32 v220, 0, v18, vcc
    v_cndmask_b32 v221, 0, v18, vcc
    v_cndmask_b32 v222, 0, v18, vcc
    v_cndmask_b32 v223, 0, v18, vcc
    v_mov_b32 v18, 0x3f80
    v_lshlrev_b32 v18, v25, v18
    v_cmp_gt_u32 vcc, 2, v131
    v_mov_b32 v171, 0
    v_mov_b32 v167, 0
    v_cndmask_b32 v216, 0, v18, vcc
    v_cndmask_b32 v218, 0, v18, vcc
    v_cmp_le_u32 vcc, 2, v131
    v_mov_b32 v163, 0
    v_mov_b32 v159, 0
    v_cndmask_b32 v217, 0, v18, vcc
    v_cndmask_b32 v219, 0, v18, vcc
    v_cmp_eq_u32 vcc, v5, v24
    v_mov_b32 v150, 0
    v_mov_b32 v151, 0
    v_cndmask_b32 v168, 0, v216, vcc
    v_cndmask_b32 v169, 0, v217, vcc
    v_mov_b32 v144, 0
    v_mov_b32 v145, 0
    v_mov_b32 v138, 0
    v_mov_b32 v139, 0
    v_lshrrev_b32 v25, 1, v5
    v_lshl_add_u32 v18, v5, 2, v24
    v_lshl_add_u32 v18, v25, 3, v18
    v_mul_u32_u24 v18, 96, v18
    v_add_u32 v18, s90, v18
    v_lshl_add_u32 v6, v131, 4, v18
    v_lshl_add_u32 v7, v131, 3, v18
    s_waitcnt lgkmcnt(0)
    s_lshl_b32 s84, s68, 4
    s_lshr_b64 s[82:83], s[82:83], s84
    s_lshl_b32 s82, s82, 16
    v_mov_b32 v4, s82
    v_min_f32 v4, 0x40930000, v4
    v_max_f32 v4, 0xc2c80000, v4
    v_mul_f32 v4, 0x3fb8aa3b, v4
    v_exp_f32 v4, v4
    v_mov_b32 v18, 0
    v_cvt_pk_bf16_f32 v4, v4, v4
    v_lshlrev_b32 v4, 16, v4
    v_mul_f32 v4, 0x4038aa3b, v4
    v_mov_b32 v31, 0
    v_readfirstlane_b32 s55, v4
    v_add_f32 v4, v4, v4
    v_mul_u32_u24 v132, 5120, v5
    v_readfirstlane_b32 s52, v4
    v_add_u32 v132, v19, v132
    s_mov_b32 s84, 0x41b8aa3b
    v_mov_b32 v156, 0xc138aa3b
    v_mul_u32_u24 v4, 5120, v24
    v_mad_u32_u24 v4, v131, s86, v4
    v_and_b32 v19, 7, v158
    v_xor_b32 v25, v19, v5
    v_lshl_add_u32 v148, v25, 4, v4
    v_xor_b32 v147, 64, v148
    v_add_u32 v137, 40960, v148
    s_mov_b32 s47, 0
    s_mov_b32 s57, s72
    buffer_load_dwordx4 v121, s[32:35], s92 offen offset:1024 lds
    v_xor_b32 v136, 64, v137
    v_add_u32 v4, 61440, v4
    v_add_u32 v25, s93, v5
    v_xor_b32 v25, v19, v25
    v_lshl_add_u32 v135, v25, 4, v4
    v_lshrrev_b32 v25, 1, v5
    v_add3_u32 v25, v25, s93, 4
    s_add_u32 s93, s54, 20480
    s_mov_b32 s58, 0
    buffer_load_dwordx4 v26, s[32:35], s92 offen offset:2048 lds
    s_add_u32 m0, s90, 12288
    s_mov_b32 s92, 36864
    v_xor_b32 v25, v19, v25
    v_lshl_add_u32 v25, v25, 4, v4
    v_and_b32 v4, 1, v5
    v_lshl_add_u32 v134, v4, 3, v25
    v_lshlrev_b32 v4, 4, v170
    s_mov_b32 s59, 0
    s_mov_b32 s60, 0
    buffer_load_dwordx4 v149, s[32:35], s92 offen offset:0 lds
    s_waitcnt vmcnt(16)
    v_lshl_or_b32 v16, v17, 16, v16
    v_cmp_gt_u32 vcc, 16, v170
    v_mov_b32 v17, 0
    v_add_u32 v133, s93, v4
    v_cndmask_b32 v19, 0, v16, vcc
    v_cndmask_b32 v16, 0, v16, vcc
    v_add_u32 v129, 81920, v4
    v_mfma_f32_16x16x16_bf16 v[0:3], v[18:19], v[28:29], 0
    s_waitcnt vmcnt(14)
    s_lshr_b32 s93, s68, 1
    v_lshl_or_b32 v160, v162, 16, v160
    v_mul_u32_u24 v4, 1792, v5
    v_mfma_f32_16x16x16_bf16 v[12:15], v[16:17], v[28:29], 0
    s_lshl_b32 s93, s93, 10
    v_mov_b32 v122, 0
    v_mul_u32_u24 v76, 48, v24
    v_mfma_f32_16x16x16_bf16 v[20:23], v[16:17], v[30:31], 0
    s_waitcnt vmcnt(12)
    s_add_u32 s93, s93, s94
    buffer_load_dwordx4 v121, s[32:35], s92 offen offset:1024 lds
    v_lshl_or_b32 v161, v130, 16, v161
    v_max_f32 v0, 0, v0
    v_max_f32 v12, 0, v12
    v_max_f32 v13, 0, v13
    v_max_f32 v14, 0, v14
    v_max_f32 v15, 0, v15
    v_cvt_pk_bf16_f32 v12, v12, v13
    v_cvt_pk_bf16_f32 v13, v14, v15
    v_max_f32 v1, 0, v1
    v_max_f32 v2, 0, v2
    v_mfma_f32_16x16x16_bf16 v[16:19], v[160:161], v[12:13], 0
    s_mov_b32 s65, -1
    v_max_f32 v3, 0, v3
    v_cvt_pk_bf16_f32 v0, v0, v1
    v_cvt_pk_bf16_f32 v1, v2, v3
    v_max_f32 v20, 0, v20
    v_max_f32 v21, 0, v21
    v_mfma_f32_16x16x16_bf16 v[12:15], v[160:161], v[0:1], 0
    s_mov_b32 s61, 1
    v_max_f32 v22, 0, v22
    v_max_f32 v23, 0, v23
    v_cvt_pk_bf16_f32 v20, v20, v21
    v_cvt_pk_bf16_f32 v21, v22, v23
    v_cvt_pk_bf16_f32 v16, v16, v16
    v_lshlrev_b32 v16, 16, v16
    v_mfma_f32_16x16x16_bf16 v[0:3], v[160:161], v[20:21], 0
    s_movk_i32 s4, 112
    v_mul_f32 v16, 0xbfb8aa3b, v16
    v_cvt_pk_bf16_f32 v12, v12, v12
    v_exp_f32 v16, v16
    v_lshlrev_b32 v12, 16, v12
    v_add_f32 v16, 1.0, v16
    v_rcp_f32 v16, v16
    v_mul_f32 v12, 0xbfb8aa3b, v12
    v_cvt_pk_bf16_f32 v16, v16, v16
    v_lshlrev_b32 v16, 16, v16
    v_fma_f32 v16, v16, s84, v156
    s_mov_b32 s5, 0
    s_mov_b32 s6, 0
    ds_write_b32 v132, v16 offset:44032
    v_exp_f32 v12, v12
    v_cvt_pk_bf16_f32 v0, v0, v0
    v_add_f32 v12, 1.0, v12
    v_rcp_f32 v12, v12
    v_lshlrev_b32 v0, 16, v0
    v_cvt_pk_bf16_f32 v12, v12, v12
    v_lshlrev_b32 v12, 16, v12
    v_fma_f32 v12, v12, s84, v156
    s_mov_b32 s12, 0
    s_mov_b32 s64, 3
    ds_write_b32 v132, v12 offset:44036
    v_mul_f32 v0, 0xbfb8aa3b, v0
    v_exp_f32 v0, v0
    v_add_u32 v130, s93, v129
    v_add_f32 v0, 1.0, v0
    v_rcp_f32 v0, v0
    s_mul_i32 s93, s68, 7168
    v_cvt_pk_bf16_f32 v0, v0, v0
    v_lshlrev_b32 v0, 16, v0
    v_fma_f32 v0, v0, s84, v156
    s_add_u32 s93, s93, 135168
    s_mov_b32 s10, 81924
    ds_write_b32 v132, v0 offset:44040
    v_add_u32 v25, s93, v4
    v_mul_u32_u24 v4, 112, v158
    v_add_u32 v156, v4, v25
    v_subrev_u32 v156, 28672, v156
    v_cmp_eq_u32 vcc, 0, v24
    v_add_u32 v4, 16, v25
    s_mov_b32 s11, 0x20000
    v_cndmask_b32 v132, v157, v25, vcc
    v_cmp_eq_u32 vcc, 3, v131
    s_add_u32 s101, s54, 44032
    v_lshl_add_u32 v76, v131, 2, v76
    v_cndmask_b32 v132, v132, v4, vcc
    v_mul_u32_u24 v4, 1792, v24
    v_lshl_add_u32 v4, v5, 3, v4
    v_lshl_add_u32 v4, v131, 1, v4
    v_add_u32 v4, s93, v4
    v_cmp_gt_u32 vcc, 3, v5
    v_mov_b32 v123, v4
    s_add_u32 s93, s69, 1
    v_cndmask_b32 v131, v157, v4, vcc
    s_mul_i32 s94, s93, 58255
    s_lshr_b32 s94, s94, 22
    s_mul_i32 s94, s94, s63
    s_mul_i32 s56, s93, s62
    s_add_u32 s56, s56, s94
    s_sub_u32 s93, s71, 1
    s_cmp_eq_u32 s68, 0
    s_cselect_b32 s13, s93, -1
    s_cmp_gt_u32 s73, 20
    s_cselect_b32 s13, s13, -1
    s_and_b32 s93, s2, -8
    s_sub_u32 s93, 81920, s93
    s_sub_u32 s8, s38, s93
    s_waitcnt lgkmcnt(0)
    s_barrier
    s_subb_u32 s9, s39, 0
    s_mov_b32 s39, 0x00010001
    v_mul_u32_u24 v79, 48, v5
    v_add_u32 v174, 0, v76
    v_mul_u32_u24 v4, 37, v174
    v_lshrrev_b32 v4, 10, v4
    v_mad_u32_u24 v174, v4, 24, v174
    v_add_u32 v174, s101, v174
    v_add_u32 v77, 16, v76
    v_mul_u32_u24 v4, 37, v77
    v_lshrrev_b32 v4, 10, v4
    v_mad_u32_u24 v77, v4, 24, v77
    v_add_u32 v77, s101, v77
    v_add_u32 v4, 32, v76
    v_mul_u32_u24 v120, 37, v4
    v_lshrrev_b32 v120, 10, v120
    v_mad_u32_u24 v4, v120, 24, v4
    v_add_u32 v4, s101, v4
    v_add_u32 v173, 0, v79
    v_mul_u32_u24 v120, 37, v173
    v_lshrrev_b32 v120, 10, v120
    v_mad_u32_u24 v173, v120, 24, v173
    v_add_u32 v172, 4, v79
    v_mul_u32_u24 v120, 37, v172
    v_lshrrev_b32 v120, 10, v120
    v_mad_u32_u24 v172, v120, 24, v172
    v_add_u32 v165, 8, v79
    v_mul_u32_u24 v120, 37, v165
    v_lshrrev_b32 v120, 10, v120
    v_mad_u32_u24 v165, v120, 24, v165
    v_add_u32 v166, 12, v79
    v_mul_u32_u24 v120, 37, v166
    v_lshrrev_b32 v120, 10, v120
    v_mad_u32_u24 v166, v120, 24, v166
    v_add_u32 v164, 16, v79
    v_mul_u32_u24 v120, 37, v164
    v_lshrrev_b32 v120, 10, v120
    v_mad_u32_u24 v164, v120, 24, v164
    v_add_u32 v161, 20, v79
    v_mul_u32_u24 v120, 37, v161
    v_lshrrev_b32 v120, 10, v120
    v_mad_u32_u24 v161, v120, 24, v161
    v_add_u32 v162, 24, v79
    v_mul_u32_u24 v120, 37, v162
    v_lshrrev_b32 v120, 10, v120
    v_mad_u32_u24 v162, v120, 24, v162
    v_add_u32 v25, 28, v79
    v_mul_u32_u24 v24, 37, v25
    v_lshrrev_b32 v24, 10, v24
    v_mad_u32_u24 v25, v24, 24, v25
    v_add_u32 v160, 32, v79
    v_mul_u32_u24 v24, 37, v160
    v_lshrrev_b32 v24, 10, v24
    v_mad_u32_u24 v160, v24, 24, v160
    v_add_u32 v24, 36, v79
    v_mul_u32_u24 v120, 37, v24
    v_lshrrev_b32 v120, 10, v120
    v_mad_u32_u24 v24, v120, 24, v24
    v_add_u32 v120, 40, v79
    v_mul_u32_u24 v175, 37, v120
    v_lshrrev_b32 v175, 10, v175
    v_mad_u32_u24 v120, v175, 24, v120
    v_add_u32 v175, 44, v79
    v_mul_u32_u24 v79, 37, v175
    v_lshrrev_b32 v79, 10, v79
    s_lshr_b32 s93, s68, 1
    s_mul_i32 s93, s93, 30720
    buffer_load_dwordx4 v26, s[32:35], s92 offen offset:2048 lds
    s_add_u32 m0, s90, 24576
    s_mov_b32 s92, 73728
    ds_read_b32 v208, v174
    v_mad_u32_u24 v175, v79, 24, v175
    v_lshl_add_u32 v79, v5, 4, v76
    v_mul_u32_u24 v209, 37, v79
    v_lshrrev_b32 v209, 10, v209
    v_mad_u32_u24 v79, v209, 24, v79
    v_mov_b32 v205, 336
    v_cmp_gt_u32 vcc, 3, v5
    v_sub_u32 v204, v174, v173
    s_and_b32 s94, s68, 1
    v_cndmask_b32 v79, v205, v79, vcc
    v_sub_u32 v79, s101, v79
    s_mul_i32 s94, s94, -2304
    s_add_u32 s93, s93, s94
    ds_read_b32 v204, v204 offset:336
    v_sub_u32 v205, v174, v172
    v_sub_u32 v206, v174, v165
    v_sub_u32 v207, v174, v166
    v_sub_u32 v200, v174, v164
    s_lshl_b32 s94, s97, 4
    buffer_load_dwordx4 v149, s[32:35], s92 offen offset:0 lds
    ds_read_b32 v205, v205 offset:336
    v_sub_u32 v201, v174, v161
    v_sub_u32 v202, v174, v162
    v_sub_u32 v203, v174, v25
    v_sub_u32 v196, v174, v160
    v_sub_u32 v197, v174, v24
    ds_read_b32 v206, v206 offset:336
    buffer_load_dwordx4 v121, s[32:35], s92 offen offset:1024 lds
    v_sub_u32 v198, v174, v120
    v_sub_u32 v199, v174, v175
    v_sub_u32 v192, v77, v173
    v_sub_u32 v193, v77, v172
    ds_read_b32 v207, v207 offset:336
    v_sub_u32 v194, v77, v165
    v_sub_u32 v195, v77, v166
    v_sub_u32 v188, v77, v164
    v_sub_u32 v189, v77, v161
    v_sub_u32 v190, v77, v162
    ds_read_b32 v200, v200 offset:336
    v_sub_u32 v191, v77, v25
    v_sub_u32 v184, v77, v160
    v_sub_u32 v185, v77, v24
    v_sub_u32 v186, v77, v120
    v_sub_u32 v187, v77, v175
    ds_read_b32 v201, v201 offset:336
    buffer_load_dwordx4 v26, s[32:35], s92 offen offset:2048 lds
    s_add_u32 m0, s90, 36864
    s_mov_b32 s92, 110592
    v_sub_u32 v180, v4, v173
    v_sub_u32 v181, v4, v172
    ds_read_b32 v202, v202 offset:336
    v_sub_u32 v182, v4, v165
    v_sub_u32 v183, v4, v166
    v_sub_u32 v176, v4, v164
    v_sub_u32 v177, v4, v161
    v_sub_u32 v178, v4, v162
    s_waitcnt vmcnt(9)
    s_barrier
    ds_read_b32 v203, v203 offset:336
    v_sub_u32 v179, v4, v25
    v_sub_u32 v172, v4, v160
    v_sub_u32 v173, v4, v24
    v_sub_u32 v174, v4, v120
    v_sub_u32 v175, v4, v175
    ds_read_b32 v196, v196 offset:336
    v_mov_b32 v120, 0xf149f2ca
    v_and_b32 v25, 8, v158
    v_add_u32 v25, v25, v158
    v_mul_u32_u24 v25, 96, v25
    v_add_u32 v25, s90, v25
    ds_read_b32 v197, v197 offset:336
    buffer_load_dwordx4 v149, s[32:35], s92 offen offset:0 lds
    v_lshl_add_u32 v24, v5, 4, v25
    v_lshl_add_u32 v19, v5, 3, v25
    v_add_u32 v17, s93, v24
    v_add_u32 v16, s93, v19
    s_lshr_b32 s93, s68, 1
    s_mul_i32 s93, s93, 5120
    ds_read_b32 v198, v198 offset:336
    v_lshlrev_b32 v18, 4, v5
    v_add_u32 v18, 4608, v18
    s_add_u32 s93, s93, s94
    v_add_u32 v25, s93, v18
    v_cmp_eq_u32 vcc, 0, v158
    ds_read_b32 v199, v199 offset:336
    s_nop 0
    v_cndmask_b32 v25, v157, v25, vcc
    buffer_load_dwordx4 v121, s[32:35], s92 offen offset:1024 lds
    ds_read_b32 v211, v79 offset:672
    ds_read_b32 v192, v192 offset:336
    ds_read_b32 v193, v193 offset:336
    ds_read_b32 v194, v194 offset:336
    buffer_load_dwordx4 v26, s[32:35], s92 offen offset:2048 lds
    s_add_u32 m0, s90, 49152
    s_mov_b32 s92, 147456
    ds_read_b32 v195, v195 offset:336
    ds_read_b32 v188, v188 offset:336
    ds_read_b32 v189, v189 offset:336
    buffer_load_dwordx4 v149, s[32:35], s92 offen offset:0 lds
    ds_read_b32 v190, v190 offset:336
    ds_read_b32 v191, v191 offset:336
    ds_read_b32 v184, v184 offset:336
    buffer_load_dwordx4 v121, s[32:35], s92 offen offset:1024 lds
    ds_read_b32 v185, v185 offset:336
    ds_read_b32 v186, v186 offset:336
    ds_read_b32 v187, v187 offset:336
    ds_read_b32 v209, v77
    buffer_load_dwordx4 v26, s[32:35], s92 offen offset:2048 lds
    s_add_u32 m0, s90, 61440
    s_mov_b32 s92, 184320
    ds_read_b32 v180, v180 offset:336
    ds_read_b32 v181, v181 offset:336
    ds_read_b32 v182, v182 offset:336
    buffer_load_dwordx4 v149, s[32:35], s92 offen offset:0 lds
    ds_read_b32 v183, v183 offset:336
    ds_read_b32 v176, v176 offset:336
    ds_read_b32 v177, v177 offset:336
    buffer_load_dwordx4 v121, s[32:35], s92 offen offset:1024 lds
    ds_read_b32 v178, v178 offset:336
    ds_read_b32 v179, v179 offset:336
    ds_read_b32 v172, v172 offset:336
    ds_read_b32 v173, v173 offset:336
    buffer_load_dwordx4 v26, s[32:35], s92 offen offset:2048 lds
    ds_read_b32 v174, v174 offset:336
    ds_read_b32 v175, v175 offset:336
    ds_read_b32 v210, v4
    s_waitcnt vmcnt(15)
    ds_read_b64_tr_b16 a[0:1], v7 offset:0
    ds_read_b64_tr_b16 a[2:3], v7 offset:768
    ds_read_b64_tr_b16 a[24:25], v7 offset:32
    ds_read_b64_tr_b16 a[26:27], v7 offset:800
    ds_read_b64_tr_b16 a[48:49], v7 offset:64
    ds_read_b64_tr_b16 a[50:51], v7 offset:832
    s_add_u32 m0, s90, 0
    s_mov_b32 s92, 384
    s_waitcnt vmcnt(12)
    ds_read_b64_tr_b16 a[4:5], v7 offset:12288
    ds_read_b64_tr_b16 a[6:7], v7 offset:13056
    ds_read_b64_tr_b16 a[28:29], v7 offset:12320
    ds_read_b64_tr_b16 a[30:31], v7 offset:13088
    ds_read_b64_tr_b16 a[52:53], v7 offset:12352
    ds_read_b64_tr_b16 a[54:55], v7 offset:13120
    s_waitcnt vmcnt(9)
    ds_read_b64_tr_b16 a[8:9], v7 offset:24576
    ds_read_b64_tr_b16 a[10:11], v7 offset:25344
    ds_read_b64_tr_b16 a[32:33], v7 offset:24608
    s_waitcnt lgkmcnt(15)
    s_cmp_ge_u32 s2, 247
    s_cbranch_scc1 L_maskS
L_nomaskS:
    v_cmp_gt_u32 vcc, 16, v170
    v_readlane_b32 s84, v211, 48
    ds_read_b64_tr_b16 a[34:35], v7 offset:25376
    v_cndmask_b32 v208, v120, v208, vcc
    v_cndmask_b32 v209, v120, v209, vcc
    v_cndmask_b32 v210, v120, v210, vcc
    v_cmp_gt_u32 vcc, 49, v170
    ds_read_b64_tr_b16 a[56:57], v7 offset:24640
    s_waitcnt lgkmcnt(10)
    buffer_load_dwordx4 v149, s[32:35], s92 offen offset:0 lds
    ds_read_b64_tr_b16 a[58:59], v7 offset:25408
    v_cndmask_b32 v211, v120, v211, vcc
    s_waitcnt vmcnt(7)
    ds_read_b64_tr_b16 a[12:13], v7 offset:36864
    ds_read_b64_tr_b16 a[14:15], v7 offset:37632
    buffer_load_dwordx4 v121, s[32:35], s92 offen offset:1024 lds
    ds_read_b64_tr_b16 a[36:37], v7 offset:36896
    ds_read_b64_tr_b16 a[38:39], v7 offset:37664
    ds_read_b64_tr_b16 a[60:61], v7 offset:36928
    ds_read_b64_tr_b16 a[62:63], v7 offset:37696
    buffer_load_dwordx4 v26, s[32:35], s92 offen offset:2048 lds
    s_add_u32 m0, s90, 12288
    s_mov_b32 s92, 37248
    ds_read_b128 v[60:63], v148 offset:40960
    ds_read_b128 v[56:59], v147 offset:40960
    s_waitcnt lgkmcnt(10)
    buffer_load_dwordx4 v149, s[32:35], s92 offen offset:0 lds
    ds_read_b128 v[52:55], v148 offset:41088
    ds_read_b128 v[48:51], v147 offset:41088
    buffer_load_dwordx4 v121, s[32:35], s92 offen offset:1024 lds
    ds_read_b128 v[40:43], v148 offset:41216
    ds_read_b128 v[0:3], v147 offset:41216
    buffer_load_dwordx4 v26, s[32:35], s92 offen offset:2048 lds
    s_add_u32 m0, s90, 24576
    s_mov_b32 s92, 74112
    s_waitcnt vmcnt(9)
    ds_read_b64_tr_b16 a[16:17], v7 offset:49152
    ds_read_b64_tr_b16 a[18:19], v7 offset:49920
    ds_read_b64_tr_b16 a[40:41], v7 offset:49184
    ds_read_b64_tr_b16 a[42:43], v7 offset:49952
    ds_read_b64_tr_b16 a[64:65], v7 offset:49216
    ds_read_b64_tr_b16 a[66:67], v7 offset:49984
    s_waitcnt lgkmcnt(6)
    buffer_load_dwordx4 v149, s[32:35], s92 offen offset:0 lds
    buffer_load_dwordx4 v121, s[32:35], s92 offen offset:1024 lds
    buffer_load_dwordx4 v26, s[32:35], s92 offen offset:2048 lds
    s_add_u32 m0, s90, 36864
    s_mov_b32 s92, 110976
    s_waitcnt vmcnt(9)
    ds_read_b64_tr_b16 a[20:21], v7 offset:61440
    ds_read_b64_tr_b16 a[22:23], v7 offset:62208
    v_mfma_f32_16x16x32_bf16 v[68:71], a[0:3], v[60:63], 0
    ds_read_b64_tr_b16 a[44:45], v7 offset:61472
    v_mfma_f32_16x16x32_bf16 v[68:71], a[4:7], v[56:59], v[68:71]
    ds_read_b64_tr_b16 a[46:47], v7 offset:62240
    v_mfma_f32_16x16x32_bf16 v[68:71], a[8:11], v[52:55], v[68:71]
    ds_read_b64_tr_b16 a[68:69], v7 offset:61504
    v_mfma_f32_16x16x32_bf16 v[68:71], a[12:15], v[48:51], v[68:71]
    s_waitcnt lgkmcnt(5)
    ds_read_b64_tr_b16 a[70:71], v7 offset:62272
    v_mfma_f32_16x16x32_bf16 v[68:71], a[16:19], v[40:43], v[68:71]
    ds_read_b128 v[44:47], v148 offset:42496
    ds_read_b128 v[36:39], v147 offset:42496
    ds_read_b128 v[32:35], v148 offset:42624
    ds_read_b128 v[28:31], v147 offset:42624
    s_waitcnt lgkmcnt(7)
    v_mfma_f32_16x16x32_bf16 v[68:71], a[20:23], v[0:3], v[68:71]
    ds_read_b128 v[20:23], v148 offset:42752
    s_nop 0
    v_mfma_f32_16x16x32_bf16 v[92:95], a[24:27], v[60:63], 0
    s_nop 0
    ds_read_b128 v[12:15], v147 offset:42752
    s_nop 0
    v_mfma_f32_16x16x32_bf16 v[92:95], a[28:31], v[56:59], v[92:95]
    s_nop 0
    v_fma_f32 v170, v68, v68, s41
    v_fmac_f32 v170, v69, v69
    v_mfma_f32_16x16x32_bf16 v[92:95], a[32:35], v[52:55], v[92:95]
    v_fmac_f32 v170, v70, v70
    v_fmac_f32 v170, v71, v71
    v_mfma_f32_16x16x32_bf16 v[92:95], a[36:39], v[48:51], v[92:95]
    v_mfma_f32_16x16x32_bf16 v[92:95], a[40:43], v[40:43], v[92:95]
    s_waitcnt lgkmcnt(4)
    buffer_load_dwordx4 v149, s[32:35], s92 offen offset:0 lds
    v_mfma_f32_16x16x32_bf16 v[92:95], a[44:47], v[0:3], v[92:95]
    s_nop 1
    v_mfma_f32_16x16x32_bf16 v[88:91], a[48:51], v[60:63], 0
    s_nop 2
    v_mfma_f32_16x16x32_bf16 v[88:91], a[52:55], v[56:59], v[88:91]
    s_nop 0
    v_fmac_f32 v170, v92, v92
    v_fmac_f32 v170, v93, v93
    v_mfma_f32_16x16x32_bf16 v[88:91], a[56:59], v[52:55], v[88:91]
    v_fmac_f32 v170, v94, v94
    v_fmac_f32 v170, v95, v95
    v_mfma_f32_16x16x32_bf16 v[88:91], a[60:63], v[48:51], v[88:91]
    buffer_load_dwordx4 v121, s[32:35], s92 offen offset:1024 lds
    v_mfma_f32_16x16x32_bf16 v[88:91], a[64:67], v[40:43], v[88:91]
    v_mfma_f32_16x16x32_bf16 v[88:91], a[68:71], v[0:3], v[88:91]
    s_nop 0
    v_mfma_f32_16x16x32_bf16 v[0:3], a[0:3], v[44:47], 0
    s_nop 2
    v_mfma_f32_16x16x32_bf16 v[0:3], a[4:7], v[36:39], v[0:3]
    s_waitcnt lgkmcnt(0)
    s_nop 0
    v_fmac_f32 v170, v88, v88
    v_fmac_f32 v170, v89, v89
    v_mfma_f32_16x16x32_bf16 v[0:3], a[8:11], v[32:35], v[0:3]
    v_fmac_f32 v170, v90, v90
    v_fmac_f32 v170, v91, v91
    v_mfma_f32_16x16x32_bf16 v[0:3], a[12:15], v[28:31], v[0:3]
    s_waitcnt vmcnt(8)
    buffer_load_dwordx4 v26, s[32:35], s92 offen offset:2048 lds
    ds_read_b64_tr_b16 a[72:73], v7 offset:0
    v_mfma_f32_16x16x32_bf16 v[0:3], a[16:19], v[20:23], v[0:3]
    s_add_u32 m0, s90, 49152
    ds_read_b64_tr_b16 a[74:75], v7 offset:768
    v_mfma_f32_16x16x32_bf16 v[0:3], a[20:23], v[12:15], v[0:3]
    s_mov_b32 s92, 147840
    ds_read_b64_tr_b16 a[96:97], v7 offset:32
    v_mfma_f32_16x16x32_bf16 v[56:59], a[24:27], v[44:47], 0
    ds_read_b64_tr_b16 a[98:99], v7 offset:800
    v_mfma_f32_16x16x32_bf16 v[56:59], a[28:31], v[36:39], v[56:59]
    ds_read_b64_tr_b16 a[120:121], v7 offset:64
    buffer_load_dwordx4 v149, s[32:35], s92 offen offset:0 lds
    v_mfma_f32_16x16x32_bf16 v[56:59], a[32:35], v[32:35], v[56:59]
    ds_read_b64_tr_b16 a[122:123], v7 offset:832
    v_fma_f32 v120, v0, v0, s41
    v_mfma_f32_16x16x32_bf16 v[56:59], a[36:39], v[28:31], v[56:59]
    ds_read_b128 v[100:103], v148 offset:40960
    v_fmac_f32 v120, v1, v1
    v_mfma_f32_16x16x32_bf16 v[56:59], a[40:43], v[20:23], v[56:59]
    ds_read_b128 v[64:67], v147 offset:40960
    v_fmac_f32 v120, v2, v2
    v_mfma_f32_16x16x32_bf16 v[56:59], a[44:47], v[12:15], v[56:59]
    ds_read_b128 v[52:55], v148 offset:41088
    v_fmac_f32 v120, v3, v3
    v_mfma_f32_16x16x32_bf16 v[40:43], a[48:51], v[44:47], 0
    ds_read_b128 v[48:51], v147 offset:41088
    buffer_load_dwordx4 v121, s[32:35], s92 offen offset:1024 lds
    v_mfma_f32_16x16x32_bf16 v[40:43], a[52:55], v[36:39], v[40:43]
    s_nop 0
    ds_read_b128 v[44:47], v148 offset:41216
    v_fmac_f32 v120, v56, v56
    v_mfma_f32_16x16x32_bf16 v[40:43], a[56:59], v[32:35], v[40:43]
    ds_read_b128 v[32:35], v147 offset:41216
    v_fmac_f32 v120, v57, v57
    v_mfma_f32_16x16x32_bf16 v[40:43], a[60:63], v[28:31], v[40:43]
    v_fmac_f32 v120, v58, v58
    v_fmac_f32 v120, v59, v59
    v_mfma_f32_16x16x32_bf16 v[40:43], a[64:67], v[20:23], v[40:43]
    v_mfma_f32_16x16x32_bf16 v[40:43], a[68:71], v[12:15], v[40:43]
    s_waitcnt vmcnt(8)
    buffer_load_dwordx4 v26, s[32:35], s92 offen offset:2048 lds
    ds_read_b64_tr_b16 a[76:77], v7 offset:12288
    s_add_u32 m0, s90, 61440
    s_mov_b32 s92, 184704
    ds_read_b64_tr_b16 a[78:79], v7 offset:13056
    s_nop 0
    ds_read_b64_tr_b16 a[100:101], v7 offset:12320
    v_fmac_f32 v120, v40, v40
    ds_read_b64_tr_b16 a[102:103], v7 offset:13088
    v_fmac_f32 v120, v41, v41
    ds_read_b64_tr_b16 a[124:125], v7 offset:12352
    v_fmac_f32 v120, v42, v42
    ds_read_b64_tr_b16 a[126:127], v7 offset:13120
    v_fmac_f32 v120, v43, v43
    buffer_load_dwordx4 v149, s[32:35], s92 offen offset:0 lds
    buffer_load_dwordx4 v121, s[32:35], s92 offen offset:1024 lds
    buffer_load_dwordx4 v26, s[32:35], s92 offen offset:2048 lds
    s_add_u32 m0, s90, 0
    s_mov_b32 s92, 768
    s_waitcnt vmcnt(9)
    ds_read_b64_tr_b16 a[80:81], v7 offset:24576
    ds_read_b64_tr_b16 a[82:83], v7 offset:25344
    ds_read_b64_tr_b16 a[104:105], v7 offset:24608
    ds_read_b64_tr_b16 a[106:107], v7 offset:25376
    ds_read_b64_tr_b16 a[128:129], v7 offset:24640
    ds_read_b64_tr_b16 a[130:131], v7 offset:25408
    s_waitcnt lgkmcnt(6)
    buffer_load_dwordx4 v149, s[32:35], s92 offen offset:0 lds
    buffer_load_dwordx4 v121, s[32:35], s92 offen offset:1024 lds
    buffer_load_dwordx4 v26, s[32:35], s92 offen offset:2048 lds
    s_add_u32 m0, s90, 12288
    s_mov_b32 s92, 37632
    s_waitcnt vmcnt(9)
    ds_read_b64_tr_b16 a[84:85], v7 offset:36864
    ds_read_b64_tr_b16 a[86:87], v7 offset:37632
    ds_read_b64_tr_b16 a[108:109], v7 offset:36896
    ds_read_b64_tr_b16 a[110:111], v7 offset:37664
    ds_read_b64_tr_b16 a[132:133], v7 offset:36928
    ds_read_b64_tr_b16 a[134:135], v7 offset:37696
    buffer_load_dwordx4 v149, s[32:35], s92 offen offset:0 lds
    buffer_load_dwordx4 v121, s[32:35], s92 offen offset:1024 lds
    buffer_load_dwordx4 v26, s[32:35], s92 offen offset:2048 lds
    s_add_u32 m0, s90, 24576
    s_mov_b32 s92, 74496
    s_waitcnt vmcnt(9)
    ds_read_b64_tr_b16 a[88:89], v7 offset:49152
    ds_read_b64_tr_b16 a[90:91], v7 offset:49920
    ds_read_b64_tr_b16 a[112:113], v7 offset:49184
    ds_read_b64_tr_b16 a[114:115], v7 offset:49952
    ds_read_b64_tr_b16 a[136:137], v7 offset:49216
    ds_read_b64_tr_b16 a[138:139], v7 offset:49984
    s_waitcnt lgkmcnt(6)
    buffer_load_dwordx4 v149, s[32:35], s92 offen offset:0 lds
    buffer_load_dwordx4 v121, s[32:35], s92 offen offset:1024 lds
    buffer_load_dwordx4 v26, s[32:35], s92 offen offset:2048 lds
    s_add_u32 m0, s90, 36864
    s_mov_b32 s92, 111360
    s_waitcnt vmcnt(9)
    ds_read_b64_tr_b16 a[92:93], v7 offset:61440
    ds_read_b64_tr_b16 a[94:95], v7 offset:62208
    v_mfma_f32_16x16x32_bf16 v[36:39], a[72:75], v[100:103], 0
    ds_read_b64_tr_b16 a[116:117], v7 offset:61472
    v_mfma_f32_16x16x32_bf16 v[36:39], a[76:79], v[64:67], v[36:39]
    ds_read_b64_tr_b16 a[118:119], v7 offset:62240
    v_mfma_f32_16x16x32_bf16 v[36:39], a[80:83], v[52:55], v[36:39]
    ds_read_b64_tr_b16 a[140:141], v7 offset:61504
    v_mfma_f32_16x16x32_bf16 v[36:39], a[84:87], v[48:51], v[36:39]
    s_waitcnt lgkmcnt(5)
    buffer_load_dwordx4 v149, s[32:35], s92 offen offset:0 lds
    ds_read_b64_tr_b16 a[142:143], v7 offset:62272
    v_mfma_f32_16x16x32_bf16 v[36:39], a[88:91], v[44:47], v[36:39]
    ds_read_b128 v[96:99], v148 offset:42496
    ds_read_b128 v[80:83], v147 offset:42496
    ds_read_b128 v[28:31], v148 offset:42624
    ds_read_b128 v[20:23], v147 offset:42624
    s_waitcnt lgkmcnt(7)
    v_mfma_f32_16x16x32_bf16 v[36:39], a[92:95], v[32:35], v[36:39]
    buffer_load_dwordx4 v121, s[32:35], s92 offen offset:1024 lds
    ds_read_b128 v[60:63], v148 offset:42752
    v_mfma_f32_16x16x32_bf16 v[84:87], a[96:99], v[100:103], 0
    s_nop 1
    ds_read_b128 v[12:15], v147 offset:42752
    v_mfma_f32_16x16x32_bf16 v[84:87], a[100:103], v[64:67], v[84:87]
    s_nop 0
    v_fma_f32 v4, v36, v36, s41
    v_fmac_f32 v4, v37, v37
    v_mfma_f32_16x16x32_bf16 v[84:87], a[104:107], v[52:55], v[84:87]
    v_fmac_f32 v4, v38, v38
    v_fmac_f32 v4, v39, v39
    v_mfma_f32_16x16x32_bf16 v[84:87], a[108:111], v[48:51], v[84:87]
    v_mfma_f32_16x16x32_bf16 v[84:87], a[112:115], v[44:47], v[84:87]
    s_waitcnt vmcnt(8) lgkmcnt(4)
    buffer_load_dwordx4 v26, s[32:35], s92 offen offset:2048 lds
    ds_read_b64_tr_b16 a[144:145], v6 offset:0
    v_mfma_f32_16x16x32_bf16 v[84:87], a[116:119], v[32:35], v[84:87]
    s_add_u32 m0, s90, 49152
    ds_read_b64_tr_b16 a[146:147], v6 offset:768
    v_mfma_f32_16x16x32_bf16 v[72:75], a[120:123], v[100:103], 0
    s_mov_b32 s92, 148224
    s_nop 0
    ds_read_b64_tr_b16 a[168:169], v6 offset:8
    v_mfma_f32_16x16x32_bf16 v[72:75], a[124:127], v[64:67], v[72:75]
    s_nop 0
    v_fmac_f32 v4, v84, v84
    v_fmac_f32 v4, v85, v85
    v_mfma_f32_16x16x32_bf16 v[72:75], a[128:131], v[52:55], v[72:75]
    ds_read_b64_tr_b16 a[170:171], v6 offset:776
    v_fmac_f32 v4, v86, v86
    v_mfma_f32_16x16x32_bf16 v[72:75], a[132:135], v[48:51], v[72:75]
    buffer_load_dwordx4 v149, s[32:35], s92 offen offset:0 lds
    ds_read_b64_tr_b16 a[192:193], v7 offset:64
    v_mfma_f32_16x16x32_bf16 v[72:75], a[136:139], v[44:47], v[72:75]
    ds_read_b64_tr_b16 a[194:195], v7 offset:832
    v_fmac_f32 v4, v87, v87
    v_mfma_f32_16x16x32_bf16 v[72:75], a[140:143], v[32:35], v[72:75]
    s_nop 0
    v_mfma_f32_16x16x32_bf16 v[52:55], a[72:75], v[96:99], 0
    s_nop 2
    v_mfma_f32_16x16x32_bf16 v[52:55], a[76:79], v[80:83], v[52:55]
    s_waitcnt lgkmcnt(5)
    s_nop 0
    v_fmac_f32 v4, v72, v72
    v_fmac_f32 v4, v73, v73
    v_mfma_f32_16x16x32_bf16 v[52:55], a[80:83], v[28:31], v[52:55]
    buffer_load_dwordx4 v121, s[32:35], s92 offen offset:1024 lds
    v_fmac_f32 v4, v74, v74
    v_mfma_f32_16x16x32_bf16 v[52:55], a[84:87], v[20:23], v[52:55]
    v_fmac_f32 v4, v75, v75
    v_cvt_pk_bf16_f32 v170, v170, v4
    v_mfma_f32_16x16x32_bf16 v[52:55], a[88:91], v[60:63], v[52:55]
    v_mfma_f32_16x16x32_bf16 v[52:55], a[92:95], v[12:15], v[52:55]
    ds_read_b128 v[64:67], v148 offset:40960
    v_mfma_f32_16x16x32_bf16 v[48:51], a[96:99], v[96:99], 0
    ds_read_b128 v[32:35], v147 offset:40960
    v_mfma_f32_16x16x32_bf16 v[48:51], a[100:103], v[80:83], v[48:51]
    s_waitcnt vmcnt(8)
    buffer_load_dwordx4 v26, s[32:35], s92 offen offset:2048 lds
    ds_read_b64_tr_b16 a[148:149], v6 offset:12288
    v_mfma_f32_16x16x32_bf16 v[48:51], a[104:107], v[28:31], v[48:51]
    s_add_u32 m0, s90, 61440
    v_fma_f32 v79, v52, v52, s41
    v_fmac_f32 v79, v53, v53
    v_mfma_f32_16x16x32_bf16 v[48:51], a[108:111], v[20:23], v[48:51]
    s_mov_b32 s92, 185088
    ds_read_b64_tr_b16 a[150:151], v6 offset:13056
    v_fmac_f32 v79, v54, v54
    v_mfma_f32_16x16x32_bf16 v[48:51], a[112:115], v[60:63], v[48:51]
    ds_read_b64_tr_b16 a[172:173], v6 offset:12296
    v_fmac_f32 v79, v55, v55
    v_mfma_f32_16x16x32_bf16 v[48:51], a[116:119], v[12:15], v[48:51]
    ds_read_b64_tr_b16 a[174:175], v6 offset:13064
    v_mfma_f32_16x16x32_bf16 v[44:47], a[120:123], v[96:99], 0
    s_nop 0
    buffer_load_dwordx4 v149, s[32:35], s92 offen offset:0 lds
    ds_read_b64_tr_b16 a[196:197], v7 offset:12352
    v_mfma_f32_16x16x32_bf16 v[44:47], a[124:127], v[80:83], v[44:47]
    s_nop 0
    ds_read_b64_tr_b16 a[198:199], v7 offset:13120
    v_fmac_f32 v79, v48, v48
    v_mfma_f32_16x16x32_bf16 v[44:47], a[128:131], v[28:31], v[44:47]
    ds_read_b128 v[28:31], v148 offset:41088
    v_fmac_f32 v79, v49, v49
    v_mfma_f32_16x16x32_bf16 v[44:47], a[132:135], v[20:23], v[44:47]
    ds_read_b128 v[20:23], v147 offset:41088
    v_fmac_f32 v79, v50, v50
    v_mfma_f32_16x16x32_bf16 v[44:47], a[136:139], v[60:63], v[44:47]
    ds_read_b128 v[60:63], v148 offset:41216
    v_fmac_f32 v79, v51, v51
    v_mfma_f32_16x16x32_bf16 v[44:47], a[140:143], v[12:15], v[44:47]
    s_nop 0
    buffer_load_dwordx4 v121, s[32:35], s92 offen offset:1024 lds
    ds_read_b128 v[12:15], v147 offset:41216
    v_mfma_f32_16x16x16_bf16 v[80:83], v[216:217], v[170:171], 0
    s_nop 0
    v_mov_b32 v254, 0
    v_mov_b32 v255, 0
    v_mov_b32 v253, 0
    v_fmac_f32 v79, v44, v44
    v_fmac_f32 v79, v45, v45
    v_fmac_f32 v79, v46, v46
    v_fmac_f32 v79, v47, v47
    v_rsq_f32 v80, v80
    v_rsq_f32 v81, v81
    v_mul_f32 v80, s55, v80
    v_mul_f32 v81, 0.5, v81
    v_mul_f32 v68, v68, v80
    buffer_load_dwordx4 v26, s[32:35], s92 offen offset:2048 lds
    s_add_u32 m0, s90, 0
    s_mov_b32 s92, 0
    s_waitcnt vmcnt(9)
    ds_read_b64_tr_b16 a[152:153], v6 offset:24576
    v_mul_f32 v69, v69, v80
    v_cvt_pk_f16_f32 v68, v68, v69
    v_mul_f32 v70, v70, v80
    ds_read_b64_tr_b16 a[154:155], v6 offset:25344
    v_mul_f32 v71, v71, v80
    v_cvt_pk_f16_f32 v69, v70, v71
    v_mul_f32 v92, v92, v80
    ds_read_b64_tr_b16 a[176:177], v6 offset:24584
    v_mul_f32 v93, v93, v80
    v_cvt_pk_f16_f32 v70, v92, v93
    s_waitcnt lgkmcnt(3)
    buffer_load_dwordx4 v27, s[76:79], s92 offen offset:0 lds
    ds_read_b64_tr_b16 a[178:179], v6 offset:25352
    v_mul_f32 v94, v94, v80
    v_mul_f32 v95, v95, v80
    v_cvt_pk_f16_f32 v71, v94, v95
    ds_read_b64_tr_b16 a[200:201], v7 offset:24640
    v_mul_f32 v88, v88, v80
    ds_read_b64_tr_b16 a[202:203], v7 offset:25408
    v_mul_f32 v89, v89, v80
    v_cvt_pk_f16_f32 v76, v88, v89
    v_mul_f32 v90, v90, v80
    v_mul_f32 v91, v91, v80
    v_cvt_pk_f16_f32 v77, v90, v91
    v_mul_f32 v36, v36, v81
    buffer_load_dwordx4 v146, s[76:79], s92 offen offset:1024 lds
    v_mul_f32 v37, v37, v81
    v_cvt_pk_f16_f32 v36, v36, v37
    v_mul_f32 v38, v38, v81
    v_mul_f32 v39, v39, v81
    v_cvt_pk_f16_f32 v37, v38, v39
    v_mul_f32 v84, v84, v81
    v_mul_f32 v85, v85, v81
    v_cvt_pk_f16_f32 v38, v84, v85
    v_mul_f32 v86, v86, v81
    v_mul_f32 v87, v87, v81
    v_cvt_pk_f16_f32 v39, v86, v87
    v_mul_f32 v72, v72, v81
    v_mul_f32 v73, v73, v81
    v_cvt_pk_f16_f32 v4, v72, v73
    v_mul_f32 v74, v74, v81
    v_mul_f32 v75, v75, v81
    v_cvt_pk_f16_f32 v5, v74, v75
    buffer_load_dwordx4 v78, s[76:79], s92 offen offset:2048 lds
    s_add_u32 m0, s90, 12288
    s_mov_b32 s92, 12288
    s_waitcnt vmcnt(9)
    ds_read_b64_tr_b16 a[156:157], v6 offset:36864
    v_fma_mix_f32 v252, v68, v36, 0 op_sel:[0,0,0] op_sel_hi:[1,1,0]
    v_fma_mix_f32 v252, v68, v36, v252 op_sel:[1,1,0] op_sel_hi:[1,1,0]
    v_fma_mix_f32 v252, v69, v37, v252 op_sel:[0,0,0] op_sel_hi:[1,1,0]
    ds_read_b64_tr_b16 a[158:159], v6 offset:37632
    v_fma_mix_f32 v252, v69, v37, v252 op_sel:[1,1,0] op_sel_hi:[1,1,0]
    v_fma_mix_f32 v252, v70, v38, v252 op_sel:[0,0,0] op_sel_hi:[1,1,0]
    v_fma_mix_f32 v252, v70, v38, v252 op_sel:[1,1,0] op_sel_hi:[1,1,0]
    ds_read_b64_tr_b16 a[180:181], v6 offset:36872
    v_fma_mix_f32 v252, v71, v39, v252 op_sel:[0,0,0] op_sel_hi:[1,1,0]
    v_fma_mix_f32 v252, v71, v39, v252 op_sel:[1,1,0] op_sel_hi:[1,1,0]
    buffer_load_dwordx4 v27, s[76:79], s92 offen offset:0 lds
    ds_read_b64_tr_b16 a[182:183], v6 offset:37640
    v_fma_mix_f32 v252, v76, v4, v252 op_sel:[0,0,0] op_sel_hi:[1,1,0]
    v_fma_mix_f32 v252, v76, v4, v252 op_sel:[1,1,0] op_sel_hi:[1,1,0]
    v_fma_mix_f32 v252, v77, v5, v252 op_sel:[0,0,0] op_sel_hi:[1,1,0]
    ds_read_b64_tr_b16 a[204:205], v7 offset:36928
    v_fma_mix_f32 v252, v77, v5, v252 op_sel:[1,1,0] op_sel_hi:[1,1,0]
    ds_read_b64_tr_b16 a[206:207], v7 offset:37696
    v_mov_b32 v26, v252
    v_add_u32 v149, 28672, v156
    ds_write_b128 v149, v[36:39]
    buffer_load_dwordx4 v146, s[76:79], s92 offen offset:1024 lds
    v_permlane32_swap_b32 v26, v252
    v_add_f32 v252, v26, v252
    v_mov_b32 v26, v252
    v_cvt_pk_bf16_f32 v170, v120, v79
    s_nop 0
    v_permlane16_swap_b32 v26, v252
    v_mfma_f32_16x16x16_bf16 v[36:39], v[216:217], v[170:171], 0
    s_waitcnt vmcnt(8)
    ds_write2_b64 v149, v[254:255], v[254:255] offset0:2 offset1:3
    v_add_f32 v252, v26, v252
    buffer_load_dwordx4 v78, s[76:79], s92 offen offset:2048 lds
    s_add_u32 m0, s90, 24576
    s_mov_b32 s92, 24576
    v_and_b32 v26, 0xffff0000, v252
    v_sub_f32 v252, v252, v26
    ds_read_b64_tr_b16 a[160:161], v6 offset:49152
    v_cvt_pk_bf16_f32 v252, v252, v26
    v_rsq_f32 v36, v36
    ds_read_b64_tr_b16 a[162:163], v6 offset:49920
    v_rsq_f32 v37, v37
    v_mul_f32 v36, s55, v36
    s_waitcnt lgkmcnt(3)
    buffer_load_dwordx4 v27, s[76:79], s92 offen offset:0 lds
    ds_read_b64_tr_b16 a[184:185], v6 offset:49160
    v_mul_f32 v37, 0.5, v37
    v_mul_f32 v0, v0, v36
    v_mul_f32 v1, v1, v36
    ds_read_b64_tr_b16 a[186:187], v6 offset:49928
    v_cvt_pk_f16_f32 v0, v0, v1
    v_mul_f32 v2, v2, v36
    v_mul_f32 v3, v3, v36
    ds_read_b64_tr_b16 a[208:209], v7 offset:49216
    v_cvt_pk_f16_f32 v1, v2, v3
    ds_read_b64_tr_b16 a[210:211], v7 offset:49984
    v_mul_f32 v56, v56, v36
    buffer_load_dwordx4 v146, s[76:79], s92 offen offset:1024 lds
    ds_write_b128 v149, v[68:71] offset:32
    v_mul_f32 v57, v57, v36
    v_cvt_pk_f16_f32 v2, v56, v57
    v_mul_f32 v58, v58, v36
    v_mul_f32 v59, v59, v36
    v_cvt_pk_f16_f32 v3, v58, v59
    v_mul_f32 v40, v40, v36
    v_mul_f32 v41, v41, v36
    v_cvt_pk_f16_f32 v120, v40, v41
    ds_write2_b64 v149, v[4:5], v[254:255] offset0:6 offset1:7
    buffer_load_dwordx4 v78, s[76:79], s92 offen offset:2048 lds
    s_add_u32 m0, s90, 36864
    s_mov_b32 s92, 36864
    v_mul_f32 v42, v42, v36
    v_mul_f32 v43, v43, v36
    v_cvt_pk_f16_f32 v121, v42, v43
    v_mul_f32 v52, v52, v37
    v_mul_f32 v53, v53, v37
    s_waitcnt vmcnt(9)
    ds_read_b64_tr_b16 a[164:165], v6 offset:61440
    v_cvt_pk_f16_f32 v4, v52, v53
    v_mul_f32 v54, v54, v37
    v_mul_f32 v55, v55, v37
    ds_read_b64_tr_b16 a[166:167], v6 offset:62208
    v_mfma_f32_16x16x32_bf16 v[40:43], a[144:147], v[64:67], 0
    buffer_load_dwordx4 v27, s[76:79], s92 offen offset:0 lds
    ds_read_b64_tr_b16 a[188:189], v6 offset:61448
    v_mfma_f32_16x16x32_bf16 v[40:43], a[148:151], v[32:35], v[40:43]
    v_cvt_pk_f16_f32 v5, v54, v55
    v_mul_f32 v48, v48, v37
    v_mfma_f32_16x16x32_bf16 v[40:43], a[152:155], v[28:31], v[40:43]
    ds_read_b64_tr_b16 a[190:191], v6 offset:62216
    v_mul_f32 v49, v49, v37
    v_mfma_f32_16x16x32_bf16 v[40:43], a[156:159], v[20:23], v[40:43]
    s_waitcnt lgkmcnt(4)
    ds_read_b64_tr_b16 a[212:213], v7 offset:61504
    v_cvt_pk_f16_f32 v6, v48, v49
    v_mfma_f32_16x16x32_bf16 v[40:43], a[160:163], v[60:63], v[40:43]
    ds_read_b64_tr_b16 a[214:215], v7 offset:62272
    v_mul_f32 v50, v50, v37
    v_mul_f32 v51, v51, v37
    v_cvt_pk_f16_f32 v7, v50, v51
    buffer_load_dwordx4 v146, s[76:79], s92 offen offset:1024 lds
    ds_write2_b64 v149, v[254:255], v[76:77] offset0:8 offset1:9
    v_mul_f32 v44, v44, v37
    v_mul_f32 v45, v45, v37
    v_cvt_pk_f16_f32 v254, v44, v45
    v_mul_f32 v46, v46, v37
    s_waitcnt lgkmcnt(5)
    v_mfma_f32_16x16x32_bf16 v[40:43], a[164:167], v[12:15], v[40:43]
    v_mul_f32 v47, v47, v37
    v_cvt_pk_f16_f32 v255, v46, v47
    v_mfma_f32_16x16x32_bf16 v[52:55], a[168:171], v[64:67], 0
    buffer_load_dwordx4 v78, s[76:79], s92 offen offset:2048 lds
    ds_read_b128 v[48:51], v148 offset:42496
    v_mfma_f32_16x16x32_bf16 v[52:55], a[172:175], v[32:35], v[52:55]
    s_add_u32 m0, s90, 49152
    v_fma_mix_f32 v26, v0, v4, 0 op_sel:[0,0,0] op_sel_hi:[1,1,0]
    v_fma_mix_f32 v26, v0, v4, v26 op_sel:[1,1,0] op_sel_hi:[1,1,0]
    v_mfma_f32_16x16x32_bf16 v[52:55], a[176:179], v[28:31], v[52:55]
    s_mov_b32 s92, 49152
    ds_write_b64 v149, v[252:253] offset:88
    v_mfma_f32_16x16x32_bf16 v[52:55], a[180:183], v[20:23], v[52:55]
    s_lshl_b32 s93, s68, 10
    v_fma_mix_f32 v26, v1, v5, v26 op_sel:[0,0,0] op_sel_hi:[1,1,0]
    v_fma_mix_f32 v26, v1, v5, v26 op_sel:[1,1,0] op_sel_hi:[1,1,0]
    v_mfma_f32_16x16x32_bf16 v[52:55], a[184:187], v[60:63], v[52:55]
    s_waitcnt lgkmcnt(3)
    s_mov_b32 s53, s47
    ds_read_b128 v[44:47], v147 offset:42496
    v_fma_mix_f32 v26, v2, v6, v26 op_sel:[0,0,0] op_sel_hi:[1,1,0]
    v_mfma_f32_16x16x32_bf16 v[52:55], a[188:191], v[12:15], v[52:55]
    s_mov_b32 s47, s46
    buffer_load_dwordx4 v27, s[76:79], s92 offen offset:0 lds
    ds_read_b128 v[36:39], v148 offset:42624
    v_mfma_f32_16x16x32_bf16 v[56:59], a[192:195], v[64:67], 0
    s_mov_b32 s46, s45
    v_fma_mix_f32 v26, v2, v6, v26 op_sel:[1,1,0] op_sel_hi:[1,1,0]
    v_fma_mix_f32 v26, v3, v7, v26 op_sel:[0,0,0] op_sel_hi:[1,1,0]
    v_mfma_f32_16x16x32_bf16 v[56:59], a[196:199], v[32:35], v[56:59]
    s_mov_b32 s45, s44
    ds_read_b128 v[32:35], v147 offset:42624
    v_fma_mix_f32 v26, v3, v7, v26 op_sel:[1,1,0] op_sel_hi:[1,1,0]
    v_mfma_f32_16x16x32_bf16 v[56:59], a[200:203], v[28:31], v[56:59]
    s_mov_b32 s44, s53
    ds_read_b128 v[28:31], v148 offset:42752
    v_fma_mix_f32 v26, v120, v254, v26 op_sel:[0,0,0] op_sel_hi:[1,1,0]
    v_mfma_f32_16x16x32_bf16 v[56:59], a[204:207], v[20:23], v[56:59]
    s_sub_u32 s48, s44, s46
    ds_read_b128 v[20:23], v147 offset:42752
    v_fma_mix_f32 v26, v120, v254, v26 op_sel:[1,1,0] op_sel_hi:[1,1,0]
    v_mfma_f32_16x16x32_bf16 v[56:59], a[208:211], v[60:63], v[56:59]
    s_sub_u32 s49, s46, s45
    buffer_load_dwordx4 v146, s[76:79], s92 offen offset:1024 lds
    v_fma_mix_f32 v26, v121, v255, v26 op_sel:[0,0,0] op_sel_hi:[1,1,0]
    v_mfma_f32_16x16x32_bf16 v[56:59], a[212:215], v[12:15], v[56:59]
    s_waitcnt lgkmcnt(5)
    v_fma_mix_f32 v26, v121, v255, v26 op_sel:[1,1,0] op_sel_hi:[1,1,0]
    v_mov_b32 v147, v26
    v_mfma_f32_16x16x32_bf16 v[12:15], a[144:147], v[48:51], 0
    s_waitcnt lgkmcnt(4)
    v_permlane32_swap_b32 v147, v26
    v_add_f32 v26, v147, v26
    v_mfma_f32_16x16x32_bf16 v[12:15], a[148:151], v[44:47], v[12:15]
    s_waitcnt lgkmcnt(3)
    v_mov_b32 v147, v26
    v_cvt_pk_bf16_f32 v148, v40, v41
    v_cvt_pk_bf16_f32 v149, v42, v43
    v_mfma_f32_16x16x32_bf16 v[12:15], a[152:155], v[36:39], v[12:15]
    s_waitcnt lgkmcnt(2)
    ds_write_b64 v156, v[148:149] offset:28752
    buffer_load_dwordx4 v78, s[76:79], s92 offen offset:2048 lds
    s_add_u32 m0, s90, 61440
    v_mfma_f32_16x16x32_bf16 v[12:15], a[156:159], v[32:35], v[12:15]
    s_waitcnt lgkmcnt(2)
    s_mov_b32 s92, 61440
    v_permlane16_swap_b32 v147, v26
    v_mfma_f32_16x16x32_bf16 v[12:15], a[160:163], v[28:31], v[12:15]
    s_waitcnt lgkmcnt(1)
    v_add_f32 v26, v147, v26
    v_and_b32 v147, 0xffff0000, v26
    v_mfma_f32_16x16x32_bf16 v[12:15], a[164:167], v[20:23], v[12:15]
    v_sub_f32 v26, v26, v147
    v_cvt_pk_bf16_f32 v26, v26, v147
    v_mfma_f32_16x16x32_bf16 v[40:43], a[168:171], v[48:51], 0
    v_cvt_pk_bf16_f32 v52, v52, v53
    v_cvt_pk_bf16_f32 v53, v54, v55
    v_mfma_f32_16x16x32_bf16 v[40:43], a[172:175], v[44:47], v[40:43]
    buffer_load_dwordx4 v27, s[76:79], s92 offen offset:0 lds
    v_cvt_pk_bf16_f32 v54, v56, v57
    v_mfma_f32_16x16x32_bf16 v[40:43], a[176:179], v[36:39], v[40:43]
    v_cvt_pk_bf16_f32 v55, v58, v59
    v_cvt_pk_bf16_f32 v246, v12, v13
    v_mfma_f32_16x16x32_bf16 v[40:43], a[180:183], v[32:35], v[40:43]
    ds_write_b128 v156, v[52:55] offset:28768
    v_mfma_f32_16x16x32_bf16 v[40:43], a[184:187], v[28:31], v[40:43]
    v_cvt_pk_bf16_f32 v247, v14, v15
    v_add_u32 v27, s93, v129
    v_mfma_f32_16x16x32_bf16 v[40:43], a[188:191], v[20:23], v[40:43]
    buffer_load_dwordx4 v146, s[76:79], s92 offen offset:1024 lds
    v_add_u32 v137, s48, v137
    v_mfma_f32_16x16x32_bf16 v[12:15], a[192:195], v[48:51], 0
    s_nop 0
    v_add_u32 v136, s48, v136
    s_nop 0
    v_mfma_f32_16x16x32_bf16 v[12:15], a[196:199], v[44:47], v[12:15]
    s_nop 0
    v_cvt_pk_bf16_f32 v76, v40, v41
    v_cvt_pk_bf16_f32 v77, v42, v43
    v_mfma_f32_16x16x32_bf16 v[12:15], a[200:203], v[36:39], v[12:15]
    v_mfma_f32_16x16x32_bf16 v[12:15], a[204:207], v[32:35], v[12:15]
    v_mfma_f32_16x16x32_bf16 v[12:15], a[208:211], v[28:31], v[12:15]
    buffer_load_dwordx4 v78, s[76:79], s92 offen offset:2048 lds
    v_mfma_f32_16x16x32_bf16 v[12:15], a[212:215], v[20:23], v[12:15]
    s_add_u32 m0, s54, 20480
    s_nop 6
    v_cvt_pk_bf16_f32 v78, v12, v13
    v_cvt_pk_bf16_f32 v79, v14, v15
    buffer_load_dwordx4 v128, s[24:27], s56 offen nt lds
    s_add_u32 m0, s54, 21504
    s_nop 0
    buffer_load_dwordx4 v127, s[24:27], s56 offen nt lds
    s_add_u32 m0, s54, 22528
    s_nop 0
    buffer_load_dwordx4 v126, s[24:27], s56 offen nt lds
    s_add_u32 m0, s54, 23552
    s_nop 0
    buffer_load_dwordx4 v125, s[24:27], s56 offen nt lds
    s_add_u32 m0, s54, 24576
    s_nop 0
    buffer_load_dwordx4 v124, s[24:27], s56 offen nt lds
    s_waitcnt vmcnt(5)
    s_barrier
    ds_read_b128 v[36:39], v17 offset:0
    ds_read_b64 v[12:13], v16 offset:64
    ds_read_b128 v[20:23], v17 offset:3072
    ds_read_b64 v[14:15], v16 offset:3136
    ds_read_b128 v[48:51], v17 offset:6144
    ds_read_b64 v[40:41], v16 offset:6208
    ds_read_b128 v[32:35], v17 offset:9216
    ds_read_b64 v[42:43], v16 offset:9280
    ds_read_b128 v[44:47], v17 offset:12288
    ds_read_b64 v[52:53], v16 offset:12352
    ds_read_b128 v[28:31], v17 offset:15360
    ds_read_b64 v[54:55], v16 offset:15424
    s_waitcnt lgkmcnt(11)
    v_mfma_f32_16x16x32_bf16 v[56:59], v[36:39], v[220:223], 0
    s_waitcnt lgkmcnt(9)
    ds_read_b128 v[36:39], v17 offset:18432
    v_mfma_f32_16x16x32_bf16 v[56:59], v[20:23], v[220:223], v[56:59]
    s_waitcnt lgkmcnt(8)
    ds_read_b64 v[20:21], v16 offset:18496
    ds_read_b128 v[60:63], v17 offset:21504
    v_mfma_f32_16x16x32_bf16 v[56:59], v[48:51], v[220:223], v[56:59]
    s_waitcnt lgkmcnt(8)
    ds_read_b64 v[22:23], v16 offset:21568
    ds_read_b128 v[48:51], v17 offset:24576
    v_mfma_f32_16x16x32_bf16 v[56:59], v[32:35], v[220:223], v[56:59]
    ds_read_b64 v[32:33], v16 offset:24640
    v_mfma_f32_16x16x32_bf16 v[56:59], v[12:15], v[220:223], v[56:59]
    s_waitcnt lgkmcnt(9)
    ds_read_b128 v[12:15], v17 offset:27648
    v_mfma_f32_16x16x32_bf16 v[56:59], v[40:43], v[220:223], v[56:59]
    ds_read_b64 v[34:35], v16 offset:27712
    v_mfma_f32_16x16x32_bf16 v[40:43], v[44:47], v[220:223], 0
    s_waitcnt lgkmcnt(8)
    ds_read_b128 v[44:47], v17 offset:30720
    v_mfma_f32_16x16x32_bf16 v[40:43], v[28:31], v[220:223], v[40:43]
    s_waitcnt lgkmcnt(8)
    s_nop 0
    ds_read_b64 v[28:29], v16 offset:30784
    v_mul_f32 v56, 0xbbaaaaab, v56
    v_mfma_f32_16x16x32_bf16 v[40:43], v[36:39], v[220:223], v[40:43]
    s_waitcnt lgkmcnt(7)
    ds_read_b128 v[36:39], v17 offset:33792
    v_mul_f32 v57, 0xbbaaaaab, v57
    v_mul_f32 v58, 0xbbaaaaab, v58
    v_mul_f32 v59, 0xbbaaaaab, v59
    v_mfma_f32_16x16x32_bf16 v[40:43], v[60:63], v[220:223], v[40:43]
    ds_write_b128 v25, v[56:59] offset:0
    v_mfma_f32_16x16x32_bf16 v[40:43], v[52:55], v[220:223], v[40:43]
    s_waitcnt lgkmcnt(6)
    v_mfma_f32_16x16x32_bf16 v[40:43], v[20:23], v[220:223], v[40:43]
    v_mfma_f32_16x16x32_bf16 v[20:23], v[48:51], v[220:223], 0
    s_waitcnt lgkmcnt(4)
    ds_read_b64 v[30:31], v16 offset:33856
    s_nop 0
    v_mfma_f32_16x16x32_bf16 v[20:23], v[12:15], v[220:223], v[20:23]
    s_waitcnt lgkmcnt(4)
    s_nop 0
    ds_read_b128 v[12:15], v24 offset:0
    v_mul_f32 v40, 0xbbaaaaab, v40
    v_mfma_f32_16x16x32_bf16 v[20:23], v[44:47], v[220:223], v[20:23]
    s_waitcnt lgkmcnt(3)
    ds_read_b64 v[16:17], v19 offset:64
    v_mul_f32 v41, 0xbbaaaaab, v41
    v_mul_f32 v42, 0xbbaaaaab, v42
    v_mul_f32 v43, 0xbbaaaaab, v43
    v_mfma_f32_16x16x32_bf16 v[20:23], v[36:39], v[220:223], v[20:23]
    ds_write_b128 v25, v[40:43] offset:128
    v_mfma_f32_16x16x32_bf16 v[20:23], v[32:35], v[220:223], v[20:23]
    ds_read_b128 v[70:73], v24 offset:768
    ds_read_b64 v[74:75], v19 offset:832
    ds_read_b128 v[64:67], v24 offset:12288
    s_waitcnt lgkmcnt(6)
    v_mfma_f32_16x16x32_bf16 v[20:23], v[28:31], v[220:223], v[20:23]
    s_nop 0
    ds_read_b64 v[68:69], v19 offset:12352
    s_nop 0
    ds_read_b128 v[104:107], v24 offset:13056
    s_nop 2
    ds_read_b64 v[108:109], v19 offset:13120
    v_mul_f32 v20, 0xbbaaaaab, v20
    v_mul_f32 v21, 0xbbaaaaab, v21
    v_mul_f32 v22, 0xbbaaaaab, v22
    v_mul_f32 v23, 0xbbaaaaab, v23
    ds_write_b128 v25, v[20:23] offset:256
    s_waitcnt lgkmcnt(0)
    s_barrier
    ds_read_b128 v[40:43], v18 offset:0
    ds_read_b128 v[28:31], v18 offset:64
    ds_read_b128 v[36:39], v18 offset:128
    ds_read_b128 v[56:59], v18 offset:192
    s_waitcnt lgkmcnt(3)
    v_mfma_f32_16x16x16_bf16 v[32:35], v[12:13], v[168:169], v[40:43]
    v_mfma_f32_16x16x16_bf16 v[20:23], v[14:15], v[168:169], v[40:43]
    s_nop 2
    v_mfma_f32_16x16x16_bf16 v[60:63], v[16:17], v[168:169], v[40:43]
    s_waitcnt lgkmcnt(0)
    s_nop 0
    ds_read_b128 v[12:15], v24 offset:24576
    v_cvt_pk_bf16_f32 v32, v32, v33
    v_mfma_f32_16x16x16_bf16 v[52:55], v[70:71], v[168:169], v[28:31]
    ds_read_b64 v[16:17], v19 offset:24640
    v_accvgpr_write_b32 a216, v32
    v_mfma_f32_16x16x16_bf16 v[44:47], v[72:73], v[168:169], v[28:31]
    ds_read_b128 v[48:51], v18 offset:256
    v_cvt_pk_bf16_f32 v34, v34, v35
    v_mfma_f32_16x16x16_bf16 v[40:43], v[74:75], v[168:169], v[28:31]
    ds_read_b128 v[98:101], v24 offset:25344
    v_accvgpr_write_b32 a217, v34
    v_mfma_f32_16x16x16_bf16 v[84:87], v[64:65], v[168:169], v[36:39]
    ds_read_b64 v[102:103], v19 offset:25408
    v_cvt_pk_bf16_f32 v20, v20, v21
    v_mfma_f32_16x16x16_bf16 v[32:35], v[66:67], v[168:169], v[36:39]
    ds_read_b128 v[80:83], v18 offset:320
    v_accvgpr_write_b32 a240, v20
    v_mfma_f32_16x16x16_bf16 v[28:31], v[68:69], v[168:169], v[36:39]
    ds_read_b128 v[92:95], v24 offset:36864
    v_cvt_pk_bf16_f32 v22, v22, v23
    v_mfma_f32_16x16x16_bf16 v[68:71], v[104:105], v[168:169], v[56:59]
    ds_read_b64 v[96:97], v19 offset:36928
    v_accvgpr_write_b32 a241, v22
    v_mfma_f32_16x16x16_bf16 v[36:39], v[106:107], v[168:169], v[56:59]
    ds_read_b128 v[64:67], v18 offset:5120
    v_cvt_pk_bf16_f32 v232, v60, v61
    v_mfma_f32_16x16x16_bf16 v[20:23], v[108:109], v[168:169], v[56:59]
    s_waitcnt lgkmcnt(6)
    ds_read_b128 v[110:113], v24 offset:37632
    v_cvt_pk_bf16_f32 v233, v62, v63
    v_cvt_pk_bf16_f32 v52, v52, v53
    v_accvgpr_write_b32 a218, v52
    v_cvt_pk_bf16_f32 v54, v54, v55
    v_accvgpr_write_b32 a219, v54
    v_cvt_pk_bf16_f32 v44, v44, v45
    v_mfma_f32_16x16x16_bf16 v[88:91], v[12:13], v[168:169], v[48:51]
    ds_read_b64 v[114:115], v19 offset:37696
    v_accvgpr_write_b32 a242, v44
    v_mfma_f32_16x16x16_bf16 v[56:59], v[14:15], v[168:169], v[48:51]
    ds_read_b128 v[60:63], v18 offset:5184
    v_cvt_pk_bf16_f32 v46, v46, v47
    v_mfma_f32_16x16x16_bf16 v[52:55], v[16:17], v[168:169], v[48:51]
    s_waitcnt lgkmcnt(6)
    ds_read_b128 v[12:15], v24 offset:49152
    v_accvgpr_write_b32 a243, v46
    v_cvt_pk_bf16_f32 v234, v40, v41
    v_cvt_pk_bf16_f32 v235, v42, v43
    v_mfma_f32_16x16x16_bf16 v[48:51], v[98:99], v[168:169], v[80:83]
    ds_read_b64 v[16:17], v19 offset:49216
    v_cvt_pk_bf16_f32 v84, v84, v85
    v_mfma_f32_16x16x16_bf16 v[44:47], v[100:101], v[168:169], v[80:83]
    ds_read_b128 v[72:75], v18 offset:5248
    v_accvgpr_write_b32 a220, v84
    v_mfma_f32_16x16x16_bf16 v[40:43], v[102:103], v[168:169], v[80:83]
    s_waitcnt lgkmcnt(6)
    ds_read_b128 v[104:107], v24 offset:49920
    v_cvt_pk_bf16_f32 v86, v86, v87
    v_accvgpr_write_b32 a221, v86
    v_cvt_pk_bf16_f32 v32, v32, v33
    v_accvgpr_write_b32 a244, v32
    v_cvt_pk_bf16_f32 v34, v34, v35
    v_accvgpr_write_b32 a245, v34
    v_cvt_pk_bf16_f32 v236, v28, v29
    v_cvt_pk_bf16_f32 v237, v30, v31
    v_mfma_f32_16x16x16_bf16 v[84:87], v[92:93], v[168:169], v[64:67]
    ds_read_b64 v[108:109], v19 offset:49984
    v_cvt_pk_bf16_f32 v68, v68, v69
    v_mfma_f32_16x16x16_bf16 v[28:31], v[94:95], v[168:169], v[64:67]
    ds_read_b128 v[100:103], v18 offset:5312
    v_accvgpr_write_b32 a222, v68
    v_mfma_f32_16x16x16_bf16 v[32:35], v[96:97], v[168:169], v[64:67]
    s_waitcnt lgkmcnt(5)
    ds_read_b128 v[92:95], v24 offset:61440
    v_cvt_pk_bf16_f32 v70, v70, v71
    v_accvgpr_write_b32 a223, v70
    v_cvt_pk_bf16_f32 v36, v36, v37
    v_accvgpr_write_b32 a246, v36
    v_cvt_pk_bf16_f32 v38, v38, v39
    v_accvgpr_write_b32 a247, v38
    v_cvt_pk_bf16_f32 v238, v20, v21
    v_cvt_pk_bf16_f32 v239, v22, v23
    v_mfma_f32_16x16x16_bf16 v[36:39], v[110:111], v[168:169], v[60:63]
    ds_read_b64 v[96:97], v19 offset:61504
    v_cvt_pk_bf16_f32 v88, v88, v89
    v_mfma_f32_16x16x16_bf16 v[68:71], v[112:113], v[168:169], v[60:63]
    ds_read_b128 v[80:83], v18 offset:5376
    v_accvgpr_write_b32 a224, v88
    v_mfma_f32_16x16x16_bf16 v[64:67], v[114:115], v[168:169], v[60:63]
    s_waitcnt lgkmcnt(5)
    ds_read_b128 v[20:23], v24 offset:62208
    v_cvt_pk_bf16_f32 v90, v90, v91
    v_accvgpr_write_b32 a225, v90
    v_cvt_pk_bf16_f32 v56, v56, v57
    v_accvgpr_write_b32 a248, v56
    v_cvt_pk_bf16_f32 v58, v58, v59
    v_accvgpr_write_b32 a249, v58
    v_cvt_pk_bf16_f32 v240, v52, v53
    v_cvt_pk_bf16_f32 v241, v54, v55
    v_mfma_f32_16x16x16_bf16 v[60:63], v[12:13], v[168:169], v[72:75]
    ds_read_b64 v[24:25], v19 offset:62272
    v_cvt_pk_bf16_f32 v48, v48, v49
    v_mfma_f32_16x16x16_bf16 v[56:59], v[14:15], v[168:169], v[72:75]
    ds_read_b128 v[12:15], v18 offset:5440
    v_accvgpr_write_b32 a226, v48
    v_mfma_f32_16x16x16_bf16 v[52:55], v[16:17], v[168:169], v[72:75]
    s_waitcnt lgkmcnt(5)
    ds_read_b128 v[16:19], v137 offset:0
    v_cvt_pk_bf16_f32 v50, v50, v51
    v_accvgpr_write_b32 a227, v50
    v_cvt_pk_bf16_f32 v44, v44, v45
    v_accvgpr_write_b32 a250, v44
    v_cvt_pk_bf16_f32 v46, v46, v47
    v_accvgpr_write_b32 a251, v46
    v_cvt_pk_bf16_f32 v242, v40, v41
    v_cvt_pk_bf16_f32 v243, v42, v43
    v_mfma_f32_16x16x16_bf16 v[48:51], v[104:105], v[168:169], v[100:103]
    ds_read_b128 v[146:149], v136 offset:0
    v_cvt_pk_bf16_f32 v84, v84, v85
    v_mfma_f32_16x16x16_bf16 v[40:43], v[106:107], v[168:169], v[100:103]
    ds_read_b128 v[72:75], v137 offset:128
    v_accvgpr_write_b32 a228, v84
    v_mfma_f32_16x16x16_bf16 v[44:47], v[108:109], v[168:169], v[100:103]
    s_waitcnt lgkmcnt(5)
    ds_read_b128 v[88:91], v136 offset:128
    v_cvt_pk_bf16_f32 v86, v86, v87
    v_accvgpr_write_b32 a229, v86
    v_cvt_pk_bf16_f32 v28, v28, v29
    v_accvgpr_write_b32 a252, v28
    v_cvt_pk_bf16_f32 v30, v30, v31
    v_accvgpr_write_b32 a253, v30
    v_cvt_pk_bf16_f32 v244, v32, v33
    v_cvt_pk_bf16_f32 v245, v34, v35
    v_mfma_f32_16x16x16_bf16 v[32:35], v[92:93], v[168:169], v[80:83]
    s_waitcnt vmcnt(0) lgkmcnt(4)
    s_barrier
    ds_write_b128 v27, v[8:11] offset:6144
    v_mfma_f32_16x16x16_bf16 v[8:11], v[94:95], v[168:169], v[80:83]
    v_cvt_pk_bf16_f32 v36, v36, v37
    v_accvgpr_write_b32 a230, v36
    v_mfma_f32_16x16x16_bf16 v[28:31], v[96:97], v[168:169], v[80:83]
    s_waitcnt lgkmcnt(4)
    v_cvt_pk_bf16_f32 v38, v38, v39
    v_accvgpr_write_b32 a231, v38
    v_cvt_pk_bf16_f32 v68, v68, v69
    v_mfma_f32_16x16x32_bf16 v[36:39], a[0:3], v[16:19], 0
    s_waitcnt lgkmcnt(3)
    ds_write_b64 v156, v[246:247] offset:80
    v_mfma_f32_16x16x32_bf16 v[36:39], a[4:7], v[146:149], v[36:39]
    s_waitcnt lgkmcnt(3)
    v_accvgpr_write_b32 a254, v68
    v_cvt_pk_bf16_f32 v70, v70, v71
    v_mfma_f32_16x16x32_bf16 v[36:39], a[8:11], v[72:75], v[36:39]
    s_waitcnt lgkmcnt(2)
    ds_write_b128 v156, v[76:79] offset:96
    v_mfma_f32_16x16x32_bf16 v[36:39], a[12:15], v[88:91], v[36:39]
    v_accvgpr_write_b32 a255, v70
    v_cvt_pk_bf16_f32 v246, v64, v65
    v_cvt_pk_bf16_f32 v247, v66, v67
    v_cvt_pk_bf16_f32 v60, v60, v61
    v_accvgpr_write_b32 a232, v60
    v_cvt_pk_bf16_f32 v62, v62, v63
    v_accvgpr_write_b32 a233, v62
    v_cvt_pk_bf16_f32 v224, v56, v57
    v_cvt_pk_bf16_f32 v225, v58, v59
    v_cvt_pk_bf16_f32 v248, v52, v53
    v_cvt_pk_bf16_f32 v249, v54, v55
    v_cvt_pk_bf16_f32 v48, v48, v49
    v_accvgpr_write_b32 a234, v48
    v_cvt_pk_bf16_f32 v50, v50, v51
    v_accvgpr_write_b32 a235, v50
    v_cvt_pk_bf16_f32 v226, v40, v41
    v_cvt_pk_bf16_f32 v227, v42, v43
    v_cvt_pk_bf16_f32 v250, v44, v45
    v_cvt_pk_bf16_f32 v251, v46, v47
    v_cvt_pk_bf16_f32 v32, v32, v33
    v_accvgpr_write_b32 a236, v32
    v_cvt_pk_bf16_f32 v34, v34, v35
    v_accvgpr_write_b32 a237, v34
    v_cvt_pk_bf16_f32 v228, v8, v9
    v_cvt_pk_bf16_f32 v229, v10, v11
    v_cvt_pk_bf16_f32 v252, v28, v29
    v_cvt_pk_bf16_f32 v253, v30, v31
    v_mov_b32 v230, 0
    v_mov_b32 v231, 0
    v_mov_b32 v27, 0
    v_add_u32 v170, 0, v156
    ds_write_b128 v170, v[4:7]
    v_add_u32 v135, s49, v135
    v_add_u32 v134, s49, v134
    ds_write2_b64 v170, v[230:231], v[230:231] offset0:2 offset1:3
    ds_write_b128 v170, v[0:3] offset:32
    ds_write2_b64 v170, v[254:255], v[230:231] offset0:6 offset1:7
    ds_write2_b64 v170, v[230:231], v[120:121] offset0:8 offset1:9
    ds_write_b64 v170, v[26:27] offset:88
    ds_read_b128 v[76:79], v137 offset:256
    ds_read_b128 v[56:59], v136 offset:256
    s_waitcnt lgkmcnt(1)
    v_mfma_f32_16x16x32_bf16 v[36:39], a[16:19], v[76:79], v[36:39]
    s_waitcnt lgkmcnt(0)
    v_mfma_f32_16x16x32_bf16 v[36:39], a[20:23], v[56:59], v[36:39]
    s_nop 0
    v_mfma_f32_16x16x16_bf16 v[8:11], v[20:21], v[168:169], v[12:15]
    s_nop 3
    v_mfma_f32_16x16x16_bf16 v[4:7], v[22:23], v[168:169], v[12:15]
    s_nop 0
    v_fma_f32 v121, v36, v36, s41
    v_fmac_f32 v121, v37, v37
    v_mfma_f32_16x16x16_bf16 v[0:3], v[24:25], v[168:169], v[12:15]
    v_cvt_pk_bf16_f32 v8, v8, v9
    v_accvgpr_write_b32 a238, v8
    v_cvt_pk_bf16_f32 v10, v10, v11
    v_mfma_f32_16x16x32_bf16 v[48:51], a[24:27], v[16:19], 0
    v_accvgpr_write_b32 a239, v10
    v_cvt_pk_bf16_f32 v230, v4, v5
    v_mfma_f32_16x16x32_bf16 v[48:51], a[28:31], v[146:149], v[48:51]
    v_cvt_pk_bf16_f32 v231, v6, v7
    v_cvt_pk_bf16_f32 v254, v0, v1
    v_mfma_f32_16x16x32_bf16 v[48:51], a[32:35], v[72:75], v[48:51]
    v_cvt_pk_bf16_f32 v255, v2, v3
    v_fmac_f32 v121, v38, v38
    v_mfma_f32_16x16x32_bf16 v[48:51], a[36:39], v[88:91], v[48:51]
    v_fmac_f32 v121, v39, v39
    v_mfma_f32_16x16x32_bf16 v[48:51], a[40:43], v[76:79], v[48:51]
    v_mfma_f32_16x16x32_bf16 v[48:51], a[44:47], v[56:59], v[48:51]
    s_nop 1
    v_mfma_f32_16x16x32_bf16 v[40:43], a[48:51], v[16:19], 0
    s_nop 2
    v_mfma_f32_16x16x32_bf16 v[40:43], a[52:55], v[146:149], v[40:43]
    s_nop 0
    v_fmac_f32 v121, v48, v48
    v_fmac_f32 v121, v49, v49
    v_mfma_f32_16x16x32_bf16 v[40:43], a[56:59], v[72:75], v[40:43]
    v_fmac_f32 v121, v50, v50
    v_fmac_f32 v121, v51, v51
    v_mfma_f32_16x16x32_bf16 v[40:43], a[60:63], v[88:91], v[40:43]
    v_mfma_f32_16x16x32_bf16 v[40:43], a[64:67], v[76:79], v[40:43]
    v_mfma_f32_16x16x32_bf16 v[40:43], a[68:71], v[56:59], v[40:43]
    s_nop 1
    v_mfma_f32_16x16x32_bf16 v[28:31], a[72:75], v[16:19], 0
    s_nop 2
    v_mfma_f32_16x16x32_bf16 v[28:31], a[76:79], v[146:149], v[28:31]
    s_nop 0
    v_fmac_f32 v121, v40, v40
    v_fmac_f32 v121, v41, v41
    v_mfma_f32_16x16x32_bf16 v[28:31], a[80:83], v[72:75], v[28:31]
    v_fmac_f32 v121, v42, v42
    v_fmac_f32 v121, v43, v43
    v_mfma_f32_16x16x32_bf16 v[28:31], a[84:87], v[88:91], v[28:31]
    v_mfma_f32_16x16x32_bf16 v[28:31], a[88:91], v[76:79], v[28:31]
    v_mfma_f32_16x16x32_bf16 v[28:31], a[92:95], v[56:59], v[28:31]
    s_nop 1
    v_mfma_f32_16x16x32_bf16 v[32:35], a[96:99], v[16:19], 0
    s_nop 2
    v_mfma_f32_16x16x32_bf16 v[32:35], a[100:103], v[146:149], v[32:35]
    s_nop 0
    v_fma_f32 v120, v28, v28, s41
    v_fmac_f32 v120, v29, v29
    v_mfma_f32_16x16x32_bf16 v[32:35], a[104:107], v[72:75], v[32:35]
    v_fmac_f32 v120, v30, v30
    v_fmac_f32 v120, v31, v31
    v_mfma_f32_16x16x32_bf16 v[32:35], a[108:111], v[88:91], v[32:35]
    v_mfma_f32_16x16x32_bf16 v[32:35], a[112:115], v[76:79], v[32:35]
    v_mfma_f32_16x16x32_bf16 v[32:35], a[116:119], v[56:59], v[32:35]
    s_nop 1
    v_mfma_f32_16x16x32_bf16 v[20:23], a[120:123], v[16:19], 0
    s_nop 2
    v_mfma_f32_16x16x32_bf16 v[20:23], a[124:127], v[146:149], v[20:23]
    s_nop 0
    v_fmac_f32 v120, v32, v32
    v_fmac_f32 v120, v33, v33
    v_mfma_f32_16x16x32_bf16 v[20:23], a[128:131], v[72:75], v[20:23]
    v_fmac_f32 v120, v34, v34
    v_fmac_f32 v120, v35, v35
    v_mfma_f32_16x16x32_bf16 v[20:23], a[132:135], v[88:91], v[20:23]
    v_mfma_f32_16x16x32_bf16 v[20:23], a[136:139], v[76:79], v[20:23]
    v_mfma_f32_16x16x32_bf16 v[20:23], a[140:143], v[56:59], v[20:23]
    s_nop 1
    v_mfma_f32_16x16x32_bf16 v[8:11], v[16:19], a[144:147], 0
    s_nop 2
    v_mfma_f32_16x16x32_bf16 v[8:11], v[146:149], a[148:151], v[8:11]
    s_nop 0
    v_fmac_f32 v120, v20, v20
    v_fmac_f32 v120, v21, v21
    v_mfma_f32_16x16x32_bf16 v[8:11], v[72:75], a[152:155], v[8:11]
    v_fmac_f32 v120, v22, v22
    v_fmac_f32 v120, v23, v23
    v_mfma_f32_16x16x32_bf16 v[8:11], v[88:91], a[156:159], v[8:11]
    v_cvt_pk_bf16_f32 v170, v121, v120
    v_mfma_f32_16x16x32_bf16 v[8:11], v[76:79], a[160:163], v[8:11]
    ds_read_b128 v[104:107], v137 offset:1536
    v_mfma_f32_16x16x32_bf16 v[8:11], v[56:59], a[164:167], v[8:11]
    s_nop 0
    ds_read_b128 v[100:103], v136 offset:1536
    s_nop 0
    v_mfma_f32_16x16x16_bf16 v[24:27], v[216:217], v[170:171], 0
    s_nop 0
    ds_read_b128 v[44:47], v137 offset:1664
    s_nop 1
    v_cvt_pk_bf16_f32 v0, v8, v9
    v_mfma_f32_16x16x32_bf16 v[4:7], v[16:19], a[168:171], 0
    ds_read_b128 v[84:87], v136 offset:1664
    v_cvt_pk_bf16_f32 v1, v10, v11
    v_mfma_f32_16x16x32_bf16 v[4:7], v[146:149], a[172:175], v[4:7]
    ds_read_b128 v[68:71], v137 offset:1792
    v_mfma_f32_16x16x32_bf16 v[4:7], v[72:75], a[176:179], v[4:7]
    ds_read_b128 v[64:67], v136 offset:1792
    v_mfma_f32_16x16x32_bf16 v[4:7], v[88:91], a[180:183], v[4:7]
    v_rsq_f32 v24, v24
    v_mfma_f32_16x16x32_bf16 v[4:7], v[76:79], a[184:187], v[4:7]
    v_rsq_f32 v25, v25
    v_mfma_f32_16x16x32_bf16 v[4:7], v[56:59], a[188:191], v[4:7]
    v_mul_f32 v24, s55, v24
    v_mul_f32 v25, 0.5, v25
    v_mfma_f32_16x16x32_bf16 v[12:15], v[16:19], a[192:195], 0
    s_nop 0
    v_mul_f32 v36, v36, v24
    v_mul_f32 v37, v37, v24
    v_mfma_f32_16x16x32_bf16 v[12:15], v[146:149], a[196:199], v[12:15]
    s_nop 0
    v_cvt_pk_bf16_f32 v8, v4, v5
    v_cvt_pk_bf16_f32 v9, v6, v7
    v_mfma_f32_16x16x32_bf16 v[12:15], v[72:75], a[200:203], v[12:15]
    v_cvt_pk_f16_f32 v4, v36, v37
    v_mul_f32 v38, v38, v24
    v_mfma_f32_16x16x32_bf16 v[12:15], v[88:91], a[204:207], v[12:15]
    v_mul_f32 v39, v39, v24
    v_cvt_pk_f16_f32 v5, v38, v39
    v_mfma_f32_16x16x32_bf16 v[12:15], v[76:79], a[208:211], v[12:15]
    v_mul_f32 v48, v48, v24
    v_mul_f32 v49, v49, v24
    v_mfma_f32_16x16x32_bf16 v[12:15], v[56:59], a[212:215], v[12:15]
    s_waitcnt lgkmcnt(0)
    v_cvt_pk_f16_f32 v6, v48, v49
    v_mul_f32 v50, v50, v24
    v_mfma_f32_16x16x32_bf16 v[16:19], a[0:3], v[104:107], 0
    v_mul_f32 v51, v51, v24
    v_cvt_pk_f16_f32 v7, v50, v51
    v_mfma_f32_16x16x32_bf16 v[16:19], a[4:7], v[100:103], v[16:19]
    v_mul_f32 v40, v40, v24
    v_mul_f32 v41, v41, v24
    v_mfma_f32_16x16x32_bf16 v[16:19], a[8:11], v[44:47], v[16:19]
    v_cvt_pk_f16_f32 v152, v40, v41
    v_mul_f32 v42, v42, v24
    v_mfma_f32_16x16x32_bf16 v[16:19], a[12:15], v[84:87], v[16:19]
    v_mul_f32 v43, v43, v24
    v_cvt_pk_f16_f32 v153, v42, v43
    v_mfma_f32_16x16x32_bf16 v[16:19], a[16:19], v[68:71], v[16:19]
    v_mul_f32 v28, v28, v25
    v_mul_f32 v29, v29, v25
    v_mfma_f32_16x16x32_bf16 v[16:19], a[20:23], v[64:67], v[16:19]
    v_cvt_pk_f16_f32 v28, v28, v29
    v_mul_f32 v30, v30, v25
    v_mfma_f32_16x16x32_bf16 v[60:63], a[24:27], v[104:107], 0
    v_mul_f32 v31, v31, v25
    v_cvt_pk_f16_f32 v29, v30, v31
    v_mfma_f32_16x16x32_bf16 v[60:63], a[28:31], v[100:103], v[60:63]
    v_mul_f32 v32, v32, v25
    v_mul_f32 v33, v33, v25
    v_mfma_f32_16x16x32_bf16 v[60:63], a[32:35], v[44:47], v[60:63]
    v_cvt_pk_f16_f32 v30, v32, v33
    v_mul_f32 v34, v34, v25
    v_mfma_f32_16x16x32_bf16 v[60:63], a[36:39], v[84:87], v[60:63]
    v_mul_f32 v35, v35, v25
    v_cvt_pk_f16_f32 v31, v34, v35
    v_mfma_f32_16x16x32_bf16 v[60:63], a[40:43], v[68:71], v[60:63]
    v_mul_f32 v20, v20, v25
    v_mul_f32 v21, v21, v25
    v_mfma_f32_16x16x32_bf16 v[60:63], a[44:47], v[64:67], v[60:63]
    v_cvt_pk_f16_f32 v154, v20, v21
    v_mul_f32 v22, v22, v25
    v_mfma_f32_16x16x32_bf16 v[36:39], a[48:51], v[104:107], 0
    v_mul_f32 v23, v23, v25
    v_cvt_pk_f16_f32 v155, v22, v23
    v_mfma_f32_16x16x32_bf16 v[36:39], a[52:55], v[100:103], v[36:39]
    v_cvt_pk_bf16_f32 v20, v12, v13
    v_cvt_pk_bf16_f32 v21, v14, v15
    v_mfma_f32_16x16x32_bf16 v[36:39], a[56:59], v[44:47], v[36:39]
    v_fma_f32 v2, v16, v16, s41
    v_fmac_f32 v2, v17, v17
    v_mfma_f32_16x16x32_bf16 v[36:39], a[60:63], v[84:87], v[36:39]
    v_fmac_f32 v2, v18, v18
    v_fmac_f32 v2, v19, v19
    v_mfma_f32_16x16x32_bf16 v[36:39], a[64:67], v[68:71], v[36:39]
    v_fmac_f32 v2, v60, v60
    v_fmac_f32 v2, v61, v61
    v_mfma_f32_16x16x32_bf16 v[36:39], a[68:71], v[64:67], v[36:39]
    v_fmac_f32 v2, v62, v62
    v_fmac_f32 v2, v63, v63
    v_mfma_f32_16x16x32_bf16 v[52:55], a[72:75], v[104:107], 0
    s_nop 2
    v_mfma_f32_16x16x32_bf16 v[52:55], a[76:79], v[100:103], v[52:55]
    s_nop 0
    v_fmac_f32 v2, v36, v36
    v_fmac_f32 v2, v37, v37
    v_mfma_f32_16x16x32_bf16 v[52:55], a[80:83], v[44:47], v[52:55]
    v_fmac_f32 v2, v38, v38
    v_fmac_f32 v2, v39, v39
    v_mfma_f32_16x16x32_bf16 v[52:55], a[84:87], v[84:87], v[52:55]
    v_mfma_f32_16x16x32_bf16 v[52:55], a[88:91], v[68:71], v[52:55]
    v_mfma_f32_16x16x32_bf16 v[52:55], a[92:95], v[64:67], v[52:55]
    s_nop 1
    v_mfma_f32_16x16x32_bf16 v[12:15], a[96:99], v[104:107], 0
    s_nop 2
    v_mfma_f32_16x16x32_bf16 v[12:15], a[100:103], v[100:103], v[12:15]
    s_nop 0
    v_fma_f32 v3, v52, v52, s41
    v_fmac_f32 v3, v53, v53
    v_mfma_f32_16x16x32_bf16 v[12:15], a[104:107], v[44:47], v[12:15]
    v_fmac_f32 v3, v54, v54
    v_fmac_f32 v3, v55, v55
    v_mfma_f32_16x16x32_bf16 v[12:15], a[108:111], v[84:87], v[12:15]
    v_mfma_f32_16x16x32_bf16 v[12:15], a[112:115], v[68:71], v[12:15]
    v_mfma_f32_16x16x32_bf16 v[12:15], a[116:119], v[64:67], v[12:15]
    s_sub_u32 s50, s45, s44
    v_add_u32 v135, s48, v135
    v_add_u32 v134, s48, v134
    v_mfma_f32_16x16x32_bf16 v[48:51], a[120:123], v[104:107], 0
    s_sub_u32 s51, s46, s47
    v_add_u32 v133, s51, v133
    v_mfma_f32_16x16x32_bf16 v[48:51], a[124:127], v[100:103], v[48:51]
    s_mov_b32 s60, s59
    v_fmac_f32 v3, v12, v12
    v_fmac_f32 v3, v13, v13
    v_mfma_f32_16x16x32_bf16 v[48:51], a[128:131], v[44:47], v[48:51]
    s_mov_b32 s59, s58
    v_fmac_f32 v3, v14, v14
    v_fmac_f32 v3, v15, v15
    v_mfma_f32_16x16x32_bf16 v[48:51], a[132:135], v[84:87], v[48:51]
    s_mov_b32 s58, s57
    v_mfma_f32_16x16x32_bf16 v[48:51], a[136:139], v[68:71], v[48:51]
    s_mov_b32 s57, s56
    v_mfma_f32_16x16x32_bf16 v[48:51], a[140:143], v[64:67], v[48:51]
    s_mov_b32 s7, s6
    s_nop 0
    v_mfma_f32_16x16x32_bf16 v[24:27], v[104:107], a[144:147], 0
    s_mov_b32 s6, s5
    s_nop 1
    v_mfma_f32_16x16x32_bf16 v[24:27], v[100:103], a[148:151], v[24:27]
    s_mov_b32 s5, s4
    v_fmac_f32 v3, v48, v48
    v_fmac_f32 v3, v49, v49
    v_mfma_f32_16x16x32_bf16 v[24:27], v[44:47], a[152:155], v[24:27]
    s_sub_u32 s14, s6, s7
    v_fmac_f32 v3, v50, v50
    v_fmac_f32 v3, v51, v51
    v_mfma_f32_16x16x32_bf16 v[24:27], v[84:87], a[156:159], v[24:27]
    s_add_u32 s61, s61, 1
    v_cvt_pk_bf16_f32 v170, v2, v3
    v_add_u32 v132, s14, v132
    v_mfma_f32_16x16x32_bf16 v[24:27], v[68:71], a[160:163], v[24:27]
    s_ff1_i32_b32 s15, s66
    ds_read_b128 v[96:99], v137 offset:3072
    v_add_u32 v131, s14, v131
    v_mfma_f32_16x16x32_bf16 v[24:27], v[64:67], a[164:167], v[24:27]
    s_cmp_lg_u32 s66, 0
    ds_read_b128 v[92:95], v136 offset:3072
    v_add_u32 v123, s14, v123
    v_mfma_f32_16x16x16_bf16 v[40:43], v[216:217], v[170:171], 0
    s_cselect_b32 s12, s15, s12
    ds_read_b128 v[88:91], v137 offset:3200
    s_nop 1
    v_cvt_pk_bf16_f32 v2, v24, v25
    v_mfma_f32_16x16x32_bf16 v[72:75], v[104:107], a[168:171], 0
    s_cmp_lt_u32 s61, s71
    ds_read_b128 v[80:83], v136 offset:3200
    v_cvt_pk_bf16_f32 v3, v26, v27
    v_mfma_f32_16x16x32_bf16 v[72:75], v[100:103], a[172:175], v[72:75]
    s_cselect_b32 s15, 31, s15
    ds_read_b128 v[56:59], v137 offset:3328
    v_add_u32 v137, s50, v137
    v_mfma_f32_16x16x32_bf16 v[72:75], v[44:47], a[176:179], v[72:75]
    s_bitset0_b32 s66, s15
    ds_read_b128 v[24:27], v136 offset:3328
    v_add_u32 v136, s50, v136
    v_mfma_f32_16x16x32_bf16 v[72:75], v[84:87], a[180:183], v[72:75]
    s_add_u32 s12, s12, 20
    v_rsq_f32 v40, v40
    v_mfma_f32_16x16x32_bf16 v[72:75], v[68:71], a[184:187], v[72:75]
    s_max_u32 s12, s12, s61
    v_rsq_f32 v41, v41
    v_mfma_f32_16x16x32_bf16 v[72:75], v[64:67], a[188:191], v[72:75]
    s_cmp_lt_u32 s61, s71
    v_mul_f32 v40, s55, v40
    v_mul_f32 v41, 0.5, v41
    v_mfma_f32_16x16x32_bf16 v[32:35], v[104:107], a[192:195], 0
    s_cselect_b32 s15, s61, s12
    v_mul_f32 v16, v16, v40
    v_mul_f32 v17, v17, v40
    v_mfma_f32_16x16x32_bf16 v[32:35], v[100:103], a[196:199], v[32:35]
    s_cselect_b32 s56, s69, s70
    v_cvt_pk_bf16_f32 v10, v72, v73
    v_cvt_pk_bf16_f32 v11, v74, v75
    v_mfma_f32_16x16x32_bf16 v[32:35], v[44:47], a[200:203], v[32:35]
    s_add_u32 s56, s56, s15
    v_cvt_pk_f16_f32 v44, v16, v17
    v_mul_f32 v18, v18, v40
    v_mfma_f32_16x16x32_bf16 v[32:35], v[84:87], a[204:207], v[32:35]
    s_mul_i32 s53, s56, 58255
    v_mul_f32 v19, v19, v40
    v_cvt_pk_f16_f32 v45, v18, v19
    v_mfma_f32_16x16x32_bf16 v[32:35], v[68:71], a[208:211], v[32:35]
    s_waitcnt lgkmcnt(0)
    s_lshr_b32 s53, s53, 22
    v_mul_f32 v60, v60, v40
    v_mul_f32 v61, v61, v40
    v_mfma_f32_16x16x32_bf16 v[32:35], v[64:67], a[212:215], v[32:35]
    s_barrier
    v_cvt_pk_f16_f32 v46, v60, v61
    v_mul_f32 v62, v62, v40
    v_mfma_f32_16x16x32_bf16 v[16:19], a[0:3], v[96:99], 0
    s_mul_i32 s53, s53, s63
    v_mul_f32 v63, v63, v40
    v_cvt_pk_f16_f32 v47, v62, v63
    v_mfma_f32_16x16x32_bf16 v[16:19], a[4:7], v[92:95], v[16:19]
    s_mul_i32 s56, s56, s62
    v_mul_f32 v36, v36, v40
    v_mul_f32 v37, v37, v40
    v_mfma_f32_16x16x32_bf16 v[16:19], a[8:11], v[88:91], v[16:19]
    s_add_u32 s56, s56, s53
    v_cvt_pk_f16_f32 v146, v36, v37
    v_mul_f32 v38, v38, v40
    v_mfma_f32_16x16x32_bf16 v[16:19], a[12:15], v[80:83], v[16:19]
    s_mul_i32 s4, s15, 112
    v_mul_f32 v39, v39, v40
    v_cvt_pk_f16_f32 v147, v38, v39
    v_mfma_f32_16x16x32_bf16 v[16:19], a[16:19], v[56:59], v[16:19]
    s_cmp_ge_u32 s15, 16
    v_mul_f32 v52, v52, v41
    v_mul_f32 v53, v53, v41
    v_mfma_f32_16x16x32_bf16 v[16:19], a[20:23], v[24:27], v[16:19]
    s_cselect_b32 s53, -30464, 0
    v_cvt_pk_f16_f32 v72, v52, v53
    v_mul_f32 v54, v54, v41
    v_mfma_f32_16x16x32_bf16 v[36:39], a[24:27], v[96:99], 0
    s_add_u32 s4, s4, s53
    v_mul_f32 v55, v55, v41
    v_cvt_pk_f16_f32 v73, v54, v55
    v_mfma_f32_16x16x32_bf16 v[36:39], a[28:31], v[92:95], v[36:39]
    s_cmp_lt_u32 s15, s73
    v_mul_f32 v12, v12, v41
    v_mul_f32 v13, v13, v41
    v_mfma_f32_16x16x32_bf16 v[36:39], a[32:35], v[88:91], v[36:39]
    s_cselect_b32 s26, 100270464, 0
    v_cvt_pk_f16_f32 v74, v12, v13
    v_mul_f32 v14, v14, v41
    v_mfma_f32_16x16x32_bf16 v[36:39], a[36:39], v[80:83], v[36:39]
    s_cselect_b32 s56, s56, 0
    v_mul_f32 v15, v15, v41
    v_cvt_pk_f16_f32 v75, v14, v15
    v_mfma_f32_16x16x32_bf16 v[36:39], a[40:43], v[56:59], v[36:39]
    s_cselect_b32 s4, s4, -1
    v_mul_f32 v48, v48, v41
    v_mul_f32 v49, v49, v41
    v_mfma_f32_16x16x32_bf16 v[36:39], a[44:47], v[24:27], v[36:39]
    s_cselect_b32 s15, s15, 0
    v_cvt_pk_f16_f32 v148, v48, v49
    v_mul_f32 v50, v50, v41
    v_mfma_f32_16x16x32_bf16 v[12:15], a[48:51], v[96:99], 0
    s_cselect_b32 s13, s13, -1
    v_mul_f32 v51, v51, v41
    v_cvt_pk_f16_f32 v149, v50, v51
    v_mfma_f32_16x16x32_bf16 v[12:15], a[52:55], v[92:95], v[12:15]
    s_bitset1_b32 s64, s15
    v_cvt_pk_bf16_f32 v22, v32, v33
    v_cvt_pk_bf16_f32 v23, v34, v35
    v_mfma_f32_16x16x32_bf16 v[12:15], a[56:59], v[88:91], v[12:15]
    s_add_u32 s65, s65, 1
    v_fma_f32 v156, v16, v16, s41
    v_fmac_f32 v156, v17, v17
    v_mfma_f32_16x16x32_bf16 v[12:15], a[60:63], v[80:83], v[12:15]
    s_cmp_ge_i32 s65, 2
    v_fmac_f32 v156, v18, v18
    v_fmac_f32 v156, v19, v19
    v_mfma_f32_16x16x32_bf16 v[12:15], a[64:67], v[56:59], v[12:15]
    s_cselect_b32 s30, 100270464, 0
    v_fmac_f32 v156, v36, v36
    v_fmac_f32 v156, v37, v37
    v_mfma_f32_16x16x32_bf16 v[12:15], a[68:71], v[24:27], v[12:15]
    s_add_u32 s67, s46, s54
    v_fmac_f32 v156, v38, v38
    v_fmac_f32 v156, v39, v39
    v_mfma_f32_16x16x32_bf16 v[64:67], a[72:75], v[96:99], 0
    s_add_u32 m0, s67, 0
    v_and_b32 v120, -8, v123
    v_mfma_f32_16x16x32_bf16 v[64:67], a[76:79], v[92:95], v[64:67]
    buffer_load_dwordx4 v128, s[24:27], s56 offen nt lds
    v_fmac_f32 v156, v12, v12
    v_mfma_f32_16x16x32_bf16 v[64:67], a[80:83], v[88:91], v[64:67]
    s_add_u32 m0, s67, 1024
    v_fmac_f32 v156, v13, v13
    v_fmac_f32 v156, v14, v14
    v_mfma_f32_16x16x32_bf16 v[64:67], a[84:87], v[80:83], v[64:67]
    buffer_load_dwordx4 v127, s[24:27], s56 offen nt lds
    v_fmac_f32 v156, v15, v15
    v_mfma_f32_16x16x32_bf16 v[64:67], a[88:91], v[56:59], v[64:67]
    s_add_u32 m0, s67, 2048
    v_mfma_f32_16x16x32_bf16 v[64:67], a[92:95], v[24:27], v[64:67]
    buffer_load_dwordx4 v126, s[24:27], s56 offen nt lds
    v_mfma_f32_16x16x32_bf16 v[32:35], a[96:99], v[96:99], 0
    s_add_u32 m0, s67, 3072
    s_nop 1
    v_mfma_f32_16x16x32_bf16 v[32:35], a[100:103], v[92:95], v[32:35]
    s_nop 0
    buffer_load_dwordx4 v125, s[24:27], s56 offen nt lds
    v_fma_f32 v121, v64, v64, s41
    v_mfma_f32_16x16x32_bf16 v[32:35], a[104:107], v[88:91], v[32:35]
    s_add_u32 m0, s67, 4096
    v_fmac_f32 v121, v65, v65
    v_fmac_f32 v121, v66, v66
    v_mfma_f32_16x16x32_bf16 v[32:35], a[108:111], v[80:83], v[32:35]
    buffer_load_dwordx4 v124, s[24:27], s56 offen nt lds
    v_fmac_f32 v121, v67, v67
    v_mfma_f32_16x16x32_bf16 v[32:35], a[112:115], v[56:59], v[32:35]
    v_mfma_f32_16x16x32_bf16 v[32:35], a[116:119], v[24:27], v[32:35]
    s_nop 1
    v_mfma_f32_16x16x32_bf16 v[40:43], a[120:123], v[96:99], 0
    s_nop 2
    v_mfma_f32_16x16x32_bf16 v[40:43], a[124:127], v[92:95], v[40:43]
    s_mov_b32 s53, s47
    v_fmac_f32 v121, v32, v32
    v_fmac_f32 v121, v33, v33
    v_mfma_f32_16x16x32_bf16 v[40:43], a[128:131], v[88:91], v[40:43]
    s_mov_b32 s47, s46
    v_fmac_f32 v121, v34, v34
    v_fmac_f32 v121, v35, v35
    v_mfma_f32_16x16x32_bf16 v[40:43], a[132:135], v[80:83], v[40:43]
    s_mov_b32 s46, s45
    v_mfma_f32_16x16x32_bf16 v[40:43], a[136:139], v[56:59], v[40:43]
    s_mov_b32 s45, s44
    v_mfma_f32_16x16x32_bf16 v[40:43], a[140:143], v[24:27], v[40:43]
    s_mov_b32 s44, s53
    s_nop 0
    v_mfma_f32_16x16x32_bf16 v[68:71], v[96:99], a[144:147], 0
    s_sub_u32 s48, s44, s46
    v_add_u32 v137, s48, v137
    v_add_u32 v136, s48, v136
    v_mfma_f32_16x16x32_bf16 v[68:71], v[92:95], a[148:151], v[68:71]
    s_sub_u32 s49, s46, s45
    v_fmac_f32 v121, v40, v40
    v_fmac_f32 v121, v41, v41
    v_mfma_f32_16x16x32_bf16 v[68:71], v[88:91], a[152:155], v[68:71]
    v_fmac_f32 v121, v42, v42
    v_fmac_f32 v121, v43, v43
    v_mfma_f32_16x16x32_bf16 v[68:71], v[80:83], a[156:159], v[68:71]
    v_cvt_pk_bf16_f32 v170, v156, v121
    v_mfma_f32_16x16x32_bf16 v[68:71], v[56:59], a[160:163], v[68:71]
    ds_read_b128 v[60:63], v132 offset:0
    v_mfma_f32_16x16x32_bf16 v[68:71], v[24:27], a[164:167], v[68:71]
    s_nop 0
    ds_read_b128 v[52:55], v132 offset:16
    s_nop 0
    v_mfma_f32_16x16x16_bf16 v[76:79], v[216:217], v[170:171], 0
    s_nop 0
    ds_read_b128 v[48:51], v132 offset:48
    s_nop 1
    v_cvt_pk_bf16_f32 v164, v68, v69
    v_mfma_f32_16x16x32_bf16 v[84:87], v[96:99], a[168:171], 0
    v_cvt_pk_bf16_f32 v165, v70, v71
    v_mfma_f32_16x16x32_bf16 v[84:87], v[92:95], a[172:175], v[84:87]
    v_rsq_f32 v76, v76
    v_mfma_f32_16x16x32_bf16 v[84:87], v[88:91], a[176:179], v[84:87]
    v_rsq_f32 v77, v77
    v_mfma_f32_16x16x32_bf16 v[84:87], v[80:83], a[180:183], v[84:87]
    v_mul_f32 v76, s55, v76
    v_mul_f32 v77, 0.5, v77
    v_mfma_f32_16x16x32_bf16 v[84:87], v[56:59], a[184:187], v[84:87]
    v_mul_f32 v64, v64, v77
    v_mul_f32 v65, v65, v77
    v_mfma_f32_16x16x32_bf16 v[84:87], v[24:27], a[188:191], v[84:87]
    v_cvt_pk_f16_f32 v64, v64, v65
    v_mul_f32 v66, v66, v77
    v_mfma_f32_16x16x32_bf16 v[68:71], v[96:99], a[192:195], 0
    s_nop 0
    v_mul_f32 v67, v67, v77
    v_cvt_pk_f16_f32 v65, v66, v67
    v_mfma_f32_16x16x32_bf16 v[68:71], v[92:95], a[196:199], v[68:71]
    s_nop 0
    v_cvt_pk_bf16_f32 v160, v84, v85
    v_cvt_pk_bf16_f32 v161, v86, v87
    v_mfma_f32_16x16x32_bf16 v[68:71], v[88:91], a[200:203], v[68:71]
    v_mul_f32 v32, v32, v77
    v_mul_f32 v33, v33, v77
    v_mfma_f32_16x16x32_bf16 v[68:71], v[80:83], a[204:207], v[68:71]
    v_cvt_pk_f16_f32 v66, v32, v33
    v_mul_f32 v34, v34, v77
    v_mfma_f32_16x16x32_bf16 v[68:71], v[56:59], a[208:211], v[68:71]
    v_mul_f32 v35, v35, v77
    v_cvt_pk_f16_f32 v67, v34, v35
    v_mfma_f32_16x16x32_bf16 v[68:71], v[24:27], a[212:215], v[68:71]
    v_mul_f32 v40, v40, v77
    v_mul_f32 v41, v41, v77
    v_mfma_f32_16x16x32_f16 v[32:35], v[28:31], v[4:7], v[204:207]
    ds_read_u16 v166, v131 offset:80
    v_cvt_pk_f16_f32 v142, v40, v41
    v_mfma_f32_16x16x32_f16 v[32:35], v[152:155], v[150:153], v[32:35]
    ds_read_u16 v162, v131 offset:96
    v_mul_f32 v42, v42, v77
    v_mfma_f32_16x16x32_f16 v[24:27], v[72:75], v[4:7], v[200:203]
    ds_read_u16 v158, v131 offset:104
    v_mul_f32 v43, v43, v77
    v_mfma_f32_16x16x32_f16 v[24:27], v[146:149], v[150:153], v[24:27]
    s_waitcnt lgkmcnt(3)
    ds_read_b32 v120, v120 offset:64
    v_cvt_pk_f16_f32 v143, v42, v43
    v_mfma_f32_16x16x32_f16 v[56:59], v[60:63], v[4:7], v[208:211]
    v_mul_f32 v16, v16, v76
    v_mul_f32 v17, v17, v76
    v_mfma_f32_16x16x32_f16 v[56:59], v[52:55], v[28:31], v[56:59]
    v_cvt_pk_f16_f32 v16, v16, v17
    v_mul_f32 v18, v18, v76
    v_mfma_f32_16x16x32_f16 v[56:59], v[48:51], v[152:155], v[56:59]
    v_mul_f32 v19, v19, v76
    v_cvt_pk_f16_f32 v17, v18, v19
    v_mfma_f32_16x16x32_f16 v[40:43], v[60:63], v[44:47], v[208:211]
    v_mul_f32 v36, v36, v76
    v_mul_f32 v37, v37, v76
    v_mfma_f32_16x16x32_f16 v[40:43], v[52:55], v[72:75], v[40:43]
    v_cvt_pk_f16_f32 v18, v36, v37
    v_mul_f32 v38, v38, v76
    v_mfma_f32_16x16x32_f16 v[40:43], v[48:51], v[146:149], v[40:43]
    v_mul_f32 v39, v39, v76
    v_cvt_pk_f16_f32 v19, v38, v39
    v_mfma_f32_16x16x32_f16 v[36:39], v[28:31], v[44:47], v[192:195]
    v_mul_f32 v12, v12, v76
    v_mul_f32 v13, v13, v76
    v_mfma_f32_16x16x32_f16 v[36:39], v[152:155], v[144:147], v[36:39]
    v_cvt_pk_f16_f32 v140, v12, v13
    v_mul_f32 v14, v14, v76
    v_mul_f32 v15, v15, v76
    v_cvt_pk_f16_f32 v141, v14, v15
    v_mfma_f32_16x16x32_f16 v[12:15], v[64:67], v[4:7], v[196:199]
    v_cvt_pk_bf16_f32 v156, v68, v69
    v_cvt_pk_bf16_f32 v157, v70, v71
    v_mfma_f32_16x16x32_f16 v[12:15], v[140:143], v[150:153], v[12:15]
    v_max3_f32 v121, v32, v33, v34
    v_max3_f32 v121, v121, v35, v24
    v_mfma_f32_16x16x32_f16 v[4:7], v[60:63], v[16:19], v[208:211]
    s_nop 0
    v_max3_f32 v121, v121, v25, v26
    v_mov_b32_dpp v59, v43 quad_perm:[0,1,2,3] row_mask:0x2 bank_mask:0xf
    v_mfma_f32_16x16x32_f16 v[4:7], v[52:55], v[64:67], v[4:7]
    s_nop 0
    v_max3_f32 v121, v121, v27, v12
    v_max3_f32 v121, v121, v13, v14
    v_mfma_f32_16x16x32_f16 v[4:7], v[48:51], v[140:143], v[4:7]
    v_max3_f32 v121, v121, v15, v56
    v_mov_b32 v57, v121
    v_mfma_f32_16x16x32_f16 v[52:55], v[72:75], v[44:47], v[188:191]
    s_nop 0
    v_permlane32_swap_b32 v57, v121
    v_mfma_f32_16x16x32_f16 v[52:55], v[146:149], v[144:147], v[52:55]
    v_max_f32 v121, v57, v121
    v_mov_b32 v57, v121
    v_mfma_f32_16x16x32_f16 v[48:51], v[64:67], v[44:47], v[184:187]
    s_nop 0
    v_permlane16_swap_b32 v57, v121
    v_mfma_f32_16x16x32_f16 v[48:51], v[140:143], v[144:147], v[48:51]
    v_max_f32 v121, v57, v121
    v_sub_f32 v32, v32, v121
    v_sub_f32 v33, v33, v121
    v_sub_f32 v34, v34, v121
    v_sub_f32 v35, v35, v121
    v_sub_f32 v24, v24, v121
    v_sub_f32 v25, v25, v121
    v_sub_f32 v26, v26, v121
    v_sub_f32 v27, v27, v121
    v_sub_f32 v12, v12, v121
    v_sub_f32 v13, v13, v121
    v_sub_f32 v14, v14, v121
    v_sub_f32 v15, v15, v121
    v_sub_f32 v56, v56, v121
    v_exp_f32 v32, v32
    v_exp_f32 v33, v33
    v_exp_f32 v34, v34
    v_exp_f32 v35, v35
    v_cvt_pk_bf16_f32 v60, v32, v33
    v_cvt_pk_bf16_f32 v61, v34, v35
    v_exp_f32 v24, v24
    v_exp_f32 v25, v25
    v_exp_f32 v26, v26
    v_exp_f32 v27, v27
    v_cvt_pk_bf16_f32 v62, v24, v25
    v_cvt_pk_bf16_f32 v63, v26, v27
    v_exp_f32 v12, v12
    v_exp_f32 v13, v13
    v_exp_f32 v14, v14
    v_exp_f32 v15, v15
    v_cvt_pk_bf16_f32 v168, v12, v13
    v_cvt_pk_bf16_f32 v169, v14, v15
    v_exp_f32 v56, v56
    v_mov_b32_dpp v59, v7 quad_perm:[0,1,2,3] row_mask:0x4 bank_mask:0xf
    v_cvt_pk_bf16_f32 v170, v56, 0
    v_mfma_f32_16x16x32_bf16 v[44:47], v[220:223], v[60:63], 0
    s_waitcnt lgkmcnt(0)
    v_and_b32 v121, 0xffff0000, v120
    v_lshlrev_b32 v120, 16, v120
    v_mfma_f32_16x16x32_bf16 v[44:47], v[220:223], v[168:171], v[44:47]
    v_add_f32 v120, v120, v121
    v_add_f32 v120, v120, v211
    v_mfma_f32_16x16x32_bf16 v[12:15], v[0:3], v[60:63], 0
    s_nop 0
    v_mov_b32_dpp v59, v120 quad_perm:[0,1,2,3] row_mask:0x8 bank_mask:0xf
    v_mov_b32 v4, v59
    v_mfma_f32_16x16x32_bf16 v[12:15], v[164:167], v[168:171], v[12:15]
    s_nop 0
    v_max_f32_dpp v4, v4, v4 row_ror:8 row_mask:0xf bank_mask:0xf
    v_max3_f32 v121, v36, v37, v38
    v_mfma_f32_16x16x32_bf16 v[24:27], v[8:11], v[60:63], 0
    v_max_f32_dpp v4, v4, v4 row_ror:4 row_mask:0xf bank_mask:0xf
    v_max3_f32 v121, v121, v39, v52
    v_mfma_f32_16x16x32_bf16 v[24:27], v[160:163], v[168:171], v[24:27]
    v_max_f32_dpp v4, v4, v4 row_ror:2 row_mask:0xf bank_mask:0xf
    v_max3_f32 v121, v121, v53, v54
    v_mfma_f32_16x16x32_bf16 v[32:35], v[20:23], v[60:63], 0
    v_max_f32_dpp v4, v4, v4 row_ror:1 row_mask:0xf bank_mask:0xf
    v_mov_b32 v120, v4
    v_mfma_f32_16x16x32_bf16 v[32:35], v[156:159], v[168:171], v[32:35]
    s_nop 0
    v_permlane32_swap_b32 v120, v4
    v_max_f32 v4, v120, v4
    v_mov_b32 v120, v4
    v_rcp_f32 v44, v44
    v_max3_f32 v121, v121, v55, v48
    v_permlane16_swap_b32 v120, v4
    v_max_f32 v4, v120, v4
    v_sub_f32 v59, v59, v4
    v_exp_f32 v59, v59
    v_mul_f32 v12, v12, v44
    v_cvt_pk_bf16_f32 v59, v59, v59
    ds_write_b16 v123, v59 offset:64
    v_mul_f32 v13, v13, v44
    v_cvt_pk_bf16_f32 v68, v12, v13
    ds_read_b128 v[60:63], v132 offset:48
    v_mul_f32 v14, v14, v44
    v_mul_f32 v15, v15, v44
    v_cvt_pk_bf16_f32 v69, v14, v15
    ds_read_b128 v[56:59], v132 offset:64
    v_mfma_f32_16x16x32_f16 v[12:15], v[28:31], v[16:19], v[180:183]
    v_mul_f32 v24, v24, v44
    v_mul_f32 v25, v25, v44
    v_mfma_f32_16x16x32_f16 v[12:15], v[152:155], v[138:141], v[12:15]
    ds_write_b64 v135, v[68:69] offset:0
    v_mfma_f32_16x16x32_f16 v[28:31], v[72:75], v[16:19], v[176:179]
    v_cvt_pk_bf16_f32 v70, v24, v25
    v_mul_f32 v26, v26, v44
    v_mfma_f32_16x16x32_f16 v[28:31], v[146:149], v[138:141], v[28:31]
    v_mul_f32 v27, v27, v44
    v_cvt_pk_bf16_f32 v71, v26, v27
    v_mfma_f32_16x16x32_f16 v[24:27], v[64:67], v[16:19], v[172:175]
    ds_write_b64 v135, v[70:71] offset:8
    v_mfma_f32_16x16x32_f16 v[24:27], v[140:143], v[138:141], v[24:27]
    s_waitcnt lgkmcnt(3)
    v_mul_f32 v32, v32, v44
    v_mul_f32 v33, v33, v44
    v_cvt_pk_bf16_f32 v146, v32, v33
    v_mul_f32 v34, v34, v44
    v_mfma_f32_16x16x32_bf16 v[16:19], v[60:63], v[0:3], 0
    s_waitcnt lgkmcnt(2)
    v_mul_f32 v35, v35, v44
    v_cvt_pk_bf16_f32 v147, v34, v35
    v_max3_f32 v121, v121, v49, v50
    v_max3_f32 v121, v121, v51, v41
    v_mfma_f32_16x16x32_bf16 v[16:19], v[56:59], v[164:167], v[16:19]
    ds_write_b64 v134, v[146:147] offset:0
    v_mfma_f32_16x16x32_bf16 v[44:47], v[60:63], v[8:11], 0
    v_mov_b32 v146, v121
    v_max3_f32 v120, v12, v13, v14
    v_mfma_f32_16x16x32_bf16 v[44:47], v[56:59], v[160:163], v[44:47]
    v_permlane32_swap_b32 v146, v121
    v_mfma_f32_16x16x32_bf16 v[32:35], v[60:63], v[20:23], 0
    v_max_f32 v121, v146, v121
    v_mov_b32 v146, v121
    v_mfma_f32_16x16x32_bf16 v[32:35], v[56:59], v[156:159], v[32:35]
    s_nop 0
    v_permlane16_swap_b32 v146, v121
    v_max_f32 v121, v146, v121
    v_sub_f32 v36, v36, v121
    v_sub_f32 v37, v37, v121
    v_sub_f32 v38, v38, v121
    v_sub_f32 v39, v39, v121
    v_sub_f32 v52, v52, v121
    v_sub_f32 v53, v53, v121
    v_sub_f32 v54, v54, v121
    v_sub_f32 v55, v55, v121
    v_sub_f32 v48, v48, v121
    v_sub_f32 v49, v49, v121
    v_sub_f32 v50, v50, v121
    v_sub_f32 v51, v51, v121
    v_sub_f32 v41, v41, v121
    v_exp_f32 v36, v36
    v_exp_f32 v37, v37
    v_exp_f32 v38, v38
    v_exp_f32 v39, v39
    v_cvt_pk_bf16_f32 v36, v36, v37
    v_cvt_pk_bf16_f32 v37, v38, v39
    v_exp_f32 v52, v52
    v_exp_f32 v53, v53
    v_exp_f32 v54, v54
    v_exp_f32 v55, v55
    v_cvt_pk_bf16_f32 v38, v52, v53
    v_cvt_pk_bf16_f32 v39, v54, v55
    v_exp_f32 v48, v48
    v_exp_f32 v49, v49
    v_exp_f32 v50, v50
    v_exp_f32 v51, v51
    v_cvt_pk_bf16_f32 v168, v48, v49
    v_cvt_pk_bf16_f32 v169, v50, v51
    v_exp_f32 v41, v41
    v_mov_b32_dpp v19, v47 quad_perm:[0,1,2,3] row_mask:0x2 bank_mask:0xf
    v_cvt_pk_bf16_f32 v170, v41, 0
    v_mfma_f32_16x16x32_bf16 v[44:47], v[220:223], v[36:39], 0
    v_mov_b32_dpp v19, v35 quad_perm:[0,1,2,3] row_mask:0x4 bank_mask:0xf
    v_cvt_pk_bf16_f32 v19, v19, v19
    v_mfma_f32_16x16x32_bf16 v[44:47], v[220:223], v[168:171], v[44:47]
    ds_write_b16 v131, v19
    v_mfma_f32_16x16x32_bf16 v[32:35], v[0:3], v[36:39], 0
    ds_read_b128 v[16:19], v137 offset:0
    v_max3_f32 v120, v120, v15, v28
    v_mfma_f32_16x16x32_bf16 v[32:35], v[164:167], v[168:171], v[32:35]
    ds_read_b128 v[146:149], v136 offset:0
    v_max3_f32 v120, v120, v29, v30
    v_mfma_f32_16x16x32_bf16 v[48:51], v[8:11], v[36:39], 0
    ds_read_b128 v[72:75], v137 offset:128
    v_max3_f32 v120, v120, v31, v24
    v_mfma_f32_16x16x32_bf16 v[48:51], v[160:163], v[168:171], v[48:51]
    ds_read_b128 v[88:91], v136 offset:128
    v_max3_f32 v120, v120, v25, v26
    v_mfma_f32_16x16x32_bf16 v[40:43], v[20:23], v[36:39], 0
    ds_read_b128 v[76:79], v137 offset:256
    v_max3_f32 v120, v120, v27, v6
    v_mfma_f32_16x16x32_bf16 v[40:43], v[156:159], v[168:171], v[40:43]
    ds_read_b128 v[56:59], v136 offset:256
    v_mov_b32 v121, v120
    v_rcp_f32 v44, v44
    s_nop 0
    v_mul_f32 v32, v32, v44
    v_mul_f32 v33, v33, v44
    v_cvt_pk_bf16_f32 v32, v32, v33
    v_mul_f32 v34, v34, v44
    v_mul_f32 v35, v35, v44
    v_cvt_pk_bf16_f32 v33, v34, v35
    v_mul_f32 v48, v48, v44
    v_mul_f32 v49, v49, v44
    v_cvt_pk_bf16_f32 v34, v48, v49
    v_mul_f32 v50, v50, v44
    s_waitcnt lgkmcnt(5)
    v_mfma_f32_16x16x32_bf16 v[36:39], a[0:3], v[16:19], 0
    ds_write_b64 v135, v[32:33] offset:1536
    v_mul_f32 v51, v51, v44
    v_cvt_pk_bf16_f32 v35, v50, v51
    v_mul_f32 v40, v40, v44
    v_mul_f32 v41, v41, v44
    v_cvt_pk_bf16_f32 v4, v40, v41
    v_mul_f32 v42, v42, v44
    v_mul_f32 v43, v43, v44
    v_cvt_pk_bf16_f32 v5, v42, v43
    ds_write_b64 v135, v[34:35] offset:1544
    v_permlane32_swap_b32 v121, v120
    v_max_f32 v120, v121, v120
    v_mov_b32 v121, v120
    s_nop 0
    ds_write_b64 v134, v[4:5] offset:1536
    v_permlane16_swap_b32 v121, v120
    v_max_f32 v120, v121, v120
    v_sub_f32 v12, v12, v120
    v_sub_f32 v13, v13, v120
    v_sub_f32 v14, v14, v120
    v_sub_f32 v15, v15, v120
    v_sub_f32 v28, v28, v120
    v_sub_f32 v29, v29, v120
    v_sub_f32 v30, v30, v120
    v_sub_f32 v31, v31, v120
    v_sub_f32 v24, v24, v120
    v_sub_f32 v25, v25, v120
    v_sub_f32 v26, v26, v120
    v_sub_f32 v27, v27, v120
    v_sub_f32 v6, v6, v120
    v_exp_f32 v12, v12
    v_exp_f32 v13, v13
    v_exp_f32 v14, v14
    v_exp_f32 v15, v15
    v_cvt_pk_bf16_f32 v12, v12, v13
    v_cvt_pk_bf16_f32 v13, v14, v15
    v_exp_f32 v28, v28
    v_exp_f32 v29, v29
    v_exp_f32 v30, v30
    v_exp_f32 v31, v31
    v_cvt_pk_bf16_f32 v14, v28, v29
    v_cvt_pk_bf16_f32 v15, v30, v31
    v_exp_f32 v24, v24
    v_exp_f32 v25, v25
    v_exp_f32 v26, v26
    v_exp_f32 v27, v27
    v_cvt_pk_bf16_f32 v168, v24, v25
    v_cvt_pk_bf16_f32 v169, v26, v27
    v_exp_f32 v6, v6
    s_nop 0
    v_cvt_pk_bf16_f32 v170, v6, 0
    v_mfma_f32_16x16x32_bf16 v[152:155], v[220:223], v[12:15], 0
    s_nop 0
    v_mfma_f32_16x16x32_bf16 v[152:155], v[220:223], v[168:171], v[152:155]
    s_nop 1
    v_mfma_f32_16x16x32_bf16 v[4:7], v[0:3], v[12:15], 0
    s_nop 2
    v_mfma_f32_16x16x32_bf16 v[4:7], v[164:167], v[168:171], v[4:7]
    s_nop 0
    v_rcp_f32 v152, v152
    v_mfma_f32_16x16x32_bf16 v[0:3], v[8:11], v[12:15], 0
    s_nop 2
    v_mfma_f32_16x16x32_bf16 v[0:3], v[160:163], v[168:171], v[0:3]
    s_nop 0
    v_mul_f32 v4, v4, v152
    v_mul_f32 v5, v5, v152
    v_mfma_f32_16x16x32_bf16 v[8:11], v[20:23], v[12:15], 0
    v_cvt_pk_bf16_f32 v12, v4, v5
    v_mul_f32 v6, v6, v152
    v_mfma_f32_16x16x32_bf16 v[8:11], v[156:159], v[168:171], v[8:11]
    v_mul_f32 v7, v7, v152
    v_cvt_pk_bf16_f32 v13, v6, v7
    s_waitcnt lgkmcnt(0)
.p2align 6
L_loopS0:
    v_mfma_f32_16x16x32_bf16 v[36:39], a[4:7], v[146:149], v[36:39]
    ds_write_b64 v135, v[12:13] offset:3072
    v_mfma_f32_16x16x32_bf16 v[36:39], a[8:11], v[72:75], v[36:39]
    v_mul_f32 v0, v0, v152
    v_mul_f32 v1, v1, v152
    v_mfma_f32_16x16x32_bf16 v[36:39], a[12:15], v[88:91], v[36:39]
    v_cvt_pk_bf16_f32 v14, v0, v1
    v_mul_f32 v2, v2, v152
    v_mfma_f32_16x16x32_bf16 v[36:39], a[16:19], v[76:79], v[36:39]
    v_mul_f32 v3, v3, v152
    v_cvt_pk_bf16_f32 v15, v2, v3
    v_mfma_f32_16x16x32_bf16 v[36:39], a[20:23], v[56:59], v[36:39]
    ds_write_b64 v135, v[14:15] offset:3080
    v_mfma_f32_16x16x32_bf16 v[12:15], a[24:27], v[16:19], 0
    v_mul_f32 v8, v8, v152
    v_mul_f32 v9, v9, v152
    v_mfma_f32_16x16x32_bf16 v[12:15], a[28:31], v[146:149], v[12:15]
    v_cvt_pk_bf16_f32 v8, v8, v9
    v_mul_f32 v10, v10, v152
    v_mfma_f32_16x16x32_bf16 v[12:15], a[32:35], v[72:75], v[12:15]
    v_mul_f32 v11, v11, v152
    v_cvt_pk_bf16_f32 v9, v10, v11
    v_mfma_f32_16x16x32_bf16 v[12:15], a[36:39], v[88:91], v[12:15]
    ds_write_b64 v134, v[8:9] offset:3072
    v_mfma_f32_16x16x32_bf16 v[12:15], a[40:43], v[76:79], v[12:15]
    v_fma_f32 v170, v40, v40, s42
    v_fmac_f32 v170, v41, v41
    v_mfma_f32_16x16x32_bf16 v[12:15], a[44:47], v[56:59], v[12:15]
    v_fmac_f32 v170, v42, v42
    v_fmac_f32 v170, v43, v43
    v_mfma_f32_16x16x32_bf16 v[152:155], a[48:51], v[16:19], 0
    v_fmac_f32 v170, v140, v140
    v_fmac_f32 v170, v141, v141
    v_mfma_f32_16x16x32_bf16 v[152:155], a[52:55], v[146:149], v[152:155]
    v_fmac_f32 v170, v142, v142
    v_fmac_f32 v170, v143, v143
    v_mfma_f32_16x16x32_bf16 v[152:155], a[56:59], v[72:75], v[152:155]
    s_waitcnt vmcnt(10)
    v_fmac_f32 v170, v44, v44
    v_fmac_f32 v170, v45, v45
    v_mfma_f32_16x16x32_bf16 v[152:155], a[60:63], v[88:91], v[152:155]
    v_fmac_f32 v170, v46, v46
    v_fmac_f32 v170, v47, v47
    v_mfma_f32_16x16x32_bf16 v[152:155], a[64:67], v[76:79], v[152:155]
    v_cvt_pk_bf16_f32 v0, v92, v93
    v_cvt_pk_bf16_f32 v1, v170, v122
    v_mfma_f32_16x16x32_bf16 v[152:155], a[68:71], v[56:59], v[152:155]
    ds_write_b64 v130, v[0:1]
    v_mfma_f32_16x16x32_bf16 v[60:63], a[72:75], v[16:19], 0
    v_add_u32 v135, s49, v135
    v_add_u32 v134, s49, v134
    v_mfma_f32_16x16x32_bf16 v[60:63], a[76:79], v[146:149], v[60:63]
    v_fma_f32 v170, v36, v36, s41
    v_fmac_f32 v170, v37, v37
    v_mfma_f32_16x16x32_bf16 v[60:63], a[80:83], v[72:75], v[60:63]
    v_fmac_f32 v170, v38, v38
    v_fmac_f32 v170, v39, v39
    v_mfma_f32_16x16x32_bf16 v[60:63], a[84:87], v[88:91], v[60:63]
    v_fmac_f32 v170, v12, v12
    v_fmac_f32 v170, v13, v13
    v_mfma_f32_16x16x32_bf16 v[60:63], a[88:91], v[76:79], v[60:63]
    v_fmac_f32 v170, v14, v14
    v_fmac_f32 v170, v15, v15
    v_mfma_f32_16x16x32_bf16 v[60:63], a[92:95], v[56:59], v[60:63]
    v_fmac_f32 v170, v152, v152
    v_fmac_f32 v170, v153, v153
    v_mfma_f32_16x16x32_bf16 v[92:95], a[96:99], v[16:19], 0
    v_fmac_f32 v170, v154, v154
    v_fmac_f32 v170, v155, v155
    v_mfma_f32_16x16x32_bf16 v[92:95], a[100:103], v[146:149], v[92:95]
    s_waitcnt lgkmcnt(0)
    s_nop 0
    v_fma_f32 v0, v60, v60, s41
    v_fmac_f32 v0, v61, v61
    v_mfma_f32_16x16x32_bf16 v[92:95], a[104:107], v[72:75], v[92:95]
    s_barrier
    ds_read_b128 v[8:11], v129 offset:0
    v_fmac_f32 v0, v62, v62
    v_mfma_f32_16x16x32_bf16 v[92:95], a[108:111], v[88:91], v[92:95]
    ds_read_b128 v[64:67], v129 offset:1024
    v_fmac_f32 v0, v63, v63
    v_mfma_f32_16x16x32_bf16 v[92:95], a[112:115], v[76:79], v[92:95]
    v_mfma_f32_16x16x32_bf16 v[92:95], a[116:119], v[56:59], v[92:95]
    s_nop 1
    v_mfma_f32_16x16x32_bf16 v[80:83], a[120:123], v[16:19], 0
    s_nop 2
    v_mfma_f32_16x16x32_bf16 v[80:83], a[124:127], v[146:149], v[80:83]
    s_nop 0
    v_fmac_f32 v0, v92, v92
    v_fmac_f32 v0, v93, v93
    v_mfma_f32_16x16x32_bf16 v[80:83], a[128:131], v[72:75], v[80:83]
    v_fmac_f32 v0, v94, v94
    v_fmac_f32 v0, v95, v95
    v_mfma_f32_16x16x32_bf16 v[80:83], a[132:135], v[88:91], v[80:83]
    v_mfma_f32_16x16x32_bf16 v[80:83], a[136:139], v[76:79], v[80:83]
    v_mfma_f32_16x16x32_bf16 v[80:83], a[140:143], v[56:59], v[80:83]
    s_waitcnt lgkmcnt(1)
    v_readfirstlane_b32 s12, v9
    v_mfma_f32_16x16x32_bf16 v[84:87], v[216:219], v[8:11], 0
    s_waitcnt lgkmcnt(0)
    s_nop 1
    v_mfma_f32_16x16x32_bf16 v[84:87], v[216:219], v[64:67], v[84:87]
    s_lshr_b32 s12, s12, 23
    v_fmac_f32 v0, v80, v80
    v_fmac_f32 v0, v81, v81
    v_mfma_f32_16x16x32_bf16 v[8:11], v[16:19], a[144:147], 0
    v_fmac_f32 v0, v82, v82
    v_fmac_f32 v0, v83, v83
    v_mfma_f32_16x16x32_bf16 v[8:11], v[146:149], a[148:151], v[8:11]
    s_nop 0
    v_rsq_f32 v84, v84
    v_mfma_f32_16x16x32_bf16 v[8:11], v[72:75], a[152:155], v[8:11]
    v_rsq_f32 v85, v85
    v_mfma_f32_16x16x32_bf16 v[8:11], v[88:91], a[156:159], v[8:11]
    v_rsq_f32 v86, v86
    v_mfma_f32_16x16x32_bf16 v[8:11], v[76:79], a[160:163], v[8:11]
    ds_read_b128 v[64:67], v137 offset:1536
    v_mul_f32 v84, s43, v84
    v_mfma_f32_16x16x32_bf16 v[8:11], v[56:59], a[164:167], v[8:11]
    ds_read_b128 v[68:71], v136 offset:1536
    v_mul_f32 v85, s43, v85
    v_mfma_f32_16x16x32_bf16 v[48:51], v[16:19], a[168:171], 0
    ds_read_b128 v[52:55], v137 offset:1664
    v_mul_f32 v86, s43, v86
    v_mfma_f32_16x16x32_bf16 v[48:51], v[146:149], a[172:175], v[48:51]
    ds_read_b128 v[96:99], v136 offset:1664
    v_cvt_pk_bf16_f32 v170, v170, v0
    v_mfma_f32_16x16x32_bf16 v[48:51], v[72:75], a[176:179], v[48:51]
    ds_read_b128 v[108:111], v137 offset:1792
    v_cvt_pk_bf16_f32 v0, v8, v9
    v_mfma_f32_16x16x32_bf16 v[48:51], v[88:91], a[180:183], v[48:51]
    ds_read_b128 v[104:107], v136 offset:1792
    v_cvt_pk_bf16_f32 v1, v10, v11
    v_mfma_f32_16x16x32_bf16 v[48:51], v[76:79], a[184:187], v[48:51]
    v_mul_f32 v32, v32, v84
    v_mul_f32 v33, v33, v84
    v_mfma_f32_16x16x32_bf16 v[48:51], v[56:59], a[188:191], v[48:51]
    s_nop 0
    v_cvt_pk_bf16_f32 v2, v32, v33
    v_mul_f32 v34, v34, v84
    v_mfma_f32_16x16x16_bf16 v[118:121], v[216:217], v[170:171], 0
    s_nop 0
    v_mul_f32 v35, v35, v84
    v_cvt_pk_bf16_f32 v3, v34, v35
    v_mul_f32 v4, v4, v84
    v_cvt_pk_bf16_f32 v8, v48, v49
    v_mfma_f32_16x16x32_bf16 v[32:35], v[16:19], a[192:195], 0
    ds_write_b64 v135, v[2:3] offset:0
    v_mfma_f32_16x16x32_bf16 v[32:35], v[146:149], a[196:199], v[32:35]
    v_rsq_f32 v118, v118
    v_mfma_f32_16x16x32_bf16 v[32:35], v[72:75], a[200:203], v[32:35]
    v_rsq_f32 v119, v119
    v_mfma_f32_16x16x32_bf16 v[32:35], v[88:91], a[204:207], v[32:35]
    v_mul_f32 v118, s55, v118
    v_mul_f32 v119, 0.5, v119
    v_mfma_f32_16x16x32_bf16 v[32:35], v[76:79], a[208:211], v[32:35]
    v_cvt_pk_bf16_f32 v9, v50, v51
    v_mul_f32 v36, v36, v118
    v_mfma_f32_16x16x32_bf16 v[32:35], v[56:59], a[212:215], v[32:35]
    s_waitcnt lgkmcnt(1)
    v_mul_f32 v37, v37, v118
    v_cvt_pk_f16_f32 v76, v36, v37
    v_mfma_f32_16x16x32_bf16 v[146:149], a[0:3], v[64:67], 0
    v_mul_f32 v38, v38, v118
    v_mul_f32 v39, v39, v118
    v_mfma_f32_16x16x32_bf16 v[146:149], a[4:7], v[68:71], v[146:149]
    v_cvt_pk_f16_f32 v77, v38, v39
    v_mul_f32 v12, v12, v118
    v_mfma_f32_16x16x32_bf16 v[146:149], a[8:11], v[52:55], v[146:149]
    v_mul_f32 v13, v13, v118
    v_cvt_pk_f16_f32 v78, v12, v13
    v_mfma_f32_16x16x32_bf16 v[146:149], a[12:15], v[96:99], v[146:149]
    v_mul_f32 v14, v14, v118
    v_mul_f32 v15, v15, v118
    v_mfma_f32_16x16x32_bf16 v[146:149], a[16:19], v[108:111], v[146:149]
    v_cvt_pk_f16_f32 v79, v14, v15
    v_mul_f32 v152, v152, v118
    v_mfma_f32_16x16x32_bf16 v[146:149], a[20:23], v[104:107], v[146:149]
    v_mul_f32 v153, v153, v118
    v_cvt_pk_f16_f32 v152, v152, v153
    v_mfma_f32_16x16x32_bf16 v[36:39], a[24:27], v[64:67], 0
    v_mul_f32 v154, v154, v118
    v_mul_f32 v155, v155, v118
    v_mfma_f32_16x16x32_bf16 v[36:39], a[28:31], v[68:71], v[36:39]
    v_cvt_pk_f16_f32 v153, v154, v155
    v_mul_f32 v60, v60, v119
    v_mfma_f32_16x16x32_bf16 v[36:39], a[32:35], v[52:55], v[36:39]
    v_mul_f32 v61, v61, v119
    v_cvt_pk_f16_f32 v16, v60, v61
    v_mfma_f32_16x16x32_bf16 v[36:39], a[36:39], v[96:99], v[36:39]
    v_mul_f32 v62, v62, v119
    v_mul_f32 v63, v63, v119
    v_mfma_f32_16x16x32_bf16 v[36:39], a[40:43], v[108:111], v[36:39]
    v_cvt_pk_f16_f32 v17, v62, v63
    v_mul_f32 v92, v92, v119
    v_mfma_f32_16x16x32_bf16 v[36:39], a[44:47], v[104:107], v[36:39]
    v_mul_f32 v93, v93, v119
    v_cvt_pk_f16_f32 v18, v92, v93
    v_mfma_f32_16x16x32_bf16 v[72:75], a[48:51], v[64:67], 0
    v_mul_f32 v94, v94, v119
    v_mul_f32 v95, v95, v119
    v_mfma_f32_16x16x32_bf16 v[72:75], a[52:55], v[68:71], v[72:75]
    v_cvt_pk_f16_f32 v19, v94, v95
    v_mul_f32 v80, v80, v119
    v_mfma_f32_16x16x32_bf16 v[72:75], a[56:59], v[52:55], v[72:75]
    v_mul_f32 v81, v81, v119
    v_cvt_pk_f16_f32 v154, v80, v81
    v_mfma_f32_16x16x32_bf16 v[72:75], a[60:63], v[96:99], v[72:75]
    v_mul_f32 v82, v82, v119
    v_mul_f32 v83, v83, v119
    v_mfma_f32_16x16x32_bf16 v[72:75], a[64:67], v[108:111], v[72:75]
    v_cvt_pk_f16_f32 v155, v82, v83
    v_cvt_pk_bf16_f32 v12, v32, v33
    v_mfma_f32_16x16x32_bf16 v[72:75], a[68:71], v[104:107], v[72:75]
    v_cvt_pk_bf16_f32 v13, v34, v35
    v_mul_f32 v5, v5, v84
    v_mfma_f32_16x16x32_bf16 v[32:35], a[72:75], v[64:67], 0
    v_cvt_pk_bf16_f32 v4, v4, v5
    v_mul_f32 v6, v6, v84
    v_mfma_f32_16x16x32_bf16 v[32:35], a[76:79], v[68:71], v[32:35]
    v_mul_f32 v7, v7, v84
    v_cvt_pk_bf16_f32 v5, v6, v7
    v_mfma_f32_16x16x32_bf16 v[32:35], a[80:83], v[52:55], v[32:35]
    ds_write_b64 v135, v[4:5] offset:8
    v_mfma_f32_16x16x32_bf16 v[32:35], a[84:87], v[96:99], v[32:35]
    v_mul_f32 v24, v24, v84
    v_mul_f32 v25, v25, v84
    v_mfma_f32_16x16x32_bf16 v[32:35], a[88:91], v[108:111], v[32:35]
    v_cvt_pk_bf16_f32 v2, v24, v25
    v_mul_f32 v26, v26, v84
    v_mfma_f32_16x16x32_bf16 v[32:35], a[92:95], v[104:107], v[32:35]
    v_mul_f32 v27, v27, v84
    v_cvt_pk_bf16_f32 v3, v26, v27
    v_mfma_f32_16x16x32_bf16 v[4:7], a[96:99], v[64:67], 0
    ds_write_b64 v134, v[2:3] offset:0
    v_mfma_f32_16x16x32_bf16 v[4:7], a[100:103], v[68:71], v[4:7]
    v_fma_f32 v2, v146, v146, s41
    v_fmac_f32 v2, v147, v147
    v_mfma_f32_16x16x32_bf16 v[4:7], a[104:107], v[52:55], v[4:7]
    v_fmac_f32 v2, v148, v148
    v_fmac_f32 v2, v149, v149
    v_mfma_f32_16x16x32_bf16 v[4:7], a[108:111], v[96:99], v[4:7]
    v_fmac_f32 v2, v36, v36
    v_fmac_f32 v2, v37, v37
    v_mfma_f32_16x16x32_bf16 v[4:7], a[112:115], v[108:111], v[4:7]
    v_fmac_f32 v2, v38, v38
    v_fmac_f32 v2, v39, v39
    v_mfma_f32_16x16x32_bf16 v[4:7], a[116:119], v[104:107], v[4:7]
    v_fmac_f32 v2, v72, v72
    v_fmac_f32 v2, v73, v73
    v_mfma_f32_16x16x32_bf16 v[24:27], a[120:123], v[64:67], 0
    v_fmac_f32 v2, v74, v74
    v_fmac_f32 v2, v75, v75
    v_mfma_f32_16x16x32_bf16 v[24:27], a[124:127], v[68:71], v[24:27]
    v_mul_f32 v28, v28, v85
    v_mul_f32 v29, v29, v85
    v_mfma_f32_16x16x32_bf16 v[24:27], a[128:131], v[52:55], v[24:27]
    v_cvt_pk_bf16_f32 v88, v28, v29
    v_mul_f32 v30, v30, v85
    v_mfma_f32_16x16x32_bf16 v[24:27], a[132:135], v[96:99], v[24:27]
    v_mul_f32 v31, v31, v85
    v_cvt_pk_bf16_f32 v89, v30, v31
    v_mfma_f32_16x16x32_bf16 v[24:27], a[136:139], v[108:111], v[24:27]
    ds_write_b64 v135, v[88:89] offset:1536
    v_mfma_f32_16x16x32_bf16 v[24:27], a[140:143], v[104:107], v[24:27]
    v_mul_f32 v20, v20, v85
    v_mul_f32 v21, v21, v85
    v_mfma_f32_16x16x32_bf16 v[60:63], v[64:67], a[144:147], 0
    v_cvt_pk_bf16_f32 v90, v20, v21
    v_mul_f32 v22, v22, v85
    v_mfma_f32_16x16x32_bf16 v[60:63], v[68:71], a[148:151], v[60:63]
    v_mul_f32 v23, v23, v85
    v_cvt_pk_bf16_f32 v91, v22, v23
    v_mfma_f32_16x16x32_bf16 v[60:63], v[52:55], a[152:155], v[60:63]
    ds_write_b64 v135, v[90:91] offset:1544
    v_mfma_f32_16x16x32_bf16 v[60:63], v[96:99], a[156:159], v[60:63]
    v_mul_f32 v114, v114, v85
    v_mul_f32 v115, v115, v85
    v_mfma_f32_16x16x32_bf16 v[60:63], v[108:111], a[160:163], v[60:63]
    ds_read_b128 v[88:91], v137 offset:3072
    v_cvt_pk_bf16_f32 v10, v114, v115
    v_mfma_f32_16x16x32_bf16 v[60:63], v[104:107], a[164:167], v[60:63]
    ds_read_b128 v[56:59], v136 offset:3072
    v_mul_f32 v116, v116, v85
    v_mfma_f32_16x16x32_bf16 v[92:95], v[64:67], a[168:171], 0
    ds_read_b128 v[80:83], v137 offset:3200
    v_mul_f32 v117, v117, v85
    v_mfma_f32_16x16x32_bf16 v[92:95], v[68:71], a[172:175], v[92:95]
    ds_read_b128 v[28:31], v136 offset:3200
    v_cvt_pk_bf16_f32 v11, v116, v117
    v_mfma_f32_16x16x32_bf16 v[92:95], v[52:55], a[176:179], v[92:95]
    ds_write_b64 v134, v[10:11] offset:1536
    v_mfma_f32_16x16x32_bf16 v[92:95], v[96:99], a[180:183], v[92:95]
    v_fma_f32 v3, v32, v32, s41
    v_fmac_f32 v3, v33, v33
    v_mfma_f32_16x16x32_bf16 v[92:95], v[108:111], a[184:187], v[92:95]
    ds_read_b128 v[48:51], v137 offset:3328
    v_fmac_f32 v3, v34, v34
    v_mfma_f32_16x16x32_bf16 v[92:95], v[104:107], a[188:191], v[92:95]
    ds_read_b128 v[20:23], v136 offset:3328
    v_fmac_f32 v3, v35, v35
    v_mfma_f32_16x16x32_bf16 v[112:115], v[64:67], a[192:195], 0
    v_fmac_f32 v3, v4, v4
    v_fmac_f32 v3, v5, v5
    v_mfma_f32_16x16x32_bf16 v[112:115], v[68:71], a[196:199], v[112:115]
    s_sub_u32 s50, s45, s44
    v_fmac_f32 v3, v6, v6
    v_fmac_f32 v3, v7, v7
    v_mfma_f32_16x16x32_bf16 v[112:115], v[52:55], a[200:203], v[112:115]
    s_sub_u32 s51, s46, s47
    v_fmac_f32 v3, v24, v24
    v_fmac_f32 v3, v25, v25
    v_mfma_f32_16x16x32_bf16 v[112:115], v[96:99], a[204:207], v[112:115]
    s_mov_b32 s60, s59
    v_fmac_f32 v3, v26, v26
    v_fmac_f32 v3, v27, v27
    v_mfma_f32_16x16x32_bf16 v[112:115], v[108:111], a[208:211], v[112:115]
    s_mov_b32 s59, s58
    v_cvt_pk_bf16_f32 v170, v2, v3
    v_cvt_pk_bf16_f32 v2, v60, v61
    v_mfma_f32_16x16x32_bf16 v[112:115], v[104:107], a[212:215], v[112:115]
    s_mov_b32 s58, s57
    v_cvt_pk_bf16_f32 v3, v62, v63
    v_cvt_pk_bf16_f32 v10, v92, v93
    v_mfma_f32_16x16x16_bf16 v[60:63], v[216:217], v[170:171], 0
    s_waitcnt lgkmcnt(2)
    s_mov_b32 s57, s56
    v_cvt_pk_bf16_f32 v11, v94, v95
    v_mul_f32 v40, v40, v86
    v_mul_f32 v41, v41, v86
    v_cvt_pk_bf16_f32 v14, v112, v113
    v_mfma_f32_16x16x32_bf16 v[92:95], a[0:3], v[88:91], 0
    s_mov_b32 s7, s6
    v_cvt_pk_bf16_f32 v15, v114, v115
    v_cvt_pk_bf16_f32 v40, v40, v41
    v_mfma_f32_16x16x32_bf16 v[92:95], a[4:7], v[56:59], v[92:95]
    s_mov_b32 s6, s5
    v_rsq_f32 v60, v60
    v_mfma_f32_16x16x32_bf16 v[92:95], a[8:11], v[80:83], v[92:95]
    s_mov_b32 s5, s4
    v_rsq_f32 v61, v61
    v_mfma_f32_16x16x32_bf16 v[92:95], a[12:15], v[28:31], v[92:95]
    s_waitcnt lgkmcnt(0)
    s_sub_u32 s14, s6, s7
    v_mul_f32 v60, s55, v60
    v_mul_f32 v61, 0.5, v61
    v_mfma_f32_16x16x32_bf16 v[92:95], a[16:19], v[48:51], v[92:95]
    s_add_u32 s61, s61, 1
    v_mul_f32 v146, v146, v60
    v_mul_f32 v147, v147, v60
    v_mfma_f32_16x16x32_bf16 v[92:95], a[20:23], v[20:23], v[92:95]
    s_ff1_i32_b32 s15, s66
    v_cvt_pk_f16_f32 v96, v146, v147
    v_mul_f32 v148, v148, v60
    v_mfma_f32_16x16x32_bf16 v[64:67], a[24:27], v[88:91], 0
    s_cmp_lg_u32 s66, 0
    v_mul_f32 v149, v149, v60
    v_cvt_pk_f16_f32 v97, v148, v149
    v_mfma_f32_16x16x32_bf16 v[64:67], a[28:31], v[56:59], v[64:67]
    s_cselect_b32 s12, s15, s12
    v_mul_f32 v36, v36, v60
    v_mul_f32 v37, v37, v60
    v_mfma_f32_16x16x32_bf16 v[64:67], a[32:35], v[80:83], v[64:67]
    s_cmp_lt_u32 s61, s71
    v_cvt_pk_f16_f32 v98, v36, v37
    v_mul_f32 v38, v38, v60
    v_mfma_f32_16x16x32_bf16 v[64:67], a[36:39], v[28:31], v[64:67]
    s_cselect_b32 s15, 31, s15
    v_mul_f32 v39, v39, v60
    v_cvt_pk_f16_f32 v99, v38, v39
    v_mfma_f32_16x16x32_bf16 v[64:67], a[40:43], v[48:51], v[64:67]
    s_bitset0_b32 s66, s15
    v_mul_f32 v72, v72, v60
    v_mul_f32 v73, v73, v60
    v_mfma_f32_16x16x32_bf16 v[64:67], a[44:47], v[20:23], v[64:67]
    s_add_u32 s12, s12, 20
    v_cvt_pk_f16_f32 v146, v72, v73
    v_mul_f32 v74, v74, v60
    v_mfma_f32_16x16x32_bf16 v[68:71], a[48:51], v[88:91], 0
    s_max_u32 s12, s12, s61
    v_mul_f32 v75, v75, v60
    v_cvt_pk_f16_f32 v147, v74, v75
    v_mfma_f32_16x16x32_bf16 v[68:71], a[52:55], v[56:59], v[68:71]
    s_cmp_lt_u32 s61, s71
    v_mul_f32 v32, v32, v61
    v_mul_f32 v33, v33, v61
    v_mfma_f32_16x16x32_bf16 v[68:71], a[56:59], v[80:83], v[68:71]
    s_cselect_b32 s15, s61, s12
    v_cvt_pk_f16_f32 v36, v32, v33
    v_mul_f32 v34, v34, v61
    v_mfma_f32_16x16x32_bf16 v[68:71], a[60:63], v[28:31], v[68:71]
    s_cselect_b32 s56, s69, s70
    v_mul_f32 v35, v35, v61
    v_cvt_pk_f16_f32 v37, v34, v35
    v_mfma_f32_16x16x32_bf16 v[68:71], a[64:67], v[48:51], v[68:71]
    s_add_u32 s56, s56, s15
    v_mul_f32 v4, v4, v61
    v_mul_f32 v5, v5, v61
    v_mfma_f32_16x16x32_bf16 v[68:71], a[68:71], v[20:23], v[68:71]
    s_mul_i32 s53, s56, 58255
    v_cvt_pk_f16_f32 v38, v4, v5
    v_mul_f32 v6, v6, v61
    v_mfma_f32_16x16x32_bf16 v[72:75], a[72:75], v[88:91], 0
    s_lshr_b32 s53, s53, 22
    v_mul_f32 v7, v7, v61
    v_cvt_pk_f16_f32 v39, v6, v7
    v_mfma_f32_16x16x32_bf16 v[72:75], a[76:79], v[56:59], v[72:75]
    s_mul_i32 s53, s53, s63
    v_mul_f32 v24, v24, v61
    v_mul_f32 v25, v25, v61
    v_mfma_f32_16x16x32_bf16 v[72:75], a[80:83], v[80:83], v[72:75]
    s_mul_i32 s56, s56, s62
    v_cvt_pk_f16_f32 v148, v24, v25
    v_mul_f32 v26, v26, v61
    v_mfma_f32_16x16x32_bf16 v[72:75], a[84:87], v[28:31], v[72:75]
    s_add_u32 s56, s56, s53
    v_mul_f32 v27, v27, v61
    v_cvt_pk_f16_f32 v149, v26, v27
    v_mfma_f32_16x16x32_bf16 v[72:75], a[88:91], v[48:51], v[72:75]
    s_mul_i32 s4, s15, 112
    v_mul_f32 v42, v42, v86
    v_mul_f32 v43, v43, v86
    v_mfma_f32_16x16x32_bf16 v[72:75], a[92:95], v[20:23], v[72:75]
    s_cmp_ge_u32 s15, 16
    v_cvt_pk_bf16_f32 v41, v42, v43
    v_mul_f32 v140, v140, v86
    v_mfma_f32_16x16x32_bf16 v[4:7], a[96:99], v[88:91], 0
    s_cselect_b32 s53, -30464, 0
    ds_write_b64 v135, v[40:41] offset:3072
    v_mfma_f32_16x16x32_bf16 v[4:7], a[100:103], v[56:59], v[4:7]
    s_add_u32 s4, s4, s53
    v_mul_f32 v141, v141, v86
    v_cvt_pk_bf16_f32 v42, v140, v141
    v_mfma_f32_16x16x32_bf16 v[4:7], a[104:107], v[80:83], v[4:7]
    s_cmp_lt_u32 s15, s73
    v_mul_f32 v142, v142, v86
    v_mul_f32 v143, v143, v86
    v_mfma_f32_16x16x32_bf16 v[4:7], a[108:111], v[28:31], v[4:7]
    s_cselect_b32 s26, 100270464, 0
    v_cvt_pk_bf16_f32 v43, v142, v143
    v_mul_f32 v44, v44, v86
    v_mfma_f32_16x16x32_bf16 v[4:7], a[112:115], v[48:51], v[4:7]
    s_cselect_b32 s56, s56, 0
    ds_write_b64 v135, v[42:43] offset:3080
    v_mfma_f32_16x16x32_bf16 v[4:7], a[116:119], v[20:23], v[4:7]
    s_cselect_b32 s4, s4, -1
    v_mul_f32 v45, v45, v86
    v_cvt_pk_bf16_f32 v44, v44, v45
    v_mul_f32 v46, v46, v86
    v_mul_f32 v47, v47, v86
    v_cvt_pk_bf16_f32 v45, v46, v47
    s_cselect_b32 s15, s15, 0
    s_cselect_b32 s13, s13, -1
    ds_write_b64 v134, v[44:45] offset:3072
    v_fma_f32 v120, v92, v92, s41
    v_fmac_f32 v120, v93, v93
    v_fmac_f32 v120, v94, v94
    v_fmac_f32 v120, v95, v95
    v_mfma_f32_16x16x32_bf16 v[24:27], a[120:123], v[88:91], 0
    s_waitcnt vmcnt(0)
    v_fmac_f32 v120, v64, v64
    v_fmac_f32 v120, v65, v65
    v_mfma_f32_16x16x32_bf16 v[24:27], a[124:127], v[56:59], v[24:27]
    s_bitset1_b32 s64, s15
    v_fmac_f32 v120, v66, v66
    v_fmac_f32 v120, v67, v67
    v_mfma_f32_16x16x32_bf16 v[24:27], a[128:131], v[80:83], v[24:27]
    s_add_u32 s65, s65, 1
    v_fmac_f32 v120, v68, v68
    v_fmac_f32 v120, v69, v69
    v_mfma_f32_16x16x32_bf16 v[24:27], a[132:135], v[28:31], v[24:27]
    s_cmp_ge_i32 s65, 2
    v_fmac_f32 v120, v70, v70
    v_fmac_f32 v120, v71, v71
    v_mfma_f32_16x16x32_bf16 v[24:27], a[136:139], v[48:51], v[24:27]
    s_cselect_b32 s30, 100270464, 0
    v_fma_f32 v121, v72, v72, s41
    v_fmac_f32 v121, v73, v73
    v_mfma_f32_16x16x32_bf16 v[24:27], a[140:143], v[20:23], v[24:27]
    s_add_u32 s67, s46, s54
    v_fmac_f32 v121, v74, v74
    v_fmac_f32 v121, v75, v75
    v_mfma_f32_16x16x32_bf16 v[32:35], v[88:91], a[144:147], 0
    s_waitcnt lgkmcnt(0)
    s_add_u32 m0, s67, 0
    v_fmac_f32 v121, v4, v4
    v_fmac_f32 v121, v5, v5
    v_mfma_f32_16x16x32_bf16 v[32:35], v[56:59], a[148:151], v[32:35]
    s_barrier
    v_fmac_f32 v121, v6, v6
    v_fmac_f32 v121, v7, v7
    v_mfma_f32_16x16x32_bf16 v[32:35], v[80:83], a[152:155], v[32:35]
    s_cmp_ge_u32 s61, s13
    v_fmac_f32 v121, v24, v24
    v_fmac_f32 v121, v25, v25
    v_mfma_f32_16x16x32_bf16 v[32:35], v[28:31], a[156:159], v[32:35]
    s_cbranch_scc1 L_atomS0
L_atomS0r:
    v_mfma_f32_16x16x32_bf16 v[32:35], v[48:51], a[160:163], v[32:35]
    v_fmac_f32 v121, v26, v26
    v_fmac_f32 v121, v27, v27
    v_mfma_f32_16x16x32_bf16 v[32:35], v[20:23], a[164:167], v[32:35]
    v_cvt_pk_bf16_f32 v170, v120, v121
    v_add_u32 v137, s50, v137
    v_mfma_f32_16x16x32_bf16 v[40:43], v[88:91], a[168:171], 0
    ds_read_b128 v[60:63], v137 offset:0
    v_add_u32 v136, s50, v136
    v_mfma_f32_16x16x32_bf16 v[40:43], v[56:59], a[172:175], v[40:43]
    s_nop 0
    ds_read_b128 v[84:87], v136 offset:0
    v_cvt_pk_bf16_f32 v164, v32, v33
    v_mfma_f32_16x16x32_bf16 v[40:43], v[80:83], a[176:179], v[40:43]
    ds_read_b128 v[52:55], v137 offset:128
    v_cvt_pk_bf16_f32 v165, v34, v35
    v_mfma_f32_16x16x32_bf16 v[40:43], v[28:31], a[180:183], v[40:43]
    ds_read_b128 v[112:115], v136 offset:128
    v_add_u32 v135, s48, v135
    v_mfma_f32_16x16x32_bf16 v[40:43], v[48:51], a[184:187], v[40:43]
    ds_read_b128 v[108:111], v137 offset:256
    v_add_u32 v134, s48, v134
    v_mfma_f32_16x16x32_bf16 v[40:43], v[20:23], a[188:191], v[40:43]
    s_nop 0
    ds_read_b128 v[104:107], v136 offset:256
    v_add_u32 v133, s51, v133
    v_mfma_f32_16x16x16_bf16 v[118:121], v[216:217], v[170:171], 0
    s_nop 0
    v_add_u32 v132, s14, v132
    v_add_u32 v131, s14, v131
    v_add_u32 v123, s14, v123
    v_cvt_pk_bf16_f32 v160, v40, v41
    v_mfma_f32_16x16x32_bf16 v[100:103], v[88:91], a[192:195], 0
    v_cvt_pk_bf16_f32 v161, v42, v43
    v_and_b32 v116, -8, v123
    v_mfma_f32_16x16x32_bf16 v[100:103], v[56:59], a[196:199], v[100:103]
    v_rsq_f32 v118, v118
    v_mfma_f32_16x16x32_bf16 v[100:103], v[80:83], a[200:203], v[100:103]
    v_rsq_f32 v119, v119
    v_mfma_f32_16x16x32_bf16 v[100:103], v[28:31], a[204:207], v[100:103]
    ds_read_b128 v[28:31], v132 offset:0
    v_mul_f32 v118, s55, v118
    v_mfma_f32_16x16x32_bf16 v[100:103], v[48:51], a[208:211], v[100:103]
    ds_read_b128 v[48:51], v132 offset:16
    v_mul_f32 v119, 0.5, v119
    v_mfma_f32_16x16x32_bf16 v[100:103], v[20:23], a[212:215], v[100:103]
    s_waitcnt lgkmcnt(3)
    ds_read_b128 v[20:23], v132 offset:48
    v_mul_f32 v72, v72, v119
    v_mfma_f32_16x16x32_bf16 v[32:35], a[216:219], v[60:63], 0
    ds_read_b128 v[88:91], v133 offset:0
    v_mul_f32 v73, v73, v119
    v_mfma_f32_16x16x32_bf16 v[32:35], a[220:223], v[84:87], v[32:35]
    v_cvt_pk_f16_f32 v40, v72, v73
    v_mul_f32 v74, v74, v119
    v_mfma_f32_16x16x32_bf16 v[32:35], a[224:227], v[52:55], v[32:35]
    v_mul_f32 v75, v75, v119
    v_cvt_pk_f16_f32 v41, v74, v75
    v_mfma_f32_16x16x32_bf16 v[32:35], a[228:231], v[112:115], v[32:35]
    v_mul_f32 v4, v4, v119
    v_mul_f32 v5, v5, v119
    v_mfma_f32_16x16x32_bf16 v[32:35], a[232:235], v[108:111], v[32:35]
    s_waitcnt lgkmcnt(4)
    v_cvt_pk_f16_f32 v42, v4, v5
    v_mul_f32 v6, v6, v119
    v_mfma_f32_16x16x32_bf16 v[32:35], a[236:239], v[104:107], v[32:35]
    v_mul_f32 v7, v7, v119
    v_cvt_pk_f16_f32 v43, v6, v7
    v_mfma_f32_16x16x32_bf16 v[4:7], a[240:243], v[60:63], 0
    v_mul_f32 v24, v24, v119
    v_mul_f32 v25, v25, v119
    v_mfma_f32_16x16x32_bf16 v[4:7], a[244:247], v[84:87], v[4:7]
    v_cvt_pk_f16_f32 v142, v24, v25
    v_mul_f32 v26, v26, v119
    v_mfma_f32_16x16x32_bf16 v[4:7], a[248:251], v[52:55], v[4:7]
    v_mul_f32 v27, v27, v119
    v_cvt_pk_f16_f32 v143, v26, v27
    v_mfma_f32_16x16x32_bf16 v[4:7], a[252:255], v[112:115], v[4:7]
    s_waitcnt lgkmcnt(0)
    buffer_load_dwordx4 v128, s[24:27], s56 offen nt lds
    v_mul_f32 v92, v92, v118
    v_mfma_f32_16x16x32_bf16 v[4:7], v[224:227], v[108:111], v[4:7]
    v_mul_f32 v93, v93, v118
    v_cvt_pk_f16_f32 v44, v92, v93
    v_mfma_f32_16x16x32_bf16 v[4:7], v[228:231], v[104:107], v[4:7]
    v_mul_f32 v94, v94, v118
    v_mul_f32 v95, v95, v118
    v_mfma_f32_16x16x32_bf16 v[24:27], v[232:235], v[60:63], 0
    v_cvt_pk_f16_f32 v45, v94, v95
    v_mul_f32 v64, v64, v118
    v_mfma_f32_16x16x32_bf16 v[24:27], v[236:239], v[84:87], v[24:27]
    v_mul_f32 v65, v65, v118
    v_cvt_pk_f16_f32 v46, v64, v65
    v_mfma_f32_16x16x32_bf16 v[24:27], v[240:243], v[52:55], v[24:27]
    v_mul_f32 v66, v66, v118
    v_mul_f32 v67, v67, v118
    v_mfma_f32_16x16x32_bf16 v[24:27], v[244:247], v[112:115], v[24:27]
    v_cvt_pk_f16_f32 v47, v66, v67
    v_mul_f32 v68, v68, v118
    v_mfma_f32_16x16x32_bf16 v[24:27], v[248:251], v[108:111], v[24:27]
    buffer_store_dwordx4 v[88:91], v128, s[28:31], s60 offen sc1
    v_mul_f32 v69, v69, v118
    v_cvt_pk_f16_f32 v140, v68, v69
    v_mul_f32 v70, v70, v118
    v_mul_f32 v71, v71, v118
    v_mfma_f32_16x16x32_bf16 v[24:27], v[252:255], v[104:107], v[24:27]
    s_add_u32 m0, s67, 1024
    v_cvt_pk_f16_f32 v141, v70, v71
    v_cvt_pk_bf16_f32 v156, v100, v101
    v_mfma_f32_16x16x32_f16 v[112:115], v[16:19], v[76:79], v[204:207]
    ds_read_u16 v166, v131 offset:80
    v_cvt_pk_bf16_f32 v157, v102, v103
    v_mfma_f32_16x16x32_f16 v[112:115], v[152:155], v[150:153], v[112:115]
    ds_read_u16 v162, v131 offset:96
    v_mfma_f32_16x16x32_f16 v[108:111], v[36:39], v[76:79], v[200:203]
    s_nop 0
    ds_read_u16 v158, v131 offset:104
    s_nop 0
    v_mfma_f32_16x16x32_f16 v[108:111], v[146:149], v[150:153], v[108:111]
    s_nop 0
    ds_read_b32 v116, v116 offset:64
    v_max3_f32 v120, v112, v113, v114
    v_mfma_f32_16x16x32_f16 v[104:107], v[40:43], v[76:79], v[196:199]
    ds_read_b128 v[68:71], v133 offset:1024
    v_mfma_f32_16x16x32_f16 v[104:107], v[140:143], v[150:153], v[104:107]
    s_nop 0
    ds_read_b128 v[72:75], v137 offset:1536
    v_max3_f32 v120, v120, v115, v108
    v_mfma_f32_16x16x32_f16 v[88:91], v[28:31], v[76:79], v[208:211]
    ds_read_b128 v[76:79], v136 offset:1536
    v_max3_f32 v120, v120, v109, v110
    v_mfma_f32_16x16x32_f16 v[88:91], v[48:51], v[16:19], v[88:91]
    ds_read_b128 v[60:63], v137 offset:1664
    v_max3_f32 v120, v120, v111, v104
    v_mfma_f32_16x16x32_f16 v[88:91], v[20:23], v[152:155], v[88:91]
    ds_read_b128 v[56:59], v136 offset:1664
    v_max3_f32 v120, v120, v105, v106
    v_mfma_f32_16x16x32_f16 v[92:95], v[28:31], v[96:99], v[208:211]
    ds_read_b128 v[64:67], v137 offset:1792
    s_nop 0
    v_mfma_f32_16x16x32_f16 v[92:95], v[48:51], v[36:39], v[92:95]
    s_nop 0
    ds_read_b128 v[80:83], v136 offset:1792
    v_max3_f32 v120, v120, v107, v88
    v_mfma_f32_16x16x32_f16 v[92:95], v[20:23], v[146:149], v[92:95]
    v_mov_b32 v121, v120
    v_mfma_f32_16x16x32_f16 v[84:87], v[28:31], v[44:47], v[208:211]
    s_nop 0
    v_permlane32_swap_b32 v121, v120
    v_mfma_f32_16x16x32_f16 v[84:87], v[48:51], v[40:43], v[84:87]
    s_waitcnt lgkmcnt(6)
    buffer_load_dwordx4 v127, s[24:27], s56 offen nt lds
    v_max_f32 v120, v121, v120
    v_mfma_f32_16x16x32_f16 v[84:87], v[20:23], v[140:143], v[84:87]
    s_waitcnt lgkmcnt(5)
    v_mov_b32 v121, v120
    v_mov_b32_dpp v91, v95 quad_perm:[0,1,2,3] row_mask:0x2 bank_mask:0xf
    v_mfma_f32_16x16x32_bf16 v[28:31], a[216:219], v[72:75], 0
    s_waitcnt lgkmcnt(4)
    v_permlane16_swap_b32 v121, v120
    v_mfma_f32_16x16x32_bf16 v[28:31], a[220:223], v[76:79], v[28:31]
    s_waitcnt lgkmcnt(3)
    v_max_f32 v120, v121, v120
    v_sub_f32 v112, v112, v120
    v_mfma_f32_16x16x32_bf16 v[28:31], a[224:227], v[60:63], v[28:31]
    s_waitcnt lgkmcnt(2)
    v_sub_f32 v113, v113, v120
    v_sub_f32 v114, v114, v120
    v_mfma_f32_16x16x32_bf16 v[28:31], a[228:231], v[56:59], v[28:31]
    s_waitcnt lgkmcnt(1)
    v_sub_f32 v115, v115, v120
    v_sub_f32 v108, v108, v120
    v_mfma_f32_16x16x32_bf16 v[28:31], a[232:235], v[64:67], v[28:31]
    s_waitcnt lgkmcnt(0)
    v_sub_f32 v109, v109, v120
    v_sub_f32 v110, v110, v120
    v_mfma_f32_16x16x32_bf16 v[28:31], a[236:239], v[80:83], v[28:31]
    buffer_store_dwordx4 v[68:71], v127, s[28:31], s60 offen sc1
    ds_read_b128 v[100:103], v133 offset:2048
    v_sub_f32 v111, v111, v120
    v_sub_f32 v104, v104, v120
    v_sub_f32 v105, v105, v120
    v_mfma_f32_16x16x32_f16 v[48:51], v[16:19], v[96:99], v[192:195]
    s_add_u32 m0, s67, 2048
    v_sub_f32 v106, v106, v120
    v_sub_f32 v107, v107, v120
    v_mfma_f32_16x16x32_f16 v[48:51], v[152:155], v[144:147], v[48:51]
    v_sub_f32 v88, v88, v120
    v_mov_b32_dpp v91, v87 quad_perm:[0,1,2,3] row_mask:0x4 bank_mask:0xf
    v_mfma_f32_16x16x32_f16 v[68:71], v[36:39], v[96:99], v[188:191]
    v_exp_f32 v112, v112
    v_mfma_f32_16x16x32_f16 v[68:71], v[146:149], v[144:147], v[68:71]
    v_exp_f32 v113, v113
    v_mfma_f32_16x16x32_f16 v[52:55], v[40:43], v[96:99], v[184:187]
    v_exp_f32 v114, v114
    v_mfma_f32_16x16x32_f16 v[52:55], v[140:143], v[144:147], v[52:55]
    v_exp_f32 v115, v115
    v_mfma_f32_16x16x32_bf16 v[20:23], a[240:243], v[72:75], 0
    v_cvt_pk_bf16_f32 v96, v112, v113
    v_cvt_pk_bf16_f32 v97, v114, v115
    v_mfma_f32_16x16x32_bf16 v[20:23], a[244:247], v[76:79], v[20:23]
    v_exp_f32 v108, v108
    v_mfma_f32_16x16x32_bf16 v[20:23], a[248:251], v[60:63], v[20:23]
    s_waitcnt lgkmcnt(0)
    buffer_load_dwordx4 v126, s[24:27], s56 offen nt lds
    v_and_b32 v120, 0xffff0000, v116
    v_mfma_f32_16x16x32_bf16 v[20:23], a[252:255], v[56:59], v[20:23]
    v_exp_f32 v109, v109
    v_mfma_f32_16x16x32_bf16 v[20:23], v[224:227], v[64:67], v[20:23]
    v_exp_f32 v110, v110
    v_mfma_f32_16x16x32_bf16 v[20:23], v[228:231], v[80:83], v[20:23]
    s_mov_b32 s53, s47
    v_exp_f32 v111, v111
    v_cvt_pk_bf16_f32 v98, v108, v109
    v_cvt_pk_bf16_f32 v99, v110, v111
    v_exp_f32 v104, v104
    v_exp_f32 v105, v105
    v_exp_f32 v106, v106
    v_exp_f32 v107, v107
    v_cvt_pk_bf16_f32 v168, v104, v105
    v_cvt_pk_bf16_f32 v169, v106, v107
    v_exp_f32 v88, v88
    v_lshlrev_b32 v116, 16, v116
    v_cvt_pk_bf16_f32 v170, v88, 0
    v_mfma_f32_16x16x32_bf16 v[112:115], v[220:223], v[96:99], 0
    s_add_u32 m0, s67, 3072
    buffer_store_dwordx4 v[100:103], v126, s[28:31], s60 offen sc1
    v_add_f32 v116, v116, v120
    v_add_f32 v116, v116, v211
    v_max3_f32 v120, v48, v49, v50
    v_max3_f32 v120, v120, v51, v68
    v_mfma_f32_16x16x32_bf16 v[112:115], v[220:223], v[168:171], v[112:115]
    s_mov_b32 s47, s46
    v_mov_b32_dpp v91, v116 quad_perm:[0,1,2,3] row_mask:0x8 bank_mask:0xf
    v_mov_b32 v121, v91
    v_mfma_f32_16x16x32_bf16 v[108:111], v[0:3], v[96:99], 0
    s_mov_b32 s46, s45
    v_max_f32_dpp v121, v121, v121 row_ror:8 row_mask:0xf bank_mask:0xf
    v_max3_f32 v120, v120, v69, v70
    v_mfma_f32_16x16x32_bf16 v[108:111], v[164:167], v[168:171], v[108:111]
    s_mov_b32 s45, s44
    v_max_f32_dpp v121, v121, v121 row_ror:4 row_mask:0xf bank_mask:0xf
    v_max3_f32 v120, v120, v71, v52
    v_mfma_f32_16x16x32_bf16 v[104:107], v[8:11], v[96:99], 0
    s_mov_b32 s44, s53
    v_max_f32_dpp v121, v121, v121 row_ror:2 row_mask:0xf bank_mask:0xf
    v_max3_f32 v120, v120, v53, v54
    v_mfma_f32_16x16x32_bf16 v[104:107], v[160:163], v[168:171], v[104:107]
    s_sub_u32 s48, s44, s46
    v_max_f32_dpp v121, v121, v121 row_ror:1 row_mask:0xf bank_mask:0xf
    v_mov_b32 v84, v121
    v_mfma_f32_16x16x32_bf16 v[100:103], v[12:15], v[96:99], 0
    s_sub_u32 s49, s46, s45
    v_permlane32_swap_b32 v84, v121
    v_mfma_f32_16x16x32_bf16 v[100:103], v[156:159], v[168:171], v[100:103]
    v_max_f32 v121, v84, v121
    v_mov_b32 v84, v121
    v_rcp_f32 v112, v112
    v_max3_f32 v120, v120, v55, v93
    v_permlane16_swap_b32 v84, v121
    v_max_f32 v121, v84, v121
    v_sub_f32 v91, v91, v121
    v_exp_f32 v91, v91
    v_mul_f32 v108, v108, v112
    v_cvt_pk_bf16_f32 v91, v91, v91
    ds_write_b16 v123, v91 offset:64
    v_mul_f32 v109, v109, v112
    v_cvt_pk_bf16_f32 v88, v108, v109
    ds_read_b128 v[94:97], v132 offset:48
    v_mul_f32 v110, v110, v112
    v_mul_f32 v111, v111, v112
    v_cvt_pk_bf16_f32 v89, v110, v111
    ds_read_b128 v[108:111], v132 offset:64
    v_mfma_f32_16x16x32_bf16 v[114:117], v[232:235], v[72:75], 0
    v_mul_f32 v104, v104, v112
    v_mul_f32 v105, v105, v112
    v_mfma_f32_16x16x32_bf16 v[114:117], v[236:239], v[76:79], v[114:117]
    ds_write_b64 v135, v[88:89] offset:0
    v_mfma_f32_16x16x32_bf16 v[114:117], v[240:243], v[60:63], v[114:117]
    v_cvt_pk_bf16_f32 v90, v104, v105
    v_mul_f32 v106, v106, v112
    v_mfma_f32_16x16x32_bf16 v[114:117], v[244:247], v[56:59], v[114:117]
    v_mul_f32 v107, v107, v112
    v_cvt_pk_bf16_f32 v91, v106, v107
    v_mfma_f32_16x16x32_bf16 v[114:117], v[248:251], v[64:67], v[114:117]
    ds_write_b64 v135, v[90:91] offset:8
    v_mfma_f32_16x16x32_bf16 v[114:117], v[252:255], v[80:83], v[114:117]
    s_waitcnt lgkmcnt(3)
    v_mul_f32 v100, v100, v112
    v_mul_f32 v101, v101, v112
    v_cvt_pk_bf16_f32 v168, v100, v101
    v_mul_f32 v102, v102, v112
    v_mfma_f32_16x16x32_bf16 v[72:75], v[94:97], v[0:3], 0
    s_waitcnt lgkmcnt(2)
    v_mul_f32 v103, v103, v112
    v_cvt_pk_bf16_f32 v169, v102, v103
    v_mov_b32 v170, v120
    v_fma_f32 v92, v32, v32, s42
    v_mfma_f32_16x16x32_bf16 v[72:75], v[108:111], v[164:167], v[72:75]
    ds_write_b64 v134, v[168:169] offset:0
    v_mfma_f32_16x16x32_bf16 v[88:91], v[94:97], v[8:11], 0
    v_permlane32_swap_b32 v170, v120
    v_mfma_f32_16x16x32_bf16 v[88:91], v[108:111], v[160:163], v[88:91]
    v_max_f32 v120, v170, v120
    v_mov_b32 v170, v120
    v_mfma_f32_16x16x32_bf16 v[76:79], v[94:97], v[12:15], 0
    s_nop 0
    v_permlane16_swap_b32 v170, v120
    v_mfma_f32_16x16x32_bf16 v[76:79], v[108:111], v[156:159], v[76:79]
    ds_read_b128 v[60:63], v133 offset:3072
    v_max_f32 v120, v170, v120
    v_sub_f32 v48, v48, v120
    v_sub_f32 v49, v49, v120
    v_sub_f32 v50, v50, v120
    v_sub_f32 v51, v51, v120
    v_sub_f32 v68, v68, v120
    v_sub_f32 v69, v69, v120
    v_sub_f32 v70, v70, v120
    v_sub_f32 v71, v71, v120
    v_sub_f32 v52, v52, v120
    v_sub_f32 v53, v53, v120
    v_sub_f32 v54, v54, v120
    v_sub_f32 v55, v55, v120
    v_sub_f32 v93, v93, v120
    v_exp_f32 v48, v48
    v_exp_f32 v49, v49
    v_exp_f32 v50, v50
    v_exp_f32 v51, v51
    v_cvt_pk_bf16_f32 v56, v48, v49
    v_cvt_pk_bf16_f32 v57, v50, v51
    v_exp_f32 v68, v68
    v_exp_f32 v69, v69
    v_exp_f32 v70, v70
    v_exp_f32 v71, v71
    v_cvt_pk_bf16_f32 v58, v68, v69
    v_cvt_pk_bf16_f32 v59, v70, v71
    v_exp_f32 v52, v52
    v_exp_f32 v53, v53
    v_exp_f32 v54, v54
    v_exp_f32 v55, v55
    v_cvt_pk_bf16_f32 v168, v52, v53
    v_cvt_pk_bf16_f32 v169, v54, v55
    v_exp_f32 v93, v93
    v_mov_b32_dpp v75, v91 quad_perm:[0,1,2,3] row_mask:0x2 bank_mask:0xf
    v_cvt_pk_bf16_f32 v170, v93, 0
    v_mfma_f32_16x16x32_bf16 v[88:91], v[220:223], v[56:59], 0
    s_waitcnt lgkmcnt(0)
    buffer_load_dwordx4 v125, s[24:27], s56 offen nt lds
    ds_read_b128 v[64:67], v137 offset:3072
    v_mfma_f32_16x16x32_bf16 v[88:91], v[220:223], v[168:171], v[88:91]
    v_mov_b32_dpp v75, v79 quad_perm:[0,1,2,3] row_mask:0x4 bank_mask:0xf
    v_cvt_pk_bf16_f32 v75, v75, v75
    v_mfma_f32_16x16x32_bf16 v[76:79], v[0:3], v[56:59], 0
    ds_write_b16 v131, v75
    v_mfma_f32_16x16x32_bf16 v[76:79], v[164:167], v[168:171], v[76:79]
    ds_read_b128 v[72:75], v136 offset:3072
    v_fmac_f32 v92, v33, v33
    v_mfma_f32_16x16x32_bf16 v[80:83], v[8:11], v[56:59], 0
    ds_read_b128 v[48:51], v137 offset:3200
    v_fmac_f32 v92, v34, v34
    v_mfma_f32_16x16x32_bf16 v[80:83], v[160:163], v[168:171], v[80:83]
    ds_read_b128 v[68:71], v136 offset:3200
    v_fmac_f32 v92, v35, v35
    v_mfma_f32_16x16x32_bf16 v[52:55], v[12:15], v[56:59], 0
    ds_read_b128 v[56:59], v137 offset:3328
    v_add_u32 v137, s48, v137
    v_mfma_f32_16x16x32_bf16 v[52:55], v[156:159], v[168:171], v[52:55]
    buffer_store_dwordx4 v[60:63], v125, s[28:31], s60 offen sc1
    ds_read_b128 v[94:97], v136 offset:3328
    v_rcp_f32 v88, v88
    v_add_u32 v136, s48, v136
    v_mfma_f32_16x16x32_f16 v[60:63], v[16:19], v[44:47], v[180:183]
    s_add_u32 m0, s67, 4096
    ds_read_b128 v[16:19], v133 offset:4096
    v_mul_f32 v76, v76, v88
    v_mfma_f32_16x16x32_f16 v[60:63], v[152:155], v[138:141], v[60:63]
    s_cmp_lg_u32 s5, -1
    v_mul_f32 v77, v77, v88
    v_cvt_pk_bf16_f32 v76, v76, v77
    v_mfma_f32_16x16x32_f16 v[152:155], v[36:39], v[44:47], v[176:179]
    v_mul_f32 v78, v78, v88
    v_mul_f32 v79, v79, v88
    v_mfma_f32_16x16x32_f16 v[152:155], v[146:149], v[138:141], v[152:155]
    v_cvt_pk_bf16_f32 v77, v78, v79
    v_mul_f32 v80, v80, v88
    v_mfma_f32_16x16x32_f16 v[36:39], v[40:43], v[44:47], v[172:175]
    ds_write_b64 v135, v[76:77] offset:1536
    v_mfma_f32_16x16x32_f16 v[36:39], v[140:143], v[138:141], v[36:39]
    s_waitcnt lgkmcnt(4)
    v_mul_f32 v81, v81, v88
    v_cvt_pk_bf16_f32 v78, v80, v81
    v_mfma_f32_16x16x32_bf16 v[40:43], a[216:219], v[64:67], 0
    v_mul_f32 v82, v82, v88
    v_mul_f32 v83, v83, v88
    v_mfma_f32_16x16x32_bf16 v[40:43], a[220:223], v[72:75], v[40:43]
    v_cvt_pk_bf16_f32 v79, v82, v83
    v_mul_f32 v52, v52, v88
    v_mfma_f32_16x16x32_bf16 v[40:43], a[224:227], v[48:51], v[40:43]
    ds_write_b64 v135, v[78:79] offset:1544
    v_mfma_f32_16x16x32_bf16 v[40:43], a[228:231], v[68:71], v[40:43]
    s_waitcnt lgkmcnt(2)
    buffer_load_dwordx4 v124, s[24:27], s56 offen nt lds
    v_mul_f32 v53, v53, v88
    v_mfma_f32_16x16x32_bf16 v[40:43], a[232:235], v[56:59], v[40:43]
    v_cvt_pk_bf16_f32 v168, v52, v53
    v_mul_f32 v54, v54, v88
    v_mfma_f32_16x16x32_bf16 v[40:43], a[236:239], v[94:97], v[40:43]
    v_mul_f32 v55, v55, v88
    v_cvt_pk_bf16_f32 v169, v54, v55
    v_mfma_f32_16x16x32_bf16 v[140:143], a[240:243], v[64:67], 0
    ds_write_b64 v134, v[168:169] offset:1536
    v_mfma_f32_16x16x32_bf16 v[140:143], a[244:247], v[72:75], v[140:143]
    v_max3_f32 v168, v60, v61, v62
    v_max3_f32 v168, v168, v63, v152
    v_mfma_f32_16x16x32_bf16 v[140:143], a[248:251], v[48:51], v[140:143]
    v_max3_f32 v168, v168, v153, v154
    v_max3_f32 v168, v168, v155, v36
    v_mfma_f32_16x16x32_bf16 v[140:143], a[252:255], v[68:71], v[140:143]
    v_max3_f32 v168, v168, v37, v38
    v_max3_f32 v168, v168, v39, v86
    v_mfma_f32_16x16x32_bf16 v[140:143], v[224:227], v[56:59], v[140:143]
    buffer_store_dwordx4 v[16:19], v124, s[28:31], s60 offen sc1
    v_mov_b32 v169, v168
    v_fmac_f32 v92, v4, v4
    v_fmac_f32 v92, v5, v5
    v_fmac_f32 v92, v6, v6
    v_mfma_f32_16x16x32_bf16 v[140:143], v[228:231], v[94:97], v[140:143]
    ds_read_b128 v[16:19], v137 offset:0
    v_fmac_f32 v92, v7, v7
    v_mfma_f32_16x16x32_bf16 v[44:47], v[232:235], v[64:67], 0
    ds_read_b128 v[146:149], v136 offset:0
    v_fmac_f32 v92, v24, v24
    v_mfma_f32_16x16x32_bf16 v[44:47], v[236:239], v[72:75], v[44:47]
    ds_read_b128 v[72:75], v137 offset:128
    v_fmac_f32 v92, v25, v25
    v_mfma_f32_16x16x32_bf16 v[44:47], v[240:243], v[48:51], v[44:47]
    ds_read_b128 v[88:91], v136 offset:128
    v_fmac_f32 v92, v26, v26
    v_mfma_f32_16x16x32_bf16 v[44:47], v[244:247], v[68:71], v[44:47]
    ds_read_b128 v[76:79], v137 offset:256
    v_fmac_f32 v92, v27, v27
    v_mfma_f32_16x16x32_bf16 v[44:47], v[248:251], v[56:59], v[44:47]
    ds_read_b128 v[56:59], v136 offset:256
    v_fma_f32 v93, v28, v28, s42
    v_mfma_f32_16x16x32_bf16 v[44:47], v[252:255], v[94:97], v[44:47]
    v_permlane32_swap_b32 v169, v168
    v_max_f32 v168, v169, v168
    v_mov_b32 v169, v168
    v_fmac_f32 v93, v29, v29
    v_fmac_f32 v93, v30, v30
    v_permlane16_swap_b32 v169, v168
    v_max_f32 v168, v169, v168
    v_sub_f32 v60, v60, v168
    v_sub_f32 v61, v61, v168
    v_sub_f32 v62, v62, v168
    v_sub_f32 v63, v63, v168
    v_sub_f32 v152, v152, v168
    v_sub_f32 v153, v153, v168
    v_sub_f32 v154, v154, v168
    v_sub_f32 v155, v155, v168
    v_sub_f32 v36, v36, v168
    v_sub_f32 v37, v37, v168
    v_sub_f32 v38, v38, v168
    v_sub_f32 v39, v39, v168
    v_sub_f32 v86, v86, v168
    v_exp_f32 v60, v60
    v_exp_f32 v61, v61
    v_exp_f32 v62, v62
    v_exp_f32 v63, v63
    v_cvt_pk_bf16_f32 v60, v60, v61
    v_cvt_pk_bf16_f32 v61, v62, v63
    v_exp_f32 v152, v152
    v_exp_f32 v153, v153
    v_exp_f32 v154, v154
    v_exp_f32 v155, v155
    v_cvt_pk_bf16_f32 v62, v152, v153
    v_cvt_pk_bf16_f32 v63, v154, v155
    v_exp_f32 v36, v36
    v_exp_f32 v37, v37
    v_exp_f32 v38, v38
    v_exp_f32 v39, v39
    v_cvt_pk_bf16_f32 v168, v36, v37
    v_cvt_pk_bf16_f32 v169, v38, v39
    v_exp_f32 v86, v86
    v_fmac_f32 v93, v31, v31
    v_cvt_pk_bf16_f32 v170, v86, 0
    v_mfma_f32_16x16x32_bf16 v[152:155], v[220:223], v[60:63], 0
    v_fmac_f32 v93, v20, v20
    v_fmac_f32 v93, v21, v21
    v_mfma_f32_16x16x32_bf16 v[152:155], v[220:223], v[168:171], v[152:155]
    v_fmac_f32 v93, v22, v22
    v_fmac_f32 v93, v23, v23
    v_mfma_f32_16x16x32_bf16 v[36:39], v[0:3], v[60:63], 0
    s_nop 0
    v_fmac_f32 v93, v114, v114
    v_fmac_f32 v93, v115, v115
    v_mfma_f32_16x16x32_bf16 v[36:39], v[164:167], v[168:171], v[36:39]
    s_nop 0
    v_rcp_f32 v152, v152
    v_mfma_f32_16x16x32_bf16 v[0:3], v[8:11], v[60:63], 0
    s_nop 0
    v_fmac_f32 v93, v116, v116
    v_fmac_f32 v93, v117, v117
    v_mfma_f32_16x16x32_bf16 v[0:3], v[160:163], v[168:171], v[0:3]
    s_nop 0
    v_mul_f32 v36, v36, v152
    v_mul_f32 v37, v37, v152
    v_mfma_f32_16x16x32_bf16 v[8:11], v[12:15], v[60:63], 0
    v_cvt_pk_bf16_f32 v12, v36, v37
    v_mul_f32 v38, v38, v152
    v_mfma_f32_16x16x32_bf16 v[8:11], v[156:159], v[168:171], v[8:11]
    s_waitcnt lgkmcnt(0)
    v_mul_f32 v39, v39, v152
    v_cvt_pk_bf16_f32 v13, v38, v39
    v_mfma_f32_16x16x32_bf16 v[36:39], a[0:3], v[16:19], 0
    s_cbranch_scc1 L_loopS0
    ds_write_b64 v135, v[12:13] offset:3072
    v_mul_f32 v0, v0, v152
    v_mul_f32 v1, v1, v152
    v_cvt_pk_bf16_f32 v14, v0, v1
    v_mul_f32 v2, v2, v152
    v_mul_f32 v3, v3, v152
    v_cvt_pk_bf16_f32 v15, v2, v3
    v_mul_f32 v8, v8, v152
    v_mul_f32 v9, v9, v152
    v_cvt_pk_bf16_f32 v8, v8, v9
    v_mul_f32 v10, v10, v152
    v_mul_f32 v11, v11, v152
    v_cvt_pk_bf16_f32 v9, v10, v11
    s_mov_b32 s30, 100270464
    s_mul_i32 s89, s68, 7168
    ds_write_b64 v135, v[14:15] offset:3080
    v_fma_f32 v113, v40, v40, s42
    s_add_u32 s89, s89, 135168
    s_movk_i32 s90, 112
    ds_write_b64 v134, v[8:9] offset:3072
    v_fmac_f32 v113, v41, v41
    v_fmac_f32 v113, v42, v42
    v_fmac_f32 v113, v43, v43
    v_fmac_f32 v113, v140, v140
    v_fmac_f32 v113, v141, v141
    v_fmac_f32 v113, v142, v142
    v_fmac_f32 v113, v143, v143
    v_fmac_f32 v113, v44, v44
    v_fmac_f32 v113, v45, v45
    v_fmac_f32 v113, v46, v46
    v_fmac_f32 v113, v47, v47
    v_cvt_pk_bf16_f32 v112, v92, v93
    v_cvt_pk_bf16_f32 v113, v113, v122
    s_lshr_b32 s91, s64, 16
    s_lshl_b32 s92, s68, 10
    ds_write_b64 v130, v[112:113]
    v_mbcnt_lo_u32_b32 v131, -1, 0
    v_mbcnt_hi_u32_b32 v131, -1, v131
    v_and_b32 v132, 15, v131
    v_lshrrev_b32 v131, 4, v131
    v_mul_u32_u24 v118, 1792, v131
    v_add_u32 v118, s89, v118
    v_mad_u32_u24 v131, v132, s90, v118
    v_lshrrev_b32 v119, v132, s64
    v_and_b32 v119, 1, v119
    v_cmp_eq_u32 vcc, 1, v119
    v_mad_u32_u24 v119, v132, s90, v118
    v_lshrrev_b32 v132, v132, s91
    v_cndmask_b32 v131, v118, v131, vcc
    v_and_b32 v132, 1, v132
    v_subrev_u32 v119, 28672, v119
    v_cmp_eq_u32 vcc, 1, v132
    s_sub_u32 s84, s45, s44
    s_sub_u32 s85, s46, s45
    ds_read_b128 v[48:51], v131 offset:64
    ds_read_b128 v[36:39], v131 offset:80
    v_cndmask_b32 v119, v118, v119, vcc
    v_add_u32 v118, s92, v129
    s_waitcnt lgkmcnt(2)
    s_barrier
    s_sub_u32 s86, s44, s45
    ds_read_b128 v[86:89], v131
    v_add_u32 v139, s84, v137
    s_sub_u32 s93, s44, s47
    s_sub_u32 s94, s45, s47
    ds_read_b64 v[90:91], v131 offset:16
    ds_read_b128 v[8:11], v118 offset:6144
    v_add_u32 v138, s84, v136
    v_add_u32 v118, s85, v135
    s_sub_u32 s95, s46, s47
    ds_read_b128 v[16:19], v129 offset:0
    v_add_u32 v63, s85, v134
    ds_read_b128 v[0:3], v129 offset:1024
    v_add_u32 v112, s86, v135
    v_add_u32 v132, s86, v134
    v_add_u32 v131, s93, v133
    v_add_u32 v113, s94, v133
    s_waitcnt lgkmcnt(6)
    v_mfma_f32_16x16x32_bf16 v[12:15], v[220:223], v[48:51], 0
    s_waitcnt lgkmcnt(5)
    ds_read_b128 v[80:83], v139 offset:1536
    ds_read_b128 v[76:79], v138 offset:1536
    v_mfma_f32_16x16x32_bf16 v[12:15], v[220:223], v[36:39], v[12:15]
    s_waitcnt lgkmcnt(3)
    ds_read_b128 v[72:75], v139 offset:1664
    v_lshlrev_b32 v92, 16, v86
    v_and_b32 v86, 0xffff0000, v86
    v_lshlrev_b32 v93, 16, v87
    v_and_b32 v87, 0xffff0000, v87
    v_lshlrev_b32 v94, 16, v88
    v_and_b32 v88, 0xffff0000, v88
    v_rcp_f32 v12, v12
    v_lshlrev_b32 v95, 16, v89
    v_mfma_f32_16x16x32_bf16 v[64:67], v[216:219], v[16:19], 0
    s_waitcnt lgkmcnt(3)
    ds_read_b128 v[68:71], v138 offset:1664
    ds_read_b128 v[48:51], v139 offset:1792
    v_mfma_f32_16x16x32_bf16 v[64:67], v[216:219], v[0:3], v[64:67]
    s_waitcnt lgkmcnt(4)
    ds_read_b128 v[16:19], v138 offset:1792
    v_mul_f32 v92, v92, v12
    v_mul_f32 v86, v86, v12
    v_cvt_pk_bf16_f32 v92, v92, v86
    v_mul_f32 v93, v93, v12
    v_mfma_f32_16x16x32_bf16 v[0:3], a[216:219], v[80:83], 0
    s_waitcnt lgkmcnt(4)
    v_mul_f32 v87, v87, v12
    v_cvt_pk_bf16_f32 v93, v93, v87
    v_mfma_f32_16x16x32_bf16 v[0:3], a[220:223], v[76:79], v[0:3]
    s_waitcnt lgkmcnt(3)
    ds_read_b128 v[108:111], v139 offset:0
    ds_read_b128 v[104:107], v138 offset:0
    v_mfma_f32_16x16x32_bf16 v[0:3], a[224:227], v[72:75], v[0:3]
    s_waitcnt lgkmcnt(4)
    ds_read_b128 v[96:99], v139 offset:128
    v_mul_f32 v94, v94, v12
    v_mul_f32 v88, v88, v12
    v_cvt_pk_bf16_f32 v94, v94, v88
    v_and_b32 v89, 0xffff0000, v89
    v_mul_f32 v95, v95, v12
    v_mfma_f32_16x16x32_bf16 v[0:3], a[228:231], v[68:71], v[0:3]
    s_waitcnt lgkmcnt(4)
    ds_read_b128 v[84:87], v138 offset:128
    ds_read_b128 v[56:59], v139 offset:256
    v_mfma_f32_16x16x32_bf16 v[0:3], a[232:235], v[48:51], v[0:3]
    s_waitcnt lgkmcnt(5)
    ds_read_b128 v[36:39], v138 offset:256
    v_mul_f32 v89, v89, v12
    v_mfma_f32_16x16x32_bf16 v[0:3], a[236:239], v[16:19], v[0:3]
    v_cvt_pk_bf16_f32 v95, v95, v89
    v_lshlrev_b32 v67, 16, v90
    v_mfma_f32_16x16x32_bf16 v[52:55], a[240:243], v[80:83], 0
    ds_write_b128 v112, v[92:95] offset:0
    v_mfma_f32_16x16x32_bf16 v[52:55], a[244:247], v[76:79], v[52:55]
    v_and_b32 v90, 0xffff0000, v90
    v_mul_f32 v67, v67, v12
    v_mfma_f32_16x16x32_bf16 v[52:55], a[248:251], v[72:75], v[52:55]
    v_mul_f32 v90, v90, v12
    v_cvt_pk_bf16_f32 v60, v67, v90
    v_mfma_f32_16x16x32_bf16 v[52:55], a[252:255], v[68:71], v[52:55]
    v_lshlrev_b32 v67, 16, v91
    v_and_b32 v91, 0xffff0000, v91
    v_mfma_f32_16x16x32_bf16 v[52:55], v[224:227], v[48:51], v[52:55]
    v_mul_f32 v67, v67, v12
    v_mul_f32 v91, v91, v12
    v_mfma_f32_16x16x32_bf16 v[52:55], v[228:231], v[16:19], v[52:55]
    v_cvt_pk_bf16_f32 v61, v67, v91
    v_lshrrev_b32 v67, 0, v11
    v_mfma_f32_16x16x32_bf16 v[12:15], v[232:235], v[80:83], 0
    ds_write_b64 v132, v[60:61] offset:0
    v_mfma_f32_16x16x32_bf16 v[12:15], v[236:239], v[76:79], v[12:15]
    v_lshrrev_b32 v67, v67, s64
    v_and_b32 v67, 1, v67
    v_mfma_f32_16x16x32_bf16 v[12:15], v[240:243], v[72:75], v[12:15]
    v_cmp_eq_u32 vcc, 1, v67
    v_lshrrev_b32 v67, 8, v11
    v_mfma_f32_16x16x32_bf16 v[12:15], v[244:247], v[68:71], v[12:15]
    v_cndmask_b32 v8, 2.0, v8, vcc
    v_lshrrev_b32 v67, v67, s64
    v_mfma_f32_16x16x32_bf16 v[12:15], v[248:251], v[48:51], v[12:15]
    v_and_b32 v67, 1, v67
    v_cmp_eq_u32 vcc, 1, v67
    v_mfma_f32_16x16x32_bf16 v[12:15], v[252:255], v[16:19], v[12:15]
    s_waitcnt lgkmcnt(1)
    v_cndmask_b32 v9, 2.0, v9, vcc
    v_lshrrev_b32 v11, 16, v11
    v_mfma_f32_16x16x32_bf16 v[72:75], a[216:219], v[108:111], 0
    v_lshrrev_b32 v11, v11, s64
    v_and_b32 v11, 1, v11
    v_mfma_f32_16x16x32_bf16 v[72:75], a[220:223], v[104:107], v[72:75]
    ds_read_b128 v[100:103], v139 offset:3072
    ds_read_b128 v[92:95], v138 offset:3072
    v_mfma_f32_16x16x32_bf16 v[72:75], a[224:227], v[96:99], v[72:75]
    ds_read_b128 v[88:91], v139 offset:3200
    v_cmp_eq_u32 vcc, 1, v11
    v_mfma_f32_16x16x32_bf16 v[72:75], a[228:231], v[84:87], v[72:75]
    ds_read_b128 v[80:83], v138 offset:3200
    v_cndmask_b32 v10, 2.0, v10, vcc
    v_mfma_f32_16x16x32_bf16 v[72:75], a[232:235], v[56:59], v[72:75]
    ds_read_b128 v[76:79], v139 offset:3328
    v_add_u32 v11, s95, v133
    v_mfma_f32_16x16x32_bf16 v[72:75], a[236:239], v[36:39], v[72:75]
    ds_read_b128 v[16:19], v138 offset:3328
    v_fma_f32 v133, v0, v0, s42
    v_mfma_f32_16x16x32_bf16 v[48:51], a[240:243], v[108:111], 0
    v_rsq_f32 v64, v64
    v_mfma_f32_16x16x32_bf16 v[48:51], a[244:247], v[104:107], v[48:51]
    v_mul_f32 v64, s43, v64
    v_mul_f32 v32, v32, v64
    v_mfma_f32_16x16x32_bf16 v[48:51], a[248:251], v[96:99], v[48:51]
    v_mul_f32 v33, v33, v64
    v_cvt_pk_bf16_f32 v32, v32, v33
    v_mfma_f32_16x16x32_bf16 v[48:51], a[252:255], v[84:87], v[48:51]
    v_mul_f32 v34, v34, v64
    v_mul_f32 v35, v35, v64
    v_mfma_f32_16x16x32_bf16 v[48:51], v[224:227], v[56:59], v[48:51]
    v_cvt_pk_bf16_f32 v33, v34, v35
    v_mul_f32 v4, v4, v64
    v_mfma_f32_16x16x32_bf16 v[48:51], v[228:231], v[36:39], v[48:51]
    v_mul_f32 v5, v5, v64
    v_cvt_pk_bf16_f32 v34, v4, v5
    v_mfma_f32_16x16x32_bf16 v[68:71], v[232:235], v[108:111], 0
    v_mul_f32 v6, v6, v64
    v_mul_f32 v7, v7, v64
    v_mfma_f32_16x16x32_bf16 v[68:71], v[236:239], v[104:107], v[68:71]
    v_cvt_pk_bf16_f32 v35, v6, v7
    v_mul_f32 v24, v24, v64
    v_mfma_f32_16x16x32_bf16 v[68:71], v[240:243], v[96:99], v[68:71]
    ds_write_b128 v118, v[32:35] offset:0
    v_mfma_f32_16x16x32_bf16 v[68:71], v[244:247], v[84:87], v[68:71]
    v_mul_f32 v25, v25, v64
    v_cvt_pk_bf16_f32 v24, v24, v25
    v_mfma_f32_16x16x32_bf16 v[68:71], v[248:251], v[56:59], v[68:71]
    v_mul_f32 v26, v26, v64
    v_mul_f32 v27, v27, v64
    v_mfma_f32_16x16x32_bf16 v[68:71], v[252:255], v[36:39], v[68:71]
    s_waitcnt lgkmcnt(1)
    v_cvt_pk_bf16_f32 v25, v26, v27
    v_fma_f32 v62, v72, v72, s42
    v_mfma_f32_16x16x32_bf16 v[84:87], a[216:219], v[100:103], 0
    ds_write_b64 v63, v[24:25] offset:0
    v_mfma_f32_16x16x32_bf16 v[84:87], a[220:223], v[92:95], v[84:87]
    ds_read_b128 v[24:27], v119 offset:64
    v_fmac_f32 v62, v73, v73
    v_mfma_f32_16x16x32_bf16 v[84:87], a[224:227], v[88:91], v[84:87]
    ds_read_b128 v[4:7], v119 offset:80
    v_fmac_f32 v62, v74, v74
    v_mfma_f32_16x16x32_bf16 v[84:87], a[228:231], v[80:83], v[84:87]
    ds_read_b128 v[56:59], v119
    v_fmac_f32 v62, v75, v75
    v_mfma_f32_16x16x32_bf16 v[84:87], a[232:235], v[76:79], v[84:87]
    ds_read_b64 v[60:61], v119 offset:16
    v_fmac_f32 v62, v48, v48
    v_mfma_f32_16x16x32_bf16 v[84:87], a[236:239], v[16:19], v[84:87]
    v_rsq_f32 v65, v65
    v_mfma_f32_16x16x32_bf16 v[96:99], a[240:243], v[100:103], 0
    v_mul_f32 v65, s43, v65
    v_mul_f32 v28, v28, v65
    v_mfma_f32_16x16x32_bf16 v[96:99], a[244:247], v[92:95], v[96:99]
    v_mul_f32 v29, v29, v65
    v_cvt_pk_bf16_f32 v28, v28, v29
    v_mfma_f32_16x16x32_bf16 v[96:99], a[248:251], v[88:91], v[96:99]
    v_mul_f32 v30, v30, v65
    v_mul_f32 v31, v31, v65
    v_mfma_f32_16x16x32_bf16 v[96:99], a[252:255], v[80:83], v[96:99]
    v_cvt_pk_bf16_f32 v29, v30, v31
    v_mul_f32 v20, v20, v65
    v_mfma_f32_16x16x32_bf16 v[96:99], v[224:227], v[76:79], v[96:99]
    v_mul_f32 v21, v21, v65
    v_cvt_pk_bf16_f32 v30, v20, v21
    v_mfma_f32_16x16x32_bf16 v[96:99], v[228:231], v[16:19], v[96:99]
    v_mul_f32 v22, v22, v65
    v_mul_f32 v23, v23, v65
    v_mfma_f32_16x16x32_bf16 v[36:39], v[232:235], v[100:103], 0
    v_cvt_pk_bf16_f32 v31, v22, v23
    v_mul_f32 v114, v114, v65
    v_mfma_f32_16x16x32_bf16 v[36:39], v[236:239], v[92:95], v[36:39]
    ds_write_b128 v118, v[28:31] offset:1536
    v_mfma_f32_16x16x32_bf16 v[36:39], v[240:243], v[88:91], v[36:39]
    v_mul_f32 v115, v115, v65
    v_cvt_pk_bf16_f32 v114, v114, v115
    v_mfma_f32_16x16x32_bf16 v[36:39], v[244:247], v[80:83], v[36:39]
    v_mul_f32 v116, v116, v65
    v_mul_f32 v117, v117, v65
    v_mfma_f32_16x16x32_bf16 v[36:39], v[248:251], v[76:79], v[36:39]
    v_cvt_pk_bf16_f32 v115, v116, v117
    v_fmac_f32 v62, v49, v49
    v_mfma_f32_16x16x32_bf16 v[36:39], v[252:255], v[16:19], v[36:39]
    s_waitcnt lgkmcnt(1)
    ds_write_b64 v63, v[114:115] offset:1536
    v_mfma_f32_16x16x32_bf16 v[16:19], v[220:223], v[24:27], 0
    v_rsq_f32 v66, v66
    v_mfma_f32_16x16x32_bf16 v[16:19], v[220:223], v[4:7], v[16:19]
    v_mul_f32 v66, s43, v66
    v_mul_f32 v40, v40, v66
    v_mul_f32 v41, v41, v66
    v_cvt_pk_bf16_f32 v4, v40, v41
    v_mul_f32 v42, v42, v66
    v_mul_f32 v43, v43, v66
    v_cvt_pk_bf16_f32 v5, v42, v43
    v_mul_f32 v140, v140, v66
    v_mul_f32 v141, v141, v66
    v_cvt_pk_bf16_f32 v6, v140, v141
    v_mul_f32 v142, v142, v66
    v_mul_f32 v143, v143, v66
    v_cvt_pk_bf16_f32 v7, v142, v143
    v_mul_f32 v44, v44, v66
    v_mul_f32 v45, v45, v66
    v_cvt_pk_bf16_f32 v44, v44, v45
    v_mul_f32 v46, v46, v66
    v_mul_f32 v47, v47, v66
    v_cvt_pk_bf16_f32 v45, v46, v47
    ds_write_b128 v118, v[4:7] offset:3072
    v_fmac_f32 v62, v50, v50
    v_fmac_f32 v62, v51, v51
    v_fmac_f32 v62, v68, v68
    v_fmac_f32 v62, v69, v69
    ds_write_b64 v63, v[44:45] offset:3072
    v_fmac_f32 v62, v70, v70
    v_fmac_f32 v62, v71, v71
    v_fmac_f32 v133, v1, v1
    v_fmac_f32 v133, v2, v2
    v_fmac_f32 v133, v3, v3
    v_fmac_f32 v133, v52, v52
    v_fmac_f32 v133, v53, v53
    v_fmac_f32 v133, v54, v54
    v_fmac_f32 v133, v55, v55
    v_fmac_f32 v133, v12, v12
    v_fmac_f32 v133, v13, v13
    v_fmac_f32 v133, v14, v14
    v_fmac_f32 v133, v15, v15
    v_cvt_pk_bf16_f32 v62, v62, v133
    v_fma_f32 v63, v84, v84, s42
    v_fmac_f32 v63, v85, v85
    v_fmac_f32 v63, v86, v86
    v_fmac_f32 v63, v87, v87
    v_fmac_f32 v63, v96, v96
    v_fmac_f32 v63, v97, v97
    v_fmac_f32 v63, v98, v98
    v_fmac_f32 v63, v99, v99
    v_fmac_f32 v63, v36, v36
    v_fmac_f32 v63, v37, v37
    v_fmac_f32 v63, v38, v38
    v_fmac_f32 v63, v39, v39
    v_cvt_pk_bf16_f32 v63, v63, v63
    ds_write_b64 v130, v[62:63] offset:2048
    v_rcp_f32 v16, v16
    v_lshlrev_b32 v133, 16, v56
    v_and_b32 v56, 0xffff0000, v56
    v_mul_f32 v133, v133, v16
    v_mul_f32 v56, v56, v16
    v_cvt_pk_bf16_f32 v4, v133, v56
    v_lshlrev_b32 v56, 16, v57
    v_and_b32 v57, 0xffff0000, v57
    v_mul_f32 v56, v56, v16
    v_mul_f32 v57, v57, v16
    v_cvt_pk_bf16_f32 v5, v56, v57
    v_lshlrev_b32 v133, 16, v58
    v_and_b32 v58, 0xffff0000, v58
    v_mul_f32 v133, v133, v16
    v_mul_f32 v58, v58, v16
    v_cvt_pk_bf16_f32 v6, v133, v58
    v_lshlrev_b32 v7, 16, v59
    v_and_b32 v59, 0xffff0000, v59
    v_mul_f32 v7, v7, v16
    v_mul_f32 v59, v59, v16
    v_cvt_pk_bf16_f32 v7, v7, v59
    v_lshlrev_b32 v133, 16, v60
    v_and_b32 v60, 0xffff0000, v60
    v_mul_f32 v133, v133, v16
    v_mul_f32 v60, v60, v16
    v_cvt_pk_bf16_f32 v138, v133, v60
    v_lshlrev_b32 v133, 16, v61
    v_and_b32 v61, 0xffff0000, v61
    v_mul_f32 v133, v133, v16
    v_mul_f32 v61, v61, v16
    v_cvt_pk_bf16_f32 v139, v133, v61
    s_waitcnt lgkmcnt(0)
    s_barrier
    ds_write_b128 v112, v[4:7] offset:1536
    v_mov_b32 v115, 0
    ds_write_b64 v132, v[138:139] offset:1536
    ds_read_b128 v[32:35], v11 offset:0
    ds_read_b128 v[4:7], v11 offset:1024
    ds_read_b128 v[24:27], v11 offset:2048
    ds_read_b128 v[20:23], v11 offset:3072
    ds_read_b128 v[80:83], v11 offset:4096
    s_waitcnt lgkmcnt(5)
    s_barrier
    s_waitcnt lgkmcnt(4)
    buffer_store_dwordx4 v[32:35], v128, s[28:31], s59 offen sc1
    ds_read_b128 v[28:31], v129 offset:2048
    ds_read_b128 v[16:19], v129 offset:3072
    ds_read_b128 v[104:107], v137 offset:1536
    ds_read_b128 v[100:103], v136 offset:1536
    ds_read_b128 v[92:95], v137 offset:1664
    ds_read_b128 v[88:91], v136 offset:1664
    ds_read_b128 v[76:79], v137 offset:1792
    s_waitcnt lgkmcnt(9)
    buffer_store_dwordx4 v[4:7], v127, s[28:31], s59 offen sc1
    ds_read_b128 v[40:43], v136 offset:1792
    s_waitcnt lgkmcnt(7)
    v_mfma_f32_16x16x32_bf16 v[4:7], v[216:219], v[28:31], 0
    s_waitcnt lgkmcnt(6)
    v_mfma_f32_16x16x32_bf16 v[4:7], v[216:219], v[16:19], v[4:7]
    s_waitcnt lgkmcnt(5)
    v_mfma_f32_16x16x32_bf16 v[16:19], a[216:219], v[104:107], 0
    s_waitcnt lgkmcnt(4)
    v_mfma_f32_16x16x32_bf16 v[16:19], a[220:223], v[100:103], v[16:19]
    s_waitcnt lgkmcnt(3)
    ds_read_b128 v[64:67], v137 offset:0
    ds_read_b128 v[60:63], v136 offset:0
    v_mfma_f32_16x16x32_bf16 v[16:19], a[224:227], v[92:95], v[16:19]
    s_waitcnt lgkmcnt(4)
    ds_read_b128 v[56:59], v137 offset:128
    v_mfma_f32_16x16x32_bf16 v[16:19], a[228:231], v[88:91], v[16:19]
    s_waitcnt lgkmcnt(4)
    buffer_store_dwordx4 v[24:27], v126, s[28:31], s59 offen sc1
    ds_read_b128 v[44:47], v136 offset:128
    v_rsq_f32 v4, v4
    v_mfma_f32_16x16x32_bf16 v[16:19], a[232:235], v[76:79], v[16:19]
    s_waitcnt lgkmcnt(4)
    ds_read_b128 v[32:35], v137 offset:256
    ds_read_b128 v[24:27], v136 offset:256
    v_mfma_f32_16x16x32_bf16 v[16:19], a[236:239], v[40:43], v[16:19]
    v_rsq_f32 v5, v5
    v_mfma_f32_16x16x32_bf16 v[28:31], a[240:243], v[104:107], 0
    v_mul_f32 v4, s43, v4
    v_mul_f32 v5, s43, v5
    v_mfma_f32_16x16x32_bf16 v[28:31], a[244:247], v[100:103], v[28:31]
    v_rsq_f32 v6, v6
    v_mfma_f32_16x16x32_bf16 v[28:31], a[248:251], v[92:95], v[28:31]
    v_mul_f32 v6, s43, v6
    v_mul_f32 v84, v84, v6
    v_mfma_f32_16x16x32_bf16 v[28:31], a[252:255], v[88:91], v[28:31]
    buffer_store_dwordx4 v[20:23], v125, s[28:31], s59 offen sc1
    v_mul_f32 v85, v85, v6
    v_cvt_pk_bf16_f32 v84, v84, v85
    v_mul_f32 v86, v86, v6
    v_mul_f32 v87, v87, v6
    v_mfma_f32_16x16x32_bf16 v[28:31], v[224:227], v[76:79], v[28:31]
    v_cvt_pk_bf16_f32 v85, v86, v87
    v_mul_f32 v96, v96, v6
    v_mfma_f32_16x16x32_bf16 v[28:31], v[228:231], v[40:43], v[28:31]
    v_mul_f32 v97, v97, v6
    v_cvt_pk_bf16_f32 v86, v96, v97
    v_mfma_f32_16x16x32_bf16 v[20:23], v[232:235], v[104:107], 0
    v_mul_f32 v98, v98, v6
    v_mul_f32 v99, v99, v6
    v_mfma_f32_16x16x32_bf16 v[20:23], v[236:239], v[100:103], v[20:23]
    v_cvt_pk_bf16_f32 v87, v98, v99
    v_mul_f32 v36, v36, v6
    v_mfma_f32_16x16x32_bf16 v[20:23], v[240:243], v[92:95], v[20:23]
    ds_write_b128 v135, v[84:87] offset:3072
    v_mfma_f32_16x16x32_bf16 v[20:23], v[244:247], v[88:91], v[20:23]
    buffer_store_dwordx4 v[80:83], v124, s[28:31], s59 offen sc1
    v_mul_f32 v37, v37, v6
    v_cvt_pk_bf16_f32 v36, v36, v37
    v_mul_f32 v38, v38, v6
    v_mul_f32 v39, v39, v6
    v_mfma_f32_16x16x32_bf16 v[20:23], v[248:251], v[76:79], v[20:23]
    v_cvt_pk_bf16_f32 v37, v38, v39
    v_mul_f32 v72, v72, v4
    v_mfma_f32_16x16x32_bf16 v[20:23], v[252:255], v[40:43], v[20:23]
    s_waitcnt lgkmcnt(1)
    ds_write_b64 v134, v[36:37] offset:3072
    v_mfma_f32_16x16x32_bf16 v[36:39], a[216:219], v[64:67], 0
    v_mul_f32 v73, v73, v4
    v_cvt_pk_bf16_f32 v40, v72, v73
    v_mfma_f32_16x16x32_bf16 v[36:39], a[220:223], v[60:63], v[36:39]
    v_mul_f32 v74, v74, v4
    v_mul_f32 v75, v75, v4
    v_mfma_f32_16x16x32_bf16 v[36:39], a[224:227], v[56:59], v[36:39]
    v_cvt_pk_bf16_f32 v41, v74, v75
    v_mul_f32 v48, v48, v4
    v_mfma_f32_16x16x32_bf16 v[36:39], a[228:231], v[44:47], v[36:39]
    v_mul_f32 v49, v49, v4
    v_cvt_pk_bf16_f32 v42, v48, v49
    v_mfma_f32_16x16x32_bf16 v[36:39], a[232:235], v[32:35], v[36:39]
    v_mul_f32 v50, v50, v4
    v_mul_f32 v51, v51, v4
    v_mfma_f32_16x16x32_bf16 v[36:39], a[236:239], v[24:27], v[36:39]
    v_cvt_pk_bf16_f32 v43, v50, v51
    v_mul_f32 v68, v68, v4
    v_mfma_f32_16x16x32_bf16 v[48:51], a[240:243], v[64:67], 0
    ds_write_b128 v135, v[40:43] offset:0
    v_mfma_f32_16x16x32_bf16 v[48:51], a[244:247], v[60:63], v[48:51]
    v_mul_f32 v69, v69, v4
    v_cvt_pk_bf16_f32 v6, v68, v69
    v_mfma_f32_16x16x32_bf16 v[48:51], a[248:251], v[56:59], v[48:51]
    v_mul_f32 v70, v70, v4
    v_mul_f32 v71, v71, v4
    v_mfma_f32_16x16x32_bf16 v[48:51], a[252:255], v[44:47], v[48:51]
    v_cvt_pk_bf16_f32 v7, v70, v71
    v_fma_f32 v11, v16, v16, s42
    v_mfma_f32_16x16x32_bf16 v[48:51], v[224:227], v[32:35], v[48:51]
    ds_write_b64 v134, v[6:7] offset:0
    v_mfma_f32_16x16x32_bf16 v[48:51], v[228:231], v[24:27], v[48:51]
    v_fmac_f32 v11, v17, v17
    v_fmac_f32 v11, v18, v18
    v_mfma_f32_16x16x32_bf16 v[40:43], v[232:235], v[64:67], 0
    v_fmac_f32 v11, v19, v19
    v_fmac_f32 v11, v28, v28
    v_mfma_f32_16x16x32_bf16 v[40:43], v[236:239], v[60:63], v[40:43]
    v_fmac_f32 v11, v29, v29
    v_fmac_f32 v11, v30, v30
    v_mfma_f32_16x16x32_bf16 v[40:43], v[240:243], v[56:59], v[40:43]
    v_fmac_f32 v11, v31, v31
    v_fmac_f32 v11, v20, v20
    v_mfma_f32_16x16x32_bf16 v[40:43], v[244:247], v[44:47], v[40:43]
    v_fmac_f32 v11, v21, v21
    v_fmac_f32 v11, v22, v22
    v_mfma_f32_16x16x32_bf16 v[40:43], v[248:251], v[32:35], v[40:43]
    v_fmac_f32 v11, v23, v23
    v_fma_f32 v114, v36, v36, s42
    v_mfma_f32_16x16x32_bf16 v[40:43], v[252:255], v[24:27], v[40:43]
    s_nop 0
    v_fmac_f32 v114, v37, v37
    v_fmac_f32 v114, v38, v38
    v_fmac_f32 v114, v39, v39
    v_fmac_f32 v114, v48, v48
    v_fmac_f32 v114, v49, v49
    v_fmac_f32 v114, v50, v50
    v_fmac_f32 v114, v51, v51
    v_fmac_f32 v114, v40, v40
    v_fmac_f32 v114, v41, v41
    v_fmac_f32 v114, v42, v42
    v_fmac_f32 v114, v43, v43
    v_cvt_pk_bf16_f32 v114, v114, v11
    ds_write_b64 v130, v[114:115] offset:4096
    v_mul_f32 v0, v0, v5
    v_mul_f32 v1, v1, v5
    v_cvt_pk_bf16_f32 v0, v0, v1
    v_mul_f32 v2, v2, v5
    v_mul_f32 v3, v3, v5
    v_cvt_pk_bf16_f32 v1, v2, v3
    v_mul_f32 v52, v52, v5
    v_mul_f32 v53, v53, v5
    v_cvt_pk_bf16_f32 v2, v52, v53
    v_mul_f32 v54, v54, v5
    v_mul_f32 v55, v55, v5
    v_cvt_pk_bf16_f32 v3, v54, v55
    v_mul_f32 v12, v12, v5
    v_mul_f32 v13, v13, v5
    v_cvt_pk_bf16_f32 v114, v12, v13
    v_mul_f32 v14, v14, v5
    v_mul_f32 v15, v15, v5
    v_cvt_pk_bf16_f32 v115, v14, v15
    ds_write_b128 v135, v[0:3] offset:1536
    s_waitcnt lgkmcnt(1)
    s_barrier
    ds_write_b64 v134, v[114:115] offset:1536
    ds_read_b128 v[4:7], v129 offset:4096
    ds_read_b128 v[0:3], v129 offset:5120
    s_waitcnt lgkmcnt(2)
    s_barrier
    s_waitcnt lgkmcnt(1)
    v_mfma_f32_16x16x32_bf16 v[24:27], v[216:219], v[4:7], 0
    s_waitcnt lgkmcnt(0)
    ds_read_b128 v[44:47], v113 offset:0
    ds_read_b128 v[32:35], v113 offset:1024
    v_mfma_f32_16x16x32_bf16 v[24:27], v[216:219], v[0:3], v[24:27]
    s_nop 0
    ds_read_b128 v[12:15], v113 offset:2048
    s_nop 2
    ds_read_b128 v[4:7], v113 offset:3072
    s_nop 1
    v_rsq_f32 v24, v24
    ds_read_b128 v[0:3], v113 offset:4096
    v_mul_f32 v24, s43, v24
    v_mul_f32 v36, v36, v24
    v_mul_f32 v37, v37, v24
    v_cvt_pk_bf16_f32 v36, v36, v37
    v_mul_f32 v38, v38, v24
    v_mul_f32 v39, v39, v24
    v_cvt_pk_bf16_f32 v37, v38, v39
    v_mul_f32 v48, v48, v24
    v_mul_f32 v49, v49, v24
    s_waitcnt lgkmcnt(4)
    buffer_store_dwordx4 v[44:47], v128, s[28:31], s58 offen sc1
    v_cvt_pk_bf16_f32 v38, v48, v49
    v_mul_f32 v50, v50, v24
    v_mul_f32 v51, v51, v24
    v_cvt_pk_bf16_f32 v39, v50, v51
    v_mul_f32 v40, v40, v24
    v_mul_f32 v41, v41, v24
    v_cvt_pk_bf16_f32 v26, v40, v41
    v_mul_f32 v42, v42, v24
    v_mul_f32 v43, v43, v24
    v_cvt_pk_bf16_f32 v27, v42, v43
    ds_write_b128 v112, v[36:39] offset:0
    v_rsq_f32 v25, v25
    s_nop 0
    v_mul_f32 v25, s43, v25
    s_waitcnt lgkmcnt(1)
    buffer_store_dwordx4 v[32:35], v127, s[28:31], s58 offen sc1
    ds_write_b64 v132, v[26:27] offset:0
    v_mul_f32 v16, v16, v25
    v_mul_f32 v17, v17, v25
    v_cvt_pk_bf16_f32 v16, v16, v17
    v_mul_f32 v18, v18, v25
    v_mul_f32 v19, v19, v25
    v_cvt_pk_bf16_f32 v17, v18, v19
    v_mul_f32 v28, v28, v25
    v_mul_f32 v29, v29, v25
    v_cvt_pk_bf16_f32 v18, v28, v29
    v_mul_f32 v30, v30, v25
    v_mul_f32 v31, v31, v25
    v_cvt_pk_bf16_f32 v19, v30, v31
    v_mul_f32 v20, v20, v25
    v_mul_f32 v21, v21, v25
    v_cvt_pk_bf16_f32 v128, v20, v21
    v_mul_f32 v22, v22, v25
    v_mul_f32 v23, v23, v25
    v_cvt_pk_bf16_f32 v129, v22, v23
    buffer_store_dwordx4 v[12:15], v126, s[28:31], s58 offen sc1
    ds_write_b128 v112, v[16:19] offset:1536
    ds_write_b64 v132, v[128:129] offset:1536
    buffer_store_dwordx4 v[4:7], v125, s[28:31], s58 offen sc1
    s_waitcnt lgkmcnt(0)
    s_barrier
    buffer_store_dwordx4 v[0:3], v124, s[28:31], s58 offen sc1
    ds_read_b128 v[12:15], v131 offset:0
    ds_read_b128 v[4:7], v131 offset:1024
    ds_read_b128 v[0:3], v131 offset:2048
    s_waitcnt lgkmcnt(2)
    buffer_store_dwordx4 v[12:15], v8, s[28:31], 0 offen sc1
    s_waitcnt lgkmcnt(0)
    buffer_store_dwordx4 v[4:7], v9, s[28:31], 0 offen sc1
    buffer_store_dwordx4 v[0:3], v10, s[28:31], 0 offen sc1
    s_endpgm
L_maskF:
    s_add_u32 s20, s20, s74
    s_addc_u32 s21, s21, 0
    s_mov_b32 s22, 4802
    s_mov_b32 s23, 0x20000
    s_mov_b32 s85, 0x3fb8aa3b
    s_waitcnt vmcnt(0)
    v_lshrrev_b32 v154, 2, v51
    v_add_u32 v154, 0, v154
    v_mul_u32_u24 v154, 98, v154
    v_mad_u32_u24 v155, v9, 24, v154
    buffer_load_ushort v81, v155, s[20:23], 0 offen offset:0
    buffer_load_ushort v144, v155, s[20:23], 0 offen offset:2
    buffer_load_ushort v31, v155, s[20:23], 0 offen offset:4
    buffer_load_ushort v142, v155, s[20:23], 0 offen offset:6
    buffer_load_ushort v0, v155, s[20:23], 0 offen offset:8
    buffer_load_ushort v43, v155, s[20:23], 0 offen offset:10
    buffer_load_ushort v30, v155, s[20:23], 0 offen offset:12
    buffer_load_ushort v96, v155, s[20:23], 0 offen offset:14
    buffer_load_ushort v49, v155, s[20:23], 0 offen offset:16
    buffer_load_ushort v143, v155, s[20:23], 0 offen offset:18
    buffer_load_ushort v145, v155, s[20:23], 0 offen offset:20
    buffer_load_ushort v42, v155, s[20:23], 0 offen offset:22
    buffer_load_ushort v138, v154, s[20:23], 0 offen offset:96
    s_waitcnt vmcnt(0)
    v_lshlrev_b32 v81, 16, v81
    v_fmac_f32 v204, s85, v81
    v_lshlrev_b32 v144, 16, v144
    v_fmac_f32 v205, s85, v144
    v_lshlrev_b32 v31, 16, v31
    v_fmac_f32 v206, s85, v31
    v_lshlrev_b32 v142, 16, v142
    v_fmac_f32 v207, s85, v142
    v_lshlrev_b32 v0, 16, v0
    v_fmac_f32 v200, s85, v0
    v_lshlrev_b32 v43, 16, v43
    v_fmac_f32 v201, s85, v43
    v_lshlrev_b32 v30, 16, v30
    v_fmac_f32 v202, s85, v30
    v_lshlrev_b32 v96, 16, v96
    v_fmac_f32 v203, s85, v96
    v_lshlrev_b32 v49, 16, v49
    v_fmac_f32 v196, s85, v49
    v_lshlrev_b32 v143, 16, v143
    v_fmac_f32 v197, s85, v143
    v_lshlrev_b32 v145, 16, v145
    v_fmac_f32 v198, s85, v145
    v_lshlrev_b32 v42, 16, v42
    v_fmac_f32 v199, s85, v42
    v_lshlrev_b32 v138, 16, v138
    v_fmac_f32 v208, s85, v138
    v_lshrrev_b32 v154, 2, v51
    v_add_u32 v154, 4, v154
    v_mul_u32_u24 v154, 98, v154
    v_mad_u32_u24 v155, v9, 24, v154
    buffer_load_ushort v81, v155, s[20:23], 0 offen offset:0
    buffer_load_ushort v144, v155, s[20:23], 0 offen offset:2
    buffer_load_ushort v31, v155, s[20:23], 0 offen offset:4
    buffer_load_ushort v142, v155, s[20:23], 0 offen offset:6
    buffer_load_ushort v0, v155, s[20:23], 0 offen offset:8
    buffer_load_ushort v43, v155, s[20:23], 0 offen offset:10
    buffer_load_ushort v30, v155, s[20:23], 0 offen offset:12
    buffer_load_ushort v96, v155, s[20:23], 0 offen offset:14
    buffer_load_ushort v49, v155, s[20:23], 0 offen offset:16
    buffer_load_ushort v143, v155, s[20:23], 0 offen offset:18
    buffer_load_ushort v145, v155, s[20:23], 0 offen offset:20
    buffer_load_ushort v42, v155, s[20:23], 0 offen offset:22
    buffer_load_ushort v138, v154, s[20:23], 0 offen offset:96
    s_waitcnt vmcnt(0)
    v_lshlrev_b32 v81, 16, v81
    v_fmac_f32 v192, s85, v81
    v_lshlrev_b32 v144, 16, v144
    v_fmac_f32 v193, s85, v144
    v_lshlrev_b32 v31, 16, v31
    v_fmac_f32 v194, s85, v31
    v_lshlrev_b32 v142, 16, v142
    v_fmac_f32 v195, s85, v142
    v_lshlrev_b32 v0, 16, v0
    v_fmac_f32 v188, s85, v0
    v_lshlrev_b32 v43, 16, v43
    v_fmac_f32 v189, s85, v43
    v_lshlrev_b32 v30, 16, v30
    v_fmac_f32 v190, s85, v30
    v_lshlrev_b32 v96, 16, v96
    v_fmac_f32 v191, s85, v96
    v_lshlrev_b32 v49, 16, v49
    v_fmac_f32 v184, s85, v49
    v_lshlrev_b32 v143, 16, v143
    v_fmac_f32 v185, s85, v143
    v_lshlrev_b32 v145, 16, v145
    v_fmac_f32 v186, s85, v145
    v_lshlrev_b32 v42, 16, v42
    v_fmac_f32 v187, s85, v42
    v_lshlrev_b32 v138, 16, v138
    v_fmac_f32 v209, s85, v138
    v_lshrrev_b32 v154, 2, v51
    v_add_u32 v154, 8, v154
    v_mul_u32_u24 v154, 98, v154
    v_mad_u32_u24 v155, v9, 24, v154
    buffer_load_ushort v81, v155, s[20:23], 0 offen offset:0
    buffer_load_ushort v144, v155, s[20:23], 0 offen offset:2
    buffer_load_ushort v31, v155, s[20:23], 0 offen offset:4
    buffer_load_ushort v142, v155, s[20:23], 0 offen offset:6
    buffer_load_ushort v0, v155, s[20:23], 0 offen offset:8
    buffer_load_ushort v43, v155, s[20:23], 0 offen offset:10
    buffer_load_ushort v30, v155, s[20:23], 0 offen offset:12
    buffer_load_ushort v96, v155, s[20:23], 0 offen offset:14
    buffer_load_ushort v49, v155, s[20:23], 0 offen offset:16
    buffer_load_ushort v143, v155, s[20:23], 0 offen offset:18
    buffer_load_ushort v145, v155, s[20:23], 0 offen offset:20
    buffer_load_ushort v42, v155, s[20:23], 0 offen offset:22
    buffer_load_ushort v138, v154, s[20:23], 0 offen offset:96
    s_waitcnt vmcnt(0)
    v_lshlrev_b32 v81, 16, v81
    v_fmac_f32 v180, s85, v81
    v_lshlrev_b32 v144, 16, v144
    v_fmac_f32 v181, s85, v144
    v_lshlrev_b32 v31, 16, v31
    v_fmac_f32 v182, s85, v31
    v_lshlrev_b32 v142, 16, v142
    v_fmac_f32 v183, s85, v142
    v_lshlrev_b32 v0, 16, v0
    v_fmac_f32 v176, s85, v0
    v_lshlrev_b32 v43, 16, v43
    v_fmac_f32 v177, s85, v43
    v_lshlrev_b32 v30, 16, v30
    v_fmac_f32 v178, s85, v30
    v_lshlrev_b32 v96, 16, v96
    v_fmac_f32 v179, s85, v96
    v_lshlrev_b32 v49, 16, v49
    v_fmac_f32 v172, s85, v49
    v_lshlrev_b32 v143, 16, v143
    v_fmac_f32 v173, s85, v143
    v_lshlrev_b32 v145, 16, v145
    v_fmac_f32 v174, s85, v145
    v_lshlrev_b32 v42, 16, v42
    v_fmac_f32 v175, s85, v42
    v_lshlrev_b32 v138, 16, v138
    v_fmac_f32 v210, s85, v138
    v_lshrrev_b32 v154, 2, v51
    v_lshl_add_u32 v154, v9, 2, v154
    v_cmp_gt_u32 vcc, 3, v9
    v_mov_b32 v155, 48
    s_nop 1
    v_cndmask_b32 v154, v155, v154, vcc
    v_add_u32 v154, 2352, v154
    v_lshlrev_b32 v154, 1, v154
    buffer_load_ushort v81, v154, s[20:23], 0 offen
    s_waitcnt vmcnt(0)
    v_lshlrev_b32 v81, 16, v81
    v_fmac_f32 v211, s85, v81
    s_branch L_nomaskF
L_bndF:
    s_movk_i32 s73, 24
    s_sub_u32 s70, s70, 20
    s_cmp_lt_u32 s2, 247
    s_cbranch_scc1 L_bndrF
    s_movk_i32 s73, 20
    s_movk_i32 s71, 18
    s_movk_i32 s70, -20
    s_mov_b32 s74, 0
    s_cmp_lt_u32 s2, 251
    s_cbranch_scc1 L_bndcF
    s_sub_u32 s94, s2, 251
    s_mul_i32 s69, s94, 18
    s_mov_b32 s74, 25239312
    s_sub_u32 s93, s93, 1373568
    v_cmp_le_u32 vcc, 4, v89
    v_add_u32 v66, 98896896, v128
    v_subrev_u32 v67, 1373568, v128
    v_cndmask_b32 v128, v66, v67, vcc
    v_cmp_le_u32 vcc, 4, v4
    v_add_u32 v66, 98896896, v127
    v_subrev_u32 v67, 1373568, v127
    v_cndmask_b32 v127, v66, v67, vcc
    v_cmp_le_u32 vcc, 4, v27
    v_add_u32 v66, 98896896, v126
    v_subrev_u32 v67, 1373568, v126
    v_cndmask_b32 v126, v66, v67, vcc
    v_cmp_le_u32 vcc, 4, v0
    v_add_u32 v66, 98896896, v125
    v_subrev_u32 v67, 1373568, v125
    v_cndmask_b32 v125, v66, v67, vcc
    v_cmp_le_u32 vcc, 4, v18
    v_add_u32 v66, 98896896, v124
    v_subrev_u32 v67, 1373568, v124
    v_cndmask_b32 v124, v66, v67, vcc
    s_cmp_lt_u32 s2, 255
    s_cbranch_scc1 L_bndrF
L_bndcF:
    s_sub_u32 s94, s2, 247
    s_mul_i32 s69, s94, 18
    s_mov_b32 s62, 1373568
    s_add_u32 s74, s74, 345744
    s_sub_u32 s93, s93, 2688
    v_mad_i32_i24 v66, v89, -7, v64
    v_cmp_le_u32 vcc, 4, v66
    v_add_u32 v66, 193536, v128
    v_subrev_u32 v67, 2688, v128
    v_cndmask_b32 v128, v66, v67, vcc
    v_mad_i32_i24 v66, v4, -7, v16
    v_cmp_le_u32 vcc, 4, v66
    v_add_u32 v66, 193536, v127
    v_subrev_u32 v67, 2688, v127
    v_cndmask_b32 v127, v66, v67, vcc
    v_mad_i32_i24 v66, v27, -7, v26
    v_cmp_le_u32 vcc, 4, v66
    v_add_u32 v66, 193536, v126
    v_subrev_u32 v67, 2688, v126
    v_cndmask_b32 v126, v66, v67, vcc
    v_mad_i32_i24 v66, v0, -7, v88
    v_cmp_le_u32 vcc, 4, v66
    v_add_u32 v66, 193536, v125
    v_subrev_u32 v67, 2688, v125
    v_cndmask_b32 v125, v66, v67, vcc
    v_mad_i32_i24 v66, v18, -7, v8
    v_cmp_le_u32 vcc, 4, v66
    v_add_u32 v66, 193536, v124
    v_subrev_u32 v67, 2688, v124
    v_cndmask_b32 v124, v66, v67, vcc
    s_cmp_eq_u32 s2, 255
    s_cselect_b32 s62, 0, s62
    s_cselect_b32 s69, 0, s69
    s_cselect_b32 s71, 2, s71
    s_branch L_bndrF
L_bndS:
    s_movk_i32 s73, 24
    s_sub_u32 s70, s70, 20
    s_cmp_lt_u32 s2, 247
    s_cbranch_scc1 L_bndrS
    s_movk_i32 s73, 20
    s_movk_i32 s71, 18
    s_movk_i32 s70, -20
    s_mov_b32 s74, 0
    s_cmp_lt_u32 s2, 251
    s_cbranch_scc1 L_bndcS
    s_sub_u32 s94, s2, 251
    s_mul_i32 s69, s94, 18
    s_mov_b32 s74, 25239312
    s_sub_u32 s93, s93, 1373568
    v_cmp_le_u32 vcc, 4, v11
    v_add_u32 v26, 98896896, v128
    v_subrev_u32 v27, 1373568, v128
    v_cndmask_b32 v128, v26, v27, vcc
    v_cmp_le_u32 vcc, 4, v6
    v_add_u32 v26, 98896896, v127
    v_subrev_u32 v27, 1373568, v127
    v_cndmask_b32 v127, v26, v27, vcc
    v_cmp_le_u32 vcc, 4, v18
    v_add_u32 v26, 98896896, v126
    v_subrev_u32 v27, 1373568, v126
    v_cndmask_b32 v126, v26, v27, vcc
    v_cmp_le_u32 vcc, 4, v4
    v_add_u32 v26, 98896896, v125
    v_subrev_u32 v27, 1373568, v125
    v_cndmask_b32 v125, v26, v27, vcc
    v_cmp_le_u32 vcc, 4, v7
    v_add_u32 v26, 98896896, v124
    v_subrev_u32 v27, 1373568, v124
    v_cndmask_b32 v124, v26, v27, vcc
    s_cmp_lt_u32 s2, 255
    s_cbranch_scc1 L_bndrS
L_bndcS:
    s_sub_u32 s94, s2, 247
    s_mul_i32 s69, s94, 18
    s_mov_b32 s62, 1373568
    s_add_u32 s74, s74, 345744
    s_sub_u32 s93, s93, 2688
    v_mad_i32_i24 v26, v11, -7, v129
    v_cmp_le_u32 vcc, 4, v26
    v_add_u32 v26, 193536, v128
    v_subrev_u32 v27, 2688, v128
    v_cndmask_b32 v128, v26, v27, vcc
    v_mad_i32_i24 v26, v6, -7, v31
    v_cmp_le_u32 vcc, 4, v26
    v_add_u32 v26, 193536, v127
    v_subrev_u32 v27, 2688, v127
    v_cndmask_b32 v127, v26, v27, vcc
    v_mad_i32_i24 v26, v18, -7, v163
    v_cmp_le_u32 vcc, 4, v26
    v_add_u32 v26, 193536, v126
    v_subrev_u32 v27, 2688, v126
    v_cndmask_b32 v126, v26, v27, vcc
    v_mad_i32_i24 v26, v4, -7, v25
    v_cmp_le_u32 vcc, 4, v26
    v_add_u32 v26, 193536, v125
    v_subrev_u32 v27, 2688, v125
    v_cndmask_b32 v125, v26, v27, vcc
    v_mad_i32_i24 v26, v7, -7, v156
    v_cmp_le_u32 vcc, 4, v26
    v_add_u32 v26, 193536, v124
    v_subrev_u32 v27, 2688, v124
    v_cndmask_b32 v124, v26, v27, vcc
    s_cmp_eq_u32 s2, 255
    s_cselect_b32 s62, 0, s62
    s_cselect_b32 s69, 0, s69
    s_cselect_b32 s71, 2, s71
    s_branch L_bndrS
L_maskS:
    s_add_u32 s20, s20, s74
    s_addc_u32 s21, s21, 0
    s_mov_b32 s22, 4802
    s_mov_b32 s23, 0x20000
    s_mov_b32 s85, 0x3fb8aa3b
    s_waitcnt vmcnt(0)
    v_lshrrev_b32 v160, 2, v76
    v_add_u32 v160, 0, v160
    v_mul_u32_u24 v160, 98, v160
    v_mad_u32_u24 v161, v5, 24, v160
    buffer_load_ushort v79, v161, s[20:23], 0 offen offset:0
    buffer_load_ushort v3, v161, s[20:23], 0 offen offset:2
    buffer_load_ushort v2, v161, s[20:23], 0 offen offset:4
    buffer_load_ushort v1, v161, s[20:23], 0 offen offset:6
    buffer_load_ushort v4, v161, s[20:23], 0 offen offset:8
    buffer_load_ushort v166, v161, s[20:23], 0 offen offset:10
    buffer_load_ushort v164, v161, s[20:23], 0 offen offset:12
    buffer_load_ushort v162, v161, s[20:23], 0 offen offset:14
    buffer_load_ushort v165, v161, s[20:23], 0 offen offset:16
    buffer_load_ushort v0, v161, s[20:23], 0 offen offset:18
    buffer_load_ushort v158, v161, s[20:23], 0 offen offset:20
    buffer_load_ushort v77, v161, s[20:23], 0 offen offset:22
    buffer_load_ushort v157, v160, s[20:23], 0 offen offset:96
    s_waitcnt vmcnt(0)
    v_lshlrev_b32 v79, 16, v79
    v_fmac_f32 v204, s85, v79
    v_lshlrev_b32 v3, 16, v3
    v_fmac_f32 v205, s85, v3
    v_lshlrev_b32 v2, 16, v2
    v_fmac_f32 v206, s85, v2
    v_lshlrev_b32 v1, 16, v1
    v_fmac_f32 v207, s85, v1
    v_lshlrev_b32 v4, 16, v4
    v_fmac_f32 v200, s85, v4
    v_lshlrev_b32 v166, 16, v166
    v_fmac_f32 v201, s85, v166
    v_lshlrev_b32 v164, 16, v164
    v_fmac_f32 v202, s85, v164
    v_lshlrev_b32 v162, 16, v162
    v_fmac_f32 v203, s85, v162
    v_lshlrev_b32 v165, 16, v165
    v_fmac_f32 v196, s85, v165
    v_lshlrev_b32 v0, 16, v0
    v_fmac_f32 v197, s85, v0
    v_lshlrev_b32 v158, 16, v158
    v_fmac_f32 v198, s85, v158
    v_lshlrev_b32 v77, 16, v77
    v_fmac_f32 v199, s85, v77
    v_lshlrev_b32 v157, 16, v157
    v_fmac_f32 v208, s85, v157
    v_lshrrev_b32 v160, 2, v76
    v_add_u32 v160, 4, v160
    v_mul_u32_u24 v160, 98, v160
    v_mad_u32_u24 v161, v5, 24, v160
    buffer_load_ushort v79, v161, s[20:23], 0 offen offset:0
    buffer_load_ushort v3, v161, s[20:23], 0 offen offset:2
    buffer_load_ushort v2, v161, s[20:23], 0 offen offset:4
    buffer_load_ushort v1, v161, s[20:23], 0 offen offset:6
    buffer_load_ushort v4, v161, s[20:23], 0 offen offset:8
    buffer_load_ushort v166, v161, s[20:23], 0 offen offset:10
    buffer_load_ushort v164, v161, s[20:23], 0 offen offset:12
    buffer_load_ushort v162, v161, s[20:23], 0 offen offset:14
    buffer_load_ushort v165, v161, s[20:23], 0 offen offset:16
    buffer_load_ushort v0, v161, s[20:23], 0 offen offset:18
    buffer_load_ushort v158, v161, s[20:23], 0 offen offset:20
    buffer_load_ushort v77, v161, s[20:23], 0 offen offset:22
    buffer_load_ushort v157, v160, s[20:23], 0 offen offset:96
    s_waitcnt vmcnt(0)
    v_lshlrev_b32 v79, 16, v79
    v_fmac_f32 v192, s85, v79
    v_lshlrev_b32 v3, 16, v3
    v_fmac_f32 v193, s85, v3
    v_lshlrev_b32 v2, 16, v2
    v_fmac_f32 v194, s85, v2
    v_lshlrev_b32 v1, 16, v1
    v_fmac_f32 v195, s85, v1
    v_lshlrev_b32 v4, 16, v4
    v_fmac_f32 v188, s85, v4
    v_lshlrev_b32 v166, 16, v166
    v_fmac_f32 v189, s85, v166
    v_lshlrev_b32 v164, 16, v164
    v_fmac_f32 v190, s85, v164
    v_lshlrev_b32 v162, 16, v162
    v_fmac_f32 v191, s85, v162
    v_lshlrev_b32 v165, 16, v165
    v_fmac_f32 v184, s85, v165
    v_lshlrev_b32 v0, 16, v0
    v_fmac_f32 v185, s85, v0
    v_lshlrev_b32 v158, 16, v158
    v_fmac_f32 v186, s85, v158
    v_lshlrev_b32 v77, 16, v77
    v_fmac_f32 v187, s85, v77
    v_lshlrev_b32 v157, 16, v157
    v_fmac_f32 v209, s85, v157
    v_lshrrev_b32 v160, 2, v76
    v_add_u32 v160, 8, v160
    v_mul_u32_u24 v160, 98, v160
    v_mad_u32_u24 v161, v5, 24, v160
    buffer_load_ushort v79, v161, s[20:23], 0 offen offset:0
    buffer_load_ushort v3, v161, s[20:23], 0 offen offset:2
    buffer_load_ushort v2, v161, s[20:23], 0 offen offset:4
    buffer_load_ushort v1, v161, s[20:23], 0 offen offset:6
    buffer_load_ushort v4, v161, s[20:23], 0 offen offset:8
    buffer_load_ushort v166, v161, s[20:23], 0 offen offset:10
    buffer_load_ushort v164, v161, s[20:23], 0 offen offset:12
    buffer_load_ushort v162, v161, s[20:23], 0 offen offset:14
    buffer_load_ushort v165, v161, s[20:23], 0 offen offset:16
    buffer_load_ushort v0, v161, s[20:23], 0 offen offset:18
    buffer_load_ushort v158, v161, s[20:23], 0 offen offset:20
    buffer_load_ushort v77, v161, s[20:23], 0 offen offset:22
    buffer_load_ushort v157, v160, s[20:23], 0 offen offset:96
    s_waitcnt vmcnt(0)
    v_lshlrev_b32 v79, 16, v79
    v_fmac_f32 v180, s85, v79
    v_lshlrev_b32 v3, 16, v3
    v_fmac_f32 v181, s85, v3
    v_lshlrev_b32 v2, 16, v2
    v_fmac_f32 v182, s85, v2
    v_lshlrev_b32 v1, 16, v1
    v_fmac_f32 v183, s85, v1
    v_lshlrev_b32 v4, 16, v4
    v_fmac_f32 v176, s85, v4
    v_lshlrev_b32 v166, 16, v166
    v_fmac_f32 v177, s85, v166
    v_lshlrev_b32 v164, 16, v164
    v_fmac_f32 v178, s85, v164
    v_lshlrev_b32 v162, 16, v162
    v_fmac_f32 v179, s85, v162
    v_lshlrev_b32 v165, 16, v165
    v_fmac_f32 v172, s85, v165
    v_lshlrev_b32 v0, 16, v0
    v_fmac_f32 v173, s85, v0
    v_lshlrev_b32 v158, 16, v158
    v_fmac_f32 v174, s85, v158
    v_lshlrev_b32 v77, 16, v77
    v_fmac_f32 v175, s85, v77
    v_lshlrev_b32 v157, 16, v157
    v_fmac_f32 v210, s85, v157
    v_lshrrev_b32 v160, 2, v76
    v_lshl_add_u32 v160, v5, 2, v160
    v_cmp_gt_u32 vcc, 3, v5
    v_mov_b32 v161, 48
    s_nop 1
    v_cndmask_b32 v160, v161, v160, vcc
    v_add_u32 v160, 2352, v160
    v_lshlrev_b32 v160, 1, v160
    buffer_load_ushort v79, v160, s[20:23], 0 offen
    s_waitcnt vmcnt(0)
    v_lshlrev_b32 v79, 16, v79
    v_fmac_f32 v211, s85, v79
    s_branch L_nomaskS
L_atomS0:
    v_mov_b32 v122, 0x800000
    buffer_atomic_add v122, v129, s[8:11], 0 offen sc0 sc1
    s_branch L_atomS0r
.section .rodata,"a"
.p2align 6
.amdhsa_kernel standalone__window_attn_swin_v2__vision_kernel
  .amdhsa_next_free_vgpr 512
  .amdhsa_next_free_sgpr 102
  .amdhsa_accum_offset 256
  .amdhsa_group_segment_fixed_size 0
  .amdhsa_kernarg_size 96
  .amdhsa_user_sgpr_count 2
  .amdhsa_user_sgpr_kernarg_segment_ptr 1
  .amdhsa_system_sgpr_workgroup_id_x 1
.end_amdhsa_kernel
```

```asm
; @launch grid=(256,1,1) block=(256,1,1) lds=163840
.amdgcn_target "amdgcn-amd-amdhsa--gfx950"
.text
.globl standalone__window_attn_swin_v2__vision_kernel
.p2align 8
.type standalone__window_attn_swin_v2__vision_kernel,@function
standalone__window_attn_swin_v2__vision_kernel:
    v_lshrrev_b32 v0, 6, v0
    s_cmp_ge_u32 s2, 256
    s_cbranch_scc1 L_end
    v_readfirstlane_b32 s68, v0
L_top:
    s_mov_b32 s64, 0
    s_nop 0
    v_mbcnt_lo_u32_b32 v2, -1, 0
    v_mbcnt_hi_u32_b32 v2, -1, v2
    s_load_dwordx16 s[4:19], s[0:1], 0
    s_load_dwordx4 s[20:23], s[0:1], 64
    s_load_dwordx2 s[38:39], s[0:1], 80
    s_bfe_u32 s88, s2, 0x50003
    s_lshl2_add_u32 s88, s88, s68
    v_lshlrev_b32 v1, 7, v2
    s_getpc_b64 s[80:81]
    s_mul_i32 s84, s88, 288
    v_min_u32 v0, 256, v1
    v_add_u32 v0, s84, v0
    v_min_u32 v0, L_slow-standalone__window_attn_swin_v2__vision_kernel-256, v0
    s_mul_i32 s89, s88, 576
    s_mul_i32 s88, s88, 1728
    global_load_dword a255, v0, s[80:81]
    v_min_u32 v0, 1664, v1
    v_min_u32 v8, 512, v1
    s_mov_b32 s34, 221184
    s_mov_b32 s35, 0x20000
    s_mov_b32 s78, 73728
    s_mov_b32 s79, 0x20000
    v_and_b32 v9, 15, v2
    v_lshrrev_b32 v49, 4, v2
    v_lshrrev_b32 v10, 2, v9
    v_and_b32 v131, 3, v9
    s_mul_i32 s87, s68, 192
    v_mad_u32_u24 v11, v9, 12, s87
    v_lshlrev_b32 v35, 1, v9
    v_lshlrev_b32 v75, 1, v10
    v_lshl_add_u32 v75, v49, 5, v75
    s_movk_i32 s86, 384
    s_mov_b32 s26, 100270464
    s_mov_b32 s27, 0x20000
    s_mov_b32 s30, 0
    s_mov_b32 s31, 0x20000
    s_waitcnt lgkmcnt(0)
    s_mov_b32 s24, s4
    s_mov_b32 s25, s5
    s_mov_b32 s32, s6
    s_mov_b32 s33, s7
    s_mov_b32 s76, s8
    s_mov_b32 s77, s9
    buffer_load_dword a254, v0, s[32:35], s88 offen
    buffer_load_dword a253, v8, s[76:79], s89 offen
    s_load_dwordx2 s[82:83], s[10:11], 0
    s_movk_i32 s18, 676
    s_mov_b32 s19, 0x20000
    buffer_load_dwordx3 v[32:34], v11, s[16:19], 0 offen
    s_mul_i32 s96, s68, 288
    s_and_b32 s97, s68, 1
    s_lshl_b32 s97, s97, 2
    s_mov_b32 s98, 193536
    s_mov_b32 s99, 589824
    global_load_ushort v20, v35, s[12:13]
    v_add_u32 v8, s96, v2
    v_mul_u32_u24 v96, 2731, v8
    v_mul_u32_u24 v129, 6242, v8
    v_lshrrev_b32 v96, 16, v96
    v_lshrrev_b32 v129, 20, v129
    s_lshr_b32 s94, s2, 3
    s_mul_i32 s70, s94, 167
    global_load_ushort v21, v35, s[12:13] offset:32
    v_and_or_b32 v72, v96, 3, s97
    v_xor_b32 v72, v8, v72
    v_lshl_add_u32 v128, v72, 4, s99
    v_mad_u32_u24 v128, v129, s98, v128
    v_add_u32 v74, 64, v8
    s_min_u32 s95, s94, 7
    s_add_u32 s70, s70, s95
    global_load_ushort v98, v75, s[14:15] offset:0
    v_mul_u32_u24 v73, 2731, v74
    v_mul_u32_u24 v23, 6242, v74
    v_lshrrev_b32 v73, 16, v73
    v_lshrrev_b32 v23, 20, v23
    v_and_or_b32 v22, v73, 3, s97
    s_and_b32 s95, s2, 7
    s_mul_i32 s95, s95, 20
    global_load_ushort v35, v75, s[14:15] offset:8
    v_xor_b32 v22, v74, v22
    v_lshl_add_u32 v127, v22, 4, s99
    v_mad_u32_u24 v127, v23, s98, v127
    v_add_u32 v130, 128, v8
    v_mul_u32_u24 v97, 2731, v130
    s_add_u32 s69, s70, s95
    s_add_u32 s70, s70, 140
    global_load_ushort v99, v75, s[14:15] offset:16
    v_mul_u32_u24 v3, 6242, v130
    v_lshrrev_b32 v97, 16, v97
    v_lshrrev_b32 v3, 20, v3
    v_and_or_b32 v74, v97, 3, s97
    v_xor_b32 v74, v130, v74
    s_movk_i32 s62, 2688
    s_movk_i32 s71, 20
    global_load_ushort v29, v75, s[14:15] offset:24
    v_lshl_add_u32 v126, v74, 4, s99
    v_mad_u32_u24 v126, v3, s98, v126
    v_add_u32 v0, 192, v8
    v_mul_u32_u24 v75, 2731, v0
    v_mul_u32_u24 v130, 6242, v0
    v_lshrrev_b32 v75, 16, v75
    v_lshrrev_b32 v130, 20, v130
    v_and_or_b32 v1, v75, 3, s97
    v_xor_b32 v1, v0, v1
    v_lshl_add_u32 v125, v1, 4, s99
    v_mad_u32_u24 v125, v130, s98, v125
    v_add_u32 v124, 256, v8
    v_mul_u32_u24 v8, 2731, v124
    v_mul_u32_u24 v28, 6242, v124
    v_lshrrev_b32 v8, 16, v8
    v_lshrrev_b32 v28, 20, v28
    v_and_or_b32 v0, v8, 3, s97
    v_xor_b32 v0, v124, v0
    v_lshl_add_u32 v124, v0, 4, s99
    v_mad_u32_u24 v124, v28, s98, v124
    s_cmp_lt_u32 s94, 7
    s_cselect_b32 s73, 28, 27
    s_mov_b32 s93, 1769472
    s_mul_i32 s54, s68, 5120
    s_cmp_ge_u32 s2, 248
    s_cbranch_scc1 L_bndF
L_bndrF:
    s_mov_b32 s63, 1180032
    s_mul_i32 s94, s69, 58255
    s_lshr_b32 s94, s94, 22
    s_mul_i32 s94, s94, s63
    s_mul_i32 s72, s69, s62
    s_add_u32 s72, s72, s94
    v_lshl_or_b32 v8, v2, 4, 2.0
    s_sub_u32 s94, s73, 1
    s_max_u32 s94, s94, 20
    s_mul_i32 s95, s68, -44
    s_movk_i32 s99, -24
    s_add_u32 m0, s54, 0
    v_and_b32 v75, -4, v97
    s_mul_i32 s85, s68, 96
    s_sub_u32 s100, s85, 1024
    buffer_load_dwordx4 v128, s[24:27], s72 offen nt lds
    s_add_u32 m0, s54, 1024
    v_mad_u32_u24 v23, v75, 3, v97
    v_add_u32 v23, s95, v23
    v_mad_i32_i24 v74, v97, s99, v74
    v_med3_u32 v75, v23, 20, s94
    v_add_u32 v75, s70, v75
    v_add_u32 v97, s69, v23
    s_sub_u32 s87, s85, 2048
    s_movk_i32 s91, 1152
    buffer_load_dwordx4 v127, s[24:27], s72 offen nt lds
    v_cmp_gt_u32 vcc, s71, v23
    v_lshl_add_u32 v74, v74, 4, s93
    s_add_u32 m0, s54, 43008
    v_cndmask_b32 v97, v75, v97, vcc
    v_mul_u32_u24 v75, 58255, v97
    v_mad_u32_u24 v74, v97, s62, v74
    v_lshrrev_b32 v75, 22, v75
    v_mad_u32_u24 v74, v75, s63, v74
    s_mul_i32 s90, s68, 3072
    s_add_u32 s90, s90, 61440
    buffer_load_dwordx4 v74, s[24:27], 0 offen  lds
    v_lshlrev_b32 v75, 16, v23
    s_add_u32 m0, s54, 2048
    v_and_b32 v23, -4, v73
    v_mad_u32_u24 v97, v23, 3, v73
    v_add_u32 v97, s95, v97
    v_mad_i32_i24 v73, v73, s99, v22
    v_med3_u32 v23, v97, 20, s94
    s_add_u32 s101, s54, 44032
    s_mov_b32 s28, s22
    buffer_load_dwordx4 v126, s[24:27], s72 offen nt lds
    v_add_u32 v23, s70, v23
    v_add_u32 v22, s69, v97
    v_cmp_gt_u32 vcc, s71, v97
    v_lshl_add_u32 v73, v73, 4, s93
    s_add_u32 m0, s54, 41984
    v_cndmask_b32 v22, v23, v22, vcc
    v_mul_u32_u24 v23, 58255, v22
    v_mad_u32_u24 v73, v22, s62, v73
    v_lshrrev_b32 v23, 22, v23
    v_mad_u32_u24 v73, v23, s63, v73
    s_mov_b32 s29, s23
    s_mov_b32 s41, 0x2a8cbccc
    buffer_load_dwordx4 v73, s[24:27], 0 offen  lds
    v_lshl_or_b32 v75, v97, 8, v75
    s_add_u32 m0, s54, 3072
    v_cmp_gt_u32 vcc, 32, v2
    v_and_b32 v23, -4, v96
    v_mad_u32_u24 v22, v23, 3, v96
    v_cndmask_b32 v124, v8, v124, vcc
    v_add_u32 v22, s95, v22
    s_mov_b32 s42, 0x38fba882
    s_mov_b32 s43, 0x415db3d7
    buffer_load_dwordx4 v125, s[24:27], s72 offen nt lds
    s_add_u32 m0, s54, 4096
    v_mad_i32_i24 v72, v96, s99, v72
    v_med3_u32 v23, v22, 20, s94
    v_add_u32 v23, s70, v23
    v_add_u32 v96, s69, v22
    v_cmp_gt_u32 vcc, s71, v22
    v_lshl_add_u32 v72, v72, 4, s93
    s_mul_i32 s93, s68, 6
    s_lshl_b32 s94, s97, 1
    buffer_load_dwordx4 v124, s[24:27], s72 offen nt lds
    v_cndmask_b32 v96, v23, v96, vcc
    v_mul_u32_u24 v23, 58255, v96
    v_mad_u32_u24 v72, v96, s62, v72
    v_lshrrev_b32 v23, 22, v23
    v_mad_u32_u24 v72, v23, s63, v72
    s_add_u32 m0, s54, 40960
    v_lshl_or_b32 v75, v22, 0, v75
    s_mov_b32 s44, 61440
    s_mov_b32 s45, 40960
    buffer_load_dwordx4 v72, s[24:27], 0 offen nt lds
    v_mul_u32_u24 v51, 10923, v2
    v_lshrrev_b32 v48, 17, v51
    v_lshrrev_b32 v51, 16, v51
    v_mad_i32_i24 v50, v51, -6, v2
    v_bitop3_b32 v48, v48, v51, 4 bitop3:0x28
    v_lshl_add_u32 v50, v50, 4, s85
    v_mul_u32_u24 v48, 3, v48
    v_xor_b32 v51, v51, v48
    v_mad_u32_u24 v48, v51, s91, v50
    v_add_u32 v23, 64, v2
    v_mul_u32_u24 v22, 10923, v23
    v_lshrrev_b32 v139, 17, v22
    v_lshrrev_b32 v22, 16, v22
    v_mad_i32_i24 v23, v22, -6, v23
    v_bitop3_b32 v139, v139, v22, 4 bitop3:0x28
    v_lshl_add_u32 v23, v23, 4, s100
    v_mul_u32_u24 v139, 3, v139
    v_xor_b32 v22, v22, v139
    v_mad_u32_u24 v139, v22, s91, v23
    v_add_u32 v1, 128, v2
    v_mul_u32_u24 v3, 10923, v1
    v_lshrrev_b32 v0, 17, v3
    v_lshrrev_b32 v3, 16, v3
    v_mad_i32_i24 v1, v3, -6, v1
    v_bitop3_b32 v0, v0, v3, 4 bitop3:0x28
    v_lshl_add_u32 v1, v1, 4, s87
    v_mul_u32_u24 v0, 3, v0
    v_xor_b32 v3, v3, v0
    v_mad_u32_u24 v0, v3, s91, v1
    v_mad_u32_u24 v4, v51, s86, v50
    v_mad_u32_u24 v120, v22, s86, v23
    v_mad_u32_u24 v28, v3, s86, v1
    s_add_u32 m0, s90, 0
    s_mov_b32 s92, 0
    buffer_load_dwordx4 v48, s[32:35], s92 offen offset:0 lds
    v_lshrrev_b32 v3, 1, v49
    v_lshl_add_u32 v1, v49, 2, v10
    v_lshl_add_u32 v1, v3, 3, v1
    v_mul_u32_u24 v1, 96, v1
    v_add_u32 v1, s90, v1
    v_lshl_add_u32 v138, v131, 4, v1
    v_lshl_add_u32 v5, v131, 3, v1
    v_mov_b32 v1, 0x3f803f80
    v_cmp_eq_u32 vcc, 0, v131
    v_and_b32 v3, 1, v2
    v_lshlrev_b32 v3, 4, v3
    v_cndmask_b32 v220, 0, v1, vcc
    v_cndmask_b32 v221, 0, v1, vcc
    v_cndmask_b32 v222, 0, v1, vcc
    v_cndmask_b32 v223, 0, v1, vcc
    v_mov_b32 v1, 0x3f80
    v_lshlrev_b32 v97, v3, v1
    v_cmp_gt_u32 vcc, 2, v131
    v_mov_b32 v3, 0x44004400
    v_mul_u32_u24 v96, 48, v10
    v_cndmask_b32 v216, 0, v97, vcc
    v_cndmask_b32 v218, 0, v97, vcc
    v_cmp_le_u32 vcc, 2, v131
    v_lshl_add_u32 v96, v131, 2, v96
    v_mul_u32_u24 v1, 48, v49
    v_cndmask_b32 v217, 0, v97, vcc
    v_cndmask_b32 v219, 0, v97, vcc
    v_cmp_eq_u32 vcc, v49, v10
    v_add_u32 v199, 0, v96
    v_mul_u32_u24 v97, 37, v199
    v_cndmask_b32 v50, 0, v216, vcc
    v_cndmask_b32 v51, 0, v217, vcc
    v_cmp_eq_u32 vcc, 0, v131
    v_lshrrev_b32 v97, 10, v97
    v_mad_u32_u24 v199, v97, 24, v199
    v_cndmask_b32 v212, 0, v3, vcc
    v_cmp_eq_u32 vcc, 1, v131
    v_add_u32 v199, s101, v199
    v_add_u32 v187, 16, v96
    v_cndmask_b32 v213, 0, v3, vcc
    v_cmp_eq_u32 vcc, 2, v131
    v_mul_u32_u24 v97, 37, v187
    v_lshrrev_b32 v97, 10, v97
    v_cndmask_b32 v214, 0, v3, vcc
    v_cmp_eq_u32 vcc, 3, v131
    v_mad_u32_u24 v187, v97, 24, v187
    v_add_u32 v187, s101, v187
    v_cndmask_b32 v215, 0, v3, vcc
    v_add_u32 v175, 32, v96
    v_mul_u32_u24 v3, 37, v175
    v_lshrrev_b32 v3, 10, v3
    v_mad_u32_u24 v175, v3, 24, v175
    v_add_u32 v175, s101, v175
    v_add_u32 v204, 0, v1
    v_mul_u32_u24 v3, 37, v204
    v_lshrrev_b32 v3, 10, v3
    v_mad_u32_u24 v204, v3, 24, v204
    v_add_u32 v205, 4, v1
    v_mul_u32_u24 v3, 37, v205
    v_lshrrev_b32 v3, 10, v3
    v_mad_u32_u24 v205, v3, 24, v205
    v_add_u32 v206, 8, v1
    v_mul_u32_u24 v3, 37, v206
    v_lshrrev_b32 v3, 10, v3
    v_mad_u32_u24 v206, v3, 24, v206
    v_add_u32 v207, 12, v1
    v_mul_u32_u24 v3, 37, v207
    v_lshrrev_b32 v3, 10, v3
    v_mad_u32_u24 v207, v3, 24, v207
    v_add_u32 v200, 16, v1
    v_mul_u32_u24 v3, 37, v200
    v_lshrrev_b32 v3, 10, v3
    v_mad_u32_u24 v200, v3, 24, v200
    v_add_u32 v201, 20, v1
    v_mul_u32_u24 v3, 37, v201
    v_lshrrev_b32 v3, 10, v3
    v_mad_u32_u24 v201, v3, 24, v201
    v_add_u32 v202, 24, v1
    v_mul_u32_u24 v3, 37, v202
    v_lshrrev_b32 v3, 10, v3
    v_mad_u32_u24 v202, v3, 24, v202
    v_add_u32 v203, 28, v1
    v_mul_u32_u24 v3, 37, v203
    v_lshrrev_b32 v3, 10, v3
    v_mad_u32_u24 v203, v3, 24, v203
    s_waitcnt lgkmcnt(0)
    s_sext_i32_i16 s84, s82
    s_ashr_i32 s85, s82, 16
    s_max_i32 s84, s84, s85
    s_sext_i32_i16 s85, s83
    s_max_i32 s84, s84, s85
    s_ashr_i32 s85, s83, 16
    s_max_i32 s84, s84, s85
    s_cmp_gt_i32 s84, 16492
    s_cbranch_scc1 L_slow
    s_lshl_b32 s84, s68, 4
    buffer_load_dwordx4 v139, s[32:35], s92 offen offset:1024 lds
    v_add_u32 v31, 32, v1
    v_mul_u32_u24 v3, 37, v31
    v_lshrrev_b32 v3, 10, v3
    v_mad_u32_u24 v31, v3, 24, v31
    v_add_u32 v30, 36, v1
    v_mul_u32_u24 v3, 37, v30
    v_lshrrev_b32 v3, 10, v3
    s_lshr_b64 s[82:83], s[82:83], s84
    s_lshl_b32 s82, s82, 16
    buffer_load_dwordx4 v0, s[32:35], s92 offen offset:2048 lds
    s_add_u32 m0, s90, 12288
    s_mov_b32 s92, 36864
    v_mad_u32_u24 v30, v3, 24, v30
    v_add_u32 v97, 40, v1
    v_mul_u32_u24 v3, 37, v97
    v_lshrrev_b32 v3, 10, v3
    v_mad_u32_u24 v97, v3, 24, v97
    s_mov_b32 s84, 0x41b8aa3b
    s_mov_b32 s46, 20480
    buffer_load_dwordx4 v48, s[32:35], s92 offen offset:0 lds
    v_add_u32 v1, 44, v1
    v_mul_u32_u24 v3, 37, v1
    v_lshrrev_b32 v3, 10, v3
    v_mad_u32_u24 v1, v3, 24, v1
    v_lshl_add_u32 v3, v49, 4, v96
    v_mul_u32_u24 v6, 37, v3
    v_lshrrev_b32 v6, 10, v6
    v_mad_u32_u24 v3, v6, 24, v3
    v_mov_b32 v7, 336
    v_cmp_gt_u32 vcc, 3, v49
    v_mov_b32 v6, s82
    v_min_f32 v6, 0x40930000, v6
    v_cndmask_b32 v3, v7, v3, vcc
    v_sub_u32 v3, s101, v3
    v_max_f32 v6, 0xc2c80000, v6
    s_mov_b32 s47, 0
    s_mov_b32 s57, s72
    buffer_load_dwordx4 v139, s[32:35], s92 offen offset:1024 lds
    v_mul_f32 v6, 0x3fb8aa3b, v6
    v_exp_f32 v6, v6
    s_waitcnt vmcnt(17)
    v_lshl_or_b32 v20, v21, 16, v20
    v_cvt_pk_bf16_f32 v6, v6, v6
    v_lshlrev_b32 v6, 16, v6
    v_mul_f32 v6, 0x4038aa3b, v6
    s_waitcnt vmcnt(15)
    v_lshl_or_b32 v98, v35, 16, v98
    v_readfirstlane_b32 s55, v6
    v_add_f32 v6, v6, v6
    s_waitcnt vmcnt(13)
    v_lshl_or_b32 v99, v29, 16, v99
    v_readfirstlane_b32 s52, v6
    v_cmp_gt_u32 vcc, 16, v2
    v_mov_b32 v21, 0
    v_mov_b32 v22, 0
    v_cndmask_b32 v23, 0, v20, vcc
    v_cndmask_b32 v20, 0, v20, vcc
    v_mov_b32 v35, 0
    v_mfma_f32_16x16x16_bf16 v[12:15], v[22:23], v[32:33], 0
    s_mov_b32 s58, 0
    v_mul_u32_u24 v29, 5120, v49
    v_add_u32 v29, v11, v29
    v_mfma_f32_16x16x16_bf16 v[16:19], v[20:21], v[32:33], 0
    s_mov_b32 s59, 0
    v_mov_b32 v6, 0xc138aa3b
    v_and_b32 v11, 8, v9
    v_mfma_f32_16x16x16_bf16 v[24:27], v[20:21], v[34:35], 0
    s_mov_b32 s60, 0
    v_max_f32 v12, 0, v12
    v_max_f32 v13, 0, v13
    v_max_f32 v14, 0, v14
    v_max_f32 v16, 0, v16
    v_max_f32 v17, 0, v17
    v_max_f32 v18, 0, v18
    v_max_f32 v19, 0, v19
    v_cvt_pk_bf16_f32 v16, v16, v17
    v_cvt_pk_bf16_f32 v17, v18, v19
    v_max_f32 v15, 0, v15
    v_cvt_pk_bf16_f32 v12, v12, v13
    v_mfma_f32_16x16x16_bf16 v[20:23], v[98:99], v[16:17], 0
    s_mov_b32 s65, -1
    v_cvt_pk_bf16_f32 v13, v14, v15
    v_max_f32 v24, 0, v24
    v_max_f32 v25, 0, v25
    v_mfma_f32_16x16x16_bf16 v[16:19], v[98:99], v[12:13], 0
    s_mov_b32 s61, 1
    v_max_f32 v26, 0, v26
    v_max_f32 v27, 0, v27
    v_cvt_pk_bf16_f32 v24, v24, v25
    v_cvt_pk_bf16_f32 v25, v26, v27
    v_cvt_pk_bf16_f32 v20, v20, v20
    v_lshlrev_b32 v20, 16, v20
    v_mfma_f32_16x16x16_bf16 v[12:15], v[98:99], v[24:25], 0
    s_movk_i32 s4, 112
    v_mul_f32 v20, 0xbfb8aa3b, v20
    v_cvt_pk_bf16_f32 v16, v16, v16
    v_exp_f32 v20, v20
    v_lshlrev_b32 v16, 16, v16
    v_add_f32 v20, 1.0, v20
    v_rcp_f32 v20, v20
    v_mul_f32 v16, 0xbfb8aa3b, v16
    v_cvt_pk_bf16_f32 v20, v20, v20
    v_lshlrev_b32 v20, 16, v20
    v_fma_f32 v20, v20, s84, v6
    s_mov_b32 s5, 0
    s_mov_b32 s6, 0
    ds_write_b32 v29, v20 offset:44032
    v_exp_f32 v16, v16
    v_cvt_pk_bf16_f32 v12, v12, v12
    v_add_f32 v16, 1.0, v16
    v_rcp_f32 v16, v16
    v_lshlrev_b32 v12, 16, v12
    v_cvt_pk_bf16_f32 v16, v16, v16
    v_lshlrev_b32 v16, 16, v16
    v_fma_f32 v16, v16, s84, v6
    s_mov_b32 s12, 0
    s_mov_b32 s64, 3
    ds_write_b32 v29, v16 offset:44036
    v_mul_f32 v12, 0xbfb8aa3b, v12
    v_exp_f32 v12, v12
    v_add_u32 v11, v11, v9
    v_add_f32 v12, 1.0, v12
    v_rcp_f32 v12, v12
    v_mul_u32_u24 v11, 96, v11
    v_cvt_pk_bf16_f32 v12, v12, v12
    v_lshlrev_b32 v12, 16, v12
    v_fma_f32 v12, v12, s84, v6
    s_mov_b32 s10, 81924
    s_mov_b32 s11, 0x20000
    ds_write_b32 v29, v12 offset:44040
    v_add_u32 v11, s90, v11
    v_lshl_add_u32 v99, v49, 4, v11
    v_lshl_add_u32 v100, v49, 3, v11
    v_lshlrev_b32 v98, 4, v49
    v_add_u32 v98, 4608, v98
    v_mul_u32_u24 v121, 5120, v10
    v_mad_u32_u24 v121, v131, s86, v121
    v_and_b32 v29, 7, v9
    v_xor_b32 v11, v29, v49
    v_lshl_add_u32 v7, v11, 4, v121
    v_xor_b32 v6, 64, v7
    v_add_u32 v137, 40960, v7
    v_xor_b32 v136, 64, v137
    v_add_u32 v121, 61440, v121
    v_add_u32 v11, s93, v49
    v_xor_b32 v11, v29, v11
    v_lshl_add_u32 v135, v11, 4, v121
    v_lshrrev_b32 v11, 1, v49
    v_add3_u32 v11, v11, s93, 4
    v_xor_b32 v11, v29, v11
    v_lshl_add_u32 v11, v11, 4, v121
    v_and_b32 v121, 1, v49
    v_lshl_add_u32 v134, v121, 3, v11
    v_lshlrev_b32 v11, 4, v2
    s_add_u32 s93, s54, 20480
    v_add_u32 v133, s93, v11
    v_add_u32 v129, 81920, v11
    s_lshr_b32 s93, s68, 1
    s_lshl_b32 s93, s93, 10
    s_add_u32 s93, s93, s94
    v_add_u32 v130, s93, v129
    s_mul_i32 s93, s68, 7168
    s_add_u32 s93, s93, 135168
    s_waitcnt lgkmcnt(0)
    s_barrier
    ds_read_b32 v209, v187
    v_mul_u32_u24 v121, 1792, v49
    v_add_u32 v11, s93, v121
    v_mul_u32_u24 v121, 112, v9
    v_add_u32 v29, v121, v11
    v_subrev_u32 v29, 28672, v29
    v_cmp_eq_u32 vcc, 0, v10
    v_add_u32 v121, 16, v11
    s_mov_b32 s30, 100270464
    buffer_load_dwordx4 v0, s[32:35], s92 offen offset:2048 lds
    s_add_u32 m0, s90, 24576
    s_mov_b32 s92, 73728
    ds_read_b32 v210, v175
    v_cndmask_b32 v132, v8, v11, vcc
    v_cmp_eq_u32 vcc, 3, v131
    v_mov_b32 v123, 0
    v_mov_b32 v122, 0
    v_cndmask_b32 v132, v132, v121, vcc
    v_mul_u32_u24 v121, 1792, v10
    v_lshl_add_u32 v121, v49, 3, v121
    v_lshl_add_u32 v121, v131, 1, v121
    v_add_u32 v121, s93, v121
    v_cmp_gt_u32 vcc, 3, v49
    s_add_u32 s93, s69, 1
    s_mul_i32 s94, s93, 58255
    ds_read_b32 v208, v199
    v_cndmask_b32 v131, v8, v121, vcc
    s_lshr_b32 s94, s94, 22
    s_mul_i32 s94, s94, s63
    s_mul_i32 s56, s93, s62
    s_add_u32 s56, s56, s94
    buffer_load_dwordx4 v48, s[32:35], s92 offen offset:0 lds
    s_and_b32 s94, s68, 1
    s_mul_i32 s94, s94, -2304
    s_sub_u32 s93, s71, 1
    s_cmp_eq_u32 s68, 0
    s_cselect_b32 s13, s93, -1
    s_cmp_gt_u32 s73, 20
    s_cselect_b32 s13, s13, -1
    s_and_b32 s93, s2, -8
    s_sub_u32 s93, 81920, s93
    s_sub_u32 s8, s38, s93
    s_subb_u32 s9, s39, 0
    buffer_load_dwordx4 v139, s[32:35], s92 offen offset:1024 lds
    s_lshr_b32 s93, s68, 1
    s_mul_i32 s93, s93, 30720
    s_add_u32 s93, s93, s94
    ds_read_b32 v211, v3 offset:672
    v_add_u32 v10, s93, v99
    v_add_u32 v3, s93, v100
    s_lshr_b32 s93, s68, 1
    s_mul_i32 s93, s93, 5120
    s_lshl_b32 s94, s97, 4
    s_add_u32 s93, s93, s94
    v_add_u32 v121, s93, v98
    v_cmp_eq_u32 vcc, 0, v9
    s_mov_b32 s39, 0x00010001
    v_sub_u32 v192, v187, v204
    v_cndmask_b32 v121, v8, v121, vcc
    ds_read_b32 v192, v192 offset:336
    v_sub_u32 v193, v187, v205
    v_sub_u32 v194, v187, v206
    v_sub_u32 v195, v187, v207
    v_sub_u32 v188, v187, v200
    v_sub_u32 v189, v187, v201
    buffer_load_dwordx4 v0, s[32:35], s92 offen offset:2048 lds
    s_add_u32 m0, s90, 36864
    s_mov_b32 s92, 110592
    ds_read_b32 v193, v193 offset:336
    v_sub_u32 v190, v187, v202
    v_sub_u32 v191, v187, v203
    v_sub_u32 v184, v187, v31
    v_sub_u32 v185, v187, v30
    v_sub_u32 v186, v187, v97
    s_mov_b64 exec, 0
    s_cmp_eq_u32 s68, 2
    s_cbranch_scc1 L_pga
    s_cmp_eq_u32 s68, 3
    s_cbranch_scc1 L_pg2
    s_cmp_eq_u32 s68, 1
    s_cbranch_scc1 L_pg1
    s_branch L_pg0
.p2align 12
L_main:
    s_mov_b64 exec, -1
    s_waitcnt vmcnt(9)
    s_barrier
    ds_read_b32 v194, v194 offset:336
    v_sub_u32 v187, v187, v1
    v_sub_u32 v180, v175, v204
    v_sub_u32 v181, v175, v205
    v_sub_u32 v182, v175, v206
    v_sub_u32 v183, v175, v207
    ds_read_b32 v195, v195 offset:336
    v_sub_u32 v176, v175, v200
    v_sub_u32 v177, v175, v201
    v_sub_u32 v178, v175, v202
    v_sub_u32 v179, v175, v203
    v_sub_u32 v172, v175, v31
    ds_read_b32 v188, v188 offset:336
    v_sub_u32 v173, v175, v30
    v_sub_u32 v174, v175, v97
    buffer_load_dwordx4 v48, s[32:35], s92 offen offset:0 lds
    ds_read_b32 v189, v189 offset:336
    v_sub_u32 v175, v175, v1
    v_sub_u32 v204, v199, v204
    v_sub_u32 v205, v199, v205
    v_sub_u32 v206, v199, v206
    v_sub_u32 v207, v199, v207
    ds_read_b32 v190, v190 offset:336
    v_sub_u32 v200, v199, v200
    v_sub_u32 v201, v199, v201
    v_sub_u32 v202, v199, v202
    v_sub_u32 v203, v199, v203
    v_sub_u32 v196, v199, v31
    ds_read_b32 v191, v191 offset:336
    buffer_load_dwordx4 v139, s[32:35], s92 offen offset:1024 lds
    v_sub_u32 v197, v199, v30
    v_sub_u32 v198, v199, v97
    v_sub_u32 v199, v199, v1
    ds_read_b32 v184, v184 offset:336
    ds_read_b32 v185, v185 offset:336
    ds_read_b32 v186, v186 offset:336
    buffer_load_dwordx4 v0, s[32:35], s92 offen offset:2048 lds
    s_add_u32 m0, s90, 49152
    s_mov_b32 s92, 147456
    s_waitcnt vmcnt(9)
    ds_read_b64_tr_b16 a[0:1], v5 offset:0
    ds_read_b64_tr_b16 a[2:3], v5 offset:768
    ds_read_b64_tr_b16 a[24:25], v5 offset:32
    ds_read_b64_tr_b16 a[26:27], v5 offset:800
    ds_read_b64_tr_b16 a[48:49], v5 offset:64
    ds_read_b64_tr_b16 a[50:51], v5 offset:832
    ds_read_b32 v187, v187 offset:336
    buffer_load_dwordx4 v48, s[32:35], s92 offen offset:0 lds
    ds_read_b128 v[24:27], v7 offset:40960
    ds_read_b128 v[20:23], v7 offset:42496
    ds_read_b128 v[16:19], v7 offset:0
    ds_read_b128 v[12:15], v7 offset:1536
    ds_read_b128 v[36:39], v7 offset:3072
    buffer_load_dwordx4 v139, s[32:35], s92 offen offset:1024 lds
    ds_read_b32 v180, v180 offset:336
    ds_read_b32 v181, v181 offset:336
    ds_read_b32 v182, v182 offset:336
    s_waitcnt lgkmcnt(7)
    v_mfma_f32_16x16x32_bf16 v[84:87], a[0:3], v[24:27], 0
    buffer_load_dwordx4 v0, s[32:35], s92 offen offset:2048 lds
    v_mfma_f32_16x16x32_bf16 v[56:59], a[24:27], v[24:27], 0
    s_waitcnt vmcnt(9)
    s_add_u32 m0, s90, 61440
    ds_read_b64_tr_b16 a[4:5], v5 offset:12288
    v_mfma_f32_16x16x32_bf16 v[80:83], a[48:51], v[24:27], 0
    s_waitcnt lgkmcnt(5)
    s_mov_b32 s92, 184320
    ds_read_b64_tr_b16 a[6:7], v5 offset:13056
    v_mfma_f32_16x16x32_bf16 v[60:63], a[0:3], v[20:23], 0
    ds_read_b64_tr_b16 a[28:29], v5 offset:12320
    v_mfma_f32_16x16x32_bf16 v[148:151], a[24:27], v[20:23], 0
    ds_read_b64_tr_b16 a[30:31], v5 offset:13088
    v_mfma_f32_16x16x32_bf16 v[108:111], a[48:51], v[20:23], 0
    ds_read_b64_tr_b16 a[52:53], v5 offset:12352
    buffer_load_dwordx4 v48, s[32:35], s92 offen offset:0 lds
    v_mfma_f32_16x16x32_bf16 v[30:33], a[0:3], v[16:19], 0
    ds_read_b64_tr_b16 a[54:55], v5 offset:13120
    v_mfma_f32_16x16x32_bf16 v[20:23], a[24:27], v[16:19], 0
    ds_read_b128 v[116:119], v7 offset:41088
    v_mfma_f32_16x16x32_bf16 v[44:47], a[48:51], v[16:19], 0
    ds_read_b128 v[88:91], v7 offset:42624
    v_mfma_f32_16x16x32_bf16 v[140:143], a[0:3], v[12:15], 0
    ds_read_b128 v[112:115], v7 offset:128
    v_mfma_f32_16x16x32_bf16 v[68:71], a[24:27], v[12:15], 0
    ds_read_b128 v[52:55], v7 offset:1664
    buffer_load_dwordx4 v139, s[32:35], s92 offen offset:1024 lds
    v_mfma_f32_16x16x32_bf16 v[24:27], a[48:51], v[12:15], 0
    s_waitcnt lgkmcnt(8)
    ds_read_b128 v[16:19], v7 offset:3200
    v_mfma_f32_16x16x32_bf16 v[76:79], a[0:3], v[36:39], 0
    ds_read_b128 v[144:147], v6 offset:41088
    v_mfma_f32_16x16x32_bf16 v[40:43], a[24:27], v[36:39], 0
    ds_read_b128 v[104:107], v6 offset:42624
    v_mfma_f32_16x16x32_bf16 v[12:15], a[48:51], v[36:39], 0
    s_waitcnt vmcnt(8)
    ds_read_b128 v[92:95], v6 offset:128
    ds_read_b128 v[36:39], v6 offset:1664
    buffer_load_dwordx4 v0, s[32:35], s92 offen offset:2048 lds
    s_add_u32 m0, s90, 0
    s_mov_b32 s92, 384
    ds_read_b64_tr_b16 a[8:9], v5 offset:24576
    ds_read_b64_tr_b16 a[10:11], v5 offset:25344
    ds_read_b64_tr_b16 a[32:33], v5 offset:24608
    ds_read_b64_tr_b16 a[34:35], v5 offset:25376
    ds_read_b64_tr_b16 a[56:57], v5 offset:24640
    ds_read_b64_tr_b16 a[58:59], v5 offset:25408
    ds_read_b128 v[64:67], v6 offset:3200
    ds_read_b128 v[156:159], v6 offset:40960
    buffer_load_dwordx4 v48, s[32:35], s92 offen offset:0 lds
    ds_read_b128 v[152:155], v6 offset:42496
    ds_read_b32 v183, v183 offset:336
    ds_read_b32 v176, v176 offset:336
    ds_read_b32 v177, v177 offset:336
    buffer_load_dwordx4 v139, s[32:35], s92 offen offset:1024 lds
    ds_read_b32 v178, v178 offset:336
    ds_read_b32 v179, v179 offset:336
    s_waitcnt lgkmcnt(6)
    v_mfma_f32_16x16x32_bf16 v[84:87], a[4:7], v[156:159], v[84:87]
    ds_read_b32 v172, v172 offset:336
    v_mfma_f32_16x16x32_bf16 v[84:87], a[8:11], v[116:119], v[84:87]
    buffer_load_dwordx4 v0, s[32:35], s92 offen offset:2048 lds
    v_mfma_f32_16x16x32_bf16 v[56:59], a[28:31], v[156:159], v[56:59]
    s_waitcnt vmcnt(9)
    s_add_u32 m0, s90, 12288
    ds_read_b64_tr_b16 a[12:13], v5 offset:36864
    v_mfma_f32_16x16x32_bf16 v[56:59], a[32:35], v[116:119], v[56:59]
    s_mov_b32 s92, 37248
    ds_read_b64_tr_b16 a[14:15], v5 offset:37632
    v_mfma_f32_16x16x32_bf16 v[80:83], a[52:55], v[156:159], v[80:83]
    ds_read_b64_tr_b16 a[36:37], v5 offset:36896
    v_mfma_f32_16x16x32_bf16 v[80:83], a[56:59], v[116:119], v[80:83]
    s_waitcnt lgkmcnt(6)
    ds_read_b64_tr_b16 a[38:39], v5 offset:37664
    v_mfma_f32_16x16x32_bf16 v[60:63], a[4:7], v[152:155], v[60:63]
    buffer_load_dwordx4 v48, s[32:35], s92 offen offset:0 lds
    ds_read_b64_tr_b16 a[60:61], v5 offset:36928
    v_mfma_f32_16x16x32_bf16 v[60:63], a[8:11], v[88:91], v[60:63]
    ds_read_b64_tr_b16 a[62:63], v5 offset:37696
    v_mfma_f32_16x16x32_bf16 v[148:151], a[28:31], v[152:155], v[148:151]
    ds_read_b128 v[116:119], v6 offset:0
    v_mfma_f32_16x16x32_bf16 v[148:151], a[32:35], v[88:91], v[148:151]
    ds_read_b32 v173, v173 offset:336
    v_mfma_f32_16x16x32_bf16 v[108:111], a[52:55], v[152:155], v[108:111]
    v_mfma_f32_16x16x32_bf16 v[108:111], a[56:59], v[88:91], v[108:111]
    s_waitcnt lgkmcnt(6)
    buffer_load_dwordx4 v139, s[32:35], s92 offen offset:1024 lds
    ds_read_b32 v174, v174 offset:336
    v_mfma_f32_16x16x32_bf16 v[84:87], a[12:15], v[144:147], v[84:87]
    v_mfma_f32_16x16x32_bf16 v[60:63], a[12:15], v[104:107], v[60:63]
    s_waitcnt lgkmcnt(5)
    ds_read_b128 v[88:91], v6 offset:1536
    v_mfma_f32_16x16x32_bf16 v[56:59], a[36:39], v[144:147], v[56:59]
    ds_read_b32 v175, v175 offset:336
    v_mfma_f32_16x16x32_bf16 v[148:151], a[36:39], v[104:107], v[148:151]
    s_waitcnt lgkmcnt(5)
    v_mfma_f32_16x16x32_bf16 v[80:83], a[60:63], v[144:147], v[80:83]
    s_waitcnt vmcnt(8)
    buffer_load_dwordx4 v0, s[32:35], s92 offen offset:2048 lds
    ds_read_b64_tr_b16 a[16:17], v5 offset:49152
    v_mfma_f32_16x16x32_bf16 v[108:111], a[60:63], v[104:107], v[108:111]
    s_waitcnt lgkmcnt(4)
    s_add_u32 m0, s90, 24576
    ds_read_b64_tr_b16 a[18:19], v5 offset:49920
    v_mfma_f32_16x16x32_bf16 v[30:33], a[4:7], v[116:119], v[30:33]
    s_mov_b32 s92, 74112
    ds_read_b64_tr_b16 a[40:41], v5 offset:49184
    v_mfma_f32_16x16x32_bf16 v[30:33], a[8:11], v[112:115], v[30:33]
    ds_read_b64_tr_b16 a[42:43], v5 offset:49952
    v_mfma_f32_16x16x32_bf16 v[30:33], a[12:15], v[92:95], v[30:33]
    ds_read_b64_tr_b16 a[64:65], v5 offset:49216
    v_mfma_f32_16x16x32_bf16 v[20:23], a[28:31], v[116:119], v[20:23]
    buffer_load_dwordx4 v48, s[32:35], s92 offen offset:0 lds
    ds_read_b64_tr_b16 a[66:67], v5 offset:49984
    v_mfma_f32_16x16x32_bf16 v[20:23], a[32:35], v[112:115], v[20:23]
    ds_read_b128 v[104:107], v6 offset:3072
    v_mfma_f32_16x16x32_bf16 v[20:23], a[36:39], v[92:95], v[20:23]
    ds_read_b32 v204, v204 offset:336
    v_mfma_f32_16x16x32_bf16 v[44:47], a[52:55], v[116:119], v[44:47]
    v_mfma_f32_16x16x32_bf16 v[44:47], a[56:59], v[112:115], v[44:47]
    ds_read_b32 v205, v205 offset:336
    v_mfma_f32_16x16x32_bf16 v[44:47], a[60:63], v[92:95], v[44:47]
    s_waitcnt lgkmcnt(7)
    buffer_load_dwordx4 v139, s[32:35], s92 offen offset:1024 lds
    v_mfma_f32_16x16x32_bf16 v[140:143], a[4:7], v[88:91], v[140:143]
    ds_read_b32 v206, v206 offset:336
    v_mfma_f32_16x16x32_bf16 v[140:143], a[8:11], v[52:55], v[140:143]
    v_mfma_f32_16x16x32_bf16 v[140:143], a[12:15], v[36:39], v[140:143]
    ds_read_b32 v207, v207 offset:336
    v_mfma_f32_16x16x32_bf16 v[68:71], a[28:31], v[88:91], v[68:71]
    v_mfma_f32_16x16x32_bf16 v[68:71], a[32:35], v[52:55], v[68:71]
    s_waitcnt vmcnt(8)
    buffer_load_dwordx4 v0, s[32:35], s92 offen offset:2048 lds
    ds_read_b64_tr_b16 a[20:21], v5 offset:61440
    v_mfma_f32_16x16x32_bf16 v[68:71], a[36:39], v[36:39], v[68:71]
    s_add_u32 m0, s90, 36864
    ds_read_b64_tr_b16 a[22:23], v5 offset:62208
    v_mfma_f32_16x16x32_bf16 v[24:27], a[52:55], v[88:91], v[24:27]
    s_mov_b32 s92, 110976
    ds_read_b64_tr_b16 a[44:45], v5 offset:61472
    v_mfma_f32_16x16x32_bf16 v[24:27], a[56:59], v[52:55], v[24:27]
    ds_read_b64_tr_b16 a[46:47], v5 offset:62240
    v_mfma_f32_16x16x32_bf16 v[24:27], a[60:63], v[36:39], v[24:27]
    s_waitcnt lgkmcnt(6)
    ds_read_b64_tr_b16 a[68:69], v5 offset:61504
    v_mfma_f32_16x16x32_bf16 v[76:79], a[4:7], v[104:107], v[76:79]
    buffer_load_dwordx4 v48, s[32:35], s92 offen offset:0 lds
    ds_read_b64_tr_b16 a[70:71], v5 offset:62272
    v_mfma_f32_16x16x32_bf16 v[76:79], a[8:11], v[16:19], v[76:79]
    ds_read_b128 v[92:95], v6 offset:41216
    v_mfma_f32_16x16x32_bf16 v[76:79], a[12:15], v[64:67], v[76:79]
    ds_read_b128 v[88:91], v6 offset:42752
    v_mfma_f32_16x16x32_bf16 v[40:43], a[28:31], v[104:107], v[40:43]
    ds_read_b128 v[36:39], v6 offset:256
    v_mfma_f32_16x16x32_bf16 v[40:43], a[32:35], v[16:19], v[40:43]
    ds_read_b128 v[116:119], v6 offset:1792
    v_mfma_f32_16x16x32_bf16 v[40:43], a[36:39], v[64:67], v[40:43]
    buffer_load_dwordx4 v139, s[32:35], s92 offen offset:1024 lds
    ds_read_b128 v[52:55], v6 offset:3328
    v_mfma_f32_16x16x32_bf16 v[12:15], a[52:55], v[104:107], v[12:15]
    ds_read_b128 v[104:107], v7 offset:41216
    v_mfma_f32_16x16x32_bf16 v[12:15], a[56:59], v[16:19], v[12:15]
    ds_read_b128 v[16:19], v7 offset:42752
    v_mfma_f32_16x16x32_bf16 v[12:15], a[60:63], v[64:67], v[12:15]
    ds_read_b128 v[64:67], v7 offset:256
    ds_read_b32 v200, v200 offset:336
    buffer_load_dwordx4 v0, s[32:35], s92 offen offset:2048 lds
    s_add_u32 m0, s90, 49152
    s_mov_b32 s92, 147840
    s_waitcnt vmcnt(9)
    ds_read_b64_tr_b16 a[72:73], v5 offset:0
    ds_read_b64_tr_b16 a[74:75], v5 offset:768
    ds_read_b64_tr_b16 a[96:97], v5 offset:32
    ds_read_b64_tr_b16 a[98:99], v5 offset:800
    ds_read_b64_tr_b16 a[120:121], v5 offset:64
    ds_read_b64_tr_b16 a[122:123], v5 offset:832
    ds_read_b32 v201, v201 offset:336
    buffer_load_dwordx4 v48, s[32:35], s92 offen offset:0 lds
    s_waitcnt lgkmcnt(10)
    v_mfma_f32_16x16x32_bf16 v[84:87], a[16:19], v[104:107], v[84:87]
    ds_read_b32 v202, v202 offset:336
    v_mfma_f32_16x16x32_bf16 v[84:87], a[20:23], v[92:95], v[84:87]
    s_nop 1
    v_mfma_f32_16x16x32_bf16 v[56:59], a[40:43], v[104:107], v[56:59]
    s_nop 0
    ds_read_b32 v203, v203 offset:336
    s_nop 0
    v_mfma_f32_16x16x32_bf16 v[56:59], a[44:47], v[92:95], v[56:59]
    s_nop 0
    v_cvt_pk_f16_f32 v84, v84, v85
    v_cvt_pk_f16_f32 v85, v86, v87
    v_mfma_f32_16x16x32_bf16 v[80:83], a[64:67], v[104:107], v[80:83]
    ds_read_b128 v[104:107], v7 offset:1792
    buffer_load_dwordx4 v139, s[32:35], s92 offen offset:1024 lds
    v_mfma_f32_16x16x32_bf16 v[80:83], a[68:71], v[92:95], v[80:83]
    s_waitcnt lgkmcnt(6)
    ds_read_b32 v196, v196 offset:336
    v_pk_fma_f16 v112, v84, v84, s39
    v_mfma_f32_16x16x32_bf16 v[60:63], a[16:19], v[16:19], v[60:63]
    v_pk_fmac_f16 v112, v85, v85
    v_cvt_pk_f16_f32 v86, v56, v57
    v_mfma_f32_16x16x32_bf16 v[60:63], a[20:23], v[88:91], v[60:63]
    ds_read_b32 v197, v197 offset:336
    v_cvt_pk_f16_f32 v87, v58, v59
    v_mfma_f32_16x16x32_bf16 v[148:151], a[40:43], v[16:19], v[148:151]
    v_pk_fmac_f16 v112, v86, v86
    v_pk_fmac_f16 v112, v87, v87
    v_mfma_f32_16x16x32_bf16 v[148:151], a[44:47], v[88:91], v[148:151]
    ds_read_b128 v[56:59], v7 offset:3328
    buffer_load_dwordx4 v0, s[32:35], s92 offen offset:2048 lds
    v_mfma_f32_16x16x32_bf16 v[108:111], a[64:67], v[16:19], v[108:111]
    s_waitcnt vmcnt(9)
    s_add_u32 m0, s90, 61440
    ds_read_b64_tr_b16 a[76:77], v5 offset:12288
    v_cvt_pk_f16_f32 v18, v80, v81
    v_mfma_f32_16x16x32_bf16 v[108:111], a[68:71], v[88:91], v[108:111]
    s_mov_b32 s92, 184704
    ds_read_b64_tr_b16 a[78:79], v5 offset:13056
    v_cvt_pk_f16_f32 v19, v82, v83
    v_mfma_f32_16x16x32_bf16 v[30:33], a[16:19], v[64:67], v[30:33]
    ds_read_b64_tr_b16 a[100:101], v5 offset:12320
    v_pk_fmac_f16 v112, v18, v18
    v_mfma_f32_16x16x32_bf16 v[30:33], a[20:23], v[36:39], v[30:33]
    ds_read_b64_tr_b16 a[102:103], v5 offset:13088
    v_pk_fmac_f16 v112, v19, v19
    v_mfma_f32_16x16x32_bf16 v[20:23], a[40:43], v[64:67], v[20:23]
    ds_read_b64_tr_b16 a[124:125], v5 offset:12352
    buffer_load_dwordx4 v48, s[32:35], s92 offen offset:0 lds
    v_mfma_f32_16x16x32_bf16 v[20:23], a[44:47], v[36:39], v[20:23]
    ds_read_b64_tr_b16 a[126:127], v5 offset:13120
    v_cvt_pk_f16_f32 v60, v60, v61
    v_mfma_f32_16x16x32_bf16 v[44:47], a[64:67], v[64:67], v[44:47]
    ds_read_b128 v[80:83], v6 offset:40960
    v_cvt_pk_f16_f32 v61, v62, v63
    v_mfma_f32_16x16x32_bf16 v[44:47], a[68:71], v[36:39], v[44:47]
    s_waitcnt lgkmcnt(8)
    ds_read_b128 v[88:91], v6 offset:42496
    v_pk_fma_f16 v114, v60, v60, s39
    v_mfma_f32_16x16x32_bf16 v[140:143], a[16:19], v[104:107], v[140:143]
    ds_read_b128 v[92:95], v6 offset:0
    v_pk_fmac_f16 v114, v61, v61
    v_mfma_f32_16x16x32_bf16 v[140:143], a[20:23], v[116:119], v[140:143]
    ds_read_b128 v[36:39], v6 offset:1536
    buffer_load_dwordx4 v139, s[32:35], s92 offen offset:1024 lds
    v_mfma_f32_16x16x32_bf16 v[68:71], a[40:43], v[104:107], v[68:71]
    ds_read_b128 v[64:67], v6 offset:3072
    v_cvt_pk_f16_f32 v62, v148, v149
    v_mfma_f32_16x16x32_bf16 v[68:71], a[44:47], v[116:119], v[68:71]
    ds_read_b128 v[144:147], v7 offset:40960
    v_cvt_pk_f16_f32 v63, v150, v151
    v_mfma_f32_16x16x32_bf16 v[24:27], a[64:67], v[104:107], v[24:27]
    ds_read_b128 v[104:107], v7 offset:42496
    v_pk_fmac_f16 v114, v62, v62
    v_mfma_f32_16x16x32_bf16 v[24:27], a[68:71], v[116:119], v[24:27]
    s_waitcnt lgkmcnt(8)
    ds_read_b32 v198, v198 offset:336
    v_pk_fmac_f16 v114, v63, v63
    v_mfma_f32_16x16x32_bf16 v[76:79], a[16:19], v[56:59], v[76:79]
    v_cvt_pk_f16_f32 v16, v108, v109
    v_cvt_pk_f16_f32 v17, v110, v111
    v_mfma_f32_16x16x32_bf16 v[76:79], a[20:23], v[52:55], v[76:79]
    s_waitcnt vmcnt(8)
    buffer_load_dwordx4 v0, s[32:35], s92 offen offset:2048 lds
    ds_read_b64_tr_b16 a[80:81], v5 offset:24576
    v_mfma_f32_16x16x32_bf16 v[40:43], a[40:43], v[56:59], v[40:43]
    s_add_u32 m0, s90, 0
    ds_read_b64_tr_b16 a[82:83], v5 offset:25344
    v_pk_fmac_f16 v114, v16, v16
    v_mfma_f32_16x16x32_bf16 v[40:43], a[44:47], v[52:55], v[40:43]
    s_mov_b32 s92, 768
    ds_read_b64_tr_b16 a[104:105], v5 offset:24608
    v_pk_fmac_f16 v114, v17, v17
    v_mfma_f32_16x16x32_bf16 v[12:15], a[64:67], v[56:59], v[12:15]
    ds_read_b64_tr_b16 a[106:107], v5 offset:25376
    v_cvt_pk_f16_f32 v224, v30, v31
    v_mfma_f32_16x16x32_bf16 v[12:15], a[68:71], v[52:55], v[12:15]
    s_waitcnt lgkmcnt(6)
    ds_read_b64_tr_b16 a[128:129], v5 offset:24640
    buffer_load_dwordx4 v48, s[32:35], s92 offen offset:0 lds
    ds_read_b64_tr_b16 a[130:131], v5 offset:25408
    v_mfma_f32_16x16x32_bf16 v[56:59], a[72:75], v[144:147], 0
    ds_read_b128 v[52:55], v7 offset:0
    v_cvt_pk_f16_f32 v225, v32, v33
    v_mfma_f32_16x16x32_bf16 v[56:59], a[76:79], v[80:83], v[56:59]
    ds_read_b32 v199, v199 offset:336
    v_pk_fma_f16 v156, v224, v224, s39
    v_mfma_f32_16x16x32_bf16 v[116:119], a[96:99], v[144:147], 0
    v_pk_fmac_f16 v156, v225, v225
    v_cvt_pk_f16_f32 v226, v20, v21
    v_mfma_f32_16x16x32_bf16 v[116:119], a[100:103], v[80:83], v[116:119]
    ds_read_b128 v[108:111], v7 offset:1536
    v_cvt_pk_f16_f32 v227, v22, v23
    v_mfma_f32_16x16x32_bf16 v[20:23], a[120:123], v[144:147], 0
    buffer_load_dwordx4 v139, s[32:35], s92 offen offset:1024 lds
    v_pk_fmac_f16 v156, v226, v226
    v_mfma_f32_16x16x32_bf16 v[20:23], a[124:127], v[80:83], v[20:23]
    s_waitcnt lgkmcnt(6)
    v_pk_fmac_f16 v156, v227, v227
    v_cvt_pk_f16_f32 v152, v44, v45
    v_mfma_f32_16x16x32_bf16 v[80:83], a[72:75], v[104:107], 0
    v_cvt_pk_f16_f32 v153, v46, v47
    v_pk_fmac_f16 v156, v152, v152
    v_mfma_f32_16x16x32_bf16 v[80:83], a[76:79], v[88:91], v[80:83]
    v_pk_fmac_f16 v156, v153, v153
    v_cvt_pk_f16_f32 v232, v140, v141
    v_mfma_f32_16x16x32_bf16 v[44:47], a[96:99], v[104:107], 0
    v_cvt_pk_f16_f32 v233, v142, v143
    v_pk_fma_f16 v158, v232, v232, s39
    v_mfma_f32_16x16x32_bf16 v[44:47], a[100:103], v[88:91], v[44:47]
    s_waitcnt vmcnt(8)
    buffer_load_dwordx4 v0, s[32:35], s92 offen offset:2048 lds
    ds_read_b64_tr_b16 a[84:85], v5 offset:36864
    v_mfma_f32_16x16x32_bf16 v[168:171], a[120:123], v[104:107], 0
    s_add_u32 m0, s90, 12288
    ds_read_b64_tr_b16 a[86:87], v5 offset:37632
    v_pk_fmac_f16 v158, v233, v233
    v_mfma_f32_16x16x32_bf16 v[168:171], a[124:127], v[88:91], v[168:171]
    s_waitcnt lgkmcnt(3)
    s_mov_b32 s92, 37632
    ds_read_b64_tr_b16 a[108:109], v5 offset:36896
    v_cvt_pk_f16_f32 v234, v68, v69
    v_mfma_f32_16x16x32_bf16 v[104:107], a[72:75], v[52:55], 0
    ds_read_b64_tr_b16 a[110:111], v5 offset:37664
    v_cvt_pk_f16_f32 v235, v70, v71
    v_mfma_f32_16x16x32_bf16 v[104:107], a[76:79], v[92:95], v[104:107]
    ds_read_b64_tr_b16 a[132:133], v5 offset:36928
    v_pk_fmac_f16 v158, v234, v234
    v_mfma_f32_16x16x32_bf16 v[160:163], a[96:99], v[52:55], 0
    buffer_load_dwordx4 v48, s[32:35], s92 offen offset:0 lds
    ds_read_b64_tr_b16 a[134:135], v5 offset:37696
    v_mfma_f32_16x16x32_bf16 v[160:163], a[100:103], v[92:95], v[160:163]
    ds_read_b128 v[68:71], v7 offset:3072
    v_pk_fmac_f16 v158, v235, v235
    v_mfma_f32_16x16x32_bf16 v[88:91], a[120:123], v[52:55], 0
    ds_read_b128 v[52:55], v7 offset:41088
    v_cvt_pk_f16_f32 v146, v24, v25
    v_mfma_f32_16x16x32_bf16 v[88:91], a[124:127], v[92:95], v[88:91]
    s_waitcnt lgkmcnt(8)
    v_cvt_pk_f16_f32 v147, v26, v27
    v_pk_fmac_f16 v158, v146, v146
    v_mfma_f32_16x16x32_bf16 v[24:27], a[72:75], v[108:111], 0
    ds_read_b128 v[228:231], v7 offset:42624
    v_pk_fmac_f16 v158, v147, v147
    v_mfma_f32_16x16x32_bf16 v[24:27], a[76:79], v[36:39], v[24:27]
    buffer_load_dwordx4 v139, s[32:35], s92 offen offset:1024 lds
    v_cvt_pk_f16_f32 v92, v76, v77
    v_mfma_f32_16x16x32_bf16 v[164:167], a[96:99], v[108:111], 0
    v_cvt_pk_f16_f32 v93, v78, v79
    v_pk_fma_f16 v32, v92, v92, s39
    v_mfma_f32_16x16x32_bf16 v[164:167], a[100:103], v[36:39], v[164:167]
    ds_read_b128 v[76:79], v7 offset:128
    v_pk_fmac_f16 v32, v93, v93
    v_mfma_f32_16x16x32_bf16 v[148:151], a[120:123], v[108:111], 0
    v_cvt_pk_f16_f32 v94, v40, v41
    v_cvt_pk_f16_f32 v95, v42, v43
    v_mfma_f32_16x16x32_bf16 v[148:151], a[124:127], v[36:39], v[148:151]
    s_waitcnt lgkmcnt(3)
    v_pk_fmac_f16 v32, v94, v94
    v_pk_fmac_f16 v32, v95, v95
    v_cvt_pk_f16_f32 v140, v12, v13
    v_mfma_f32_16x16x32_bf16 v[36:39], a[72:75], v[68:71], 0
    s_waitcnt vmcnt(8)
    buffer_load_dwordx4 v0, s[32:35], s92 offen offset:2048 lds
    ds_read_b64_tr_b16 a[88:89], v5 offset:49152
    v_mfma_f32_16x16x32_bf16 v[36:39], a[76:79], v[64:67], v[36:39]
    s_add_u32 m0, s90, 24576
    ds_read_b64_tr_b16 a[90:91], v5 offset:49920
    v_cvt_pk_f16_f32 v141, v14, v15
    v_mfma_f32_16x16x32_bf16 v[40:43], a[96:99], v[68:71], 0
    s_mov_b32 s92, 74496
    ds_read_b64_tr_b16 a[112:113], v5 offset:49184
    v_pk_fmac_f16 v32, v140, v140
    v_mfma_f32_16x16x32_bf16 v[40:43], a[100:103], v[64:67], v[40:43]
    ds_read_b64_tr_b16 a[114:115], v5 offset:49952
    v_pk_fmac_f16 v32, v141, v141
    v_mfma_f32_16x16x32_bf16 v[12:15], a[120:123], v[68:71], 0
    ds_read_b64_tr_b16 a[136:137], v5 offset:49216
    v_mfma_f32_16x16x32_bf16 v[12:15], a[124:127], v[64:67], v[12:15]
    s_waitcnt lgkmcnt(5)
    buffer_load_dwordx4 v48, s[32:35], s92 offen offset:0 lds
    ds_read_b64_tr_b16 a[138:139], v5 offset:49984
    v_mfma_f32_16x16x32_bf16 v[56:59], a[80:83], v[52:55], v[56:59]
    ds_read_b128 v[68:71], v7 offset:1664
    v_mov_b32 v34, 0
    v_mfma_f32_16x16x32_bf16 v[116:119], a[104:107], v[52:55], v[116:119]
    ds_read_b128 v[64:67], v7 offset:3200
    v_mov_b32 v35, 0
    v_mfma_f32_16x16x32_bf16 v[20:23], a[128:131], v[52:55], v[20:23]
    ds_read_b128 v[52:55], v6 offset:41088
    v_mfma_f32_16x16x32_bf16 v[80:83], a[80:83], v[228:231], v[80:83]
    ds_read_b128 v[108:111], v6 offset:42624
    v_mov_b32 v1, 0xf149f2ca
    v_mfma_f32_16x16x32_bf16 v[44:47], a[104:107], v[228:231], v[44:47]
    buffer_load_dwordx4 v139, s[32:35], s92 offen offset:1024 lds
    v_mfma_f32_16x16x32_bf16 v[168:171], a[128:131], v[228:231], v[168:171]
    s_cmp_ge_u32 s2, 248
    s_cbranch_scc1 L_maskF
L_nomaskF:
    v_mfma_f32_16x16x32_bf16 v[104:107], a[80:83], v[76:79], v[104:107]
    ds_read_b128 v[228:231], v6 offset:128
    v_readlane_b32 s84, v211, 48
    v_mfma_f32_16x16x32_bf16 v[160:163], a[104:107], v[76:79], v[160:163]
    v_cmp_gt_u32 vcc, 16, v2
    v_mfma_f32_16x16x32_bf16 v[88:91], a[128:131], v[76:79], v[88:91]
    s_waitcnt lgkmcnt(4)
    v_cndmask_b32 v208, v1, v208, vcc
    v_cndmask_b32 v209, v1, v209, vcc
    v_cndmask_b32 v210, v1, v210, vcc
    v_mfma_f32_16x16x32_bf16 v[24:27], a[80:83], v[68:71], v[24:27]
    s_waitcnt vmcnt(8)
    buffer_load_dwordx4 v0, s[32:35], s92 offen offset:2048 lds
    ds_read_b64_tr_b16 a[92:93], v5 offset:61440
    v_mfma_f32_16x16x32_bf16 v[164:167], a[104:107], v[68:71], v[164:167]
    s_add_u32 m0, s90, 36864
    ds_read_b64_tr_b16 a[94:95], v5 offset:62208
    v_cmp_gt_u32 vcc, 49, v2
    v_mfma_f32_16x16x32_bf16 v[148:151], a[128:131], v[68:71], v[148:151]
    s_waitcnt lgkmcnt(3)
    s_mov_b32 s92, 111360
    ds_read_b64_tr_b16 a[116:117], v5 offset:61472
    v_cndmask_b32 v211, v1, v211, vcc
    v_mfma_f32_16x16x32_bf16 v[36:39], a[80:83], v[64:67], v[36:39]
    ds_read_b64_tr_b16 a[118:119], v5 offset:62240
    v_mfma_f32_16x16x32_bf16 v[40:43], a[104:107], v[64:67], v[40:43]
    ds_read_b64_tr_b16 a[140:141], v5 offset:61504
    v_mfma_f32_16x16x32_bf16 v[12:15], a[128:131], v[64:67], v[12:15]
    buffer_load_dwordx4 v48, s[32:35], s92 offen offset:0 lds
    ds_read_b64_tr_b16 a[142:143], v5 offset:62272
    v_mfma_f32_16x16x32_bf16 v[56:59], a[84:87], v[52:55], v[56:59]
    ds_read_b128 v[76:79], v6 offset:1664
    v_mfma_f32_16x16x32_bf16 v[116:119], a[108:111], v[52:55], v[116:119]
    ds_read_b128 v[68:71], v6 offset:3200
    v_mfma_f32_16x16x32_bf16 v[20:23], a[132:135], v[52:55], v[20:23]
    ds_read_b128 v[64:67], v7 offset:41216
    v_mfma_f32_16x16x32_bf16 v[80:83], a[84:87], v[108:111], v[80:83]
    ds_read_b128 v[52:55], v7 offset:42752
    v_mfma_f32_16x16x32_bf16 v[44:47], a[108:111], v[108:111], v[44:47]
    buffer_load_dwordx4 v139, s[32:35], s92 offen offset:1024 lds
    v_mfma_f32_16x16x32_bf16 v[168:171], a[132:135], v[108:111], v[168:171]
    s_waitcnt lgkmcnt(7)
    v_mfma_f32_16x16x32_bf16 v[104:107], a[84:87], v[228:231], v[104:107]
    s_mov_b32 s53, s47
    ds_read_b128 v[108:111], v7 offset:256
    v_mfma_f32_16x16x32_bf16 v[160:163], a[108:111], v[228:231], v[160:163]
    s_mov_b32 s47, s46
    v_mfma_f32_16x16x32_bf16 v[88:91], a[132:135], v[228:231], v[88:91]
    s_waitcnt vmcnt(8) lgkmcnt(4)
    s_mov_b32 s46, s45
    ds_read_b64_tr_b16 a[144:145], v138 offset:0
    v_mfma_f32_16x16x32_bf16 v[24:27], a[84:87], v[76:79], v[24:27]
    s_mov_b32 s45, s44
    buffer_load_dwordx4 v0, s[32:35], s92 offen offset:2048 lds
    ds_read_b64_tr_b16 a[146:147], v138 offset:768
    v_mfma_f32_16x16x32_bf16 v[164:167], a[108:111], v[76:79], v[164:167]
    s_add_u32 m0, s90, 49152
    ds_read_b64_tr_b16 a[168:169], v138 offset:8
    v_mfma_f32_16x16x32_bf16 v[148:151], a[132:135], v[76:79], v[148:151]
    s_waitcnt lgkmcnt(4)
    s_mov_b32 s92, 148224
    ds_read_b64_tr_b16 a[170:171], v138 offset:776
    v_mfma_f32_16x16x32_bf16 v[36:39], a[84:87], v[68:71], v[36:39]
    s_mov_b32 s44, s53
    v_mov_b32 v30, 0
    v_mov_b32 v31, 0
    v_mfma_f32_16x16x32_bf16 v[40:43], a[108:111], v[68:71], v[40:43]
    s_sub_u32 s48, s44, s46
    ds_read_b64_tr_b16 a[192:193], v5 offset:64
    buffer_load_dwordx4 v48, s[32:35], s92 offen offset:0 lds
    v_mfma_f32_16x16x32_bf16 v[12:15], a[132:135], v[68:71], v[12:15]
    s_sub_u32 s49, s46, s45
    ds_read_b64_tr_b16 a[194:195], v5 offset:832
    v_mov_b32 v1, 0
    v_mfma_f32_16x16x32_bf16 v[56:59], a[88:91], v[64:67], v[56:59]
    s_sub_u32 s50, s45, s44
    ds_read_b128 v[76:79], v7 offset:1792
    v_add_u32 v33, 28672, v29
    v_mfma_f32_16x16x32_bf16 v[116:119], a[112:115], v[64:67], v[116:119]
    s_sub_u32 s51, s46, s47
    ds_write2_b64 v33, v[30:31], v[30:31] offset0:2 offset1:3
    v_mfma_f32_16x16x32_bf16 v[20:23], a[136:139], v[64:67], v[20:23]
    s_mov_b32 s60, s59
    v_add_u32 v137, s48, v137
    v_add_u32 v136, s48, v136
    v_mfma_f32_16x16x32_bf16 v[80:83], a[88:91], v[52:55], v[80:83]
    s_mov_b32 s59, s58
    buffer_load_dwordx4 v139, s[32:35], s92 offen offset:1024 lds
    v_add_u32 v135, s49, v135
    v_mfma_f32_16x16x32_bf16 v[44:47], a[112:115], v[52:55], v[44:47]
    s_mov_b32 s58, s57
    ds_read_b128 v[68:71], v7 offset:3328
    v_add_u32 v134, s49, v134
    v_mfma_f32_16x16x32_bf16 v[168:171], a[136:139], v[52:55], v[168:171]
    s_waitcnt lgkmcnt(5)
    s_mov_b32 s57, s56
    ds_read_b128 v[64:67], v6 offset:41216
    v_add_u32 v137, s50, v137
    v_mfma_f32_16x16x32_bf16 v[104:107], a[88:91], v[108:111], v[104:107]
    s_mov_b32 s7, s6
    ds_read_b128 v[52:55], v6 offset:42752
    v_add_u32 v136, s50, v136
    v_mfma_f32_16x16x32_bf16 v[160:163], a[112:115], v[108:111], v[160:163]
    s_mov_b32 s6, s5
    ds_read_b128 v[240:243], v6 offset:256
    v_add_u32 v135, s48, v135
    v_mfma_f32_16x16x32_bf16 v[88:91], a[136:139], v[108:111], v[88:91]
    s_waitcnt vmcnt(8) lgkmcnt(5)
    s_mov_b32 s5, s4
    ds_read_b64_tr_b16 a[148:149], v138 offset:12288
    buffer_load_dwordx4 v0, s[32:35], s92 offen offset:2048 lds
    v_mfma_f32_16x16x32_bf16 v[24:27], a[88:91], v[76:79], v[24:27]
    s_add_u32 m0, s90, 61440
    ds_read_b64_tr_b16 a[150:151], v138 offset:13056
    v_add_u32 v134, s48, v134
    v_mfma_f32_16x16x32_bf16 v[164:167], a[112:115], v[76:79], v[164:167]
    s_mov_b32 s92, 185088
    ds_read_b64_tr_b16 a[172:173], v138 offset:12296
    v_add_u32 v133, s51, v133
    v_mfma_f32_16x16x32_bf16 v[148:151], a[136:139], v[76:79], v[148:151]
    s_waitcnt lgkmcnt(6)
    s_sub_u32 s14, s6, s7
    ds_read_b64_tr_b16 a[174:175], v138 offset:13064
    v_add_u32 v132, s14, v132
    v_add_u32 v131, s14, v131
    s_add_u32 s61, s61, 1
    s_add_u32 s12, s12, 20
    ds_read_b64_tr_b16 a[196:197], v5 offset:12352
    buffer_load_dwordx4 v48, s[32:35], s92 offen offset:0 lds
    v_mfma_f32_16x16x32_bf16 v[36:39], a[88:91], v[68:71], v[36:39]
L_pg0:
    s_cbranch_execz L_main
    s_max_u32 s12, s12, s61
    ds_read_b64_tr_b16 a[198:199], v5 offset:13120
    v_mfma_f32_16x16x32_bf16 v[40:43], a[112:115], v[68:71], v[40:43]
    s_add_u32 s65, s65, 1
    ds_read_b128 v[236:239], v6 offset:1792
    v_mfma_f32_16x16x32_bf16 v[12:15], a[136:139], v[68:71], v[12:15]
    s_waitcnt lgkmcnt(7)
    s_add_u32 s67, s46, s54
    ds_read_b128 v[228:231], v6 offset:3328
    v_mfma_f32_16x16x32_bf16 v[56:59], a[92:95], v[64:67], v[56:59]
    s_nop 0
    v_mfma_f32_16x16x32_bf16 v[116:119], a[116:119], v[64:67], v[116:119]
    s_nop 1
    buffer_load_dwordx4 v139, s[32:35], s92 offen offset:1024 lds
    v_mfma_f32_16x16x32_bf16 v[20:23], a[140:143], v[64:67], v[20:23]
    s_nop 0
    ds_read_b128 v[76:79], v7 offset:40960
    v_cvt_pk_f16_f32 v108, v56, v57
    v_mfma_f32_16x16x32_bf16 v[80:83], a[92:95], v[52:55], v[80:83]
    ds_read_b128 v[64:67], v6 offset:40960
    v_cvt_pk_f16_f32 v109, v58, v59
    v_mfma_f32_16x16x32_bf16 v[44:47], a[116:119], v[52:55], v[44:47]
    ds_read_b128 v[68:71], v7 offset:41088
    v_pk_fma_f16 v113, v108, v108, s39
    v_mfma_f32_16x16x32_bf16 v[168:171], a[140:143], v[52:55], v[168:171]
    s_nop 0
    ds_read_b128 v[56:59], v6 offset:41088
    v_cvt_pk_f16_f32 v80, v80, v81
    v_mfma_f32_16x16x32_bf16 v[104:107], a[92:95], v[240:243], v[104:107]
    ds_read_b128 v[52:55], v7 offset:41216
    buffer_load_dwordx4 v0, s[32:35], s92 offen offset:2048 lds
    v_mfma_f32_16x16x32_bf16 v[160:163], a[116:119], v[240:243], v[160:163]
    s_waitcnt vmcnt(9)
    s_add_u32 m0, s90, 0
    ds_read_b64_tr_b16 a[152:153], v138 offset:24576
    v_cvt_pk_f16_f32 v81, v82, v83
    v_mfma_f32_16x16x32_bf16 v[88:91], a[140:143], v[240:243], v[88:91]
    s_waitcnt lgkmcnt(6)
    s_mov_b32 s92, 0
    ds_read_b64_tr_b16 a[154:155], v138 offset:25344
    v_pk_fma_f16 v115, v80, v80, s39
    v_mfma_f32_16x16x32_bf16 v[24:27], a[92:95], v[236:239], v[24:27]
    ds_read_b64_tr_b16 a[176:177], v138 offset:24584
    v_pk_fmac_f16 v115, v81, v81
    v_mfma_f32_16x16x32_bf16 v[164:167], a[116:119], v[236:239], v[164:167]
    ds_read_b64_tr_b16 a[178:179], v138 offset:25352
    v_cvt_pk_f16_f32 v82, v44, v45
    v_mfma_f32_16x16x32_bf16 v[148:151], a[140:143], v[236:239], v[148:151]
    ds_read_b64_tr_b16 a[200:201], v5 offset:24640
    buffer_load_dwordx4 v4, s[76:79], s92 offen offset:0 lds
    v_mfma_f32_16x16x32_bf16 v[36:39], a[92:95], v[228:231], v[36:39]
    ds_read_b64_tr_b16 a[202:203], v5 offset:25408
    v_cvt_pk_f16_f32 v83, v46, v47
    v_mfma_f32_16x16x32_bf16 v[40:43], a[116:119], v[228:231], v[40:43]
    ds_read_b128 v[44:47], v6 offset:41216
    v_pk_fmac_f16 v115, v82, v82
    v_mfma_f32_16x16x32_bf16 v[12:15], a[140:143], v[228:231], v[12:15]
    v_pk_fmac_f16 v115, v83, v83
    v_cvt_pk_f16_f32 v48, v168, v169
    v_cvt_pk_f16_f32 v49, v170, v171
    v_pk_fmac_f16 v115, v48, v48
    v_pk_fmac_f16 v115, v49, v49
    v_cvt_pk_f16_f32 v24, v24, v25
    v_cvt_pk_f16_f32 v25, v26, v27
    v_pk_fma_f16 v159, v24, v24, s39
    v_pk_fmac_f16 v159, v25, v25
    buffer_load_dwordx4 v120, s[76:79], s92 offen offset:1024 lds
    v_cvt_pk_f16_f32 v26, v164, v165
    v_cvt_pk_f16_f32 v27, v166, v167
    v_pk_fmac_f16 v159, v26, v26
    v_pk_fmac_f16 v159, v27, v27
    v_cvt_pk_f16_f32 v148, v148, v149
    v_cvt_pk_f16_f32 v149, v150, v151
    v_pk_fmac_f16 v159, v148, v148
    v_pk_fmac_f16 v159, v149, v149
    v_cvt_pk_f16_f32 v104, v104, v105
    v_cvt_pk_f16_f32 v105, v106, v107
    v_pk_fma_f16 v157, v104, v104, s39
    v_pk_fmac_f16 v157, v105, v105
    v_cvt_pk_f16_f32 v106, v160, v161
    v_cvt_pk_f16_f32 v107, v162, v163
    v_pk_fmac_f16 v157, v106, v106
    v_pk_fmac_f16 v157, v107, v107
    v_cvt_pk_f16_f32 v154, v88, v89
    s_waitcnt vmcnt(8)
    ds_read_b64_tr_b16 a[156:157], v138 offset:36864
    buffer_load_dwordx4 v28, s[76:79], s92 offen offset:2048 lds
    s_add_u32 m0, s90, 12288
    s_mov_b32 s92, 12288
    ds_read_b64_tr_b16 a[158:159], v138 offset:37632
    v_cvt_pk_f16_f32 v155, v90, v91
    v_pk_fmac_f16 v157, v154, v154
    v_pk_fmac_f16 v157, v155, v155
    ds_read_b64_tr_b16 a[180:181], v138 offset:36872
    v_pk_fmac_f16 v113, v109, v109
    v_mfma_f32_16x16x32_f16 v[88:91], v[212:215], v[156:159], 0
    ds_read_b64_tr_b16 a[182:183], v138 offset:37640
    v_cvt_pk_f16_f32 v110, v116, v117
    v_cvt_pk_f16_f32 v111, v118, v119
    v_pk_fmac_f16 v113, v110, v110
    ds_read_b64_tr_b16 a[204:205], v5 offset:36928
    buffer_load_dwordx4 v4, s[76:79], s92 offen offset:0 lds
    ds_read_b64_tr_b16 a[206:207], v5 offset:37696
    v_pk_fmac_f16 v113, v111, v111
    v_cvt_pk_f16_f32 v96, v20, v21
    v_cvt_pk_f16_f32 v97, v22, v23
    v_pk_fmac_f16 v113, v96, v96
    v_pk_fmac_f16 v113, v97, v97
    v_mov_b32 v171, 0
    v_mov_b32 v167, 0
    v_mfma_f32_16x16x32_f16 v[20:23], v[212:215], v[112:115], 0
    s_nop 0
    v_mov_b32 v163, 0
    v_mov_b32 v159, 0
    v_mov_b32 v150, 0
    v_mov_b32 v151, 0
    v_mov_b32 v144, 0
    v_mov_b32 v145, 0
    buffer_load_dwordx4 v120, s[76:79], s92 offen offset:1024 lds
    v_or3_b32 v123, v123, v20, v21
    v_rsq_f32 v20, v20
    v_rsq_f32 v21, v21
    v_mul_f32 v20, s52, v20
    v_cvt_pk_f16_f32 v20, v20, v21
    v_or3_b32 v123, v123, v22, v23
    v_rsq_f32 v22, v22
    v_rsq_f32 v23, v23
    v_mul_f32 v22, s52, v22
    v_cvt_pk_f16_f32 v22, v22, v23
    v_pk_mul_f16 v84, v84, v20 op_sel:[0,0] op_sel_hi:[1,0]
    v_pk_mul_f16 v85, v85, v20 op_sel:[0,0] op_sel_hi:[1,0]
    v_pk_mul_f16 v86, v86, v20 op_sel:[0,0] op_sel_hi:[1,0]
    s_waitcnt vmcnt(8)
    ds_read_b64_tr_b16 a[160:161], v138 offset:49152
    buffer_load_dwordx4 v28, s[76:79], s92 offen offset:2048 lds
    s_add_u32 m0, s90, 24576
    s_mov_b32 s92, 24576
    ds_read_b64_tr_b16 a[162:163], v138 offset:49920
    v_pk_mul_f16 v87, v87, v20 op_sel:[0,0] op_sel_hi:[1,0]
    v_pk_mul_f16 v18, v18, v20 op_sel:[0,0] op_sel_hi:[1,0]
    v_pk_mul_f16 v19, v19, v20 op_sel:[0,0] op_sel_hi:[1,0]
    ds_read_b64_tr_b16 a[184:185], v138 offset:49160
    v_pk_mul_f16 v108, v108, v20 op_sel:[0,1] op_sel_hi:[1,1]
    v_pk_mul_f16 v109, v109, v20 op_sel:[0,1] op_sel_hi:[1,1]
    v_pk_mul_f16 v110, v110, v20 op_sel:[0,1] op_sel_hi:[1,1]
    ds_read_b64_tr_b16 a[186:187], v138 offset:49928
    v_pk_mul_f16 v111, v111, v20 op_sel:[0,1] op_sel_hi:[1,1]
    ds_read_b64_tr_b16 a[208:209], v5 offset:49216
    s_waitcnt lgkmcnt(5)
    buffer_load_dwordx4 v4, s[76:79], s92 offen offset:0 lds
    ds_read_b64_tr_b16 a[210:211], v5 offset:49984
    v_pk_mul_f16 v96, v96, v20 op_sel:[0,1] op_sel_hi:[1,1]
    v_pk_mul_f16 v97, v97, v20 op_sel:[0,1] op_sel_hi:[1,1]
    v_fma_mix_f32 v0, v84, v108, 0 op_sel:[0,0,0] op_sel_hi:[1,1,0]
    v_fma_mix_f32 v0, v84, v108, v0 op_sel:[1,1,0] op_sel_hi:[1,1,0]
    v_fma_mix_f32 v0, v85, v109, v0 op_sel:[0,0,0] op_sel_hi:[1,1,0]
    v_fma_mix_f32 v0, v85, v109, v0 op_sel:[1,1,0] op_sel_hi:[1,1,0]
    v_fma_mix_f32 v0, v86, v110, v0 op_sel:[0,0,0] op_sel_hi:[1,1,0]
    v_fma_mix_f32 v0, v86, v110, v0 op_sel:[1,1,0] op_sel_hi:[1,1,0]
    v_fma_mix_f32 v0, v87, v111, v0 op_sel:[0,0,0] op_sel_hi:[1,1,0]
    v_fma_mix_f32 v0, v87, v111, v0 op_sel:[1,1,0] op_sel_hi:[1,1,0]
    v_fma_mix_f32 v0, v18, v96, v0 op_sel:[0,0,0] op_sel_hi:[1,1,0]
    v_fma_mix_f32 v0, v18, v96, v0 op_sel:[1,1,0] op_sel_hi:[1,1,0]
    v_fma_mix_f32 v0, v19, v97, v0 op_sel:[0,0,0] op_sel_hi:[1,1,0]
    v_fma_mix_f32 v0, v19, v97, v0 op_sel:[1,1,0] op_sel_hi:[1,1,0]
    v_mov_b32 v139, v0
    buffer_load_dwordx4 v120, s[76:79], s92 offen offset:1024 lds
    ds_write_b128 v33, v[108:111]
    v_permlane32_swap_b32 v139, v0
    v_add_f32 v0, v139, v0
    v_mov_b32 v139, v0
    v_or3_b32 v123, v123, v88, v89
    v_rsq_f32 v88, v88
    v_permlane16_swap_b32 v139, v0
    v_add_f32 v0, v139, v0
    buffer_load_dwordx4 v28, s[76:79], s92 offen offset:2048 lds
    s_add_u32 m0, s90, 36864
    s_mov_b32 s92, 36864
    s_waitcnt vmcnt(9)
    ds_read_b64_tr_b16 a[164:165], v138 offset:61440
    v_rsq_f32 v89, v89
    v_mul_f32 v88, s52, v88
    ds_read_b64_tr_b16 a[166:167], v138 offset:62208
    v_mfma_f32_16x16x32_bf16 v[116:119], a[144:147], v[76:79], 0
    v_cvt_pk_f16_f32 v88, v88, v89
    v_or3_b32 v123, v123, v90, v91
    v_mfma_f32_16x16x32_bf16 v[116:119], a[148:151], v[64:67], v[116:119]
    ds_read_b64_tr_b16 a[188:189], v138 offset:61448
    v_pk_mul_f16 v104, v104, v88 op_sel:[0,1] op_sel_hi:[1,1]
    v_mfma_f32_16x16x32_bf16 v[116:119], a[152:155], v[68:71], v[116:119]
    buffer_load_dwordx4 v4, s[76:79], s92 offen offset:0 lds
    ds_read_b64_tr_b16 a[190:191], v138 offset:62216
    v_mfma_f32_16x16x32_bf16 v[116:119], a[156:159], v[56:59], v[116:119]
    s_waitcnt lgkmcnt(4)
    v_rsq_f32 v90, v90
    v_mfma_f32_16x16x32_bf16 v[116:119], a[160:163], v[52:55], v[116:119]
    s_waitcnt lgkmcnt(2)
    ds_read_b64_tr_b16 a[212:213], v5 offset:61504
    v_mul_f32 v90, s52, v90
    v_rsq_f32 v91, v91
    ds_read_b64_tr_b16 a[214:215], v5 offset:62272
    v_cvt_pk_f16_f32 v90, v90, v91
    ds_write_b128 v33, v[84:87] offset:32
    buffer_load_dwordx4 v120, s[76:79], s92 offen offset:1024 lds
    v_mfma_f32_16x16x32_bf16 v[116:119], a[164:167], v[44:47], v[116:119]
    v_pk_mul_f16 v105, v105, v88 op_sel:[0,1] op_sel_hi:[1,1]
    v_pk_mul_f16 v106, v106, v88 op_sel:[0,1] op_sel_hi:[1,1]
    v_mfma_f32_16x16x32_bf16 v[84:87], a[168:171], v[76:79], 0
    v_pk_mul_f16 v107, v107, v88 op_sel:[0,1] op_sel_hi:[1,1]
    v_pk_mul_f16 v154, v154, v88 op_sel:[0,1] op_sel_hi:[1,1]
    v_mfma_f32_16x16x32_bf16 v[84:87], a[172:175], v[64:67], v[84:87]
    ds_write2_b64 v33, v[96:97], v[30:31] offset0:6 offset1:7
    v_mfma_f32_16x16x32_bf16 v[84:87], a[176:179], v[68:71], v[84:87]
    buffer_load_dwordx4 v28, s[76:79], s92 offen offset:2048 lds
    v_pk_mul_f16 v155, v155, v88 op_sel:[0,1] op_sel_hi:[1,1]
    v_mfma_f32_16x16x32_bf16 v[84:87], a[180:183], v[56:59], v[84:87]
    s_add_u32 m0, s90, 49152
    v_pk_mul_f16 v224, v224, v88 op_sel:[0,0] op_sel_hi:[1,0]
    v_pk_mul_f16 v225, v225, v88 op_sel:[0,0] op_sel_hi:[1,0]
    v_mfma_f32_16x16x32_bf16 v[84:87], a[184:187], v[52:55], v[84:87]
    s_waitcnt lgkmcnt(1)
    s_mov_b32 s92, 49152
    ds_write2_b64 v33, v[30:31], v[18:19] offset0:8 offset1:9
    v_mfma_f32_16x16x32_bf16 v[84:87], a[188:191], v[44:47], v[84:87]
    v_pk_mul_f16 v226, v226, v88 op_sel:[0,0] op_sel_hi:[1,0]
    v_pk_mul_f16 v227, v227, v88 op_sel:[0,0] op_sel_hi:[1,0]
    v_mfma_f32_16x16x32_bf16 v[108:111], a[192:195], v[76:79], 0
    buffer_load_dwordx4 v4, s[76:79], s92 offen offset:0 lds
    v_pk_mul_f16 v152, v152, v88 op_sel:[0,0] op_sel_hi:[1,0]
    v_mfma_f32_16x16x32_bf16 v[108:111], a[196:199], v[64:67], v[108:111]
    ds_read_b128 v[64:67], v7 offset:3072
    v_pk_mul_f16 v153, v153, v88 op_sel:[0,0] op_sel_hi:[1,0]
    v_mfma_f32_16x16x32_bf16 v[108:111], a[200:203], v[68:71], v[108:111]
    ds_read_b128 v[76:79], v6 offset:3072
    v_pk_mul_f16 v24, v24, v90 op_sel:[0,1] op_sel_hi:[1,1]
    v_mfma_f32_16x16x32_bf16 v[108:111], a[204:207], v[56:59], v[108:111]
    ds_read_b128 v[112:115], v7 offset:3200
    v_pk_mul_f16 v25, v25, v90 op_sel:[0,1] op_sel_hi:[1,1]
    v_mfma_f32_16x16x32_bf16 v[108:111], a[208:211], v[52:55], v[108:111]
    ds_read_b128 v[56:59], v6 offset:3200
    v_pk_mul_f16 v26, v26, v90 op_sel:[0,1] op_sel_hi:[1,1]
    v_mfma_f32_16x16x32_bf16 v[108:111], a[212:215], v[44:47], v[108:111]
    buffer_load_dwordx4 v120, s[76:79], s92 offen offset:1024 lds
    ds_read_b128 v[52:55], v7 offset:3328
    v_mfma_f32_16x16x32_f16 v[68:71], v[104:107], v[224:227], v[204:207]
    v_pk_mul_f16 v27, v27, v90 op_sel:[0,1] op_sel_hi:[1,1]
    v_pk_mul_f16 v148, v148, v90 op_sel:[0,1] op_sel_hi:[1,1]
    v_mfma_f32_16x16x32_f16 v[68:71], v[152:155], v[150:153], v[68:71]
    ds_read_b128 v[44:47], v6 offset:3328
    v_pk_mul_f16 v149, v149, v90 op_sel:[0,1] op_sel_hi:[1,1]
    v_pk_mul_f16 v232, v232, v90 op_sel:[0,0] op_sel_hi:[1,0]
    v_pk_mul_f16 v233, v233, v90 op_sel:[0,0] op_sel_hi:[1,0]
    v_pk_mul_f16 v234, v234, v90 op_sel:[0,0] op_sel_hi:[1,0]
    v_pk_mul_f16 v235, v235, v90 op_sel:[0,0] op_sel_hi:[1,0]
    v_pk_mul_f16 v146, v146, v90 op_sel:[0,0] op_sel_hi:[1,0]
    v_pk_mul_f16 v147, v147, v90 op_sel:[0,0] op_sel_hi:[1,0]
    v_mfma_f32_16x16x32_f16 v[244:247], v[24:27], v[224:227], v[200:203]
    v_mov_b32 v138, 0
    v_mov_b32 v139, 0
    v_mfma_f32_16x16x32_f16 v[244:247], v[146:149], v[150:153], v[244:247]
    s_waitcnt lgkmcnt(4)
    buffer_load_dwordx4 v28, s[76:79], s92 offen offset:2048 lds
    v_cvt_pk_bf16_f32 v18, v116, v117
    v_mfma_f32_16x16x32_bf16 v[88:91], v[64:67], a[144:147], 0
    s_add_u32 m0, s90, 61440
    v_cvt_pk_bf16_f32 v19, v118, v119
    v_cvt_pk_bf16_f32 v84, v84, v85
    v_mfma_f32_16x16x32_bf16 v[88:91], v[76:79], a[148:151], v[88:91]
    s_waitcnt lgkmcnt(2)
    s_mov_b32 s92, 61440
    ds_write_b64 v29, v[18:19] offset:28752
    v_mfma_f32_16x16x32_bf16 v[88:91], v[112:115], a[152:155], v[88:91]
    v_cvt_pk_bf16_f32 v85, v86, v87
    v_cvt_pk_bf16_f32 v86, v108, v109
    v_mfma_f32_16x16x32_bf16 v[88:91], v[56:59], a[156:159], v[88:91]
    s_waitcnt lgkmcnt(2)
    v_cvt_pk_bf16_f32 v87, v110, v111
    v_add_f32 v0, s84, v0
    v_mfma_f32_16x16x32_bf16 v[88:91], v[52:55], a[160:163], v[88:91]
    s_waitcnt lgkmcnt(1)
    buffer_load_dwordx4 v4, s[76:79], s92 offen offset:0 lds
    v_cvt_pk_f16_f32 v108, v36, v37
    v_mfma_f32_16x16x32_bf16 v[88:91], v[44:47], a[164:167], v[88:91]
    ds_write_b128 v29, v[84:87] offset:28768
    v_mfma_f32_16x16x32_bf16 v[84:87], v[64:67], a[168:171], 0
    v_exp_f32 v0, v0
    v_mfma_f32_16x16x32_bf16 v[84:87], v[76:79], a[172:175], v[84:87]
    v_cvt_pk_bf16_f32 v0, v0, 0
    v_cmp_gt_u32 vcc, 16, v2
    v_mfma_f32_16x16x32_bf16 v[84:87], v[112:115], a[176:179], v[84:87]
    buffer_load_dwordx4 v120, s[76:79], s92 offen offset:1024 lds
    v_cndmask_b32 v0, 0, v0, vcc
    v_mfma_f32_16x16x32_bf16 v[84:87], v[56:59], a[180:183], v[84:87]
    ds_write_b64 v33, v[0:1] offset:88
    v_mfma_f32_16x16x32_bf16 v[84:87], v[52:55], a[184:187], v[84:87]
    v_cvt_pk_bf16_f32 v164, v88, v89
    v_cvt_pk_bf16_f32 v165, v90, v91
    v_mfma_f32_16x16x32_bf16 v[84:87], v[44:47], a[188:191], v[84:87]
    ds_read_b128 v[88:91], v132 offset:0
    v_cvt_pk_f16_f32 v109, v38, v39
    v_mfma_f32_16x16x32_bf16 v[36:39], v[64:67], a[192:195], 0
    ds_read_b128 v[64:67], v132 offset:16
    buffer_load_dwordx4 v28, s[76:79], s92 offen offset:2048 lds
    v_mfma_f32_16x16x32_bf16 v[36:39], v[76:79], a[196:199], v[36:39]
    s_add_u32 m0, s54, 20480
    ds_read_b128 v[76:79], v132 offset:48
    v_cvt_pk_bf16_f32 v160, v84, v85
    v_mfma_f32_16x16x32_bf16 v[36:39], v[112:115], a[200:203], v[36:39]
    v_cvt_pk_bf16_f32 v161, v86, v87
    v_pk_fma_f16 v33, v108, v108, s39
    v_mfma_f32_16x16x32_bf16 v[36:39], v[56:59], a[204:207], v[36:39]
    ds_read_u16 v166, v131 offset:80
    v_pk_fmac_f16 v33, v109, v109
    v_mfma_f32_16x16x32_bf16 v[36:39], v[52:55], a[208:211], v[36:39]
    ds_read_u16 v162, v131 offset:96
    v_cvt_pk_f16_f32 v110, v40, v41
    v_mfma_f32_16x16x32_bf16 v[36:39], v[44:47], a[212:215], v[36:39]
    ds_read_u16 v158, v131 offset:104
    buffer_load_dwordx4 v128, s[24:27], s56 offen nt lds
    v_mfma_f32_16x16x32_f16 v[228:231], v[104:107], v[232:235], v[192:195]
    s_add_u32 m0, s54, 21504
    v_cvt_pk_f16_f32 v111, v42, v43
    v_pk_fmac_f16 v33, v110, v110
    v_mfma_f32_16x16x32_f16 v[228:231], v[152:155], v[144:147], v[228:231]
    s_nop 0
    v_cvt_pk_bf16_f32 v156, v36, v37
    v_cvt_pk_bf16_f32 v157, v38, v39
    v_mfma_f32_16x16x32_f16 v[36:39], v[24:27], v[232:235], v[188:191]
    v_pk_fmac_f16 v33, v111, v111
    v_cvt_pk_f16_f32 v142, v12, v13
    v_mfma_f32_16x16x32_f16 v[36:39], v[146:149], v[144:147], v[36:39]
    s_waitcnt lgkmcnt(4)
    ds_read_b128 v[18:21], v7 offset:42496
    v_cvt_pk_f16_f32 v143, v14, v15
    v_mfma_f32_16x16x32_f16 v[40:43], v[88:91], v[224:227], v[208:211]
    ds_read_b128 v[252:255], v6 offset:42496
    buffer_load_dwordx4 v127, s[24:27], s56 offen nt lds
    v_mfma_f32_16x16x32_f16 v[40:43], v[64:67], v[104:107], v[40:43]
    s_waitcnt lgkmcnt(5)
    s_add_u32 m0, s54, 22528
    ds_read_b128 v[248:251], v7 offset:42624
    v_pk_fmac_f16 v33, v142, v142
    v_mfma_f32_16x16x32_f16 v[40:43], v[76:79], v[152:155], v[40:43]
    ds_read_b128 v[116:119], v6 offset:42624
    v_pk_fmac_f16 v33, v143, v143
    v_mfma_f32_16x16x32_f16 v[44:47], v[88:91], v[232:235], v[208:211]
    ds_read_b128 v[52:55], v7 offset:42752
    v_pk_mul_f16 v60, v60, v22 op_sel:[0,0] op_sel_hi:[1,0]
    v_mfma_f32_16x16x32_f16 v[44:47], v[64:67], v[24:27], v[44:47]
    ds_read_b128 v[112:115], v6 offset:42752
    v_pk_mul_f16 v61, v61, v22 op_sel:[0,0] op_sel_hi:[1,0]
    v_mfma_f32_16x16x32_f16 v[44:47], v[76:79], v[146:149], v[44:47]
    v_exp_f32 v68, v68
    v_mfma_f32_16x16x32_f16 v[12:15], v[212:215], v[32:35], 0
    s_waitcnt lgkmcnt(5)
    s_nop 0
    buffer_load_dwordx4 v126, s[24:27], s56 offen nt lds
    v_pk_mul_f16 v62, v62, v22 op_sel:[0,0] op_sel_hi:[1,0]
    v_exp_f32 v69, v69
    s_add_u32 m0, s54, 23552
    v_mov_b32_dpp v43, v47 quad_perm:[0,1,2,3] row_mask:0x2 bank_mask:0xf
    v_exp_f32 v70, v70
    v_mfma_f32_16x16x32_bf16 v[56:59], a[144:147], v[18:21], 0
    s_waitcnt lgkmcnt(4)
    v_or3_b32 v123, v123, v12, v13
    v_cvt_pk_bf16_f32 v68, v68, v69
    v_mfma_f32_16x16x32_bf16 v[56:59], a[148:151], v[252:255], v[56:59]
    s_waitcnt lgkmcnt(3)
    v_rsq_f32 v12, v12
    v_mfma_f32_16x16x32_bf16 v[56:59], a[152:155], v[248:251], v[56:59]
    s_waitcnt lgkmcnt(2)
    buffer_load_dwordx4 v125, s[24:27], s56 offen nt lds
    v_mul_f32 v12, s52, v12
    v_mfma_f32_16x16x32_bf16 v[56:59], a[156:159], v[116:119], v[56:59]
    s_waitcnt lgkmcnt(1)
    s_add_u32 m0, s54, 24576
    v_rsq_f32 v13, v13
    v_mfma_f32_16x16x32_bf16 v[56:59], a[160:163], v[52:55], v[56:59]
    s_waitcnt lgkmcnt(0)
    v_cvt_pk_f16_f32 v12, v12, v13
    v_pk_mul_f16 v108, v108, v12 op_sel:[0,1] op_sel_hi:[1,1]
    v_mfma_f32_16x16x32_bf16 v[56:59], a[164:167], v[112:115], v[56:59]
    v_pk_mul_f16 v109, v109, v12 op_sel:[0,1] op_sel_hi:[1,1]
    v_pk_mul_f16 v110, v110, v12 op_sel:[0,1] op_sel_hi:[1,1]
    v_mfma_f32_16x16x32_bf16 v[32:35], a[168:171], v[18:21], 0
    v_pk_mul_f16 v111, v111, v12 op_sel:[0,1] op_sel_hi:[1,1]
    v_pk_mul_f16 v142, v142, v12 op_sel:[0,1] op_sel_hi:[1,1]
    v_mfma_f32_16x16x32_bf16 v[32:35], a[172:175], v[252:255], v[32:35]
    buffer_load_dwordx4 v124, s[24:27], s56 offen nt lds
    v_pk_mul_f16 v143, v143, v12 op_sel:[0,1] op_sel_hi:[1,1]
    v_mfma_f32_16x16x32_bf16 v[32:35], a[176:179], v[248:251], v[32:35]
    s_cmp_lt_u32 s61, s71
    v_pk_mul_f16 v92, v92, v12 op_sel:[0,0] op_sel_hi:[1,0]
    v_pk_mul_f16 v93, v93, v12 op_sel:[0,0] op_sel_hi:[1,0]
    v_mfma_f32_16x16x32_bf16 v[32:35], a[180:183], v[116:119], v[32:35]
    s_cselect_b32 s15, s61, s12
    v_pk_mul_f16 v94, v94, v12 op_sel:[0,0] op_sel_hi:[1,0]
    v_pk_mul_f16 v95, v95, v12 op_sel:[0,0] op_sel_hi:[1,0]
    v_mfma_f32_16x16x32_bf16 v[32:35], a[184:187], v[52:55], v[32:35]
    s_cselect_b32 s56, s69, s70
    ds_read_b128 v[236:239], v7 offset:0
    v_pk_mul_f16 v140, v140, v12 op_sel:[0,0] op_sel_hi:[1,0]
    v_mfma_f32_16x16x32_bf16 v[32:35], a[188:191], v[112:115], v[32:35]
    s_add_u32 s56, s56, s15
    ds_read_b128 v[84:87], v6 offset:0
    v_pk_mul_f16 v141, v141, v12 op_sel:[0,0] op_sel_hi:[1,0]
    v_mfma_f32_16x16x32_f16 v[240:243], v[108:111], v[224:227], v[196:199]
    s_mul_i32 s53, s56, 58255
    buffer_load_dword v28, v126, s[28:31], s72 offen nt
    ds_read_b128 v[224:227], v7 offset:128
    v_mfma_f32_16x16x32_f16 v[240:243], v[140:143], v[150:153], v[240:243]
    s_lshr_b32 s53, s53, 22
    v_exp_f32 v71, v71
    v_mfma_f32_16x16x32_f16 v[12:15], v[88:91], v[92:95], v[208:211]
    s_mul_i32 s53, s53, s63
    ds_read_b128 v[88:91], v6 offset:128
    v_cvt_pk_bf16_f32 v69, v70, v71
    v_mfma_f32_16x16x32_f16 v[12:15], v[64:67], v[108:111], v[12:15]
    s_mul_i32 s56, s56, s62
    ds_read_b128 v[64:67], v7 offset:256
    v_cvt_pk_bf16_f32 v30, v56, v57
    v_mfma_f32_16x16x32_f16 v[12:15], v[76:79], v[140:143], v[12:15]
    s_add_u32 s56, s56, s53
    ds_read_b128 v[76:79], v6 offset:256
    v_cvt_pk_bf16_f32 v31, v58, v59
    v_mfma_f32_16x16x32_f16 v[56:59], v[108:111], v[232:235], v[184:187]
    s_mul_i32 s4, s15, 112
    v_exp_f32 v244, v244
    v_mfma_f32_16x16x32_f16 v[56:59], v[140:143], v[144:147], v[56:59]
    s_cmp_ge_u32 s15, 16
    v_mov_b32_dpp v43, v15 quad_perm:[0,1,2,3] row_mask:0x4 bank_mask:0xf
    v_cvt_pk_bf16_f32 v32, v32, v33
    v_mfma_f32_16x16x32_bf16 v[232:235], a[192:195], v[18:21], 0
    s_cselect_b32 s53, -30464, 0
    v_exp_f32 v43, v43
    v_mfma_f32_16x16x32_bf16 v[232:235], a[196:199], v[252:255], v[232:235]
    s_add_u32 s4, s4, s53
    v_cvt_pk_bf16_f32 v43, v43, v43
    v_cvt_pk_bf16_f32 v33, v34, v35
    v_mfma_f32_16x16x32_bf16 v[232:235], a[200:203], v[248:251], v[232:235]
    s_cmp_lt_u32 s15, s73
    ds_write_b16 v131, v43 offset:64
    v_mfma_f32_16x16x32_bf16 v[232:235], a[204:207], v[116:119], v[232:235]
    s_cselect_b32 s26, 100270464, 0
    ds_read_b128 v[116:119], v132 offset:48
    v_pk_mul_f16 v63, v63, v22 op_sel:[0,0] op_sel_hi:[1,0]
    v_mfma_f32_16x16x32_bf16 v[232:235], a[208:211], v[52:55], v[232:235]
    s_cselect_b32 s56, s56, 0
    ds_read_b128 v[52:55], v132 offset:64
    v_pk_mul_f16 v16, v16, v22 op_sel:[0,0] op_sel_hi:[1,0]
    v_mfma_f32_16x16x32_bf16 v[232:235], a[212:215], v[112:115], v[232:235]
    s_waitcnt lgkmcnt(4)
    s_cselect_b32 s4, s4, -1
    v_exp_f32 v245, v245
    v_mfma_f32_16x16x32_bf16 v[112:115], v[236:239], a[144:147], 0
    s_cselect_b32 s15, s15, 0
    v_exp_f32 v246, v246
    v_mfma_f32_16x16x32_bf16 v[112:115], v[84:87], a[148:151], v[112:115]
    s_cselect_b32 s13, s13, -1
    v_exp_f32 v247, v247
    v_mfma_f32_16x16x32_bf16 v[112:115], v[224:227], a[152:155], v[112:115]
    s_bitset1_b32 s64, s15
    v_cvt_pk_bf16_f32 v70, v244, v245
    v_cvt_pk_bf16_f32 v71, v246, v247
    v_mfma_f32_16x16x32_bf16 v[112:115], v[88:91], a[156:159], v[112:115]
    s_cmp_ge_i32 s65, 2
    v_exp_f32 v240, v240
    v_mfma_f32_16x16x32_bf16 v[112:115], v[64:67], a[160:163], v[112:115]
    s_waitcnt vmcnt(6) lgkmcnt(3)
    s_cselect_b32 s30, 100270464, 0
    v_exp_f32 v241, v241
    v_mfma_f32_16x16x32_bf16 v[112:115], v[76:79], a[164:167], v[112:115]
    s_barrier
    v_exp_f32 v242, v242
    v_exp_f32 v243, v243
    v_cvt_pk_bf16_f32 v168, v240, v241
    v_cvt_pk_bf16_f32 v169, v242, v243
    v_exp_f32 v40, v40
    v_exp_f32 v228, v228
    v_cvt_pk_bf16_f32 v170, v40, 0
    v_mfma_f32_16x16x32_bf16 v[40:43], v[236:239], a[168:171], 0
    v_exp_f32 v229, v229
    v_mfma_f32_16x16x32_bf16 v[40:43], v[84:87], a[172:175], v[40:43]
    s_lshl_b32 s93, s68, 10
    v_exp_f32 v230, v230
    v_mfma_f32_16x16x32_bf16 v[40:43], v[224:227], a[176:179], v[40:43]
    s_mov_b32 s53, s47
    v_exp_f32 v231, v231
    v_mfma_f32_16x16x32_bf16 v[40:43], v[88:91], a[180:183], v[40:43]
    s_mov_b32 s47, s46
    v_cvt_pk_bf16_f32 v228, v228, v229
    v_cvt_pk_bf16_f32 v229, v230, v231
    v_mfma_f32_16x16x32_bf16 v[40:43], v[64:67], a[184:187], v[40:43]
    s_mov_b32 s46, s45
    v_exp_f32 v36, v36
    v_mfma_f32_16x16x32_bf16 v[40:43], v[76:79], a[188:191], v[40:43]
    s_mov_b32 s45, s44
    ds_read_b128 v[244:247], v10 offset:0
    v_cvt_pk_bf16_f32 v34, v232, v233
    v_exp_f32 v37, v37
    v_exp_f32 v38, v38
    v_exp_f32 v39, v39
    v_cvt_pk_bf16_f32 v230, v36, v37
    v_cvt_pk_bf16_f32 v231, v38, v39
    v_exp_f32 v56, v56
    v_exp_f32 v57, v57
    v_exp_f32 v58, v58
    v_exp_f32 v59, v59
    v_exp_f32 v45, v45
    v_mfma_f32_16x16x32_bf16 v[36:39], v[236:239], a[192:195], 0
    s_mov_b32 s44, s53
    ds_read_b64 v[240:241], v3 offset:64
    v_cvt_pk_bf16_f32 v35, v234, v235
    v_mfma_f32_16x16x32_bf16 v[36:39], v[84:87], a[196:199], v[36:39]
    s_sub_u32 s48, s44, s46
    ds_read_b128 v[84:87], v10 offset:3072
    v_cvt_pk_bf16_f32 v0, v112, v113
    v_mfma_f32_16x16x32_bf16 v[36:39], v[224:227], a[200:203], v[36:39]
    s_sub_u32 s49, s46, s45
    ds_read_b64 v[242:243], v3 offset:3136
    v_cvt_pk_bf16_f32 v1, v114, v115
    v_mfma_f32_16x16x32_bf16 v[36:39], v[88:91], a[204:207], v[36:39]
    ds_read_b128 v[224:227], v10 offset:6144
    v_cvt_pk_bf16_f32 v8, v40, v41
    v_mfma_f32_16x16x32_bf16 v[36:39], v[64:67], a[208:211], v[36:39]
    ds_read_b64 v[64:65], v3 offset:6208
    v_cvt_pk_bf16_f32 v9, v42, v43
    v_mfma_f32_16x16x32_bf16 v[36:39], v[76:79], a[212:215], v[36:39]
    ds_read_b128 v[76:79], v10 offset:9216
    v_pk_mul_f16 v17, v17, v22 op_sel:[0,0] op_sel_hi:[1,0]
    v_mfma_f32_16x16x32_bf16 v[88:91], v[220:223], v[68:71], 0
    ds_read_b64 v[66:67], v3 offset:9280
    v_pk_mul_f16 v80, v80, v22 op_sel:[0,1] op_sel_hi:[1,1]
    v_mfma_f32_16x16x32_bf16 v[88:91], v[220:223], v[168:171], v[88:91]
    s_nop 0
    ds_read_b128 v[112:115], v10 offset:12288
    v_cvt_pk_bf16_f32 v4, v36, v37
    v_mfma_f32_16x16x32_f16 v[40:43], v[104:107], v[92:95], v[180:183]
    ds_read_b64 v[104:105], v3 offset:12352
    v_cvt_pk_bf16_f32 v5, v38, v39
    v_mfma_f32_16x16x32_f16 v[40:43], v[152:155], v[138:141], v[40:43]
    ds_read_b128 v[232:235], v10 offset:15360
    v_pk_mul_f16 v81, v81, v22 op_sel:[0,1] op_sel_hi:[1,1]
    v_mfma_f32_16x16x32_f16 v[36:39], v[24:27], v[92:95], v[176:179]
    ds_read_b64 v[106:107], v3 offset:15424
    v_pk_mul_f16 v82, v82, v22 op_sel:[0,1] op_sel_hi:[1,1]
    v_mfma_f32_16x16x32_f16 v[36:39], v[146:149], v[138:141], v[36:39]
    ds_read_b128 v[236:239], v10 offset:18432
    v_pk_mul_f16 v83, v83, v22 op_sel:[0,1] op_sel_hi:[1,1]
    v_mfma_f32_16x16x32_f16 v[24:27], v[108:111], v[92:95], v[172:175]
    ds_read_b64 v[20:21], v3 offset:18496
    v_pk_mul_f16 v48, v48, v22 op_sel:[0,1] op_sel_hi:[1,1]
    v_mfma_f32_16x16x32_f16 v[24:27], v[140:143], v[138:141], v[24:27]
    s_waitcnt lgkmcnt(8)
    ds_read_b128 v[108:111], v10 offset:21504
    v_pk_mul_f16 v49, v49, v22 op_sel:[0,1] op_sel_hi:[1,1]
    v_mfma_f32_16x16x32_bf16 v[92:95], v[244:247], v[220:223], 0
    ds_read_b64 v[22:23], v3 offset:21568
    v_fma_mix_f32 v120, v60, v80, 0 op_sel:[0,0,0] op_sel_hi:[1,1,0]
    v_mfma_f32_16x16x32_bf16 v[92:95], v[84:87], v[220:223], v[92:95]
    ds_read_b128 v[84:87], v10 offset:24576
    v_fma_mix_f32 v120, v60, v80, v120 op_sel:[1,1,0] op_sel_hi:[1,1,0]
    v_mfma_f32_16x16x32_bf16 v[92:95], v[224:227], v[220:223], v[92:95]
    s_waitcnt lgkmcnt(8)
    ds_read_b64 v[224:225], v3 offset:24640
    v_fma_mix_f32 v120, v61, v81, v120 op_sel:[0,0,0] op_sel_hi:[1,1,0]
    v_mfma_f32_16x16x32_bf16 v[92:95], v[76:79], v[220:223], v[92:95]
    ds_read_b128 v[76:79], v10 offset:27648
    v_fma_mix_f32 v120, v61, v81, v120 op_sel:[1,1,0] op_sel_hi:[1,1,0]
    v_mfma_f32_16x16x32_bf16 v[92:95], v[240:243], v[220:223], v[92:95]
    ds_read_b64 v[226:227], v3 offset:27712
    v_fma_mix_f32 v120, v62, v82, v120 op_sel:[0,0,0] op_sel_hi:[1,1,0]
    v_mfma_f32_16x16x32_bf16 v[92:95], v[64:67], v[220:223], v[92:95]
    s_add_u32 m0, s67, 0
    ds_read_b128 v[64:67], v10 offset:30720
    v_fma_mix_f32 v120, v62, v82, v120 op_sel:[1,1,0] op_sel_hi:[1,1,0]
    v_mfma_f32_16x16x32_bf16 v[152:155], v[112:115], v[220:223], 0
    s_waitcnt lgkmcnt(8)
    ds_read_b64 v[112:113], v3 offset:30784
    v_fma_mix_f32 v120, v63, v83, v120 op_sel:[0,0,0] op_sel_hi:[1,1,0]
    v_mfma_f32_16x16x32_bf16 v[152:155], v[232:235], v[220:223], v[152:155]
    ds_read_b128 v[232:235], v10 offset:33792
    v_fma_mix_f32 v120, v63, v83, v120 op_sel:[1,1,0] op_sel_hi:[1,1,0]
    v_mfma_f32_16x16x32_bf16 v[152:155], v[236:239], v[220:223], v[152:155]
L_pg1:
    s_cbranch_execz L_main
    s_waitcnt lgkmcnt(8)
    ds_read_b64 v[114:115], v3 offset:33856
    v_fma_mix_f32 v120, v16, v48, v120 op_sel:[0,0,0] op_sel_hi:[1,1,0]
    v_mfma_f32_16x16x32_bf16 v[152:155], v[108:111], v[220:223], v[152:155]
    ds_read_b128 v[140:143], v7 offset:1536
    v_fma_mix_f32 v120, v16, v48, v120 op_sel:[1,1,0] op_sel_hi:[1,1,0]
    v_mfma_f32_16x16x32_bf16 v[152:155], v[104:107], v[220:223], v[152:155]
    s_waitcnt lgkmcnt(8)
    ds_read_b128 v[108:111], v6 offset:1536
    v_fma_mix_f32 v120, v17, v49, v120 op_sel:[0,0,0] op_sel_hi:[1,1,0]
    v_mfma_f32_16x16x32_bf16 v[152:155], v[20:23], v[220:223], v[152:155]
    ds_read_b128 v[104:107], v7 offset:1664
    v_fma_mix_f32 v120, v17, v49, v120 op_sel:[1,1,0] op_sel_hi:[1,1,0]
    v_mfma_f32_16x16x32_bf16 v[20:23], v[84:87], v[220:223], 0
    s_waitcnt lgkmcnt(8)
    ds_read_b128 v[84:87], v6 offset:1664
    v_mov_b32 v3, v120
    v_mfma_f32_16x16x32_bf16 v[20:23], v[76:79], v[220:223], v[20:23]
    s_waitcnt lgkmcnt(7)
    ds_read_b128 v[76:79], v7 offset:1792
    v_mul_f32 v92, 0xbbaaaaab, v92
    v_rcp_f32 v88, v88
    v_mfma_f32_16x16x32_bf16 v[20:23], v[64:67], v[220:223], v[20:23]
    s_waitcnt lgkmcnt(6)
    ds_read_b128 v[64:67], v6 offset:1792
    v_mul_f32 v93, 0xbbaaaaab, v93
    v_permlane32_swap_b32 v3, v120
    v_add_f32 v120, v3, v120
    v_mfma_f32_16x16x32_bf16 v[20:23], v[232:235], v[220:223], v[20:23]
    v_mov_b32 v3, v120
    v_mul_f32 v94, 0xbbaaaaab, v94
    v_mfma_f32_16x16x32_bf16 v[20:23], v[224:227], v[220:223], v[20:23]
    s_waitcnt lgkmcnt(5)
    v_permlane16_swap_b32 v3, v120
    v_mfma_f32_16x16x32_bf16 v[20:23], v[112:115], v[220:223], v[20:23]
    v_add_f32 v120, v3, v120
    v_add_f32 v120, s84, v120
    v_mfma_f32_16x16x32_bf16 v[112:115], v[140:143], a[144:147], 0
    s_waitcnt lgkmcnt(3)
    v_exp_f32 v120, v120
    v_mfma_f32_16x16x32_bf16 v[112:115], v[108:111], a[148:151], v[112:115]
    v_cvt_pk_bf16_f32 v120, v120, 0
    v_cmp_gt_u32 vcc, 16, v2
    v_mfma_f32_16x16x32_bf16 v[112:115], v[104:107], a[152:155], v[112:115]
    s_waitcnt lgkmcnt(1)
    v_cndmask_b32 v120, 0, v120, vcc
    v_mul_f32 v95, 0xbbaaaaab, v95
    v_mfma_f32_16x16x32_bf16 v[112:115], v[84:87], a[156:159], v[112:115]
    s_waitcnt lgkmcnt(0)
    ds_write_b128 v121, v[92:95] offset:0
    v_mfma_f32_16x16x32_bf16 v[112:115], v[76:79], a[160:163], v[112:115]
    s_barrier
    buffer_load_dwordx4 v128, s[24:27], s56 offen nt lds
    v_mul_f32 v152, 0xbbaaaaab, v152
    v_mfma_f32_16x16x32_bf16 v[112:115], v[64:67], a[164:167], v[112:115]
    s_add_u32 m0, s67, 1024
    v_mul_f32 v153, 0xbbaaaaab, v153
    v_mul_f32 v154, 0xbbaaaaab, v154
    v_mfma_f32_16x16x32_bf16 v[92:95], v[140:143], a[168:171], 0
    buffer_load_dwordx4 v127, s[24:27], s56 offen nt lds
    v_mul_f32 v155, 0xbbaaaaab, v155
    v_mfma_f32_16x16x32_bf16 v[92:95], v[108:111], a[172:175], v[92:95]
    s_add_u32 m0, s67, 2048
    ds_write_b128 v121, v[152:155] offset:128
    v_mfma_f32_16x16x32_bf16 v[92:95], v[104:107], a[176:179], v[92:95]
    buffer_load_dwordx4 v126, s[24:27], s56 offen nt lds
    v_mul_f32 v20, 0xbbaaaaab, v20
    v_mfma_f32_16x16x32_bf16 v[92:95], v[84:87], a[180:183], v[92:95]
    s_add_u32 m0, s67, 3072
    v_mul_f32 v21, 0xbbaaaaab, v21
    v_mul_f32 v22, 0xbbaaaaab, v22
    v_mfma_f32_16x16x32_bf16 v[92:95], v[76:79], a[184:187], v[92:95]
    buffer_load_dwordx4 v125, s[24:27], s56 offen nt lds
    v_mul_f32 v23, 0xbbaaaaab, v23
    v_mfma_f32_16x16x32_bf16 v[92:95], v[64:67], a[188:191], v[92:95]
    s_add_u32 m0, s67, 4096
    ds_write_b128 v121, v[20:23] offset:256
    v_mfma_f32_16x16x32_bf16 v[20:23], v[140:143], a[192:195], 0
    buffer_load_dwordx4 v124, s[24:27], s56 offen nt lds
    v_cvt_pk_bf16_f32 v2, v112, v113
    v_mfma_f32_16x16x32_bf16 v[20:23], v[108:111], a[196:199], v[20:23]
    s_nop 0
    v_cvt_pk_bf16_f32 v3, v114, v115
    v_cvt_pk_bf16_f32 v10, v92, v93
    v_mfma_f32_16x16x32_bf16 v[20:23], v[104:107], a[200:203], v[20:23]
    ds_read_b128 v[106:109], v99 offset:24576
    v_cvt_pk_bf16_f32 v11, v94, v95
    v_mfma_f32_16x16x32_bf16 v[20:23], v[84:87], a[204:207], v[20:23]
    ds_read_b64 v[110:111], v100 offset:24640
    v_and_b32 v18, 0xb8000000, v123
    v_mfma_f32_16x16x32_bf16 v[20:23], v[76:79], a[208:211], v[20:23]
    v_cmp_ne_u32 s[94:95], 0, v18
    v_add_u32 v19, s93, v129
    v_mfma_f32_16x16x32_bf16 v[20:23], v[64:67], a[212:215], v[20:23]
    s_or_b32 s94, s94, s95
    ds_read_b128 v[90:93], v99 offset:25344
    v_mov_b32 v18, s94
    v_mfma_f32_16x16x32_bf16 v[64:67], v[0:3], v[68:71], 0
    s_lshl_b32 s95, s68, 2
    ds_read_b64 v[94:95], v100 offset:25408
    v_mov_b32 v89, s95
    v_mfma_f32_16x16x32_bf16 v[64:67], v[164:167], v[168:171], v[64:67]
    s_waitcnt lgkmcnt(4)
    v_cvt_pk_bf16_f32 v6, v20, v21
    v_cvt_pk_bf16_f32 v7, v22, v23
    v_mfma_f32_16x16x32_bf16 v[76:79], v[8:11], v[68:71], 0
    s_barrier
    ds_read_b128 v[84:87], v98 offset:256
    v_add_u32 v137, s48, v137
    v_mfma_f32_16x16x32_bf16 v[76:79], v[160:163], v[168:171], v[76:79]
    ds_read_b128 v[20:23], v98 offset:320
    v_mul_f32 v64, v64, v88
    v_mfma_f32_16x16x32_bf16 v[112:115], v[4:7], v[68:71], 0
    v_mul_f32 v65, v65, v88
    v_cvt_pk_bf16_f32 v140, v64, v65
    v_mfma_f32_16x16x32_bf16 v[112:115], v[156:159], v[168:171], v[112:115]
    v_mul_f32 v66, v66, v88
    v_mul_f32 v67, v67, v88
    v_cvt_pk_bf16_f32 v141, v66, v67
    v_mfma_f32_16x16x32_bf16 v[64:67], v[116:119], v[0:3], 0
    ds_write_b64 v135, v[140:141] offset:0
    v_mfma_f32_16x16x32_bf16 v[64:67], v[52:55], v[164:167], v[64:67]
    v_mul_f32 v76, v76, v88
    v_mul_f32 v77, v77, v88
    v_mfma_f32_16x16x32_bf16 v[68:71], v[116:119], v[8:11], 0
    v_cvt_pk_bf16_f32 v142, v76, v77
    v_mul_f32 v78, v78, v88
    v_mfma_f32_16x16x32_bf16 v[68:71], v[52:55], v[160:163], v[68:71]
    v_mul_f32 v79, v79, v88
    v_cvt_pk_bf16_f32 v143, v78, v79
    v_mfma_f32_16x16x32_bf16 v[76:79], v[116:119], v[4:7], 0
    ds_write_b64 v135, v[142:143] offset:8
    v_mfma_f32_16x16x32_bf16 v[76:79], v[52:55], v[156:159], v[76:79]
    s_waitcnt lgkmcnt(2)
    v_mul_f32 v112, v112, v88
    v_mul_f32 v113, v113, v88
    v_mfma_f32_16x16x16_bf16 v[52:55], v[106:107], v[50:51], v[84:87]
    ds_write_b32 v89, v18 offset:14848
    v_cvt_pk_bf16_f32 v96, v112, v113
    v_mfma_f32_16x16x16_bf16 v[104:107], v[108:109], v[50:51], v[84:87]
    v_mul_f32 v114, v114, v88
    v_mul_f32 v115, v115, v88
    v_mfma_f32_16x16x16_bf16 v[152:155], v[110:111], v[50:51], v[84:87]
    v_cvt_pk_bf16_f32 v97, v114, v115
    v_cvt_pk_bf16_f32 v168, v56, v57
    v_mfma_f32_16x16x16_bf16 v[140:143], v[90:91], v[50:51], v[20:23]
    v_cvt_pk_bf16_f32 v169, v58, v59
    v_cvt_pk_bf16_f32 v170, v45, 0
    v_mfma_f32_16x16x16_bf16 v[88:91], v[92:93], v[50:51], v[20:23]
    ds_write_b32 v134, v96 offset:0
    v_mfma_f32_16x16x16_bf16 v[108:111], v[94:95], v[50:51], v[20:23]
    ds_write_b32 v134, v97 offset:4
    v_cvt_pk_bf16_f32 v52, v52, v53
    v_mfma_f32_16x16x32_bf16 v[44:47], v[220:223], v[228:231], 0
    ds_read_b128 v[112:115], v99 offset:49152
    v_accvgpr_write_b32 a224, v52
    v_mfma_f32_16x16x32_bf16 v[44:47], v[220:223], v[168:171], v[44:47]
    ds_read_b64 v[116:117], v100 offset:49216
    v_cvt_pk_bf16_f32 v54, v54, v55
    v_mfma_f32_16x16x32_bf16 v[20:23], v[0:3], v[228:231], 0
    ds_read_b128 v[84:87], v98 offset:5248
    v_accvgpr_write_b32 a225, v54
    v_mfma_f32_16x16x32_bf16 v[20:23], v[164:167], v[168:171], v[20:23]
    ds_read_b128 v[92:95], v99 offset:49920
    v_cvt_pk_bf16_f32 v104, v104, v105
    v_mfma_f32_16x16x32_bf16 v[56:59], v[8:11], v[228:231], 0
    ds_read_b64 v[96:97], v100 offset:49984
    v_accvgpr_write_b32 a248, v104
    v_mfma_f32_16x16x32_bf16 v[56:59], v[160:163], v[168:171], v[56:59]
    ds_read_b128 v[224:227], v98 offset:5312
    v_cvt_pk_bf16_f32 v106, v106, v107
    v_mfma_f32_16x16x32_bf16 v[52:55], v[4:7], v[228:231], 0
    ds_read_b128 v[102:105], v99 offset:12288
    v_accvgpr_write_b32 a249, v106
    v_mfma_f32_16x16x32_bf16 v[52:55], v[156:159], v[168:171], v[52:55]
    ds_read_b64 v[106:107], v100 offset:12352
    v_cvt_pk_bf16_f32 v240, v152, v153
    v_cvt_pk_bf16_f32 v241, v154, v155
    v_cvt_pk_bf16_f32 v140, v140, v141
    v_accvgpr_write_b32 a226, v140
    v_cvt_pk_bf16_f32 v142, v142, v143
    v_accvgpr_write_b32 a227, v142
    v_cvt_pk_bf16_f32 v88, v88, v89
    v_accvgpr_write_b32 a250, v88
    v_cvt_pk_bf16_f32 v90, v90, v91
    v_accvgpr_write_b32 a251, v90
    v_cvt_pk_bf16_f32 v242, v108, v109
    v_cvt_pk_bf16_f32 v243, v110, v111
    v_mov_b32_dpp v67, v71 quad_perm:[0,1,2,3] row_mask:0x2 bank_mask:0xf
    v_mov_b32 v146, 0
    s_waitcnt lgkmcnt(5)
    v_mfma_f32_16x16x16_bf16 v[140:143], v[112:113], v[50:51], v[84:87]
    ds_read_b128 v[68:71], v98 offset:128
    v_mov_b32_dpp v67, v79 quad_perm:[0,1,2,3] row_mask:0x4 bank_mask:0xf
    v_mfma_f32_16x16x16_bf16 v[76:79], v[114:115], v[50:51], v[84:87]
    ds_read_b128 v[88:91], v99 offset:13056
    v_cvt_pk_bf16_f32 v67, v67, v67
    v_mfma_f32_16x16x16_bf16 v[112:115], v[116:117], v[50:51], v[84:87]
    s_waitcnt lgkmcnt(4)
    ds_write_b16 v131, v67
    v_mfma_f32_16x16x16_bf16 v[64:67], v[92:93], v[50:51], v[224:227]
    ds_read_b64 v[92:93], v100 offset:13120
    v_mov_b32 v147, 0
    v_mfma_f32_16x16x16_bf16 v[116:119], v[94:95], v[50:51], v[224:227]
    ds_read_b128 v[152:155], v98 offset:192
    v_mov_b32 v121, 0
    v_mfma_f32_16x16x16_bf16 v[84:87], v[96:97], v[50:51], v[224:227]
    ds_read_b128 v[108:111], v99 offset:61440
    v_add_u32 v18, 0, v29
    v_add_u32 v136, s48, v136
    v_cvt_pk_bf16_f32 v140, v140, v141
    v_accvgpr_write_b32 a232, v140
    v_cvt_pk_bf16_f32 v142, v142, v143
    v_accvgpr_write_b32 a233, v142
    v_cvt_pk_bf16_f32 v224, v76, v77
    v_cvt_pk_bf16_f32 v225, v78, v79
    v_cvt_pk_bf16_f32 v248, v112, v113
    v_cvt_pk_bf16_f32 v249, v114, v115
    v_cvt_pk_bf16_f32 v64, v64, v65
    v_accvgpr_write_b32 a234, v64
    v_cvt_pk_bf16_f32 v66, v66, v67
    v_accvgpr_write_b32 a235, v66
    s_waitcnt lgkmcnt(5)
    v_mfma_f32_16x16x16_bf16 v[64:67], v[102:103], v[50:51], v[68:71]
    ds_read_b64 v[112:113], v100 offset:61504
    v_cvt_pk_bf16_f32 v226, v116, v117
    v_mfma_f32_16x16x16_bf16 v[140:143], v[104:105], v[50:51], v[68:71]
    ds_read_b128 v[76:79], v98 offset:5376
    v_cvt_pk_bf16_f32 v227, v118, v119
    v_mfma_f32_16x16x16_bf16 v[116:119], v[106:107], v[50:51], v[68:71]
    s_waitcnt lgkmcnt(3)
    ds_read_b128 v[102:105], v99 offset:62208
    v_cvt_pk_bf16_f32 v250, v84, v85
    v_cvt_pk_bf16_f32 v251, v86, v87
    v_cvt_pk_bf16_f32 v64, v64, v65
    v_accvgpr_write_b32 a220, v64
    v_cvt_pk_bf16_f32 v66, v66, v67
    v_mfma_f32_16x16x16_bf16 v[84:87], v[88:89], v[50:51], v[152:155]
    ds_read_b64 v[106:107], v100 offset:62272
    v_accvgpr_write_b32 a221, v66
    v_mfma_f32_16x16x16_bf16 v[68:71], v[90:91], v[50:51], v[152:155]
    ds_read_b128 v[88:91], v98 offset:5440
    v_cvt_pk_bf16_f32 v140, v140, v141
    v_mfma_f32_16x16x16_bf16 v[64:67], v[92:93], v[50:51], v[152:155]
    ds_read_b128 v[92:95], v99 offset:36864
    v_accvgpr_write_b32 a244, v140
    v_cvt_pk_bf16_f32 v142, v142, v143
    v_accvgpr_write_b32 a245, v142
    v_cvt_pk_bf16_f32 v236, v116, v117
    v_cvt_pk_bf16_f32 v237, v118, v119
    v_cvt_pk_bf16_f32 v84, v84, v85
    v_accvgpr_write_b32 a222, v84
    v_cvt_pk_bf16_f32 v86, v86, v87
    v_accvgpr_write_b32 a223, v86
    v_cvt_pk_bf16_f32 v68, v68, v69
    v_accvgpr_write_b32 a246, v68
    v_cvt_pk_bf16_f32 v70, v70, v71
    v_accvgpr_write_b32 a247, v70
    v_cvt_pk_bf16_f32 v238, v64, v65
    s_waitcnt lgkmcnt(4)
    v_mfma_f32_16x16x16_bf16 v[68:71], v[108:109], v[50:51], v[76:79]
    ds_read_b64 v[96:97], v100 offset:36928
    v_cvt_pk_bf16_f32 v239, v66, v67
    v_mfma_f32_16x16x16_bf16 v[64:67], v[110:111], v[50:51], v[76:79]
    ds_read_b128 v[84:87], v98 offset:5120
    v_mfma_f32_16x16x16_bf16 v[108:111], v[112:113], v[50:51], v[76:79]
    s_waitcnt lgkmcnt(3)
    s_nop 0
    ds_read_b128 v[112:115], v99 offset:37632
    v_cvt_pk_bf16_f32 v68, v68, v69
    v_accvgpr_write_b32 a236, v68
    v_cvt_pk_bf16_f32 v70, v70, v71
    v_accvgpr_write_b32 a237, v70
    v_cvt_pk_bf16_f32 v228, v64, v65
    v_mfma_f32_16x16x16_bf16 v[76:79], v[102:103], v[50:51], v[88:91]
    ds_read_b64 v[116:117], v100 offset:37696
    v_cvt_pk_bf16_f32 v229, v66, v67
    v_mfma_f32_16x16x16_bf16 v[68:71], v[104:105], v[50:51], v[88:91]
    ds_read_b128 v[140:143], v98 offset:5184
    v_cvt_pk_bf16_f32 v252, v108, v109
    v_mfma_f32_16x16x16_bf16 v[64:67], v[106:107], v[50:51], v[88:91]
    ds_read_b128 v[102:105], v99 offset:0
    v_cvt_pk_bf16_f32 v253, v110, v111
    v_cvt_pk_bf16_f32 v76, v76, v77
    v_accvgpr_write_b32 a238, v76
    v_cvt_pk_bf16_f32 v78, v78, v79
    v_accvgpr_write_b32 a239, v78
    v_cvt_pk_bf16_f32 v230, v68, v69
    v_cvt_pk_bf16_f32 v231, v70, v71
    v_cvt_pk_bf16_f32 v254, v64, v65
    v_cvt_pk_bf16_f32 v255, v66, v67
    ds_read_b64 v[106:107], v100 offset:64
    v_rcp_f32 v44, v44
    s_waitcnt lgkmcnt(5)
    v_mfma_f32_16x16x16_bf16 v[64:67], v[92:93], v[50:51], v[84:87]
    ds_read_b128 v[68:71], v98 offset:0
    v_mul_f32 v20, v20, v44
    v_mfma_f32_16x16x16_bf16 v[76:79], v[94:95], v[50:51], v[84:87]
    ds_read_b128 v[92:95], v99 offset:768
    v_mul_f32 v21, v21, v44
    v_mfma_f32_16x16x16_bf16 v[108:111], v[96:97], v[50:51], v[84:87]
    s_waitcnt lgkmcnt(4)
    ds_read_b64 v[96:97], v100 offset:832
    v_cvt_pk_bf16_f32 v64, v64, v65
    v_accvgpr_write_b32 a228, v64
    v_cvt_pk_bf16_f32 v66, v66, v67
    v_accvgpr_write_b32 a229, v66
    v_cvt_pk_bf16_f32 v76, v76, v77
    v_mfma_f32_16x16x16_bf16 v[88:91], v[112:113], v[50:51], v[140:143]
    ds_read_b128 v[84:87], v98 offset:64
    v_accvgpr_write_b32 a252, v76
    v_mfma_f32_16x16x16_bf16 v[64:67], v[114:115], v[50:51], v[140:143]
    v_cvt_pk_bf16_f32 v78, v78, v79
    v_accvgpr_write_b32 a253, v78
    v_mfma_f32_16x16x16_bf16 v[76:79], v[116:117], v[50:51], v[140:143]
    v_cvt_pk_bf16_f32 v244, v108, v109
    v_cvt_pk_bf16_f32 v245, v110, v111
    v_cvt_pk_bf16_f32 v88, v88, v89
    v_accvgpr_write_b32 a230, v88
    v_cvt_pk_bf16_f32 v90, v90, v91
    v_accvgpr_write_b32 a231, v90
    v_cvt_pk_bf16_f32 v64, v64, v65
    v_accvgpr_write_b32 a254, v64
    v_cvt_pk_bf16_f32 v66, v66, v67
    v_accvgpr_write_b32 a255, v66
    v_cvt_pk_bf16_f32 v246, v76, v77
    s_waitcnt lgkmcnt(3)
    v_mfma_f32_16x16x16_bf16 v[64:67], v[102:103], v[50:51], v[68:71]
    v_cvt_pk_bf16_f32 v247, v78, v79
    v_cvt_pk_bf16_f32 v20, v20, v21
    v_mfma_f32_16x16x16_bf16 v[100:103], v[104:105], v[50:51], v[68:71]
    s_waitcnt vmcnt(5) lgkmcnt(1)
    ds_write_b32 v135, v20 offset:1536
    v_mfma_f32_16x16x16_bf16 v[88:91], v[106:107], v[50:51], v[68:71]
    s_waitcnt lgkmcnt(1)
    s_barrier
    v_cvt_pk_bf16_f32 v64, v64, v65
    v_accvgpr_write_b32 a216, v64
    v_cvt_pk_bf16_f32 v66, v66, v67
    v_accvgpr_write_b32 a217, v66
    v_cvt_pk_bf16_f32 v100, v100, v101
    v_accvgpr_write_b32 a240, v100
    v_mfma_f32_16x16x16_bf16 v[76:79], v[92:93], v[50:51], v[84:87]
    ds_read_b128 v[64:67], v122 offset:14848
    v_cvt_pk_bf16_f32 v102, v102, v103
    v_mfma_f32_16x16x16_bf16 v[68:71], v[94:95], v[50:51], v[84:87]
    ds_write_b128 v19, v[72:75] offset:6144
    v_mfma_f32_16x16x16_bf16 v[72:75], v[96:97], v[50:51], v[84:87]
    v_accvgpr_write_b32 a241, v102
    v_cvt_pk_bf16_f32 v232, v88, v89
    v_cvt_pk_bf16_f32 v233, v90, v91
    v_cvt_pk_bf16_f32 v76, v76, v77
    v_accvgpr_write_b32 a218, v76
    v_cvt_pk_bf16_f32 v78, v78, v79
    ds_write_b128 v18, v[80:83]
    v_accvgpr_write_b32 a219, v78
    v_cvt_pk_bf16_f32 v68, v68, v69
    v_accvgpr_write_b32 a242, v68
    v_cvt_pk_bf16_f32 v70, v70, v71
    v_accvgpr_write_b32 a243, v70
    v_cvt_pk_bf16_f32 v234, v72, v73
    v_cvt_pk_bf16_f32 v235, v74, v75
    v_mul_f32 v22, v22, v44
    ds_write2_b64 v18, v[146:147], v[146:147] offset0:2 offset1:3
    s_waitcnt lgkmcnt(2)
    v_or3_b32 v64, v64, v65, v66
    v_or_b32 v64, v64, v67
    v_mul_f32 v23, v23, v44
    v_readfirstlane_b32 s75, v64
    v_cvt_pk_bf16_f32 v21, v22, v23
    v_mul_f32 v56, v56, v44
    v_mul_f32 v57, v57, v44
    v_cvt_pk_bf16_f32 v22, v56, v57
    ds_write_b128 v18, v[60:63] offset:32
    v_mul_f32 v58, v58, v44
    v_mul_f32 v59, v59, v44
    v_cvt_pk_bf16_f32 v23, v58, v59
    v_mul_f32 v52, v52, v44
    v_mul_f32 v53, v53, v44
    v_cvt_pk_bf16_f32 v154, v52, v53
    v_mul_f32 v54, v54, v44
    v_mul_f32 v55, v55, v44
    ds_write2_b64 v18, v[48:49], v[146:147] offset0:6 offset1:7
    v_cvt_pk_bf16_f32 v155, v54, v55
    v_exp_f32 v40, v40
    v_exp_f32 v41, v41
    v_exp_f32 v42, v42
    v_exp_f32 v43, v43
    ds_write2_b64 v18, v[146:147], v[16:17] offset0:8 offset1:9
    v_cvt_pk_bf16_f32 v16, v40, v41
    v_cvt_pk_bf16_f32 v17, v42, v43
    v_exp_f32 v36, v36
    v_exp_f32 v37, v37
    v_exp_f32 v38, v38
    ds_write_b64 v18, v[120:121] offset:88
    v_exp_f32 v39, v39
    v_cvt_pk_bf16_f32 v18, v36, v37
    v_cvt_pk_bf16_f32 v19, v38, v39
    v_exp_f32 v24, v24
    ds_write_b64 v29, v[30:31] offset:80
    v_exp_f32 v25, v25
    v_exp_f32 v26, v26
    v_exp_f32 v27, v27
    ds_write_b128 v29, v[32:35] offset:96
    v_cvt_pk_bf16_f32 v168, v24, v25
    v_cvt_pk_bf16_f32 v169, v26, v27
    v_exp_f32 v14, v14
    s_nop 0
    v_cvt_pk_bf16_f32 v170, v14, 0
    v_mfma_f32_16x16x32_bf16 v[12:15], v[220:223], v[16:19], 0
    ds_read_b128 v[146:149], v137 offset:0
    v_mfma_f32_16x16x32_bf16 v[12:15], v[220:223], v[168:171], v[12:15]
    ds_read_b128 v[88:91], v136 offset:0
    v_mfma_f32_16x16x32_bf16 v[72:75], v[0:3], v[16:19], 0
    ds_read_b128 v[108:111], v137 offset:128
    v_mfma_f32_16x16x32_bf16 v[72:75], v[164:167], v[168:171], v[72:75]
    ds_read_b128 v[116:119], v136 offset:128
    v_mfma_f32_16x16x32_bf16 v[0:3], v[8:11], v[16:19], 0
    ds_read_b128 v[60:63], v137 offset:256
    v_mfma_f32_16x16x32_bf16 v[0:3], v[160:163], v[168:171], v[0:3]
    ds_read_b128 v[64:67], v136 offset:256
    v_mfma_f32_16x16x32_bf16 v[8:11], v[4:7], v[16:19], 0
    ds_read_b128 v[68:71], v137 offset:1536
    v_mfma_f32_16x16x32_bf16 v[8:11], v[156:159], v[168:171], v[8:11]
    s_waitcnt lgkmcnt(6)
    ds_read_b128 v[100:103], v136 offset:1536
    ds_read_b128 v[80:83], v137 offset:1664
    v_mfma_f32_16x16x32_bf16 v[30:33], a[0:3], v[146:149], 0
    ds_read_b128 v[76:79], v136 offset:1792
    s_waitcnt lgkmcnt(0)
    s_cmp_lg_u32 s75, 0
    s_cbranch_scc0 L_loopF0
    s_branch L_slow
L_bndF:
    s_movk_i32 s73, 20
    s_movk_i32 s71, 18
    s_movk_i32 s70, -20
    s_mov_b32 s74, 0
    s_cmp_lt_u32 s2, 252
    s_cbranch_scc1 L_bndcF
    s_sub_u32 s94, s2, 252
    s_mul_i32 s69, s94, 18
    s_mov_b32 s74, 2
    s_sub_u32 s93, s93, 1373568
    v_cmp_le_u32 vcc, 4, v129
    v_add_u32 v0, 98896896, v128
    v_subrev_u32 v1, 1373568, v128
    v_cndmask_b32 v128, v0, v1, vcc
    v_cmp_le_u32 vcc, 4, v23
    v_add_u32 v0, 98896896, v127
    v_subrev_u32 v1, 1373568, v127
    v_cndmask_b32 v127, v0, v1, vcc
    v_cmp_le_u32 vcc, 4, v3
    v_add_u32 v0, 98896896, v126
    v_subrev_u32 v1, 1373568, v126
    v_cndmask_b32 v126, v0, v1, vcc
    v_cmp_le_u32 vcc, 4, v130
    v_add_u32 v0, 98896896, v125
    v_subrev_u32 v1, 1373568, v125
    v_cndmask_b32 v125, v0, v1, vcc
    v_cmp_le_u32 vcc, 4, v28
    v_add_u32 v0, 98896896, v124
    v_subrev_u32 v1, 1373568, v124
    v_cndmask_b32 v124, v0, v1, vcc
    s_cmp_lt_u32 s2, 256
    s_cbranch_scc1 L_bndrF
L_bndcF:
    s_sub_u32 s94, s2, 248
    s_mul_i32 s69, s94, 20
    s_lshr_b32 s71, s94, 1
    s_sub_u32 s69, s69, s71
    s_and_b32 s94, s94, 1
    s_sub_u32 s71, 20, s94
    s_cmp_eq_u32 s2, 251
    s_cselect_b32 s71, 13, s71
    s_mov_b32 s62, 1373568
    s_add_u32 s74, s74, 1
    s_sub_u32 s93, s93, 2688
    v_mad_i32_i24 v0, v129, -7, v96
    v_cmp_le_u32 vcc, 4, v0
    v_add_u32 v0, 193536, v128
    v_subrev_u32 v1, 2688, v128
    v_cndmask_b32 v128, v0, v1, vcc
    v_mad_i32_i24 v0, v23, -7, v73
    v_cmp_le_u32 vcc, 4, v0
    v_add_u32 v0, 193536, v127
    v_subrev_u32 v1, 2688, v127
    v_cndmask_b32 v127, v0, v1, vcc
    v_mad_i32_i24 v0, v3, -7, v97
    v_cmp_le_u32 vcc, 4, v0
    v_add_u32 v0, 193536, v126
    v_subrev_u32 v1, 2688, v126
    v_cndmask_b32 v126, v0, v1, vcc
    v_mad_i32_i24 v0, v130, -7, v75
    v_cmp_le_u32 vcc, 4, v0
    v_add_u32 v0, 193536, v125
    v_subrev_u32 v1, 2688, v125
    v_cndmask_b32 v125, v0, v1, vcc
    v_mad_i32_i24 v0, v28, -7, v8
    v_cmp_le_u32 vcc, 4, v0
    v_add_u32 v0, 193536, v124
    v_subrev_u32 v1, 2688, v124
    v_cndmask_b32 v124, v0, v1, vcc
    s_cmp_eq_u32 s2, 256
    s_cselect_b32 s62, 0, s62
    s_cselect_b32 s69, 0, s69
    s_cselect_b32 s71, 2, s71
    s_branch L_bndrF
L_maskF:
    s_and_b32 s20, s74, 2
    s_and_b32 s21, s74, 1
    s_mov_b32 s22, 0xc31044fe
    v_lshrrev_b32 v33, 2, v96
    v_add_u32 v33, 0, v33
    v_mul_u32_u24 v115, 37, v33
    v_lshrrev_b32 v31, 8, v115
    v_mad_i32_i24 v31, v31, -7, v33
    v_lshrrev_b32 v115, 10, v115
    v_lshrrev_b32 v31, 2, v31
    v_mul_u32_u24 v115, s20, v115
    v_mad_u32_u24 v33, v31, s21, v115
    v_cvt_f32_u32 v33, v33
    v_lshrrev_b32 v113, 2, v96
    v_add_u32 v113, 4, v113
    v_mul_u32_u24 v115, 37, v113
    v_lshrrev_b32 v31, 8, v115
    v_mad_i32_i24 v31, v31, -7, v113
    v_lshrrev_b32 v115, 10, v115
    v_lshrrev_b32 v31, 2, v31
    v_mul_u32_u24 v115, s20, v115
    v_mad_u32_u24 v113, v31, s21, v115
    v_cvt_f32_u32 v113, v113
    v_lshrrev_b32 v30, 2, v96
    v_add_u32 v30, 8, v30
    v_mul_u32_u24 v115, 37, v30
    v_lshrrev_b32 v31, 8, v115
    v_mad_i32_i24 v31, v31, -7, v30
    v_lshrrev_b32 v115, 10, v115
    v_lshrrev_b32 v31, 2, v31
    v_mul_u32_u24 v115, s20, v115
    v_mad_u32_u24 v30, v31, s21, v115
    v_cvt_f32_u32 v30, v30
    v_mad_u32_u24 v97, v49, 12, 0
    v_mul_u32_u24 v115, 37, v97
    v_lshrrev_b32 v31, 8, v115
    v_mad_i32_i24 v31, v31, -7, v97
    v_lshrrev_b32 v115, 10, v115
    v_lshrrev_b32 v31, 2, v31
    v_mul_u32_u24 v115, s20, v115
    v_mad_u32_u24 v97, v31, s21, v115
    v_cvt_f32_u32 v97, v97
    v_sub_f32 v115, v33, v97
    v_mul_f32 v115, v115, v115 clamp
    v_fmac_f32 v204, s22, v115
    v_sub_f32 v115, v113, v97
    v_mul_f32 v115, v115, v115 clamp
    v_fmac_f32 v192, s22, v115
    v_sub_f32 v115, v30, v97
    v_mul_f32 v115, v115, v115 clamp
    v_fmac_f32 v180, s22, v115
    v_mad_u32_u24 v97, v49, 12, 1
    v_mul_u32_u24 v115, 37, v97
    v_lshrrev_b32 v31, 8, v115
    v_mad_i32_i24 v31, v31, -7, v97
    v_lshrrev_b32 v115, 10, v115
    v_lshrrev_b32 v31, 2, v31
    v_mul_u32_u24 v115, s20, v115
    v_mad_u32_u24 v97, v31, s21, v115
    v_cvt_f32_u32 v97, v97
    v_sub_f32 v115, v33, v97
    v_mul_f32 v115, v115, v115 clamp
    v_fmac_f32 v205, s22, v115
    v_sub_f32 v115, v113, v97
    v_mul_f32 v115, v115, v115 clamp
    v_fmac_f32 v193, s22, v115
    v_sub_f32 v115, v30, v97
    v_mul_f32 v115, v115, v115 clamp
    v_fmac_f32 v181, s22, v115
    v_mad_u32_u24 v97, v49, 12, 2
    v_mul_u32_u24 v115, 37, v97
    v_lshrrev_b32 v31, 8, v115
    v_mad_i32_i24 v31, v31, -7, v97
    v_lshrrev_b32 v115, 10, v115
    v_lshrrev_b32 v31, 2, v31
    v_mul_u32_u24 v115, s20, v115
    v_mad_u32_u24 v97, v31, s21, v115
    v_cvt_f32_u32 v97, v97
    v_sub_f32 v115, v33, v97
    v_mul_f32 v115, v115, v115 clamp
    v_fmac_f32 v206, s22, v115
    v_sub_f32 v115, v113, v97
    v_mul_f32 v115, v115, v115 clamp
    v_fmac_f32 v194, s22, v115
    v_sub_f32 v115, v30, v97
    v_mul_f32 v115, v115, v115 clamp
    v_fmac_f32 v182, s22, v115
    v_mad_u32_u24 v97, v49, 12, 3
    v_mul_u32_u24 v115, 37, v97
    v_lshrrev_b32 v31, 8, v115
    v_mad_i32_i24 v31, v31, -7, v97
    v_lshrrev_b32 v115, 10, v115
    v_lshrrev_b32 v31, 2, v31
    v_mul_u32_u24 v115, s20, v115
    v_mad_u32_u24 v97, v31, s21, v115
    v_cvt_f32_u32 v97, v97
    v_sub_f32 v115, v33, v97
    v_mul_f32 v115, v115, v115 clamp
    v_fmac_f32 v207, s22, v115
    v_sub_f32 v115, v113, v97
    v_mul_f32 v115, v115, v115 clamp
    v_fmac_f32 v195, s22, v115
    v_sub_f32 v115, v30, v97
    v_mul_f32 v115, v115, v115 clamp
    v_fmac_f32 v183, s22, v115
    v_mad_u32_u24 v97, v49, 12, 4
    v_mul_u32_u24 v115, 37, v97
    v_lshrrev_b32 v31, 8, v115
    v_mad_i32_i24 v31, v31, -7, v97
    v_lshrrev_b32 v115, 10, v115
    v_lshrrev_b32 v31, 2, v31
    v_mul_u32_u24 v115, s20, v115
    v_mad_u32_u24 v97, v31, s21, v115
    v_cvt_f32_u32 v97, v97
    v_sub_f32 v115, v33, v97
    v_mul_f32 v115, v115, v115 clamp
    v_fmac_f32 v200, s22, v115
    v_sub_f32 v115, v113, v97
    v_mul_f32 v115, v115, v115 clamp
    v_fmac_f32 v188, s22, v115
    v_sub_f32 v115, v30, v97
    v_mul_f32 v115, v115, v115 clamp
    v_fmac_f32 v176, s22, v115
    v_mad_u32_u24 v97, v49, 12, 5
    v_mul_u32_u24 v115, 37, v97
    v_lshrrev_b32 v31, 8, v115
    v_mad_i32_i24 v31, v31, -7, v97
    v_lshrrev_b32 v115, 10, v115
    v_lshrrev_b32 v31, 2, v31
    v_mul_u32_u24 v115, s20, v115
    v_mad_u32_u24 v97, v31, s21, v115
    v_cvt_f32_u32 v97, v97
    v_sub_f32 v115, v33, v97
    v_mul_f32 v115, v115, v115 clamp
    v_fmac_f32 v201, s22, v115
    v_sub_f32 v115, v113, v97
    v_mul_f32 v115, v115, v115 clamp
    v_fmac_f32 v189, s22, v115
    v_sub_f32 v115, v30, v97
    v_mul_f32 v115, v115, v115 clamp
    v_fmac_f32 v177, s22, v115
    v_mad_u32_u24 v97, v49, 12, 6
    v_mul_u32_u24 v115, 37, v97
    v_lshrrev_b32 v31, 8, v115
    v_mad_i32_i24 v31, v31, -7, v97
    v_lshrrev_b32 v115, 10, v115
    v_lshrrev_b32 v31, 2, v31
    v_mul_u32_u24 v115, s20, v115
    v_mad_u32_u24 v97, v31, s21, v115
    v_cvt_f32_u32 v97, v97
    v_sub_f32 v115, v33, v97
    v_mul_f32 v115, v115, v115 clamp
    v_fmac_f32 v202, s22, v115
    v_sub_f32 v115, v113, v97
    v_mul_f32 v115, v115, v115 clamp
    v_fmac_f32 v190, s22, v115
    v_sub_f32 v115, v30, v97
    v_mul_f32 v115, v115, v115 clamp
    v_fmac_f32 v178, s22, v115
    v_mad_u32_u24 v97, v49, 12, 7
    v_mul_u32_u24 v115, 37, v97
    v_lshrrev_b32 v31, 8, v115
    v_mad_i32_i24 v31, v31, -7, v97
    v_lshrrev_b32 v115, 10, v115
    v_lshrrev_b32 v31, 2, v31
    v_mul_u32_u24 v115, s20, v115
    v_mad_u32_u24 v97, v31, s21, v115
    v_cvt_f32_u32 v97, v97
    v_sub_f32 v115, v33, v97
    v_mul_f32 v115, v115, v115 clamp
    v_fmac_f32 v203, s22, v115
    v_sub_f32 v115, v113, v97
    v_mul_f32 v115, v115, v115 clamp
    v_fmac_f32 v191, s22, v115
    v_sub_f32 v115, v30, v97
    v_mul_f32 v115, v115, v115 clamp
    v_fmac_f32 v179, s22, v115
    v_mad_u32_u24 v97, v49, 12, 8
    v_mul_u32_u24 v115, 37, v97
    v_lshrrev_b32 v31, 8, v115
    v_mad_i32_i24 v31, v31, -7, v97
    v_lshrrev_b32 v115, 10, v115
    v_lshrrev_b32 v31, 2, v31
    v_mul_u32_u24 v115, s20, v115
    v_mad_u32_u24 v97, v31, s21, v115
    v_cvt_f32_u32 v97, v97
    v_sub_f32 v115, v33, v97
    v_mul_f32 v115, v115, v115 clamp
    v_fmac_f32 v196, s22, v115
    v_sub_f32 v115, v113, v97
    v_mul_f32 v115, v115, v115 clamp
    v_fmac_f32 v184, s22, v115
    v_sub_f32 v115, v30, v97
    v_mul_f32 v115, v115, v115 clamp
    v_fmac_f32 v172, s22, v115
    v_mad_u32_u24 v97, v49, 12, 9
    v_mul_u32_u24 v115, 37, v97
    v_lshrrev_b32 v31, 8, v115
    v_mad_i32_i24 v31, v31, -7, v97
    v_lshrrev_b32 v115, 10, v115
    v_lshrrev_b32 v31, 2, v31
    v_mul_u32_u24 v115, s20, v115
    v_mad_u32_u24 v97, v31, s21, v115
    v_cvt_f32_u32 v97, v97
    v_sub_f32 v115, v33, v97
    v_mul_f32 v115, v115, v115 clamp
    v_fmac_f32 v197, s22, v115
    v_sub_f32 v115, v113, v97
    v_mul_f32 v115, v115, v115 clamp
    v_fmac_f32 v185, s22, v115
    v_sub_f32 v115, v30, v97
    v_mul_f32 v115, v115, v115 clamp
    v_fmac_f32 v173, s22, v115
    v_mad_u32_u24 v97, v49, 12, 10
    v_mul_u32_u24 v115, 37, v97
    v_lshrrev_b32 v31, 8, v115
    v_mad_i32_i24 v31, v31, -7, v97
    v_lshrrev_b32 v115, 10, v115
    v_lshrrev_b32 v31, 2, v31
    v_mul_u32_u24 v115, s20, v115
    v_mad_u32_u24 v97, v31, s21, v115
    v_cvt_f32_u32 v97, v97
    v_sub_f32 v115, v33, v97
    v_mul_f32 v115, v115, v115 clamp
    v_fmac_f32 v198, s22, v115
    v_sub_f32 v115, v113, v97
    v_mul_f32 v115, v115, v115 clamp
    v_fmac_f32 v186, s22, v115
    v_sub_f32 v115, v30, v97
    v_mul_f32 v115, v115, v115 clamp
    v_fmac_f32 v174, s22, v115
    v_mad_u32_u24 v97, v49, 12, 11
    v_mul_u32_u24 v115, 37, v97
    v_lshrrev_b32 v31, 8, v115
    v_mad_i32_i24 v31, v31, -7, v97
    v_lshrrev_b32 v115, 10, v115
    v_lshrrev_b32 v31, 2, v31
    v_mul_u32_u24 v115, s20, v115
    v_mad_u32_u24 v97, v31, s21, v115
    v_cvt_f32_u32 v97, v97
    v_sub_f32 v115, v33, v97
    v_mul_f32 v115, v115, v115 clamp
    v_fmac_f32 v199, s22, v115
    v_sub_f32 v115, v113, v97
    v_mul_f32 v115, v115, v115 clamp
    v_fmac_f32 v187, s22, v115
    v_sub_f32 v115, v30, v97
    v_mul_f32 v115, v115, v115 clamp
    v_fmac_f32 v175, s22, v115
    v_cvt_f32_u32 v97, s74
    v_sub_f32 v115, v33, v97
    v_mul_f32 v115, v115, v115 clamp
    v_fmac_f32 v208, s22, v115
    v_sub_f32 v115, v113, v97
    v_mul_f32 v115, v115, v115 clamp
    v_fmac_f32 v209, s22, v115
    v_sub_f32 v115, v30, v97
    v_mul_f32 v115, v115, v115 clamp
    v_fmac_f32 v210, s22, v115
    v_lshrrev_b32 v33, 2, v96
    v_lshl_add_u32 v33, v49, 2, v33
    v_add_u32 v115, 1, v49
    v_lshrrev_b32 v115, 2, v115
    v_mad_u32_u24 v33, v115, 36, v33
    v_min_u32 v33, 48, v33
    v_mul_u32_u24 v115, 37, v33
    v_lshrrev_b32 v31, 8, v115
    v_mad_i32_i24 v31, v31, -7, v33
    v_lshrrev_b32 v115, 10, v115
    v_lshrrev_b32 v31, 2, v31
    v_mul_u32_u24 v115, s20, v115
    v_mad_u32_u24 v33, v31, s21, v115
    v_cvt_f32_u32 v33, v33
    v_sub_f32 v115, v33, v97
    v_mul_f32 v115, v115, v115 clamp
    v_fmac_f32 v211, s22, v115
    s_branch L_nomaskF
.fill 115, 4, 0xbf800000
L_atomF0:
    s_cbranch_execz L_main
    v_mov_b32 v122, 0x800000
    buffer_atomic_add v122, v129, s[8:11], 0 offen sc0 sc1
    s_branch L_atomF0r
.p2align 6
L_loopF0:
    v_mfma_f32_16x16x32_bf16 v[30:33], a[4:7], v[88:91], v[30:33]
    ds_write_b32 v135, v21 offset:1540
    v_mfma_f32_16x16x32_bf16 v[30:33], a[8:11], v[108:111], v[30:33]
    v_rcp_f32 v12, v12
    v_mfma_f32_16x16x32_bf16 v[30:33], a[12:15], v[116:119], v[30:33]
    v_mul_f32 v72, v72, v12
    v_mul_f32 v73, v73, v12
    v_mfma_f32_16x16x32_bf16 v[30:33], a[16:19], v[60:63], v[30:33]
    v_cvt_pk_bf16_f32 v4, v72, v73
    v_mul_f32 v74, v74, v12
    v_mfma_f32_16x16x32_bf16 v[30:33], a[20:23], v[64:67], v[30:33]
    ds_write_b64 v135, v[22:23] offset:1544
    v_mfma_f32_16x16x32_bf16 v[20:23], v[146:149], a[168:171], 0
    v_mul_f32 v75, v75, v12
    v_cvt_pk_bf16_f32 v5, v74, v75
    v_mfma_f32_16x16x32_bf16 v[20:23], v[88:91], a[172:175], v[20:23]
    v_mul_f32 v0, v0, v12
    v_mul_f32 v1, v1, v12
    v_mfma_f32_16x16x32_bf16 v[20:23], v[108:111], a[176:179], v[20:23]
    ds_read_b128 v[72:75], v136 offset:1664
    v_cvt_pk_bf16_f32 v6, v0, v1
    v_mfma_f32_16x16x32_bf16 v[20:23], v[116:119], a[180:183], v[20:23]
    v_mul_f32 v2, v2, v12
    v_mul_f32 v3, v3, v12
    v_mfma_f32_16x16x32_bf16 v[20:23], v[60:63], a[184:187], v[20:23]
    v_cvt_pk_bf16_f32 v7, v2, v3
    v_mul_f32 v8, v8, v12
    v_mfma_f32_16x16x32_bf16 v[20:23], v[64:67], a[188:191], v[20:23]
    ds_read_b128 v[112:115], v137 offset:1792
    v_mul_f32 v9, v9, v12
    v_mfma_f32_16x16x32_bf16 v[0:3], a[120:123], v[146:149], 0
    v_cvt_pk_bf16_f32 v152, v8, v9
    v_mul_f32 v10, v10, v12
    v_mfma_f32_16x16x32_bf16 v[0:3], a[124:127], v[88:91], v[0:3]
    v_mul_f32 v11, v11, v12
    v_cvt_pk_bf16_f32 v153, v10, v11
    v_mfma_f32_16x16x32_bf16 v[0:3], a[128:131], v[108:111], v[0:3]
    v_fmac_f32 v28, v39, v39
    v_fmac_f32 v28, v96, v96
    v_mfma_f32_16x16x32_bf16 v[0:3], a[132:135], v[116:119], v[0:3]
    ds_write_b64 v134, v[154:155] offset:1536
    v_mfma_f32_16x16x32_bf16 v[0:3], a[136:139], v[60:63], v[0:3]
    v_fmac_f32 v28, v97, v97
    v_fmac_f32 v28, v98, v98
    v_mfma_f32_16x16x32_bf16 v[0:3], a[140:143], v[64:67], v[0:3]
    v_fmac_f32 v28, v99, v99
    v_fma_f32 v29, v56, v56, s42
    v_mfma_f32_16x16x32_bf16 v[12:15], a[48:51], v[146:149], 0
    v_fmac_f32 v29, v57, v57
    v_fmac_f32 v29, v58, v58
    v_mfma_f32_16x16x32_bf16 v[12:15], a[52:55], v[88:91], v[12:15]
    ds_write_b64 v135, v[4:5] offset:3072
    v_mfma_f32_16x16x32_bf16 v[12:15], a[56:59], v[108:111], v[12:15]
    v_fmac_f32 v29, v59, v59
    v_fmac_f32 v29, v140, v140
    v_mfma_f32_16x16x32_bf16 v[12:15], a[60:63], v[116:119], v[12:15]
    v_fmac_f32 v29, v141, v141
    v_fmac_f32 v29, v142, v142
    v_mfma_f32_16x16x32_bf16 v[12:15], a[64:67], v[60:63], v[12:15]
    v_fmac_f32 v29, v143, v143
    v_fmac_f32 v29, v104, v104
    v_mfma_f32_16x16x32_bf16 v[12:15], a[68:71], v[64:67], v[12:15]
    ds_write_b64 v135, v[6:7] offset:3080
    v_mfma_f32_16x16x32_bf16 v[4:7], a[24:27], v[146:149], 0
    v_fmac_f32 v29, v105, v105
    v_fmac_f32 v29, v106, v106
    v_mfma_f32_16x16x32_bf16 v[4:7], a[28:31], v[88:91], v[4:7]
    v_fmac_f32 v29, v107, v107
    v_fma_f32 v154, v52, v52, s42
    v_mfma_f32_16x16x32_bf16 v[4:7], a[32:35], v[108:111], v[4:7]
    v_fmac_f32 v154, v53, v53
    v_fmac_f32 v154, v54, v54
    v_mfma_f32_16x16x32_bf16 v[4:7], a[36:39], v[116:119], v[4:7]
    ds_write_b32 v134, v152 offset:3072
    v_mfma_f32_16x16x32_bf16 v[4:7], a[40:43], v[60:63], v[4:7]
    v_fmac_f32 v154, v55, v55
    v_fmac_f32 v154, v84, v84
    v_mfma_f32_16x16x32_bf16 v[4:7], a[44:47], v[64:67], v[4:7]
    v_fmac_f32 v154, v85, v85
    v_fmac_f32 v154, v86, v86
    v_mfma_f32_16x16x32_bf16 v[8:11], v[146:149], a[192:195], 0
    v_fmac_f32 v154, v87, v87
    v_fmac_f32 v154, v48, v48
    v_mfma_f32_16x16x32_bf16 v[8:11], v[88:91], a[196:199], v[8:11]
    s_waitcnt vmcnt(10)
    ds_write_b32 v134, v153 offset:3076
    v_mfma_f32_16x16x32_bf16 v[8:11], v[108:111], a[200:203], v[8:11]
    v_fmac_f32 v154, v49, v49
    v_fmac_f32 v154, v50, v50
    v_mfma_f32_16x16x32_bf16 v[8:11], v[116:119], a[204:207], v[8:11]
    v_fmac_f32 v154, v51, v51
    v_cvt_pk_bf16_f32 v28, v28, v29
    v_mfma_f32_16x16x32_bf16 v[8:11], v[60:63], a[208:211], v[8:11]
    v_cvt_pk_bf16_f32 v29, v154, v122
    v_add_u32 v135, s49, v135
    v_mfma_f32_16x16x32_bf16 v[8:11], v[64:67], a[212:215], v[8:11]
    ds_write_b64 v130, v[28:29]
    v_mfma_f32_16x16x32_bf16 v[40:43], a[72:75], v[146:149], 0
    v_add_u32 v134, s49, v134
    v_cvt_pk_f16_f32 v28, v30, v31
    v_mfma_f32_16x16x32_bf16 v[40:43], a[76:79], v[88:91], v[40:43]
    v_cvt_pk_f16_f32 v29, v32, v33
    v_pk_fma_f16 v32, v28, v28, s39
    v_mfma_f32_16x16x32_bf16 v[40:43], a[80:83], v[108:111], v[40:43]
    v_pk_fmac_f16 v32, v29, v29
    v_cvt_pk_f16_f32 v154, v0, v1
    v_mfma_f32_16x16x32_bf16 v[40:43], a[84:87], v[116:119], v[40:43]
    v_cvt_pk_f16_f32 v155, v2, v3
    v_cvt_pk_f16_f32 v30, v4, v5
    v_mfma_f32_16x16x32_bf16 v[40:43], a[88:91], v[60:63], v[40:43]
    v_cvt_pk_f16_f32 v31, v6, v7
    v_pk_fmac_f16 v32, v30, v30
    v_mfma_f32_16x16x32_bf16 v[40:43], a[92:95], v[64:67], v[40:43]
    v_pk_fmac_f16 v32, v31, v31
    v_cvt_pk_bf16_f32 v4, v8, v9
    v_mfma_f32_16x16x32_bf16 v[0:3], a[96:99], v[146:149], 0
    v_cvt_pk_bf16_f32 v5, v10, v11
    v_cvt_pk_f16_f32 v152, v12, v13
    v_mfma_f32_16x16x32_bf16 v[0:3], a[100:103], v[88:91], v[0:3]
    s_waitcnt lgkmcnt(0)
    v_cvt_pk_f16_f32 v153, v14, v15
    v_pk_fmac_f16 v32, v152, v152
    v_mfma_f32_16x16x32_bf16 v[0:3], a[104:107], v[108:111], v[0:3]
    s_barrier
    ds_read_b128 v[8:11], v129 offset:0
    v_pk_fmac_f16 v32, v153, v153
    v_mfma_f32_16x16x32_bf16 v[0:3], a[108:111], v[116:119], v[0:3]
    ds_read_b128 v[44:47], v129 offset:1024
    v_cvt_pk_f16_f32 v12, v40, v41
    v_mfma_f32_16x16x32_bf16 v[0:3], a[112:115], v[60:63], v[0:3]
    v_cvt_pk_f16_f32 v13, v42, v43
    v_pk_fma_f16 v33, v12, v12, s39
    v_mfma_f32_16x16x32_bf16 v[0:3], a[116:119], v[64:67], v[0:3]
    v_pk_fmac_f16 v33, v13, v13
    s_nop 0
    v_mfma_f32_16x16x32_bf16 v[40:43], v[146:149], a[144:147], 0
    s_nop 2
    v_mfma_f32_16x16x32_bf16 v[40:43], v[88:91], a[148:151], v[40:43]
    s_nop 0
    v_cvt_pk_f16_f32 v14, v0, v1
    v_cvt_pk_f16_f32 v15, v2, v3
    v_mfma_f32_16x16x32_bf16 v[40:43], v[108:111], a[152:155], v[40:43]
    v_pk_fmac_f16 v33, v14, v14
    v_pk_fmac_f16 v33, v15, v15
    v_mfma_f32_16x16x32_bf16 v[40:43], v[116:119], a[156:159], v[40:43]
    v_pk_fmac_f16 v33, v154, v154
    v_pk_fmac_f16 v33, v155, v155
    v_mfma_f32_16x16x32_bf16 v[40:43], v[60:63], a[160:163], v[40:43]
    v_mfma_f32_16x16x32_bf16 v[40:43], v[64:67], a[164:167], v[40:43]
    s_waitcnt lgkmcnt(1)
    v_readfirstlane_b32 s12, v9
    v_mfma_f32_16x16x32_bf16 v[88:91], v[216:219], v[8:11], 0
    s_waitcnt lgkmcnt(0)
    s_nop 1
    v_mfma_f32_16x16x32_bf16 v[88:91], v[216:219], v[44:47], v[88:91]
    s_lshr_b32 s12, s12, 23
    v_cvt_pk_bf16_f32 v0, v40, v41
    v_cvt_pk_bf16_f32 v1, v42, v43
    v_mfma_f32_16x16x32_bf16 v[60:63], a[24:27], v[68:71], 0
    s_nop 1
    v_mfma_f32_16x16x32_bf16 v[60:63], a[28:31], v[100:103], v[60:63]
    s_nop 0
    v_rsq_f32 v88, v88
    v_mfma_f32_16x16x32_bf16 v[60:63], a[32:35], v[80:83], v[60:63]
    v_rsq_f32 v89, v89
    v_mfma_f32_16x16x32_bf16 v[60:63], a[36:39], v[72:75], v[60:63]
    v_rsq_f32 v90, v90
    v_mfma_f32_16x16x32_bf16 v[60:63], a[40:43], v[112:115], v[60:63]
    v_mul_f32 v88, s43, v88
    v_mul_f32 v89, s43, v89
    v_mfma_f32_16x16x32_bf16 v[60:63], a[44:47], v[76:79], v[60:63]
    v_mul_f32 v90, s43, v90
    v_mul_f32 v56, v56, v89
    v_mfma_f32_16x16x32_bf16 v[40:43], a[96:99], v[68:71], 0
    v_mul_f32 v57, v57, v89
    v_cvt_pk_bf16_f32 v44, v56, v57
    v_mfma_f32_16x16x32_bf16 v[40:43], a[100:103], v[100:103], v[40:43]
    ds_write_b32 v135, v44 offset:1536
    v_mfma_f32_16x16x32_bf16 v[40:43], a[104:107], v[80:83], v[40:43]
    v_mul_f32 v58, v58, v89
    v_mul_f32 v59, v59, v89
    v_mfma_f32_16x16x32_bf16 v[40:43], a[108:111], v[72:75], v[40:43]
    v_cvt_pk_bf16_f32 v45, v58, v59
    v_mul_f32 v140, v140, v89
    v_mfma_f32_16x16x32_bf16 v[40:43], a[112:115], v[112:115], v[40:43]
    v_mul_f32 v141, v141, v89
    v_cvt_pk_bf16_f32 v46, v140, v141
    v_mfma_f32_16x16x32_bf16 v[40:43], a[116:119], v[76:79], v[40:43]
    s_nop 0
    ds_write_b32 v135, v45 offset:1540
    v_mfma_f32_16x16x32_bf16 v[146:149], v[68:71], a[168:171], 0
    s_nop 0
    v_mul_f32 v142, v142, v89
    v_mul_f32 v143, v143, v89
    v_mfma_f32_16x16x32_bf16 v[146:149], v[100:103], a[172:175], v[146:149]
    s_nop 0
    v_cvt_pk_f16_f32 v10, v40, v41
    v_cvt_pk_f16_f32 v11, v42, v43
    v_mfma_f32_16x16x32_bf16 v[146:149], v[80:83], a[176:179], v[146:149]
    v_cvt_pk_bf16_f32 v47, v142, v143
    v_mul_f32 v104, v104, v89
    v_mfma_f32_16x16x32_bf16 v[146:149], v[72:75], a[180:183], v[146:149]
    ds_write_b64 v135, v[46:47] offset:1544
    v_mfma_f32_16x16x32_bf16 v[146:149], v[112:115], a[184:187], v[146:149]
    s_sub_u32 s50, s45, s44
    v_mul_f32 v105, v105, v89
    v_cvt_pk_bf16_f32 v8, v104, v105
    v_mfma_f32_16x16x32_bf16 v[146:149], v[76:79], a[188:191], v[146:149]
    s_sub_u32 s51, s46, s47
    v_mul_f32 v106, v106, v89
    v_mul_f32 v107, v107, v89
    v_mfma_f32_16x16x32_bf16 v[40:43], a[48:51], v[68:71], 0
    s_mov_b32 s60, s59
    v_cvt_pk_bf16_f32 v9, v106, v107
    v_mul_f32 v92, v92, v88
    v_mfma_f32_16x16x32_bf16 v[40:43], a[52:55], v[100:103], v[40:43]
    s_mov_b32 s59, s58
    ds_write_b32 v134, v9 offset:1540
    v_mfma_f32_16x16x32_bf16 v[40:43], a[56:59], v[80:83], v[40:43]
    s_mov_b32 s58, s57
    v_cvt_pk_bf16_f32 v26, v146, v147
    v_cvt_pk_bf16_f32 v27, v148, v149
    v_mfma_f32_16x16x32_bf16 v[40:43], a[60:63], v[72:75], v[40:43]
    s_mov_b32 s57, s56
    v_mul_f32 v93, v93, v88
    v_cvt_pk_bf16_f32 v16, v92, v93
    v_mfma_f32_16x16x32_bf16 v[40:43], a[64:67], v[112:115], v[40:43]
    s_mov_b32 s7, s6
    v_mul_f32 v94, v94, v88
    v_mul_f32 v95, v95, v88
    v_mfma_f32_16x16x32_bf16 v[40:43], a[68:71], v[76:79], v[40:43]
    s_mov_b32 s6, s5
    ds_write_b32 v134, v8 offset:1536
    v_mfma_f32_16x16x32_bf16 v[64:67], a[72:75], v[68:71], 0
    s_mov_b32 s5, s4
    v_cvt_pk_bf16_f32 v17, v94, v95
    v_mul_f32 v36, v36, v88
    v_mfma_f32_16x16x32_bf16 v[64:67], a[76:79], v[100:103], v[64:67]
    s_sub_u32 s14, s6, s7
    v_cvt_pk_f16_f32 v146, v40, v41
    v_cvt_pk_f16_f32 v147, v42, v43
    v_mfma_f32_16x16x32_bf16 v[64:67], a[80:83], v[80:83], v[64:67]
    s_add_u32 s61, s61, 1
    v_mul_f32 v37, v37, v88
    v_cvt_pk_bf16_f32 v18, v36, v37
    v_mfma_f32_16x16x32_bf16 v[64:67], a[84:87], v[72:75], v[64:67]
    s_add_u32 s12, s12, 20
    ds_write_b64 v135, v[16:17] offset:0
    v_mfma_f32_16x16x32_bf16 v[64:67], a[88:91], v[112:115], v[64:67]
    s_max_u32 s12, s12, s61
    v_mul_f32 v38, v38, v88
    v_mul_f32 v39, v39, v88
    v_mfma_f32_16x16x32_bf16 v[64:67], a[92:95], v[76:79], v[64:67]
    s_cmp_lt_u32 s61, s71
    v_cvt_pk_bf16_f32 v19, v38, v39
    v_mul_f32 v96, v96, v88
    v_mfma_f32_16x16x32_bf16 v[92:95], a[120:123], v[68:71], 0
    s_cselect_b32 s15, s61, s12
    ds_read_b128 v[40:43], v136 offset:3072
    v_mul_f32 v97, v97, v88
    v_mfma_f32_16x16x32_bf16 v[92:95], a[124:127], v[100:103], v[92:95]
    s_cselect_b32 s56, s69, s70
    ds_read_b128 v[44:47], v136 offset:3200
    v_cvt_pk_bf16_f32 v2, v96, v97
    v_mfma_f32_16x16x32_bf16 v[92:95], a[128:131], v[80:83], v[92:95]
    s_add_u32 s56, s56, s15
    v_mul_f32 v98, v98, v88
    v_mul_f32 v99, v99, v88
    v_mfma_f32_16x16x32_bf16 v[92:95], a[132:135], v[72:75], v[92:95]
    s_mul_i32 s53, s56, 58255
    v_cvt_pk_bf16_f32 v3, v98, v99
    v_cvt_pk_f16_f32 v8, v64, v65
    v_mfma_f32_16x16x32_bf16 v[92:95], a[136:139], v[112:115], v[92:95]
    s_lshr_b32 s53, s53, 22
    ds_read_b128 v[36:39], v136 offset:3328
    v_cvt_pk_f16_f32 v9, v66, v67
    v_mfma_f32_16x16x32_bf16 v[92:95], a[140:143], v[76:79], v[92:95]
    s_mul_i32 s53, s53, s63
    v_pk_fma_f16 v35, v8, v8, s39
    v_pk_fmac_f16 v35, v9, v9
    v_mfma_f32_16x16x32_bf16 v[64:67], v[68:71], a[144:147], 0
    s_mul_i32 s56, s56, s62
    v_pk_fmac_f16 v35, v10, v10
    v_pk_fmac_f16 v35, v11, v11
    v_mfma_f32_16x16x32_bf16 v[64:67], v[100:103], a[148:151], v[64:67]
    s_add_u32 s56, s56, s53
    v_cvt_pk_f16_f32 v148, v92, v93
    v_cvt_pk_f16_f32 v149, v94, v95
    v_mfma_f32_16x16x32_bf16 v[64:67], v[80:83], a[152:155], v[64:67]
    s_mul_i32 s4, s15, 112
    ds_write_b64 v135, v[18:19] offset:8
    v_mfma_f32_16x16x32_bf16 v[64:67], v[72:75], a[156:159], v[64:67]
    s_cmp_ge_u32 s15, 16
    v_pk_fmac_f16 v35, v148, v148
    v_pk_fmac_f16 v35, v149, v149
    v_mfma_f32_16x16x32_bf16 v[64:67], v[112:115], a[160:163], v[64:67]
    s_cselect_b32 s53, -30464, 0
    v_cvt_pk_f16_f32 v18, v60, v61
    v_cvt_pk_f16_f32 v19, v62, v63
    v_mfma_f32_16x16x32_bf16 v[64:67], v[76:79], a[164:167], v[64:67]
    s_add_u32 s4, s4, s53
    v_mul_f32 v52, v52, v90
    v_mul_f32 v53, v53, v90
    v_mfma_f32_16x16x32_bf16 v[92:95], a[0:3], v[68:71], 0
    s_cmp_lt_u32 s15, s73
    ds_write_b64 v134, v[2:3] offset:0
    v_mfma_f32_16x16x32_bf16 v[92:95], a[4:7], v[100:103], v[92:95]
    s_cselect_b32 s26, 100270464, 0
    v_cvt_pk_bf16_f32 v2, v64, v65
    v_cvt_pk_bf16_f32 v3, v66, v67
    v_mfma_f32_16x16x32_bf16 v[92:95], a[8:11], v[80:83], v[92:95]
    s_cselect_b32 s56, s56, 0
    v_cvt_pk_bf16_f32 v104, v52, v53
    v_mul_f32 v54, v54, v90
    v_mfma_f32_16x16x32_bf16 v[92:95], a[12:15], v[72:75], v[92:95]
    s_cselect_b32 s4, s4, -1
    ds_read_b128 v[60:63], v137 offset:3072
    v_mul_f32 v55, v55, v90
    v_mfma_f32_16x16x32_bf16 v[92:95], a[16:19], v[112:115], v[92:95]
    s_cselect_b32 s15, s15, 0
    ds_read_b128 v[64:67], v137 offset:3200
    v_cvt_pk_bf16_f32 v105, v54, v55
    v_mfma_f32_16x16x32_bf16 v[92:95], a[20:23], v[76:79], v[92:95]
    s_cselect_b32 s13, s13, -1
    ds_read_b128 v[52:55], v137 offset:3328
    v_mul_f32 v84, v84, v90
    v_mfma_f32_16x16x32_bf16 v[56:59], v[68:71], a[192:195], 0
    s_bitset1_b32 s64, s15
    v_mul_f32 v85, v85, v90
    v_cvt_pk_bf16_f32 v106, v84, v85
    v_mfma_f32_16x16x32_bf16 v[56:59], v[100:103], a[196:199], v[56:59]
    s_add_u32 s65, s65, 1
    v_cvt_pk_f16_f32 v16, v92, v93
    v_cvt_pk_f16_f32 v17, v94, v95
    v_mfma_f32_16x16x32_bf16 v[56:59], v[80:83], a[200:203], v[56:59]
    s_cmp_ge_i32 s65, 2
    v_pk_fma_f16 v34, v16, v16, s39
    v_pk_fmac_f16 v34, v17, v17
    v_mfma_f32_16x16x32_bf16 v[56:59], v[72:75], a[204:207], v[56:59]
    s_cselect_b32 s30, 100270464, 0
    ds_write_b64 v135, v[104:105] offset:3072
    v_mfma_f32_16x16x32_bf16 v[56:59], v[112:115], a[208:211], v[56:59]
    s_add_u32 s67, s46, s54
    v_pk_fmac_f16 v34, v18, v18
    v_pk_fmac_f16 v34, v19, v19
    v_mfma_f32_16x16x32_bf16 v[56:59], v[76:79], a[212:215], v[56:59]
    s_waitcnt lgkmcnt(3)
    v_pk_fmac_f16 v34, v146, v146
    v_pk_fmac_f16 v34, v147, v147
    v_mfma_f32_16x16x32_bf16 v[80:83], a[72:75], v[60:63], 0
    s_add_u32 m0, s67, 0
    v_mul_f32 v86, v86, v90
    v_mul_f32 v87, v87, v90
    v_mfma_f32_16x16x32_bf16 v[80:83], a[76:79], v[40:43], v[80:83]
    s_waitcnt lgkmcnt(1)
    ds_write_b32 v135, v106 offset:3080
    v_mfma_f32_16x16x32_bf16 v[80:83], a[80:83], v[64:67], v[80:83]
    v_cvt_pk_bf16_f32 v107, v86, v87
    v_mul_f32 v48, v48, v90
    v_mfma_f32_16x16x32_bf16 v[80:83], a[84:87], v[44:47], v[80:83]
    v_mul_f32 v49, v49, v90
    v_cvt_pk_bf16_f32 v104, v48, v49
    v_mfma_f32_16x16x32_bf16 v[80:83], a[88:91], v[52:55], v[80:83]
    v_mul_f32 v50, v50, v90
    v_mul_f32 v51, v51, v90
    v_mfma_f32_16x16x32_bf16 v[80:83], a[92:95], v[36:39], v[80:83]
    s_nop 0
    ds_write_b32 v135, v107 offset:3084
    v_mfma_f32_16x16x32_bf16 v[92:95], a[120:123], v[60:63], 0
    s_nop 0
    v_cvt_pk_bf16_f32 v105, v50, v51
    v_cvt_pk_bf16_f32 v6, v56, v57
    v_mfma_f32_16x16x32_bf16 v[92:95], a[124:127], v[40:43], v[92:95]
    s_nop 0
    v_cvt_pk_f16_f32 v48, v80, v81
    v_cvt_pk_f16_f32 v49, v82, v83
    v_mfma_f32_16x16x32_bf16 v[92:95], a[128:131], v[64:67], v[92:95]
    v_cvt_pk_bf16_f32 v7, v58, v59
    v_add_u32 v137, s50, v137
    v_mfma_f32_16x16x32_bf16 v[92:95], a[132:135], v[44:47], v[92:95]
    ds_write_b32 v134, v104 offset:3072
    v_mfma_f32_16x16x32_bf16 v[92:95], a[136:139], v[52:55], v[92:95]
    v_add_u32 v136, s50, v136
    v_add_u32 v135, s48, v135
    v_mfma_f32_16x16x32_bf16 v[92:95], a[140:143], v[36:39], v[92:95]
    v_add_u32 v133, s51, v133
    v_add_u32 v132, s14, v132
    v_mfma_f32_16x16x32_f16 v[88:91], v[212:215], v[32:35], 0
    s_nop 0
    v_pk_fma_f16 v33, v48, v48, s39
    v_pk_fmac_f16 v33, v49, v49
    v_mfma_f32_16x16x32_bf16 v[84:87], v[60:63], a[168:171], 0
    s_nop 0
    ds_write_b32 v134, v105 offset:3076
    v_mfma_f32_16x16x32_bf16 v[84:87], v[40:43], a[172:175], v[84:87]
    s_waitcnt vmcnt(0)
    v_or3_b32 v123, v123, v88, v89
    v_or3_b32 v123, v123, v90, v91
    v_mfma_f32_16x16x32_bf16 v[84:87], v[64:67], a[176:179], v[84:87]
    v_rsq_f32 v88, v88
    v_mfma_f32_16x16x32_bf16 v[84:87], v[44:47], a[180:183], v[84:87]
    v_rsq_f32 v89, v89
    v_mfma_f32_16x16x32_bf16 v[84:87], v[52:55], a[184:187], v[84:87]
    v_mul_f32 v88, s52, v88
    v_cvt_pk_f16_f32 v88, v88, v89
    v_mfma_f32_16x16x32_bf16 v[84:87], v[36:39], a[188:191], v[84:87]
    v_rsq_f32 v90, v90
    v_mfma_f32_16x16x32_bf16 v[76:79], a[24:27], v[60:63], 0
    v_rsq_f32 v91, v91
    v_mfma_f32_16x16x32_bf16 v[76:79], a[28:31], v[40:43], v[76:79]
    v_mul_f32 v90, s52, v90
    v_cvt_pk_f16_f32 v90, v90, v91
    v_mfma_f32_16x16x32_bf16 v[76:79], a[32:35], v[64:67], v[76:79]
    s_waitcnt lgkmcnt(0)
    v_pk_mul_f16 v12, v12, v88 op_sel:[0,1] op_sel_hi:[1,1]
    v_pk_mul_f16 v13, v13, v88 op_sel:[0,1] op_sel_hi:[1,1]
    v_mfma_f32_16x16x32_bf16 v[76:79], a[36:39], v[44:47], v[76:79]
    s_barrier
    v_pk_mul_f16 v14, v14, v88 op_sel:[0,1] op_sel_hi:[1,1]
    v_pk_mul_f16 v15, v15, v88 op_sel:[0,1] op_sel_hi:[1,1]
    v_mfma_f32_16x16x32_bf16 v[76:79], a[40:43], v[52:55], v[76:79]
    s_cmp_ge_u32 s61, s13
    v_pk_mul_f16 v154, v154, v88 op_sel:[0,1] op_sel_hi:[1,1]
    v_pk_mul_f16 v155, v155, v88 op_sel:[0,1] op_sel_hi:[1,1]
    v_mfma_f32_16x16x32_bf16 v[76:79], a[44:47], v[36:39], v[76:79]
L_pga:
    s_cbranch_scc1 L_atomF0
L_atomF0r:
    v_mfma_f32_16x16x32_bf16 v[140:143], v[60:63], a[144:147], 0
    v_pk_mul_f16 v8, v8, v90 op_sel:[0,1] op_sel_hi:[1,1]
    v_pk_mul_f16 v9, v9, v90 op_sel:[0,1] op_sel_hi:[1,1]
    v_mfma_f32_16x16x32_bf16 v[140:143], v[40:43], a[148:151], v[140:143]
    v_pk_mul_f16 v10, v10, v90 op_sel:[0,1] op_sel_hi:[1,1]
    v_pk_mul_f16 v11, v11, v90 op_sel:[0,1] op_sel_hi:[1,1]
    v_mfma_f32_16x16x32_bf16 v[140:143], v[64:67], a[152:155], v[140:143]
    v_pk_mul_f16 v148, v148, v90 op_sel:[0,1] op_sel_hi:[1,1]
    v_pk_mul_f16 v149, v149, v90 op_sel:[0,1] op_sel_hi:[1,1]
    v_mfma_f32_16x16x32_bf16 v[140:143], v[44:47], a[156:159], v[140:143]
    v_pk_mul_f16 v28, v28, v88 op_sel:[0,0] op_sel_hi:[1,0]
    v_pk_mul_f16 v29, v29, v88 op_sel:[0,0] op_sel_hi:[1,0]
    v_mfma_f32_16x16x32_bf16 v[140:143], v[52:55], a[160:163], v[140:143]
    ds_read_b128 v[80:83], v137 offset:0
    v_pk_mul_f16 v30, v30, v88 op_sel:[0,0] op_sel_hi:[1,0]
    v_mfma_f32_16x16x32_bf16 v[140:143], v[36:39], a[164:167], v[140:143]
    v_pk_mul_f16 v31, v31, v88 op_sel:[0,0] op_sel_hi:[1,0]
    v_pk_mul_f16 v152, v152, v88 op_sel:[0,0] op_sel_hi:[1,0]
    v_mfma_f32_16x16x32_bf16 v[96:99], a[0:3], v[60:63], 0
    ds_read_b128 v[68:71], v132 offset:0
    v_pk_mul_f16 v153, v153, v88 op_sel:[0,0] op_sel_hi:[1,0]
    v_mfma_f32_16x16x32_bf16 v[96:99], a[4:7], v[40:43], v[96:99]
    ds_read_b128 v[104:107], v133 offset:0
    v_cvt_pk_f16_f32 v58, v76, v77
    v_mfma_f32_16x16x32_bf16 v[96:99], a[8:11], v[64:67], v[96:99]
    v_cvt_pk_f16_f32 v59, v78, v79
    v_add_u32 v134, s48, v134
    v_mfma_f32_16x16x32_bf16 v[96:99], a[12:15], v[44:47], v[96:99]
    ds_read_b128 v[76:79], v132 offset:16
    v_add_u32 v131, s14, v131
    v_mfma_f32_16x16x32_bf16 v[96:99], a[16:19], v[52:55], v[96:99]
    v_pk_mul_f16 v16, v16, v90 op_sel:[0,0] op_sel_hi:[1,0]
    v_pk_mul_f16 v17, v17, v90 op_sel:[0,0] op_sel_hi:[1,0]
    v_mfma_f32_16x16x32_bf16 v[96:99], a[20:23], v[36:39], v[96:99]
    v_pk_mul_f16 v18, v18, v90 op_sel:[0,0] op_sel_hi:[1,0]
    v_pk_mul_f16 v19, v19, v90 op_sel:[0,0] op_sel_hi:[1,0]
    v_mfma_f32_16x16x32_bf16 v[100:103], a[48:51], v[60:63], 0
    v_pk_mul_f16 v146, v146, v90 op_sel:[0,0] op_sel_hi:[1,0]
    v_pk_mul_f16 v147, v147, v90 op_sel:[0,0] op_sel_hi:[1,0]
    v_mfma_f32_16x16x32_bf16 v[100:103], a[52:55], v[40:43], v[100:103]
    s_nop 0
    ds_read_b128 v[88:91], v136 offset:128
    v_cvt_pk_f16_f32 v56, v96, v97
    v_mfma_f32_16x16x32_bf16 v[100:103], a[56:59], v[64:67], v[100:103]
    ds_read_b128 v[72:75], v132 offset:48
    v_cvt_pk_f16_f32 v57, v98, v99
    v_mfma_f32_16x16x32_bf16 v[100:103], a[60:63], v[44:47], v[100:103]
    ds_read_b128 v[96:99], v133 offset:2048
    v_pk_fma_f16 v32, v56, v56, s39
    v_mfma_f32_16x16x32_bf16 v[100:103], a[64:67], v[52:55], v[100:103]
    v_pk_fmac_f16 v32, v57, v57
    v_pk_fmac_f16 v32, v58, v58
    v_mfma_f32_16x16x32_bf16 v[100:103], a[68:71], v[36:39], v[100:103]
    v_pk_fmac_f16 v32, v59, v59
    v_cvt_pk_bf16_f32 v164, v140, v141
    v_mfma_f32_16x16x32_bf16 v[116:119], a[96:99], v[60:63], 0
    s_waitcnt lgkmcnt(3)
    ds_read_b128 v[108:111], v133 offset:1024
    buffer_load_dwordx4 v128, s[24:27], s56 offen nt lds
    v_mfma_f32_16x16x32_bf16 v[116:119], a[100:103], v[40:43], v[116:119]
    s_nop 0
    v_cvt_pk_f16_f32 v140, v100, v101
    v_cvt_pk_f16_f32 v141, v102, v103
    v_mfma_f32_16x16x32_bf16 v[116:119], a[104:107], v[64:67], v[116:119]
    ds_read_b128 v[100:103], v137 offset:256
    v_pk_fmac_f16 v32, v140, v140
    v_mfma_f32_16x16x32_bf16 v[116:119], a[108:111], v[44:47], v[116:119]
    ds_read_u16 v166, v131 offset:80
    v_pk_fmac_f16 v32, v141, v141
    v_mfma_f32_16x16x32_bf16 v[116:119], a[112:115], v[52:55], v[116:119]
    ds_read_u16 v162, v131 offset:96
    v_cvt_pk_bf16_f32 v165, v142, v143
    v_mfma_f32_16x16x32_bf16 v[116:119], a[116:119], v[36:39], v[116:119]
    ds_read_u16 v158, v131 offset:104
    v_cvt_pk_f16_f32 v142, v92, v93
    v_mfma_f32_16x16x32_bf16 v[112:115], v[60:63], a[192:195], 0
    ds_read_b128 v[60:63], v136 offset:0
    v_cvt_pk_f16_f32 v143, v94, v95
    v_mfma_f32_16x16x32_bf16 v[112:115], v[40:43], a[196:199], v[112:115]
    s_nop 0
    ds_read_b128 v[40:43], v133 offset:3072
    v_cvt_pk_f16_f32 v50, v116, v117
    v_mfma_f32_16x16x32_bf16 v[112:115], v[64:67], a[200:203], v[112:115]
    s_add_u32 m0, s67, 1024
    ds_read_b128 v[64:67], v137 offset:128
    v_cvt_pk_f16_f32 v51, v118, v119
    v_mfma_f32_16x16x32_bf16 v[112:115], v[44:47], a[204:207], v[112:115]
    s_waitcnt lgkmcnt(7)
    buffer_store_dwordx4 v[104:107], v128, s[28:31], s60 offen sc1
    buffer_load_dwordx4 v127, s[24:27], s56 offen nt lds
    ds_read_b128 v[44:47], v136 offset:256
    v_pk_fmac_f16 v33, v50, v50
    v_pk_fmac_f16 v33, v51, v51
    v_mfma_f32_16x16x32_bf16 v[112:115], v[52:55], a[208:211], v[112:115]
    v_pk_fmac_f16 v33, v142, v142
    v_pk_fmac_f16 v33, v143, v143
    v_mfma_f32_16x16x32_bf16 v[112:115], v[36:39], a[212:215], v[112:115]
    v_cvt_pk_bf16_f32 v24, v20, v21
    v_cvt_pk_bf16_f32 v25, v22, v23
    v_mfma_f32_16x16x32_f16 v[20:23], v[212:215], v[32:35], 0
    s_nop 0
    v_cvt_pk_bf16_f32 v160, v84, v85
    v_cvt_pk_bf16_f32 v161, v86, v87
    v_mfma_f32_16x16x32_f16 v[32:35], v[8:11], v[28:31], v[200:203]
    s_nop 0
    v_cvt_pk_bf16_f32 v156, v112, v113
    v_cvt_pk_bf16_f32 v157, v114, v115
    v_mfma_f32_16x16x32_f16 v[32:35], v[146:149], v[150:153], v[32:35]
    s_add_u32 m0, s67, 2048
    v_or3_b32 v123, v123, v20, v21
    v_mfma_f32_16x16x32_bf16 v[36:39], a[240:243], v[80:83], 0
    s_waitcnt lgkmcnt(2)
    ds_read_b128 v[52:55], v133 offset:4096
    v_mfma_f32_16x16x32_bf16 v[36:39], a[244:247], v[60:63], v[36:39]
    s_waitcnt lgkmcnt(2)
    buffer_store_dwordx4 v[108:111], v127, s[28:31], s60 offen sc1
    buffer_load_dwordx4 v126, s[24:27], s56 offen nt lds
    v_rsq_f32 v20, v20
    v_mfma_f32_16x16x32_bf16 v[36:39], a[248:251], v[64:67], v[36:39]
    v_rsq_f32 v21, v21
    v_mfma_f32_16x16x32_bf16 v[36:39], a[252:255], v[88:91], v[36:39]
    v_exp_f32 v32, v32
    v_mfma_f32_16x16x32_bf16 v[36:39], v[224:227], v[100:103], v[36:39]
    s_waitcnt lgkmcnt(1)
    v_exp_f32 v33, v33
    v_mfma_f32_16x16x32_bf16 v[36:39], v[228:231], v[44:47], v[36:39]
    v_mul_f32 v20, s52, v20
    v_cvt_pk_f16_f32 v20, v20, v21
    v_mfma_f32_16x16x32_bf16 v[92:95], a[216:219], v[80:83], 0
    v_pk_mul_f16 v56, v56, v20 op_sel:[0,0] op_sel_hi:[1,0]
    v_pk_mul_f16 v57, v57, v20 op_sel:[0,0] op_sel_hi:[1,0]
    v_mfma_f32_16x16x32_bf16 v[92:95], a[220:223], v[60:63], v[92:95]
    v_pk_mul_f16 v58, v58, v20 op_sel:[0,0] op_sel_hi:[1,0]
    v_pk_mul_f16 v59, v59, v20 op_sel:[0,0] op_sel_hi:[1,0]
    v_mfma_f32_16x16x32_bf16 v[92:95], a[224:227], v[64:67], v[92:95]
    v_pk_mul_f16 v140, v140, v20 op_sel:[0,0] op_sel_hi:[1,0]
    v_pk_mul_f16 v141, v141, v20 op_sel:[0,0] op_sel_hi:[1,0]
    v_mfma_f32_16x16x32_bf16 v[92:95], a[228:231], v[88:91], v[92:95]
    v_pk_mul_f16 v48, v48, v20 op_sel:[0,1] op_sel_hi:[1,1]
    v_pk_mul_f16 v49, v49, v20 op_sel:[0,1] op_sel_hi:[1,1]
    v_mfma_f32_16x16x32_bf16 v[92:95], a[232:235], v[100:103], v[92:95]
    v_pk_mul_f16 v50, v50, v20 op_sel:[0,1] op_sel_hi:[1,1]
    v_pk_mul_f16 v51, v51, v20 op_sel:[0,1] op_sel_hi:[1,1]
    v_mfma_f32_16x16x32_bf16 v[92:95], a[236:239], v[44:47], v[92:95]
    s_add_u32 m0, s67, 3072
    buffer_store_dwordx4 v[96:99], v126, s[28:31], s60 offen sc1
    v_pk_mul_f16 v142, v142, v20 op_sel:[0,1] op_sel_hi:[1,1]
    v_pk_mul_f16 v143, v143, v20 op_sel:[0,1] op_sel_hi:[1,1]
    v_exp_f32 v34, v34
    v_mfma_f32_16x16x32_f16 v[20:23], v[68:71], v[28:31], v[208:211]
    v_exp_f32 v35, v35
    v_mfma_f32_16x16x32_f16 v[20:23], v[76:79], v[12:15], v[20:23]
    v_cvt_pk_bf16_f32 v32, v32, v33
    v_cvt_pk_bf16_f32 v33, v34, v35
    v_mfma_f32_16x16x32_f16 v[20:23], v[72:75], v[152:155], v[20:23]
    s_nop 0
    buffer_load_dwordx4 v125, s[24:27], s56 offen nt lds
    v_mfma_f32_16x16x32_f16 v[84:87], v[48:51], v[28:31], v[196:199]
    s_add_u32 m0, s67, 4096
    s_nop 1
    v_mfma_f32_16x16x32_f16 v[84:87], v[140:143], v[150:153], v[84:87]
    s_nop 0
    v_exp_f32 v20, v20
    v_mfma_f32_16x16x32_f16 v[104:107], v[12:15], v[28:31], v[204:207]
    s_nop 0
    v_cvt_pk_bf16_f32 v170, v20, 0
    s_nop 0
    v_mfma_f32_16x16x32_f16 v[104:107], v[152:155], v[150:153], v[104:107]
    s_nop 0
    v_exp_f32 v84, v84
    v_mfma_f32_16x16x32_bf16 v[96:99], v[232:235], v[80:83], 0
    s_waitcnt lgkmcnt(0)
    buffer_store_dwordx4 v[40:43], v125, s[28:31], s60 offen sc1
    buffer_load_dwordx4 v124, s[24:27], s56 offen nt lds
    v_exp_f32 v85, v85
    v_mfma_f32_16x16x32_bf16 v[96:99], v[236:239], v[60:63], v[96:99]
    v_exp_f32 v104, v104
    v_mfma_f32_16x16x32_bf16 v[96:99], v[240:243], v[64:67], v[96:99]
    v_exp_f32 v105, v105
    v_mfma_f32_16x16x32_bf16 v[96:99], v[244:247], v[88:91], v[96:99]
    v_exp_f32 v106, v106
    v_mfma_f32_16x16x32_bf16 v[96:99], v[248:251], v[100:103], v[96:99]
    v_exp_f32 v107, v107
    v_mfma_f32_16x16x32_bf16 v[96:99], v[252:255], v[44:47], v[96:99]
    v_cvt_pk_bf16_f32 v30, v104, v105
    v_cvt_pk_bf16_f32 v31, v106, v107
    v_mfma_f32_16x16x32_f16 v[40:43], v[12:15], v[16:19], v[192:195]
    v_exp_f32 v86, v86
    v_mfma_f32_16x16x32_f16 v[40:43], v[152:155], v[144:147], v[40:43]
    v_exp_f32 v87, v87
    v_mfma_f32_16x16x32_f16 v[44:47], v[48:51], v[16:19], v[184:187]
    buffer_store_dwordx4 v[52:55], v124, s[28:31], s60 offen sc1
    v_cvt_pk_bf16_f32 v168, v84, v85
    v_cvt_pk_bf16_f32 v169, v86, v87
    s_nop 0
    v_mfma_f32_16x16x32_f16 v[44:47], v[140:143], v[144:147], v[44:47]
    s_mov_b32 s53, s47
    v_exp_f32 v40, v40
    v_mfma_f32_16x16x32_f16 v[60:63], v[48:51], v[56:59], v[172:175]
    s_mov_b32 s47, s46
    v_exp_f32 v41, v41
    v_mfma_f32_16x16x32_f16 v[60:63], v[140:143], v[138:141], v[60:63]
    s_mov_b32 s46, s45
    v_exp_f32 v42, v42
    v_mfma_f32_16x16x32_f16 v[64:67], v[68:71], v[56:59], v[208:211]
    s_mov_b32 s45, s44
    v_exp_f32 v43, v43
    v_mfma_f32_16x16x32_f16 v[64:67], v[76:79], v[48:51], v[64:67]
    s_mov_b32 s44, s53
    v_cvt_pk_bf16_f32 v20, v40, v41
    v_cvt_pk_bf16_f32 v21, v42, v43
    v_mfma_f32_16x16x32_f16 v[64:67], v[72:75], v[140:143], v[64:67]
    s_sub_u32 s48, s44, s46
    ds_read_b128 v[40:43], v136 offset:1536
    v_mfma_f32_16x16x32_f16 v[84:87], v[68:71], v[16:19], v[208:211]
    s_sub_u32 s49, s46, s45
    ds_read_b128 v[52:55], v137 offset:1792
    v_fma_f32 v28, v92, v92, s42
    v_mfma_f32_16x16x32_f16 v[84:87], v[76:79], v[8:11], v[84:87]
    s_cmp_lg_u32 s5, -1
    ds_read_b128 v[80:83], v137 offset:1664
    v_fmac_f32 v28, v93, v93
    v_mfma_f32_16x16x32_f16 v[84:87], v[72:75], v[146:149], v[84:87]
    s_nop 0
    v_exp_f32 v44, v44
    v_mfma_f32_16x16x32_bf16 v[68:71], v[220:223], v[30:33], 0
    s_nop 0
    v_exp_f32 v45, v45
    v_mfma_f32_16x16x32_bf16 v[68:71], v[220:223], v[168:171], v[68:71]
    s_nop 0
    ds_read_b128 v[76:79], v137 offset:1536
    v_mov_b32_dpp v23, v87 quad_perm:[0,1,2,3] row_mask:0x2 bank_mask:0xf
    v_mfma_f32_16x16x32_bf16 v[104:107], v[0:3], v[30:33], 0
    ds_read_b128 v[86:89], v136 offset:1664
    v_mov_b32_dpp v23, v67 quad_perm:[0,1,2,3] row_mask:0x4 bank_mask:0xf
    v_mfma_f32_16x16x32_bf16 v[104:107], v[164:167], v[168:171], v[104:107]
    v_exp_f32 v46, v46
    v_mfma_f32_16x16x32_bf16 v[72:75], v[24:27], v[30:33], 0
    v_exp_f32 v47, v47
    v_mfma_f32_16x16x32_bf16 v[72:75], v[160:163], v[168:171], v[72:75]
    v_exp_f32 v85, v85
    v_mfma_f32_16x16x32_bf16 v[116:119], v[4:7], v[30:33], 0
    ds_read_b128 v[30:33], v136 offset:1792
    v_fmac_f32 v28, v94, v94
    v_mfma_f32_16x16x32_bf16 v[116:119], v[156:159], v[168:171], v[116:119]
    v_exp_f32 v23, v23
    v_mfma_f32_16x16x32_f16 v[108:111], v[12:15], v[56:59], v[180:183]
    v_cvt_pk_bf16_f32 v23, v23, v23
    v_cvt_pk_bf16_f32 v168, v44, v45
    v_mfma_f32_16x16x32_f16 v[108:111], v[152:155], v[138:141], v[108:111]
    v_rcp_f32 v68, v68
    v_mfma_f32_16x16x32_f16 v[152:155], v[8:11], v[56:59], v[176:179]
    ds_write_b16 v131, v23 offset:64
    v_mfma_f32_16x16x32_f16 v[152:155], v[146:149], v[138:141], v[152:155]
    s_waitcnt lgkmcnt(2)
    v_mul_f32 v104, v104, v68
    v_mul_f32 v105, v105, v68
    v_mfma_f32_16x16x32_bf16 v[56:59], a[216:219], v[76:79], 0
    v_cvt_pk_bf16_f32 v12, v104, v105
    v_mul_f32 v106, v106, v68
    v_mfma_f32_16x16x32_bf16 v[56:59], a[220:223], v[40:43], v[56:59]
    ds_read_b128 v[100:103], v132 offset:48
    v_mul_f32 v107, v107, v68
    v_mfma_f32_16x16x32_bf16 v[56:59], a[224:227], v[80:83], v[56:59]
    ds_read_b128 v[140:143], v132 offset:64
    v_cvt_pk_bf16_f32 v13, v106, v107
    v_mfma_f32_16x16x32_bf16 v[56:59], a[228:231], v[86:89], v[56:59]
    v_mul_f32 v72, v72, v68
    v_mul_f32 v73, v73, v68
    v_mfma_f32_16x16x32_bf16 v[56:59], a[232:235], v[52:55], v[56:59]
    s_waitcnt lgkmcnt(3)
    v_cvt_pk_bf16_f32 v14, v72, v73
    v_mul_f32 v74, v74, v68
    v_mfma_f32_16x16x32_bf16 v[56:59], a[236:239], v[30:33], v[56:59]
    v_mul_f32 v75, v75, v68
    v_cvt_pk_bf16_f32 v15, v74, v75
    v_mfma_f32_16x16x32_bf16 v[104:107], v[232:235], v[76:79], 0
    ds_write_b64 v135, v[12:13] offset:0
    v_mfma_f32_16x16x32_bf16 v[104:107], v[236:239], v[40:43], v[104:107]
    v_mul_f32 v116, v116, v68
    v_mul_f32 v117, v117, v68
    v_mfma_f32_16x16x32_bf16 v[104:107], v[240:243], v[80:83], v[104:107]
    v_cvt_pk_bf16_f32 v22, v116, v117
    v_mul_f32 v118, v118, v68
    v_mfma_f32_16x16x32_bf16 v[104:107], v[244:247], v[86:89], v[104:107]
    ds_read_b128 v[72:75], v137 offset:3200
    v_mul_f32 v119, v119, v68
    v_mfma_f32_16x16x32_bf16 v[104:107], v[248:251], v[52:55], v[104:107]
    v_cvt_pk_bf16_f32 v23, v118, v119
    v_cvt_pk_bf16_f32 v169, v46, v47
    v_mfma_f32_16x16x32_bf16 v[104:107], v[252:255], v[30:33], v[104:107]
    s_waitcnt lgkmcnt(2)
    v_cvt_pk_bf16_f32 v170, v85, 0
    v_fmac_f32 v28, v95, v95
    v_mfma_f32_16x16x32_bf16 v[44:47], v[100:103], v[0:3], 0
    v_exp_f32 v60, v60
    v_mfma_f32_16x16x32_bf16 v[44:47], v[140:143], v[164:167], v[44:47]
    ds_write_b64 v135, v[14:15] offset:8
    v_mfma_f32_16x16x32_bf16 v[12:15], v[100:103], v[24:27], 0
    v_exp_f32 v61, v61
    v_mfma_f32_16x16x32_bf16 v[12:15], v[140:143], v[160:163], v[12:15]
    v_exp_f32 v62, v62
    v_mfma_f32_16x16x32_bf16 v[68:71], v[100:103], v[4:7], 0
    s_nop 0
    ds_read_b128 v[116:119], v137 offset:3072
    v_fmac_f32 v28, v36, v36
    v_mfma_f32_16x16x32_bf16 v[68:71], v[140:143], v[156:159], v[68:71]
    s_nop 0
    ds_read_b128 v[100:103], v136 offset:3072
    v_mov_b32_dpp v47, v15 quad_perm:[0,1,2,3] row_mask:0x2 bank_mask:0xf
    v_mfma_f32_16x16x32_bf16 v[140:143], a[240:243], v[76:79], 0
    ds_read_b128 v[12:15], v136 offset:3200
    v_fmac_f32 v28, v37, v37
    v_mfma_f32_16x16x32_bf16 v[140:143], a[244:247], v[40:43], v[140:143]
    ds_read_b128 v[40:43], v137 offset:3328
    v_mov_b32_dpp v47, v71 quad_perm:[0,1,2,3] row_mask:0x4 bank_mask:0xf
    v_mfma_f32_16x16x32_bf16 v[140:143], a[248:251], v[80:83], v[140:143]
    ds_read_b128 v[80:83], v136 offset:3328
    v_cvt_pk_bf16_f32 v47, v47, v47
    v_mfma_f32_16x16x32_bf16 v[140:143], a[252:255], v[86:89], v[140:143]
    v_exp_f32 v63, v63
    v_mfma_f32_16x16x32_bf16 v[140:143], v[224:227], v[52:55], v[140:143]
    v_exp_f32 v66, v66
    v_mfma_f32_16x16x32_bf16 v[140:143], v[228:231], v[30:33], v[140:143]
    v_exp_f32 v152, v152
    v_mfma_f32_16x16x32_f16 v[30:33], v[8:11], v[16:19], v[188:191]
    ds_write_b32 v134, v22 offset:0
    v_mfma_f32_16x16x32_f16 v[30:33], v[146:149], v[144:147], v[30:33]
    s_waitcnt lgkmcnt(5)
    v_exp_f32 v153, v153
    v_mfma_f32_16x16x32_bf16 v[84:87], a[240:243], v[116:119], 0
    s_waitcnt lgkmcnt(4)
    v_exp_f32 v154, v154
    v_mfma_f32_16x16x32_bf16 v[84:87], a[244:247], v[100:103], v[84:87]
    v_exp_f32 v155, v155
    v_mfma_f32_16x16x32_bf16 v[84:87], a[248:251], v[72:75], v[84:87]
    s_waitcnt lgkmcnt(2)
    ds_write_b32 v134, v23 offset:4
    v_mfma_f32_16x16x32_bf16 v[84:87], a[252:255], v[12:15], v[84:87]
    v_cvt_pk_bf16_f32 v34, v152, v153
    v_cvt_pk_bf16_f32 v35, v154, v155
    v_mfma_f32_16x16x32_bf16 v[84:87], v[224:227], v[40:43], v[84:87]
    s_waitcnt lgkmcnt(2)
    v_exp_f32 v30, v30
    v_mfma_f32_16x16x32_bf16 v[84:87], v[228:231], v[80:83], v[84:87]
    v_exp_f32 v31, v31
    v_mfma_f32_16x16x32_bf16 v[52:55], a[216:219], v[116:119], 0
    ds_write_b16 v131, v47
    v_mfma_f32_16x16x32_bf16 v[52:55], a[220:223], v[100:103], v[52:55]
    v_exp_f32 v32, v32
    v_mfma_f32_16x16x32_bf16 v[52:55], a[224:227], v[72:75], v[52:55]
    v_exp_f32 v33, v33
    v_mfma_f32_16x16x32_bf16 v[52:55], a[228:231], v[12:15], v[52:55]
    v_cvt_pk_bf16_f32 v22, v30, v31
    v_cvt_pk_bf16_f32 v23, v32, v33
    v_mfma_f32_16x16x32_bf16 v[52:55], a[232:235], v[40:43], v[52:55]
    v_exp_f32 v108, v108
    v_mfma_f32_16x16x32_bf16 v[52:55], a[236:239], v[80:83], v[52:55]
    v_exp_f32 v109, v109
    v_mfma_f32_16x16x32_bf16 v[152:155], v[220:223], v[20:23], 0
    v_exp_f32 v110, v110
    v_mfma_f32_16x16x32_bf16 v[152:155], v[220:223], v[168:171], v[152:155]
    s_nop 0
    v_exp_f32 v111, v111
    v_mfma_f32_16x16x32_bf16 v[8:11], v[0:3], v[20:23], 0
    s_nop 0
    v_cvt_pk_bf16_f32 v32, v108, v109
    v_cvt_pk_bf16_f32 v33, v110, v111
    v_mfma_f32_16x16x32_bf16 v[8:11], v[164:167], v[168:171], v[8:11]
    s_nop 0
    v_rcp_f32 v152, v152
    v_mfma_f32_16x16x32_bf16 v[44:47], v[24:27], v[20:23], 0
    v_add_u32 v137, s48, v137
    v_add_u32 v136, s48, v136
    v_mfma_f32_16x16x32_bf16 v[44:47], v[160:163], v[168:171], v[44:47]
    s_nop 0
    ds_read_b128 v[146:149], v137 offset:0
    v_mul_f32 v8, v8, v152
    v_mfma_f32_16x16x32_bf16 v[16:19], v[4:7], v[20:23], 0
    ds_read_b128 v[88:91], v136 offset:0
    v_mul_f32 v9, v9, v152
    v_mfma_f32_16x16x32_bf16 v[16:19], v[156:159], v[168:171], v[16:19]
    ds_read_b128 v[108:111], v137 offset:128
    v_cvt_pk_bf16_f32 v168, v60, v61
    v_mfma_f32_16x16x32_bf16 v[48:51], v[232:235], v[116:119], 0
    ds_read_b128 v[116:119], v136 offset:128
    v_cvt_pk_bf16_f32 v169, v62, v63
    v_mfma_f32_16x16x32_bf16 v[48:51], v[236:239], v[100:103], v[48:51]
    ds_read_b128 v[60:63], v137 offset:256
    v_cvt_pk_bf16_f32 v170, v66, 0
    v_mfma_f32_16x16x32_bf16 v[48:51], v[240:243], v[72:75], v[48:51]
    ds_read_b128 v[64:67], v136 offset:256
    v_cvt_pk_bf16_f32 v20, v8, v9
    v_mfma_f32_16x16x32_bf16 v[48:51], v[244:247], v[12:15], v[48:51]
    v_mul_f32 v10, v10, v152
    v_mul_f32 v11, v11, v152
    v_mfma_f32_16x16x32_bf16 v[48:51], v[248:251], v[40:43], v[48:51]
    ds_read_b128 v[100:103], v136 offset:1536
    v_cvt_pk_bf16_f32 v21, v10, v11
    v_mfma_f32_16x16x32_bf16 v[48:51], v[252:255], v[80:83], v[48:51]
    ds_read_b128 v[80:83], v137 offset:1664
    v_mul_f32 v44, v44, v152
    v_mfma_f32_16x16x32_bf16 v[12:15], v[220:223], v[32:35], 0
    ds_read_b128 v[68:71], v137 offset:1536
    v_mul_f32 v45, v45, v152
    v_mfma_f32_16x16x32_bf16 v[12:15], v[220:223], v[168:171], v[12:15]
    ds_read_b128 v[76:79], v136 offset:1792
    v_cvt_pk_bf16_f32 v22, v44, v45
    v_mfma_f32_16x16x32_bf16 v[72:75], v[0:3], v[32:35], 0
    v_mul_f32 v46, v46, v152
    v_mul_f32 v47, v47, v152
    v_mfma_f32_16x16x32_bf16 v[72:75], v[164:167], v[168:171], v[72:75]
    v_cvt_pk_bf16_f32 v23, v46, v47
    v_mul_f32 v16, v16, v152
    v_mfma_f32_16x16x32_bf16 v[0:3], v[24:27], v[32:35], 0
    v_mul_f32 v17, v17, v152
    v_cvt_pk_bf16_f32 v154, v16, v17
    v_mfma_f32_16x16x32_bf16 v[0:3], v[160:163], v[168:171], v[0:3]
    ds_write_b32 v135, v20 offset:1536
    v_mfma_f32_16x16x32_bf16 v[8:11], v[4:7], v[32:35], 0
    v_mul_f32 v18, v18, v152
    v_mul_f32 v19, v19, v152
    v_mfma_f32_16x16x32_bf16 v[8:11], v[156:159], v[168:171], v[8:11]
    s_waitcnt lgkmcnt(4)
    v_cvt_pk_bf16_f32 v155, v18, v19
    v_fmac_f32 v28, v38, v38
    v_mfma_f32_16x16x32_bf16 v[30:33], a[0:3], v[146:149], 0
    s_cbranch_scc1 L_loopF0
    ds_write_b32 v135, v21 offset:1540
    v_rcp_f32 v12, v12
    s_mov_b32 s30, 100270464
    s_mul_i32 s89, s68, 7168
    ds_write_b64 v135, v[22:23] offset:1544
    v_mul_f32 v72, v72, v12
    v_mul_f32 v73, v73, v12
    v_cvt_pk_bf16_f32 v4, v72, v73
    s_add_u32 s89, s89, 135168
    s_movk_i32 s90, 112
    ds_write_b64 v134, v[154:155] offset:1536
    v_mul_f32 v74, v74, v12
    v_mul_f32 v75, v75, v12
    v_cvt_pk_bf16_f32 v5, v74, v75
    v_mul_f32 v0, v0, v12
    v_mul_f32 v1, v1, v12
    v_cvt_pk_bf16_f32 v6, v0, v1
    v_mul_f32 v2, v2, v12
    v_mul_f32 v3, v3, v12
    v_cvt_pk_bf16_f32 v7, v2, v3
    v_mul_f32 v8, v8, v12
    v_mul_f32 v9, v9, v12
    v_cvt_pk_bf16_f32 v8, v8, v9
    v_mul_f32 v10, v10, v12
    v_mul_f32 v11, v11, v12
    v_cvt_pk_bf16_f32 v9, v10, v11
    s_lshr_b32 s91, s64, 16
    s_lshl_b32 s92, s68, 10
    ds_write_b64 v135, v[4:5] offset:3072
    v_fmac_f32 v28, v39, v39
    s_sub_u32 s84, s45, s44
    s_sub_u32 s85, s46, s45
    ds_write_b64 v135, v[6:7] offset:3080
    v_fmac_f32 v28, v96, v96
    v_fmac_f32 v28, v97, v97
    v_fmac_f32 v28, v98, v98
    s_sub_u32 s86, s44, s45
    s_sub_u32 s93, s44, s47
    ds_write_b32 v134, v8 offset:3072
    ds_write_b32 v134, v9 offset:3076
    v_fmac_f32 v28, v99, v99
    v_fma_f32 v131, v56, v56, s42
    v_fmac_f32 v131, v57, v57
    v_fmac_f32 v131, v58, v58
    v_fmac_f32 v131, v59, v59
    v_fmac_f32 v131, v140, v140
    v_fmac_f32 v131, v141, v141
    v_fmac_f32 v131, v142, v142
    v_fmac_f32 v131, v143, v143
    v_fmac_f32 v131, v104, v104
    v_fmac_f32 v131, v105, v105
    v_fmac_f32 v131, v106, v106
    v_fmac_f32 v131, v107, v107
    v_fma_f32 v121, v52, v52, s42
    v_fmac_f32 v121, v53, v53
    v_fmac_f32 v121, v54, v54
    v_fmac_f32 v121, v55, v55
    v_fmac_f32 v121, v84, v84
    v_fmac_f32 v121, v85, v85
    v_fmac_f32 v121, v86, v86
    v_fmac_f32 v121, v87, v87
    v_fmac_f32 v121, v48, v48
    v_fmac_f32 v121, v49, v49
    v_fmac_f32 v121, v50, v50
    v_fmac_f32 v121, v51, v51
    v_cvt_pk_bf16_f32 v120, v28, v131
    v_cvt_pk_bf16_f32 v121, v121, v122
    s_sub_u32 s94, s45, s47
    s_sub_u32 s95, s46, s47
    ds_write_b64 v130, v[120:121]
    v_mbcnt_lo_u32_b32 v131, -1, 0
    v_mbcnt_hi_u32_b32 v131, -1, v131
    v_and_b32 v120, 15, v131
    v_lshrrev_b32 v131, 4, v131
    v_mul_u32_u24 v131, 1792, v131
    v_add_u32 v131, s89, v131
    v_mad_u32_u24 v132, v120, s90, v131
    v_lshrrev_b32 v121, v120, s64
    v_and_b32 v121, 1, v121
    v_cmp_eq_u32 vcc, 1, v121
    v_mad_u32_u24 v122, v120, s90, v131
    v_lshrrev_b32 v120, v120, s91
    v_cndmask_b32 v132, v131, v132, vcc
    v_and_b32 v120, 1, v120
    v_subrev_u32 v122, 28672, v122
    v_cmp_eq_u32 vcc, 1, v120
    ds_read_b128 v[20:23], v132 offset:64
    ds_read_b128 v[16:19], v132 offset:80
    v_cndmask_b32 v122, v131, v122, vcc
    v_add_u32 v131, s92, v129
    s_waitcnt lgkmcnt(2)
    s_barrier
    ds_read_b128 v[114:117], v132
    v_add_u32 v29, s84, v137
    ds_read_b64 v[118:119], v132 offset:16
    ds_read_b128 v[4:7], v131 offset:6144
    v_add_u32 v28, s84, v136
    v_add_u32 v121, s85, v135
    ds_read_b128 v[8:11], v129 offset:0
    v_add_u32 v120, s85, v134
    ds_read_b128 v[0:3], v129 offset:1024
    v_add_u32 v138, s86, v135
    v_add_u32 v132, s86, v134
    v_add_u32 v131, s93, v133
    v_add_u32 v139, s94, v133
    s_waitcnt lgkmcnt(6)
    v_mfma_f32_16x16x32_bf16 v[12:15], v[220:223], v[20:23], 0
    s_waitcnt lgkmcnt(5)
    ds_read_b128 v[76:79], v29 offset:1536
    ds_read_b128 v[72:75], v28 offset:1536
    v_mfma_f32_16x16x32_bf16 v[12:15], v[220:223], v[16:19], v[12:15]
    s_waitcnt lgkmcnt(3)
    ds_read_b128 v[68:71], v29 offset:1664
    v_lshlrev_b32 v80, 16, v114
    v_and_b32 v114, 0xffff0000, v114
    v_lshlrev_b32 v81, 16, v115
    v_and_b32 v115, 0xffff0000, v115
    v_lshlrev_b32 v82, 16, v116
    v_and_b32 v116, 0xffff0000, v116
    v_rcp_f32 v12, v12
    v_lshlrev_b32 v83, 16, v117
    v_mfma_f32_16x16x32_bf16 v[16:19], v[216:219], v[8:11], 0
    s_waitcnt lgkmcnt(3)
    ds_read_b128 v[64:67], v28 offset:1664
    ds_read_b128 v[44:47], v29 offset:1792
    v_mfma_f32_16x16x32_bf16 v[16:19], v[216:219], v[0:3], v[16:19]
    s_waitcnt lgkmcnt(4)
    ds_read_b128 v[40:43], v28 offset:1792
    v_mul_f32 v80, v80, v12
    v_mul_f32 v114, v114, v12
    v_cvt_pk_bf16_f32 v80, v80, v114
    v_mul_f32 v81, v81, v12
    v_mfma_f32_16x16x32_bf16 v[8:11], a[216:219], v[76:79], 0
    s_waitcnt lgkmcnt(4)
    v_mul_f32 v115, v115, v12
    v_cvt_pk_bf16_f32 v81, v81, v115
    v_mfma_f32_16x16x32_bf16 v[8:11], a[220:223], v[72:75], v[8:11]
    s_waitcnt lgkmcnt(3)
    ds_read_b128 v[112:115], v29 offset:0
    ds_read_b128 v[108:111], v28 offset:0
    v_mfma_f32_16x16x32_bf16 v[8:11], a[224:227], v[68:71], v[8:11]
    s_waitcnt lgkmcnt(4)
    ds_read_b128 v[60:63], v29 offset:128
    v_mul_f32 v82, v82, v12
    v_mul_f32 v116, v116, v12
    v_cvt_pk_bf16_f32 v82, v82, v116
    v_and_b32 v117, 0xffff0000, v117
    v_mul_f32 v83, v83, v12
    v_mfma_f32_16x16x32_bf16 v[8:11], a[228:231], v[64:67], v[8:11]
    s_waitcnt lgkmcnt(4)
    ds_read_b128 v[32:35], v28 offset:128
    ds_read_b128 v[20:23], v29 offset:256
    v_mfma_f32_16x16x32_bf16 v[8:11], a[232:235], v[44:47], v[8:11]
    s_waitcnt lgkmcnt(5)
    ds_read_b128 v[0:3], v28 offset:256
    v_mul_f32 v117, v117, v12
    v_mfma_f32_16x16x32_bf16 v[8:11], a[236:239], v[40:43], v[8:11]
    v_cvt_pk_bf16_f32 v83, v83, v117
    v_lshlrev_b32 v19, 16, v118
    v_mfma_f32_16x16x32_bf16 v[24:27], a[240:243], v[76:79], 0
    ds_write_b128 v138, v[80:83] offset:0
    v_mfma_f32_16x16x32_bf16 v[24:27], a[244:247], v[72:75], v[24:27]
    v_and_b32 v118, 0xffff0000, v118
    v_mul_f32 v19, v19, v12
    v_mfma_f32_16x16x32_bf16 v[24:27], a[248:251], v[68:71], v[24:27]
    v_mul_f32 v118, v118, v12
    v_cvt_pk_bf16_f32 v30, v19, v118
    v_mfma_f32_16x16x32_bf16 v[24:27], a[252:255], v[64:67], v[24:27]
    v_lshlrev_b32 v19, 16, v119
    v_and_b32 v119, 0xffff0000, v119
    v_mfma_f32_16x16x32_bf16 v[24:27], v[224:227], v[44:47], v[24:27]
    v_mul_f32 v19, v19, v12
    v_mul_f32 v119, v119, v12
    v_mfma_f32_16x16x32_bf16 v[24:27], v[228:231], v[40:43], v[24:27]
    v_cvt_pk_bf16_f32 v31, v19, v119
    v_lshrrev_b32 v19, 0, v7
    v_mfma_f32_16x16x32_bf16 v[12:15], v[232:235], v[76:79], 0
    ds_write_b64 v132, v[30:31] offset:0
    v_mfma_f32_16x16x32_bf16 v[12:15], v[236:239], v[72:75], v[12:15]
    v_lshrrev_b32 v19, v19, s64
    v_and_b32 v19, 1, v19
    v_mfma_f32_16x16x32_bf16 v[12:15], v[240:243], v[68:71], v[12:15]
    v_cmp_eq_u32 vcc, 1, v19
    v_lshrrev_b32 v19, 8, v7
    v_mfma_f32_16x16x32_bf16 v[12:15], v[244:247], v[64:67], v[12:15]
    v_cndmask_b32 v4, 2.0, v4, vcc
    v_lshrrev_b32 v19, v19, s64
    v_mfma_f32_16x16x32_bf16 v[12:15], v[248:251], v[44:47], v[12:15]
    v_and_b32 v19, 1, v19
    v_cmp_eq_u32 vcc, 1, v19
    v_mfma_f32_16x16x32_bf16 v[12:15], v[252:255], v[40:43], v[12:15]
    s_waitcnt lgkmcnt(1)
    v_cndmask_b32 v5, 2.0, v5, vcc
    v_lshrrev_b32 v7, 16, v7
    v_mfma_f32_16x16x32_bf16 v[68:71], a[216:219], v[112:115], 0
    v_lshrrev_b32 v7, v7, s64
    v_and_b32 v7, 1, v7
    v_mfma_f32_16x16x32_bf16 v[68:71], a[220:223], v[108:111], v[68:71]
    ds_read_b128 v[100:103], v29 offset:3072
    ds_read_b128 v[88:91], v28 offset:3072
    v_mfma_f32_16x16x32_bf16 v[68:71], a[224:227], v[60:63], v[68:71]
    ds_read_b128 v[80:83], v29 offset:3200
    v_cmp_eq_u32 vcc, 1, v7
    v_mfma_f32_16x16x32_bf16 v[68:71], a[228:231], v[32:35], v[68:71]
    ds_read_b128 v[76:79], v28 offset:3200
    v_cndmask_b32 v6, 2.0, v6, vcc
    v_mfma_f32_16x16x32_bf16 v[68:71], a[232:235], v[20:23], v[68:71]
L_pg2:
    s_cbranch_execz L_main
    ds_read_b128 v[64:67], v29 offset:3328
    v_add_u32 v7, s95, v133
    v_mfma_f32_16x16x32_bf16 v[68:71], a[236:239], v[0:3], v[68:71]
    ds_read_b128 v[28:31], v28 offset:3328
    v_fma_f32 v133, v8, v8, s42
    v_mfma_f32_16x16x32_bf16 v[44:47], a[240:243], v[112:115], 0
    v_rsq_f32 v16, v16
    v_mfma_f32_16x16x32_bf16 v[44:47], a[244:247], v[108:111], v[44:47]
    v_mul_f32 v16, s43, v16
    v_mul_f32 v92, v92, v16
    v_mfma_f32_16x16x32_bf16 v[44:47], a[248:251], v[60:63], v[44:47]
    v_mul_f32 v93, v93, v16
    v_cvt_pk_bf16_f32 v72, v92, v93
    v_mfma_f32_16x16x32_bf16 v[44:47], a[252:255], v[32:35], v[44:47]
    v_mul_f32 v94, v94, v16
    v_mul_f32 v95, v95, v16
    v_mfma_f32_16x16x32_bf16 v[44:47], v[224:227], v[20:23], v[44:47]
    v_cvt_pk_bf16_f32 v73, v94, v95
    v_mul_f32 v36, v36, v16
    v_mfma_f32_16x16x32_bf16 v[44:47], v[228:231], v[0:3], v[44:47]
    v_mul_f32 v37, v37, v16
    v_cvt_pk_bf16_f32 v74, v36, v37
    v_mfma_f32_16x16x32_bf16 v[40:43], v[232:235], v[112:115], 0
    v_mul_f32 v38, v38, v16
    v_mul_f32 v39, v39, v16
    v_mfma_f32_16x16x32_bf16 v[40:43], v[236:239], v[108:111], v[40:43]
    v_cvt_pk_bf16_f32 v75, v38, v39
    v_mul_f32 v96, v96, v16
    v_mfma_f32_16x16x32_bf16 v[40:43], v[240:243], v[60:63], v[40:43]
    ds_write_b128 v121, v[72:75] offset:0
    v_mfma_f32_16x16x32_bf16 v[40:43], v[244:247], v[32:35], v[40:43]
    v_mul_f32 v97, v97, v16
    v_cvt_pk_bf16_f32 v96, v96, v97
    v_mfma_f32_16x16x32_bf16 v[40:43], v[248:251], v[20:23], v[40:43]
    v_mul_f32 v98, v98, v16
    v_mul_f32 v99, v99, v16
    v_mfma_f32_16x16x32_bf16 v[40:43], v[252:255], v[0:3], v[40:43]
    s_waitcnt lgkmcnt(1)
    v_cvt_pk_bf16_f32 v97, v98, v99
    v_fma_f32 v38, v68, v68, s42
    v_mfma_f32_16x16x32_bf16 v[20:23], a[216:219], v[100:103], 0
    ds_write_b64 v120, v[96:97] offset:0
    v_mfma_f32_16x16x32_bf16 v[20:23], a[220:223], v[88:91], v[20:23]
    ds_read_b128 v[60:63], v122 offset:64
    v_fmac_f32 v38, v69, v69
    v_mfma_f32_16x16x32_bf16 v[20:23], a[224:227], v[80:83], v[20:23]
    ds_read_b128 v[0:3], v122 offset:80
    v_fmac_f32 v38, v70, v70
    v_mfma_f32_16x16x32_bf16 v[20:23], a[228:231], v[76:79], v[20:23]
    ds_read_b128 v[32:35], v122
    v_fmac_f32 v38, v71, v71
    v_mfma_f32_16x16x32_bf16 v[20:23], a[232:235], v[64:67], v[20:23]
    ds_read_b64 v[36:37], v122 offset:16
    v_fmac_f32 v38, v44, v44
    v_mfma_f32_16x16x32_bf16 v[20:23], a[236:239], v[28:31], v[20:23]
    v_rsq_f32 v17, v17
    v_mfma_f32_16x16x32_bf16 v[96:99], a[240:243], v[100:103], 0
    v_mul_f32 v17, s43, v17
    v_mul_f32 v56, v56, v17
    v_mfma_f32_16x16x32_bf16 v[96:99], a[244:247], v[88:91], v[96:99]
    v_mul_f32 v57, v57, v17
    v_cvt_pk_bf16_f32 v56, v56, v57
    v_mfma_f32_16x16x32_bf16 v[96:99], a[248:251], v[80:83], v[96:99]
    v_mul_f32 v58, v58, v17
    v_mul_f32 v59, v59, v17
    v_mfma_f32_16x16x32_bf16 v[96:99], a[252:255], v[76:79], v[96:99]
    v_cvt_pk_bf16_f32 v57, v58, v59
    v_mul_f32 v140, v140, v17
    v_mfma_f32_16x16x32_bf16 v[96:99], v[224:227], v[64:67], v[96:99]
    v_mul_f32 v141, v141, v17
    v_cvt_pk_bf16_f32 v58, v140, v141
    v_mfma_f32_16x16x32_bf16 v[96:99], v[228:231], v[28:31], v[96:99]
    v_mul_f32 v142, v142, v17
    v_mul_f32 v143, v143, v17
    v_mfma_f32_16x16x32_bf16 v[72:75], v[232:235], v[100:103], 0
    v_cvt_pk_bf16_f32 v59, v142, v143
    v_mul_f32 v104, v104, v17
    v_mfma_f32_16x16x32_bf16 v[72:75], v[236:239], v[88:91], v[72:75]
    ds_write_b128 v121, v[56:59] offset:1536
    v_mfma_f32_16x16x32_bf16 v[72:75], v[240:243], v[80:83], v[72:75]
    v_mul_f32 v105, v105, v17
    v_cvt_pk_bf16_f32 v104, v104, v105
    v_mfma_f32_16x16x32_bf16 v[72:75], v[244:247], v[76:79], v[72:75]
    v_mul_f32 v106, v106, v17
    v_mul_f32 v107, v107, v17
    v_mfma_f32_16x16x32_bf16 v[72:75], v[248:251], v[64:67], v[72:75]
    v_cvt_pk_bf16_f32 v105, v106, v107
    v_fmac_f32 v38, v45, v45
    v_mfma_f32_16x16x32_bf16 v[72:75], v[252:255], v[28:31], v[72:75]
    s_waitcnt lgkmcnt(1)
    ds_write_b64 v120, v[104:105] offset:1536
    v_mfma_f32_16x16x32_bf16 v[28:31], v[220:223], v[60:63], 0
    v_rsq_f32 v18, v18
    v_mfma_f32_16x16x32_bf16 v[28:31], v[220:223], v[0:3], v[28:31]
    v_mul_f32 v18, s43, v18
    v_mul_f32 v52, v52, v18
    v_mul_f32 v53, v53, v18
    v_cvt_pk_bf16_f32 v0, v52, v53
    v_mul_f32 v54, v54, v18
    v_mul_f32 v55, v55, v18
    v_cvt_pk_bf16_f32 v1, v54, v55
    v_mul_f32 v84, v84, v18
    v_mul_f32 v85, v85, v18
    v_cvt_pk_bf16_f32 v2, v84, v85
    v_mul_f32 v86, v86, v18
    v_mul_f32 v87, v87, v18
    v_cvt_pk_bf16_f32 v3, v86, v87
    v_mul_f32 v48, v48, v18
    v_mul_f32 v49, v49, v18
    v_cvt_pk_bf16_f32 v48, v48, v49
    v_mul_f32 v50, v50, v18
    v_mul_f32 v51, v51, v18
    v_cvt_pk_bf16_f32 v49, v50, v51
    ds_write_b128 v121, v[0:3] offset:3072
    v_fmac_f32 v38, v46, v46
    v_fmac_f32 v38, v47, v47
    v_fmac_f32 v38, v40, v40
    v_fmac_f32 v38, v41, v41
    ds_write_b64 v120, v[48:49] offset:3072
    v_fmac_f32 v38, v42, v42
    v_fmac_f32 v38, v43, v43
    v_fmac_f32 v133, v9, v9
    v_fmac_f32 v133, v10, v10
    v_fmac_f32 v133, v11, v11
    v_fmac_f32 v133, v24, v24
    v_fmac_f32 v133, v25, v25
    v_fmac_f32 v133, v26, v26
    v_fmac_f32 v133, v27, v27
    v_fmac_f32 v133, v12, v12
    v_fmac_f32 v133, v13, v13
    v_fmac_f32 v133, v14, v14
    v_fmac_f32 v133, v15, v15
    v_cvt_pk_bf16_f32 v38, v38, v133
    v_fma_f32 v133, v20, v20, s42
    v_fmac_f32 v133, v21, v21
    v_fmac_f32 v133, v22, v22
    v_fmac_f32 v133, v23, v23
    v_fmac_f32 v133, v96, v96
    v_fmac_f32 v133, v97, v97
    v_fmac_f32 v133, v98, v98
    v_fmac_f32 v133, v99, v99
    v_fmac_f32 v133, v72, v72
    v_fmac_f32 v133, v73, v73
    v_fmac_f32 v133, v74, v74
    v_fmac_f32 v133, v75, v75
    v_cvt_pk_bf16_f32 v39, v133, v133
    ds_write_b64 v130, v[38:39] offset:2048
    v_rcp_f32 v28, v28
    v_lshlrev_b32 v133, 16, v32
    v_and_b32 v32, 0xffff0000, v32
    v_mul_f32 v133, v133, v28
    v_mul_f32 v32, v32, v28
    v_cvt_pk_bf16_f32 v16, v133, v32
    v_lshlrev_b32 v32, 16, v33
    v_and_b32 v33, 0xffff0000, v33
    v_mul_f32 v32, v32, v28
    v_mul_f32 v33, v33, v28
    v_cvt_pk_bf16_f32 v17, v32, v33
    v_lshlrev_b32 v133, 16, v34
    v_and_b32 v34, 0xffff0000, v34
    v_mul_f32 v133, v133, v28
    v_mul_f32 v34, v34, v28
    v_cvt_pk_bf16_f32 v18, v133, v34
    v_lshlrev_b32 v19, 16, v35
    v_and_b32 v35, 0xffff0000, v35
    v_mul_f32 v19, v19, v28
    v_mul_f32 v35, v35, v28
    v_cvt_pk_bf16_f32 v19, v19, v35
    v_lshlrev_b32 v133, 16, v36
    v_and_b32 v36, 0xffff0000, v36
    v_mul_f32 v133, v133, v28
    v_mul_f32 v36, v36, v28
    v_cvt_pk_bf16_f32 v0, v133, v36
    v_lshlrev_b32 v133, 16, v37
    v_and_b32 v37, 0xffff0000, v37
    v_mul_f32 v133, v133, v28
    v_mul_f32 v37, v37, v28
    v_cvt_pk_bf16_f32 v1, v133, v37
    s_waitcnt lgkmcnt(0)
    s_barrier
    ds_write_b128 v138, v[16:19] offset:1536
    v_and_b32 v123, 0xb8000000, v123
    v_mov_b32 v121, 0x3f803f80
    v_cmp_ne_u32 vcc, 0, v123
    s_nop 0
    ds_write_b64 v132, v[0:1] offset:1536
    v_cndmask_b32 v121, 0, v121, vcc
    ds_read_b128 v[36:39], v7 offset:0
    ds_read_b128 v[0:3], v7 offset:1024
    ds_read_b128 v[28:31], v7 offset:2048
    ds_read_b128 v[108:111], v7 offset:3072
    ds_read_b128 v[80:83], v7 offset:4096
    s_waitcnt lgkmcnt(5)
    s_barrier
    s_waitcnt lgkmcnt(4)
    buffer_store_dwordx4 v[36:39], v128, s[28:31], s59 offen sc1
    ds_read_b128 v[32:35], v129 offset:2048
    ds_read_b128 v[16:19], v129 offset:3072
    ds_read_b128 v[104:107], v137 offset:1536
    ds_read_b128 v[100:103], v136 offset:1536
    ds_read_b128 v[92:95], v137 offset:1664
    ds_read_b128 v[84:87], v136 offset:1664
    ds_read_b128 v[76:79], v137 offset:1792
    s_waitcnt lgkmcnt(9)
    buffer_store_dwordx4 v[0:3], v127, s[28:31], s59 offen sc1
    ds_read_b128 v[36:39], v136 offset:1792
    s_waitcnt lgkmcnt(7)
    v_mfma_f32_16x16x32_bf16 v[0:3], v[216:219], v[32:35], 0
    s_waitcnt lgkmcnt(6)
    v_mfma_f32_16x16x32_bf16 v[0:3], v[216:219], v[16:19], v[0:3]
    s_waitcnt lgkmcnt(5)
    v_mfma_f32_16x16x32_bf16 v[16:19], a[216:219], v[104:107], 0
    s_waitcnt lgkmcnt(4)
    v_mfma_f32_16x16x32_bf16 v[16:19], a[220:223], v[100:103], v[16:19]
    s_waitcnt lgkmcnt(3)
    ds_read_b128 v[64:67], v137 offset:0
    ds_read_b128 v[60:63], v136 offset:0
    v_mfma_f32_16x16x32_bf16 v[16:19], a[224:227], v[92:95], v[16:19]
    s_waitcnt lgkmcnt(4)
    ds_read_b128 v[56:59], v137 offset:128
    v_mfma_f32_16x16x32_bf16 v[16:19], a[228:231], v[84:87], v[16:19]
    s_waitcnt lgkmcnt(4)
    buffer_store_dwordx4 v[28:31], v126, s[28:31], s59 offen sc1
    ds_read_b128 v[52:55], v136 offset:128
    v_rsq_f32 v0, v0
    v_mfma_f32_16x16x32_bf16 v[16:19], a[232:235], v[76:79], v[16:19]
    s_waitcnt lgkmcnt(4)
    ds_read_b128 v[48:51], v137 offset:256
    ds_read_b128 v[32:35], v136 offset:256
    v_mfma_f32_16x16x32_bf16 v[16:19], a[236:239], v[36:39], v[16:19]
    v_rsq_f32 v1, v1
    v_mfma_f32_16x16x32_bf16 v[28:31], a[240:243], v[104:107], 0
    v_mul_f32 v0, s43, v0
    v_mul_f32 v1, s43, v1
    v_mfma_f32_16x16x32_bf16 v[28:31], a[244:247], v[100:103], v[28:31]
    v_rsq_f32 v2, v2
    v_mfma_f32_16x16x32_bf16 v[28:31], a[248:251], v[92:95], v[28:31]
    v_mul_f32 v2, s43, v2
    v_mul_f32 v20, v20, v2
    v_mfma_f32_16x16x32_bf16 v[28:31], a[252:255], v[84:87], v[28:31]
    buffer_store_dwordx4 v[108:111], v125, s[28:31], s59 offen sc1
    v_mul_f32 v21, v21, v2
    v_cvt_pk_bf16_f32 v88, v20, v21
    v_mul_f32 v22, v22, v2
    v_mul_f32 v23, v23, v2
    v_mfma_f32_16x16x32_bf16 v[28:31], v[224:227], v[76:79], v[28:31]
    v_cvt_pk_bf16_f32 v89, v22, v23
    v_mul_f32 v96, v96, v2
    v_mfma_f32_16x16x32_bf16 v[28:31], v[228:231], v[36:39], v[28:31]
    v_mul_f32 v97, v97, v2
    v_cvt_pk_bf16_f32 v90, v96, v97
    v_mfma_f32_16x16x32_bf16 v[20:23], v[232:235], v[104:107], 0
    v_mul_f32 v98, v98, v2
    v_mul_f32 v99, v99, v2
    v_mfma_f32_16x16x32_bf16 v[20:23], v[236:239], v[100:103], v[20:23]
    v_cvt_pk_bf16_f32 v91, v98, v99
    v_mul_f32 v72, v72, v2
    v_mfma_f32_16x16x32_bf16 v[20:23], v[240:243], v[92:95], v[20:23]
    ds_write_b128 v135, v[88:91] offset:3072
    v_mfma_f32_16x16x32_bf16 v[20:23], v[244:247], v[84:87], v[20:23]
    buffer_store_dwordx4 v[80:83], v124, s[28:31], s59 offen sc1
    v_mul_f32 v73, v73, v2
    v_cvt_pk_bf16_f32 v136, v72, v73
    v_mul_f32 v74, v74, v2
    v_mul_f32 v75, v75, v2
    v_mfma_f32_16x16x32_bf16 v[20:23], v[248:251], v[76:79], v[20:23]
    v_cvt_pk_bf16_f32 v137, v74, v75
    v_mul_f32 v68, v68, v0
    v_mfma_f32_16x16x32_bf16 v[20:23], v[252:255], v[36:39], v[20:23]
    s_waitcnt lgkmcnt(1)
    ds_write_b64 v134, v[136:137] offset:3072
    v_mfma_f32_16x16x32_bf16 v[36:39], a[216:219], v[64:67], 0
    v_mul_f32 v69, v69, v0
    v_cvt_pk_bf16_f32 v68, v68, v69
    v_mfma_f32_16x16x32_bf16 v[36:39], a[220:223], v[60:63], v[36:39]
    v_mul_f32 v70, v70, v0
    v_mul_f32 v71, v71, v0
    v_mfma_f32_16x16x32_bf16 v[36:39], a[224:227], v[56:59], v[36:39]
    v_cvt_pk_bf16_f32 v69, v70, v71
    v_mul_f32 v44, v44, v0
    v_mfma_f32_16x16x32_bf16 v[36:39], a[228:231], v[52:55], v[36:39]
    v_mul_f32 v45, v45, v0
    v_cvt_pk_bf16_f32 v70, v44, v45
    v_mfma_f32_16x16x32_bf16 v[36:39], a[232:235], v[48:51], v[36:39]
    v_mul_f32 v46, v46, v0
    v_mul_f32 v47, v47, v0
    v_mfma_f32_16x16x32_bf16 v[36:39], a[236:239], v[32:35], v[36:39]
    v_cvt_pk_bf16_f32 v71, v46, v47
    v_mul_f32 v40, v40, v0
    v_mfma_f32_16x16x32_bf16 v[44:47], a[240:243], v[64:67], 0
    ds_write_b128 v135, v[68:71] offset:0
    v_mfma_f32_16x16x32_bf16 v[44:47], a[244:247], v[60:63], v[44:47]
    v_mul_f32 v41, v41, v0
    v_cvt_pk_bf16_f32 v2, v40, v41
    v_mfma_f32_16x16x32_bf16 v[44:47], a[248:251], v[56:59], v[44:47]
    v_mul_f32 v42, v42, v0
    v_mul_f32 v43, v43, v0
    v_mfma_f32_16x16x32_bf16 v[44:47], a[252:255], v[52:55], v[44:47]
    v_cvt_pk_bf16_f32 v3, v42, v43
    v_fma_f32 v7, v16, v16, s42
    v_mfma_f32_16x16x32_bf16 v[44:47], v[224:227], v[48:51], v[44:47]
    ds_write_b64 v134, v[2:3] offset:0
    v_mfma_f32_16x16x32_bf16 v[44:47], v[228:231], v[32:35], v[44:47]
    v_fmac_f32 v7, v17, v17
    v_fmac_f32 v7, v18, v18
    v_mfma_f32_16x16x32_bf16 v[40:43], v[232:235], v[64:67], 0
    v_fmac_f32 v7, v19, v19
    v_fmac_f32 v7, v28, v28
    v_mfma_f32_16x16x32_bf16 v[40:43], v[236:239], v[60:63], v[40:43]
    v_fmac_f32 v7, v29, v29
    v_fmac_f32 v7, v30, v30
    v_mfma_f32_16x16x32_bf16 v[40:43], v[240:243], v[56:59], v[40:43]
    v_fmac_f32 v7, v31, v31
    v_fmac_f32 v7, v20, v20
    v_mfma_f32_16x16x32_bf16 v[40:43], v[244:247], v[52:55], v[40:43]
    v_fmac_f32 v7, v21, v21
    v_fmac_f32 v7, v22, v22
    v_mfma_f32_16x16x32_bf16 v[40:43], v[248:251], v[48:51], v[40:43]
    v_fmac_f32 v7, v23, v23
    v_fma_f32 v133, v36, v36, s42
    v_mfma_f32_16x16x32_bf16 v[40:43], v[252:255], v[32:35], v[40:43]
    s_nop 0
    v_fmac_f32 v133, v37, v37
    v_fmac_f32 v133, v38, v38
    v_fmac_f32 v133, v39, v39
    v_fmac_f32 v133, v44, v44
    v_fmac_f32 v133, v45, v45
    v_fmac_f32 v133, v46, v46
    v_fmac_f32 v133, v47, v47
    v_fmac_f32 v133, v40, v40
    v_fmac_f32 v133, v41, v41
    v_fmac_f32 v133, v42, v42
    v_fmac_f32 v133, v43, v43
    v_cvt_pk_bf16_f32 v120, v133, v7
    ds_write_b64 v130, v[120:121] offset:4096
    v_mul_f32 v8, v8, v1
    v_mul_f32 v9, v9, v1
    v_cvt_pk_bf16_f32 v8, v8, v9
    v_mul_f32 v10, v10, v1
    v_mul_f32 v11, v11, v1
    v_cvt_pk_bf16_f32 v9, v10, v11
    v_mul_f32 v24, v24, v1
    v_mul_f32 v25, v25, v1
    v_cvt_pk_bf16_f32 v10, v24, v25
    v_mul_f32 v26, v26, v1
    v_mul_f32 v27, v27, v1
    v_cvt_pk_bf16_f32 v11, v26, v27
    v_mul_f32 v12, v12, v1
    v_mul_f32 v13, v13, v1
    v_cvt_pk_bf16_f32 v136, v12, v13
    v_mul_f32 v14, v14, v1
    v_mul_f32 v15, v15, v1
    v_cvt_pk_bf16_f32 v137, v14, v15
    ds_write_b128 v135, v[8:11] offset:1536
    s_waitcnt lgkmcnt(1)
    s_barrier
    ds_write_b64 v134, v[136:137] offset:1536
    ds_read_b128 v[8:11], v129 offset:4096
    ds_read_b128 v[0:3], v129 offset:5120
    s_waitcnt lgkmcnt(2)
    s_barrier
    s_waitcnt lgkmcnt(1)
    v_mfma_f32_16x16x32_bf16 v[24:27], v[216:219], v[8:11], 0
    s_waitcnt lgkmcnt(0)
    ds_read_b128 v[48:51], v139 offset:0
    ds_read_b128 v[32:35], v139 offset:1024
    v_mfma_f32_16x16x32_bf16 v[24:27], v[216:219], v[0:3], v[24:27]
    s_nop 0
    ds_read_b128 v[12:15], v139 offset:2048
    s_nop 2
    ds_read_b128 v[8:11], v139 offset:3072
    s_nop 1
    v_rsq_f32 v24, v24
    ds_read_b128 v[0:3], v139 offset:4096
    v_mul_f32 v24, s43, v24
    v_mul_f32 v36, v36, v24
    v_mul_f32 v37, v37, v24
    v_cvt_pk_bf16_f32 v36, v36, v37
    v_mul_f32 v38, v38, v24
    v_mul_f32 v39, v39, v24
    v_cvt_pk_bf16_f32 v37, v38, v39
    v_mul_f32 v44, v44, v24
    v_mul_f32 v45, v45, v24
    s_waitcnt lgkmcnt(4)
    buffer_store_dwordx4 v[48:51], v128, s[28:31], s58 offen sc1
    v_cvt_pk_bf16_f32 v38, v44, v45
    v_mul_f32 v46, v46, v24
    v_mul_f32 v47, v47, v24
    v_cvt_pk_bf16_f32 v39, v46, v47
    v_mul_f32 v40, v40, v24
    v_mul_f32 v41, v41, v24
    v_cvt_pk_bf16_f32 v128, v40, v41
    v_mul_f32 v42, v42, v24
    v_mul_f32 v43, v43, v24
    v_cvt_pk_bf16_f32 v129, v42, v43
    ds_write_b128 v138, v[36:39] offset:0
    v_rsq_f32 v25, v25
    v_cmp_neq_f32 vcc, 0, v26
    v_mul_f32 v25, s43, v25
    s_waitcnt lgkmcnt(1)
    buffer_store_dwordx4 v[32:35], v127, s[28:31], s58 offen sc1
    ds_write_b64 v132, v[128:129] offset:0
    v_mul_f32 v16, v16, v25
    v_mul_f32 v17, v17, v25
    v_cvt_pk_bf16_f32 v16, v16, v17
    v_mul_f32 v18, v18, v25
    v_mul_f32 v19, v19, v25
    v_cvt_pk_bf16_f32 v17, v18, v19
    v_mul_f32 v28, v28, v25
    v_mul_f32 v29, v29, v25
    v_cvt_pk_bf16_f32 v18, v28, v29
    v_mul_f32 v30, v30, v25
    v_mul_f32 v31, v31, v25
    v_cvt_pk_bf16_f32 v19, v30, v31
    v_mul_f32 v20, v20, v25
    v_mul_f32 v21, v21, v25
    v_cvt_pk_bf16_f32 v128, v20, v21
    v_mul_f32 v22, v22, v25
    v_mul_f32 v23, v23, v25
    v_cvt_pk_bf16_f32 v129, v22, v23
    buffer_store_dwordx4 v[12:15], v126, s[28:31], s58 offen sc1
    ds_write_b128 v138, v[16:19] offset:1536
    ds_write_b64 v132, v[128:129] offset:1536
    buffer_store_dwordx4 v[8:11], v125, s[28:31], s58 offen sc1
    s_waitcnt lgkmcnt(0)
    s_barrier
    buffer_store_dwordx4 v[0:3], v124, s[28:31], s58 offen sc1
    ds_read_b128 v[12:15], v131 offset:0
    ds_read_b128 v[8:11], v131 offset:1024
    ds_read_b128 v[0:3], v131 offset:2048
    s_waitcnt lgkmcnt(2)
    buffer_store_dwordx4 v[12:15], v4, s[28:31], 0 offen sc1
    s_waitcnt lgkmcnt(0)
    buffer_store_dwordx4 v[8:11], v5, s[28:31], 0 offen sc1
    buffer_store_dwordx4 v[0:3], v6, s[28:31], 0 offen sc1
    s_nop 4
    s_cbranch_vccnz L_slow
L_fin:
    s_cmp_eq_u32 s2, 251
    s_cbranch_scc1 L_again
L_end:
    s_endpgm
L_slow:
    s_waitcnt vmcnt(0) lgkmcnt(0)
    s_nop 15
    s_barrier
    s_lshr_b32 s66, s64, 20
    v_mbcnt_lo_u32_b32 v157, -1, 0
    v_mbcnt_hi_u32_b32 v157, -1, v157
    s_load_dwordx16 s[4:19], s[0:1], 0
    s_load_dwordx4 s[20:23], s[0:1], 64
    s_load_dwordx2 s[38:39], s[0:1], 80
    s_bfe_u32 s88, s2, 0x50003
    s_lshl2_add_u32 s88, s88, s68
    v_lshlrev_b32 v72, 7, v157
    s_mul_i32 s89, s88, 576
    s_mul_i32 s88, s88, 1728
    v_min_u32 v74, 1664, v72
    v_min_u32 v73, 512, v72
    s_mov_b32 s34, 221184
    s_mov_b32 s35, 0x20000
    s_mov_b32 s78, 73728
    s_mov_b32 s79, 0x20000
    v_and_b32 v75, 15, v157
    v_lshrrev_b32 v160, 4, v157
    v_lshrrev_b32 v72, 2, v75
    v_and_b32 v5, 3, v75
    s_mul_i32 s87, s68, 192
    v_mad_u32_u24 v19, v75, 12, s87
    v_lshlrev_b32 v31, 1, v75
    v_lshlrev_b32 v11, 1, v72
    v_lshl_add_u32 v11, v160, 5, v11
    s_movk_i32 s86, 384
    s_mov_b32 s26, 100270464
    s_mov_b32 s27, 0x20000
    s_mov_b32 s30, 0
    s_mov_b32 s31, 0x20000
    s_mul_i32 s96, s68, 288
    s_and_b32 s97, s68, 1
    s_lshl_b32 s97, s97, 2
    s_mov_b32 s98, 193536
    s_waitcnt lgkmcnt(0)
    s_mov_b32 s24, s4
    s_mov_b32 s25, s5
    s_mov_b32 s32, s6
    s_mov_b32 s33, s7
    s_mov_b32 s76, s8
    s_mov_b32 s77, s9
    buffer_load_dword a254, v74, s[32:35], s88 offen
    buffer_load_dword a253, v73, s[76:79], s89 offen
    s_load_dwordx2 s[82:83], s[10:11], 0
    s_movk_i32 s18, 676
    s_mov_b32 s19, 0x20000
    buffer_load_dwordx3 v[28:30], v19, s[16:19], 0 offen
    s_mov_b32 s99, 589824
    v_add_u32 v124, s96, v157
    v_mul_u32_u24 v74, 2731, v124
    v_mul_u32_u24 v73, 6242, v124
    v_lshrrev_b32 v74, 16, v74
    s_lshr_b32 s94, s2, 3
    s_mul_i32 s70, s94, 167
    global_load_ushort v16, v31, s[12:13]
    v_lshrrev_b32 v73, 20, v73
    v_and_or_b32 v8, v74, 3, s97
    v_xor_b32 v8, v124, v8
    v_lshl_add_u32 v128, v8, 4, s99
    v_mad_u32_u24 v128, v73, s98, v128
    s_min_u32 s95, s94, 7
    s_add_u32 s70, s70, s95
    global_load_ushort v17, v31, s[12:13] offset:32
    v_add_u32 v10, 64, v124
    v_mul_u32_u24 v150, 2731, v10
    v_mul_u32_u24 v156, 6242, v10
    v_lshrrev_b32 v150, 16, v150
    v_lshrrev_b32 v156, 20, v156
    s_and_b32 s95, s2, 7
    s_mul_i32 s95, s95, 20
    global_load_ushort v148, v11, s[14:15] offset:0
    v_and_or_b32 v9, v150, 3, s97
    v_xor_b32 v9, v10, v9
    v_lshl_add_u32 v127, v9, 4, s99
    v_mad_u32_u24 v127, v156, s98, v127
    v_add_u32 v18, 128, v124
    s_add_u32 s69, s70, s95
    s_add_u32 s70, s70, 140
    global_load_ushort v158, v11, s[14:15] offset:8
    v_mul_u32_u24 v10, 2731, v18
    v_mul_u32_u24 v4, 6242, v18
    v_lshrrev_b32 v10, 16, v10
    v_lshrrev_b32 v4, 20, v4
    v_and_or_b32 v31, v10, 3, s97
    s_movk_i32 s62, 2688
    s_movk_i32 s71, 20
    global_load_ushort v149, v11, s[14:15] offset:16
    v_xor_b32 v31, v18, v31
    v_lshl_add_u32 v126, v31, 4, s99
    v_mad_u32_u24 v126, v4, s98, v126
    v_add_u32 v125, 192, v124
    v_mul_u32_u24 v159, 2731, v125
    s_cmp_lt_u32 s94, 7
    s_cselect_b32 s73, 28, 27
    global_load_ushort v132, v11, s[14:15] offset:24
    v_mul_u32_u24 v18, 6242, v125
    v_lshrrev_b32 v159, 16, v159
    v_lshrrev_b32 v18, 20, v18
    v_and_or_b32 v11, v159, 3, s97
    v_xor_b32 v11, v125, v11
    v_lshl_add_u32 v125, v11, 4, s99
    v_mad_u32_u24 v125, v18, s98, v125
    v_add_u32 v6, 256, v124
    v_mul_u32_u24 v151, 2731, v6
    v_mul_u32_u24 v11, 6242, v6
    v_lshrrev_b32 v151, 16, v151
    v_lshrrev_b32 v11, 20, v11
    v_and_or_b32 v124, v151, 3, s97
    v_xor_b32 v124, v6, v124
    v_lshl_add_u32 v124, v124, 4, s99
    v_mad_u32_u24 v124, v11, s98, v124
    s_mov_b32 s93, 1769472
    s_mul_i32 s54, s68, 5120
    s_cmp_ge_u32 s2, 248
    s_cbranch_scc1 L_bndS
L_bndrS:
    s_mov_b32 s63, 1180032
    s_mul_i32 s94, s69, 58255
    s_lshr_b32 s94, s94, 22
    s_mul_i32 s94, s94, s63
    s_mul_i32 s72, s69, s62
    s_add_u32 s72, s72, s94
    v_lshl_or_b32 v73, v157, 4, 2.0
    s_sub_u32 s94, s73, 1
    s_max_u32 s94, s94, 20
    s_mul_i32 s95, s68, -44
    s_movk_i32 s99, -24
    s_add_u32 m0, s54, 0
    v_and_b32 v18, -4, v10
    s_mul_i32 s85, s68, 96
    s_sub_u32 s100, s85, 1024
    buffer_load_dwordx4 v128, s[24:27], s72 offen nt lds
    s_add_u32 m0, s54, 1024
    v_mad_u32_u24 v11, v18, 3, v10
    v_add_u32 v11, s95, v11
    v_mad_i32_i24 v10, v10, s99, v31
    v_med3_u32 v18, v11, 20, s94
    v_add_u32 v18, s70, v18
    v_add_u32 v31, s69, v11
    s_sub_u32 s87, s85, 2048
    s_movk_i32 s91, 1152
    buffer_load_dwordx4 v127, s[24:27], s72 offen nt lds
    v_cmp_gt_u32 vcc, s71, v11
    v_lshl_add_u32 v10, v10, 4, s93
    s_add_u32 m0, s54, 43008
    v_cndmask_b32 v31, v18, v31, vcc
    v_mul_u32_u24 v18, 58255, v31
    v_mad_u32_u24 v10, v31, s62, v10
    v_lshrrev_b32 v18, 22, v18
    v_mad_u32_u24 v10, v18, s63, v10
    s_mul_i32 s90, s68, 3072
    s_add_u32 s90, s90, 61440
    buffer_load_dwordx4 v10, s[24:27], 0 offen  lds
    v_lshlrev_b32 v11, 16, v11
    s_add_u32 m0, s54, 2048
    v_and_b32 v31, -4, v150
    v_mad_u32_u24 v18, v31, 3, v150
    v_add_u32 v18, s95, v18
    v_mad_i32_i24 v9, v150, s99, v9
    v_med3_u32 v31, v18, 20, s94
    s_mov_b32 s28, s22
    s_mov_b32 s29, s23
    buffer_load_dwordx4 v126, s[24:27], s72 offen nt lds
    v_add_u32 v31, s70, v31
    v_add_u32 v150, s69, v18
    v_cmp_gt_u32 vcc, s71, v18
    v_lshl_add_u32 v9, v9, 4, s93
    s_add_u32 m0, s54, 41984
    v_cndmask_b32 v150, v31, v150, vcc
    v_mul_u32_u24 v31, 58255, v150
    v_mad_u32_u24 v9, v150, s62, v9
    v_lshrrev_b32 v31, 22, v31
    v_mad_u32_u24 v9, v31, s63, v9
    s_mov_b32 s41, 0x2a8cbccc
    s_mov_b32 s42, 0x38fba882
    buffer_load_dwordx4 v9, s[24:27], 0 offen  lds
    v_lshl_or_b32 v11, v18, 8, v11
    s_add_u32 m0, s54, 3072
    v_cmp_gt_u32 vcc, 32, v157
    v_and_b32 v31, -4, v74
    v_mad_u32_u24 v18, v31, 3, v74
    v_cndmask_b32 v124, v73, v124, vcc
    v_add_u32 v18, s95, v18
    s_mov_b32 s43, 0x415db3d7
    s_mov_b32 s44, 61440
    buffer_load_dwordx4 v125, s[24:27], s72 offen nt lds
    s_add_u32 m0, s54, 4096
    v_mad_i32_i24 v8, v74, s99, v8
    v_med3_u32 v31, v18, 20, s94
    v_add_u32 v31, s70, v31
    v_add_u32 v74, s69, v18
    v_cmp_gt_u32 vcc, s71, v18
    v_lshl_add_u32 v8, v8, 4, s93
    s_mul_i32 s93, s68, 6
    s_lshl_b32 s94, s97, 1
    buffer_load_dwordx4 v124, s[24:27], s72 offen nt lds
    v_cndmask_b32 v74, v31, v74, vcc
    v_mul_u32_u24 v31, 58255, v74
    v_mad_u32_u24 v8, v74, s62, v8
    v_lshrrev_b32 v31, 22, v31
    v_mad_u32_u24 v8, v31, s63, v8
    s_add_u32 m0, s54, 40960
    v_lshl_or_b32 v11, v18, 0, v11
    s_mov_b32 s45, 40960
    s_mov_b32 s46, 20480
    buffer_load_dwordx4 v8, s[24:27], 0 offen nt lds
    v_mul_u32_u24 v6, 10923, v157
    v_lshrrev_b32 v4, 17, v6
    v_lshrrev_b32 v6, 16, v6
    v_mad_i32_i24 v7, v6, -6, v157
    v_bitop3_b32 v4, v4, v6, 4 bitop3:0x28
    v_lshl_add_u32 v7, v7, 4, s85
    v_mul_u32_u24 v4, 3, v4
    v_xor_b32 v6, v6, v4
    v_mad_u32_u24 v4, v6, s91, v7
    v_add_u32 v18, 64, v157
    v_mul_u32_u24 v31, 10923, v18
    v_lshrrev_b32 v156, 17, v31
    v_lshrrev_b32 v31, 16, v31
    v_mad_i32_i24 v159, v31, -6, v18
    v_bitop3_b32 v156, v156, v31, 4 bitop3:0x28
    v_lshl_add_u32 v159, v159, 4, s100
    v_mul_u32_u24 v156, 3, v156
    v_xor_b32 v31, v31, v156
    v_mad_u32_u24 v156, v31, s91, v159
    v_add_u32 v18, 128, v157
    v_mul_u32_u24 v74, 10923, v18
    v_lshrrev_b32 v120, 17, v74
    v_lshrrev_b32 v74, 16, v74
    v_mad_i32_i24 v18, v74, -6, v18
    v_bitop3_b32 v120, v120, v74, 4 bitop3:0x28
    v_lshl_add_u32 v18, v18, 4, s87
    v_mul_u32_u24 v120, 3, v120
    v_xor_b32 v74, v74, v120
    v_mad_u32_u24 v120, v74, s91, v18
    v_mad_u32_u24 v121, v6, s86, v7
    v_mad_u32_u24 v25, v31, s86, v159
    v_mad_u32_u24 v24, v74, s86, v18
    s_add_u32 m0, s90, 0
    s_mov_b32 s92, 0
    buffer_load_dwordx4 v4, s[32:35], s92 offen offset:0 lds
    v_mov_b32 v18, 0x3f803f80
    v_cmp_eq_u32 vcc, 0, v5
    v_and_b32 v31, 1, v157
    v_lshlrev_b32 v31, 4, v31
    v_cndmask_b32 v220, 0, v18, vcc
    v_cndmask_b32 v221, 0, v18, vcc
    v_cndmask_b32 v222, 0, v18, vcc
    v_cndmask_b32 v223, 0, v18, vcc
    v_mov_b32 v18, 0x3f80
    v_lshlrev_b32 v18, v31, v18
    v_cmp_gt_u32 vcc, 2, v5
    v_mov_b32 v171, 0
    v_mov_b32 v167, 0
    v_cndmask_b32 v216, 0, v18, vcc
    v_cndmask_b32 v218, 0, v18, vcc
    v_cmp_le_u32 vcc, 2, v5
    v_mov_b32 v163, 0
    v_mov_b32 v159, 0
    v_cndmask_b32 v217, 0, v18, vcc
    v_cndmask_b32 v219, 0, v18, vcc
    v_cmp_eq_u32 vcc, v160, v72
    v_mov_b32 v150, 0
    v_mov_b32 v151, 0
    v_cndmask_b32 v26, 0, v216, vcc
    v_cndmask_b32 v27, 0, v217, vcc
    v_mov_b32 v144, 0
    v_mov_b32 v145, 0
    v_mov_b32 v138, 0
    v_mov_b32 v139, 0
    v_lshrrev_b32 v6, 1, v160
    v_lshl_add_u32 v7, v160, 2, v72
    v_lshl_add_u32 v7, v6, 3, v7
    v_mul_u32_u24 v7, 96, v7
    v_add_u32 v7, s90, v7
    v_lshl_add_u32 v6, v5, 4, v7
    v_lshl_add_u32 v7, v5, 3, v7
    s_waitcnt lgkmcnt(0)
    s_lshl_b32 s84, s68, 4
    s_lshr_b64 s[82:83], s[82:83], s84
    s_lshl_b32 s82, s82, 16
    v_mov_b32 v74, s82
    v_min_f32 v74, 0x40930000, v74
    v_max_f32 v74, 0xc2c80000, v74
    v_mul_f32 v74, 0x3fb8aa3b, v74
    v_exp_f32 v74, v74
    v_mov_b32 v18, 0
    v_cvt_pk_bf16_f32 v74, v74, v74
    v_lshlrev_b32 v74, 16, v74
    v_mul_f32 v74, 0x4038aa3b, v74
    v_mov_b32 v31, 0
    v_readfirstlane_b32 s55, v74
    v_add_f32 v74, v74, v74
    v_mul_u32_u24 v122, 5120, v160
    v_readfirstlane_b32 s52, v74
    v_add_u32 v122, v19, v122
    s_mov_b32 s84, 0x41b8aa3b
    v_mov_b32 v131, 0xc138aa3b
    v_mul_u32_u24 v74, 5120, v72
    v_mad_u32_u24 v74, v5, s86, v74
    v_and_b32 v19, 7, v75
    s_mov_b32 s47, 0
    s_mov_b32 s57, s72
    buffer_load_dwordx4 v156, s[32:35], s92 offen offset:1024 lds
    v_xor_b32 v123, v19, v160
    v_lshl_add_u32 v147, v123, 4, v74
    v_xor_b32 v146, 64, v147
    v_add_u32 v137, 40960, v147
    v_xor_b32 v136, 64, v137
    v_add_u32 v74, 61440, v74
    v_add_u32 v123, s93, v160
    s_mov_b32 s58, 0
    s_mov_b32 s59, 0
    buffer_load_dwordx4 v120, s[32:35], s92 offen offset:2048 lds
    s_add_u32 m0, s90, 12288
    s_mov_b32 s92, 36864
    v_xor_b32 v123, v19, v123
    v_lshl_add_u32 v135, v123, 4, v74
    v_lshrrev_b32 v123, 1, v160
    v_add3_u32 v123, v123, s93, 4
    v_xor_b32 v123, v19, v123
    s_add_u32 s93, s54, 20480
    s_mov_b32 s60, 0
    buffer_load_dwordx4 v4, s[32:35], s92 offen offset:0 lds
    s_waitcnt vmcnt(16)
    v_lshl_or_b32 v16, v17, 16, v16
    v_cmp_gt_u32 vcc, 16, v157
    v_mov_b32 v17, 0
    v_lshl_add_u32 v123, v123, 4, v74
    v_cndmask_b32 v19, 0, v16, vcc
    v_cndmask_b32 v16, 0, v16, vcc
    v_and_b32 v74, 1, v160
    v_mfma_f32_16x16x16_bf16 v[0:3], v[18:19], v[28:29], 0
    s_waitcnt vmcnt(14)
    s_mov_b32 s65, -1
    v_lshl_or_b32 v148, v158, 16, v148
    v_lshl_add_u32 v134, v74, 3, v123
    v_mfma_f32_16x16x16_bf16 v[12:15], v[16:17], v[28:29], 0
    s_mov_b32 s61, 1
    v_lshlrev_b32 v74, 4, v157
    v_add_u32 v133, s93, v74
    v_mfma_f32_16x16x16_bf16 v[20:23], v[16:17], v[30:31], 0
    s_waitcnt vmcnt(12)
    s_lshr_b32 s93, s68, 1
    buffer_load_dwordx4 v156, s[32:35], s92 offen offset:1024 lds
    v_lshl_or_b32 v149, v132, 16, v149
    v_max_f32 v0, 0, v0
    v_max_f32 v12, 0, v12
    v_max_f32 v13, 0, v13
    v_max_f32 v14, 0, v14
    v_max_f32 v15, 0, v15
    v_cvt_pk_bf16_f32 v12, v12, v13
    v_cvt_pk_bf16_f32 v13, v14, v15
    v_max_f32 v1, 0, v1
    v_max_f32 v2, 0, v2
    v_mfma_f32_16x16x16_bf16 v[16:19], v[148:149], v[12:13], 0
    s_lshl_b32 s93, s93, 10
    v_max_f32 v3, 0, v3
    v_cvt_pk_bf16_f32 v0, v0, v1
    v_cvt_pk_bf16_f32 v1, v2, v3
    v_max_f32 v20, 0, v20
    v_max_f32 v21, 0, v21
    v_mfma_f32_16x16x16_bf16 v[12:15], v[148:149], v[0:1], 0
    s_add_u32 s93, s93, s94
    v_max_f32 v22, 0, v22
    v_max_f32 v23, 0, v23
    v_cvt_pk_bf16_f32 v20, v20, v21
    v_cvt_pk_bf16_f32 v21, v22, v23
    v_cvt_pk_bf16_f32 v16, v16, v16
    v_lshlrev_b32 v16, 16, v16
    v_mfma_f32_16x16x16_bf16 v[0:3], v[148:149], v[20:21], 0
    s_movk_i32 s4, 112
    v_mul_f32 v16, 0xbfb8aa3b, v16
    v_cvt_pk_bf16_f32 v12, v12, v12
    v_exp_f32 v16, v16
    v_lshlrev_b32 v12, 16, v12
    v_add_f32 v16, 1.0, v16
    v_rcp_f32 v16, v16
    v_mul_f32 v12, 0xbfb8aa3b, v12
    v_cvt_pk_bf16_f32 v16, v16, v16
    v_lshlrev_b32 v16, 16, v16
    v_fma_f32 v16, v16, s84, v131
    s_mov_b32 s5, 0
    s_mov_b32 s6, 0
    ds_write_b32 v122, v16 offset:44032
    v_exp_f32 v12, v12
    v_cvt_pk_bf16_f32 v0, v0, v0
    v_add_f32 v12, 1.0, v12
    v_rcp_f32 v12, v12
    v_lshlrev_b32 v0, 16, v0
    v_cvt_pk_bf16_f32 v12, v12, v12
    v_lshlrev_b32 v12, 16, v12
    v_fma_f32 v12, v12, s84, v131
    s_mov_b32 s12, 0
    s_mov_b32 s64, 3
    ds_write_b32 v122, v12 offset:44036
    v_mul_f32 v0, 0xbfb8aa3b, v0
    v_exp_f32 v0, v0
    v_add_u32 v129, 81920, v74
    v_add_f32 v0, 1.0, v0
    v_rcp_f32 v0, v0
    v_add_u32 v130, s93, v129
    v_cvt_pk_bf16_f32 v0, v0, v0
    v_lshlrev_b32 v0, 16, v0
    v_fma_f32 v0, v0, s84, v131
    s_mul_i32 s93, s68, 7168
    s_add_u32 s93, s93, 135168
    ds_write_b32 v122, v0 offset:44040
    v_mul_u32_u24 v74, 1792, v160
    v_add_u32 v123, s93, v74
    v_mul_u32_u24 v74, 112, v75
    v_add_u32 v158, v74, v123
    v_subrev_u32 v158, 28672, v158
    v_cmp_eq_u32 vcc, 0, v72
    v_add_u32 v74, 16, v123
    v_mov_b32 v122, 0
    v_cndmask_b32 v132, v73, v123, vcc
    v_cmp_eq_u32 vcc, 3, v5
    s_mov_b32 s10, 81924
    s_mov_b32 s11, 0x20000
    v_cndmask_b32 v132, v132, v74, vcc
    v_mul_u32_u24 v74, 1792, v72
    v_lshl_add_u32 v74, v160, 3, v74
    v_lshl_add_u32 v74, v5, 1, v74
    v_add_u32 v74, s93, v74
    v_cmp_gt_u32 vcc, 3, v160
    v_mov_b32 v123, v74
    s_add_u32 s93, s69, 1
    v_cndmask_b32 v131, v73, v74, vcc
    s_mul_i32 s94, s93, 58255
    s_lshr_b32 s94, s94, 22
    s_mul_i32 s94, s94, s63
    s_mul_i32 s56, s93, s62
    s_add_u32 s56, s56, s94
    s_sub_u32 s93, s71, 1
    s_cmp_eq_u32 s68, 0
    s_cselect_b32 s13, s93, -1
    s_cmp_gt_u32 s73, 20
    s_cselect_b32 s13, s13, -1
    s_and_b32 s93, s2, -8
    s_sub_u32 s93, 81920, s93
    s_waitcnt lgkmcnt(0)
    s_barrier
    s_sub_u32 s8, s38, s93
    s_subb_u32 s9, s39, 0
    s_mov_b32 s39, 0x00010001
    s_add_u32 s101, s54, 44032
    v_mul_u32_u24 v149, 48, v72
    v_lshl_add_u32 v149, v5, 2, v149
    v_mul_u32_u24 v5, 48, v160
    v_add_u32 v199, 0, v149
    v_mul_u32_u24 v148, 37, v199
    v_lshrrev_b32 v148, 10, v148
    v_mad_u32_u24 v199, v148, 24, v199
    v_add_u32 v199, s101, v199
    v_add_u32 v161, 16, v149
    v_mul_u32_u24 v148, 37, v161
    v_lshrrev_b32 v148, 10, v148
    v_mad_u32_u24 v161, v148, 24, v161
    v_add_u32 v161, s101, v161
    v_add_u32 v148, 32, v149
    v_mul_u32_u24 v162, 37, v148
    v_lshrrev_b32 v162, 10, v162
    v_mad_u32_u24 v148, v162, 24, v148
    v_add_u32 v148, s101, v148
    v_add_u32 v176, 0, v5
    v_mul_u32_u24 v162, 37, v176
    v_lshrrev_b32 v162, 10, v162
    v_mad_u32_u24 v176, v162, 24, v176
    v_add_u32 v169, 4, v5
    v_mul_u32_u24 v162, 37, v169
    v_lshrrev_b32 v162, 10, v162
    v_mad_u32_u24 v169, v162, 24, v169
    v_add_u32 v170, 8, v5
    v_mul_u32_u24 v162, 37, v170
    v_lshrrev_b32 v162, 10, v162
    v_mad_u32_u24 v170, v162, 24, v170
    v_add_u32 v183, 12, v5
    v_mul_u32_u24 v162, 37, v183
    v_lshrrev_b32 v162, 10, v162
    v_mad_u32_u24 v183, v162, 24, v183
    v_add_u32 v168, 16, v5
    v_mul_u32_u24 v162, 37, v168
    v_lshrrev_b32 v162, 10, v162
    v_mad_u32_u24 v168, v162, 24, v168
    v_add_u32 v165, 20, v5
    v_mul_u32_u24 v162, 37, v165
    v_lshrrev_b32 v162, 10, v162
    v_mad_u32_u24 v165, v162, 24, v165
    v_add_u32 v166, 24, v5
    v_mul_u32_u24 v162, 37, v166
    v_lshrrev_b32 v162, 10, v162
    v_mad_u32_u24 v166, v162, 24, v166
    v_add_u32 v179, 28, v5
    v_mul_u32_u24 v162, 37, v179
    v_lshrrev_b32 v162, 10, v162
    v_mad_u32_u24 v179, v162, 24, v179
    v_add_u32 v164, 32, v5
    v_mul_u32_u24 v162, 37, v164
    v_lshrrev_b32 v162, 10, v162
    v_mad_u32_u24 v164, v162, 24, v164
    v_add_u32 v74, 36, v5
    v_mul_u32_u24 v72, 37, v74
    v_lshrrev_b32 v72, 10, v72
    v_mad_u32_u24 v74, v72, 24, v74
    v_add_u32 v162, 40, v5
    v_mul_u32_u24 v72, 37, v162
    v_lshrrev_b32 v72, 10, v72
    s_lshr_b32 s93, s68, 1
    s_mul_i32 s93, s93, 30720
    buffer_load_dwordx4 v120, s[32:35], s92 offen offset:2048 lds
    s_add_u32 m0, s90, 24576
    s_mov_b32 s92, 73728
    ds_read_b32 v208, v199
    v_mad_u32_u24 v162, v72, 24, v162
    v_add_u32 v5, 44, v5
    v_mul_u32_u24 v72, 37, v5
    v_lshrrev_b32 v72, 10, v72
    v_mad_u32_u24 v5, v72, 24, v5
    v_lshl_add_u32 v72, v160, 4, v149
    v_mul_u32_u24 v177, 37, v72
    v_lshrrev_b32 v177, 10, v177
    v_mad_u32_u24 v72, v177, 24, v72
    v_mov_b32 v177, 336
    v_cmp_gt_u32 vcc, 3, v160
    v_sub_u32 v204, v199, v176
    s_and_b32 s94, s68, 1
    v_cndmask_b32 v72, v177, v72, vcc
    v_sub_u32 v72, s101, v72
    s_mul_i32 s94, s94, -2304
    s_add_u32 s93, s93, s94
    ds_read_b32 v204, v204 offset:336
    buffer_load_dwordx4 v4, s[32:35], s92 offen offset:0 lds
    v_sub_u32 v205, v199, v169
    v_sub_u32 v206, v199, v170
    v_sub_u32 v207, v199, v183
    v_sub_u32 v200, v199, v168
    s_lshl_b32 s94, s97, 4
    ds_read_b32 v205, v205 offset:336
    v_sub_u32 v201, v199, v165
    v_sub_u32 v202, v199, v166
    v_sub_u32 v203, v199, v179
    v_sub_u32 v196, v199, v164
    buffer_load_dwordx4 v156, s[32:35], s92 offen offset:1024 lds
    ds_read_b32 v206, v206 offset:336
    v_sub_u32 v197, v199, v74
    v_sub_u32 v198, v199, v162
    v_sub_u32 v199, v199, v5
    v_sub_u32 v192, v161, v176
    v_sub_u32 v193, v161, v169
    ds_read_b32 v207, v207 offset:336
    v_sub_u32 v194, v161, v170
    v_sub_u32 v195, v161, v183
    v_sub_u32 v188, v161, v168
    v_sub_u32 v189, v161, v165
    v_sub_u32 v190, v161, v166
    ds_read_b32 v200, v200 offset:336
    v_sub_u32 v191, v161, v179
    v_sub_u32 v184, v161, v164
    v_sub_u32 v185, v161, v74
    v_sub_u32 v186, v161, v162
    buffer_load_dwordx4 v120, s[32:35], s92 offen offset:2048 lds
    s_add_u32 m0, s90, 36864
    s_mov_b32 s92, 110592
    ds_read_b32 v201, v201 offset:336
    v_sub_u32 v187, v161, v5
    v_sub_u32 v180, v148, v176
    v_sub_u32 v181, v148, v169
    v_sub_u32 v182, v148, v170
    v_sub_u32 v183, v148, v183
    s_waitcnt vmcnt(9)
    s_barrier
    ds_read_b32 v202, v202 offset:336
    v_sub_u32 v176, v148, v168
    v_sub_u32 v177, v148, v165
    v_sub_u32 v178, v148, v166
    v_sub_u32 v179, v148, v179
    v_sub_u32 v172, v148, v164
    ds_read_b32 v203, v203 offset:336
    v_sub_u32 v173, v148, v74
    v_sub_u32 v174, v148, v162
    v_sub_u32 v175, v148, v5
    v_mov_b32 v5, 0xf149f2ca
    v_and_b32 v74, 8, v75
    ds_read_b32 v196, v196 offset:336
    v_add_u32 v74, v74, v75
    v_mul_u32_u24 v74, 96, v74
    buffer_load_dwordx4 v4, s[32:35], s92 offen offset:0 lds
    ds_read_b32 v197, v197 offset:336
    v_add_u32 v74, s90, v74
    v_lshl_add_u32 v19, v160, 4, v74
    v_lshl_add_u32 v18, v160, 3, v74
    v_add_u32 v17, s93, v19
    v_add_u32 v16, s93, v18
    s_lshr_b32 s93, s68, 1
    s_mul_i32 s93, s93, 5120
    ds_read_b32 v198, v198 offset:336
    v_lshlrev_b32 v162, 4, v160
    v_add_u32 v162, 4608, v162
    s_add_u32 s93, s93, s94
    v_add_u32 v74, s93, v162
    v_cmp_eq_u32 vcc, 0, v75
    ds_read_b32 v199, v199 offset:336
    buffer_load_dwordx4 v156, s[32:35], s92 offen offset:1024 lds
    v_cndmask_b32 v74, v73, v74, vcc
    ds_read_b32 v211, v72 offset:672
    ds_read_b32 v192, v192 offset:336
    ds_read_b32 v193, v193 offset:336
    buffer_load_dwordx4 v120, s[32:35], s92 offen offset:2048 lds
    s_add_u32 m0, s90, 49152
    s_mov_b32 s92, 147456
    ds_read_b32 v194, v194 offset:336
    ds_read_b32 v195, v195 offset:336
    ds_read_b32 v188, v188 offset:336
    buffer_load_dwordx4 v4, s[32:35], s92 offen offset:0 lds
    ds_read_b32 v189, v189 offset:336
    ds_read_b32 v190, v190 offset:336
    ds_read_b32 v191, v191 offset:336
    ds_read_b32 v184, v184 offset:336
    buffer_load_dwordx4 v156, s[32:35], s92 offen offset:1024 lds
    ds_read_b32 v185, v185 offset:336
    ds_read_b32 v186, v186 offset:336
    ds_read_b32 v187, v187 offset:336
    buffer_load_dwordx4 v120, s[32:35], s92 offen offset:2048 lds
    s_add_u32 m0, s90, 61440
    s_mov_b32 s92, 184320
    ds_read_b32 v209, v161
    ds_read_b32 v180, v180 offset:336
    ds_read_b32 v181, v181 offset:336
    buffer_load_dwordx4 v4, s[32:35], s92 offen offset:0 lds
    ds_read_b32 v182, v182 offset:336
    ds_read_b32 v183, v183 offset:336
    ds_read_b32 v176, v176 offset:336
    ds_read_b32 v177, v177 offset:336
    buffer_load_dwordx4 v156, s[32:35], s92 offen offset:1024 lds
    ds_read_b32 v178, v178 offset:336
    ds_read_b32 v179, v179 offset:336
    ds_read_b32 v172, v172 offset:336
    buffer_load_dwordx4 v120, s[32:35], s92 offen offset:2048 lds
    ds_read_b32 v173, v173 offset:336
    ds_read_b32 v174, v174 offset:336
    ds_read_b32 v175, v175 offset:336
    ds_read_b32 v210, v148
    s_waitcnt vmcnt(15)
    ds_read_b64_tr_b16 a[0:1], v7 offset:0
    ds_read_b64_tr_b16 a[2:3], v7 offset:768
    ds_read_b64_tr_b16 a[24:25], v7 offset:32
    ds_read_b64_tr_b16 a[26:27], v7 offset:800
    ds_read_b64_tr_b16 a[48:49], v7 offset:64
    ds_read_b64_tr_b16 a[50:51], v7 offset:832
    s_add_u32 m0, s90, 0
    s_mov_b32 s92, 384
    s_waitcnt vmcnt(12)
    ds_read_b64_tr_b16 a[4:5], v7 offset:12288
    ds_read_b64_tr_b16 a[6:7], v7 offset:13056
    ds_read_b64_tr_b16 a[28:29], v7 offset:12320
    ds_read_b64_tr_b16 a[30:31], v7 offset:13088
    ds_read_b64_tr_b16 a[52:53], v7 offset:12352
    ds_read_b64_tr_b16 a[54:55], v7 offset:13120
    s_waitcnt vmcnt(9)
    ds_read_b64_tr_b16 a[8:9], v7 offset:24576
    ds_read_b64_tr_b16 a[10:11], v7 offset:25344
    ds_read_b64_tr_b16 a[32:33], v7 offset:24608
    s_waitcnt lgkmcnt(15)
    s_cmp_ge_u32 s2, 248
    s_cbranch_scc1 L_maskS
L_nomaskS:
    v_cmp_gt_u32 vcc, 16, v157
    v_readlane_b32 s84, v211, 48
    ds_read_b64_tr_b16 a[34:35], v7 offset:25376
    v_cndmask_b32 v208, v5, v208, vcc
    v_cndmask_b32 v209, v5, v209, vcc
    v_cndmask_b32 v210, v5, v210, vcc
    v_cmp_gt_u32 vcc, 49, v157
    ds_read_b64_tr_b16 a[56:57], v7 offset:24640
    s_waitcnt lgkmcnt(10)
    buffer_load_dwordx4 v4, s[32:35], s92 offen offset:0 lds
    ds_read_b64_tr_b16 a[58:59], v7 offset:25408
    v_cndmask_b32 v211, v5, v211, vcc
    s_waitcnt vmcnt(7)
    ds_read_b64_tr_b16 a[12:13], v7 offset:36864
    ds_read_b64_tr_b16 a[14:15], v7 offset:37632
    buffer_load_dwordx4 v156, s[32:35], s92 offen offset:1024 lds
    ds_read_b64_tr_b16 a[36:37], v7 offset:36896
    ds_read_b64_tr_b16 a[38:39], v7 offset:37664
    ds_read_b64_tr_b16 a[60:61], v7 offset:36928
    ds_read_b64_tr_b16 a[62:63], v7 offset:37696
    buffer_load_dwordx4 v120, s[32:35], s92 offen offset:2048 lds
    s_add_u32 m0, s90, 12288
    s_mov_b32 s92, 37248
    ds_read_b128 v[60:63], v147 offset:40960
    ds_read_b128 v[56:59], v146 offset:40960
    s_waitcnt lgkmcnt(10)
    buffer_load_dwordx4 v4, s[32:35], s92 offen offset:0 lds
    ds_read_b128 v[52:55], v147 offset:41088
    ds_read_b128 v[48:51], v146 offset:41088
    buffer_load_dwordx4 v156, s[32:35], s92 offen offset:1024 lds
    ds_read_b128 v[40:43], v147 offset:41216
    ds_read_b128 v[0:3], v146 offset:41216
    buffer_load_dwordx4 v120, s[32:35], s92 offen offset:2048 lds
    s_add_u32 m0, s90, 24576
    s_mov_b32 s92, 74112
    s_waitcnt vmcnt(9)
    ds_read_b64_tr_b16 a[16:17], v7 offset:49152
    ds_read_b64_tr_b16 a[18:19], v7 offset:49920
    ds_read_b64_tr_b16 a[40:41], v7 offset:49184
    ds_read_b64_tr_b16 a[42:43], v7 offset:49952
    ds_read_b64_tr_b16 a[64:65], v7 offset:49216
    ds_read_b64_tr_b16 a[66:67], v7 offset:49984
    s_waitcnt lgkmcnt(7)
    buffer_load_dwordx4 v4, s[32:35], s92 offen offset:0 lds
    buffer_load_dwordx4 v156, s[32:35], s92 offen offset:1024 lds
    buffer_load_dwordx4 v120, s[32:35], s92 offen offset:2048 lds
    s_add_u32 m0, s90, 36864
    s_mov_b32 s92, 110976
    s_waitcnt vmcnt(9)
    ds_read_b64_tr_b16 a[20:21], v7 offset:61440
    ds_read_b64_tr_b16 a[22:23], v7 offset:62208
    v_mfma_f32_16x16x32_bf16 v[68:71], a[0:3], v[60:63], 0
    ds_read_b64_tr_b16 a[44:45], v7 offset:61472
    v_mfma_f32_16x16x32_bf16 v[68:71], a[4:7], v[56:59], v[68:71]
    ds_read_b64_tr_b16 a[46:47], v7 offset:62240
    v_mfma_f32_16x16x32_bf16 v[68:71], a[8:11], v[52:55], v[68:71]
    ds_read_b64_tr_b16 a[68:69], v7 offset:61504
    v_mfma_f32_16x16x32_bf16 v[68:71], a[12:15], v[48:51], v[68:71]
    s_waitcnt lgkmcnt(5)
    ds_read_b64_tr_b16 a[70:71], v7 offset:62272
    v_mfma_f32_16x16x32_bf16 v[68:71], a[16:19], v[40:43], v[68:71]
    ds_read_b128 v[44:47], v147 offset:42496
    ds_read_b128 v[36:39], v146 offset:42496
    ds_read_b128 v[32:35], v147 offset:42624
    ds_read_b128 v[28:31], v146 offset:42624
    s_waitcnt lgkmcnt(7)
    v_mfma_f32_16x16x32_bf16 v[68:71], a[20:23], v[0:3], v[68:71]
    ds_read_b128 v[20:23], v147 offset:42752
    s_nop 0
    v_mfma_f32_16x16x32_bf16 v[92:95], a[24:27], v[60:63], 0
    s_nop 0
    ds_read_b128 v[12:15], v146 offset:42752
    s_nop 0
    v_mfma_f32_16x16x32_bf16 v[92:95], a[28:31], v[56:59], v[92:95]
    s_nop 0
    v_fma_f32 v5, v68, v68, s41
    v_fmac_f32 v5, v69, v69
    v_mfma_f32_16x16x32_bf16 v[92:95], a[32:35], v[52:55], v[92:95]
    v_fmac_f32 v5, v70, v70
    v_fmac_f32 v5, v71, v71
    v_mfma_f32_16x16x32_bf16 v[92:95], a[36:39], v[48:51], v[92:95]
    v_mfma_f32_16x16x32_bf16 v[92:95], a[40:43], v[40:43], v[92:95]
    s_waitcnt lgkmcnt(4)
    v_mfma_f32_16x16x32_bf16 v[92:95], a[44:47], v[0:3], v[92:95]
    s_nop 0
    buffer_load_dwordx4 v4, s[32:35], s92 offen offset:0 lds
    v_mfma_f32_16x16x32_bf16 v[88:91], a[48:51], v[60:63], 0
    s_nop 2
    v_mfma_f32_16x16x32_bf16 v[88:91], a[52:55], v[56:59], v[88:91]
    s_nop 0
    v_fmac_f32 v5, v92, v92
    v_fmac_f32 v5, v93, v93
    v_mfma_f32_16x16x32_bf16 v[88:91], a[56:59], v[52:55], v[88:91]
    v_fmac_f32 v5, v94, v94
    v_fmac_f32 v5, v95, v95
    v_mfma_f32_16x16x32_bf16 v[88:91], a[60:63], v[48:51], v[88:91]
    v_mfma_f32_16x16x32_bf16 v[88:91], a[64:67], v[40:43], v[88:91]
    buffer_load_dwordx4 v156, s[32:35], s92 offen offset:1024 lds
    v_mfma_f32_16x16x32_bf16 v[88:91], a[68:71], v[0:3], v[88:91]
    s_nop 0
    v_mfma_f32_16x16x32_bf16 v[0:3], a[0:3], v[44:47], 0
    s_nop 2
    v_mfma_f32_16x16x32_bf16 v[0:3], a[4:7], v[36:39], v[0:3]
    s_waitcnt lgkmcnt(0)
    s_nop 0
    v_fmac_f32 v5, v88, v88
    v_fmac_f32 v5, v89, v89
    v_mfma_f32_16x16x32_bf16 v[0:3], a[8:11], v[32:35], v[0:3]
    v_fmac_f32 v5, v90, v90
    v_fmac_f32 v5, v91, v91
    v_mfma_f32_16x16x32_bf16 v[0:3], a[12:15], v[28:31], v[0:3]
    ds_read_b128 v[100:103], v147 offset:40960
    buffer_load_dwordx4 v120, s[32:35], s92 offen offset:2048 lds
    v_mfma_f32_16x16x32_bf16 v[0:3], a[16:19], v[20:23], v[0:3]
    s_waitcnt vmcnt(9)
    s_add_u32 m0, s90, 49152
    ds_read_b64_tr_b16 a[72:73], v7 offset:0
    v_mfma_f32_16x16x32_bf16 v[0:3], a[20:23], v[12:15], v[0:3]
    s_mov_b32 s92, 147840
    ds_read_b64_tr_b16 a[74:75], v7 offset:768
    v_mfma_f32_16x16x32_bf16 v[56:59], a[24:27], v[44:47], 0
    ds_read_b64_tr_b16 a[96:97], v7 offset:32
    s_nop 0
    v_mfma_f32_16x16x32_bf16 v[56:59], a[28:31], v[36:39], v[56:59]
    s_nop 0
    ds_read_b64_tr_b16 a[98:99], v7 offset:800
    v_fma_f32 v72, v0, v0, s41
    v_mfma_f32_16x16x32_bf16 v[56:59], a[32:35], v[32:35], v[56:59]
    ds_read_b64_tr_b16 a[120:121], v7 offset:64
    buffer_load_dwordx4 v4, s[32:35], s92 offen offset:0 lds
    v_mfma_f32_16x16x32_bf16 v[56:59], a[36:39], v[28:31], v[56:59]
    ds_read_b64_tr_b16 a[122:123], v7 offset:832
    v_fmac_f32 v72, v1, v1
    v_mfma_f32_16x16x32_bf16 v[56:59], a[40:43], v[20:23], v[56:59]
    ds_read_b128 v[64:67], v146 offset:40960
    v_fmac_f32 v72, v2, v2
    v_mfma_f32_16x16x32_bf16 v[56:59], a[44:47], v[12:15], v[56:59]
    ds_read_b128 v[52:55], v147 offset:41088
    v_fmac_f32 v72, v3, v3
    v_mfma_f32_16x16x32_bf16 v[40:43], a[48:51], v[44:47], 0
    ds_read_b128 v[48:51], v146 offset:41088
    v_mfma_f32_16x16x32_bf16 v[40:43], a[52:55], v[36:39], v[40:43]
    ds_read_b128 v[44:47], v147 offset:41216
    buffer_load_dwordx4 v156, s[32:35], s92 offen offset:1024 lds
    v_mfma_f32_16x16x32_bf16 v[40:43], a[56:59], v[32:35], v[40:43]
    ds_read_b128 v[32:35], v146 offset:41216
    v_fmac_f32 v72, v56, v56
    v_mfma_f32_16x16x32_bf16 v[40:43], a[60:63], v[28:31], v[40:43]
    v_fmac_f32 v72, v57, v57
    v_fmac_f32 v72, v58, v58
    v_mfma_f32_16x16x32_bf16 v[40:43], a[64:67], v[20:23], v[40:43]
    v_fmac_f32 v72, v59, v59
    v_mfma_f32_16x16x32_bf16 v[40:43], a[68:71], v[12:15], v[40:43]
    s_waitcnt vmcnt(8)
    s_nop 2
    buffer_load_dwordx4 v120, s[32:35], s92 offen offset:2048 lds
    s_add_u32 m0, s90, 61440
    s_mov_b32 s92, 184704
    ds_read_b64_tr_b16 a[76:77], v7 offset:12288
    v_fmac_f32 v72, v40, v40
    ds_read_b64_tr_b16 a[78:79], v7 offset:13056
    v_fmac_f32 v72, v41, v41
    ds_read_b64_tr_b16 a[100:101], v7 offset:12320
    v_fmac_f32 v72, v42, v42
    ds_read_b64_tr_b16 a[102:103], v7 offset:13088
    v_fmac_f32 v72, v43, v43
    ds_read_b64_tr_b16 a[124:125], v7 offset:12352
    buffer_load_dwordx4 v4, s[32:35], s92 offen offset:0 lds
    ds_read_b64_tr_b16 a[126:127], v7 offset:13120
    buffer_load_dwordx4 v156, s[32:35], s92 offen offset:1024 lds
    buffer_load_dwordx4 v120, s[32:35], s92 offen offset:2048 lds
    s_add_u32 m0, s90, 0
    s_mov_b32 s92, 768
    s_waitcnt vmcnt(9)
    ds_read_b64_tr_b16 a[80:81], v7 offset:24576
    ds_read_b64_tr_b16 a[82:83], v7 offset:25344
    ds_read_b64_tr_b16 a[104:105], v7 offset:24608
    ds_read_b64_tr_b16 a[106:107], v7 offset:25376
    ds_read_b64_tr_b16 a[128:129], v7 offset:24640
    ds_read_b64_tr_b16 a[130:131], v7 offset:25408
    s_waitcnt lgkmcnt(6)
    buffer_load_dwordx4 v4, s[32:35], s92 offen offset:0 lds
    buffer_load_dwordx4 v156, s[32:35], s92 offen offset:1024 lds
    buffer_load_dwordx4 v120, s[32:35], s92 offen offset:2048 lds
    s_add_u32 m0, s90, 12288
    s_mov_b32 s92, 37632
    s_waitcnt vmcnt(9)
    ds_read_b64_tr_b16 a[84:85], v7 offset:36864
    ds_read_b64_tr_b16 a[86:87], v7 offset:37632
    ds_read_b64_tr_b16 a[108:109], v7 offset:36896
    ds_read_b64_tr_b16 a[110:111], v7 offset:37664
    ds_read_b64_tr_b16 a[132:133], v7 offset:36928
    ds_read_b64_tr_b16 a[134:135], v7 offset:37696
    buffer_load_dwordx4 v4, s[32:35], s92 offen offset:0 lds
    buffer_load_dwordx4 v156, s[32:35], s92 offen offset:1024 lds
    buffer_load_dwordx4 v120, s[32:35], s92 offen offset:2048 lds
    s_add_u32 m0, s90, 24576
    s_mov_b32 s92, 74496
    s_waitcnt vmcnt(9)
    ds_read_b64_tr_b16 a[88:89], v7 offset:49152
    ds_read_b64_tr_b16 a[90:91], v7 offset:49920
    ds_read_b64_tr_b16 a[112:113], v7 offset:49184
    ds_read_b64_tr_b16 a[114:115], v7 offset:49952
    ds_read_b64_tr_b16 a[136:137], v7 offset:49216
    ds_read_b64_tr_b16 a[138:139], v7 offset:49984
    s_waitcnt lgkmcnt(6)
    buffer_load_dwordx4 v4, s[32:35], s92 offen offset:0 lds
    buffer_load_dwordx4 v156, s[32:35], s92 offen offset:1024 lds
    buffer_load_dwordx4 v120, s[32:35], s92 offen offset:2048 lds
    s_add_u32 m0, s90, 36864
    s_mov_b32 s92, 111360
    s_waitcnt vmcnt(9)
    ds_read_b64_tr_b16 a[92:93], v7 offset:61440
    ds_read_b64_tr_b16 a[94:95], v7 offset:62208
    v_mfma_f32_16x16x32_bf16 v[36:39], a[72:75], v[100:103], 0
    ds_read_b64_tr_b16 a[116:117], v7 offset:61472
    v_mfma_f32_16x16x32_bf16 v[36:39], a[76:79], v[64:67], v[36:39]
    ds_read_b64_tr_b16 a[118:119], v7 offset:62240
    v_mfma_f32_16x16x32_bf16 v[36:39], a[80:83], v[52:55], v[36:39]
    ds_read_b64_tr_b16 a[140:141], v7 offset:61504
    v_mfma_f32_16x16x32_bf16 v[36:39], a[84:87], v[48:51], v[36:39]
    s_waitcnt lgkmcnt(5)
    buffer_load_dwordx4 v4, s[32:35], s92 offen offset:0 lds
    ds_read_b64_tr_b16 a[142:143], v7 offset:62272
    v_mfma_f32_16x16x32_bf16 v[36:39], a[88:91], v[44:47], v[36:39]
    ds_read_b128 v[96:99], v147 offset:42496
    ds_read_b128 v[80:83], v146 offset:42496
    ds_read_b128 v[28:31], v147 offset:42624
    ds_read_b128 v[20:23], v146 offset:42624
    s_waitcnt lgkmcnt(7)
    v_mfma_f32_16x16x32_bf16 v[36:39], a[92:95], v[32:35], v[36:39]
    buffer_load_dwordx4 v156, s[32:35], s92 offen offset:1024 lds
    ds_read_b128 v[60:63], v147 offset:42752
    v_mfma_f32_16x16x32_bf16 v[84:87], a[96:99], v[100:103], 0
    s_nop 1
    ds_read_b128 v[12:15], v146 offset:42752
    v_mfma_f32_16x16x32_bf16 v[84:87], a[100:103], v[64:67], v[84:87]
    s_nop 0
    v_fma_f32 v157, v36, v36, s41
    v_fmac_f32 v157, v37, v37
    v_mfma_f32_16x16x32_bf16 v[84:87], a[104:107], v[52:55], v[84:87]
    v_fmac_f32 v157, v38, v38
    v_fmac_f32 v157, v39, v39
    v_mfma_f32_16x16x32_bf16 v[84:87], a[108:111], v[48:51], v[84:87]
    v_mfma_f32_16x16x32_bf16 v[84:87], a[112:115], v[44:47], v[84:87]
    s_waitcnt vmcnt(8) lgkmcnt(4)
    buffer_load_dwordx4 v120, s[32:35], s92 offen offset:2048 lds
    ds_read_b64_tr_b16 a[144:145], v6 offset:0
    v_mfma_f32_16x16x32_bf16 v[84:87], a[116:119], v[32:35], v[84:87]
    s_add_u32 m0, s90, 49152
    ds_read_b64_tr_b16 a[146:147], v6 offset:768
    v_mfma_f32_16x16x32_bf16 v[76:79], a[120:123], v[100:103], 0
    s_mov_b32 s92, 148224
    s_nop 0
    ds_read_b64_tr_b16 a[168:169], v6 offset:8
    v_mfma_f32_16x16x32_bf16 v[76:79], a[124:127], v[64:67], v[76:79]
    s_nop 0
    v_fmac_f32 v157, v84, v84
    v_fmac_f32 v157, v85, v85
    v_mfma_f32_16x16x32_bf16 v[76:79], a[128:131], v[52:55], v[76:79]
    ds_read_b64_tr_b16 a[170:171], v6 offset:776
    v_fmac_f32 v157, v86, v86
    v_mfma_f32_16x16x32_bf16 v[76:79], a[132:135], v[48:51], v[76:79]
    buffer_load_dwordx4 v4, s[32:35], s92 offen offset:0 lds
    ds_read_b64_tr_b16 a[192:193], v7 offset:64
    v_mfma_f32_16x16x32_bf16 v[76:79], a[136:139], v[44:47], v[76:79]
    ds_read_b64_tr_b16 a[194:195], v7 offset:832
    v_fmac_f32 v157, v87, v87
    v_mfma_f32_16x16x32_bf16 v[76:79], a[140:143], v[32:35], v[76:79]
    s_nop 0
    v_mfma_f32_16x16x32_bf16 v[52:55], a[72:75], v[96:99], 0
    s_nop 2
    v_mfma_f32_16x16x32_bf16 v[52:55], a[76:79], v[80:83], v[52:55]
    s_waitcnt lgkmcnt(5)
    s_nop 0
    v_fmac_f32 v157, v76, v76
    v_fmac_f32 v157, v77, v77
    v_mfma_f32_16x16x32_bf16 v[52:55], a[80:83], v[28:31], v[52:55]
    buffer_load_dwordx4 v156, s[32:35], s92 offen offset:1024 lds
    v_fmac_f32 v157, v78, v78
    v_mfma_f32_16x16x32_bf16 v[52:55], a[84:87], v[20:23], v[52:55]
    v_fmac_f32 v157, v79, v79
    v_cvt_pk_bf16_f32 v170, v5, v157
    v_mfma_f32_16x16x32_bf16 v[52:55], a[88:91], v[60:63], v[52:55]
    v_mfma_f32_16x16x32_bf16 v[52:55], a[92:95], v[12:15], v[52:55]
    ds_read_b128 v[64:67], v147 offset:40960
    v_mfma_f32_16x16x32_bf16 v[48:51], a[96:99], v[96:99], 0
    ds_read_b128 v[32:35], v146 offset:40960
    v_mfma_f32_16x16x32_bf16 v[48:51], a[100:103], v[80:83], v[48:51]
    s_waitcnt vmcnt(8)
    buffer_load_dwordx4 v120, s[32:35], s92 offen offset:2048 lds
    ds_read_b64_tr_b16 a[148:149], v6 offset:12288
    v_mfma_f32_16x16x32_bf16 v[48:51], a[104:107], v[28:31], v[48:51]
    s_add_u32 m0, s90, 61440
    v_fma_f32 v157, v52, v52, s41
    v_fmac_f32 v157, v53, v53
    v_mfma_f32_16x16x32_bf16 v[48:51], a[108:111], v[20:23], v[48:51]
    s_mov_b32 s92, 185088
    ds_read_b64_tr_b16 a[150:151], v6 offset:13056
    v_fmac_f32 v157, v54, v54
    v_mfma_f32_16x16x32_bf16 v[48:51], a[112:115], v[60:63], v[48:51]
    ds_read_b64_tr_b16 a[172:173], v6 offset:12296
    v_fmac_f32 v157, v55, v55
    v_mfma_f32_16x16x32_bf16 v[48:51], a[116:119], v[12:15], v[48:51]
    ds_read_b64_tr_b16 a[174:175], v6 offset:13064
    v_mfma_f32_16x16x32_bf16 v[44:47], a[120:123], v[96:99], 0
    s_nop 0
    buffer_load_dwordx4 v4, s[32:35], s92 offen offset:0 lds
    ds_read_b64_tr_b16 a[196:197], v7 offset:12352
    v_mfma_f32_16x16x32_bf16 v[44:47], a[124:127], v[80:83], v[44:47]
    s_nop 0
    ds_read_b64_tr_b16 a[198:199], v7 offset:13120
    v_fmac_f32 v157, v48, v48
    v_mfma_f32_16x16x32_bf16 v[44:47], a[128:131], v[28:31], v[44:47]
    ds_read_b128 v[28:31], v147 offset:41088
    v_fmac_f32 v157, v49, v49
    v_mfma_f32_16x16x32_bf16 v[44:47], a[132:135], v[20:23], v[44:47]
    ds_read_b128 v[20:23], v146 offset:41088
    v_fmac_f32 v157, v50, v50
    v_mfma_f32_16x16x32_bf16 v[44:47], a[136:139], v[60:63], v[44:47]
    ds_read_b128 v[60:63], v147 offset:41216
    v_fmac_f32 v157, v51, v51
    v_mfma_f32_16x16x32_bf16 v[44:47], a[140:143], v[12:15], v[44:47]
    s_nop 0
    buffer_load_dwordx4 v156, s[32:35], s92 offen offset:1024 lds
    ds_read_b128 v[12:15], v146 offset:41216
    v_mfma_f32_16x16x16_bf16 v[80:83], v[216:217], v[170:171], 0
    s_nop 0
    v_mov_b32 v168, 0
    v_mov_b32 v169, 0
    v_mov_b32 v149, 0
    v_fmac_f32 v157, v44, v44
    v_fmac_f32 v157, v45, v45
    v_fmac_f32 v157, v46, v46
    v_fmac_f32 v157, v47, v47
    v_rsq_f32 v80, v80
    v_rsq_f32 v81, v81
    v_mul_f32 v80, s55, v80
    v_mul_f32 v81, 0.5, v81
    v_mul_f32 v68, v68, v80
    buffer_load_dwordx4 v120, s[32:35], s92 offen offset:2048 lds
    s_add_u32 m0, s90, 0
    s_mov_b32 s92, 0
    s_waitcnt vmcnt(9)
    ds_read_b64_tr_b16 a[152:153], v6 offset:24576
    v_mul_f32 v69, v69, v80
    v_cvt_pk_f16_f32 v68, v68, v69
    v_mul_f32 v70, v70, v80
    ds_read_b64_tr_b16 a[154:155], v6 offset:25344
    v_mul_f32 v71, v71, v80
    v_cvt_pk_f16_f32 v69, v70, v71
    v_mul_f32 v92, v92, v80
    ds_read_b64_tr_b16 a[176:177], v6 offset:24584
    v_mul_f32 v93, v93, v80
    v_cvt_pk_f16_f32 v70, v92, v93
    s_waitcnt lgkmcnt(3)
    buffer_load_dwordx4 v121, s[76:79], s92 offen offset:0 lds
    ds_read_b64_tr_b16 a[178:179], v6 offset:25352
    v_mul_f32 v94, v94, v80
    v_mul_f32 v95, v95, v80
    v_cvt_pk_f16_f32 v71, v94, v95
    ds_read_b64_tr_b16 a[200:201], v7 offset:24640
    v_mul_f32 v88, v88, v80
    ds_read_b64_tr_b16 a[202:203], v7 offset:25408
    v_mul_f32 v89, v89, v80
    v_cvt_pk_f16_f32 v160, v88, v89
    v_mul_f32 v90, v90, v80
    v_mul_f32 v91, v91, v80
    v_cvt_pk_f16_f32 v161, v90, v91
    v_mul_f32 v36, v36, v81
    buffer_load_dwordx4 v25, s[76:79], s92 offen offset:1024 lds
    v_mul_f32 v37, v37, v81
    v_cvt_pk_f16_f32 v36, v36, v37
    v_mul_f32 v38, v38, v81
    v_mul_f32 v39, v39, v81
    v_cvt_pk_f16_f32 v37, v38, v39
    v_mul_f32 v84, v84, v81
    v_mul_f32 v85, v85, v81
    v_cvt_pk_f16_f32 v38, v84, v85
    v_mul_f32 v86, v86, v81
    v_mul_f32 v87, v87, v81
    v_cvt_pk_f16_f32 v39, v86, v87
    v_mul_f32 v76, v76, v81
    v_mul_f32 v77, v77, v81
    v_cvt_pk_f16_f32 v4, v76, v77
    v_mul_f32 v78, v78, v81
    v_mul_f32 v79, v79, v81
    v_cvt_pk_f16_f32 v5, v78, v79
    buffer_load_dwordx4 v24, s[76:79], s92 offen offset:2048 lds
    s_add_u32 m0, s90, 12288
    s_mov_b32 s92, 12288
    s_waitcnt vmcnt(9)
    ds_read_b64_tr_b16 a[156:157], v6 offset:36864
    v_fma_mix_f32 v148, v68, v36, 0 op_sel:[0,0,0] op_sel_hi:[1,1,0]
    v_fma_mix_f32 v148, v68, v36, v148 op_sel:[1,1,0] op_sel_hi:[1,1,0]
    v_fma_mix_f32 v148, v69, v37, v148 op_sel:[0,0,0] op_sel_hi:[1,1,0]
    ds_read_b64_tr_b16 a[158:159], v6 offset:37632
    v_fma_mix_f32 v148, v69, v37, v148 op_sel:[1,1,0] op_sel_hi:[1,1,0]
    v_fma_mix_f32 v148, v70, v38, v148 op_sel:[0,0,0] op_sel_hi:[1,1,0]
    v_fma_mix_f32 v148, v70, v38, v148 op_sel:[1,1,0] op_sel_hi:[1,1,0]
    ds_read_b64_tr_b16 a[180:181], v6 offset:36872
    v_fma_mix_f32 v148, v71, v39, v148 op_sel:[0,0,0] op_sel_hi:[1,1,0]
    v_fma_mix_f32 v148, v71, v39, v148 op_sel:[1,1,0] op_sel_hi:[1,1,0]
    buffer_load_dwordx4 v121, s[76:79], s92 offen offset:0 lds
    ds_read_b64_tr_b16 a[182:183], v6 offset:37640
    v_fma_mix_f32 v148, v160, v4, v148 op_sel:[0,0,0] op_sel_hi:[1,1,0]
    v_fma_mix_f32 v148, v160, v4, v148 op_sel:[1,1,0] op_sel_hi:[1,1,0]
    v_fma_mix_f32 v148, v161, v5, v148 op_sel:[0,0,0] op_sel_hi:[1,1,0]
    ds_read_b64_tr_b16 a[204:205], v7 offset:36928
    v_fma_mix_f32 v148, v161, v5, v148 op_sel:[1,1,0] op_sel_hi:[1,1,0]
    ds_read_b64_tr_b16 a[206:207], v7 offset:37696
    v_mov_b32 v120, v148
    v_add_u32 v156, 28672, v158
    ds_write_b128 v156, v[36:39]
    buffer_load_dwordx4 v25, s[76:79], s92 offen offset:1024 lds
    v_permlane32_swap_b32 v120, v148
    v_add_f32 v148, v120, v148
    v_mov_b32 v120, v148
    v_cvt_pk_bf16_f32 v170, v72, v157
    s_nop 0
    v_permlane16_swap_b32 v120, v148
    v_mfma_f32_16x16x16_bf16 v[36:39], v[216:217], v[170:171], 0
    s_waitcnt vmcnt(8)
    ds_write2_b64 v156, v[168:169], v[168:169] offset0:2 offset1:3
    v_add_f32 v148, v120, v148
    buffer_load_dwordx4 v24, s[76:79], s92 offen offset:2048 lds
    s_add_u32 m0, s90, 24576
    s_mov_b32 s92, 24576
    v_and_b32 v120, 0xffff0000, v148
    v_sub_f32 v148, v148, v120
    ds_read_b64_tr_b16 a[160:161], v6 offset:49152
    v_cvt_pk_bf16_f32 v148, v148, v120
    v_rsq_f32 v36, v36
    ds_read_b64_tr_b16 a[162:163], v6 offset:49920
    v_rsq_f32 v37, v37
    v_mul_f32 v36, s55, v36
    s_waitcnt lgkmcnt(3)
    buffer_load_dwordx4 v121, s[76:79], s92 offen offset:0 lds
    ds_read_b64_tr_b16 a[184:185], v6 offset:49160
    v_mul_f32 v37, 0.5, v37
    v_mul_f32 v0, v0, v36
    v_mul_f32 v1, v1, v36
    ds_read_b64_tr_b16 a[186:187], v6 offset:49928
    v_cvt_pk_f16_f32 v0, v0, v1
    v_mul_f32 v2, v2, v36
    v_mul_f32 v3, v3, v36
    ds_read_b64_tr_b16 a[208:209], v7 offset:49216
    v_cvt_pk_f16_f32 v1, v2, v3
    ds_read_b64_tr_b16 a[210:211], v7 offset:49984
    v_mul_f32 v56, v56, v36
    buffer_load_dwordx4 v25, s[76:79], s92 offen offset:1024 lds
    ds_write_b128 v156, v[68:71] offset:32
    v_mul_f32 v57, v57, v36
    v_cvt_pk_f16_f32 v2, v56, v57
    v_mul_f32 v58, v58, v36
    v_mul_f32 v59, v59, v36
    v_cvt_pk_f16_f32 v3, v58, v59
    v_mul_f32 v40, v40, v36
    v_mul_f32 v41, v41, v36
    v_cvt_pk_f16_f32 v254, v40, v41
    ds_write2_b64 v156, v[4:5], v[168:169] offset0:6 offset1:7
    buffer_load_dwordx4 v24, s[76:79], s92 offen offset:2048 lds
    s_add_u32 m0, s90, 36864
    s_mov_b32 s92, 36864
    v_mul_f32 v42, v42, v36
    v_mul_f32 v43, v43, v36
    v_cvt_pk_f16_f32 v255, v42, v43
    v_mul_f32 v52, v52, v37
    v_mul_f32 v53, v53, v37
    s_waitcnt vmcnt(9)
    ds_read_b64_tr_b16 a[164:165], v6 offset:61440
    v_cvt_pk_f16_f32 v4, v52, v53
    v_mul_f32 v54, v54, v37
    v_mul_f32 v55, v55, v37
    ds_read_b64_tr_b16 a[166:167], v6 offset:62208
    v_mfma_f32_16x16x32_bf16 v[40:43], a[144:147], v[64:67], 0
    buffer_load_dwordx4 v121, s[76:79], s92 offen offset:0 lds
    ds_read_b64_tr_b16 a[188:189], v6 offset:61448
    v_mfma_f32_16x16x32_bf16 v[40:43], a[148:151], v[32:35], v[40:43]
    v_cvt_pk_f16_f32 v5, v54, v55
    v_mul_f32 v48, v48, v37
    v_mfma_f32_16x16x32_bf16 v[40:43], a[152:155], v[28:31], v[40:43]
    ds_read_b64_tr_b16 a[190:191], v6 offset:62216
    v_mul_f32 v49, v49, v37
    v_mfma_f32_16x16x32_bf16 v[40:43], a[156:159], v[20:23], v[40:43]
    s_waitcnt lgkmcnt(4)
    ds_read_b64_tr_b16 a[212:213], v7 offset:61504
    v_cvt_pk_f16_f32 v6, v48, v49
    v_mfma_f32_16x16x32_bf16 v[40:43], a[160:163], v[60:63], v[40:43]
    ds_read_b64_tr_b16 a[214:215], v7 offset:62272
    v_mul_f32 v50, v50, v37
    v_mul_f32 v51, v51, v37
    v_cvt_pk_f16_f32 v7, v50, v51
    buffer_load_dwordx4 v25, s[76:79], s92 offen offset:1024 lds
    ds_write2_b64 v156, v[168:169], v[160:161] offset0:8 offset1:9
    v_mul_f32 v44, v44, v37
    v_mul_f32 v45, v45, v37
    v_cvt_pk_f16_f32 v160, v44, v45
    v_mul_f32 v46, v46, v37
    s_waitcnt lgkmcnt(5)
    v_mfma_f32_16x16x32_bf16 v[40:43], a[164:167], v[12:15], v[40:43]
    v_mul_f32 v47, v47, v37
    v_cvt_pk_f16_f32 v161, v46, v47
    v_mfma_f32_16x16x32_bf16 v[52:55], a[168:171], v[64:67], 0
    buffer_load_dwordx4 v24, s[76:79], s92 offen offset:2048 lds
    ds_read_b128 v[48:51], v147 offset:42496
    v_mfma_f32_16x16x32_bf16 v[52:55], a[172:175], v[32:35], v[52:55]
    s_add_u32 m0, s90, 49152
    v_fma_mix_f32 v120, v0, v4, 0 op_sel:[0,0,0] op_sel_hi:[1,1,0]
    v_fma_mix_f32 v120, v0, v4, v120 op_sel:[1,1,0] op_sel_hi:[1,1,0]
    v_mfma_f32_16x16x32_bf16 v[52:55], a[176:179], v[28:31], v[52:55]
    s_mov_b32 s92, 49152
    ds_write_b64 v156, v[148:149] offset:88
    v_mfma_f32_16x16x32_bf16 v[52:55], a[180:183], v[20:23], v[52:55]
    s_lshl_b32 s93, s68, 10
    v_fma_mix_f32 v120, v1, v5, v120 op_sel:[0,0,0] op_sel_hi:[1,1,0]
    v_fma_mix_f32 v120, v1, v5, v120 op_sel:[1,1,0] op_sel_hi:[1,1,0]
    v_mfma_f32_16x16x32_bf16 v[52:55], a[184:187], v[60:63], v[52:55]
    s_waitcnt lgkmcnt(3)
    s_mov_b32 s53, s47
    ds_read_b128 v[44:47], v146 offset:42496
    v_fma_mix_f32 v120, v2, v6, v120 op_sel:[0,0,0] op_sel_hi:[1,1,0]
    v_mfma_f32_16x16x32_bf16 v[52:55], a[188:191], v[12:15], v[52:55]
    s_mov_b32 s47, s46
    buffer_load_dwordx4 v121, s[76:79], s92 offen offset:0 lds
    ds_read_b128 v[36:39], v147 offset:42624
    v_mfma_f32_16x16x32_bf16 v[56:59], a[192:195], v[64:67], 0
    s_mov_b32 s46, s45
    v_fma_mix_f32 v120, v2, v6, v120 op_sel:[1,1,0] op_sel_hi:[1,1,0]
    v_fma_mix_f32 v120, v3, v7, v120 op_sel:[0,0,0] op_sel_hi:[1,1,0]
    v_mfma_f32_16x16x32_bf16 v[56:59], a[196:199], v[32:35], v[56:59]
    s_mov_b32 s45, s44
    ds_read_b128 v[32:35], v146 offset:42624
    v_fma_mix_f32 v120, v3, v7, v120 op_sel:[1,1,0] op_sel_hi:[1,1,0]
    v_mfma_f32_16x16x32_bf16 v[56:59], a[200:203], v[28:31], v[56:59]
    s_mov_b32 s44, s53
    ds_read_b128 v[28:31], v147 offset:42752
    v_fma_mix_f32 v120, v254, v160, v120 op_sel:[0,0,0] op_sel_hi:[1,1,0]
    v_mfma_f32_16x16x32_bf16 v[56:59], a[204:207], v[20:23], v[56:59]
    s_sub_u32 s48, s44, s46
    ds_read_b128 v[20:23], v146 offset:42752
    v_fma_mix_f32 v120, v254, v160, v120 op_sel:[1,1,0] op_sel_hi:[1,1,0]
    v_mfma_f32_16x16x32_bf16 v[56:59], a[208:211], v[60:63], v[56:59]
    s_sub_u32 s49, s46, s45
    buffer_load_dwordx4 v25, s[76:79], s92 offen offset:1024 lds
    v_fma_mix_f32 v120, v255, v161, v120 op_sel:[0,0,0] op_sel_hi:[1,1,0]
    v_mfma_f32_16x16x32_bf16 v[56:59], a[212:215], v[12:15], v[56:59]
    s_waitcnt lgkmcnt(5)
    v_fma_mix_f32 v120, v255, v161, v120 op_sel:[1,1,0] op_sel_hi:[1,1,0]
    v_mov_b32 v146, v120
    v_mfma_f32_16x16x32_bf16 v[12:15], a[144:147], v[48:51], 0
    s_waitcnt lgkmcnt(4)
    v_permlane32_swap_b32 v146, v120
    v_add_f32 v120, v146, v120
    v_mfma_f32_16x16x32_bf16 v[12:15], a[148:151], v[44:47], v[12:15]
    s_waitcnt lgkmcnt(3)
    v_mov_b32 v146, v120
    v_cvt_pk_bf16_f32 v148, v40, v41
    v_cvt_pk_bf16_f32 v149, v42, v43
    v_mfma_f32_16x16x32_bf16 v[12:15], a[152:155], v[36:39], v[12:15]
    s_waitcnt lgkmcnt(2)
    ds_write_b64 v158, v[148:149] offset:28752
    buffer_load_dwordx4 v24, s[76:79], s92 offen offset:2048 lds
    s_add_u32 m0, s90, 61440
    v_mfma_f32_16x16x32_bf16 v[12:15], a[156:159], v[32:35], v[12:15]
    s_waitcnt lgkmcnt(2)
    s_mov_b32 s92, 61440
    v_permlane16_swap_b32 v146, v120
    v_mfma_f32_16x16x32_bf16 v[12:15], a[160:163], v[28:31], v[12:15]
    s_waitcnt lgkmcnt(1)
    v_add_f32 v120, v146, v120
    v_and_b32 v146, 0xffff0000, v120
    v_mfma_f32_16x16x32_bf16 v[12:15], a[164:167], v[20:23], v[12:15]
    v_sub_f32 v120, v120, v146
    v_cvt_pk_bf16_f32 v120, v120, v146
    v_mfma_f32_16x16x32_bf16 v[40:43], a[168:171], v[48:51], 0
    v_cvt_pk_bf16_f32 v52, v52, v53
    v_cvt_pk_bf16_f32 v53, v54, v55
    v_mfma_f32_16x16x32_bf16 v[40:43], a[172:175], v[44:47], v[40:43]
    buffer_load_dwordx4 v121, s[76:79], s92 offen offset:0 lds
    v_cvt_pk_bf16_f32 v54, v56, v57
    v_mfma_f32_16x16x32_bf16 v[40:43], a[176:179], v[36:39], v[40:43]
    v_cvt_pk_bf16_f32 v55, v58, v59
    v_cvt_pk_bf16_f32 v156, v12, v13
    v_mfma_f32_16x16x32_bf16 v[40:43], a[180:183], v[32:35], v[40:43]
    ds_write_b128 v158, v[52:55] offset:28768
    v_mfma_f32_16x16x32_bf16 v[40:43], a[184:187], v[28:31], v[40:43]
    v_cvt_pk_bf16_f32 v157, v14, v15
    v_add_u32 v121, s93, v129
    v_mfma_f32_16x16x32_bf16 v[40:43], a[188:191], v[20:23], v[40:43]
    buffer_load_dwordx4 v25, s[76:79], s92 offen offset:1024 lds
    v_add_u32 v137, s48, v137
    v_mfma_f32_16x16x32_bf16 v[12:15], a[192:195], v[48:51], 0
    s_nop 0
    v_add_u32 v136, s48, v136
    s_nop 0
    v_mfma_f32_16x16x32_bf16 v[12:15], a[196:199], v[44:47], v[12:15]
    s_nop 0
    v_cvt_pk_bf16_f32 v76, v40, v41
    v_cvt_pk_bf16_f32 v77, v42, v43
    v_mfma_f32_16x16x32_bf16 v[12:15], a[200:203], v[36:39], v[12:15]
    v_mfma_f32_16x16x32_bf16 v[12:15], a[204:207], v[32:35], v[12:15]
    v_mfma_f32_16x16x32_bf16 v[12:15], a[208:211], v[28:31], v[12:15]
    buffer_load_dwordx4 v24, s[76:79], s92 offen offset:2048 lds
    v_mfma_f32_16x16x32_bf16 v[12:15], a[212:215], v[20:23], v[12:15]
    s_add_u32 m0, s54, 20480
    s_nop 6
    v_cvt_pk_bf16_f32 v78, v12, v13
    v_cvt_pk_bf16_f32 v79, v14, v15
    buffer_load_dwordx4 v128, s[24:27], s56 offen nt lds
    s_add_u32 m0, s54, 21504
    s_nop 0
    buffer_load_dwordx4 v127, s[24:27], s56 offen nt lds
    s_add_u32 m0, s54, 22528
    s_nop 0
    buffer_load_dwordx4 v126, s[24:27], s56 offen nt lds
    s_add_u32 m0, s54, 23552
    s_nop 0
    buffer_load_dwordx4 v125, s[24:27], s56 offen nt lds
    s_add_u32 m0, s54, 24576
    s_nop 0
    buffer_load_dwordx4 v124, s[24:27], s56 offen nt lds
    s_waitcnt vmcnt(5)
    s_barrier
    ds_read_b128 v[36:39], v17 offset:0
    ds_read_b64 v[12:13], v16 offset:64
    ds_read_b128 v[28:31], v17 offset:3072
    ds_read_b64 v[14:15], v16 offset:3136
    ds_read_b128 v[48:51], v17 offset:6144
    ds_read_b64 v[32:33], v16 offset:6208
    ds_read_b128 v[40:43], v17 offset:9216
    ds_read_b64 v[34:35], v16 offset:9280
    ds_read_b128 v[44:47], v17 offset:12288
    ds_read_b64 v[52:53], v16 offset:12352
    ds_read_b128 v[20:23], v17 offset:15360
    ds_read_b64 v[54:55], v16 offset:15424
    s_waitcnt lgkmcnt(11)
    v_mfma_f32_16x16x32_bf16 v[56:59], v[36:39], v[220:223], 0
    s_waitcnt lgkmcnt(9)
    ds_read_b128 v[36:39], v17 offset:18432
    v_mfma_f32_16x16x32_bf16 v[56:59], v[28:31], v[220:223], v[56:59]
    s_waitcnt lgkmcnt(8)
    ds_read_b64 v[28:29], v16 offset:18496
    ds_read_b128 v[60:63], v17 offset:21504
    v_mfma_f32_16x16x32_bf16 v[56:59], v[48:51], v[220:223], v[56:59]
    s_waitcnt lgkmcnt(8)
    ds_read_b64 v[30:31], v16 offset:21568
    ds_read_b128 v[48:51], v17 offset:24576
    v_mfma_f32_16x16x32_bf16 v[56:59], v[40:43], v[220:223], v[56:59]
    ds_read_b64 v[40:41], v16 offset:24640
    v_mfma_f32_16x16x32_bf16 v[56:59], v[12:15], v[220:223], v[56:59]
    s_waitcnt lgkmcnt(9)
    ds_read_b128 v[12:15], v17 offset:27648
    v_mfma_f32_16x16x32_bf16 v[56:59], v[32:35], v[220:223], v[56:59]
    ds_read_b64 v[42:43], v16 offset:27712
    v_mfma_f32_16x16x32_bf16 v[32:35], v[44:47], v[220:223], 0
    s_waitcnt lgkmcnt(8)
    ds_read_b128 v[44:47], v17 offset:30720
    v_mfma_f32_16x16x32_bf16 v[32:35], v[20:23], v[220:223], v[32:35]
    s_waitcnt lgkmcnt(8)
    s_nop 0
    ds_read_b64 v[20:21], v16 offset:30784
    v_mul_f32 v56, 0xbbaaaaab, v56
    v_mfma_f32_16x16x32_bf16 v[32:35], v[36:39], v[220:223], v[32:35]
    s_waitcnt lgkmcnt(7)
    ds_read_b128 v[36:39], v17 offset:33792
    v_mul_f32 v57, 0xbbaaaaab, v57
    v_mul_f32 v58, 0xbbaaaaab, v58
    v_mul_f32 v59, 0xbbaaaaab, v59
    v_mfma_f32_16x16x32_bf16 v[32:35], v[60:63], v[220:223], v[32:35]
    ds_write_b128 v74, v[56:59] offset:0
    v_mfma_f32_16x16x32_bf16 v[32:35], v[52:55], v[220:223], v[32:35]
    s_waitcnt lgkmcnt(6)
    v_mfma_f32_16x16x32_bf16 v[32:35], v[28:31], v[220:223], v[32:35]
    v_mfma_f32_16x16x32_bf16 v[28:31], v[48:51], v[220:223], 0
    s_waitcnt lgkmcnt(4)
    ds_read_b64 v[22:23], v16 offset:33856
    s_nop 0
    v_mfma_f32_16x16x32_bf16 v[28:31], v[12:15], v[220:223], v[28:31]
    s_waitcnt lgkmcnt(4)
    s_nop 0
    ds_read_b128 v[12:15], v19 offset:0
    v_mul_f32 v32, 0xbbaaaaab, v32
    v_mfma_f32_16x16x32_bf16 v[28:31], v[44:47], v[220:223], v[28:31]
    s_waitcnt lgkmcnt(3)
    ds_read_b64 v[16:17], v18 offset:64
    v_mul_f32 v33, 0xbbaaaaab, v33
    v_mul_f32 v34, 0xbbaaaaab, v34
    v_mul_f32 v35, 0xbbaaaaab, v35
    v_mfma_f32_16x16x32_bf16 v[28:31], v[36:39], v[220:223], v[28:31]
    ds_write_b128 v74, v[32:35] offset:128
    v_mfma_f32_16x16x32_bf16 v[28:31], v[40:43], v[220:223], v[28:31]
    ds_read_b128 v[80:83], v19 offset:768
    ds_read_b64 v[84:85], v18 offset:832
    ds_read_b128 v[68:71], v19 offset:12288
    s_waitcnt lgkmcnt(6)
    v_mfma_f32_16x16x32_bf16 v[28:31], v[20:23], v[220:223], v[28:31]
    s_nop 0
    ds_read_b64 v[72:73], v18 offset:12352
    s_nop 0
    ds_read_b128 v[20:23], v19 offset:13056
    s_nop 2
    ds_read_b64 v[24:25], v18 offset:13120
    v_mul_f32 v28, 0xbbaaaaab, v28
    v_mul_f32 v29, 0xbbaaaaab, v29
    v_mul_f32 v30, 0xbbaaaaab, v30
    v_mul_f32 v31, 0xbbaaaaab, v31
    ds_write_b128 v74, v[28:31] offset:256
    s_waitcnt lgkmcnt(0)
    s_barrier
    ds_read_b128 v[40:43], v162 offset:0
    ds_read_b128 v[28:31], v162 offset:64
    ds_read_b128 v[64:67], v162 offset:128
    ds_read_b128 v[56:59], v162 offset:192
    s_waitcnt lgkmcnt(3)
    v_mfma_f32_16x16x16_bf16 v[32:35], v[12:13], v[26:27], v[40:43]
    v_mfma_f32_16x16x16_bf16 v[36:39], v[14:15], v[26:27], v[40:43]
    s_nop 2
    v_mfma_f32_16x16x16_bf16 v[60:63], v[16:17], v[26:27], v[40:43]
    s_waitcnt lgkmcnt(0)
    s_nop 0
    ds_read_b128 v[12:15], v19 offset:24576
    v_cvt_pk_bf16_f32 v32, v32, v33
    v_mfma_f32_16x16x16_bf16 v[52:55], v[80:81], v[26:27], v[28:31]
    ds_read_b64 v[16:17], v18 offset:24640
    v_accvgpr_write_b32 a216, v32
    v_mfma_f32_16x16x16_bf16 v[48:51], v[82:83], v[26:27], v[28:31]
    ds_read_b128 v[44:47], v162 offset:256
    v_cvt_pk_bf16_f32 v34, v34, v35
    v_mfma_f32_16x16x16_bf16 v[40:43], v[84:85], v[26:27], v[28:31]
    ds_read_b128 v[104:107], v19 offset:25344
    v_accvgpr_write_b32 a217, v34
    v_mfma_f32_16x16x16_bf16 v[84:87], v[68:69], v[26:27], v[64:67]
    ds_read_b64 v[108:109], v18 offset:25408
    v_cvt_pk_bf16_f32 v36, v36, v37
    v_mfma_f32_16x16x16_bf16 v[32:35], v[70:71], v[26:27], v[64:67]
    ds_read_b128 v[100:103], v162 offset:320
    v_accvgpr_write_b32 a240, v36
    v_mfma_f32_16x16x16_bf16 v[28:31], v[72:73], v[26:27], v[64:67]
    ds_read_b128 v[92:95], v19 offset:36864
    v_cvt_pk_bf16_f32 v38, v38, v39
    v_mfma_f32_16x16x16_bf16 v[68:71], v[20:21], v[26:27], v[56:59]
    ds_read_b64 v[96:97], v18 offset:36928
    v_accvgpr_write_b32 a241, v38
    v_mfma_f32_16x16x16_bf16 v[64:67], v[22:23], v[26:27], v[56:59]
    ds_read_b128 v[80:83], v162 offset:5120
    v_cvt_pk_bf16_f32 v232, v60, v61
    v_mfma_f32_16x16x16_bf16 v[36:39], v[24:25], v[26:27], v[56:59]
    s_waitcnt lgkmcnt(6)
    ds_read_b128 v[20:23], v19 offset:37632
    v_cvt_pk_bf16_f32 v233, v62, v63
    v_cvt_pk_bf16_f32 v52, v52, v53
    v_accvgpr_write_b32 a218, v52
    v_cvt_pk_bf16_f32 v54, v54, v55
    v_accvgpr_write_b32 a219, v54
    v_cvt_pk_bf16_f32 v48, v48, v49
    v_mfma_f32_16x16x16_bf16 v[60:63], v[12:13], v[26:27], v[44:47]
    ds_read_b64 v[24:25], v18 offset:37696
    v_accvgpr_write_b32 a242, v48
    v_mfma_f32_16x16x16_bf16 v[56:59], v[14:15], v[26:27], v[44:47]
    ds_read_b128 v[88:91], v162 offset:5184
    v_cvt_pk_bf16_f32 v50, v50, v51
    v_mfma_f32_16x16x16_bf16 v[52:55], v[16:17], v[26:27], v[44:47]
    s_waitcnt lgkmcnt(6)
    ds_read_b128 v[12:15], v19 offset:49152
    v_accvgpr_write_b32 a243, v50
    v_cvt_pk_bf16_f32 v234, v40, v41
    v_cvt_pk_bf16_f32 v235, v42, v43
    v_mfma_f32_16x16x16_bf16 v[72:75], v[104:105], v[26:27], v[100:103]
    ds_read_b64 v[16:17], v18 offset:49216
    v_cvt_pk_bf16_f32 v84, v84, v85
    v_mfma_f32_16x16x16_bf16 v[40:43], v[106:107], v[26:27], v[100:103]
    ds_read_b128 v[48:51], v162 offset:5248
    v_accvgpr_write_b32 a220, v84
    v_mfma_f32_16x16x16_bf16 v[44:47], v[108:109], v[26:27], v[100:103]
    s_waitcnt lgkmcnt(6)
    ds_read_b128 v[104:107], v19 offset:49920
    v_cvt_pk_bf16_f32 v86, v86, v87
    v_accvgpr_write_b32 a221, v86
    v_cvt_pk_bf16_f32 v32, v32, v33
    v_accvgpr_write_b32 a244, v32
    v_cvt_pk_bf16_f32 v34, v34, v35
    v_accvgpr_write_b32 a245, v34
    v_cvt_pk_bf16_f32 v236, v28, v29
    v_cvt_pk_bf16_f32 v237, v30, v31
    v_mfma_f32_16x16x16_bf16 v[84:87], v[92:93], v[26:27], v[80:83]
    ds_read_b64 v[108:109], v18 offset:49984
    v_cvt_pk_bf16_f32 v68, v68, v69
    v_mfma_f32_16x16x16_bf16 v[32:35], v[94:95], v[26:27], v[80:83]
    ds_read_b128 v[100:103], v162 offset:5312
    v_accvgpr_write_b32 a222, v68
    v_mfma_f32_16x16x16_bf16 v[28:31], v[96:97], v[26:27], v[80:83]
    s_waitcnt lgkmcnt(5)
    ds_read_b128 v[92:95], v19 offset:61440
    v_cvt_pk_bf16_f32 v70, v70, v71
    v_accvgpr_write_b32 a223, v70
    v_cvt_pk_bf16_f32 v64, v64, v65
    v_accvgpr_write_b32 a246, v64
    v_cvt_pk_bf16_f32 v66, v66, v67
    v_accvgpr_write_b32 a247, v66
    v_cvt_pk_bf16_f32 v238, v36, v37
    v_cvt_pk_bf16_f32 v239, v38, v39
    v_mfma_f32_16x16x16_bf16 v[36:39], v[20:21], v[26:27], v[88:91]
    ds_read_b64 v[96:97], v18 offset:61504
    v_cvt_pk_bf16_f32 v60, v60, v61
    v_mfma_f32_16x16x16_bf16 v[68:71], v[22:23], v[26:27], v[88:91]
    ds_read_b128 v[80:83], v162 offset:5376
    v_accvgpr_write_b32 a224, v60
    v_mfma_f32_16x16x16_bf16 v[64:67], v[24:25], v[26:27], v[88:91]
    s_waitcnt lgkmcnt(5)
    ds_read_b128 v[20:23], v19 offset:62208
    v_cvt_pk_bf16_f32 v62, v62, v63
    v_accvgpr_write_b32 a225, v62
    v_cvt_pk_bf16_f32 v56, v56, v57
    v_accvgpr_write_b32 a248, v56
    v_cvt_pk_bf16_f32 v58, v58, v59
    v_accvgpr_write_b32 a249, v58
    v_cvt_pk_bf16_f32 v240, v52, v53
    v_cvt_pk_bf16_f32 v241, v54, v55
    v_mfma_f32_16x16x16_bf16 v[60:63], v[12:13], v[26:27], v[48:51]
    ds_read_b64 v[24:25], v18 offset:62272
    v_cvt_pk_bf16_f32 v72, v72, v73
    v_mfma_f32_16x16x16_bf16 v[56:59], v[14:15], v[26:27], v[48:51]
    ds_read_b128 v[12:15], v162 offset:5440
    v_accvgpr_write_b32 a226, v72
    v_mfma_f32_16x16x16_bf16 v[52:55], v[16:17], v[26:27], v[48:51]
    s_waitcnt lgkmcnt(5)
    ds_read_b128 v[16:19], v137 offset:0
    v_cvt_pk_bf16_f32 v74, v74, v75
    v_accvgpr_write_b32 a227, v74
    v_cvt_pk_bf16_f32 v40, v40, v41
    v_accvgpr_write_b32 a250, v40
    v_cvt_pk_bf16_f32 v42, v42, v43
    v_accvgpr_write_b32 a251, v42
    v_cvt_pk_bf16_f32 v242, v44, v45
    v_cvt_pk_bf16_f32 v243, v46, v47
    v_mfma_f32_16x16x16_bf16 v[48:51], v[104:105], v[26:27], v[100:103]
    ds_read_b128 v[146:149], v136 offset:0
    v_cvt_pk_bf16_f32 v84, v84, v85
    v_mfma_f32_16x16x16_bf16 v[44:47], v[106:107], v[26:27], v[100:103]
    ds_read_b128 v[72:75], v137 offset:128
    v_accvgpr_write_b32 a228, v84
    v_mfma_f32_16x16x16_bf16 v[40:43], v[108:109], v[26:27], v[100:103]
    s_waitcnt lgkmcnt(5)
    ds_read_b128 v[88:91], v136 offset:128
    v_cvt_pk_bf16_f32 v86, v86, v87
    v_accvgpr_write_b32 a229, v86
    v_cvt_pk_bf16_f32 v32, v32, v33
    v_accvgpr_write_b32 a252, v32
    v_cvt_pk_bf16_f32 v34, v34, v35
    v_accvgpr_write_b32 a253, v34
    v_cvt_pk_bf16_f32 v244, v28, v29
    v_cvt_pk_bf16_f32 v245, v30, v31
    v_mfma_f32_16x16x16_bf16 v[32:35], v[92:93], v[26:27], v[80:83]
    s_waitcnt vmcnt(0) lgkmcnt(4)
    s_barrier
    ds_write_b128 v121, v[8:11] offset:6144
    v_mfma_f32_16x16x16_bf16 v[28:31], v[94:95], v[26:27], v[80:83]
    v_cvt_pk_bf16_f32 v36, v36, v37
    v_accvgpr_write_b32 a230, v36
    v_mfma_f32_16x16x16_bf16 v[8:11], v[96:97], v[26:27], v[80:83]
    s_waitcnt lgkmcnt(4)
    v_cvt_pk_bf16_f32 v38, v38, v39
    v_accvgpr_write_b32 a231, v38
    v_cvt_pk_bf16_f32 v68, v68, v69
    v_mfma_f32_16x16x32_bf16 v[36:39], a[0:3], v[16:19], 0
    s_waitcnt lgkmcnt(3)
    ds_write_b64 v158, v[156:157] offset:80
    v_mfma_f32_16x16x32_bf16 v[36:39], a[4:7], v[146:149], v[36:39]
    s_waitcnt lgkmcnt(3)
    v_accvgpr_write_b32 a254, v68
    v_cvt_pk_bf16_f32 v70, v70, v71
    v_mfma_f32_16x16x32_bf16 v[36:39], a[8:11], v[72:75], v[36:39]
    s_waitcnt lgkmcnt(2)
    ds_write_b128 v158, v[76:79] offset:96
    v_mfma_f32_16x16x32_bf16 v[36:39], a[12:15], v[88:91], v[36:39]
    v_accvgpr_write_b32 a255, v70
    v_cvt_pk_bf16_f32 v246, v64, v65
    v_cvt_pk_bf16_f32 v247, v66, v67
    v_cvt_pk_bf16_f32 v60, v60, v61
    v_accvgpr_write_b32 a232, v60
    v_cvt_pk_bf16_f32 v62, v62, v63
    v_accvgpr_write_b32 a233, v62
    v_cvt_pk_bf16_f32 v224, v56, v57
    v_cvt_pk_bf16_f32 v225, v58, v59
    v_cvt_pk_bf16_f32 v248, v52, v53
    v_cvt_pk_bf16_f32 v249, v54, v55
    v_cvt_pk_bf16_f32 v48, v48, v49
    v_accvgpr_write_b32 a234, v48
    v_cvt_pk_bf16_f32 v50, v50, v51
    v_accvgpr_write_b32 a235, v50
    v_cvt_pk_bf16_f32 v226, v44, v45
    v_cvt_pk_bf16_f32 v227, v46, v47
    v_cvt_pk_bf16_f32 v250, v40, v41
    v_cvt_pk_bf16_f32 v251, v42, v43
    v_cvt_pk_bf16_f32 v32, v32, v33
    v_accvgpr_write_b32 a236, v32
    v_cvt_pk_bf16_f32 v34, v34, v35
    v_accvgpr_write_b32 a237, v34
    v_cvt_pk_bf16_f32 v228, v28, v29
    v_cvt_pk_bf16_f32 v229, v30, v31
    v_cvt_pk_bf16_f32 v252, v8, v9
    v_cvt_pk_bf16_f32 v253, v10, v11
    v_mov_b32 v156, 0
    v_mov_b32 v157, 0
    v_mov_b32 v121, 0
    v_add_u32 v230, 0, v158
    ds_write_b128 v230, v[4:7]
    v_add_u32 v135, s49, v135
    v_add_u32 v134, s49, v134
    ds_write2_b64 v230, v[156:157], v[156:157] offset0:2 offset1:3
    ds_write_b128 v230, v[0:3] offset:32
    ds_write2_b64 v230, v[160:161], v[156:157] offset0:6 offset1:7
    ds_write2_b64 v230, v[156:157], v[254:255] offset0:8 offset1:9
    ds_write_b64 v230, v[120:121] offset:88
    ds_read_b128 v[76:79], v137 offset:256
    ds_read_b128 v[56:59], v136 offset:256
    s_waitcnt lgkmcnt(1)
    v_mfma_f32_16x16x32_bf16 v[36:39], a[16:19], v[76:79], v[36:39]
    s_waitcnt lgkmcnt(0)
    v_mfma_f32_16x16x32_bf16 v[36:39], a[20:23], v[56:59], v[36:39]
    s_nop 0
    v_mfma_f32_16x16x16_bf16 v[8:11], v[20:21], v[26:27], v[12:15]
    s_nop 3
    v_mfma_f32_16x16x16_bf16 v[4:7], v[22:23], v[26:27], v[12:15]
    s_nop 0
    v_fma_f32 v121, v36, v36, s41
    v_fmac_f32 v121, v37, v37
    v_mfma_f32_16x16x16_bf16 v[0:3], v[24:25], v[26:27], v[12:15]
    v_cvt_pk_bf16_f32 v8, v8, v9
    v_accvgpr_write_b32 a238, v8
    v_cvt_pk_bf16_f32 v10, v10, v11
    v_mfma_f32_16x16x32_bf16 v[48:51], a[24:27], v[16:19], 0
    v_accvgpr_write_b32 a239, v10
    v_cvt_pk_bf16_f32 v230, v4, v5
    v_mfma_f32_16x16x32_bf16 v[48:51], a[28:31], v[146:149], v[48:51]
    v_cvt_pk_bf16_f32 v231, v6, v7
    v_cvt_pk_bf16_f32 v254, v0, v1
    v_mfma_f32_16x16x32_bf16 v[48:51], a[32:35], v[72:75], v[48:51]
    v_cvt_pk_bf16_f32 v255, v2, v3
    v_fmac_f32 v121, v38, v38
    v_mfma_f32_16x16x32_bf16 v[48:51], a[36:39], v[88:91], v[48:51]
    v_fmac_f32 v121, v39, v39
    v_mfma_f32_16x16x32_bf16 v[48:51], a[40:43], v[76:79], v[48:51]
    v_mfma_f32_16x16x32_bf16 v[48:51], a[44:47], v[56:59], v[48:51]
    s_nop 1
    v_mfma_f32_16x16x32_bf16 v[40:43], a[48:51], v[16:19], 0
    s_nop 2
    v_mfma_f32_16x16x32_bf16 v[40:43], a[52:55], v[146:149], v[40:43]
    s_nop 0
    v_fmac_f32 v121, v48, v48
    v_fmac_f32 v121, v49, v49
    v_mfma_f32_16x16x32_bf16 v[40:43], a[56:59], v[72:75], v[40:43]
    v_fmac_f32 v121, v50, v50
    v_fmac_f32 v121, v51, v51
    v_mfma_f32_16x16x32_bf16 v[40:43], a[60:63], v[88:91], v[40:43]
    v_mfma_f32_16x16x32_bf16 v[40:43], a[64:67], v[76:79], v[40:43]
    v_mfma_f32_16x16x32_bf16 v[40:43], a[68:71], v[56:59], v[40:43]
    s_nop 1
    v_mfma_f32_16x16x32_bf16 v[28:31], a[72:75], v[16:19], 0
    s_nop 2
    v_mfma_f32_16x16x32_bf16 v[28:31], a[76:79], v[146:149], v[28:31]
    s_nop 0
    v_fmac_f32 v121, v40, v40
    v_fmac_f32 v121, v41, v41
    v_mfma_f32_16x16x32_bf16 v[28:31], a[80:83], v[72:75], v[28:31]
    v_fmac_f32 v121, v42, v42
    v_fmac_f32 v121, v43, v43
    v_mfma_f32_16x16x32_bf16 v[28:31], a[84:87], v[88:91], v[28:31]
    v_mfma_f32_16x16x32_bf16 v[28:31], a[88:91], v[76:79], v[28:31]
    v_mfma_f32_16x16x32_bf16 v[28:31], a[92:95], v[56:59], v[28:31]
    s_nop 1
    v_mfma_f32_16x16x32_bf16 v[32:35], a[96:99], v[16:19], 0
    s_nop 2
    v_mfma_f32_16x16x32_bf16 v[32:35], a[100:103], v[146:149], v[32:35]
    s_nop 0
    v_fma_f32 v120, v28, v28, s41
    v_fmac_f32 v120, v29, v29
    v_mfma_f32_16x16x32_bf16 v[32:35], a[104:107], v[72:75], v[32:35]
    v_fmac_f32 v120, v30, v30
    v_fmac_f32 v120, v31, v31
    v_mfma_f32_16x16x32_bf16 v[32:35], a[108:111], v[88:91], v[32:35]
    v_mfma_f32_16x16x32_bf16 v[32:35], a[112:115], v[76:79], v[32:35]
    v_mfma_f32_16x16x32_bf16 v[32:35], a[116:119], v[56:59], v[32:35]
    s_nop 1
    v_mfma_f32_16x16x32_bf16 v[20:23], a[120:123], v[16:19], 0
    s_nop 2
    v_mfma_f32_16x16x32_bf16 v[20:23], a[124:127], v[146:149], v[20:23]
    s_nop 0
    v_fmac_f32 v120, v32, v32
    v_fmac_f32 v120, v33, v33
    v_mfma_f32_16x16x32_bf16 v[20:23], a[128:131], v[72:75], v[20:23]
    v_fmac_f32 v120, v34, v34
    v_fmac_f32 v120, v35, v35
    v_mfma_f32_16x16x32_bf16 v[20:23], a[132:135], v[88:91], v[20:23]
    v_mfma_f32_16x16x32_bf16 v[20:23], a[136:139], v[76:79], v[20:23]
    v_mfma_f32_16x16x32_bf16 v[20:23], a[140:143], v[56:59], v[20:23]
    s_nop 1
    v_mfma_f32_16x16x32_bf16 v[8:11], v[16:19], a[144:147], 0
    s_nop 2
    v_mfma_f32_16x16x32_bf16 v[8:11], v[146:149], a[148:151], v[8:11]
    s_nop 0
    v_fmac_f32 v120, v20, v20
    v_fmac_f32 v120, v21, v21
    v_mfma_f32_16x16x32_bf16 v[8:11], v[72:75], a[152:155], v[8:11]
    v_fmac_f32 v120, v22, v22
    v_fmac_f32 v120, v23, v23
    v_mfma_f32_16x16x32_bf16 v[8:11], v[88:91], a[156:159], v[8:11]
    v_cvt_pk_bf16_f32 v170, v121, v120
    v_mfma_f32_16x16x32_bf16 v[8:11], v[76:79], a[160:163], v[8:11]
    ds_read_b128 v[104:107], v137 offset:1536
    v_mfma_f32_16x16x32_bf16 v[8:11], v[56:59], a[164:167], v[8:11]
    s_nop 0
    ds_read_b128 v[100:103], v136 offset:1536
    s_nop 0
    v_mfma_f32_16x16x16_bf16 v[24:27], v[216:217], v[170:171], 0
    s_nop 0
    ds_read_b128 v[44:47], v137 offset:1664
    s_nop 1
    v_cvt_pk_bf16_f32 v0, v8, v9
    v_mfma_f32_16x16x32_bf16 v[4:7], v[16:19], a[168:171], 0
    ds_read_b128 v[84:87], v136 offset:1664
    v_cvt_pk_bf16_f32 v1, v10, v11
    v_mfma_f32_16x16x32_bf16 v[4:7], v[146:149], a[172:175], v[4:7]
    ds_read_b128 v[68:71], v137 offset:1792
    v_mfma_f32_16x16x32_bf16 v[4:7], v[72:75], a[176:179], v[4:7]
    ds_read_b128 v[64:67], v136 offset:1792
    v_mfma_f32_16x16x32_bf16 v[4:7], v[88:91], a[180:183], v[4:7]
    v_rsq_f32 v24, v24
    v_mfma_f32_16x16x32_bf16 v[4:7], v[76:79], a[184:187], v[4:7]
    v_rsq_f32 v25, v25
    v_mfma_f32_16x16x32_bf16 v[4:7], v[56:59], a[188:191], v[4:7]
    v_mul_f32 v24, s55, v24
    v_mul_f32 v25, 0.5, v25
    v_mfma_f32_16x16x32_bf16 v[12:15], v[16:19], a[192:195], 0
    s_nop 0
    v_mul_f32 v36, v36, v24
    v_mul_f32 v37, v37, v24
    v_mfma_f32_16x16x32_bf16 v[12:15], v[146:149], a[196:199], v[12:15]
    s_nop 0
    v_cvt_pk_bf16_f32 v8, v4, v5
    v_cvt_pk_bf16_f32 v9, v6, v7
    v_mfma_f32_16x16x32_bf16 v[12:15], v[72:75], a[200:203], v[12:15]
    v_cvt_pk_f16_f32 v4, v36, v37
    v_mul_f32 v38, v38, v24
    v_mfma_f32_16x16x32_bf16 v[12:15], v[88:91], a[204:207], v[12:15]
    v_mul_f32 v39, v39, v24
    v_cvt_pk_f16_f32 v5, v38, v39
    v_mfma_f32_16x16x32_bf16 v[12:15], v[76:79], a[208:211], v[12:15]
    v_mul_f32 v48, v48, v24
    v_mul_f32 v49, v49, v24
    v_mfma_f32_16x16x32_bf16 v[12:15], v[56:59], a[212:215], v[12:15]
    s_waitcnt lgkmcnt(0)
    v_cvt_pk_f16_f32 v6, v48, v49
    v_mul_f32 v50, v50, v24
    v_mfma_f32_16x16x32_bf16 v[16:19], a[0:3], v[104:107], 0
    v_mul_f32 v51, v51, v24
    v_cvt_pk_f16_f32 v7, v50, v51
    v_mfma_f32_16x16x32_bf16 v[16:19], a[4:7], v[100:103], v[16:19]
    v_mul_f32 v40, v40, v24
    v_mul_f32 v41, v41, v24
    v_mfma_f32_16x16x32_bf16 v[16:19], a[8:11], v[44:47], v[16:19]
    v_cvt_pk_f16_f32 v152, v40, v41
    v_mul_f32 v42, v42, v24
    v_mfma_f32_16x16x32_bf16 v[16:19], a[12:15], v[84:87], v[16:19]
    v_mul_f32 v43, v43, v24
    v_cvt_pk_f16_f32 v153, v42, v43
    v_mfma_f32_16x16x32_bf16 v[16:19], a[16:19], v[68:71], v[16:19]
    v_mul_f32 v28, v28, v25
    v_mul_f32 v29, v29, v25
    v_mfma_f32_16x16x32_bf16 v[16:19], a[20:23], v[64:67], v[16:19]
    v_cvt_pk_f16_f32 v28, v28, v29
    v_mul_f32 v30, v30, v25
    v_mfma_f32_16x16x32_bf16 v[60:63], a[24:27], v[104:107], 0
    v_mul_f32 v31, v31, v25
    v_cvt_pk_f16_f32 v29, v30, v31
    v_mfma_f32_16x16x32_bf16 v[60:63], a[28:31], v[100:103], v[60:63]
    v_mul_f32 v32, v32, v25
    v_mul_f32 v33, v33, v25
    v_mfma_f32_16x16x32_bf16 v[60:63], a[32:35], v[44:47], v[60:63]
    v_cvt_pk_f16_f32 v30, v32, v33
    v_mul_f32 v34, v34, v25
    v_mfma_f32_16x16x32_bf16 v[60:63], a[36:39], v[84:87], v[60:63]
    v_mul_f32 v35, v35, v25
    v_cvt_pk_f16_f32 v31, v34, v35
    v_mfma_f32_16x16x32_bf16 v[60:63], a[40:43], v[68:71], v[60:63]
    v_mul_f32 v20, v20, v25
    v_mul_f32 v21, v21, v25
    v_mfma_f32_16x16x32_bf16 v[60:63], a[44:47], v[64:67], v[60:63]
    v_cvt_pk_f16_f32 v154, v20, v21
    v_mul_f32 v22, v22, v25
    v_mfma_f32_16x16x32_bf16 v[36:39], a[48:51], v[104:107], 0
    v_mul_f32 v23, v23, v25
    v_cvt_pk_f16_f32 v155, v22, v23
    v_mfma_f32_16x16x32_bf16 v[36:39], a[52:55], v[100:103], v[36:39]
    v_cvt_pk_bf16_f32 v20, v12, v13
    v_cvt_pk_bf16_f32 v21, v14, v15
    v_mfma_f32_16x16x32_bf16 v[36:39], a[56:59], v[44:47], v[36:39]
    v_fma_f32 v2, v16, v16, s41
    v_fmac_f32 v2, v17, v17
    v_mfma_f32_16x16x32_bf16 v[36:39], a[60:63], v[84:87], v[36:39]
    v_fmac_f32 v2, v18, v18
    v_fmac_f32 v2, v19, v19
    v_mfma_f32_16x16x32_bf16 v[36:39], a[64:67], v[68:71], v[36:39]
    v_fmac_f32 v2, v60, v60
    v_fmac_f32 v2, v61, v61
    v_mfma_f32_16x16x32_bf16 v[36:39], a[68:71], v[64:67], v[36:39]
    v_fmac_f32 v2, v62, v62
    v_fmac_f32 v2, v63, v63
    v_mfma_f32_16x16x32_bf16 v[52:55], a[72:75], v[104:107], 0
    s_nop 2
    v_mfma_f32_16x16x32_bf16 v[52:55], a[76:79], v[100:103], v[52:55]
    s_nop 0
    v_fmac_f32 v2, v36, v36
    v_fmac_f32 v2, v37, v37
    v_mfma_f32_16x16x32_bf16 v[52:55], a[80:83], v[44:47], v[52:55]
    v_fmac_f32 v2, v38, v38
    v_fmac_f32 v2, v39, v39
    v_mfma_f32_16x16x32_bf16 v[52:55], a[84:87], v[84:87], v[52:55]
    v_mfma_f32_16x16x32_bf16 v[52:55], a[88:91], v[68:71], v[52:55]
    v_mfma_f32_16x16x32_bf16 v[52:55], a[92:95], v[64:67], v[52:55]
    s_nop 1
    v_mfma_f32_16x16x32_bf16 v[12:15], a[96:99], v[104:107], 0
    s_nop 2
    v_mfma_f32_16x16x32_bf16 v[12:15], a[100:103], v[100:103], v[12:15]
    s_nop 0
    v_fma_f32 v3, v52, v52, s41
    v_fmac_f32 v3, v53, v53
    v_mfma_f32_16x16x32_bf16 v[12:15], a[104:107], v[44:47], v[12:15]
    v_fmac_f32 v3, v54, v54
    v_fmac_f32 v3, v55, v55
    v_mfma_f32_16x16x32_bf16 v[12:15], a[108:111], v[84:87], v[12:15]
    v_mfma_f32_16x16x32_bf16 v[12:15], a[112:115], v[68:71], v[12:15]
    v_mfma_f32_16x16x32_bf16 v[12:15], a[116:119], v[64:67], v[12:15]
    s_sub_u32 s50, s45, s44
    v_add_u32 v135, s48, v135
    v_add_u32 v134, s48, v134
    v_mfma_f32_16x16x32_bf16 v[48:51], a[120:123], v[104:107], 0
    s_sub_u32 s51, s46, s47
    v_add_u32 v133, s51, v133
    v_mfma_f32_16x16x32_bf16 v[48:51], a[124:127], v[100:103], v[48:51]
    s_mov_b32 s60, s59
    v_fmac_f32 v3, v12, v12
    v_fmac_f32 v3, v13, v13
    v_mfma_f32_16x16x32_bf16 v[48:51], a[128:131], v[44:47], v[48:51]
    s_mov_b32 s59, s58
    v_fmac_f32 v3, v14, v14
    v_fmac_f32 v3, v15, v15
    v_mfma_f32_16x16x32_bf16 v[48:51], a[132:135], v[84:87], v[48:51]
    s_mov_b32 s58, s57
    v_mfma_f32_16x16x32_bf16 v[48:51], a[136:139], v[68:71], v[48:51]
    s_mov_b32 s57, s56
    v_mfma_f32_16x16x32_bf16 v[48:51], a[140:143], v[64:67], v[48:51]
    s_mov_b32 s7, s6
    s_nop 0
    v_mfma_f32_16x16x32_bf16 v[24:27], v[104:107], a[144:147], 0
    s_mov_b32 s6, s5
    s_nop 1
    v_mfma_f32_16x16x32_bf16 v[24:27], v[100:103], a[148:151], v[24:27]
    s_mov_b32 s5, s4
    v_fmac_f32 v3, v48, v48
    v_fmac_f32 v3, v49, v49
    v_mfma_f32_16x16x32_bf16 v[24:27], v[44:47], a[152:155], v[24:27]
    s_sub_u32 s14, s6, s7
    v_fmac_f32 v3, v50, v50
    v_fmac_f32 v3, v51, v51
    v_mfma_f32_16x16x32_bf16 v[24:27], v[84:87], a[156:159], v[24:27]
    s_add_u32 s61, s61, 1
    v_cvt_pk_bf16_f32 v170, v2, v3
    v_add_u32 v132, s14, v132
    v_mfma_f32_16x16x32_bf16 v[24:27], v[68:71], a[160:163], v[24:27]
    s_ff1_i32_b32 s15, s66
    ds_read_b128 v[96:99], v137 offset:3072
    v_add_u32 v131, s14, v131
    v_mfma_f32_16x16x32_bf16 v[24:27], v[64:67], a[164:167], v[24:27]
    s_cmp_lg_u32 s66, 0
    ds_read_b128 v[92:95], v136 offset:3072
    v_add_u32 v123, s14, v123
    v_mfma_f32_16x16x16_bf16 v[40:43], v[216:217], v[170:171], 0
    s_cselect_b32 s12, s15, s12
    ds_read_b128 v[88:91], v137 offset:3200
    s_nop 1
    v_cvt_pk_bf16_f32 v2, v24, v25
    v_mfma_f32_16x16x32_bf16 v[72:75], v[104:107], a[168:171], 0
    s_cmp_lt_u32 s61, s71
    ds_read_b128 v[80:83], v136 offset:3200
    v_cvt_pk_bf16_f32 v3, v26, v27
    v_mfma_f32_16x16x32_bf16 v[72:75], v[100:103], a[172:175], v[72:75]
    s_cselect_b32 s15, 31, s15
    ds_read_b128 v[56:59], v137 offset:3328
    v_add_u32 v137, s50, v137
    v_mfma_f32_16x16x32_bf16 v[72:75], v[44:47], a[176:179], v[72:75]
    s_bitset0_b32 s66, s15
    ds_read_b128 v[24:27], v136 offset:3328
    v_add_u32 v136, s50, v136
    v_mfma_f32_16x16x32_bf16 v[72:75], v[84:87], a[180:183], v[72:75]
    s_add_u32 s12, s12, 20
    v_rsq_f32 v40, v40
    v_mfma_f32_16x16x32_bf16 v[72:75], v[68:71], a[184:187], v[72:75]
    s_max_u32 s12, s12, s61
    v_rsq_f32 v41, v41
    v_mfma_f32_16x16x32_bf16 v[72:75], v[64:67], a[188:191], v[72:75]
    s_cmp_lt_u32 s61, s71
    v_mul_f32 v40, s55, v40
    v_mul_f32 v41, 0.5, v41
    v_mfma_f32_16x16x32_bf16 v[32:35], v[104:107], a[192:195], 0
    s_cselect_b32 s15, s61, s12
    v_mul_f32 v16, v16, v40
    v_mul_f32 v17, v17, v40
    v_mfma_f32_16x16x32_bf16 v[32:35], v[100:103], a[196:199], v[32:35]
    s_cselect_b32 s56, s69, s70
    v_cvt_pk_bf16_f32 v10, v72, v73
    v_cvt_pk_bf16_f32 v11, v74, v75
    v_mfma_f32_16x16x32_bf16 v[32:35], v[44:47], a[200:203], v[32:35]
    s_add_u32 s56, s56, s15
    v_cvt_pk_f16_f32 v44, v16, v17
    v_mul_f32 v18, v18, v40
    v_mfma_f32_16x16x32_bf16 v[32:35], v[84:87], a[204:207], v[32:35]
    s_mul_i32 s53, s56, 58255
    v_mul_f32 v19, v19, v40
    v_cvt_pk_f16_f32 v45, v18, v19
    v_mfma_f32_16x16x32_bf16 v[32:35], v[68:71], a[208:211], v[32:35]
    s_waitcnt lgkmcnt(0)
    s_lshr_b32 s53, s53, 22
    v_mul_f32 v60, v60, v40
    v_mul_f32 v61, v61, v40
    v_mfma_f32_16x16x32_bf16 v[32:35], v[64:67], a[212:215], v[32:35]
    s_barrier
    v_cvt_pk_f16_f32 v46, v60, v61
    v_mul_f32 v62, v62, v40
    v_mfma_f32_16x16x32_bf16 v[16:19], a[0:3], v[96:99], 0
    s_mul_i32 s53, s53, s63
    v_mul_f32 v63, v63, v40
    v_cvt_pk_f16_f32 v47, v62, v63
    v_mfma_f32_16x16x32_bf16 v[16:19], a[4:7], v[92:95], v[16:19]
    s_mul_i32 s56, s56, s62
    v_mul_f32 v36, v36, v40
    v_mul_f32 v37, v37, v40
    v_mfma_f32_16x16x32_bf16 v[16:19], a[8:11], v[88:91], v[16:19]
    s_add_u32 s56, s56, s53
    v_cvt_pk_f16_f32 v146, v36, v37
    v_mul_f32 v38, v38, v40
    v_mfma_f32_16x16x32_bf16 v[16:19], a[12:15], v[80:83], v[16:19]
    s_mul_i32 s4, s15, 112
    v_mul_f32 v39, v39, v40
    v_cvt_pk_f16_f32 v147, v38, v39
    v_mfma_f32_16x16x32_bf16 v[16:19], a[16:19], v[56:59], v[16:19]
    s_cmp_ge_u32 s15, 16
    v_mul_f32 v52, v52, v41
    v_mul_f32 v53, v53, v41
    v_mfma_f32_16x16x32_bf16 v[16:19], a[20:23], v[24:27], v[16:19]
    s_cselect_b32 s53, -30464, 0
    v_cvt_pk_f16_f32 v72, v52, v53
    v_mul_f32 v54, v54, v41
    v_mfma_f32_16x16x32_bf16 v[36:39], a[24:27], v[96:99], 0
    s_add_u32 s4, s4, s53
    v_mul_f32 v55, v55, v41
    v_cvt_pk_f16_f32 v73, v54, v55
    v_mfma_f32_16x16x32_bf16 v[36:39], a[28:31], v[92:95], v[36:39]
    s_cmp_lt_u32 s15, s73
    v_mul_f32 v12, v12, v41
    v_mul_f32 v13, v13, v41
    v_mfma_f32_16x16x32_bf16 v[36:39], a[32:35], v[88:91], v[36:39]
    s_cselect_b32 s26, 100270464, 0
    v_cvt_pk_f16_f32 v74, v12, v13
    v_mul_f32 v14, v14, v41
    v_mfma_f32_16x16x32_bf16 v[36:39], a[36:39], v[80:83], v[36:39]
    s_cselect_b32 s56, s56, 0
    v_mul_f32 v15, v15, v41
    v_cvt_pk_f16_f32 v75, v14, v15
    v_mfma_f32_16x16x32_bf16 v[36:39], a[40:43], v[56:59], v[36:39]
    s_cselect_b32 s4, s4, -1
    v_mul_f32 v48, v48, v41
    v_mul_f32 v49, v49, v41
    v_mfma_f32_16x16x32_bf16 v[36:39], a[44:47], v[24:27], v[36:39]
    s_cselect_b32 s15, s15, 0
    v_cvt_pk_f16_f32 v148, v48, v49
    v_mul_f32 v50, v50, v41
    v_mfma_f32_16x16x32_bf16 v[12:15], a[48:51], v[96:99], 0
    s_cselect_b32 s13, s13, -1
    v_mul_f32 v51, v51, v41
    v_cvt_pk_f16_f32 v149, v50, v51
    v_mfma_f32_16x16x32_bf16 v[12:15], a[52:55], v[92:95], v[12:15]
    s_bitset1_b32 s64, s15
    v_cvt_pk_bf16_f32 v22, v32, v33
    v_cvt_pk_bf16_f32 v23, v34, v35
    v_mfma_f32_16x16x32_bf16 v[12:15], a[56:59], v[88:91], v[12:15]
    s_add_u32 s65, s65, 1
    v_fma_f32 v156, v16, v16, s41
    v_fmac_f32 v156, v17, v17
    v_mfma_f32_16x16x32_bf16 v[12:15], a[60:63], v[80:83], v[12:15]
    s_cmp_ge_i32 s65, 2
    v_fmac_f32 v156, v18, v18
    v_fmac_f32 v156, v19, v19
    v_mfma_f32_16x16x32_bf16 v[12:15], a[64:67], v[56:59], v[12:15]
    s_cselect_b32 s30, 100270464, 0
    v_fmac_f32 v156, v36, v36
    v_fmac_f32 v156, v37, v37
    v_mfma_f32_16x16x32_bf16 v[12:15], a[68:71], v[24:27], v[12:15]
    s_add_u32 s67, s46, s54
    v_fmac_f32 v156, v38, v38
    v_fmac_f32 v156, v39, v39
    v_mfma_f32_16x16x32_bf16 v[64:67], a[72:75], v[96:99], 0
    s_add_u32 m0, s67, 0
    v_and_b32 v120, -8, v123
    v_mfma_f32_16x16x32_bf16 v[64:67], a[76:79], v[92:95], v[64:67]
    buffer_load_dwordx4 v128, s[24:27], s56 offen nt lds
    v_fmac_f32 v156, v12, v12
    v_mfma_f32_16x16x32_bf16 v[64:67], a[80:83], v[88:91], v[64:67]
    s_add_u32 m0, s67, 1024
    v_fmac_f32 v156, v13, v13
    v_fmac_f32 v156, v14, v14
    v_mfma_f32_16x16x32_bf16 v[64:67], a[84:87], v[80:83], v[64:67]
    buffer_load_dwordx4 v127, s[24:27], s56 offen nt lds
    v_fmac_f32 v156, v15, v15
    v_mfma_f32_16x16x32_bf16 v[64:67], a[88:91], v[56:59], v[64:67]
    s_add_u32 m0, s67, 2048
    v_mfma_f32_16x16x32_bf16 v[64:67], a[92:95], v[24:27], v[64:67]
    buffer_load_dwordx4 v126, s[24:27], s56 offen nt lds
    v_mfma_f32_16x16x32_bf16 v[32:35], a[96:99], v[96:99], 0
    s_add_u32 m0, s67, 3072
    s_nop 1
    v_mfma_f32_16x16x32_bf16 v[32:35], a[100:103], v[92:95], v[32:35]
    s_nop 0
    buffer_load_dwordx4 v125, s[24:27], s56 offen nt lds
    v_fma_f32 v121, v64, v64, s41
    v_mfma_f32_16x16x32_bf16 v[32:35], a[104:107], v[88:91], v[32:35]
    s_add_u32 m0, s67, 4096
    v_fmac_f32 v121, v65, v65
    v_fmac_f32 v121, v66, v66
    v_mfma_f32_16x16x32_bf16 v[32:35], a[108:111], v[80:83], v[32:35]
    buffer_load_dwordx4 v124, s[24:27], s56 offen nt lds
    v_fmac_f32 v121, v67, v67
    v_mfma_f32_16x16x32_bf16 v[32:35], a[112:115], v[56:59], v[32:35]
    v_mfma_f32_16x16x32_bf16 v[32:35], a[116:119], v[24:27], v[32:35]
    s_nop 1
    v_mfma_f32_16x16x32_bf16 v[40:43], a[120:123], v[96:99], 0
    s_nop 2
    v_mfma_f32_16x16x32_bf16 v[40:43], a[124:127], v[92:95], v[40:43]
    s_mov_b32 s53, s47
    v_fmac_f32 v121, v32, v32
    v_fmac_f32 v121, v33, v33
    v_mfma_f32_16x16x32_bf16 v[40:43], a[128:131], v[88:91], v[40:43]
    s_mov_b32 s47, s46
    v_fmac_f32 v121, v34, v34
    v_fmac_f32 v121, v35, v35
    v_mfma_f32_16x16x32_bf16 v[40:43], a[132:135], v[80:83], v[40:43]
    s_mov_b32 s46, s45
    v_mfma_f32_16x16x32_bf16 v[40:43], a[136:139], v[56:59], v[40:43]
    s_mov_b32 s45, s44
    v_mfma_f32_16x16x32_bf16 v[40:43], a[140:143], v[24:27], v[40:43]
    s_mov_b32 s44, s53
    s_nop 0
    v_mfma_f32_16x16x32_bf16 v[68:71], v[96:99], a[144:147], 0
    s_sub_u32 s48, s44, s46
    v_add_u32 v137, s48, v137
    v_add_u32 v136, s48, v136
    v_mfma_f32_16x16x32_bf16 v[68:71], v[92:95], a[148:151], v[68:71]
    s_sub_u32 s49, s46, s45
    v_fmac_f32 v121, v40, v40
    v_fmac_f32 v121, v41, v41
    v_mfma_f32_16x16x32_bf16 v[68:71], v[88:91], a[152:155], v[68:71]
    v_fmac_f32 v121, v42, v42
    v_fmac_f32 v121, v43, v43
    v_mfma_f32_16x16x32_bf16 v[68:71], v[80:83], a[156:159], v[68:71]
    v_cvt_pk_bf16_f32 v170, v156, v121
    v_mfma_f32_16x16x32_bf16 v[68:71], v[56:59], a[160:163], v[68:71]
    ds_read_b128 v[60:63], v132 offset:0
    v_mfma_f32_16x16x32_bf16 v[68:71], v[24:27], a[164:167], v[68:71]
    s_nop 0
    ds_read_b128 v[52:55], v132 offset:16
    s_nop 0
    v_mfma_f32_16x16x16_bf16 v[76:79], v[216:217], v[170:171], 0
    s_nop 0
    ds_read_b128 v[48:51], v132 offset:48
    s_nop 1
    v_cvt_pk_bf16_f32 v164, v68, v69
    v_mfma_f32_16x16x32_bf16 v[84:87], v[96:99], a[168:171], 0
    v_cvt_pk_bf16_f32 v165, v70, v71
    v_mfma_f32_16x16x32_bf16 v[84:87], v[92:95], a[172:175], v[84:87]
    v_rsq_f32 v76, v76
    v_mfma_f32_16x16x32_bf16 v[84:87], v[88:91], a[176:179], v[84:87]
    v_rsq_f32 v77, v77
    v_mfma_f32_16x16x32_bf16 v[84:87], v[80:83], a[180:183], v[84:87]
    v_mul_f32 v76, s55, v76
    v_mul_f32 v77, 0.5, v77
    v_mfma_f32_16x16x32_bf16 v[84:87], v[56:59], a[184:187], v[84:87]
    v_mul_f32 v64, v64, v77
    v_mul_f32 v65, v65, v77
    v_mfma_f32_16x16x32_bf16 v[84:87], v[24:27], a[188:191], v[84:87]
    v_cvt_pk_f16_f32 v64, v64, v65
    v_mul_f32 v66, v66, v77
    v_mfma_f32_16x16x32_bf16 v[68:71], v[96:99], a[192:195], 0
    s_nop 0
    v_mul_f32 v67, v67, v77
    v_cvt_pk_f16_f32 v65, v66, v67
    v_mfma_f32_16x16x32_bf16 v[68:71], v[92:95], a[196:199], v[68:71]
    s_nop 0
    v_cvt_pk_bf16_f32 v160, v84, v85
    v_cvt_pk_bf16_f32 v161, v86, v87
    v_mfma_f32_16x16x32_bf16 v[68:71], v[88:91], a[200:203], v[68:71]
    v_mul_f32 v32, v32, v77
    v_mul_f32 v33, v33, v77
    v_mfma_f32_16x16x32_bf16 v[68:71], v[80:83], a[204:207], v[68:71]
    v_cvt_pk_f16_f32 v66, v32, v33
    v_mul_f32 v34, v34, v77
    v_mfma_f32_16x16x32_bf16 v[68:71], v[56:59], a[208:211], v[68:71]
    v_mul_f32 v35, v35, v77
    v_cvt_pk_f16_f32 v67, v34, v35
    v_mfma_f32_16x16x32_bf16 v[68:71], v[24:27], a[212:215], v[68:71]
    v_mul_f32 v40, v40, v77
    v_mul_f32 v41, v41, v77
    v_mfma_f32_16x16x32_f16 v[32:35], v[28:31], v[4:7], v[204:207]
    ds_read_u16 v166, v131 offset:80
    v_cvt_pk_f16_f32 v142, v40, v41
    v_mfma_f32_16x16x32_f16 v[32:35], v[152:155], v[150:153], v[32:35]
    ds_read_u16 v162, v131 offset:96
    v_mul_f32 v42, v42, v77
    v_mfma_f32_16x16x32_f16 v[24:27], v[72:75], v[4:7], v[200:203]
    ds_read_u16 v158, v131 offset:104
    v_mul_f32 v43, v43, v77
    v_mfma_f32_16x16x32_f16 v[24:27], v[146:149], v[150:153], v[24:27]
    s_waitcnt lgkmcnt(3)
    ds_read_b32 v120, v120 offset:64
    v_cvt_pk_f16_f32 v143, v42, v43
    v_mfma_f32_16x16x32_f16 v[56:59], v[60:63], v[4:7], v[208:211]
    v_mul_f32 v16, v16, v76
    v_mul_f32 v17, v17, v76
    v_mfma_f32_16x16x32_f16 v[56:59], v[52:55], v[28:31], v[56:59]
    v_cvt_pk_f16_f32 v16, v16, v17
    v_mul_f32 v18, v18, v76
    v_mfma_f32_16x16x32_f16 v[56:59], v[48:51], v[152:155], v[56:59]
    v_mul_f32 v19, v19, v76
    v_cvt_pk_f16_f32 v17, v18, v19
    v_mfma_f32_16x16x32_f16 v[40:43], v[60:63], v[44:47], v[208:211]
    v_mul_f32 v36, v36, v76
    v_mul_f32 v37, v37, v76
    v_mfma_f32_16x16x32_f16 v[40:43], v[52:55], v[72:75], v[40:43]
    v_cvt_pk_f16_f32 v18, v36, v37
    v_mul_f32 v38, v38, v76
    v_mfma_f32_16x16x32_f16 v[40:43], v[48:51], v[146:149], v[40:43]
    v_mul_f32 v39, v39, v76
    v_cvt_pk_f16_f32 v19, v38, v39
    v_mfma_f32_16x16x32_f16 v[36:39], v[28:31], v[44:47], v[192:195]
    v_mul_f32 v12, v12, v76
    v_mul_f32 v13, v13, v76
    v_mfma_f32_16x16x32_f16 v[36:39], v[152:155], v[144:147], v[36:39]
    v_cvt_pk_f16_f32 v140, v12, v13
    v_mul_f32 v14, v14, v76
    v_mul_f32 v15, v15, v76
    v_cvt_pk_f16_f32 v141, v14, v15
    v_mfma_f32_16x16x32_f16 v[12:15], v[64:67], v[4:7], v[196:199]
    v_cvt_pk_bf16_f32 v156, v68, v69
    v_cvt_pk_bf16_f32 v157, v70, v71
    v_mfma_f32_16x16x32_f16 v[12:15], v[140:143], v[150:153], v[12:15]
    v_max3_f32 v121, v32, v33, v34
    v_max3_f32 v121, v121, v35, v24
    v_mfma_f32_16x16x32_f16 v[4:7], v[60:63], v[16:19], v[208:211]
    s_nop 0
    v_max3_f32 v121, v121, v25, v26
    v_mov_b32_dpp v59, v43 quad_perm:[0,1,2,3] row_mask:0x2 bank_mask:0xf
    v_mfma_f32_16x16x32_f16 v[4:7], v[52:55], v[64:67], v[4:7]
    s_nop 0
    v_max3_f32 v121, v121, v27, v12
    v_max3_f32 v121, v121, v13, v14
    v_mfma_f32_16x16x32_f16 v[4:7], v[48:51], v[140:143], v[4:7]
    v_max3_f32 v121, v121, v15, v56
    v_mov_b32 v57, v121
    v_mfma_f32_16x16x32_f16 v[52:55], v[72:75], v[44:47], v[188:191]
    s_nop 0
    v_permlane32_swap_b32 v57, v121
    v_mfma_f32_16x16x32_f16 v[52:55], v[146:149], v[144:147], v[52:55]
    v_max_f32 v121, v57, v121
    v_mov_b32 v57, v121
    v_mfma_f32_16x16x32_f16 v[48:51], v[64:67], v[44:47], v[184:187]
    s_nop 0
    v_permlane16_swap_b32 v57, v121
    v_mfma_f32_16x16x32_f16 v[48:51], v[140:143], v[144:147], v[48:51]
    v_max_f32 v121, v57, v121
    v_sub_f32 v32, v32, v121
    v_sub_f32 v33, v33, v121
    v_sub_f32 v34, v34, v121
    v_sub_f32 v35, v35, v121
    v_sub_f32 v24, v24, v121
    v_sub_f32 v25, v25, v121
    v_sub_f32 v26, v26, v121
    v_sub_f32 v27, v27, v121
    v_sub_f32 v12, v12, v121
    v_sub_f32 v13, v13, v121
    v_sub_f32 v14, v14, v121
    v_sub_f32 v15, v15, v121
    v_sub_f32 v56, v56, v121
    v_exp_f32 v32, v32
    v_exp_f32 v33, v33
    v_exp_f32 v34, v34
    v_exp_f32 v35, v35
    v_cvt_pk_bf16_f32 v60, v32, v33
    v_cvt_pk_bf16_f32 v61, v34, v35
    v_exp_f32 v24, v24
    v_exp_f32 v25, v25
    v_exp_f32 v26, v26
    v_exp_f32 v27, v27
    v_cvt_pk_bf16_f32 v62, v24, v25
    v_cvt_pk_bf16_f32 v63, v26, v27
    v_exp_f32 v12, v12
    v_exp_f32 v13, v13
    v_exp_f32 v14, v14
    v_exp_f32 v15, v15
    v_cvt_pk_bf16_f32 v168, v12, v13
    v_cvt_pk_bf16_f32 v169, v14, v15
    v_exp_f32 v56, v56
    v_mov_b32_dpp v59, v7 quad_perm:[0,1,2,3] row_mask:0x4 bank_mask:0xf
    v_cvt_pk_bf16_f32 v170, v56, 0
    v_mfma_f32_16x16x32_bf16 v[44:47], v[220:223], v[60:63], 0
    s_waitcnt lgkmcnt(0)
    v_and_b32 v121, 0xffff0000, v120
    v_lshlrev_b32 v120, 16, v120
    v_mfma_f32_16x16x32_bf16 v[44:47], v[220:223], v[168:171], v[44:47]
    v_add_f32 v120, v120, v121
    v_add_f32 v120, v120, v211
    v_mfma_f32_16x16x32_bf16 v[12:15], v[0:3], v[60:63], 0
    s_nop 0
    v_mov_b32_dpp v59, v120 quad_perm:[0,1,2,3] row_mask:0x8 bank_mask:0xf
    v_mov_b32 v4, v59
    v_mfma_f32_16x16x32_bf16 v[12:15], v[164:167], v[168:171], v[12:15]
    s_nop 0
    v_max_f32_dpp v4, v4, v4 row_ror:8 row_mask:0xf bank_mask:0xf
    v_max3_f32 v121, v36, v37, v38
    v_mfma_f32_16x16x32_bf16 v[24:27], v[8:11], v[60:63], 0
    v_max_f32_dpp v4, v4, v4 row_ror:4 row_mask:0xf bank_mask:0xf
    v_max3_f32 v121, v121, v39, v52
    v_mfma_f32_16x16x32_bf16 v[24:27], v[160:163], v[168:171], v[24:27]
    v_max_f32_dpp v4, v4, v4 row_ror:2 row_mask:0xf bank_mask:0xf
    v_max3_f32 v121, v121, v53, v54
    v_mfma_f32_16x16x32_bf16 v[32:35], v[20:23], v[60:63], 0
    v_max_f32_dpp v4, v4, v4 row_ror:1 row_mask:0xf bank_mask:0xf
    v_mov_b32 v120, v4
    v_mfma_f32_16x16x32_bf16 v[32:35], v[156:159], v[168:171], v[32:35]
    s_nop 0
    v_permlane32_swap_b32 v120, v4
    v_max_f32 v4, v120, v4
    v_mov_b32 v120, v4
    v_rcp_f32 v44, v44
    v_max3_f32 v121, v121, v55, v48
    v_permlane16_swap_b32 v120, v4
    v_max_f32 v4, v120, v4
    v_sub_f32 v59, v59, v4
    v_exp_f32 v59, v59
    v_mul_f32 v12, v12, v44
    v_cvt_pk_bf16_f32 v59, v59, v59
    ds_write_b16 v123, v59 offset:64
    v_mul_f32 v13, v13, v44
    v_cvt_pk_bf16_f32 v68, v12, v13
    ds_read_b128 v[60:63], v132 offset:48
    v_mul_f32 v14, v14, v44
    v_mul_f32 v15, v15, v44
    v_cvt_pk_bf16_f32 v69, v14, v15
    ds_read_b128 v[56:59], v132 offset:64
    v_mfma_f32_16x16x32_f16 v[12:15], v[28:31], v[16:19], v[180:183]
    v_mul_f32 v24, v24, v44
    v_mul_f32 v25, v25, v44
    v_mfma_f32_16x16x32_f16 v[12:15], v[152:155], v[138:141], v[12:15]
    ds_write_b64 v135, v[68:69] offset:0
    v_mfma_f32_16x16x32_f16 v[28:31], v[72:75], v[16:19], v[176:179]
    v_cvt_pk_bf16_f32 v70, v24, v25
    v_mul_f32 v26, v26, v44
    v_mfma_f32_16x16x32_f16 v[28:31], v[146:149], v[138:141], v[28:31]
    v_mul_f32 v27, v27, v44
    v_cvt_pk_bf16_f32 v71, v26, v27
    v_mfma_f32_16x16x32_f16 v[24:27], v[64:67], v[16:19], v[172:175]
    ds_write_b64 v135, v[70:71] offset:8
    v_mfma_f32_16x16x32_f16 v[24:27], v[140:143], v[138:141], v[24:27]
    s_waitcnt lgkmcnt(3)
    v_mul_f32 v32, v32, v44
    v_mul_f32 v33, v33, v44
    v_cvt_pk_bf16_f32 v146, v32, v33
    v_mul_f32 v34, v34, v44
    v_mfma_f32_16x16x32_bf16 v[16:19], v[60:63], v[0:3], 0
    s_waitcnt lgkmcnt(2)
    v_mul_f32 v35, v35, v44
    v_cvt_pk_bf16_f32 v147, v34, v35
    v_max3_f32 v121, v121, v49, v50
    v_max3_f32 v121, v121, v51, v41
    v_mfma_f32_16x16x32_bf16 v[16:19], v[56:59], v[164:167], v[16:19]
    ds_write_b64 v134, v[146:147] offset:0
    v_mfma_f32_16x16x32_bf16 v[44:47], v[60:63], v[8:11], 0
    v_mov_b32 v146, v121
    v_max3_f32 v120, v12, v13, v14
    v_mfma_f32_16x16x32_bf16 v[44:47], v[56:59], v[160:163], v[44:47]
    v_permlane32_swap_b32 v146, v121
    v_mfma_f32_16x16x32_bf16 v[32:35], v[60:63], v[20:23], 0
    v_max_f32 v121, v146, v121
    v_mov_b32 v146, v121
    v_mfma_f32_16x16x32_bf16 v[32:35], v[56:59], v[156:159], v[32:35]
    s_nop 0
    v_permlane16_swap_b32 v146, v121
    v_max_f32 v121, v146, v121
    v_sub_f32 v36, v36, v121
    v_sub_f32 v37, v37, v121
    v_sub_f32 v38, v38, v121
    v_sub_f32 v39, v39, v121
    v_sub_f32 v52, v52, v121
    v_sub_f32 v53, v53, v121
    v_sub_f32 v54, v54, v121
    v_sub_f32 v55, v55, v121
    v_sub_f32 v48, v48, v121
    v_sub_f32 v49, v49, v121
    v_sub_f32 v50, v50, v121
    v_sub_f32 v51, v51, v121
    v_sub_f32 v41, v41, v121
    v_exp_f32 v36, v36
    v_exp_f32 v37, v37
    v_exp_f32 v38, v38
    v_exp_f32 v39, v39
    v_cvt_pk_bf16_f32 v36, v36, v37
    v_cvt_pk_bf16_f32 v37, v38, v39
    v_exp_f32 v52, v52
    v_exp_f32 v53, v53
    v_exp_f32 v54, v54
    v_exp_f32 v55, v55
    v_cvt_pk_bf16_f32 v38, v52, v53
    v_cvt_pk_bf16_f32 v39, v54, v55
    v_exp_f32 v48, v48
    v_exp_f32 v49, v49
    v_exp_f32 v50, v50
    v_exp_f32 v51, v51
    v_cvt_pk_bf16_f32 v168, v48, v49
    v_cvt_pk_bf16_f32 v169, v50, v51
    v_exp_f32 v41, v41
    v_mov_b32_dpp v19, v47 quad_perm:[0,1,2,3] row_mask:0x2 bank_mask:0xf
    v_cvt_pk_bf16_f32 v170, v41, 0
    v_mfma_f32_16x16x32_bf16 v[44:47], v[220:223], v[36:39], 0
    v_mov_b32_dpp v19, v35 quad_perm:[0,1,2,3] row_mask:0x4 bank_mask:0xf
    v_cvt_pk_bf16_f32 v19, v19, v19
    v_mfma_f32_16x16x32_bf16 v[44:47], v[220:223], v[168:171], v[44:47]
    ds_write_b16 v131, v19
    v_mfma_f32_16x16x32_bf16 v[32:35], v[0:3], v[36:39], 0
    ds_read_b128 v[16:19], v137 offset:0
    v_max3_f32 v120, v120, v15, v28
    v_mfma_f32_16x16x32_bf16 v[32:35], v[164:167], v[168:171], v[32:35]
    ds_read_b128 v[146:149], v136 offset:0
    v_max3_f32 v120, v120, v29, v30
    v_mfma_f32_16x16x32_bf16 v[48:51], v[8:11], v[36:39], 0
    ds_read_b128 v[72:75], v137 offset:128
    v_max3_f32 v120, v120, v31, v24
    v_mfma_f32_16x16x32_bf16 v[48:51], v[160:163], v[168:171], v[48:51]
    ds_read_b128 v[88:91], v136 offset:128
    v_max3_f32 v120, v120, v25, v26
    v_mfma_f32_16x16x32_bf16 v[40:43], v[20:23], v[36:39], 0
    ds_read_b128 v[76:79], v137 offset:256
    v_max3_f32 v120, v120, v27, v6
    v_mfma_f32_16x16x32_bf16 v[40:43], v[156:159], v[168:171], v[40:43]
    ds_read_b128 v[56:59], v136 offset:256
    v_mov_b32 v121, v120
    v_rcp_f32 v44, v44
    s_nop 0
    v_mul_f32 v32, v32, v44
    v_mul_f32 v33, v33, v44
    v_cvt_pk_bf16_f32 v32, v32, v33
    v_mul_f32 v34, v34, v44
    v_mul_f32 v35, v35, v44
    v_cvt_pk_bf16_f32 v33, v34, v35
    v_mul_f32 v48, v48, v44
    v_mul_f32 v49, v49, v44
    v_cvt_pk_bf16_f32 v34, v48, v49
    v_mul_f32 v50, v50, v44
    s_waitcnt lgkmcnt(5)
    v_mfma_f32_16x16x32_bf16 v[36:39], a[0:3], v[16:19], 0
    ds_write_b64 v135, v[32:33] offset:1536
    v_mul_f32 v51, v51, v44
    v_cvt_pk_bf16_f32 v35, v50, v51
    v_mul_f32 v40, v40, v44
    v_mul_f32 v41, v41, v44
    v_cvt_pk_bf16_f32 v4, v40, v41
    v_mul_f32 v42, v42, v44
    v_mul_f32 v43, v43, v44
    v_cvt_pk_bf16_f32 v5, v42, v43
    ds_write_b64 v135, v[34:35] offset:1544
    v_permlane32_swap_b32 v121, v120
    v_max_f32 v120, v121, v120
    v_mov_b32 v121, v120
    s_nop 0
    ds_write_b64 v134, v[4:5] offset:1536
    v_permlane16_swap_b32 v121, v120
    v_max_f32 v120, v121, v120
    v_sub_f32 v12, v12, v120
    v_sub_f32 v13, v13, v120
    v_sub_f32 v14, v14, v120
    v_sub_f32 v15, v15, v120
    v_sub_f32 v28, v28, v120
    v_sub_f32 v29, v29, v120
    v_sub_f32 v30, v30, v120
    v_sub_f32 v31, v31, v120
    v_sub_f32 v24, v24, v120
    v_sub_f32 v25, v25, v120
    v_sub_f32 v26, v26, v120
    v_sub_f32 v27, v27, v120
    v_sub_f32 v6, v6, v120
    v_exp_f32 v12, v12
    v_exp_f32 v13, v13
    v_exp_f32 v14, v14
    v_exp_f32 v15, v15
    v_cvt_pk_bf16_f32 v12, v12, v13
    v_cvt_pk_bf16_f32 v13, v14, v15
    v_exp_f32 v28, v28
    v_exp_f32 v29, v29
    v_exp_f32 v30, v30
    v_exp_f32 v31, v31
    v_cvt_pk_bf16_f32 v14, v28, v29
    v_cvt_pk_bf16_f32 v15, v30, v31
    v_exp_f32 v24, v24
    v_exp_f32 v25, v25
    v_exp_f32 v26, v26
    v_exp_f32 v27, v27
    v_cvt_pk_bf16_f32 v168, v24, v25
    v_cvt_pk_bf16_f32 v169, v26, v27
    v_exp_f32 v6, v6
    s_nop 0
    v_cvt_pk_bf16_f32 v170, v6, 0
    v_mfma_f32_16x16x32_bf16 v[152:155], v[220:223], v[12:15], 0
    s_nop 0
    v_mfma_f32_16x16x32_bf16 v[152:155], v[220:223], v[168:171], v[152:155]
    s_nop 1
    v_mfma_f32_16x16x32_bf16 v[4:7], v[0:3], v[12:15], 0
    s_nop 2
    v_mfma_f32_16x16x32_bf16 v[4:7], v[164:167], v[168:171], v[4:7]
    s_nop 0
    v_rcp_f32 v152, v152
    v_mfma_f32_16x16x32_bf16 v[0:3], v[8:11], v[12:15], 0
    s_nop 2
    v_mfma_f32_16x16x32_bf16 v[0:3], v[160:163], v[168:171], v[0:3]
    s_nop 0
    v_mul_f32 v4, v4, v152
    v_mul_f32 v5, v5, v152
    v_mfma_f32_16x16x32_bf16 v[8:11], v[20:23], v[12:15], 0
    v_cvt_pk_bf16_f32 v12, v4, v5
    v_mul_f32 v6, v6, v152
    v_mfma_f32_16x16x32_bf16 v[8:11], v[156:159], v[168:171], v[8:11]
    v_mul_f32 v7, v7, v152
    v_cvt_pk_bf16_f32 v13, v6, v7
    s_waitcnt lgkmcnt(0)
.p2align 6
L_loopS0:
    v_mfma_f32_16x16x32_bf16 v[36:39], a[4:7], v[146:149], v[36:39]
    ds_write_b64 v135, v[12:13] offset:3072
    v_mfma_f32_16x16x32_bf16 v[36:39], a[8:11], v[72:75], v[36:39]
    v_mul_f32 v0, v0, v152
    v_mul_f32 v1, v1, v152
    v_mfma_f32_16x16x32_bf16 v[36:39], a[12:15], v[88:91], v[36:39]
    v_cvt_pk_bf16_f32 v14, v0, v1
    v_mul_f32 v2, v2, v152
    v_mfma_f32_16x16x32_bf16 v[36:39], a[16:19], v[76:79], v[36:39]
    v_mul_f32 v3, v3, v152
    v_cvt_pk_bf16_f32 v15, v2, v3
    v_mfma_f32_16x16x32_bf16 v[36:39], a[20:23], v[56:59], v[36:39]
    ds_write_b64 v135, v[14:15] offset:3080
    v_mfma_f32_16x16x32_bf16 v[12:15], a[24:27], v[16:19], 0
    v_mul_f32 v8, v8, v152
    v_mul_f32 v9, v9, v152
    v_mfma_f32_16x16x32_bf16 v[12:15], a[28:31], v[146:149], v[12:15]
    v_cvt_pk_bf16_f32 v8, v8, v9
    v_mul_f32 v10, v10, v152
    v_mfma_f32_16x16x32_bf16 v[12:15], a[32:35], v[72:75], v[12:15]
    v_mul_f32 v11, v11, v152
    v_cvt_pk_bf16_f32 v9, v10, v11
    v_mfma_f32_16x16x32_bf16 v[12:15], a[36:39], v[88:91], v[12:15]
    ds_write_b64 v134, v[8:9] offset:3072
    v_mfma_f32_16x16x32_bf16 v[12:15], a[40:43], v[76:79], v[12:15]
    v_fma_f32 v170, v40, v40, s42
    v_fmac_f32 v170, v41, v41
    v_mfma_f32_16x16x32_bf16 v[12:15], a[44:47], v[56:59], v[12:15]
    v_fmac_f32 v170, v42, v42
    v_fmac_f32 v170, v43, v43
    v_mfma_f32_16x16x32_bf16 v[152:155], a[48:51], v[16:19], 0
    v_fmac_f32 v170, v140, v140
    v_fmac_f32 v170, v141, v141
    v_mfma_f32_16x16x32_bf16 v[152:155], a[52:55], v[146:149], v[152:155]
    v_fmac_f32 v170, v142, v142
    v_fmac_f32 v170, v143, v143
    v_mfma_f32_16x16x32_bf16 v[152:155], a[56:59], v[72:75], v[152:155]
    s_waitcnt vmcnt(10)
    v_fmac_f32 v170, v44, v44
    v_fmac_f32 v170, v45, v45
    v_mfma_f32_16x16x32_bf16 v[152:155], a[60:63], v[88:91], v[152:155]
    v_fmac_f32 v170, v46, v46
    v_fmac_f32 v170, v47, v47
    v_mfma_f32_16x16x32_bf16 v[152:155], a[64:67], v[76:79], v[152:155]
    v_cvt_pk_bf16_f32 v0, v92, v93
    v_cvt_pk_bf16_f32 v1, v170, v122
    v_mfma_f32_16x16x32_bf16 v[152:155], a[68:71], v[56:59], v[152:155]
    ds_write_b64 v130, v[0:1]
    v_mfma_f32_16x16x32_bf16 v[60:63], a[72:75], v[16:19], 0
    v_add_u32 v135, s49, v135
    v_add_u32 v134, s49, v134
    v_mfma_f32_16x16x32_bf16 v[60:63], a[76:79], v[146:149], v[60:63]
    v_fma_f32 v170, v36, v36, s41
    v_fmac_f32 v170, v37, v37
    v_mfma_f32_16x16x32_bf16 v[60:63], a[80:83], v[72:75], v[60:63]
    v_fmac_f32 v170, v38, v38
    v_fmac_f32 v170, v39, v39
    v_mfma_f32_16x16x32_bf16 v[60:63], a[84:87], v[88:91], v[60:63]
    v_fmac_f32 v170, v12, v12
    v_fmac_f32 v170, v13, v13
    v_mfma_f32_16x16x32_bf16 v[60:63], a[88:91], v[76:79], v[60:63]
    v_fmac_f32 v170, v14, v14
    v_fmac_f32 v170, v15, v15
    v_mfma_f32_16x16x32_bf16 v[60:63], a[92:95], v[56:59], v[60:63]
    v_fmac_f32 v170, v152, v152
    v_fmac_f32 v170, v153, v153
    v_mfma_f32_16x16x32_bf16 v[92:95], a[96:99], v[16:19], 0
    v_fmac_f32 v170, v154, v154
    v_fmac_f32 v170, v155, v155
    v_mfma_f32_16x16x32_bf16 v[92:95], a[100:103], v[146:149], v[92:95]
    s_waitcnt lgkmcnt(0)
    s_nop 0
    v_fma_f32 v0, v60, v60, s41
    v_fmac_f32 v0, v61, v61
    v_mfma_f32_16x16x32_bf16 v[92:95], a[104:107], v[72:75], v[92:95]
    s_barrier
    ds_read_b128 v[8:11], v129 offset:0
    v_fmac_f32 v0, v62, v62
    v_mfma_f32_16x16x32_bf16 v[92:95], a[108:111], v[88:91], v[92:95]
    ds_read_b128 v[64:67], v129 offset:1024
    v_fmac_f32 v0, v63, v63
    v_mfma_f32_16x16x32_bf16 v[92:95], a[112:115], v[76:79], v[92:95]
    v_mfma_f32_16x16x32_bf16 v[92:95], a[116:119], v[56:59], v[92:95]
    s_nop 1
    v_mfma_f32_16x16x32_bf16 v[80:83], a[120:123], v[16:19], 0
    s_nop 2
    v_mfma_f32_16x16x32_bf16 v[80:83], a[124:127], v[146:149], v[80:83]
    s_nop 0
    v_fmac_f32 v0, v92, v92
    v_fmac_f32 v0, v93, v93
    v_mfma_f32_16x16x32_bf16 v[80:83], a[128:131], v[72:75], v[80:83]
    v_fmac_f32 v0, v94, v94
    v_fmac_f32 v0, v95, v95
    v_mfma_f32_16x16x32_bf16 v[80:83], a[132:135], v[88:91], v[80:83]
    v_mfma_f32_16x16x32_bf16 v[80:83], a[136:139], v[76:79], v[80:83]
    v_mfma_f32_16x16x32_bf16 v[80:83], a[140:143], v[56:59], v[80:83]
    s_waitcnt lgkmcnt(1)
    v_readfirstlane_b32 s12, v9
    v_mfma_f32_16x16x32_bf16 v[84:87], v[216:219], v[8:11], 0
    s_waitcnt lgkmcnt(0)
    s_nop 1
    v_mfma_f32_16x16x32_bf16 v[84:87], v[216:219], v[64:67], v[84:87]
    s_lshr_b32 s12, s12, 23
    v_fmac_f32 v0, v80, v80
    v_fmac_f32 v0, v81, v81
    v_mfma_f32_16x16x32_bf16 v[8:11], v[16:19], a[144:147], 0
    v_fmac_f32 v0, v82, v82
    v_fmac_f32 v0, v83, v83
    v_mfma_f32_16x16x32_bf16 v[8:11], v[146:149], a[148:151], v[8:11]
    s_nop 0
    v_rsq_f32 v84, v84
    v_mfma_f32_16x16x32_bf16 v[8:11], v[72:75], a[152:155], v[8:11]
    v_rsq_f32 v85, v85
    v_mfma_f32_16x16x32_bf16 v[8:11], v[88:91], a[156:159], v[8:11]
    v_rsq_f32 v86, v86
    v_mfma_f32_16x16x32_bf16 v[8:11], v[76:79], a[160:163], v[8:11]
    ds_read_b128 v[64:67], v137 offset:1536
    v_mul_f32 v84, s43, v84
    v_mfma_f32_16x16x32_bf16 v[8:11], v[56:59], a[164:167], v[8:11]
    ds_read_b128 v[68:71], v136 offset:1536
    v_mul_f32 v85, s43, v85
    v_mfma_f32_16x16x32_bf16 v[48:51], v[16:19], a[168:171], 0
    ds_read_b128 v[52:55], v137 offset:1664
    v_mul_f32 v86, s43, v86
    v_mfma_f32_16x16x32_bf16 v[48:51], v[146:149], a[172:175], v[48:51]
    ds_read_b128 v[96:99], v136 offset:1664
    v_cvt_pk_bf16_f32 v170, v170, v0
    v_mfma_f32_16x16x32_bf16 v[48:51], v[72:75], a[176:179], v[48:51]
    ds_read_b128 v[108:111], v137 offset:1792
    v_cvt_pk_bf16_f32 v0, v8, v9
    v_mfma_f32_16x16x32_bf16 v[48:51], v[88:91], a[180:183], v[48:51]
    ds_read_b128 v[104:107], v136 offset:1792
    v_cvt_pk_bf16_f32 v1, v10, v11
    v_mfma_f32_16x16x32_bf16 v[48:51], v[76:79], a[184:187], v[48:51]
    v_mul_f32 v32, v32, v84
    v_mul_f32 v33, v33, v84
    v_mfma_f32_16x16x32_bf16 v[48:51], v[56:59], a[188:191], v[48:51]
    s_nop 0
    v_cvt_pk_bf16_f32 v2, v32, v33
    v_mul_f32 v34, v34, v84
    v_mfma_f32_16x16x16_bf16 v[118:121], v[216:217], v[170:171], 0
    s_nop 0
    v_mul_f32 v35, v35, v84
    v_cvt_pk_bf16_f32 v3, v34, v35
    v_mul_f32 v4, v4, v84
    v_cvt_pk_bf16_f32 v8, v48, v49
    v_mfma_f32_16x16x32_bf16 v[32:35], v[16:19], a[192:195], 0
    ds_write_b64 v135, v[2:3] offset:0
    v_mfma_f32_16x16x32_bf16 v[32:35], v[146:149], a[196:199], v[32:35]
    v_rsq_f32 v118, v118
    v_mfma_f32_16x16x32_bf16 v[32:35], v[72:75], a[200:203], v[32:35]
    v_rsq_f32 v119, v119
    v_mfma_f32_16x16x32_bf16 v[32:35], v[88:91], a[204:207], v[32:35]
    v_mul_f32 v118, s55, v118
    v_mul_f32 v119, 0.5, v119
    v_mfma_f32_16x16x32_bf16 v[32:35], v[76:79], a[208:211], v[32:35]
    v_cvt_pk_bf16_f32 v9, v50, v51
    v_mul_f32 v36, v36, v118
    v_mfma_f32_16x16x32_bf16 v[32:35], v[56:59], a[212:215], v[32:35]
    s_waitcnt lgkmcnt(1)
    v_mul_f32 v37, v37, v118
    v_cvt_pk_f16_f32 v76, v36, v37
    v_mfma_f32_16x16x32_bf16 v[146:149], a[0:3], v[64:67], 0
    v_mul_f32 v38, v38, v118
    v_mul_f32 v39, v39, v118
    v_mfma_f32_16x16x32_bf16 v[146:149], a[4:7], v[68:71], v[146:149]
    v_cvt_pk_f16_f32 v77, v38, v39
    v_mul_f32 v12, v12, v118
    v_mfma_f32_16x16x32_bf16 v[146:149], a[8:11], v[52:55], v[146:149]
    v_mul_f32 v13, v13, v118
    v_cvt_pk_f16_f32 v78, v12, v13
    v_mfma_f32_16x16x32_bf16 v[146:149], a[12:15], v[96:99], v[146:149]
    v_mul_f32 v14, v14, v118
    v_mul_f32 v15, v15, v118
    v_mfma_f32_16x16x32_bf16 v[146:149], a[16:19], v[108:111], v[146:149]
    v_cvt_pk_f16_f32 v79, v14, v15
    v_mul_f32 v152, v152, v118
    v_mfma_f32_16x16x32_bf16 v[146:149], a[20:23], v[104:107], v[146:149]
    v_mul_f32 v153, v153, v118
    v_cvt_pk_f16_f32 v152, v152, v153
    v_mfma_f32_16x16x32_bf16 v[36:39], a[24:27], v[64:67], 0
    v_mul_f32 v154, v154, v118
    v_mul_f32 v155, v155, v118
    v_mfma_f32_16x16x32_bf16 v[36:39], a[28:31], v[68:71], v[36:39]
    v_cvt_pk_f16_f32 v153, v154, v155
    v_mul_f32 v60, v60, v119
    v_mfma_f32_16x16x32_bf16 v[36:39], a[32:35], v[52:55], v[36:39]
    v_mul_f32 v61, v61, v119
    v_cvt_pk_f16_f32 v16, v60, v61
    v_mfma_f32_16x16x32_bf16 v[36:39], a[36:39], v[96:99], v[36:39]
    v_mul_f32 v62, v62, v119
    v_mul_f32 v63, v63, v119
    v_mfma_f32_16x16x32_bf16 v[36:39], a[40:43], v[108:111], v[36:39]
    v_cvt_pk_f16_f32 v17, v62, v63
    v_mul_f32 v92, v92, v119
    v_mfma_f32_16x16x32_bf16 v[36:39], a[44:47], v[104:107], v[36:39]
    v_mul_f32 v93, v93, v119
    v_cvt_pk_f16_f32 v18, v92, v93
    v_mfma_f32_16x16x32_bf16 v[72:75], a[48:51], v[64:67], 0
    v_mul_f32 v94, v94, v119
    v_mul_f32 v95, v95, v119
    v_mfma_f32_16x16x32_bf16 v[72:75], a[52:55], v[68:71], v[72:75]
    v_cvt_pk_f16_f32 v19, v94, v95
    v_mul_f32 v80, v80, v119
    v_mfma_f32_16x16x32_bf16 v[72:75], a[56:59], v[52:55], v[72:75]
    v_mul_f32 v81, v81, v119
    v_cvt_pk_f16_f32 v154, v80, v81
    v_mfma_f32_16x16x32_bf16 v[72:75], a[60:63], v[96:99], v[72:75]
    v_mul_f32 v82, v82, v119
    v_mul_f32 v83, v83, v119
    v_mfma_f32_16x16x32_bf16 v[72:75], a[64:67], v[108:111], v[72:75]
    v_cvt_pk_f16_f32 v155, v82, v83
    v_cvt_pk_bf16_f32 v12, v32, v33
    v_mfma_f32_16x16x32_bf16 v[72:75], a[68:71], v[104:107], v[72:75]
    v_cvt_pk_bf16_f32 v13, v34, v35
    v_mul_f32 v5, v5, v84
    v_mfma_f32_16x16x32_bf16 v[32:35], a[72:75], v[64:67], 0
    v_cvt_pk_bf16_f32 v4, v4, v5
    v_mul_f32 v6, v6, v84
    v_mfma_f32_16x16x32_bf16 v[32:35], a[76:79], v[68:71], v[32:35]
    v_mul_f32 v7, v7, v84
    v_cvt_pk_bf16_f32 v5, v6, v7
    v_mfma_f32_16x16x32_bf16 v[32:35], a[80:83], v[52:55], v[32:35]
    ds_write_b64 v135, v[4:5] offset:8
    v_mfma_f32_16x16x32_bf16 v[32:35], a[84:87], v[96:99], v[32:35]
    v_mul_f32 v24, v24, v84
    v_mul_f32 v25, v25, v84
    v_mfma_f32_16x16x32_bf16 v[32:35], a[88:91], v[108:111], v[32:35]
    v_cvt_pk_bf16_f32 v2, v24, v25
    v_mul_f32 v26, v26, v84
    v_mfma_f32_16x16x32_bf16 v[32:35], a[92:95], v[104:107], v[32:35]
    v_mul_f32 v27, v27, v84
    v_cvt_pk_bf16_f32 v3, v26, v27
    v_mfma_f32_16x16x32_bf16 v[4:7], a[96:99], v[64:67], 0
    ds_write_b64 v134, v[2:3] offset:0
    v_mfma_f32_16x16x32_bf16 v[4:7], a[100:103], v[68:71], v[4:7]
    v_fma_f32 v2, v146, v146, s41
    v_fmac_f32 v2, v147, v147
    v_mfma_f32_16x16x32_bf16 v[4:7], a[104:107], v[52:55], v[4:7]
    v_fmac_f32 v2, v148, v148
    v_fmac_f32 v2, v149, v149
    v_mfma_f32_16x16x32_bf16 v[4:7], a[108:111], v[96:99], v[4:7]
    v_fmac_f32 v2, v36, v36
    v_fmac_f32 v2, v37, v37
    v_mfma_f32_16x16x32_bf16 v[4:7], a[112:115], v[108:111], v[4:7]
    v_fmac_f32 v2, v38, v38
    v_fmac_f32 v2, v39, v39
    v_mfma_f32_16x16x32_bf16 v[4:7], a[116:119], v[104:107], v[4:7]
    v_fmac_f32 v2, v72, v72
    v_fmac_f32 v2, v73, v73
    v_mfma_f32_16x16x32_bf16 v[24:27], a[120:123], v[64:67], 0
    v_fmac_f32 v2, v74, v74
    v_fmac_f32 v2, v75, v75
    v_mfma_f32_16x16x32_bf16 v[24:27], a[124:127], v[68:71], v[24:27]
    v_mul_f32 v28, v28, v85
    v_mul_f32 v29, v29, v85
    v_mfma_f32_16x16x32_bf16 v[24:27], a[128:131], v[52:55], v[24:27]
    v_cvt_pk_bf16_f32 v88, v28, v29
    v_mul_f32 v30, v30, v85
    v_mfma_f32_16x16x32_bf16 v[24:27], a[132:135], v[96:99], v[24:27]
    v_mul_f32 v31, v31, v85
    v_cvt_pk_bf16_f32 v89, v30, v31
    v_mfma_f32_16x16x32_bf16 v[24:27], a[136:139], v[108:111], v[24:27]
    ds_write_b64 v135, v[88:89] offset:1536
    v_mfma_f32_16x16x32_bf16 v[24:27], a[140:143], v[104:107], v[24:27]
    v_mul_f32 v20, v20, v85
    v_mul_f32 v21, v21, v85
    v_mfma_f32_16x16x32_bf16 v[60:63], v[64:67], a[144:147], 0
    v_cvt_pk_bf16_f32 v90, v20, v21
    v_mul_f32 v22, v22, v85
    v_mfma_f32_16x16x32_bf16 v[60:63], v[68:71], a[148:151], v[60:63]
    v_mul_f32 v23, v23, v85
    v_cvt_pk_bf16_f32 v91, v22, v23
    v_mfma_f32_16x16x32_bf16 v[60:63], v[52:55], a[152:155], v[60:63]
    ds_write_b64 v135, v[90:91] offset:1544
    v_mfma_f32_16x16x32_bf16 v[60:63], v[96:99], a[156:159], v[60:63]
    v_mul_f32 v114, v114, v85
    v_mul_f32 v115, v115, v85
    v_mfma_f32_16x16x32_bf16 v[60:63], v[108:111], a[160:163], v[60:63]
    ds_read_b128 v[88:91], v137 offset:3072
    v_cvt_pk_bf16_f32 v10, v114, v115
    v_mfma_f32_16x16x32_bf16 v[60:63], v[104:107], a[164:167], v[60:63]
    ds_read_b128 v[56:59], v136 offset:3072
    v_mul_f32 v116, v116, v85
    v_mfma_f32_16x16x32_bf16 v[92:95], v[64:67], a[168:171], 0
    ds_read_b128 v[80:83], v137 offset:3200
    v_mul_f32 v117, v117, v85
    v_mfma_f32_16x16x32_bf16 v[92:95], v[68:71], a[172:175], v[92:95]
    ds_read_b128 v[28:31], v136 offset:3200
    v_cvt_pk_bf16_f32 v11, v116, v117
    v_mfma_f32_16x16x32_bf16 v[92:95], v[52:55], a[176:179], v[92:95]
    ds_write_b64 v134, v[10:11] offset:1536
    v_mfma_f32_16x16x32_bf16 v[92:95], v[96:99], a[180:183], v[92:95]
    v_fma_f32 v3, v32, v32, s41
    v_fmac_f32 v3, v33, v33
    v_mfma_f32_16x16x32_bf16 v[92:95], v[108:111], a[184:187], v[92:95]
    ds_read_b128 v[48:51], v137 offset:3328
    v_fmac_f32 v3, v34, v34
    v_mfma_f32_16x16x32_bf16 v[92:95], v[104:107], a[188:191], v[92:95]
    ds_read_b128 v[20:23], v136 offset:3328
    v_fmac_f32 v3, v35, v35
    v_mfma_f32_16x16x32_bf16 v[112:115], v[64:67], a[192:195], 0
    v_fmac_f32 v3, v4, v4
    v_fmac_f32 v3, v5, v5
    v_mfma_f32_16x16x32_bf16 v[112:115], v[68:71], a[196:199], v[112:115]
    s_sub_u32 s50, s45, s44
    v_fmac_f32 v3, v6, v6
    v_fmac_f32 v3, v7, v7
    v_mfma_f32_16x16x32_bf16 v[112:115], v[52:55], a[200:203], v[112:115]
    s_sub_u32 s51, s46, s47
    v_fmac_f32 v3, v24, v24
    v_fmac_f32 v3, v25, v25
    v_mfma_f32_16x16x32_bf16 v[112:115], v[96:99], a[204:207], v[112:115]
    s_mov_b32 s60, s59
    v_fmac_f32 v3, v26, v26
    v_fmac_f32 v3, v27, v27
    v_mfma_f32_16x16x32_bf16 v[112:115], v[108:111], a[208:211], v[112:115]
    s_mov_b32 s59, s58
    v_cvt_pk_bf16_f32 v170, v2, v3
    v_cvt_pk_bf16_f32 v2, v60, v61
    v_mfma_f32_16x16x32_bf16 v[112:115], v[104:107], a[212:215], v[112:115]
    s_mov_b32 s58, s57
    v_cvt_pk_bf16_f32 v3, v62, v63
    v_cvt_pk_bf16_f32 v10, v92, v93
    v_mfma_f32_16x16x16_bf16 v[60:63], v[216:217], v[170:171], 0
    s_waitcnt lgkmcnt(2)
    s_mov_b32 s57, s56
    v_cvt_pk_bf16_f32 v11, v94, v95
    v_mul_f32 v40, v40, v86
    v_mul_f32 v41, v41, v86
    v_cvt_pk_bf16_f32 v14, v112, v113
    v_mfma_f32_16x16x32_bf16 v[92:95], a[0:3], v[88:91], 0
    s_mov_b32 s7, s6
    v_cvt_pk_bf16_f32 v15, v114, v115
    v_cvt_pk_bf16_f32 v40, v40, v41
    v_mfma_f32_16x16x32_bf16 v[92:95], a[4:7], v[56:59], v[92:95]
    s_mov_b32 s6, s5
    v_rsq_f32 v60, v60
    v_mfma_f32_16x16x32_bf16 v[92:95], a[8:11], v[80:83], v[92:95]
    s_mov_b32 s5, s4
    v_rsq_f32 v61, v61
    v_mfma_f32_16x16x32_bf16 v[92:95], a[12:15], v[28:31], v[92:95]
    s_waitcnt lgkmcnt(0)
    s_sub_u32 s14, s6, s7
    v_mul_f32 v60, s55, v60
    v_mul_f32 v61, 0.5, v61
    v_mfma_f32_16x16x32_bf16 v[92:95], a[16:19], v[48:51], v[92:95]
    s_add_u32 s61, s61, 1
    v_mul_f32 v146, v146, v60
    v_mul_f32 v147, v147, v60
    v_mfma_f32_16x16x32_bf16 v[92:95], a[20:23], v[20:23], v[92:95]
    s_ff1_i32_b32 s15, s66
    v_cvt_pk_f16_f32 v96, v146, v147
    v_mul_f32 v148, v148, v60
    v_mfma_f32_16x16x32_bf16 v[64:67], a[24:27], v[88:91], 0
    s_cmp_lg_u32 s66, 0
    v_mul_f32 v149, v149, v60
    v_cvt_pk_f16_f32 v97, v148, v149
    v_mfma_f32_16x16x32_bf16 v[64:67], a[28:31], v[56:59], v[64:67]
    s_cselect_b32 s12, s15, s12
    v_mul_f32 v36, v36, v60
    v_mul_f32 v37, v37, v60
    v_mfma_f32_16x16x32_bf16 v[64:67], a[32:35], v[80:83], v[64:67]
    s_cmp_lt_u32 s61, s71
    v_cvt_pk_f16_f32 v98, v36, v37
    v_mul_f32 v38, v38, v60
    v_mfma_f32_16x16x32_bf16 v[64:67], a[36:39], v[28:31], v[64:67]
    s_cselect_b32 s15, 31, s15
    v_mul_f32 v39, v39, v60
    v_cvt_pk_f16_f32 v99, v38, v39
    v_mfma_f32_16x16x32_bf16 v[64:67], a[40:43], v[48:51], v[64:67]
    s_bitset0_b32 s66, s15
    v_mul_f32 v72, v72, v60
    v_mul_f32 v73, v73, v60
    v_mfma_f32_16x16x32_bf16 v[64:67], a[44:47], v[20:23], v[64:67]
    s_add_u32 s12, s12, 20
    v_cvt_pk_f16_f32 v146, v72, v73
    v_mul_f32 v74, v74, v60
    v_mfma_f32_16x16x32_bf16 v[68:71], a[48:51], v[88:91], 0
    s_max_u32 s12, s12, s61
    v_mul_f32 v75, v75, v60
    v_cvt_pk_f16_f32 v147, v74, v75
    v_mfma_f32_16x16x32_bf16 v[68:71], a[52:55], v[56:59], v[68:71]
    s_cmp_lt_u32 s61, s71
    v_mul_f32 v32, v32, v61
    v_mul_f32 v33, v33, v61
    v_mfma_f32_16x16x32_bf16 v[68:71], a[56:59], v[80:83], v[68:71]
    s_cselect_b32 s15, s61, s12
    v_cvt_pk_f16_f32 v36, v32, v33
    v_mul_f32 v34, v34, v61
    v_mfma_f32_16x16x32_bf16 v[68:71], a[60:63], v[28:31], v[68:71]
    s_cselect_b32 s56, s69, s70
    v_mul_f32 v35, v35, v61
    v_cvt_pk_f16_f32 v37, v34, v35
    v_mfma_f32_16x16x32_bf16 v[68:71], a[64:67], v[48:51], v[68:71]
    s_add_u32 s56, s56, s15
    v_mul_f32 v4, v4, v61
    v_mul_f32 v5, v5, v61
    v_mfma_f32_16x16x32_bf16 v[68:71], a[68:71], v[20:23], v[68:71]
    s_mul_i32 s53, s56, 58255
    v_cvt_pk_f16_f32 v38, v4, v5
    v_mul_f32 v6, v6, v61
    v_mfma_f32_16x16x32_bf16 v[72:75], a[72:75], v[88:91], 0
    s_lshr_b32 s53, s53, 22
    v_mul_f32 v7, v7, v61
    v_cvt_pk_f16_f32 v39, v6, v7
    v_mfma_f32_16x16x32_bf16 v[72:75], a[76:79], v[56:59], v[72:75]
    s_mul_i32 s53, s53, s63
    v_mul_f32 v24, v24, v61
    v_mul_f32 v25, v25, v61
    v_mfma_f32_16x16x32_bf16 v[72:75], a[80:83], v[80:83], v[72:75]
    s_mul_i32 s56, s56, s62
    v_cvt_pk_f16_f32 v148, v24, v25
    v_mul_f32 v26, v26, v61
    v_mfma_f32_16x16x32_bf16 v[72:75], a[84:87], v[28:31], v[72:75]
    s_add_u32 s56, s56, s53
    v_mul_f32 v27, v27, v61
    v_cvt_pk_f16_f32 v149, v26, v27
    v_mfma_f32_16x16x32_bf16 v[72:75], a[88:91], v[48:51], v[72:75]
    s_mul_i32 s4, s15, 112
    v_mul_f32 v42, v42, v86
    v_mul_f32 v43, v43, v86
    v_mfma_f32_16x16x32_bf16 v[72:75], a[92:95], v[20:23], v[72:75]
    s_cmp_ge_u32 s15, 16
    v_cvt_pk_bf16_f32 v41, v42, v43
    v_mul_f32 v140, v140, v86
    v_mfma_f32_16x16x32_bf16 v[4:7], a[96:99], v[88:91], 0
    s_cselect_b32 s53, -30464, 0
    ds_write_b64 v135, v[40:41] offset:3072
    v_mfma_f32_16x16x32_bf16 v[4:7], a[100:103], v[56:59], v[4:7]
    s_add_u32 s4, s4, s53
    v_mul_f32 v141, v141, v86
    v_cvt_pk_bf16_f32 v42, v140, v141
    v_mfma_f32_16x16x32_bf16 v[4:7], a[104:107], v[80:83], v[4:7]
    s_cmp_lt_u32 s15, s73
    v_mul_f32 v142, v142, v86
    v_mul_f32 v143, v143, v86
    v_mfma_f32_16x16x32_bf16 v[4:7], a[108:111], v[28:31], v[4:7]
    s_cselect_b32 s26, 100270464, 0
    v_cvt_pk_bf16_f32 v43, v142, v143
    v_mul_f32 v44, v44, v86
    v_mfma_f32_16x16x32_bf16 v[4:7], a[112:115], v[48:51], v[4:7]
    s_cselect_b32 s56, s56, 0
    ds_write_b64 v135, v[42:43] offset:3080
    v_mfma_f32_16x16x32_bf16 v[4:7], a[116:119], v[20:23], v[4:7]
    s_cselect_b32 s4, s4, -1
    v_mul_f32 v45, v45, v86
    v_cvt_pk_bf16_f32 v44, v44, v45
    v_mul_f32 v46, v46, v86
    v_mul_f32 v47, v47, v86
    v_cvt_pk_bf16_f32 v45, v46, v47
    s_cselect_b32 s15, s15, 0
    s_cselect_b32 s13, s13, -1
    ds_write_b64 v134, v[44:45] offset:3072
    v_fma_f32 v120, v92, v92, s41
    v_fmac_f32 v120, v93, v93
    v_fmac_f32 v120, v94, v94
    v_fmac_f32 v120, v95, v95
    v_mfma_f32_16x16x32_bf16 v[24:27], a[120:123], v[88:91], 0
    s_waitcnt vmcnt(0)
    v_fmac_f32 v120, v64, v64
    v_fmac_f32 v120, v65, v65
    v_mfma_f32_16x16x32_bf16 v[24:27], a[124:127], v[56:59], v[24:27]
    s_bitset1_b32 s64, s15
    v_fmac_f32 v120, v66, v66
    v_fmac_f32 v120, v67, v67
    v_mfma_f32_16x16x32_bf16 v[24:27], a[128:131], v[80:83], v[24:27]
    s_add_u32 s65, s65, 1
    v_fmac_f32 v120, v68, v68
    v_fmac_f32 v120, v69, v69
    v_mfma_f32_16x16x32_bf16 v[24:27], a[132:135], v[28:31], v[24:27]
    s_cmp_ge_i32 s65, 2
    v_fmac_f32 v120, v70, v70
    v_fmac_f32 v120, v71, v71
    v_mfma_f32_16x16x32_bf16 v[24:27], a[136:139], v[48:51], v[24:27]
    s_cselect_b32 s30, 100270464, 0
    v_fma_f32 v121, v72, v72, s41
    v_fmac_f32 v121, v73, v73
    v_mfma_f32_16x16x32_bf16 v[24:27], a[140:143], v[20:23], v[24:27]
    s_add_u32 s67, s46, s54
    v_fmac_f32 v121, v74, v74
    v_fmac_f32 v121, v75, v75
    v_mfma_f32_16x16x32_bf16 v[32:35], v[88:91], a[144:147], 0
    s_waitcnt lgkmcnt(0)
    s_add_u32 m0, s67, 0
    v_fmac_f32 v121, v4, v4
    v_fmac_f32 v121, v5, v5
    v_mfma_f32_16x16x32_bf16 v[32:35], v[56:59], a[148:151], v[32:35]
    s_barrier
    v_fmac_f32 v121, v6, v6
    v_fmac_f32 v121, v7, v7
    v_mfma_f32_16x16x32_bf16 v[32:35], v[80:83], a[152:155], v[32:35]
    s_cmp_ge_u32 s61, s13
    v_fmac_f32 v121, v24, v24
    v_fmac_f32 v121, v25, v25
    v_mfma_f32_16x16x32_bf16 v[32:35], v[28:31], a[156:159], v[32:35]
    s_cbranch_scc1 L_atomS0
L_atomS0r:
    v_mfma_f32_16x16x32_bf16 v[32:35], v[48:51], a[160:163], v[32:35]
    v_fmac_f32 v121, v26, v26
    v_fmac_f32 v121, v27, v27
    v_mfma_f32_16x16x32_bf16 v[32:35], v[20:23], a[164:167], v[32:35]
    v_cvt_pk_bf16_f32 v170, v120, v121
    v_add_u32 v137, s50, v137
    v_mfma_f32_16x16x32_bf16 v[40:43], v[88:91], a[168:171], 0
    ds_read_b128 v[60:63], v137 offset:0
    v_add_u32 v136, s50, v136
    v_mfma_f32_16x16x32_bf16 v[40:43], v[56:59], a[172:175], v[40:43]
    s_nop 0
    ds_read_b128 v[84:87], v136 offset:0
    v_cvt_pk_bf16_f32 v164, v32, v33
    v_mfma_f32_16x16x32_bf16 v[40:43], v[80:83], a[176:179], v[40:43]
    ds_read_b128 v[52:55], v137 offset:128
    v_cvt_pk_bf16_f32 v165, v34, v35
    v_mfma_f32_16x16x32_bf16 v[40:43], v[28:31], a[180:183], v[40:43]
    ds_read_b128 v[112:115], v136 offset:128
    v_add_u32 v135, s48, v135
    v_mfma_f32_16x16x32_bf16 v[40:43], v[48:51], a[184:187], v[40:43]
    ds_read_b128 v[108:111], v137 offset:256
    v_add_u32 v134, s48, v134
    v_mfma_f32_16x16x32_bf16 v[40:43], v[20:23], a[188:191], v[40:43]
    s_nop 0
    ds_read_b128 v[104:107], v136 offset:256
    v_add_u32 v133, s51, v133
    v_mfma_f32_16x16x16_bf16 v[118:121], v[216:217], v[170:171], 0
    s_nop 0
    v_add_u32 v132, s14, v132
    v_add_u32 v131, s14, v131
    v_add_u32 v123, s14, v123
    v_cvt_pk_bf16_f32 v160, v40, v41
    v_mfma_f32_16x16x32_bf16 v[100:103], v[88:91], a[192:195], 0
    v_cvt_pk_bf16_f32 v161, v42, v43
    v_and_b32 v116, -8, v123
    v_mfma_f32_16x16x32_bf16 v[100:103], v[56:59], a[196:199], v[100:103]
    v_rsq_f32 v118, v118
    v_mfma_f32_16x16x32_bf16 v[100:103], v[80:83], a[200:203], v[100:103]
    v_rsq_f32 v119, v119
    v_mfma_f32_16x16x32_bf16 v[100:103], v[28:31], a[204:207], v[100:103]
    ds_read_b128 v[28:31], v132 offset:0
    v_mul_f32 v118, s55, v118
    v_mfma_f32_16x16x32_bf16 v[100:103], v[48:51], a[208:211], v[100:103]
    ds_read_b128 v[48:51], v132 offset:16
    v_mul_f32 v119, 0.5, v119
    v_mfma_f32_16x16x32_bf16 v[100:103], v[20:23], a[212:215], v[100:103]
    s_waitcnt lgkmcnt(3)
    ds_read_b128 v[20:23], v132 offset:48
    v_mul_f32 v72, v72, v119
    v_mfma_f32_16x16x32_bf16 v[32:35], a[216:219], v[60:63], 0
    ds_read_b128 v[88:91], v133 offset:0
    v_mul_f32 v73, v73, v119
    v_mfma_f32_16x16x32_bf16 v[32:35], a[220:223], v[84:87], v[32:35]
    v_cvt_pk_f16_f32 v40, v72, v73
    v_mul_f32 v74, v74, v119
    v_mfma_f32_16x16x32_bf16 v[32:35], a[224:227], v[52:55], v[32:35]
    v_mul_f32 v75, v75, v119
    v_cvt_pk_f16_f32 v41, v74, v75
    v_mfma_f32_16x16x32_bf16 v[32:35], a[228:231], v[112:115], v[32:35]
    v_mul_f32 v4, v4, v119
    v_mul_f32 v5, v5, v119
    v_mfma_f32_16x16x32_bf16 v[32:35], a[232:235], v[108:111], v[32:35]
    s_waitcnt lgkmcnt(4)
    v_cvt_pk_f16_f32 v42, v4, v5
    v_mul_f32 v6, v6, v119
    v_mfma_f32_16x16x32_bf16 v[32:35], a[236:239], v[104:107], v[32:35]
    v_mul_f32 v7, v7, v119
    v_cvt_pk_f16_f32 v43, v6, v7
    v_mfma_f32_16x16x32_bf16 v[4:7], a[240:243], v[60:63], 0
    v_mul_f32 v24, v24, v119
    v_mul_f32 v25, v25, v119
    v_mfma_f32_16x16x32_bf16 v[4:7], a[244:247], v[84:87], v[4:7]
    v_cvt_pk_f16_f32 v142, v24, v25
    v_mul_f32 v26, v26, v119
    v_mfma_f32_16x16x32_bf16 v[4:7], a[248:251], v[52:55], v[4:7]
    v_mul_f32 v27, v27, v119
    v_cvt_pk_f16_f32 v143, v26, v27
    v_mfma_f32_16x16x32_bf16 v[4:7], a[252:255], v[112:115], v[4:7]
    s_waitcnt lgkmcnt(0)
    buffer_load_dwordx4 v128, s[24:27], s56 offen nt lds
    v_mul_f32 v92, v92, v118
    v_mfma_f32_16x16x32_bf16 v[4:7], v[224:227], v[108:111], v[4:7]
    v_mul_f32 v93, v93, v118
    v_cvt_pk_f16_f32 v44, v92, v93
    v_mfma_f32_16x16x32_bf16 v[4:7], v[228:231], v[104:107], v[4:7]
    v_mul_f32 v94, v94, v118
    v_mul_f32 v95, v95, v118
    v_mfma_f32_16x16x32_bf16 v[24:27], v[232:235], v[60:63], 0
    v_cvt_pk_f16_f32 v45, v94, v95
    v_mul_f32 v64, v64, v118
    v_mfma_f32_16x16x32_bf16 v[24:27], v[236:239], v[84:87], v[24:27]
    v_mul_f32 v65, v65, v118
    v_cvt_pk_f16_f32 v46, v64, v65
    v_mfma_f32_16x16x32_bf16 v[24:27], v[240:243], v[52:55], v[24:27]
    v_mul_f32 v66, v66, v118
    v_mul_f32 v67, v67, v118
    v_mfma_f32_16x16x32_bf16 v[24:27], v[244:247], v[112:115], v[24:27]
    v_cvt_pk_f16_f32 v47, v66, v67
    v_mul_f32 v68, v68, v118
    v_mfma_f32_16x16x32_bf16 v[24:27], v[248:251], v[108:111], v[24:27]
    buffer_store_dwordx4 v[88:91], v128, s[28:31], s60 offen sc1
    v_mul_f32 v69, v69, v118
    v_cvt_pk_f16_f32 v140, v68, v69
    v_mul_f32 v70, v70, v118
    v_mul_f32 v71, v71, v118
    v_mfma_f32_16x16x32_bf16 v[24:27], v[252:255], v[104:107], v[24:27]
    s_add_u32 m0, s67, 1024
    v_cvt_pk_f16_f32 v141, v70, v71
    v_cvt_pk_bf16_f32 v156, v100, v101
    v_mfma_f32_16x16x32_f16 v[112:115], v[16:19], v[76:79], v[204:207]
    ds_read_u16 v166, v131 offset:80
    v_cvt_pk_bf16_f32 v157, v102, v103
    v_mfma_f32_16x16x32_f16 v[112:115], v[152:155], v[150:153], v[112:115]
    ds_read_u16 v162, v131 offset:96
    v_mfma_f32_16x16x32_f16 v[108:111], v[36:39], v[76:79], v[200:203]
    s_nop 0
    ds_read_u16 v158, v131 offset:104
    s_nop 0
    v_mfma_f32_16x16x32_f16 v[108:111], v[146:149], v[150:153], v[108:111]
    s_nop 0
    ds_read_b32 v116, v116 offset:64
    v_max3_f32 v120, v112, v113, v114
    v_mfma_f32_16x16x32_f16 v[104:107], v[40:43], v[76:79], v[196:199]
    ds_read_b128 v[68:71], v133 offset:1024
    v_mfma_f32_16x16x32_f16 v[104:107], v[140:143], v[150:153], v[104:107]
    s_nop 0
    ds_read_b128 v[72:75], v137 offset:1536
    v_max3_f32 v120, v120, v115, v108
    v_mfma_f32_16x16x32_f16 v[88:91], v[28:31], v[76:79], v[208:211]
    ds_read_b128 v[76:79], v136 offset:1536
    v_max3_f32 v120, v120, v109, v110
    v_mfma_f32_16x16x32_f16 v[88:91], v[48:51], v[16:19], v[88:91]
    ds_read_b128 v[60:63], v137 offset:1664
    v_max3_f32 v120, v120, v111, v104
    v_mfma_f32_16x16x32_f16 v[88:91], v[20:23], v[152:155], v[88:91]
    ds_read_b128 v[56:59], v136 offset:1664
    v_max3_f32 v120, v120, v105, v106
    v_mfma_f32_16x16x32_f16 v[92:95], v[28:31], v[96:99], v[208:211]
    ds_read_b128 v[64:67], v137 offset:1792
    s_nop 0
    v_mfma_f32_16x16x32_f16 v[92:95], v[48:51], v[36:39], v[92:95]
    s_nop 0
    ds_read_b128 v[80:83], v136 offset:1792
    v_max3_f32 v120, v120, v107, v88
    v_mfma_f32_16x16x32_f16 v[92:95], v[20:23], v[146:149], v[92:95]
    v_mov_b32 v121, v120
    v_mfma_f32_16x16x32_f16 v[84:87], v[28:31], v[44:47], v[208:211]
    s_nop 0
    v_permlane32_swap_b32 v121, v120
    v_mfma_f32_16x16x32_f16 v[84:87], v[48:51], v[40:43], v[84:87]
    s_waitcnt lgkmcnt(6)
    buffer_load_dwordx4 v127, s[24:27], s56 offen nt lds
    v_max_f32 v120, v121, v120
    v_mfma_f32_16x16x32_f16 v[84:87], v[20:23], v[140:143], v[84:87]
    s_waitcnt lgkmcnt(5)
    v_mov_b32 v121, v120
    v_mov_b32_dpp v91, v95 quad_perm:[0,1,2,3] row_mask:0x2 bank_mask:0xf
    v_mfma_f32_16x16x32_bf16 v[28:31], a[216:219], v[72:75], 0
    s_waitcnt lgkmcnt(4)
    v_permlane16_swap_b32 v121, v120
    v_mfma_f32_16x16x32_bf16 v[28:31], a[220:223], v[76:79], v[28:31]
    s_waitcnt lgkmcnt(3)
    v_max_f32 v120, v121, v120
    v_sub_f32 v112, v112, v120
    v_mfma_f32_16x16x32_bf16 v[28:31], a[224:227], v[60:63], v[28:31]
    s_waitcnt lgkmcnt(2)
    v_sub_f32 v113, v113, v120
    v_sub_f32 v114, v114, v120
    v_mfma_f32_16x16x32_bf16 v[28:31], a[228:231], v[56:59], v[28:31]
    s_waitcnt lgkmcnt(1)
    v_sub_f32 v115, v115, v120
    v_sub_f32 v108, v108, v120
    v_mfma_f32_16x16x32_bf16 v[28:31], a[232:235], v[64:67], v[28:31]
    s_waitcnt lgkmcnt(0)
    v_sub_f32 v109, v109, v120
    v_sub_f32 v110, v110, v120
    v_mfma_f32_16x16x32_bf16 v[28:31], a[236:239], v[80:83], v[28:31]
    buffer_store_dwordx4 v[68:71], v127, s[28:31], s60 offen sc1
    ds_read_b128 v[100:103], v133 offset:2048
    v_sub_f32 v111, v111, v120
    v_sub_f32 v104, v104, v120
    v_sub_f32 v105, v105, v120
    v_mfma_f32_16x16x32_f16 v[48:51], v[16:19], v[96:99], v[192:195]
    s_add_u32 m0, s67, 2048
    v_sub_f32 v106, v106, v120
    v_sub_f32 v107, v107, v120
    v_mfma_f32_16x16x32_f16 v[48:51], v[152:155], v[144:147], v[48:51]
    v_sub_f32 v88, v88, v120
    v_mov_b32_dpp v91, v87 quad_perm:[0,1,2,3] row_mask:0x4 bank_mask:0xf
    v_mfma_f32_16x16x32_f16 v[68:71], v[36:39], v[96:99], v[188:191]
    v_exp_f32 v112, v112
    v_mfma_f32_16x16x32_f16 v[68:71], v[146:149], v[144:147], v[68:71]
    v_exp_f32 v113, v113
    v_mfma_f32_16x16x32_f16 v[52:55], v[40:43], v[96:99], v[184:187]
    v_exp_f32 v114, v114
    v_mfma_f32_16x16x32_f16 v[52:55], v[140:143], v[144:147], v[52:55]
    v_exp_f32 v115, v115
    v_mfma_f32_16x16x32_bf16 v[20:23], a[240:243], v[72:75], 0
    v_cvt_pk_bf16_f32 v96, v112, v113
    v_cvt_pk_bf16_f32 v97, v114, v115
    v_mfma_f32_16x16x32_bf16 v[20:23], a[244:247], v[76:79], v[20:23]
    v_exp_f32 v108, v108
    v_mfma_f32_16x16x32_bf16 v[20:23], a[248:251], v[60:63], v[20:23]
    s_waitcnt lgkmcnt(0)
    buffer_load_dwordx4 v126, s[24:27], s56 offen nt lds
    v_and_b32 v120, 0xffff0000, v116
    v_mfma_f32_16x16x32_bf16 v[20:23], a[252:255], v[56:59], v[20:23]
    v_exp_f32 v109, v109
    v_mfma_f32_16x16x32_bf16 v[20:23], v[224:227], v[64:67], v[20:23]
    v_exp_f32 v110, v110
    v_mfma_f32_16x16x32_bf16 v[20:23], v[228:231], v[80:83], v[20:23]
    s_mov_b32 s53, s47
    v_exp_f32 v111, v111
    v_cvt_pk_bf16_f32 v98, v108, v109
    v_cvt_pk_bf16_f32 v99, v110, v111
    v_exp_f32 v104, v104
    v_exp_f32 v105, v105
    v_exp_f32 v106, v106
    v_exp_f32 v107, v107
    v_cvt_pk_bf16_f32 v168, v104, v105
    v_cvt_pk_bf16_f32 v169, v106, v107
    v_exp_f32 v88, v88
    v_lshlrev_b32 v116, 16, v116
    v_cvt_pk_bf16_f32 v170, v88, 0
    v_mfma_f32_16x16x32_bf16 v[112:115], v[220:223], v[96:99], 0
    s_add_u32 m0, s67, 3072
    buffer_store_dwordx4 v[100:103], v126, s[28:31], s60 offen sc1
    v_add_f32 v116, v116, v120
    v_add_f32 v116, v116, v211
    v_max3_f32 v120, v48, v49, v50
    v_max3_f32 v120, v120, v51, v68
    v_mfma_f32_16x16x32_bf16 v[112:115], v[220:223], v[168:171], v[112:115]
    s_mov_b32 s47, s46
    v_mov_b32_dpp v91, v116 quad_perm:[0,1,2,3] row_mask:0x8 bank_mask:0xf
    v_mov_b32 v121, v91
    v_mfma_f32_16x16x32_bf16 v[108:111], v[0:3], v[96:99], 0
    s_mov_b32 s46, s45
    v_max_f32_dpp v121, v121, v121 row_ror:8 row_mask:0xf bank_mask:0xf
    v_max3_f32 v120, v120, v69, v70
    v_mfma_f32_16x16x32_bf16 v[108:111], v[164:167], v[168:171], v[108:111]
    s_mov_b32 s45, s44
    v_max_f32_dpp v121, v121, v121 row_ror:4 row_mask:0xf bank_mask:0xf
    v_max3_f32 v120, v120, v71, v52
    v_mfma_f32_16x16x32_bf16 v[104:107], v[8:11], v[96:99], 0
    s_mov_b32 s44, s53
    v_max_f32_dpp v121, v121, v121 row_ror:2 row_mask:0xf bank_mask:0xf
    v_max3_f32 v120, v120, v53, v54
    v_mfma_f32_16x16x32_bf16 v[104:107], v[160:163], v[168:171], v[104:107]
    s_sub_u32 s48, s44, s46
    v_max_f32_dpp v121, v121, v121 row_ror:1 row_mask:0xf bank_mask:0xf
    v_mov_b32 v84, v121
    v_mfma_f32_16x16x32_bf16 v[100:103], v[12:15], v[96:99], 0
    s_sub_u32 s49, s46, s45
    v_permlane32_swap_b32 v84, v121
    v_mfma_f32_16x16x32_bf16 v[100:103], v[156:159], v[168:171], v[100:103]
    v_max_f32 v121, v84, v121
    v_mov_b32 v84, v121
    v_rcp_f32 v112, v112
    v_max3_f32 v120, v120, v55, v93
    v_permlane16_swap_b32 v84, v121
    v_max_f32 v121, v84, v121
    v_sub_f32 v91, v91, v121
    v_exp_f32 v91, v91
    v_mul_f32 v108, v108, v112
    v_cvt_pk_bf16_f32 v91, v91, v91
    ds_write_b16 v123, v91 offset:64
    v_mul_f32 v109, v109, v112
    v_cvt_pk_bf16_f32 v88, v108, v109
    ds_read_b128 v[94:97], v132 offset:48
    v_mul_f32 v110, v110, v112
    v_mul_f32 v111, v111, v112
    v_cvt_pk_bf16_f32 v89, v110, v111
    ds_read_b128 v[108:111], v132 offset:64
    v_mfma_f32_16x16x32_bf16 v[114:117], v[232:235], v[72:75], 0
    v_mul_f32 v104, v104, v112
    v_mul_f32 v105, v105, v112
    v_mfma_f32_16x16x32_bf16 v[114:117], v[236:239], v[76:79], v[114:117]
    ds_write_b64 v135, v[88:89] offset:0
    v_mfma_f32_16x16x32_bf16 v[114:117], v[240:243], v[60:63], v[114:117]
    v_cvt_pk_bf16_f32 v90, v104, v105
    v_mul_f32 v106, v106, v112
    v_mfma_f32_16x16x32_bf16 v[114:117], v[244:247], v[56:59], v[114:117]
    v_mul_f32 v107, v107, v112
    v_cvt_pk_bf16_f32 v91, v106, v107
    v_mfma_f32_16x16x32_bf16 v[114:117], v[248:251], v[64:67], v[114:117]
    ds_write_b64 v135, v[90:91] offset:8
    v_mfma_f32_16x16x32_bf16 v[114:117], v[252:255], v[80:83], v[114:117]
    s_waitcnt lgkmcnt(3)
    v_mul_f32 v100, v100, v112
    v_mul_f32 v101, v101, v112
    v_cvt_pk_bf16_f32 v168, v100, v101
    v_mul_f32 v102, v102, v112
    v_mfma_f32_16x16x32_bf16 v[72:75], v[94:97], v[0:3], 0
    s_waitcnt lgkmcnt(2)
    v_mul_f32 v103, v103, v112
    v_cvt_pk_bf16_f32 v169, v102, v103
    v_mov_b32 v170, v120
    v_fma_f32 v92, v32, v32, s42
    v_mfma_f32_16x16x32_bf16 v[72:75], v[108:111], v[164:167], v[72:75]
    ds_write_b64 v134, v[168:169] offset:0
    v_mfma_f32_16x16x32_bf16 v[88:91], v[94:97], v[8:11], 0
    v_permlane32_swap_b32 v170, v120
    v_mfma_f32_16x16x32_bf16 v[88:91], v[108:111], v[160:163], v[88:91]
    v_max_f32 v120, v170, v120
    v_mov_b32 v170, v120
    v_mfma_f32_16x16x32_bf16 v[76:79], v[94:97], v[12:15], 0
    s_nop 0
    v_permlane16_swap_b32 v170, v120
    v_mfma_f32_16x16x32_bf16 v[76:79], v[108:111], v[156:159], v[76:79]
    ds_read_b128 v[60:63], v133 offset:3072
    v_max_f32 v120, v170, v120
    v_sub_f32 v48, v48, v120
    v_sub_f32 v49, v49, v120
    v_sub_f32 v50, v50, v120
    v_sub_f32 v51, v51, v120
    v_sub_f32 v68, v68, v120
    v_sub_f32 v69, v69, v120
    v_sub_f32 v70, v70, v120
    v_sub_f32 v71, v71, v120
    v_sub_f32 v52, v52, v120
    v_sub_f32 v53, v53, v120
    v_sub_f32 v54, v54, v120
    v_sub_f32 v55, v55, v120
    v_sub_f32 v93, v93, v120
    v_exp_f32 v48, v48
    v_exp_f32 v49, v49
    v_exp_f32 v50, v50
    v_exp_f32 v51, v51
    v_cvt_pk_bf16_f32 v56, v48, v49
    v_cvt_pk_bf16_f32 v57, v50, v51
    v_exp_f32 v68, v68
    v_exp_f32 v69, v69
    v_exp_f32 v70, v70
    v_exp_f32 v71, v71
    v_cvt_pk_bf16_f32 v58, v68, v69
    v_cvt_pk_bf16_f32 v59, v70, v71
    v_exp_f32 v52, v52
    v_exp_f32 v53, v53
    v_exp_f32 v54, v54
    v_exp_f32 v55, v55
    v_cvt_pk_bf16_f32 v168, v52, v53
    v_cvt_pk_bf16_f32 v169, v54, v55
    v_exp_f32 v93, v93
    v_mov_b32_dpp v75, v91 quad_perm:[0,1,2,3] row_mask:0x2 bank_mask:0xf
    v_cvt_pk_bf16_f32 v170, v93, 0
    v_mfma_f32_16x16x32_bf16 v[88:91], v[220:223], v[56:59], 0
    s_waitcnt lgkmcnt(0)
    buffer_load_dwordx4 v125, s[24:27], s56 offen nt lds
    ds_read_b128 v[64:67], v137 offset:3072
    v_mfma_f32_16x16x32_bf16 v[88:91], v[220:223], v[168:171], v[88:91]
    v_mov_b32_dpp v75, v79 quad_perm:[0,1,2,3] row_mask:0x4 bank_mask:0xf
    v_cvt_pk_bf16_f32 v75, v75, v75
    v_mfma_f32_16x16x32_bf16 v[76:79], v[0:3], v[56:59], 0
    ds_write_b16 v131, v75
    v_mfma_f32_16x16x32_bf16 v[76:79], v[164:167], v[168:171], v[76:79]
    ds_read_b128 v[72:75], v136 offset:3072
    v_fmac_f32 v92, v33, v33
    v_mfma_f32_16x16x32_bf16 v[80:83], v[8:11], v[56:59], 0
    ds_read_b128 v[48:51], v137 offset:3200
    v_fmac_f32 v92, v34, v34
    v_mfma_f32_16x16x32_bf16 v[80:83], v[160:163], v[168:171], v[80:83]
    ds_read_b128 v[68:71], v136 offset:3200
    v_fmac_f32 v92, v35, v35
    v_mfma_f32_16x16x32_bf16 v[52:55], v[12:15], v[56:59], 0
    ds_read_b128 v[56:59], v137 offset:3328
    v_add_u32 v137, s48, v137
    v_mfma_f32_16x16x32_bf16 v[52:55], v[156:159], v[168:171], v[52:55]
    buffer_store_dwordx4 v[60:63], v125, s[28:31], s60 offen sc1
    ds_read_b128 v[94:97], v136 offset:3328
    v_rcp_f32 v88, v88
    v_add_u32 v136, s48, v136
    v_mfma_f32_16x16x32_f16 v[60:63], v[16:19], v[44:47], v[180:183]
    s_add_u32 m0, s67, 4096
    ds_read_b128 v[16:19], v133 offset:4096
    v_mul_f32 v76, v76, v88
    v_mfma_f32_16x16x32_f16 v[60:63], v[152:155], v[138:141], v[60:63]
    s_cmp_lg_u32 s5, -1
    v_mul_f32 v77, v77, v88
    v_cvt_pk_bf16_f32 v76, v76, v77
    v_mfma_f32_16x16x32_f16 v[152:155], v[36:39], v[44:47], v[176:179]
    v_mul_f32 v78, v78, v88
    v_mul_f32 v79, v79, v88
    v_mfma_f32_16x16x32_f16 v[152:155], v[146:149], v[138:141], v[152:155]
    v_cvt_pk_bf16_f32 v77, v78, v79
    v_mul_f32 v80, v80, v88
    v_mfma_f32_16x16x32_f16 v[36:39], v[40:43], v[44:47], v[172:175]
    ds_write_b64 v135, v[76:77] offset:1536
    v_mfma_f32_16x16x32_f16 v[36:39], v[140:143], v[138:141], v[36:39]
    s_waitcnt lgkmcnt(4)
    v_mul_f32 v81, v81, v88
    v_cvt_pk_bf16_f32 v78, v80, v81
    v_mfma_f32_16x16x32_bf16 v[40:43], a[216:219], v[64:67], 0
    v_mul_f32 v82, v82, v88
    v_mul_f32 v83, v83, v88
    v_mfma_f32_16x16x32_bf16 v[40:43], a[220:223], v[72:75], v[40:43]
    v_cvt_pk_bf16_f32 v79, v82, v83
    v_mul_f32 v52, v52, v88
    v_mfma_f32_16x16x32_bf16 v[40:43], a[224:227], v[48:51], v[40:43]
    ds_write_b64 v135, v[78:79] offset:1544
    v_mfma_f32_16x16x32_bf16 v[40:43], a[228:231], v[68:71], v[40:43]
    s_waitcnt lgkmcnt(2)
    buffer_load_dwordx4 v124, s[24:27], s56 offen nt lds
    v_mul_f32 v53, v53, v88
    v_mfma_f32_16x16x32_bf16 v[40:43], a[232:235], v[56:59], v[40:43]
    v_cvt_pk_bf16_f32 v168, v52, v53
    v_mul_f32 v54, v54, v88
    v_mfma_f32_16x16x32_bf16 v[40:43], a[236:239], v[94:97], v[40:43]
    v_mul_f32 v55, v55, v88
    v_cvt_pk_bf16_f32 v169, v54, v55
    v_mfma_f32_16x16x32_bf16 v[140:143], a[240:243], v[64:67], 0
    ds_write_b64 v134, v[168:169] offset:1536
    v_mfma_f32_16x16x32_bf16 v[140:143], a[244:247], v[72:75], v[140:143]
    v_max3_f32 v168, v60, v61, v62
    v_max3_f32 v168, v168, v63, v152
    v_mfma_f32_16x16x32_bf16 v[140:143], a[248:251], v[48:51], v[140:143]
    v_max3_f32 v168, v168, v153, v154
    v_max3_f32 v168, v168, v155, v36
    v_mfma_f32_16x16x32_bf16 v[140:143], a[252:255], v[68:71], v[140:143]
    v_max3_f32 v168, v168, v37, v38
    v_max3_f32 v168, v168, v39, v86
    v_mfma_f32_16x16x32_bf16 v[140:143], v[224:227], v[56:59], v[140:143]
    buffer_store_dwordx4 v[16:19], v124, s[28:31], s60 offen sc1
    v_mov_b32 v169, v168
    v_fmac_f32 v92, v4, v4
    v_fmac_f32 v92, v5, v5
    v_fmac_f32 v92, v6, v6
    v_mfma_f32_16x16x32_bf16 v[140:143], v[228:231], v[94:97], v[140:143]
    ds_read_b128 v[16:19], v137 offset:0
    v_fmac_f32 v92, v7, v7
    v_mfma_f32_16x16x32_bf16 v[44:47], v[232:235], v[64:67], 0
    ds_read_b128 v[146:149], v136 offset:0
    v_fmac_f32 v92, v24, v24
    v_mfma_f32_16x16x32_bf16 v[44:47], v[236:239], v[72:75], v[44:47]
    ds_read_b128 v[72:75], v137 offset:128
    v_fmac_f32 v92, v25, v25
    v_mfma_f32_16x16x32_bf16 v[44:47], v[240:243], v[48:51], v[44:47]
    ds_read_b128 v[88:91], v136 offset:128
    v_fmac_f32 v92, v26, v26
    v_mfma_f32_16x16x32_bf16 v[44:47], v[244:247], v[68:71], v[44:47]
    ds_read_b128 v[76:79], v137 offset:256
    v_fmac_f32 v92, v27, v27
    v_mfma_f32_16x16x32_bf16 v[44:47], v[248:251], v[56:59], v[44:47]
    ds_read_b128 v[56:59], v136 offset:256
    v_fma_f32 v93, v28, v28, s42
    v_mfma_f32_16x16x32_bf16 v[44:47], v[252:255], v[94:97], v[44:47]
    v_permlane32_swap_b32 v169, v168
    v_max_f32 v168, v169, v168
    v_mov_b32 v169, v168
    v_fmac_f32 v93, v29, v29
    v_fmac_f32 v93, v30, v30
    v_permlane16_swap_b32 v169, v168
    v_max_f32 v168, v169, v168
    v_sub_f32 v60, v60, v168
    v_sub_f32 v61, v61, v168
    v_sub_f32 v62, v62, v168
    v_sub_f32 v63, v63, v168
    v_sub_f32 v152, v152, v168
    v_sub_f32 v153, v153, v168
    v_sub_f32 v154, v154, v168
    v_sub_f32 v155, v155, v168
    v_sub_f32 v36, v36, v168
    v_sub_f32 v37, v37, v168
    v_sub_f32 v38, v38, v168
    v_sub_f32 v39, v39, v168
    v_sub_f32 v86, v86, v168
    v_exp_f32 v60, v60
    v_exp_f32 v61, v61
    v_exp_f32 v62, v62
    v_exp_f32 v63, v63
    v_cvt_pk_bf16_f32 v60, v60, v61
    v_cvt_pk_bf16_f32 v61, v62, v63
    v_exp_f32 v152, v152
    v_exp_f32 v153, v153
    v_exp_f32 v154, v154
    v_exp_f32 v155, v155
    v_cvt_pk_bf16_f32 v62, v152, v153
    v_cvt_pk_bf16_f32 v63, v154, v155
    v_exp_f32 v36, v36
    v_exp_f32 v37, v37
    v_exp_f32 v38, v38
    v_exp_f32 v39, v39
    v_cvt_pk_bf16_f32 v168, v36, v37
    v_cvt_pk_bf16_f32 v169, v38, v39
    v_exp_f32 v86, v86
    v_fmac_f32 v93, v31, v31
    v_cvt_pk_bf16_f32 v170, v86, 0
    v_mfma_f32_16x16x32_bf16 v[152:155], v[220:223], v[60:63], 0
    v_fmac_f32 v93, v20, v20
    v_fmac_f32 v93, v21, v21
    v_mfma_f32_16x16x32_bf16 v[152:155], v[220:223], v[168:171], v[152:155]
    v_fmac_f32 v93, v22, v22
    v_fmac_f32 v93, v23, v23
    v_mfma_f32_16x16x32_bf16 v[36:39], v[0:3], v[60:63], 0
    s_nop 0
    v_fmac_f32 v93, v114, v114
    v_fmac_f32 v93, v115, v115
    v_mfma_f32_16x16x32_bf16 v[36:39], v[164:167], v[168:171], v[36:39]
    s_nop 0
    v_rcp_f32 v152, v152
    v_mfma_f32_16x16x32_bf16 v[0:3], v[8:11], v[60:63], 0
    s_nop 0
    v_fmac_f32 v93, v116, v116
    v_fmac_f32 v93, v117, v117
    v_mfma_f32_16x16x32_bf16 v[0:3], v[160:163], v[168:171], v[0:3]
    s_nop 0
    v_mul_f32 v36, v36, v152
    v_mul_f32 v37, v37, v152
    v_mfma_f32_16x16x32_bf16 v[8:11], v[12:15], v[60:63], 0
    v_cvt_pk_bf16_f32 v12, v36, v37
    v_mul_f32 v38, v38, v152
    v_mfma_f32_16x16x32_bf16 v[8:11], v[156:159], v[168:171], v[8:11]
    s_waitcnt lgkmcnt(0)
    v_mul_f32 v39, v39, v152
    v_cvt_pk_bf16_f32 v13, v38, v39
    v_mfma_f32_16x16x32_bf16 v[36:39], a[0:3], v[16:19], 0
    s_cbranch_scc1 L_loopS0
    ds_write_b64 v135, v[12:13] offset:3072
    v_mul_f32 v0, v0, v152
    v_mul_f32 v1, v1, v152
    v_cvt_pk_bf16_f32 v14, v0, v1
    v_mul_f32 v2, v2, v152
    v_mul_f32 v3, v3, v152
    v_cvt_pk_bf16_f32 v15, v2, v3
    v_mul_f32 v8, v8, v152
    v_mul_f32 v9, v9, v152
    v_cvt_pk_bf16_f32 v8, v8, v9
    v_mul_f32 v10, v10, v152
    v_mul_f32 v11, v11, v152
    v_cvt_pk_bf16_f32 v9, v10, v11
    s_mov_b32 s30, 100270464
    s_mul_i32 s89, s68, 7168
    ds_write_b64 v135, v[14:15] offset:3080
    v_fma_f32 v113, v40, v40, s42
    s_add_u32 s89, s89, 135168
    s_movk_i32 s90, 112
    ds_write_b64 v134, v[8:9] offset:3072
    v_fmac_f32 v113, v41, v41
    v_fmac_f32 v113, v42, v42
    v_fmac_f32 v113, v43, v43
    v_fmac_f32 v113, v140, v140
    v_fmac_f32 v113, v141, v141
    v_fmac_f32 v113, v142, v142
    v_fmac_f32 v113, v143, v143
    v_fmac_f32 v113, v44, v44
    v_fmac_f32 v113, v45, v45
    v_fmac_f32 v113, v46, v46
    v_fmac_f32 v113, v47, v47
    v_cvt_pk_bf16_f32 v112, v92, v93
    v_cvt_pk_bf16_f32 v113, v113, v122
    s_lshr_b32 s91, s64, 16
    s_lshl_b32 s92, s68, 10
    ds_write_b64 v130, v[112:113]
    v_mbcnt_lo_u32_b32 v131, -1, 0
    v_mbcnt_hi_u32_b32 v131, -1, v131
    v_and_b32 v132, 15, v131
    v_lshrrev_b32 v131, 4, v131
    v_mul_u32_u24 v118, 1792, v131
    v_add_u32 v118, s89, v118
    v_mad_u32_u24 v131, v132, s90, v118
    v_lshrrev_b32 v119, v132, s64
    v_and_b32 v119, 1, v119
    v_cmp_eq_u32 vcc, 1, v119
    v_mad_u32_u24 v119, v132, s90, v118
    v_lshrrev_b32 v132, v132, s91
    v_cndmask_b32 v131, v118, v131, vcc
    v_and_b32 v132, 1, v132
    v_subrev_u32 v119, 28672, v119
    v_cmp_eq_u32 vcc, 1, v132
    s_sub_u32 s84, s45, s44
    s_sub_u32 s85, s46, s45
    ds_read_b128 v[48:51], v131 offset:64
    ds_read_b128 v[36:39], v131 offset:80
    v_cndmask_b32 v119, v118, v119, vcc
    v_add_u32 v118, s92, v129
    s_waitcnt lgkmcnt(2)
    s_barrier
    s_sub_u32 s86, s44, s45
    ds_read_b128 v[86:89], v131
    v_add_u32 v139, s84, v137
    s_sub_u32 s93, s44, s47
    s_sub_u32 s94, s45, s47
    ds_read_b64 v[90:91], v131 offset:16
    ds_read_b128 v[8:11], v118 offset:6144
    v_add_u32 v138, s84, v136
    v_add_u32 v118, s85, v135
    s_sub_u32 s95, s46, s47
    ds_read_b128 v[16:19], v129 offset:0
    v_add_u32 v63, s85, v134
    ds_read_b128 v[0:3], v129 offset:1024
    v_add_u32 v112, s86, v135
    v_add_u32 v132, s86, v134
    v_add_u32 v131, s93, v133
    v_add_u32 v113, s94, v133
    s_waitcnt lgkmcnt(6)
    v_mfma_f32_16x16x32_bf16 v[12:15], v[220:223], v[48:51], 0
    s_waitcnt lgkmcnt(5)
    ds_read_b128 v[80:83], v139 offset:1536
    ds_read_b128 v[76:79], v138 offset:1536
    v_mfma_f32_16x16x32_bf16 v[12:15], v[220:223], v[36:39], v[12:15]
    s_waitcnt lgkmcnt(3)
    ds_read_b128 v[72:75], v139 offset:1664
    v_lshlrev_b32 v92, 16, v86
    v_and_b32 v86, 0xffff0000, v86
    v_lshlrev_b32 v93, 16, v87
    v_and_b32 v87, 0xffff0000, v87
    v_lshlrev_b32 v94, 16, v88
    v_and_b32 v88, 0xffff0000, v88
    v_rcp_f32 v12, v12
    v_lshlrev_b32 v95, 16, v89
    v_mfma_f32_16x16x32_bf16 v[64:67], v[216:219], v[16:19], 0
    s_waitcnt lgkmcnt(3)
    ds_read_b128 v[68:71], v138 offset:1664
    ds_read_b128 v[48:51], v139 offset:1792
    v_mfma_f32_16x16x32_bf16 v[64:67], v[216:219], v[0:3], v[64:67]
    s_waitcnt lgkmcnt(4)
    ds_read_b128 v[16:19], v138 offset:1792
    v_mul_f32 v92, v92, v12
    v_mul_f32 v86, v86, v12
    v_cvt_pk_bf16_f32 v92, v92, v86
    v_mul_f32 v93, v93, v12
    v_mfma_f32_16x16x32_bf16 v[0:3], a[216:219], v[80:83], 0
    s_waitcnt lgkmcnt(4)
    v_mul_f32 v87, v87, v12
    v_cvt_pk_bf16_f32 v93, v93, v87
    v_mfma_f32_16x16x32_bf16 v[0:3], a[220:223], v[76:79], v[0:3]
    s_waitcnt lgkmcnt(3)
    ds_read_b128 v[108:111], v139 offset:0
    ds_read_b128 v[104:107], v138 offset:0
    v_mfma_f32_16x16x32_bf16 v[0:3], a[224:227], v[72:75], v[0:3]
    s_waitcnt lgkmcnt(4)
    ds_read_b128 v[96:99], v139 offset:128
    v_mul_f32 v94, v94, v12
    v_mul_f32 v88, v88, v12
    v_cvt_pk_bf16_f32 v94, v94, v88
    v_and_b32 v89, 0xffff0000, v89
    v_mul_f32 v95, v95, v12
    v_mfma_f32_16x16x32_bf16 v[0:3], a[228:231], v[68:71], v[0:3]
    s_waitcnt lgkmcnt(4)
    ds_read_b128 v[84:87], v138 offset:128
    ds_read_b128 v[56:59], v139 offset:256
    v_mfma_f32_16x16x32_bf16 v[0:3], a[232:235], v[48:51], v[0:3]
    s_waitcnt lgkmcnt(5)
    ds_read_b128 v[36:39], v138 offset:256
    v_mul_f32 v89, v89, v12
    v_mfma_f32_16x16x32_bf16 v[0:3], a[236:239], v[16:19], v[0:3]
    v_cvt_pk_bf16_f32 v95, v95, v89
    v_lshlrev_b32 v67, 16, v90
    v_mfma_f32_16x16x32_bf16 v[52:55], a[240:243], v[80:83], 0
    ds_write_b128 v112, v[92:95] offset:0
    v_mfma_f32_16x16x32_bf16 v[52:55], a[244:247], v[76:79], v[52:55]
    v_and_b32 v90, 0xffff0000, v90
    v_mul_f32 v67, v67, v12
    v_mfma_f32_16x16x32_bf16 v[52:55], a[248:251], v[72:75], v[52:55]
    v_mul_f32 v90, v90, v12
    v_cvt_pk_bf16_f32 v60, v67, v90
    v_mfma_f32_16x16x32_bf16 v[52:55], a[252:255], v[68:71], v[52:55]
    v_lshlrev_b32 v67, 16, v91
    v_and_b32 v91, 0xffff0000, v91
    v_mfma_f32_16x16x32_bf16 v[52:55], v[224:227], v[48:51], v[52:55]
    v_mul_f32 v67, v67, v12
    v_mul_f32 v91, v91, v12
    v_mfma_f32_16x16x32_bf16 v[52:55], v[228:231], v[16:19], v[52:55]
    v_cvt_pk_bf16_f32 v61, v67, v91
    v_lshrrev_b32 v67, 0, v11
    v_mfma_f32_16x16x32_bf16 v[12:15], v[232:235], v[80:83], 0
    ds_write_b64 v132, v[60:61] offset:0
    v_mfma_f32_16x16x32_bf16 v[12:15], v[236:239], v[76:79], v[12:15]
    v_lshrrev_b32 v67, v67, s64
    v_and_b32 v67, 1, v67
    v_mfma_f32_16x16x32_bf16 v[12:15], v[240:243], v[72:75], v[12:15]
    v_cmp_eq_u32 vcc, 1, v67
    v_lshrrev_b32 v67, 8, v11
    v_mfma_f32_16x16x32_bf16 v[12:15], v[244:247], v[68:71], v[12:15]
    v_cndmask_b32 v8, 2.0, v8, vcc
    v_lshrrev_b32 v67, v67, s64
    v_mfma_f32_16x16x32_bf16 v[12:15], v[248:251], v[48:51], v[12:15]
    v_and_b32 v67, 1, v67
    v_cmp_eq_u32 vcc, 1, v67
    v_mfma_f32_16x16x32_bf16 v[12:15], v[252:255], v[16:19], v[12:15]
    s_waitcnt lgkmcnt(1)
    v_cndmask_b32 v9, 2.0, v9, vcc
    v_lshrrev_b32 v11, 16, v11
    v_mfma_f32_16x16x32_bf16 v[72:75], a[216:219], v[108:111], 0
    v_lshrrev_b32 v11, v11, s64
    v_and_b32 v11, 1, v11
    v_mfma_f32_16x16x32_bf16 v[72:75], a[220:223], v[104:107], v[72:75]
    ds_read_b128 v[100:103], v139 offset:3072
    ds_read_b128 v[92:95], v138 offset:3072
    v_mfma_f32_16x16x32_bf16 v[72:75], a[224:227], v[96:99], v[72:75]
    ds_read_b128 v[88:91], v139 offset:3200
    v_cmp_eq_u32 vcc, 1, v11
    v_mfma_f32_16x16x32_bf16 v[72:75], a[228:231], v[84:87], v[72:75]
    ds_read_b128 v[80:83], v138 offset:3200
    v_cndmask_b32 v10, 2.0, v10, vcc
    v_mfma_f32_16x16x32_bf16 v[72:75], a[232:235], v[56:59], v[72:75]
    ds_read_b128 v[76:79], v139 offset:3328
    v_add_u32 v11, s95, v133
    v_mfma_f32_16x16x32_bf16 v[72:75], a[236:239], v[36:39], v[72:75]
    ds_read_b128 v[16:19], v138 offset:3328
    v_fma_f32 v133, v0, v0, s42
    v_mfma_f32_16x16x32_bf16 v[48:51], a[240:243], v[108:111], 0
    v_rsq_f32 v64, v64
    v_mfma_f32_16x16x32_bf16 v[48:51], a[244:247], v[104:107], v[48:51]
    v_mul_f32 v64, s43, v64
    v_mul_f32 v32, v32, v64
    v_mfma_f32_16x16x32_bf16 v[48:51], a[248:251], v[96:99], v[48:51]
    v_mul_f32 v33, v33, v64
    v_cvt_pk_bf16_f32 v32, v32, v33
    v_mfma_f32_16x16x32_bf16 v[48:51], a[252:255], v[84:87], v[48:51]
    v_mul_f32 v34, v34, v64
    v_mul_f32 v35, v35, v64
    v_mfma_f32_16x16x32_bf16 v[48:51], v[224:227], v[56:59], v[48:51]
    v_cvt_pk_bf16_f32 v33, v34, v35
    v_mul_f32 v4, v4, v64
    v_mfma_f32_16x16x32_bf16 v[48:51], v[228:231], v[36:39], v[48:51]
    v_mul_f32 v5, v5, v64
    v_cvt_pk_bf16_f32 v34, v4, v5
    v_mfma_f32_16x16x32_bf16 v[68:71], v[232:235], v[108:111], 0
    v_mul_f32 v6, v6, v64
    v_mul_f32 v7, v7, v64
    v_mfma_f32_16x16x32_bf16 v[68:71], v[236:239], v[104:107], v[68:71]
    v_cvt_pk_bf16_f32 v35, v6, v7
    v_mul_f32 v24, v24, v64
    v_mfma_f32_16x16x32_bf16 v[68:71], v[240:243], v[96:99], v[68:71]
    ds_write_b128 v118, v[32:35] offset:0
    v_mfma_f32_16x16x32_bf16 v[68:71], v[244:247], v[84:87], v[68:71]
    v_mul_f32 v25, v25, v64
    v_cvt_pk_bf16_f32 v24, v24, v25
    v_mfma_f32_16x16x32_bf16 v[68:71], v[248:251], v[56:59], v[68:71]
    v_mul_f32 v26, v26, v64
    v_mul_f32 v27, v27, v64
    v_mfma_f32_16x16x32_bf16 v[68:71], v[252:255], v[36:39], v[68:71]
    s_waitcnt lgkmcnt(1)
    v_cvt_pk_bf16_f32 v25, v26, v27
    v_fma_f32 v62, v72, v72, s42
    v_mfma_f32_16x16x32_bf16 v[84:87], a[216:219], v[100:103], 0
    ds_write_b64 v63, v[24:25] offset:0
    v_mfma_f32_16x16x32_bf16 v[84:87], a[220:223], v[92:95], v[84:87]
    ds_read_b128 v[24:27], v119 offset:64
    v_fmac_f32 v62, v73, v73
    v_mfma_f32_16x16x32_bf16 v[84:87], a[224:227], v[88:91], v[84:87]
    ds_read_b128 v[4:7], v119 offset:80
    v_fmac_f32 v62, v74, v74
    v_mfma_f32_16x16x32_bf16 v[84:87], a[228:231], v[80:83], v[84:87]
    ds_read_b128 v[56:59], v119
    v_fmac_f32 v62, v75, v75
    v_mfma_f32_16x16x32_bf16 v[84:87], a[232:235], v[76:79], v[84:87]
    ds_read_b64 v[60:61], v119 offset:16
    v_fmac_f32 v62, v48, v48
    v_mfma_f32_16x16x32_bf16 v[84:87], a[236:239], v[16:19], v[84:87]
    v_rsq_f32 v65, v65
    v_mfma_f32_16x16x32_bf16 v[96:99], a[240:243], v[100:103], 0
    v_mul_f32 v65, s43, v65
    v_mul_f32 v28, v28, v65
    v_mfma_f32_16x16x32_bf16 v[96:99], a[244:247], v[92:95], v[96:99]
    v_mul_f32 v29, v29, v65
    v_cvt_pk_bf16_f32 v28, v28, v29
    v_mfma_f32_16x16x32_bf16 v[96:99], a[248:251], v[88:91], v[96:99]
    v_mul_f32 v30, v30, v65
    v_mul_f32 v31, v31, v65
    v_mfma_f32_16x16x32_bf16 v[96:99], a[252:255], v[80:83], v[96:99]
    v_cvt_pk_bf16_f32 v29, v30, v31
    v_mul_f32 v20, v20, v65
    v_mfma_f32_16x16x32_bf16 v[96:99], v[224:227], v[76:79], v[96:99]
    v_mul_f32 v21, v21, v65
    v_cvt_pk_bf16_f32 v30, v20, v21
    v_mfma_f32_16x16x32_bf16 v[96:99], v[228:231], v[16:19], v[96:99]
    v_mul_f32 v22, v22, v65
    v_mul_f32 v23, v23, v65
    v_mfma_f32_16x16x32_bf16 v[36:39], v[232:235], v[100:103], 0
    v_cvt_pk_bf16_f32 v31, v22, v23
    v_mul_f32 v114, v114, v65
    v_mfma_f32_16x16x32_bf16 v[36:39], v[236:239], v[92:95], v[36:39]
    ds_write_b128 v118, v[28:31] offset:1536
    v_mfma_f32_16x16x32_bf16 v[36:39], v[240:243], v[88:91], v[36:39]
    v_mul_f32 v115, v115, v65
    v_cvt_pk_bf16_f32 v114, v114, v115
    v_mfma_f32_16x16x32_bf16 v[36:39], v[244:247], v[80:83], v[36:39]
    v_mul_f32 v116, v116, v65
    v_mul_f32 v117, v117, v65
    v_mfma_f32_16x16x32_bf16 v[36:39], v[248:251], v[76:79], v[36:39]
    v_cvt_pk_bf16_f32 v115, v116, v117
    v_fmac_f32 v62, v49, v49
    v_mfma_f32_16x16x32_bf16 v[36:39], v[252:255], v[16:19], v[36:39]
    s_waitcnt lgkmcnt(1)
    ds_write_b64 v63, v[114:115] offset:1536
    v_mfma_f32_16x16x32_bf16 v[16:19], v[220:223], v[24:27], 0
    v_rsq_f32 v66, v66
    v_mfma_f32_16x16x32_bf16 v[16:19], v[220:223], v[4:7], v[16:19]
    v_mul_f32 v66, s43, v66
    v_mul_f32 v40, v40, v66
    v_mul_f32 v41, v41, v66
    v_cvt_pk_bf16_f32 v4, v40, v41
    v_mul_f32 v42, v42, v66
    v_mul_f32 v43, v43, v66
    v_cvt_pk_bf16_f32 v5, v42, v43
    v_mul_f32 v140, v140, v66
    v_mul_f32 v141, v141, v66
    v_cvt_pk_bf16_f32 v6, v140, v141
    v_mul_f32 v142, v142, v66
    v_mul_f32 v143, v143, v66
    v_cvt_pk_bf16_f32 v7, v142, v143
    v_mul_f32 v44, v44, v66
    v_mul_f32 v45, v45, v66
    v_cvt_pk_bf16_f32 v44, v44, v45
    v_mul_f32 v46, v46, v66
    v_mul_f32 v47, v47, v66
    v_cvt_pk_bf16_f32 v45, v46, v47
    ds_write_b128 v118, v[4:7] offset:3072
    v_fmac_f32 v62, v50, v50
    v_fmac_f32 v62, v51, v51
    v_fmac_f32 v62, v68, v68
    v_fmac_f32 v62, v69, v69
    ds_write_b64 v63, v[44:45] offset:3072
    v_fmac_f32 v62, v70, v70
    v_fmac_f32 v62, v71, v71
    v_fmac_f32 v133, v1, v1
    v_fmac_f32 v133, v2, v2
    v_fmac_f32 v133, v3, v3
    v_fmac_f32 v133, v52, v52
    v_fmac_f32 v133, v53, v53
    v_fmac_f32 v133, v54, v54
    v_fmac_f32 v133, v55, v55
    v_fmac_f32 v133, v12, v12
    v_fmac_f32 v133, v13, v13
    v_fmac_f32 v133, v14, v14
    v_fmac_f32 v133, v15, v15
    v_cvt_pk_bf16_f32 v62, v62, v133
    v_fma_f32 v63, v84, v84, s42
    v_fmac_f32 v63, v85, v85
    v_fmac_f32 v63, v86, v86
    v_fmac_f32 v63, v87, v87
    v_fmac_f32 v63, v96, v96
    v_fmac_f32 v63, v97, v97
    v_fmac_f32 v63, v98, v98
    v_fmac_f32 v63, v99, v99
    v_fmac_f32 v63, v36, v36
    v_fmac_f32 v63, v37, v37
    v_fmac_f32 v63, v38, v38
    v_fmac_f32 v63, v39, v39
    v_cvt_pk_bf16_f32 v63, v63, v63
    ds_write_b64 v130, v[62:63] offset:2048
    v_rcp_f32 v16, v16
    v_lshlrev_b32 v133, 16, v56
    v_and_b32 v56, 0xffff0000, v56
    v_mul_f32 v133, v133, v16
    v_mul_f32 v56, v56, v16
    v_cvt_pk_bf16_f32 v4, v133, v56
    v_lshlrev_b32 v56, 16, v57
    v_and_b32 v57, 0xffff0000, v57
    v_mul_f32 v56, v56, v16
    v_mul_f32 v57, v57, v16
    v_cvt_pk_bf16_f32 v5, v56, v57
    v_lshlrev_b32 v133, 16, v58
    v_and_b32 v58, 0xffff0000, v58
    v_mul_f32 v133, v133, v16
    v_mul_f32 v58, v58, v16
    v_cvt_pk_bf16_f32 v6, v133, v58
    v_lshlrev_b32 v7, 16, v59
    v_and_b32 v59, 0xffff0000, v59
    v_mul_f32 v7, v7, v16
    v_mul_f32 v59, v59, v16
    v_cvt_pk_bf16_f32 v7, v7, v59
    v_lshlrev_b32 v133, 16, v60
    v_and_b32 v60, 0xffff0000, v60
    v_mul_f32 v133, v133, v16
    v_mul_f32 v60, v60, v16
    v_cvt_pk_bf16_f32 v138, v133, v60
    v_lshlrev_b32 v133, 16, v61
    v_and_b32 v61, 0xffff0000, v61
    v_mul_f32 v133, v133, v16
    v_mul_f32 v61, v61, v16
    v_cvt_pk_bf16_f32 v139, v133, v61
    s_waitcnt lgkmcnt(0)
    s_barrier
    ds_write_b128 v112, v[4:7] offset:1536
    v_mov_b32 v115, 0
    ds_write_b64 v132, v[138:139] offset:1536
    ds_read_b128 v[32:35], v11 offset:0
    ds_read_b128 v[4:7], v11 offset:1024
    ds_read_b128 v[24:27], v11 offset:2048
    ds_read_b128 v[20:23], v11 offset:3072
    ds_read_b128 v[80:83], v11 offset:4096
    s_waitcnt lgkmcnt(5)
    s_barrier
    s_waitcnt lgkmcnt(4)
    buffer_store_dwordx4 v[32:35], v128, s[28:31], s59 offen sc1
    ds_read_b128 v[28:31], v129 offset:2048
    ds_read_b128 v[16:19], v129 offset:3072
    ds_read_b128 v[104:107], v137 offset:1536
    ds_read_b128 v[100:103], v136 offset:1536
    ds_read_b128 v[92:95], v137 offset:1664
    ds_read_b128 v[88:91], v136 offset:1664
    ds_read_b128 v[76:79], v137 offset:1792
    s_waitcnt lgkmcnt(9)
    buffer_store_dwordx4 v[4:7], v127, s[28:31], s59 offen sc1
    ds_read_b128 v[40:43], v136 offset:1792
    s_waitcnt lgkmcnt(7)
    v_mfma_f32_16x16x32_bf16 v[4:7], v[216:219], v[28:31], 0
    s_waitcnt lgkmcnt(6)
    v_mfma_f32_16x16x32_bf16 v[4:7], v[216:219], v[16:19], v[4:7]
    s_waitcnt lgkmcnt(5)
    v_mfma_f32_16x16x32_bf16 v[16:19], a[216:219], v[104:107], 0
    s_waitcnt lgkmcnt(4)
    v_mfma_f32_16x16x32_bf16 v[16:19], a[220:223], v[100:103], v[16:19]
    s_waitcnt lgkmcnt(3)
    ds_read_b128 v[64:67], v137 offset:0
    ds_read_b128 v[60:63], v136 offset:0
    v_mfma_f32_16x16x32_bf16 v[16:19], a[224:227], v[92:95], v[16:19]
    s_waitcnt lgkmcnt(4)
    ds_read_b128 v[56:59], v137 offset:128
    v_mfma_f32_16x16x32_bf16 v[16:19], a[228:231], v[88:91], v[16:19]
    s_waitcnt lgkmcnt(4)
    buffer_store_dwordx4 v[24:27], v126, s[28:31], s59 offen sc1
    ds_read_b128 v[44:47], v136 offset:128
    v_rsq_f32 v4, v4
    v_mfma_f32_16x16x32_bf16 v[16:19], a[232:235], v[76:79], v[16:19]
    s_waitcnt lgkmcnt(4)
    ds_read_b128 v[32:35], v137 offset:256
    ds_read_b128 v[24:27], v136 offset:256
    v_mfma_f32_16x16x32_bf16 v[16:19], a[236:239], v[40:43], v[16:19]
    v_rsq_f32 v5, v5
    v_mfma_f32_16x16x32_bf16 v[28:31], a[240:243], v[104:107], 0
    v_mul_f32 v4, s43, v4
    v_mul_f32 v5, s43, v5
    v_mfma_f32_16x16x32_bf16 v[28:31], a[244:247], v[100:103], v[28:31]
    v_rsq_f32 v6, v6
    v_mfma_f32_16x16x32_bf16 v[28:31], a[248:251], v[92:95], v[28:31]
    v_mul_f32 v6, s43, v6
    v_mul_f32 v84, v84, v6
    v_mfma_f32_16x16x32_bf16 v[28:31], a[252:255], v[88:91], v[28:31]
    buffer_store_dwordx4 v[20:23], v125, s[28:31], s59 offen sc1
    v_mul_f32 v85, v85, v6
    v_cvt_pk_bf16_f32 v84, v84, v85
    v_mul_f32 v86, v86, v6
    v_mul_f32 v87, v87, v6
    v_mfma_f32_16x16x32_bf16 v[28:31], v[224:227], v[76:79], v[28:31]
    v_cvt_pk_bf16_f32 v85, v86, v87
    v_mul_f32 v96, v96, v6
    v_mfma_f32_16x16x32_bf16 v[28:31], v[228:231], v[40:43], v[28:31]
    v_mul_f32 v97, v97, v6
    v_cvt_pk_bf16_f32 v86, v96, v97
    v_mfma_f32_16x16x32_bf16 v[20:23], v[232:235], v[104:107], 0
    v_mul_f32 v98, v98, v6
    v_mul_f32 v99, v99, v6
    v_mfma_f32_16x16x32_bf16 v[20:23], v[236:239], v[100:103], v[20:23]
    v_cvt_pk_bf16_f32 v87, v98, v99
    v_mul_f32 v36, v36, v6
    v_mfma_f32_16x16x32_bf16 v[20:23], v[240:243], v[92:95], v[20:23]
    ds_write_b128 v135, v[84:87] offset:3072
    v_mfma_f32_16x16x32_bf16 v[20:23], v[244:247], v[88:91], v[20:23]
    buffer_store_dwordx4 v[80:83], v124, s[28:31], s59 offen sc1
    v_mul_f32 v37, v37, v6
    v_cvt_pk_bf16_f32 v36, v36, v37
    v_mul_f32 v38, v38, v6
    v_mul_f32 v39, v39, v6
    v_mfma_f32_16x16x32_bf16 v[20:23], v[248:251], v[76:79], v[20:23]
    v_cvt_pk_bf16_f32 v37, v38, v39
    v_mul_f32 v72, v72, v4
    v_mfma_f32_16x16x32_bf16 v[20:23], v[252:255], v[40:43], v[20:23]
    s_waitcnt lgkmcnt(1)
    ds_write_b64 v134, v[36:37] offset:3072
    v_mfma_f32_16x16x32_bf16 v[36:39], a[216:219], v[64:67], 0
    v_mul_f32 v73, v73, v4
    v_cvt_pk_bf16_f32 v40, v72, v73
    v_mfma_f32_16x16x32_bf16 v[36:39], a[220:223], v[60:63], v[36:39]
    v_mul_f32 v74, v74, v4
    v_mul_f32 v75, v75, v4
    v_mfma_f32_16x16x32_bf16 v[36:39], a[224:227], v[56:59], v[36:39]
    v_cvt_pk_bf16_f32 v41, v74, v75
    v_mul_f32 v48, v48, v4
    v_mfma_f32_16x16x32_bf16 v[36:39], a[228:231], v[44:47], v[36:39]
    v_mul_f32 v49, v49, v4
    v_cvt_pk_bf16_f32 v42, v48, v49
    v_mfma_f32_16x16x32_bf16 v[36:39], a[232:235], v[32:35], v[36:39]
    v_mul_f32 v50, v50, v4
    v_mul_f32 v51, v51, v4
    v_mfma_f32_16x16x32_bf16 v[36:39], a[236:239], v[24:27], v[36:39]
    v_cvt_pk_bf16_f32 v43, v50, v51
    v_mul_f32 v68, v68, v4
    v_mfma_f32_16x16x32_bf16 v[48:51], a[240:243], v[64:67], 0
    ds_write_b128 v135, v[40:43] offset:0
    v_mfma_f32_16x16x32_bf16 v[48:51], a[244:247], v[60:63], v[48:51]
    v_mul_f32 v69, v69, v4
    v_cvt_pk_bf16_f32 v6, v68, v69
    v_mfma_f32_16x16x32_bf16 v[48:51], a[248:251], v[56:59], v[48:51]
    v_mul_f32 v70, v70, v4
    v_mul_f32 v71, v71, v4
    v_mfma_f32_16x16x32_bf16 v[48:51], a[252:255], v[44:47], v[48:51]
    v_cvt_pk_bf16_f32 v7, v70, v71
    v_fma_f32 v11, v16, v16, s42
    v_mfma_f32_16x16x32_bf16 v[48:51], v[224:227], v[32:35], v[48:51]
    ds_write_b64 v134, v[6:7] offset:0
    v_mfma_f32_16x16x32_bf16 v[48:51], v[228:231], v[24:27], v[48:51]
    v_fmac_f32 v11, v17, v17
    v_fmac_f32 v11, v18, v18
    v_mfma_f32_16x16x32_bf16 v[40:43], v[232:235], v[64:67], 0
    v_fmac_f32 v11, v19, v19
    v_fmac_f32 v11, v28, v28
    v_mfma_f32_16x16x32_bf16 v[40:43], v[236:239], v[60:63], v[40:43]
    v_fmac_f32 v11, v29, v29
    v_fmac_f32 v11, v30, v30
    v_mfma_f32_16x16x32_bf16 v[40:43], v[240:243], v[56:59], v[40:43]
    v_fmac_f32 v11, v31, v31
    v_fmac_f32 v11, v20, v20
    v_mfma_f32_16x16x32_bf16 v[40:43], v[244:247], v[44:47], v[40:43]
    v_fmac_f32 v11, v21, v21
    v_fmac_f32 v11, v22, v22
    v_mfma_f32_16x16x32_bf16 v[40:43], v[248:251], v[32:35], v[40:43]
    v_fmac_f32 v11, v23, v23
    v_fma_f32 v114, v36, v36, s42
    v_mfma_f32_16x16x32_bf16 v[40:43], v[252:255], v[24:27], v[40:43]
    s_nop 0
    v_fmac_f32 v114, v37, v37
    v_fmac_f32 v114, v38, v38
    v_fmac_f32 v114, v39, v39
    v_fmac_f32 v114, v48, v48
    v_fmac_f32 v114, v49, v49
    v_fmac_f32 v114, v50, v50
    v_fmac_f32 v114, v51, v51
    v_fmac_f32 v114, v40, v40
    v_fmac_f32 v114, v41, v41
    v_fmac_f32 v114, v42, v42
    v_fmac_f32 v114, v43, v43
    v_cvt_pk_bf16_f32 v114, v114, v11
    ds_write_b64 v130, v[114:115] offset:4096
    v_mul_f32 v0, v0, v5
    v_mul_f32 v1, v1, v5
    v_cvt_pk_bf16_f32 v0, v0, v1
    v_mul_f32 v2, v2, v5
    v_mul_f32 v3, v3, v5
    v_cvt_pk_bf16_f32 v1, v2, v3
    v_mul_f32 v52, v52, v5
    v_mul_f32 v53, v53, v5
    v_cvt_pk_bf16_f32 v2, v52, v53
    v_mul_f32 v54, v54, v5
    v_mul_f32 v55, v55, v5
    v_cvt_pk_bf16_f32 v3, v54, v55
    v_mul_f32 v12, v12, v5
    v_mul_f32 v13, v13, v5
    v_cvt_pk_bf16_f32 v114, v12, v13
    v_mul_f32 v14, v14, v5
    v_mul_f32 v15, v15, v5
    v_cvt_pk_bf16_f32 v115, v14, v15
    ds_write_b128 v135, v[0:3] offset:1536
    s_waitcnt lgkmcnt(1)
    s_barrier
    ds_write_b64 v134, v[114:115] offset:1536
    ds_read_b128 v[4:7], v129 offset:4096
    ds_read_b128 v[0:3], v129 offset:5120
    s_waitcnt lgkmcnt(2)
    s_barrier
    s_waitcnt lgkmcnt(1)
    v_mfma_f32_16x16x32_bf16 v[24:27], v[216:219], v[4:7], 0
    s_waitcnt lgkmcnt(0)
    ds_read_b128 v[44:47], v113 offset:0
    ds_read_b128 v[32:35], v113 offset:1024
    v_mfma_f32_16x16x32_bf16 v[24:27], v[216:219], v[0:3], v[24:27]
    s_nop 0
    ds_read_b128 v[12:15], v113 offset:2048
    s_nop 2
    ds_read_b128 v[4:7], v113 offset:3072
    s_nop 1
    v_rsq_f32 v24, v24
    ds_read_b128 v[0:3], v113 offset:4096
    v_mul_f32 v24, s43, v24
    v_mul_f32 v36, v36, v24
    v_mul_f32 v37, v37, v24
    v_cvt_pk_bf16_f32 v36, v36, v37
    v_mul_f32 v38, v38, v24
    v_mul_f32 v39, v39, v24
    v_cvt_pk_bf16_f32 v37, v38, v39
    v_mul_f32 v48, v48, v24
    v_mul_f32 v49, v49, v24
    s_waitcnt lgkmcnt(4)
    buffer_store_dwordx4 v[44:47], v128, s[28:31], s58 offen sc1
    v_cvt_pk_bf16_f32 v38, v48, v49
    v_mul_f32 v50, v50, v24
    v_mul_f32 v51, v51, v24
    v_cvt_pk_bf16_f32 v39, v50, v51
    v_mul_f32 v40, v40, v24
    v_mul_f32 v41, v41, v24
    v_cvt_pk_bf16_f32 v26, v40, v41
    v_mul_f32 v42, v42, v24
    v_mul_f32 v43, v43, v24
    v_cvt_pk_bf16_f32 v27, v42, v43
    ds_write_b128 v112, v[36:39] offset:0
    v_rsq_f32 v25, v25
    s_nop 0
    v_mul_f32 v25, s43, v25
    s_waitcnt lgkmcnt(1)
    buffer_store_dwordx4 v[32:35], v127, s[28:31], s58 offen sc1
    ds_write_b64 v132, v[26:27] offset:0
    v_mul_f32 v16, v16, v25
    v_mul_f32 v17, v17, v25
    v_cvt_pk_bf16_f32 v16, v16, v17
    v_mul_f32 v18, v18, v25
    v_mul_f32 v19, v19, v25
    v_cvt_pk_bf16_f32 v17, v18, v19
    v_mul_f32 v28, v28, v25
    v_mul_f32 v29, v29, v25
    v_cvt_pk_bf16_f32 v18, v28, v29
    v_mul_f32 v30, v30, v25
    v_mul_f32 v31, v31, v25
    v_cvt_pk_bf16_f32 v19, v30, v31
    v_mul_f32 v20, v20, v25
    v_mul_f32 v21, v21, v25
    v_cvt_pk_bf16_f32 v128, v20, v21
    v_mul_f32 v22, v22, v25
    v_mul_f32 v23, v23, v25
    v_cvt_pk_bf16_f32 v129, v22, v23
    buffer_store_dwordx4 v[12:15], v126, s[28:31], s58 offen sc1
    ds_write_b128 v112, v[16:19] offset:1536
    ds_write_b64 v132, v[128:129] offset:1536
    buffer_store_dwordx4 v[4:7], v125, s[28:31], s58 offen sc1
    s_waitcnt lgkmcnt(0)
    s_barrier
    buffer_store_dwordx4 v[0:3], v124, s[28:31], s58 offen sc1
    ds_read_b128 v[12:15], v131 offset:0
    ds_read_b128 v[4:7], v131 offset:1024
    ds_read_b128 v[0:3], v131 offset:2048
    s_waitcnt lgkmcnt(2)
    buffer_store_dwordx4 v[12:15], v8, s[28:31], 0 offen sc1
    s_waitcnt lgkmcnt(0)
    buffer_store_dwordx4 v[4:7], v9, s[28:31], 0 offen sc1
    buffer_store_dwordx4 v[0:3], v10, s[28:31], 0 offen sc1
    s_branch L_fin
L_again:
    s_waitcnt vmcnt(0) lgkmcnt(0)
    s_nop 15
    s_barrier
    s_movk_i32 s2, 256
    s_branch L_top
L_bndS:
    s_movk_i32 s73, 20
    s_movk_i32 s71, 18
    s_movk_i32 s70, -20
    s_mov_b32 s74, 0
    s_cmp_lt_u32 s2, 252
    s_cbranch_scc1 L_bndcS
    s_sub_u32 s94, s2, 252
    s_mul_i32 s69, s94, 18
    s_mov_b32 s74, 2
    s_sub_u32 s93, s93, 1373568
    v_cmp_le_u32 vcc, 4, v73
    v_add_u32 v6, 98896896, v128
    v_subrev_u32 v7, 1373568, v128
    v_cndmask_b32 v128, v6, v7, vcc
    v_cmp_le_u32 vcc, 4, v156
    v_add_u32 v6, 98896896, v127
    v_subrev_u32 v7, 1373568, v127
    v_cndmask_b32 v127, v6, v7, vcc
    v_cmp_le_u32 vcc, 4, v4
    v_add_u32 v6, 98896896, v126
    v_subrev_u32 v7, 1373568, v126
    v_cndmask_b32 v126, v6, v7, vcc
    v_cmp_le_u32 vcc, 4, v18
    v_add_u32 v6, 98896896, v125
    v_subrev_u32 v7, 1373568, v125
    v_cndmask_b32 v125, v6, v7, vcc
    v_cmp_le_u32 vcc, 4, v11
    v_add_u32 v6, 98896896, v124
    v_subrev_u32 v7, 1373568, v124
    v_cndmask_b32 v124, v6, v7, vcc
    s_cmp_lt_u32 s2, 256
    s_cbranch_scc1 L_bndrS
L_bndcS:
    s_sub_u32 s94, s2, 248
    s_mul_i32 s69, s94, 20
    s_lshr_b32 s71, s94, 1
    s_sub_u32 s69, s69, s71
    s_and_b32 s94, s94, 1
    s_sub_u32 s71, 20, s94
    s_cmp_eq_u32 s2, 251
    s_cselect_b32 s71, 13, s71
    s_mov_b32 s62, 1373568
    s_add_u32 s74, s74, 1
    s_sub_u32 s93, s93, 2688
    v_mad_i32_i24 v6, v73, -7, v74
    v_cmp_le_u32 vcc, 4, v6
    v_add_u32 v6, 193536, v128
    v_subrev_u32 v7, 2688, v128
    v_cndmask_b32 v128, v6, v7, vcc
    v_mad_i32_i24 v6, v156, -7, v150
    v_cmp_le_u32 vcc, 4, v6
    v_add_u32 v6, 193536, v127
    v_subrev_u32 v7, 2688, v127
    v_cndmask_b32 v127, v6, v7, vcc
    v_mad_i32_i24 v6, v4, -7, v10
    v_cmp_le_u32 vcc, 4, v6
    v_add_u32 v6, 193536, v126
    v_subrev_u32 v7, 2688, v126
    v_cndmask_b32 v126, v6, v7, vcc
    v_mad_i32_i24 v6, v18, -7, v159
    v_cmp_le_u32 vcc, 4, v6
    v_add_u32 v6, 193536, v125
    v_subrev_u32 v7, 2688, v125
    v_cndmask_b32 v125, v6, v7, vcc
    v_mad_i32_i24 v6, v11, -7, v151
    v_cmp_le_u32 vcc, 4, v6
    v_add_u32 v6, 193536, v124
    v_subrev_u32 v7, 2688, v124
    v_cndmask_b32 v124, v6, v7, vcc
    s_cmp_eq_u32 s2, 256
    s_cselect_b32 s62, 0, s62
    s_cselect_b32 s69, 0, s69
    s_cselect_b32 s71, 2, s71
    s_branch L_bndrS
L_maskS:
    s_and_b32 s20, s74, 2
    s_and_b32 s21, s74, 1
    s_mov_b32 s22, 0xc31044fe
    v_lshrrev_b32 v161, 2, v149
    v_add_u32 v161, 0, v161
    v_mul_u32_u24 v148, 37, v161
    v_lshrrev_b32 v72, 8, v148
    v_mad_i32_i24 v72, v72, -7, v161
    v_lshrrev_b32 v148, 10, v148
    v_lshrrev_b32 v72, 2, v72
    v_mul_u32_u24 v148, s20, v148
    v_mad_u32_u24 v161, v72, s21, v148
    v_cvt_f32_u32 v161, v161
    v_lshrrev_b32 v164, 2, v149
    v_add_u32 v164, 4, v164
    v_mul_u32_u24 v148, 37, v164
    v_lshrrev_b32 v72, 8, v148
    v_mad_i32_i24 v72, v72, -7, v164
    v_lshrrev_b32 v148, 10, v148
    v_lshrrev_b32 v72, 2, v72
    v_mul_u32_u24 v148, s20, v148
    v_mad_u32_u24 v164, v72, s21, v148
    v_cvt_f32_u32 v164, v164
    v_lshrrev_b32 v75, 2, v149
    v_add_u32 v75, 8, v75
    v_mul_u32_u24 v148, 37, v75
    v_lshrrev_b32 v72, 8, v148
    v_mad_i32_i24 v72, v72, -7, v75
    v_lshrrev_b32 v148, 10, v148
    v_lshrrev_b32 v72, 2, v72
    v_mul_u32_u24 v148, s20, v148
    v_mad_u32_u24 v75, v72, s21, v148
    v_cvt_f32_u32 v75, v75
    v_mad_u32_u24 v73, v160, 12, 0
    v_mul_u32_u24 v148, 37, v73
    v_lshrrev_b32 v72, 8, v148
    v_mad_i32_i24 v72, v72, -7, v73
    v_lshrrev_b32 v148, 10, v148
    v_lshrrev_b32 v72, 2, v72
    v_mul_u32_u24 v148, s20, v148
    v_mad_u32_u24 v73, v72, s21, v148
    v_cvt_f32_u32 v73, v73
    v_sub_f32 v148, v161, v73
    v_mul_f32 v148, v148, v148 clamp
    v_fmac_f32 v204, s22, v148
    v_sub_f32 v148, v164, v73
    v_mul_f32 v148, v148, v148 clamp
    v_fmac_f32 v192, s22, v148
    v_sub_f32 v148, v75, v73
    v_mul_f32 v148, v148, v148 clamp
    v_fmac_f32 v180, s22, v148
    v_mad_u32_u24 v73, v160, 12, 1
    v_mul_u32_u24 v148, 37, v73
    v_lshrrev_b32 v72, 8, v148
    v_mad_i32_i24 v72, v72, -7, v73
    v_lshrrev_b32 v148, 10, v148
    v_lshrrev_b32 v72, 2, v72
    v_mul_u32_u24 v148, s20, v148
    v_mad_u32_u24 v73, v72, s21, v148
    v_cvt_f32_u32 v73, v73
    v_sub_f32 v148, v161, v73
    v_mul_f32 v148, v148, v148 clamp
    v_fmac_f32 v205, s22, v148
    v_sub_f32 v148, v164, v73
    v_mul_f32 v148, v148, v148 clamp
    v_fmac_f32 v193, s22, v148
    v_sub_f32 v148, v75, v73
    v_mul_f32 v148, v148, v148 clamp
    v_fmac_f32 v181, s22, v148
    v_mad_u32_u24 v73, v160, 12, 2
    v_mul_u32_u24 v148, 37, v73
    v_lshrrev_b32 v72, 8, v148
    v_mad_i32_i24 v72, v72, -7, v73
    v_lshrrev_b32 v148, 10, v148
    v_lshrrev_b32 v72, 2, v72
    v_mul_u32_u24 v148, s20, v148
    v_mad_u32_u24 v73, v72, s21, v148
    v_cvt_f32_u32 v73, v73
    v_sub_f32 v148, v161, v73
    v_mul_f32 v148, v148, v148 clamp
    v_fmac_f32 v206, s22, v148
    v_sub_f32 v148, v164, v73
    v_mul_f32 v148, v148, v148 clamp
    v_fmac_f32 v194, s22, v148
    v_sub_f32 v148, v75, v73
    v_mul_f32 v148, v148, v148 clamp
    v_fmac_f32 v182, s22, v148
    v_mad_u32_u24 v73, v160, 12, 3
    v_mul_u32_u24 v148, 37, v73
    v_lshrrev_b32 v72, 8, v148
    v_mad_i32_i24 v72, v72, -7, v73
    v_lshrrev_b32 v148, 10, v148
    v_lshrrev_b32 v72, 2, v72
    v_mul_u32_u24 v148, s20, v148
    v_mad_u32_u24 v73, v72, s21, v148
    v_cvt_f32_u32 v73, v73
    v_sub_f32 v148, v161, v73
    v_mul_f32 v148, v148, v148 clamp
    v_fmac_f32 v207, s22, v148
    v_sub_f32 v148, v164, v73
    v_mul_f32 v148, v148, v148 clamp
    v_fmac_f32 v195, s22, v148
    v_sub_f32 v148, v75, v73
    v_mul_f32 v148, v148, v148 clamp
    v_fmac_f32 v183, s22, v148
    v_mad_u32_u24 v73, v160, 12, 4
    v_mul_u32_u24 v148, 37, v73
    v_lshrrev_b32 v72, 8, v148
    v_mad_i32_i24 v72, v72, -7, v73
    v_lshrrev_b32 v148, 10, v148
    v_lshrrev_b32 v72, 2, v72
    v_mul_u32_u24 v148, s20, v148
    v_mad_u32_u24 v73, v72, s21, v148
    v_cvt_f32_u32 v73, v73
    v_sub_f32 v148, v161, v73
    v_mul_f32 v148, v148, v148 clamp
    v_fmac_f32 v200, s22, v148
    v_sub_f32 v148, v164, v73
    v_mul_f32 v148, v148, v148 clamp
    v_fmac_f32 v188, s22, v148
    v_sub_f32 v148, v75, v73
    v_mul_f32 v148, v148, v148 clamp
    v_fmac_f32 v176, s22, v148
    v_mad_u32_u24 v73, v160, 12, 5
    v_mul_u32_u24 v148, 37, v73
    v_lshrrev_b32 v72, 8, v148
    v_mad_i32_i24 v72, v72, -7, v73
    v_lshrrev_b32 v148, 10, v148
    v_lshrrev_b32 v72, 2, v72
    v_mul_u32_u24 v148, s20, v148
    v_mad_u32_u24 v73, v72, s21, v148
    v_cvt_f32_u32 v73, v73
    v_sub_f32 v148, v161, v73
    v_mul_f32 v148, v148, v148 clamp
    v_fmac_f32 v201, s22, v148
    v_sub_f32 v148, v164, v73
    v_mul_f32 v148, v148, v148 clamp
    v_fmac_f32 v189, s22, v148
    v_sub_f32 v148, v75, v73
    v_mul_f32 v148, v148, v148 clamp
    v_fmac_f32 v177, s22, v148
    v_mad_u32_u24 v73, v160, 12, 6
    v_mul_u32_u24 v148, 37, v73
    v_lshrrev_b32 v72, 8, v148
    v_mad_i32_i24 v72, v72, -7, v73
    v_lshrrev_b32 v148, 10, v148
    v_lshrrev_b32 v72, 2, v72
    v_mul_u32_u24 v148, s20, v148
    v_mad_u32_u24 v73, v72, s21, v148
    v_cvt_f32_u32 v73, v73
    v_sub_f32 v148, v161, v73
    v_mul_f32 v148, v148, v148 clamp
    v_fmac_f32 v202, s22, v148
    v_sub_f32 v148, v164, v73
    v_mul_f32 v148, v148, v148 clamp
    v_fmac_f32 v190, s22, v148
    v_sub_f32 v148, v75, v73
    v_mul_f32 v148, v148, v148 clamp
    v_fmac_f32 v178, s22, v148
    v_mad_u32_u24 v73, v160, 12, 7
    v_mul_u32_u24 v148, 37, v73
    v_lshrrev_b32 v72, 8, v148
    v_mad_i32_i24 v72, v72, -7, v73
    v_lshrrev_b32 v148, 10, v148
    v_lshrrev_b32 v72, 2, v72
    v_mul_u32_u24 v148, s20, v148
    v_mad_u32_u24 v73, v72, s21, v148
    v_cvt_f32_u32 v73, v73
    v_sub_f32 v148, v161, v73
    v_mul_f32 v148, v148, v148 clamp
    v_fmac_f32 v203, s22, v148
    v_sub_f32 v148, v164, v73
    v_mul_f32 v148, v148, v148 clamp
    v_fmac_f32 v191, s22, v148
    v_sub_f32 v148, v75, v73
    v_mul_f32 v148, v148, v148 clamp
    v_fmac_f32 v179, s22, v148
    v_mad_u32_u24 v73, v160, 12, 8
    v_mul_u32_u24 v148, 37, v73
    v_lshrrev_b32 v72, 8, v148
    v_mad_i32_i24 v72, v72, -7, v73
    v_lshrrev_b32 v148, 10, v148
    v_lshrrev_b32 v72, 2, v72
    v_mul_u32_u24 v148, s20, v148
    v_mad_u32_u24 v73, v72, s21, v148
    v_cvt_f32_u32 v73, v73
    v_sub_f32 v148, v161, v73
    v_mul_f32 v148, v148, v148 clamp
    v_fmac_f32 v196, s22, v148
    v_sub_f32 v148, v164, v73
    v_mul_f32 v148, v148, v148 clamp
    v_fmac_f32 v184, s22, v148
    v_sub_f32 v148, v75, v73
    v_mul_f32 v148, v148, v148 clamp
    v_fmac_f32 v172, s22, v148
    v_mad_u32_u24 v73, v160, 12, 9
    v_mul_u32_u24 v148, 37, v73
    v_lshrrev_b32 v72, 8, v148
    v_mad_i32_i24 v72, v72, -7, v73
    v_lshrrev_b32 v148, 10, v148
    v_lshrrev_b32 v72, 2, v72
    v_mul_u32_u24 v148, s20, v148
    v_mad_u32_u24 v73, v72, s21, v148
    v_cvt_f32_u32 v73, v73
    v_sub_f32 v148, v161, v73
    v_mul_f32 v148, v148, v148 clamp
    v_fmac_f32 v197, s22, v148
    v_sub_f32 v148, v164, v73
    v_mul_f32 v148, v148, v148 clamp
    v_fmac_f32 v185, s22, v148
    v_sub_f32 v148, v75, v73
    v_mul_f32 v148, v148, v148 clamp
    v_fmac_f32 v173, s22, v148
    v_mad_u32_u24 v73, v160, 12, 10
    v_mul_u32_u24 v148, 37, v73
    v_lshrrev_b32 v72, 8, v148
    v_mad_i32_i24 v72, v72, -7, v73
    v_lshrrev_b32 v148, 10, v148
    v_lshrrev_b32 v72, 2, v72
    v_mul_u32_u24 v148, s20, v148
    v_mad_u32_u24 v73, v72, s21, v148
    v_cvt_f32_u32 v73, v73
    v_sub_f32 v148, v161, v73
    v_mul_f32 v148, v148, v148 clamp
    v_fmac_f32 v198, s22, v148
    v_sub_f32 v148, v164, v73
    v_mul_f32 v148, v148, v148 clamp
    v_fmac_f32 v186, s22, v148
    v_sub_f32 v148, v75, v73
    v_mul_f32 v148, v148, v148 clamp
    v_fmac_f32 v174, s22, v148
    v_mad_u32_u24 v73, v160, 12, 11
    v_mul_u32_u24 v148, 37, v73
    v_lshrrev_b32 v72, 8, v148
    v_mad_i32_i24 v72, v72, -7, v73
    v_lshrrev_b32 v148, 10, v148
    v_lshrrev_b32 v72, 2, v72
    v_mul_u32_u24 v148, s20, v148
    v_mad_u32_u24 v73, v72, s21, v148
    v_cvt_f32_u32 v73, v73
    v_sub_f32 v148, v161, v73
    v_mul_f32 v148, v148, v148 clamp
    v_fmac_f32 v199, s22, v148
    v_sub_f32 v148, v164, v73
    v_mul_f32 v148, v148, v148 clamp
    v_fmac_f32 v187, s22, v148
    v_sub_f32 v148, v75, v73
    v_mul_f32 v148, v148, v148 clamp
    v_fmac_f32 v175, s22, v148
    v_cvt_f32_u32 v73, s74
    v_sub_f32 v148, v161, v73
    v_mul_f32 v148, v148, v148 clamp
    v_fmac_f32 v208, s22, v148
    v_sub_f32 v148, v164, v73
    v_mul_f32 v148, v148, v148 clamp
    v_fmac_f32 v209, s22, v148
    v_sub_f32 v148, v75, v73
    v_mul_f32 v148, v148, v148 clamp
    v_fmac_f32 v210, s22, v148
    v_lshrrev_b32 v161, 2, v149
    v_lshl_add_u32 v161, v160, 2, v161
    v_add_u32 v148, 1, v160
    v_lshrrev_b32 v148, 2, v148
    v_mad_u32_u24 v161, v148, 36, v161
    v_min_u32 v161, 48, v161
    v_mul_u32_u24 v148, 37, v161
    v_lshrrev_b32 v72, 8, v148
    v_mad_i32_i24 v72, v72, -7, v161
    v_lshrrev_b32 v148, 10, v148
    v_lshrrev_b32 v72, 2, v72
    v_mul_u32_u24 v148, s20, v148
    v_mad_u32_u24 v161, v72, s21, v148
    v_cvt_f32_u32 v161, v161
    v_sub_f32 v148, v161, v73
    v_mul_f32 v148, v148, v148 clamp
    v_fmac_f32 v211, s22, v148
    s_branch L_nomaskS
L_atomS0:
    v_mov_b32 v122, 0x800000
    buffer_atomic_add v122, v129, s[8:11], 0 offen sc0 sc1
    s_branch L_atomS0r
.section .rodata,"a"
.p2align 6
.amdhsa_kernel standalone__window_attn_swin_v2__vision_kernel
  .amdhsa_next_free_vgpr 512
  .amdhsa_next_free_sgpr 102
  .amdhsa_accum_offset 256
  .amdhsa_group_segment_fixed_size 0
  .amdhsa_kernarg_size 96
  .amdhsa_user_sgpr_count 2
  .amdhsa_user_sgpr_kernarg_segment_ptr 1
  .amdhsa_system_sgpr_workgroup_id_x 1
.end_amdhsa_kernel
```

```asm
; @launch grid=(256,1,1) block=(256,1,1) lds=163840
.amdgcn_target "amdgcn-amd-amdhsa--gfx950"
.text
.globl standalone__window_attn_swin_v2__vision_kernel
.p2align 8
.type standalone__window_attn_swin_v2__vision_kernel,@function
standalone__window_attn_swin_v2__vision_kernel:
    v_lshrrev_b32 v0, 6, v0
    s_cmp_ge_u32 s2, 256
    s_cbranch_scc1 L_end
    v_readfirstlane_b32 s68, v0
L_top:
    s_mov_b32 s64, 0
    s_nop 0
    v_mbcnt_lo_u32_b32 v121, -1, 0
    v_mbcnt_hi_u32_b32 v121, -1, v121
    s_load_dwordx16 s[4:19], s[0:1], 0
    s_load_dwordx4 s[20:23], s[0:1], 64
    s_load_dwordx2 s[38:39], s[0:1], 80
    s_bfe_u32 s88, s2, 0x50003
    s_lshl2_add_u32 s88, s88, s68
    v_lshlrev_b32 v4, 7, v121
    s_getpc_b64 s[80:81]
    s_mul_i32 s84, s88, 288
    v_min_u32 v5, 256, v4
    v_add_u32 v5, s84, v5
    v_min_u32 v5, L_slow-standalone__window_attn_swin_v2__vision_kernel-256, v5
    s_mul_i32 s89, s88, 576
    s_mul_i32 s88, s88, 1728
    global_load_dword a255, v5, s[80:81]
    v_min_u32 v7, 1664, v4
    v_min_u32 v4, 512, v4
    s_mov_b32 s34, 221184
    s_mov_b32 s35, 0x20000
    s_mov_b32 s78, 73728
    s_mov_b32 s79, 0x20000
    v_and_b32 v141, 15, v121
    v_lshrrev_b32 v102, 4, v121
    v_lshrrev_b32 v208, 2, v141
    v_and_b32 v131, 3, v141
    s_mul_i32 s87, s68, 192
    v_mad_u32_u24 v3, v141, 12, s87
    v_lshlrev_b32 v6, 1, v141
    v_lshlrev_b32 v5, 1, v208
    v_lshl_add_u32 v5, v102, 5, v5
    s_movk_i32 s86, 384
    s_mov_b32 s26, 100270464
    s_mov_b32 s27, 0x20000
    s_mov_b32 s30, 0
    s_mov_b32 s31, 0x20000
    s_waitcnt lgkmcnt(0)
    s_mov_b32 s24, s4
    s_mov_b32 s25, s5
    s_mov_b32 s32, s6
    s_mov_b32 s33, s7
    s_mov_b32 s76, s8
    s_mov_b32 s77, s9
    buffer_load_dword a254, v7, s[32:35], s88 offen
    buffer_load_dword a253, v4, s[76:79], s89 offen
    s_load_dwordx2 s[82:83], s[10:11], 0
    s_movk_i32 s18, 676
    s_mov_b32 s19, 0x20000
    buffer_load_dwordx3 v[24:26], v3, s[16:19], 0 offen
    s_mul_i32 s96, s68, 288
    s_and_b32 s97, s68, 1
    s_lshl_b32 s97, s97, 2
    s_mov_b32 s98, 193536
    s_mov_b32 s99, 589824
    global_load_ushort v16, v6, s[12:13]
    v_add_u32 v7, s96, v121
    v_mul_u32_u24 v68, 2731, v7
    v_mul_u32_u24 v4, 6242, v7
    v_lshrrev_b32 v68, 16, v68
    v_lshrrev_b32 v4, 20, v4
    s_lshr_b32 s94, s2, 3
    s_mul_i32 s70, s94, 167
    global_load_ushort v17, v6, s[12:13] offset:32
    v_and_or_b32 v19, v68, 3, s97
    v_xor_b32 v19, v7, v19
    v_lshl_add_u32 v128, v19, 4, s99
    v_mad_u32_u24 v128, v4, s98, v128
    v_add_u32 v18, 64, v7
    s_min_u32 s95, s94, 7
    s_add_u32 s70, s70, s95
    global_load_ushort v100, v5, s[14:15] offset:0
    v_mul_u32_u24 v103, 2731, v18
    v_mul_u32_u24 v71, 6242, v18
    v_lshrrev_b32 v103, 16, v103
    v_lshrrev_b32 v71, 20, v71
    v_and_or_b32 v69, v103, 3, s97
    s_and_b32 s95, s2, 7
    s_mul_i32 s95, s95, 20
    global_load_ushort v6, v5, s[14:15] offset:8
    v_xor_b32 v69, v18, v69
    v_lshl_add_u32 v127, v69, 4, s99
    v_mad_u32_u24 v127, v71, s98, v127
    v_add_u32 v18, 128, v7
    v_mul_u32_u24 v129, 2731, v18
    s_add_u32 s69, s70, s95
    s_add_u32 s70, s70, 140
    global_load_ushort v101, v5, s[14:15] offset:16
    v_mul_u32_u24 v2, 6242, v18
    v_lshrrev_b32 v129, 16, v129
    v_lshrrev_b32 v2, 20, v2
    v_and_or_b32 v70, v129, 3, s97
    v_xor_b32 v70, v18, v70
    s_movk_i32 s62, 2688
    s_movk_i32 s71, 20
    global_load_ushort v27, v5, s[14:15] offset:24
    v_lshl_add_u32 v126, v70, 4, s99
    v_mad_u32_u24 v126, v2, s98, v126
    v_add_u32 v18, 192, v7
    v_mul_u32_u24 v130, 2731, v18
    v_mul_u32_u24 v5, 6242, v18
    v_lshrrev_b32 v130, 16, v130
    v_lshrrev_b32 v5, 20, v5
    v_and_or_b32 v0, v130, 3, s97
    v_xor_b32 v0, v18, v0
    v_lshl_add_u32 v125, v0, 4, s99
    v_mad_u32_u24 v125, v5, s98, v125
    v_add_u32 v124, 256, v7
    v_mul_u32_u24 v18, 2731, v124
    v_mul_u32_u24 v7, 6242, v124
    v_lshrrev_b32 v18, 16, v18
    v_lshrrev_b32 v7, 20, v7
    v_and_or_b32 v0, v18, 3, s97
    v_xor_b32 v0, v124, v0
    v_lshl_add_u32 v124, v0, 4, s99
    v_mad_u32_u24 v124, v7, s98, v124
    s_cmp_lt_u32 s94, 7
    s_cselect_b32 s73, 28, 27
    s_mov_b32 s93, 1769472
    s_mul_i32 s54, s68, 5120
    s_cmp_ge_u32 s2, 248
    s_cbranch_scc1 L_bndF
L_bndrF:
    s_mov_b32 s63, 1180032
    s_mul_i32 s94, s69, 58255
    s_lshr_b32 s94, s94, 22
    s_mul_i32 s94, s94, s63
    s_mul_i32 s72, s69, s62
    s_add_u32 s72, s72, s94
    v_lshl_or_b32 v140, v121, 4, 2.0
    s_sub_u32 s94, s73, 1
    s_max_u32 s94, s94, 20
    s_mul_i32 s95, s68, -44
    s_movk_i32 s99, -24
    s_add_u32 m0, s54, 0
    v_and_b32 v71, -4, v129
    s_mul_i32 s85, s68, 96
    s_sub_u32 s100, s85, 1024
    buffer_load_dwordx4 v128, s[24:27], s72 offen nt lds
    s_add_u32 m0, s54, 1024
    v_mad_u32_u24 v18, v71, 3, v129
    v_add_u32 v18, s95, v18
    v_mad_i32_i24 v70, v129, s99, v70
    v_med3_u32 v71, v18, 20, s94
    v_add_u32 v71, s70, v71
    v_add_u32 v129, s69, v18
    s_sub_u32 s87, s85, 2048
    s_movk_i32 s91, 1152
    buffer_load_dwordx4 v127, s[24:27], s72 offen nt lds
    v_cmp_gt_u32 vcc, s71, v18
    v_lshl_add_u32 v70, v70, 4, s93
    s_add_u32 m0, s54, 43008
    v_cndmask_b32 v129, v71, v129, vcc
    v_mul_u32_u24 v71, 58255, v129
    v_mad_u32_u24 v70, v129, s62, v70
    v_lshrrev_b32 v71, 22, v71
    v_mad_u32_u24 v70, v71, s63, v70
    s_mul_i32 s90, s68, 3072
    s_add_u32 s90, s90, 61440
    buffer_load_dwordx4 v70, s[24:27], 0 offen  lds
    v_lshlrev_b32 v71, 16, v18
    s_add_u32 m0, s54, 2048
    v_and_b32 v129, -4, v103
    v_mad_u32_u24 v18, v129, 3, v103
    v_add_u32 v18, s95, v18
    v_mad_i32_i24 v69, v103, s99, v69
    v_med3_u32 v129, v18, 20, s94
    s_add_u32 s101, s54, 44032
    s_mov_b32 s28, s22
    buffer_load_dwordx4 v126, s[24:27], s72 offen nt lds
    v_add_u32 v129, s70, v129
    v_add_u32 v103, s69, v18
    v_cmp_gt_u32 vcc, s71, v18
    v_lshl_add_u32 v69, v69, 4, s93
    s_add_u32 m0, s54, 41984
    v_cndmask_b32 v103, v129, v103, vcc
    v_mul_u32_u24 v129, 58255, v103
    v_mad_u32_u24 v69, v103, s62, v69
    v_lshrrev_b32 v129, 22, v129
    v_mad_u32_u24 v69, v129, s63, v69
    s_mov_b32 s29, s23
    s_mov_b32 s41, 0x2a8cbccc
    buffer_load_dwordx4 v69, s[24:27], 0 offen  lds
    v_lshl_or_b32 v71, v18, 8, v71
    s_add_u32 m0, s54, 3072
    v_cmp_gt_u32 vcc, 32, v121
    v_and_b32 v18, -4, v68
    v_mad_u32_u24 v103, v18, 3, v68
    v_cndmask_b32 v124, v140, v124, vcc
    v_add_u32 v103, s95, v103
    s_mov_b32 s42, 0x38fba882
    s_mov_b32 s43, 0x415db3d7
    buffer_load_dwordx4 v125, s[24:27], s72 offen nt lds
    s_add_u32 m0, s54, 4096
    v_mad_i32_i24 v68, v68, s99, v19
    v_med3_u32 v18, v103, 20, s94
    v_add_u32 v18, s70, v18
    v_add_u32 v19, s69, v103
    v_cmp_gt_u32 vcc, s71, v103
    v_lshl_add_u32 v68, v68, 4, s93
    s_mul_i32 s93, s68, 6
    s_lshl_b32 s94, s97, 1
    buffer_load_dwordx4 v124, s[24:27], s72 offen nt lds
    v_cndmask_b32 v19, v18, v19, vcc
    v_mul_u32_u24 v18, 58255, v19
    v_mad_u32_u24 v68, v19, s62, v68
    v_lshrrev_b32 v18, 22, v18
    v_mad_u32_u24 v68, v18, s63, v68
    s_add_u32 m0, s54, 40960
    v_lshl_or_b32 v71, v103, 0, v71
    s_mov_b32 s44, 61440
    s_mov_b32 s45, 40960
    buffer_load_dwordx4 v68, s[24:27], 0 offen nt lds
    v_mul_u32_u24 v5, 10923, v121
    v_lshrrev_b32 v43, 17, v5
    v_lshrrev_b32 v5, 16, v5
    v_mad_i32_i24 v2, v5, -6, v121
    v_bitop3_b32 v43, v43, v5, 4 bitop3:0x28
    v_lshl_add_u32 v2, v2, 4, s85
    v_mul_u32_u24 v43, 3, v43
    v_xor_b32 v5, v5, v43
    v_mad_u32_u24 v43, v5, s91, v2
    v_add_u32 v7, 64, v121
    v_mul_u32_u24 v4, 10923, v7
    v_lshrrev_b32 v42, 17, v4
    v_lshrrev_b32 v4, 16, v4
    v_mad_i32_i24 v1, v4, -6, v7
    v_bitop3_b32 v42, v42, v4, 4 bitop3:0x28
    v_lshl_add_u32 v1, v1, 4, s100
    v_mul_u32_u24 v42, 3, v42
    v_xor_b32 v4, v4, v42
    v_mad_u32_u24 v42, v4, s91, v1
    v_add_u32 v7, 128, v121
    v_mul_u32_u24 v103, 10923, v7
    v_lshrrev_b32 v0, 17, v103
    v_lshrrev_b32 v103, 16, v103
    v_mad_i32_i24 v7, v103, -6, v7
    v_bitop3_b32 v0, v0, v103, 4 bitop3:0x28
    v_lshl_add_u32 v7, v7, 4, s87
    v_mul_u32_u24 v0, 3, v0
    v_xor_b32 v103, v103, v0
    v_mad_u32_u24 v0, v103, s91, v7
    v_mad_u32_u24 v5, v5, s86, v2
    v_mad_u32_u24 v4, v4, s86, v1
    v_mad_u32_u24 v166, v103, s86, v7
    s_add_u32 m0, s90, 0
    s_mov_b32 s92, 0
    buffer_load_dwordx4 v43, s[32:35], s92 offen offset:0 lds
    v_lshrrev_b32 v103, 1, v102
    v_lshl_add_u32 v7, v102, 2, v208
    v_lshl_add_u32 v7, v103, 3, v7
    v_mul_u32_u24 v7, 96, v7
    v_add_u32 v7, s90, v7
    v_lshl_add_u32 v143, v131, 4, v7
    v_lshl_add_u32 v142, v131, 3, v7
    v_mov_b32 v7, 0x3f803f80
    v_cmp_eq_u32 vcc, 0, v131
    v_and_b32 v103, 1, v121
    v_lshlrev_b32 v103, 4, v103
    v_cndmask_b32 v220, 0, v7, vcc
    v_cndmask_b32 v221, 0, v7, vcc
    v_cndmask_b32 v222, 0, v7, vcc
    v_cndmask_b32 v223, 0, v7, vcc
    v_mov_b32 v7, 0x3f80
    v_lshlrev_b32 v219, v103, v7
    v_cmp_gt_u32 vcc, 2, v131
    v_mov_b32 v103, 0x44004400
    v_mul_u32_u24 v105, 48, v208
    v_cndmask_b32 v216, 0, v219, vcc
    v_cndmask_b32 v218, 0, v219, vcc
    v_cmp_le_u32 vcc, 2, v131
    v_lshl_add_u32 v105, v131, 2, v105
    v_mul_u32_u24 v7, 48, v102
    v_cndmask_b32 v217, 0, v219, vcc
    v_cndmask_b32 v219, 0, v219, vcc
    v_cmp_eq_u32 vcc, v102, v208
    v_add_u32 v199, 0, v105
    v_mul_u32_u24 v1, 37, v199
    v_cndmask_b32 v94, 0, v216, vcc
    v_cndmask_b32 v95, 0, v217, vcc
    v_cmp_eq_u32 vcc, 0, v131
    v_lshrrev_b32 v1, 10, v1
    v_mad_u32_u24 v199, v1, 24, v199
    v_cndmask_b32 v212, 0, v103, vcc
    v_cmp_eq_u32 vcc, 1, v131
    v_add_u32 v199, s101, v199
    v_add_u32 v187, 16, v105
    v_cndmask_b32 v213, 0, v103, vcc
    v_cmp_eq_u32 vcc, 2, v131
    v_mul_u32_u24 v215, 37, v187
    v_lshrrev_b32 v215, 10, v215
    v_cndmask_b32 v214, 0, v103, vcc
    v_cmp_eq_u32 vcc, 3, v131
    v_mad_u32_u24 v187, v215, 24, v187
    v_add_u32 v187, s101, v187
    v_cndmask_b32 v215, 0, v103, vcc
    v_add_u32 v175, 32, v105
    v_mul_u32_u24 v103, 37, v175
    v_lshrrev_b32 v103, 10, v103
    v_mad_u32_u24 v175, v103, 24, v175
    v_add_u32 v175, s101, v175
    v_add_u32 v204, 0, v7
    v_mul_u32_u24 v103, 37, v204
    v_lshrrev_b32 v103, 10, v103
    v_mad_u32_u24 v204, v103, 24, v204
    v_add_u32 v205, 4, v7
    v_mul_u32_u24 v103, 37, v205
    v_lshrrev_b32 v103, 10, v103
    v_mad_u32_u24 v205, v103, 24, v205
    v_add_u32 v206, 8, v7
    v_mul_u32_u24 v103, 37, v206
    v_lshrrev_b32 v103, 10, v103
    v_mad_u32_u24 v206, v103, 24, v206
    v_add_u32 v207, 12, v7
    v_mul_u32_u24 v103, 37, v207
    v_lshrrev_b32 v103, 10, v103
    v_mad_u32_u24 v207, v103, 24, v207
    v_add_u32 v138, 16, v7
    v_mul_u32_u24 v103, 37, v138
    v_lshrrev_b32 v103, 10, v103
    v_mad_u32_u24 v138, v103, 24, v138
    v_add_u32 v139, 20, v7
    v_mul_u32_u24 v103, 37, v139
    v_lshrrev_b32 v103, 10, v103
    v_mad_u32_u24 v139, v103, 24, v139
    v_add_u32 v92, 24, v7
    v_mul_u32_u24 v93, 37, v92
    v_lshrrev_b32 v93, 10, v93
    v_mad_u32_u24 v92, v93, 24, v92
    v_add_u32 v93, 28, v7
    v_mul_u32_u24 v103, 37, v93
    v_lshrrev_b32 v103, 10, v103
    v_mad_u32_u24 v93, v103, 24, v93
    s_waitcnt lgkmcnt(0)
    s_sext_i32_i16 s84, s82
    s_ashr_i32 s85, s82, 16
    s_max_i32 s84, s84, s85
    s_sext_i32_i16 s85, s83
    s_max_i32 s84, s84, s85
    s_ashr_i32 s85, s83, 16
    s_max_i32 s84, s84, s85
    s_cmp_gt_i32 s84, 16492
    s_cbranch_scc1 L_slow
    s_lshl_b32 s84, s68, 4
    buffer_load_dwordx4 v42, s[32:35], s92 offen offset:1024 lds
    v_add_u32 v41, 32, v7
    v_mul_u32_u24 v40, 37, v41
    v_lshrrev_b32 v40, 10, v40
    v_mad_u32_u24 v41, v40, 24, v41
    v_add_u32 v40, 36, v7
    v_mul_u32_u24 v103, 37, v40
    v_lshrrev_b32 v103, 10, v103
    s_lshr_b64 s[82:83], s[82:83], s84
    s_lshl_b32 s82, s82, 16
    buffer_load_dwordx4 v0, s[32:35], s92 offen offset:2048 lds
    s_add_u32 m0, s90, 12288
    s_mov_b32 s92, 36864
    v_mad_u32_u24 v40, v103, 24, v40
    v_add_u32 v103, 40, v7
    v_mul_u32_u24 v1, 37, v103
    v_lshrrev_b32 v1, 10, v1
    v_mad_u32_u24 v103, v1, 24, v103
    s_mov_b32 s84, 0x41b8aa3b
    s_mov_b32 s46, 20480
    buffer_load_dwordx4 v43, s[32:35], s92 offen offset:0 lds
    v_add_u32 v1, 44, v7
    v_mul_u32_u24 v2, 37, v1
    v_lshrrev_b32 v2, 10, v2
    v_mad_u32_u24 v1, v2, 24, v1
    v_lshl_add_u32 v2, v102, 4, v105
    v_mul_u32_u24 v7, 37, v2
    v_lshrrev_b32 v7, 10, v7
    v_mad_u32_u24 v2, v7, 24, v2
    v_mov_b32 v18, 336
    v_cmp_gt_u32 vcc, 3, v102
    v_mov_b32 v7, s82
    v_min_f32 v7, 0x40930000, v7
    v_cndmask_b32 v2, v18, v2, vcc
    v_sub_u32 v2, s101, v2
    v_max_f32 v7, 0xc2c80000, v7
    s_mov_b32 s47, 0
    s_mov_b32 s57, s72
    buffer_load_dwordx4 v42, s[32:35], s92 offen offset:1024 lds
    v_mul_f32 v7, 0x3fb8aa3b, v7
    v_exp_f32 v7, v7
    s_waitcnt vmcnt(17)
    v_lshl_or_b32 v16, v17, 16, v16
    v_cvt_pk_bf16_f32 v7, v7, v7
    v_lshlrev_b32 v7, 16, v7
    v_mul_f32 v7, 0x4038aa3b, v7
    s_waitcnt vmcnt(15)
    v_lshl_or_b32 v100, v6, 16, v100
    v_readfirstlane_b32 s55, v7
    v_add_f32 v7, v7, v7
    s_waitcnt vmcnt(13)
    v_lshl_or_b32 v101, v27, 16, v101
    v_readfirstlane_b32 s52, v7
    v_cmp_gt_u32 vcc, 16, v121
    v_mov_b32 v17, 0
    v_mov_b32 v18, 0
    v_cndmask_b32 v19, 0, v16, vcc
    v_cndmask_b32 v16, 0, v16, vcc
    v_mov_b32 v27, 0
    v_mfma_f32_16x16x16_bf16 v[8:11], v[18:19], v[24:25], 0
    s_mov_b32 s58, 0
    v_mul_u32_u24 v6, 5120, v102
    v_add_u32 v6, v3, v6
    v_mfma_f32_16x16x16_bf16 v[12:15], v[16:17], v[24:25], 0
    s_mov_b32 s59, 0
    v_mov_b32 v7, 0xc138aa3b
    v_and_b32 v3, 8, v141
    v_mfma_f32_16x16x16_bf16 v[20:23], v[16:17], v[26:27], 0
    s_mov_b32 s60, 0
    v_max_f32 v8, 0, v8
    v_max_f32 v9, 0, v9
    v_max_f32 v10, 0, v10
    v_max_f32 v12, 0, v12
    v_max_f32 v13, 0, v13
    v_max_f32 v14, 0, v14
    v_max_f32 v15, 0, v15
    v_cvt_pk_bf16_f32 v12, v12, v13
    v_cvt_pk_bf16_f32 v13, v14, v15
    v_max_f32 v11, 0, v11
    v_cvt_pk_bf16_f32 v8, v8, v9
    v_mfma_f32_16x16x16_bf16 v[16:19], v[100:101], v[12:13], 0
    s_mov_b32 s65, -1
    v_cvt_pk_bf16_f32 v9, v10, v11
    v_max_f32 v20, 0, v20
    v_max_f32 v21, 0, v21
    v_mfma_f32_16x16x16_bf16 v[12:15], v[100:101], v[8:9], 0
    s_mov_b32 s61, 1
    v_max_f32 v22, 0, v22
    v_max_f32 v23, 0, v23
    v_cvt_pk_bf16_f32 v20, v20, v21
    v_cvt_pk_bf16_f32 v21, v22, v23
    v_cvt_pk_bf16_f32 v16, v16, v16
    v_lshlrev_b32 v16, 16, v16
    v_mfma_f32_16x16x16_bf16 v[8:11], v[100:101], v[20:21], 0
    s_movk_i32 s4, 112
    v_mul_f32 v16, 0xbfb8aa3b, v16
    v_cvt_pk_bf16_f32 v12, v12, v12
    v_exp_f32 v16, v16
    v_lshlrev_b32 v12, 16, v12
    v_add_f32 v16, 1.0, v16
    v_rcp_f32 v16, v16
    v_mul_f32 v12, 0xbfb8aa3b, v12
    v_cvt_pk_bf16_f32 v16, v16, v16
    v_lshlrev_b32 v16, 16, v16
    v_fma_f32 v16, v16, s84, v7
    s_mov_b32 s5, 0
    s_mov_b32 s6, 0
    ds_write_b32 v6, v16 offset:44032
    v_exp_f32 v12, v12
    v_cvt_pk_bf16_f32 v8, v8, v8
    v_add_f32 v12, 1.0, v12
    v_rcp_f32 v12, v12
    v_lshlrev_b32 v8, 16, v8
    v_cvt_pk_bf16_f32 v12, v12, v12
    v_lshlrev_b32 v12, 16, v12
    v_fma_f32 v12, v12, s84, v7
    s_mov_b32 s12, 0
    s_mov_b32 s64, 3
    ds_write_b32 v6, v12 offset:44036
    v_mul_f32 v8, 0xbfb8aa3b, v8
    v_exp_f32 v8, v8
    v_add_u32 v3, v3, v141
    v_add_f32 v8, 1.0, v8
    v_rcp_f32 v8, v8
    v_mul_u32_u24 v3, 96, v3
    v_cvt_pk_bf16_f32 v8, v8, v8
    v_lshlrev_b32 v8, 16, v8
    v_fma_f32 v8, v8, s84, v7
    s_mov_b32 s10, 81924
    s_mov_b32 s11, 0x20000
    ds_write_b32 v6, v8 offset:44040
    v_add_u32 v3, s90, v3
    v_lshl_add_u32 v118, v102, 4, v3
    v_lshl_add_u32 v101, v102, 3, v3
    v_lshlrev_b32 v100, 4, v102
    v_add_u32 v100, 4608, v100
    v_mul_u32_u24 v7, 5120, v208
    v_mad_u32_u24 v7, v131, s86, v7
    v_and_b32 v129, 7, v141
    v_xor_b32 v132, v129, v102
    v_lshl_add_u32 v6, v132, 4, v7
    v_xor_b32 v3, 64, v6
    v_add_u32 v137, 40960, v6
    v_xor_b32 v136, 64, v137
    v_add_u32 v7, 61440, v7
    v_add_u32 v132, s93, v102
    v_xor_b32 v132, v129, v132
    v_lshl_add_u32 v135, v132, 4, v7
    v_lshrrev_b32 v132, 1, v102
    v_add3_u32 v132, v132, s93, 4
    v_xor_b32 v132, v129, v132
    v_lshl_add_u32 v132, v132, 4, v7
    v_and_b32 v7, 1, v102
    v_lshl_add_u32 v134, v7, 3, v132
    v_lshlrev_b32 v7, 4, v121
    s_add_u32 s93, s54, 20480
    v_add_u32 v133, s93, v7
    v_add_u32 v129, 81920, v7
    s_lshr_b32 s93, s68, 1
    s_lshl_b32 s93, s93, 10
    s_add_u32 s93, s93, s94
    v_add_u32 v130, s93, v129
    s_mul_i32 s93, s68, 7168
    s_add_u32 s93, s93, 135168
    s_waitcnt lgkmcnt(0)
    s_barrier
    ds_read_b32 v209, v187
    v_mul_u32_u24 v7, 1792, v102
    v_add_u32 v132, s93, v7
    v_mul_u32_u24 v7, 112, v141
    v_add_u32 v120, v7, v132
    v_subrev_u32 v120, 28672, v120
    v_cmp_eq_u32 vcc, 0, v208
    v_add_u32 v7, 16, v132
    s_mov_b32 s30, 100270464
    buffer_load_dwordx4 v0, s[32:35], s92 offen offset:2048 lds
    s_add_u32 m0, s90, 24576
    s_mov_b32 s92, 73728
    ds_read_b32 v210, v175
    v_cndmask_b32 v132, v140, v132, vcc
    v_cmp_eq_u32 vcc, 3, v131
    v_mov_b32 v123, 0
    v_mov_b32 v122, 0
    v_cndmask_b32 v132, v132, v7, vcc
    v_mul_u32_u24 v7, 1792, v208
    v_lshl_add_u32 v7, v102, 3, v7
    v_lshl_add_u32 v7, v131, 1, v7
    v_add_u32 v7, s93, v7
    v_cmp_gt_u32 vcc, 3, v102
    s_add_u32 s93, s69, 1
    s_mul_i32 s94, s93, 58255
    ds_read_b32 v208, v199
    v_cndmask_b32 v131, v140, v7, vcc
    s_lshr_b32 s94, s94, 22
    s_mul_i32 s94, s94, s63
    s_mul_i32 s56, s93, s62
    s_add_u32 s56, s56, s94
    buffer_load_dwordx4 v43, s[32:35], s92 offen offset:0 lds
    s_and_b32 s94, s68, 1
    s_mul_i32 s94, s94, -2304
    s_sub_u32 s93, s71, 1
    s_cmp_eq_u32 s68, 0
    s_cselect_b32 s13, s93, -1
    s_cmp_gt_u32 s73, 20
    s_cselect_b32 s13, s13, -1
    s_and_b32 s93, s2, -8
    s_sub_u32 s93, 81920, s93
    s_sub_u32 s8, s38, s93
    s_subb_u32 s9, s39, 0
    buffer_load_dwordx4 v42, s[32:35], s92 offen offset:1024 lds
    s_lshr_b32 s93, s68, 1
    s_mul_i32 s93, s93, 30720
    s_add_u32 s93, s93, s94
    ds_read_b32 v211, v2 offset:672
    v_add_u32 v7, s93, v118
    v_add_u32 v2, s93, v101
    s_lshr_b32 s93, s68, 1
    s_mul_i32 s93, s93, 5120
    s_lshl_b32 s94, s97, 4
    s_add_u32 s93, s93, s94
    v_add_u32 v97, s93, v100
    v_cmp_eq_u32 vcc, 0, v141
    s_mov_b32 s39, 0x00010001
    v_sub_u32 v192, v187, v204
    v_cndmask_b32 v97, v140, v97, vcc
    ds_read_b32 v192, v192 offset:336
    v_sub_u32 v193, v187, v205
    v_sub_u32 v194, v187, v206
    v_sub_u32 v195, v187, v207
    v_sub_u32 v188, v187, v138
    v_sub_u32 v189, v187, v139
    buffer_load_dwordx4 v0, s[32:35], s92 offen offset:2048 lds
    s_add_u32 m0, s90, 36864
    s_mov_b32 s92, 110592
    ds_read_b32 v193, v193 offset:336
    v_sub_u32 v190, v187, v92
    v_sub_u32 v191, v187, v93
    v_sub_u32 v184, v187, v41
    v_sub_u32 v185, v187, v40
    v_sub_u32 v186, v187, v103
    s_mov_b64 exec, 0
    s_cmp_eq_u32 s68, 2
    s_cbranch_scc1 L_pga
    s_cmp_eq_u32 s68, 3
    s_cbranch_scc1 L_pg2
    s_cmp_eq_u32 s68, 1
    s_cbranch_scc1 L_pg1
    s_branch L_pg0
.p2align 12
L_main:
    s_mov_b64 exec, -1
    s_waitcnt vmcnt(9)
    s_barrier
    ds_read_b32 v194, v194 offset:336
    v_sub_u32 v187, v187, v1
    v_sub_u32 v180, v175, v204
    v_sub_u32 v181, v175, v205
    v_sub_u32 v182, v175, v206
    v_sub_u32 v183, v175, v207
    ds_read_b32 v195, v195 offset:336
    v_sub_u32 v176, v175, v138
    v_sub_u32 v177, v175, v139
    v_sub_u32 v178, v175, v92
    v_sub_u32 v179, v175, v93
    v_sub_u32 v172, v175, v41
    ds_read_b32 v188, v188 offset:336
    v_sub_u32 v173, v175, v40
    v_sub_u32 v174, v175, v103
    buffer_load_dwordx4 v43, s[32:35], s92 offen offset:0 lds
    ds_read_b32 v189, v189 offset:336
    v_sub_u32 v175, v175, v1
    v_sub_u32 v204, v199, v204
    v_sub_u32 v205, v199, v205
    v_sub_u32 v206, v199, v206
    v_sub_u32 v207, v199, v207
    ds_read_b32 v190, v190 offset:336
    v_sub_u32 v200, v199, v138
    v_sub_u32 v201, v199, v139
    v_sub_u32 v202, v199, v92
    v_sub_u32 v203, v199, v93
    v_sub_u32 v196, v199, v41
    ds_read_b32 v191, v191 offset:336
    buffer_load_dwordx4 v42, s[32:35], s92 offen offset:1024 lds
    v_sub_u32 v197, v199, v40
    v_sub_u32 v198, v199, v103
    v_sub_u32 v199, v199, v1
    ds_read_b32 v184, v184 offset:336
    ds_read_b32 v185, v185 offset:336
    ds_read_b32 v186, v186 offset:336
    buffer_load_dwordx4 v0, s[32:35], s92 offen offset:2048 lds
    s_add_u32 m0, s90, 49152
    s_mov_b32 s92, 147456
    s_waitcnt vmcnt(9)
    ds_read_b64_tr_b16 a[0:1], v142 offset:0
    ds_read_b64_tr_b16 a[2:3], v142 offset:768
    ds_read_b64_tr_b16 a[24:25], v142 offset:32
    ds_read_b64_tr_b16 a[26:27], v142 offset:800
    ds_read_b64_tr_b16 a[48:49], v142 offset:64
    ds_read_b64_tr_b16 a[50:51], v142 offset:832
    ds_read_b32 v187, v187 offset:336
    buffer_load_dwordx4 v43, s[32:35], s92 offen offset:0 lds
    ds_read_b128 v[24:27], v6 offset:40960
    ds_read_b128 v[12:15], v6 offset:42496
    ds_read_b128 v[20:23], v6 offset:0
    ds_read_b128 v[8:11], v6 offset:1536
    ds_read_b128 v[16:19], v6 offset:3072
    buffer_load_dwordx4 v42, s[32:35], s92 offen offset:1024 lds
    ds_read_b32 v180, v180 offset:336
    ds_read_b32 v181, v181 offset:336
    ds_read_b32 v182, v182 offset:336
    s_waitcnt lgkmcnt(7)
    v_mfma_f32_16x16x32_bf16 v[72:75], a[0:3], v[24:27], 0
    buffer_load_dwordx4 v0, s[32:35], s92 offen offset:2048 lds
    v_mfma_f32_16x16x32_bf16 v[44:47], a[24:27], v[24:27], 0
    s_waitcnt vmcnt(9)
    s_add_u32 m0, s90, 61440
    ds_read_b64_tr_b16 a[4:5], v142 offset:12288
    v_mfma_f32_16x16x32_bf16 v[56:59], a[48:51], v[24:27], 0
    s_waitcnt lgkmcnt(5)
    s_mov_b32 s92, 184320
    ds_read_b64_tr_b16 a[6:7], v142 offset:13056
    v_mfma_f32_16x16x32_bf16 v[48:51], a[0:3], v[12:15], 0
    ds_read_b64_tr_b16 a[28:29], v142 offset:12320
    v_mfma_f32_16x16x32_bf16 v[112:115], a[24:27], v[12:15], 0
    ds_read_b64_tr_b16 a[30:31], v142 offset:13088
    v_mfma_f32_16x16x32_bf16 v[88:91], a[48:51], v[12:15], 0
    ds_read_b64_tr_b16 a[52:53], v142 offset:12352
    buffer_load_dwordx4 v43, s[32:35], s92 offen offset:0 lds
    v_mfma_f32_16x16x32_bf16 v[28:31], a[0:3], v[20:23], 0
    ds_read_b64_tr_b16 a[54:55], v142 offset:13120
    v_mfma_f32_16x16x32_bf16 v[12:15], a[24:27], v[20:23], 0
    ds_read_b128 v[152:155], v6 offset:41088
    v_mfma_f32_16x16x32_bf16 v[32:35], a[48:51], v[20:23], 0
    ds_read_b128 v[76:79], v6 offset:42624
    v_mfma_f32_16x16x32_bf16 v[144:147], a[0:3], v[8:11], 0
    ds_read_b128 v[148:151], v6 offset:128
    v_mfma_f32_16x16x32_bf16 v[52:55], a[24:27], v[8:11], 0
    ds_read_b128 v[36:39], v6 offset:1664
    buffer_load_dwordx4 v42, s[32:35], s92 offen offset:1024 lds
    v_mfma_f32_16x16x32_bf16 v[24:27], a[48:51], v[8:11], 0
    s_waitcnt lgkmcnt(8)
    ds_read_b128 v[84:87], v6 offset:3200
    v_mfma_f32_16x16x32_bf16 v[64:67], a[0:3], v[16:19], 0
    ds_read_b128 v[156:159], v3 offset:41088
    v_mfma_f32_16x16x32_bf16 v[20:23], a[24:27], v[16:19], 0
    ds_read_b128 v[80:83], v3 offset:42624
    v_mfma_f32_16x16x32_bf16 v[8:11], a[48:51], v[16:19], 0
    s_waitcnt vmcnt(8)
    ds_read_b128 v[108:111], v3 offset:128
    ds_read_b128 v[16:19], v3 offset:1664
    buffer_load_dwordx4 v0, s[32:35], s92 offen offset:2048 lds
    s_add_u32 m0, s90, 0
    s_mov_b32 s92, 384
    ds_read_b64_tr_b16 a[8:9], v142 offset:24576
    ds_read_b64_tr_b16 a[10:11], v142 offset:25344
    ds_read_b64_tr_b16 a[32:33], v142 offset:24608
    ds_read_b64_tr_b16 a[34:35], v142 offset:25376
    ds_read_b64_tr_b16 a[56:57], v142 offset:24640
    ds_read_b64_tr_b16 a[58:59], v142 offset:25408
    ds_read_b128 v[60:63], v3 offset:3200
    ds_read_b128 v[168:171], v3 offset:40960
    buffer_load_dwordx4 v43, s[32:35], s92 offen offset:0 lds
    ds_read_b128 v[160:163], v3 offset:42496
    ds_read_b32 v183, v183 offset:336
    ds_read_b32 v176, v176 offset:336
    ds_read_b32 v177, v177 offset:336
    buffer_load_dwordx4 v42, s[32:35], s92 offen offset:1024 lds
    ds_read_b32 v178, v178 offset:336
    ds_read_b32 v179, v179 offset:336
    s_waitcnt lgkmcnt(6)
    v_mfma_f32_16x16x32_bf16 v[72:75], a[4:7], v[168:171], v[72:75]
    ds_read_b32 v172, v172 offset:336
    v_mfma_f32_16x16x32_bf16 v[72:75], a[8:11], v[152:155], v[72:75]
    buffer_load_dwordx4 v0, s[32:35], s92 offen offset:2048 lds
    v_mfma_f32_16x16x32_bf16 v[44:47], a[28:31], v[168:171], v[44:47]
    s_waitcnt vmcnt(9)
    s_add_u32 m0, s90, 12288
    ds_read_b64_tr_b16 a[12:13], v142 offset:36864
    v_mfma_f32_16x16x32_bf16 v[44:47], a[32:35], v[152:155], v[44:47]
    s_mov_b32 s92, 37248
    ds_read_b64_tr_b16 a[14:15], v142 offset:37632
    v_mfma_f32_16x16x32_bf16 v[56:59], a[52:55], v[168:171], v[56:59]
    ds_read_b64_tr_b16 a[36:37], v142 offset:36896
    v_mfma_f32_16x16x32_bf16 v[56:59], a[56:59], v[152:155], v[56:59]
    s_waitcnt lgkmcnt(6)
    ds_read_b64_tr_b16 a[38:39], v142 offset:37664
    v_mfma_f32_16x16x32_bf16 v[48:51], a[4:7], v[160:163], v[48:51]
    buffer_load_dwordx4 v43, s[32:35], s92 offen offset:0 lds
    ds_read_b64_tr_b16 a[60:61], v142 offset:36928
    v_mfma_f32_16x16x32_bf16 v[48:51], a[8:11], v[76:79], v[48:51]
    ds_read_b64_tr_b16 a[62:63], v142 offset:37696
    v_mfma_f32_16x16x32_bf16 v[112:115], a[28:31], v[160:163], v[112:115]
    ds_read_b128 v[152:155], v3 offset:0
    v_mfma_f32_16x16x32_bf16 v[112:115], a[32:35], v[76:79], v[112:115]
    ds_read_b32 v173, v173 offset:336
    v_mfma_f32_16x16x32_bf16 v[88:91], a[52:55], v[160:163], v[88:91]
    v_mfma_f32_16x16x32_bf16 v[88:91], a[56:59], v[76:79], v[88:91]
    s_waitcnt lgkmcnt(6)
    buffer_load_dwordx4 v42, s[32:35], s92 offen offset:1024 lds
    ds_read_b32 v174, v174 offset:336
    v_mfma_f32_16x16x32_bf16 v[72:75], a[12:15], v[156:159], v[72:75]
    v_mfma_f32_16x16x32_bf16 v[48:51], a[12:15], v[80:83], v[48:51]
    s_waitcnt lgkmcnt(5)
    ds_read_b128 v[76:79], v3 offset:1536
    v_mfma_f32_16x16x32_bf16 v[44:47], a[36:39], v[156:159], v[44:47]
    ds_read_b32 v175, v175 offset:336
    v_mfma_f32_16x16x32_bf16 v[112:115], a[36:39], v[80:83], v[112:115]
    s_waitcnt lgkmcnt(5)
    v_mfma_f32_16x16x32_bf16 v[56:59], a[60:63], v[156:159], v[56:59]
    s_waitcnt vmcnt(8)
    buffer_load_dwordx4 v0, s[32:35], s92 offen offset:2048 lds
    ds_read_b64_tr_b16 a[16:17], v142 offset:49152
    v_mfma_f32_16x16x32_bf16 v[88:91], a[60:63], v[80:83], v[88:91]
    s_waitcnt lgkmcnt(4)
    s_add_u32 m0, s90, 24576
    ds_read_b64_tr_b16 a[18:19], v142 offset:49920
    v_mfma_f32_16x16x32_bf16 v[28:31], a[4:7], v[152:155], v[28:31]
    s_mov_b32 s92, 74112
    ds_read_b64_tr_b16 a[40:41], v142 offset:49184
    v_mfma_f32_16x16x32_bf16 v[28:31], a[8:11], v[148:151], v[28:31]
    ds_read_b64_tr_b16 a[42:43], v142 offset:49952
    v_mfma_f32_16x16x32_bf16 v[28:31], a[12:15], v[108:111], v[28:31]
    ds_read_b64_tr_b16 a[64:65], v142 offset:49216
    v_mfma_f32_16x16x32_bf16 v[12:15], a[28:31], v[152:155], v[12:15]
    buffer_load_dwordx4 v43, s[32:35], s92 offen offset:0 lds
    ds_read_b64_tr_b16 a[66:67], v142 offset:49984
    v_mfma_f32_16x16x32_bf16 v[12:15], a[32:35], v[148:151], v[12:15]
    ds_read_b128 v[80:83], v3 offset:3072
    v_mfma_f32_16x16x32_bf16 v[12:15], a[36:39], v[108:111], v[12:15]
    ds_read_b32 v204, v204 offset:336
    v_mfma_f32_16x16x32_bf16 v[32:35], a[52:55], v[152:155], v[32:35]
    v_mfma_f32_16x16x32_bf16 v[32:35], a[56:59], v[148:151], v[32:35]
    ds_read_b32 v205, v205 offset:336
    v_mfma_f32_16x16x32_bf16 v[32:35], a[60:63], v[108:111], v[32:35]
    s_waitcnt lgkmcnt(7)
    buffer_load_dwordx4 v42, s[32:35], s92 offen offset:1024 lds
    v_mfma_f32_16x16x32_bf16 v[144:147], a[4:7], v[76:79], v[144:147]
    ds_read_b32 v206, v206 offset:336
    v_mfma_f32_16x16x32_bf16 v[144:147], a[8:11], v[36:39], v[144:147]
    v_mfma_f32_16x16x32_bf16 v[144:147], a[12:15], v[16:19], v[144:147]
    ds_read_b32 v207, v207 offset:336
    v_mfma_f32_16x16x32_bf16 v[52:55], a[28:31], v[76:79], v[52:55]
    v_mfma_f32_16x16x32_bf16 v[52:55], a[32:35], v[36:39], v[52:55]
    s_waitcnt vmcnt(8)
    buffer_load_dwordx4 v0, s[32:35], s92 offen offset:2048 lds
    ds_read_b64_tr_b16 a[20:21], v142 offset:61440
    v_mfma_f32_16x16x32_bf16 v[52:55], a[36:39], v[16:19], v[52:55]
    s_add_u32 m0, s90, 36864
    ds_read_b64_tr_b16 a[22:23], v142 offset:62208
    v_mfma_f32_16x16x32_bf16 v[24:27], a[52:55], v[76:79], v[24:27]
    s_mov_b32 s92, 110976
    ds_read_b64_tr_b16 a[44:45], v142 offset:61472
    v_mfma_f32_16x16x32_bf16 v[24:27], a[56:59], v[36:39], v[24:27]
    ds_read_b64_tr_b16 a[46:47], v142 offset:62240
    v_mfma_f32_16x16x32_bf16 v[24:27], a[60:63], v[16:19], v[24:27]
    s_waitcnt lgkmcnt(6)
    ds_read_b64_tr_b16 a[68:69], v142 offset:61504
    v_mfma_f32_16x16x32_bf16 v[64:67], a[4:7], v[80:83], v[64:67]
    buffer_load_dwordx4 v43, s[32:35], s92 offen offset:0 lds
    ds_read_b64_tr_b16 a[70:71], v142 offset:62272
    v_mfma_f32_16x16x32_bf16 v[64:67], a[8:11], v[84:87], v[64:67]
    ds_read_b128 v[148:151], v3 offset:41216
    v_mfma_f32_16x16x32_bf16 v[64:67], a[12:15], v[60:63], v[64:67]
    ds_read_b128 v[76:79], v3 offset:42752
    v_mfma_f32_16x16x32_bf16 v[20:23], a[28:31], v[80:83], v[20:23]
    ds_read_b128 v[16:19], v3 offset:256
    v_mfma_f32_16x16x32_bf16 v[20:23], a[32:35], v[84:87], v[20:23]
    ds_read_b128 v[108:111], v3 offset:1792
    v_mfma_f32_16x16x32_bf16 v[20:23], a[36:39], v[60:63], v[20:23]
    buffer_load_dwordx4 v42, s[32:35], s92 offen offset:1024 lds
    ds_read_b128 v[36:39], v3 offset:3328
    v_mfma_f32_16x16x32_bf16 v[8:11], a[52:55], v[80:83], v[8:11]
    ds_read_b128 v[80:83], v6 offset:41216
    v_mfma_f32_16x16x32_bf16 v[8:11], a[56:59], v[84:87], v[8:11]
    ds_read_b128 v[84:87], v6 offset:42752
    v_mfma_f32_16x16x32_bf16 v[8:11], a[60:63], v[60:63], v[8:11]
    ds_read_b128 v[60:63], v6 offset:256
    ds_read_b32 v200, v200 offset:336
    buffer_load_dwordx4 v0, s[32:35], s92 offen offset:2048 lds
    s_add_u32 m0, s90, 49152
    s_mov_b32 s92, 147840
    s_waitcnt vmcnt(9)
    ds_read_b64_tr_b16 a[72:73], v142 offset:0
    ds_read_b64_tr_b16 a[74:75], v142 offset:768
    ds_read_b64_tr_b16 a[96:97], v142 offset:32
    ds_read_b64_tr_b16 a[98:99], v142 offset:800
    ds_read_b64_tr_b16 a[120:121], v142 offset:64
    ds_read_b64_tr_b16 a[122:123], v142 offset:832
    ds_read_b32 v201, v201 offset:336
    buffer_load_dwordx4 v43, s[32:35], s92 offen offset:0 lds
    s_waitcnt lgkmcnt(10)
    v_mfma_f32_16x16x32_bf16 v[72:75], a[16:19], v[80:83], v[72:75]
    ds_read_b32 v202, v202 offset:336
    v_mfma_f32_16x16x32_bf16 v[72:75], a[20:23], v[148:151], v[72:75]
    s_nop 1
    v_mfma_f32_16x16x32_bf16 v[44:47], a[40:43], v[80:83], v[44:47]
    s_nop 0
    ds_read_b32 v203, v203 offset:336
    s_nop 0
    v_mfma_f32_16x16x32_bf16 v[44:47], a[44:47], v[148:151], v[44:47]
    s_nop 0
    v_cvt_pk_f16_f32 v72, v72, v73
    v_cvt_pk_f16_f32 v73, v74, v75
    v_mfma_f32_16x16x32_bf16 v[56:59], a[64:67], v[80:83], v[56:59]
    ds_read_b128 v[80:83], v6 offset:1792
    buffer_load_dwordx4 v42, s[32:35], s92 offen offset:1024 lds
    v_mfma_f32_16x16x32_bf16 v[56:59], a[68:71], v[148:151], v[56:59]
    s_waitcnt lgkmcnt(6)
    ds_read_b32 v196, v196 offset:336
    v_pk_fma_f16 v104, v72, v72, s39
    v_mfma_f32_16x16x32_bf16 v[48:51], a[16:19], v[84:87], v[48:51]
    v_pk_fmac_f16 v104, v73, v73
    v_cvt_pk_f16_f32 v74, v44, v45
    v_mfma_f32_16x16x32_bf16 v[48:51], a[20:23], v[76:79], v[48:51]
    ds_read_b32 v197, v197 offset:336
    v_cvt_pk_f16_f32 v75, v46, v47
    v_mfma_f32_16x16x32_bf16 v[112:115], a[40:43], v[84:87], v[112:115]
    v_pk_fmac_f16 v104, v74, v74
    v_pk_fmac_f16 v104, v75, v75
    v_mfma_f32_16x16x32_bf16 v[112:115], a[44:47], v[76:79], v[112:115]
    ds_read_b128 v[44:47], v6 offset:3328
    buffer_load_dwordx4 v0, s[32:35], s92 offen offset:2048 lds
    v_mfma_f32_16x16x32_bf16 v[88:91], a[64:67], v[84:87], v[88:91]
    s_waitcnt vmcnt(9)
    s_add_u32 m0, s90, 61440
    ds_read_b64_tr_b16 a[76:77], v142 offset:12288
    v_cvt_pk_f16_f32 v92, v56, v57
    v_mfma_f32_16x16x32_bf16 v[88:91], a[68:71], v[76:79], v[88:91]
    s_mov_b32 s92, 184704
    ds_read_b64_tr_b16 a[78:79], v142 offset:13056
    v_cvt_pk_f16_f32 v93, v58, v59
    v_mfma_f32_16x16x32_bf16 v[28:31], a[16:19], v[60:63], v[28:31]
    ds_read_b64_tr_b16 a[100:101], v142 offset:12320
    v_pk_fmac_f16 v104, v92, v92
    v_mfma_f32_16x16x32_bf16 v[28:31], a[20:23], v[16:19], v[28:31]
    ds_read_b64_tr_b16 a[102:103], v142 offset:13088
    v_pk_fmac_f16 v104, v93, v93
    v_mfma_f32_16x16x32_bf16 v[12:15], a[40:43], v[60:63], v[12:15]
    ds_read_b64_tr_b16 a[124:125], v142 offset:12352
    buffer_load_dwordx4 v43, s[32:35], s92 offen offset:0 lds
    v_mfma_f32_16x16x32_bf16 v[12:15], a[44:47], v[16:19], v[12:15]
    ds_read_b64_tr_b16 a[126:127], v142 offset:13120
    v_cvt_pk_f16_f32 v56, v48, v49
    v_mfma_f32_16x16x32_bf16 v[32:35], a[64:67], v[60:63], v[32:35]
    ds_read_b128 v[76:79], v3 offset:40960
    v_cvt_pk_f16_f32 v57, v50, v51
    v_mfma_f32_16x16x32_bf16 v[32:35], a[68:71], v[16:19], v[32:35]
    s_waitcnt lgkmcnt(8)
    ds_read_b128 v[60:63], v3 offset:42496
    v_pk_fma_f16 v106, v56, v56, s39
    v_mfma_f32_16x16x32_bf16 v[144:147], a[16:19], v[80:83], v[144:147]
    ds_read_b128 v[84:87], v3 offset:0
    v_pk_fmac_f16 v106, v57, v57
    v_mfma_f32_16x16x32_bf16 v[144:147], a[20:23], v[108:111], v[144:147]
    ds_read_b128 v[16:19], v3 offset:1536
    buffer_load_dwordx4 v42, s[32:35], s92 offen offset:1024 lds
    v_mfma_f32_16x16x32_bf16 v[52:55], a[40:43], v[80:83], v[52:55]
    ds_read_b128 v[48:51], v3 offset:3072
    v_cvt_pk_f16_f32 v58, v112, v113
    v_mfma_f32_16x16x32_bf16 v[52:55], a[44:47], v[108:111], v[52:55]
    ds_read_b128 v[148:151], v6 offset:40960
    v_cvt_pk_f16_f32 v59, v114, v115
    v_mfma_f32_16x16x32_bf16 v[24:27], a[64:67], v[80:83], v[24:27]
    ds_read_b128 v[80:83], v6 offset:42496
    v_pk_fmac_f16 v106, v58, v58
    v_mfma_f32_16x16x32_bf16 v[24:27], a[68:71], v[108:111], v[24:27]
    s_waitcnt lgkmcnt(8)
    ds_read_b32 v198, v198 offset:336
    v_pk_fmac_f16 v106, v59, v59
    v_mfma_f32_16x16x32_bf16 v[64:67], a[16:19], v[44:47], v[64:67]
    v_cvt_pk_f16_f32 v40, v88, v89
    v_cvt_pk_f16_f32 v41, v90, v91
    v_mfma_f32_16x16x32_bf16 v[64:67], a[20:23], v[36:39], v[64:67]
    s_waitcnt vmcnt(8)
    buffer_load_dwordx4 v0, s[32:35], s92 offen offset:2048 lds
    ds_read_b64_tr_b16 a[80:81], v142 offset:24576
    v_mfma_f32_16x16x32_bf16 v[20:23], a[40:43], v[44:47], v[20:23]
    s_add_u32 m0, s90, 0
    ds_read_b64_tr_b16 a[82:83], v142 offset:25344
    v_pk_fmac_f16 v106, v40, v40
    v_mfma_f32_16x16x32_bf16 v[20:23], a[44:47], v[36:39], v[20:23]
    s_mov_b32 s92, 768
    ds_read_b64_tr_b16 a[104:105], v142 offset:24608
    v_pk_fmac_f16 v106, v41, v41
    v_mfma_f32_16x16x32_bf16 v[8:11], a[64:67], v[44:47], v[8:11]
    ds_read_b64_tr_b16 a[106:107], v142 offset:25376
    v_cvt_pk_f16_f32 v112, v28, v29
    v_mfma_f32_16x16x32_bf16 v[8:11], a[68:71], v[36:39], v[8:11]
    s_waitcnt lgkmcnt(6)
    ds_read_b64_tr_b16 a[128:129], v142 offset:24640
    buffer_load_dwordx4 v43, s[32:35], s92 offen offset:0 lds
    ds_read_b64_tr_b16 a[130:131], v142 offset:25408
    v_mfma_f32_16x16x32_bf16 v[36:39], a[72:75], v[148:151], 0
    ds_read_b128 v[44:47], v6 offset:0
    v_cvt_pk_f16_f32 v113, v30, v31
    v_mfma_f32_16x16x32_bf16 v[36:39], a[76:79], v[76:79], v[36:39]
    ds_read_b32 v199, v199 offset:336
    v_pk_fma_f16 v156, v112, v112, s39
    v_mfma_f32_16x16x32_bf16 v[108:111], a[96:99], v[148:151], 0
    v_pk_fmac_f16 v156, v113, v113
    v_cvt_pk_f16_f32 v114, v12, v13
    v_mfma_f32_16x16x32_bf16 v[108:111], a[100:103], v[76:79], v[108:111]
    ds_read_b128 v[88:91], v6 offset:1536
    v_cvt_pk_f16_f32 v115, v14, v15
    v_mfma_f32_16x16x32_bf16 v[12:15], a[120:123], v[148:151], 0
    buffer_load_dwordx4 v42, s[32:35], s92 offen offset:1024 lds
    v_pk_fmac_f16 v156, v114, v114
    v_mfma_f32_16x16x32_bf16 v[12:15], a[124:127], v[76:79], v[12:15]
    s_waitcnt lgkmcnt(6)
    v_pk_fmac_f16 v156, v115, v115
    v_cvt_pk_f16_f32 v152, v32, v33
    v_mfma_f32_16x16x32_bf16 v[76:79], a[72:75], v[80:83], 0
    v_cvt_pk_f16_f32 v153, v34, v35
    v_pk_fmac_f16 v156, v152, v152
    v_mfma_f32_16x16x32_bf16 v[76:79], a[76:79], v[60:63], v[76:79]
    v_pk_fmac_f16 v156, v153, v153
    v_cvt_pk_f16_f32 v224, v144, v145
    v_mfma_f32_16x16x32_bf16 v[32:35], a[96:99], v[80:83], 0
    v_cvt_pk_f16_f32 v225, v146, v147
    v_pk_fma_f16 v158, v224, v224, s39
    v_mfma_f32_16x16x32_bf16 v[32:35], a[100:103], v[60:63], v[32:35]
    s_waitcnt vmcnt(8)
    buffer_load_dwordx4 v0, s[32:35], s92 offen offset:2048 lds
    ds_read_b64_tr_b16 a[84:85], v142 offset:36864
    v_mfma_f32_16x16x32_bf16 v[228:231], a[120:123], v[80:83], 0
    s_add_u32 m0, s90, 12288
    ds_read_b64_tr_b16 a[86:87], v142 offset:37632
    v_pk_fmac_f16 v158, v225, v225
    v_mfma_f32_16x16x32_bf16 v[228:231], a[124:127], v[60:63], v[228:231]
    s_waitcnt lgkmcnt(3)
    s_mov_b32 s92, 37632
    ds_read_b64_tr_b16 a[108:109], v142 offset:36896
    v_cvt_pk_f16_f32 v226, v52, v53
    v_mfma_f32_16x16x32_bf16 v[80:83], a[72:75], v[44:47], 0
    ds_read_b64_tr_b16 a[110:111], v142 offset:37664
    v_cvt_pk_f16_f32 v227, v54, v55
    v_mfma_f32_16x16x32_bf16 v[80:83], a[76:79], v[84:87], v[80:83]
    ds_read_b64_tr_b16 a[132:133], v142 offset:36928
    v_pk_fmac_f16 v158, v226, v226
    v_mfma_f32_16x16x32_bf16 v[160:163], a[96:99], v[44:47], 0
    buffer_load_dwordx4 v43, s[32:35], s92 offen offset:0 lds
    ds_read_b64_tr_b16 a[134:135], v142 offset:37696
    v_mfma_f32_16x16x32_bf16 v[160:163], a[100:103], v[84:87], v[160:163]
    ds_read_b128 v[52:55], v6 offset:3072
    v_pk_fmac_f16 v158, v227, v227
    v_mfma_f32_16x16x32_bf16 v[60:63], a[120:123], v[44:47], 0
    ds_read_b128 v[44:47], v6 offset:41088
    v_cvt_pk_f16_f32 v146, v24, v25
    v_mfma_f32_16x16x32_bf16 v[60:63], a[124:127], v[84:87], v[60:63]
    s_waitcnt lgkmcnt(8)
    v_cvt_pk_f16_f32 v147, v26, v27
    v_pk_fmac_f16 v158, v146, v146
    v_mfma_f32_16x16x32_bf16 v[24:27], a[72:75], v[88:91], 0
    ds_read_b128 v[232:235], v6 offset:42624
    v_pk_fmac_f16 v158, v147, v147
    v_mfma_f32_16x16x32_bf16 v[24:27], a[76:79], v[16:19], v[24:27]
    buffer_load_dwordx4 v42, s[32:35], s92 offen offset:1024 lds
    v_cvt_pk_f16_f32 v84, v64, v65
    v_mfma_f32_16x16x32_bf16 v[168:171], a[96:99], v[88:91], 0
    v_cvt_pk_f16_f32 v85, v66, v67
    v_pk_fma_f16 v28, v84, v84, s39
    v_mfma_f32_16x16x32_bf16 v[168:171], a[100:103], v[16:19], v[168:171]
    ds_read_b128 v[64:67], v6 offset:128
    v_pk_fmac_f16 v28, v85, v85
    v_mfma_f32_16x16x32_bf16 v[148:151], a[120:123], v[88:91], 0
    v_cvt_pk_f16_f32 v86, v20, v21
    v_cvt_pk_f16_f32 v87, v22, v23
    v_mfma_f32_16x16x32_bf16 v[148:151], a[124:127], v[16:19], v[148:151]
    s_waitcnt lgkmcnt(3)
    v_pk_fmac_f16 v28, v86, v86
    v_pk_fmac_f16 v28, v87, v87
    v_cvt_pk_f16_f32 v140, v8, v9
    v_mfma_f32_16x16x32_bf16 v[16:19], a[72:75], v[52:55], 0
    s_waitcnt vmcnt(8)
    buffer_load_dwordx4 v0, s[32:35], s92 offen offset:2048 lds
    ds_read_b64_tr_b16 a[88:89], v142 offset:49152
    v_mfma_f32_16x16x32_bf16 v[16:19], a[76:79], v[48:51], v[16:19]
    s_add_u32 m0, s90, 24576
    ds_read_b64_tr_b16 a[90:91], v142 offset:49920
    v_cvt_pk_f16_f32 v141, v10, v11
    v_mfma_f32_16x16x32_bf16 v[20:23], a[96:99], v[52:55], 0
    s_mov_b32 s92, 74496
    ds_read_b64_tr_b16 a[112:113], v142 offset:49184
    v_pk_fmac_f16 v28, v140, v140
    v_mfma_f32_16x16x32_bf16 v[20:23], a[100:103], v[48:51], v[20:23]
    ds_read_b64_tr_b16 a[114:115], v142 offset:49952
    v_pk_fmac_f16 v28, v141, v141
    v_mfma_f32_16x16x32_bf16 v[8:11], a[120:123], v[52:55], 0
    ds_read_b64_tr_b16 a[136:137], v142 offset:49216
    v_mfma_f32_16x16x32_bf16 v[8:11], a[124:127], v[48:51], v[8:11]
    s_waitcnt lgkmcnt(5)
    buffer_load_dwordx4 v43, s[32:35], s92 offen offset:0 lds
    ds_read_b64_tr_b16 a[138:139], v142 offset:49984
    v_mfma_f32_16x16x32_bf16 v[36:39], a[80:83], v[44:47], v[36:39]
    ds_read_b128 v[52:55], v6 offset:1664
    v_mov_b32 v30, 0
    v_mfma_f32_16x16x32_bf16 v[108:111], a[104:107], v[44:47], v[108:111]
    ds_read_b128 v[48:51], v6 offset:3200
    v_mov_b32 v31, 0
    v_mfma_f32_16x16x32_bf16 v[12:15], a[128:131], v[44:47], v[12:15]
    ds_read_b128 v[44:47], v3 offset:41088
    v_mfma_f32_16x16x32_bf16 v[76:79], a[80:83], v[232:235], v[76:79]
    ds_read_b128 v[88:91], v3 offset:42624
    v_mov_b32 v1, 0xf149f2ca
    v_mfma_f32_16x16x32_bf16 v[32:35], a[104:107], v[232:235], v[32:35]
    buffer_load_dwordx4 v42, s[32:35], s92 offen offset:1024 lds
    v_mfma_f32_16x16x32_bf16 v[228:231], a[128:131], v[232:235], v[228:231]
    s_cmp_ge_u32 s2, 248
    s_cbranch_scc1 L_maskF
L_nomaskF:
    v_mfma_f32_16x16x32_bf16 v[80:83], a[80:83], v[64:67], v[80:83]
    ds_read_b128 v[232:235], v3 offset:128
    v_readlane_b32 s84, v211, 48
    v_mfma_f32_16x16x32_bf16 v[160:163], a[104:107], v[64:67], v[160:163]
    v_cmp_gt_u32 vcc, 16, v121
    v_mfma_f32_16x16x32_bf16 v[60:63], a[128:131], v[64:67], v[60:63]
    s_waitcnt lgkmcnt(4)
    v_cndmask_b32 v208, v1, v208, vcc
    v_cndmask_b32 v209, v1, v209, vcc
    v_cndmask_b32 v210, v1, v210, vcc
    v_mfma_f32_16x16x32_bf16 v[24:27], a[80:83], v[52:55], v[24:27]
    s_waitcnt vmcnt(8)
    buffer_load_dwordx4 v0, s[32:35], s92 offen offset:2048 lds
    ds_read_b64_tr_b16 a[92:93], v142 offset:61440
    v_mfma_f32_16x16x32_bf16 v[168:171], a[104:107], v[52:55], v[168:171]
    s_add_u32 m0, s90, 36864
    ds_read_b64_tr_b16 a[94:95], v142 offset:62208
    v_cmp_gt_u32 vcc, 49, v121
    v_mfma_f32_16x16x32_bf16 v[148:151], a[128:131], v[52:55], v[148:151]
    s_waitcnt lgkmcnt(3)
    s_mov_b32 s92, 111360
    ds_read_b64_tr_b16 a[116:117], v142 offset:61472
    v_cndmask_b32 v211, v1, v211, vcc
    v_mfma_f32_16x16x32_bf16 v[16:19], a[80:83], v[48:51], v[16:19]
    ds_read_b64_tr_b16 a[118:119], v142 offset:62240
    v_mfma_f32_16x16x32_bf16 v[20:23], a[104:107], v[48:51], v[20:23]
    ds_read_b64_tr_b16 a[140:141], v142 offset:61504
    v_mfma_f32_16x16x32_bf16 v[8:11], a[128:131], v[48:51], v[8:11]
    buffer_load_dwordx4 v43, s[32:35], s92 offen offset:0 lds
    ds_read_b64_tr_b16 a[142:143], v142 offset:62272
    v_mfma_f32_16x16x32_bf16 v[36:39], a[84:87], v[44:47], v[36:39]
    ds_read_b128 v[64:67], v3 offset:1664
    v_mfma_f32_16x16x32_bf16 v[108:111], a[108:111], v[44:47], v[108:111]
    ds_read_b128 v[52:55], v3 offset:3200
    v_mfma_f32_16x16x32_bf16 v[12:15], a[132:135], v[44:47], v[12:15]
    ds_read_b128 v[48:51], v6 offset:41216
    v_mfma_f32_16x16x32_bf16 v[76:79], a[84:87], v[88:91], v[76:79]
    ds_read_b128 v[44:47], v6 offset:42752
    v_mfma_f32_16x16x32_bf16 v[32:35], a[108:111], v[88:91], v[32:35]
    buffer_load_dwordx4 v42, s[32:35], s92 offen offset:1024 lds
    v_mfma_f32_16x16x32_bf16 v[228:231], a[132:135], v[88:91], v[228:231]
    s_waitcnt lgkmcnt(7)
    v_mfma_f32_16x16x32_bf16 v[80:83], a[84:87], v[232:235], v[80:83]
    s_mov_b32 s53, s47
    ds_read_b128 v[88:91], v6 offset:256
    v_mfma_f32_16x16x32_bf16 v[160:163], a[108:111], v[232:235], v[160:163]
    s_mov_b32 s47, s46
    v_mfma_f32_16x16x32_bf16 v[60:63], a[132:135], v[232:235], v[60:63]
    s_waitcnt vmcnt(8) lgkmcnt(4)
    s_mov_b32 s46, s45
    ds_read_b64_tr_b16 a[144:145], v143 offset:0
    v_mfma_f32_16x16x32_bf16 v[24:27], a[84:87], v[64:67], v[24:27]
    s_mov_b32 s45, s44
    buffer_load_dwordx4 v0, s[32:35], s92 offen offset:2048 lds
    ds_read_b64_tr_b16 a[146:147], v143 offset:768
    v_mfma_f32_16x16x32_bf16 v[168:171], a[108:111], v[64:67], v[168:171]
    s_add_u32 m0, s90, 49152
    ds_read_b64_tr_b16 a[168:169], v143 offset:8
    v_mfma_f32_16x16x32_bf16 v[148:151], a[132:135], v[64:67], v[148:151]
    s_waitcnt lgkmcnt(4)
    s_mov_b32 s92, 148224
    ds_read_b64_tr_b16 a[170:171], v143 offset:776
    v_mfma_f32_16x16x32_bf16 v[16:19], a[84:87], v[52:55], v[16:19]
    s_mov_b32 s44, s53
    v_mov_b32 v102, 0
    v_mov_b32 v103, 0
    v_mfma_f32_16x16x32_bf16 v[20:23], a[108:111], v[52:55], v[20:23]
    s_sub_u32 s48, s44, s46
    ds_read_b64_tr_b16 a[192:193], v142 offset:64
    buffer_load_dwordx4 v43, s[32:35], s92 offen offset:0 lds
    v_mfma_f32_16x16x32_bf16 v[8:11], a[132:135], v[52:55], v[8:11]
    s_sub_u32 s49, s46, s45
    ds_read_b64_tr_b16 a[194:195], v142 offset:832
    v_mov_b32 v1, 0
    v_mfma_f32_16x16x32_bf16 v[36:39], a[88:91], v[48:51], v[36:39]
    s_sub_u32 s50, s45, s44
    ds_read_b128 v[64:67], v6 offset:1792
    v_add_u32 v29, 28672, v120
    v_mfma_f32_16x16x32_bf16 v[108:111], a[112:115], v[48:51], v[108:111]
    s_sub_u32 s51, s46, s47
    ds_write2_b64 v29, v[102:103], v[102:103] offset0:2 offset1:3
    v_mfma_f32_16x16x32_bf16 v[12:15], a[136:139], v[48:51], v[12:15]
    s_mov_b32 s60, s59
    v_add_u32 v137, s48, v137
    v_add_u32 v136, s48, v136
    v_mfma_f32_16x16x32_bf16 v[76:79], a[88:91], v[44:47], v[76:79]
    s_mov_b32 s59, s58
    buffer_load_dwordx4 v42, s[32:35], s92 offen offset:1024 lds
    v_add_u32 v135, s49, v135
    v_mfma_f32_16x16x32_bf16 v[32:35], a[112:115], v[44:47], v[32:35]
    s_mov_b32 s58, s57
    ds_read_b128 v[52:55], v6 offset:3328
    v_add_u32 v134, s49, v134
    v_mfma_f32_16x16x32_bf16 v[228:231], a[136:139], v[44:47], v[228:231]
    s_waitcnt lgkmcnt(5)
    s_mov_b32 s57, s56
    ds_read_b128 v[48:51], v3 offset:41216
    v_add_u32 v137, s50, v137
    v_mfma_f32_16x16x32_bf16 v[80:83], a[88:91], v[88:91], v[80:83]
    s_mov_b32 s7, s6
    ds_read_b128 v[44:47], v3 offset:42752
    v_add_u32 v136, s50, v136
    v_mfma_f32_16x16x32_bf16 v[160:163], a[112:115], v[88:91], v[160:163]
    s_mov_b32 s6, s5
    ds_read_b128 v[240:243], v3 offset:256
    v_add_u32 v135, s48, v135
    v_mfma_f32_16x16x32_bf16 v[60:63], a[136:139], v[88:91], v[60:63]
    s_waitcnt vmcnt(8) lgkmcnt(5)
    s_mov_b32 s5, s4
    ds_read_b64_tr_b16 a[148:149], v143 offset:12288
    buffer_load_dwordx4 v0, s[32:35], s92 offen offset:2048 lds
    v_mfma_f32_16x16x32_bf16 v[24:27], a[88:91], v[64:67], v[24:27]
    s_add_u32 m0, s90, 61440
    ds_read_b64_tr_b16 a[150:151], v143 offset:13056
    v_add_u32 v134, s48, v134
    v_mfma_f32_16x16x32_bf16 v[168:171], a[112:115], v[64:67], v[168:171]
    s_mov_b32 s92, 185088
    ds_read_b64_tr_b16 a[172:173], v143 offset:12296
    v_add_u32 v133, s51, v133
    v_mfma_f32_16x16x32_bf16 v[148:151], a[136:139], v[64:67], v[148:151]
    s_waitcnt lgkmcnt(6)
    s_sub_u32 s14, s6, s7
    ds_read_b64_tr_b16 a[174:175], v143 offset:13064
    v_add_u32 v132, s14, v132
    v_add_u32 v131, s14, v131
    s_add_u32 s61, s61, 1
    s_add_u32 s12, s12, 20
    ds_read_b64_tr_b16 a[196:197], v142 offset:12352
    buffer_load_dwordx4 v43, s[32:35], s92 offen offset:0 lds
    v_mfma_f32_16x16x32_bf16 v[16:19], a[88:91], v[52:55], v[16:19]
L_pg0:
    s_cbranch_execz L_main
    s_max_u32 s12, s12, s61
    ds_read_b64_tr_b16 a[198:199], v142 offset:13120
    v_mfma_f32_16x16x32_bf16 v[20:23], a[112:115], v[52:55], v[20:23]
    s_add_u32 s65, s65, 1
    ds_read_b128 v[236:239], v3 offset:1792
    v_mfma_f32_16x16x32_bf16 v[8:11], a[136:139], v[52:55], v[8:11]
    s_waitcnt lgkmcnt(7)
    s_add_u32 s67, s46, s54
    ds_read_b128 v[232:235], v3 offset:3328
    v_mfma_f32_16x16x32_bf16 v[36:39], a[92:95], v[48:51], v[36:39]
    s_nop 0
    v_mfma_f32_16x16x32_bf16 v[108:111], a[116:119], v[48:51], v[108:111]
    s_nop 1
    buffer_load_dwordx4 v42, s[32:35], s92 offen offset:1024 lds
    v_mfma_f32_16x16x32_bf16 v[12:15], a[140:143], v[48:51], v[12:15]
    s_nop 0
    ds_read_b128 v[64:67], v6 offset:40960
    v_cvt_pk_f16_f32 v88, v36, v37
    v_mfma_f32_16x16x32_bf16 v[76:79], a[92:95], v[44:47], v[76:79]
    ds_read_b128 v[52:55], v3 offset:40960
    v_cvt_pk_f16_f32 v89, v38, v39
    v_mfma_f32_16x16x32_bf16 v[32:35], a[116:119], v[44:47], v[32:35]
    ds_read_b128 v[36:39], v6 offset:41088
    v_pk_fma_f16 v105, v88, v88, s39
    v_mfma_f32_16x16x32_bf16 v[228:231], a[140:143], v[44:47], v[228:231]
    s_nop 0
    ds_read_b128 v[48:51], v3 offset:41088
    v_cvt_pk_f16_f32 v76, v76, v77
    v_mfma_f32_16x16x32_bf16 v[80:83], a[92:95], v[240:243], v[80:83]
    ds_read_b128 v[44:47], v6 offset:41216
    buffer_load_dwordx4 v0, s[32:35], s92 offen offset:2048 lds
    v_mfma_f32_16x16x32_bf16 v[160:163], a[116:119], v[240:243], v[160:163]
    s_waitcnt vmcnt(9)
    s_add_u32 m0, s90, 0
    ds_read_b64_tr_b16 a[152:153], v143 offset:24576
    v_cvt_pk_f16_f32 v77, v78, v79
    v_mfma_f32_16x16x32_bf16 v[60:63], a[140:143], v[240:243], v[60:63]
    s_waitcnt lgkmcnt(6)
    s_mov_b32 s92, 0
    ds_read_b64_tr_b16 a[154:155], v143 offset:25344
    v_pk_fma_f16 v107, v76, v76, s39
    v_mfma_f32_16x16x32_bf16 v[24:27], a[92:95], v[236:239], v[24:27]
    ds_read_b64_tr_b16 a[176:177], v143 offset:24584
    v_pk_fmac_f16 v107, v77, v77
    v_mfma_f32_16x16x32_bf16 v[168:171], a[116:119], v[236:239], v[168:171]
    ds_read_b64_tr_b16 a[178:179], v143 offset:25352
    v_cvt_pk_f16_f32 v78, v32, v33
    v_mfma_f32_16x16x32_bf16 v[148:151], a[140:143], v[236:239], v[148:151]
    ds_read_b64_tr_b16 a[200:201], v142 offset:24640
    buffer_load_dwordx4 v5, s[76:79], s92 offen offset:0 lds
    v_mfma_f32_16x16x32_bf16 v[16:19], a[92:95], v[232:235], v[16:19]
    ds_read_b64_tr_b16 a[202:203], v142 offset:25408
    v_cvt_pk_f16_f32 v79, v34, v35
    v_mfma_f32_16x16x32_bf16 v[20:23], a[116:119], v[232:235], v[20:23]
    ds_read_b128 v[32:35], v3 offset:41216
    v_pk_fmac_f16 v107, v78, v78
    v_mfma_f32_16x16x32_bf16 v[8:11], a[140:143], v[232:235], v[8:11]
    v_pk_fmac_f16 v107, v79, v79
    v_cvt_pk_f16_f32 v42, v228, v229
    v_cvt_pk_f16_f32 v43, v230, v231
    v_pk_fmac_f16 v107, v42, v42
    v_pk_fmac_f16 v107, v43, v43
    v_cvt_pk_f16_f32 v24, v24, v25
    v_cvt_pk_f16_f32 v25, v26, v27
    v_pk_fma_f16 v159, v24, v24, s39
    v_pk_fmac_f16 v159, v25, v25
    buffer_load_dwordx4 v4, s[76:79], s92 offen offset:1024 lds
    v_cvt_pk_f16_f32 v26, v168, v169
    v_cvt_pk_f16_f32 v27, v170, v171
    v_pk_fmac_f16 v159, v26, v26
    v_pk_fmac_f16 v159, v27, v27
    v_cvt_pk_f16_f32 v148, v148, v149
    v_cvt_pk_f16_f32 v149, v150, v151
    v_pk_fmac_f16 v159, v148, v148
    v_pk_fmac_f16 v159, v149, v149
    v_cvt_pk_f16_f32 v80, v80, v81
    v_cvt_pk_f16_f32 v81, v82, v83
    v_pk_fma_f16 v157, v80, v80, s39
    v_pk_fmac_f16 v157, v81, v81
    v_cvt_pk_f16_f32 v82, v160, v161
    v_cvt_pk_f16_f32 v83, v162, v163
    v_pk_fmac_f16 v157, v82, v82
    v_pk_fmac_f16 v157, v83, v83
    v_cvt_pk_f16_f32 v154, v60, v61
    s_waitcnt vmcnt(8)
    ds_read_b64_tr_b16 a[156:157], v143 offset:36864
    buffer_load_dwordx4 v166, s[76:79], s92 offen offset:2048 lds
    s_add_u32 m0, s90, 12288
    s_mov_b32 s92, 12288
    ds_read_b64_tr_b16 a[158:159], v143 offset:37632
    v_cvt_pk_f16_f32 v155, v62, v63
    v_pk_fmac_f16 v157, v154, v154
    v_pk_fmac_f16 v157, v155, v155
    ds_read_b64_tr_b16 a[180:181], v143 offset:36872
    v_pk_fmac_f16 v105, v89, v89
    v_mfma_f32_16x16x32_f16 v[60:63], v[212:215], v[156:159], 0
    ds_read_b64_tr_b16 a[182:183], v143 offset:37640
    v_cvt_pk_f16_f32 v90, v108, v109
    v_cvt_pk_f16_f32 v91, v110, v111
    v_pk_fmac_f16 v105, v90, v90
    ds_read_b64_tr_b16 a[204:205], v142 offset:36928
    buffer_load_dwordx4 v5, s[76:79], s92 offen offset:0 lds
    ds_read_b64_tr_b16 a[206:207], v142 offset:37696
    v_pk_fmac_f16 v105, v91, v91
    v_cvt_pk_f16_f32 v138, v12, v13
    v_cvt_pk_f16_f32 v139, v14, v15
    v_pk_fmac_f16 v105, v138, v138
    v_pk_fmac_f16 v105, v139, v139
    v_mov_b32 v171, 0
    v_mov_b32 v167, 0
    v_mfma_f32_16x16x32_f16 v[12:15], v[212:215], v[104:107], 0
    s_nop 0
    v_mov_b32 v163, 0
    v_mov_b32 v159, 0
    v_mov_b32 v150, 0
    v_mov_b32 v151, 0
    v_mov_b32 v144, 0
    v_mov_b32 v145, 0
    buffer_load_dwordx4 v4, s[76:79], s92 offen offset:1024 lds
    v_or3_b32 v123, v123, v12, v13
    v_rsq_f32 v12, v12
    v_rsq_f32 v13, v13
    v_mul_f32 v12, s52, v12
    v_cvt_pk_f16_f32 v12, v12, v13
    v_or3_b32 v123, v123, v14, v15
    v_rsq_f32 v14, v14
    v_rsq_f32 v15, v15
    v_mul_f32 v14, s52, v14
    v_cvt_pk_f16_f32 v14, v14, v15
    v_pk_mul_f16 v72, v72, v12 op_sel:[0,0] op_sel_hi:[1,0]
    v_pk_mul_f16 v73, v73, v12 op_sel:[0,0] op_sel_hi:[1,0]
    v_pk_mul_f16 v74, v74, v12 op_sel:[0,0] op_sel_hi:[1,0]
    s_waitcnt vmcnt(8)
    ds_read_b64_tr_b16 a[160:161], v143 offset:49152
    buffer_load_dwordx4 v166, s[76:79], s92 offen offset:2048 lds
    s_add_u32 m0, s90, 24576
    s_mov_b32 s92, 24576
    ds_read_b64_tr_b16 a[162:163], v143 offset:49920
    v_pk_mul_f16 v75, v75, v12 op_sel:[0,0] op_sel_hi:[1,0]
    v_pk_mul_f16 v92, v92, v12 op_sel:[0,0] op_sel_hi:[1,0]
    v_pk_mul_f16 v93, v93, v12 op_sel:[0,0] op_sel_hi:[1,0]
    ds_read_b64_tr_b16 a[184:185], v143 offset:49160
    v_pk_mul_f16 v88, v88, v12 op_sel:[0,1] op_sel_hi:[1,1]
    v_pk_mul_f16 v89, v89, v12 op_sel:[0,1] op_sel_hi:[1,1]
    v_pk_mul_f16 v90, v90, v12 op_sel:[0,1] op_sel_hi:[1,1]
    ds_read_b64_tr_b16 a[186:187], v143 offset:49928
    v_pk_mul_f16 v91, v91, v12 op_sel:[0,1] op_sel_hi:[1,1]
    ds_read_b64_tr_b16 a[208:209], v142 offset:49216
    s_waitcnt lgkmcnt(5)
    buffer_load_dwordx4 v5, s[76:79], s92 offen offset:0 lds
    ds_read_b64_tr_b16 a[210:211], v142 offset:49984
    v_pk_mul_f16 v138, v138, v12 op_sel:[0,1] op_sel_hi:[1,1]
    v_pk_mul_f16 v139, v139, v12 op_sel:[0,1] op_sel_hi:[1,1]
    v_fma_mix_f32 v0, v72, v88, 0 op_sel:[0,0,0] op_sel_hi:[1,1,0]
    v_fma_mix_f32 v0, v72, v88, v0 op_sel:[1,1,0] op_sel_hi:[1,1,0]
    v_fma_mix_f32 v0, v73, v89, v0 op_sel:[0,0,0] op_sel_hi:[1,1,0]
    v_fma_mix_f32 v0, v73, v89, v0 op_sel:[1,1,0] op_sel_hi:[1,1,0]
    v_fma_mix_f32 v0, v74, v90, v0 op_sel:[0,0,0] op_sel_hi:[1,1,0]
    v_fma_mix_f32 v0, v74, v90, v0 op_sel:[1,1,0] op_sel_hi:[1,1,0]
    v_fma_mix_f32 v0, v75, v91, v0 op_sel:[0,0,0] op_sel_hi:[1,1,0]
    v_fma_mix_f32 v0, v75, v91, v0 op_sel:[1,1,0] op_sel_hi:[1,1,0]
    v_fma_mix_f32 v0, v92, v138, v0 op_sel:[0,0,0] op_sel_hi:[1,1,0]
    v_fma_mix_f32 v0, v92, v138, v0 op_sel:[1,1,0] op_sel_hi:[1,1,0]
    v_fma_mix_f32 v0, v93, v139, v0 op_sel:[0,0,0] op_sel_hi:[1,1,0]
    v_fma_mix_f32 v0, v93, v139, v0 op_sel:[1,1,0] op_sel_hi:[1,1,0]
    v_mov_b32 v164, v0
    buffer_load_dwordx4 v4, s[76:79], s92 offen offset:1024 lds
    ds_write_b128 v29, v[88:91]
    v_permlane32_swap_b32 v164, v0
    v_add_f32 v0, v164, v0
    v_mov_b32 v164, v0
    v_or3_b32 v123, v123, v60, v61
    v_rsq_f32 v60, v60
    v_permlane16_swap_b32 v164, v0
    v_add_f32 v0, v164, v0
    buffer_load_dwordx4 v166, s[76:79], s92 offen offset:2048 lds
    s_add_u32 m0, s90, 36864
    s_mov_b32 s92, 36864
    s_waitcnt vmcnt(9)
    ds_read_b64_tr_b16 a[164:165], v143 offset:61440
    v_rsq_f32 v61, v61
    v_mul_f32 v60, s52, v60
    ds_read_b64_tr_b16 a[166:167], v143 offset:62208
    v_mfma_f32_16x16x32_bf16 v[108:111], a[144:147], v[64:67], 0
    v_cvt_pk_f16_f32 v60, v60, v61
    v_or3_b32 v123, v123, v62, v63
    v_mfma_f32_16x16x32_bf16 v[108:111], a[148:151], v[52:55], v[108:111]
    ds_read_b64_tr_b16 a[188:189], v143 offset:61448
    v_pk_mul_f16 v80, v80, v60 op_sel:[0,1] op_sel_hi:[1,1]
    v_mfma_f32_16x16x32_bf16 v[108:111], a[152:155], v[36:39], v[108:111]
    buffer_load_dwordx4 v5, s[76:79], s92 offen offset:0 lds
    ds_read_b64_tr_b16 a[190:191], v143 offset:62216
    v_mfma_f32_16x16x32_bf16 v[108:111], a[156:159], v[48:51], v[108:111]
    s_waitcnt lgkmcnt(4)
    v_rsq_f32 v62, v62
    v_mfma_f32_16x16x32_bf16 v[108:111], a[160:163], v[44:47], v[108:111]
    s_waitcnt lgkmcnt(2)
    ds_read_b64_tr_b16 a[212:213], v142 offset:61504
    v_mul_f32 v62, s52, v62
    v_rsq_f32 v63, v63
    ds_read_b64_tr_b16 a[214:215], v142 offset:62272
    v_cvt_pk_f16_f32 v62, v62, v63
    ds_write_b128 v29, v[72:75] offset:32
    buffer_load_dwordx4 v4, s[76:79], s92 offen offset:1024 lds
    v_mfma_f32_16x16x32_bf16 v[108:111], a[164:167], v[32:35], v[108:111]
    v_pk_mul_f16 v81, v81, v60 op_sel:[0,1] op_sel_hi:[1,1]
    v_pk_mul_f16 v82, v82, v60 op_sel:[0,1] op_sel_hi:[1,1]
    v_mfma_f32_16x16x32_bf16 v[72:75], a[168:171], v[64:67], 0
    v_pk_mul_f16 v83, v83, v60 op_sel:[0,1] op_sel_hi:[1,1]
    v_pk_mul_f16 v154, v154, v60 op_sel:[0,1] op_sel_hi:[1,1]
    v_mfma_f32_16x16x32_bf16 v[72:75], a[172:175], v[52:55], v[72:75]
    ds_write2_b64 v29, v[138:139], v[102:103] offset0:6 offset1:7
    v_mfma_f32_16x16x32_bf16 v[72:75], a[176:179], v[36:39], v[72:75]
    buffer_load_dwordx4 v166, s[76:79], s92 offen offset:2048 lds
    v_pk_mul_f16 v155, v155, v60 op_sel:[0,1] op_sel_hi:[1,1]
    v_mfma_f32_16x16x32_bf16 v[72:75], a[180:183], v[48:51], v[72:75]
    s_add_u32 m0, s90, 49152
    v_pk_mul_f16 v112, v112, v60 op_sel:[0,0] op_sel_hi:[1,0]
    v_pk_mul_f16 v113, v113, v60 op_sel:[0,0] op_sel_hi:[1,0]
    v_mfma_f32_16x16x32_bf16 v[72:75], a[184:187], v[44:47], v[72:75]
    s_waitcnt lgkmcnt(1)
    s_mov_b32 s92, 49152
    ds_write2_b64 v29, v[102:103], v[92:93] offset0:8 offset1:9
    v_mfma_f32_16x16x32_bf16 v[72:75], a[188:191], v[32:35], v[72:75]
    v_pk_mul_f16 v114, v114, v60 op_sel:[0,0] op_sel_hi:[1,0]
    v_pk_mul_f16 v115, v115, v60 op_sel:[0,0] op_sel_hi:[1,0]
    v_mfma_f32_16x16x32_bf16 v[88:91], a[192:195], v[64:67], 0
    buffer_load_dwordx4 v5, s[76:79], s92 offen offset:0 lds
    v_pk_mul_f16 v152, v152, v60 op_sel:[0,0] op_sel_hi:[1,0]
    v_mfma_f32_16x16x32_bf16 v[88:91], a[196:199], v[52:55], v[88:91]
    ds_read_b128 v[52:55], v6 offset:3072
    v_pk_mul_f16 v153, v153, v60 op_sel:[0,0] op_sel_hi:[1,0]
    v_mfma_f32_16x16x32_bf16 v[88:91], a[200:203], v[36:39], v[88:91]
    ds_read_b128 v[36:39], v3 offset:3072
    v_pk_mul_f16 v24, v24, v62 op_sel:[0,1] op_sel_hi:[1,1]
    v_mfma_f32_16x16x32_bf16 v[88:91], a[204:207], v[48:51], v[88:91]
    ds_read_b128 v[104:107], v6 offset:3200
    v_pk_mul_f16 v25, v25, v62 op_sel:[0,1] op_sel_hi:[1,1]
    v_mfma_f32_16x16x32_bf16 v[88:91], a[208:211], v[44:47], v[88:91]
    ds_read_b128 v[48:51], v3 offset:3200
    v_pk_mul_f16 v26, v26, v62 op_sel:[0,1] op_sel_hi:[1,1]
    v_mfma_f32_16x16x32_bf16 v[88:91], a[212:215], v[32:35], v[88:91]
    buffer_load_dwordx4 v4, s[76:79], s92 offen offset:1024 lds
    ds_read_b128 v[44:47], v6 offset:3328
    v_mfma_f32_16x16x32_f16 v[64:67], v[80:83], v[112:115], v[204:207]
    v_pk_mul_f16 v27, v27, v62 op_sel:[0,1] op_sel_hi:[1,1]
    v_pk_mul_f16 v148, v148, v62 op_sel:[0,1] op_sel_hi:[1,1]
    v_mfma_f32_16x16x32_f16 v[64:67], v[152:155], v[150:153], v[64:67]
    ds_read_b128 v[32:35], v3 offset:3328
    v_pk_mul_f16 v149, v149, v62 op_sel:[0,1] op_sel_hi:[1,1]
    v_pk_mul_f16 v224, v224, v62 op_sel:[0,0] op_sel_hi:[1,0]
    v_pk_mul_f16 v225, v225, v62 op_sel:[0,0] op_sel_hi:[1,0]
    v_pk_mul_f16 v226, v226, v62 op_sel:[0,0] op_sel_hi:[1,0]
    v_pk_mul_f16 v227, v227, v62 op_sel:[0,0] op_sel_hi:[1,0]
    v_pk_mul_f16 v146, v146, v62 op_sel:[0,0] op_sel_hi:[1,0]
    v_pk_mul_f16 v147, v147, v62 op_sel:[0,0] op_sel_hi:[1,0]
    v_mfma_f32_16x16x32_f16 v[240:243], v[24:27], v[112:115], v[200:203]
    v_mov_b32 v138, 0
    v_mov_b32 v139, 0
    v_mfma_f32_16x16x32_f16 v[240:243], v[146:149], v[150:153], v[240:243]
    s_waitcnt lgkmcnt(4)
    buffer_load_dwordx4 v166, s[76:79], s92 offen offset:2048 lds
    v_cvt_pk_bf16_f32 v92, v108, v109
    v_mfma_f32_16x16x32_bf16 v[60:63], v[52:55], a[144:147], 0
    s_add_u32 m0, s90, 61440
    v_cvt_pk_bf16_f32 v93, v110, v111
    v_cvt_pk_bf16_f32 v72, v72, v73
    v_mfma_f32_16x16x32_bf16 v[60:63], v[36:39], a[148:151], v[60:63]
    s_waitcnt lgkmcnt(2)
    s_mov_b32 s92, 61440
    ds_write_b64 v120, v[92:93] offset:28752
    v_mfma_f32_16x16x32_bf16 v[60:63], v[104:107], a[152:155], v[60:63]
    v_cvt_pk_bf16_f32 v73, v74, v75
    v_cvt_pk_bf16_f32 v74, v88, v89
    v_mfma_f32_16x16x32_bf16 v[60:63], v[48:51], a[156:159], v[60:63]
    s_waitcnt lgkmcnt(2)
    v_cvt_pk_bf16_f32 v75, v90, v91
    v_add_f32 v0, s84, v0
    v_mfma_f32_16x16x32_bf16 v[60:63], v[44:47], a[160:163], v[60:63]
    s_waitcnt lgkmcnt(1)
    buffer_load_dwordx4 v5, s[76:79], s92 offen offset:0 lds
    v_cvt_pk_f16_f32 v88, v16, v17
    v_mfma_f32_16x16x32_bf16 v[60:63], v[32:35], a[164:167], v[60:63]
    ds_write_b128 v120, v[72:75] offset:28768
    v_mfma_f32_16x16x32_bf16 v[72:75], v[52:55], a[168:171], 0
    v_exp_f32 v0, v0
    v_mfma_f32_16x16x32_bf16 v[72:75], v[36:39], a[172:175], v[72:75]
    v_cvt_pk_bf16_f32 v0, v0, 0
    v_cmp_gt_u32 vcc, 16, v121
    v_mfma_f32_16x16x32_bf16 v[72:75], v[104:107], a[176:179], v[72:75]
    buffer_load_dwordx4 v4, s[76:79], s92 offen offset:1024 lds
    v_cndmask_b32 v0, 0, v0, vcc
    v_mfma_f32_16x16x32_bf16 v[72:75], v[48:51], a[180:183], v[72:75]
    ds_write_b64 v29, v[0:1] offset:88
    v_mfma_f32_16x16x32_bf16 v[72:75], v[44:47], a[184:187], v[72:75]
    v_cvt_pk_bf16_f32 v164, v60, v61
    v_cvt_pk_bf16_f32 v165, v62, v63
    v_mfma_f32_16x16x32_bf16 v[72:75], v[32:35], a[188:191], v[72:75]
    ds_read_b128 v[60:63], v132 offset:0
    v_cvt_pk_f16_f32 v89, v18, v19
    v_mfma_f32_16x16x32_bf16 v[16:19], v[52:55], a[192:195], 0
    ds_read_b128 v[52:55], v132 offset:16
    buffer_load_dwordx4 v166, s[76:79], s92 offen offset:2048 lds
    v_mfma_f32_16x16x32_bf16 v[16:19], v[36:39], a[196:199], v[16:19]
    s_add_u32 m0, s54, 20480
    ds_read_b128 v[36:39], v132 offset:48
    v_cvt_pk_bf16_f32 v160, v72, v73
    v_mfma_f32_16x16x32_bf16 v[16:19], v[104:107], a[200:203], v[16:19]
    v_cvt_pk_bf16_f32 v161, v74, v75
    v_pk_fma_f16 v29, v88, v88, s39
    v_mfma_f32_16x16x32_bf16 v[16:19], v[48:51], a[204:207], v[16:19]
    ds_read_u16 v166, v131 offset:80
    v_pk_fmac_f16 v29, v89, v89
    v_mfma_f32_16x16x32_bf16 v[16:19], v[44:47], a[208:211], v[16:19]
    ds_read_u16 v162, v131 offset:96
    v_cvt_pk_f16_f32 v90, v20, v21
    v_mfma_f32_16x16x32_bf16 v[16:19], v[32:35], a[212:215], v[16:19]
    ds_read_u16 v158, v131 offset:104
    buffer_load_dwordx4 v128, s[24:27], s56 offen nt lds
    v_mfma_f32_16x16x32_f16 v[228:231], v[80:83], v[224:227], v[192:195]
    s_add_u32 m0, s54, 21504
    v_cvt_pk_f16_f32 v91, v22, v23
    v_pk_fmac_f16 v29, v90, v90
    v_mfma_f32_16x16x32_f16 v[228:231], v[152:155], v[144:147], v[228:231]
    s_nop 0
    v_cvt_pk_bf16_f32 v156, v16, v17
    v_cvt_pk_bf16_f32 v157, v18, v19
    v_mfma_f32_16x16x32_f16 v[32:35], v[24:27], v[224:227], v[188:191]
    v_pk_fmac_f16 v29, v91, v91
    v_cvt_pk_f16_f32 v142, v8, v9
    v_mfma_f32_16x16x32_f16 v[32:35], v[146:149], v[144:147], v[32:35]
    s_waitcnt lgkmcnt(4)
    ds_read_b128 v[252:255], v6 offset:42496
    v_cvt_pk_f16_f32 v143, v10, v11
    v_mfma_f32_16x16x32_f16 v[20:23], v[60:63], v[112:115], v[208:211]
    ds_read_b128 v[248:251], v3 offset:42496
    buffer_load_dwordx4 v127, s[24:27], s56 offen nt lds
    v_mfma_f32_16x16x32_f16 v[20:23], v[52:55], v[80:83], v[20:23]
    s_waitcnt lgkmcnt(5)
    s_add_u32 m0, s54, 22528
    ds_read_b128 v[244:247], v6 offset:42624
    v_pk_fmac_f16 v29, v142, v142
    v_mfma_f32_16x16x32_f16 v[20:23], v[36:39], v[152:155], v[20:23]
    ds_read_b128 v[104:107], v3 offset:42624
    v_pk_fmac_f16 v29, v143, v143
    v_mfma_f32_16x16x32_f16 v[16:19], v[60:63], v[224:227], v[208:211]
    ds_read_b128 v[48:51], v6 offset:42752
    v_pk_mul_f16 v56, v56, v14 op_sel:[0,0] op_sel_hi:[1,0]
    v_mfma_f32_16x16x32_f16 v[16:19], v[52:55], v[24:27], v[16:19]
    ds_read_b128 v[108:111], v3 offset:42752
    v_pk_mul_f16 v57, v57, v14 op_sel:[0,0] op_sel_hi:[1,0]
    v_mfma_f32_16x16x32_f16 v[16:19], v[36:39], v[146:149], v[16:19]
    v_exp_f32 v64, v64
    v_mfma_f32_16x16x32_f16 v[8:11], v[212:215], v[28:31], 0
    s_waitcnt lgkmcnt(5)
    s_nop 0
    buffer_load_dwordx4 v126, s[24:27], s56 offen nt lds
    v_pk_mul_f16 v58, v58, v14 op_sel:[0,0] op_sel_hi:[1,0]
    v_exp_f32 v65, v65
    s_add_u32 m0, s54, 23552
    v_mov_b32_dpp v23, v19 quad_perm:[0,1,2,3] row_mask:0x2 bank_mask:0xf
    v_exp_f32 v66, v66
    v_mfma_f32_16x16x32_bf16 v[44:47], a[144:147], v[252:255], 0
    s_waitcnt lgkmcnt(4)
    v_or3_b32 v123, v123, v8, v9
    v_cvt_pk_bf16_f32 v64, v64, v65
    v_mfma_f32_16x16x32_bf16 v[44:47], a[148:151], v[248:251], v[44:47]
    s_waitcnt lgkmcnt(3)
    v_rsq_f32 v8, v8
    v_mfma_f32_16x16x32_bf16 v[44:47], a[152:155], v[244:247], v[44:47]
    s_waitcnt lgkmcnt(2)
    buffer_load_dwordx4 v125, s[24:27], s56 offen nt lds
    v_mul_f32 v8, s52, v8
    v_mfma_f32_16x16x32_bf16 v[44:47], a[156:159], v[104:107], v[44:47]
    s_waitcnt lgkmcnt(1)
    s_add_u32 m0, s54, 24576
    v_rsq_f32 v9, v9
    v_mfma_f32_16x16x32_bf16 v[44:47], a[160:163], v[48:51], v[44:47]
    s_waitcnt lgkmcnt(0)
    v_cvt_pk_f16_f32 v8, v8, v9
    v_pk_mul_f16 v88, v88, v8 op_sel:[0,1] op_sel_hi:[1,1]
    v_mfma_f32_16x16x32_bf16 v[44:47], a[164:167], v[108:111], v[44:47]
    v_pk_mul_f16 v89, v89, v8 op_sel:[0,1] op_sel_hi:[1,1]
    v_pk_mul_f16 v90, v90, v8 op_sel:[0,1] op_sel_hi:[1,1]
    v_mfma_f32_16x16x32_bf16 v[28:31], a[168:171], v[252:255], 0
    v_pk_mul_f16 v91, v91, v8 op_sel:[0,1] op_sel_hi:[1,1]
    v_pk_mul_f16 v142, v142, v8 op_sel:[0,1] op_sel_hi:[1,1]
    v_mfma_f32_16x16x32_bf16 v[28:31], a[172:175], v[248:251], v[28:31]
    buffer_load_dwordx4 v124, s[24:27], s56 offen nt lds
    v_pk_mul_f16 v143, v143, v8 op_sel:[0,1] op_sel_hi:[1,1]
    v_mfma_f32_16x16x32_bf16 v[28:31], a[176:179], v[244:247], v[28:31]
    s_cmp_lt_u32 s61, s71
    v_pk_mul_f16 v84, v84, v8 op_sel:[0,0] op_sel_hi:[1,0]
    v_pk_mul_f16 v85, v85, v8 op_sel:[0,0] op_sel_hi:[1,0]
    v_mfma_f32_16x16x32_bf16 v[28:31], a[180:183], v[104:107], v[28:31]
    s_cselect_b32 s15, s61, s12
    v_pk_mul_f16 v86, v86, v8 op_sel:[0,0] op_sel_hi:[1,0]
    v_pk_mul_f16 v87, v87, v8 op_sel:[0,0] op_sel_hi:[1,0]
    v_mfma_f32_16x16x32_bf16 v[28:31], a[184:187], v[48:51], v[28:31]
    s_cselect_b32 s56, s69, s70
    ds_read_b128 v[232:235], v6 offset:0
    v_pk_mul_f16 v140, v140, v8 op_sel:[0,0] op_sel_hi:[1,0]
    v_mfma_f32_16x16x32_bf16 v[28:31], a[188:191], v[108:111], v[28:31]
    s_add_u32 s56, s56, s15
    ds_read_b128 v[72:75], v3 offset:0
    v_pk_mul_f16 v141, v141, v8 op_sel:[0,0] op_sel_hi:[1,0]
    v_mfma_f32_16x16x32_f16 v[236:239], v[88:91], v[112:115], v[196:199]
    s_mul_i32 s53, s56, 58255
    buffer_load_dword v96, v126, s[28:31], s72 offen nt
    ds_read_b128 v[112:115], v6 offset:128
    v_mfma_f32_16x16x32_f16 v[236:239], v[140:143], v[150:153], v[236:239]
    s_lshr_b32 s53, s53, 22
    v_exp_f32 v67, v67
    v_mfma_f32_16x16x32_f16 v[8:11], v[60:63], v[84:87], v[208:211]
    s_mul_i32 s53, s53, s63
    ds_read_b128 v[60:63], v3 offset:128
    v_cvt_pk_bf16_f32 v65, v66, v67
    v_mfma_f32_16x16x32_f16 v[8:11], v[52:55], v[88:91], v[8:11]
    s_mul_i32 s56, s56, s62
    ds_read_b128 v[52:55], v6 offset:256
    v_cvt_pk_bf16_f32 v98, v44, v45
    v_mfma_f32_16x16x32_f16 v[8:11], v[36:39], v[140:143], v[8:11]
    s_add_u32 s56, s56, s53
    ds_read_b128 v[36:39], v3 offset:256
    v_cvt_pk_bf16_f32 v99, v46, v47
    v_mfma_f32_16x16x32_f16 v[44:47], v[88:91], v[224:227], v[184:187]
    s_mul_i32 s4, s15, 112
    v_exp_f32 v240, v240
    v_mfma_f32_16x16x32_f16 v[44:47], v[140:143], v[144:147], v[44:47]
    s_cmp_ge_u32 s15, 16
    v_mov_b32_dpp v23, v11 quad_perm:[0,1,2,3] row_mask:0x4 bank_mask:0xf
    v_cvt_pk_bf16_f32 v28, v28, v29
    v_mfma_f32_16x16x32_bf16 v[224:227], a[192:195], v[252:255], 0
    s_cselect_b32 s53, -30464, 0
    v_exp_f32 v23, v23
    v_mfma_f32_16x16x32_bf16 v[224:227], a[196:199], v[248:251], v[224:227]
    s_add_u32 s4, s4, s53
    v_cvt_pk_bf16_f32 v23, v23, v23
    v_cvt_pk_bf16_f32 v29, v30, v31
    v_mfma_f32_16x16x32_bf16 v[224:227], a[200:203], v[244:247], v[224:227]
    s_cmp_lt_u32 s15, s73
    ds_write_b16 v131, v23 offset:64
    v_mfma_f32_16x16x32_bf16 v[224:227], a[204:207], v[104:107], v[224:227]
    s_cselect_b32 s26, 100270464, 0
    ds_read_b128 v[104:107], v132 offset:48
    v_pk_mul_f16 v59, v59, v14 op_sel:[0,0] op_sel_hi:[1,0]
    v_mfma_f32_16x16x32_bf16 v[224:227], a[208:211], v[48:51], v[224:227]
    s_cselect_b32 s56, s56, 0
    ds_read_b128 v[48:51], v132 offset:64
    v_pk_mul_f16 v40, v40, v14 op_sel:[0,0] op_sel_hi:[1,0]
    v_mfma_f32_16x16x32_bf16 v[224:227], a[212:215], v[108:111], v[224:227]
    s_waitcnt lgkmcnt(4)
    s_cselect_b32 s4, s4, -1
    v_exp_f32 v241, v241
    v_mfma_f32_16x16x32_bf16 v[108:111], v[232:235], a[144:147], 0
    s_cselect_b32 s15, s15, 0
    v_exp_f32 v242, v242
    v_mfma_f32_16x16x32_bf16 v[108:111], v[72:75], a[148:151], v[108:111]
    s_cselect_b32 s13, s13, -1
    v_exp_f32 v243, v243
    v_mfma_f32_16x16x32_bf16 v[108:111], v[112:115], a[152:155], v[108:111]
    s_bitset1_b32 s64, s15
    v_cvt_pk_bf16_f32 v66, v240, v241
    v_cvt_pk_bf16_f32 v67, v242, v243
    v_mfma_f32_16x16x32_bf16 v[108:111], v[60:63], a[156:159], v[108:111]
    s_cmp_ge_i32 s65, 2
    v_exp_f32 v236, v236
    v_mfma_f32_16x16x32_bf16 v[108:111], v[52:55], a[160:163], v[108:111]
    s_waitcnt vmcnt(6) lgkmcnt(3)
    s_cselect_b32 s30, 100270464, 0
    v_exp_f32 v237, v237
    v_mfma_f32_16x16x32_bf16 v[108:111], v[36:39], a[164:167], v[108:111]
    s_barrier
    v_exp_f32 v238, v238
    v_exp_f32 v239, v239
    v_cvt_pk_bf16_f32 v168, v236, v237
    v_cvt_pk_bf16_f32 v169, v238, v239
    v_exp_f32 v20, v20
    v_exp_f32 v228, v228
    v_cvt_pk_bf16_f32 v170, v20, 0
    v_mfma_f32_16x16x32_bf16 v[20:23], v[232:235], a[168:171], 0
    v_exp_f32 v229, v229
    v_mfma_f32_16x16x32_bf16 v[20:23], v[72:75], a[172:175], v[20:23]
    s_lshl_b32 s93, s68, 10
    v_exp_f32 v230, v230
    v_mfma_f32_16x16x32_bf16 v[20:23], v[112:115], a[176:179], v[20:23]
    s_mov_b32 s53, s47
    v_exp_f32 v231, v231
    v_mfma_f32_16x16x32_bf16 v[20:23], v[60:63], a[180:183], v[20:23]
    s_mov_b32 s47, s46
    v_cvt_pk_bf16_f32 v228, v228, v229
    v_cvt_pk_bf16_f32 v229, v230, v231
    v_mfma_f32_16x16x32_bf16 v[20:23], v[52:55], a[184:187], v[20:23]
    s_mov_b32 s46, s45
    v_exp_f32 v32, v32
    v_mfma_f32_16x16x32_bf16 v[20:23], v[36:39], a[188:191], v[20:23]
    s_mov_b32 s45, s44
    ds_read_b128 v[244:247], v7 offset:0
    v_cvt_pk_bf16_f32 v30, v224, v225
    v_exp_f32 v33, v33
    v_exp_f32 v34, v34
    v_exp_f32 v35, v35
    v_cvt_pk_bf16_f32 v230, v32, v33
    v_cvt_pk_bf16_f32 v231, v34, v35
    v_exp_f32 v44, v44
    v_exp_f32 v45, v45
    v_exp_f32 v46, v46
    v_exp_f32 v47, v47
    v_exp_f32 v17, v17
    v_mfma_f32_16x16x32_bf16 v[32:35], v[232:235], a[192:195], 0
    s_mov_b32 s44, s53
    ds_read_b64 v[240:241], v2 offset:64
    v_cvt_pk_bf16_f32 v31, v226, v227
    v_mfma_f32_16x16x32_bf16 v[32:35], v[72:75], a[196:199], v[32:35]
    s_sub_u32 s48, s44, s46
    ds_read_b128 v[72:75], v7 offset:3072
    v_cvt_pk_bf16_f32 v0, v108, v109
    v_mfma_f32_16x16x32_bf16 v[32:35], v[112:115], a[200:203], v[32:35]
    s_sub_u32 s49, s46, s45
    ds_read_b64 v[242:243], v2 offset:3136
    v_cvt_pk_bf16_f32 v1, v110, v111
    v_mfma_f32_16x16x32_bf16 v[32:35], v[60:63], a[204:207], v[32:35]
    ds_read_b128 v[224:227], v7 offset:6144
    v_cvt_pk_bf16_f32 v20, v20, v21
    v_mfma_f32_16x16x32_bf16 v[32:35], v[52:55], a[208:211], v[32:35]
    ds_read_b64 v[52:53], v2 offset:6208
    v_cvt_pk_bf16_f32 v21, v22, v23
    v_mfma_f32_16x16x32_bf16 v[32:35], v[36:39], a[212:215], v[32:35]
    ds_read_b128 v[60:63], v7 offset:9216
    v_pk_mul_f16 v41, v41, v14 op_sel:[0,0] op_sel_hi:[1,0]
    v_mfma_f32_16x16x32_bf16 v[112:115], v[220:223], v[64:67], 0
    ds_read_b64 v[54:55], v2 offset:9280
    v_pk_mul_f16 v76, v76, v14 op_sel:[0,1] op_sel_hi:[1,1]
    v_mfma_f32_16x16x32_bf16 v[112:115], v[220:223], v[168:171], v[112:115]
    s_nop 0
    ds_read_b128 v[108:111], v7 offset:12288
    v_cvt_pk_bf16_f32 v4, v32, v33
    v_mfma_f32_16x16x32_f16 v[36:39], v[80:83], v[84:87], v[180:183]
    ds_read_b64 v[80:81], v2 offset:12352
    v_cvt_pk_bf16_f32 v5, v34, v35
    v_mfma_f32_16x16x32_f16 v[36:39], v[152:155], v[138:141], v[36:39]
    ds_read_b128 v[232:235], v7 offset:15360
    v_pk_mul_f16 v77, v77, v14 op_sel:[0,1] op_sel_hi:[1,1]
    v_mfma_f32_16x16x32_f16 v[32:35], v[24:27], v[84:87], v[176:179]
    ds_read_b64 v[82:83], v2 offset:15424
    v_pk_mul_f16 v78, v78, v14 op_sel:[0,1] op_sel_hi:[1,1]
    v_mfma_f32_16x16x32_f16 v[32:35], v[146:149], v[138:141], v[32:35]
    ds_read_b128 v[236:239], v7 offset:18432
    v_pk_mul_f16 v79, v79, v14 op_sel:[0,1] op_sel_hi:[1,1]
    v_mfma_f32_16x16x32_f16 v[24:27], v[88:91], v[84:87], v[172:175]
    ds_read_b64 v[12:13], v2 offset:18496
    v_pk_mul_f16 v42, v42, v14 op_sel:[0,1] op_sel_hi:[1,1]
    v_mfma_f32_16x16x32_f16 v[24:27], v[140:143], v[138:141], v[24:27]
    s_waitcnt lgkmcnt(8)
    ds_read_b128 v[88:91], v7 offset:21504
    v_pk_mul_f16 v43, v43, v14 op_sel:[0,1] op_sel_hi:[1,1]
    v_mfma_f32_16x16x32_bf16 v[84:87], v[244:247], v[220:223], 0
    ds_read_b64 v[14:15], v2 offset:21568
    v_fma_mix_f32 v18, v56, v76, 0 op_sel:[0,0,0] op_sel_hi:[1,1,0]
    v_mfma_f32_16x16x32_bf16 v[84:87], v[72:75], v[220:223], v[84:87]
    ds_read_b128 v[72:75], v7 offset:24576
    v_fma_mix_f32 v18, v56, v76, v18 op_sel:[1,1,0] op_sel_hi:[1,1,0]
    v_mfma_f32_16x16x32_bf16 v[84:87], v[224:227], v[220:223], v[84:87]
    s_waitcnt lgkmcnt(8)
    ds_read_b64 v[224:225], v2 offset:24640
    v_fma_mix_f32 v18, v57, v77, v18 op_sel:[0,0,0] op_sel_hi:[1,1,0]
    v_mfma_f32_16x16x32_bf16 v[84:87], v[60:63], v[220:223], v[84:87]
    ds_read_b128 v[60:63], v7 offset:27648
    v_fma_mix_f32 v18, v57, v77, v18 op_sel:[1,1,0] op_sel_hi:[1,1,0]
    v_mfma_f32_16x16x32_bf16 v[84:87], v[240:243], v[220:223], v[84:87]
    ds_read_b64 v[226:227], v2 offset:27712
    v_fma_mix_f32 v18, v58, v78, v18 op_sel:[0,0,0] op_sel_hi:[1,1,0]
    v_mfma_f32_16x16x32_bf16 v[84:87], v[52:55], v[220:223], v[84:87]
    s_add_u32 m0, s67, 0
    ds_read_b128 v[52:55], v7 offset:30720
    v_fma_mix_f32 v18, v58, v78, v18 op_sel:[1,1,0] op_sel_hi:[1,1,0]
    v_mfma_f32_16x16x32_bf16 v[152:155], v[108:111], v[220:223], 0
    s_waitcnt lgkmcnt(8)
    ds_read_b64 v[108:109], v2 offset:30784
    v_fma_mix_f32 v18, v59, v79, v18 op_sel:[0,0,0] op_sel_hi:[1,1,0]
    v_mfma_f32_16x16x32_bf16 v[152:155], v[232:235], v[220:223], v[152:155]
    ds_read_b128 v[232:235], v7 offset:33792
    v_fma_mix_f32 v18, v59, v79, v18 op_sel:[1,1,0] op_sel_hi:[1,1,0]
    v_mfma_f32_16x16x32_bf16 v[152:155], v[236:239], v[220:223], v[152:155]
L_pg1:
    s_cbranch_execz L_main
    s_waitcnt lgkmcnt(8)
    ds_read_b64 v[110:111], v2 offset:33856
    v_fma_mix_f32 v18, v40, v42, v18 op_sel:[0,0,0] op_sel_hi:[1,1,0]
    v_mfma_f32_16x16x32_bf16 v[152:155], v[88:91], v[220:223], v[152:155]
    ds_read_b128 v[140:143], v6 offset:1536
    v_fma_mix_f32 v18, v40, v42, v18 op_sel:[1,1,0] op_sel_hi:[1,1,0]
    v_mfma_f32_16x16x32_bf16 v[152:155], v[80:83], v[220:223], v[152:155]
    s_waitcnt lgkmcnt(8)
    ds_read_b128 v[88:91], v3 offset:1536
    v_fma_mix_f32 v18, v41, v43, v18 op_sel:[0,0,0] op_sel_hi:[1,1,0]
    v_mfma_f32_16x16x32_bf16 v[152:155], v[12:15], v[220:223], v[152:155]
    ds_read_b128 v[80:83], v6 offset:1664
    v_fma_mix_f32 v18, v41, v43, v18 op_sel:[1,1,0] op_sel_hi:[1,1,0]
    v_mfma_f32_16x16x32_bf16 v[12:15], v[72:75], v[220:223], 0
    s_waitcnt lgkmcnt(8)
    ds_read_b128 v[72:75], v3 offset:1664
    v_mov_b32 v2, v18
    v_mfma_f32_16x16x32_bf16 v[12:15], v[60:63], v[220:223], v[12:15]
    s_waitcnt lgkmcnt(7)
    ds_read_b128 v[60:63], v6 offset:1792
    v_mul_f32 v84, 0xbbaaaaab, v84
    v_rcp_f32 v112, v112
    v_mfma_f32_16x16x32_bf16 v[12:15], v[52:55], v[220:223], v[12:15]
    s_waitcnt lgkmcnt(6)
    ds_read_b128 v[52:55], v3 offset:1792
    v_mul_f32 v85, 0xbbaaaaab, v85
    v_permlane32_swap_b32 v2, v18
    v_add_f32 v18, v2, v18
    v_mfma_f32_16x16x32_bf16 v[12:15], v[232:235], v[220:223], v[12:15]
    v_mov_b32 v2, v18
    v_mul_f32 v86, 0xbbaaaaab, v86
    v_mfma_f32_16x16x32_bf16 v[12:15], v[224:227], v[220:223], v[12:15]
    s_waitcnt lgkmcnt(5)
    v_permlane16_swap_b32 v2, v18
    v_mfma_f32_16x16x32_bf16 v[12:15], v[108:111], v[220:223], v[12:15]
    v_add_f32 v18, v2, v18
    v_add_f32 v18, s84, v18
    v_mfma_f32_16x16x32_bf16 v[108:111], v[140:143], a[144:147], 0
    s_waitcnt lgkmcnt(3)
    v_exp_f32 v18, v18
    v_mfma_f32_16x16x32_bf16 v[108:111], v[88:91], a[148:151], v[108:111]
    v_cvt_pk_bf16_f32 v18, v18, 0
    v_cmp_gt_u32 vcc, 16, v121
    v_mfma_f32_16x16x32_bf16 v[108:111], v[80:83], a[152:155], v[108:111]
    s_waitcnt lgkmcnt(1)
    v_cndmask_b32 v18, 0, v18, vcc
    v_mul_f32 v87, 0xbbaaaaab, v87
    v_mfma_f32_16x16x32_bf16 v[108:111], v[72:75], a[156:159], v[108:111]
    s_waitcnt lgkmcnt(0)
    ds_write_b128 v97, v[84:87] offset:0
    v_mfma_f32_16x16x32_bf16 v[108:111], v[60:63], a[160:163], v[108:111]
    s_barrier
    buffer_load_dwordx4 v128, s[24:27], s56 offen nt lds
    v_mul_f32 v152, 0xbbaaaaab, v152
    v_mfma_f32_16x16x32_bf16 v[108:111], v[52:55], a[164:167], v[108:111]
    s_add_u32 m0, s67, 1024
    v_mul_f32 v153, 0xbbaaaaab, v153
    v_mul_f32 v154, 0xbbaaaaab, v154
    v_mfma_f32_16x16x32_bf16 v[84:87], v[140:143], a[168:171], 0
    buffer_load_dwordx4 v127, s[24:27], s56 offen nt lds
    v_mul_f32 v155, 0xbbaaaaab, v155
    v_mfma_f32_16x16x32_bf16 v[84:87], v[88:91], a[172:175], v[84:87]
    s_add_u32 m0, s67, 2048
    ds_write_b128 v97, v[152:155] offset:128
    v_mfma_f32_16x16x32_bf16 v[84:87], v[80:83], a[176:179], v[84:87]
    buffer_load_dwordx4 v126, s[24:27], s56 offen nt lds
    v_mul_f32 v12, 0xbbaaaaab, v12
    v_mfma_f32_16x16x32_bf16 v[84:87], v[72:75], a[180:183], v[84:87]
    s_add_u32 m0, s67, 3072
    v_mul_f32 v13, 0xbbaaaaab, v13
    v_mul_f32 v14, 0xbbaaaaab, v14
    v_mfma_f32_16x16x32_bf16 v[84:87], v[60:63], a[184:187], v[84:87]
    buffer_load_dwordx4 v125, s[24:27], s56 offen nt lds
    v_mul_f32 v15, 0xbbaaaaab, v15
    v_mfma_f32_16x16x32_bf16 v[84:87], v[52:55], a[188:191], v[84:87]
    s_add_u32 m0, s67, 4096
    ds_write_b128 v97, v[12:15] offset:256
    v_mfma_f32_16x16x32_bf16 v[12:15], v[140:143], a[192:195], 0
    buffer_load_dwordx4 v124, s[24:27], s56 offen nt lds
    v_cvt_pk_bf16_f32 v2, v108, v109
    v_mfma_f32_16x16x32_bf16 v[12:15], v[88:91], a[196:199], v[12:15]
    s_nop 0
    v_cvt_pk_bf16_f32 v3, v110, v111
    v_cvt_pk_bf16_f32 v22, v84, v85
    v_mfma_f32_16x16x32_bf16 v[12:15], v[80:83], a[200:203], v[12:15]
    ds_read_b128 v[80:83], v118 offset:24576
    v_cvt_pk_bf16_f32 v23, v86, v87
    v_mfma_f32_16x16x32_bf16 v[12:15], v[72:75], a[204:207], v[12:15]
    ds_read_b64 v[84:85], v101 offset:24640
    v_and_b32 v97, 0xb8000000, v123
    v_mfma_f32_16x16x32_bf16 v[12:15], v[60:63], a[208:211], v[12:15]
    v_cmp_ne_u32 s[94:95], 0, v97
    v_add_u32 v121, s93, v129
    v_mfma_f32_16x16x32_bf16 v[12:15], v[52:55], a[212:215], v[12:15]
    s_or_b32 s94, s94, s95
    ds_read_b128 v[86:89], v118 offset:25344
    v_mov_b32 v97, s94
    v_mfma_f32_16x16x32_bf16 v[60:63], v[0:3], v[64:67], 0
    s_lshl_b32 s95, s68, 2
    ds_read_b64 v[90:91], v101 offset:25408
    v_mov_b32 v16, s95
    v_mfma_f32_16x16x32_bf16 v[60:63], v[164:167], v[168:171], v[60:63]
    s_waitcnt lgkmcnt(4)
    v_cvt_pk_bf16_f32 v6, v12, v13
    v_cvt_pk_bf16_f32 v7, v14, v15
    v_mfma_f32_16x16x32_bf16 v[72:75], v[20:23], v[64:67], 0
    s_barrier
    ds_read_b128 v[52:55], v100 offset:256
    v_add_u32 v137, s48, v137
    v_mfma_f32_16x16x32_bf16 v[72:75], v[160:163], v[168:171], v[72:75]
    ds_read_b128 v[12:15], v100 offset:320
    v_mul_f32 v60, v60, v112
    v_mfma_f32_16x16x32_bf16 v[108:111], v[4:7], v[64:67], 0
    v_mul_f32 v61, v61, v112
    v_cvt_pk_bf16_f32 v140, v60, v61
    v_mfma_f32_16x16x32_bf16 v[108:111], v[156:159], v[168:171], v[108:111]
    v_mul_f32 v62, v62, v112
    v_mul_f32 v63, v63, v112
    v_cvt_pk_bf16_f32 v141, v62, v63
    v_mfma_f32_16x16x32_bf16 v[60:63], v[104:107], v[0:3], 0
    ds_write_b64 v135, v[140:141] offset:0
    v_mfma_f32_16x16x32_bf16 v[60:63], v[48:51], v[164:167], v[60:63]
    v_mul_f32 v72, v72, v112
    v_mul_f32 v73, v73, v112
    v_mfma_f32_16x16x32_bf16 v[64:67], v[104:107], v[20:23], 0
    v_cvt_pk_bf16_f32 v142, v72, v73
    v_mul_f32 v74, v74, v112
    v_mfma_f32_16x16x32_bf16 v[64:67], v[48:51], v[160:163], v[64:67]
    v_mul_f32 v75, v75, v112
    v_cvt_pk_bf16_f32 v143, v74, v75
    v_mfma_f32_16x16x32_bf16 v[72:75], v[104:107], v[4:7], 0
    ds_write_b64 v135, v[142:143] offset:8
    v_mfma_f32_16x16x32_bf16 v[72:75], v[48:51], v[156:159], v[72:75]
    s_waitcnt lgkmcnt(2)
    v_mul_f32 v108, v108, v112
    v_mul_f32 v109, v109, v112
    v_mfma_f32_16x16x16_bf16 v[48:51], v[80:81], v[94:95], v[52:55]
    ds_write_b32 v16, v97 offset:14848
    v_cvt_pk_bf16_f32 v92, v108, v109
    v_mfma_f32_16x16x16_bf16 v[104:107], v[82:83], v[94:95], v[52:55]
    v_mul_f32 v110, v110, v112
    v_mul_f32 v111, v111, v112
    v_mfma_f32_16x16x16_bf16 v[152:155], v[84:85], v[94:95], v[52:55]
    v_cvt_pk_bf16_f32 v93, v110, v111
    v_cvt_pk_bf16_f32 v168, v44, v45
    v_mfma_f32_16x16x16_bf16 v[140:143], v[86:87], v[94:95], v[12:15]
    v_cvt_pk_bf16_f32 v169, v46, v47
    v_cvt_pk_bf16_f32 v170, v17, 0
    v_mfma_f32_16x16x16_bf16 v[84:87], v[88:89], v[94:95], v[12:15]
    ds_write_b32 v134, v92 offset:0
    v_mfma_f32_16x16x16_bf16 v[108:111], v[90:91], v[94:95], v[12:15]
    ds_write_b32 v134, v93 offset:4
    v_cvt_pk_bf16_f32 v48, v48, v49
    v_mfma_f32_16x16x32_bf16 v[44:47], v[220:223], v[228:231], 0
    ds_read_b128 v[112:115], v118 offset:49152
    v_accvgpr_write_b32 a224, v48
    v_mfma_f32_16x16x32_bf16 v[44:47], v[220:223], v[168:171], v[44:47]
    ds_read_b64 v[116:117], v101 offset:49216
    v_cvt_pk_bf16_f32 v50, v50, v51
    v_mfma_f32_16x16x32_bf16 v[12:15], v[0:3], v[228:231], 0
    ds_read_b128 v[80:83], v100 offset:5248
    v_accvgpr_write_b32 a225, v50
    v_mfma_f32_16x16x32_bf16 v[12:15], v[164:167], v[168:171], v[12:15]
    ds_read_b128 v[88:91], v118 offset:49920
    v_cvt_pk_bf16_f32 v104, v104, v105
    v_mfma_f32_16x16x32_bf16 v[52:55], v[20:23], v[228:231], 0
    ds_read_b64 v[92:93], v101 offset:49984
    v_accvgpr_write_b32 a248, v104
    v_mfma_f32_16x16x32_bf16 v[52:55], v[160:163], v[168:171], v[52:55]
    ds_read_b128 v[224:227], v100 offset:5312
    v_cvt_pk_bf16_f32 v106, v106, v107
    v_mfma_f32_16x16x32_bf16 v[48:51], v[4:7], v[228:231], 0
    ds_read_b128 v[102:105], v118 offset:12288
    v_accvgpr_write_b32 a249, v106
    v_mfma_f32_16x16x32_bf16 v[48:51], v[156:159], v[168:171], v[48:51]
    ds_read_b64 v[106:107], v101 offset:12352
    v_cvt_pk_bf16_f32 v240, v152, v153
    v_cvt_pk_bf16_f32 v241, v154, v155
    v_cvt_pk_bf16_f32 v140, v140, v141
    v_accvgpr_write_b32 a226, v140
    v_cvt_pk_bf16_f32 v142, v142, v143
    v_accvgpr_write_b32 a227, v142
    v_cvt_pk_bf16_f32 v84, v84, v85
    v_accvgpr_write_b32 a250, v84
    v_cvt_pk_bf16_f32 v86, v86, v87
    v_accvgpr_write_b32 a251, v86
    v_cvt_pk_bf16_f32 v242, v108, v109
    v_cvt_pk_bf16_f32 v243, v110, v111
    v_mov_b32_dpp v63, v67 quad_perm:[0,1,2,3] row_mask:0x2 bank_mask:0xf
    v_mov_b32 v16, 0
    s_waitcnt lgkmcnt(5)
    v_mfma_f32_16x16x16_bf16 v[152:155], v[112:113], v[94:95], v[80:83]
    ds_read_b128 v[64:67], v100 offset:128
    v_mov_b32_dpp v63, v75 quad_perm:[0,1,2,3] row_mask:0x4 bank_mask:0xf
    v_mfma_f32_16x16x16_bf16 v[72:75], v[114:115], v[94:95], v[80:83]
    ds_read_b128 v[84:87], v118 offset:13056
    v_cvt_pk_bf16_f32 v63, v63, v63
    v_mfma_f32_16x16x16_bf16 v[112:115], v[116:117], v[94:95], v[80:83]
    s_waitcnt lgkmcnt(4)
    ds_write_b16 v131, v63
    v_mfma_f32_16x16x16_bf16 v[60:63], v[88:89], v[94:95], v[224:227]
    ds_read_b64 v[88:89], v101 offset:13120
    v_mov_b32 v17, 0
    v_mfma_f32_16x16x16_bf16 v[140:143], v[90:91], v[94:95], v[224:227]
    ds_read_b128 v[228:231], v100 offset:192
    v_mov_b32 v19, 0
    v_mfma_f32_16x16x16_bf16 v[80:83], v[92:93], v[94:95], v[224:227]
    ds_read_b128 v[108:111], v118 offset:61440
    v_add_u32 v97, 0, v120
    v_add_u32 v136, s48, v136
    v_cvt_pk_bf16_f32 v152, v152, v153
    v_accvgpr_write_b32 a232, v152
    v_cvt_pk_bf16_f32 v154, v154, v155
    v_accvgpr_write_b32 a233, v154
    v_cvt_pk_bf16_f32 v224, v72, v73
    v_cvt_pk_bf16_f32 v225, v74, v75
    v_cvt_pk_bf16_f32 v248, v112, v113
    v_cvt_pk_bf16_f32 v249, v114, v115
    v_cvt_pk_bf16_f32 v60, v60, v61
    v_accvgpr_write_b32 a234, v60
    v_cvt_pk_bf16_f32 v62, v62, v63
    v_accvgpr_write_b32 a235, v62
    s_waitcnt lgkmcnt(5)
    v_mfma_f32_16x16x16_bf16 v[60:63], v[102:103], v[94:95], v[64:67]
    ds_read_b64 v[112:113], v101 offset:61504
    v_cvt_pk_bf16_f32 v226, v140, v141
    v_mfma_f32_16x16x16_bf16 v[152:155], v[104:105], v[94:95], v[64:67]
    ds_read_b128 v[72:75], v100 offset:5376
    v_cvt_pk_bf16_f32 v227, v142, v143
    v_mfma_f32_16x16x16_bf16 v[140:143], v[106:107], v[94:95], v[64:67]
    s_waitcnt lgkmcnt(3)
    ds_read_b128 v[102:105], v118 offset:62208
    v_cvt_pk_bf16_f32 v250, v80, v81
    v_cvt_pk_bf16_f32 v251, v82, v83
    v_cvt_pk_bf16_f32 v60, v60, v61
    v_accvgpr_write_b32 a220, v60
    v_cvt_pk_bf16_f32 v62, v62, v63
    v_mfma_f32_16x16x16_bf16 v[80:83], v[84:85], v[94:95], v[228:231]
    ds_read_b64 v[106:107], v101 offset:62272
    v_accvgpr_write_b32 a221, v62
    v_mfma_f32_16x16x16_bf16 v[64:67], v[86:87], v[94:95], v[228:231]
    ds_read_b128 v[84:87], v100 offset:5440
    v_cvt_pk_bf16_f32 v152, v152, v153
    v_mfma_f32_16x16x16_bf16 v[60:63], v[88:89], v[94:95], v[228:231]
    ds_read_b128 v[88:91], v118 offset:36864
    v_accvgpr_write_b32 a244, v152
    v_cvt_pk_bf16_f32 v154, v154, v155
    v_accvgpr_write_b32 a245, v154
    v_cvt_pk_bf16_f32 v236, v140, v141
    v_cvt_pk_bf16_f32 v237, v142, v143
    v_cvt_pk_bf16_f32 v80, v80, v81
    v_accvgpr_write_b32 a222, v80
    v_cvt_pk_bf16_f32 v82, v82, v83
    v_accvgpr_write_b32 a223, v82
    v_cvt_pk_bf16_f32 v64, v64, v65
    v_accvgpr_write_b32 a246, v64
    v_cvt_pk_bf16_f32 v66, v66, v67
    v_accvgpr_write_b32 a247, v66
    v_cvt_pk_bf16_f32 v238, v60, v61
    s_waitcnt lgkmcnt(4)
    v_mfma_f32_16x16x16_bf16 v[64:67], v[108:109], v[94:95], v[72:75]
    ds_read_b64 v[92:93], v101 offset:36928
    v_cvt_pk_bf16_f32 v239, v62, v63
    v_mfma_f32_16x16x16_bf16 v[60:63], v[110:111], v[94:95], v[72:75]
    ds_read_b128 v[80:83], v100 offset:5120
    v_mfma_f32_16x16x16_bf16 v[108:111], v[112:113], v[94:95], v[72:75]
    s_waitcnt lgkmcnt(3)
    s_nop 0
    ds_read_b128 v[112:115], v118 offset:37632
    v_cvt_pk_bf16_f32 v64, v64, v65
    v_accvgpr_write_b32 a236, v64
    v_cvt_pk_bf16_f32 v66, v66, v67
    v_accvgpr_write_b32 a237, v66
    v_cvt_pk_bf16_f32 v228, v60, v61
    v_mfma_f32_16x16x16_bf16 v[72:75], v[102:103], v[94:95], v[84:87]
    ds_read_b64 v[116:117], v101 offset:37696
    v_cvt_pk_bf16_f32 v229, v62, v63
    v_mfma_f32_16x16x16_bf16 v[64:67], v[104:105], v[94:95], v[84:87]
    ds_read_b128 v[140:143], v100 offset:5184
    v_cvt_pk_bf16_f32 v252, v108, v109
    v_mfma_f32_16x16x16_bf16 v[60:63], v[106:107], v[94:95], v[84:87]
    ds_read_b128 v[102:105], v118 offset:0
    v_cvt_pk_bf16_f32 v253, v110, v111
    v_cvt_pk_bf16_f32 v72, v72, v73
    v_accvgpr_write_b32 a238, v72
    v_cvt_pk_bf16_f32 v74, v74, v75
    v_accvgpr_write_b32 a239, v74
    v_cvt_pk_bf16_f32 v230, v64, v65
    v_cvt_pk_bf16_f32 v231, v66, v67
    v_cvt_pk_bf16_f32 v254, v60, v61
    v_cvt_pk_bf16_f32 v255, v62, v63
    ds_read_b64 v[106:107], v101 offset:64
    v_rcp_f32 v44, v44
    s_waitcnt lgkmcnt(5)
    v_mfma_f32_16x16x16_bf16 v[60:63], v[88:89], v[94:95], v[80:83]
    ds_read_b128 v[64:67], v100 offset:0
    v_mul_f32 v12, v12, v44
    v_mfma_f32_16x16x16_bf16 v[72:75], v[90:91], v[94:95], v[80:83]
    ds_read_b128 v[88:91], v118 offset:768
    v_mul_f32 v13, v13, v44
    v_mfma_f32_16x16x16_bf16 v[108:111], v[92:93], v[94:95], v[80:83]
    s_waitcnt lgkmcnt(4)
    ds_read_b64 v[92:93], v101 offset:832
    v_cvt_pk_bf16_f32 v60, v60, v61
    v_accvgpr_write_b32 a228, v60
    v_cvt_pk_bf16_f32 v62, v62, v63
    v_accvgpr_write_b32 a229, v62
    v_cvt_pk_bf16_f32 v72, v72, v73
    v_mfma_f32_16x16x16_bf16 v[84:87], v[112:113], v[94:95], v[140:143]
    ds_read_b128 v[80:83], v100 offset:64
    v_accvgpr_write_b32 a252, v72
    v_mfma_f32_16x16x16_bf16 v[60:63], v[114:115], v[94:95], v[140:143]
    v_cvt_pk_bf16_f32 v74, v74, v75
    v_accvgpr_write_b32 a253, v74
    v_mfma_f32_16x16x16_bf16 v[72:75], v[116:117], v[94:95], v[140:143]
    v_cvt_pk_bf16_f32 v244, v108, v109
    v_cvt_pk_bf16_f32 v245, v110, v111
    v_cvt_pk_bf16_f32 v84, v84, v85
    v_accvgpr_write_b32 a230, v84
    v_cvt_pk_bf16_f32 v86, v86, v87
    v_accvgpr_write_b32 a231, v86
    v_cvt_pk_bf16_f32 v60, v60, v61
    v_accvgpr_write_b32 a254, v60
    v_cvt_pk_bf16_f32 v62, v62, v63
    v_accvgpr_write_b32 a255, v62
    v_cvt_pk_bf16_f32 v246, v72, v73
    s_waitcnt lgkmcnt(3)
    v_mfma_f32_16x16x16_bf16 v[60:63], v[102:103], v[94:95], v[64:67]
    v_cvt_pk_bf16_f32 v247, v74, v75
    v_cvt_pk_bf16_f32 v12, v12, v13
    v_mfma_f32_16x16x16_bf16 v[100:103], v[104:105], v[94:95], v[64:67]
    s_waitcnt vmcnt(5) lgkmcnt(1)
    ds_write_b32 v135, v12 offset:1536
    v_mfma_f32_16x16x16_bf16 v[84:87], v[106:107], v[94:95], v[64:67]
    s_waitcnt lgkmcnt(1)
    s_barrier
    v_cvt_pk_bf16_f32 v60, v60, v61
    v_accvgpr_write_b32 a216, v60
    v_cvt_pk_bf16_f32 v62, v62, v63
    v_accvgpr_write_b32 a217, v62
    v_cvt_pk_bf16_f32 v100, v100, v101
    v_accvgpr_write_b32 a240, v100
    v_mfma_f32_16x16x16_bf16 v[72:75], v[88:89], v[94:95], v[80:83]
    ds_read_b128 v[60:63], v122 offset:14848
    v_cvt_pk_bf16_f32 v102, v102, v103
    v_mfma_f32_16x16x16_bf16 v[64:67], v[90:91], v[94:95], v[80:83]
    ds_write_b128 v121, v[68:71] offset:6144
    v_mfma_f32_16x16x16_bf16 v[68:71], v[92:93], v[94:95], v[80:83]
    v_accvgpr_write_b32 a241, v102
    v_cvt_pk_bf16_f32 v232, v84, v85
    v_cvt_pk_bf16_f32 v233, v86, v87
    v_cvt_pk_bf16_f32 v72, v72, v73
    v_accvgpr_write_b32 a218, v72
    v_cvt_pk_bf16_f32 v74, v74, v75
    ds_write_b128 v97, v[76:79]
    v_accvgpr_write_b32 a219, v74
    v_cvt_pk_bf16_f32 v64, v64, v65
    v_accvgpr_write_b32 a242, v64
    v_cvt_pk_bf16_f32 v66, v66, v67
    v_accvgpr_write_b32 a243, v66
    v_cvt_pk_bf16_f32 v234, v68, v69
    v_cvt_pk_bf16_f32 v235, v70, v71
    v_mul_f32 v14, v14, v44
    ds_write2_b64 v97, v[16:17], v[16:17] offset0:2 offset1:3
    s_waitcnt lgkmcnt(2)
    v_or3_b32 v60, v60, v61, v62
    v_or_b32 v60, v60, v63
    v_mul_f32 v15, v15, v44
    v_readfirstlane_b32 s75, v60
    v_cvt_pk_bf16_f32 v13, v14, v15
    v_mul_f32 v52, v52, v44
    v_mul_f32 v53, v53, v44
    v_cvt_pk_bf16_f32 v14, v52, v53
    ds_write_b128 v97, v[56:59] offset:32
    v_mul_f32 v54, v54, v44
    v_mul_f32 v55, v55, v44
    v_cvt_pk_bf16_f32 v15, v54, v55
    v_mul_f32 v48, v48, v44
    v_mul_f32 v49, v49, v44
    v_cvt_pk_bf16_f32 v154, v48, v49
    v_mul_f32 v50, v50, v44
    v_mul_f32 v51, v51, v44
    ds_write2_b64 v97, v[42:43], v[16:17] offset0:6 offset1:7
    v_cvt_pk_bf16_f32 v155, v50, v51
    v_exp_f32 v36, v36
    v_exp_f32 v37, v37
    v_exp_f32 v38, v38
    v_exp_f32 v39, v39
    ds_write2_b64 v97, v[16:17], v[40:41] offset0:8 offset1:9
    v_cvt_pk_bf16_f32 v16, v36, v37
    v_cvt_pk_bf16_f32 v17, v38, v39
    v_exp_f32 v32, v32
    v_exp_f32 v33, v33
    v_exp_f32 v34, v34
    ds_write_b64 v97, v[18:19] offset:88
    v_exp_f32 v35, v35
    v_cvt_pk_bf16_f32 v18, v32, v33
    v_cvt_pk_bf16_f32 v19, v34, v35
    v_exp_f32 v24, v24
    ds_write_b64 v120, v[98:99] offset:80
    v_exp_f32 v25, v25
    v_exp_f32 v26, v26
    v_exp_f32 v27, v27
    ds_write_b128 v120, v[28:31] offset:96
    v_cvt_pk_bf16_f32 v168, v24, v25
    v_cvt_pk_bf16_f32 v169, v26, v27
    v_exp_f32 v10, v10
    s_nop 0
    v_cvt_pk_bf16_f32 v170, v10, 0
    v_mfma_f32_16x16x32_bf16 v[36:39], v[220:223], v[16:19], 0
    ds_read_b128 v[84:87], v137 offset:0
    v_mfma_f32_16x16x32_bf16 v[36:39], v[220:223], v[168:171], v[36:39]
    ds_read_b128 v[108:111], v136 offset:0
    v_mfma_f32_16x16x32_bf16 v[64:67], v[0:3], v[16:19], 0
    ds_read_b128 v[8:11], v137 offset:128
    v_mfma_f32_16x16x32_bf16 v[64:67], v[164:167], v[168:171], v[64:67]
    ds_read_b128 v[112:115], v136 offset:128
    v_mfma_f32_16x16x32_bf16 v[0:3], v[20:23], v[16:19], 0
    ds_read_b128 v[40:43], v137 offset:256
    v_mfma_f32_16x16x32_bf16 v[0:3], v[160:163], v[168:171], v[0:3]
    ds_read_b128 v[52:55], v136 offset:256
    v_mfma_f32_16x16x32_bf16 v[146:149], v[4:7], v[16:19], 0
    ds_read_b128 v[68:71], v137 offset:1536
    v_mfma_f32_16x16x32_bf16 v[146:149], v[156:159], v[168:171], v[146:149]
    s_waitcnt lgkmcnt(6)
    ds_read_b128 v[60:63], v136 offset:1536
    ds_read_b128 v[98:101], v137 offset:1664
    v_mfma_f32_16x16x32_bf16 v[28:31], a[0:3], v[84:87], 0
    ds_read_b128 v[104:107], v136 offset:1792
    s_waitcnt lgkmcnt(0)
    s_cmp_lg_u32 s75, 0
    s_cbranch_scc0 L_loopF0
    s_branch L_slow
L_bndF:
    s_movk_i32 s73, 20
    s_movk_i32 s71, 18
    s_movk_i32 s70, -20
    s_mov_b32 s74, 0
    s_cmp_lt_u32 s2, 252
    s_cbranch_scc1 L_bndcF
    s_sub_u32 s94, s2, 252
    s_mul_i32 s69, s94, 18
    s_mov_b32 s74, 2
    s_sub_u32 s93, s93, 1373568
    v_cmp_le_u32 vcc, 4, v4
    v_add_u32 v0, 98896896, v128
    v_subrev_u32 v1, 1373568, v128
    v_cndmask_b32 v128, v0, v1, vcc
    v_cmp_le_u32 vcc, 4, v71
    v_add_u32 v0, 98896896, v127
    v_subrev_u32 v1, 1373568, v127
    v_cndmask_b32 v127, v0, v1, vcc
    v_cmp_le_u32 vcc, 4, v2
    v_add_u32 v0, 98896896, v126
    v_subrev_u32 v1, 1373568, v126
    v_cndmask_b32 v126, v0, v1, vcc
    v_cmp_le_u32 vcc, 4, v5
    v_add_u32 v0, 98896896, v125
    v_subrev_u32 v1, 1373568, v125
    v_cndmask_b32 v125, v0, v1, vcc
    v_cmp_le_u32 vcc, 4, v7
    v_add_u32 v0, 98896896, v124
    v_subrev_u32 v1, 1373568, v124
    v_cndmask_b32 v124, v0, v1, vcc
    s_cmp_lt_u32 s2, 256
    s_cbranch_scc1 L_bndrF
L_bndcF:
    s_sub_u32 s94, s2, 248
    s_mul_i32 s69, s94, 20
    s_lshr_b32 s71, s94, 1
    s_sub_u32 s69, s69, s71
    s_and_b32 s94, s94, 1
    s_sub_u32 s71, 20, s94
    s_cmp_eq_u32 s2, 251
    s_cselect_b32 s71, 13, s71
    s_mov_b32 s62, 1373568
    s_add_u32 s74, s74, 1
    s_sub_u32 s93, s93, 2688
    v_mad_i32_i24 v0, v4, -7, v68
    v_cmp_le_u32 vcc, 4, v0
    v_add_u32 v0, 193536, v128
    v_subrev_u32 v1, 2688, v128
    v_cndmask_b32 v128, v0, v1, vcc
    v_mad_i32_i24 v0, v71, -7, v103
    v_cmp_le_u32 vcc, 4, v0
    v_add_u32 v0, 193536, v127
    v_subrev_u32 v1, 2688, v127
    v_cndmask_b32 v127, v0, v1, vcc
    v_mad_i32_i24 v0, v2, -7, v129
    v_cmp_le_u32 vcc, 4, v0
    v_add_u32 v0, 193536, v126
    v_subrev_u32 v1, 2688, v126
    v_cndmask_b32 v126, v0, v1, vcc
    v_mad_i32_i24 v0, v5, -7, v130
    v_cmp_le_u32 vcc, 4, v0
    v_add_u32 v0, 193536, v125
    v_subrev_u32 v1, 2688, v125
    v_cndmask_b32 v125, v0, v1, vcc
    v_mad_i32_i24 v0, v7, -7, v18
    v_cmp_le_u32 vcc, 4, v0
    v_add_u32 v0, 193536, v124
    v_subrev_u32 v1, 2688, v124
    v_cndmask_b32 v124, v0, v1, vcc
    s_cmp_eq_u32 s2, 256
    s_cselect_b32 s62, 0, s62
    s_cselect_b32 s69, 0, s69
    s_cselect_b32 s71, 2, s71
    s_branch L_bndrF
L_maskF:
    s_and_b32 s20, s74, 2
    s_and_b32 s21, s74, 1
    s_mov_b32 s22, 0xc31044fe
    v_lshrrev_b32 v29, 2, v105
    v_add_u32 v29, 0, v29
    v_mul_u32_u24 v144, 37, v29
    v_lshrrev_b32 v107, 8, v144
    v_mad_i32_i24 v107, v107, -7, v29
    v_lshrrev_b32 v144, 10, v144
    v_lshrrev_b32 v107, 2, v107
    v_mul_u32_u24 v144, s20, v144
    v_mad_u32_u24 v29, v107, s21, v144
    v_cvt_f32_u32 v29, v29
    v_lshrrev_b32 v139, 2, v105
    v_add_u32 v139, 4, v139
    v_mul_u32_u24 v144, 37, v139
    v_lshrrev_b32 v107, 8, v144
    v_mad_i32_i24 v107, v107, -7, v139
    v_lshrrev_b32 v144, 10, v144
    v_lshrrev_b32 v107, 2, v107
    v_mul_u32_u24 v144, s20, v144
    v_mad_u32_u24 v139, v107, s21, v144
    v_cvt_f32_u32 v139, v139
    v_lshrrev_b32 v103, 2, v105
    v_add_u32 v103, 8, v103
    v_mul_u32_u24 v144, 37, v103
    v_lshrrev_b32 v107, 8, v144
    v_mad_i32_i24 v107, v107, -7, v103
    v_lshrrev_b32 v144, 10, v144
    v_lshrrev_b32 v107, 2, v107
    v_mul_u32_u24 v144, s20, v144
    v_mad_u32_u24 v103, v107, s21, v144
    v_cvt_f32_u32 v103, v103
    v_mad_u32_u24 v138, v102, 12, 0
    v_mul_u32_u24 v144, 37, v138
    v_lshrrev_b32 v107, 8, v144
    v_mad_i32_i24 v107, v107, -7, v138
    v_lshrrev_b32 v144, 10, v144
    v_lshrrev_b32 v107, 2, v107
    v_mul_u32_u24 v144, s20, v144
    v_mad_u32_u24 v138, v107, s21, v144
    v_cvt_f32_u32 v138, v138
    v_sub_f32 v144, v29, v138
    v_mul_f32 v144, v144, v144 clamp
    v_fmac_f32 v204, s22, v144
    v_sub_f32 v144, v139, v138
    v_mul_f32 v144, v144, v144 clamp
    v_fmac_f32 v192, s22, v144
    v_sub_f32 v144, v103, v138
    v_mul_f32 v144, v144, v144 clamp
    v_fmac_f32 v180, s22, v144
    v_mad_u32_u24 v138, v102, 12, 1
    v_mul_u32_u24 v144, 37, v138
    v_lshrrev_b32 v107, 8, v144
    v_mad_i32_i24 v107, v107, -7, v138
    v_lshrrev_b32 v144, 10, v144
    v_lshrrev_b32 v107, 2, v107
    v_mul_u32_u24 v144, s20, v144
    v_mad_u32_u24 v138, v107, s21, v144
    v_cvt_f32_u32 v138, v138
    v_sub_f32 v144, v29, v138
    v_mul_f32 v144, v144, v144 clamp
    v_fmac_f32 v205, s22, v144
    v_sub_f32 v144, v139, v138
    v_mul_f32 v144, v144, v144 clamp
    v_fmac_f32 v193, s22, v144
    v_sub_f32 v144, v103, v138
    v_mul_f32 v144, v144, v144 clamp
    v_fmac_f32 v181, s22, v144
    v_mad_u32_u24 v138, v102, 12, 2
    v_mul_u32_u24 v144, 37, v138
    v_lshrrev_b32 v107, 8, v144
    v_mad_i32_i24 v107, v107, -7, v138
    v_lshrrev_b32 v144, 10, v144
    v_lshrrev_b32 v107, 2, v107
    v_mul_u32_u24 v144, s20, v144
    v_mad_u32_u24 v138, v107, s21, v144
    v_cvt_f32_u32 v138, v138
    v_sub_f32 v144, v29, v138
    v_mul_f32 v144, v144, v144 clamp
    v_fmac_f32 v206, s22, v144
    v_sub_f32 v144, v139, v138
    v_mul_f32 v144, v144, v144 clamp
    v_fmac_f32 v194, s22, v144
    v_sub_f32 v144, v103, v138
    v_mul_f32 v144, v144, v144 clamp
    v_fmac_f32 v182, s22, v144
    v_mad_u32_u24 v138, v102, 12, 3
    v_mul_u32_u24 v144, 37, v138
    v_lshrrev_b32 v107, 8, v144
    v_mad_i32_i24 v107, v107, -7, v138
    v_lshrrev_b32 v144, 10, v144
    v_lshrrev_b32 v107, 2, v107
    v_mul_u32_u24 v144, s20, v144
    v_mad_u32_u24 v138, v107, s21, v144
    v_cvt_f32_u32 v138, v138
    v_sub_f32 v144, v29, v138
    v_mul_f32 v144, v144, v144 clamp
    v_fmac_f32 v207, s22, v144
    v_sub_f32 v144, v139, v138
    v_mul_f32 v144, v144, v144 clamp
    v_fmac_f32 v195, s22, v144
    v_sub_f32 v144, v103, v138
    v_mul_f32 v144, v144, v144 clamp
    v_fmac_f32 v183, s22, v144
    v_mad_u32_u24 v138, v102, 12, 4
    v_mul_u32_u24 v144, 37, v138
    v_lshrrev_b32 v107, 8, v144
    v_mad_i32_i24 v107, v107, -7, v138
    v_lshrrev_b32 v144, 10, v144
    v_lshrrev_b32 v107, 2, v107
    v_mul_u32_u24 v144, s20, v144
    v_mad_u32_u24 v138, v107, s21, v144
    v_cvt_f32_u32 v138, v138
    v_sub_f32 v144, v29, v138
    v_mul_f32 v144, v144, v144 clamp
    v_fmac_f32 v200, s22, v144
    v_sub_f32 v144, v139, v138
    v_mul_f32 v144, v144, v144 clamp
    v_fmac_f32 v188, s22, v144
    v_sub_f32 v144, v103, v138
    v_mul_f32 v144, v144, v144 clamp
    v_fmac_f32 v176, s22, v144
    v_mad_u32_u24 v138, v102, 12, 5
    v_mul_u32_u24 v144, 37, v138
    v_lshrrev_b32 v107, 8, v144
    v_mad_i32_i24 v107, v107, -7, v138
    v_lshrrev_b32 v144, 10, v144
    v_lshrrev_b32 v107, 2, v107
    v_mul_u32_u24 v144, s20, v144
    v_mad_u32_u24 v138, v107, s21, v144
    v_cvt_f32_u32 v138, v138
    v_sub_f32 v144, v29, v138
    v_mul_f32 v144, v144, v144 clamp
    v_fmac_f32 v201, s22, v144
    v_sub_f32 v144, v139, v138
    v_mul_f32 v144, v144, v144 clamp
    v_fmac_f32 v189, s22, v144
    v_sub_f32 v144, v103, v138
    v_mul_f32 v144, v144, v144 clamp
    v_fmac_f32 v177, s22, v144
    v_mad_u32_u24 v138, v102, 12, 6
    v_mul_u32_u24 v144, 37, v138
    v_lshrrev_b32 v107, 8, v144
    v_mad_i32_i24 v107, v107, -7, v138
    v_lshrrev_b32 v144, 10, v144
    v_lshrrev_b32 v107, 2, v107
    v_mul_u32_u24 v144, s20, v144
    v_mad_u32_u24 v138, v107, s21, v144
    v_cvt_f32_u32 v138, v138
    v_sub_f32 v144, v29, v138
    v_mul_f32 v144, v144, v144 clamp
    v_fmac_f32 v202, s22, v144
    v_sub_f32 v144, v139, v138
    v_mul_f32 v144, v144, v144 clamp
    v_fmac_f32 v190, s22, v144
    v_sub_f32 v144, v103, v138
    v_mul_f32 v144, v144, v144 clamp
    v_fmac_f32 v178, s22, v144
    v_mad_u32_u24 v138, v102, 12, 7
    v_mul_u32_u24 v144, 37, v138
    v_lshrrev_b32 v107, 8, v144
    v_mad_i32_i24 v107, v107, -7, v138
    v_lshrrev_b32 v144, 10, v144
    v_lshrrev_b32 v107, 2, v107
    v_mul_u32_u24 v144, s20, v144
    v_mad_u32_u24 v138, v107, s21, v144
    v_cvt_f32_u32 v138, v138
    v_sub_f32 v144, v29, v138
    v_mul_f32 v144, v144, v144 clamp
    v_fmac_f32 v203, s22, v144
    v_sub_f32 v144, v139, v138
    v_mul_f32 v144, v144, v144 clamp
    v_fmac_f32 v191, s22, v144
    v_sub_f32 v144, v103, v138
    v_mul_f32 v144, v144, v144 clamp
    v_fmac_f32 v179, s22, v144
    v_mad_u32_u24 v138, v102, 12, 8
    v_mul_u32_u24 v144, 37, v138
    v_lshrrev_b32 v107, 8, v144
    v_mad_i32_i24 v107, v107, -7, v138
    v_lshrrev_b32 v144, 10, v144
    v_lshrrev_b32 v107, 2, v107
    v_mul_u32_u24 v144, s20, v144
    v_mad_u32_u24 v138, v107, s21, v144
    v_cvt_f32_u32 v138, v138
    v_sub_f32 v144, v29, v138
    v_mul_f32 v144, v144, v144 clamp
    v_fmac_f32 v196, s22, v144
    v_sub_f32 v144, v139, v138
    v_mul_f32 v144, v144, v144 clamp
    v_fmac_f32 v184, s22, v144
    v_sub_f32 v144, v103, v138
    v_mul_f32 v144, v144, v144 clamp
    v_fmac_f32 v172, s22, v144
    v_mad_u32_u24 v138, v102, 12, 9
    v_mul_u32_u24 v144, 37, v138
    v_lshrrev_b32 v107, 8, v144
    v_mad_i32_i24 v107, v107, -7, v138
    v_lshrrev_b32 v144, 10, v144
    v_lshrrev_b32 v107, 2, v107
    v_mul_u32_u24 v144, s20, v144
    v_mad_u32_u24 v138, v107, s21, v144
    v_cvt_f32_u32 v138, v138
    v_sub_f32 v144, v29, v138
    v_mul_f32 v144, v144, v144 clamp
    v_fmac_f32 v197, s22, v144
    v_sub_f32 v144, v139, v138
    v_mul_f32 v144, v144, v144 clamp
    v_fmac_f32 v185, s22, v144
    v_sub_f32 v144, v103, v138
    v_mul_f32 v144, v144, v144 clamp
    v_fmac_f32 v173, s22, v144
    v_mad_u32_u24 v138, v102, 12, 10
    v_mul_u32_u24 v144, 37, v138
    v_lshrrev_b32 v107, 8, v144
    v_mad_i32_i24 v107, v107, -7, v138
    v_lshrrev_b32 v144, 10, v144
    v_lshrrev_b32 v107, 2, v107
    v_mul_u32_u24 v144, s20, v144
    v_mad_u32_u24 v138, v107, s21, v144
    v_cvt_f32_u32 v138, v138
    v_sub_f32 v144, v29, v138
    v_mul_f32 v144, v144, v144 clamp
    v_fmac_f32 v198, s22, v144
    v_sub_f32 v144, v139, v138
    v_mul_f32 v144, v144, v144 clamp
    v_fmac_f32 v186, s22, v144
    v_sub_f32 v144, v103, v138
    v_mul_f32 v144, v144, v144 clamp
    v_fmac_f32 v174, s22, v144
    v_mad_u32_u24 v138, v102, 12, 11
    v_mul_u32_u24 v144, 37, v138
    v_lshrrev_b32 v107, 8, v144
    v_mad_i32_i24 v107, v107, -7, v138
    v_lshrrev_b32 v144, 10, v144
    v_lshrrev_b32 v107, 2, v107
    v_mul_u32_u24 v144, s20, v144
    v_mad_u32_u24 v138, v107, s21, v144
    v_cvt_f32_u32 v138, v138
    v_sub_f32 v144, v29, v138
    v_mul_f32 v144, v144, v144 clamp
    v_fmac_f32 v199, s22, v144
    v_sub_f32 v144, v139, v138
    v_mul_f32 v144, v144, v144 clamp
    v_fmac_f32 v187, s22, v144
    v_sub_f32 v144, v103, v138
    v_mul_f32 v144, v144, v144 clamp
    v_fmac_f32 v175, s22, v144
    v_cvt_f32_u32 v138, s74
    v_sub_f32 v144, v29, v138
    v_mul_f32 v144, v144, v144 clamp
    v_fmac_f32 v208, s22, v144
    v_sub_f32 v144, v139, v138
    v_mul_f32 v144, v144, v144 clamp
    v_fmac_f32 v209, s22, v144
    v_sub_f32 v144, v103, v138
    v_mul_f32 v144, v144, v144 clamp
    v_fmac_f32 v210, s22, v144
    v_lshrrev_b32 v29, 2, v105
    v_lshl_add_u32 v29, v102, 2, v29
    v_add_u32 v144, 1, v102
    v_lshrrev_b32 v144, 2, v144
    v_mad_u32_u24 v29, v144, 36, v29
    v_min_u32 v29, 48, v29
    v_mul_u32_u24 v144, 37, v29
    v_lshrrev_b32 v107, 8, v144
    v_mad_i32_i24 v107, v107, -7, v29
    v_lshrrev_b32 v144, 10, v144
    v_lshrrev_b32 v107, 2, v107
    v_mul_u32_u24 v144, s20, v144
    v_mad_u32_u24 v29, v107, s21, v144
    v_cvt_f32_u32 v29, v29
    v_sub_f32 v144, v29, v138
    v_mul_f32 v144, v144, v144 clamp
    v_fmac_f32 v211, s22, v144
    s_branch L_nomaskF
.fill 115, 4, 0xbf800000
L_atomF0:
    s_cbranch_execz L_main
    v_mov_b32 v122, 0x800000
    buffer_atomic_add v122, v129, s[8:11], 0 offen sc0 sc1
    s_branch L_atomF0r
.p2align 6
L_loopF0:
    v_mfma_f32_16x16x32_bf16 v[28:31], a[4:7], v[108:111], v[28:31]
    ds_write_b32 v135, v13 offset:1540
    v_mfma_f32_16x16x32_bf16 v[28:31], a[8:11], v[8:11], v[28:31]
    v_rcp_f32 v36, v36
    v_mfma_f32_16x16x32_bf16 v[28:31], a[12:15], v[112:115], v[28:31]
    v_mul_f32 v64, v64, v36
    v_mul_f32 v65, v65, v36
    v_mfma_f32_16x16x32_bf16 v[28:31], a[16:19], v[40:43], v[28:31]
    ds_read_b128 v[76:79], v136 offset:1664
    v_cvt_pk_bf16_f32 v4, v64, v65
    v_mfma_f32_16x16x32_bf16 v[28:31], a[20:23], v[52:55], v[28:31]
    v_mul_f32 v66, v66, v36
    v_mul_f32 v67, v67, v36
    v_mfma_f32_16x16x32_bf16 v[16:19], v[84:87], a[168:171], 0
    v_cvt_pk_bf16_f32 v5, v66, v67
    v_mul_f32 v0, v0, v36
    v_mfma_f32_16x16x32_bf16 v[16:19], v[108:111], a[172:175], v[16:19]
    v_mul_f32 v1, v1, v36
    v_cvt_pk_bf16_f32 v6, v0, v1
    v_mfma_f32_16x16x32_bf16 v[16:19], v[8:11], a[176:179], v[16:19]
    ds_write_b64 v135, v[14:15] offset:1544
    v_mfma_f32_16x16x32_bf16 v[16:19], v[112:115], a[180:183], v[16:19]
    v_mul_f32 v2, v2, v36
    v_mul_f32 v3, v3, v36
    v_mfma_f32_16x16x32_bf16 v[16:19], v[40:43], a[184:187], v[16:19]
    v_cvt_pk_bf16_f32 v7, v2, v3
    v_mul_f32 v146, v146, v36
    v_mfma_f32_16x16x32_bf16 v[16:19], v[52:55], a[188:191], v[16:19]
    v_mul_f32 v147, v147, v36
    v_cvt_pk_bf16_f32 v152, v146, v147
    v_mfma_f32_16x16x32_bf16 v[12:15], a[120:123], v[84:87], 0
    ds_write_b64 v134, v[154:155] offset:1536
    v_mfma_f32_16x16x32_bf16 v[12:15], a[124:127], v[108:111], v[12:15]
    v_mul_f32 v148, v148, v36
    v_mul_f32 v149, v149, v36
    v_mfma_f32_16x16x32_bf16 v[12:15], a[128:131], v[8:11], v[12:15]
    v_cvt_pk_bf16_f32 v153, v148, v149
    v_fmac_f32 v32, v116, v116
    v_mfma_f32_16x16x32_bf16 v[12:15], a[132:135], v[112:115], v[12:15]
    ds_read_b128 v[92:95], v137 offset:1792
    v_fmac_f32 v32, v117, v117
    v_mfma_f32_16x16x32_bf16 v[12:15], a[136:139], v[40:43], v[12:15]
    v_fmac_f32 v32, v118, v118
    v_fmac_f32 v32, v119, v119
    v_mfma_f32_16x16x32_bf16 v[12:15], a[140:143], v[52:55], v[12:15]
    v_fma_f32 v154, v140, v140, s42
    v_fmac_f32 v154, v141, v141
    v_mfma_f32_16x16x32_bf16 v[0:3], a[48:51], v[84:87], 0
    v_fmac_f32 v154, v142, v142
    v_fmac_f32 v154, v143, v143
    v_mfma_f32_16x16x32_bf16 v[0:3], a[52:55], v[108:111], v[0:3]
    ds_write_b64 v135, v[4:5] offset:3072
    v_mfma_f32_16x16x32_bf16 v[0:3], a[56:59], v[8:11], v[0:3]
    v_fmac_f32 v154, v44, v44
    v_fmac_f32 v154, v45, v45
    v_mfma_f32_16x16x32_bf16 v[0:3], a[60:63], v[112:115], v[0:3]
    v_fmac_f32 v154, v46, v46
    v_fmac_f32 v154, v47, v47
    v_mfma_f32_16x16x32_bf16 v[0:3], a[64:67], v[40:43], v[0:3]
    v_fmac_f32 v154, v56, v56
    v_fmac_f32 v154, v57, v57
    v_mfma_f32_16x16x32_bf16 v[0:3], a[68:71], v[52:55], v[0:3]
    ds_write_b64 v135, v[6:7] offset:3080
    v_mfma_f32_16x16x32_bf16 v[4:7], a[24:27], v[84:87], 0
    v_fmac_f32 v154, v58, v58
    v_fmac_f32 v154, v59, v59
    v_mfma_f32_16x16x32_bf16 v[4:7], a[28:31], v[108:111], v[4:7]
    v_fma_f32 v155, v24, v24, s42
    v_fmac_f32 v155, v25, v25
    v_mfma_f32_16x16x32_bf16 v[4:7], a[32:35], v[8:11], v[4:7]
    v_fmac_f32 v155, v26, v26
    v_fmac_f32 v155, v27, v27
    v_mfma_f32_16x16x32_bf16 v[4:7], a[36:39], v[112:115], v[4:7]
    ds_write_b32 v134, v152 offset:3072
    v_mfma_f32_16x16x32_bf16 v[4:7], a[40:43], v[40:43], v[4:7]
    v_fmac_f32 v155, v88, v88
    v_fmac_f32 v155, v89, v89
    v_mfma_f32_16x16x32_bf16 v[4:7], a[44:47], v[52:55], v[4:7]
    v_fmac_f32 v155, v90, v90
    v_fmac_f32 v155, v91, v91
    v_mfma_f32_16x16x32_bf16 v[146:149], v[84:87], a[192:195], 0
    s_waitcnt vmcnt(10)
    v_fmac_f32 v155, v72, v72
    v_fmac_f32 v155, v73, v73
    v_mfma_f32_16x16x32_bf16 v[146:149], v[108:111], a[196:199], v[146:149]
    ds_write_b32 v134, v153 offset:3076
    v_mfma_f32_16x16x32_bf16 v[146:149], v[8:11], a[200:203], v[146:149]
    v_fmac_f32 v155, v74, v74
    v_fmac_f32 v155, v75, v75
    v_mfma_f32_16x16x32_bf16 v[146:149], v[112:115], a[204:207], v[146:149]
    v_cvt_pk_bf16_f32 v152, v32, v154
    v_cvt_pk_bf16_f32 v153, v155, v122
    v_mfma_f32_16x16x32_bf16 v[146:149], v[40:43], a[208:211], v[146:149]
    v_add_u32 v135, s49, v135
    v_add_u32 v134, s49, v134
    v_mfma_f32_16x16x32_bf16 v[146:149], v[52:55], a[212:215], v[146:149]
    ds_write_b64 v130, v[152:153]
    v_mfma_f32_16x16x32_bf16 v[32:35], a[72:75], v[84:87], 0
    v_cvt_pk_f16_f32 v28, v28, v29
    v_cvt_pk_f16_f32 v29, v30, v31
    v_mfma_f32_16x16x32_bf16 v[32:35], a[76:79], v[108:111], v[32:35]
    v_pk_fma_f16 v36, v28, v28, s39
    v_pk_fmac_f16 v36, v29, v29
    v_mfma_f32_16x16x32_bf16 v[32:35], a[80:83], v[8:11], v[32:35]
    v_cvt_pk_f16_f32 v154, v12, v13
    v_cvt_pk_f16_f32 v155, v14, v15
    v_mfma_f32_16x16x32_bf16 v[32:35], a[84:87], v[112:115], v[32:35]
    v_cvt_pk_f16_f32 v30, v4, v5
    v_cvt_pk_f16_f32 v31, v6, v7
    v_mfma_f32_16x16x32_bf16 v[32:35], a[88:91], v[40:43], v[32:35]
    v_pk_fmac_f16 v36, v30, v30
    v_pk_fmac_f16 v36, v31, v31
    v_mfma_f32_16x16x32_bf16 v[32:35], a[92:95], v[52:55], v[32:35]
    v_cvt_pk_bf16_f32 v4, v146, v147
    v_cvt_pk_bf16_f32 v5, v148, v149
    v_mfma_f32_16x16x32_bf16 v[146:149], a[96:99], v[84:87], 0
    v_cvt_pk_f16_f32 v152, v0, v1
    v_cvt_pk_f16_f32 v153, v2, v3
    v_mfma_f32_16x16x32_bf16 v[146:149], a[100:103], v[108:111], v[146:149]
    s_waitcnt lgkmcnt(0)
    v_pk_fmac_f16 v36, v152, v152
    v_pk_fmac_f16 v36, v153, v153
    v_mfma_f32_16x16x32_bf16 v[146:149], a[104:107], v[8:11], v[146:149]
    s_barrier
    ds_read_b128 v[0:3], v129 offset:0
    v_cvt_pk_f16_f32 v12, v32, v33
    v_mfma_f32_16x16x32_bf16 v[146:149], a[108:111], v[112:115], v[146:149]
    ds_read_b128 v[64:67], v129 offset:1024
    v_cvt_pk_f16_f32 v13, v34, v35
    v_mfma_f32_16x16x32_bf16 v[146:149], a[112:115], v[40:43], v[146:149]
    v_pk_fma_f16 v37, v12, v12, s39
    v_pk_fmac_f16 v37, v13, v13
    v_mfma_f32_16x16x32_bf16 v[146:149], a[116:119], v[52:55], v[146:149]
    s_nop 1
    v_mfma_f32_16x16x32_bf16 v[32:35], v[84:87], a[144:147], 0
    s_nop 2
    v_mfma_f32_16x16x32_bf16 v[32:35], v[108:111], a[148:151], v[32:35]
    s_nop 0
    v_cvt_pk_f16_f32 v14, v146, v147
    v_cvt_pk_f16_f32 v15, v148, v149
    v_mfma_f32_16x16x32_bf16 v[32:35], v[8:11], a[152:155], v[32:35]
    v_pk_fmac_f16 v37, v14, v14
    v_pk_fmac_f16 v37, v15, v15
    v_mfma_f32_16x16x32_bf16 v[32:35], v[112:115], a[156:159], v[32:35]
    v_pk_fmac_f16 v37, v154, v154
    v_pk_fmac_f16 v37, v155, v155
    v_mfma_f32_16x16x32_bf16 v[32:35], v[40:43], a[160:163], v[32:35]
    v_mfma_f32_16x16x32_bf16 v[32:35], v[52:55], a[164:167], v[32:35]
    s_waitcnt lgkmcnt(1)
    v_readfirstlane_b32 s12, v1
    v_mfma_f32_16x16x32_bf16 v[84:87], v[216:219], v[0:3], 0
    s_waitcnt lgkmcnt(0)
    s_nop 1
    v_mfma_f32_16x16x32_bf16 v[84:87], v[216:219], v[64:67], v[84:87]
    s_lshr_b32 s12, s12, 23
    v_cvt_pk_bf16_f32 v0, v32, v33
    v_cvt_pk_bf16_f32 v1, v34, v35
    v_mfma_f32_16x16x32_bf16 v[32:35], a[96:99], v[68:71], 0
    s_nop 1
    v_mfma_f32_16x16x32_bf16 v[32:35], a[100:103], v[60:63], v[32:35]
    s_nop 0
    v_rsq_f32 v84, v84
    v_mfma_f32_16x16x32_bf16 v[32:35], a[104:107], v[98:101], v[32:35]
    v_rsq_f32 v85, v85
    v_mfma_f32_16x16x32_bf16 v[32:35], a[108:111], v[76:79], v[32:35]
    v_rsq_f32 v86, v86
    v_mfma_f32_16x16x32_bf16 v[32:35], a[112:115], v[92:95], v[32:35]
    v_mul_f32 v84, s43, v84
    v_mul_f32 v85, s43, v85
    v_mfma_f32_16x16x32_bf16 v[32:35], a[116:119], v[104:107], v[32:35]
    v_mul_f32 v86, s43, v86
    v_mul_f32 v140, v140, v85
    v_mfma_f32_16x16x32_bf16 v[40:43], v[68:71], a[168:171], 0
    s_nop 0
    v_mul_f32 v141, v141, v85
    v_cvt_pk_bf16_f32 v52, v140, v141
    v_mfma_f32_16x16x32_bf16 v[40:43], v[60:63], a[172:175], v[40:43]
    s_nop 0
    v_cvt_pk_f16_f32 v10, v32, v33
    v_cvt_pk_f16_f32 v11, v34, v35
    v_mfma_f32_16x16x32_bf16 v[40:43], v[98:101], a[176:179], v[40:43]
    v_mul_f32 v142, v142, v85
    v_mul_f32 v143, v143, v85
    v_mfma_f32_16x16x32_bf16 v[40:43], v[76:79], a[180:183], v[40:43]
    v_cvt_pk_bf16_f32 v53, v142, v143
    v_mul_f32 v44, v44, v85
    v_mfma_f32_16x16x32_bf16 v[40:43], v[92:95], a[184:187], v[40:43]
    ds_write_b32 v135, v52 offset:1536
    v_mfma_f32_16x16x32_bf16 v[40:43], v[104:107], a[188:191], v[40:43]
    v_mul_f32 v45, v45, v85
    v_cvt_pk_bf16_f32 v54, v44, v45
    v_mfma_f32_16x16x32_bf16 v[140:143], a[24:27], v[68:71], 0
    s_nop 0
    v_mul_f32 v46, v46, v85
    v_mul_f32 v47, v47, v85
    v_mfma_f32_16x16x32_bf16 v[140:143], a[28:31], v[60:63], v[140:143]
    s_nop 0
    v_cvt_pk_bf16_f32 v22, v40, v41
    v_cvt_pk_bf16_f32 v23, v42, v43
    v_mfma_f32_16x16x32_bf16 v[140:143], a[32:35], v[98:101], v[140:143]
    v_cvt_pk_bf16_f32 v55, v46, v47
    v_mul_f32 v56, v56, v85
    v_mfma_f32_16x16x32_bf16 v[140:143], a[36:39], v[76:79], v[140:143]
    ds_write_b64 v135, v[54:55] offset:1544
    v_mfma_f32_16x16x32_bf16 v[140:143], a[40:43], v[92:95], v[140:143]
    s_sub_u32 s50, s45, s44
    v_mul_f32 v57, v57, v85
    v_cvt_pk_bf16_f32 v38, v56, v57
    v_mfma_f32_16x16x32_bf16 v[140:143], a[44:47], v[104:107], v[140:143]
    s_sub_u32 s51, s46, s47
    v_mul_f32 v58, v58, v85
    v_mul_f32 v59, v59, v85
    v_mfma_f32_16x16x32_bf16 v[32:35], a[72:75], v[68:71], 0
    s_mov_b32 s60, s59
    v_cvt_pk_bf16_f32 v39, v58, v59
    v_mul_f32 v48, v48, v84
    v_mfma_f32_16x16x32_bf16 v[32:35], a[76:79], v[60:63], v[32:35]
    s_mov_b32 s59, s58
    ds_write_b32 v134, v39 offset:1540
    v_mfma_f32_16x16x32_bf16 v[32:35], a[80:83], v[98:101], v[32:35]
    s_mov_b32 s58, s57
    v_mul_f32 v49, v49, v84
    v_cvt_pk_bf16_f32 v64, v48, v49
    v_mfma_f32_16x16x32_bf16 v[32:35], a[84:87], v[76:79], v[32:35]
    s_mov_b32 s57, s56
    v_mul_f32 v50, v50, v84
    v_mul_f32 v51, v51, v84
    v_mfma_f32_16x16x32_bf16 v[32:35], a[88:91], v[92:95], v[32:35]
    s_mov_b32 s7, s6
    v_cvt_pk_bf16_f32 v65, v50, v51
    v_mul_f32 v80, v80, v84
    v_mfma_f32_16x16x32_bf16 v[32:35], a[92:95], v[104:107], v[32:35]
    s_mov_b32 s6, s5
    ds_write_b32 v135, v53 offset:1540
    v_mfma_f32_16x16x32_bf16 v[146:149], a[48:51], v[68:71], 0
    s_mov_b32 s5, s4
    v_mul_f32 v81, v81, v84
    v_cvt_pk_bf16_f32 v66, v80, v81
    v_mfma_f32_16x16x32_bf16 v[146:149], a[52:55], v[60:63], v[146:149]
    s_sub_u32 s14, s6, s7
    v_cvt_pk_f16_f32 v8, v32, v33
    v_cvt_pk_f16_f32 v9, v34, v35
    v_mfma_f32_16x16x32_bf16 v[146:149], a[56:59], v[98:101], v[146:149]
    s_add_u32 s61, s61, 1
    ds_read_b128 v[32:35], v137 offset:3328
    v_pk_fma_f16 v39, v8, v8, s39
    v_mfma_f32_16x16x32_bf16 v[146:149], a[60:63], v[76:79], v[146:149]
    s_add_u32 s12, s12, 20
    ds_read_b128 v[40:43], v137 offset:3200
    v_pk_fmac_f16 v39, v9, v9
    v_mfma_f32_16x16x32_bf16 v[146:149], a[64:67], v[92:95], v[146:149]
    s_max_u32 s12, s12, s61
    ds_read_b128 v[48:51], v136 offset:3200
    v_pk_fmac_f16 v39, v10, v10
    v_mfma_f32_16x16x32_bf16 v[146:149], a[68:71], v[104:107], v[146:149]
    s_cmp_lt_u32 s61, s71
    ds_read_b128 v[44:47], v136 offset:3328
    v_pk_fmac_f16 v39, v11, v11
    v_mfma_f32_16x16x32_bf16 v[108:111], a[120:123], v[68:71], 0
    s_cselect_b32 s15, s61, s12
    ds_read_b128 v[52:55], v136 offset:3072
    v_mul_f32 v82, v82, v84
    v_mfma_f32_16x16x32_bf16 v[108:111], a[124:127], v[60:63], v[108:111]
    s_cselect_b32 s56, s69, s70
    v_cvt_pk_f16_f32 v146, v146, v147
    v_cvt_pk_f16_f32 v147, v148, v149
    v_mfma_f32_16x16x32_bf16 v[108:111], a[128:131], v[98:101], v[108:111]
    s_add_u32 s56, s56, s15
    v_mul_f32 v83, v83, v84
    v_cvt_pk_bf16_f32 v67, v82, v83
    v_mfma_f32_16x16x32_bf16 v[108:111], a[132:135], v[76:79], v[108:111]
    s_mul_i32 s53, s56, 58255
    v_mul_f32 v116, v116, v84
    v_mul_f32 v117, v117, v84
    v_mfma_f32_16x16x32_bf16 v[108:111], a[136:139], v[92:95], v[108:111]
    s_lshr_b32 s53, s53, 22
    ds_write_b32 v134, v38 offset:1536
    v_mfma_f32_16x16x32_bf16 v[108:111], a[140:143], v[104:107], v[108:111]
    s_mul_i32 s53, s53, s63
    v_cvt_pk_bf16_f32 v2, v116, v117
    v_mul_f32 v118, v118, v84
    v_mfma_f32_16x16x32_bf16 v[80:83], a[0:3], v[68:71], 0
    s_mul_i32 s56, s56, s62
    v_mul_f32 v119, v119, v84
    v_cvt_pk_bf16_f32 v3, v118, v119
    v_mfma_f32_16x16x32_bf16 v[80:83], a[4:7], v[60:63], v[80:83]
    s_add_u32 s56, s56, s53
    v_cvt_pk_f16_f32 v148, v108, v109
    v_cvt_pk_f16_f32 v149, v110, v111
    v_mfma_f32_16x16x32_bf16 v[80:83], a[8:11], v[98:101], v[80:83]
    s_mul_i32 s4, s15, 112
    ds_write_b64 v135, v[64:65] offset:0
    v_mfma_f32_16x16x32_bf16 v[80:83], a[12:15], v[76:79], v[80:83]
    s_cmp_ge_u32 s15, 16
    v_pk_fmac_f16 v39, v148, v148
    v_pk_fmac_f16 v39, v149, v149
    v_mfma_f32_16x16x32_bf16 v[80:83], a[16:19], v[92:95], v[80:83]
    s_cselect_b32 s53, -30464, 0
    v_mul_f32 v24, v24, v86
    v_mul_f32 v25, v25, v86
    v_mfma_f32_16x16x32_bf16 v[80:83], a[20:23], v[104:107], v[80:83]
    s_add_u32 s4, s4, s53
    v_cvt_pk_bf16_f32 v116, v24, v25
    v_mul_f32 v26, v26, v86
    v_mfma_f32_16x16x32_bf16 v[108:111], v[68:71], a[144:147], 0
    s_cmp_lt_u32 s15, s73
    ds_write_b64 v135, v[66:67] offset:8
    v_mfma_f32_16x16x32_bf16 v[108:111], v[60:63], a[148:151], v[108:111]
    s_cselect_b32 s26, 100270464, 0
    v_cvt_pk_f16_f32 v24, v80, v81
    v_cvt_pk_f16_f32 v25, v82, v83
    v_mfma_f32_16x16x32_bf16 v[108:111], v[98:101], a[152:155], v[108:111]
    s_cselect_b32 s56, s56, 0
    v_pk_fma_f16 v38, v24, v24, s39
    v_pk_fmac_f16 v38, v25, v25
    v_mfma_f32_16x16x32_bf16 v[108:111], v[76:79], a[156:159], v[108:111]
    s_cselect_b32 s4, s4, -1
    ds_read_b128 v[64:67], v137 offset:3072
    v_mul_f32 v27, v27, v86
    v_mfma_f32_16x16x32_bf16 v[108:111], v[92:95], a[160:163], v[108:111]
    s_cselect_b32 s15, s15, 0
    v_cvt_pk_bf16_f32 v117, v26, v27
    v_mul_f32 v88, v88, v86
    v_mfma_f32_16x16x32_bf16 v[108:111], v[104:107], a[164:167], v[108:111]
    s_cselect_b32 s13, s13, -1
    v_mul_f32 v89, v89, v86
    v_cvt_pk_bf16_f32 v118, v88, v89
    v_mfma_f32_16x16x32_bf16 v[80:83], v[68:71], a[192:195], 0
    s_bitset1_b32 s64, s15
    v_mul_f32 v90, v90, v86
    v_mul_f32 v91, v91, v86
    v_mfma_f32_16x16x32_bf16 v[80:83], v[60:63], a[196:199], v[80:83]
    s_add_u32 s65, s65, 1
    ds_write_b64 v134, v[2:3] offset:0
    v_mfma_f32_16x16x32_bf16 v[80:83], v[98:101], a[200:203], v[80:83]
    s_cmp_ge_i32 s65, 2
    v_cvt_pk_bf16_f32 v119, v90, v91
    v_mul_f32 v72, v72, v86
    v_mfma_f32_16x16x32_bf16 v[80:83], v[76:79], a[204:207], v[80:83]
    s_cselect_b32 s30, 100270464, 0
    v_mul_f32 v73, v73, v86
    v_cvt_pk_bf16_f32 v72, v72, v73
    v_mfma_f32_16x16x32_bf16 v[80:83], v[92:95], a[208:211], v[80:83]
    s_add_u32 s67, s46, s54
    v_mul_f32 v74, v74, v86
    v_mul_f32 v75, v75, v86
    v_mfma_f32_16x16x32_bf16 v[80:83], v[104:107], a[212:215], v[80:83]
    s_waitcnt lgkmcnt(1)
    ds_write_b64 v135, v[116:117] offset:3072
    v_mfma_f32_16x16x32_bf16 v[60:63], a[72:75], v[64:67], 0
    s_add_u32 m0, s67, 0
    v_cvt_pk_bf16_f32 v73, v74, v75
    v_cvt_pk_bf16_f32 v2, v108, v109
    v_mfma_f32_16x16x32_bf16 v[60:63], a[76:79], v[52:55], v[60:63]
    v_cvt_pk_bf16_f32 v3, v110, v111
    v_cvt_pk_f16_f32 v26, v140, v141
    v_mfma_f32_16x16x32_bf16 v[60:63], a[80:83], v[40:43], v[60:63]
    v_cvt_pk_f16_f32 v27, v142, v143
    v_pk_fmac_f16 v38, v26, v26
    v_mfma_f32_16x16x32_bf16 v[60:63], a[84:87], v[48:51], v[60:63]
    ds_write_b32 v135, v118 offset:3080
    v_mfma_f32_16x16x32_bf16 v[60:63], a[88:91], v[32:35], v[60:63]
    v_pk_fmac_f16 v38, v27, v27
    v_pk_fmac_f16 v38, v146, v146
    v_mfma_f32_16x16x32_bf16 v[60:63], a[92:95], v[44:47], v[60:63]
    v_pk_fmac_f16 v38, v147, v147
    v_cvt_pk_bf16_f32 v6, v80, v81
    v_mfma_f32_16x16x32_bf16 v[98:101], a[120:123], v[64:67], 0
    v_cvt_pk_bf16_f32 v7, v82, v83
    v_add_u32 v137, s50, v137
    v_mfma_f32_16x16x32_bf16 v[98:101], a[124:127], v[52:55], v[98:101]
    ds_write_b32 v135, v119 offset:3084
    v_mfma_f32_16x16x32_bf16 v[98:101], a[128:131], v[40:43], v[98:101]
    v_cvt_pk_f16_f32 v56, v60, v61
    v_cvt_pk_f16_f32 v57, v62, v63
    v_mfma_f32_16x16x32_bf16 v[98:101], a[132:135], v[48:51], v[98:101]
    v_add_u32 v136, s50, v136
    v_add_u32 v135, s48, v135
    v_mfma_f32_16x16x32_bf16 v[98:101], a[136:139], v[32:35], v[98:101]
    v_add_u32 v133, s51, v133
    v_add_u32 v132, s14, v132
    v_mfma_f32_16x16x32_bf16 v[98:101], a[140:143], v[44:47], v[98:101]
    s_nop 0
    ds_write_b32 v134, v72 offset:3072
    v_mfma_f32_16x16x32_f16 v[76:79], v[212:215], v[36:39], 0
    s_nop 0
    v_pk_fma_f16 v37, v56, v56, s39
    v_pk_fmac_f16 v37, v57, v57
    v_mfma_f32_16x16x32_bf16 v[80:83], v[64:67], a[168:171], 0
    s_nop 0
    v_cvt_pk_f16_f32 v142, v98, v99
    v_cvt_pk_f16_f32 v143, v100, v101
    v_mfma_f32_16x16x32_bf16 v[80:83], v[52:55], a[172:175], v[80:83]
    v_or3_b32 v123, v123, v76, v77
    v_or3_b32 v123, v123, v78, v79
    v_mfma_f32_16x16x32_bf16 v[80:83], v[40:43], a[176:179], v[80:83]
    ds_write_b32 v134, v73 offset:3076
    v_mfma_f32_16x16x32_bf16 v[80:83], v[48:51], a[180:183], v[80:83]
    s_waitcnt vmcnt(0)
    v_rsq_f32 v76, v76
    v_mfma_f32_16x16x32_bf16 v[80:83], v[32:35], a[184:187], v[80:83]
    v_rsq_f32 v77, v77
    v_mfma_f32_16x16x32_bf16 v[80:83], v[44:47], a[188:191], v[80:83]
    v_mul_f32 v76, s52, v76
    v_cvt_pk_f16_f32 v76, v76, v77
    v_mfma_f32_16x16x32_bf16 v[98:101], v[64:67], a[144:147], 0
    v_rsq_f32 v78, v78
    v_mfma_f32_16x16x32_bf16 v[98:101], v[52:55], a[148:151], v[98:101]
    v_rsq_f32 v79, v79
    v_mfma_f32_16x16x32_bf16 v[98:101], v[40:43], a[152:155], v[98:101]
    v_mul_f32 v78, s52, v78
    v_cvt_pk_f16_f32 v78, v78, v79
    v_mfma_f32_16x16x32_bf16 v[98:101], v[48:51], a[156:159], v[98:101]
    v_pk_mul_f16 v8, v8, v78 op_sel:[0,1] op_sel_hi:[1,1]
    v_pk_mul_f16 v9, v9, v78 op_sel:[0,1] op_sel_hi:[1,1]
    v_mfma_f32_16x16x32_bf16 v[98:101], v[32:35], a[160:163], v[98:101]
    s_waitcnt lgkmcnt(0)
    v_pk_mul_f16 v10, v10, v78 op_sel:[0,1] op_sel_hi:[1,1]
    v_pk_mul_f16 v11, v11, v78 op_sel:[0,1] op_sel_hi:[1,1]
    v_mfma_f32_16x16x32_bf16 v[98:101], v[44:47], a[164:167], v[98:101]
    s_barrier
    v_pk_mul_f16 v148, v148, v78 op_sel:[0,1] op_sel_hi:[1,1]
    v_pk_mul_f16 v149, v149, v78 op_sel:[0,1] op_sel_hi:[1,1]
    v_mfma_f32_16x16x32_bf16 v[92:95], a[0:3], v[64:67], 0
    s_cmp_ge_u32 s61, s13
    v_pk_mul_f16 v12, v12, v76 op_sel:[0,1] op_sel_hi:[1,1]
    v_pk_mul_f16 v13, v13, v76 op_sel:[0,1] op_sel_hi:[1,1]
    v_mfma_f32_16x16x32_bf16 v[92:95], a[4:7], v[52:55], v[92:95]
L_pga:
    s_cbranch_scc1 L_atomF0
L_atomF0r:
    v_mfma_f32_16x16x32_bf16 v[92:95], a[8:11], v[40:43], v[92:95]
    ds_read_b128 v[60:63], v132 offset:16
    v_pk_mul_f16 v14, v14, v76 op_sel:[0,1] op_sel_hi:[1,1]
    v_mfma_f32_16x16x32_bf16 v[92:95], a[12:15], v[48:51], v[92:95]
    ds_read_b128 v[68:71], v132 offset:0
    v_pk_mul_f16 v15, v15, v76 op_sel:[0,1] op_sel_hi:[1,1]
    v_mfma_f32_16x16x32_bf16 v[92:95], a[16:19], v[32:35], v[92:95]
    v_pk_mul_f16 v154, v154, v76 op_sel:[0,1] op_sel_hi:[1,1]
    v_pk_mul_f16 v155, v155, v76 op_sel:[0,1] op_sel_hi:[1,1]
    v_mfma_f32_16x16x32_bf16 v[92:95], a[20:23], v[44:47], v[92:95]
    ds_read_b128 v[104:107], v133 offset:0
    v_pk_mul_f16 v28, v28, v76 op_sel:[0,0] op_sel_hi:[1,0]
    v_mfma_f32_16x16x32_bf16 v[116:119], a[48:51], v[64:67], 0
    v_pk_mul_f16 v29, v29, v76 op_sel:[0,0] op_sel_hi:[1,0]
    v_pk_mul_f16 v30, v30, v76 op_sel:[0,0] op_sel_hi:[1,0]
    v_mfma_f32_16x16x32_bf16 v[116:119], a[52:55], v[52:55], v[116:119]
    ds_read_b128 v[88:91], v133 offset:2048
    v_pk_mul_f16 v31, v31, v76 op_sel:[0,0] op_sel_hi:[1,0]
    v_mfma_f32_16x16x32_bf16 v[116:119], a[56:59], v[40:43], v[116:119]
    v_pk_mul_f16 v152, v152, v76 op_sel:[0,0] op_sel_hi:[1,0]
    v_pk_mul_f16 v153, v153, v76 op_sel:[0,0] op_sel_hi:[1,0]
    v_mfma_f32_16x16x32_bf16 v[116:119], a[60:63], v[48:51], v[116:119]
    ds_read_b128 v[72:75], v132 offset:48
    v_cvt_pk_f16_f32 v76, v92, v93
    v_mfma_f32_16x16x32_bf16 v[116:119], a[64:67], v[32:35], v[116:119]
    ds_read_b128 v[84:87], v137 offset:0
    v_cvt_pk_f16_f32 v77, v94, v95
    v_mfma_f32_16x16x32_bf16 v[116:119], a[68:71], v[44:47], v[116:119]
    v_pk_fma_f16 v36, v76, v76, s39
    v_pk_fmac_f16 v36, v77, v77
    v_mfma_f32_16x16x32_bf16 v[112:115], a[24:27], v[64:67], 0
    s_nop 0
    v_add_u32 v134, s48, v134
    v_add_u32 v131, s14, v131
    v_mfma_f32_16x16x32_bf16 v[112:115], a[28:31], v[52:55], v[112:115]
    s_nop 0
    v_cvt_pk_f16_f32 v140, v116, v117
    v_cvt_pk_f16_f32 v141, v118, v119
    v_mfma_f32_16x16x32_bf16 v[112:115], a[32:35], v[40:43], v[112:115]
    s_waitcnt lgkmcnt(3)
    buffer_load_dwordx4 v128, s[24:27], s56 offen nt lds
    v_pk_mul_f16 v24, v24, v78 op_sel:[0,0] op_sel_hi:[1,0]
    v_mfma_f32_16x16x32_bf16 v[112:115], a[36:39], v[48:51], v[112:115]
    ds_read_b128 v[92:95], v136 offset:128
    v_pk_mul_f16 v25, v25, v78 op_sel:[0,0] op_sel_hi:[1,0]
    v_mfma_f32_16x16x32_bf16 v[112:115], a[40:43], v[32:35], v[112:115]
    v_pk_mul_f16 v26, v26, v78 op_sel:[0,0] op_sel_hi:[1,0]
    v_pk_mul_f16 v27, v27, v78 op_sel:[0,0] op_sel_hi:[1,0]
    v_mfma_f32_16x16x32_bf16 v[112:115], a[44:47], v[44:47], v[112:115]
    v_pk_mul_f16 v146, v146, v78 op_sel:[0,0] op_sel_hi:[1,0]
    v_pk_mul_f16 v147, v147, v78 op_sel:[0,0] op_sel_hi:[1,0]
    v_mfma_f32_16x16x32_bf16 v[116:119], a[96:99], v[64:67], 0
    ds_read_b128 v[108:111], v133 offset:1024
    v_cvt_pk_bf16_f32 v164, v98, v99
    v_mfma_f32_16x16x32_bf16 v[116:119], a[100:103], v[52:55], v[116:119]
    s_nop 0
    ds_read_u16 v166, v131 offset:80
    v_cvt_pk_f16_f32 v78, v112, v113
    v_mfma_f32_16x16x32_bf16 v[116:119], a[104:107], v[40:43], v[116:119]
    ds_read_u16 v162, v131 offset:96
    v_cvt_pk_f16_f32 v79, v114, v115
    v_mfma_f32_16x16x32_bf16 v[116:119], a[108:111], v[48:51], v[116:119]
    ds_read_u16 v158, v131 offset:104
    v_pk_fmac_f16 v36, v78, v78
    v_mfma_f32_16x16x32_bf16 v[116:119], a[112:115], v[32:35], v[116:119]
    ds_read_b128 v[96:99], v137 offset:256
    v_pk_fmac_f16 v36, v79, v79
    v_mfma_f32_16x16x32_bf16 v[116:119], a[116:119], v[44:47], v[116:119]
    s_add_u32 m0, s67, 1024
    v_pk_fmac_f16 v36, v140, v140
    v_pk_fmac_f16 v36, v141, v141
    v_mfma_f32_16x16x32_bf16 v[112:115], v[64:67], a[192:195], 0
    ds_read_b128 v[64:67], v136 offset:0
    v_cvt_pk_bf16_f32 v165, v100, v101
    v_mfma_f32_16x16x32_bf16 v[112:115], v[52:55], a[196:199], v[112:115]
    ds_read_b128 v[52:55], v133 offset:3072
    v_cvt_pk_f16_f32 v58, v116, v117
    v_mfma_f32_16x16x32_bf16 v[112:115], v[40:43], a[200:203], v[112:115]
    ds_read_b128 v[40:43], v137 offset:128
    v_cvt_pk_f16_f32 v59, v118, v119
    v_mfma_f32_16x16x32_bf16 v[112:115], v[48:51], a[204:207], v[112:115]
    s_waitcnt lgkmcnt(7)
    buffer_store_dwordx4 v[104:107], v128, s[28:31], s60 offen sc1
    buffer_load_dwordx4 v127, s[24:27], s56 offen nt lds
    v_pk_fmac_f16 v37, v58, v58
    v_pk_fmac_f16 v37, v59, v59
    v_pk_fmac_f16 v37, v142, v142
    v_mfma_f32_16x16x32_bf16 v[112:115], v[32:35], a[208:211], v[112:115]
    v_pk_fmac_f16 v37, v143, v143
    v_cvt_pk_bf16_f32 v20, v16, v17
    v_mfma_f32_16x16x32_bf16 v[112:115], v[44:47], a[212:215], v[112:115]
    ds_read_b128 v[32:35], v136 offset:256
    v_cvt_pk_bf16_f32 v21, v18, v19
    v_mfma_f32_16x16x32_f16 v[16:19], v[212:215], v[36:39], 0
    s_nop 0
    v_cvt_pk_bf16_f32 v160, v80, v81
    v_cvt_pk_bf16_f32 v161, v82, v83
    v_mfma_f32_16x16x32_f16 v[36:39], v[8:11], v[28:31], v[200:203]
    s_nop 0
    v_cvt_pk_bf16_f32 v156, v112, v113
    v_cvt_pk_bf16_f32 v157, v114, v115
    v_mfma_f32_16x16x32_f16 v[36:39], v[146:149], v[150:153], v[36:39]
    s_add_u32 m0, s67, 2048
    v_or3_b32 v123, v123, v16, v17
    v_mfma_f32_16x16x32_bf16 v[48:51], a[216:219], v[84:87], 0
    s_waitcnt lgkmcnt(2)
    ds_read_b128 v[44:47], v133 offset:4096
    v_mfma_f32_16x16x32_bf16 v[48:51], a[220:223], v[64:67], v[48:51]
    s_waitcnt lgkmcnt(2)
    buffer_store_dwordx4 v[108:111], v127, s[28:31], s60 offen sc1
    buffer_load_dwordx4 v126, s[24:27], s56 offen nt lds
    v_rsq_f32 v16, v16
    v_mfma_f32_16x16x32_bf16 v[48:51], a[224:227], v[40:43], v[48:51]
    v_rsq_f32 v17, v17
    v_mfma_f32_16x16x32_bf16 v[48:51], a[228:231], v[92:95], v[48:51]
    v_exp_f32 v36, v36
    v_mfma_f32_16x16x32_bf16 v[48:51], a[232:235], v[96:99], v[48:51]
    s_waitcnt lgkmcnt(1)
    v_exp_f32 v37, v37
    v_mfma_f32_16x16x32_bf16 v[48:51], a[236:239], v[32:35], v[48:51]
    v_mul_f32 v16, s52, v16
    v_cvt_pk_f16_f32 v16, v16, v17
    v_mfma_f32_16x16x32_bf16 v[80:83], a[240:243], v[84:87], 0
    v_pk_mul_f16 v76, v76, v16 op_sel:[0,0] op_sel_hi:[1,0]
    v_pk_mul_f16 v77, v77, v16 op_sel:[0,0] op_sel_hi:[1,0]
    v_mfma_f32_16x16x32_bf16 v[80:83], a[244:247], v[64:67], v[80:83]
    v_pk_mul_f16 v78, v78, v16 op_sel:[0,0] op_sel_hi:[1,0]
    v_pk_mul_f16 v79, v79, v16 op_sel:[0,0] op_sel_hi:[1,0]
    v_mfma_f32_16x16x32_bf16 v[80:83], a[248:251], v[40:43], v[80:83]
    v_pk_mul_f16 v140, v140, v16 op_sel:[0,0] op_sel_hi:[1,0]
    v_pk_mul_f16 v141, v141, v16 op_sel:[0,0] op_sel_hi:[1,0]
    v_mfma_f32_16x16x32_bf16 v[80:83], a[252:255], v[92:95], v[80:83]
    v_pk_mul_f16 v56, v56, v16 op_sel:[0,1] op_sel_hi:[1,1]
    v_pk_mul_f16 v57, v57, v16 op_sel:[0,1] op_sel_hi:[1,1]
    v_mfma_f32_16x16x32_bf16 v[80:83], v[224:227], v[96:99], v[80:83]
    v_pk_mul_f16 v58, v58, v16 op_sel:[0,1] op_sel_hi:[1,1]
    v_pk_mul_f16 v59, v59, v16 op_sel:[0,1] op_sel_hi:[1,1]
    v_mfma_f32_16x16x32_bf16 v[80:83], v[228:231], v[32:35], v[80:83]
    s_add_u32 m0, s67, 3072
    buffer_store_dwordx4 v[88:91], v126, s[28:31], s60 offen sc1
    v_pk_mul_f16 v142, v142, v16 op_sel:[0,1] op_sel_hi:[1,1]
    v_pk_mul_f16 v143, v143, v16 op_sel:[0,1] op_sel_hi:[1,1]
    v_exp_f32 v38, v38
    v_mfma_f32_16x16x32_f16 v[16:19], v[68:71], v[28:31], v[208:211]
    v_exp_f32 v39, v39
    v_mfma_f32_16x16x32_f16 v[16:19], v[60:63], v[12:15], v[16:19]
    v_cvt_pk_bf16_f32 v36, v36, v37
    v_cvt_pk_bf16_f32 v37, v38, v39
    v_mfma_f32_16x16x32_f16 v[16:19], v[72:75], v[152:155], v[16:19]
    s_nop 0
    buffer_load_dwordx4 v125, s[24:27], s56 offen nt lds
    v_mfma_f32_16x16x32_f16 v[104:107], v[56:59], v[28:31], v[196:199]
    s_add_u32 m0, s67, 4096
    s_nop 1
    v_mfma_f32_16x16x32_f16 v[104:107], v[140:143], v[150:153], v[104:107]
    s_nop 0
    v_exp_f32 v16, v16
    v_mfma_f32_16x16x32_f16 v[88:91], v[12:15], v[28:31], v[204:207]
    s_nop 0
    v_cvt_pk_bf16_f32 v170, v16, 0
    s_nop 0
    v_mfma_f32_16x16x32_f16 v[88:91], v[152:155], v[150:153], v[88:91]
    s_nop 0
    v_exp_f32 v104, v104
    v_mfma_f32_16x16x32_bf16 v[116:119], v[232:235], v[84:87], 0
    s_waitcnt lgkmcnt(0)
    buffer_store_dwordx4 v[52:55], v125, s[28:31], s60 offen sc1
    buffer_load_dwordx4 v124, s[24:27], s56 offen nt lds
    v_exp_f32 v105, v105
    v_mfma_f32_16x16x32_bf16 v[116:119], v[236:239], v[64:67], v[116:119]
    v_exp_f32 v88, v88
    v_mfma_f32_16x16x32_bf16 v[116:119], v[240:243], v[40:43], v[116:119]
    v_exp_f32 v89, v89
    v_mfma_f32_16x16x32_bf16 v[116:119], v[244:247], v[92:95], v[116:119]
    v_exp_f32 v90, v90
    v_mfma_f32_16x16x32_bf16 v[116:119], v[248:251], v[96:99], v[116:119]
    v_exp_f32 v91, v91
    v_mfma_f32_16x16x32_bf16 v[116:119], v[252:255], v[32:35], v[116:119]
    v_cvt_pk_bf16_f32 v34, v88, v89
    v_cvt_pk_bf16_f32 v35, v90, v91
    v_mfma_f32_16x16x32_f16 v[28:31], v[56:59], v[24:27], v[184:187]
    v_exp_f32 v106, v106
    v_mfma_f32_16x16x32_f16 v[28:31], v[140:143], v[144:147], v[28:31]
    v_exp_f32 v107, v107
    v_mfma_f32_16x16x32_f16 v[40:43], v[56:59], v[76:79], v[172:175]
    buffer_store_dwordx4 v[44:47], v124, s[28:31], s60 offen sc1
    v_cvt_pk_bf16_f32 v168, v104, v105
    v_cvt_pk_bf16_f32 v169, v106, v107
    s_nop 0
    v_mfma_f32_16x16x32_f16 v[40:43], v[140:143], v[138:141], v[40:43]
    s_mov_b32 s53, s47
    v_exp_f32 v28, v28
    v_mfma_f32_16x16x32_f16 v[44:47], v[12:15], v[24:27], v[192:195]
    s_mov_b32 s47, s46
    v_exp_f32 v29, v29
    v_mfma_f32_16x16x32_f16 v[44:47], v[152:155], v[144:147], v[44:47]
    s_mov_b32 s46, s45
    v_exp_f32 v30, v30
    v_mfma_f32_16x16x32_f16 v[52:55], v[68:71], v[76:79], v[208:211]
    s_mov_b32 s45, s44
    v_exp_f32 v31, v31
    v_mfma_f32_16x16x32_f16 v[52:55], v[60:63], v[56:59], v[52:55]
    s_mov_b32 s44, s53
    v_exp_f32 v40, v40
    v_mfma_f32_16x16x32_f16 v[52:55], v[72:75], v[140:143], v[52:55]
    s_sub_u32 s48, s44, s46
    v_exp_f32 v44, v44
    v_mfma_f32_16x16x32_f16 v[64:67], v[68:71], v[24:27], v[208:211]
    s_sub_u32 s49, s46, s45
    v_exp_f32 v45, v45
    v_mfma_f32_16x16x32_f16 v[64:67], v[60:63], v[8:11], v[64:67]
    s_cmp_lg_u32 s5, -1
    v_exp_f32 v46, v46
    v_mfma_f32_16x16x32_f16 v[64:67], v[72:75], v[146:149], v[64:67]
    ds_read_b128 v[60:63], v136 offset:1536
    v_cvt_pk_bf16_f32 v16, v44, v45
    v_mfma_f32_16x16x32_bf16 v[98:101], v[220:223], v[34:37], 0
    ds_read_b128 v[68:71], v137 offset:1664
    v_fma_f32 v32, v48, v48, s42
    v_mfma_f32_16x16x32_bf16 v[98:101], v[220:223], v[168:171], v[98:101]
    s_nop 0
    ds_read_b128 v[88:91], v137 offset:1536
    v_mov_b32_dpp v19, v67 quad_perm:[0,1,2,3] row_mask:0x2 bank_mask:0xf
    v_mfma_f32_16x16x32_bf16 v[104:107], v[0:3], v[34:37], 0
    ds_read_b128 v[72:75], v136 offset:1664
    v_mov_b32_dpp v19, v55 quad_perm:[0,1,2,3] row_mask:0x4 bank_mask:0xf
    v_mfma_f32_16x16x32_bf16 v[104:107], v[164:167], v[168:171], v[104:107]
    ds_read_b128 v[84:87], v136 offset:1792
    v_fmac_f32 v32, v49, v49
    v_mfma_f32_16x16x32_bf16 v[92:95], v[20:23], v[34:37], 0
    v_exp_f32 v47, v47
    v_mfma_f32_16x16x32_bf16 v[92:95], v[160:163], v[168:171], v[92:95]
    v_cvt_pk_bf16_f32 v17, v46, v47
    v_fmac_f32 v32, v50, v50
    v_mfma_f32_16x16x32_bf16 v[44:47], v[4:7], v[34:37], 0
    ds_read_b128 v[36:39], v137 offset:1792
    v_fmac_f32 v32, v51, v51
    v_mfma_f32_16x16x32_bf16 v[44:47], v[156:159], v[168:171], v[44:47]
    v_exp_f32 v65, v65
    v_mfma_f32_16x16x32_f16 v[108:111], v[12:15], v[76:79], v[180:183]
    v_exp_f32 v19, v19
    v_mfma_f32_16x16x32_f16 v[108:111], v[152:155], v[138:141], v[108:111]
    v_cvt_pk_bf16_f32 v19, v19, v19
    v_cvt_pk_bf16_f32 v168, v28, v29
    v_mfma_f32_16x16x32_f16 v[152:155], v[8:11], v[76:79], v[176:179]
    ds_write_b16 v131, v19 offset:64
    v_mfma_f32_16x16x32_f16 v[152:155], v[146:149], v[138:141], v[152:155]
    s_waitcnt lgkmcnt(3)
    v_rcp_f32 v98, v98
    v_mfma_f32_16x16x32_bf16 v[140:143], a[216:219], v[88:91], 0
    v_mul_f32 v104, v104, v98
    v_mul_f32 v105, v105, v98
    v_mfma_f32_16x16x32_bf16 v[140:143], a[220:223], v[60:63], v[140:143]
    ds_read_b128 v[12:15], v132 offset:48
    v_cvt_pk_bf16_f32 v104, v104, v105
    v_mfma_f32_16x16x32_bf16 v[140:143], a[224:227], v[68:71], v[140:143]
    ds_read_b128 v[76:79], v132 offset:64
    v_mul_f32 v106, v106, v98
    v_mfma_f32_16x16x32_bf16 v[140:143], a[228:231], v[72:75], v[140:143]
    s_waitcnt lgkmcnt(3)
    v_mul_f32 v107, v107, v98
    v_cvt_pk_bf16_f32 v105, v106, v107
    v_mfma_f32_16x16x32_bf16 v[140:143], a[232:235], v[36:39], v[140:143]
    v_mul_f32 v92, v92, v98
    v_mul_f32 v93, v93, v98
    v_mfma_f32_16x16x32_bf16 v[140:143], a[236:239], v[84:87], v[140:143]
    v_cvt_pk_bf16_f32 v106, v92, v93
    v_mul_f32 v94, v94, v98
    v_mfma_f32_16x16x32_bf16 v[56:59], v[232:235], v[88:91], 0
    ds_write_b64 v135, v[104:105] offset:0
    v_mfma_f32_16x16x32_bf16 v[56:59], v[236:239], v[60:63], v[56:59]
    v_mul_f32 v95, v95, v98
    v_cvt_pk_bf16_f32 v107, v94, v95
    v_mfma_f32_16x16x32_bf16 v[56:59], v[240:243], v[68:71], v[56:59]
    v_mul_f32 v44, v44, v98
    v_mul_f32 v45, v45, v98
    v_mfma_f32_16x16x32_bf16 v[56:59], v[244:247], v[72:75], v[56:59]
    ds_read_b128 v[92:95], v137 offset:3200
    v_cvt_pk_bf16_f32 v18, v44, v45
    v_mfma_f32_16x16x32_bf16 v[56:59], v[248:251], v[36:39], v[56:59]
    v_mul_f32 v46, v46, v98
    v_mul_f32 v47, v47, v98
    v_mfma_f32_16x16x32_bf16 v[56:59], v[252:255], v[84:87], v[56:59]
    s_waitcnt lgkmcnt(2)
    v_cvt_pk_bf16_f32 v19, v46, v47
    v_cvt_pk_bf16_f32 v169, v30, v31
    v_mfma_f32_16x16x32_bf16 v[28:31], v[12:15], v[0:3], 0
    v_cvt_pk_bf16_f32 v170, v65, 0
    v_fmac_f32 v32, v80, v80
    v_mfma_f32_16x16x32_bf16 v[28:31], v[76:79], v[164:167], v[28:31]
    ds_write_b64 v135, v[106:107] offset:8
    v_mfma_f32_16x16x32_bf16 v[44:47], v[12:15], v[20:23], 0
    v_exp_f32 v41, v41
    v_mfma_f32_16x16x32_bf16 v[44:47], v[76:79], v[160:163], v[44:47]
    v_exp_f32 v42, v42
    v_mfma_f32_16x16x32_bf16 v[64:67], v[12:15], v[4:7], 0
    s_nop 0
    ds_read_b128 v[12:15], v137 offset:3072
    v_fmac_f32 v32, v81, v81
    v_mfma_f32_16x16x32_bf16 v[64:67], v[76:79], v[156:159], v[64:67]
    s_nop 0
    ds_read_b128 v[98:101], v136 offset:3072
    v_mov_b32_dpp v31, v47 quad_perm:[0,1,2,3] row_mask:0x2 bank_mask:0xf
    v_mfma_f32_16x16x32_bf16 v[44:47], a[240:243], v[88:91], 0
    ds_read_b128 v[104:107], v136 offset:3200
    v_fmac_f32 v32, v82, v82
    v_mfma_f32_16x16x32_bf16 v[44:47], a[244:247], v[60:63], v[44:47]
    s_nop 0
    ds_read_b128 v[62:65], v137 offset:3328
    v_mov_b32_dpp v31, v67 quad_perm:[0,1,2,3] row_mask:0x4 bank_mask:0xf
    v_mfma_f32_16x16x32_bf16 v[44:47], a[248:251], v[68:71], v[44:47]
    ds_read_b128 v[66:69], v136 offset:3328
    v_cvt_pk_bf16_f32 v31, v31, v31
    v_mfma_f32_16x16x32_bf16 v[44:47], a[252:255], v[72:75], v[44:47]
    v_exp_f32 v43, v43
    v_mfma_f32_16x16x32_bf16 v[44:47], v[224:227], v[36:39], v[44:47]
    v_exp_f32 v54, v54
    v_mfma_f32_16x16x32_bf16 v[44:47], v[228:231], v[84:87], v[44:47]
    v_exp_f32 v152, v152
    v_mfma_f32_16x16x32_f16 v[36:39], v[8:11], v[24:27], v[188:191]
    ds_write_b16 v131, v31
    v_mfma_f32_16x16x32_f16 v[36:39], v[146:149], v[144:147], v[36:39]
    s_waitcnt lgkmcnt(5)
    v_exp_f32 v153, v153
    v_mfma_f32_16x16x32_bf16 v[88:91], a[240:243], v[12:15], 0
    s_waitcnt lgkmcnt(4)
    v_exp_f32 v154, v154
    v_mfma_f32_16x16x32_bf16 v[88:91], a[244:247], v[98:101], v[88:91]
    v_exp_f32 v155, v155
    v_mfma_f32_16x16x32_bf16 v[88:91], a[248:251], v[92:95], v[88:91]
    s_waitcnt lgkmcnt(2)
    ds_write_b32 v134, v18 offset:0
    v_mfma_f32_16x16x32_bf16 v[88:91], a[252:255], v[104:107], v[88:91]
    v_cvt_pk_bf16_f32 v30, v152, v153
    v_cvt_pk_bf16_f32 v31, v154, v155
    v_mfma_f32_16x16x32_bf16 v[88:91], v[224:227], v[62:65], v[88:91]
    s_waitcnt lgkmcnt(2)
    v_exp_f32 v36, v36
    v_mfma_f32_16x16x32_bf16 v[88:91], v[228:231], v[66:69], v[88:91]
    v_exp_f32 v37, v37
    v_mfma_f32_16x16x32_bf16 v[24:27], a[216:219], v[12:15], 0
    ds_write_b32 v134, v19 offset:4
    v_mfma_f32_16x16x32_bf16 v[24:27], a[220:223], v[98:101], v[24:27]
    v_exp_f32 v38, v38
    v_mfma_f32_16x16x32_bf16 v[24:27], a[224:227], v[92:95], v[24:27]
    v_exp_f32 v39, v39
    v_mfma_f32_16x16x32_bf16 v[24:27], a[228:231], v[104:107], v[24:27]
    v_cvt_pk_bf16_f32 v18, v36, v37
    v_cvt_pk_bf16_f32 v19, v38, v39
    v_mfma_f32_16x16x32_bf16 v[24:27], a[232:235], v[62:65], v[24:27]
    v_exp_f32 v108, v108
    v_mfma_f32_16x16x32_bf16 v[24:27], a[236:239], v[66:69], v[24:27]
    v_exp_f32 v109, v109
    v_mfma_f32_16x16x32_bf16 v[152:155], v[220:223], v[16:19], 0
    v_exp_f32 v110, v110
    v_mfma_f32_16x16x32_bf16 v[152:155], v[220:223], v[168:171], v[152:155]
    s_nop 0
    v_exp_f32 v111, v111
    v_mfma_f32_16x16x32_bf16 v[36:39], v[0:3], v[16:19], 0
    s_nop 0
    v_cvt_pk_bf16_f32 v28, v108, v109
    v_cvt_pk_bf16_f32 v29, v110, v111
    v_mfma_f32_16x16x32_bf16 v[36:39], v[164:167], v[168:171], v[36:39]
    s_nop 0
    v_rcp_f32 v152, v152
    v_mfma_f32_16x16x32_bf16 v[146:149], v[20:23], v[16:19], 0
    v_add_u32 v137, s48, v137
    v_add_u32 v136, s48, v136
    v_mfma_f32_16x16x32_bf16 v[146:149], v[160:163], v[168:171], v[146:149]
    s_nop 0
    ds_read_b128 v[84:87], v137 offset:0
    v_mul_f32 v36, v36, v152
    v_mfma_f32_16x16x32_bf16 v[76:79], v[4:7], v[16:19], 0
    ds_read_b128 v[108:111], v136 offset:0
    v_mul_f32 v37, v37, v152
    v_mfma_f32_16x16x32_bf16 v[76:79], v[156:159], v[168:171], v[76:79]
    ds_read_b128 v[8:11], v137 offset:128
    v_cvt_pk_bf16_f32 v168, v40, v41
    v_mfma_f32_16x16x32_bf16 v[72:75], v[232:235], v[12:15], 0
    ds_read_b128 v[112:115], v136 offset:128
    v_cvt_pk_bf16_f32 v169, v42, v43
    v_mfma_f32_16x16x32_bf16 v[72:75], v[236:239], v[98:101], v[72:75]
    ds_read_b128 v[40:43], v137 offset:256
    v_cvt_pk_bf16_f32 v170, v54, 0
    v_mfma_f32_16x16x32_bf16 v[72:75], v[240:243], v[92:95], v[72:75]
    ds_read_b128 v[52:55], v136 offset:256
    v_cvt_pk_bf16_f32 v12, v36, v37
    v_mfma_f32_16x16x32_bf16 v[72:75], v[244:247], v[104:107], v[72:75]
    ds_read_b128 v[104:107], v136 offset:1792
    v_mul_f32 v38, v38, v152
    v_mfma_f32_16x16x32_bf16 v[72:75], v[248:251], v[62:65], v[72:75]
    ds_read_b128 v[60:63], v136 offset:1536
    v_mul_f32 v39, v39, v152
    v_mfma_f32_16x16x32_bf16 v[72:75], v[252:255], v[66:69], v[72:75]
    ds_read_b128 v[98:101], v137 offset:1664
    v_cvt_pk_bf16_f32 v13, v38, v39
    v_mfma_f32_16x16x32_bf16 v[36:39], v[220:223], v[28:31], 0
    ds_read_b128 v[68:71], v137 offset:1536
    v_mul_f32 v146, v146, v152
    v_mfma_f32_16x16x32_bf16 v[36:39], v[220:223], v[168:171], v[36:39]
    v_mul_f32 v147, v147, v152
    v_cvt_pk_bf16_f32 v14, v146, v147
    v_mfma_f32_16x16x32_bf16 v[64:67], v[0:3], v[28:31], 0
    v_mul_f32 v148, v148, v152
    v_mul_f32 v149, v149, v152
    v_mfma_f32_16x16x32_bf16 v[64:67], v[164:167], v[168:171], v[64:67]
    v_cvt_pk_bf16_f32 v15, v148, v149
    v_mul_f32 v76, v76, v152
    v_mfma_f32_16x16x32_bf16 v[0:3], v[20:23], v[28:31], 0
    ds_write_b32 v135, v12 offset:1536
    v_mfma_f32_16x16x32_bf16 v[0:3], v[160:163], v[168:171], v[0:3]
    v_mul_f32 v77, v77, v152
    v_cvt_pk_bf16_f32 v154, v76, v77
    v_mfma_f32_16x16x32_bf16 v[146:149], v[4:7], v[28:31], 0
    v_mul_f32 v78, v78, v152
    v_mul_f32 v79, v79, v152
    v_mfma_f32_16x16x32_bf16 v[146:149], v[156:159], v[168:171], v[146:149]
    s_waitcnt lgkmcnt(3)
    v_cvt_pk_bf16_f32 v155, v78, v79
    v_fmac_f32 v32, v83, v83
    v_mfma_f32_16x16x32_bf16 v[28:31], a[0:3], v[84:87], 0
    s_cbranch_scc1 L_loopF0
    ds_write_b32 v135, v13 offset:1540
    v_rcp_f32 v36, v36
    s_mov_b32 s30, 100270464
    s_mul_i32 s89, s68, 7168
    ds_write_b64 v135, v[14:15] offset:1544
    v_mul_f32 v64, v64, v36
    v_mul_f32 v65, v65, v36
    v_cvt_pk_bf16_f32 v4, v64, v65
    s_add_u32 s89, s89, 135168
    s_movk_i32 s90, 112
    ds_write_b64 v134, v[154:155] offset:1536
    v_mul_f32 v66, v66, v36
    v_mul_f32 v67, v67, v36
    v_cvt_pk_bf16_f32 v5, v66, v67
    v_mul_f32 v0, v0, v36
    v_mul_f32 v1, v1, v36
    v_cvt_pk_bf16_f32 v6, v0, v1
    v_mul_f32 v2, v2, v36
    v_mul_f32 v3, v3, v36
    v_cvt_pk_bf16_f32 v7, v2, v3
    v_mul_f32 v146, v146, v36
    v_mul_f32 v147, v147, v36
    v_cvt_pk_bf16_f32 v120, v146, v147
    v_mul_f32 v148, v148, v36
    v_mul_f32 v149, v149, v36
    v_cvt_pk_bf16_f32 v121, v148, v149
    s_lshr_b32 s91, s64, 16
    s_lshl_b32 s92, s68, 10
    ds_write_b64 v135, v[4:5] offset:3072
    v_fmac_f32 v32, v116, v116
    s_sub_u32 s84, s45, s44
    s_sub_u32 s85, s46, s45
    ds_write_b64 v135, v[6:7] offset:3080
    v_fmac_f32 v32, v117, v117
    v_fmac_f32 v32, v118, v118
    v_fmac_f32 v32, v119, v119
    s_sub_u32 s86, s44, s45
    s_sub_u32 s93, s44, s47
    ds_write_b32 v134, v120 offset:3072
    ds_write_b32 v134, v121 offset:3076
    v_fma_f32 v131, v140, v140, s42
    v_fmac_f32 v131, v141, v141
    v_fmac_f32 v131, v142, v142
    v_fmac_f32 v131, v143, v143
    v_fmac_f32 v131, v44, v44
    v_fmac_f32 v131, v45, v45
    v_fmac_f32 v131, v46, v46
    v_fmac_f32 v131, v47, v47
    v_fmac_f32 v131, v56, v56
    v_fmac_f32 v131, v57, v57
    v_fmac_f32 v131, v58, v58
    v_fmac_f32 v131, v59, v59
    v_fma_f32 v121, v24, v24, s42
    v_fmac_f32 v121, v25, v25
    v_fmac_f32 v121, v26, v26
    v_fmac_f32 v121, v27, v27
    v_fmac_f32 v121, v88, v88
    v_fmac_f32 v121, v89, v89
    v_fmac_f32 v121, v90, v90
    v_fmac_f32 v121, v91, v91
    v_fmac_f32 v121, v72, v72
    v_fmac_f32 v121, v73, v73
    v_fmac_f32 v121, v74, v74
    v_fmac_f32 v121, v75, v75
    v_cvt_pk_bf16_f32 v120, v32, v131
    v_cvt_pk_bf16_f32 v121, v121, v122
    s_sub_u32 s94, s45, s47
    s_sub_u32 s95, s46, s47
    ds_write_b64 v130, v[120:121]
    v_mbcnt_lo_u32_b32 v131, -1, 0
    v_mbcnt_hi_u32_b32 v131, -1, v131
    v_and_b32 v138, 15, v131
    v_lshrrev_b32 v131, 4, v131
    v_mul_u32_u24 v131, 1792, v131
    v_add_u32 v131, s89, v131
    v_mad_u32_u24 v132, v138, s90, v131
    v_lshrrev_b32 v139, v138, s64
    v_and_b32 v139, 1, v139
    v_cmp_eq_u32 vcc, 1, v139
    v_mad_u32_u24 v52, v138, s90, v131
    v_lshrrev_b32 v138, v138, s91
    v_cndmask_b32 v132, v131, v132, vcc
    v_and_b32 v138, 1, v138
    v_subrev_u32 v52, 28672, v52
    v_cmp_eq_u32 vcc, 1, v138
    ds_read_b128 v[20:23], v132 offset:64
    ds_read_b128 v[16:19], v132 offset:80
    v_cndmask_b32 v52, v131, v52, vcc
    v_add_u32 v131, s92, v129
    s_waitcnt lgkmcnt(2)
    s_barrier
    ds_read_b128 v[98:101], v132
    v_add_u32 v54, s84, v137
    ds_read_b64 v[102:103], v132 offset:16
    ds_read_b128 v[4:7], v131 offset:6144
    v_add_u32 v53, s84, v136
    v_add_u32 v120, s85, v135
    ds_read_b128 v[8:11], v129 offset:0
    v_add_u32 v55, s85, v134
    ds_read_b128 v[0:3], v129 offset:1024
    v_add_u32 v138, s86, v135
    v_add_u32 v132, s86, v134
    v_add_u32 v131, s93, v133
    v_add_u32 v139, s94, v133
    s_waitcnt lgkmcnt(6)
    v_mfma_f32_16x16x32_bf16 v[12:15], v[220:223], v[20:23], 0
    s_waitcnt lgkmcnt(5)
    ds_read_b128 v[92:95], v54 offset:1536
    ds_read_b128 v[68:71], v53 offset:1536
    v_mfma_f32_16x16x32_bf16 v[12:15], v[220:223], v[16:19], v[12:15]
    s_waitcnt lgkmcnt(3)
    ds_read_b128 v[64:67], v54 offset:1664
    v_lshlrev_b32 v76, 16, v98
    v_and_b32 v98, 0xffff0000, v98
    v_lshlrev_b32 v77, 16, v99
    v_and_b32 v99, 0xffff0000, v99
    v_lshlrev_b32 v78, 16, v100
    v_and_b32 v100, 0xffff0000, v100
    v_rcp_f32 v12, v12
    v_lshlrev_b32 v79, 16, v101
    v_mfma_f32_16x16x32_bf16 v[16:19], v[216:219], v[8:11], 0
    s_waitcnt lgkmcnt(3)
    ds_read_b128 v[60:63], v53 offset:1664
    ds_read_b128 v[40:43], v54 offset:1792
    v_mfma_f32_16x16x32_bf16 v[16:19], v[216:219], v[0:3], v[16:19]
    s_waitcnt lgkmcnt(4)
    ds_read_b128 v[28:31], v53 offset:1792
    v_mul_f32 v76, v76, v12
    v_mul_f32 v98, v98, v12
    v_cvt_pk_bf16_f32 v76, v76, v98
    v_mul_f32 v77, v77, v12
    v_mfma_f32_16x16x32_bf16 v[8:11], a[216:219], v[92:95], 0
    s_waitcnt lgkmcnt(4)
    v_mul_f32 v99, v99, v12
    v_cvt_pk_bf16_f32 v77, v77, v99
    v_mfma_f32_16x16x32_bf16 v[8:11], a[220:223], v[68:71], v[8:11]
    s_waitcnt lgkmcnt(3)
    ds_read_b128 v[108:111], v54 offset:0
    ds_read_b128 v[96:99], v53 offset:0
    v_mfma_f32_16x16x32_bf16 v[8:11], a[224:227], v[64:67], v[8:11]
    s_waitcnt lgkmcnt(4)
    ds_read_b128 v[84:87], v54 offset:128
    v_mul_f32 v78, v78, v12
    v_mul_f32 v100, v100, v12
    v_cvt_pk_bf16_f32 v78, v78, v100
    v_and_b32 v101, 0xffff0000, v101
    v_mul_f32 v79, v79, v12
    v_mfma_f32_16x16x32_bf16 v[8:11], a[228:231], v[60:63], v[8:11]
    s_waitcnt lgkmcnt(4)
    ds_read_b128 v[36:39], v53 offset:128
    ds_read_b128 v[20:23], v54 offset:256
    v_mfma_f32_16x16x32_bf16 v[8:11], a[232:235], v[40:43], v[8:11]
    s_waitcnt lgkmcnt(5)
    ds_read_b128 v[0:3], v53 offset:256
    v_mul_f32 v101, v101, v12
    v_mfma_f32_16x16x32_bf16 v[8:11], a[236:239], v[28:31], v[8:11]
    v_cvt_pk_bf16_f32 v79, v79, v101
    v_lshlrev_b32 v19, 16, v102
    v_mfma_f32_16x16x32_bf16 v[32:35], a[240:243], v[92:95], 0
    ds_write_b128 v138, v[76:79] offset:0
    v_mfma_f32_16x16x32_bf16 v[32:35], a[244:247], v[68:71], v[32:35]
    v_and_b32 v102, 0xffff0000, v102
    v_mul_f32 v19, v19, v12
    v_mfma_f32_16x16x32_bf16 v[32:35], a[248:251], v[64:67], v[32:35]
    v_mul_f32 v102, v102, v12
    v_cvt_pk_bf16_f32 v76, v19, v102
    v_mfma_f32_16x16x32_bf16 v[32:35], a[252:255], v[60:63], v[32:35]
    v_lshlrev_b32 v19, 16, v103
    v_and_b32 v103, 0xffff0000, v103
    v_mfma_f32_16x16x32_bf16 v[32:35], v[224:227], v[40:43], v[32:35]
    v_mul_f32 v19, v19, v12
    v_mul_f32 v103, v103, v12
    v_mfma_f32_16x16x32_bf16 v[32:35], v[228:231], v[28:31], v[32:35]
    v_cvt_pk_bf16_f32 v77, v19, v103
    v_lshrrev_b32 v19, 0, v7
    v_mfma_f32_16x16x32_bf16 v[12:15], v[232:235], v[92:95], 0
    ds_write_b64 v132, v[76:77] offset:0
    v_mfma_f32_16x16x32_bf16 v[12:15], v[236:239], v[68:71], v[12:15]
    v_lshrrev_b32 v19, v19, s64
    v_and_b32 v19, 1, v19
    v_mfma_f32_16x16x32_bf16 v[12:15], v[240:243], v[64:67], v[12:15]
    v_cmp_eq_u32 vcc, 1, v19
    v_lshrrev_b32 v19, 8, v7
    v_mfma_f32_16x16x32_bf16 v[12:15], v[244:247], v[60:63], v[12:15]
    v_cndmask_b32 v4, 2.0, v4, vcc
    v_lshrrev_b32 v19, v19, s64
    v_mfma_f32_16x16x32_bf16 v[12:15], v[248:251], v[40:43], v[12:15]
    v_and_b32 v19, 1, v19
    v_cmp_eq_u32 vcc, 1, v19
    v_mfma_f32_16x16x32_bf16 v[12:15], v[252:255], v[28:31], v[12:15]
    s_waitcnt lgkmcnt(1)
    v_cndmask_b32 v5, 2.0, v5, vcc
    v_lshrrev_b32 v7, 16, v7
    v_mfma_f32_16x16x32_bf16 v[68:71], a[216:219], v[108:111], 0
    v_lshrrev_b32 v7, v7, s64
    v_and_b32 v7, 1, v7
    v_mfma_f32_16x16x32_bf16 v[68:71], a[220:223], v[96:99], v[68:71]
    ds_read_b128 v[104:107], v54 offset:3072
    ds_read_b128 v[100:103], v53 offset:3072
    v_mfma_f32_16x16x32_bf16 v[68:71], a[224:227], v[84:87], v[68:71]
    ds_read_b128 v[92:95], v54 offset:3200
    v_cmp_eq_u32 vcc, 1, v7
    v_mfma_f32_16x16x32_bf16 v[68:71], a[228:231], v[36:39], v[68:71]
    ds_read_b128 v[64:67], v53 offset:3200
    v_cndmask_b32 v6, 2.0, v6, vcc
    v_mfma_f32_16x16x32_bf16 v[68:71], a[232:235], v[20:23], v[68:71]
L_pg2:
    s_cbranch_execz L_main
    ds_read_b128 v[60:63], v54 offset:3328
    v_add_u32 v7, s95, v133
    v_mfma_f32_16x16x32_bf16 v[68:71], a[236:239], v[0:3], v[68:71]
    ds_read_b128 v[28:31], v53 offset:3328
    v_fma_f32 v133, v8, v8, s42
    v_mfma_f32_16x16x32_bf16 v[76:79], a[240:243], v[108:111], 0
    v_rsq_f32 v16, v16
    v_mfma_f32_16x16x32_bf16 v[76:79], a[244:247], v[96:99], v[76:79]
    v_mul_f32 v16, s43, v16
    v_mul_f32 v48, v48, v16
    v_mfma_f32_16x16x32_bf16 v[76:79], a[248:251], v[84:87], v[76:79]
    v_mul_f32 v49, v49, v16
    v_cvt_pk_bf16_f32 v48, v48, v49
    v_mfma_f32_16x16x32_bf16 v[76:79], a[252:255], v[36:39], v[76:79]
    v_mul_f32 v50, v50, v16
    v_mul_f32 v51, v51, v16
    v_mfma_f32_16x16x32_bf16 v[76:79], v[224:227], v[20:23], v[76:79]
    v_cvt_pk_bf16_f32 v49, v50, v51
    v_mul_f32 v80, v80, v16
    v_mfma_f32_16x16x32_bf16 v[76:79], v[228:231], v[0:3], v[76:79]
    v_mul_f32 v81, v81, v16
    v_cvt_pk_bf16_f32 v50, v80, v81
    v_mfma_f32_16x16x32_bf16 v[40:43], v[232:235], v[108:111], 0
    v_mul_f32 v82, v82, v16
    v_mul_f32 v83, v83, v16
    v_mfma_f32_16x16x32_bf16 v[40:43], v[236:239], v[96:99], v[40:43]
    v_cvt_pk_bf16_f32 v51, v82, v83
    v_mul_f32 v116, v116, v16
    v_mfma_f32_16x16x32_bf16 v[40:43], v[240:243], v[84:87], v[40:43]
    ds_write_b128 v120, v[48:51] offset:0
    v_mfma_f32_16x16x32_bf16 v[40:43], v[244:247], v[36:39], v[40:43]
    v_mul_f32 v117, v117, v16
    v_cvt_pk_bf16_f32 v116, v116, v117
    v_mfma_f32_16x16x32_bf16 v[40:43], v[248:251], v[20:23], v[40:43]
    v_mul_f32 v118, v118, v16
    v_mul_f32 v119, v119, v16
    v_mfma_f32_16x16x32_bf16 v[40:43], v[252:255], v[0:3], v[40:43]
    s_waitcnt lgkmcnt(1)
    v_cvt_pk_bf16_f32 v117, v118, v119
    v_fma_f32 v54, v68, v68, s42
    v_mfma_f32_16x16x32_bf16 v[20:23], a[216:219], v[104:107], 0
    ds_write_b64 v55, v[116:117] offset:0
    v_mfma_f32_16x16x32_bf16 v[20:23], a[220:223], v[100:103], v[20:23]
    ds_read_b128 v[36:39], v52 offset:64
    v_fmac_f32 v54, v69, v69
    v_mfma_f32_16x16x32_bf16 v[20:23], a[224:227], v[92:95], v[20:23]
    ds_read_b128 v[0:3], v52 offset:80
    v_fmac_f32 v54, v70, v70
    v_mfma_f32_16x16x32_bf16 v[20:23], a[228:231], v[64:67], v[20:23]
    ds_read_b128 v[48:51], v52
    v_fmac_f32 v54, v71, v71
    v_mfma_f32_16x16x32_bf16 v[20:23], a[232:235], v[60:63], v[20:23]
    ds_read_b64 v[52:53], v52 offset:16
    v_fmac_f32 v54, v76, v76
    v_mfma_f32_16x16x32_bf16 v[20:23], a[236:239], v[28:31], v[20:23]
    v_rsq_f32 v17, v17
    v_mfma_f32_16x16x32_bf16 v[96:99], a[240:243], v[104:107], 0
    v_mul_f32 v17, s43, v17
    v_mul_f32 v140, v140, v17
    v_mfma_f32_16x16x32_bf16 v[96:99], a[244:247], v[100:103], v[96:99]
    v_mul_f32 v141, v141, v17
    v_cvt_pk_bf16_f32 v84, v140, v141
    v_mfma_f32_16x16x32_bf16 v[96:99], a[248:251], v[92:95], v[96:99]
    v_mul_f32 v142, v142, v17
    v_mul_f32 v143, v143, v17
    v_mfma_f32_16x16x32_bf16 v[96:99], a[252:255], v[64:67], v[96:99]
    v_cvt_pk_bf16_f32 v85, v142, v143
    v_mul_f32 v44, v44, v17
    v_mfma_f32_16x16x32_bf16 v[96:99], v[224:227], v[60:63], v[96:99]
    v_mul_f32 v45, v45, v17
    v_cvt_pk_bf16_f32 v86, v44, v45
    v_mfma_f32_16x16x32_bf16 v[96:99], v[228:231], v[28:31], v[96:99]
    v_mul_f32 v46, v46, v17
    v_mul_f32 v47, v47, v17
    v_mfma_f32_16x16x32_bf16 v[80:83], v[232:235], v[104:107], 0
    v_cvt_pk_bf16_f32 v87, v46, v47
    v_mul_f32 v56, v56, v17
    v_mfma_f32_16x16x32_bf16 v[80:83], v[236:239], v[100:103], v[80:83]
    ds_write_b128 v120, v[84:87] offset:1536
    v_mfma_f32_16x16x32_bf16 v[80:83], v[240:243], v[92:95], v[80:83]
    v_mul_f32 v57, v57, v17
    v_cvt_pk_bf16_f32 v56, v56, v57
    v_mfma_f32_16x16x32_bf16 v[80:83], v[244:247], v[64:67], v[80:83]
    v_mul_f32 v58, v58, v17
    v_mul_f32 v59, v59, v17
    v_mfma_f32_16x16x32_bf16 v[80:83], v[248:251], v[60:63], v[80:83]
    v_cvt_pk_bf16_f32 v57, v58, v59
    v_fmac_f32 v54, v77, v77
    v_mfma_f32_16x16x32_bf16 v[80:83], v[252:255], v[28:31], v[80:83]
    s_waitcnt lgkmcnt(1)
    ds_write_b64 v55, v[56:57] offset:1536
    v_mfma_f32_16x16x32_bf16 v[28:31], v[220:223], v[36:39], 0
    v_rsq_f32 v18, v18
    v_mfma_f32_16x16x32_bf16 v[28:31], v[220:223], v[0:3], v[28:31]
    v_mul_f32 v18, s43, v18
    v_mul_f32 v24, v24, v18
    v_mul_f32 v25, v25, v18
    v_cvt_pk_bf16_f32 v0, v24, v25
    v_mul_f32 v26, v26, v18
    v_mul_f32 v27, v27, v18
    v_cvt_pk_bf16_f32 v1, v26, v27
    v_mul_f32 v88, v88, v18
    v_mul_f32 v89, v89, v18
    v_cvt_pk_bf16_f32 v2, v88, v89
    v_mul_f32 v90, v90, v18
    v_mul_f32 v91, v91, v18
    v_cvt_pk_bf16_f32 v3, v90, v91
    v_mul_f32 v72, v72, v18
    v_mul_f32 v73, v73, v18
    v_cvt_pk_bf16_f32 v72, v72, v73
    v_mul_f32 v74, v74, v18
    v_mul_f32 v75, v75, v18
    v_cvt_pk_bf16_f32 v73, v74, v75
    ds_write_b128 v120, v[0:3] offset:3072
    v_fmac_f32 v54, v78, v78
    v_fmac_f32 v54, v79, v79
    v_fmac_f32 v54, v40, v40
    v_fmac_f32 v54, v41, v41
    ds_write_b64 v55, v[72:73] offset:3072
    v_fmac_f32 v54, v42, v42
    v_fmac_f32 v54, v43, v43
    v_fmac_f32 v133, v9, v9
    v_fmac_f32 v133, v10, v10
    v_fmac_f32 v133, v11, v11
    v_fmac_f32 v133, v32, v32
    v_fmac_f32 v133, v33, v33
    v_fmac_f32 v133, v34, v34
    v_fmac_f32 v133, v35, v35
    v_fmac_f32 v133, v12, v12
    v_fmac_f32 v133, v13, v13
    v_fmac_f32 v133, v14, v14
    v_fmac_f32 v133, v15, v15
    v_cvt_pk_bf16_f32 v54, v54, v133
    v_fma_f32 v133, v20, v20, s42
    v_fmac_f32 v133, v21, v21
    v_fmac_f32 v133, v22, v22
    v_fmac_f32 v133, v23, v23
    v_fmac_f32 v133, v96, v96
    v_fmac_f32 v133, v97, v97
    v_fmac_f32 v133, v98, v98
    v_fmac_f32 v133, v99, v99
    v_fmac_f32 v133, v80, v80
    v_fmac_f32 v133, v81, v81
    v_fmac_f32 v133, v82, v82
    v_fmac_f32 v133, v83, v83
    v_cvt_pk_bf16_f32 v55, v133, v133
    ds_write_b64 v130, v[54:55] offset:2048
    v_rcp_f32 v28, v28
    v_lshlrev_b32 v133, 16, v48
    v_and_b32 v48, 0xffff0000, v48
    v_mul_f32 v133, v133, v28
    v_mul_f32 v48, v48, v28
    v_cvt_pk_bf16_f32 v16, v133, v48
    v_lshlrev_b32 v48, 16, v49
    v_and_b32 v49, 0xffff0000, v49
    v_mul_f32 v48, v48, v28
    v_mul_f32 v49, v49, v28
    v_cvt_pk_bf16_f32 v17, v48, v49
    v_lshlrev_b32 v133, 16, v50
    v_and_b32 v50, 0xffff0000, v50
    v_mul_f32 v133, v133, v28
    v_mul_f32 v50, v50, v28
    v_cvt_pk_bf16_f32 v18, v133, v50
    v_lshlrev_b32 v19, 16, v51
    v_and_b32 v51, 0xffff0000, v51
    v_mul_f32 v19, v19, v28
    v_mul_f32 v51, v51, v28
    v_cvt_pk_bf16_f32 v19, v19, v51
    v_lshlrev_b32 v133, 16, v52
    v_and_b32 v52, 0xffff0000, v52
    v_mul_f32 v133, v133, v28
    v_mul_f32 v52, v52, v28
    v_cvt_pk_bf16_f32 v0, v133, v52
    v_lshlrev_b32 v133, 16, v53
    v_and_b32 v53, 0xffff0000, v53
    v_mul_f32 v133, v133, v28
    v_mul_f32 v53, v53, v28
    v_cvt_pk_bf16_f32 v1, v133, v53
    s_waitcnt lgkmcnt(0)
    s_barrier
    ds_write_b128 v138, v[16:19] offset:1536
    v_and_b32 v123, 0xb8000000, v123
    v_mov_b32 v121, 0x3f803f80
    v_cmp_ne_u32 vcc, 0, v123
    s_nop 0
    ds_write_b64 v132, v[0:1] offset:1536
    v_cndmask_b32 v121, 0, v121, vcc
    ds_read_b128 v[36:39], v7 offset:0
    ds_read_b128 v[0:3], v7 offset:1024
    ds_read_b128 v[24:27], v7 offset:2048
    ds_read_b128 v[108:111], v7 offset:3072
    ds_read_b128 v[72:75], v7 offset:4096
    s_waitcnt lgkmcnt(5)
    s_barrier
    s_waitcnt lgkmcnt(4)
    buffer_store_dwordx4 v[36:39], v128, s[28:31], s59 offen sc1
    ds_read_b128 v[28:31], v129 offset:2048
    ds_read_b128 v[16:19], v129 offset:3072
    ds_read_b128 v[104:107], v137 offset:1536
    ds_read_b128 v[100:103], v136 offset:1536
    ds_read_b128 v[92:95], v137 offset:1664
    ds_read_b128 v[84:87], v136 offset:1664
    ds_read_b128 v[44:47], v137 offset:1792
    s_waitcnt lgkmcnt(9)
    buffer_store_dwordx4 v[0:3], v127, s[28:31], s59 offen sc1
    ds_read_b128 v[36:39], v136 offset:1792
    s_waitcnt lgkmcnt(7)
    v_mfma_f32_16x16x32_bf16 v[0:3], v[216:219], v[28:31], 0
    s_waitcnt lgkmcnt(6)
    v_mfma_f32_16x16x32_bf16 v[0:3], v[216:219], v[16:19], v[0:3]
    s_waitcnt lgkmcnt(5)
    v_mfma_f32_16x16x32_bf16 v[16:19], a[216:219], v[104:107], 0
    s_waitcnt lgkmcnt(4)
    v_mfma_f32_16x16x32_bf16 v[16:19], a[220:223], v[100:103], v[16:19]
    s_waitcnt lgkmcnt(3)
    ds_read_b128 v[64:67], v137 offset:0
    ds_read_b128 v[60:63], v136 offset:0
    v_mfma_f32_16x16x32_bf16 v[16:19], a[224:227], v[92:95], v[16:19]
    s_waitcnt lgkmcnt(4)
    ds_read_b128 v[56:59], v137 offset:128
    v_mfma_f32_16x16x32_bf16 v[16:19], a[228:231], v[84:87], v[16:19]
    s_waitcnt lgkmcnt(4)
    buffer_store_dwordx4 v[24:27], v126, s[28:31], s59 offen sc1
    ds_read_b128 v[52:55], v136 offset:128
    v_rsq_f32 v0, v0
    v_mfma_f32_16x16x32_bf16 v[16:19], a[232:235], v[44:47], v[16:19]
    s_waitcnt lgkmcnt(4)
    ds_read_b128 v[48:51], v137 offset:256
    ds_read_b128 v[24:27], v136 offset:256
    v_mfma_f32_16x16x32_bf16 v[16:19], a[236:239], v[36:39], v[16:19]
    v_rsq_f32 v1, v1
    v_mfma_f32_16x16x32_bf16 v[28:31], a[240:243], v[104:107], 0
    v_mul_f32 v0, s43, v0
    v_mul_f32 v1, s43, v1
    v_mfma_f32_16x16x32_bf16 v[28:31], a[244:247], v[100:103], v[28:31]
    v_rsq_f32 v2, v2
    v_mfma_f32_16x16x32_bf16 v[28:31], a[248:251], v[92:95], v[28:31]
    v_mul_f32 v2, s43, v2
    v_mul_f32 v20, v20, v2
    v_mfma_f32_16x16x32_bf16 v[28:31], a[252:255], v[84:87], v[28:31]
    buffer_store_dwordx4 v[108:111], v125, s[28:31], s59 offen sc1
    v_mul_f32 v21, v21, v2
    v_cvt_pk_bf16_f32 v88, v20, v21
    v_mul_f32 v22, v22, v2
    v_mul_f32 v23, v23, v2
    v_mfma_f32_16x16x32_bf16 v[28:31], v[224:227], v[44:47], v[28:31]
    v_cvt_pk_bf16_f32 v89, v22, v23
    v_mul_f32 v96, v96, v2
    v_mfma_f32_16x16x32_bf16 v[28:31], v[228:231], v[36:39], v[28:31]
    v_mul_f32 v97, v97, v2
    v_cvt_pk_bf16_f32 v90, v96, v97
    v_mfma_f32_16x16x32_bf16 v[20:23], v[232:235], v[104:107], 0
    v_mul_f32 v98, v98, v2
    v_mul_f32 v99, v99, v2
    v_mfma_f32_16x16x32_bf16 v[20:23], v[236:239], v[100:103], v[20:23]
    v_cvt_pk_bf16_f32 v91, v98, v99
    v_mul_f32 v80, v80, v2
    v_mfma_f32_16x16x32_bf16 v[20:23], v[240:243], v[92:95], v[20:23]
    ds_write_b128 v135, v[88:91] offset:3072
    v_mfma_f32_16x16x32_bf16 v[20:23], v[244:247], v[84:87], v[20:23]
    buffer_store_dwordx4 v[72:75], v124, s[28:31], s59 offen sc1
    v_mul_f32 v81, v81, v2
    v_cvt_pk_bf16_f32 v136, v80, v81
    v_mul_f32 v82, v82, v2
    v_mul_f32 v83, v83, v2
    v_mfma_f32_16x16x32_bf16 v[20:23], v[248:251], v[44:47], v[20:23]
    v_cvt_pk_bf16_f32 v137, v82, v83
    v_mul_f32 v68, v68, v0
    v_mfma_f32_16x16x32_bf16 v[20:23], v[252:255], v[36:39], v[20:23]
    s_waitcnt lgkmcnt(1)
    ds_write_b64 v134, v[136:137] offset:3072
    v_mfma_f32_16x16x32_bf16 v[36:39], a[216:219], v[64:67], 0
    v_mul_f32 v69, v69, v0
    v_cvt_pk_bf16_f32 v68, v68, v69
    v_mfma_f32_16x16x32_bf16 v[36:39], a[220:223], v[60:63], v[36:39]
    v_mul_f32 v70, v70, v0
    v_mul_f32 v71, v71, v0
    v_mfma_f32_16x16x32_bf16 v[36:39], a[224:227], v[56:59], v[36:39]
    v_cvt_pk_bf16_f32 v69, v70, v71
    v_mul_f32 v76, v76, v0
    v_mfma_f32_16x16x32_bf16 v[36:39], a[228:231], v[52:55], v[36:39]
    v_mul_f32 v77, v77, v0
    v_cvt_pk_bf16_f32 v70, v76, v77
    v_mfma_f32_16x16x32_bf16 v[36:39], a[232:235], v[48:51], v[36:39]
    v_mul_f32 v78, v78, v0
    v_mul_f32 v79, v79, v0
    v_mfma_f32_16x16x32_bf16 v[36:39], a[236:239], v[24:27], v[36:39]
    v_cvt_pk_bf16_f32 v71, v78, v79
    v_mul_f32 v40, v40, v0
    v_mfma_f32_16x16x32_bf16 v[44:47], a[240:243], v[64:67], 0
    ds_write_b128 v135, v[68:71] offset:0
    v_mfma_f32_16x16x32_bf16 v[44:47], a[244:247], v[60:63], v[44:47]
    v_mul_f32 v41, v41, v0
    v_cvt_pk_bf16_f32 v2, v40, v41
    v_mfma_f32_16x16x32_bf16 v[44:47], a[248:251], v[56:59], v[44:47]
    v_mul_f32 v42, v42, v0
    v_mul_f32 v43, v43, v0
    v_mfma_f32_16x16x32_bf16 v[44:47], a[252:255], v[52:55], v[44:47]
    v_cvt_pk_bf16_f32 v3, v42, v43
    v_fma_f32 v7, v16, v16, s42
    v_mfma_f32_16x16x32_bf16 v[44:47], v[224:227], v[48:51], v[44:47]
    ds_write_b64 v134, v[2:3] offset:0
    v_mfma_f32_16x16x32_bf16 v[44:47], v[228:231], v[24:27], v[44:47]
    v_fmac_f32 v7, v17, v17
    v_fmac_f32 v7, v18, v18
    v_mfma_f32_16x16x32_bf16 v[40:43], v[232:235], v[64:67], 0
    v_fmac_f32 v7, v19, v19
    v_fmac_f32 v7, v28, v28
    v_mfma_f32_16x16x32_bf16 v[40:43], v[236:239], v[60:63], v[40:43]
    v_fmac_f32 v7, v29, v29
    v_fmac_f32 v7, v30, v30
    v_mfma_f32_16x16x32_bf16 v[40:43], v[240:243], v[56:59], v[40:43]
    v_fmac_f32 v7, v31, v31
    v_fmac_f32 v7, v20, v20
    v_mfma_f32_16x16x32_bf16 v[40:43], v[244:247], v[52:55], v[40:43]
    v_fmac_f32 v7, v21, v21
    v_fmac_f32 v7, v22, v22
    v_mfma_f32_16x16x32_bf16 v[40:43], v[248:251], v[48:51], v[40:43]
    v_fmac_f32 v7, v23, v23
    v_fma_f32 v133, v36, v36, s42
    v_mfma_f32_16x16x32_bf16 v[40:43], v[252:255], v[24:27], v[40:43]
    s_nop 0
    v_fmac_f32 v133, v37, v37
    v_fmac_f32 v133, v38, v38
    v_fmac_f32 v133, v39, v39
    v_fmac_f32 v133, v44, v44
    v_fmac_f32 v133, v45, v45
    v_fmac_f32 v133, v46, v46
    v_fmac_f32 v133, v47, v47
    v_fmac_f32 v133, v40, v40
    v_fmac_f32 v133, v41, v41
    v_fmac_f32 v133, v42, v42
    v_fmac_f32 v133, v43, v43
    v_cvt_pk_bf16_f32 v120, v133, v7
    ds_write_b64 v130, v[120:121] offset:4096
    v_mul_f32 v8, v8, v1
    v_mul_f32 v9, v9, v1
    v_cvt_pk_bf16_f32 v8, v8, v9
    v_mul_f32 v10, v10, v1
    v_mul_f32 v11, v11, v1
    v_cvt_pk_bf16_f32 v9, v10, v11
    v_mul_f32 v32, v32, v1
    v_mul_f32 v33, v33, v1
    v_cvt_pk_bf16_f32 v10, v32, v33
    v_mul_f32 v34, v34, v1
    v_mul_f32 v35, v35, v1
    v_cvt_pk_bf16_f32 v11, v34, v35
    v_mul_f32 v12, v12, v1
    v_mul_f32 v13, v13, v1
    v_cvt_pk_bf16_f32 v136, v12, v13
    v_mul_f32 v14, v14, v1
    v_mul_f32 v15, v15, v1
    v_cvt_pk_bf16_f32 v137, v14, v15
    ds_write_b128 v135, v[8:11] offset:1536
    s_waitcnt lgkmcnt(1)
    s_barrier
    ds_write_b64 v134, v[136:137] offset:1536
    ds_read_b128 v[8:11], v129 offset:4096
    ds_read_b128 v[0:3], v129 offset:5120
    s_waitcnt lgkmcnt(2)
    s_barrier
    s_waitcnt lgkmcnt(1)
    v_mfma_f32_16x16x32_bf16 v[24:27], v[216:219], v[8:11], 0
    s_waitcnt lgkmcnt(0)
    ds_read_b128 v[48:51], v139 offset:0
    ds_read_b128 v[32:35], v139 offset:1024
    v_mfma_f32_16x16x32_bf16 v[24:27], v[216:219], v[0:3], v[24:27]
    s_nop 0
    ds_read_b128 v[12:15], v139 offset:2048
    s_nop 2
    ds_read_b128 v[8:11], v139 offset:3072
    s_nop 1
    v_rsq_f32 v24, v24
    ds_read_b128 v[0:3], v139 offset:4096
    v_mul_f32 v24, s43, v24
    v_mul_f32 v36, v36, v24
    v_mul_f32 v37, v37, v24
    v_cvt_pk_bf16_f32 v36, v36, v37
    v_mul_f32 v38, v38, v24
    v_mul_f32 v39, v39, v24
    v_cvt_pk_bf16_f32 v37, v38, v39
    v_mul_f32 v44, v44, v24
    v_mul_f32 v45, v45, v24
    s_waitcnt lgkmcnt(4)
    buffer_store_dwordx4 v[48:51], v128, s[28:31], s58 offen sc1
    v_cvt_pk_bf16_f32 v38, v44, v45
    v_mul_f32 v46, v46, v24
    v_mul_f32 v47, v47, v24
    v_cvt_pk_bf16_f32 v39, v46, v47
    v_mul_f32 v40, v40, v24
    v_mul_f32 v41, v41, v24
    v_cvt_pk_bf16_f32 v128, v40, v41
    v_mul_f32 v42, v42, v24
    v_mul_f32 v43, v43, v24
    v_cvt_pk_bf16_f32 v129, v42, v43
    ds_write_b128 v138, v[36:39] offset:0
    v_rsq_f32 v25, v25
    v_cmp_neq_f32 vcc, 0, v26
    v_mul_f32 v25, s43, v25
    s_waitcnt lgkmcnt(1)
    buffer_store_dwordx4 v[32:35], v127, s[28:31], s58 offen sc1
    ds_write_b64 v132, v[128:129] offset:0
    v_mul_f32 v16, v16, v25
    v_mul_f32 v17, v17, v25
    v_cvt_pk_bf16_f32 v16, v16, v17
    v_mul_f32 v18, v18, v25
    v_mul_f32 v19, v19, v25
    v_cvt_pk_bf16_f32 v17, v18, v19
    v_mul_f32 v28, v28, v25
    v_mul_f32 v29, v29, v25
    v_cvt_pk_bf16_f32 v18, v28, v29
    v_mul_f32 v30, v30, v25
    v_mul_f32 v31, v31, v25
    v_cvt_pk_bf16_f32 v19, v30, v31
    v_mul_f32 v20, v20, v25
    v_mul_f32 v21, v21, v25
    v_cvt_pk_bf16_f32 v128, v20, v21
    v_mul_f32 v22, v22, v25
    v_mul_f32 v23, v23, v25
    v_cvt_pk_bf16_f32 v129, v22, v23
    buffer_store_dwordx4 v[12:15], v126, s[28:31], s58 offen sc1
    ds_write_b128 v138, v[16:19] offset:1536
    ds_write_b64 v132, v[128:129] offset:1536
    buffer_store_dwordx4 v[8:11], v125, s[28:31], s58 offen sc1
    s_waitcnt lgkmcnt(0)
    s_barrier
    buffer_store_dwordx4 v[0:3], v124, s[28:31], s58 offen sc1
    ds_read_b128 v[12:15], v131 offset:0
    ds_read_b128 v[8:11], v131 offset:1024
    ds_read_b128 v[0:3], v131 offset:2048
    s_waitcnt lgkmcnt(2)
    buffer_store_dwordx4 v[12:15], v4, s[28:31], 0 offen sc1
    s_waitcnt lgkmcnt(0)
    buffer_store_dwordx4 v[8:11], v5, s[28:31], 0 offen sc1
    buffer_store_dwordx4 v[0:3], v6, s[28:31], 0 offen sc1
    s_nop 4
    s_cbranch_vccnz L_slow
L_fin:
    s_cmp_eq_u32 s2, 251
    s_cbranch_scc1 L_again
L_end:
    s_endpgm
L_slow:
    s_waitcnt vmcnt(0) lgkmcnt(0)
    s_nop 15
    s_barrier
    s_lshr_b32 s66, s64, 20
    v_mbcnt_lo_u32_b32 v157, -1, 0
    v_mbcnt_hi_u32_b32 v157, -1, v157
    s_load_dwordx16 s[4:19], s[0:1], 0
    s_load_dwordx4 s[20:23], s[0:1], 64
    s_load_dwordx2 s[38:39], s[0:1], 80
    s_bfe_u32 s88, s2, 0x50003
    s_lshl2_add_u32 s88, s88, s68
    v_lshlrev_b32 v72, 7, v157
    s_mul_i32 s89, s88, 576
    s_mul_i32 s88, s88, 1728
    v_min_u32 v74, 1664, v72
    v_min_u32 v73, 512, v72
    s_mov_b32 s34, 221184
    s_mov_b32 s35, 0x20000
    s_mov_b32 s78, 73728
    s_mov_b32 s79, 0x20000
    v_and_b32 v75, 15, v157
    v_lshrrev_b32 v160, 4, v157
    v_lshrrev_b32 v72, 2, v75
    v_and_b32 v5, 3, v75
    s_mul_i32 s87, s68, 192
    v_mad_u32_u24 v19, v75, 12, s87
    v_lshlrev_b32 v31, 1, v75
    v_lshlrev_b32 v11, 1, v72
    v_lshl_add_u32 v11, v160, 5, v11
    s_movk_i32 s86, 384
    s_mov_b32 s26, 100270464
    s_mov_b32 s27, 0x20000
    s_mov_b32 s30, 0
    s_mov_b32 s31, 0x20000
    s_mul_i32 s96, s68, 288
    s_and_b32 s97, s68, 1
    s_lshl_b32 s97, s97, 2
    s_mov_b32 s98, 193536
    s_waitcnt lgkmcnt(0)
    s_mov_b32 s24, s4
    s_mov_b32 s25, s5
    s_mov_b32 s32, s6
    s_mov_b32 s33, s7
    s_mov_b32 s76, s8
    s_mov_b32 s77, s9
    buffer_load_dword a254, v74, s[32:35], s88 offen
    buffer_load_dword a253, v73, s[76:79], s89 offen
    s_load_dwordx2 s[82:83], s[10:11], 0
    s_movk_i32 s18, 676
    s_mov_b32 s19, 0x20000
    buffer_load_dwordx3 v[28:30], v19, s[16:19], 0 offen
    s_mov_b32 s99, 589824
    v_add_u32 v124, s96, v157
    v_mul_u32_u24 v74, 2731, v124
    v_mul_u32_u24 v73, 6242, v124
    v_lshrrev_b32 v74, 16, v74
    s_lshr_b32 s94, s2, 3
    s_mul_i32 s70, s94, 167
    global_load_ushort v16, v31, s[12:13]
    v_lshrrev_b32 v73, 20, v73
    v_and_or_b32 v8, v74, 3, s97
    v_xor_b32 v8, v124, v8
    v_lshl_add_u32 v128, v8, 4, s99
    v_mad_u32_u24 v128, v73, s98, v128
    s_min_u32 s95, s94, 7
    s_add_u32 s70, s70, s95
    global_load_ushort v17, v31, s[12:13] offset:32
    v_add_u32 v10, 64, v124
    v_mul_u32_u24 v150, 2731, v10
    v_mul_u32_u24 v156, 6242, v10
    v_lshrrev_b32 v150, 16, v150
    v_lshrrev_b32 v156, 20, v156
    s_and_b32 s95, s2, 7
    s_mul_i32 s95, s95, 20
    global_load_ushort v148, v11, s[14:15] offset:0
    v_and_or_b32 v9, v150, 3, s97
    v_xor_b32 v9, v10, v9
    v_lshl_add_u32 v127, v9, 4, s99
    v_mad_u32_u24 v127, v156, s98, v127
    v_add_u32 v18, 128, v124
    s_add_u32 s69, s70, s95
    s_add_u32 s70, s70, 140
    global_load_ushort v158, v11, s[14:15] offset:8
    v_mul_u32_u24 v10, 2731, v18
    v_mul_u32_u24 v4, 6242, v18
    v_lshrrev_b32 v10, 16, v10
    v_lshrrev_b32 v4, 20, v4
    v_and_or_b32 v31, v10, 3, s97
    s_movk_i32 s62, 2688
    s_movk_i32 s71, 20
    global_load_ushort v149, v11, s[14:15] offset:16
    v_xor_b32 v31, v18, v31
    v_lshl_add_u32 v126, v31, 4, s99
    v_mad_u32_u24 v126, v4, s98, v126
    v_add_u32 v125, 192, v124
    v_mul_u32_u24 v159, 2731, v125
    s_cmp_lt_u32 s94, 7
    s_cselect_b32 s73, 28, 27
    global_load_ushort v132, v11, s[14:15] offset:24
    v_mul_u32_u24 v18, 6242, v125
    v_lshrrev_b32 v159, 16, v159
    v_lshrrev_b32 v18, 20, v18
    v_and_or_b32 v11, v159, 3, s97
    v_xor_b32 v11, v125, v11
    v_lshl_add_u32 v125, v11, 4, s99
    v_mad_u32_u24 v125, v18, s98, v125
    v_add_u32 v6, 256, v124
    v_mul_u32_u24 v151, 2731, v6
    v_mul_u32_u24 v11, 6242, v6
    v_lshrrev_b32 v151, 16, v151
    v_lshrrev_b32 v11, 20, v11
    v_and_or_b32 v124, v151, 3, s97
    v_xor_b32 v124, v6, v124
    v_lshl_add_u32 v124, v124, 4, s99
    v_mad_u32_u24 v124, v11, s98, v124
    s_mov_b32 s93, 1769472
    s_mul_i32 s54, s68, 5120
    s_cmp_ge_u32 s2, 248
    s_cbranch_scc1 L_bndS
L_bndrS:
    s_mov_b32 s63, 1180032
    s_mul_i32 s94, s69, 58255
    s_lshr_b32 s94, s94, 22
    s_mul_i32 s94, s94, s63
    s_mul_i32 s72, s69, s62
    s_add_u32 s72, s72, s94
    v_lshl_or_b32 v73, v157, 4, 2.0
    s_sub_u32 s94, s73, 1
    s_max_u32 s94, s94, 20
    s_mul_i32 s95, s68, -44
    s_movk_i32 s99, -24
    s_add_u32 m0, s54, 0
    v_and_b32 v18, -4, v10
    s_mul_i32 s85, s68, 96
    s_sub_u32 s100, s85, 1024
    buffer_load_dwordx4 v128, s[24:27], s72 offen nt lds
    s_add_u32 m0, s54, 1024
    v_mad_u32_u24 v11, v18, 3, v10
    v_add_u32 v11, s95, v11
    v_mad_i32_i24 v10, v10, s99, v31
    v_med3_u32 v18, v11, 20, s94
    v_add_u32 v18, s70, v18
    v_add_u32 v31, s69, v11
    s_sub_u32 s87, s85, 2048
    s_movk_i32 s91, 1152
    buffer_load_dwordx4 v127, s[24:27], s72 offen nt lds
    v_cmp_gt_u32 vcc, s71, v11
    v_lshl_add_u32 v10, v10, 4, s93
    s_add_u32 m0, s54, 43008
    v_cndmask_b32 v31, v18, v31, vcc
    v_mul_u32_u24 v18, 58255, v31
    v_mad_u32_u24 v10, v31, s62, v10
    v_lshrrev_b32 v18, 22, v18
    v_mad_u32_u24 v10, v18, s63, v10
    s_mul_i32 s90, s68, 3072
    s_add_u32 s90, s90, 61440
    buffer_load_dwordx4 v10, s[24:27], 0 offen  lds
    v_lshlrev_b32 v11, 16, v11
    s_add_u32 m0, s54, 2048
    v_and_b32 v31, -4, v150
    v_mad_u32_u24 v18, v31, 3, v150
    v_add_u32 v18, s95, v18
    v_mad_i32_i24 v9, v150, s99, v9
    v_med3_u32 v31, v18, 20, s94
    s_mov_b32 s28, s22
    s_mov_b32 s29, s23
    buffer_load_dwordx4 v126, s[24:27], s72 offen nt lds
    v_add_u32 v31, s70, v31
    v_add_u32 v150, s69, v18
    v_cmp_gt_u32 vcc, s71, v18
    v_lshl_add_u32 v9, v9, 4, s93
    s_add_u32 m0, s54, 41984
    v_cndmask_b32 v150, v31, v150, vcc
    v_mul_u32_u24 v31, 58255, v150
    v_mad_u32_u24 v9, v150, s62, v9
    v_lshrrev_b32 v31, 22, v31
    v_mad_u32_u24 v9, v31, s63, v9
    s_mov_b32 s41, 0x2a8cbccc
    s_mov_b32 s42, 0x38fba882
    buffer_load_dwordx4 v9, s[24:27], 0 offen  lds
    v_lshl_or_b32 v11, v18, 8, v11
    s_add_u32 m0, s54, 3072
    v_cmp_gt_u32 vcc, 32, v157
    v_and_b32 v31, -4, v74
    v_mad_u32_u24 v18, v31, 3, v74
    v_cndmask_b32 v124, v73, v124, vcc
    v_add_u32 v18, s95, v18
    s_mov_b32 s43, 0x415db3d7
    s_mov_b32 s44, 61440
    buffer_load_dwordx4 v125, s[24:27], s72 offen nt lds
    s_add_u32 m0, s54, 4096
    v_mad_i32_i24 v8, v74, s99, v8
    v_med3_u32 v31, v18, 20, s94
    v_add_u32 v31, s70, v31
    v_add_u32 v74, s69, v18
    v_cmp_gt_u32 vcc, s71, v18
    v_lshl_add_u32 v8, v8, 4, s93
    s_mul_i32 s93, s68, 6
    s_lshl_b32 s94, s97, 1
    buffer_load_dwordx4 v124, s[24:27], s72 offen nt lds
    v_cndmask_b32 v74, v31, v74, vcc
    v_mul_u32_u24 v31, 58255, v74
    v_mad_u32_u24 v8, v74, s62, v8
    v_lshrrev_b32 v31, 22, v31
    v_mad_u32_u24 v8, v31, s63, v8
    s_add_u32 m0, s54, 40960
    v_lshl_or_b32 v11, v18, 0, v11
    s_mov_b32 s45, 40960
    s_mov_b32 s46, 20480
    buffer_load_dwordx4 v8, s[24:27], 0 offen nt lds
    v_mul_u32_u24 v6, 10923, v157
    v_lshrrev_b32 v4, 17, v6
    v_lshrrev_b32 v6, 16, v6
    v_mad_i32_i24 v7, v6, -6, v157
    v_bitop3_b32 v4, v4, v6, 4 bitop3:0x28
    v_lshl_add_u32 v7, v7, 4, s85
    v_mul_u32_u24 v4, 3, v4
    v_xor_b32 v6, v6, v4
    v_mad_u32_u24 v4, v6, s91, v7
    v_add_u32 v18, 64, v157
    v_mul_u32_u24 v31, 10923, v18
    v_lshrrev_b32 v156, 17, v31
    v_lshrrev_b32 v31, 16, v31
    v_mad_i32_i24 v159, v31, -6, v18
    v_bitop3_b32 v156, v156, v31, 4 bitop3:0x28
    v_lshl_add_u32 v159, v159, 4, s100
    v_mul_u32_u24 v156, 3, v156
    v_xor_b32 v31, v31, v156
    v_mad_u32_u24 v156, v31, s91, v159
    v_add_u32 v18, 128, v157
    v_mul_u32_u24 v74, 10923, v18
    v_lshrrev_b32 v120, 17, v74
    v_lshrrev_b32 v74, 16, v74
    v_mad_i32_i24 v18, v74, -6, v18
    v_bitop3_b32 v120, v120, v74, 4 bitop3:0x28
    v_lshl_add_u32 v18, v18, 4, s87
    v_mul_u32_u24 v120, 3, v120
    v_xor_b32 v74, v74, v120
    v_mad_u32_u24 v120, v74, s91, v18
    v_mad_u32_u24 v121, v6, s86, v7
    v_mad_u32_u24 v25, v31, s86, v159
    v_mad_u32_u24 v24, v74, s86, v18
    s_add_u32 m0, s90, 0
    s_mov_b32 s92, 0
    buffer_load_dwordx4 v4, s[32:35], s92 offen offset:0 lds
    v_mov_b32 v18, 0x3f803f80
    v_cmp_eq_u32 vcc, 0, v5
    v_and_b32 v31, 1, v157
    v_lshlrev_b32 v31, 4, v31
    v_cndmask_b32 v220, 0, v18, vcc
    v_cndmask_b32 v221, 0, v18, vcc
    v_cndmask_b32 v222, 0, v18, vcc
    v_cndmask_b32 v223, 0, v18, vcc
    v_mov_b32 v18, 0x3f80
    v_lshlrev_b32 v18, v31, v18
    v_cmp_gt_u32 vcc, 2, v5
    v_mov_b32 v171, 0
    v_mov_b32 v167, 0
    v_cndmask_b32 v216, 0, v18, vcc
    v_cndmask_b32 v218, 0, v18, vcc
    v_cmp_le_u32 vcc, 2, v5
    v_mov_b32 v163, 0
    v_mov_b32 v159, 0
    v_cndmask_b32 v217, 0, v18, vcc
    v_cndmask_b32 v219, 0, v18, vcc
    v_cmp_eq_u32 vcc, v160, v72
    v_mov_b32 v150, 0
    v_mov_b32 v151, 0
    v_cndmask_b32 v26, 0, v216, vcc
    v_cndmask_b32 v27, 0, v217, vcc
    v_mov_b32 v144, 0
    v_mov_b32 v145, 0
    v_mov_b32 v138, 0
    v_mov_b32 v139, 0
    v_lshrrev_b32 v6, 1, v160
    v_lshl_add_u32 v7, v160, 2, v72
    v_lshl_add_u32 v7, v6, 3, v7
    v_mul_u32_u24 v7, 96, v7
    v_add_u32 v7, s90, v7
    v_lshl_add_u32 v6, v5, 4, v7
    v_lshl_add_u32 v7, v5, 3, v7
    s_waitcnt lgkmcnt(0)
    s_lshl_b32 s84, s68, 4
    s_lshr_b64 s[82:83], s[82:83], s84
    s_lshl_b32 s82, s82, 16
    v_mov_b32 v74, s82
    v_min_f32 v74, 0x40930000, v74
    v_max_f32 v74, 0xc2c80000, v74
    v_mul_f32 v74, 0x3fb8aa3b, v74
    v_exp_f32 v74, v74
    v_mov_b32 v18, 0
    v_cvt_pk_bf16_f32 v74, v74, v74
    v_lshlrev_b32 v74, 16, v74
    v_mul_f32 v74, 0x4038aa3b, v74
    v_mov_b32 v31, 0
    v_readfirstlane_b32 s55, v74
    v_add_f32 v74, v74, v74
    v_mul_u32_u24 v122, 5120, v160
    v_readfirstlane_b32 s52, v74
    v_add_u32 v122, v19, v122
    s_mov_b32 s84, 0x41b8aa3b
    v_mov_b32 v131, 0xc138aa3b
    v_mul_u32_u24 v74, 5120, v72
    v_mad_u32_u24 v74, v5, s86, v74
    v_and_b32 v19, 7, v75
    s_mov_b32 s47, 0
    s_mov_b32 s57, s72
    buffer_load_dwordx4 v156, s[32:35], s92 offen offset:1024 lds
    v_xor_b32 v123, v19, v160
    v_lshl_add_u32 v147, v123, 4, v74
    v_xor_b32 v146, 64, v147
    v_add_u32 v137, 40960, v147
    v_xor_b32 v136, 64, v137
    v_add_u32 v74, 61440, v74
    v_add_u32 v123, s93, v160
    s_mov_b32 s58, 0
    s_mov_b32 s59, 0
    buffer_load_dwordx4 v120, s[32:35], s92 offen offset:2048 lds
    s_add_u32 m0, s90, 12288
    s_mov_b32 s92, 36864
    v_xor_b32 v123, v19, v123
    v_lshl_add_u32 v135, v123, 4, v74
    v_lshrrev_b32 v123, 1, v160
    v_add3_u32 v123, v123, s93, 4
    v_xor_b32 v123, v19, v123
    s_add_u32 s93, s54, 20480
    s_mov_b32 s60, 0
    buffer_load_dwordx4 v4, s[32:35], s92 offen offset:0 lds
    s_waitcnt vmcnt(16)
    v_lshl_or_b32 v16, v17, 16, v16
    v_cmp_gt_u32 vcc, 16, v157
    v_mov_b32 v17, 0
    v_lshl_add_u32 v123, v123, 4, v74
    v_cndmask_b32 v19, 0, v16, vcc
    v_cndmask_b32 v16, 0, v16, vcc
    v_and_b32 v74, 1, v160
    v_mfma_f32_16x16x16_bf16 v[0:3], v[18:19], v[28:29], 0
    s_waitcnt vmcnt(14)
    s_mov_b32 s65, -1
    v_lshl_or_b32 v148, v158, 16, v148
    v_lshl_add_u32 v134, v74, 3, v123
    v_mfma_f32_16x16x16_bf16 v[12:15], v[16:17], v[28:29], 0
    s_mov_b32 s61, 1
    v_lshlrev_b32 v74, 4, v157
    v_add_u32 v133, s93, v74
    v_mfma_f32_16x16x16_bf16 v[20:23], v[16:17], v[30:31], 0
    s_waitcnt vmcnt(12)
    s_lshr_b32 s93, s68, 1
    buffer_load_dwordx4 v156, s[32:35], s92 offen offset:1024 lds
    v_lshl_or_b32 v149, v132, 16, v149
    v_max_f32 v0, 0, v0
    v_max_f32 v12, 0, v12
    v_max_f32 v13, 0, v13
    v_max_f32 v14, 0, v14
    v_max_f32 v15, 0, v15
    v_cvt_pk_bf16_f32 v12, v12, v13
    v_cvt_pk_bf16_f32 v13, v14, v15
    v_max_f32 v1, 0, v1
    v_max_f32 v2, 0, v2
    v_mfma_f32_16x16x16_bf16 v[16:19], v[148:149], v[12:13], 0
    s_lshl_b32 s93, s93, 10
    v_max_f32 v3, 0, v3
    v_cvt_pk_bf16_f32 v0, v0, v1
    v_cvt_pk_bf16_f32 v1, v2, v3
    v_max_f32 v20, 0, v20
    v_max_f32 v21, 0, v21
    v_mfma_f32_16x16x16_bf16 v[12:15], v[148:149], v[0:1], 0
    s_add_u32 s93, s93, s94
    v_max_f32 v22, 0, v22
    v_max_f32 v23, 0, v23
    v_cvt_pk_bf16_f32 v20, v20, v21
    v_cvt_pk_bf16_f32 v21, v22, v23
    v_cvt_pk_bf16_f32 v16, v16, v16
    v_lshlrev_b32 v16, 16, v16
    v_mfma_f32_16x16x16_bf16 v[0:3], v[148:149], v[20:21], 0
    s_movk_i32 s4, 112
    v_mul_f32 v16, 0xbfb8aa3b, v16
    v_cvt_pk_bf16_f32 v12, v12, v12
    v_exp_f32 v16, v16
    v_lshlrev_b32 v12, 16, v12
    v_add_f32 v16, 1.0, v16
    v_rcp_f32 v16, v16
    v_mul_f32 v12, 0xbfb8aa3b, v12
    v_cvt_pk_bf16_f32 v16, v16, v16
    v_lshlrev_b32 v16, 16, v16
    v_fma_f32 v16, v16, s84, v131
    s_mov_b32 s5, 0
    s_mov_b32 s6, 0
    ds_write_b32 v122, v16 offset:44032
    v_exp_f32 v12, v12
    v_cvt_pk_bf16_f32 v0, v0, v0
    v_add_f32 v12, 1.0, v12
    v_rcp_f32 v12, v12
    v_lshlrev_b32 v0, 16, v0
    v_cvt_pk_bf16_f32 v12, v12, v12
    v_lshlrev_b32 v12, 16, v12
    v_fma_f32 v12, v12, s84, v131
    s_mov_b32 s12, 0
    s_mov_b32 s64, 3
    ds_write_b32 v122, v12 offset:44036
    v_mul_f32 v0, 0xbfb8aa3b, v0
    v_exp_f32 v0, v0
    v_add_u32 v129, 81920, v74
    v_add_f32 v0, 1.0, v0
    v_rcp_f32 v0, v0
    v_add_u32 v130, s93, v129
    v_cvt_pk_bf16_f32 v0, v0, v0
    v_lshlrev_b32 v0, 16, v0
    v_fma_f32 v0, v0, s84, v131
    s_mul_i32 s93, s68, 7168
    s_add_u32 s93, s93, 135168
    ds_write_b32 v122, v0 offset:44040
    v_mul_u32_u24 v74, 1792, v160
    v_add_u32 v123, s93, v74
    v_mul_u32_u24 v74, 112, v75
    v_add_u32 v158, v74, v123
    v_subrev_u32 v158, 28672, v158
    v_cmp_eq_u32 vcc, 0, v72
    v_add_u32 v74, 16, v123
    v_mov_b32 v122, 0
    v_cndmask_b32 v132, v73, v123, vcc
    v_cmp_eq_u32 vcc, 3, v5
    s_mov_b32 s10, 81924
    s_mov_b32 s11, 0x20000
    v_cndmask_b32 v132, v132, v74, vcc
    v_mul_u32_u24 v74, 1792, v72
    v_lshl_add_u32 v74, v160, 3, v74
    v_lshl_add_u32 v74, v5, 1, v74
    v_add_u32 v74, s93, v74
    v_cmp_gt_u32 vcc, 3, v160
    v_mov_b32 v123, v74
    s_add_u32 s93, s69, 1
    v_cndmask_b32 v131, v73, v74, vcc
    s_mul_i32 s94, s93, 58255
    s_lshr_b32 s94, s94, 22
    s_mul_i32 s94, s94, s63
    s_mul_i32 s56, s93, s62
    s_add_u32 s56, s56, s94
    s_sub_u32 s93, s71, 1
    s_cmp_eq_u32 s68, 0
    s_cselect_b32 s13, s93, -1
    s_cmp_gt_u32 s73, 20
    s_cselect_b32 s13, s13, -1
    s_and_b32 s93, s2, -8
    s_sub_u32 s93, 81920, s93
    s_waitcnt lgkmcnt(0)
    s_barrier
    s_sub_u32 s8, s38, s93
    s_subb_u32 s9, s39, 0
    s_mov_b32 s39, 0x00010001
    s_add_u32 s101, s54, 44032
    v_mul_u32_u24 v149, 48, v72
    v_lshl_add_u32 v149, v5, 2, v149
    v_mul_u32_u24 v5, 48, v160
    v_add_u32 v199, 0, v149
    v_mul_u32_u24 v148, 37, v199
    v_lshrrev_b32 v148, 10, v148
    v_mad_u32_u24 v199, v148, 24, v199
    v_add_u32 v199, s101, v199
    v_add_u32 v161, 16, v149
    v_mul_u32_u24 v148, 37, v161
    v_lshrrev_b32 v148, 10, v148
    v_mad_u32_u24 v161, v148, 24, v161
    v_add_u32 v161, s101, v161
    v_add_u32 v148, 32, v149
    v_mul_u32_u24 v162, 37, v148
    v_lshrrev_b32 v162, 10, v162
    v_mad_u32_u24 v148, v162, 24, v148
    v_add_u32 v148, s101, v148
    v_add_u32 v176, 0, v5
    v_mul_u32_u24 v162, 37, v176
    v_lshrrev_b32 v162, 10, v162
    v_mad_u32_u24 v176, v162, 24, v176
    v_add_u32 v169, 4, v5
    v_mul_u32_u24 v162, 37, v169
    v_lshrrev_b32 v162, 10, v162
    v_mad_u32_u24 v169, v162, 24, v169
    v_add_u32 v170, 8, v5
    v_mul_u32_u24 v162, 37, v170
    v_lshrrev_b32 v162, 10, v162
    v_mad_u32_u24 v170, v162, 24, v170
    v_add_u32 v183, 12, v5
    v_mul_u32_u24 v162, 37, v183
    v_lshrrev_b32 v162, 10, v162
    v_mad_u32_u24 v183, v162, 24, v183
    v_add_u32 v168, 16, v5
    v_mul_u32_u24 v162, 37, v168
    v_lshrrev_b32 v162, 10, v162
    v_mad_u32_u24 v168, v162, 24, v168
    v_add_u32 v165, 20, v5
    v_mul_u32_u24 v162, 37, v165
    v_lshrrev_b32 v162, 10, v162
    v_mad_u32_u24 v165, v162, 24, v165
    v_add_u32 v166, 24, v5
    v_mul_u32_u24 v162, 37, v166
    v_lshrrev_b32 v162, 10, v162
    v_mad_u32_u24 v166, v162, 24, v166
    v_add_u32 v179, 28, v5
    v_mul_u32_u24 v162, 37, v179
    v_lshrrev_b32 v162, 10, v162
    v_mad_u32_u24 v179, v162, 24, v179
    v_add_u32 v164, 32, v5
    v_mul_u32_u24 v162, 37, v164
    v_lshrrev_b32 v162, 10, v162
    v_mad_u32_u24 v164, v162, 24, v164
    v_add_u32 v74, 36, v5
    v_mul_u32_u24 v72, 37, v74
    v_lshrrev_b32 v72, 10, v72
    v_mad_u32_u24 v74, v72, 24, v74
    v_add_u32 v162, 40, v5
    v_mul_u32_u24 v72, 37, v162
    v_lshrrev_b32 v72, 10, v72
    s_lshr_b32 s93, s68, 1
    s_mul_i32 s93, s93, 30720
    buffer_load_dwordx4 v120, s[32:35], s92 offen offset:2048 lds
    s_add_u32 m0, s90, 24576
    s_mov_b32 s92, 73728
    ds_read_b32 v208, v199
    v_mad_u32_u24 v162, v72, 24, v162
    v_add_u32 v5, 44, v5
    v_mul_u32_u24 v72, 37, v5
    v_lshrrev_b32 v72, 10, v72
    v_mad_u32_u24 v5, v72, 24, v5
    v_lshl_add_u32 v72, v160, 4, v149
    v_mul_u32_u24 v177, 37, v72
    v_lshrrev_b32 v177, 10, v177
    v_mad_u32_u24 v72, v177, 24, v72
    v_mov_b32 v177, 336
    v_cmp_gt_u32 vcc, 3, v160
    v_sub_u32 v204, v199, v176
    s_and_b32 s94, s68, 1
    v_cndmask_b32 v72, v177, v72, vcc
    v_sub_u32 v72, s101, v72
    s_mul_i32 s94, s94, -2304
    s_add_u32 s93, s93, s94
    ds_read_b32 v204, v204 offset:336
    buffer_load_dwordx4 v4, s[32:35], s92 offen offset:0 lds
    v_sub_u32 v205, v199, v169
    v_sub_u32 v206, v199, v170
    v_sub_u32 v207, v199, v183
    v_sub_u32 v200, v199, v168
    s_lshl_b32 s94, s97, 4
    ds_read_b32 v205, v205 offset:336
    v_sub_u32 v201, v199, v165
    v_sub_u32 v202, v199, v166
    v_sub_u32 v203, v199, v179
    v_sub_u32 v196, v199, v164
    buffer_load_dwordx4 v156, s[32:35], s92 offen offset:1024 lds
    ds_read_b32 v206, v206 offset:336
    v_sub_u32 v197, v199, v74
    v_sub_u32 v198, v199, v162
    v_sub_u32 v199, v199, v5
    v_sub_u32 v192, v161, v176
    v_sub_u32 v193, v161, v169
    ds_read_b32 v207, v207 offset:336
    v_sub_u32 v194, v161, v170
    v_sub_u32 v195, v161, v183
    v_sub_u32 v188, v161, v168
    v_sub_u32 v189, v161, v165
    v_sub_u32 v190, v161, v166
    ds_read_b32 v200, v200 offset:336
    v_sub_u32 v191, v161, v179
    v_sub_u32 v184, v161, v164
    v_sub_u32 v185, v161, v74
    v_sub_u32 v186, v161, v162
    buffer_load_dwordx4 v120, s[32:35], s92 offen offset:2048 lds
    s_add_u32 m0, s90, 36864
    s_mov_b32 s92, 110592
    ds_read_b32 v201, v201 offset:336
    v_sub_u32 v187, v161, v5
    v_sub_u32 v180, v148, v176
    v_sub_u32 v181, v148, v169
    v_sub_u32 v182, v148, v170
    v_sub_u32 v183, v148, v183
    s_waitcnt vmcnt(9)
    s_barrier
    ds_read_b32 v202, v202 offset:336
    v_sub_u32 v176, v148, v168
    v_sub_u32 v177, v148, v165
    v_sub_u32 v178, v148, v166
    v_sub_u32 v179, v148, v179
    v_sub_u32 v172, v148, v164
    ds_read_b32 v203, v203 offset:336
    v_sub_u32 v173, v148, v74
    v_sub_u32 v174, v148, v162
    v_sub_u32 v175, v148, v5
    v_mov_b32 v5, 0xf149f2ca
    v_and_b32 v74, 8, v75
    ds_read_b32 v196, v196 offset:336
    v_add_u32 v74, v74, v75
    v_mul_u32_u24 v74, 96, v74
    buffer_load_dwordx4 v4, s[32:35], s92 offen offset:0 lds
    ds_read_b32 v197, v197 offset:336
    v_add_u32 v74, s90, v74
    v_lshl_add_u32 v19, v160, 4, v74
    v_lshl_add_u32 v18, v160, 3, v74
    v_add_u32 v17, s93, v19
    v_add_u32 v16, s93, v18
    s_lshr_b32 s93, s68, 1
    s_mul_i32 s93, s93, 5120
    ds_read_b32 v198, v198 offset:336
    v_lshlrev_b32 v162, 4, v160
    v_add_u32 v162, 4608, v162
    s_add_u32 s93, s93, s94
    v_add_u32 v74, s93, v162
    v_cmp_eq_u32 vcc, 0, v75
    ds_read_b32 v199, v199 offset:336
    buffer_load_dwordx4 v156, s[32:35], s92 offen offset:1024 lds
    v_cndmask_b32 v74, v73, v74, vcc
    ds_read_b32 v211, v72 offset:672
    ds_read_b32 v192, v192 offset:336
    ds_read_b32 v193, v193 offset:336
    buffer_load_dwordx4 v120, s[32:35], s92 offen offset:2048 lds
    s_add_u32 m0, s90, 49152
    s_mov_b32 s92, 147456
    ds_read_b32 v194, v194 offset:336
    ds_read_b32 v195, v195 offset:336
    ds_read_b32 v188, v188 offset:336
    buffer_load_dwordx4 v4, s[32:35], s92 offen offset:0 lds
    ds_read_b32 v189, v189 offset:336
    ds_read_b32 v190, v190 offset:336
    ds_read_b32 v191, v191 offset:336
    ds_read_b32 v184, v184 offset:336
    buffer_load_dwordx4 v156, s[32:35], s92 offen offset:1024 lds
    ds_read_b32 v185, v185 offset:336
    ds_read_b32 v186, v186 offset:336
    ds_read_b32 v187, v187 offset:336
    buffer_load_dwordx4 v120, s[32:35], s92 offen offset:2048 lds
    s_add_u32 m0, s90, 61440
    s_mov_b32 s92, 184320
    ds_read_b32 v209, v161
    ds_read_b32 v180, v180 offset:336
    ds_read_b32 v181, v181 offset:336
    buffer_load_dwordx4 v4, s[32:35], s92 offen offset:0 lds
    ds_read_b32 v182, v182 offset:336
    ds_read_b32 v183, v183 offset:336
    ds_read_b32 v176, v176 offset:336
    ds_read_b32 v177, v177 offset:336
    buffer_load_dwordx4 v156, s[32:35], s92 offen offset:1024 lds
    ds_read_b32 v178, v178 offset:336
    ds_read_b32 v179, v179 offset:336
    ds_read_b32 v172, v172 offset:336
    buffer_load_dwordx4 v120, s[32:35], s92 offen offset:2048 lds
    ds_read_b32 v173, v173 offset:336
    ds_read_b32 v174, v174 offset:336
    ds_read_b32 v175, v175 offset:336
    ds_read_b32 v210, v148
    s_waitcnt vmcnt(15)
    ds_read_b64_tr_b16 a[0:1], v7 offset:0
    ds_read_b64_tr_b16 a[2:3], v7 offset:768
    ds_read_b64_tr_b16 a[24:25], v7 offset:32
    ds_read_b64_tr_b16 a[26:27], v7 offset:800
    ds_read_b64_tr_b16 a[48:49], v7 offset:64
    ds_read_b64_tr_b16 a[50:51], v7 offset:832
    s_add_u32 m0, s90, 0
    s_mov_b32 s92, 384
    s_waitcnt vmcnt(12)
    ds_read_b64_tr_b16 a[4:5], v7 offset:12288
    ds_read_b64_tr_b16 a[6:7], v7 offset:13056
    ds_read_b64_tr_b16 a[28:29], v7 offset:12320
    ds_read_b64_tr_b16 a[30:31], v7 offset:13088
    ds_read_b64_tr_b16 a[52:53], v7 offset:12352
    ds_read_b64_tr_b16 a[54:55], v7 offset:13120
    s_waitcnt vmcnt(9)
    ds_read_b64_tr_b16 a[8:9], v7 offset:24576
    ds_read_b64_tr_b16 a[10:11], v7 offset:25344
    ds_read_b64_tr_b16 a[32:33], v7 offset:24608
    s_waitcnt lgkmcnt(15)
    s_cmp_ge_u32 s2, 248
    s_cbranch_scc1 L_maskS
L_nomaskS:
    v_cmp_gt_u32 vcc, 16, v157
    v_readlane_b32 s84, v211, 48
    ds_read_b64_tr_b16 a[34:35], v7 offset:25376
    v_cndmask_b32 v208, v5, v208, vcc
    v_cndmask_b32 v209, v5, v209, vcc
    v_cndmask_b32 v210, v5, v210, vcc
    v_cmp_gt_u32 vcc, 49, v157
    ds_read_b64_tr_b16 a[56:57], v7 offset:24640
    s_waitcnt lgkmcnt(10)
    buffer_load_dwordx4 v4, s[32:35], s92 offen offset:0 lds
    ds_read_b64_tr_b16 a[58:59], v7 offset:25408
    v_cndmask_b32 v211, v5, v211, vcc
    s_waitcnt vmcnt(7)
    ds_read_b64_tr_b16 a[12:13], v7 offset:36864
    ds_read_b64_tr_b16 a[14:15], v7 offset:37632
    buffer_load_dwordx4 v156, s[32:35], s92 offen offset:1024 lds
    ds_read_b64_tr_b16 a[36:37], v7 offset:36896
    ds_read_b64_tr_b16 a[38:39], v7 offset:37664
    ds_read_b64_tr_b16 a[60:61], v7 offset:36928
    ds_read_b64_tr_b16 a[62:63], v7 offset:37696
    buffer_load_dwordx4 v120, s[32:35], s92 offen offset:2048 lds
    s_add_u32 m0, s90, 12288
    s_mov_b32 s92, 37248
    ds_read_b128 v[60:63], v147 offset:40960
    ds_read_b128 v[56:59], v146 offset:40960
    s_waitcnt lgkmcnt(10)
    buffer_load_dwordx4 v4, s[32:35], s92 offen offset:0 lds
    ds_read_b128 v[52:55], v147 offset:41088
    ds_read_b128 v[48:51], v146 offset:41088
    buffer_load_dwordx4 v156, s[32:35], s92 offen offset:1024 lds
    ds_read_b128 v[40:43], v147 offset:41216
    ds_read_b128 v[0:3], v146 offset:41216
    buffer_load_dwordx4 v120, s[32:35], s92 offen offset:2048 lds
    s_add_u32 m0, s90, 24576
    s_mov_b32 s92, 74112
    s_waitcnt vmcnt(9)
    ds_read_b64_tr_b16 a[16:17], v7 offset:49152
    ds_read_b64_tr_b16 a[18:19], v7 offset:49920
    ds_read_b64_tr_b16 a[40:41], v7 offset:49184
    ds_read_b64_tr_b16 a[42:43], v7 offset:49952
    ds_read_b64_tr_b16 a[64:65], v7 offset:49216
    ds_read_b64_tr_b16 a[66:67], v7 offset:49984
    s_waitcnt lgkmcnt(7)
    buffer_load_dwordx4 v4, s[32:35], s92 offen offset:0 lds
    buffer_load_dwordx4 v156, s[32:35], s92 offen offset:1024 lds
    buffer_load_dwordx4 v120, s[32:35], s92 offen offset:2048 lds
    s_add_u32 m0, s90, 36864
    s_mov_b32 s92, 110976
    s_waitcnt vmcnt(9)
    ds_read_b64_tr_b16 a[20:21], v7 offset:61440
    ds_read_b64_tr_b16 a[22:23], v7 offset:62208
    v_mfma_f32_16x16x32_bf16 v[68:71], a[0:3], v[60:63], 0
    ds_read_b64_tr_b16 a[44:45], v7 offset:61472
    v_mfma_f32_16x16x32_bf16 v[68:71], a[4:7], v[56:59], v[68:71]
    ds_read_b64_tr_b16 a[46:47], v7 offset:62240
    v_mfma_f32_16x16x32_bf16 v[68:71], a[8:11], v[52:55], v[68:71]
    ds_read_b64_tr_b16 a[68:69], v7 offset:61504
    v_mfma_f32_16x16x32_bf16 v[68:71], a[12:15], v[48:51], v[68:71]
    s_waitcnt lgkmcnt(5)
    ds_read_b64_tr_b16 a[70:71], v7 offset:62272
    v_mfma_f32_16x16x32_bf16 v[68:71], a[16:19], v[40:43], v[68:71]
    ds_read_b128 v[44:47], v147 offset:42496
    ds_read_b128 v[36:39], v146 offset:42496
    ds_read_b128 v[32:35], v147 offset:42624
    ds_read_b128 v[28:31], v146 offset:42624
    s_waitcnt lgkmcnt(7)
    v_mfma_f32_16x16x32_bf16 v[68:71], a[20:23], v[0:3], v[68:71]
    ds_read_b128 v[20:23], v147 offset:42752
    s_nop 0
    v_mfma_f32_16x16x32_bf16 v[92:95], a[24:27], v[60:63], 0
    s_nop 0
    ds_read_b128 v[12:15], v146 offset:42752
    s_nop 0
    v_mfma_f32_16x16x32_bf16 v[92:95], a[28:31], v[56:59], v[92:95]
    s_nop 0
    v_fma_f32 v5, v68, v68, s41
    v_fmac_f32 v5, v69, v69
    v_mfma_f32_16x16x32_bf16 v[92:95], a[32:35], v[52:55], v[92:95]
    v_fmac_f32 v5, v70, v70
    v_fmac_f32 v5, v71, v71
    v_mfma_f32_16x16x32_bf16 v[92:95], a[36:39], v[48:51], v[92:95]
    v_mfma_f32_16x16x32_bf16 v[92:95], a[40:43], v[40:43], v[92:95]
    s_waitcnt lgkmcnt(4)
    v_mfma_f32_16x16x32_bf16 v[92:95], a[44:47], v[0:3], v[92:95]
    s_nop 0
    buffer_load_dwordx4 v4, s[32:35], s92 offen offset:0 lds
    v_mfma_f32_16x16x32_bf16 v[88:91], a[48:51], v[60:63], 0
    s_nop 2
    v_mfma_f32_16x16x32_bf16 v[88:91], a[52:55], v[56:59], v[88:91]
    s_nop 0
    v_fmac_f32 v5, v92, v92
    v_fmac_f32 v5, v93, v93
    v_mfma_f32_16x16x32_bf16 v[88:91], a[56:59], v[52:55], v[88:91]
    v_fmac_f32 v5, v94, v94
    v_fmac_f32 v5, v95, v95
    v_mfma_f32_16x16x32_bf16 v[88:91], a[60:63], v[48:51], v[88:91]
    v_mfma_f32_16x16x32_bf16 v[88:91], a[64:67], v[40:43], v[88:91]
    buffer_load_dwordx4 v156, s[32:35], s92 offen offset:1024 lds
    v_mfma_f32_16x16x32_bf16 v[88:91], a[68:71], v[0:3], v[88:91]
    s_nop 0
    v_mfma_f32_16x16x32_bf16 v[0:3], a[0:3], v[44:47], 0
    s_nop 2
    v_mfma_f32_16x16x32_bf16 v[0:3], a[4:7], v[36:39], v[0:3]
    s_waitcnt lgkmcnt(0)
    s_nop 0
    v_fmac_f32 v5, v88, v88
    v_fmac_f32 v5, v89, v89
    v_mfma_f32_16x16x32_bf16 v[0:3], a[8:11], v[32:35], v[0:3]
    v_fmac_f32 v5, v90, v90
    v_fmac_f32 v5, v91, v91
    v_mfma_f32_16x16x32_bf16 v[0:3], a[12:15], v[28:31], v[0:3]
    ds_read_b128 v[100:103], v147 offset:40960
    buffer_load_dwordx4 v120, s[32:35], s92 offen offset:2048 lds
    v_mfma_f32_16x16x32_bf16 v[0:3], a[16:19], v[20:23], v[0:3]
    s_waitcnt vmcnt(9)
    s_add_u32 m0, s90, 49152
    ds_read_b64_tr_b16 a[72:73], v7 offset:0
    v_mfma_f32_16x16x32_bf16 v[0:3], a[20:23], v[12:15], v[0:3]
    s_mov_b32 s92, 147840
    ds_read_b64_tr_b16 a[74:75], v7 offset:768
    v_mfma_f32_16x16x32_bf16 v[56:59], a[24:27], v[44:47], 0
    ds_read_b64_tr_b16 a[96:97], v7 offset:32
    s_nop 0
    v_mfma_f32_16x16x32_bf16 v[56:59], a[28:31], v[36:39], v[56:59]
    s_nop 0
    ds_read_b64_tr_b16 a[98:99], v7 offset:800
    v_fma_f32 v72, v0, v0, s41
    v_mfma_f32_16x16x32_bf16 v[56:59], a[32:35], v[32:35], v[56:59]
    ds_read_b64_tr_b16 a[120:121], v7 offset:64
    buffer_load_dwordx4 v4, s[32:35], s92 offen offset:0 lds
    v_mfma_f32_16x16x32_bf16 v[56:59], a[36:39], v[28:31], v[56:59]
    ds_read_b64_tr_b16 a[122:123], v7 offset:832
    v_fmac_f32 v72, v1, v1
    v_mfma_f32_16x16x32_bf16 v[56:59], a[40:43], v[20:23], v[56:59]
    ds_read_b128 v[64:67], v146 offset:40960
    v_fmac_f32 v72, v2, v2
    v_mfma_f32_16x16x32_bf16 v[56:59], a[44:47], v[12:15], v[56:59]
    ds_read_b128 v[52:55], v147 offset:41088
    v_fmac_f32 v72, v3, v3
    v_mfma_f32_16x16x32_bf16 v[40:43], a[48:51], v[44:47], 0
    ds_read_b128 v[48:51], v146 offset:41088
    v_mfma_f32_16x16x32_bf16 v[40:43], a[52:55], v[36:39], v[40:43]
    ds_read_b128 v[44:47], v147 offset:41216
    buffer_load_dwordx4 v156, s[32:35], s92 offen offset:1024 lds
    v_mfma_f32_16x16x32_bf16 v[40:43], a[56:59], v[32:35], v[40:43]
    ds_read_b128 v[32:35], v146 offset:41216
    v_fmac_f32 v72, v56, v56
    v_mfma_f32_16x16x32_bf16 v[40:43], a[60:63], v[28:31], v[40:43]
    v_fmac_f32 v72, v57, v57
    v_fmac_f32 v72, v58, v58
    v_mfma_f32_16x16x32_bf16 v[40:43], a[64:67], v[20:23], v[40:43]
    v_fmac_f32 v72, v59, v59
    v_mfma_f32_16x16x32_bf16 v[40:43], a[68:71], v[12:15], v[40:43]
    s_waitcnt vmcnt(8)
    s_nop 2
    buffer_load_dwordx4 v120, s[32:35], s92 offen offset:2048 lds
    s_add_u32 m0, s90, 61440
    s_mov_b32 s92, 184704
    ds_read_b64_tr_b16 a[76:77], v7 offset:12288
    v_fmac_f32 v72, v40, v40
    ds_read_b64_tr_b16 a[78:79], v7 offset:13056
    v_fmac_f32 v72, v41, v41
    ds_read_b64_tr_b16 a[100:101], v7 offset:12320
    v_fmac_f32 v72, v42, v42
    ds_read_b64_tr_b16 a[102:103], v7 offset:13088
    v_fmac_f32 v72, v43, v43
    ds_read_b64_tr_b16 a[124:125], v7 offset:12352
    buffer_load_dwordx4 v4, s[32:35], s92 offen offset:0 lds
    ds_read_b64_tr_b16 a[126:127], v7 offset:13120
    buffer_load_dwordx4 v156, s[32:35], s92 offen offset:1024 lds
    buffer_load_dwordx4 v120, s[32:35], s92 offen offset:2048 lds
    s_add_u32 m0, s90, 0
    s_mov_b32 s92, 768
    s_waitcnt vmcnt(9)
    ds_read_b64_tr_b16 a[80:81], v7 offset:24576
    ds_read_b64_tr_b16 a[82:83], v7 offset:25344
    ds_read_b64_tr_b16 a[104:105], v7 offset:24608
    ds_read_b64_tr_b16 a[106:107], v7 offset:25376
    ds_read_b64_tr_b16 a[128:129], v7 offset:24640
    ds_read_b64_tr_b16 a[130:131], v7 offset:25408
    s_waitcnt lgkmcnt(6)
    buffer_load_dwordx4 v4, s[32:35], s92 offen offset:0 lds
    buffer_load_dwordx4 v156, s[32:35], s92 offen offset:1024 lds
    buffer_load_dwordx4 v120, s[32:35], s92 offen offset:2048 lds
    s_add_u32 m0, s90, 12288
    s_mov_b32 s92, 37632
    s_waitcnt vmcnt(9)
    ds_read_b64_tr_b16 a[84:85], v7 offset:36864
    ds_read_b64_tr_b16 a[86:87], v7 offset:37632
    ds_read_b64_tr_b16 a[108:109], v7 offset:36896
    ds_read_b64_tr_b16 a[110:111], v7 offset:37664
    ds_read_b64_tr_b16 a[132:133], v7 offset:36928
    ds_read_b64_tr_b16 a[134:135], v7 offset:37696
    buffer_load_dwordx4 v4, s[32:35], s92 offen offset:0 lds
    buffer_load_dwordx4 v156, s[32:35], s92 offen offset:1024 lds
    buffer_load_dwordx4 v120, s[32:35], s92 offen offset:2048 lds
    s_add_u32 m0, s90, 24576
    s_mov_b32 s92, 74496
    s_waitcnt vmcnt(9)
    ds_read_b64_tr_b16 a[88:89], v7 offset:49152
    ds_read_b64_tr_b16 a[90:91], v7 offset:49920
    ds_read_b64_tr_b16 a[112:113], v7 offset:49184
    ds_read_b64_tr_b16 a[114:115], v7 offset:49952
    ds_read_b64_tr_b16 a[136:137], v7 offset:49216
    ds_read_b64_tr_b16 a[138:139], v7 offset:49984
    s_waitcnt lgkmcnt(6)
    buffer_load_dwordx4 v4, s[32:35], s92 offen offset:0 lds
    buffer_load_dwordx4 v156, s[32:35], s92 offen offset:1024 lds
    buffer_load_dwordx4 v120, s[32:35], s92 offen offset:2048 lds
    s_add_u32 m0, s90, 36864
    s_mov_b32 s92, 111360
    s_waitcnt vmcnt(9)
    ds_read_b64_tr_b16 a[92:93], v7 offset:61440
    ds_read_b64_tr_b16 a[94:95], v7 offset:62208
    v_mfma_f32_16x16x32_bf16 v[36:39], a[72:75], v[100:103], 0
    ds_read_b64_tr_b16 a[116:117], v7 offset:61472
    v_mfma_f32_16x16x32_bf16 v[36:39], a[76:79], v[64:67], v[36:39]
    ds_read_b64_tr_b16 a[118:119], v7 offset:62240
    v_mfma_f32_16x16x32_bf16 v[36:39], a[80:83], v[52:55], v[36:39]
    ds_read_b64_tr_b16 a[140:141], v7 offset:61504
    v_mfma_f32_16x16x32_bf16 v[36:39], a[84:87], v[48:51], v[36:39]
    s_waitcnt lgkmcnt(5)
    buffer_load_dwordx4 v4, s[32:35], s92 offen offset:0 lds
    ds_read_b64_tr_b16 a[142:143], v7 offset:62272
    v_mfma_f32_16x16x32_bf16 v[36:39], a[88:91], v[44:47], v[36:39]
    ds_read_b128 v[96:99], v147 offset:42496
    ds_read_b128 v[80:83], v146 offset:42496
    ds_read_b128 v[28:31], v147 offset:42624
    ds_read_b128 v[20:23], v146 offset:42624
    s_waitcnt lgkmcnt(7)
    v_mfma_f32_16x16x32_bf16 v[36:39], a[92:95], v[32:35], v[36:39]
    buffer_load_dwordx4 v156, s[32:35], s92 offen offset:1024 lds
    ds_read_b128 v[60:63], v147 offset:42752
    v_mfma_f32_16x16x32_bf16 v[84:87], a[96:99], v[100:103], 0
    s_nop 1
    ds_read_b128 v[12:15], v146 offset:42752
    v_mfma_f32_16x16x32_bf16 v[84:87], a[100:103], v[64:67], v[84:87]
    s_nop 0
    v_fma_f32 v157, v36, v36, s41
    v_fmac_f32 v157, v37, v37
    v_mfma_f32_16x16x32_bf16 v[84:87], a[104:107], v[52:55], v[84:87]
    v_fmac_f32 v157, v38, v38
    v_fmac_f32 v157, v39, v39
    v_mfma_f32_16x16x32_bf16 v[84:87], a[108:111], v[48:51], v[84:87]
    v_mfma_f32_16x16x32_bf16 v[84:87], a[112:115], v[44:47], v[84:87]
    s_waitcnt vmcnt(8) lgkmcnt(4)
    buffer_load_dwordx4 v120, s[32:35], s92 offen offset:2048 lds
    ds_read_b64_tr_b16 a[144:145], v6 offset:0
    v_mfma_f32_16x16x32_bf16 v[84:87], a[116:119], v[32:35], v[84:87]
    s_add_u32 m0, s90, 49152
    ds_read_b64_tr_b16 a[146:147], v6 offset:768
    v_mfma_f32_16x16x32_bf16 v[76:79], a[120:123], v[100:103], 0
    s_mov_b32 s92, 148224
    s_nop 0
    ds_read_b64_tr_b16 a[168:169], v6 offset:8
    v_mfma_f32_16x16x32_bf16 v[76:79], a[124:127], v[64:67], v[76:79]
    s_nop 0
    v_fmac_f32 v157, v84, v84
    v_fmac_f32 v157, v85, v85
    v_mfma_f32_16x16x32_bf16 v[76:79], a[128:131], v[52:55], v[76:79]
    ds_read_b64_tr_b16 a[170:171], v6 offset:776
    v_fmac_f32 v157, v86, v86
    v_mfma_f32_16x16x32_bf16 v[76:79], a[132:135], v[48:51], v[76:79]
    buffer_load_dwordx4 v4, s[32:35], s92 offen offset:0 lds
    ds_read_b64_tr_b16 a[192:193], v7 offset:64
    v_mfma_f32_16x16x32_bf16 v[76:79], a[136:139], v[44:47], v[76:79]
    ds_read_b64_tr_b16 a[194:195], v7 offset:832
    v_fmac_f32 v157, v87, v87
    v_mfma_f32_16x16x32_bf16 v[76:79], a[140:143], v[32:35], v[76:79]
    s_nop 0
    v_mfma_f32_16x16x32_bf16 v[52:55], a[72:75], v[96:99], 0
    s_nop 2
    v_mfma_f32_16x16x32_bf16 v[52:55], a[76:79], v[80:83], v[52:55]
    s_waitcnt lgkmcnt(5)
    s_nop 0
    v_fmac_f32 v157, v76, v76
    v_fmac_f32 v157, v77, v77
    v_mfma_f32_16x16x32_bf16 v[52:55], a[80:83], v[28:31], v[52:55]
    buffer_load_dwordx4 v156, s[32:35], s92 offen offset:1024 lds
    v_fmac_f32 v157, v78, v78
    v_mfma_f32_16x16x32_bf16 v[52:55], a[84:87], v[20:23], v[52:55]
    v_fmac_f32 v157, v79, v79
    v_cvt_pk_bf16_f32 v170, v5, v157
    v_mfma_f32_16x16x32_bf16 v[52:55], a[88:91], v[60:63], v[52:55]
    v_mfma_f32_16x16x32_bf16 v[52:55], a[92:95], v[12:15], v[52:55]
    ds_read_b128 v[64:67], v147 offset:40960
    v_mfma_f32_16x16x32_bf16 v[48:51], a[96:99], v[96:99], 0
    ds_read_b128 v[32:35], v146 offset:40960
    v_mfma_f32_16x16x32_bf16 v[48:51], a[100:103], v[80:83], v[48:51]
    s_waitcnt vmcnt(8)
    buffer_load_dwordx4 v120, s[32:35], s92 offen offset:2048 lds
    ds_read_b64_tr_b16 a[148:149], v6 offset:12288
    v_mfma_f32_16x16x32_bf16 v[48:51], a[104:107], v[28:31], v[48:51]
    s_add_u32 m0, s90, 61440
    v_fma_f32 v157, v52, v52, s41
    v_fmac_f32 v157, v53, v53
    v_mfma_f32_16x16x32_bf16 v[48:51], a[108:111], v[20:23], v[48:51]
    s_mov_b32 s92, 185088
    ds_read_b64_tr_b16 a[150:151], v6 offset:13056
    v_fmac_f32 v157, v54, v54
    v_mfma_f32_16x16x32_bf16 v[48:51], a[112:115], v[60:63], v[48:51]
    ds_read_b64_tr_b16 a[172:173], v6 offset:12296
    v_fmac_f32 v157, v55, v55
    v_mfma_f32_16x16x32_bf16 v[48:51], a[116:119], v[12:15], v[48:51]
    ds_read_b64_tr_b16 a[174:175], v6 offset:13064
    v_mfma_f32_16x16x32_bf16 v[44:47], a[120:123], v[96:99], 0
    s_nop 0
    buffer_load_dwordx4 v4, s[32:35], s92 offen offset:0 lds
    ds_read_b64_tr_b16 a[196:197], v7 offset:12352
    v_mfma_f32_16x16x32_bf16 v[44:47], a[124:127], v[80:83], v[44:47]
    s_nop 0
    ds_read_b64_tr_b16 a[198:199], v7 offset:13120
    v_fmac_f32 v157, v48, v48
    v_mfma_f32_16x16x32_bf16 v[44:47], a[128:131], v[28:31], v[44:47]
    ds_read_b128 v[28:31], v147 offset:41088
    v_fmac_f32 v157, v49, v49
    v_mfma_f32_16x16x32_bf16 v[44:47], a[132:135], v[20:23], v[44:47]
    ds_read_b128 v[20:23], v146 offset:41088
    v_fmac_f32 v157, v50, v50
    v_mfma_f32_16x16x32_bf16 v[44:47], a[136:139], v[60:63], v[44:47]
    ds_read_b128 v[60:63], v147 offset:41216
    v_fmac_f32 v157, v51, v51
    v_mfma_f32_16x16x32_bf16 v[44:47], a[140:143], v[12:15], v[44:47]
    s_nop 0
    buffer_load_dwordx4 v156, s[32:35], s92 offen offset:1024 lds
    ds_read_b128 v[12:15], v146 offset:41216
    v_mfma_f32_16x16x16_bf16 v[80:83], v[216:217], v[170:171], 0
    s_nop 0
    v_mov_b32 v168, 0
    v_mov_b32 v169, 0
    v_mov_b32 v149, 0
    v_fmac_f32 v157, v44, v44
    v_fmac_f32 v157, v45, v45
    v_fmac_f32 v157, v46, v46
    v_fmac_f32 v157, v47, v47
    v_rsq_f32 v80, v80
    v_rsq_f32 v81, v81
    v_mul_f32 v80, s55, v80
    v_mul_f32 v81, 0.5, v81
    v_mul_f32 v68, v68, v80
    buffer_load_dwordx4 v120, s[32:35], s92 offen offset:2048 lds
    s_add_u32 m0, s90, 0
    s_mov_b32 s92, 0
    s_waitcnt vmcnt(9)
    ds_read_b64_tr_b16 a[152:153], v6 offset:24576
    v_mul_f32 v69, v69, v80
    v_cvt_pk_f16_f32 v68, v68, v69
    v_mul_f32 v70, v70, v80
    ds_read_b64_tr_b16 a[154:155], v6 offset:25344
    v_mul_f32 v71, v71, v80
    v_cvt_pk_f16_f32 v69, v70, v71
    v_mul_f32 v92, v92, v80
    ds_read_b64_tr_b16 a[176:177], v6 offset:24584
    v_mul_f32 v93, v93, v80
    v_cvt_pk_f16_f32 v70, v92, v93
    s_waitcnt lgkmcnt(3)
    buffer_load_dwordx4 v121, s[76:79], s92 offen offset:0 lds
    ds_read_b64_tr_b16 a[178:179], v6 offset:25352
    v_mul_f32 v94, v94, v80
    v_mul_f32 v95, v95, v80
    v_cvt_pk_f16_f32 v71, v94, v95
    ds_read_b64_tr_b16 a[200:201], v7 offset:24640
    v_mul_f32 v88, v88, v80
    ds_read_b64_tr_b16 a[202:203], v7 offset:25408
    v_mul_f32 v89, v89, v80
    v_cvt_pk_f16_f32 v160, v88, v89
    v_mul_f32 v90, v90, v80
    v_mul_f32 v91, v91, v80
    v_cvt_pk_f16_f32 v161, v90, v91
    v_mul_f32 v36, v36, v81
    buffer_load_dwordx4 v25, s[76:79], s92 offen offset:1024 lds
    v_mul_f32 v37, v37, v81
    v_cvt_pk_f16_f32 v36, v36, v37
    v_mul_f32 v38, v38, v81
    v_mul_f32 v39, v39, v81
    v_cvt_pk_f16_f32 v37, v38, v39
    v_mul_f32 v84, v84, v81
    v_mul_f32 v85, v85, v81
    v_cvt_pk_f16_f32 v38, v84, v85
    v_mul_f32 v86, v86, v81
    v_mul_f32 v87, v87, v81
    v_cvt_pk_f16_f32 v39, v86, v87
    v_mul_f32 v76, v76, v81
    v_mul_f32 v77, v77, v81
    v_cvt_pk_f16_f32 v4, v76, v77
    v_mul_f32 v78, v78, v81
    v_mul_f32 v79, v79, v81
    v_cvt_pk_f16_f32 v5, v78, v79
    buffer_load_dwordx4 v24, s[76:79], s92 offen offset:2048 lds
    s_add_u32 m0, s90, 12288
    s_mov_b32 s92, 12288
    s_waitcnt vmcnt(9)
    ds_read_b64_tr_b16 a[156:157], v6 offset:36864
    v_fma_mix_f32 v148, v68, v36, 0 op_sel:[0,0,0] op_sel_hi:[1,1,0]
    v_fma_mix_f32 v148, v68, v36, v148 op_sel:[1,1,0] op_sel_hi:[1,1,0]
    v_fma_mix_f32 v148, v69, v37, v148 op_sel:[0,0,0] op_sel_hi:[1,1,0]
    ds_read_b64_tr_b16 a[158:159], v6 offset:37632
    v_fma_mix_f32 v148, v69, v37, v148 op_sel:[1,1,0] op_sel_hi:[1,1,0]
    v_fma_mix_f32 v148, v70, v38, v148 op_sel:[0,0,0] op_sel_hi:[1,1,0]
    v_fma_mix_f32 v148, v70, v38, v148 op_sel:[1,1,0] op_sel_hi:[1,1,0]
    ds_read_b64_tr_b16 a[180:181], v6 offset:36872
    v_fma_mix_f32 v148, v71, v39, v148 op_sel:[0,0,0] op_sel_hi:[1,1,0]
    v_fma_mix_f32 v148, v71, v39, v148 op_sel:[1,1,0] op_sel_hi:[1,1,0]
    buffer_load_dwordx4 v121, s[76:79], s92 offen offset:0 lds
    ds_read_b64_tr_b16 a[182:183], v6 offset:37640
    v_fma_mix_f32 v148, v160, v4, v148 op_sel:[0,0,0] op_sel_hi:[1,1,0]
    v_fma_mix_f32 v148, v160, v4, v148 op_sel:[1,1,0] op_sel_hi:[1,1,0]
    v_fma_mix_f32 v148, v161, v5, v148 op_sel:[0,0,0] op_sel_hi:[1,1,0]
    ds_read_b64_tr_b16 a[204:205], v7 offset:36928
    v_fma_mix_f32 v148, v161, v5, v148 op_sel:[1,1,0] op_sel_hi:[1,1,0]
    ds_read_b64_tr_b16 a[206:207], v7 offset:37696
    v_mov_b32 v120, v148
    v_add_u32 v156, 28672, v158
    ds_write_b128 v156, v[36:39]
    buffer_load_dwordx4 v25, s[76:79], s92 offen offset:1024 lds
    v_permlane32_swap_b32 v120, v148
    v_add_f32 v148, v120, v148
    v_mov_b32 v120, v148
    v_cvt_pk_bf16_f32 v170, v72, v157
    s_nop 0
    v_permlane16_swap_b32 v120, v148
    v_mfma_f32_16x16x16_bf16 v[36:39], v[216:217], v[170:171], 0
    s_waitcnt vmcnt(8)
    ds_write2_b64 v156, v[168:169], v[168:169] offset0:2 offset1:3
    v_add_f32 v148, v120, v148
    buffer_load_dwordx4 v24, s[76:79], s92 offen offset:2048 lds
    s_add_u32 m0, s90, 24576
    s_mov_b32 s92, 24576
    v_and_b32 v120, 0xffff0000, v148
    v_sub_f32 v148, v148, v120
    ds_read_b64_tr_b16 a[160:161], v6 offset:49152
    v_cvt_pk_bf16_f32 v148, v148, v120
    v_rsq_f32 v36, v36
    ds_read_b64_tr_b16 a[162:163], v6 offset:49920
    v_rsq_f32 v37, v37
    v_mul_f32 v36, s55, v36
    s_waitcnt lgkmcnt(3)
    buffer_load_dwordx4 v121, s[76:79], s92 offen offset:0 lds
    ds_read_b64_tr_b16 a[184:185], v6 offset:49160
    v_mul_f32 v37, 0.5, v37
    v_mul_f32 v0, v0, v36
    v_mul_f32 v1, v1, v36
    ds_read_b64_tr_b16 a[186:187], v6 offset:49928
    v_cvt_pk_f16_f32 v0, v0, v1
    v_mul_f32 v2, v2, v36
    v_mul_f32 v3, v3, v36
    ds_read_b64_tr_b16 a[208:209], v7 offset:49216
    v_cvt_pk_f16_f32 v1, v2, v3
    ds_read_b64_tr_b16 a[210:211], v7 offset:49984
    v_mul_f32 v56, v56, v36
    buffer_load_dwordx4 v25, s[76:79], s92 offen offset:1024 lds
    ds_write_b128 v156, v[68:71] offset:32
    v_mul_f32 v57, v57, v36
    v_cvt_pk_f16_f32 v2, v56, v57
    v_mul_f32 v58, v58, v36
    v_mul_f32 v59, v59, v36
    v_cvt_pk_f16_f32 v3, v58, v59
    v_mul_f32 v40, v40, v36
    v_mul_f32 v41, v41, v36
    v_cvt_pk_f16_f32 v254, v40, v41
    ds_write2_b64 v156, v[4:5], v[168:169] offset0:6 offset1:7
    buffer_load_dwordx4 v24, s[76:79], s92 offen offset:2048 lds
    s_add_u32 m0, s90, 36864
    s_mov_b32 s92, 36864
    v_mul_f32 v42, v42, v36
    v_mul_f32 v43, v43, v36
    v_cvt_pk_f16_f32 v255, v42, v43
    v_mul_f32 v52, v52, v37
    v_mul_f32 v53, v53, v37
    s_waitcnt vmcnt(9)
    ds_read_b64_tr_b16 a[164:165], v6 offset:61440
    v_cvt_pk_f16_f32 v4, v52, v53
    v_mul_f32 v54, v54, v37
    v_mul_f32 v55, v55, v37
    ds_read_b64_tr_b16 a[166:167], v6 offset:62208
    v_mfma_f32_16x16x32_bf16 v[40:43], a[144:147], v[64:67], 0
    buffer_load_dwordx4 v121, s[76:79], s92 offen offset:0 lds
    ds_read_b64_tr_b16 a[188:189], v6 offset:61448
    v_mfma_f32_16x16x32_bf16 v[40:43], a[148:151], v[32:35], v[40:43]
    v_cvt_pk_f16_f32 v5, v54, v55
    v_mul_f32 v48, v48, v37
    v_mfma_f32_16x16x32_bf16 v[40:43], a[152:155], v[28:31], v[40:43]
    ds_read_b64_tr_b16 a[190:191], v6 offset:62216
    v_mul_f32 v49, v49, v37
    v_mfma_f32_16x16x32_bf16 v[40:43], a[156:159], v[20:23], v[40:43]
    s_waitcnt lgkmcnt(4)
    ds_read_b64_tr_b16 a[212:213], v7 offset:61504
    v_cvt_pk_f16_f32 v6, v48, v49
    v_mfma_f32_16x16x32_bf16 v[40:43], a[160:163], v[60:63], v[40:43]
    ds_read_b64_tr_b16 a[214:215], v7 offset:62272
    v_mul_f32 v50, v50, v37
    v_mul_f32 v51, v51, v37
    v_cvt_pk_f16_f32 v7, v50, v51
    buffer_load_dwordx4 v25, s[76:79], s92 offen offset:1024 lds
    ds_write2_b64 v156, v[168:169], v[160:161] offset0:8 offset1:9
    v_mul_f32 v44, v44, v37
    v_mul_f32 v45, v45, v37
    v_cvt_pk_f16_f32 v160, v44, v45
    v_mul_f32 v46, v46, v37
    s_waitcnt lgkmcnt(5)
    v_mfma_f32_16x16x32_bf16 v[40:43], a[164:167], v[12:15], v[40:43]
    v_mul_f32 v47, v47, v37
    v_cvt_pk_f16_f32 v161, v46, v47
    v_mfma_f32_16x16x32_bf16 v[52:55], a[168:171], v[64:67], 0
    buffer_load_dwordx4 v24, s[76:79], s92 offen offset:2048 lds
    ds_read_b128 v[48:51], v147 offset:42496
    v_mfma_f32_16x16x32_bf16 v[52:55], a[172:175], v[32:35], v[52:55]
    s_add_u32 m0, s90, 49152
    v_fma_mix_f32 v120, v0, v4, 0 op_sel:[0,0,0] op_sel_hi:[1,1,0]
    v_fma_mix_f32 v120, v0, v4, v120 op_sel:[1,1,0] op_sel_hi:[1,1,0]
    v_mfma_f32_16x16x32_bf16 v[52:55], a[176:179], v[28:31], v[52:55]
    s_mov_b32 s92, 49152
    ds_write_b64 v156, v[148:149] offset:88
    v_mfma_f32_16x16x32_bf16 v[52:55], a[180:183], v[20:23], v[52:55]
    s_lshl_b32 s93, s68, 10
    v_fma_mix_f32 v120, v1, v5, v120 op_sel:[0,0,0] op_sel_hi:[1,1,0]
    v_fma_mix_f32 v120, v1, v5, v120 op_sel:[1,1,0] op_sel_hi:[1,1,0]
    v_mfma_f32_16x16x32_bf16 v[52:55], a[184:187], v[60:63], v[52:55]
    s_waitcnt lgkmcnt(3)
    s_mov_b32 s53, s47
    ds_read_b128 v[44:47], v146 offset:42496
    v_fma_mix_f32 v120, v2, v6, v120 op_sel:[0,0,0] op_sel_hi:[1,1,0]
    v_mfma_f32_16x16x32_bf16 v[52:55], a[188:191], v[12:15], v[52:55]
    s_mov_b32 s47, s46
    buffer_load_dwordx4 v121, s[76:79], s92 offen offset:0 lds
    ds_read_b128 v[36:39], v147 offset:42624
    v_mfma_f32_16x16x32_bf16 v[56:59], a[192:195], v[64:67], 0
    s_mov_b32 s46, s45
    v_fma_mix_f32 v120, v2, v6, v120 op_sel:[1,1,0] op_sel_hi:[1,1,0]
    v_fma_mix_f32 v120, v3, v7, v120 op_sel:[0,0,0] op_sel_hi:[1,1,0]
    v_mfma_f32_16x16x32_bf16 v[56:59], a[196:199], v[32:35], v[56:59]
    s_mov_b32 s45, s44
    ds_read_b128 v[32:35], v146 offset:42624
    v_fma_mix_f32 v120, v3, v7, v120 op_sel:[1,1,0] op_sel_hi:[1,1,0]
    v_mfma_f32_16x16x32_bf16 v[56:59], a[200:203], v[28:31], v[56:59]
    s_mov_b32 s44, s53
    ds_read_b128 v[28:31], v147 offset:42752
    v_fma_mix_f32 v120, v254, v160, v120 op_sel:[0,0,0] op_sel_hi:[1,1,0]
    v_mfma_f32_16x16x32_bf16 v[56:59], a[204:207], v[20:23], v[56:59]
    s_sub_u32 s48, s44, s46
    ds_read_b128 v[20:23], v146 offset:42752
    v_fma_mix_f32 v120, v254, v160, v120 op_sel:[1,1,0] op_sel_hi:[1,1,0]
    v_mfma_f32_16x16x32_bf16 v[56:59], a[208:211], v[60:63], v[56:59]
    s_sub_u32 s49, s46, s45
    buffer_load_dwordx4 v25, s[76:79], s92 offen offset:1024 lds
    v_fma_mix_f32 v120, v255, v161, v120 op_sel:[0,0,0] op_sel_hi:[1,1,0]
    v_mfma_f32_16x16x32_bf16 v[56:59], a[212:215], v[12:15], v[56:59]
    s_waitcnt lgkmcnt(5)
    v_fma_mix_f32 v120, v255, v161, v120 op_sel:[1,1,0] op_sel_hi:[1,1,0]
    v_mov_b32 v146, v120
    v_mfma_f32_16x16x32_bf16 v[12:15], a[144:147], v[48:51], 0
    s_waitcnt lgkmcnt(4)
    v_permlane32_swap_b32 v146, v120
    v_add_f32 v120, v146, v120
    v_mfma_f32_16x16x32_bf16 v[12:15], a[148:151], v[44:47], v[12:15]
    s_waitcnt lgkmcnt(3)
    v_mov_b32 v146, v120
    v_cvt_pk_bf16_f32 v148, v40, v41
    v_cvt_pk_bf16_f32 v149, v42, v43
    v_mfma_f32_16x16x32_bf16 v[12:15], a[152:155], v[36:39], v[12:15]
    s_waitcnt lgkmcnt(2)
    ds_write_b64 v158, v[148:149] offset:28752
    buffer_load_dwordx4 v24, s[76:79], s92 offen offset:2048 lds
    s_add_u32 m0, s90, 61440
    v_mfma_f32_16x16x32_bf16 v[12:15], a[156:159], v[32:35], v[12:15]
    s_waitcnt lgkmcnt(2)
    s_mov_b32 s92, 61440
    v_permlane16_swap_b32 v146, v120
    v_mfma_f32_16x16x32_bf16 v[12:15], a[160:163], v[28:31], v[12:15]
    s_waitcnt lgkmcnt(1)
    v_add_f32 v120, v146, v120
    v_and_b32 v146, 0xffff0000, v120
    v_mfma_f32_16x16x32_bf16 v[12:15], a[164:167], v[20:23], v[12:15]
    v_sub_f32 v120, v120, v146
    v_cvt_pk_bf16_f32 v120, v120, v146
    v_mfma_f32_16x16x32_bf16 v[40:43], a[168:171], v[48:51], 0
    v_cvt_pk_bf16_f32 v52, v52, v53
    v_cvt_pk_bf16_f32 v53, v54, v55
    v_mfma_f32_16x16x32_bf16 v[40:43], a[172:175], v[44:47], v[40:43]
    buffer_load_dwordx4 v121, s[76:79], s92 offen offset:0 lds
    v_cvt_pk_bf16_f32 v54, v56, v57
    v_mfma_f32_16x16x32_bf16 v[40:43], a[176:179], v[36:39], v[40:43]
    v_cvt_pk_bf16_f32 v55, v58, v59
    v_cvt_pk_bf16_f32 v156, v12, v13
    v_mfma_f32_16x16x32_bf16 v[40:43], a[180:183], v[32:35], v[40:43]
    ds_write_b128 v158, v[52:55] offset:28768
    v_mfma_f32_16x16x32_bf16 v[40:43], a[184:187], v[28:31], v[40:43]
    v_cvt_pk_bf16_f32 v157, v14, v15
    v_add_u32 v121, s93, v129
    v_mfma_f32_16x16x32_bf16 v[40:43], a[188:191], v[20:23], v[40:43]
    buffer_load_dwordx4 v25, s[76:79], s92 offen offset:1024 lds
    v_add_u32 v137, s48, v137
    v_mfma_f32_16x16x32_bf16 v[12:15], a[192:195], v[48:51], 0
    s_nop 0
    v_add_u32 v136, s48, v136
    s_nop 0
    v_mfma_f32_16x16x32_bf16 v[12:15], a[196:199], v[44:47], v[12:15]
    s_nop 0
    v_cvt_pk_bf16_f32 v76, v40, v41
    v_cvt_pk_bf16_f32 v77, v42, v43
    v_mfma_f32_16x16x32_bf16 v[12:15], a[200:203], v[36:39], v[12:15]
    v_mfma_f32_16x16x32_bf16 v[12:15], a[204:207], v[32:35], v[12:15]
    v_mfma_f32_16x16x32_bf16 v[12:15], a[208:211], v[28:31], v[12:15]
    buffer_load_dwordx4 v24, s[76:79], s92 offen offset:2048 lds
    v_mfma_f32_16x16x32_bf16 v[12:15], a[212:215], v[20:23], v[12:15]
    s_add_u32 m0, s54, 20480
    s_nop 6
    v_cvt_pk_bf16_f32 v78, v12, v13
    v_cvt_pk_bf16_f32 v79, v14, v15
    buffer_load_dwordx4 v128, s[24:27], s56 offen nt lds
    s_add_u32 m0, s54, 21504
    s_nop 0
    buffer_load_dwordx4 v127, s[24:27], s56 offen nt lds
    s_add_u32 m0, s54, 22528
    s_nop 0
    buffer_load_dwordx4 v126, s[24:27], s56 offen nt lds
    s_add_u32 m0, s54, 23552
    s_nop 0
    buffer_load_dwordx4 v125, s[24:27], s56 offen nt lds
    s_add_u32 m0, s54, 24576
    s_nop 0
    buffer_load_dwordx4 v124, s[24:27], s56 offen nt lds
    s_waitcnt vmcnt(5)
    s_barrier
    ds_read_b128 v[36:39], v17 offset:0
    ds_read_b64 v[12:13], v16 offset:64
    ds_read_b128 v[28:31], v17 offset:3072
    ds_read_b64 v[14:15], v16 offset:3136
    ds_read_b128 v[48:51], v17 offset:6144
    ds_read_b64 v[32:33], v16 offset:6208
    ds_read_b128 v[40:43], v17 offset:9216
    ds_read_b64 v[34:35], v16 offset:9280
    ds_read_b128 v[44:47], v17 offset:12288
    ds_read_b64 v[52:53], v16 offset:12352
    ds_read_b128 v[20:23], v17 offset:15360
    ds_read_b64 v[54:55], v16 offset:15424
    s_waitcnt lgkmcnt(11)
    v_mfma_f32_16x16x32_bf16 v[56:59], v[36:39], v[220:223], 0
    s_waitcnt lgkmcnt(9)
    ds_read_b128 v[36:39], v17 offset:18432
    v_mfma_f32_16x16x32_bf16 v[56:59], v[28:31], v[220:223], v[56:59]
    s_waitcnt lgkmcnt(8)
    ds_read_b64 v[28:29], v16 offset:18496
    ds_read_b128 v[60:63], v17 offset:21504
    v_mfma_f32_16x16x32_bf16 v[56:59], v[48:51], v[220:223], v[56:59]
    s_waitcnt lgkmcnt(8)
    ds_read_b64 v[30:31], v16 offset:21568
    ds_read_b128 v[48:51], v17 offset:24576
    v_mfma_f32_16x16x32_bf16 v[56:59], v[40:43], v[220:223], v[56:59]
    ds_read_b64 v[40:41], v16 offset:24640
    v_mfma_f32_16x16x32_bf16 v[56:59], v[12:15], v[220:223], v[56:59]
    s_waitcnt lgkmcnt(9)
    ds_read_b128 v[12:15], v17 offset:27648
    v_mfma_f32_16x16x32_bf16 v[56:59], v[32:35], v[220:223], v[56:59]
    ds_read_b64 v[42:43], v16 offset:27712
    v_mfma_f32_16x16x32_bf16 v[32:35], v[44:47], v[220:223], 0
    s_waitcnt lgkmcnt(8)
    ds_read_b128 v[44:47], v17 offset:30720
    v_mfma_f32_16x16x32_bf16 v[32:35], v[20:23], v[220:223], v[32:35]
    s_waitcnt lgkmcnt(8)
    s_nop 0
    ds_read_b64 v[20:21], v16 offset:30784
    v_mul_f32 v56, 0xbbaaaaab, v56
    v_mfma_f32_16x16x32_bf16 v[32:35], v[36:39], v[220:223], v[32:35]
    s_waitcnt lgkmcnt(7)
    ds_read_b128 v[36:39], v17 offset:33792
    v_mul_f32 v57, 0xbbaaaaab, v57
    v_mul_f32 v58, 0xbbaaaaab, v58
    v_mul_f32 v59, 0xbbaaaaab, v59
    v_mfma_f32_16x16x32_bf16 v[32:35], v[60:63], v[220:223], v[32:35]
    ds_write_b128 v74, v[56:59] offset:0
    v_mfma_f32_16x16x32_bf16 v[32:35], v[52:55], v[220:223], v[32:35]
    s_waitcnt lgkmcnt(6)
    v_mfma_f32_16x16x32_bf16 v[32:35], v[28:31], v[220:223], v[32:35]
    v_mfma_f32_16x16x32_bf16 v[28:31], v[48:51], v[220:223], 0
    s_waitcnt lgkmcnt(4)
    ds_read_b64 v[22:23], v16 offset:33856
    s_nop 0
    v_mfma_f32_16x16x32_bf16 v[28:31], v[12:15], v[220:223], v[28:31]
    s_waitcnt lgkmcnt(4)
    s_nop 0
    ds_read_b128 v[12:15], v19 offset:0
    v_mul_f32 v32, 0xbbaaaaab, v32
    v_mfma_f32_16x16x32_bf16 v[28:31], v[44:47], v[220:223], v[28:31]
    s_waitcnt lgkmcnt(3)
    ds_read_b64 v[16:17], v18 offset:64
    v_mul_f32 v33, 0xbbaaaaab, v33
    v_mul_f32 v34, 0xbbaaaaab, v34
    v_mul_f32 v35, 0xbbaaaaab, v35
    v_mfma_f32_16x16x32_bf16 v[28:31], v[36:39], v[220:223], v[28:31]
    ds_write_b128 v74, v[32:35] offset:128
    v_mfma_f32_16x16x32_bf16 v[28:31], v[40:43], v[220:223], v[28:31]
    ds_read_b128 v[80:83], v19 offset:768
    ds_read_b64 v[84:85], v18 offset:832
    ds_read_b128 v[68:71], v19 offset:12288
    s_waitcnt lgkmcnt(6)
    v_mfma_f32_16x16x32_bf16 v[28:31], v[20:23], v[220:223], v[28:31]
    s_nop 0
    ds_read_b64 v[72:73], v18 offset:12352
    s_nop 0
    ds_read_b128 v[20:23], v19 offset:13056
    s_nop 2
    ds_read_b64 v[24:25], v18 offset:13120
    v_mul_f32 v28, 0xbbaaaaab, v28
    v_mul_f32 v29, 0xbbaaaaab, v29
    v_mul_f32 v30, 0xbbaaaaab, v30
    v_mul_f32 v31, 0xbbaaaaab, v31
    ds_write_b128 v74, v[28:31] offset:256
    s_waitcnt lgkmcnt(0)
    s_barrier
    ds_read_b128 v[40:43], v162 offset:0
    ds_read_b128 v[28:31], v162 offset:64
    ds_read_b128 v[64:67], v162 offset:128
    ds_read_b128 v[56:59], v162 offset:192
    s_waitcnt lgkmcnt(3)
    v_mfma_f32_16x16x16_bf16 v[32:35], v[12:13], v[26:27], v[40:43]
    v_mfma_f32_16x16x16_bf16 v[36:39], v[14:15], v[26:27], v[40:43]
    s_nop 2
    v_mfma_f32_16x16x16_bf16 v[60:63], v[16:17], v[26:27], v[40:43]
    s_waitcnt lgkmcnt(0)
    s_nop 0
    ds_read_b128 v[12:15], v19 offset:24576
    v_cvt_pk_bf16_f32 v32, v32, v33
    v_mfma_f32_16x16x16_bf16 v[52:55], v[80:81], v[26:27], v[28:31]
    ds_read_b64 v[16:17], v18 offset:24640
    v_accvgpr_write_b32 a216, v32
    v_mfma_f32_16x16x16_bf16 v[48:51], v[82:83], v[26:27], v[28:31]
    ds_read_b128 v[44:47], v162 offset:256
    v_cvt_pk_bf16_f32 v34, v34, v35
    v_mfma_f32_16x16x16_bf16 v[40:43], v[84:85], v[26:27], v[28:31]
    ds_read_b128 v[104:107], v19 offset:25344
    v_accvgpr_write_b32 a217, v34
    v_mfma_f32_16x16x16_bf16 v[84:87], v[68:69], v[26:27], v[64:67]
    ds_read_b64 v[108:109], v18 offset:25408
    v_cvt_pk_bf16_f32 v36, v36, v37
    v_mfma_f32_16x16x16_bf16 v[32:35], v[70:71], v[26:27], v[64:67]
    ds_read_b128 v[100:103], v162 offset:320
    v_accvgpr_write_b32 a240, v36
    v_mfma_f32_16x16x16_bf16 v[28:31], v[72:73], v[26:27], v[64:67]
    ds_read_b128 v[92:95], v19 offset:36864
    v_cvt_pk_bf16_f32 v38, v38, v39
    v_mfma_f32_16x16x16_bf16 v[68:71], v[20:21], v[26:27], v[56:59]
    ds_read_b64 v[96:97], v18 offset:36928
    v_accvgpr_write_b32 a241, v38
    v_mfma_f32_16x16x16_bf16 v[64:67], v[22:23], v[26:27], v[56:59]
    ds_read_b128 v[80:83], v162 offset:5120
    v_cvt_pk_bf16_f32 v232, v60, v61
    v_mfma_f32_16x16x16_bf16 v[36:39], v[24:25], v[26:27], v[56:59]
    s_waitcnt lgkmcnt(6)
    ds_read_b128 v[20:23], v19 offset:37632
    v_cvt_pk_bf16_f32 v233, v62, v63
    v_cvt_pk_bf16_f32 v52, v52, v53
    v_accvgpr_write_b32 a218, v52
    v_cvt_pk_bf16_f32 v54, v54, v55
    v_accvgpr_write_b32 a219, v54
    v_cvt_pk_bf16_f32 v48, v48, v49
    v_mfma_f32_16x16x16_bf16 v[60:63], v[12:13], v[26:27], v[44:47]
    ds_read_b64 v[24:25], v18 offset:37696
    v_accvgpr_write_b32 a242, v48
    v_mfma_f32_16x16x16_bf16 v[56:59], v[14:15], v[26:27], v[44:47]
    ds_read_b128 v[88:91], v162 offset:5184
    v_cvt_pk_bf16_f32 v50, v50, v51
    v_mfma_f32_16x16x16_bf16 v[52:55], v[16:17], v[26:27], v[44:47]
    s_waitcnt lgkmcnt(6)
    ds_read_b128 v[12:15], v19 offset:49152
    v_accvgpr_write_b32 a243, v50
    v_cvt_pk_bf16_f32 v234, v40, v41
    v_cvt_pk_bf16_f32 v235, v42, v43
    v_mfma_f32_16x16x16_bf16 v[72:75], v[104:105], v[26:27], v[100:103]
    ds_read_b64 v[16:17], v18 offset:49216
    v_cvt_pk_bf16_f32 v84, v84, v85
    v_mfma_f32_16x16x16_bf16 v[40:43], v[106:107], v[26:27], v[100:103]
    ds_read_b128 v[48:51], v162 offset:5248
    v_accvgpr_write_b32 a220, v84
    v_mfma_f32_16x16x16_bf16 v[44:47], v[108:109], v[26:27], v[100:103]
    s_waitcnt lgkmcnt(6)
    ds_read_b128 v[104:107], v19 offset:49920
    v_cvt_pk_bf16_f32 v86, v86, v87
    v_accvgpr_write_b32 a221, v86
    v_cvt_pk_bf16_f32 v32, v32, v33
    v_accvgpr_write_b32 a244, v32
    v_cvt_pk_bf16_f32 v34, v34, v35
    v_accvgpr_write_b32 a245, v34
    v_cvt_pk_bf16_f32 v236, v28, v29
    v_cvt_pk_bf16_f32 v237, v30, v31
    v_mfma_f32_16x16x16_bf16 v[84:87], v[92:93], v[26:27], v[80:83]
    ds_read_b64 v[108:109], v18 offset:49984
    v_cvt_pk_bf16_f32 v68, v68, v69
    v_mfma_f32_16x16x16_bf16 v[32:35], v[94:95], v[26:27], v[80:83]
    ds_read_b128 v[100:103], v162 offset:5312
    v_accvgpr_write_b32 a222, v68
    v_mfma_f32_16x16x16_bf16 v[28:31], v[96:97], v[26:27], v[80:83]
    s_waitcnt lgkmcnt(5)
    ds_read_b128 v[92:95], v19 offset:61440
    v_cvt_pk_bf16_f32 v70, v70, v71
    v_accvgpr_write_b32 a223, v70
    v_cvt_pk_bf16_f32 v64, v64, v65
    v_accvgpr_write_b32 a246, v64
    v_cvt_pk_bf16_f32 v66, v66, v67
    v_accvgpr_write_b32 a247, v66
    v_cvt_pk_bf16_f32 v238, v36, v37
    v_cvt_pk_bf16_f32 v239, v38, v39
    v_mfma_f32_16x16x16_bf16 v[36:39], v[20:21], v[26:27], v[88:91]
    ds_read_b64 v[96:97], v18 offset:61504
    v_cvt_pk_bf16_f32 v60, v60, v61
    v_mfma_f32_16x16x16_bf16 v[68:71], v[22:23], v[26:27], v[88:91]
    ds_read_b128 v[80:83], v162 offset:5376
    v_accvgpr_write_b32 a224, v60
    v_mfma_f32_16x16x16_bf16 v[64:67], v[24:25], v[26:27], v[88:91]
    s_waitcnt lgkmcnt(5)
    ds_read_b128 v[20:23], v19 offset:62208
    v_cvt_pk_bf16_f32 v62, v62, v63
    v_accvgpr_write_b32 a225, v62
    v_cvt_pk_bf16_f32 v56, v56, v57
    v_accvgpr_write_b32 a248, v56
    v_cvt_pk_bf16_f32 v58, v58, v59
    v_accvgpr_write_b32 a249, v58
    v_cvt_pk_bf16_f32 v240, v52, v53
    v_cvt_pk_bf16_f32 v241, v54, v55
    v_mfma_f32_16x16x16_bf16 v[60:63], v[12:13], v[26:27], v[48:51]
    ds_read_b64 v[24:25], v18 offset:62272
    v_cvt_pk_bf16_f32 v72, v72, v73
    v_mfma_f32_16x16x16_bf16 v[56:59], v[14:15], v[26:27], v[48:51]
    ds_read_b128 v[12:15], v162 offset:5440
    v_accvgpr_write_b32 a226, v72
    v_mfma_f32_16x16x16_bf16 v[52:55], v[16:17], v[26:27], v[48:51]
    s_waitcnt lgkmcnt(5)
    ds_read_b128 v[16:19], v137 offset:0
    v_cvt_pk_bf16_f32 v74, v74, v75
    v_accvgpr_write_b32 a227, v74
    v_cvt_pk_bf16_f32 v40, v40, v41
    v_accvgpr_write_b32 a250, v40
    v_cvt_pk_bf16_f32 v42, v42, v43
    v_accvgpr_write_b32 a251, v42
    v_cvt_pk_bf16_f32 v242, v44, v45
    v_cvt_pk_bf16_f32 v243, v46, v47
    v_mfma_f32_16x16x16_bf16 v[48:51], v[104:105], v[26:27], v[100:103]
    ds_read_b128 v[146:149], v136 offset:0
    v_cvt_pk_bf16_f32 v84, v84, v85
    v_mfma_f32_16x16x16_bf16 v[44:47], v[106:107], v[26:27], v[100:103]
    ds_read_b128 v[72:75], v137 offset:128
    v_accvgpr_write_b32 a228, v84
    v_mfma_f32_16x16x16_bf16 v[40:43], v[108:109], v[26:27], v[100:103]
    s_waitcnt lgkmcnt(5)
    ds_read_b128 v[88:91], v136 offset:128
    v_cvt_pk_bf16_f32 v86, v86, v87
    v_accvgpr_write_b32 a229, v86
    v_cvt_pk_bf16_f32 v32, v32, v33
    v_accvgpr_write_b32 a252, v32
    v_cvt_pk_bf16_f32 v34, v34, v35
    v_accvgpr_write_b32 a253, v34
    v_cvt_pk_bf16_f32 v244, v28, v29
    v_cvt_pk_bf16_f32 v245, v30, v31
    v_mfma_f32_16x16x16_bf16 v[32:35], v[92:93], v[26:27], v[80:83]
    s_waitcnt vmcnt(0) lgkmcnt(4)
    s_barrier
    ds_write_b128 v121, v[8:11] offset:6144
    v_mfma_f32_16x16x16_bf16 v[28:31], v[94:95], v[26:27], v[80:83]
    v_cvt_pk_bf16_f32 v36, v36, v37
    v_accvgpr_write_b32 a230, v36
    v_mfma_f32_16x16x16_bf16 v[8:11], v[96:97], v[26:27], v[80:83]
    s_waitcnt lgkmcnt(4)
    v_cvt_pk_bf16_f32 v38, v38, v39
    v_accvgpr_write_b32 a231, v38
    v_cvt_pk_bf16_f32 v68, v68, v69
    v_mfma_f32_16x16x32_bf16 v[36:39], a[0:3], v[16:19], 0
    s_waitcnt lgkmcnt(3)
    ds_write_b64 v158, v[156:157] offset:80
    v_mfma_f32_16x16x32_bf16 v[36:39], a[4:7], v[146:149], v[36:39]
    s_waitcnt lgkmcnt(3)
    v_accvgpr_write_b32 a254, v68
    v_cvt_pk_bf16_f32 v70, v70, v71
    v_mfma_f32_16x16x32_bf16 v[36:39], a[8:11], v[72:75], v[36:39]
    s_waitcnt lgkmcnt(2)
    ds_write_b128 v158, v[76:79] offset:96
    v_mfma_f32_16x16x32_bf16 v[36:39], a[12:15], v[88:91], v[36:39]
    v_accvgpr_write_b32 a255, v70
    v_cvt_pk_bf16_f32 v246, v64, v65
    v_cvt_pk_bf16_f32 v247, v66, v67
    v_cvt_pk_bf16_f32 v60, v60, v61
    v_accvgpr_write_b32 a232, v60
    v_cvt_pk_bf16_f32 v62, v62, v63
    v_accvgpr_write_b32 a233, v62
    v_cvt_pk_bf16_f32 v224, v56, v57
    v_cvt_pk_bf16_f32 v225, v58, v59
    v_cvt_pk_bf16_f32 v248, v52, v53
    v_cvt_pk_bf16_f32 v249, v54, v55
    v_cvt_pk_bf16_f32 v48, v48, v49
    v_accvgpr_write_b32 a234, v48
    v_cvt_pk_bf16_f32 v50, v50, v51
    v_accvgpr_write_b32 a235, v50
    v_cvt_pk_bf16_f32 v226, v44, v45
    v_cvt_pk_bf16_f32 v227, v46, v47
    v_cvt_pk_bf16_f32 v250, v40, v41
    v_cvt_pk_bf16_f32 v251, v42, v43
    v_cvt_pk_bf16_f32 v32, v32, v33
    v_accvgpr_write_b32 a236, v32
    v_cvt_pk_bf16_f32 v34, v34, v35
    v_accvgpr_write_b32 a237, v34
    v_cvt_pk_bf16_f32 v228, v28, v29
    v_cvt_pk_bf16_f32 v229, v30, v31
    v_cvt_pk_bf16_f32 v252, v8, v9
    v_cvt_pk_bf16_f32 v253, v10, v11
    v_mov_b32 v156, 0
    v_mov_b32 v157, 0
    v_mov_b32 v121, 0
    v_add_u32 v230, 0, v158
    ds_write_b128 v230, v[4:7]
    v_add_u32 v135, s49, v135
    v_add_u32 v134, s49, v134
    ds_write2_b64 v230, v[156:157], v[156:157] offset0:2 offset1:3
    ds_write_b128 v230, v[0:3] offset:32
    ds_write2_b64 v230, v[160:161], v[156:157] offset0:6 offset1:7
    ds_write2_b64 v230, v[156:157], v[254:255] offset0:8 offset1:9
    ds_write_b64 v230, v[120:121] offset:88
    ds_read_b128 v[76:79], v137 offset:256
    ds_read_b128 v[56:59], v136 offset:256
    s_waitcnt lgkmcnt(1)
    v_mfma_f32_16x16x32_bf16 v[36:39], a[16:19], v[76:79], v[36:39]
    s_waitcnt lgkmcnt(0)
    v_mfma_f32_16x16x32_bf16 v[36:39], a[20:23], v[56:59], v[36:39]
    s_nop 0
    v_mfma_f32_16x16x16_bf16 v[8:11], v[20:21], v[26:27], v[12:15]
    s_nop 3
    v_mfma_f32_16x16x16_bf16 v[4:7], v[22:23], v[26:27], v[12:15]
    s_nop 0
    v_fma_f32 v121, v36, v36, s41
    v_fmac_f32 v121, v37, v37
    v_mfma_f32_16x16x16_bf16 v[0:3], v[24:25], v[26:27], v[12:15]
    v_cvt_pk_bf16_f32 v8, v8, v9
    v_accvgpr_write_b32 a238, v8
    v_cvt_pk_bf16_f32 v10, v10, v11
    v_mfma_f32_16x16x32_bf16 v[48:51], a[24:27], v[16:19], 0
    v_accvgpr_write_b32 a239, v10
    v_cvt_pk_bf16_f32 v230, v4, v5
    v_mfma_f32_16x16x32_bf16 v[48:51], a[28:31], v[146:149], v[48:51]
    v_cvt_pk_bf16_f32 v231, v6, v7
    v_cvt_pk_bf16_f32 v254, v0, v1
    v_mfma_f32_16x16x32_bf16 v[48:51], a[32:35], v[72:75], v[48:51]
    v_cvt_pk_bf16_f32 v255, v2, v3
    v_fmac_f32 v121, v38, v38
    v_mfma_f32_16x16x32_bf16 v[48:51], a[36:39], v[88:91], v[48:51]
    v_fmac_f32 v121, v39, v39
    v_mfma_f32_16x16x32_bf16 v[48:51], a[40:43], v[76:79], v[48:51]
    v_mfma_f32_16x16x32_bf16 v[48:51], a[44:47], v[56:59], v[48:51]
    s_nop 1
    v_mfma_f32_16x16x32_bf16 v[40:43], a[48:51], v[16:19], 0
    s_nop 2
    v_mfma_f32_16x16x32_bf16 v[40:43], a[52:55], v[146:149], v[40:43]
    s_nop 0
    v_fmac_f32 v121, v48, v48
    v_fmac_f32 v121, v49, v49
    v_mfma_f32_16x16x32_bf16 v[40:43], a[56:59], v[72:75], v[40:43]
    v_fmac_f32 v121, v50, v50
    v_fmac_f32 v121, v51, v51
    v_mfma_f32_16x16x32_bf16 v[40:43], a[60:63], v[88:91], v[40:43]
    v_mfma_f32_16x16x32_bf16 v[40:43], a[64:67], v[76:79], v[40:43]
    v_mfma_f32_16x16x32_bf16 v[40:43], a[68:71], v[56:59], v[40:43]
    s_nop 1
    v_mfma_f32_16x16x32_bf16 v[28:31], a[72:75], v[16:19], 0
    s_nop 2
    v_mfma_f32_16x16x32_bf16 v[28:31], a[76:79], v[146:149], v[28:31]
    s_nop 0
    v_fmac_f32 v121, v40, v40
    v_fmac_f32 v121, v41, v41
    v_mfma_f32_16x16x32_bf16 v[28:31], a[80:83], v[72:75], v[28:31]
    v_fmac_f32 v121, v42, v42
    v_fmac_f32 v121, v43, v43
    v_mfma_f32_16x16x32_bf16 v[28:31], a[84:87], v[88:91], v[28:31]
    v_mfma_f32_16x16x32_bf16 v[28:31], a[88:91], v[76:79], v[28:31]
    v_mfma_f32_16x16x32_bf16 v[28:31], a[92:95], v[56:59], v[28:31]
    s_nop 1
    v_mfma_f32_16x16x32_bf16 v[32:35], a[96:99], v[16:19], 0
    s_nop 2
    v_mfma_f32_16x16x32_bf16 v[32:35], a[100:103], v[146:149], v[32:35]
    s_nop 0
    v_fma_f32 v120, v28, v28, s41
    v_fmac_f32 v120, v29, v29
    v_mfma_f32_16x16x32_bf16 v[32:35], a[104:107], v[72:75], v[32:35]
    v_fmac_f32 v120, v30, v30
    v_fmac_f32 v120, v31, v31
    v_mfma_f32_16x16x32_bf16 v[32:35], a[108:111], v[88:91], v[32:35]
    v_mfma_f32_16x16x32_bf16 v[32:35], a[112:115], v[76:79], v[32:35]
    v_mfma_f32_16x16x32_bf16 v[32:35], a[116:119], v[56:59], v[32:35]
    s_nop 1
    v_mfma_f32_16x16x32_bf16 v[20:23], a[120:123], v[16:19], 0
    s_nop 2
    v_mfma_f32_16x16x32_bf16 v[20:23], a[124:127], v[146:149], v[20:23]
    s_nop 0
    v_fmac_f32 v120, v32, v32
    v_fmac_f32 v120, v33, v33
    v_mfma_f32_16x16x32_bf16 v[20:23], a[128:131], v[72:75], v[20:23]
    v_fmac_f32 v120, v34, v34
    v_fmac_f32 v120, v35, v35
    v_mfma_f32_16x16x32_bf16 v[20:23], a[132:135], v[88:91], v[20:23]
    v_mfma_f32_16x16x32_bf16 v[20:23], a[136:139], v[76:79], v[20:23]
    v_mfma_f32_16x16x32_bf16 v[20:23], a[140:143], v[56:59], v[20:23]
    s_nop 1
    v_mfma_f32_16x16x32_bf16 v[8:11], v[16:19], a[144:147], 0
    s_nop 2
    v_mfma_f32_16x16x32_bf16 v[8:11], v[146:149], a[148:151], v[8:11]
    s_nop 0
    v_fmac_f32 v120, v20, v20
    v_fmac_f32 v120, v21, v21
    v_mfma_f32_16x16x32_bf16 v[8:11], v[72:75], a[152:155], v[8:11]
    v_fmac_f32 v120, v22, v22
    v_fmac_f32 v120, v23, v23
    v_mfma_f32_16x16x32_bf16 v[8:11], v[88:91], a[156:159], v[8:11]
    v_cvt_pk_bf16_f32 v170, v121, v120
    v_mfma_f32_16x16x32_bf16 v[8:11], v[76:79], a[160:163], v[8:11]
    ds_read_b128 v[104:107], v137 offset:1536
    v_mfma_f32_16x16x32_bf16 v[8:11], v[56:59], a[164:167], v[8:11]
    s_nop 0
    ds_read_b128 v[100:103], v136 offset:1536
    s_nop 0
    v_mfma_f32_16x16x16_bf16 v[24:27], v[216:217], v[170:171], 0
    s_nop 0
    ds_read_b128 v[44:47], v137 offset:1664
    s_nop 1
    v_cvt_pk_bf16_f32 v0, v8, v9
    v_mfma_f32_16x16x32_bf16 v[4:7], v[16:19], a[168:171], 0
    ds_read_b128 v[84:87], v136 offset:1664
    v_cvt_pk_bf16_f32 v1, v10, v11
    v_mfma_f32_16x16x32_bf16 v[4:7], v[146:149], a[172:175], v[4:7]
    ds_read_b128 v[68:71], v137 offset:1792
    v_mfma_f32_16x16x32_bf16 v[4:7], v[72:75], a[176:179], v[4:7]
    ds_read_b128 v[64:67], v136 offset:1792
    v_mfma_f32_16x16x32_bf16 v[4:7], v[88:91], a[180:183], v[4:7]
    v_rsq_f32 v24, v24
    v_mfma_f32_16x16x32_bf16 v[4:7], v[76:79], a[184:187], v[4:7]
    v_rsq_f32 v25, v25
    v_mfma_f32_16x16x32_bf16 v[4:7], v[56:59], a[188:191], v[4:7]
    v_mul_f32 v24, s55, v24
    v_mul_f32 v25, 0.5, v25
    v_mfma_f32_16x16x32_bf16 v[12:15], v[16:19], a[192:195], 0
    s_nop 0
    v_mul_f32 v36, v36, v24
    v_mul_f32 v37, v37, v24
    v_mfma_f32_16x16x32_bf16 v[12:15], v[146:149], a[196:199], v[12:15]
    s_nop 0
    v_cvt_pk_bf16_f32 v8, v4, v5
    v_cvt_pk_bf16_f32 v9, v6, v7
    v_mfma_f32_16x16x32_bf16 v[12:15], v[72:75], a[200:203], v[12:15]
    v_cvt_pk_f16_f32 v4, v36, v37
    v_mul_f32 v38, v38, v24
    v_mfma_f32_16x16x32_bf16 v[12:15], v[88:91], a[204:207], v[12:15]
    v_mul_f32 v39, v39, v24
    v_cvt_pk_f16_f32 v5, v38, v39
    v_mfma_f32_16x16x32_bf16 v[12:15], v[76:79], a[208:211], v[12:15]
    v_mul_f32 v48, v48, v24
    v_mul_f32 v49, v49, v24
    v_mfma_f32_16x16x32_bf16 v[12:15], v[56:59], a[212:215], v[12:15]
    s_waitcnt lgkmcnt(0)
    v_cvt_pk_f16_f32 v6, v48, v49
    v_mul_f32 v50, v50, v24
    v_mfma_f32_16x16x32_bf16 v[16:19], a[0:3], v[104:107], 0
    v_mul_f32 v51, v51, v24
    v_cvt_pk_f16_f32 v7, v50, v51
    v_mfma_f32_16x16x32_bf16 v[16:19], a[4:7], v[100:103], v[16:19]
    v_mul_f32 v40, v40, v24
    v_mul_f32 v41, v41, v24
    v_mfma_f32_16x16x32_bf16 v[16:19], a[8:11], v[44:47], v[16:19]
    v_cvt_pk_f16_f32 v152, v40, v41
    v_mul_f32 v42, v42, v24
    v_mfma_f32_16x16x32_bf16 v[16:19], a[12:15], v[84:87], v[16:19]
    v_mul_f32 v43, v43, v24
    v_cvt_pk_f16_f32 v153, v42, v43
    v_mfma_f32_16x16x32_bf16 v[16:19], a[16:19], v[68:71], v[16:19]
    v_mul_f32 v28, v28, v25
    v_mul_f32 v29, v29, v25
    v_mfma_f32_16x16x32_bf16 v[16:19], a[20:23], v[64:67], v[16:19]
    v_cvt_pk_f16_f32 v28, v28, v29
    v_mul_f32 v30, v30, v25
    v_mfma_f32_16x16x32_bf16 v[60:63], a[24:27], v[104:107], 0
    v_mul_f32 v31, v31, v25
    v_cvt_pk_f16_f32 v29, v30, v31
    v_mfma_f32_16x16x32_bf16 v[60:63], a[28:31], v[100:103], v[60:63]
    v_mul_f32 v32, v32, v25
    v_mul_f32 v33, v33, v25
    v_mfma_f32_16x16x32_bf16 v[60:63], a[32:35], v[44:47], v[60:63]
    v_cvt_pk_f16_f32 v30, v32, v33
    v_mul_f32 v34, v34, v25
    v_mfma_f32_16x16x32_bf16 v[60:63], a[36:39], v[84:87], v[60:63]
    v_mul_f32 v35, v35, v25
    v_cvt_pk_f16_f32 v31, v34, v35
    v_mfma_f32_16x16x32_bf16 v[60:63], a[40:43], v[68:71], v[60:63]
    v_mul_f32 v20, v20, v25
    v_mul_f32 v21, v21, v25
    v_mfma_f32_16x16x32_bf16 v[60:63], a[44:47], v[64:67], v[60:63]
    v_cvt_pk_f16_f32 v154, v20, v21
    v_mul_f32 v22, v22, v25
    v_mfma_f32_16x16x32_bf16 v[36:39], a[48:51], v[104:107], 0
    v_mul_f32 v23, v23, v25
    v_cvt_pk_f16_f32 v155, v22, v23
    v_mfma_f32_16x16x32_bf16 v[36:39], a[52:55], v[100:103], v[36:39]
    v_cvt_pk_bf16_f32 v20, v12, v13
    v_cvt_pk_bf16_f32 v21, v14, v15
    v_mfma_f32_16x16x32_bf16 v[36:39], a[56:59], v[44:47], v[36:39]
    v_fma_f32 v2, v16, v16, s41
    v_fmac_f32 v2, v17, v17
    v_mfma_f32_16x16x32_bf16 v[36:39], a[60:63], v[84:87], v[36:39]
    v_fmac_f32 v2, v18, v18
    v_fmac_f32 v2, v19, v19
    v_mfma_f32_16x16x32_bf16 v[36:39], a[64:67], v[68:71], v[36:39]
    v_fmac_f32 v2, v60, v60
    v_fmac_f32 v2, v61, v61
    v_mfma_f32_16x16x32_bf16 v[36:39], a[68:71], v[64:67], v[36:39]
    v_fmac_f32 v2, v62, v62
    v_fmac_f32 v2, v63, v63
    v_mfma_f32_16x16x32_bf16 v[52:55], a[72:75], v[104:107], 0
    s_nop 2
    v_mfma_f32_16x16x32_bf16 v[52:55], a[76:79], v[100:103], v[52:55]
    s_nop 0
    v_fmac_f32 v2, v36, v36
    v_fmac_f32 v2, v37, v37
    v_mfma_f32_16x16x32_bf16 v[52:55], a[80:83], v[44:47], v[52:55]
    v_fmac_f32 v2, v38, v38
    v_fmac_f32 v2, v39, v39
    v_mfma_f32_16x16x32_bf16 v[52:55], a[84:87], v[84:87], v[52:55]
    v_mfma_f32_16x16x32_bf16 v[52:55], a[88:91], v[68:71], v[52:55]
    v_mfma_f32_16x16x32_bf16 v[52:55], a[92:95], v[64:67], v[52:55]
    s_nop 1
    v_mfma_f32_16x16x32_bf16 v[12:15], a[96:99], v[104:107], 0
    s_nop 2
    v_mfma_f32_16x16x32_bf16 v[12:15], a[100:103], v[100:103], v[12:15]
    s_nop 0
    v_fma_f32 v3, v52, v52, s41
    v_fmac_f32 v3, v53, v53
    v_mfma_f32_16x16x32_bf16 v[12:15], a[104:107], v[44:47], v[12:15]
    v_fmac_f32 v3, v54, v54
    v_fmac_f32 v3, v55, v55
    v_mfma_f32_16x16x32_bf16 v[12:15], a[108:111], v[84:87], v[12:15]
    v_mfma_f32_16x16x32_bf16 v[12:15], a[112:115], v[68:71], v[12:15]
    v_mfma_f32_16x16x32_bf16 v[12:15], a[116:119], v[64:67], v[12:15]
    s_sub_u32 s50, s45, s44
    v_add_u32 v135, s48, v135
    v_add_u32 v134, s48, v134
    v_mfma_f32_16x16x32_bf16 v[48:51], a[120:123], v[104:107], 0
    s_sub_u32 s51, s46, s47
    v_add_u32 v133, s51, v133
    v_mfma_f32_16x16x32_bf16 v[48:51], a[124:127], v[100:103], v[48:51]
    s_mov_b32 s60, s59
    v_fmac_f32 v3, v12, v12
    v_fmac_f32 v3, v13, v13
    v_mfma_f32_16x16x32_bf16 v[48:51], a[128:131], v[44:47], v[48:51]
    s_mov_b32 s59, s58
    v_fmac_f32 v3, v14, v14
    v_fmac_f32 v3, v15, v15
    v_mfma_f32_16x16x32_bf16 v[48:51], a[132:135], v[84:87], v[48:51]
    s_mov_b32 s58, s57
    v_mfma_f32_16x16x32_bf16 v[48:51], a[136:139], v[68:71], v[48:51]
    s_mov_b32 s57, s56
    v_mfma_f32_16x16x32_bf16 v[48:51], a[140:143], v[64:67], v[48:51]
    s_mov_b32 s7, s6
    s_nop 0
    v_mfma_f32_16x16x32_bf16 v[24:27], v[104:107], a[144:147], 0
    s_mov_b32 s6, s5
    s_nop 1
    v_mfma_f32_16x16x32_bf16 v[24:27], v[100:103], a[148:151], v[24:27]
    s_mov_b32 s5, s4
    v_fmac_f32 v3, v48, v48
    v_fmac_f32 v3, v49, v49
    v_mfma_f32_16x16x32_bf16 v[24:27], v[44:47], a[152:155], v[24:27]
    s_sub_u32 s14, s6, s7
    v_fmac_f32 v3, v50, v50
    v_fmac_f32 v3, v51, v51
    v_mfma_f32_16x16x32_bf16 v[24:27], v[84:87], a[156:159], v[24:27]
    s_add_u32 s61, s61, 1
    v_cvt_pk_bf16_f32 v170, v2, v3
    v_add_u32 v132, s14, v132
    v_mfma_f32_16x16x32_bf16 v[24:27], v[68:71], a[160:163], v[24:27]
    s_ff1_i32_b32 s15, s66
    ds_read_b128 v[96:99], v137 offset:3072
    v_add_u32 v131, s14, v131
    v_mfma_f32_16x16x32_bf16 v[24:27], v[64:67], a[164:167], v[24:27]
    s_cmp_lg_u32 s66, 0
    ds_read_b128 v[92:95], v136 offset:3072
    v_add_u32 v123, s14, v123
    v_mfma_f32_16x16x16_bf16 v[40:43], v[216:217], v[170:171], 0
    s_cselect_b32 s12, s15, s12
    ds_read_b128 v[88:91], v137 offset:3200
    s_nop 1
    v_cvt_pk_bf16_f32 v2, v24, v25
    v_mfma_f32_16x16x32_bf16 v[72:75], v[104:107], a[168:171], 0
    s_cmp_lt_u32 s61, s71
    ds_read_b128 v[80:83], v136 offset:3200
    v_cvt_pk_bf16_f32 v3, v26, v27
    v_mfma_f32_16x16x32_bf16 v[72:75], v[100:103], a[172:175], v[72:75]
    s_cselect_b32 s15, 31, s15
    ds_read_b128 v[56:59], v137 offset:3328
    v_add_u32 v137, s50, v137
    v_mfma_f32_16x16x32_bf16 v[72:75], v[44:47], a[176:179], v[72:75]
    s_bitset0_b32 s66, s15
    ds_read_b128 v[24:27], v136 offset:3328
    v_add_u32 v136, s50, v136
    v_mfma_f32_16x16x32_bf16 v[72:75], v[84:87], a[180:183], v[72:75]
    s_add_u32 s12, s12, 20
    v_rsq_f32 v40, v40
    v_mfma_f32_16x16x32_bf16 v[72:75], v[68:71], a[184:187], v[72:75]
    s_max_u32 s12, s12, s61
    v_rsq_f32 v41, v41
    v_mfma_f32_16x16x32_bf16 v[72:75], v[64:67], a[188:191], v[72:75]
    s_cmp_lt_u32 s61, s71
    v_mul_f32 v40, s55, v40
    v_mul_f32 v41, 0.5, v41
    v_mfma_f32_16x16x32_bf16 v[32:35], v[104:107], a[192:195], 0
    s_cselect_b32 s15, s61, s12
    v_mul_f32 v16, v16, v40
    v_mul_f32 v17, v17, v40
    v_mfma_f32_16x16x32_bf16 v[32:35], v[100:103], a[196:199], v[32:35]
    s_cselect_b32 s56, s69, s70
    v_cvt_pk_bf16_f32 v10, v72, v73
    v_cvt_pk_bf16_f32 v11, v74, v75
    v_mfma_f32_16x16x32_bf16 v[32:35], v[44:47], a[200:203], v[32:35]
    s_add_u32 s56, s56, s15
    v_cvt_pk_f16_f32 v44, v16, v17
    v_mul_f32 v18, v18, v40
    v_mfma_f32_16x16x32_bf16 v[32:35], v[84:87], a[204:207], v[32:35]
    s_mul_i32 s53, s56, 58255
    v_mul_f32 v19, v19, v40
    v_cvt_pk_f16_f32 v45, v18, v19
    v_mfma_f32_16x16x32_bf16 v[32:35], v[68:71], a[208:211], v[32:35]
    s_waitcnt lgkmcnt(0)
    s_lshr_b32 s53, s53, 22
    v_mul_f32 v60, v60, v40
    v_mul_f32 v61, v61, v40
    v_mfma_f32_16x16x32_bf16 v[32:35], v[64:67], a[212:215], v[32:35]
    s_barrier
    v_cvt_pk_f16_f32 v46, v60, v61
    v_mul_f32 v62, v62, v40
    v_mfma_f32_16x16x32_bf16 v[16:19], a[0:3], v[96:99], 0
    s_mul_i32 s53, s53, s63
    v_mul_f32 v63, v63, v40
    v_cvt_pk_f16_f32 v47, v62, v63
    v_mfma_f32_16x16x32_bf16 v[16:19], a[4:7], v[92:95], v[16:19]
    s_mul_i32 s56, s56, s62
    v_mul_f32 v36, v36, v40
    v_mul_f32 v37, v37, v40
    v_mfma_f32_16x16x32_bf16 v[16:19], a[8:11], v[88:91], v[16:19]
    s_add_u32 s56, s56, s53
    v_cvt_pk_f16_f32 v146, v36, v37
    v_mul_f32 v38, v38, v40
    v_mfma_f32_16x16x32_bf16 v[16:19], a[12:15], v[80:83], v[16:19]
    s_mul_i32 s4, s15, 112
    v_mul_f32 v39, v39, v40
    v_cvt_pk_f16_f32 v147, v38, v39
    v_mfma_f32_16x16x32_bf16 v[16:19], a[16:19], v[56:59], v[16:19]
    s_cmp_ge_u32 s15, 16
    v_mul_f32 v52, v52, v41
    v_mul_f32 v53, v53, v41
    v_mfma_f32_16x16x32_bf16 v[16:19], a[20:23], v[24:27], v[16:19]
    s_cselect_b32 s53, -30464, 0
    v_cvt_pk_f16_f32 v72, v52, v53
    v_mul_f32 v54, v54, v41
    v_mfma_f32_16x16x32_bf16 v[36:39], a[24:27], v[96:99], 0
    s_add_u32 s4, s4, s53
    v_mul_f32 v55, v55, v41
    v_cvt_pk_f16_f32 v73, v54, v55
    v_mfma_f32_16x16x32_bf16 v[36:39], a[28:31], v[92:95], v[36:39]
    s_cmp_lt_u32 s15, s73
    v_mul_f32 v12, v12, v41
    v_mul_f32 v13, v13, v41
    v_mfma_f32_16x16x32_bf16 v[36:39], a[32:35], v[88:91], v[36:39]
    s_cselect_b32 s26, 100270464, 0
    v_cvt_pk_f16_f32 v74, v12, v13
    v_mul_f32 v14, v14, v41
    v_mfma_f32_16x16x32_bf16 v[36:39], a[36:39], v[80:83], v[36:39]
    s_cselect_b32 s56, s56, 0
    v_mul_f32 v15, v15, v41
    v_cvt_pk_f16_f32 v75, v14, v15
    v_mfma_f32_16x16x32_bf16 v[36:39], a[40:43], v[56:59], v[36:39]
    s_cselect_b32 s4, s4, -1
    v_mul_f32 v48, v48, v41
    v_mul_f32 v49, v49, v41
    v_mfma_f32_16x16x32_bf16 v[36:39], a[44:47], v[24:27], v[36:39]
    s_cselect_b32 s15, s15, 0
    v_cvt_pk_f16_f32 v148, v48, v49
    v_mul_f32 v50, v50, v41
    v_mfma_f32_16x16x32_bf16 v[12:15], a[48:51], v[96:99], 0
    s_cselect_b32 s13, s13, -1
    v_mul_f32 v51, v51, v41
    v_cvt_pk_f16_f32 v149, v50, v51
    v_mfma_f32_16x16x32_bf16 v[12:15], a[52:55], v[92:95], v[12:15]
    s_bitset1_b32 s64, s15
    v_cvt_pk_bf16_f32 v22, v32, v33
    v_cvt_pk_bf16_f32 v23, v34, v35
    v_mfma_f32_16x16x32_bf16 v[12:15], a[56:59], v[88:91], v[12:15]
    s_add_u32 s65, s65, 1
    v_fma_f32 v156, v16, v16, s41
    v_fmac_f32 v156, v17, v17
    v_mfma_f32_16x16x32_bf16 v[12:15], a[60:63], v[80:83], v[12:15]
    s_cmp_ge_i32 s65, 2
    v_fmac_f32 v156, v18, v18
    v_fmac_f32 v156, v19, v19
    v_mfma_f32_16x16x32_bf16 v[12:15], a[64:67], v[56:59], v[12:15]
    s_cselect_b32 s30, 100270464, 0
    v_fmac_f32 v156, v36, v36
    v_fmac_f32 v156, v37, v37
    v_mfma_f32_16x16x32_bf16 v[12:15], a[68:71], v[24:27], v[12:15]
    s_add_u32 s67, s46, s54
    v_fmac_f32 v156, v38, v38
    v_fmac_f32 v156, v39, v39
    v_mfma_f32_16x16x32_bf16 v[64:67], a[72:75], v[96:99], 0
    s_add_u32 m0, s67, 0
    v_and_b32 v120, -8, v123
    v_mfma_f32_16x16x32_bf16 v[64:67], a[76:79], v[92:95], v[64:67]
    buffer_load_dwordx4 v128, s[24:27], s56 offen nt lds
    v_fmac_f32 v156, v12, v12
    v_mfma_f32_16x16x32_bf16 v[64:67], a[80:83], v[88:91], v[64:67]
    s_add_u32 m0, s67, 1024
    v_fmac_f32 v156, v13, v13
    v_fmac_f32 v156, v14, v14
    v_mfma_f32_16x16x32_bf16 v[64:67], a[84:87], v[80:83], v[64:67]
    buffer_load_dwordx4 v127, s[24:27], s56 offen nt lds
    v_fmac_f32 v156, v15, v15
    v_mfma_f32_16x16x32_bf16 v[64:67], a[88:91], v[56:59], v[64:67]
    s_add_u32 m0, s67, 2048
    v_mfma_f32_16x16x32_bf16 v[64:67], a[92:95], v[24:27], v[64:67]
    buffer_load_dwordx4 v126, s[24:27], s56 offen nt lds
    v_mfma_f32_16x16x32_bf16 v[32:35], a[96:99], v[96:99], 0
    s_add_u32 m0, s67, 3072
    s_nop 1
    v_mfma_f32_16x16x32_bf16 v[32:35], a[100:103], v[92:95], v[32:35]
    s_nop 0
    buffer_load_dwordx4 v125, s[24:27], s56 offen nt lds
    v_fma_f32 v121, v64, v64, s41
    v_mfma_f32_16x16x32_bf16 v[32:35], a[104:107], v[88:91], v[32:35]
    s_add_u32 m0, s67, 4096
    v_fmac_f32 v121, v65, v65
    v_fmac_f32 v121, v66, v66
    v_mfma_f32_16x16x32_bf16 v[32:35], a[108:111], v[80:83], v[32:35]
    buffer_load_dwordx4 v124, s[24:27], s56 offen nt lds
    v_fmac_f32 v121, v67, v67
    v_mfma_f32_16x16x32_bf16 v[32:35], a[112:115], v[56:59], v[32:35]
    v_mfma_f32_16x16x32_bf16 v[32:35], a[116:119], v[24:27], v[32:35]
    s_nop 1
    v_mfma_f32_16x16x32_bf16 v[40:43], a[120:123], v[96:99], 0
    s_nop 2
    v_mfma_f32_16x16x32_bf16 v[40:43], a[124:127], v[92:95], v[40:43]
    s_mov_b32 s53, s47
    v_fmac_f32 v121, v32, v32
    v_fmac_f32 v121, v33, v33
    v_mfma_f32_16x16x32_bf16 v[40:43], a[128:131], v[88:91], v[40:43]
    s_mov_b32 s47, s46
    v_fmac_f32 v121, v34, v34
    v_fmac_f32 v121, v35, v35
    v_mfma_f32_16x16x32_bf16 v[40:43], a[132:135], v[80:83], v[40:43]
    s_mov_b32 s46, s45
    v_mfma_f32_16x16x32_bf16 v[40:43], a[136:139], v[56:59], v[40:43]
    s_mov_b32 s45, s44
    v_mfma_f32_16x16x32_bf16 v[40:43], a[140:143], v[24:27], v[40:43]
    s_mov_b32 s44, s53
    s_nop 0
    v_mfma_f32_16x16x32_bf16 v[68:71], v[96:99], a[144:147], 0
    s_sub_u32 s48, s44, s46
    v_add_u32 v137, s48, v137
    v_add_u32 v136, s48, v136
    v_mfma_f32_16x16x32_bf16 v[68:71], v[92:95], a[148:151], v[68:71]
    s_sub_u32 s49, s46, s45
    v_fmac_f32 v121, v40, v40
    v_fmac_f32 v121, v41, v41
    v_mfma_f32_16x16x32_bf16 v[68:71], v[88:91], a[152:155], v[68:71]
    v_fmac_f32 v121, v42, v42
    v_fmac_f32 v121, v43, v43
    v_mfma_f32_16x16x32_bf16 v[68:71], v[80:83], a[156:159], v[68:71]
    v_cvt_pk_bf16_f32 v170, v156, v121
    v_mfma_f32_16x16x32_bf16 v[68:71], v[56:59], a[160:163], v[68:71]
    ds_read_b128 v[60:63], v132 offset:0
    v_mfma_f32_16x16x32_bf16 v[68:71], v[24:27], a[164:167], v[68:71]
    s_nop 0
    ds_read_b128 v[52:55], v132 offset:16
    s_nop 0
    v_mfma_f32_16x16x16_bf16 v[76:79], v[216:217], v[170:171], 0
    s_nop 0
    ds_read_b128 v[48:51], v132 offset:48
    s_nop 1
    v_cvt_pk_bf16_f32 v164, v68, v69
    v_mfma_f32_16x16x32_bf16 v[84:87], v[96:99], a[168:171], 0
    v_cvt_pk_bf16_f32 v165, v70, v71
    v_mfma_f32_16x16x32_bf16 v[84:87], v[92:95], a[172:175], v[84:87]
    v_rsq_f32 v76, v76
    v_mfma_f32_16x16x32_bf16 v[84:87], v[88:91], a[176:179], v[84:87]
    v_rsq_f32 v77, v77
    v_mfma_f32_16x16x32_bf16 v[84:87], v[80:83], a[180:183], v[84:87]
    v_mul_f32 v76, s55, v76
    v_mul_f32 v77, 0.5, v77
    v_mfma_f32_16x16x32_bf16 v[84:87], v[56:59], a[184:187], v[84:87]
    v_mul_f32 v64, v64, v77
    v_mul_f32 v65, v65, v77
    v_mfma_f32_16x16x32_bf16 v[84:87], v[24:27], a[188:191], v[84:87]
    v_cvt_pk_f16_f32 v64, v64, v65
    v_mul_f32 v66, v66, v77
    v_mfma_f32_16x16x32_bf16 v[68:71], v[96:99], a[192:195], 0
    s_nop 0
    v_mul_f32 v67, v67, v77
    v_cvt_pk_f16_f32 v65, v66, v67
    v_mfma_f32_16x16x32_bf16 v[68:71], v[92:95], a[196:199], v[68:71]
    s_nop 0
    v_cvt_pk_bf16_f32 v160, v84, v85
    v_cvt_pk_bf16_f32 v161, v86, v87
    v_mfma_f32_16x16x32_bf16 v[68:71], v[88:91], a[200:203], v[68:71]
    v_mul_f32 v32, v32, v77
    v_mul_f32 v33, v33, v77
    v_mfma_f32_16x16x32_bf16 v[68:71], v[80:83], a[204:207], v[68:71]
    v_cvt_pk_f16_f32 v66, v32, v33
    v_mul_f32 v34, v34, v77
    v_mfma_f32_16x16x32_bf16 v[68:71], v[56:59], a[208:211], v[68:71]
    v_mul_f32 v35, v35, v77
    v_cvt_pk_f16_f32 v67, v34, v35
    v_mfma_f32_16x16x32_bf16 v[68:71], v[24:27], a[212:215], v[68:71]
    v_mul_f32 v40, v40, v77
    v_mul_f32 v41, v41, v77
    v_mfma_f32_16x16x32_f16 v[32:35], v[28:31], v[4:7], v[204:207]
    ds_read_u16 v166, v131 offset:80
    v_cvt_pk_f16_f32 v142, v40, v41
    v_mfma_f32_16x16x32_f16 v[32:35], v[152:155], v[150:153], v[32:35]
    ds_read_u16 v162, v131 offset:96
    v_mul_f32 v42, v42, v77
    v_mfma_f32_16x16x32_f16 v[24:27], v[72:75], v[4:7], v[200:203]
    ds_read_u16 v158, v131 offset:104
    v_mul_f32 v43, v43, v77
    v_mfma_f32_16x16x32_f16 v[24:27], v[146:149], v[150:153], v[24:27]
    s_waitcnt lgkmcnt(3)
    ds_read_b32 v120, v120 offset:64
    v_cvt_pk_f16_f32 v143, v42, v43
    v_mfma_f32_16x16x32_f16 v[56:59], v[60:63], v[4:7], v[208:211]
    v_mul_f32 v16, v16, v76
    v_mul_f32 v17, v17, v76
    v_mfma_f32_16x16x32_f16 v[56:59], v[52:55], v[28:31], v[56:59]
    v_cvt_pk_f16_f32 v16, v16, v17
    v_mul_f32 v18, v18, v76
    v_mfma_f32_16x16x32_f16 v[56:59], v[48:51], v[152:155], v[56:59]
    v_mul_f32 v19, v19, v76
    v_cvt_pk_f16_f32 v17, v18, v19
    v_mfma_f32_16x16x32_f16 v[40:43], v[60:63], v[44:47], v[208:211]
    v_mul_f32 v36, v36, v76
    v_mul_f32 v37, v37, v76
    v_mfma_f32_16x16x32_f16 v[40:43], v[52:55], v[72:75], v[40:43]
    v_cvt_pk_f16_f32 v18, v36, v37
    v_mul_f32 v38, v38, v76
    v_mfma_f32_16x16x32_f16 v[40:43], v[48:51], v[146:149], v[40:43]
    v_mul_f32 v39, v39, v76
    v_cvt_pk_f16_f32 v19, v38, v39
    v_mfma_f32_16x16x32_f16 v[36:39], v[28:31], v[44:47], v[192:195]
    v_mul_f32 v12, v12, v76
    v_mul_f32 v13, v13, v76
    v_mfma_f32_16x16x32_f16 v[36:39], v[152:155], v[144:147], v[36:39]
    v_cvt_pk_f16_f32 v140, v12, v13
    v_mul_f32 v14, v14, v76
    v_mul_f32 v15, v15, v76
    v_cvt_pk_f16_f32 v141, v14, v15
    v_mfma_f32_16x16x32_f16 v[12:15], v[64:67], v[4:7], v[196:199]
    v_cvt_pk_bf16_f32 v156, v68, v69
    v_cvt_pk_bf16_f32 v157, v70, v71
    v_mfma_f32_16x16x32_f16 v[12:15], v[140:143], v[150:153], v[12:15]
    v_max3_f32 v121, v32, v33, v34
    v_max3_f32 v121, v121, v35, v24
    v_mfma_f32_16x16x32_f16 v[4:7], v[60:63], v[16:19], v[208:211]
    s_nop 0
    v_max3_f32 v121, v121, v25, v26
    v_mov_b32_dpp v59, v43 quad_perm:[0,1,2,3] row_mask:0x2 bank_mask:0xf
    v_mfma_f32_16x16x32_f16 v[4:7], v[52:55], v[64:67], v[4:7]
    s_nop 0
    v_max3_f32 v121, v121, v27, v12
    v_max3_f32 v121, v121, v13, v14
    v_mfma_f32_16x16x32_f16 v[4:7], v[48:51], v[140:143], v[4:7]
    v_max3_f32 v121, v121, v15, v56
    v_mov_b32 v57, v121
    v_mfma_f32_16x16x32_f16 v[52:55], v[72:75], v[44:47], v[188:191]
    s_nop 0
    v_permlane32_swap_b32 v57, v121
    v_mfma_f32_16x16x32_f16 v[52:55], v[146:149], v[144:147], v[52:55]
    v_max_f32 v121, v57, v121
    v_mov_b32 v57, v121
    v_mfma_f32_16x16x32_f16 v[48:51], v[64:67], v[44:47], v[184:187]
    s_nop 0
    v_permlane16_swap_b32 v57, v121
    v_mfma_f32_16x16x32_f16 v[48:51], v[140:143], v[144:147], v[48:51]
    v_max_f32 v121, v57, v121
    v_sub_f32 v32, v32, v121
    v_sub_f32 v33, v33, v121
    v_sub_f32 v34, v34, v121
    v_sub_f32 v35, v35, v121
    v_sub_f32 v24, v24, v121
    v_sub_f32 v25, v25, v121
    v_sub_f32 v26, v26, v121
    v_sub_f32 v27, v27, v121
    v_sub_f32 v12, v12, v121
    v_sub_f32 v13, v13, v121
    v_sub_f32 v14, v14, v121
    v_sub_f32 v15, v15, v121
    v_sub_f32 v56, v56, v121
    v_exp_f32 v32, v32
    v_exp_f32 v33, v33
    v_exp_f32 v34, v34
    v_exp_f32 v35, v35
    v_cvt_pk_bf16_f32 v60, v32, v33
    v_cvt_pk_bf16_f32 v61, v34, v35
    v_exp_f32 v24, v24
    v_exp_f32 v25, v25
    v_exp_f32 v26, v26
    v_exp_f32 v27, v27
    v_cvt_pk_bf16_f32 v62, v24, v25
    v_cvt_pk_bf16_f32 v63, v26, v27
    v_exp_f32 v12, v12
    v_exp_f32 v13, v13
    v_exp_f32 v14, v14
    v_exp_f32 v15, v15
    v_cvt_pk_bf16_f32 v168, v12, v13
    v_cvt_pk_bf16_f32 v169, v14, v15
    v_exp_f32 v56, v56
    v_mov_b32_dpp v59, v7 quad_perm:[0,1,2,3] row_mask:0x4 bank_mask:0xf
    v_cvt_pk_bf16_f32 v170, v56, 0
    v_mfma_f32_16x16x32_bf16 v[44:47], v[220:223], v[60:63], 0
    s_waitcnt lgkmcnt(0)
    v_and_b32 v121, 0xffff0000, v120
    v_lshlrev_b32 v120, 16, v120
    v_mfma_f32_16x16x32_bf16 v[44:47], v[220:223], v[168:171], v[44:47]
    v_add_f32 v120, v120, v121
    v_add_f32 v120, v120, v211
    v_mfma_f32_16x16x32_bf16 v[12:15], v[0:3], v[60:63], 0
    s_nop 0
    v_mov_b32_dpp v59, v120 quad_perm:[0,1,2,3] row_mask:0x8 bank_mask:0xf
    v_mov_b32 v4, v59
    v_mfma_f32_16x16x32_bf16 v[12:15], v[164:167], v[168:171], v[12:15]
    s_nop 0
    v_max_f32_dpp v4, v4, v4 row_ror:8 row_mask:0xf bank_mask:0xf
    v_max3_f32 v121, v36, v37, v38
    v_mfma_f32_16x16x32_bf16 v[24:27], v[8:11], v[60:63], 0
    v_max_f32_dpp v4, v4, v4 row_ror:4 row_mask:0xf bank_mask:0xf
    v_max3_f32 v121, v121, v39, v52
    v_mfma_f32_16x16x32_bf16 v[24:27], v[160:163], v[168:171], v[24:27]
    v_max_f32_dpp v4, v4, v4 row_ror:2 row_mask:0xf bank_mask:0xf
    v_max3_f32 v121, v121, v53, v54
    v_mfma_f32_16x16x32_bf16 v[32:35], v[20:23], v[60:63], 0
    v_max_f32_dpp v4, v4, v4 row_ror:1 row_mask:0xf bank_mask:0xf
    v_mov_b32 v120, v4
    v_mfma_f32_16x16x32_bf16 v[32:35], v[156:159], v[168:171], v[32:35]
    s_nop 0
    v_permlane32_swap_b32 v120, v4
    v_max_f32 v4, v120, v4
    v_mov_b32 v120, v4
    v_rcp_f32 v44, v44
    v_max3_f32 v121, v121, v55, v48
    v_permlane16_swap_b32 v120, v4
    v_max_f32 v4, v120, v4
    v_sub_f32 v59, v59, v4
    v_exp_f32 v59, v59
    v_mul_f32 v12, v12, v44
    v_cvt_pk_bf16_f32 v59, v59, v59
    ds_write_b16 v123, v59 offset:64
    v_mul_f32 v13, v13, v44
    v_cvt_pk_bf16_f32 v68, v12, v13
    ds_read_b128 v[60:63], v132 offset:48
    v_mul_f32 v14, v14, v44
    v_mul_f32 v15, v15, v44
    v_cvt_pk_bf16_f32 v69, v14, v15
    ds_read_b128 v[56:59], v132 offset:64
    v_mfma_f32_16x16x32_f16 v[12:15], v[28:31], v[16:19], v[180:183]
    v_mul_f32 v24, v24, v44
    v_mul_f32 v25, v25, v44
    v_mfma_f32_16x16x32_f16 v[12:15], v[152:155], v[138:141], v[12:15]
    ds_write_b64 v135, v[68:69] offset:0
    v_mfma_f32_16x16x32_f16 v[28:31], v[72:75], v[16:19], v[176:179]
    v_cvt_pk_bf16_f32 v70, v24, v25
    v_mul_f32 v26, v26, v44
    v_mfma_f32_16x16x32_f16 v[28:31], v[146:149], v[138:141], v[28:31]
    v_mul_f32 v27, v27, v44
    v_cvt_pk_bf16_f32 v71, v26, v27
    v_mfma_f32_16x16x32_f16 v[24:27], v[64:67], v[16:19], v[172:175]
    ds_write_b64 v135, v[70:71] offset:8
    v_mfma_f32_16x16x32_f16 v[24:27], v[140:143], v[138:141], v[24:27]
    s_waitcnt lgkmcnt(3)
    v_mul_f32 v32, v32, v44
    v_mul_f32 v33, v33, v44
    v_cvt_pk_bf16_f32 v146, v32, v33
    v_mul_f32 v34, v34, v44
    v_mfma_f32_16x16x32_bf16 v[16:19], v[60:63], v[0:3], 0
    s_waitcnt lgkmcnt(2)
    v_mul_f32 v35, v35, v44
    v_cvt_pk_bf16_f32 v147, v34, v35
    v_max3_f32 v121, v121, v49, v50
    v_max3_f32 v121, v121, v51, v41
    v_mfma_f32_16x16x32_bf16 v[16:19], v[56:59], v[164:167], v[16:19]
    ds_write_b64 v134, v[146:147] offset:0
    v_mfma_f32_16x16x32_bf16 v[44:47], v[60:63], v[8:11], 0
    v_mov_b32 v146, v121
    v_max3_f32 v120, v12, v13, v14
    v_mfma_f32_16x16x32_bf16 v[44:47], v[56:59], v[160:163], v[44:47]
    v_permlane32_swap_b32 v146, v121
    v_mfma_f32_16x16x32_bf16 v[32:35], v[60:63], v[20:23], 0
    v_max_f32 v121, v146, v121
    v_mov_b32 v146, v121
    v_mfma_f32_16x16x32_bf16 v[32:35], v[56:59], v[156:159], v[32:35]
    s_nop 0
    v_permlane16_swap_b32 v146, v121
    v_max_f32 v121, v146, v121
    v_sub_f32 v36, v36, v121
    v_sub_f32 v37, v37, v121
    v_sub_f32 v38, v38, v121
    v_sub_f32 v39, v39, v121
    v_sub_f32 v52, v52, v121
    v_sub_f32 v53, v53, v121
    v_sub_f32 v54, v54, v121
    v_sub_f32 v55, v55, v121
    v_sub_f32 v48, v48, v121
    v_sub_f32 v49, v49, v121
    v_sub_f32 v50, v50, v121
    v_sub_f32 v51, v51, v121
    v_sub_f32 v41, v41, v121
    v_exp_f32 v36, v36
    v_exp_f32 v37, v37
    v_exp_f32 v38, v38
    v_exp_f32 v39, v39
    v_cvt_pk_bf16_f32 v36, v36, v37
    v_cvt_pk_bf16_f32 v37, v38, v39
    v_exp_f32 v52, v52
    v_exp_f32 v53, v53
    v_exp_f32 v54, v54
    v_exp_f32 v55, v55
    v_cvt_pk_bf16_f32 v38, v52, v53
    v_cvt_pk_bf16_f32 v39, v54, v55
    v_exp_f32 v48, v48
    v_exp_f32 v49, v49
    v_exp_f32 v50, v50
    v_exp_f32 v51, v51
    v_cvt_pk_bf16_f32 v168, v48, v49
    v_cvt_pk_bf16_f32 v169, v50, v51
    v_exp_f32 v41, v41
    v_mov_b32_dpp v19, v47 quad_perm:[0,1,2,3] row_mask:0x2 bank_mask:0xf
    v_cvt_pk_bf16_f32 v170, v41, 0
    v_mfma_f32_16x16x32_bf16 v[44:47], v[220:223], v[36:39], 0
    v_mov_b32_dpp v19, v35 quad_perm:[0,1,2,3] row_mask:0x4 bank_mask:0xf
    v_cvt_pk_bf16_f32 v19, v19, v19
    v_mfma_f32_16x16x32_bf16 v[44:47], v[220:223], v[168:171], v[44:47]
    ds_write_b16 v131, v19
    v_mfma_f32_16x16x32_bf16 v[32:35], v[0:3], v[36:39], 0
    ds_read_b128 v[16:19], v137 offset:0
    v_max3_f32 v120, v120, v15, v28
    v_mfma_f32_16x16x32_bf16 v[32:35], v[164:167], v[168:171], v[32:35]
    ds_read_b128 v[146:149], v136 offset:0
    v_max3_f32 v120, v120, v29, v30
    v_mfma_f32_16x16x32_bf16 v[48:51], v[8:11], v[36:39], 0
    ds_read_b128 v[72:75], v137 offset:128
    v_max3_f32 v120, v120, v31, v24
    v_mfma_f32_16x16x32_bf16 v[48:51], v[160:163], v[168:171], v[48:51]
    ds_read_b128 v[88:91], v136 offset:128
    v_max3_f32 v120, v120, v25, v26
    v_mfma_f32_16x16x32_bf16 v[40:43], v[20:23], v[36:39], 0
    ds_read_b128 v[76:79], v137 offset:256
    v_max3_f32 v120, v120, v27, v6
    v_mfma_f32_16x16x32_bf16 v[40:43], v[156:159], v[168:171], v[40:43]
    ds_read_b128 v[56:59], v136 offset:256
    v_mov_b32 v121, v120
    v_rcp_f32 v44, v44
    s_nop 0
    v_mul_f32 v32, v32, v44
    v_mul_f32 v33, v33, v44
    v_cvt_pk_bf16_f32 v32, v32, v33
    v_mul_f32 v34, v34, v44
    v_mul_f32 v35, v35, v44
    v_cvt_pk_bf16_f32 v33, v34, v35
    v_mul_f32 v48, v48, v44
    v_mul_f32 v49, v49, v44
    v_cvt_pk_bf16_f32 v34, v48, v49
    v_mul_f32 v50, v50, v44
    s_waitcnt lgkmcnt(5)
    v_mfma_f32_16x16x32_bf16 v[36:39], a[0:3], v[16:19], 0
    ds_write_b64 v135, v[32:33] offset:1536
    v_mul_f32 v51, v51, v44
    v_cvt_pk_bf16_f32 v35, v50, v51
    v_mul_f32 v40, v40, v44
    v_mul_f32 v41, v41, v44
    v_cvt_pk_bf16_f32 v4, v40, v41
    v_mul_f32 v42, v42, v44
    v_mul_f32 v43, v43, v44
    v_cvt_pk_bf16_f32 v5, v42, v43
    ds_write_b64 v135, v[34:35] offset:1544
    v_permlane32_swap_b32 v121, v120
    v_max_f32 v120, v121, v120
    v_mov_b32 v121, v120
    s_nop 0
    ds_write_b64 v134, v[4:5] offset:1536
    v_permlane16_swap_b32 v121, v120
    v_max_f32 v120, v121, v120
    v_sub_f32 v12, v12, v120
    v_sub_f32 v13, v13, v120
    v_sub_f32 v14, v14, v120
    v_sub_f32 v15, v15, v120
    v_sub_f32 v28, v28, v120
    v_sub_f32 v29, v29, v120
    v_sub_f32 v30, v30, v120
    v_sub_f32 v31, v31, v120
    v_sub_f32 v24, v24, v120
    v_sub_f32 v25, v25, v120
    v_sub_f32 v26, v26, v120
    v_sub_f32 v27, v27, v120
    v_sub_f32 v6, v6, v120
    v_exp_f32 v12, v12
    v_exp_f32 v13, v13
    v_exp_f32 v14, v14
    v_exp_f32 v15, v15
    v_cvt_pk_bf16_f32 v12, v12, v13
    v_cvt_pk_bf16_f32 v13, v14, v15
    v_exp_f32 v28, v28
    v_exp_f32 v29, v29
    v_exp_f32 v30, v30
    v_exp_f32 v31, v31
    v_cvt_pk_bf16_f32 v14, v28, v29
    v_cvt_pk_bf16_f32 v15, v30, v31
    v_exp_f32 v24, v24
    v_exp_f32 v25, v25
    v_exp_f32 v26, v26
    v_exp_f32 v27, v27
    v_cvt_pk_bf16_f32 v168, v24, v25
    v_cvt_pk_bf16_f32 v169, v26, v27
    v_exp_f32 v6, v6
    s_nop 0
    v_cvt_pk_bf16_f32 v170, v6, 0
    v_mfma_f32_16x16x32_bf16 v[152:155], v[220:223], v[12:15], 0
    s_nop 0
    v_mfma_f32_16x16x32_bf16 v[152:155], v[220:223], v[168:171], v[152:155]
    s_nop 1
    v_mfma_f32_16x16x32_bf16 v[4:7], v[0:3], v[12:15], 0
    s_nop 2
    v_mfma_f32_16x16x32_bf16 v[4:7], v[164:167], v[168:171], v[4:7]
    s_nop 0
    v_rcp_f32 v152, v152
    v_mfma_f32_16x16x32_bf16 v[0:3], v[8:11], v[12:15], 0
    s_nop 2
    v_mfma_f32_16x16x32_bf16 v[0:3], v[160:163], v[168:171], v[0:3]
    s_nop 0
    v_mul_f32 v4, v4, v152
    v_mul_f32 v5, v5, v152
    v_mfma_f32_16x16x32_bf16 v[8:11], v[20:23], v[12:15], 0
    v_cvt_pk_bf16_f32 v12, v4, v5
    v_mul_f32 v6, v6, v152
    v_mfma_f32_16x16x32_bf16 v[8:11], v[156:159], v[168:171], v[8:11]
    v_mul_f32 v7, v7, v152
    v_cvt_pk_bf16_f32 v13, v6, v7
    s_waitcnt lgkmcnt(0)
.p2align 6
L_loopS0:
    v_mfma_f32_16x16x32_bf16 v[36:39], a[4:7], v[146:149], v[36:39]
    ds_write_b64 v135, v[12:13] offset:3072
    v_mfma_f32_16x16x32_bf16 v[36:39], a[8:11], v[72:75], v[36:39]
    v_mul_f32 v0, v0, v152
    v_mul_f32 v1, v1, v152
    v_mfma_f32_16x16x32_bf16 v[36:39], a[12:15], v[88:91], v[36:39]
    v_cvt_pk_bf16_f32 v14, v0, v1
    v_mul_f32 v2, v2, v152
    v_mfma_f32_16x16x32_bf16 v[36:39], a[16:19], v[76:79], v[36:39]
    v_mul_f32 v3, v3, v152
    v_cvt_pk_bf16_f32 v15, v2, v3
    v_mfma_f32_16x16x32_bf16 v[36:39], a[20:23], v[56:59], v[36:39]
    ds_write_b64 v135, v[14:15] offset:3080
    v_mfma_f32_16x16x32_bf16 v[12:15], a[24:27], v[16:19], 0
    v_mul_f32 v8, v8, v152
    v_mul_f32 v9, v9, v152
    v_mfma_f32_16x16x32_bf16 v[12:15], a[28:31], v[146:149], v[12:15]
    v_cvt_pk_bf16_f32 v8, v8, v9
    v_mul_f32 v10, v10, v152
    v_mfma_f32_16x16x32_bf16 v[12:15], a[32:35], v[72:75], v[12:15]
    v_mul_f32 v11, v11, v152
    v_cvt_pk_bf16_f32 v9, v10, v11
    v_mfma_f32_16x16x32_bf16 v[12:15], a[36:39], v[88:91], v[12:15]
    ds_write_b64 v134, v[8:9] offset:3072
    v_mfma_f32_16x16x32_bf16 v[12:15], a[40:43], v[76:79], v[12:15]
    v_fma_f32 v170, v40, v40, s42
    v_fmac_f32 v170, v41, v41
    v_mfma_f32_16x16x32_bf16 v[12:15], a[44:47], v[56:59], v[12:15]
    v_fmac_f32 v170, v42, v42
    v_fmac_f32 v170, v43, v43
    v_mfma_f32_16x16x32_bf16 v[152:155], a[48:51], v[16:19], 0
    v_fmac_f32 v170, v140, v140
    v_fmac_f32 v170, v141, v141
    v_mfma_f32_16x16x32_bf16 v[152:155], a[52:55], v[146:149], v[152:155]
    v_fmac_f32 v170, v142, v142
    v_fmac_f32 v170, v143, v143
    v_mfma_f32_16x16x32_bf16 v[152:155], a[56:59], v[72:75], v[152:155]
    s_waitcnt vmcnt(10)
    v_fmac_f32 v170, v44, v44
    v_fmac_f32 v170, v45, v45
    v_mfma_f32_16x16x32_bf16 v[152:155], a[60:63], v[88:91], v[152:155]
    v_fmac_f32 v170, v46, v46
    v_fmac_f32 v170, v47, v47
    v_mfma_f32_16x16x32_bf16 v[152:155], a[64:67], v[76:79], v[152:155]
    v_cvt_pk_bf16_f32 v0, v92, v93
    v_cvt_pk_bf16_f32 v1, v170, v122
    v_mfma_f32_16x16x32_bf16 v[152:155], a[68:71], v[56:59], v[152:155]
    ds_write_b64 v130, v[0:1]
    v_mfma_f32_16x16x32_bf16 v[60:63], a[72:75], v[16:19], 0
    v_add_u32 v135, s49, v135
    v_add_u32 v134, s49, v134
    v_mfma_f32_16x16x32_bf16 v[60:63], a[76:79], v[146:149], v[60:63]
    v_fma_f32 v170, v36, v36, s41
    v_fmac_f32 v170, v37, v37
    v_mfma_f32_16x16x32_bf16 v[60:63], a[80:83], v[72:75], v[60:63]
    v_fmac_f32 v170, v38, v38
    v_fmac_f32 v170, v39, v39
    v_mfma_f32_16x16x32_bf16 v[60:63], a[84:87], v[88:91], v[60:63]
    v_fmac_f32 v170, v12, v12
    v_fmac_f32 v170, v13, v13
    v_mfma_f32_16x16x32_bf16 v[60:63], a[88:91], v[76:79], v[60:63]
    v_fmac_f32 v170, v14, v14
    v_fmac_f32 v170, v15, v15
    v_mfma_f32_16x16x32_bf16 v[60:63], a[92:95], v[56:59], v[60:63]
    v_fmac_f32 v170, v152, v152
    v_fmac_f32 v170, v153, v153
    v_mfma_f32_16x16x32_bf16 v[92:95], a[96:99], v[16:19], 0
    v_fmac_f32 v170, v154, v154
    v_fmac_f32 v170, v155, v155
    v_mfma_f32_16x16x32_bf16 v[92:95], a[100:103], v[146:149], v[92:95]
    s_waitcnt lgkmcnt(0)
    s_nop 0
    v_fma_f32 v0, v60, v60, s41
    v_fmac_f32 v0, v61, v61
    v_mfma_f32_16x16x32_bf16 v[92:95], a[104:107], v[72:75], v[92:95]
    s_barrier
    ds_read_b128 v[8:11], v129 offset:0
    v_fmac_f32 v0, v62, v62
    v_mfma_f32_16x16x32_bf16 v[92:95], a[108:111], v[88:91], v[92:95]
    ds_read_b128 v[64:67], v129 offset:1024
    v_fmac_f32 v0, v63, v63
    v_mfma_f32_16x16x32_bf16 v[92:95], a[112:115], v[76:79], v[92:95]
    v_mfma_f32_16x16x32_bf16 v[92:95], a[116:119], v[56:59], v[92:95]
    s_nop 1
    v_mfma_f32_16x16x32_bf16 v[80:83], a[120:123], v[16:19], 0
    s_nop 2
    v_mfma_f32_16x16x32_bf16 v[80:83], a[124:127], v[146:149], v[80:83]
    s_nop 0
    v_fmac_f32 v0, v92, v92
    v_fmac_f32 v0, v93, v93
    v_mfma_f32_16x16x32_bf16 v[80:83], a[128:131], v[72:75], v[80:83]
    v_fmac_f32 v0, v94, v94
    v_fmac_f32 v0, v95, v95
    v_mfma_f32_16x16x32_bf16 v[80:83], a[132:135], v[88:91], v[80:83]
    v_mfma_f32_16x16x32_bf16 v[80:83], a[136:139], v[76:79], v[80:83]
    v_mfma_f32_16x16x32_bf16 v[80:83], a[140:143], v[56:59], v[80:83]
    s_waitcnt lgkmcnt(1)
    v_readfirstlane_b32 s12, v9
    v_mfma_f32_16x16x32_bf16 v[84:87], v[216:219], v[8:11], 0
    s_waitcnt lgkmcnt(0)
    s_nop 1
    v_mfma_f32_16x16x32_bf16 v[84:87], v[216:219], v[64:67], v[84:87]
    s_lshr_b32 s12, s12, 23
    v_fmac_f32 v0, v80, v80
    v_fmac_f32 v0, v81, v81
    v_mfma_f32_16x16x32_bf16 v[8:11], v[16:19], a[144:147], 0
    v_fmac_f32 v0, v82, v82
    v_fmac_f32 v0, v83, v83
    v_mfma_f32_16x16x32_bf16 v[8:11], v[146:149], a[148:151], v[8:11]
    s_nop 0
    v_rsq_f32 v84, v84
    v_mfma_f32_16x16x32_bf16 v[8:11], v[72:75], a[152:155], v[8:11]
    v_rsq_f32 v85, v85
    v_mfma_f32_16x16x32_bf16 v[8:11], v[88:91], a[156:159], v[8:11]
    v_rsq_f32 v86, v86
    v_mfma_f32_16x16x32_bf16 v[8:11], v[76:79], a[160:163], v[8:11]
    ds_read_b128 v[64:67], v137 offset:1536
    v_mul_f32 v84, s43, v84
    v_mfma_f32_16x16x32_bf16 v[8:11], v[56:59], a[164:167], v[8:11]
    ds_read_b128 v[68:71], v136 offset:1536
    v_mul_f32 v85, s43, v85
    v_mfma_f32_16x16x32_bf16 v[48:51], v[16:19], a[168:171], 0
    ds_read_b128 v[52:55], v137 offset:1664
    v_mul_f32 v86, s43, v86
    v_mfma_f32_16x16x32_bf16 v[48:51], v[146:149], a[172:175], v[48:51]
    ds_read_b128 v[96:99], v136 offset:1664
    v_cvt_pk_bf16_f32 v170, v170, v0
    v_mfma_f32_16x16x32_bf16 v[48:51], v[72:75], a[176:179], v[48:51]
    ds_read_b128 v[108:111], v137 offset:1792
    v_cvt_pk_bf16_f32 v0, v8, v9
    v_mfma_f32_16x16x32_bf16 v[48:51], v[88:91], a[180:183], v[48:51]
    ds_read_b128 v[104:107], v136 offset:1792
    v_cvt_pk_bf16_f32 v1, v10, v11
    v_mfma_f32_16x16x32_bf16 v[48:51], v[76:79], a[184:187], v[48:51]
    v_mul_f32 v32, v32, v84
    v_mul_f32 v33, v33, v84
    v_mfma_f32_16x16x32_bf16 v[48:51], v[56:59], a[188:191], v[48:51]
    s_nop 0
    v_cvt_pk_bf16_f32 v2, v32, v33
    v_mul_f32 v34, v34, v84
    v_mfma_f32_16x16x16_bf16 v[118:121], v[216:217], v[170:171], 0
    s_nop 0
    v_mul_f32 v35, v35, v84
    v_cvt_pk_bf16_f32 v3, v34, v35
    v_mul_f32 v4, v4, v84
    v_cvt_pk_bf16_f32 v8, v48, v49
    v_mfma_f32_16x16x32_bf16 v[32:35], v[16:19], a[192:195], 0
    ds_write_b64 v135, v[2:3] offset:0
    v_mfma_f32_16x16x32_bf16 v[32:35], v[146:149], a[196:199], v[32:35]
    v_rsq_f32 v118, v118
    v_mfma_f32_16x16x32_bf16 v[32:35], v[72:75], a[200:203], v[32:35]
    v_rsq_f32 v119, v119
    v_mfma_f32_16x16x32_bf16 v[32:35], v[88:91], a[204:207], v[32:35]
    v_mul_f32 v118, s55, v118
    v_mul_f32 v119, 0.5, v119
    v_mfma_f32_16x16x32_bf16 v[32:35], v[76:79], a[208:211], v[32:35]
    v_cvt_pk_bf16_f32 v9, v50, v51
    v_mul_f32 v36, v36, v118
    v_mfma_f32_16x16x32_bf16 v[32:35], v[56:59], a[212:215], v[32:35]
    s_waitcnt lgkmcnt(1)
    v_mul_f32 v37, v37, v118
    v_cvt_pk_f16_f32 v76, v36, v37
    v_mfma_f32_16x16x32_bf16 v[146:149], a[0:3], v[64:67], 0
    v_mul_f32 v38, v38, v118
    v_mul_f32 v39, v39, v118
    v_mfma_f32_16x16x32_bf16 v[146:149], a[4:7], v[68:71], v[146:149]
    v_cvt_pk_f16_f32 v77, v38, v39
    v_mul_f32 v12, v12, v118
    v_mfma_f32_16x16x32_bf16 v[146:149], a[8:11], v[52:55], v[146:149]
    v_mul_f32 v13, v13, v118
    v_cvt_pk_f16_f32 v78, v12, v13
    v_mfma_f32_16x16x32_bf16 v[146:149], a[12:15], v[96:99], v[146:149]
    v_mul_f32 v14, v14, v118
    v_mul_f32 v15, v15, v118
    v_mfma_f32_16x16x32_bf16 v[146:149], a[16:19], v[108:111], v[146:149]
    v_cvt_pk_f16_f32 v79, v14, v15
    v_mul_f32 v152, v152, v118
    v_mfma_f32_16x16x32_bf16 v[146:149], a[20:23], v[104:107], v[146:149]
    v_mul_f32 v153, v153, v118
    v_cvt_pk_f16_f32 v152, v152, v153
    v_mfma_f32_16x16x32_bf16 v[36:39], a[24:27], v[64:67], 0
    v_mul_f32 v154, v154, v118
    v_mul_f32 v155, v155, v118
    v_mfma_f32_16x16x32_bf16 v[36:39], a[28:31], v[68:71], v[36:39]
    v_cvt_pk_f16_f32 v153, v154, v155
    v_mul_f32 v60, v60, v119
    v_mfma_f32_16x16x32_bf16 v[36:39], a[32:35], v[52:55], v[36:39]
    v_mul_f32 v61, v61, v119
    v_cvt_pk_f16_f32 v16, v60, v61
    v_mfma_f32_16x16x32_bf16 v[36:39], a[36:39], v[96:99], v[36:39]
    v_mul_f32 v62, v62, v119
    v_mul_f32 v63, v63, v119
    v_mfma_f32_16x16x32_bf16 v[36:39], a[40:43], v[108:111], v[36:39]
    v_cvt_pk_f16_f32 v17, v62, v63
    v_mul_f32 v92, v92, v119
    v_mfma_f32_16x16x32_bf16 v[36:39], a[44:47], v[104:107], v[36:39]
    v_mul_f32 v93, v93, v119
    v_cvt_pk_f16_f32 v18, v92, v93
    v_mfma_f32_16x16x32_bf16 v[72:75], a[48:51], v[64:67], 0
    v_mul_f32 v94, v94, v119
    v_mul_f32 v95, v95, v119
    v_mfma_f32_16x16x32_bf16 v[72:75], a[52:55], v[68:71], v[72:75]
    v_cvt_pk_f16_f32 v19, v94, v95
    v_mul_f32 v80, v80, v119
    v_mfma_f32_16x16x32_bf16 v[72:75], a[56:59], v[52:55], v[72:75]
    v_mul_f32 v81, v81, v119
    v_cvt_pk_f16_f32 v154, v80, v81
    v_mfma_f32_16x16x32_bf16 v[72:75], a[60:63], v[96:99], v[72:75]
    v_mul_f32 v82, v82, v119
    v_mul_f32 v83, v83, v119
    v_mfma_f32_16x16x32_bf16 v[72:75], a[64:67], v[108:111], v[72:75]
    v_cvt_pk_f16_f32 v155, v82, v83
    v_cvt_pk_bf16_f32 v12, v32, v33
    v_mfma_f32_16x16x32_bf16 v[72:75], a[68:71], v[104:107], v[72:75]
    v_cvt_pk_bf16_f32 v13, v34, v35
    v_mul_f32 v5, v5, v84
    v_mfma_f32_16x16x32_bf16 v[32:35], a[72:75], v[64:67], 0
    v_cvt_pk_bf16_f32 v4, v4, v5
    v_mul_f32 v6, v6, v84
    v_mfma_f32_16x16x32_bf16 v[32:35], a[76:79], v[68:71], v[32:35]
    v_mul_f32 v7, v7, v84
    v_cvt_pk_bf16_f32 v5, v6, v7
    v_mfma_f32_16x16x32_bf16 v[32:35], a[80:83], v[52:55], v[32:35]
    ds_write_b64 v135, v[4:5] offset:8
    v_mfma_f32_16x16x32_bf16 v[32:35], a[84:87], v[96:99], v[32:35]
    v_mul_f32 v24, v24, v84
    v_mul_f32 v25, v25, v84
    v_mfma_f32_16x16x32_bf16 v[32:35], a[88:91], v[108:111], v[32:35]
    v_cvt_pk_bf16_f32 v2, v24, v25
    v_mul_f32 v26, v26, v84
    v_mfma_f32_16x16x32_bf16 v[32:35], a[92:95], v[104:107], v[32:35]
    v_mul_f32 v27, v27, v84
    v_cvt_pk_bf16_f32 v3, v26, v27
    v_mfma_f32_16x16x32_bf16 v[4:7], a[96:99], v[64:67], 0
    ds_write_b64 v134, v[2:3] offset:0
    v_mfma_f32_16x16x32_bf16 v[4:7], a[100:103], v[68:71], v[4:7]
    v_fma_f32 v2, v146, v146, s41
    v_fmac_f32 v2, v147, v147
    v_mfma_f32_16x16x32_bf16 v[4:7], a[104:107], v[52:55], v[4:7]
    v_fmac_f32 v2, v148, v148
    v_fmac_f32 v2, v149, v149
    v_mfma_f32_16x16x32_bf16 v[4:7], a[108:111], v[96:99], v[4:7]
    v_fmac_f32 v2, v36, v36
    v_fmac_f32 v2, v37, v37
    v_mfma_f32_16x16x32_bf16 v[4:7], a[112:115], v[108:111], v[4:7]
    v_fmac_f32 v2, v38, v38
    v_fmac_f32 v2, v39, v39
    v_mfma_f32_16x16x32_bf16 v[4:7], a[116:119], v[104:107], v[4:7]
    v_fmac_f32 v2, v72, v72
    v_fmac_f32 v2, v73, v73
    v_mfma_f32_16x16x32_bf16 v[24:27], a[120:123], v[64:67], 0
    v_fmac_f32 v2, v74, v74
    v_fmac_f32 v2, v75, v75
    v_mfma_f32_16x16x32_bf16 v[24:27], a[124:127], v[68:71], v[24:27]
    v_mul_f32 v28, v28, v85
    v_mul_f32 v29, v29, v85
    v_mfma_f32_16x16x32_bf16 v[24:27], a[128:131], v[52:55], v[24:27]
    v_cvt_pk_bf16_f32 v88, v28, v29
    v_mul_f32 v30, v30, v85
    v_mfma_f32_16x16x32_bf16 v[24:27], a[132:135], v[96:99], v[24:27]
    v_mul_f32 v31, v31, v85
    v_cvt_pk_bf16_f32 v89, v30, v31
    v_mfma_f32_16x16x32_bf16 v[24:27], a[136:139], v[108:111], v[24:27]
    ds_write_b64 v135, v[88:89] offset:1536
    v_mfma_f32_16x16x32_bf16 v[24:27], a[140:143], v[104:107], v[24:27]
    v_mul_f32 v20, v20, v85
    v_mul_f32 v21, v21, v85
    v_mfma_f32_16x16x32_bf16 v[60:63], v[64:67], a[144:147], 0
    v_cvt_pk_bf16_f32 v90, v20, v21
    v_mul_f32 v22, v22, v85
    v_mfma_f32_16x16x32_bf16 v[60:63], v[68:71], a[148:151], v[60:63]
    v_mul_f32 v23, v23, v85
    v_cvt_pk_bf16_f32 v91, v22, v23
    v_mfma_f32_16x16x32_bf16 v[60:63], v[52:55], a[152:155], v[60:63]
    ds_write_b64 v135, v[90:91] offset:1544
    v_mfma_f32_16x16x32_bf16 v[60:63], v[96:99], a[156:159], v[60:63]
    v_mul_f32 v114, v114, v85
    v_mul_f32 v115, v115, v85
    v_mfma_f32_16x16x32_bf16 v[60:63], v[108:111], a[160:163], v[60:63]
    ds_read_b128 v[88:91], v137 offset:3072
    v_cvt_pk_bf16_f32 v10, v114, v115
    v_mfma_f32_16x16x32_bf16 v[60:63], v[104:107], a[164:167], v[60:63]
    ds_read_b128 v[56:59], v136 offset:3072
    v_mul_f32 v116, v116, v85
    v_mfma_f32_16x16x32_bf16 v[92:95], v[64:67], a[168:171], 0
    ds_read_b128 v[80:83], v137 offset:3200
    v_mul_f32 v117, v117, v85
    v_mfma_f32_16x16x32_bf16 v[92:95], v[68:71], a[172:175], v[92:95]
    ds_read_b128 v[28:31], v136 offset:3200
    v_cvt_pk_bf16_f32 v11, v116, v117
    v_mfma_f32_16x16x32_bf16 v[92:95], v[52:55], a[176:179], v[92:95]
    ds_write_b64 v134, v[10:11] offset:1536
    v_mfma_f32_16x16x32_bf16 v[92:95], v[96:99], a[180:183], v[92:95]
    v_fma_f32 v3, v32, v32, s41
    v_fmac_f32 v3, v33, v33
    v_mfma_f32_16x16x32_bf16 v[92:95], v[108:111], a[184:187], v[92:95]
    ds_read_b128 v[48:51], v137 offset:3328
    v_fmac_f32 v3, v34, v34
    v_mfma_f32_16x16x32_bf16 v[92:95], v[104:107], a[188:191], v[92:95]
    ds_read_b128 v[20:23], v136 offset:3328
    v_fmac_f32 v3, v35, v35
    v_mfma_f32_16x16x32_bf16 v[112:115], v[64:67], a[192:195], 0
    v_fmac_f32 v3, v4, v4
    v_fmac_f32 v3, v5, v5
    v_mfma_f32_16x16x32_bf16 v[112:115], v[68:71], a[196:199], v[112:115]
    s_sub_u32 s50, s45, s44
    v_fmac_f32 v3, v6, v6
    v_fmac_f32 v3, v7, v7
    v_mfma_f32_16x16x32_bf16 v[112:115], v[52:55], a[200:203], v[112:115]
    s_sub_u32 s51, s46, s47
    v_fmac_f32 v3, v24, v24
    v_fmac_f32 v3, v25, v25
    v_mfma_f32_16x16x32_bf16 v[112:115], v[96:99], a[204:207], v[112:115]
    s_mov_b32 s60, s59
    v_fmac_f32 v3, v26, v26
    v_fmac_f32 v3, v27, v27
    v_mfma_f32_16x16x32_bf16 v[112:115], v[108:111], a[208:211], v[112:115]
    s_mov_b32 s59, s58
    v_cvt_pk_bf16_f32 v170, v2, v3
    v_cvt_pk_bf16_f32 v2, v60, v61
    v_mfma_f32_16x16x32_bf16 v[112:115], v[104:107], a[212:215], v[112:115]
    s_mov_b32 s58, s57
    v_cvt_pk_bf16_f32 v3, v62, v63
    v_cvt_pk_bf16_f32 v10, v92, v93
    v_mfma_f32_16x16x16_bf16 v[60:63], v[216:217], v[170:171], 0
    s_waitcnt lgkmcnt(2)
    s_mov_b32 s57, s56
    v_cvt_pk_bf16_f32 v11, v94, v95
    v_mul_f32 v40, v40, v86
    v_mul_f32 v41, v41, v86
    v_cvt_pk_bf16_f32 v14, v112, v113
    v_mfma_f32_16x16x32_bf16 v[92:95], a[0:3], v[88:91], 0
    s_mov_b32 s7, s6
    v_cvt_pk_bf16_f32 v15, v114, v115
    v_cvt_pk_bf16_f32 v40, v40, v41
    v_mfma_f32_16x16x32_bf16 v[92:95], a[4:7], v[56:59], v[92:95]
    s_mov_b32 s6, s5
    v_rsq_f32 v60, v60
    v_mfma_f32_16x16x32_bf16 v[92:95], a[8:11], v[80:83], v[92:95]
    s_mov_b32 s5, s4
    v_rsq_f32 v61, v61
    v_mfma_f32_16x16x32_bf16 v[92:95], a[12:15], v[28:31], v[92:95]
    s_waitcnt lgkmcnt(0)
    s_sub_u32 s14, s6, s7
    v_mul_f32 v60, s55, v60
    v_mul_f32 v61, 0.5, v61
    v_mfma_f32_16x16x32_bf16 v[92:95], a[16:19], v[48:51], v[92:95]
    s_add_u32 s61, s61, 1
    v_mul_f32 v146, v146, v60
    v_mul_f32 v147, v147, v60
    v_mfma_f32_16x16x32_bf16 v[92:95], a[20:23], v[20:23], v[92:95]
    s_ff1_i32_b32 s15, s66
    v_cvt_pk_f16_f32 v96, v146, v147
    v_mul_f32 v148, v148, v60
    v_mfma_f32_16x16x32_bf16 v[64:67], a[24:27], v[88:91], 0
    s_cmp_lg_u32 s66, 0
    v_mul_f32 v149, v149, v60
    v_cvt_pk_f16_f32 v97, v148, v149
    v_mfma_f32_16x16x32_bf16 v[64:67], a[28:31], v[56:59], v[64:67]
    s_cselect_b32 s12, s15, s12
    v_mul_f32 v36, v36, v60
    v_mul_f32 v37, v37, v60
    v_mfma_f32_16x16x32_bf16 v[64:67], a[32:35], v[80:83], v[64:67]
    s_cmp_lt_u32 s61, s71
    v_cvt_pk_f16_f32 v98, v36, v37
    v_mul_f32 v38, v38, v60
    v_mfma_f32_16x16x32_bf16 v[64:67], a[36:39], v[28:31], v[64:67]
    s_cselect_b32 s15, 31, s15
    v_mul_f32 v39, v39, v60
    v_cvt_pk_f16_f32 v99, v38, v39
    v_mfma_f32_16x16x32_bf16 v[64:67], a[40:43], v[48:51], v[64:67]
    s_bitset0_b32 s66, s15
    v_mul_f32 v72, v72, v60
    v_mul_f32 v73, v73, v60
    v_mfma_f32_16x16x32_bf16 v[64:67], a[44:47], v[20:23], v[64:67]
    s_add_u32 s12, s12, 20
    v_cvt_pk_f16_f32 v146, v72, v73
    v_mul_f32 v74, v74, v60
    v_mfma_f32_16x16x32_bf16 v[68:71], a[48:51], v[88:91], 0
    s_max_u32 s12, s12, s61
    v_mul_f32 v75, v75, v60
    v_cvt_pk_f16_f32 v147, v74, v75
    v_mfma_f32_16x16x32_bf16 v[68:71], a[52:55], v[56:59], v[68:71]
    s_cmp_lt_u32 s61, s71
    v_mul_f32 v32, v32, v61
    v_mul_f32 v33, v33, v61
    v_mfma_f32_16x16x32_bf16 v[68:71], a[56:59], v[80:83], v[68:71]
    s_cselect_b32 s15, s61, s12
    v_cvt_pk_f16_f32 v36, v32, v33
    v_mul_f32 v34, v34, v61
    v_mfma_f32_16x16x32_bf16 v[68:71], a[60:63], v[28:31], v[68:71]
    s_cselect_b32 s56, s69, s70
    v_mul_f32 v35, v35, v61
    v_cvt_pk_f16_f32 v37, v34, v35
    v_mfma_f32_16x16x32_bf16 v[68:71], a[64:67], v[48:51], v[68:71]
    s_add_u32 s56, s56, s15
    v_mul_f32 v4, v4, v61
    v_mul_f32 v5, v5, v61
    v_mfma_f32_16x16x32_bf16 v[68:71], a[68:71], v[20:23], v[68:71]
    s_mul_i32 s53, s56, 58255
    v_cvt_pk_f16_f32 v38, v4, v5
    v_mul_f32 v6, v6, v61
    v_mfma_f32_16x16x32_bf16 v[72:75], a[72:75], v[88:91], 0
    s_lshr_b32 s53, s53, 22
    v_mul_f32 v7, v7, v61
    v_cvt_pk_f16_f32 v39, v6, v7
    v_mfma_f32_16x16x32_bf16 v[72:75], a[76:79], v[56:59], v[72:75]
    s_mul_i32 s53, s53, s63
    v_mul_f32 v24, v24, v61
    v_mul_f32 v25, v25, v61
    v_mfma_f32_16x16x32_bf16 v[72:75], a[80:83], v[80:83], v[72:75]
    s_mul_i32 s56, s56, s62
    v_cvt_pk_f16_f32 v148, v24, v25
    v_mul_f32 v26, v26, v61
    v_mfma_f32_16x16x32_bf16 v[72:75], a[84:87], v[28:31], v[72:75]
    s_add_u32 s56, s56, s53
    v_mul_f32 v27, v27, v61
    v_cvt_pk_f16_f32 v149, v26, v27
    v_mfma_f32_16x16x32_bf16 v[72:75], a[88:91], v[48:51], v[72:75]
    s_mul_i32 s4, s15, 112
    v_mul_f32 v42, v42, v86
    v_mul_f32 v43, v43, v86
    v_mfma_f32_16x16x32_bf16 v[72:75], a[92:95], v[20:23], v[72:75]
    s_cmp_ge_u32 s15, 16
    v_cvt_pk_bf16_f32 v41, v42, v43
    v_mul_f32 v140, v140, v86
    v_mfma_f32_16x16x32_bf16 v[4:7], a[96:99], v[88:91], 0
    s_cselect_b32 s53, -30464, 0
    ds_write_b64 v135, v[40:41] offset:3072
    v_mfma_f32_16x16x32_bf16 v[4:7], a[100:103], v[56:59], v[4:7]
    s_add_u32 s4, s4, s53
    v_mul_f32 v141, v141, v86
    v_cvt_pk_bf16_f32 v42, v140, v141
    v_mfma_f32_16x16x32_bf16 v[4:7], a[104:107], v[80:83], v[4:7]
    s_cmp_lt_u32 s15, s73
    v_mul_f32 v142, v142, v86
    v_mul_f32 v143, v143, v86
    v_mfma_f32_16x16x32_bf16 v[4:7], a[108:111], v[28:31], v[4:7]
    s_cselect_b32 s26, 100270464, 0
    v_cvt_pk_bf16_f32 v43, v142, v143
    v_mul_f32 v44, v44, v86
    v_mfma_f32_16x16x32_bf16 v[4:7], a[112:115], v[48:51], v[4:7]
    s_cselect_b32 s56, s56, 0
    ds_write_b64 v135, v[42:43] offset:3080
    v_mfma_f32_16x16x32_bf16 v[4:7], a[116:119], v[20:23], v[4:7]
    s_cselect_b32 s4, s4, -1
    v_mul_f32 v45, v45, v86
    v_cvt_pk_bf16_f32 v44, v44, v45
    v_mul_f32 v46, v46, v86
    v_mul_f32 v47, v47, v86
    v_cvt_pk_bf16_f32 v45, v46, v47
    s_cselect_b32 s15, s15, 0
    s_cselect_b32 s13, s13, -1
    ds_write_b64 v134, v[44:45] offset:3072
    v_fma_f32 v120, v92, v92, s41
    v_fmac_f32 v120, v93, v93
    v_fmac_f32 v120, v94, v94
    v_fmac_f32 v120, v95, v95
    v_mfma_f32_16x16x32_bf16 v[24:27], a[120:123], v[88:91], 0
    s_waitcnt vmcnt(0)
    v_fmac_f32 v120, v64, v64
    v_fmac_f32 v120, v65, v65
    v_mfma_f32_16x16x32_bf16 v[24:27], a[124:127], v[56:59], v[24:27]
    s_bitset1_b32 s64, s15
    v_fmac_f32 v120, v66, v66
    v_fmac_f32 v120, v67, v67
    v_mfma_f32_16x16x32_bf16 v[24:27], a[128:131], v[80:83], v[24:27]
    s_add_u32 s65, s65, 1
    v_fmac_f32 v120, v68, v68
    v_fmac_f32 v120, v69, v69
    v_mfma_f32_16x16x32_bf16 v[24:27], a[132:135], v[28:31], v[24:27]
    s_cmp_ge_i32 s65, 2
    v_fmac_f32 v120, v70, v70
    v_fmac_f32 v120, v71, v71
    v_mfma_f32_16x16x32_bf16 v[24:27], a[136:139], v[48:51], v[24:27]
    s_cselect_b32 s30, 100270464, 0
    v_fma_f32 v121, v72, v72, s41
    v_fmac_f32 v121, v73, v73
    v_mfma_f32_16x16x32_bf16 v[24:27], a[140:143], v[20:23], v[24:27]
    s_add_u32 s67, s46, s54
    v_fmac_f32 v121, v74, v74
    v_fmac_f32 v121, v75, v75
    v_mfma_f32_16x16x32_bf16 v[32:35], v[88:91], a[144:147], 0
    s_waitcnt lgkmcnt(0)
    s_add_u32 m0, s67, 0
    v_fmac_f32 v121, v4, v4
    v_fmac_f32 v121, v5, v5
    v_mfma_f32_16x16x32_bf16 v[32:35], v[56:59], a[148:151], v[32:35]
    s_barrier
    v_fmac_f32 v121, v6, v6
    v_fmac_f32 v121, v7, v7
    v_mfma_f32_16x16x32_bf16 v[32:35], v[80:83], a[152:155], v[32:35]
    s_cmp_ge_u32 s61, s13
    v_fmac_f32 v121, v24, v24
    v_fmac_f32 v121, v25, v25
    v_mfma_f32_16x16x32_bf16 v[32:35], v[28:31], a[156:159], v[32:35]
    s_cbranch_scc1 L_atomS0
L_atomS0r:
    v_mfma_f32_16x16x32_bf16 v[32:35], v[48:51], a[160:163], v[32:35]
    v_fmac_f32 v121, v26, v26
    v_fmac_f32 v121, v27, v27
    v_mfma_f32_16x16x32_bf16 v[32:35], v[20:23], a[164:167], v[32:35]
    v_cvt_pk_bf16_f32 v170, v120, v121
    v_add_u32 v137, s50, v137
    v_mfma_f32_16x16x32_bf16 v[40:43], v[88:91], a[168:171], 0
    ds_read_b128 v[60:63], v137 offset:0
    v_add_u32 v136, s50, v136
    v_mfma_f32_16x16x32_bf16 v[40:43], v[56:59], a[172:175], v[40:43]
    s_nop 0
    ds_read_b128 v[84:87], v136 offset:0
    v_cvt_pk_bf16_f32 v164, v32, v33
    v_mfma_f32_16x16x32_bf16 v[40:43], v[80:83], a[176:179], v[40:43]
    ds_read_b128 v[52:55], v137 offset:128
    v_cvt_pk_bf16_f32 v165, v34, v35
    v_mfma_f32_16x16x32_bf16 v[40:43], v[28:31], a[180:183], v[40:43]
    ds_read_b128 v[112:115], v136 offset:128
    v_add_u32 v135, s48, v135
    v_mfma_f32_16x16x32_bf16 v[40:43], v[48:51], a[184:187], v[40:43]
    ds_read_b128 v[108:111], v137 offset:256
    v_add_u32 v134, s48, v134
    v_mfma_f32_16x16x32_bf16 v[40:43], v[20:23], a[188:191], v[40:43]
    s_nop 0
    ds_read_b128 v[104:107], v136 offset:256
    v_add_u32 v133, s51, v133
    v_mfma_f32_16x16x16_bf16 v[118:121], v[216:217], v[170:171], 0
    s_nop 0
    v_add_u32 v132, s14, v132
    v_add_u32 v131, s14, v131
    v_add_u32 v123, s14, v123
    v_cvt_pk_bf16_f32 v160, v40, v41
    v_mfma_f32_16x16x32_bf16 v[100:103], v[88:91], a[192:195], 0
    v_cvt_pk_bf16_f32 v161, v42, v43
    v_and_b32 v116, -8, v123
    v_mfma_f32_16x16x32_bf16 v[100:103], v[56:59], a[196:199], v[100:103]
    v_rsq_f32 v118, v118
    v_mfma_f32_16x16x32_bf16 v[100:103], v[80:83], a[200:203], v[100:103]
    v_rsq_f32 v119, v119
    v_mfma_f32_16x16x32_bf16 v[100:103], v[28:31], a[204:207], v[100:103]
    ds_read_b128 v[28:31], v132 offset:0
    v_mul_f32 v118, s55, v118
    v_mfma_f32_16x16x32_bf16 v[100:103], v[48:51], a[208:211], v[100:103]
    ds_read_b128 v[48:51], v132 offset:16
    v_mul_f32 v119, 0.5, v119
    v_mfma_f32_16x16x32_bf16 v[100:103], v[20:23], a[212:215], v[100:103]
    s_waitcnt lgkmcnt(3)
    ds_read_b128 v[20:23], v132 offset:48
    v_mul_f32 v72, v72, v119
    v_mfma_f32_16x16x32_bf16 v[32:35], a[216:219], v[60:63], 0
    ds_read_b128 v[88:91], v133 offset:0
    v_mul_f32 v73, v73, v119
    v_mfma_f32_16x16x32_bf16 v[32:35], a[220:223], v[84:87], v[32:35]
    v_cvt_pk_f16_f32 v40, v72, v73
    v_mul_f32 v74, v74, v119
    v_mfma_f32_16x16x32_bf16 v[32:35], a[224:227], v[52:55], v[32:35]
    v_mul_f32 v75, v75, v119
    v_cvt_pk_f16_f32 v41, v74, v75
    v_mfma_f32_16x16x32_bf16 v[32:35], a[228:231], v[112:115], v[32:35]
    v_mul_f32 v4, v4, v119
    v_mul_f32 v5, v5, v119
    v_mfma_f32_16x16x32_bf16 v[32:35], a[232:235], v[108:111], v[32:35]
    s_waitcnt lgkmcnt(4)
    v_cvt_pk_f16_f32 v42, v4, v5
    v_mul_f32 v6, v6, v119
    v_mfma_f32_16x16x32_bf16 v[32:35], a[236:239], v[104:107], v[32:35]
    v_mul_f32 v7, v7, v119
    v_cvt_pk_f16_f32 v43, v6, v7
    v_mfma_f32_16x16x32_bf16 v[4:7], a[240:243], v[60:63], 0
    v_mul_f32 v24, v24, v119
    v_mul_f32 v25, v25, v119
    v_mfma_f32_16x16x32_bf16 v[4:7], a[244:247], v[84:87], v[4:7]
    v_cvt_pk_f16_f32 v142, v24, v25
    v_mul_f32 v26, v26, v119
    v_mfma_f32_16x16x32_bf16 v[4:7], a[248:251], v[52:55], v[4:7]
    v_mul_f32 v27, v27, v119
    v_cvt_pk_f16_f32 v143, v26, v27
    v_mfma_f32_16x16x32_bf16 v[4:7], a[252:255], v[112:115], v[4:7]
    s_waitcnt lgkmcnt(0)
    buffer_load_dwordx4 v128, s[24:27], s56 offen nt lds
    v_mul_f32 v92, v92, v118
    v_mfma_f32_16x16x32_bf16 v[4:7], v[224:227], v[108:111], v[4:7]
    v_mul_f32 v93, v93, v118
    v_cvt_pk_f16_f32 v44, v92, v93
    v_mfma_f32_16x16x32_bf16 v[4:7], v[228:231], v[104:107], v[4:7]
    v_mul_f32 v94, v94, v118
    v_mul_f32 v95, v95, v118
    v_mfma_f32_16x16x32_bf16 v[24:27], v[232:235], v[60:63], 0
    v_cvt_pk_f16_f32 v45, v94, v95
    v_mul_f32 v64, v64, v118
    v_mfma_f32_16x16x32_bf16 v[24:27], v[236:239], v[84:87], v[24:27]
    v_mul_f32 v65, v65, v118
    v_cvt_pk_f16_f32 v46, v64, v65
    v_mfma_f32_16x16x32_bf16 v[24:27], v[240:243], v[52:55], v[24:27]
    v_mul_f32 v66, v66, v118
    v_mul_f32 v67, v67, v118
    v_mfma_f32_16x16x32_bf16 v[24:27], v[244:247], v[112:115], v[24:27]
    v_cvt_pk_f16_f32 v47, v66, v67
    v_mul_f32 v68, v68, v118
    v_mfma_f32_16x16x32_bf16 v[24:27], v[248:251], v[108:111], v[24:27]
    buffer_store_dwordx4 v[88:91], v128, s[28:31], s60 offen sc1
    v_mul_f32 v69, v69, v118
    v_cvt_pk_f16_f32 v140, v68, v69
    v_mul_f32 v70, v70, v118
    v_mul_f32 v71, v71, v118
    v_mfma_f32_16x16x32_bf16 v[24:27], v[252:255], v[104:107], v[24:27]
    s_add_u32 m0, s67, 1024
    v_cvt_pk_f16_f32 v141, v70, v71
    v_cvt_pk_bf16_f32 v156, v100, v101
    v_mfma_f32_16x16x32_f16 v[112:115], v[16:19], v[76:79], v[204:207]
    ds_read_u16 v166, v131 offset:80
    v_cvt_pk_bf16_f32 v157, v102, v103
    v_mfma_f32_16x16x32_f16 v[112:115], v[152:155], v[150:153], v[112:115]
    ds_read_u16 v162, v131 offset:96
    v_mfma_f32_16x16x32_f16 v[108:111], v[36:39], v[76:79], v[200:203]
    s_nop 0
    ds_read_u16 v158, v131 offset:104
    s_nop 0
    v_mfma_f32_16x16x32_f16 v[108:111], v[146:149], v[150:153], v[108:111]
    s_nop 0
    ds_read_b32 v116, v116 offset:64
    v_max3_f32 v120, v112, v113, v114
    v_mfma_f32_16x16x32_f16 v[104:107], v[40:43], v[76:79], v[196:199]
    ds_read_b128 v[68:71], v133 offset:1024
    v_mfma_f32_16x16x32_f16 v[104:107], v[140:143], v[150:153], v[104:107]
    s_nop 0
    ds_read_b128 v[72:75], v137 offset:1536
    v_max3_f32 v120, v120, v115, v108
    v_mfma_f32_16x16x32_f16 v[88:91], v[28:31], v[76:79], v[208:211]
    ds_read_b128 v[76:79], v136 offset:1536
    v_max3_f32 v120, v120, v109, v110
    v_mfma_f32_16x16x32_f16 v[88:91], v[48:51], v[16:19], v[88:91]
    ds_read_b128 v[60:63], v137 offset:1664
    v_max3_f32 v120, v120, v111, v104
    v_mfma_f32_16x16x32_f16 v[88:91], v[20:23], v[152:155], v[88:91]
    ds_read_b128 v[56:59], v136 offset:1664
    v_max3_f32 v120, v120, v105, v106
    v_mfma_f32_16x16x32_f16 v[92:95], v[28:31], v[96:99], v[208:211]
    ds_read_b128 v[64:67], v137 offset:1792
    s_nop 0
    v_mfma_f32_16x16x32_f16 v[92:95], v[48:51], v[36:39], v[92:95]
    s_nop 0
    ds_read_b128 v[80:83], v136 offset:1792
    v_max3_f32 v120, v120, v107, v88
    v_mfma_f32_16x16x32_f16 v[92:95], v[20:23], v[146:149], v[92:95]
    v_mov_b32 v121, v120
    v_mfma_f32_16x16x32_f16 v[84:87], v[28:31], v[44:47], v[208:211]
    s_nop 0
    v_permlane32_swap_b32 v121, v120
    v_mfma_f32_16x16x32_f16 v[84:87], v[48:51], v[40:43], v[84:87]
    s_waitcnt lgkmcnt(6)
    buffer_load_dwordx4 v127, s[24:27], s56 offen nt lds
    v_max_f32 v120, v121, v120
    v_mfma_f32_16x16x32_f16 v[84:87], v[20:23], v[140:143], v[84:87]
    s_waitcnt lgkmcnt(5)
    v_mov_b32 v121, v120
    v_mov_b32_dpp v91, v95 quad_perm:[0,1,2,3] row_mask:0x2 bank_mask:0xf
    v_mfma_f32_16x16x32_bf16 v[28:31], a[216:219], v[72:75], 0
    s_waitcnt lgkmcnt(4)
    v_permlane16_swap_b32 v121, v120
    v_mfma_f32_16x16x32_bf16 v[28:31], a[220:223], v[76:79], v[28:31]
    s_waitcnt lgkmcnt(3)
    v_max_f32 v120, v121, v120
    v_sub_f32 v112, v112, v120
    v_mfma_f32_16x16x32_bf16 v[28:31], a[224:227], v[60:63], v[28:31]
    s_waitcnt lgkmcnt(2)
    v_sub_f32 v113, v113, v120
    v_sub_f32 v114, v114, v120
    v_mfma_f32_16x16x32_bf16 v[28:31], a[228:231], v[56:59], v[28:31]
    s_waitcnt lgkmcnt(1)
    v_sub_f32 v115, v115, v120
    v_sub_f32 v108, v108, v120
    v_mfma_f32_16x16x32_bf16 v[28:31], a[232:235], v[64:67], v[28:31]
    s_waitcnt lgkmcnt(0)
    v_sub_f32 v109, v109, v120
    v_sub_f32 v110, v110, v120
    v_mfma_f32_16x16x32_bf16 v[28:31], a[236:239], v[80:83], v[28:31]
    buffer_store_dwordx4 v[68:71], v127, s[28:31], s60 offen sc1
    ds_read_b128 v[100:103], v133 offset:2048
    v_sub_f32 v111, v111, v120
    v_sub_f32 v104, v104, v120
    v_sub_f32 v105, v105, v120
    v_mfma_f32_16x16x32_f16 v[48:51], v[16:19], v[96:99], v[192:195]
    s_add_u32 m0, s67, 2048
    v_sub_f32 v106, v106, v120
    v_sub_f32 v107, v107, v120
    v_mfma_f32_16x16x32_f16 v[48:51], v[152:155], v[144:147], v[48:51]
    v_sub_f32 v88, v88, v120
    v_mov_b32_dpp v91, v87 quad_perm:[0,1,2,3] row_mask:0x4 bank_mask:0xf
    v_mfma_f32_16x16x32_f16 v[68:71], v[36:39], v[96:99], v[188:191]
    v_exp_f32 v112, v112
    v_mfma_f32_16x16x32_f16 v[68:71], v[146:149], v[144:147], v[68:71]
    v_exp_f32 v113, v113
    v_mfma_f32_16x16x32_f16 v[52:55], v[40:43], v[96:99], v[184:187]
    v_exp_f32 v114, v114
    v_mfma_f32_16x16x32_f16 v[52:55], v[140:143], v[144:147], v[52:55]
    v_exp_f32 v115, v115
    v_mfma_f32_16x16x32_bf16 v[20:23], a[240:243], v[72:75], 0
    v_cvt_pk_bf16_f32 v96, v112, v113
    v_cvt_pk_bf16_f32 v97, v114, v115
    v_mfma_f32_16x16x32_bf16 v[20:23], a[244:247], v[76:79], v[20:23]
    v_exp_f32 v108, v108
    v_mfma_f32_16x16x32_bf16 v[20:23], a[248:251], v[60:63], v[20:23]
    s_waitcnt lgkmcnt(0)
    buffer_load_dwordx4 v126, s[24:27], s56 offen nt lds
    v_and_b32 v120, 0xffff0000, v116
    v_mfma_f32_16x16x32_bf16 v[20:23], a[252:255], v[56:59], v[20:23]
    v_exp_f32 v109, v109
    v_mfma_f32_16x16x32_bf16 v[20:23], v[224:227], v[64:67], v[20:23]
    v_exp_f32 v110, v110
    v_mfma_f32_16x16x32_bf16 v[20:23], v[228:231], v[80:83], v[20:23]
    s_mov_b32 s53, s47
    v_exp_f32 v111, v111
    v_cvt_pk_bf16_f32 v98, v108, v109
    v_cvt_pk_bf16_f32 v99, v110, v111
    v_exp_f32 v104, v104
    v_exp_f32 v105, v105
    v_exp_f32 v106, v106
    v_exp_f32 v107, v107
    v_cvt_pk_bf16_f32 v168, v104, v105
    v_cvt_pk_bf16_f32 v169, v106, v107
    v_exp_f32 v88, v88
    v_lshlrev_b32 v116, 16, v116
    v_cvt_pk_bf16_f32 v170, v88, 0
    v_mfma_f32_16x16x32_bf16 v[112:115], v[220:223], v[96:99], 0
    s_add_u32 m0, s67, 3072
    buffer_store_dwordx4 v[100:103], v126, s[28:31], s60 offen sc1
    v_add_f32 v116, v116, v120
    v_add_f32 v116, v116, v211
    v_max3_f32 v120, v48, v49, v50
    v_max3_f32 v120, v120, v51, v68
    v_mfma_f32_16x16x32_bf16 v[112:115], v[220:223], v[168:171], v[112:115]
    s_mov_b32 s47, s46
    v_mov_b32_dpp v91, v116 quad_perm:[0,1,2,3] row_mask:0x8 bank_mask:0xf
    v_mov_b32 v121, v91
    v_mfma_f32_16x16x32_bf16 v[108:111], v[0:3], v[96:99], 0
    s_mov_b32 s46, s45
    v_max_f32_dpp v121, v121, v121 row_ror:8 row_mask:0xf bank_mask:0xf
    v_max3_f32 v120, v120, v69, v70
    v_mfma_f32_16x16x32_bf16 v[108:111], v[164:167], v[168:171], v[108:111]
    s_mov_b32 s45, s44
    v_max_f32_dpp v121, v121, v121 row_ror:4 row_mask:0xf bank_mask:0xf
    v_max3_f32 v120, v120, v71, v52
    v_mfma_f32_16x16x32_bf16 v[104:107], v[8:11], v[96:99], 0
    s_mov_b32 s44, s53
    v_max_f32_dpp v121, v121, v121 row_ror:2 row_mask:0xf bank_mask:0xf
    v_max3_f32 v120, v120, v53, v54
    v_mfma_f32_16x16x32_bf16 v[104:107], v[160:163], v[168:171], v[104:107]
    s_sub_u32 s48, s44, s46
    v_max_f32_dpp v121, v121, v121 row_ror:1 row_mask:0xf bank_mask:0xf
    v_mov_b32 v84, v121
    v_mfma_f32_16x16x32_bf16 v[100:103], v[12:15], v[96:99], 0
    s_sub_u32 s49, s46, s45
    v_permlane32_swap_b32 v84, v121
    v_mfma_f32_16x16x32_bf16 v[100:103], v[156:159], v[168:171], v[100:103]
    v_max_f32 v121, v84, v121
    v_mov_b32 v84, v121
    v_rcp_f32 v112, v112
    v_max3_f32 v120, v120, v55, v93
    v_permlane16_swap_b32 v84, v121
    v_max_f32 v121, v84, v121
    v_sub_f32 v91, v91, v121
    v_exp_f32 v91, v91
    v_mul_f32 v108, v108, v112
    v_cvt_pk_bf16_f32 v91, v91, v91
    ds_write_b16 v123, v91 offset:64
    v_mul_f32 v109, v109, v112
    v_cvt_pk_bf16_f32 v88, v108, v109
    ds_read_b128 v[94:97], v132 offset:48
    v_mul_f32 v110, v110, v112
    v_mul_f32 v111, v111, v112
    v_cvt_pk_bf16_f32 v89, v110, v111
    ds_read_b128 v[108:111], v132 offset:64
    v_mfma_f32_16x16x32_bf16 v[114:117], v[232:235], v[72:75], 0
    v_mul_f32 v104, v104, v112
    v_mul_f32 v105, v105, v112
    v_mfma_f32_16x16x32_bf16 v[114:117], v[236:239], v[76:79], v[114:117]
    ds_write_b64 v135, v[88:89] offset:0
    v_mfma_f32_16x16x32_bf16 v[114:117], v[240:243], v[60:63], v[114:117]
    v_cvt_pk_bf16_f32 v90, v104, v105
    v_mul_f32 v106, v106, v112
    v_mfma_f32_16x16x32_bf16 v[114:117], v[244:247], v[56:59], v[114:117]
    v_mul_f32 v107, v107, v112
    v_cvt_pk_bf16_f32 v91, v106, v107
    v_mfma_f32_16x16x32_bf16 v[114:117], v[248:251], v[64:67], v[114:117]
    ds_write_b64 v135, v[90:91] offset:8
    v_mfma_f32_16x16x32_bf16 v[114:117], v[252:255], v[80:83], v[114:117]
    s_waitcnt lgkmcnt(3)
    v_mul_f32 v100, v100, v112
    v_mul_f32 v101, v101, v112
    v_cvt_pk_bf16_f32 v168, v100, v101
    v_mul_f32 v102, v102, v112
    v_mfma_f32_16x16x32_bf16 v[72:75], v[94:97], v[0:3], 0
    s_waitcnt lgkmcnt(2)
    v_mul_f32 v103, v103, v112
    v_cvt_pk_bf16_f32 v169, v102, v103
    v_mov_b32 v170, v120
    v_fma_f32 v92, v32, v32, s42
    v_mfma_f32_16x16x32_bf16 v[72:75], v[108:111], v[164:167], v[72:75]
    ds_write_b64 v134, v[168:169] offset:0
    v_mfma_f32_16x16x32_bf16 v[88:91], v[94:97], v[8:11], 0
    v_permlane32_swap_b32 v170, v120
    v_mfma_f32_16x16x32_bf16 v[88:91], v[108:111], v[160:163], v[88:91]
    v_max_f32 v120, v170, v120
    v_mov_b32 v170, v120
    v_mfma_f32_16x16x32_bf16 v[76:79], v[94:97], v[12:15], 0
    s_nop 0
    v_permlane16_swap_b32 v170, v120
    v_mfma_f32_16x16x32_bf16 v[76:79], v[108:111], v[156:159], v[76:79]
    ds_read_b128 v[60:63], v133 offset:3072
    v_max_f32 v120, v170, v120
    v_sub_f32 v48, v48, v120
    v_sub_f32 v49, v49, v120
    v_sub_f32 v50, v50, v120
    v_sub_f32 v51, v51, v120
    v_sub_f32 v68, v68, v120
    v_sub_f32 v69, v69, v120
    v_sub_f32 v70, v70, v120
    v_sub_f32 v71, v71, v120
    v_sub_f32 v52, v52, v120
    v_sub_f32 v53, v53, v120
    v_sub_f32 v54, v54, v120
    v_sub_f32 v55, v55, v120
    v_sub_f32 v93, v93, v120
    v_exp_f32 v48, v48
    v_exp_f32 v49, v49
    v_exp_f32 v50, v50
    v_exp_f32 v51, v51
    v_cvt_pk_bf16_f32 v56, v48, v49
    v_cvt_pk_bf16_f32 v57, v50, v51
    v_exp_f32 v68, v68
    v_exp_f32 v69, v69
    v_exp_f32 v70, v70
    v_exp_f32 v71, v71
    v_cvt_pk_bf16_f32 v58, v68, v69
    v_cvt_pk_bf16_f32 v59, v70, v71
    v_exp_f32 v52, v52
    v_exp_f32 v53, v53
    v_exp_f32 v54, v54
    v_exp_f32 v55, v55
    v_cvt_pk_bf16_f32 v168, v52, v53
    v_cvt_pk_bf16_f32 v169, v54, v55
    v_exp_f32 v93, v93
    v_mov_b32_dpp v75, v91 quad_perm:[0,1,2,3] row_mask:0x2 bank_mask:0xf
    v_cvt_pk_bf16_f32 v170, v93, 0
    v_mfma_f32_16x16x32_bf16 v[88:91], v[220:223], v[56:59], 0
    s_waitcnt lgkmcnt(0)
    buffer_load_dwordx4 v125, s[24:27], s56 offen nt lds
    ds_read_b128 v[64:67], v137 offset:3072
    v_mfma_f32_16x16x32_bf16 v[88:91], v[220:223], v[168:171], v[88:91]
    v_mov_b32_dpp v75, v79 quad_perm:[0,1,2,3] row_mask:0x4 bank_mask:0xf
    v_cvt_pk_bf16_f32 v75, v75, v75
    v_mfma_f32_16x16x32_bf16 v[76:79], v[0:3], v[56:59], 0
    ds_write_b16 v131, v75
    v_mfma_f32_16x16x32_bf16 v[76:79], v[164:167], v[168:171], v[76:79]
    ds_read_b128 v[72:75], v136 offset:3072
    v_fmac_f32 v92, v33, v33
    v_mfma_f32_16x16x32_bf16 v[80:83], v[8:11], v[56:59], 0
    ds_read_b128 v[48:51], v137 offset:3200
    v_fmac_f32 v92, v34, v34
    v_mfma_f32_16x16x32_bf16 v[80:83], v[160:163], v[168:171], v[80:83]
    ds_read_b128 v[68:71], v136 offset:3200
    v_fmac_f32 v92, v35, v35
    v_mfma_f32_16x16x32_bf16 v[52:55], v[12:15], v[56:59], 0
    ds_read_b128 v[56:59], v137 offset:3328
    v_add_u32 v137, s48, v137
    v_mfma_f32_16x16x32_bf16 v[52:55], v[156:159], v[168:171], v[52:55]
    buffer_store_dwordx4 v[60:63], v125, s[28:31], s60 offen sc1
    ds_read_b128 v[94:97], v136 offset:3328
    v_rcp_f32 v88, v88
    v_add_u32 v136, s48, v136
    v_mfma_f32_16x16x32_f16 v[60:63], v[16:19], v[44:47], v[180:183]
    s_add_u32 m0, s67, 4096
    ds_read_b128 v[16:19], v133 offset:4096
    v_mul_f32 v76, v76, v88
    v_mfma_f32_16x16x32_f16 v[60:63], v[152:155], v[138:141], v[60:63]
    s_cmp_lg_u32 s5, -1
    v_mul_f32 v77, v77, v88
    v_cvt_pk_bf16_f32 v76, v76, v77
    v_mfma_f32_16x16x32_f16 v[152:155], v[36:39], v[44:47], v[176:179]
    v_mul_f32 v78, v78, v88
    v_mul_f32 v79, v79, v88
    v_mfma_f32_16x16x32_f16 v[152:155], v[146:149], v[138:141], v[152:155]
    v_cvt_pk_bf16_f32 v77, v78, v79
    v_mul_f32 v80, v80, v88
    v_mfma_f32_16x16x32_f16 v[36:39], v[40:43], v[44:47], v[172:175]
    ds_write_b64 v135, v[76:77] offset:1536
    v_mfma_f32_16x16x32_f16 v[36:39], v[140:143], v[138:141], v[36:39]
    s_waitcnt lgkmcnt(4)
    v_mul_f32 v81, v81, v88
    v_cvt_pk_bf16_f32 v78, v80, v81
    v_mfma_f32_16x16x32_bf16 v[40:43], a[216:219], v[64:67], 0
    v_mul_f32 v82, v82, v88
    v_mul_f32 v83, v83, v88
    v_mfma_f32_16x16x32_bf16 v[40:43], a[220:223], v[72:75], v[40:43]
    v_cvt_pk_bf16_f32 v79, v82, v83
    v_mul_f32 v52, v52, v88
    v_mfma_f32_16x16x32_bf16 v[40:43], a[224:227], v[48:51], v[40:43]
    ds_write_b64 v135, v[78:79] offset:1544
    v_mfma_f32_16x16x32_bf16 v[40:43], a[228:231], v[68:71], v[40:43]
    s_waitcnt lgkmcnt(2)
    buffer_load_dwordx4 v124, s[24:27], s56 offen nt lds
    v_mul_f32 v53, v53, v88
    v_mfma_f32_16x16x32_bf16 v[40:43], a[232:235], v[56:59], v[40:43]
    v_cvt_pk_bf16_f32 v168, v52, v53
    v_mul_f32 v54, v54, v88
    v_mfma_f32_16x16x32_bf16 v[40:43], a[236:239], v[94:97], v[40:43]
    v_mul_f32 v55, v55, v88
    v_cvt_pk_bf16_f32 v169, v54, v55
    v_mfma_f32_16x16x32_bf16 v[140:143], a[240:243], v[64:67], 0
    ds_write_b64 v134, v[168:169] offset:1536
    v_mfma_f32_16x16x32_bf16 v[140:143], a[244:247], v[72:75], v[140:143]
    v_max3_f32 v168, v60, v61, v62
    v_max3_f32 v168, v168, v63, v152
    v_mfma_f32_16x16x32_bf16 v[140:143], a[248:251], v[48:51], v[140:143]
    v_max3_f32 v168, v168, v153, v154
    v_max3_f32 v168, v168, v155, v36
    v_mfma_f32_16x16x32_bf16 v[140:143], a[252:255], v[68:71], v[140:143]
    v_max3_f32 v168, v168, v37, v38
    v_max3_f32 v168, v168, v39, v86
    v_mfma_f32_16x16x32_bf16 v[140:143], v[224:227], v[56:59], v[140:143]
    buffer_store_dwordx4 v[16:19], v124, s[28:31], s60 offen sc1
    v_mov_b32 v169, v168
    v_fmac_f32 v92, v4, v4
    v_fmac_f32 v92, v5, v5
    v_fmac_f32 v92, v6, v6
    v_mfma_f32_16x16x32_bf16 v[140:143], v[228:231], v[94:97], v[140:143]
    ds_read_b128 v[16:19], v137 offset:0
    v_fmac_f32 v92, v7, v7
    v_mfma_f32_16x16x32_bf16 v[44:47], v[232:235], v[64:67], 0
    ds_read_b128 v[146:149], v136 offset:0
    v_fmac_f32 v92, v24, v24
    v_mfma_f32_16x16x32_bf16 v[44:47], v[236:239], v[72:75], v[44:47]
    ds_read_b128 v[72:75], v137 offset:128
    v_fmac_f32 v92, v25, v25
    v_mfma_f32_16x16x32_bf16 v[44:47], v[240:243], v[48:51], v[44:47]
    ds_read_b128 v[88:91], v136 offset:128
    v_fmac_f32 v92, v26, v26
    v_mfma_f32_16x16x32_bf16 v[44:47], v[244:247], v[68:71], v[44:47]
    ds_read_b128 v[76:79], v137 offset:256
    v_fmac_f32 v92, v27, v27
    v_mfma_f32_16x16x32_bf16 v[44:47], v[248:251], v[56:59], v[44:47]
    ds_read_b128 v[56:59], v136 offset:256
    v_fma_f32 v93, v28, v28, s42
    v_mfma_f32_16x16x32_bf16 v[44:47], v[252:255], v[94:97], v[44:47]
    v_permlane32_swap_b32 v169, v168
    v_max_f32 v168, v169, v168
    v_mov_b32 v169, v168
    v_fmac_f32 v93, v29, v29
    v_fmac_f32 v93, v30, v30
    v_permlane16_swap_b32 v169, v168
    v_max_f32 v168, v169, v168
    v_sub_f32 v60, v60, v168
    v_sub_f32 v61, v61, v168
    v_sub_f32 v62, v62, v168
    v_sub_f32 v63, v63, v168
    v_sub_f32 v152, v152, v168
    v_sub_f32 v153, v153, v168
    v_sub_f32 v154, v154, v168
    v_sub_f32 v155, v155, v168
    v_sub_f32 v36, v36, v168
    v_sub_f32 v37, v37, v168
    v_sub_f32 v38, v38, v168
    v_sub_f32 v39, v39, v168
    v_sub_f32 v86, v86, v168
    v_exp_f32 v60, v60
    v_exp_f32 v61, v61
    v_exp_f32 v62, v62
    v_exp_f32 v63, v63
    v_cvt_pk_bf16_f32 v60, v60, v61
    v_cvt_pk_bf16_f32 v61, v62, v63
    v_exp_f32 v152, v152
    v_exp_f32 v153, v153
    v_exp_f32 v154, v154
    v_exp_f32 v155, v155
    v_cvt_pk_bf16_f32 v62, v152, v153
    v_cvt_pk_bf16_f32 v63, v154, v155
    v_exp_f32 v36, v36
    v_exp_f32 v37, v37
    v_exp_f32 v38, v38
    v_exp_f32 v39, v39
    v_cvt_pk_bf16_f32 v168, v36, v37
    v_cvt_pk_bf16_f32 v169, v38, v39
    v_exp_f32 v86, v86
    v_fmac_f32 v93, v31, v31
    v_cvt_pk_bf16_f32 v170, v86, 0
    v_mfma_f32_16x16x32_bf16 v[152:155], v[220:223], v[60:63], 0
    v_fmac_f32 v93, v20, v20
    v_fmac_f32 v93, v21, v21
    v_mfma_f32_16x16x32_bf16 v[152:155], v[220:223], v[168:171], v[152:155]
    v_fmac_f32 v93, v22, v22
    v_fmac_f32 v93, v23, v23
    v_mfma_f32_16x16x32_bf16 v[36:39], v[0:3], v[60:63], 0
    s_nop 0
    v_fmac_f32 v93, v114, v114
    v_fmac_f32 v93, v115, v115
    v_mfma_f32_16x16x32_bf16 v[36:39], v[164:167], v[168:171], v[36:39]
    s_nop 0
    v_rcp_f32 v152, v152
    v_mfma_f32_16x16x32_bf16 v[0:3], v[8:11], v[60:63], 0
    s_nop 0
    v_fmac_f32 v93, v116, v116
    v_fmac_f32 v93, v117, v117
    v_mfma_f32_16x16x32_bf16 v[0:3], v[160:163], v[168:171], v[0:3]
    s_nop 0
    v_mul_f32 v36, v36, v152
    v_mul_f32 v37, v37, v152
    v_mfma_f32_16x16x32_bf16 v[8:11], v[12:15], v[60:63], 0
    v_cvt_pk_bf16_f32 v12, v36, v37
    v_mul_f32 v38, v38, v152
    v_mfma_f32_16x16x32_bf16 v[8:11], v[156:159], v[168:171], v[8:11]
    s_waitcnt lgkmcnt(0)
    v_mul_f32 v39, v39, v152
    v_cvt_pk_bf16_f32 v13, v38, v39
    v_mfma_f32_16x16x32_bf16 v[36:39], a[0:3], v[16:19], 0
    s_cbranch_scc1 L_loopS0
    ds_write_b64 v135, v[12:13] offset:3072
    v_mul_f32 v0, v0, v152
    v_mul_f32 v1, v1, v152
    v_cvt_pk_bf16_f32 v14, v0, v1
    v_mul_f32 v2, v2, v152
    v_mul_f32 v3, v3, v152
    v_cvt_pk_bf16_f32 v15, v2, v3
    v_mul_f32 v8, v8, v152
    v_mul_f32 v9, v9, v152
    v_cvt_pk_bf16_f32 v8, v8, v9
    v_mul_f32 v10, v10, v152
    v_mul_f32 v11, v11, v152
    v_cvt_pk_bf16_f32 v9, v10, v11
    s_mov_b32 s30, 100270464
    s_mul_i32 s89, s68, 7168
    ds_write_b64 v135, v[14:15] offset:3080
    v_fma_f32 v113, v40, v40, s42
    s_add_u32 s89, s89, 135168
    s_movk_i32 s90, 112
    ds_write_b64 v134, v[8:9] offset:3072
    v_fmac_f32 v113, v41, v41
    v_fmac_f32 v113, v42, v42
    v_fmac_f32 v113, v43, v43
    v_fmac_f32 v113, v140, v140
    v_fmac_f32 v113, v141, v141
    v_fmac_f32 v113, v142, v142
    v_fmac_f32 v113, v143, v143
    v_fmac_f32 v113, v44, v44
    v_fmac_f32 v113, v45, v45
    v_fmac_f32 v113, v46, v46
    v_fmac_f32 v113, v47, v47
    v_cvt_pk_bf16_f32 v112, v92, v93
    v_cvt_pk_bf16_f32 v113, v113, v122
    s_lshr_b32 s91, s64, 16
    s_lshl_b32 s92, s68, 10
    ds_write_b64 v130, v[112:113]
    v_mbcnt_lo_u32_b32 v131, -1, 0
    v_mbcnt_hi_u32_b32 v131, -1, v131
    v_and_b32 v132, 15, v131
    v_lshrrev_b32 v131, 4, v131
    v_mul_u32_u24 v118, 1792, v131
    v_add_u32 v118, s89, v118
    v_mad_u32_u24 v131, v132, s90, v118
    v_lshrrev_b32 v119, v132, s64
    v_and_b32 v119, 1, v119
    v_cmp_eq_u32 vcc, 1, v119
    v_mad_u32_u24 v119, v132, s90, v118
    v_lshrrev_b32 v132, v132, s91
    v_cndmask_b32 v131, v118, v131, vcc
    v_and_b32 v132, 1, v132
    v_subrev_u32 v119, 28672, v119
    v_cmp_eq_u32 vcc, 1, v132
    s_sub_u32 s84, s45, s44
    s_sub_u32 s85, s46, s45
    ds_read_b128 v[48:51], v131 offset:64
    ds_read_b128 v[36:39], v131 offset:80
    v_cndmask_b32 v119, v118, v119, vcc
    v_add_u32 v118, s92, v129
    s_waitcnt lgkmcnt(2)
    s_barrier
    s_sub_u32 s86, s44, s45
    ds_read_b128 v[86:89], v131
    v_add_u32 v139, s84, v137
    s_sub_u32 s93, s44, s47
    s_sub_u32 s94, s45, s47
    ds_read_b64 v[90:91], v131 offset:16
    ds_read_b128 v[8:11], v118 offset:6144
    v_add_u32 v138, s84, v136
    v_add_u32 v118, s85, v135
    s_sub_u32 s95, s46, s47
    ds_read_b128 v[16:19], v129 offset:0
    v_add_u32 v63, s85, v134
    ds_read_b128 v[0:3], v129 offset:1024
    v_add_u32 v112, s86, v135
    v_add_u32 v132, s86, v134
    v_add_u32 v131, s93, v133
    v_add_u32 v113, s94, v133
    s_waitcnt lgkmcnt(6)
    v_mfma_f32_16x16x32_bf16 v[12:15], v[220:223], v[48:51], 0
    s_waitcnt lgkmcnt(5)
    ds_read_b128 v[80:83], v139 offset:1536
    ds_read_b128 v[76:79], v138 offset:1536
    v_mfma_f32_16x16x32_bf16 v[12:15], v[220:223], v[36:39], v[12:15]
    s_waitcnt lgkmcnt(3)
    ds_read_b128 v[72:75], v139 offset:1664
    v_lshlrev_b32 v92, 16, v86
    v_and_b32 v86, 0xffff0000, v86
    v_lshlrev_b32 v93, 16, v87
    v_and_b32 v87, 0xffff0000, v87
    v_lshlrev_b32 v94, 16, v88
    v_and_b32 v88, 0xffff0000, v88
    v_rcp_f32 v12, v12
    v_lshlrev_b32 v95, 16, v89
    v_mfma_f32_16x16x32_bf16 v[64:67], v[216:219], v[16:19], 0
    s_waitcnt lgkmcnt(3)
    ds_read_b128 v[68:71], v138 offset:1664
    ds_read_b128 v[48:51], v139 offset:1792
    v_mfma_f32_16x16x32_bf16 v[64:67], v[216:219], v[0:3], v[64:67]
    s_waitcnt lgkmcnt(4)
    ds_read_b128 v[16:19], v138 offset:1792
    v_mul_f32 v92, v92, v12
    v_mul_f32 v86, v86, v12
    v_cvt_pk_bf16_f32 v92, v92, v86
    v_mul_f32 v93, v93, v12
    v_mfma_f32_16x16x32_bf16 v[0:3], a[216:219], v[80:83], 0
    s_waitcnt lgkmcnt(4)
    v_mul_f32 v87, v87, v12
    v_cvt_pk_bf16_f32 v93, v93, v87
    v_mfma_f32_16x16x32_bf16 v[0:3], a[220:223], v[76:79], v[0:3]
    s_waitcnt lgkmcnt(3)
    ds_read_b128 v[108:111], v139 offset:0
    ds_read_b128 v[104:107], v138 offset:0
    v_mfma_f32_16x16x32_bf16 v[0:3], a[224:227], v[72:75], v[0:3]
    s_waitcnt lgkmcnt(4)
    ds_read_b128 v[96:99], v139 offset:128
    v_mul_f32 v94, v94, v12
    v_mul_f32 v88, v88, v12
    v_cvt_pk_bf16_f32 v94, v94, v88
    v_and_b32 v89, 0xffff0000, v89
    v_mul_f32 v95, v95, v12
    v_mfma_f32_16x16x32_bf16 v[0:3], a[228:231], v[68:71], v[0:3]
    s_waitcnt lgkmcnt(4)
    ds_read_b128 v[84:87], v138 offset:128
    ds_read_b128 v[56:59], v139 offset:256
    v_mfma_f32_16x16x32_bf16 v[0:3], a[232:235], v[48:51], v[0:3]
    s_waitcnt lgkmcnt(5)
    ds_read_b128 v[36:39], v138 offset:256
    v_mul_f32 v89, v89, v12
    v_mfma_f32_16x16x32_bf16 v[0:3], a[236:239], v[16:19], v[0:3]
    v_cvt_pk_bf16_f32 v95, v95, v89
    v_lshlrev_b32 v67, 16, v90
    v_mfma_f32_16x16x32_bf16 v[52:55], a[240:243], v[80:83], 0
    ds_write_b128 v112, v[92:95] offset:0
    v_mfma_f32_16x16x32_bf16 v[52:55], a[244:247], v[76:79], v[52:55]
    v_and_b32 v90, 0xffff0000, v90
    v_mul_f32 v67, v67, v12
    v_mfma_f32_16x16x32_bf16 v[52:55], a[248:251], v[72:75], v[52:55]
    v_mul_f32 v90, v90, v12
    v_cvt_pk_bf16_f32 v60, v67, v90
    v_mfma_f32_16x16x32_bf16 v[52:55], a[252:255], v[68:71], v[52:55]
    v_lshlrev_b32 v67, 16, v91
    v_and_b32 v91, 0xffff0000, v91
    v_mfma_f32_16x16x32_bf16 v[52:55], v[224:227], v[48:51], v[52:55]
    v_mul_f32 v67, v67, v12
    v_mul_f32 v91, v91, v12
    v_mfma_f32_16x16x32_bf16 v[52:55], v[228:231], v[16:19], v[52:55]
    v_cvt_pk_bf16_f32 v61, v67, v91
    v_lshrrev_b32 v67, 0, v11
    v_mfma_f32_16x16x32_bf16 v[12:15], v[232:235], v[80:83], 0
    ds_write_b64 v132, v[60:61] offset:0
    v_mfma_f32_16x16x32_bf16 v[12:15], v[236:239], v[76:79], v[12:15]
    v_lshrrev_b32 v67, v67, s64
    v_and_b32 v67, 1, v67
    v_mfma_f32_16x16x32_bf16 v[12:15], v[240:243], v[72:75], v[12:15]
    v_cmp_eq_u32 vcc, 1, v67
    v_lshrrev_b32 v67, 8, v11
    v_mfma_f32_16x16x32_bf16 v[12:15], v[244:247], v[68:71], v[12:15]
    v_cndmask_b32 v8, 2.0, v8, vcc
    v_lshrrev_b32 v67, v67, s64
    v_mfma_f32_16x16x32_bf16 v[12:15], v[248:251], v[48:51], v[12:15]
    v_and_b32 v67, 1, v67
    v_cmp_eq_u32 vcc, 1, v67
    v_mfma_f32_16x16x32_bf16 v[12:15], v[252:255], v[16:19], v[12:15]
    s_waitcnt lgkmcnt(1)
    v_cndmask_b32 v9, 2.0, v9, vcc
    v_lshrrev_b32 v11, 16, v11
    v_mfma_f32_16x16x32_bf16 v[72:75], a[216:219], v[108:111], 0
    v_lshrrev_b32 v11, v11, s64
    v_and_b32 v11, 1, v11
    v_mfma_f32_16x16x32_bf16 v[72:75], a[220:223], v[104:107], v[72:75]
    ds_read_b128 v[100:103], v139 offset:3072
    ds_read_b128 v[92:95], v138 offset:3072
    v_mfma_f32_16x16x32_bf16 v[72:75], a[224:227], v[96:99], v[72:75]
    ds_read_b128 v[88:91], v139 offset:3200
    v_cmp_eq_u32 vcc, 1, v11
    v_mfma_f32_16x16x32_bf16 v[72:75], a[228:231], v[84:87], v[72:75]
    ds_read_b128 v[80:83], v138 offset:3200
    v_cndmask_b32 v10, 2.0, v10, vcc
    v_mfma_f32_16x16x32_bf16 v[72:75], a[232:235], v[56:59], v[72:75]
    ds_read_b128 v[76:79], v139 offset:3328
    v_add_u32 v11, s95, v133
    v_mfma_f32_16x16x32_bf16 v[72:75], a[236:239], v[36:39], v[72:75]
    ds_read_b128 v[16:19], v138 offset:3328
    v_fma_f32 v133, v0, v0, s42
    v_mfma_f32_16x16x32_bf16 v[48:51], a[240:243], v[108:111], 0
    v_rsq_f32 v64, v64
    v_mfma_f32_16x16x32_bf16 v[48:51], a[244:247], v[104:107], v[48:51]
    v_mul_f32 v64, s43, v64
    v_mul_f32 v32, v32, v64
    v_mfma_f32_16x16x32_bf16 v[48:51], a[248:251], v[96:99], v[48:51]
    v_mul_f32 v33, v33, v64
    v_cvt_pk_bf16_f32 v32, v32, v33
    v_mfma_f32_16x16x32_bf16 v[48:51], a[252:255], v[84:87], v[48:51]
    v_mul_f32 v34, v34, v64
    v_mul_f32 v35, v35, v64
    v_mfma_f32_16x16x32_bf16 v[48:51], v[224:227], v[56:59], v[48:51]
    v_cvt_pk_bf16_f32 v33, v34, v35
    v_mul_f32 v4, v4, v64
    v_mfma_f32_16x16x32_bf16 v[48:51], v[228:231], v[36:39], v[48:51]
    v_mul_f32 v5, v5, v64
    v_cvt_pk_bf16_f32 v34, v4, v5
    v_mfma_f32_16x16x32_bf16 v[68:71], v[232:235], v[108:111], 0
    v_mul_f32 v6, v6, v64
    v_mul_f32 v7, v7, v64
    v_mfma_f32_16x16x32_bf16 v[68:71], v[236:239], v[104:107], v[68:71]
    v_cvt_pk_bf16_f32 v35, v6, v7
    v_mul_f32 v24, v24, v64
    v_mfma_f32_16x16x32_bf16 v[68:71], v[240:243], v[96:99], v[68:71]
    ds_write_b128 v118, v[32:35] offset:0
    v_mfma_f32_16x16x32_bf16 v[68:71], v[244:247], v[84:87], v[68:71]
    v_mul_f32 v25, v25, v64
    v_cvt_pk_bf16_f32 v24, v24, v25
    v_mfma_f32_16x16x32_bf16 v[68:71], v[248:251], v[56:59], v[68:71]
    v_mul_f32 v26, v26, v64
    v_mul_f32 v27, v27, v64
    v_mfma_f32_16x16x32_bf16 v[68:71], v[252:255], v[36:39], v[68:71]
    s_waitcnt lgkmcnt(1)
    v_cvt_pk_bf16_f32 v25, v26, v27
    v_fma_f32 v62, v72, v72, s42
    v_mfma_f32_16x16x32_bf16 v[84:87], a[216:219], v[100:103], 0
    ds_write_b64 v63, v[24:25] offset:0
    v_mfma_f32_16x16x32_bf16 v[84:87], a[220:223], v[92:95], v[84:87]
    ds_read_b128 v[24:27], v119 offset:64
    v_fmac_f32 v62, v73, v73
    v_mfma_f32_16x16x32_bf16 v[84:87], a[224:227], v[88:91], v[84:87]
    ds_read_b128 v[4:7], v119 offset:80
    v_fmac_f32 v62, v74, v74
    v_mfma_f32_16x16x32_bf16 v[84:87], a[228:231], v[80:83], v[84:87]
    ds_read_b128 v[56:59], v119
    v_fmac_f32 v62, v75, v75
    v_mfma_f32_16x16x32_bf16 v[84:87], a[232:235], v[76:79], v[84:87]
    ds_read_b64 v[60:61], v119 offset:16
    v_fmac_f32 v62, v48, v48
    v_mfma_f32_16x16x32_bf16 v[84:87], a[236:239], v[16:19], v[84:87]
    v_rsq_f32 v65, v65
    v_mfma_f32_16x16x32_bf16 v[96:99], a[240:243], v[100:103], 0
    v_mul_f32 v65, s43, v65
    v_mul_f32 v28, v28, v65
    v_mfma_f32_16x16x32_bf16 v[96:99], a[244:247], v[92:95], v[96:99]
    v_mul_f32 v29, v29, v65
    v_cvt_pk_bf16_f32 v28, v28, v29
    v_mfma_f32_16x16x32_bf16 v[96:99], a[248:251], v[88:91], v[96:99]
    v_mul_f32 v30, v30, v65
    v_mul_f32 v31, v31, v65
    v_mfma_f32_16x16x32_bf16 v[96:99], a[252:255], v[80:83], v[96:99]
    v_cvt_pk_bf16_f32 v29, v30, v31
    v_mul_f32 v20, v20, v65
    v_mfma_f32_16x16x32_bf16 v[96:99], v[224:227], v[76:79], v[96:99]
    v_mul_f32 v21, v21, v65
    v_cvt_pk_bf16_f32 v30, v20, v21
    v_mfma_f32_16x16x32_bf16 v[96:99], v[228:231], v[16:19], v[96:99]
    v_mul_f32 v22, v22, v65
    v_mul_f32 v23, v23, v65
    v_mfma_f32_16x16x32_bf16 v[36:39], v[232:235], v[100:103], 0
    v_cvt_pk_bf16_f32 v31, v22, v23
    v_mul_f32 v114, v114, v65
    v_mfma_f32_16x16x32_bf16 v[36:39], v[236:239], v[92:95], v[36:39]
    ds_write_b128 v118, v[28:31] offset:1536
    v_mfma_f32_16x16x32_bf16 v[36:39], v[240:243], v[88:91], v[36:39]
    v_mul_f32 v115, v115, v65
    v_cvt_pk_bf16_f32 v114, v114, v115
    v_mfma_f32_16x16x32_bf16 v[36:39], v[244:247], v[80:83], v[36:39]
    v_mul_f32 v116, v116, v65
    v_mul_f32 v117, v117, v65
    v_mfma_f32_16x16x32_bf16 v[36:39], v[248:251], v[76:79], v[36:39]
    v_cvt_pk_bf16_f32 v115, v116, v117
    v_fmac_f32 v62, v49, v49
    v_mfma_f32_16x16x32_bf16 v[36:39], v[252:255], v[16:19], v[36:39]
    s_waitcnt lgkmcnt(1)
    ds_write_b64 v63, v[114:115] offset:1536
    v_mfma_f32_16x16x32_bf16 v[16:19], v[220:223], v[24:27], 0
    v_rsq_f32 v66, v66
    v_mfma_f32_16x16x32_bf16 v[16:19], v[220:223], v[4:7], v[16:19]
    v_mul_f32 v66, s43, v66
    v_mul_f32 v40, v40, v66
    v_mul_f32 v41, v41, v66
    v_cvt_pk_bf16_f32 v4, v40, v41
    v_mul_f32 v42, v42, v66
    v_mul_f32 v43, v43, v66
    v_cvt_pk_bf16_f32 v5, v42, v43
    v_mul_f32 v140, v140, v66
    v_mul_f32 v141, v141, v66
    v_cvt_pk_bf16_f32 v6, v140, v141
    v_mul_f32 v142, v142, v66
    v_mul_f32 v143, v143, v66
    v_cvt_pk_bf16_f32 v7, v142, v143
    v_mul_f32 v44, v44, v66
    v_mul_f32 v45, v45, v66
    v_cvt_pk_bf16_f32 v44, v44, v45
    v_mul_f32 v46, v46, v66
    v_mul_f32 v47, v47, v66
    v_cvt_pk_bf16_f32 v45, v46, v47
    ds_write_b128 v118, v[4:7] offset:3072
    v_fmac_f32 v62, v50, v50
    v_fmac_f32 v62, v51, v51
    v_fmac_f32 v62, v68, v68
    v_fmac_f32 v62, v69, v69
    ds_write_b64 v63, v[44:45] offset:3072
    v_fmac_f32 v62, v70, v70
    v_fmac_f32 v62, v71, v71
    v_fmac_f32 v133, v1, v1
    v_fmac_f32 v133, v2, v2
    v_fmac_f32 v133, v3, v3
    v_fmac_f32 v133, v52, v52
    v_fmac_f32 v133, v53, v53
    v_fmac_f32 v133, v54, v54
    v_fmac_f32 v133, v55, v55
    v_fmac_f32 v133, v12, v12
    v_fmac_f32 v133, v13, v13
    v_fmac_f32 v133, v14, v14
    v_fmac_f32 v133, v15, v15
    v_cvt_pk_bf16_f32 v62, v62, v133
    v_fma_f32 v63, v84, v84, s42
    v_fmac_f32 v63, v85, v85
    v_fmac_f32 v63, v86, v86
    v_fmac_f32 v63, v87, v87
    v_fmac_f32 v63, v96, v96
    v_fmac_f32 v63, v97, v97
    v_fmac_f32 v63, v98, v98
    v_fmac_f32 v63, v99, v99
    v_fmac_f32 v63, v36, v36
    v_fmac_f32 v63, v37, v37
    v_fmac_f32 v63, v38, v38
    v_fmac_f32 v63, v39, v39
    v_cvt_pk_bf16_f32 v63, v63, v63
    ds_write_b64 v130, v[62:63] offset:2048
    v_rcp_f32 v16, v16
    v_lshlrev_b32 v133, 16, v56
    v_and_b32 v56, 0xffff0000, v56
    v_mul_f32 v133, v133, v16
    v_mul_f32 v56, v56, v16
    v_cvt_pk_bf16_f32 v4, v133, v56
    v_lshlrev_b32 v56, 16, v57
    v_and_b32 v57, 0xffff0000, v57
    v_mul_f32 v56, v56, v16
    v_mul_f32 v57, v57, v16
    v_cvt_pk_bf16_f32 v5, v56, v57
    v_lshlrev_b32 v133, 16, v58
    v_and_b32 v58, 0xffff0000, v58
    v_mul_f32 v133, v133, v16
    v_mul_f32 v58, v58, v16
    v_cvt_pk_bf16_f32 v6, v133, v58
    v_lshlrev_b32 v7, 16, v59
    v_and_b32 v59, 0xffff0000, v59
    v_mul_f32 v7, v7, v16
    v_mul_f32 v59, v59, v16
    v_cvt_pk_bf16_f32 v7, v7, v59
    v_lshlrev_b32 v133, 16, v60
    v_and_b32 v60, 0xffff0000, v60
    v_mul_f32 v133, v133, v16
    v_mul_f32 v60, v60, v16
    v_cvt_pk_bf16_f32 v138, v133, v60
    v_lshlrev_b32 v133, 16, v61
    v_and_b32 v61, 0xffff0000, v61
    v_mul_f32 v133, v133, v16
    v_mul_f32 v61, v61, v16
    v_cvt_pk_bf16_f32 v139, v133, v61
    s_waitcnt lgkmcnt(0)
    s_barrier
    ds_write_b128 v112, v[4:7] offset:1536
    v_mov_b32 v115, 0
    ds_write_b64 v132, v[138:139] offset:1536
    ds_read_b128 v[32:35], v11 offset:0
    ds_read_b128 v[4:7], v11 offset:1024
    ds_read_b128 v[24:27], v11 offset:2048
    ds_read_b128 v[20:23], v11 offset:3072
    ds_read_b128 v[80:83], v11 offset:4096
    s_waitcnt lgkmcnt(5)
    s_barrier
    s_waitcnt lgkmcnt(4)
    buffer_store_dwordx4 v[32:35], v128, s[28:31], s59 offen sc1
    ds_read_b128 v[28:31], v129 offset:2048
    ds_read_b128 v[16:19], v129 offset:3072
    ds_read_b128 v[104:107], v137 offset:1536
    ds_read_b128 v[100:103], v136 offset:1536
    ds_read_b128 v[92:95], v137 offset:1664
    ds_read_b128 v[88:91], v136 offset:1664
    ds_read_b128 v[76:79], v137 offset:1792
    s_waitcnt lgkmcnt(9)
    buffer_store_dwordx4 v[4:7], v127, s[28:31], s59 offen sc1
    ds_read_b128 v[40:43], v136 offset:1792
    s_waitcnt lgkmcnt(7)
    v_mfma_f32_16x16x32_bf16 v[4:7], v[216:219], v[28:31], 0
    s_waitcnt lgkmcnt(6)
    v_mfma_f32_16x16x32_bf16 v[4:7], v[216:219], v[16:19], v[4:7]
    s_waitcnt lgkmcnt(5)
    v_mfma_f32_16x16x32_bf16 v[16:19], a[216:219], v[104:107], 0
    s_waitcnt lgkmcnt(4)
    v_mfma_f32_16x16x32_bf16 v[16:19], a[220:223], v[100:103], v[16:19]
    s_waitcnt lgkmcnt(3)
    ds_read_b128 v[64:67], v137 offset:0
    ds_read_b128 v[60:63], v136 offset:0
    v_mfma_f32_16x16x32_bf16 v[16:19], a[224:227], v[92:95], v[16:19]
    s_waitcnt lgkmcnt(4)
    ds_read_b128 v[56:59], v137 offset:128
    v_mfma_f32_16x16x32_bf16 v[16:19], a[228:231], v[88:91], v[16:19]
    s_waitcnt lgkmcnt(4)
    buffer_store_dwordx4 v[24:27], v126, s[28:31], s59 offen sc1
    ds_read_b128 v[44:47], v136 offset:128
    v_rsq_f32 v4, v4
    v_mfma_f32_16x16x32_bf16 v[16:19], a[232:235], v[76:79], v[16:19]
    s_waitcnt lgkmcnt(4)
    ds_read_b128 v[32:35], v137 offset:256
    ds_read_b128 v[24:27], v136 offset:256
    v_mfma_f32_16x16x32_bf16 v[16:19], a[236:239], v[40:43], v[16:19]
    v_rsq_f32 v5, v5
    v_mfma_f32_16x16x32_bf16 v[28:31], a[240:243], v[104:107], 0
    v_mul_f32 v4, s43, v4
    v_mul_f32 v5, s43, v5
    v_mfma_f32_16x16x32_bf16 v[28:31], a[244:247], v[100:103], v[28:31]
    v_rsq_f32 v6, v6
    v_mfma_f32_16x16x32_bf16 v[28:31], a[248:251], v[92:95], v[28:31]
    v_mul_f32 v6, s43, v6
    v_mul_f32 v84, v84, v6
    v_mfma_f32_16x16x32_bf16 v[28:31], a[252:255], v[88:91], v[28:31]
    buffer_store_dwordx4 v[20:23], v125, s[28:31], s59 offen sc1
    v_mul_f32 v85, v85, v6
    v_cvt_pk_bf16_f32 v84, v84, v85
    v_mul_f32 v86, v86, v6
    v_mul_f32 v87, v87, v6
    v_mfma_f32_16x16x32_bf16 v[28:31], v[224:227], v[76:79], v[28:31]
    v_cvt_pk_bf16_f32 v85, v86, v87
    v_mul_f32 v96, v96, v6
    v_mfma_f32_16x16x32_bf16 v[28:31], v[228:231], v[40:43], v[28:31]
    v_mul_f32 v97, v97, v6
    v_cvt_pk_bf16_f32 v86, v96, v97
    v_mfma_f32_16x16x32_bf16 v[20:23], v[232:235], v[104:107], 0
    v_mul_f32 v98, v98, v6
    v_mul_f32 v99, v99, v6
    v_mfma_f32_16x16x32_bf16 v[20:23], v[236:239], v[100:103], v[20:23]
    v_cvt_pk_bf16_f32 v87, v98, v99
    v_mul_f32 v36, v36, v6
    v_mfma_f32_16x16x32_bf16 v[20:23], v[240:243], v[92:95], v[20:23]
    ds_write_b128 v135, v[84:87] offset:3072
    v_mfma_f32_16x16x32_bf16 v[20:23], v[244:247], v[88:91], v[20:23]
    buffer_store_dwordx4 v[80:83], v124, s[28:31], s59 offen sc1
    v_mul_f32 v37, v37, v6
    v_cvt_pk_bf16_f32 v36, v36, v37
    v_mul_f32 v38, v38, v6
    v_mul_f32 v39, v39, v6
    v_mfma_f32_16x16x32_bf16 v[20:23], v[248:251], v[76:79], v[20:23]
    v_cvt_pk_bf16_f32 v37, v38, v39
    v_mul_f32 v72, v72, v4
    v_mfma_f32_16x16x32_bf16 v[20:23], v[252:255], v[40:43], v[20:23]
    s_waitcnt lgkmcnt(1)
    ds_write_b64 v134, v[36:37] offset:3072
    v_mfma_f32_16x16x32_bf16 v[36:39], a[216:219], v[64:67], 0
    v_mul_f32 v73, v73, v4
    v_cvt_pk_bf16_f32 v40, v72, v73
    v_mfma_f32_16x16x32_bf16 v[36:39], a[220:223], v[60:63], v[36:39]
    v_mul_f32 v74, v74, v4
    v_mul_f32 v75, v75, v4
    v_mfma_f32_16x16x32_bf16 v[36:39], a[224:227], v[56:59], v[36:39]
    v_cvt_pk_bf16_f32 v41, v74, v75
    v_mul_f32 v48, v48, v4
    v_mfma_f32_16x16x32_bf16 v[36:39], a[228:231], v[44:47], v[36:39]
    v_mul_f32 v49, v49, v4
    v_cvt_pk_bf16_f32 v42, v48, v49
    v_mfma_f32_16x16x32_bf16 v[36:39], a[232:235], v[32:35], v[36:39]
    v_mul_f32 v50, v50, v4
    v_mul_f32 v51, v51, v4
    v_mfma_f32_16x16x32_bf16 v[36:39], a[236:239], v[24:27], v[36:39]
    v_cvt_pk_bf16_f32 v43, v50, v51
    v_mul_f32 v68, v68, v4
    v_mfma_f32_16x16x32_bf16 v[48:51], a[240:243], v[64:67], 0
    ds_write_b128 v135, v[40:43] offset:0
    v_mfma_f32_16x16x32_bf16 v[48:51], a[244:247], v[60:63], v[48:51]
    v_mul_f32 v69, v69, v4
    v_cvt_pk_bf16_f32 v6, v68, v69
    v_mfma_f32_16x16x32_bf16 v[48:51], a[248:251], v[56:59], v[48:51]
    v_mul_f32 v70, v70, v4
    v_mul_f32 v71, v71, v4
    v_mfma_f32_16x16x32_bf16 v[48:51], a[252:255], v[44:47], v[48:51]
    v_cvt_pk_bf16_f32 v7, v70, v71
    v_fma_f32 v11, v16, v16, s42
    v_mfma_f32_16x16x32_bf16 v[48:51], v[224:227], v[32:35], v[48:51]
    ds_write_b64 v134, v[6:7] offset:0
    v_mfma_f32_16x16x32_bf16 v[48:51], v[228:231], v[24:27], v[48:51]
    v_fmac_f32 v11, v17, v17
    v_fmac_f32 v11, v18, v18
    v_mfma_f32_16x16x32_bf16 v[40:43], v[232:235], v[64:67], 0
    v_fmac_f32 v11, v19, v19
    v_fmac_f32 v11, v28, v28
    v_mfma_f32_16x16x32_bf16 v[40:43], v[236:239], v[60:63], v[40:43]
    v_fmac_f32 v11, v29, v29
    v_fmac_f32 v11, v30, v30
    v_mfma_f32_16x16x32_bf16 v[40:43], v[240:243], v[56:59], v[40:43]
    v_fmac_f32 v11, v31, v31
    v_fmac_f32 v11, v20, v20
    v_mfma_f32_16x16x32_bf16 v[40:43], v[244:247], v[44:47], v[40:43]
    v_fmac_f32 v11, v21, v21
    v_fmac_f32 v11, v22, v22
    v_mfma_f32_16x16x32_bf16 v[40:43], v[248:251], v[32:35], v[40:43]
    v_fmac_f32 v11, v23, v23
    v_fma_f32 v114, v36, v36, s42
    v_mfma_f32_16x16x32_bf16 v[40:43], v[252:255], v[24:27], v[40:43]
    s_nop 0
    v_fmac_f32 v114, v37, v37
    v_fmac_f32 v114, v38, v38
    v_fmac_f32 v114, v39, v39
    v_fmac_f32 v114, v48, v48
    v_fmac_f32 v114, v49, v49
    v_fmac_f32 v114, v50, v50
    v_fmac_f32 v114, v51, v51
    v_fmac_f32 v114, v40, v40
    v_fmac_f32 v114, v41, v41
    v_fmac_f32 v114, v42, v42
    v_fmac_f32 v114, v43, v43
    v_cvt_pk_bf16_f32 v114, v114, v11
    ds_write_b64 v130, v[114:115] offset:4096
    v_mul_f32 v0, v0, v5
    v_mul_f32 v1, v1, v5
    v_cvt_pk_bf16_f32 v0, v0, v1
    v_mul_f32 v2, v2, v5
    v_mul_f32 v3, v3, v5
    v_cvt_pk_bf16_f32 v1, v2, v3
    v_mul_f32 v52, v52, v5
    v_mul_f32 v53, v53, v5
    v_cvt_pk_bf16_f32 v2, v52, v53
    v_mul_f32 v54, v54, v5
    v_mul_f32 v55, v55, v5
    v_cvt_pk_bf16_f32 v3, v54, v55
    v_mul_f32 v12, v12, v5
    v_mul_f32 v13, v13, v5
    v_cvt_pk_bf16_f32 v114, v12, v13
    v_mul_f32 v14, v14, v5
    v_mul_f32 v15, v15, v5
    v_cvt_pk_bf16_f32 v115, v14, v15
    ds_write_b128 v135, v[0:3] offset:1536
    s_waitcnt lgkmcnt(1)
    s_barrier
    ds_write_b64 v134, v[114:115] offset:1536
    ds_read_b128 v[4:7], v129 offset:4096
    ds_read_b128 v[0:3], v129 offset:5120
    s_waitcnt lgkmcnt(2)
    s_barrier
    s_waitcnt lgkmcnt(1)
    v_mfma_f32_16x16x32_bf16 v[24:27], v[216:219], v[4:7], 0
    s_waitcnt lgkmcnt(0)
    ds_read_b128 v[44:47], v113 offset:0
    ds_read_b128 v[32:35], v113 offset:1024
    v_mfma_f32_16x16x32_bf16 v[24:27], v[216:219], v[0:3], v[24:27]
    s_nop 0
    ds_read_b128 v[12:15], v113 offset:2048
    s_nop 2
    ds_read_b128 v[4:7], v113 offset:3072
    s_nop 1
    v_rsq_f32 v24, v24
    ds_read_b128 v[0:3], v113 offset:4096
    v_mul_f32 v24, s43, v24
    v_mul_f32 v36, v36, v24
    v_mul_f32 v37, v37, v24
    v_cvt_pk_bf16_f32 v36, v36, v37
    v_mul_f32 v38, v38, v24
    v_mul_f32 v39, v39, v24
    v_cvt_pk_bf16_f32 v37, v38, v39
    v_mul_f32 v48, v48, v24
    v_mul_f32 v49, v49, v24
    s_waitcnt lgkmcnt(4)
    buffer_store_dwordx4 v[44:47], v128, s[28:31], s58 offen sc1
    v_cvt_pk_bf16_f32 v38, v48, v49
    v_mul_f32 v50, v50, v24
    v_mul_f32 v51, v51, v24
    v_cvt_pk_bf16_f32 v39, v50, v51
    v_mul_f32 v40, v40, v24
    v_mul_f32 v41, v41, v24
    v_cvt_pk_bf16_f32 v26, v40, v41
    v_mul_f32 v42, v42, v24
    v_mul_f32 v43, v43, v24
    v_cvt_pk_bf16_f32 v27, v42, v43
    ds_write_b128 v112, v[36:39] offset:0
    v_rsq_f32 v25, v25
    s_nop 0
    v_mul_f32 v25, s43, v25
    s_waitcnt lgkmcnt(1)
    buffer_store_dwordx4 v[32:35], v127, s[28:31], s58 offen sc1
    ds_write_b64 v132, v[26:27] offset:0
    v_mul_f32 v16, v16, v25
    v_mul_f32 v17, v17, v25
    v_cvt_pk_bf16_f32 v16, v16, v17
    v_mul_f32 v18, v18, v25
    v_mul_f32 v19, v19, v25
    v_cvt_pk_bf16_f32 v17, v18, v19
    v_mul_f32 v28, v28, v25
    v_mul_f32 v29, v29, v25
    v_cvt_pk_bf16_f32 v18, v28, v29
    v_mul_f32 v30, v30, v25
    v_mul_f32 v31, v31, v25
    v_cvt_pk_bf16_f32 v19, v30, v31
    v_mul_f32 v20, v20, v25
    v_mul_f32 v21, v21, v25
    v_cvt_pk_bf16_f32 v128, v20, v21
    v_mul_f32 v22, v22, v25
    v_mul_f32 v23, v23, v25
    v_cvt_pk_bf16_f32 v129, v22, v23
    buffer_store_dwordx4 v[12:15], v126, s[28:31], s58 offen sc1
    ds_write_b128 v112, v[16:19] offset:1536
    ds_write_b64 v132, v[128:129] offset:1536
    buffer_store_dwordx4 v[4:7], v125, s[28:31], s58 offen sc1
    s_waitcnt lgkmcnt(0)
    s_barrier
    buffer_store_dwordx4 v[0:3], v124, s[28:31], s58 offen sc1
    ds_read_b128 v[12:15], v131 offset:0
    ds_read_b128 v[4:7], v131 offset:1024
    ds_read_b128 v[0:3], v131 offset:2048
    s_waitcnt lgkmcnt(2)
    buffer_store_dwordx4 v[12:15], v8, s[28:31], 0 offen sc1
    s_waitcnt lgkmcnt(0)
    buffer_store_dwordx4 v[4:7], v9, s[28:31], 0 offen sc1
    buffer_store_dwordx4 v[0:3], v10, s[28:31], 0 offen sc1
    s_branch L_fin
L_again:
    s_waitcnt vmcnt(0) lgkmcnt(0)
    s_nop 15
    s_barrier
    s_movk_i32 s2, 256
    s_branch L_top
L_bndS:
    s_movk_i32 s73, 20
    s_movk_i32 s71, 18
    s_movk_i32 s70, -20
    s_mov_b32 s74, 0
    s_cmp_lt_u32 s2, 252
    s_cbranch_scc1 L_bndcS
    s_sub_u32 s94, s2, 252
    s_mul_i32 s69, s94, 18
    s_mov_b32 s74, 2
    s_sub_u32 s93, s93, 1373568
    v_cmp_le_u32 vcc, 4, v73
    v_add_u32 v6, 98896896, v128
    v_subrev_u32 v7, 1373568, v128
    v_cndmask_b32 v128, v6, v7, vcc
    v_cmp_le_u32 vcc, 4, v156
    v_add_u32 v6, 98896896, v127
    v_subrev_u32 v7, 1373568, v127
    v_cndmask_b32 v127, v6, v7, vcc
    v_cmp_le_u32 vcc, 4, v4
    v_add_u32 v6, 98896896, v126
    v_subrev_u32 v7, 1373568, v126
    v_cndmask_b32 v126, v6, v7, vcc
    v_cmp_le_u32 vcc, 4, v18
    v_add_u32 v6, 98896896, v125
    v_subrev_u32 v7, 1373568, v125
    v_cndmask_b32 v125, v6, v7, vcc
    v_cmp_le_u32 vcc, 4, v11
    v_add_u32 v6, 98896896, v124
    v_subrev_u32 v7, 1373568, v124
    v_cndmask_b32 v124, v6, v7, vcc
    s_cmp_lt_u32 s2, 256
    s_cbranch_scc1 L_bndrS
L_bndcS:
    s_sub_u32 s94, s2, 248
    s_mul_i32 s69, s94, 20
    s_lshr_b32 s71, s94, 1
    s_sub_u32 s69, s69, s71
    s_and_b32 s94, s94, 1
    s_sub_u32 s71, 20, s94
    s_cmp_eq_u32 s2, 251
    s_cselect_b32 s71, 13, s71
    s_mov_b32 s62, 1373568
    s_add_u32 s74, s74, 1
    s_sub_u32 s93, s93, 2688
    v_mad_i32_i24 v6, v73, -7, v74
    v_cmp_le_u32 vcc, 4, v6
    v_add_u32 v6, 193536, v128
    v_subrev_u32 v7, 2688, v128
    v_cndmask_b32 v128, v6, v7, vcc
    v_mad_i32_i24 v6, v156, -7, v150
    v_cmp_le_u32 vcc, 4, v6
    v_add_u32 v6, 193536, v127
    v_subrev_u32 v7, 2688, v127
    v_cndmask_b32 v127, v6, v7, vcc
    v_mad_i32_i24 v6, v4, -7, v10
    v_cmp_le_u32 vcc, 4, v6
    v_add_u32 v6, 193536, v126
    v_subrev_u32 v7, 2688, v126
    v_cndmask_b32 v126, v6, v7, vcc
    v_mad_i32_i24 v6, v18, -7, v159
    v_cmp_le_u32 vcc, 4, v6
    v_add_u32 v6, 193536, v125
    v_subrev_u32 v7, 2688, v125
    v_cndmask_b32 v125, v6, v7, vcc
    v_mad_i32_i24 v6, v11, -7, v151
    v_cmp_le_u32 vcc, 4, v6
    v_add_u32 v6, 193536, v124
    v_subrev_u32 v7, 2688, v124
    v_cndmask_b32 v124, v6, v7, vcc
    s_cmp_eq_u32 s2, 256
    s_cselect_b32 s62, 0, s62
    s_cselect_b32 s69, 0, s69
    s_cselect_b32 s71, 2, s71
    s_branch L_bndrS
L_maskS:
    s_and_b32 s20, s74, 2
    s_and_b32 s21, s74, 1
    s_mov_b32 s22, 0xc31044fe
    v_lshrrev_b32 v161, 2, v149
    v_add_u32 v161, 0, v161
    v_mul_u32_u24 v148, 37, v161
    v_lshrrev_b32 v72, 8, v148
    v_mad_i32_i24 v72, v72, -7, v161
    v_lshrrev_b32 v148, 10, v148
    v_lshrrev_b32 v72, 2, v72
    v_mul_u32_u24 v148, s20, v148
    v_mad_u32_u24 v161, v72, s21, v148
    v_cvt_f32_u32 v161, v161
    v_lshrrev_b32 v164, 2, v149
    v_add_u32 v164, 4, v164
    v_mul_u32_u24 v148, 37, v164
    v_lshrrev_b32 v72, 8, v148
    v_mad_i32_i24 v72, v72, -7, v164
    v_lshrrev_b32 v148, 10, v148
    v_lshrrev_b32 v72, 2, v72
    v_mul_u32_u24 v148, s20, v148
    v_mad_u32_u24 v164, v72, s21, v148
    v_cvt_f32_u32 v164, v164
    v_lshrrev_b32 v75, 2, v149
    v_add_u32 v75, 8, v75
    v_mul_u32_u24 v148, 37, v75
    v_lshrrev_b32 v72, 8, v148
    v_mad_i32_i24 v72, v72, -7, v75
    v_lshrrev_b32 v148, 10, v148
    v_lshrrev_b32 v72, 2, v72
    v_mul_u32_u24 v148, s20, v148
    v_mad_u32_u24 v75, v72, s21, v148
    v_cvt_f32_u32 v75, v75
    v_mad_u32_u24 v73, v160, 12, 0
    v_mul_u32_u24 v148, 37, v73
    v_lshrrev_b32 v72, 8, v148
    v_mad_i32_i24 v72, v72, -7, v73
    v_lshrrev_b32 v148, 10, v148
    v_lshrrev_b32 v72, 2, v72
    v_mul_u32_u24 v148, s20, v148
    v_mad_u32_u24 v73, v72, s21, v148
    v_cvt_f32_u32 v73, v73
    v_sub_f32 v148, v161, v73
    v_mul_f32 v148, v148, v148 clamp
    v_fmac_f32 v204, s22, v148
    v_sub_f32 v148, v164, v73
    v_mul_f32 v148, v148, v148 clamp
    v_fmac_f32 v192, s22, v148
    v_sub_f32 v148, v75, v73
    v_mul_f32 v148, v148, v148 clamp
    v_fmac_f32 v180, s22, v148
    v_mad_u32_u24 v73, v160, 12, 1
    v_mul_u32_u24 v148, 37, v73
    v_lshrrev_b32 v72, 8, v148
    v_mad_i32_i24 v72, v72, -7, v73
    v_lshrrev_b32 v148, 10, v148
    v_lshrrev_b32 v72, 2, v72
    v_mul_u32_u24 v148, s20, v148
    v_mad_u32_u24 v73, v72, s21, v148
    v_cvt_f32_u32 v73, v73
    v_sub_f32 v148, v161, v73
    v_mul_f32 v148, v148, v148 clamp
    v_fmac_f32 v205, s22, v148
    v_sub_f32 v148, v164, v73
    v_mul_f32 v148, v148, v148 clamp
    v_fmac_f32 v193, s22, v148
    v_sub_f32 v148, v75, v73
    v_mul_f32 v148, v148, v148 clamp
    v_fmac_f32 v181, s22, v148
    v_mad_u32_u24 v73, v160, 12, 2
    v_mul_u32_u24 v148, 37, v73
    v_lshrrev_b32 v72, 8, v148
    v_mad_i32_i24 v72, v72, -7, v73
    v_lshrrev_b32 v148, 10, v148
    v_lshrrev_b32 v72, 2, v72
    v_mul_u32_u24 v148, s20, v148
    v_mad_u32_u24 v73, v72, s21, v148
    v_cvt_f32_u32 v73, v73
    v_sub_f32 v148, v161, v73
    v_mul_f32 v148, v148, v148 clamp
    v_fmac_f32 v206, s22, v148
    v_sub_f32 v148, v164, v73
    v_mul_f32 v148, v148, v148 clamp
    v_fmac_f32 v194, s22, v148
    v_sub_f32 v148, v75, v73
    v_mul_f32 v148, v148, v148 clamp
    v_fmac_f32 v182, s22, v148
    v_mad_u32_u24 v73, v160, 12, 3
    v_mul_u32_u24 v148, 37, v73
    v_lshrrev_b32 v72, 8, v148
    v_mad_i32_i24 v72, v72, -7, v73
    v_lshrrev_b32 v148, 10, v148
    v_lshrrev_b32 v72, 2, v72
    v_mul_u32_u24 v148, s20, v148
    v_mad_u32_u24 v73, v72, s21, v148
    v_cvt_f32_u32 v73, v73
    v_sub_f32 v148, v161, v73
    v_mul_f32 v148, v148, v148 clamp
    v_fmac_f32 v207, s22, v148
    v_sub_f32 v148, v164, v73
    v_mul_f32 v148, v148, v148 clamp
    v_fmac_f32 v195, s22, v148
    v_sub_f32 v148, v75, v73
    v_mul_f32 v148, v148, v148 clamp
    v_fmac_f32 v183, s22, v148
    v_mad_u32_u24 v73, v160, 12, 4
    v_mul_u32_u24 v148, 37, v73
    v_lshrrev_b32 v72, 8, v148
    v_mad_i32_i24 v72, v72, -7, v73
    v_lshrrev_b32 v148, 10, v148
    v_lshrrev_b32 v72, 2, v72
    v_mul_u32_u24 v148, s20, v148
    v_mad_u32_u24 v73, v72, s21, v148
    v_cvt_f32_u32 v73, v73
    v_sub_f32 v148, v161, v73
    v_mul_f32 v148, v148, v148 clamp
    v_fmac_f32 v200, s22, v148
    v_sub_f32 v148, v164, v73
    v_mul_f32 v148, v148, v148 clamp
    v_fmac_f32 v188, s22, v148
    v_sub_f32 v148, v75, v73
    v_mul_f32 v148, v148, v148 clamp
    v_fmac_f32 v176, s22, v148
    v_mad_u32_u24 v73, v160, 12, 5
    v_mul_u32_u24 v148, 37, v73
    v_lshrrev_b32 v72, 8, v148
    v_mad_i32_i24 v72, v72, -7, v73
    v_lshrrev_b32 v148, 10, v148
    v_lshrrev_b32 v72, 2, v72
    v_mul_u32_u24 v148, s20, v148
    v_mad_u32_u24 v73, v72, s21, v148
    v_cvt_f32_u32 v73, v73
    v_sub_f32 v148, v161, v73
    v_mul_f32 v148, v148, v148 clamp
    v_fmac_f32 v201, s22, v148
    v_sub_f32 v148, v164, v73
    v_mul_f32 v148, v148, v148 clamp
    v_fmac_f32 v189, s22, v148
    v_sub_f32 v148, v75, v73
    v_mul_f32 v148, v148, v148 clamp
    v_fmac_f32 v177, s22, v148
    v_mad_u32_u24 v73, v160, 12, 6
    v_mul_u32_u24 v148, 37, v73
    v_lshrrev_b32 v72, 8, v148
    v_mad_i32_i24 v72, v72, -7, v73
    v_lshrrev_b32 v148, 10, v148
    v_lshrrev_b32 v72, 2, v72
    v_mul_u32_u24 v148, s20, v148
    v_mad_u32_u24 v73, v72, s21, v148
    v_cvt_f32_u32 v73, v73
    v_sub_f32 v148, v161, v73
    v_mul_f32 v148, v148, v148 clamp
    v_fmac_f32 v202, s22, v148
    v_sub_f32 v148, v164, v73
    v_mul_f32 v148, v148, v148 clamp
    v_fmac_f32 v190, s22, v148
    v_sub_f32 v148, v75, v73
    v_mul_f32 v148, v148, v148 clamp
    v_fmac_f32 v178, s22, v148
    v_mad_u32_u24 v73, v160, 12, 7
    v_mul_u32_u24 v148, 37, v73
    v_lshrrev_b32 v72, 8, v148
    v_mad_i32_i24 v72, v72, -7, v73
    v_lshrrev_b32 v148, 10, v148
    v_lshrrev_b32 v72, 2, v72
    v_mul_u32_u24 v148, s20, v148
    v_mad_u32_u24 v73, v72, s21, v148
    v_cvt_f32_u32 v73, v73
    v_sub_f32 v148, v161, v73
    v_mul_f32 v148, v148, v148 clamp
    v_fmac_f32 v203, s22, v148
    v_sub_f32 v148, v164, v73
    v_mul_f32 v148, v148, v148 clamp
    v_fmac_f32 v191, s22, v148
    v_sub_f32 v148, v75, v73
    v_mul_f32 v148, v148, v148 clamp
    v_fmac_f32 v179, s22, v148
    v_mad_u32_u24 v73, v160, 12, 8
    v_mul_u32_u24 v148, 37, v73
    v_lshrrev_b32 v72, 8, v148
    v_mad_i32_i24 v72, v72, -7, v73
    v_lshrrev_b32 v148, 10, v148
    v_lshrrev_b32 v72, 2, v72
    v_mul_u32_u24 v148, s20, v148
    v_mad_u32_u24 v73, v72, s21, v148
    v_cvt_f32_u32 v73, v73
    v_sub_f32 v148, v161, v73
    v_mul_f32 v148, v148, v148 clamp
    v_fmac_f32 v196, s22, v148
    v_sub_f32 v148, v164, v73
    v_mul_f32 v148, v148, v148 clamp
    v_fmac_f32 v184, s22, v148
    v_sub_f32 v148, v75, v73
    v_mul_f32 v148, v148, v148 clamp
    v_fmac_f32 v172, s22, v148
    v_mad_u32_u24 v73, v160, 12, 9
    v_mul_u32_u24 v148, 37, v73
    v_lshrrev_b32 v72, 8, v148
    v_mad_i32_i24 v72, v72, -7, v73
    v_lshrrev_b32 v148, 10, v148
    v_lshrrev_b32 v72, 2, v72
    v_mul_u32_u24 v148, s20, v148
    v_mad_u32_u24 v73, v72, s21, v148
    v_cvt_f32_u32 v73, v73
    v_sub_f32 v148, v161, v73
    v_mul_f32 v148, v148, v148 clamp
    v_fmac_f32 v197, s22, v148
    v_sub_f32 v148, v164, v73
    v_mul_f32 v148, v148, v148 clamp
    v_fmac_f32 v185, s22, v148
    v_sub_f32 v148, v75, v73
    v_mul_f32 v148, v148, v148 clamp
    v_fmac_f32 v173, s22, v148
    v_mad_u32_u24 v73, v160, 12, 10
    v_mul_u32_u24 v148, 37, v73
    v_lshrrev_b32 v72, 8, v148
    v_mad_i32_i24 v72, v72, -7, v73
    v_lshrrev_b32 v148, 10, v148
    v_lshrrev_b32 v72, 2, v72
    v_mul_u32_u24 v148, s20, v148
    v_mad_u32_u24 v73, v72, s21, v148
    v_cvt_f32_u32 v73, v73
    v_sub_f32 v148, v161, v73
    v_mul_f32 v148, v148, v148 clamp
    v_fmac_f32 v198, s22, v148
    v_sub_f32 v148, v164, v73
    v_mul_f32 v148, v148, v148 clamp
    v_fmac_f32 v186, s22, v148
    v_sub_f32 v148, v75, v73
    v_mul_f32 v148, v148, v148 clamp
    v_fmac_f32 v174, s22, v148
    v_mad_u32_u24 v73, v160, 12, 11
    v_mul_u32_u24 v148, 37, v73
    v_lshrrev_b32 v72, 8, v148
    v_mad_i32_i24 v72, v72, -7, v73
    v_lshrrev_b32 v148, 10, v148
    v_lshrrev_b32 v72, 2, v72
    v_mul_u32_u24 v148, s20, v148
    v_mad_u32_u24 v73, v72, s21, v148
    v_cvt_f32_u32 v73, v73
    v_sub_f32 v148, v161, v73
    v_mul_f32 v148, v148, v148 clamp
    v_fmac_f32 v199, s22, v148
    v_sub_f32 v148, v164, v73
    v_mul_f32 v148, v148, v148 clamp
    v_fmac_f32 v187, s22, v148
    v_sub_f32 v148, v75, v73
    v_mul_f32 v148, v148, v148 clamp
    v_fmac_f32 v175, s22, v148
    v_cvt_f32_u32 v73, s74
    v_sub_f32 v148, v161, v73
    v_mul_f32 v148, v148, v148 clamp
    v_fmac_f32 v208, s22, v148
    v_sub_f32 v148, v164, v73
    v_mul_f32 v148, v148, v148 clamp
    v_fmac_f32 v209, s22, v148
    v_sub_f32 v148, v75, v73
    v_mul_f32 v148, v148, v148 clamp
    v_fmac_f32 v210, s22, v148
    v_lshrrev_b32 v161, 2, v149
    v_lshl_add_u32 v161, v160, 2, v161
    v_add_u32 v148, 1, v160
    v_lshrrev_b32 v148, 2, v148
    v_mad_u32_u24 v161, v148, 36, v161
    v_min_u32 v161, 48, v161
    v_mul_u32_u24 v148, 37, v161
    v_lshrrev_b32 v72, 8, v148
    v_mad_i32_i24 v72, v72, -7, v161
    v_lshrrev_b32 v148, 10, v148
    v_lshrrev_b32 v72, 2, v72
    v_mul_u32_u24 v148, s20, v148
    v_mad_u32_u24 v161, v72, s21, v148
    v_cvt_f32_u32 v161, v161
    v_sub_f32 v148, v161, v73
    v_mul_f32 v148, v148, v148 clamp
    v_fmac_f32 v211, s22, v148
    s_branch L_nomaskS
L_atomS0:
    v_mov_b32 v122, 0x800000
    buffer_atomic_add v122, v129, s[8:11], 0 offen sc0 sc1
    s_branch L_atomS0r
.section .rodata,"a"
.p2align 6
.amdhsa_kernel standalone__window_attn_swin_v2__vision_kernel
  .amdhsa_next_free_vgpr 512
  .amdhsa_next_free_sgpr 102
  .amdhsa_accum_offset 256
  .amdhsa_group_segment_fixed_size 0
  .amdhsa_kernarg_size 96
  .amdhsa_user_sgpr_count 2
  .amdhsa_user_sgpr_kernarg_segment_ptr 1
  .amdhsa_system_sgpr_workgroup_id_x 1
.end_amdhsa_kernel
```

```asm
; @launch grid=(256,1,1) block=(256,1,1) lds=163840
.amdgcn_target "amdgcn-amd-amdhsa--gfx950"
.text
.globl standalone__window_attn_swin_v2__vision_kernel
.p2align 8
.type standalone__window_attn_swin_v2__vision_kernel,@function
standalone__window_attn_swin_v2__vision_kernel:
    v_lshrrev_b32 v0, 6, v0
    s_cmp_ge_u32 s2, 256
    s_cbranch_scc1 L_end
    v_readfirstlane_b32 s68, v0
L_top:
    s_mov_b32 s64, 0
    s_nop 0
L_top2:
    v_mbcnt_lo_u32_b32 v9, -1, 0
    v_mbcnt_hi_u32_b32 v9, -1, v9
    s_load_dwordx16 s[4:19], s[0:1], 0
    s_load_dwordx4 s[20:23], s[0:1], 64
    s_load_dwordx2 s[38:39], s[0:1], 80
    s_load_dwordx2 s[76:77], s[0:1], 88
    s_add_u32 s84, s2, s64
    s_sub_u32 s84, s84, 248
    s_cmp_lt_u32 s84, 3
    s_cbranch_scc1 L_prod
    s_bfe_u32 s88, s2, 0x50003
    s_lshl2_add_u32 s88, s88, s68
    v_lshlrev_b32 v8, 7, v9
    s_getpc_b64 s[80:81]
    s_mul_i32 s84, s88, 288
    v_min_u32 v10, 256, v8
    v_add_u32 v10, s84, v10
    v_min_u32 v10, L_slow-standalone__window_attn_swin_v2__vision_kernel-256, v10
    s_mul_i32 s88, s88, 1728
    s_mov_b32 s34, 221184
    global_load_dword a255, v10, s[80:81]
    v_min_u32 v97, 1664, v8
    s_mov_b32 s35, 0x20000
    s_mov_b32 s78, 73728
    s_mov_b32 s79, 0x20000
    v_and_b32 v98, 15, v9
    v_lshrrev_b32 v96, 4, v9
    v_lshrrev_b32 v17, 2, v98
    v_and_b32 v19, 3, v98
    s_mul_i32 s87, s68, 192
    v_mad_u32_u24 v16, v98, 12, s87
    v_lshlrev_b32 v18, 1, v98
    v_lshlrev_b32 v14, 1, v17
    v_lshl_add_u32 v14, v96, 5, v14
    s_movk_i32 s86, 384
    s_mov_b32 s26, 100270464
    s_mov_b32 s27, 0x20000
    s_mov_b32 s30, 0
    s_mov_b32 s31, 0x20000
    s_waitcnt lgkmcnt(0)
    s_mov_b32 s24, s4
    s_mov_b32 s25, s5
    s_mov_b32 s32, s6
    s_mov_b32 s33, s7
    buffer_load_dword a254, v97, s[32:35], s88 offen
    s_load_dwordx2 s[82:83], s[10:11], 0
    s_movk_i32 s18, 676
    s_mov_b32 s19, 0x20000
    buffer_load_dwordx3 v[24:26], v16, s[16:19], 0 offen
    s_mul_i32 s96, s68, 288
    s_and_b32 s97, s68, 1
    s_lshl_b32 s97, s97, 2
    s_mov_b32 s98, 193536
    s_mov_b32 s99, 589824
    global_load_ushort v12, v18, s[12:13]
    v_add_u32 v8, s96, v9
    v_mul_u32_u24 v32, 2731, v8
    v_mul_u32_u24 v130, 6242, v8
    v_lshrrev_b32 v32, 16, v32
    v_lshrrev_b32 v130, 20, v130
    s_lshr_b32 s94, s2, 3
    s_mul_i32 s70, s94, 167
    global_load_ushort v13, v18, s[12:13] offset:32
    v_and_or_b32 v27, v32, 3, s97
    v_xor_b32 v27, v8, v27
    v_lshl_add_u32 v128, v27, 4, s99
    v_mad_u32_u24 v128, v130, s98, v128
    v_add_u32 v18, 64, v8
    s_min_u32 s95, s94, 7
    s_add_u32 s70, s70, s95
    global_load_ushort v122, v14, s[14:15] offset:0
    v_mul_u32_u24 v99, 2731, v18
    v_mul_u32_u24 v129, 6242, v18
    v_lshrrev_b32 v99, 16, v99
    v_lshrrev_b32 v129, 20, v129
    v_and_or_b32 v33, v99, 3, s97
    s_and_b32 s95, s2, 7
    s_mul_i32 s95, s95, 20
    global_load_ushort v15, v14, s[14:15] offset:8
    v_xor_b32 v33, v18, v33
    v_lshl_add_u32 v127, v33, 4, s99
    v_mad_u32_u24 v127, v129, s98, v127
    v_add_u32 v35, 128, v8
    v_mul_u32_u24 v97, 2731, v35
    s_add_u32 s69, s70, s95
    s_add_u32 s70, s70, 140
    global_load_ushort v123, v14, s[14:15] offset:16
    v_mul_u32_u24 v18, 6242, v35
    v_lshrrev_b32 v97, 16, v97
    v_lshrrev_b32 v18, 20, v18
    v_and_or_b32 v34, v97, 3, s97
    v_xor_b32 v34, v35, v34
    s_movk_i32 s62, 2688
    s_movk_i32 s71, 20
    global_load_ushort v14, v14, s[14:15] offset:24
    v_lshl_add_u32 v126, v34, 4, s99
    v_mad_u32_u24 v126, v18, s98, v126
    v_add_u32 v131, 192, v8
    v_mul_u32_u24 v11, 2731, v131
    v_mul_u32_u24 v10, 6242, v131
    v_lshrrev_b32 v11, 16, v11
    v_lshrrev_b32 v10, 20, v10
    v_and_or_b32 v35, v11, 3, s97
    v_xor_b32 v35, v131, v35
    v_lshl_add_u32 v125, v35, 4, s99
    v_mad_u32_u24 v125, v10, s98, v125
    v_add_u32 v124, 256, v8
    v_mul_u32_u24 v8, 2731, v124
    v_mul_u32_u24 v35, 6242, v124
    v_lshrrev_b32 v8, 16, v8
    v_lshrrev_b32 v35, 20, v35
    v_and_or_b32 v131, v8, 3, s97
    v_xor_b32 v131, v124, v131
    v_lshl_add_u32 v124, v131, 4, s99
    v_mad_u32_u24 v124, v35, s98, v124
    s_cmp_lt_u32 s94, 7
    s_cselect_b32 s73, 28, 27
    s_mov_b32 s93, 1769472
    s_mul_i32 s54, s68, 5120
    s_cmp_ge_u32 s2, 248
    s_cbranch_scc1 L_bndF
L_bndrF:
    s_mov_b32 s63, 1180032
    s_mul_i32 s94, s69, 58255
    s_lshr_b32 s94, s94, 22
    s_mul_i32 s94, s94, s63
    s_mul_i32 s72, s69, s62
    s_add_u32 s72, s72, s94
    v_lshl_or_b32 v131, v9, 4, 2.0
    s_sub_u32 s94, s73, 1
    s_max_u32 s94, s94, 20
    s_mul_i32 s95, s68, -44
    s_movk_i32 s99, -24
    s_add_u32 m0, s54, 0
    v_and_b32 v35, -4, v97
    s_mul_i32 s85, s68, 96
    s_sub_u32 s100, s85, 1024
    buffer_load_dwordx4 v128, s[24:27], s72 offen nt lds
    s_add_u32 m0, s54, 1024
    v_mad_u32_u24 v18, v35, 3, v97
    v_add_u32 v18, s95, v18
    v_mad_i32_i24 v34, v97, s99, v34
    v_med3_u32 v35, v18, 20, s94
    v_add_u32 v35, s70, v35
    v_add_u32 v97, s69, v18
    s_sub_u32 s87, s85, 2048
    s_movk_i32 s91, 1152
    buffer_load_dwordx4 v127, s[24:27], s72 offen nt lds
    v_cmp_gt_u32 vcc, s71, v18
    v_lshl_add_u32 v34, v34, 4, s93
    s_add_u32 m0, s54, 43008
    v_cndmask_b32 v97, v35, v97, vcc
    v_mul_u32_u24 v35, 58255, v97
    v_mad_u32_u24 v34, v97, s62, v34
    v_lshrrev_b32 v35, 22, v35
    v_mad_u32_u24 v34, v35, s63, v34
    s_mul_i32 s90, s68, 3072
    s_add_u32 s90, s90, 61440
    buffer_load_dwordx4 v34, s[24:27], 0 offen  lds
    v_lshlrev_b32 v35, 16, v18
    s_add_u32 m0, s54, 2048
    v_and_b32 v97, -4, v99
    v_mad_u32_u24 v18, v97, 3, v99
    v_add_u32 v18, s95, v18
    v_mad_i32_i24 v33, v99, s99, v33
    v_med3_u32 v97, v18, 20, s94
    s_add_u32 s101, s54, 44032
    s_mov_b32 s28, s22
    buffer_load_dwordx4 v126, s[24:27], s72 offen nt lds
    v_add_u32 v97, s70, v97
    v_add_u32 v99, s69, v18
    v_cmp_gt_u32 vcc, s71, v18
    v_lshl_add_u32 v33, v33, 4, s93
    s_add_u32 m0, s54, 41984
    v_cndmask_b32 v99, v97, v99, vcc
    v_mul_u32_u24 v97, 58255, v99
    v_mad_u32_u24 v33, v99, s62, v33
    v_lshrrev_b32 v97, 22, v97
    v_mad_u32_u24 v33, v97, s63, v33
    s_mov_b32 s29, s23
    s_mov_b32 s41, 0x2a8cbccc
    buffer_load_dwordx4 v33, s[24:27], 0 offen  lds
    v_lshl_or_b32 v35, v18, 8, v35
    s_add_u32 m0, s54, 3072
    v_cmp_gt_u32 vcc, 32, v9
    v_and_b32 v97, -4, v32
    v_mad_u32_u24 v18, v97, 3, v32
    v_cndmask_b32 v124, v131, v124, vcc
    v_add_u32 v18, s95, v18
    s_mov_b32 s42, 0x38fba882
    s_mov_b32 s43, 0x415db3d7
    buffer_load_dwordx4 v125, s[24:27], s72 offen nt lds
    s_add_u32 m0, s54, 4096
    v_mad_i32_i24 v32, v32, s99, v27
    v_med3_u32 v97, v18, 20, s94
    v_add_u32 v97, s70, v97
    v_add_u32 v27, s69, v18
    v_cmp_gt_u32 vcc, s71, v18
    v_lshl_add_u32 v32, v32, 4, s93
    s_mul_i32 s93, s68, 6
    s_lshl_b32 s94, s97, 1
    buffer_load_dwordx4 v124, s[24:27], s72 offen nt lds
    v_cndmask_b32 v27, v97, v27, vcc
    v_mul_u32_u24 v97, 58255, v27
    v_mad_u32_u24 v32, v27, s62, v32
    v_lshrrev_b32 v97, 22, v97
    v_mad_u32_u24 v32, v97, s63, v32
    s_add_u32 m0, s54, 40960
    v_lshl_or_b32 v35, v18, 0, v35
    s_mov_b32 s44, 61440
    s_mov_b32 s45, 40960
    buffer_load_dwordx4 v32, s[24:27], 0 offen nt lds
    v_mul_u32_u24 v27, 10923, v9
    v_lshrrev_b32 v93, 17, v27
    v_lshrrev_b32 v27, 16, v27
    v_mad_i32_i24 v18, v27, -6, v9
    v_bitop3_b32 v93, v93, v27, 4 bitop3:0x28
    v_lshl_add_u32 v18, v18, 4, s85
    v_mul_u32_u24 v93, 3, v93
    v_xor_b32 v27, v27, v93
    v_mad_u32_u24 v93, v27, s91, v18
    v_add_u32 v27, 64, v9
    v_mul_u32_u24 v18, 10923, v27
    v_lshrrev_b32 v45, 17, v18
    v_lshrrev_b32 v18, 16, v18
    v_mad_i32_i24 v27, v18, -6, v27
    v_bitop3_b32 v45, v45, v18, 4 bitop3:0x28
    v_lshl_add_u32 v27, v27, 4, s100
    v_mul_u32_u24 v45, 3, v45
    v_xor_b32 v18, v18, v45
    v_mad_u32_u24 v45, v18, s91, v27
    v_add_u32 v97, 128, v9
    v_mul_u32_u24 v27, 10923, v97
    v_lshrrev_b32 v18, 17, v27
    v_lshrrev_b32 v27, 16, v27
    v_mad_i32_i24 v97, v27, -6, v97
    v_bitop3_b32 v18, v18, v27, 4 bitop3:0x28
    v_lshl_add_u32 v97, v97, 4, s87
    v_mul_u32_u24 v18, 3, v18
    v_xor_b32 v27, v27, v18
    v_mad_u32_u24 v18, v27, s91, v97
    s_add_u32 m0, s90, 0
    s_mov_b32 s92, 0
    buffer_load_dwordx4 v93, s[32:35], s92 offen offset:0 lds
    v_mov_b32 v27, 0x3f803f80
    v_cmp_eq_u32 vcc, 0, v19
    v_and_b32 v97, 1, v9
    v_lshlrev_b32 v97, 4, v97
    v_cndmask_b32 v220, 0, v27, vcc
    v_cndmask_b32 v221, 0, v27, vcc
    v_cndmask_b32 v222, 0, v27, vcc
    s_waitcnt lgkmcnt(0)
    s_sext_i32_i16 s84, s82
    s_ashr_i32 s85, s82, 16
    s_max_i32 s84, s84, s85
    s_sext_i32_i16 s85, s83
    s_max_i32 s84, s84, s85
    s_ashr_i32 s85, s83, 16
    s_max_i32 s84, s84, s85
    s_cmp_gt_i32 s84, 16492
    s_cbranch_scc1 L_slow
    s_lshl_b32 s84, s68, 4
    buffer_load_dwordx4 v45, s[32:35], s92 offen offset:1024 lds
    v_cndmask_b32 v223, 0, v27, vcc
    v_mov_b32 v27, 0x3f80
    v_lshlrev_b32 v44, v97, v27
    v_cmp_gt_u32 vcc, 2, v19
    v_mov_b32 v47, 0x44004400
    v_mul_u32_u24 v46, 48, v17
    v_cndmask_b32 v216, 0, v44, vcc
    v_cndmask_b32 v218, 0, v44, vcc
    v_cmp_le_u32 vcc, 2, v19
    v_lshl_add_u32 v46, v19, 2, v46
    v_mul_u32_u24 v27, 48, v96
    v_cndmask_b32 v217, 0, v44, vcc
    v_cndmask_b32 v219, 0, v44, vcc
    v_cmp_eq_u32 vcc, 0, v19
    v_add_u32 v182, 0, v46
    v_mul_u32_u24 v44, 37, v182
    v_cndmask_b32 v212, 0, v47, vcc
    v_cmp_eq_u32 vcc, 1, v19
    v_lshrrev_b32 v44, 10, v44
    v_mad_u32_u24 v182, v44, 24, v182
    v_cndmask_b32 v213, 0, v47, vcc
    v_cmp_eq_u32 vcc, 2, v19
    v_add_u32 v182, s101, v182
    v_add_u32 v187, 16, v46
    v_cndmask_b32 v214, 0, v47, vcc
    v_cmp_eq_u32 vcc, 3, v19
    v_mul_u32_u24 v44, 37, v187
    v_lshrrev_b32 v44, 10, v44
    v_cndmask_b32 v215, 0, v47, vcc
    v_mad_u32_u24 v187, v44, 24, v187
    v_add_u32 v187, s101, v187
    v_add_u32 v8, 32, v46
    v_mul_u32_u24 v10, 37, v8
    v_lshrrev_b32 v10, 10, v10
    v_mad_u32_u24 v8, v10, 24, v8
    v_add_u32 v8, s101, v8
    v_add_u32 v180, 0, v27
    v_mul_u32_u24 v10, 37, v180
    v_lshrrev_b32 v10, 10, v10
    v_mad_u32_u24 v180, v10, 24, v180
    v_add_u32 v181, 4, v27
    v_mul_u32_u24 v183, 37, v181
    v_lshrrev_b32 v183, 10, v183
    v_mad_u32_u24 v181, v183, 24, v181
    v_add_u32 v139, 8, v27
    v_mul_u32_u24 v183, 37, v139
    v_lshrrev_b32 v183, 10, v183
    v_mad_u32_u24 v139, v183, 24, v139
    v_add_u32 v183, 12, v27
    v_mul_u32_u24 v10, 37, v183
    v_lshrrev_b32 v10, 10, v10
    v_mad_u32_u24 v183, v10, 24, v183
    v_add_u32 v138, 16, v27
    v_mul_u32_u24 v10, 37, v138
    v_lshrrev_b32 v10, 10, v10
    v_mad_u32_u24 v138, v10, 24, v138
    v_add_u32 v121, 20, v27
    v_mul_u32_u24 v120, 37, v121
    v_lshrrev_b32 v120, 10, v120
    v_mad_u32_u24 v121, v120, 24, v121
    v_add_u32 v120, 24, v27
    v_mul_u32_u24 v10, 37, v120
    v_lshrrev_b32 v10, 10, v10
    v_mad_u32_u24 v120, v10, 24, v120
    v_add_u32 v73, 28, v27
    v_mul_u32_u24 v10, 37, v73
    v_lshrrev_b32 v10, 10, v10
    v_mad_u32_u24 v73, v10, 24, v73
    v_add_u32 v47, 32, v27
    v_mul_u32_u24 v44, 37, v47
    v_lshrrev_b32 v44, 10, v44
    v_mad_u32_u24 v47, v44, 24, v47
    v_add_u32 v72, 36, v27
    v_mul_u32_u24 v44, 37, v72
    v_lshrrev_b32 v44, 10, v44
    v_mad_u32_u24 v72, v44, 24, v72
    v_add_u32 v44, 40, v27
    v_mul_u32_u24 v10, 37, v44
    v_lshrrev_b32 v10, 10, v10
    v_mad_u32_u24 v44, v10, 24, v44
    v_add_u32 v11, 44, v27
    s_lshr_b64 s[82:83], s[82:83], s84
    s_lshl_b32 s82, s82, 16
    buffer_load_dwordx4 v18, s[32:35], s92 offen offset:2048 lds
    s_add_u32 m0, s90, 12288
    s_mov_b32 s92, 36864
    v_mul_u32_u24 v10, 37, v11
    v_lshrrev_b32 v10, 10, v10
    v_mad_u32_u24 v11, v10, 24, v11
    v_lshl_add_u32 v10, v96, 4, v46
    v_mul_u32_u24 v27, 37, v10
    s_mov_b32 s84, 0x41b8aa3b
    s_mov_b32 s46, 20480
    buffer_load_dwordx4 v93, s[32:35], s92 offen offset:0 lds
    v_lshrrev_b32 v27, 10, v27
    v_mad_u32_u24 v10, v27, 24, v10
    v_mov_b32 v74, 336
    v_cmp_gt_u32 vcc, 3, v96
    v_mov_b32 v27, s82
    v_min_f32 v27, 0x40930000, v27
    v_cndmask_b32 v10, v74, v10, vcc
    v_sub_u32 v10, s101, v10
    v_max_f32 v27, 0xc2c80000, v27
    v_mul_f32 v27, 0x3fb8aa3b, v27
    v_exp_f32 v27, v27
    s_waitcnt vmcnt(16)
    v_lshl_or_b32 v12, v13, 16, v12
    v_cvt_pk_bf16_f32 v27, v27, v27
    v_lshlrev_b32 v27, 16, v27
    s_mov_b32 s47, 0
    s_mov_b32 s57, s72
    buffer_load_dwordx4 v45, s[32:35], s92 offen offset:1024 lds
    v_mul_f32 v27, 0x4038aa3b, v27
    s_waitcnt vmcnt(15)
    v_lshl_or_b32 v122, v15, 16, v122
    v_readfirstlane_b32 s55, v27
    v_add_f32 v27, v27, v27
    s_waitcnt vmcnt(13)
    v_lshl_or_b32 v123, v14, 16, v123
    v_readfirstlane_b32 s52, v27
    v_cmp_gt_u32 vcc, 16, v9
    v_mov_b32 v13, 0
    v_mov_b32 v14, 0
    v_cndmask_b32 v15, 0, v12, vcc
    v_cndmask_b32 v12, 0, v12, vcc
    v_mov_b32 v27, 0
    v_mfma_f32_16x16x16_bf16 v[0:3], v[14:15], v[24:25], 0
    s_mov_b32 s58, 0
    v_mul_u32_u24 v74, 5120, v96
    v_add_u32 v74, v16, v74
    v_mfma_f32_16x16x16_bf16 v[4:7], v[12:13], v[24:25], 0
    s_mov_b32 s59, 0
    v_mov_b32 v75, 0xc138aa3b
    v_lshrrev_b32 v97, 1, v96
    v_mfma_f32_16x16x16_bf16 v[20:23], v[12:13], v[26:27], 0
    s_mov_b32 s60, 0
    v_max_f32 v0, 0, v0
    v_max_f32 v1, 0, v1
    v_max_f32 v2, 0, v2
    v_max_f32 v4, 0, v4
    v_max_f32 v5, 0, v5
    v_max_f32 v6, 0, v6
    v_max_f32 v7, 0, v7
    v_cvt_pk_bf16_f32 v4, v4, v5
    v_cvt_pk_bf16_f32 v5, v6, v7
    v_max_f32 v3, 0, v3
    v_cvt_pk_bf16_f32 v0, v0, v1
    v_mfma_f32_16x16x16_bf16 v[12:15], v[122:123], v[4:5], 0
    s_mov_b32 s65, -1
    v_cvt_pk_bf16_f32 v1, v2, v3
    v_max_f32 v20, 0, v20
    v_max_f32 v21, 0, v21
    v_mfma_f32_16x16x16_bf16 v[4:7], v[122:123], v[0:1], 0
    s_mov_b32 s61, 1
    v_max_f32 v22, 0, v22
    v_max_f32 v23, 0, v23
    v_cvt_pk_bf16_f32 v20, v20, v21
    v_cvt_pk_bf16_f32 v21, v22, v23
    v_cvt_pk_bf16_f32 v12, v12, v12
    v_lshlrev_b32 v12, 16, v12
    v_mfma_f32_16x16x16_bf16 v[0:3], v[122:123], v[20:21], 0
    s_movk_i32 s4, 112
    v_mul_f32 v12, 0xbfb8aa3b, v12
    v_cvt_pk_bf16_f32 v4, v4, v4
    v_exp_f32 v12, v12
    v_lshlrev_b32 v4, 16, v4
    v_add_f32 v12, 1.0, v12
    v_rcp_f32 v12, v12
    v_mul_f32 v4, 0xbfb8aa3b, v4
    v_cvt_pk_bf16_f32 v12, v12, v12
    v_lshlrev_b32 v12, 16, v12
    v_fma_f32 v12, v12, s84, v75
    s_mov_b32 s5, 0
    s_mov_b32 s6, 0
    ds_write_b32 v74, v12 offset:44032
    v_exp_f32 v4, v4
    v_cvt_pk_bf16_f32 v0, v0, v0
    v_add_f32 v4, 1.0, v4
    v_rcp_f32 v4, v4
    v_lshlrev_b32 v0, 16, v0
    v_cvt_pk_bf16_f32 v4, v4, v4
    v_lshlrev_b32 v4, 16, v4
    v_fma_f32 v4, v4, s84, v75
    s_mov_b32 s12, 0
    s_mov_b32 s64, 3
    ds_write_b32 v74, v4 offset:44036
    v_mul_f32 v0, 0xbfb8aa3b, v0
    v_exp_f32 v0, v0
    v_lshl_add_u32 v16, v96, 2, v17
    v_add_f32 v0, 1.0, v0
    v_rcp_f32 v0, v0
    v_lshl_add_u32 v16, v97, 3, v16
    v_cvt_pk_bf16_f32 v0, v0, v0
    v_lshlrev_b32 v0, 16, v0
    v_fma_f32 v0, v0, s84, v75
    s_mov_b32 s10, 81924
    s_mov_b32 s11, 0x20000
    ds_write_b32 v74, v0 offset:44040
    v_mul_u32_u24 v16, 96, v16
    v_add_u32 v16, s90, v16
    v_lshl_add_u32 v75, v19, 4, v16
    v_lshl_add_u32 v74, v19, 3, v16
    v_mul_u32_u24 v16, 5120, v17
    v_mad_u32_u24 v16, v19, s86, v16
    v_and_b32 v123, 7, v98
    v_xor_b32 v122, v123, v96
    v_lshl_add_u32 v99, v122, 4, v16
    v_xor_b32 v97, 64, v99
    v_add_u32 v137, 40960, v99
    v_xor_b32 v136, 64, v137
    v_add_u32 v16, 61440, v16
    v_add_u32 v122, s93, v96
    v_xor_b32 v122, v123, v122
    v_lshl_add_u32 v135, v122, 4, v16
    v_lshrrev_b32 v122, 1, v96
    v_add3_u32 v122, v122, s93, 4
    v_xor_b32 v122, v123, v122
    v_lshl_add_u32 v122, v122, 4, v16
    v_and_b32 v16, 1, v96
    v_lshl_add_u32 v134, v16, 3, v122
    v_lshlrev_b32 v16, 4, v9
    s_add_u32 s93, s54, 20480
    v_add_u32 v133, s93, v16
    v_add_u32 v129, 81920, v16
    s_lshr_b32 s93, s68, 1
    s_lshl_b32 s93, s93, 10
    s_add_u32 s93, s93, s94
    v_add_u32 v130, s93, v129
    s_mul_i32 s93, s68, 7168
    s_add_u32 s93, s93, 135168
    v_mul_u32_u24 v16, 1792, v96
    s_waitcnt lgkmcnt(0)
    s_barrier
    v_add_u32 v122, s93, v16
    v_mul_u32_u24 v16, 112, v98
    v_add_u32 v98, v16, v122
    v_subrev_u32 v98, 28672, v98
    v_cmp_eq_u32 vcc, 0, v17
    v_add_u32 v16, 16, v122
    v_mov_b32 v123, 0
    v_cndmask_b32 v132, v131, v122, vcc
    v_cmp_eq_u32 vcc, 3, v19
    v_mov_b32 v122, 0
    s_mov_b32 s3, 0x00010001
    v_cndmask_b32 v132, v132, v16, vcc
    v_mul_u32_u24 v16, 1792, v17
    v_lshl_add_u32 v16, v96, 3, v16
    v_lshl_add_u32 v16, v19, 1, v16
    v_add_u32 v16, s93, v16
    v_cmp_gt_u32 vcc, 3, v96
    s_add_u32 s93, s69, 1
    s_mul_i32 s94, s93, 58255
    ds_read_b32 v209, v187
    v_cndmask_b32 v131, v131, v16, vcc
    s_lshr_b32 s94, s94, 22
    s_mul_i32 s94, s94, s63
    s_mul_i32 s56, s93, s62
    buffer_load_dwordx4 v18, s[32:35], s92 offen offset:2048 lds
    s_add_u32 m0, s90, 24576
    s_mov_b32 s92, 73728
    s_add_u32 s56, s56, s94
    s_sub_u32 s93, s71, 1
    s_cmp_eq_u32 s68, 0
    s_cselect_b32 s13, s93, -1
    s_cmp_gt_u32 s73, 20
    s_cselect_b32 s13, s13, -1
    s_and_b32 s93, s2, -8
    s_sub_u32 s93, 81920, s93
    s_sub_u32 s8, s38, s93
    s_subb_u32 s9, s39, 0
    ds_read_b32 v208, v182
    v_sub_u32 v192, v187, v180
    v_sub_u32 v193, v187, v181
    v_sub_u32 v194, v187, v139
    v_sub_u32 v195, v187, v183
    v_sub_u32 v188, v187, v138
    s_mov_b32 s30, 100270464
    ds_read_b32 v192, v192 offset:336
    v_sub_u32 v189, v187, v121
    v_sub_u32 v190, v187, v120
    buffer_load_dwordx4 v93, s[32:35], s92 offen offset:0 lds
    ds_read_b32 v193, v193 offset:336
    v_sub_u32 v191, v187, v73
    v_sub_u32 v184, v187, v47
    v_sub_u32 v185, v187, v72
    v_sub_u32 v186, v187, v44
    v_sub_u32 v187, v187, v11
    ds_read_b32 v194, v194 offset:336
    buffer_load_dwordx4 v45, s[32:35], s92 offen offset:1024 lds
    v_sub_u32 v204, v182, v180
    v_sub_u32 v205, v182, v181
    v_sub_u32 v206, v182, v139
    v_sub_u32 v207, v182, v183
    ds_read_b32 v195, v195 offset:336
    v_sub_u32 v200, v182, v138
    v_sub_u32 v201, v182, v121
    v_sub_u32 v202, v182, v120
    v_sub_u32 v203, v182, v73
    v_sub_u32 v196, v182, v47
    ds_read_b32 v188, v188 offset:336
    v_sub_u32 v197, v182, v72
    v_sub_u32 v198, v182, v44
    v_sub_u32 v199, v182, v11
    v_sub_u32 v180, v8, v180
    v_sub_u32 v181, v8, v181
    ds_read_b32 v189, v189 offset:336
    buffer_load_dwordx4 v18, s[32:35], s92 offen offset:2048 lds
    s_add_u32 m0, s90, 36864
    s_mov_b32 s92, 110592
    v_sub_u32 v182, v8, v139
    v_sub_u32 v183, v8, v183
    ds_read_b32 v190, v190 offset:336
    v_sub_u32 v176, v8, v138
    v_sub_u32 v177, v8, v121
    v_sub_u32 v178, v8, v120
    v_sub_u32 v179, v8, v73
    s_mov_b64 exec, 0
    s_cmp_eq_u32 s68, 2
    s_cbranch_scc1 L_pga
    s_cmp_eq_u32 s68, 3
    s_cbranch_scc1 L_pg2
    s_cmp_eq_u32 s68, 1
    s_cbranch_scc1 L_pg1
    s_branch L_pg0
L_prod:
    v_mbcnt_lo_u32_b32 v1, -1, 0
    v_mbcnt_hi_u32_b32 v1, -1, v1
    v_and_b32 v2, 15, v1
    v_lshrrev_b32 v3, 4, v1
    v_lshrrev_b32 v4, 2, v2
    v_and_b32 v5, 3, v2
    v_lshl_add_u32 v6, v4, 3, v5
    v_mul_u32_u24 v6, 384, v6
    s_lshr_b32 s85, s68, 1
    s_lshl1_add_u32 s84, s84, s85
    s_mul_i32 s85, s84, 12288
    v_add_u32 v6, s85, v6
    v_lshl_add_u32 v7, v3, 4, v6
    v_lshl_add_u32 v8, v3, 3, v6
    s_and_b32 s85, s68, 1
    s_mul_i32 s86, s85, 192
    s_sub_u32 s87, 192, s86
    s_mul_i32 s85, s85, 36
    s_add_u32 s85, s85, s84
    s_lshl_b32 s85, s85, 10
    v_lshl_add_u32 v18, v1, 4, s85
    v_mov_b32 v10, 0
    s_waitcnt lgkmcnt(0)
    s_mov_b32 s10, 73728
    s_mov_b32 s11, 0x20000
    s_mov_b32 s78, 73728
    s_mov_b32 s79, 0x20000
    buffer_load_dwordx4 v[20:23], v7, s[8:11], s86 offen offset:0
    buffer_load_dwordx2 v[36:37], v8, s[8:11], s86 offen offset:64
    buffer_load_dwordx4 v[24:27], v7, s[8:11], s86 offen offset:96
    buffer_load_dwordx2 v[38:39], v8, s[8:11], s86 offen offset:160
    buffer_load_dwordx4 v[28:31], v7, s[8:11], s87 offen offset:0
    buffer_load_dwordx2 v[40:41], v8, s[8:11], s87 offen offset:64
    buffer_load_dwordx4 v[32:35], v7, s[8:11], s87 offen offset:96
    buffer_load_dwordx2 v[42:43], v8, s[8:11], s87 offen offset:160
    buffer_load_dwordx4 v[44:47], v7, s[8:11], s86 offen offset:1536
    buffer_load_dwordx2 v[60:61], v8, s[8:11], s86 offen offset:1600
    buffer_load_dwordx4 v[48:51], v7, s[8:11], s86 offen offset:1632
    buffer_load_dwordx2 v[62:63], v8, s[8:11], s86 offen offset:1696
    buffer_load_dwordx4 v[52:55], v7, s[8:11], s87 offen offset:1536
    buffer_load_dwordx2 v[64:65], v8, s[8:11], s87 offen offset:1600
    buffer_load_dwordx4 v[56:59], v7, s[8:11], s87 offen offset:1632
    buffer_load_dwordx2 v[66:67], v8, s[8:11], s87 offen offset:1696
    s_add_u32 s88, s76, 0x18000
    s_addc_u32 s89, s77, 0
    global_load_dword v9, v10, s[88:89]
    global_load_dword v19, v10, s[38:39] offset:248 sc1
    v_mov_b32 v12, 0x3f803f80
    v_mov_b32 v13, 0x3f803f80
    v_mov_b32 v14, 0x3f803f80
    v_mov_b32 v15, 0x3f803f80
    v_and_b32 v10, 1, v1
    v_lshlrev_b32 v10, 4, v10
    v_mov_b32 v11, 0x3f80
    v_lshlrev_b32 v10, v10, v11
    v_cmp_eq_u32 vcc, v3, v4
    s_nop 1
    v_cndmask_b32 v10, 0, v10, vcc
    v_cmp_gt_u32 vcc, 2, v5
    s_nop 1
    v_cndmask_b32 v16, 0, v10, vcc
    v_cmp_le_u32 vcc, 2, v5
    s_nop 1
    v_cndmask_b32 v17, 0, v10, vcc
    s_waitcnt vmcnt(2)
    v_mfma_f32_16x16x32_bf16 v[68:71], v[20:23], v[12:15], 0
    v_mfma_f32_16x16x32_bf16 v[68:71], v[24:27], v[12:15], v[68:71]
    v_mfma_f32_16x16x32_bf16 v[68:71], v[28:31], v[12:15], v[68:71]
    v_mfma_f32_16x16x32_bf16 v[68:71], v[32:35], v[12:15], v[68:71]
    v_mfma_f32_16x16x32_bf16 v[68:71], v[36:39], v[12:15], v[68:71]
    v_mfma_f32_16x16x32_bf16 v[68:71], v[40:43], v[12:15], v[68:71]
    v_mfma_f32_16x16x32_bf16 v[72:75], v[44:47], v[12:15], 0
    v_mfma_f32_16x16x32_bf16 v[72:75], v[48:51], v[12:15], v[72:75]
    v_mfma_f32_16x16x32_bf16 v[72:75], v[52:55], v[12:15], v[72:75]
    v_mfma_f32_16x16x32_bf16 v[72:75], v[56:59], v[12:15], v[72:75]
    v_mfma_f32_16x16x32_bf16 v[72:75], v[60:63], v[12:15], v[72:75]
    v_mfma_f32_16x16x32_bf16 v[72:75], v[64:67], v[12:15], v[72:75]
    s_nop 1
    v_mul_f32 v68, 0xbbaaaaab, v68
    v_mul_f32 v69, 0xbbaaaaab, v69
    v_mul_f32 v70, 0xbbaaaaab, v70
    v_mul_f32 v71, 0xbbaaaaab, v71
    s_nop 1
    v_mfma_f32_16x16x16_bf16 v[76:79], v[20:21], v[16:17], v[68:71]
    v_mfma_f32_16x16x16_bf16 v[80:83], v[22:23], v[16:17], v[68:71]
    v_mfma_f32_16x16x16_bf16 v[84:87], v[36:37], v[16:17], v[68:71]
    v_mfma_f32_16x16x16_bf16 v[88:91], v[24:25], v[16:17], v[68:71]
    v_mfma_f32_16x16x16_bf16 v[92:95], v[26:27], v[16:17], v[68:71]
    v_mfma_f32_16x16x16_bf16 v[96:99], v[38:39], v[16:17], v[68:71]
    v_mul_f32 v72, 0xbbaaaaab, v72
    v_mul_f32 v73, 0xbbaaaaab, v73
    v_mul_f32 v74, 0xbbaaaaab, v74
    v_mul_f32 v75, 0xbbaaaaab, v75
    s_nop 1
    v_mfma_f32_16x16x16_bf16 v[100:103], v[44:45], v[16:17], v[72:75]
    v_mfma_f32_16x16x16_bf16 v[104:107], v[46:47], v[16:17], v[72:75]
    v_mfma_f32_16x16x16_bf16 v[108:111], v[60:61], v[16:17], v[72:75]
    v_mfma_f32_16x16x16_bf16 v[112:115], v[48:49], v[16:17], v[72:75]
    v_mfma_f32_16x16x16_bf16 v[116:119], v[50:51], v[16:17], v[72:75]
    v_mfma_f32_16x16x16_bf16 v[120:123], v[62:63], v[16:17], v[72:75]
    v_cvt_pk_bf16_f32 v124, v76, v77
    v_cvt_pk_bf16_f32 v125, v78, v79
    s_nop 0
    v_cvt_pk_bf16_f32 v126, v100, v101
    v_cvt_pk_bf16_f32 v127, v102, v103
    s_movk_i32 s85, 0
    buffer_store_dwordx4 v[124:127], v18, s[76:79], s85 offen sc1
    v_cvt_pk_bf16_f32 v128, v80, v81
    v_cvt_pk_bf16_f32 v129, v82, v83
    v_cvt_pk_bf16_f32 v130, v104, v105
    v_cvt_pk_bf16_f32 v131, v106, v107
    s_movk_i32 s85, 6144
    buffer_store_dwordx4 v[128:131], v18, s[76:79], s85 offen sc1
    v_cvt_pk_bf16_f32 v132, v84, v85
    v_cvt_pk_bf16_f32 v133, v86, v87
    v_cvt_pk_bf16_f32 v134, v108, v109
    v_cvt_pk_bf16_f32 v135, v110, v111
    s_movk_i32 s85, 12288
    buffer_store_dwordx4 v[132:135], v18, s[76:79], s85 offen sc1
    v_cvt_pk_bf16_f32 v136, v88, v89
    v_cvt_pk_bf16_f32 v137, v90, v91
    v_cvt_pk_bf16_f32 v138, v112, v113
    v_cvt_pk_bf16_f32 v139, v114, v115
    s_movk_i32 s85, 18432
    buffer_store_dwordx4 v[136:139], v18, s[76:79], s85 offen sc1
    v_cvt_pk_bf16_f32 v140, v92, v93
    v_cvt_pk_bf16_f32 v141, v94, v95
    v_cvt_pk_bf16_f32 v142, v116, v117
    v_cvt_pk_bf16_f32 v143, v118, v119
    s_movk_i32 s85, 24576
    buffer_store_dwordx4 v[140:143], v18, s[76:79], s85 offen sc1
    v_cvt_pk_bf16_f32 v144, v96, v97
    v_cvt_pk_bf16_f32 v145, v98, v99
    v_cvt_pk_bf16_f32 v146, v120, v121
    v_cvt_pk_bf16_f32 v147, v122, v123
    s_movk_i32 s85, 30720
    buffer_store_dwordx4 v[144:147], v18, s[76:79], s85 offen sc1
    v_mov_b32 v10, 0
    v_mov_b32 v11, 1
    s_mov_b32 s64, 8
    s_waitcnt vmcnt(0)
    s_barrier
    s_cmp_lg_u32 s68, 0
    s_cbranch_scc1 L_top2
    s_mov_b64 exec, 1
    global_atomic_add v10, v11, s[38:39] offset:248 sc1
    s_mov_b64 exec, -1
    s_branch L_top2
.p2align 12
L_main:
    s_mov_b64 exec, -1
    s_waitcnt vmcnt(9)
    s_barrier
    ds_read_b32 v191, v191 offset:336
    v_sub_u32 v172, v8, v47
    v_sub_u32 v173, v8, v72
    v_sub_u32 v174, v8, v44
    v_sub_u32 v175, v8, v11
    ds_read_b32 v184, v184 offset:336
    ds_read_b32 v185, v185 offset:336
    buffer_load_dwordx4 v93, s[32:35], s92 offen offset:0 lds
    ds_read_b32 v186, v186 offset:336
    ds_read_b32 v187, v187 offset:336
    ds_read_b128 v[76:79], v97 offset:40960
    ds_read_b128 v[60:63], v97 offset:42496
    buffer_load_dwordx4 v45, s[32:35], s92 offen offset:1024 lds
    ds_read_b128 v[40:43], v97 offset:0
    ds_read_b128 v[12:15], v97 offset:1536
    ds_read_b128 v[68:71], v97 offset:3072
    ds_read_b128 v[20:23], v99 offset:40960
    ds_read_b128 v[0:3], v99 offset:42496
    buffer_load_dwordx4 v18, s[32:35], s92 offen offset:2048 lds
    s_add_u32 m0, s90, 49152
    s_mov_b32 s92, 147456
    s_waitcnt vmcnt(9)
    ds_read_b64_tr_b16 a[0:1], v74 offset:0
    ds_read_b64_tr_b16 a[2:3], v74 offset:768
    ds_read_b64_tr_b16 a[24:25], v74 offset:32
    ds_read_b64_tr_b16 a[26:27], v74 offset:800
    ds_read_b64_tr_b16 a[48:49], v74 offset:64
    ds_read_b64_tr_b16 a[50:51], v74 offset:832
    ds_read_b128 v[52:55], v99 offset:0
    ds_read_b32 v204, v204 offset:336
    buffer_load_dwordx4 v93, s[32:35], s92 offen offset:0 lds
    ds_read_b32 v205, v205 offset:336
    ds_read_b32 v206, v206 offset:336
    ds_read_b32 v207, v207 offset:336
    s_waitcnt lgkmcnt(8)
    v_mfma_f32_16x16x32_bf16 v[56:59], a[0:3], v[20:23], 0
    s_waitcnt lgkmcnt(7)
    buffer_load_dwordx4 v45, s[32:35], s92 offen offset:1024 lds
    ds_read_b32 v200, v200 offset:336
    v_mfma_f32_16x16x32_bf16 v[48:51], a[24:27], v[20:23], 0
    s_waitcnt lgkmcnt(6)
    v_mfma_f32_16x16x32_bf16 v[4:7], a[48:51], v[20:23], 0
    ds_read_b32 v201, v201 offset:336
    v_mfma_f32_16x16x32_bf16 v[20:23], a[0:3], v[0:3], 0
    v_mfma_f32_16x16x32_bf16 v[64:67], a[24:27], v[0:3], 0
    ds_read_b128 v[24:27], v99 offset:1536
    v_mfma_f32_16x16x32_bf16 v[36:39], a[48:51], v[0:3], 0
    s_waitcnt vmcnt(8) lgkmcnt(5)
    buffer_load_dwordx4 v18, s[32:35], s92 offen offset:2048 lds
    ds_read_b64_tr_b16 a[4:5], v74 offset:12288
    v_mfma_f32_16x16x32_bf16 v[28:31], a[0:3], v[52:55], 0
    s_add_u32 m0, s90, 61440
    ds_read_b64_tr_b16 a[6:7], v74 offset:13056
    v_mfma_f32_16x16x32_bf16 v[112:115], a[24:27], v[52:55], 0
    s_mov_b32 s92, 184320
    ds_read_b64_tr_b16 a[28:29], v74 offset:12320
    v_mfma_f32_16x16x32_bf16 v[0:3], a[48:51], v[52:55], 0
    ds_read_b64_tr_b16 a[30:31], v74 offset:13088
    ds_read_b64_tr_b16 a[52:53], v74 offset:12352
    ds_read_b64_tr_b16 a[54:55], v74 offset:13120
    buffer_load_dwordx4 v93, s[32:35], s92 offen offset:0 lds
    ds_read_b32 v202, v202 offset:336
    ds_read_b32 v203, v203 offset:336
    s_waitcnt lgkmcnt(8)
    v_mfma_f32_16x16x32_bf16 v[52:55], a[0:3], v[24:27], 0
    ds_read_b128 v[84:87], v99 offset:3072
    v_mfma_f32_16x16x32_bf16 v[80:83], a[24:27], v[24:27], 0
    s_waitcnt lgkmcnt(7)
    ds_read_b32 v196, v196 offset:336
    buffer_load_dwordx4 v45, s[32:35], s92 offen offset:1024 lds
    v_mfma_f32_16x16x32_bf16 v[56:59], a[4:7], v[76:79], v[56:59]
    v_mfma_f32_16x16x32_bf16 v[20:23], a[4:7], v[60:63], v[20:23]
    s_waitcnt lgkmcnt(6)
    ds_read_b32 v197, v197 offset:336
    v_mfma_f32_16x16x32_bf16 v[48:51], a[28:31], v[76:79], v[48:51]
    s_waitcnt lgkmcnt(5)
    v_mfma_f32_16x16x32_bf16 v[4:7], a[52:55], v[76:79], v[4:7]
    ds_read_b32 v198, v198 offset:336
    v_mfma_f32_16x16x32_bf16 v[64:67], a[28:31], v[60:63], v[64:67]
    buffer_load_dwordx4 v18, s[32:35], s92 offen offset:2048 lds
    v_mfma_f32_16x16x32_bf16 v[36:39], a[52:55], v[60:63], v[36:39]
    s_waitcnt vmcnt(9)
    s_add_u32 m0, s90, 0
    ds_read_b64_tr_b16 a[8:9], v74 offset:24576
    v_mfma_f32_16x16x32_bf16 v[28:31], a[4:7], v[40:43], v[28:31]
    s_mov_b32 s92, 384
    ds_read_b64_tr_b16 a[10:11], v74 offset:25344
    v_mfma_f32_16x16x32_bf16 v[112:115], a[28:31], v[40:43], v[112:115]
    ds_read_b64_tr_b16 a[32:33], v74 offset:24608
    v_mfma_f32_16x16x32_bf16 v[0:3], a[52:55], v[40:43], v[0:3]
    ds_read_b64_tr_b16 a[34:35], v74 offset:25376
    v_mfma_f32_16x16x32_bf16 v[52:55], a[4:7], v[12:15], v[52:55]
    ds_read_b64_tr_b16 a[56:57], v74 offset:24640
    buffer_load_dwordx4 v93, s[32:35], s92 offen offset:0 lds
    v_mfma_f32_16x16x32_bf16 v[80:83], a[28:31], v[12:15], v[80:83]
    ds_read_b64_tr_b16 a[58:59], v74 offset:25408
    v_mfma_f32_16x16x32_bf16 v[116:119], a[48:51], v[24:27], 0
    ds_read_b128 v[40:43], v99 offset:41088
    v_mfma_f32_16x16x32_bf16 v[116:119], a[52:55], v[12:15], v[116:119]
    s_waitcnt lgkmcnt(7)
    ds_read_b128 v[12:15], v99 offset:42624
    v_mfma_f32_16x16x32_bf16 v[76:79], a[0:3], v[84:87], 0
    ds_read_b128 v[24:27], v99 offset:128
    v_mfma_f32_16x16x32_bf16 v[76:79], a[4:7], v[68:71], v[76:79]
    ds_read_b128 v[88:91], v99 offset:1664
    buffer_load_dwordx4 v45, s[32:35], s92 offen offset:1024 lds
    v_mfma_f32_16x16x32_bf16 v[60:63], a[24:27], v[84:87], 0
    ds_read_b32 v199, v199 offset:336
    v_mfma_f32_16x16x32_bf16 v[60:63], a[28:31], v[68:71], v[60:63]
    v_mfma_f32_16x16x32_bf16 v[140:143], a[48:51], v[84:87], 0
    ds_read_b128 v[84:87], v99 offset:3200
    v_mfma_f32_16x16x32_bf16 v[140:143], a[52:55], v[68:71], v[140:143]
    s_waitcnt lgkmcnt(5)
    ds_read_b32 v211, v10 offset:672
    buffer_load_dwordx4 v18, s[32:35], s92 offen offset:2048 lds
    s_add_u32 m0, s90, 12288
    v_mfma_f32_16x16x32_bf16 v[56:59], a[8:11], v[40:43], v[56:59]
    s_waitcnt vmcnt(9)
    s_mov_b32 s92, 37248
    ds_read_b64_tr_b16 a[12:13], v74 offset:36864
    v_mfma_f32_16x16x32_bf16 v[48:51], a[32:35], v[40:43], v[48:51]
    ds_read_b64_tr_b16 a[14:15], v74 offset:37632
    v_mfma_f32_16x16x32_bf16 v[4:7], a[56:59], v[40:43], v[4:7]
    s_waitcnt lgkmcnt(5)
    ds_read_b64_tr_b16 a[36:37], v74 offset:36896
    v_mfma_f32_16x16x32_bf16 v[20:23], a[8:11], v[12:15], v[20:23]
    ds_read_b64_tr_b16 a[38:39], v74 offset:37664
    v_mfma_f32_16x16x32_bf16 v[64:67], a[32:35], v[12:15], v[64:67]
    buffer_load_dwordx4 v93, s[32:35], s92 offen offset:0 lds
    ds_read_b64_tr_b16 a[60:61], v74 offset:36928
    v_mfma_f32_16x16x32_bf16 v[36:39], a[56:59], v[12:15], v[36:39]
    ds_read_b64_tr_b16 a[62:63], v74 offset:37696
    v_mfma_f32_16x16x32_bf16 v[28:31], a[8:11], v[24:27], v[28:31]
    ds_read_b128 v[68:71], v97 offset:41088
    v_mfma_f32_16x16x32_bf16 v[112:115], a[32:35], v[24:27], v[112:115]
    ds_read_b128 v[12:15], v97 offset:42624
    v_mfma_f32_16x16x32_bf16 v[0:3], a[56:59], v[24:27], v[0:3]
    ds_read_b128 v[40:43], v97 offset:128
    v_mfma_f32_16x16x32_bf16 v[52:55], a[8:11], v[88:91], v[52:55]
    buffer_load_dwordx4 v45, s[32:35], s92 offen offset:1024 lds
    ds_read_b128 v[24:27], v97 offset:1664
    v_mfma_f32_16x16x32_bf16 v[80:83], a[32:35], v[88:91], v[80:83]
    ds_read_b32 v180, v180 offset:336
    v_mfma_f32_16x16x32_bf16 v[116:119], a[56:59], v[88:91], v[116:119]
    s_waitcnt lgkmcnt(8)
    v_mfma_f32_16x16x32_bf16 v[76:79], a[8:11], v[84:87], v[76:79]
    ds_read_b128 v[108:111], v97 offset:3200
    v_mfma_f32_16x16x32_bf16 v[60:63], a[32:35], v[84:87], v[60:63]
    ds_read_b32 v181, v181 offset:336
    v_mfma_f32_16x16x32_bf16 v[140:143], a[56:59], v[84:87], v[140:143]
    s_waitcnt vmcnt(8) lgkmcnt(6)
    buffer_load_dwordx4 v18, s[32:35], s92 offen offset:2048 lds
    ds_read_b64_tr_b16 a[16:17], v74 offset:49152
    v_mfma_f32_16x16x32_bf16 v[56:59], a[12:15], v[68:71], v[56:59]
    s_add_u32 m0, s90, 24576
    ds_read_b64_tr_b16 a[18:19], v74 offset:49920
    v_mfma_f32_16x16x32_bf16 v[48:51], a[36:39], v[68:71], v[48:51]
    s_mov_b32 s92, 74112
    ds_read_b64_tr_b16 a[40:41], v74 offset:49184
    v_mfma_f32_16x16x32_bf16 v[4:7], a[60:63], v[68:71], v[4:7]
    s_waitcnt lgkmcnt(7)
    ds_read_b64_tr_b16 a[42:43], v74 offset:49952
    v_mfma_f32_16x16x32_bf16 v[20:23], a[12:15], v[12:15], v[20:23]
    ds_read_b64_tr_b16 a[64:65], v74 offset:49216
    v_mfma_f32_16x16x32_bf16 v[64:67], a[36:39], v[12:15], v[64:67]
    buffer_load_dwordx4 v93, s[32:35], s92 offen offset:0 lds
    ds_read_b64_tr_b16 a[66:67], v74 offset:49984
    v_mfma_f32_16x16x32_bf16 v[36:39], a[60:63], v[12:15], v[36:39]
    ds_read_b128 v[68:71], v97 offset:41216
    v_mfma_f32_16x16x32_bf16 v[28:31], a[12:15], v[40:43], v[28:31]
    ds_read_b128 v[84:87], v97 offset:42752
    v_mfma_f32_16x16x32_bf16 v[112:115], a[36:39], v[40:43], v[112:115]
    ds_read_b128 v[12:15], v97 offset:256
    v_mfma_f32_16x16x32_bf16 v[0:3], a[60:63], v[40:43], v[0:3]
    s_waitcnt lgkmcnt(8)
    ds_read_b128 v[88:91], v97 offset:1792
    v_mfma_f32_16x16x32_bf16 v[52:55], a[12:15], v[24:27], v[52:55]
    buffer_load_dwordx4 v45, s[32:35], s92 offen offset:1024 lds
    ds_read_b128 v[40:43], v97 offset:3328
    v_mfma_f32_16x16x32_bf16 v[80:83], a[36:39], v[24:27], v[80:83]
    ds_read_b128 v[100:103], v99 offset:41216
    v_mfma_f32_16x16x32_bf16 v[116:119], a[60:63], v[24:27], v[116:119]
    ds_read_b128 v[104:107], v99 offset:42752
    v_mfma_f32_16x16x32_bf16 v[76:79], a[12:15], v[108:111], v[76:79]
    ds_read_b128 v[24:27], v99 offset:256
    v_mfma_f32_16x16x32_bf16 v[60:63], a[36:39], v[108:111], v[60:63]
    ds_read_b32 v182, v182 offset:336
    v_mfma_f32_16x16x32_bf16 v[140:143], a[60:63], v[108:111], v[140:143]
    s_waitcnt vmcnt(8)
    buffer_load_dwordx4 v18, s[32:35], s92 offen offset:2048 lds
    s_add_u32 m0, s90, 36864
    ds_read_b64_tr_b16 a[20:21], v74 offset:61440
    s_mov_b32 s92, 110976
    ds_read_b64_tr_b16 a[22:23], v74 offset:62208
    ds_read_b64_tr_b16 a[44:45], v74 offset:61472
    ds_read_b64_tr_b16 a[46:47], v74 offset:62240
    ds_read_b64_tr_b16 a[68:69], v74 offset:61504
    ds_read_b64_tr_b16 a[70:71], v74 offset:62272
    ds_read_b32 v183, v183 offset:336
    buffer_load_dwordx4 v93, s[32:35], s92 offen offset:0 lds
    s_waitcnt lgkmcnt(10)
    v_mfma_f32_16x16x32_bf16 v[56:59], a[16:19], v[100:103], v[56:59]
    ds_read_b32 v176, v176 offset:336
    v_mfma_f32_16x16x32_bf16 v[48:51], a[40:43], v[100:103], v[48:51]
    v_mfma_f32_16x16x32_bf16 v[4:7], a[64:67], v[100:103], v[4:7]
    s_waitcnt lgkmcnt(8)
    ds_read_b32 v177, v177 offset:336
    v_mfma_f32_16x16x32_bf16 v[20:23], a[16:19], v[104:107], v[20:23]
    v_mfma_f32_16x16x32_bf16 v[64:67], a[40:43], v[104:107], v[64:67]
    s_waitcnt lgkmcnt(7)
    ds_read_b128 v[100:103], v99 offset:1792
    buffer_load_dwordx4 v45, s[32:35], s92 offen offset:1024 lds
    v_mfma_f32_16x16x32_bf16 v[56:59], a[20:23], v[68:71], v[56:59]
    s_waitcnt lgkmcnt(6)
    ds_read_b32 v178, v178 offset:336
    v_mfma_f32_16x16x32_bf16 v[48:51], a[44:47], v[68:71], v[48:51]
    s_waitcnt lgkmcnt(5)
    s_nop 0
    v_mfma_f32_16x16x32_bf16 v[4:7], a[68:71], v[68:71], v[4:7]
    s_nop 0
    ds_read_b32 v179, v179 offset:336
    v_cvt_pk_f16_f32 v68, v56, v57
    v_mfma_f32_16x16x32_bf16 v[20:23], a[20:23], v[84:87], v[20:23]
    v_cvt_pk_f16_f32 v69, v58, v59
    v_pk_fma_f16 v108, v68, v68, s3
    v_mfma_f32_16x16x32_bf16 v[64:67], a[44:47], v[84:87], v[64:67]
    ds_read_b128 v[56:59], v99 offset:3328
    buffer_load_dwordx4 v18, s[32:35], s92 offen offset:2048 lds
    v_mfma_f32_16x16x32_bf16 v[36:39], a[64:67], v[104:107], v[36:39]
    s_waitcnt vmcnt(9)
    s_add_u32 m0, s90, 49152
    ds_read_b64_tr_b16 a[72:73], v74 offset:0
    v_pk_fmac_f16 v108, v69, v69
    v_mfma_f32_16x16x32_bf16 v[36:39], a[68:71], v[84:87], v[36:39]
    s_mov_b32 s92, 147840
    ds_read_b64_tr_b16 a[74:75], v74 offset:768
    v_cvt_pk_f16_f32 v70, v48, v49
    v_mfma_f32_16x16x32_bf16 v[28:31], a[16:19], v[24:27], v[28:31]
    ds_read_b64_tr_b16 a[96:97], v74 offset:32
    v_cvt_pk_f16_f32 v71, v50, v51
    v_mfma_f32_16x16x32_bf16 v[28:31], a[20:23], v[12:15], v[28:31]
    ds_read_b64_tr_b16 a[98:99], v74 offset:800
    v_pk_fmac_f16 v108, v70, v70
    v_mfma_f32_16x16x32_bf16 v[112:115], a[40:43], v[24:27], v[112:115]
    ds_read_b64_tr_b16 a[120:121], v74 offset:64
    buffer_load_dwordx4 v93, s[32:35], s92 offen offset:0 lds
    v_mfma_f32_16x16x32_bf16 v[112:115], a[44:47], v[12:15], v[112:115]
    ds_read_b64_tr_b16 a[122:123], v74 offset:832
    v_pk_fmac_f16 v108, v71, v71
    v_mfma_f32_16x16x32_bf16 v[0:3], a[64:67], v[24:27], v[0:3]
    ds_read_b128 v[48:51], v97 offset:40960
    v_cvt_pk_f16_f32 v120, v4, v5
    v_mfma_f32_16x16x32_bf16 v[0:3], a[68:71], v[12:15], v[0:3]
    s_waitcnt lgkmcnt(8)
    ds_read_b128 v[84:87], v97 offset:42496
    v_cvt_pk_f16_f32 v121, v6, v7
    v_mfma_f32_16x16x32_bf16 v[52:55], a[16:19], v[100:103], v[52:55]
    ds_read_b128 v[4:7], v97 offset:0
    v_pk_fmac_f16 v108, v120, v120
    v_mfma_f32_16x16x32_bf16 v[52:55], a[20:23], v[88:91], v[52:55]
    ds_read_b128 v[24:27], v97 offset:1536
    buffer_load_dwordx4 v45, s[32:35], s92 offen offset:1024 lds
    v_mfma_f32_16x16x32_bf16 v[80:83], a[40:43], v[100:103], v[80:83]
    ds_read_b128 v[156:159], v97 offset:3072
    v_pk_fmac_f16 v108, v121, v121
    v_mfma_f32_16x16x32_bf16 v[80:83], a[44:47], v[88:91], v[80:83]
    ds_read_b128 v[12:15], v99 offset:40960
    v_cvt_pk_f16_f32 v20, v20, v21
    v_mfma_f32_16x16x32_bf16 v[116:119], a[64:67], v[100:103], v[116:119]
    ds_read_b128 v[104:107], v99 offset:42496
    v_cvt_pk_f16_f32 v21, v22, v23
    v_mfma_f32_16x16x32_bf16 v[116:119], a[68:71], v[88:91], v[116:119]
    s_waitcnt lgkmcnt(8)
    ds_read_b32 v172, v172 offset:336
    v_pk_fma_f16 v110, v20, v20, s3
    v_mfma_f32_16x16x32_bf16 v[76:79], a[16:19], v[56:59], v[76:79]
    v_pk_fmac_f16 v110, v21, v21
    v_cvt_pk_f16_f32 v22, v64, v65
    v_mfma_f32_16x16x32_bf16 v[76:79], a[20:23], v[40:43], v[76:79]
    s_waitcnt vmcnt(8)
    buffer_load_dwordx4 v18, s[32:35], s92 offen offset:2048 lds
    ds_read_b64_tr_b16 a[76:77], v74 offset:12288
    v_mfma_f32_16x16x32_bf16 v[60:63], a[40:43], v[56:59], v[60:63]
    s_add_u32 m0, s90, 61440
    ds_read_b64_tr_b16 a[78:79], v74 offset:13056
    v_cvt_pk_f16_f32 v23, v66, v67
    v_mfma_f32_16x16x32_bf16 v[60:63], a[44:47], v[40:43], v[60:63]
    s_mov_b32 s92, 184704
    ds_read_b64_tr_b16 a[100:101], v74 offset:12320
    v_pk_fmac_f16 v110, v22, v22
    v_mfma_f32_16x16x32_bf16 v[140:143], a[64:67], v[56:59], v[140:143]
    ds_read_b64_tr_b16 a[102:103], v74 offset:13088
    v_pk_fmac_f16 v110, v23, v23
    v_mfma_f32_16x16x32_bf16 v[140:143], a[68:71], v[40:43], v[140:143]
    s_waitcnt lgkmcnt(6)
    ds_read_b64_tr_b16 a[124:125], v74 offset:12352
    buffer_load_dwordx4 v93, s[32:35], s92 offen offset:0 lds
    ds_read_b64_tr_b16 a[126:127], v74 offset:13120
    v_mfma_f32_16x16x32_bf16 v[100:103], a[72:75], v[12:15], 0
    ds_read_b128 v[56:59], v99 offset:0
    v_cvt_pk_f16_f32 v10, v36, v37
    v_mfma_f32_16x16x32_bf16 v[224:227], a[96:99], v[12:15], 0
    ds_read_b32 v173, v173 offset:336
    v_cvt_pk_f16_f32 v11, v38, v39
    v_mfma_f32_16x16x32_bf16 v[64:67], a[120:123], v[12:15], 0
    s_waitcnt lgkmcnt(8)
    v_pk_fmac_f16 v110, v10, v10
    v_pk_fmac_f16 v110, v11, v11
    v_mfma_f32_16x16x32_bf16 v[12:15], a[72:75], v[104:107], 0
    ds_read_b128 v[40:43], v99 offset:1536
    v_cvt_pk_f16_f32 v36, v28, v29
    v_mfma_f32_16x16x32_bf16 v[88:91], a[96:99], v[104:107], 0
    s_waitcnt lgkmcnt(7)
    buffer_load_dwordx4 v45, s[32:35], s92 offen offset:1024 lds
    ds_read_b32 v174, v174 offset:336
    v_mfma_f32_16x16x32_bf16 v[100:103], a[76:79], v[48:51], v[100:103]
    v_cvt_pk_f16_f32 v37, v30, v31
    v_pk_fma_f16 v92, v36, v36, s3
    v_mfma_f32_16x16x32_bf16 v[12:15], a[76:79], v[84:87], v[12:15]
    s_waitcnt lgkmcnt(6)
    ds_read_b32 v175, v175 offset:336
    v_pk_fmac_f16 v92, v37, v37
    v_mfma_f32_16x16x32_bf16 v[224:227], a[100:103], v[48:51], v[224:227]
    v_cvt_pk_f16_f32 v38, v112, v113
    v_cvt_pk_f16_f32 v39, v114, v115
    v_mfma_f32_16x16x32_bf16 v[88:91], a[100:103], v[84:87], v[88:91]
    s_waitcnt lgkmcnt(5)
    ds_read_b32 v210, v8
    v_pk_fmac_f16 v92, v38, v38
    v_mfma_f32_16x16x32_bf16 v[64:67], a[124:127], v[48:51], v[64:67]
    buffer_load_dwordx4 v18, s[32:35], s92 offen offset:2048 lds
    v_pk_fmac_f16 v92, v39, v39
    v_mfma_f32_16x16x32_bf16 v[48:51], a[120:123], v[104:107], 0
    s_waitcnt vmcnt(9)
    s_add_u32 m0, s90, 0
    ds_read_b64_tr_b16 a[80:81], v74 offset:24576
    v_cvt_pk_f16_f32 v152, v0, v1
    v_mfma_f32_16x16x32_bf16 v[48:51], a[124:127], v[84:87], v[48:51]
    s_waitcnt lgkmcnt(5)
    s_mov_b32 s92, 768
    ds_read_b64_tr_b16 a[82:83], v74 offset:25344
    v_cvt_pk_f16_f32 v153, v2, v3
    v_mfma_f32_16x16x32_bf16 v[0:3], a[72:75], v[56:59], 0
    ds_read_b64_tr_b16 a[104:105], v74 offset:24608
    v_pk_fmac_f16 v92, v152, v152
    v_mfma_f32_16x16x32_bf16 v[0:3], a[76:79], v[4:7], v[0:3]
    ds_read_b64_tr_b16 a[106:107], v74 offset:25376
    v_pk_fmac_f16 v92, v153, v153
    v_mfma_f32_16x16x32_bf16 v[104:107], a[96:99], v[56:59], 0
    buffer_load_dwordx4 v93, s[32:35], s92 offen offset:0 lds
    ds_read_b64_tr_b16 a[128:129], v74 offset:24640
    v_mfma_f32_16x16x32_bf16 v[104:107], a[100:103], v[4:7], v[104:107]
    ds_read_b64_tr_b16 a[130:131], v74 offset:25408
    v_cvt_pk_f16_f32 v52, v52, v53
    v_mfma_f32_16x16x32_bf16 v[84:87], a[120:123], v[56:59], 0
    ds_read_b128 v[164:167], v99 offset:3072
    v_cvt_pk_f16_f32 v53, v54, v55
    v_mfma_f32_16x16x32_bf16 v[84:87], a[124:127], v[4:7], v[84:87]
    s_waitcnt lgkmcnt(7)
    ds_read_b128 v[4:7], v99 offset:41088
    v_pk_fma_f16 v94, v52, v52, s3
    v_mfma_f32_16x16x32_bf16 v[112:115], a[72:75], v[40:43], 0
    ds_read_b128 v[56:59], v99 offset:42624
    v_pk_fmac_f16 v94, v53, v53
    v_mfma_f32_16x16x32_bf16 v[112:115], a[76:79], v[24:27], v[112:115]
    buffer_load_dwordx4 v45, s[32:35], s92 offen offset:1024 lds
    v_cvt_pk_f16_f32 v54, v80, v81
    v_mfma_f32_16x16x32_bf16 v[160:163], a[96:99], v[40:43], 0
    v_cvt_pk_f16_f32 v55, v82, v83
    v_pk_fmac_f16 v94, v54, v54
    v_mfma_f32_16x16x32_bf16 v[160:163], a[100:103], v[24:27], v[160:163]
    ds_read_b128 v[80:83], v99 offset:128
    v_pk_fmac_f16 v94, v55, v55
    v_cvt_pk_f16_f32 v146, v116, v117
    v_cvt_pk_f16_f32 v147, v118, v119
    v_pk_fmac_f16 v94, v146, v146
    v_pk_fmac_f16 v94, v147, v147
    v_mfma_f32_16x16x32_bf16 v[116:119], a[120:123], v[40:43], 0
    v_cvt_pk_f16_f32 v40, v76, v77
    v_cvt_pk_f16_f32 v41, v78, v79
    v_mfma_f32_16x16x32_bf16 v[116:119], a[124:127], v[24:27], v[116:119]
    s_waitcnt vmcnt(8) lgkmcnt(3)
    buffer_load_dwordx4 v18, s[32:35], s92 offen offset:2048 lds
    ds_read_b64_tr_b16 a[84:85], v74 offset:36864
    v_pk_fma_f16 v44, v40, v40, s3
    v_mfma_f32_16x16x32_bf16 v[24:27], a[72:75], v[164:167], 0
    s_add_u32 m0, s90, 12288
    ds_read_b64_tr_b16 a[86:87], v74 offset:37632
    v_pk_fmac_f16 v44, v41, v41
    v_mfma_f32_16x16x32_bf16 v[24:27], a[76:79], v[156:159], v[24:27]
    s_mov_b32 s92, 37632
    ds_read_b64_tr_b16 a[108:109], v74 offset:36896
    v_cvt_pk_f16_f32 v42, v60, v61
    v_mfma_f32_16x16x32_bf16 v[76:79], a[96:99], v[164:167], 0
    ds_read_b64_tr_b16 a[110:111], v74 offset:37664
    v_cvt_pk_f16_f32 v43, v62, v63
    v_mfma_f32_16x16x32_bf16 v[76:79], a[100:103], v[156:159], v[76:79]
    s_waitcnt lgkmcnt(5)
    ds_read_b64_tr_b16 a[132:133], v74 offset:36928
    v_pk_fmac_f16 v44, v42, v42
    v_mfma_f32_16x16x32_bf16 v[100:103], a[80:83], v[4:7], v[100:103]
    buffer_load_dwordx4 v93, s[32:35], s92 offen offset:0 lds
    ds_read_b64_tr_b16 a[134:135], v74 offset:37696
    v_mfma_f32_16x16x32_bf16 v[224:227], a[104:107], v[4:7], v[224:227]
    ds_read_b128 v[60:63], v99 offset:1664
    v_pk_fmac_f16 v44, v43, v43
    v_mfma_f32_16x16x32_bf16 v[64:67], a[128:131], v[4:7], v[64:67]
    ds_read_b128 v[28:31], v99 offset:3200
    v_cvt_pk_f16_f32 v140, v140, v141
    v_mfma_f32_16x16x32_bf16 v[12:15], a[80:83], v[56:59], v[12:15]
    ds_read_b128 v[4:7], v97 offset:41088
    v_cvt_pk_f16_f32 v141, v142, v143
    v_mfma_f32_16x16x32_bf16 v[88:91], a[104:107], v[56:59], v[88:91]
    s_cmp_ge_u32 s2, 248
    s_cbranch_scc1 L_maskF
L_nomaskF:
    v_mfma_f32_16x16x32_bf16 v[48:51], a[128:131], v[56:59], v[48:51]
    s_waitcnt lgkmcnt(7)
    buffer_load_dwordx4 v45, s[32:35], s92 offen offset:1024 lds
    ds_read_b128 v[148:151], v97 offset:42624
    v_mfma_f32_16x16x32_bf16 v[0:3], a[80:83], v[80:83], v[0:3]
    v_pk_fmac_f16 v44, v140, v140
    v_pk_fmac_f16 v44, v141, v141
    v_mfma_f32_16x16x32_bf16 v[56:59], a[120:123], v[164:167], 0
    v_readlane_b32 s84, v211, 48
    v_mov_b32 v8, 0xf149f2ca
    v_mfma_f32_16x16x32_bf16 v[56:59], a[124:127], v[156:159], v[56:59]
    ds_read_b128 v[168:171], v97 offset:128
    v_cmp_gt_u32 vcc, 16, v9
    v_mfma_f32_16x16x32_bf16 v[104:107], a[104:107], v[80:83], v[104:107]
    s_nop 0
    v_cndmask_b32 v208, v8, v208, vcc
    v_cndmask_b32 v209, v8, v209, vcc
    v_mfma_f32_16x16x32_bf16 v[84:87], a[128:131], v[80:83], v[84:87]
    s_waitcnt vmcnt(8) lgkmcnt(4)
    buffer_load_dwordx4 v18, s[32:35], s92 offen offset:2048 lds
    ds_read_b64_tr_b16 a[88:89], v74 offset:49152
    v_mfma_f32_16x16x32_bf16 v[112:115], a[80:83], v[60:63], v[112:115]
    s_add_u32 m0, s90, 24576
    ds_read_b64_tr_b16 a[90:91], v74 offset:49920
    v_cndmask_b32 v210, v8, v210, vcc
    v_mfma_f32_16x16x32_bf16 v[160:163], a[104:107], v[60:63], v[160:163]
    s_mov_b32 s92, 74496
    ds_read_b64_tr_b16 a[112:113], v74 offset:49184
    v_cmp_gt_u32 vcc, 49, v9
    v_mfma_f32_16x16x32_bf16 v[116:119], a[128:131], v[60:63], v[116:119]
    s_waitcnt lgkmcnt(5)
    ds_read_b64_tr_b16 a[114:115], v74 offset:49952
    v_cndmask_b32 v211, v8, v211, vcc
    v_mfma_f32_16x16x32_bf16 v[24:27], a[80:83], v[28:31], v[24:27]
    ds_read_b64_tr_b16 a[136:137], v74 offset:49216
    v_mfma_f32_16x16x32_bf16 v[76:79], a[104:107], v[28:31], v[76:79]
    buffer_load_dwordx4 v93, s[32:35], s92 offen offset:0 lds
    ds_read_b64_tr_b16 a[138:139], v74 offset:49984
    v_mfma_f32_16x16x32_bf16 v[56:59], a[128:131], v[28:31], v[56:59]
    ds_read_b128 v[164:167], v97 offset:1664
    v_mfma_f32_16x16x32_bf16 v[100:103], a[84:87], v[4:7], v[100:103]
    ds_read_b128 v[60:63], v97 offset:3200
    v_mfma_f32_16x16x32_bf16 v[224:227], a[108:111], v[4:7], v[224:227]
    ds_read_b128 v[28:31], v97 offset:41216
    v_mfma_f32_16x16x32_bf16 v[64:67], a[132:135], v[4:7], v[64:67]
    s_waitcnt lgkmcnt(8)
    ds_read_b128 v[156:159], v97 offset:42752
    v_mfma_f32_16x16x32_bf16 v[12:15], a[84:87], v[148:151], v[12:15]
    buffer_load_dwordx4 v45, s[32:35], s92 offen offset:1024 lds
    ds_read_b128 v[4:7], v97 offset:256
    v_mfma_f32_16x16x32_bf16 v[88:91], a[108:111], v[148:151], v[88:91]
    ds_read_b128 v[80:83], v97 offset:1792
    v_mfma_f32_16x16x32_bf16 v[48:51], a[132:135], v[148:151], v[48:51]
    ds_read_b128 v[148:151], v97 offset:3328
    v_mfma_f32_16x16x32_bf16 v[0:3], a[84:87], v[168:171], v[0:3]
    v_mov_b32 v46, 0
    v_mov_b32 v47, 0
    v_mfma_f32_16x16x32_bf16 v[104:107], a[108:111], v[168:171], v[104:107]
    ds_read_b128 v[228:231], v99 offset:41216
    v_mfma_f32_16x16x32_bf16 v[84:87], a[132:135], v[168:171], v[84:87]
    s_waitcnt vmcnt(8) lgkmcnt(7)
    buffer_load_dwordx4 v18, s[32:35], s92 offen offset:2048 lds
    ds_read_b64_tr_b16 a[92:93], v74 offset:61440
    v_mfma_f32_16x16x32_bf16 v[112:115], a[84:87], v[164:167], v[112:115]
    s_add_u32 m0, s90, 36864
    ds_read_b64_tr_b16 a[94:95], v74 offset:62208
    v_mfma_f32_16x16x32_bf16 v[160:163], a[108:111], v[164:167], v[160:163]
    s_mov_b32 s92, 111360
    ds_read_b64_tr_b16 a[116:117], v74 offset:61472
    v_mfma_f32_16x16x32_bf16 v[116:119], a[132:135], v[164:167], v[116:119]
    s_waitcnt lgkmcnt(7)
    s_mov_b32 s53, s47
    ds_read_b64_tr_b16 a[118:119], v74 offset:62240
    v_mfma_f32_16x16x32_bf16 v[24:27], a[84:87], v[60:63], v[24:27]
    s_mov_b32 s47, s46
    ds_read_b64_tr_b16 a[140:141], v74 offset:61504
    v_mov_b32 v142, 0
    v_mfma_f32_16x16x32_bf16 v[76:79], a[108:111], v[60:63], v[76:79]
    s_mov_b32 s46, s45
    buffer_load_dwordx4 v93, s[32:35], s92 offen offset:0 lds
    ds_read_b64_tr_b16 a[142:143], v74 offset:62272
    v_mfma_f32_16x16x32_bf16 v[56:59], a[132:135], v[60:63], v[56:59]
    s_waitcnt lgkmcnt(6)
    s_mov_b32 s45, s44
    ds_read_b128 v[168:171], v99 offset:42752
    v_mov_b32 v143, 0
    v_mov_b32 v19, 0
    v_add_u32 v8, 28672, v98
    s_mov_b32 s44, s53
    s_sub_u32 s48, s44, s46
    ds_write2_b64 v8, v[142:143], v[142:143] offset0:2 offset1:3
    v_mfma_f32_16x16x32_bf16 v[100:103], a[88:91], v[228:231], v[100:103]
    s_waitcnt lgkmcnt(6)
    s_sub_u32 s49, s46, s45
    v_add_u32 v137, s48, v137
    v_add_u32 v136, s48, v136
    v_mfma_f32_16x16x32_bf16 v[100:103], a[92:95], v[28:31], v[100:103]
    s_sub_u32 s50, s45, s44
    buffer_load_dwordx4 v45, s[32:35], s92 offen offset:1024 lds
    v_add_u32 v135, s49, v135
    v_mfma_f32_16x16x32_bf16 v[224:227], a[112:115], v[228:231], v[224:227]
    s_waitcnt lgkmcnt(4)
    s_sub_u32 s51, s46, s47
    ds_read_b128 v[60:63], v99 offset:256
    v_add_u32 v134, s49, v134
    v_mfma_f32_16x16x32_bf16 v[224:227], a[116:119], v[28:31], v[224:227]
    s_mov_b32 s60, s59
    ds_read_b128 v[164:167], v99 offset:1792
    v_cvt_pk_f16_f32 v100, v100, v101
    v_mfma_f32_16x16x32_bf16 v[64:67], a[136:139], v[228:231], v[64:67]
    s_waitcnt lgkmcnt(4)
    s_mov_b32 s59, s58
    v_cvt_pk_f16_f32 v101, v102, v103
    v_pk_fma_f16 v109, v100, v100, s3
    v_pk_fmac_f16 v109, v101, v101
    v_mfma_f32_16x16x32_bf16 v[64:67], a[140:143], v[28:31], v[64:67]
    s_waitcnt lgkmcnt(3)
    s_mov_b32 s58, s57
    v_cvt_pk_f16_f32 v102, v224, v225
    v_cvt_pk_f16_f32 v103, v226, v227
    v_mfma_f32_16x16x32_bf16 v[12:15], a[88:91], v[168:171], v[12:15]
    s_waitcnt vmcnt(8)
    s_mov_b32 s57, s56
    ds_read_b64_tr_b16 a[144:145], v75 offset:0
    buffer_load_dwordx4 v18, s[32:35], s92 offen offset:2048 lds
    v_mfma_f32_16x16x32_bf16 v[12:15], a[92:95], v[156:159], v[12:15]
    s_add_u32 m0, s90, 49152
    ds_read_b64_tr_b16 a[146:147], v75 offset:768
    v_pk_fmac_f16 v109, v102, v102
    v_mfma_f32_16x16x32_bf16 v[88:91], a[112:115], v[168:171], v[88:91]
    s_mov_b32 s92, 148224
    ds_read_b64_tr_b16 a[168:169], v75 offset:8
    v_pk_fmac_f16 v109, v103, v103
    v_mfma_f32_16x16x32_bf16 v[88:91], a[116:119], v[156:159], v[88:91]
    s_mov_b32 s7, s6
    ds_read_b64_tr_b16 a[170:171], v75 offset:776
    v_cvt_pk_f16_f32 v28, v12, v13
    v_mfma_f32_16x16x32_bf16 v[48:51], a[136:139], v[168:171], v[48:51]
    s_mov_b32 s6, s5
    ds_read_b64_tr_b16 a[192:193], v74 offset:64
    buffer_load_dwordx4 v93, s[32:35], s92 offen offset:0 lds
    v_mfma_f32_16x16x32_bf16 v[48:51], a[140:143], v[156:159], v[48:51]
    s_waitcnt lgkmcnt(5)
    s_mov_b32 s5, s4
    ds_read_b64_tr_b16 a[194:195], v74 offset:832
    v_cvt_pk_f16_f32 v29, v14, v15
    v_mfma_f32_16x16x32_bf16 v[0:3], a[88:91], v[60:63], v[0:3]
    s_sub_u32 s14, s6, s7
    ds_read_b128 v[12:15], v99 offset:3328
    v_pk_fma_f16 v111, v28, v28, s3
    v_mfma_f32_16x16x32_bf16 v[0:3], a[92:95], v[4:7], v[0:3]
    s_add_u32 s61, s61, 1
    v_pk_fmac_f16 v111, v29, v29
    v_cvt_pk_f16_f32 v30, v88, v89
    v_mfma_f32_16x16x32_bf16 v[104:107], a[112:115], v[60:63], v[104:107]
    s_add_u32 s12, s12, 20
    v_cvt_pk_f16_f32 v31, v90, v91
    v_pk_fmac_f16 v111, v30, v30
    v_mfma_f32_16x16x32_bf16 v[104:107], a[116:119], v[4:7], v[104:107]
L_pg0:
    s_cbranch_execz L_main
    s_max_u32 s12, s12, s61
    v_pk_fmac_f16 v111, v31, v31
    v_cvt_pk_f16_f32 v16, v48, v49
    v_mfma_f32_16x16x32_bf16 v[84:87], a[136:139], v[60:63], v[84:87]
    s_add_u32 s65, s65, 1
    buffer_load_dwordx4 v45, s[32:35], s92 offen offset:1024 lds
    v_cvt_pk_f16_f32 v17, v50, v51
    v_mfma_f32_16x16x32_bf16 v[84:87], a[140:143], v[4:7], v[84:87]
    s_add_u32 s67, s46, s54
    ds_read_b128 v[60:63], v99 offset:40960
    v_pk_fmac_f16 v111, v16, v16
    v_mfma_f32_16x16x32_bf16 v[112:115], a[88:91], v[164:167], v[112:115]
    ds_read_b128 v[48:51], v97 offset:40960
    v_pk_fmac_f16 v111, v17, v17
    v_mfma_f32_16x16x32_bf16 v[112:115], a[92:95], v[80:83], v[112:115]
    ds_read_b128 v[4:7], v99 offset:41088
    v_cvt_pk_f16_f32 v156, v64, v65
    v_mfma_f32_16x16x32_bf16 v[160:163], a[112:115], v[164:167], v[160:163]
    ds_read_b128 v[88:91], v97 offset:41088
    buffer_load_dwordx4 v18, s[32:35], s92 offen offset:2048 lds
    v_mfma_f32_16x16x32_bf16 v[160:163], a[116:119], v[80:83], v[160:163]
    s_waitcnt vmcnt(9)
    s_add_u32 m0, s90, 61440
    ds_read_b64_tr_b16 a[148:149], v75 offset:12288
    v_cvt_pk_f16_f32 v112, v112, v113
    v_mfma_f32_16x16x32_bf16 v[116:119], a[136:139], v[164:167], v[116:119]
    s_mov_b32 s92, 185088
    ds_read_b64_tr_b16 a[150:151], v75 offset:13056
    v_cvt_pk_f16_f32 v113, v114, v115
    v_mfma_f32_16x16x32_bf16 v[116:119], a[140:143], v[80:83], v[116:119]
    s_waitcnt lgkmcnt(6)
    ds_read_b64_tr_b16 a[172:173], v75 offset:12296
    v_pk_fma_f16 v95, v112, v112, s3
    v_mfma_f32_16x16x32_bf16 v[24:27], a[88:91], v[12:15], v[24:27]
    ds_read_b64_tr_b16 a[174:175], v75 offset:13064
    v_pk_fmac_f16 v95, v113, v113
    v_mfma_f32_16x16x32_bf16 v[24:27], a[92:95], v[148:151], v[24:27]
    ds_read_b64_tr_b16 a[196:197], v74 offset:12352
    buffer_load_dwordx4 v93, s[32:35], s92 offen offset:0 lds
    v_mfma_f32_16x16x32_bf16 v[76:79], a[112:115], v[12:15], v[76:79]
    ds_read_b64_tr_b16 a[198:199], v74 offset:13120
    v_cvt_pk_f16_f32 v114, v160, v161
    v_mfma_f32_16x16x32_bf16 v[76:79], a[116:119], v[148:151], v[76:79]
    ds_read_b128 v[80:83], v99 offset:41216
    v_cvt_pk_f16_f32 v115, v162, v163
    v_mfma_f32_16x16x32_bf16 v[56:59], a[136:139], v[12:15], v[56:59]
    ds_read_b128 v[12:15], v97 offset:41216
    v_pk_fmac_f16 v95, v114, v114
    v_mfma_f32_16x16x32_bf16 v[56:59], a[140:143], v[148:151], v[56:59]
    v_pk_fmac_f16 v95, v115, v115
    v_cvt_pk_f16_f32 v148, v116, v117
    v_cvt_pk_f16_f32 v149, v118, v119
    v_pk_fmac_f16 v95, v148, v148
    v_pk_fmac_f16 v95, v149, v149
    buffer_load_dwordx4 v45, s[32:35], s92 offen offset:1024 lds
    v_mov_b32 v171, 0
    v_mov_b32 v167, 0
    v_mov_b32 v163, 0
    v_mov_b32 v159, 0
    v_mov_b32 v150, 0
    v_mov_b32 v151, 0
    v_mov_b32 v144, 0
    v_mov_b32 v145, 0
    v_mov_b32 v138, 0
    v_mov_b32 v139, 0
    v_cvt_pk_f16_f32 v157, v66, v67
    v_pk_fmac_f16 v109, v156, v156
    v_pk_fmac_f16 v109, v157, v157
    v_cvt_pk_f16_f32 v64, v0, v1
    v_cvt_pk_f16_f32 v65, v2, v3
    v_mfma_f32_16x16x32_f16 v[0:3], v[212:215], v[108:111], 0
    s_waitcnt vmcnt(8)
    ds_read_b64_tr_b16 a[152:153], v75 offset:24576
    buffer_load_dwordx4 v18, s[32:35], s92 offen offset:2048 lds
    v_pk_fma_f16 v93, v64, v64, s3
    v_pk_fmac_f16 v93, v65, v65
    s_add_u32 m0, s54, 20480
    ds_read_b64_tr_b16 a[154:155], v75 offset:25344
    v_cvt_pk_f16_f32 v66, v104, v105
    v_or3_b32 v123, v123, v0, v1
    v_rsq_f32 v0, v0
    ds_read_b64_tr_b16 a[176:177], v75 offset:24584
    v_rsq_f32 v1, v1
    v_mul_f32 v0, s52, v0
    ds_read_b64_tr_b16 a[178:179], v75 offset:25352
    buffer_load_dwordx4 v128, s[24:27], s56 offen nt lds
    v_cvt_pk_f16_f32 v0, v0, v1
    v_or3_b32 v123, v123, v2, v3
    s_add_u32 m0, s54, 21504
    ds_read_b64_tr_b16 a[200:201], v74 offset:24640
    v_rsq_f32 v2, v2
    ds_read_b64_tr_b16 a[202:203], v74 offset:25408
    v_rsq_f32 v3, v3
    v_mul_f32 v2, s52, v2
    v_cvt_pk_f16_f32 v2, v2, v3
    v_pk_mul_f16 v68, v68, v0 op_sel:[0,0] op_sel_hi:[1,0]
    v_pk_mul_f16 v69, v69, v0 op_sel:[0,0] op_sel_hi:[1,0]
    v_pk_mul_f16 v70, v70, v0 op_sel:[0,0] op_sel_hi:[1,0]
    v_pk_mul_f16 v71, v71, v0 op_sel:[0,0] op_sel_hi:[1,0]
    v_pk_mul_f16 v120, v120, v0 op_sel:[0,0] op_sel_hi:[1,0]
    v_pk_mul_f16 v121, v121, v0 op_sel:[0,0] op_sel_hi:[1,0]
    v_pk_mul_f16 v100, v100, v0 op_sel:[0,1] op_sel_hi:[1,1]
    v_pk_mul_f16 v101, v101, v0 op_sel:[0,1] op_sel_hi:[1,1]
    v_pk_mul_f16 v102, v102, v0 op_sel:[0,1] op_sel_hi:[1,1]
    v_pk_mul_f16 v103, v103, v0 op_sel:[0,1] op_sel_hi:[1,1]
    v_pk_mul_f16 v156, v156, v0 op_sel:[0,1] op_sel_hi:[1,1]
    v_pk_mul_f16 v157, v157, v0 op_sel:[0,1] op_sel_hi:[1,1]
    v_fma_mix_f32 v18, v68, v100, 0 op_sel:[0,0,0] op_sel_hi:[1,1,0]
    v_fma_mix_f32 v18, v68, v100, v18 op_sel:[1,1,0] op_sel_hi:[1,1,0]
    v_fma_mix_f32 v18, v69, v101, v18 op_sel:[0,0,0] op_sel_hi:[1,1,0]
    v_fma_mix_f32 v18, v69, v101, v18 op_sel:[1,1,0] op_sel_hi:[1,1,0]
    v_fma_mix_f32 v18, v70, v102, v18 op_sel:[0,0,0] op_sel_hi:[1,1,0]
    v_fma_mix_f32 v18, v70, v102, v18 op_sel:[1,1,0] op_sel_hi:[1,1,0]
    v_fma_mix_f32 v18, v71, v103, v18 op_sel:[0,0,0] op_sel_hi:[1,1,0]
    v_fma_mix_f32 v18, v71, v103, v18 op_sel:[1,1,0] op_sel_hi:[1,1,0]
    v_fma_mix_f32 v18, v120, v156, v18 op_sel:[0,0,0] op_sel_hi:[1,1,0]
    v_fma_mix_f32 v18, v120, v156, v18 op_sel:[1,1,0] op_sel_hi:[1,1,0]
    v_fma_mix_f32 v18, v121, v157, v18 op_sel:[0,0,0] op_sel_hi:[1,1,0]
    v_fma_mix_f32 v18, v121, v157, v18 op_sel:[1,1,0] op_sel_hi:[1,1,0]
    v_mov_b32 v45, v18
    s_waitcnt vmcnt(7)
    ds_read_b64_tr_b16 a[156:157], v75 offset:36864
    buffer_load_dwordx4 v127, s[24:27], s56 offen nt lds
    v_permlane32_swap_b32 v45, v18
    s_add_u32 m0, s54, 22528
    ds_read_b64_tr_b16 a[158:159], v75 offset:37632
    v_add_f32 v18, v45, v18
    v_mov_b32 v45, v18
    v_cvt_pk_f16_f32 v67, v106, v107
    ds_read_b64_tr_b16 a[180:181], v75 offset:36872
    buffer_load_dwordx4 v126, s[24:27], s56 offen nt lds
    v_permlane16_swap_b32 v45, v18
    s_add_u32 m0, s54, 23552
    ds_read_b64_tr_b16 a[182:183], v75 offset:37640
    v_add_f32 v18, v45, v18
    v_pk_fmac_f16 v93, v66, v66
    v_pk_fmac_f16 v93, v67, v67
    ds_read_b64_tr_b16 a[204:205], v74 offset:36928
    buffer_load_dwordx4 v125, s[24:27], s56 offen nt lds
    ds_read_b64_tr_b16 a[206:207], v74 offset:37696
    v_cvt_pk_f16_f32 v154, v84, v85
    s_add_u32 m0, s54, 24576
    ds_write_b128 v8, v[100:103]
    v_cvt_pk_f16_f32 v155, v86, v87
    v_pk_fmac_f16 v93, v154, v154
    v_pk_fmac_f16 v93, v155, v155
    buffer_load_dwordx4 v124, s[24:27], s56 offen nt lds
    v_add_f32 v18, s84, v18
    v_mfma_f32_16x16x32_f16 v[84:87], v[212:215], v[92:95], 0
    s_cmp_lt_u32 s61, s71
    ds_write_b128 v8, v[68:71] offset:32
    v_exp_f32 v18, v18
    v_cvt_pk_f16_f32 v72, v24, v25
    v_cvt_pk_bf16_f32 v18, v18, 0
    v_cmp_gt_u32 vcc, 16, v9
    v_cvt_pk_f16_f32 v73, v26, v27
    v_pk_fma_f16 v45, v72, v72, s3
    v_or3_b32 v123, v123, v84, v85
    s_cselect_b32 s15, s61, s12
    s_cselect_b32 s56, s69, s70
    s_waitcnt vmcnt(8)
    ds_read_b64_tr_b16 a[160:161], v75 offset:49152
    buffer_load_dword v96, v126, s[28:31], s72 offen nt
    v_rsq_f32 v84, v84
    s_add_u32 s56, s56, s15
    s_mul_i32 s53, s56, 58255
    ds_read_b64_tr_b16 a[162:163], v75 offset:49920
    v_rsq_f32 v85, v85
    v_mul_f32 v84, s52, v84
    s_lshr_b32 s53, s53, 22
    s_mul_i32 s53, s53, s63
    ds_read_b64_tr_b16 a[184:185], v75 offset:49160
    v_cvt_pk_f16_f32 v84, v84, v85
    v_or3_b32 v123, v123, v86, v87
    v_rsq_f32 v86, v86
    s_mul_i32 s56, s56, s62
    s_add_u32 s56, s56, s53
    ds_read_b64_tr_b16 a[186:187], v75 offset:49928
    v_rsq_f32 v87, v87
    v_mul_f32 v86, s52, v86
    s_mul_i32 s4, s15, 112
    s_cmp_ge_u32 s15, 16
    ds_read_b64_tr_b16 a[208:209], v74 offset:49216
    v_cvt_pk_f16_f32 v86, v86, v87
    s_cselect_b32 s53, -30464, 0
    s_add_u32 s4, s4, s53
    ds_read_b64_tr_b16 a[210:211], v74 offset:49984
    v_pk_mul_f16 v64, v64, v84 op_sel:[0,1] op_sel_hi:[1,1]
    s_cmp_lt_u32 s15, s73
    s_cselect_b32 s26, 100270464, 0
    ds_write2_b64 v8, v[156:157], v[142:143] offset0:6 offset1:7
    v_pk_mul_f16 v65, v65, v84 op_sel:[0,1] op_sel_hi:[1,1]
    v_pk_mul_f16 v66, v66, v84 op_sel:[0,1] op_sel_hi:[1,1]
    v_pk_mul_f16 v67, v67, v84 op_sel:[0,1] op_sel_hi:[1,1]
    v_pk_mul_f16 v154, v154, v84 op_sel:[0,1] op_sel_hi:[1,1]
    v_pk_mul_f16 v155, v155, v84 op_sel:[0,1] op_sel_hi:[1,1]
    v_pk_mul_f16 v36, v36, v84 op_sel:[0,0] op_sel_hi:[1,0]
    v_pk_mul_f16 v37, v37, v84 op_sel:[0,0] op_sel_hi:[1,0]
    v_pk_mul_f16 v38, v38, v84 op_sel:[0,0] op_sel_hi:[1,0]
    s_cselect_b32 s56, s56, 0
    s_cselect_b32 s4, s4, -1
    ds_write2_b64 v8, v[142:143], v[120:121] offset0:8 offset1:9
    v_pk_mul_f16 v39, v39, v84 op_sel:[0,0] op_sel_hi:[1,0]
    v_pk_mul_f16 v152, v152, v84 op_sel:[0,0] op_sel_hi:[1,0]
    v_pk_mul_f16 v153, v153, v84 op_sel:[0,0] op_sel_hi:[1,0]
    v_mfma_f32_16x16x32_f16 v[24:27], v[64:67], v[36:39], v[204:207]
    s_cselect_b32 s15, s15, 0
    v_pk_mul_f16 v112, v112, v86 op_sel:[0,1] op_sel_hi:[1,1]
    v_pk_mul_f16 v113, v113, v86 op_sel:[0,1] op_sel_hi:[1,1]
    v_mfma_f32_16x16x32_f16 v[24:27], v[152:155], v[150:153], v[24:27]
    s_waitcnt vmcnt(6) lgkmcnt(2)
    s_cselect_b32 s13, s13, -1
    ds_read_b64_tr_b16 a[164:165], v75 offset:61440
    v_pk_mul_f16 v114, v114, v86 op_sel:[0,1] op_sel_hi:[1,1]
    v_pk_mul_f16 v115, v115, v86 op_sel:[0,1] op_sel_hi:[1,1]
    v_pk_mul_f16 v148, v148, v86 op_sel:[0,1] op_sel_hi:[1,1]
    s_bitset1_b32 s64, s15
    s_cmp_ge_i32 s65, 2
    ds_read_b64_tr_b16 a[166:167], v75 offset:62208
    v_mfma_f32_16x16x32_bf16 v[68:71], a[144:147], v[60:63], 0
    s_cselect_b32 s30, 100270464, 0
    v_pk_mul_f16 v149, v149, v86 op_sel:[0,1] op_sel_hi:[1,1]
    v_pk_mul_f16 v52, v52, v86 op_sel:[0,0] op_sel_hi:[1,0]
    v_mfma_f32_16x16x32_bf16 v[68:71], a[148:151], v[48:51], v[68:71]
    ds_read_b64_tr_b16 a[188:189], v75 offset:61448
    v_pk_mul_f16 v53, v53, v86 op_sel:[0,0] op_sel_hi:[1,0]
    v_mfma_f32_16x16x32_bf16 v[68:71], a[152:155], v[4:7], v[68:71]
    ds_read_b64_tr_b16 a[190:191], v75 offset:62216
    v_pk_mul_f16 v54, v54, v86 op_sel:[0,0] op_sel_hi:[1,0]
    v_mfma_f32_16x16x32_bf16 v[68:71], a[156:159], v[88:91], v[68:71]
    ds_read_b64_tr_b16 a[212:213], v74 offset:61504
    v_pk_mul_f16 v55, v55, v86 op_sel:[0,0] op_sel_hi:[1,0]
    v_mfma_f32_16x16x32_bf16 v[68:71], a[160:163], v[80:83], v[68:71]
    ds_read_b64_tr_b16 a[214:215], v74 offset:62272
    v_pk_mul_f16 v146, v146, v86 op_sel:[0,0] op_sel_hi:[1,0]
    v_pk_mul_f16 v147, v147, v86 op_sel:[0,0] op_sel_hi:[1,0]
    v_cndmask_b32 v18, 0, v18, vcc
    v_pk_fmac_f16 v45, v73, v73
    v_cvt_pk_f16_f32 v74, v76, v77
    v_cvt_pk_f16_f32 v75, v78, v79
    v_pk_fmac_f16 v45, v74, v74
    v_pk_fmac_f16 v45, v75, v75
    v_cvt_pk_f16_f32 v142, v56, v57
    v_cvt_pk_f16_f32 v143, v58, v59
    v_pk_fmac_f16 v45, v142, v142
    v_pk_fmac_f16 v45, v143, v143
    v_add_u32 v137, s50, v137
    v_add_u32 v136, s50, v136
    v_add_u32 v135, s48, v135
    s_waitcnt lgkmcnt(4)
    v_mfma_f32_16x16x32_bf16 v[68:71], a[164:167], v[12:15], v[68:71]
    ds_write_b64 v8, v[18:19] offset:88
    v_mfma_f32_16x16x32_bf16 v[56:59], a[168:171], v[60:63], 0
    s_nop 0
    v_add_u32 v134, s48, v134
    v_add_u32 v133, s51, v133
    v_mfma_f32_16x16x32_bf16 v[56:59], a[172:175], v[48:51], v[56:59]
    s_nop 0
    ds_read_b128 v[100:103], v99 offset:3072
    v_cvt_pk_bf16_f32 v18, v68, v69
    v_mfma_f32_16x16x32_bf16 v[56:59], a[176:179], v[4:7], v[56:59]
    ds_read_b128 v[84:87], v97 offset:3072
    v_cvt_pk_bf16_f32 v19, v70, v71
    v_mfma_f32_16x16x32_bf16 v[56:59], a[180:183], v[88:91], v[56:59]
    ds_write_b64 v98, v[18:19] offset:28752
    v_mfma_f32_16x16x32_bf16 v[56:59], a[184:187], v[80:83], v[56:59]
    s_waitcnt lgkmcnt(4)
    v_add_u32 v132, s14, v132
    v_add_u32 v131, s14, v131
    v_mfma_f32_16x16x32_bf16 v[56:59], a[188:191], v[12:15], v[56:59]
    ds_read_b128 v[76:79], v99 offset:3200
    v_mfma_f32_16x16x32_bf16 v[68:71], a[192:195], v[60:63], 0
    s_nop 0
    ds_read_b128 v[60:63], v97 offset:3200
    s_nop 0
    v_mfma_f32_16x16x32_bf16 v[68:71], a[196:199], v[48:51], v[68:71]
    s_nop 0
    ds_read_b128 v[48:51], v99 offset:3328
    v_cvt_pk_bf16_f32 v56, v56, v57
    v_mfma_f32_16x16x32_bf16 v[68:71], a[200:203], v[4:7], v[68:71]
    ds_read_b128 v[4:7], v97 offset:3328
    v_cvt_pk_bf16_f32 v57, v58, v59
    v_mfma_f32_16x16x32_bf16 v[68:71], a[204:207], v[88:91], v[68:71]
    v_mfma_f32_16x16x32_bf16 v[68:71], a[208:211], v[80:83], v[68:71]
    v_mfma_f32_16x16x32_bf16 v[68:71], a[212:215], v[12:15], v[68:71]
    v_exp_f32 v24, v24
    v_mfma_f32_16x16x32_f16 v[88:91], v[112:115], v[36:39], v[200:203]
    v_exp_f32 v25, v25
    v_mfma_f32_16x16x32_f16 v[88:91], v[146:149], v[150:153], v[88:91]
    s_waitcnt lgkmcnt(4)
    v_exp_f32 v26, v26
    v_mfma_f32_16x16x32_bf16 v[12:15], v[100:103], a[144:147], 0
    s_nop 0
    v_cvt_pk_bf16_f32 v58, v68, v69
    v_cvt_pk_bf16_f32 v59, v70, v71
    v_mfma_f32_16x16x32_bf16 v[12:15], v[84:87], a[148:151], v[12:15]
    s_waitcnt lgkmcnt(2)
    ds_write_b128 v98, v[56:59] offset:28768
    v_mfma_f32_16x16x32_bf16 v[12:15], v[76:79], a[152:155], v[12:15]
    v_exp_f32 v27, v27
    v_mfma_f32_16x16x32_bf16 v[12:15], v[60:63], a[156:159], v[12:15]
    s_waitcnt lgkmcnt(1)
    v_cvt_pk_bf16_f32 v92, v24, v25
    v_cvt_pk_bf16_f32 v93, v26, v27
    v_mfma_f32_16x16x32_bf16 v[12:15], v[48:51], a[160:163], v[12:15]
    ds_read_b128 v[56:59], v132 offset:16
    v_pk_mul_f16 v20, v20, v2 op_sel:[0,0] op_sel_hi:[1,0]
    v_mfma_f32_16x16x32_bf16 v[12:15], v[4:7], a[164:167], v[12:15]
    v_exp_f32 v88, v88
    v_mfma_f32_16x16x32_bf16 v[80:83], v[100:103], a[168:171], 0
    s_nop 0
    ds_read_b128 v[68:71], v132 offset:0
    v_pk_mul_f16 v21, v21, v2 op_sel:[0,0] op_sel_hi:[1,0]
    v_mfma_f32_16x16x32_bf16 v[80:83], v[84:87], a[172:175], v[80:83]
    s_nop 0
    ds_read_b128 v[24:27], v132 offset:48
    v_cvt_pk_bf16_f32 v164, v12, v13
    v_mfma_f32_16x16x32_bf16 v[80:83], v[76:79], a[176:179], v[80:83]
    v_cvt_pk_bf16_f32 v165, v14, v15
    v_pk_mul_f16 v22, v22, v2 op_sel:[0,0] op_sel_hi:[1,0]
    v_mfma_f32_16x16x32_bf16 v[80:83], v[60:63], a[180:183], v[80:83]
    v_exp_f32 v89, v89
    v_mfma_f32_16x16x32_bf16 v[80:83], v[48:51], a[184:187], v[80:83]
    v_exp_f32 v90, v90
    v_mfma_f32_16x16x32_bf16 v[80:83], v[4:7], a[188:191], v[80:83]
    s_nop 0
    v_exp_f32 v91, v91
    v_mfma_f32_16x16x32_bf16 v[12:15], v[100:103], a[192:195], 0
    s_nop 0
    v_cvt_pk_bf16_f32 v94, v88, v89
    v_cvt_pk_bf16_f32 v95, v90, v91
    v_mfma_f32_16x16x32_bf16 v[12:15], v[84:87], a[196:199], v[12:15]
    s_nop 0
    v_cvt_pk_bf16_f32 v160, v80, v81
    v_cvt_pk_bf16_f32 v161, v82, v83
    v_mfma_f32_16x16x32_bf16 v[12:15], v[76:79], a[200:203], v[12:15]
    v_pk_mul_f16 v23, v23, v2 op_sel:[0,0] op_sel_hi:[1,0]
    v_pk_mul_f16 v10, v10, v2 op_sel:[0,0] op_sel_hi:[1,0]
    v_mfma_f32_16x16x32_bf16 v[12:15], v[60:63], a[204:207], v[12:15]
    ds_read_u16 v166, v131 offset:80
    v_pk_mul_f16 v11, v11, v2 op_sel:[0,0] op_sel_hi:[1,0]
    v_mfma_f32_16x16x32_bf16 v[12:15], v[48:51], a[208:211], v[12:15]
    ds_read_u16 v162, v131 offset:96
    v_pk_mul_f16 v28, v28, v2 op_sel:[0,1] op_sel_hi:[1,1]
    v_mfma_f32_16x16x32_bf16 v[12:15], v[4:7], a[212:215], v[12:15]
    ds_read_u16 v158, v131 offset:104
    v_pk_mul_f16 v29, v29, v2 op_sel:[0,1] op_sel_hi:[1,1]
    v_mfma_f32_16x16x32_f16 v[4:7], v[212:215], v[44:47], 0
    s_waitcnt lgkmcnt(3)
    v_pk_mul_f16 v30, v30, v2 op_sel:[0,1] op_sel_hi:[1,1]
    v_pk_mul_f16 v31, v31, v2 op_sel:[0,1] op_sel_hi:[1,1]
    v_mfma_f32_16x16x32_f16 v[76:79], v[68:71], v[36:39], v[208:211]
    s_nop 0
    v_cvt_pk_bf16_f32 v156, v12, v13
    v_cvt_pk_bf16_f32 v157, v14, v15
    v_mfma_f32_16x16x32_f16 v[76:79], v[56:59], v[64:67], v[76:79]
    v_or3_b32 v123, v123, v4, v5
    v_pk_mul_f16 v16, v16, v2 op_sel:[0,1] op_sel_hi:[1,1]
    v_mfma_f32_16x16x32_f16 v[76:79], v[24:27], v[152:155], v[76:79]
    ds_read_b128 v[88:91], v99 offset:0
    v_pk_mul_f16 v17, v17, v2 op_sel:[0,1] op_sel_hi:[1,1]
    v_mfma_f32_16x16x32_f16 v[12:15], v[68:71], v[52:55], v[208:211]
    ds_read_b128 v[80:83], v97 offset:0
    v_fma_mix_f32 v8, v20, v28, 0 op_sel:[0,0,0] op_sel_hi:[1,1,0]
    v_mfma_f32_16x16x32_f16 v[12:15], v[56:59], v[112:115], v[12:15]
    s_add_u32 m0, s67, 0
    ds_read_b128 v[232:235], v99 offset:128
    v_fma_mix_f32 v8, v20, v28, v8 op_sel:[1,1,0] op_sel_hi:[1,1,0]
    v_mfma_f32_16x16x32_f16 v[12:15], v[24:27], v[146:149], v[12:15]
    ds_read_b128 v[228:231], v97 offset:128
    v_fma_mix_f32 v8, v21, v29, v8 op_sel:[0,0,0] op_sel_hi:[1,1,0]
    v_mfma_f32_16x16x32_f16 v[44:47], v[64:67], v[52:55], v[192:195]
    ds_read_b128 v[224:227], v99 offset:256
    v_fma_mix_f32 v8, v21, v29, v8 op_sel:[1,1,0] op_sel_hi:[1,1,0]
    v_mfma_f32_16x16x32_f16 v[44:47], v[152:155], v[144:147], v[44:47]
    s_nop 0
    ds_read_b128 v[60:63], v97 offset:256
    v_mov_b32_dpp v79, v15 quad_perm:[0,1,2,3] row_mask:0x2 bank_mask:0xf
    v_mfma_f32_16x16x32_f16 v[48:51], v[112:115], v[52:55], v[188:191]
    v_rsq_f32 v4, v4
    v_mfma_f32_16x16x32_f16 v[48:51], v[146:149], v[144:147], v[48:51]
    s_waitcnt lgkmcnt(5)
    v_rsq_f32 v5, v5
    v_mul_f32 v4, s52, v4
    v_cvt_pk_f16_f32 v4, v4, v5
    v_pk_mul_f16 v72, v72, v4 op_sel:[0,1] op_sel_hi:[1,1]
    v_pk_mul_f16 v73, v73, v4 op_sel:[0,1] op_sel_hi:[1,1]
    v_pk_mul_f16 v74, v74, v4 op_sel:[0,1] op_sel_hi:[1,1]
    v_mfma_f32_16x16x32_bf16 v[0:3], v[88:91], a[144:147], 0
    s_waitcnt lgkmcnt(4)
    s_mul_i32 s93, s68, 18432
    v_pk_mul_f16 v75, v75, v4 op_sel:[0,1] op_sel_hi:[1,1]
    v_pk_mul_f16 v142, v142, v4 op_sel:[0,1] op_sel_hi:[1,1]
    v_mfma_f32_16x16x32_bf16 v[0:3], v[80:83], a[148:151], v[0:3]
    s_waitcnt lgkmcnt(3)
    s_movk_i32 s92, 0
    v_pk_mul_f16 v143, v143, v4 op_sel:[0,1] op_sel_hi:[1,1]
    v_pk_mul_f16 v40, v40, v4 op_sel:[0,0] op_sel_hi:[1,0]
    v_mfma_f32_16x16x32_bf16 v[0:3], v[232:235], a[152:155], v[0:3]
    s_waitcnt lgkmcnt(2)
    v_pk_mul_f16 v41, v41, v4 op_sel:[0,0] op_sel_hi:[1,0]
    v_pk_mul_f16 v42, v42, v4 op_sel:[0,0] op_sel_hi:[1,0]
    v_mfma_f32_16x16x32_bf16 v[0:3], v[228:231], a[156:159], v[0:3]
    s_waitcnt lgkmcnt(1)
    v_pk_mul_f16 v43, v43, v4 op_sel:[0,0] op_sel_hi:[1,0]
    v_pk_mul_f16 v140, v140, v4 op_sel:[0,0] op_sel_hi:[1,0]
    v_mfma_f32_16x16x32_bf16 v[0:3], v[224:227], a[160:163], v[0:3]
    s_waitcnt lgkmcnt(0)
    v_pk_mul_f16 v141, v141, v4 op_sel:[0,0] op_sel_hi:[1,0]
    v_fma_mix_f32 v8, v22, v30, v8 op_sel:[0,0,0] op_sel_hi:[1,1,0]
    v_mfma_f32_16x16x32_bf16 v[0:3], v[60:63], a[164:167], v[0:3]
    v_exp_f32 v44, v44
    v_mfma_f32_16x16x32_f16 v[4:7], v[72:75], v[36:39], v[196:199]
    v_exp_f32 v45, v45
    v_mfma_f32_16x16x32_f16 v[4:7], v[140:143], v[150:153], v[4:7]
    s_nop 0
    v_exp_f32 v46, v46
    v_mfma_f32_16x16x32_f16 v[36:39], v[68:71], v[40:43], v[208:211]
    s_mov_b32 s53, s47
    v_cvt_pk_bf16_f32 v0, v0, v1
    v_cvt_pk_bf16_f32 v1, v2, v3
    v_mfma_f32_16x16x32_f16 v[36:39], v[56:59], v[72:75], v[36:39]
    s_mov_b32 s47, s46
    v_exp_f32 v47, v47
    v_mfma_f32_16x16x32_f16 v[36:39], v[24:27], v[140:143], v[36:39]
    s_mov_b32 s46, s45
    ds_read_b128 v[108:111], v99 offset:42496
    v_cvt_pk_bf16_f32 v68, v44, v45
    v_mfma_f32_16x16x32_f16 v[24:27], v[72:75], v[52:55], v[184:187]
    s_mov_b32 s45, s44
    ds_read_b128 v[104:107], v97 offset:42496
    v_cvt_pk_bf16_f32 v69, v46, v47
    v_mfma_f32_16x16x32_f16 v[24:27], v[140:143], v[144:147], v[24:27]
    s_mov_b32 s44, s53
    ds_read_b128 v[100:103], v99 offset:42624
    v_mov_b32_dpp v79, v39 quad_perm:[0,1,2,3] row_mask:0x4 bank_mask:0xf
    v_mfma_f32_16x16x32_bf16 v[56:59], v[88:91], a[168:171], 0
    s_sub_u32 s48, s44, s46
    ds_read_b128 v[84:87], v97 offset:42624
    v_fma_mix_f32 v8, v22, v30, v8 op_sel:[1,1,0] op_sel_hi:[1,1,0]
    v_mfma_f32_16x16x32_bf16 v[56:59], v[80:83], a[172:175], v[56:59]
    s_sub_u32 s49, s46, s45
    ds_read_b128 v[44:47], v99 offset:42752
    v_fma_mix_f32 v8, v23, v31, v8 op_sel:[0,0,0] op_sel_hi:[1,1,0]
    v_mfma_f32_16x16x32_bf16 v[56:59], v[232:235], a[176:179], v[56:59]
    ds_read_b128 v[52:55], v97 offset:42752
    v_fma_mix_f32 v8, v23, v31, v8 op_sel:[1,1,0] op_sel_hi:[1,1,0]
    v_mfma_f32_16x16x32_bf16 v[56:59], v[228:231], a[180:183], v[56:59]
    v_exp_f32 v79, v79
    v_mfma_f32_16x16x32_bf16 v[56:59], v[224:227], a[184:187], v[56:59]
    v_cvt_pk_bf16_f32 v79, v79, v79
    v_fma_mix_f32 v8, v10, v16, v8 op_sel:[0,0,0] op_sel_hi:[1,1,0]
    v_mfma_f32_16x16x32_bf16 v[56:59], v[60:63], a[188:191], v[56:59]
    ds_write_b16 v131, v79 offset:64
    v_mfma_f32_16x16x32_bf16 v[116:119], v[88:91], a[192:195], 0
    s_nop 0
    ds_read_b128 v[88:91], v132 offset:48
    v_fma_mix_f32 v8, v10, v16, v8 op_sel:[1,1,0] op_sel_hi:[1,1,0]
    v_mfma_f32_16x16x32_bf16 v[116:119], v[80:83], a[196:199], v[116:119]
    s_nop 0
    ds_read_b128 v[80:83], v132 offset:64
    v_cvt_pk_bf16_f32 v56, v56, v57
    v_mfma_f32_16x16x32_bf16 v[116:119], v[232:235], a[200:203], v[116:119]
    v_cvt_pk_bf16_f32 v57, v58, v59
    v_fma_mix_f32 v8, v11, v17, v8 op_sel:[0,0,0] op_sel_hi:[1,1,0]
    v_mfma_f32_16x16x32_bf16 v[116:119], v[228:231], a[204:207], v[116:119]
    v_exp_f32 v48, v48
    v_mfma_f32_16x16x32_bf16 v[116:119], v[224:227], a[208:211], v[116:119]
    v_exp_f32 v49, v49
    v_mfma_f32_16x16x32_bf16 v[116:119], v[60:63], a[212:215], v[116:119]
    s_waitcnt lgkmcnt(3)
    v_exp_f32 v50, v50
    v_mfma_f32_16x16x32_bf16 v[60:63], a[144:147], v[108:111], 0
    s_nop 0
    v_exp_f32 v51, v51
    v_mfma_f32_16x16x32_bf16 v[60:63], a[148:151], v[104:107], v[60:63]
    s_nop 0
    v_cvt_pk_bf16_f32 v70, v48, v49
    v_cvt_pk_bf16_f32 v48, v116, v117
    v_mfma_f32_16x16x32_bf16 v[60:63], a[152:155], v[100:103], v[60:63]
    v_cvt_pk_bf16_f32 v49, v118, v119
    v_cvt_pk_bf16_f32 v71, v50, v51
    v_mfma_f32_16x16x32_bf16 v[60:63], a[156:159], v[84:87], v[60:63]
    v_exp_f32 v24, v24
    v_mfma_f32_16x16x32_bf16 v[60:63], a[160:163], v[44:47], v[60:63]
    v_exp_f32 v25, v25
    v_mfma_f32_16x16x32_bf16 v[60:63], a[164:167], v[52:55], v[60:63]
    v_exp_f32 v26, v26
    v_mfma_f32_16x16x32_bf16 v[224:227], a[168:171], v[108:111], 0
    v_exp_f32 v27, v27
    v_mfma_f32_16x16x32_bf16 v[224:227], a[172:175], v[104:107], v[224:227]
    s_nop 0
    v_exp_f32 v13, v13
    v_mfma_f32_16x16x32_bf16 v[224:227], a[176:179], v[100:103], v[224:227]
    s_nop 0
    v_cvt_pk_bf16_f32 v120, v60, v61
    v_cvt_pk_bf16_f32 v121, v62, v63
    v_mfma_f32_16x16x32_bf16 v[224:227], a[180:183], v[84:87], v[224:227]
    v_exp_f32 v4, v4
    v_mfma_f32_16x16x32_bf16 v[224:227], a[184:187], v[44:47], v[224:227]
    v_exp_f32 v5, v5
    v_mfma_f32_16x16x32_bf16 v[224:227], a[188:191], v[52:55], v[224:227]
    ds_read_b128 v[116:119], v99 offset:1536
    v_cvt_pk_bf16_f32 v168, v4, v5
    v_mfma_f32_16x16x32_bf16 v[60:63], a[192:195], v[108:111], 0
    ds_read_b128 v[108:111], v97 offset:1536
    v_fma_mix_f32 v8, v11, v17, v8 op_sel:[1,1,0] op_sel_hi:[1,1,0]
    v_mfma_f32_16x16x32_bf16 v[60:63], a[196:199], v[104:107], v[60:63]
    s_nop 0
    ds_read_b128 v[104:107], v99 offset:1664
    v_cvt_pk_bf16_f32 v4, v224, v225
    v_mfma_f32_16x16x32_bf16 v[60:63], a[200:203], v[100:103], v[60:63]
    ds_read_b128 v[100:103], v97 offset:1664
    v_cvt_pk_bf16_f32 v5, v226, v227
    v_mfma_f32_16x16x32_bf16 v[60:63], a[204:207], v[84:87], v[60:63]
    ds_read_b128 v[84:87], v99 offset:1792
    v_mov_b32 v99, v8
    v_mfma_f32_16x16x32_bf16 v[60:63], a[208:211], v[44:47], v[60:63]
    ds_read_b128 v[44:47], v97 offset:1792
    v_lshl_add_u32 v97, v9, 4, s93
    v_mfma_f32_16x16x32_bf16 v[60:63], a[212:215], v[52:55], v[60:63]
    s_lshl_b32 s93, s68, 10
    v_exp_f32 v6, v6
    v_mfma_f32_16x16x32_f16 v[52:55], v[64:67], v[40:43], v[180:183]
    s_nop 0
    v_exp_f32 v7, v7
    v_mfma_f32_16x16x32_f16 v[52:55], v[152:155], v[138:141], v[52:55]
    s_nop 0
    v_cvt_pk_bf16_f32 v169, v6, v7
    v_cvt_pk_bf16_f32 v6, v60, v61
    v_mfma_f32_16x16x32_f16 v[64:67], v[112:115], v[40:43], v[176:179]
    v_cvt_pk_bf16_f32 v7, v62, v63
    v_add_u32 v18, s93, v129
    v_mfma_f32_16x16x32_f16 v[64:67], v[146:149], v[138:141], v[64:67]
    v_exp_f32 v76, v76
    v_mfma_f32_16x16x32_f16 v[60:63], v[72:75], v[40:43], v[172:175]
    v_cvt_pk_bf16_f32 v170, v76, 0
    v_add_u32 v137, s48, v137
    v_mfma_f32_16x16x32_f16 v[60:63], v[140:143], v[138:141], v[60:63]
    v_permlane32_swap_b32 v99, v8
    v_mfma_f32_16x16x32_bf16 v[76:79], v[220:223], v[92:95], 0
    s_waitcnt lgkmcnt(0)
    v_add_f32 v8, v99, v8
    v_mov_b32 v99, v8
    v_mfma_f32_16x16x32_bf16 v[76:79], v[220:223], v[168:171], v[76:79]
    s_barrier
    global_load_dword v19, v122, s[38:39] offset:248 sc1
    v_add_u32 v136, s48, v136
    v_mfma_f32_16x16x32_bf16 v[40:43], v[116:119], a[144:147], 0
    v_permlane16_swap_b32 v99, v8
    v_mfma_f32_16x16x32_bf16 v[40:43], v[108:111], a[148:151], v[40:43]
    buffer_load_dwordx4 v128, s[24:27], s56 offen nt lds
    v_add_f32 v8, v99, v8
    v_mfma_f32_16x16x32_bf16 v[40:43], v[104:107], a[152:155], v[40:43]
    s_add_u32 m0, s67, 1024
    v_rcp_f32 v76, v76
    v_mfma_f32_16x16x32_bf16 v[40:43], v[100:103], a[156:159], v[40:43]
    buffer_load_dwordx4 v127, s[24:27], s56 offen nt lds
    v_add_f32 v8, s84, v8
    v_mfma_f32_16x16x32_bf16 v[40:43], v[84:87], a[160:163], v[40:43]
    s_add_u32 m0, s67, 2048
    v_exp_f32 v8, v8
    v_mfma_f32_16x16x32_bf16 v[40:43], v[44:47], a[164:167], v[40:43]
    buffer_load_dwordx4 v126, s[24:27], s56 offen nt lds
    v_cvt_pk_bf16_f32 v8, v8, 0
    v_mfma_f32_16x16x32_bf16 v[112:115], v[116:119], a[168:171], 0
    s_add_u32 m0, s67, 3072
    v_exp_f32 v52, v52
    v_mfma_f32_16x16x32_bf16 v[112:115], v[108:111], a[172:175], v[112:115]
    buffer_load_dwordx4 v125, s[24:27], s56 offen nt lds
    v_cmp_gt_u32 vcc, 16, v9
    v_mfma_f32_16x16x32_bf16 v[112:115], v[104:107], a[176:179], v[112:115]
    s_add_u32 m0, s67, 4096
    v_cndmask_b32 v8, 0, v8, vcc
    v_cvt_pk_bf16_f32 v2, v40, v41
    v_mfma_f32_16x16x32_bf16 v[112:115], v[100:103], a[180:183], v[112:115]
    buffer_load_dwordx4 v124, s[24:27], s56 offen nt lds
    v_cvt_pk_bf16_f32 v3, v42, v43
    v_mfma_f32_16x16x32_bf16 v[112:115], v[84:87], a[184:187], v[112:115]
    v_exp_f32 v53, v53
    v_mfma_f32_16x16x32_bf16 v[112:115], v[44:47], a[188:191], v[112:115]
    s_nop 0
    v_exp_f32 v54, v54
    v_mfma_f32_16x16x32_bf16 v[40:43], v[0:3], v[92:95], 0
    s_nop 0
    v_exp_f32 v55, v55
    v_mfma_f32_16x16x32_bf16 v[40:43], v[164:167], v[168:171], v[40:43]
    s_nop 0
    v_cvt_pk_bf16_f32 v52, v52, v53
    v_cvt_pk_bf16_f32 v58, v112, v113
    v_mfma_f32_16x16x32_bf16 v[72:75], v[116:119], a[192:195], 0
    v_cvt_pk_bf16_f32 v59, v114, v115
    v_cvt_pk_bf16_f32 v53, v54, v55
    v_mfma_f32_16x16x32_bf16 v[72:75], v[108:111], a[196:199], v[72:75]
    s_nop 0
    v_mul_f32 v40, v40, v76
    v_mul_f32 v41, v41, v76
    v_mfma_f32_16x16x32_bf16 v[72:75], v[104:107], a[200:203], v[72:75]
    v_cvt_pk_bf16_f32 v40, v40, v41
    v_mul_f32 v42, v42, v76
    v_mfma_f32_16x16x32_bf16 v[72:75], v[100:103], a[204:207], v[72:75]
    v_exp_f32 v64, v64
    v_mfma_f32_16x16x32_bf16 v[72:75], v[84:87], a[208:211], v[72:75]
    v_exp_f32 v65, v65
    v_mfma_f32_16x16x32_bf16 v[72:75], v[44:47], a[212:215], v[72:75]
    s_nop 0
    v_mul_f32 v43, v43, v76
    v_cvt_pk_bf16_f32 v41, v42, v43
    v_mfma_f32_16x16x32_bf16 v[44:47], v[56:59], v[92:95], 0
L_pg1:
    s_cbranch_execz L_main
    s_nop 0
    ds_write_b64 v135, v[40:41] offset:0
    v_mfma_f32_16x16x32_bf16 v[44:47], v[160:163], v[168:171], v[44:47]
    s_nop 0
    v_cvt_pk_bf16_f32 v50, v72, v73
    v_cvt_pk_bf16_f32 v51, v74, v75
    v_mfma_f32_16x16x32_bf16 v[72:75], v[88:91], v[0:3], 0
    s_nop 0
    v_exp_f32 v66, v66
    v_mfma_f32_16x16x32_bf16 v[72:75], v[80:83], v[164:167], v[72:75]
    s_nop 0
    v_mul_f32 v44, v44, v76
    v_mul_f32 v45, v45, v76
    v_mfma_f32_16x16x32_bf16 v[84:87], v[48:51], v[92:95], 0
    v_cvt_pk_bf16_f32 v42, v44, v45
    v_mul_f32 v46, v46, v76
    v_mfma_f32_16x16x32_bf16 v[84:87], v[156:159], v[168:171], v[84:87]
    s_nop 0
    v_mul_f32 v47, v47, v76
    v_cvt_pk_bf16_f32 v43, v46, v47
    v_mfma_f32_16x16x32_bf16 v[44:47], v[88:91], v[56:59], 0
    s_nop 0
    ds_write_b64 v135, v[42:43] offset:8
    v_mfma_f32_16x16x32_bf16 v[44:47], v[80:83], v[160:163], v[44:47]
    s_nop 0
    v_mul_f32 v84, v84, v76
    v_mul_f32 v85, v85, v76
    v_mfma_f32_16x16x32_bf16 v[40:43], v[88:91], v[48:51], 0
    v_cvt_pk_bf16_f32 v54, v84, v85
    v_mul_f32 v86, v86, v76
    v_mfma_f32_16x16x32_bf16 v[40:43], v[80:83], v[156:159], v[40:43]
    ds_write_b32 v134, v54 offset:0
    v_mul_f32 v87, v87, v76
    v_cvt_pk_bf16_f32 v55, v86, v87
    v_cvt_pk_bf16_f32 v168, v24, v25
    v_cvt_pk_bf16_f32 v169, v26, v27
    v_cvt_pk_bf16_f32 v170, v13, 0
    v_mfma_f32_16x16x32_bf16 v[24:27], v[220:223], v[68:71], 0
    ds_write_b32 v134, v55 offset:4
    v_mfma_f32_16x16x32_bf16 v[24:27], v[220:223], v[168:171], v[24:27]
    v_mov_b32 v152, 0
    v_mov_b32 v153, 0
    v_mfma_f32_16x16x32_bf16 v[12:15], v[0:3], v[68:71], 0
    v_mov_b32 v9, 0
    v_add_u32 v99, 0, v98
    v_mfma_f32_16x16x32_bf16 v[12:15], v[164:167], v[168:171], v[12:15]
    v_mov_b32_dpp v75, v47 quad_perm:[0,1,2,3] row_mask:0x2 bank_mask:0xf
    v_cvt_pk_bf16_f32 v54, v64, v65
    v_mfma_f32_16x16x32_bf16 v[44:47], v[56:59], v[68:71], 0
    v_exp_f32 v67, v67
    v_mfma_f32_16x16x32_bf16 v[44:47], v[160:163], v[168:171], v[44:47]
    v_mov_b32_dpp v75, v43 quad_perm:[0,1,2,3] row_mask:0x4 bank_mask:0xf
    v_cvt_pk_bf16_f32 v75, v75, v75
    v_mfma_f32_16x16x32_bf16 v[40:43], v[48:51], v[68:71], 0
    ds_write_b16 v131, v75
    v_mfma_f32_16x16x32_bf16 v[40:43], v[156:159], v[168:171], v[40:43]
    v_exp_f32 v60, v60
    v_cvt_pk_bf16_f32 v55, v66, v67
    v_exp_f32 v61, v61
    v_exp_f32 v62, v62
    v_exp_f32 v63, v63
    v_cvt_pk_bf16_f32 v168, v60, v61
    v_cvt_pk_bf16_f32 v169, v62, v63
    v_exp_f32 v38, v38
    v_rcp_f32 v24, v24
    v_cvt_pk_bf16_f32 v170, v38, 0
    v_mfma_f32_16x16x32_bf16 v[36:39], v[220:223], v[52:55], 0
    s_waitcnt vmcnt(5)
    v_readfirstlane_b32 s94, v19
    s_nop 1
    s_cmp_lt_u32 s94, 3
    s_cbranch_scc1 L_spin
L_spinr:
    v_mfma_f32_16x16x32_bf16 v[36:39], v[220:223], v[168:171], v[36:39]
    buffer_load_dwordx4 a[216:219], v97, s[76:79], s92 offen offset:0 sc1
    v_and_b32 v19, 0xb8000000, v123
    v_mfma_f32_16x16x32_bf16 v[64:67], v[0:3], v[52:55], 0
    v_cmp_ne_u32 s[94:95], 0, v19
    v_mul_f32 v12, v12, v24
    v_mfma_f32_16x16x32_bf16 v[64:67], v[164:167], v[168:171], v[64:67]
    s_or_b32 s94, s94, s95
    buffer_load_dwordx4 a[220:223], v97, s[76:79], s92 offen offset:1024 sc1
    v_mov_b32 v19, s94
    v_mfma_f32_16x16x32_bf16 v[0:3], v[56:59], v[52:55], 0
    s_lshl_b32 s95, s68, 2
    v_mov_b32 v154, s95
    v_mul_f32 v13, v13, v24
    v_mfma_f32_16x16x32_bf16 v[0:3], v[160:163], v[168:171], v[0:3]
    buffer_load_dwordx4 a[224:227], v97, s[76:79], s92 offen offset:2048 sc1
    v_cvt_pk_bf16_f32 v12, v12, v13
    v_mfma_f32_16x16x32_bf16 v[146:149], v[48:51], v[52:55], 0
    ds_write_b32 v154, v19 offset:14848
    v_mfma_f32_16x16x32_bf16 v[146:149], v[156:159], v[168:171], v[146:149]
    buffer_load_dwordx4 a[228:231], v97, s[76:79], s92 offen offset:3072 sc1
    v_mul_f32 v14, v14, v24
    v_mul_f32 v15, v15, v24
    v_cvt_pk_bf16_f32 v13, v14, v15
    s_movk_i32 s92, 4096
    v_mul_f32 v44, v44, v24
    v_mul_f32 v45, v45, v24
    v_cvt_pk_bf16_f32 v14, v44, v45
    buffer_load_dwordx4 a[232:235], v97, s[76:79], s92 offen offset:0 sc1
    v_mul_f32 v46, v46, v24
    v_mul_f32 v47, v47, v24
    v_cvt_pk_bf16_f32 v15, v46, v47
    v_mul_f32 v40, v40, v24
    v_mul_f32 v41, v41, v24
    v_cvt_pk_bf16_f32 v154, v40, v41
    v_mul_f32 v42, v42, v24
    buffer_load_dwordx4 a[236:239], v97, s[76:79], s92 offen offset:1024 sc1
    ds_write_b32 v135, v12 offset:1536
    v_mul_f32 v43, v43, v24
    v_cvt_pk_bf16_f32 v155, v42, v43
    buffer_load_dwordx4 a[240:243], v97, s[76:79], s92 offen offset:2048 sc1
    s_waitcnt lgkmcnt(1)
    s_barrier
    ds_read_b128 v[24:27], v122 offset:14848
    ds_write_b128 v18, v[32:35] offset:6144
    buffer_load_dwordx4 a[244:247], v97, s[76:79], s92 offen offset:3072 sc1
    s_movk_i32 s92, 8192
    ds_write_b128 v99, v[28:31]
    ds_write2_b64 v99, v[152:153], v[152:153] offset0:2 offset1:3
    buffer_load_dwordx4 a[248:251], v97, s[76:79], s92 offen offset:0 sc1
    s_waitcnt lgkmcnt(2)
    v_or3_b32 v24, v24, v25, v26
    v_or_b32 v24, v24, v27
    s_nop 0
    v_readfirstlane_b32 s75, v24
    ds_write_b128 v99, v[20:23] offset:32
    ds_write2_b64 v99, v[16:17], v[152:153] offset0:6 offset1:7
    ds_write2_b64 v99, v[152:153], v[10:11] offset0:8 offset1:9
    ds_write_b64 v99, v[8:9] offset:88
    ds_write_b64 v98, v[120:121] offset:80
    ds_write_b128 v98, v[4:7] offset:96
    ds_read_b128 v[84:87], v137 offset:0
    ds_read_b128 v[108:111], v136 offset:0
    buffer_load_dwordx4 a[252:255], v97, s[76:79], s92 offen offset:1024 sc1
    ds_read_b128 v[8:11], v137 offset:128
    ds_read_b128 v[112:115], v136 offset:128
    ds_read_b128 v[40:43], v137 offset:256
    ds_read_b128 v[52:55], v136 offset:256
    ds_read_b128 v[68:71], v137 offset:1536
    buffer_load_dwordx4 v[224:227], v97, s[76:79], s92 offen offset:2048 sc1
    ds_read_b128 v[60:63], v136 offset:1536
    ds_read_b128 v[98:101], v137 offset:1664
    s_waitcnt lgkmcnt(8)
    v_mfma_f32_16x16x32_bf16 v[28:31], a[0:3], v[84:87], 0
    ds_read_b128 v[104:107], v136 offset:1792
    buffer_load_dwordx4 v[228:231], v97, s[76:79], s92 offen offset:3072 sc1
    s_movk_i32 s92, 12288
    buffer_load_dwordx4 v[232:235], v97, s[76:79], s92 offen offset:0 sc1
    buffer_load_dwordx4 v[236:239], v97, s[76:79], s92 offen offset:1024 sc1
    buffer_load_dwordx4 v[240:243], v97, s[76:79], s92 offen offset:2048 sc1
    buffer_load_dwordx4 v[244:247], v97, s[76:79], s92 offen offset:3072 sc1
    s_movk_i32 s92, 16384
    buffer_load_dwordx4 v[248:251], v97, s[76:79], s92 offen offset:0 sc1
    buffer_load_dwordx4 v[252:255], v97, s[76:79], s92 offen offset:1024 sc1
    s_waitcnt lgkmcnt(0)
    s_cmp_lg_u32 s75, 0
    s_cbranch_scc0 L_loopF0
    s_branch L_slow
L_bndF:
    s_movk_i32 s73, 20
    s_movk_i32 s71, 18
    s_movk_i32 s70, -20
    s_mov_b32 s74, 0
    s_bitcmp1_b32 s2, 2
    s_cbranch_scc1 L_bndcF
    s_sub_u32 s94, s2, 248
    s_mul_i32 s69, s94, 18
    s_mov_b32 s74, 2
    s_sub_u32 s93, s93, 1373568
    v_cmp_le_u32 vcc, 4, v130
    v_add_u32 v120, 98896896, v128
    v_subrev_u32 v121, 1373568, v128
    v_cndmask_b32 v128, v120, v121, vcc
    v_cmp_le_u32 vcc, 4, v129
    v_add_u32 v120, 98896896, v127
    v_subrev_u32 v121, 1373568, v127
    v_cndmask_b32 v127, v120, v121, vcc
    v_cmp_le_u32 vcc, 4, v18
    v_add_u32 v120, 98896896, v126
    v_subrev_u32 v121, 1373568, v126
    v_cndmask_b32 v126, v120, v121, vcc
    v_cmp_le_u32 vcc, 4, v10
    v_add_u32 v120, 98896896, v125
    v_subrev_u32 v121, 1373568, v125
    v_cndmask_b32 v125, v120, v121, vcc
    v_cmp_le_u32 vcc, 4, v35
    v_add_u32 v120, 98896896, v124
    v_subrev_u32 v121, 1373568, v124
    v_cndmask_b32 v124, v120, v121, vcc
    s_cmp_lt_u32 s2, 256
    s_cbranch_scc1 L_bndrF
L_bndcF:
    s_sub_u32 s94, s2, 252
    s_mul_i32 s69, s94, 20
    s_lshr_b32 s71, s94, 1
    s_sub_u32 s69, s69, s71
    s_and_b32 s94, s94, 1
    s_sub_u32 s71, 20, s94
    s_cmp_eq_u32 s2, 255
    s_cselect_b32 s71, 13, s71
    s_mov_b32 s62, 1373568
    s_add_u32 s74, s74, 1
    s_sub_u32 s93, s93, 2688
    v_mad_i32_i24 v120, v130, -7, v32
    v_cmp_le_u32 vcc, 4, v120
    v_add_u32 v120, 193536, v128
    v_subrev_u32 v121, 2688, v128
    v_cndmask_b32 v128, v120, v121, vcc
    v_mad_i32_i24 v120, v129, -7, v99
    v_cmp_le_u32 vcc, 4, v120
    v_add_u32 v120, 193536, v127
    v_subrev_u32 v121, 2688, v127
    v_cndmask_b32 v127, v120, v121, vcc
    v_mad_i32_i24 v120, v18, -7, v97
    v_cmp_le_u32 vcc, 4, v120
    v_add_u32 v120, 193536, v126
    v_subrev_u32 v121, 2688, v126
    v_cndmask_b32 v126, v120, v121, vcc
    v_mad_i32_i24 v120, v10, -7, v11
    v_cmp_le_u32 vcc, 4, v120
    v_add_u32 v120, 193536, v125
    v_subrev_u32 v121, 2688, v125
    v_cndmask_b32 v125, v120, v121, vcc
    v_mad_i32_i24 v120, v35, -7, v8
    v_cmp_le_u32 vcc, 4, v120
    v_add_u32 v120, 193536, v124
    v_subrev_u32 v121, 2688, v124
    v_cndmask_b32 v124, v120, v121, vcc
    s_cmp_eq_u32 s2, 256
    s_cselect_b32 s62, 0, s62
    s_cselect_b32 s69, 0, s69
    s_cselect_b32 s71, 2, s71
    s_branch L_bndrF
L_maskF:
    s_and_b32 s20, s74, 2
    s_and_b32 s21, s74, 1
    s_mov_b32 s22, 0xc31044fe
    v_lshrrev_b32 v72, 2, v46
    v_add_u32 v72, 0, v72
    v_mul_u32_u24 v109, 37, v72
    v_lshrrev_b32 v95, 8, v109
    v_mad_i32_i24 v95, v95, -7, v72
    v_lshrrev_b32 v109, 10, v109
    v_lshrrev_b32 v95, 2, v95
    v_mul_u32_u24 v109, s20, v109
    v_mad_u32_u24 v72, v95, s21, v109
    v_cvt_f32_u32 v72, v72
    v_lshrrev_b32 v73, 2, v46
    v_add_u32 v73, 4, v73
    v_mul_u32_u24 v109, 37, v73
    v_lshrrev_b32 v95, 8, v109
    v_mad_i32_i24 v95, v95, -7, v73
    v_lshrrev_b32 v109, 10, v109
    v_lshrrev_b32 v95, 2, v95
    v_mul_u32_u24 v109, s20, v109
    v_mad_u32_u24 v73, v95, s21, v109
    v_cvt_f32_u32 v73, v73
    v_lshrrev_b32 v47, 2, v46
    v_add_u32 v47, 8, v47
    v_mul_u32_u24 v109, 37, v47
    v_lshrrev_b32 v95, 8, v109
    v_mad_i32_i24 v95, v95, -7, v47
    v_lshrrev_b32 v109, 10, v109
    v_lshrrev_b32 v95, 2, v95
    v_mul_u32_u24 v109, s20, v109
    v_mad_u32_u24 v47, v95, s21, v109
    v_cvt_f32_u32 v47, v47
    v_mad_u32_u24 v8, v96, 12, 0
    v_mul_u32_u24 v109, 37, v8
    v_lshrrev_b32 v95, 8, v109
    v_mad_i32_i24 v95, v95, -7, v8
    v_lshrrev_b32 v109, 10, v109
    v_lshrrev_b32 v95, 2, v95
    v_mul_u32_u24 v109, s20, v109
    v_mad_u32_u24 v8, v95, s21, v109
    v_cvt_f32_u32 v8, v8
    v_sub_f32 v109, v72, v8
    v_mul_f32 v109, v109, v109 clamp
    v_fmac_f32 v204, s22, v109
    v_sub_f32 v109, v73, v8
    v_mul_f32 v109, v109, v109 clamp
    v_fmac_f32 v192, s22, v109
    v_sub_f32 v109, v47, v8
    v_mul_f32 v109, v109, v109 clamp
    v_fmac_f32 v180, s22, v109
    v_mad_u32_u24 v8, v96, 12, 1
    v_mul_u32_u24 v109, 37, v8
    v_lshrrev_b32 v95, 8, v109
    v_mad_i32_i24 v95, v95, -7, v8
    v_lshrrev_b32 v109, 10, v109
    v_lshrrev_b32 v95, 2, v95
    v_mul_u32_u24 v109, s20, v109
    v_mad_u32_u24 v8, v95, s21, v109
    v_cvt_f32_u32 v8, v8
    v_sub_f32 v109, v72, v8
    v_mul_f32 v109, v109, v109 clamp
    v_fmac_f32 v205, s22, v109
    v_sub_f32 v109, v73, v8
    v_mul_f32 v109, v109, v109 clamp
    v_fmac_f32 v193, s22, v109
    v_sub_f32 v109, v47, v8
    v_mul_f32 v109, v109, v109 clamp
    v_fmac_f32 v181, s22, v109
    v_mad_u32_u24 v8, v96, 12, 2
    v_mul_u32_u24 v109, 37, v8
    v_lshrrev_b32 v95, 8, v109
    v_mad_i32_i24 v95, v95, -7, v8
    v_lshrrev_b32 v109, 10, v109
    v_lshrrev_b32 v95, 2, v95
    v_mul_u32_u24 v109, s20, v109
    v_mad_u32_u24 v8, v95, s21, v109
    v_cvt_f32_u32 v8, v8
    v_sub_f32 v109, v72, v8
    v_mul_f32 v109, v109, v109 clamp
    v_fmac_f32 v206, s22, v109
    v_sub_f32 v109, v73, v8
    v_mul_f32 v109, v109, v109 clamp
    v_fmac_f32 v194, s22, v109
    v_sub_f32 v109, v47, v8
    v_mul_f32 v109, v109, v109 clamp
    v_fmac_f32 v182, s22, v109
    v_mad_u32_u24 v8, v96, 12, 3
    v_mul_u32_u24 v109, 37, v8
    v_lshrrev_b32 v95, 8, v109
    v_mad_i32_i24 v95, v95, -7, v8
    v_lshrrev_b32 v109, 10, v109
    v_lshrrev_b32 v95, 2, v95
    v_mul_u32_u24 v109, s20, v109
    v_mad_u32_u24 v8, v95, s21, v109
    v_cvt_f32_u32 v8, v8
    v_sub_f32 v109, v72, v8
    v_mul_f32 v109, v109, v109 clamp
    v_fmac_f32 v207, s22, v109
    v_sub_f32 v109, v73, v8
    v_mul_f32 v109, v109, v109 clamp
    v_fmac_f32 v195, s22, v109
    v_sub_f32 v109, v47, v8
    v_mul_f32 v109, v109, v109 clamp
    v_fmac_f32 v183, s22, v109
    v_mad_u32_u24 v8, v96, 12, 4
    v_mul_u32_u24 v109, 37, v8
    v_lshrrev_b32 v95, 8, v109
    v_mad_i32_i24 v95, v95, -7, v8
    v_lshrrev_b32 v109, 10, v109
    v_lshrrev_b32 v95, 2, v95
    v_mul_u32_u24 v109, s20, v109
    v_mad_u32_u24 v8, v95, s21, v109
    v_cvt_f32_u32 v8, v8
    v_sub_f32 v109, v72, v8
    v_mul_f32 v109, v109, v109 clamp
    v_fmac_f32 v200, s22, v109
    v_sub_f32 v109, v73, v8
    v_mul_f32 v109, v109, v109 clamp
    v_fmac_f32 v188, s22, v109
    v_sub_f32 v109, v47, v8
    v_mul_f32 v109, v109, v109 clamp
    v_fmac_f32 v176, s22, v109
    v_mad_u32_u24 v8, v96, 12, 5
    v_mul_u32_u24 v109, 37, v8
    v_lshrrev_b32 v95, 8, v109
    v_mad_i32_i24 v95, v95, -7, v8
    v_lshrrev_b32 v109, 10, v109
    v_lshrrev_b32 v95, 2, v95
    v_mul_u32_u24 v109, s20, v109
    v_mad_u32_u24 v8, v95, s21, v109
    v_cvt_f32_u32 v8, v8
    v_sub_f32 v109, v72, v8
    v_mul_f32 v109, v109, v109 clamp
    v_fmac_f32 v201, s22, v109
    v_sub_f32 v109, v73, v8
    v_mul_f32 v109, v109, v109 clamp
    v_fmac_f32 v189, s22, v109
    v_sub_f32 v109, v47, v8
    v_mul_f32 v109, v109, v109 clamp
    v_fmac_f32 v177, s22, v109
    v_mad_u32_u24 v8, v96, 12, 6
    v_mul_u32_u24 v109, 37, v8
    v_lshrrev_b32 v95, 8, v109
    v_mad_i32_i24 v95, v95, -7, v8
    v_lshrrev_b32 v109, 10, v109
    v_lshrrev_b32 v95, 2, v95
    v_mul_u32_u24 v109, s20, v109
    v_mad_u32_u24 v8, v95, s21, v109
    v_cvt_f32_u32 v8, v8
    v_sub_f32 v109, v72, v8
    v_mul_f32 v109, v109, v109 clamp
    v_fmac_f32 v202, s22, v109
    v_sub_f32 v109, v73, v8
    v_mul_f32 v109, v109, v109 clamp
    v_fmac_f32 v190, s22, v109
    v_sub_f32 v109, v47, v8
    v_mul_f32 v109, v109, v109 clamp
    v_fmac_f32 v178, s22, v109
    v_mad_u32_u24 v8, v96, 12, 7
    v_mul_u32_u24 v109, 37, v8
    v_lshrrev_b32 v95, 8, v109
    v_mad_i32_i24 v95, v95, -7, v8
    v_lshrrev_b32 v109, 10, v109
    v_lshrrev_b32 v95, 2, v95
    v_mul_u32_u24 v109, s20, v109
    v_mad_u32_u24 v8, v95, s21, v109
    v_cvt_f32_u32 v8, v8
    v_sub_f32 v109, v72, v8
    v_mul_f32 v109, v109, v109 clamp
    v_fmac_f32 v203, s22, v109
    v_sub_f32 v109, v73, v8
    v_mul_f32 v109, v109, v109 clamp
    v_fmac_f32 v191, s22, v109
    v_sub_f32 v109, v47, v8
    v_mul_f32 v109, v109, v109 clamp
    v_fmac_f32 v179, s22, v109
    v_mad_u32_u24 v8, v96, 12, 8
    v_mul_u32_u24 v109, 37, v8
    v_lshrrev_b32 v95, 8, v109
    v_mad_i32_i24 v95, v95, -7, v8
    v_lshrrev_b32 v109, 10, v109
    v_lshrrev_b32 v95, 2, v95
    v_mul_u32_u24 v109, s20, v109
    v_mad_u32_u24 v8, v95, s21, v109
    v_cvt_f32_u32 v8, v8
    v_sub_f32 v109, v72, v8
    v_mul_f32 v109, v109, v109 clamp
    v_fmac_f32 v196, s22, v109
    v_sub_f32 v109, v73, v8
    v_mul_f32 v109, v109, v109 clamp
    v_fmac_f32 v184, s22, v109
    v_sub_f32 v109, v47, v8
    v_mul_f32 v109, v109, v109 clamp
    v_fmac_f32 v172, s22, v109
    v_mad_u32_u24 v8, v96, 12, 9
    v_mul_u32_u24 v109, 37, v8
    v_lshrrev_b32 v95, 8, v109
    v_mad_i32_i24 v95, v95, -7, v8
    v_lshrrev_b32 v109, 10, v109
    v_lshrrev_b32 v95, 2, v95
    v_mul_u32_u24 v109, s20, v109
    v_mad_u32_u24 v8, v95, s21, v109
    v_cvt_f32_u32 v8, v8
    v_sub_f32 v109, v72, v8
    v_mul_f32 v109, v109, v109 clamp
    v_fmac_f32 v197, s22, v109
    v_sub_f32 v109, v73, v8
    v_mul_f32 v109, v109, v109 clamp
    v_fmac_f32 v185, s22, v109
    v_sub_f32 v109, v47, v8
    v_mul_f32 v109, v109, v109 clamp
    v_fmac_f32 v173, s22, v109
    v_mad_u32_u24 v8, v96, 12, 10
    v_mul_u32_u24 v109, 37, v8
    v_lshrrev_b32 v95, 8, v109
    v_mad_i32_i24 v95, v95, -7, v8
    v_lshrrev_b32 v109, 10, v109
    v_lshrrev_b32 v95, 2, v95
    v_mul_u32_u24 v109, s20, v109
    v_mad_u32_u24 v8, v95, s21, v109
    v_cvt_f32_u32 v8, v8
    v_sub_f32 v109, v72, v8
    v_mul_f32 v109, v109, v109 clamp
    v_fmac_f32 v198, s22, v109
    v_sub_f32 v109, v73, v8
    v_mul_f32 v109, v109, v109 clamp
    v_fmac_f32 v186, s22, v109
    v_sub_f32 v109, v47, v8
    v_mul_f32 v109, v109, v109 clamp
    v_fmac_f32 v174, s22, v109
    v_mad_u32_u24 v8, v96, 12, 11
    v_mul_u32_u24 v109, 37, v8
    v_lshrrev_b32 v95, 8, v109
    v_mad_i32_i24 v95, v95, -7, v8
    v_lshrrev_b32 v109, 10, v109
    v_lshrrev_b32 v95, 2, v95
    v_mul_u32_u24 v109, s20, v109
    v_mad_u32_u24 v8, v95, s21, v109
    v_cvt_f32_u32 v8, v8
    v_sub_f32 v109, v72, v8
    v_mul_f32 v109, v109, v109 clamp
    v_fmac_f32 v199, s22, v109
    v_sub_f32 v109, v73, v8
    v_mul_f32 v109, v109, v109 clamp
    v_fmac_f32 v187, s22, v109
    v_sub_f32 v109, v47, v8
    v_mul_f32 v109, v109, v109 clamp
    v_fmac_f32 v175, s22, v109
    v_cvt_f32_u32 v8, s74
    v_sub_f32 v109, v72, v8
    v_mul_f32 v109, v109, v109 clamp
    v_fmac_f32 v208, s22, v109
    v_sub_f32 v109, v73, v8
    v_mul_f32 v109, v109, v109 clamp
    v_fmac_f32 v209, s22, v109
    v_sub_f32 v109, v47, v8
    v_mul_f32 v109, v109, v109 clamp
    v_fmac_f32 v210, s22, v109
    v_lshrrev_b32 v72, 2, v46
    v_lshl_add_u32 v72, v96, 2, v72
    v_add_u32 v109, 1, v96
    v_lshrrev_b32 v109, 2, v109
    v_mad_u32_u24 v72, v109, 36, v72
    v_min_u32 v72, 48, v72
    v_mul_u32_u24 v109, 37, v72
    v_lshrrev_b32 v95, 8, v109
    v_mad_i32_i24 v95, v95, -7, v72
    v_lshrrev_b32 v109, 10, v109
    v_lshrrev_b32 v95, 2, v95
    v_mul_u32_u24 v109, s20, v109
    v_mad_u32_u24 v72, v95, s21, v109
    v_cvt_f32_u32 v72, v72
    v_sub_f32 v109, v72, v8
    v_mul_f32 v109, v109, v109 clamp
    v_fmac_f32 v211, s22, v109
    s_branch L_nomaskF
L_spin:
    s_movk_i32 s95, 300
L_spin1:
    global_load_dword v19, v122, s[38:39] offset:248 sc1
    s_waitcnt vmcnt(0)
    v_readfirstlane_b32 s94, v19
    s_nop 1
    s_cmp_ge_u32 s94, 3
    s_cbranch_scc1 L_spinr
    s_sub_u32 s95, s95, 1
    s_cmp_lg_u32 s95, 0
    s_cbranch_scc1 L_spin1
    v_mov_b32 v123, -1
    s_branch L_spinr
.fill 614, 4, 0xbf800000
L_atomF0:
    s_cbranch_execz L_main
    v_mov_b32 v122, 0x800000
    buffer_atomic_add v122, v129, s[8:11], 0 offen sc0 sc1
    s_branch L_atomF0r
.p2align 6
L_loopF0:
    v_mfma_f32_16x16x32_bf16 v[28:31], a[4:7], v[108:111], v[28:31]
    ds_write_b32 v135, v13 offset:1540
    v_mfma_f32_16x16x32_bf16 v[28:31], a[8:11], v[8:11], v[28:31]
    v_rcp_f32 v36, v36
    v_mfma_f32_16x16x32_bf16 v[28:31], a[12:15], v[112:115], v[28:31]
    v_mul_f32 v64, v64, v36
    v_mul_f32 v65, v65, v36
    v_mfma_f32_16x16x32_bf16 v[28:31], a[16:19], v[40:43], v[28:31]
    ds_read_b128 v[76:79], v136 offset:1664
    v_cvt_pk_bf16_f32 v4, v64, v65
    v_mfma_f32_16x16x32_bf16 v[28:31], a[20:23], v[52:55], v[28:31]
    v_mul_f32 v66, v66, v36
    v_mul_f32 v67, v67, v36
    v_mfma_f32_16x16x32_bf16 v[16:19], v[84:87], a[168:171], 0
    v_cvt_pk_bf16_f32 v5, v66, v67
    v_mul_f32 v0, v0, v36
    v_mfma_f32_16x16x32_bf16 v[16:19], v[108:111], a[172:175], v[16:19]
    v_mul_f32 v1, v1, v36
    v_cvt_pk_bf16_f32 v6, v0, v1
    v_mfma_f32_16x16x32_bf16 v[16:19], v[8:11], a[176:179], v[16:19]
    ds_write_b64 v135, v[14:15] offset:1544
    v_mfma_f32_16x16x32_bf16 v[16:19], v[112:115], a[180:183], v[16:19]
    v_mul_f32 v2, v2, v36
    v_mul_f32 v3, v3, v36
    v_mfma_f32_16x16x32_bf16 v[16:19], v[40:43], a[184:187], v[16:19]
    v_cvt_pk_bf16_f32 v7, v2, v3
    v_mul_f32 v146, v146, v36
    v_mfma_f32_16x16x32_bf16 v[16:19], v[52:55], a[188:191], v[16:19]
    v_mul_f32 v147, v147, v36
    v_cvt_pk_bf16_f32 v152, v146, v147
    v_mfma_f32_16x16x32_bf16 v[12:15], a[120:123], v[84:87], 0
    ds_write_b64 v134, v[154:155] offset:1536
    v_mfma_f32_16x16x32_bf16 v[12:15], a[124:127], v[108:111], v[12:15]
    v_mul_f32 v148, v148, v36
    v_mul_f32 v149, v149, v36
    v_mfma_f32_16x16x32_bf16 v[12:15], a[128:131], v[8:11], v[12:15]
    v_cvt_pk_bf16_f32 v153, v148, v149
    v_fmac_f32 v32, v116, v116
    v_mfma_f32_16x16x32_bf16 v[12:15], a[132:135], v[112:115], v[12:15]
    ds_read_b128 v[92:95], v137 offset:1792
    v_fmac_f32 v32, v117, v117
    v_mfma_f32_16x16x32_bf16 v[12:15], a[136:139], v[40:43], v[12:15]
    v_fmac_f32 v32, v118, v118
    v_fmac_f32 v32, v119, v119
    v_mfma_f32_16x16x32_bf16 v[12:15], a[140:143], v[52:55], v[12:15]
    v_fma_f32 v154, v140, v140, s42
    v_fmac_f32 v154, v141, v141
    v_mfma_f32_16x16x32_bf16 v[0:3], a[48:51], v[84:87], 0
    v_fmac_f32 v154, v142, v142
    v_fmac_f32 v154, v143, v143
    v_mfma_f32_16x16x32_bf16 v[0:3], a[52:55], v[108:111], v[0:3]
    ds_write_b64 v135, v[4:5] offset:3072
    v_mfma_f32_16x16x32_bf16 v[0:3], a[56:59], v[8:11], v[0:3]
    v_fmac_f32 v154, v44, v44
    v_fmac_f32 v154, v45, v45
    v_mfma_f32_16x16x32_bf16 v[0:3], a[60:63], v[112:115], v[0:3]
    v_fmac_f32 v154, v46, v46
    v_fmac_f32 v154, v47, v47
    v_mfma_f32_16x16x32_bf16 v[0:3], a[64:67], v[40:43], v[0:3]
    v_fmac_f32 v154, v56, v56
    v_fmac_f32 v154, v57, v57
    v_mfma_f32_16x16x32_bf16 v[0:3], a[68:71], v[52:55], v[0:3]
    ds_write_b64 v135, v[6:7] offset:3080
    v_mfma_f32_16x16x32_bf16 v[4:7], a[24:27], v[84:87], 0
    v_fmac_f32 v154, v58, v58
    v_fmac_f32 v154, v59, v59
    v_mfma_f32_16x16x32_bf16 v[4:7], a[28:31], v[108:111], v[4:7]
    v_fma_f32 v155, v24, v24, s42
    v_fmac_f32 v155, v25, v25
    v_mfma_f32_16x16x32_bf16 v[4:7], a[32:35], v[8:11], v[4:7]
    v_fmac_f32 v155, v26, v26
    v_fmac_f32 v155, v27, v27
    v_mfma_f32_16x16x32_bf16 v[4:7], a[36:39], v[112:115], v[4:7]
    ds_write_b32 v134, v152 offset:3072
    v_mfma_f32_16x16x32_bf16 v[4:7], a[40:43], v[40:43], v[4:7]
    v_fmac_f32 v155, v88, v88
    v_fmac_f32 v155, v89, v89
    v_mfma_f32_16x16x32_bf16 v[4:7], a[44:47], v[52:55], v[4:7]
    v_fmac_f32 v155, v90, v90
    v_fmac_f32 v155, v91, v91
    v_mfma_f32_16x16x32_bf16 v[146:149], v[84:87], a[192:195], 0
    s_waitcnt vmcnt(10)
    v_fmac_f32 v155, v72, v72
    v_fmac_f32 v155, v73, v73
    v_mfma_f32_16x16x32_bf16 v[146:149], v[108:111], a[196:199], v[146:149]
    ds_write_b32 v134, v153 offset:3076
    v_mfma_f32_16x16x32_bf16 v[146:149], v[8:11], a[200:203], v[146:149]
    v_fmac_f32 v155, v74, v74
    v_fmac_f32 v155, v75, v75
    v_mfma_f32_16x16x32_bf16 v[146:149], v[112:115], a[204:207], v[146:149]
    v_cvt_pk_bf16_f32 v152, v32, v154
    v_cvt_pk_bf16_f32 v153, v155, v122
    v_mfma_f32_16x16x32_bf16 v[146:149], v[40:43], a[208:211], v[146:149]
    v_add_u32 v135, s49, v135
    v_add_u32 v134, s49, v134
    v_mfma_f32_16x16x32_bf16 v[146:149], v[52:55], a[212:215], v[146:149]
    ds_write_b64 v130, v[152:153]
    v_mfma_f32_16x16x32_bf16 v[32:35], a[72:75], v[84:87], 0
    v_cvt_pk_f16_f32 v28, v28, v29
    v_cvt_pk_f16_f32 v29, v30, v31
    v_mfma_f32_16x16x32_bf16 v[32:35], a[76:79], v[108:111], v[32:35]
    v_pk_fma_f16 v36, v28, v28, s3
    v_pk_fmac_f16 v36, v29, v29
    v_mfma_f32_16x16x32_bf16 v[32:35], a[80:83], v[8:11], v[32:35]
    v_cvt_pk_f16_f32 v154, v12, v13
    v_cvt_pk_f16_f32 v155, v14, v15
    v_mfma_f32_16x16x32_bf16 v[32:35], a[84:87], v[112:115], v[32:35]
    v_cvt_pk_f16_f32 v30, v4, v5
    v_cvt_pk_f16_f32 v31, v6, v7
    v_mfma_f32_16x16x32_bf16 v[32:35], a[88:91], v[40:43], v[32:35]
    v_pk_fmac_f16 v36, v30, v30
    v_pk_fmac_f16 v36, v31, v31
    v_mfma_f32_16x16x32_bf16 v[32:35], a[92:95], v[52:55], v[32:35]
    v_cvt_pk_bf16_f32 v4, v146, v147
    v_cvt_pk_bf16_f32 v5, v148, v149
    v_mfma_f32_16x16x32_bf16 v[146:149], a[96:99], v[84:87], 0
    v_cvt_pk_f16_f32 v152, v0, v1
    v_cvt_pk_f16_f32 v153, v2, v3
    v_mfma_f32_16x16x32_bf16 v[146:149], a[100:103], v[108:111], v[146:149]
    s_waitcnt lgkmcnt(0)
    v_pk_fmac_f16 v36, v152, v152
    v_pk_fmac_f16 v36, v153, v153
    v_mfma_f32_16x16x32_bf16 v[146:149], a[104:107], v[8:11], v[146:149]
    s_barrier
    ds_read_b128 v[0:3], v129 offset:0
    v_cvt_pk_f16_f32 v12, v32, v33
    v_mfma_f32_16x16x32_bf16 v[146:149], a[108:111], v[112:115], v[146:149]
    ds_read_b128 v[64:67], v129 offset:1024
    v_cvt_pk_f16_f32 v13, v34, v35
    v_mfma_f32_16x16x32_bf16 v[146:149], a[112:115], v[40:43], v[146:149]
    v_pk_fma_f16 v37, v12, v12, s3
    v_pk_fmac_f16 v37, v13, v13
    v_mfma_f32_16x16x32_bf16 v[146:149], a[116:119], v[52:55], v[146:149]
    s_nop 1
    v_mfma_f32_16x16x32_bf16 v[32:35], v[84:87], a[144:147], 0
    s_nop 2
    v_mfma_f32_16x16x32_bf16 v[32:35], v[108:111], a[148:151], v[32:35]
    s_nop 0
    v_cvt_pk_f16_f32 v14, v146, v147
    v_cvt_pk_f16_f32 v15, v148, v149
    v_mfma_f32_16x16x32_bf16 v[32:35], v[8:11], a[152:155], v[32:35]
    v_pk_fmac_f16 v37, v14, v14
    v_pk_fmac_f16 v37, v15, v15
    v_mfma_f32_16x16x32_bf16 v[32:35], v[112:115], a[156:159], v[32:35]
    v_pk_fmac_f16 v37, v154, v154
    v_pk_fmac_f16 v37, v155, v155
    v_mfma_f32_16x16x32_bf16 v[32:35], v[40:43], a[160:163], v[32:35]
    v_mfma_f32_16x16x32_bf16 v[32:35], v[52:55], a[164:167], v[32:35]
    s_waitcnt lgkmcnt(1)
    v_readfirstlane_b32 s12, v1
    v_mfma_f32_16x16x32_bf16 v[84:87], v[216:219], v[0:3], 0
    s_waitcnt lgkmcnt(0)
    s_nop 1
    v_mfma_f32_16x16x32_bf16 v[84:87], v[216:219], v[64:67], v[84:87]
    s_lshr_b32 s12, s12, 23
    v_cvt_pk_bf16_f32 v0, v32, v33
    v_cvt_pk_bf16_f32 v1, v34, v35
    v_mfma_f32_16x16x32_bf16 v[32:35], a[96:99], v[68:71], 0
    s_nop 1
    v_mfma_f32_16x16x32_bf16 v[32:35], a[100:103], v[60:63], v[32:35]
    s_nop 0
    v_rsq_f32 v84, v84
    v_mfma_f32_16x16x32_bf16 v[32:35], a[104:107], v[98:101], v[32:35]
    v_rsq_f32 v85, v85
    v_mfma_f32_16x16x32_bf16 v[32:35], a[108:111], v[76:79], v[32:35]
    v_rsq_f32 v86, v86
    v_mfma_f32_16x16x32_bf16 v[32:35], a[112:115], v[92:95], v[32:35]
    v_mul_f32 v84, s43, v84
    v_mul_f32 v85, s43, v85
    v_mfma_f32_16x16x32_bf16 v[32:35], a[116:119], v[104:107], v[32:35]
    v_mul_f32 v86, s43, v86
    v_mul_f32 v140, v140, v85
    v_mfma_f32_16x16x32_bf16 v[40:43], v[68:71], a[168:171], 0
    s_nop 0
    v_mul_f32 v141, v141, v85
    v_cvt_pk_bf16_f32 v52, v140, v141
    v_mfma_f32_16x16x32_bf16 v[40:43], v[60:63], a[172:175], v[40:43]
    s_nop 0
    v_cvt_pk_f16_f32 v10, v32, v33
    v_cvt_pk_f16_f32 v11, v34, v35
    v_mfma_f32_16x16x32_bf16 v[40:43], v[98:101], a[176:179], v[40:43]
    v_mul_f32 v142, v142, v85
    v_mul_f32 v143, v143, v85
    v_mfma_f32_16x16x32_bf16 v[40:43], v[76:79], a[180:183], v[40:43]
    v_cvt_pk_bf16_f32 v53, v142, v143
    v_mul_f32 v44, v44, v85
    v_mfma_f32_16x16x32_bf16 v[40:43], v[92:95], a[184:187], v[40:43]
    ds_write_b32 v135, v52 offset:1536
    v_mfma_f32_16x16x32_bf16 v[40:43], v[104:107], a[188:191], v[40:43]
    v_mul_f32 v45, v45, v85
    v_cvt_pk_bf16_f32 v54, v44, v45
    v_mfma_f32_16x16x32_bf16 v[140:143], a[24:27], v[68:71], 0
    s_nop 0
    v_mul_f32 v46, v46, v85
    v_mul_f32 v47, v47, v85
    v_mfma_f32_16x16x32_bf16 v[140:143], a[28:31], v[60:63], v[140:143]
    s_nop 0
    v_cvt_pk_bf16_f32 v22, v40, v41
    v_cvt_pk_bf16_f32 v23, v42, v43
    v_mfma_f32_16x16x32_bf16 v[140:143], a[32:35], v[98:101], v[140:143]
    v_cvt_pk_bf16_f32 v55, v46, v47
    v_mul_f32 v56, v56, v85
    v_mfma_f32_16x16x32_bf16 v[140:143], a[36:39], v[76:79], v[140:143]
    ds_write_b64 v135, v[54:55] offset:1544
    v_mfma_f32_16x16x32_bf16 v[140:143], a[40:43], v[92:95], v[140:143]
    s_sub_u32 s50, s45, s44
    v_mul_f32 v57, v57, v85
    v_cvt_pk_bf16_f32 v38, v56, v57
    v_mfma_f32_16x16x32_bf16 v[140:143], a[44:47], v[104:107], v[140:143]
    s_sub_u32 s51, s46, s47
    v_mul_f32 v58, v58, v85
    v_mul_f32 v59, v59, v85
    v_mfma_f32_16x16x32_bf16 v[32:35], a[72:75], v[68:71], 0
    s_mov_b32 s60, s59
    v_cvt_pk_bf16_f32 v39, v58, v59
    v_mul_f32 v48, v48, v84
    v_mfma_f32_16x16x32_bf16 v[32:35], a[76:79], v[60:63], v[32:35]
    s_mov_b32 s59, s58
    ds_write_b32 v134, v39 offset:1540
    v_mfma_f32_16x16x32_bf16 v[32:35], a[80:83], v[98:101], v[32:35]
    s_mov_b32 s58, s57
    v_mul_f32 v49, v49, v84
    v_cvt_pk_bf16_f32 v64, v48, v49
    v_mfma_f32_16x16x32_bf16 v[32:35], a[84:87], v[76:79], v[32:35]
    s_mov_b32 s57, s56
    v_mul_f32 v50, v50, v84
    v_mul_f32 v51, v51, v84
    v_mfma_f32_16x16x32_bf16 v[32:35], a[88:91], v[92:95], v[32:35]
    s_mov_b32 s7, s6
    v_cvt_pk_bf16_f32 v65, v50, v51
    v_mul_f32 v80, v80, v84
    v_mfma_f32_16x16x32_bf16 v[32:35], a[92:95], v[104:107], v[32:35]
    s_mov_b32 s6, s5
    ds_write_b32 v135, v53 offset:1540
    v_mfma_f32_16x16x32_bf16 v[146:149], a[48:51], v[68:71], 0
    s_mov_b32 s5, s4
    v_mul_f32 v81, v81, v84
    v_cvt_pk_bf16_f32 v66, v80, v81
    v_mfma_f32_16x16x32_bf16 v[146:149], a[52:55], v[60:63], v[146:149]
    s_sub_u32 s14, s6, s7
    v_cvt_pk_f16_f32 v8, v32, v33
    v_cvt_pk_f16_f32 v9, v34, v35
    v_mfma_f32_16x16x32_bf16 v[146:149], a[56:59], v[98:101], v[146:149]
    s_add_u32 s61, s61, 1
    ds_read_b128 v[32:35], v137 offset:3328
    v_pk_fma_f16 v39, v8, v8, s3
    v_mfma_f32_16x16x32_bf16 v[146:149], a[60:63], v[76:79], v[146:149]
    s_add_u32 s12, s12, 20
    ds_read_b128 v[40:43], v137 offset:3200
    v_pk_fmac_f16 v39, v9, v9
    v_mfma_f32_16x16x32_bf16 v[146:149], a[64:67], v[92:95], v[146:149]
    s_max_u32 s12, s12, s61
    ds_read_b128 v[48:51], v136 offset:3200
    v_pk_fmac_f16 v39, v10, v10
    v_mfma_f32_16x16x32_bf16 v[146:149], a[68:71], v[104:107], v[146:149]
    s_cmp_lt_u32 s61, s71
    ds_read_b128 v[44:47], v136 offset:3328
    v_pk_fmac_f16 v39, v11, v11
    v_mfma_f32_16x16x32_bf16 v[108:111], a[120:123], v[68:71], 0
    s_cselect_b32 s15, s61, s12
    ds_read_b128 v[52:55], v136 offset:3072
    v_mul_f32 v82, v82, v84
    v_mfma_f32_16x16x32_bf16 v[108:111], a[124:127], v[60:63], v[108:111]
    s_cselect_b32 s56, s69, s70
    v_cvt_pk_f16_f32 v146, v146, v147
    v_cvt_pk_f16_f32 v147, v148, v149
    v_mfma_f32_16x16x32_bf16 v[108:111], a[128:131], v[98:101], v[108:111]
    s_add_u32 s56, s56, s15
    v_mul_f32 v83, v83, v84
    v_cvt_pk_bf16_f32 v67, v82, v83
    v_mfma_f32_16x16x32_bf16 v[108:111], a[132:135], v[76:79], v[108:111]
    s_mul_i32 s53, s56, 58255
    v_mul_f32 v116, v116, v84
    v_mul_f32 v117, v117, v84
    v_mfma_f32_16x16x32_bf16 v[108:111], a[136:139], v[92:95], v[108:111]
    s_lshr_b32 s53, s53, 22
    ds_write_b32 v134, v38 offset:1536
    v_mfma_f32_16x16x32_bf16 v[108:111], a[140:143], v[104:107], v[108:111]
    s_mul_i32 s53, s53, s63
    v_cvt_pk_bf16_f32 v2, v116, v117
    v_mul_f32 v118, v118, v84
    v_mfma_f32_16x16x32_bf16 v[80:83], a[0:3], v[68:71], 0
    s_mul_i32 s56, s56, s62
    v_mul_f32 v119, v119, v84
    v_cvt_pk_bf16_f32 v3, v118, v119
    v_mfma_f32_16x16x32_bf16 v[80:83], a[4:7], v[60:63], v[80:83]
    s_add_u32 s56, s56, s53
    v_cvt_pk_f16_f32 v148, v108, v109
    v_cvt_pk_f16_f32 v149, v110, v111
    v_mfma_f32_16x16x32_bf16 v[80:83], a[8:11], v[98:101], v[80:83]
    s_mul_i32 s4, s15, 112
    ds_write_b64 v135, v[64:65] offset:0
    v_mfma_f32_16x16x32_bf16 v[80:83], a[12:15], v[76:79], v[80:83]
    s_cmp_ge_u32 s15, 16
    v_pk_fmac_f16 v39, v148, v148
    v_pk_fmac_f16 v39, v149, v149
    v_mfma_f32_16x16x32_bf16 v[80:83], a[16:19], v[92:95], v[80:83]
    s_cselect_b32 s53, -30464, 0
    v_mul_f32 v24, v24, v86
    v_mul_f32 v25, v25, v86
    v_mfma_f32_16x16x32_bf16 v[80:83], a[20:23], v[104:107], v[80:83]
    s_add_u32 s4, s4, s53
    v_cvt_pk_bf16_f32 v116, v24, v25
    v_mul_f32 v26, v26, v86
    v_mfma_f32_16x16x32_bf16 v[108:111], v[68:71], a[144:147], 0
    s_cmp_lt_u32 s15, s73
    ds_write_b64 v135, v[66:67] offset:8
    v_mfma_f32_16x16x32_bf16 v[108:111], v[60:63], a[148:151], v[108:111]
    s_cselect_b32 s26, 100270464, 0
    v_cvt_pk_f16_f32 v24, v80, v81
    v_cvt_pk_f16_f32 v25, v82, v83
    v_mfma_f32_16x16x32_bf16 v[108:111], v[98:101], a[152:155], v[108:111]
    s_cselect_b32 s56, s56, 0
    v_pk_fma_f16 v38, v24, v24, s3
    v_pk_fmac_f16 v38, v25, v25
    v_mfma_f32_16x16x32_bf16 v[108:111], v[76:79], a[156:159], v[108:111]
    s_cselect_b32 s4, s4, -1
    ds_read_b128 v[64:67], v137 offset:3072
    v_mul_f32 v27, v27, v86
    v_mfma_f32_16x16x32_bf16 v[108:111], v[92:95], a[160:163], v[108:111]
    s_cselect_b32 s15, s15, 0
    v_cvt_pk_bf16_f32 v117, v26, v27
    v_mul_f32 v88, v88, v86
    v_mfma_f32_16x16x32_bf16 v[108:111], v[104:107], a[164:167], v[108:111]
    s_cselect_b32 s13, s13, -1
    v_mul_f32 v89, v89, v86
    v_cvt_pk_bf16_f32 v118, v88, v89
    v_mfma_f32_16x16x32_bf16 v[80:83], v[68:71], a[192:195], 0
    s_bitset1_b32 s64, s15
    v_mul_f32 v90, v90, v86
    v_mul_f32 v91, v91, v86
    v_mfma_f32_16x16x32_bf16 v[80:83], v[60:63], a[196:199], v[80:83]
    s_add_u32 s65, s65, 1
    ds_write_b64 v134, v[2:3] offset:0
    v_mfma_f32_16x16x32_bf16 v[80:83], v[98:101], a[200:203], v[80:83]
    s_cmp_ge_i32 s65, 2
    v_cvt_pk_bf16_f32 v119, v90, v91
    v_mul_f32 v72, v72, v86
    v_mfma_f32_16x16x32_bf16 v[80:83], v[76:79], a[204:207], v[80:83]
    s_cselect_b32 s30, 100270464, 0
    v_mul_f32 v73, v73, v86
    v_cvt_pk_bf16_f32 v72, v72, v73
    v_mfma_f32_16x16x32_bf16 v[80:83], v[92:95], a[208:211], v[80:83]
    s_add_u32 s67, s46, s54
    v_mul_f32 v74, v74, v86
    v_mul_f32 v75, v75, v86
    v_mfma_f32_16x16x32_bf16 v[80:83], v[104:107], a[212:215], v[80:83]
    s_waitcnt lgkmcnt(1)
    ds_write_b64 v135, v[116:117] offset:3072
    v_mfma_f32_16x16x32_bf16 v[60:63], a[72:75], v[64:67], 0
    s_add_u32 m0, s67, 0
    v_cvt_pk_bf16_f32 v73, v74, v75
    v_cvt_pk_bf16_f32 v2, v108, v109
    v_mfma_f32_16x16x32_bf16 v[60:63], a[76:79], v[52:55], v[60:63]
    v_cvt_pk_bf16_f32 v3, v110, v111
    v_cvt_pk_f16_f32 v26, v140, v141
    v_mfma_f32_16x16x32_bf16 v[60:63], a[80:83], v[40:43], v[60:63]
    v_cvt_pk_f16_f32 v27, v142, v143
    v_pk_fmac_f16 v38, v26, v26
    v_mfma_f32_16x16x32_bf16 v[60:63], a[84:87], v[48:51], v[60:63]
    ds_write_b32 v135, v118 offset:3080
    v_mfma_f32_16x16x32_bf16 v[60:63], a[88:91], v[32:35], v[60:63]
    v_pk_fmac_f16 v38, v27, v27
    v_pk_fmac_f16 v38, v146, v146
    v_mfma_f32_16x16x32_bf16 v[60:63], a[92:95], v[44:47], v[60:63]
    v_pk_fmac_f16 v38, v147, v147
    v_cvt_pk_bf16_f32 v6, v80, v81
    v_mfma_f32_16x16x32_bf16 v[98:101], a[120:123], v[64:67], 0
    v_cvt_pk_bf16_f32 v7, v82, v83
    v_add_u32 v137, s50, v137
    v_mfma_f32_16x16x32_bf16 v[98:101], a[124:127], v[52:55], v[98:101]
    ds_write_b32 v135, v119 offset:3084
    v_mfma_f32_16x16x32_bf16 v[98:101], a[128:131], v[40:43], v[98:101]
    v_cvt_pk_f16_f32 v56, v60, v61
    v_cvt_pk_f16_f32 v57, v62, v63
    v_mfma_f32_16x16x32_bf16 v[98:101], a[132:135], v[48:51], v[98:101]
    v_add_u32 v136, s50, v136
    v_add_u32 v135, s48, v135
    v_mfma_f32_16x16x32_bf16 v[98:101], a[136:139], v[32:35], v[98:101]
    v_add_u32 v133, s51, v133
    v_add_u32 v132, s14, v132
    v_mfma_f32_16x16x32_bf16 v[98:101], a[140:143], v[44:47], v[98:101]
    s_nop 0
    ds_write_b32 v134, v72 offset:3072
    v_mfma_f32_16x16x32_f16 v[76:79], v[212:215], v[36:39], 0
    s_nop 0
    v_pk_fma_f16 v37, v56, v56, s3
    v_pk_fmac_f16 v37, v57, v57
    v_mfma_f32_16x16x32_bf16 v[80:83], v[64:67], a[168:171], 0
    s_nop 0
    v_cvt_pk_f16_f32 v142, v98, v99
    v_cvt_pk_f16_f32 v143, v100, v101
    v_mfma_f32_16x16x32_bf16 v[80:83], v[52:55], a[172:175], v[80:83]
    v_or3_b32 v123, v123, v76, v77
    v_or3_b32 v123, v123, v78, v79
    v_mfma_f32_16x16x32_bf16 v[80:83], v[40:43], a[176:179], v[80:83]
    ds_write_b32 v134, v73 offset:3076
    v_mfma_f32_16x16x32_bf16 v[80:83], v[48:51], a[180:183], v[80:83]
    s_waitcnt vmcnt(0)
    v_rsq_f32 v76, v76
    v_mfma_f32_16x16x32_bf16 v[80:83], v[32:35], a[184:187], v[80:83]
    v_rsq_f32 v77, v77
    v_mfma_f32_16x16x32_bf16 v[80:83], v[44:47], a[188:191], v[80:83]
    v_mul_f32 v76, s52, v76
    v_cvt_pk_f16_f32 v76, v76, v77
    v_mfma_f32_16x16x32_bf16 v[98:101], v[64:67], a[144:147], 0
    v_rsq_f32 v78, v78
    v_mfma_f32_16x16x32_bf16 v[98:101], v[52:55], a[148:151], v[98:101]
    v_rsq_f32 v79, v79
    v_mfma_f32_16x16x32_bf16 v[98:101], v[40:43], a[152:155], v[98:101]
    v_mul_f32 v78, s52, v78
    v_cvt_pk_f16_f32 v78, v78, v79
    v_mfma_f32_16x16x32_bf16 v[98:101], v[48:51], a[156:159], v[98:101]
    v_pk_mul_f16 v8, v8, v78 op_sel:[0,1] op_sel_hi:[1,1]
    v_pk_mul_f16 v9, v9, v78 op_sel:[0,1] op_sel_hi:[1,1]
    v_mfma_f32_16x16x32_bf16 v[98:101], v[32:35], a[160:163], v[98:101]
    s_waitcnt lgkmcnt(0)
    v_pk_mul_f16 v10, v10, v78 op_sel:[0,1] op_sel_hi:[1,1]
    v_pk_mul_f16 v11, v11, v78 op_sel:[0,1] op_sel_hi:[1,1]
    v_mfma_f32_16x16x32_bf16 v[98:101], v[44:47], a[164:167], v[98:101]
    s_barrier
    v_pk_mul_f16 v148, v148, v78 op_sel:[0,1] op_sel_hi:[1,1]
    v_pk_mul_f16 v149, v149, v78 op_sel:[0,1] op_sel_hi:[1,1]
    v_mfma_f32_16x16x32_bf16 v[92:95], a[0:3], v[64:67], 0
    s_cmp_ge_u32 s61, s13
    v_pk_mul_f16 v12, v12, v76 op_sel:[0,1] op_sel_hi:[1,1]
    v_pk_mul_f16 v13, v13, v76 op_sel:[0,1] op_sel_hi:[1,1]
    v_mfma_f32_16x16x32_bf16 v[92:95], a[4:7], v[52:55], v[92:95]
L_pga:
    s_cbranch_scc1 L_atomF0
L_atomF0r:
    v_mfma_f32_16x16x32_bf16 v[92:95], a[8:11], v[40:43], v[92:95]
    ds_read_b128 v[60:63], v132 offset:16
    v_pk_mul_f16 v14, v14, v76 op_sel:[0,1] op_sel_hi:[1,1]
    v_mfma_f32_16x16x32_bf16 v[92:95], a[12:15], v[48:51], v[92:95]
    ds_read_b128 v[68:71], v132 offset:0
    v_pk_mul_f16 v15, v15, v76 op_sel:[0,1] op_sel_hi:[1,1]
    v_mfma_f32_16x16x32_bf16 v[92:95], a[16:19], v[32:35], v[92:95]
    v_pk_mul_f16 v154, v154, v76 op_sel:[0,1] op_sel_hi:[1,1]
    v_pk_mul_f16 v155, v155, v76 op_sel:[0,1] op_sel_hi:[1,1]
    v_mfma_f32_16x16x32_bf16 v[92:95], a[20:23], v[44:47], v[92:95]
    ds_read_b128 v[104:107], v133 offset:0
    v_pk_mul_f16 v28, v28, v76 op_sel:[0,0] op_sel_hi:[1,0]
    v_mfma_f32_16x16x32_bf16 v[116:119], a[48:51], v[64:67], 0
    v_pk_mul_f16 v29, v29, v76 op_sel:[0,0] op_sel_hi:[1,0]
    v_pk_mul_f16 v30, v30, v76 op_sel:[0,0] op_sel_hi:[1,0]
    v_mfma_f32_16x16x32_bf16 v[116:119], a[52:55], v[52:55], v[116:119]
    ds_read_b128 v[88:91], v133 offset:2048
    v_pk_mul_f16 v31, v31, v76 op_sel:[0,0] op_sel_hi:[1,0]
    v_mfma_f32_16x16x32_bf16 v[116:119], a[56:59], v[40:43], v[116:119]
    v_pk_mul_f16 v152, v152, v76 op_sel:[0,0] op_sel_hi:[1,0]
    v_pk_mul_f16 v153, v153, v76 op_sel:[0,0] op_sel_hi:[1,0]
    v_mfma_f32_16x16x32_bf16 v[116:119], a[60:63], v[48:51], v[116:119]
    ds_read_b128 v[72:75], v132 offset:48
    v_cvt_pk_f16_f32 v76, v92, v93
    v_mfma_f32_16x16x32_bf16 v[116:119], a[64:67], v[32:35], v[116:119]
    ds_read_b128 v[84:87], v137 offset:0
    v_cvt_pk_f16_f32 v77, v94, v95
    v_mfma_f32_16x16x32_bf16 v[116:119], a[68:71], v[44:47], v[116:119]
    v_pk_fma_f16 v36, v76, v76, s3
    v_pk_fmac_f16 v36, v77, v77
    v_mfma_f32_16x16x32_bf16 v[112:115], a[24:27], v[64:67], 0
    s_nop 0
    v_add_u32 v134, s48, v134
    v_add_u32 v131, s14, v131
    v_mfma_f32_16x16x32_bf16 v[112:115], a[28:31], v[52:55], v[112:115]
    s_nop 0
    v_cvt_pk_f16_f32 v140, v116, v117
    v_cvt_pk_f16_f32 v141, v118, v119
    v_mfma_f32_16x16x32_bf16 v[112:115], a[32:35], v[40:43], v[112:115]
    s_waitcnt lgkmcnt(3)
    buffer_load_dwordx4 v128, s[24:27], s56 offen nt lds
    v_pk_mul_f16 v24, v24, v78 op_sel:[0,0] op_sel_hi:[1,0]
    v_mfma_f32_16x16x32_bf16 v[112:115], a[36:39], v[48:51], v[112:115]
    ds_read_b128 v[92:95], v136 offset:128
    v_pk_mul_f16 v25, v25, v78 op_sel:[0,0] op_sel_hi:[1,0]
    v_mfma_f32_16x16x32_bf16 v[112:115], a[40:43], v[32:35], v[112:115]
    v_pk_mul_f16 v26, v26, v78 op_sel:[0,0] op_sel_hi:[1,0]
    v_pk_mul_f16 v27, v27, v78 op_sel:[0,0] op_sel_hi:[1,0]
    v_mfma_f32_16x16x32_bf16 v[112:115], a[44:47], v[44:47], v[112:115]
    v_pk_mul_f16 v146, v146, v78 op_sel:[0,0] op_sel_hi:[1,0]
    v_pk_mul_f16 v147, v147, v78 op_sel:[0,0] op_sel_hi:[1,0]
    v_mfma_f32_16x16x32_bf16 v[116:119], a[96:99], v[64:67], 0
    ds_read_b128 v[108:111], v133 offset:1024
    v_cvt_pk_bf16_f32 v164, v98, v99
    v_mfma_f32_16x16x32_bf16 v[116:119], a[100:103], v[52:55], v[116:119]
    s_nop 0
    ds_read_u16 v166, v131 offset:80
    v_cvt_pk_f16_f32 v78, v112, v113
    v_mfma_f32_16x16x32_bf16 v[116:119], a[104:107], v[40:43], v[116:119]
    ds_read_u16 v162, v131 offset:96
    v_cvt_pk_f16_f32 v79, v114, v115
    v_mfma_f32_16x16x32_bf16 v[116:119], a[108:111], v[48:51], v[116:119]
    ds_read_u16 v158, v131 offset:104
    v_pk_fmac_f16 v36, v78, v78
    v_mfma_f32_16x16x32_bf16 v[116:119], a[112:115], v[32:35], v[116:119]
    ds_read_b128 v[96:99], v137 offset:256
    v_pk_fmac_f16 v36, v79, v79
    v_mfma_f32_16x16x32_bf16 v[116:119], a[116:119], v[44:47], v[116:119]
    s_add_u32 m0, s67, 1024
    v_pk_fmac_f16 v36, v140, v140
    v_pk_fmac_f16 v36, v141, v141
    v_mfma_f32_16x16x32_bf16 v[112:115], v[64:67], a[192:195], 0
    ds_read_b128 v[64:67], v136 offset:0
    v_cvt_pk_bf16_f32 v165, v100, v101
    v_mfma_f32_16x16x32_bf16 v[112:115], v[52:55], a[196:199], v[112:115]
    ds_read_b128 v[52:55], v133 offset:3072
    v_cvt_pk_f16_f32 v58, v116, v117
    v_mfma_f32_16x16x32_bf16 v[112:115], v[40:43], a[200:203], v[112:115]
    ds_read_b128 v[40:43], v137 offset:128
    v_cvt_pk_f16_f32 v59, v118, v119
    v_mfma_f32_16x16x32_bf16 v[112:115], v[48:51], a[204:207], v[112:115]
    s_waitcnt lgkmcnt(7)
    buffer_store_dwordx4 v[104:107], v128, s[28:31], s60 offen sc1
    buffer_load_dwordx4 v127, s[24:27], s56 offen nt lds
    v_pk_fmac_f16 v37, v58, v58
    v_pk_fmac_f16 v37, v59, v59
    v_pk_fmac_f16 v37, v142, v142
    v_mfma_f32_16x16x32_bf16 v[112:115], v[32:35], a[208:211], v[112:115]
    v_pk_fmac_f16 v37, v143, v143
    v_cvt_pk_bf16_f32 v20, v16, v17
    v_mfma_f32_16x16x32_bf16 v[112:115], v[44:47], a[212:215], v[112:115]
    ds_read_b128 v[32:35], v136 offset:256
    v_cvt_pk_bf16_f32 v21, v18, v19
    v_mfma_f32_16x16x32_f16 v[16:19], v[212:215], v[36:39], 0
    s_nop 0
    v_cvt_pk_bf16_f32 v160, v80, v81
    v_cvt_pk_bf16_f32 v161, v82, v83
    v_mfma_f32_16x16x32_f16 v[36:39], v[8:11], v[28:31], v[200:203]
    s_nop 0
    v_cvt_pk_bf16_f32 v156, v112, v113
    v_cvt_pk_bf16_f32 v157, v114, v115
    v_mfma_f32_16x16x32_f16 v[36:39], v[146:149], v[150:153], v[36:39]
    s_add_u32 m0, s67, 2048
    v_or3_b32 v123, v123, v16, v17
    v_mfma_f32_16x16x32_bf16 v[48:51], a[216:219], v[84:87], 0
    s_waitcnt lgkmcnt(2)
    ds_read_b128 v[44:47], v133 offset:4096
    v_mfma_f32_16x16x32_bf16 v[48:51], a[220:223], v[64:67], v[48:51]
    s_waitcnt lgkmcnt(2)
    buffer_store_dwordx4 v[108:111], v127, s[28:31], s60 offen sc1
    buffer_load_dwordx4 v126, s[24:27], s56 offen nt lds
    v_rsq_f32 v16, v16
    v_mfma_f32_16x16x32_bf16 v[48:51], a[224:227], v[40:43], v[48:51]
    v_rsq_f32 v17, v17
    v_mfma_f32_16x16x32_bf16 v[48:51], a[228:231], v[92:95], v[48:51]
    v_exp_f32 v36, v36
    v_mfma_f32_16x16x32_bf16 v[48:51], a[232:235], v[96:99], v[48:51]
    s_waitcnt lgkmcnt(1)
    v_exp_f32 v37, v37
    v_mfma_f32_16x16x32_bf16 v[48:51], a[236:239], v[32:35], v[48:51]
    v_mul_f32 v16, s52, v16
    v_cvt_pk_f16_f32 v16, v16, v17
    v_mfma_f32_16x16x32_bf16 v[80:83], a[240:243], v[84:87], 0
    v_pk_mul_f16 v76, v76, v16 op_sel:[0,0] op_sel_hi:[1,0]
    v_pk_mul_f16 v77, v77, v16 op_sel:[0,0] op_sel_hi:[1,0]
    v_mfma_f32_16x16x32_bf16 v[80:83], a[244:247], v[64:67], v[80:83]
    v_pk_mul_f16 v78, v78, v16 op_sel:[0,0] op_sel_hi:[1,0]
    v_pk_mul_f16 v79, v79, v16 op_sel:[0,0] op_sel_hi:[1,0]
    v_mfma_f32_16x16x32_bf16 v[80:83], a[248:251], v[40:43], v[80:83]
    v_pk_mul_f16 v140, v140, v16 op_sel:[0,0] op_sel_hi:[1,0]
    v_pk_mul_f16 v141, v141, v16 op_sel:[0,0] op_sel_hi:[1,0]
    v_mfma_f32_16x16x32_bf16 v[80:83], a[252:255], v[92:95], v[80:83]
    v_pk_mul_f16 v56, v56, v16 op_sel:[0,1] op_sel_hi:[1,1]
    v_pk_mul_f16 v57, v57, v16 op_sel:[0,1] op_sel_hi:[1,1]
    v_mfma_f32_16x16x32_bf16 v[80:83], v[224:227], v[96:99], v[80:83]
    v_pk_mul_f16 v58, v58, v16 op_sel:[0,1] op_sel_hi:[1,1]
    v_pk_mul_f16 v59, v59, v16 op_sel:[0,1] op_sel_hi:[1,1]
    v_mfma_f32_16x16x32_bf16 v[80:83], v[228:231], v[32:35], v[80:83]
    s_add_u32 m0, s67, 3072
    buffer_store_dwordx4 v[88:91], v126, s[28:31], s60 offen sc1
    v_pk_mul_f16 v142, v142, v16 op_sel:[0,1] op_sel_hi:[1,1]
    v_pk_mul_f16 v143, v143, v16 op_sel:[0,1] op_sel_hi:[1,1]
    v_exp_f32 v38, v38
    v_mfma_f32_16x16x32_f16 v[16:19], v[68:71], v[28:31], v[208:211]
    v_exp_f32 v39, v39
    v_mfma_f32_16x16x32_f16 v[16:19], v[60:63], v[12:15], v[16:19]
    v_cvt_pk_bf16_f32 v36, v36, v37
    v_cvt_pk_bf16_f32 v37, v38, v39
    v_mfma_f32_16x16x32_f16 v[16:19], v[72:75], v[152:155], v[16:19]
    s_nop 0
    buffer_load_dwordx4 v125, s[24:27], s56 offen nt lds
    v_mfma_f32_16x16x32_f16 v[104:107], v[56:59], v[28:31], v[196:199]
    s_add_u32 m0, s67, 4096
    s_nop 1
    v_mfma_f32_16x16x32_f16 v[104:107], v[140:143], v[150:153], v[104:107]
    s_nop 0
    v_exp_f32 v16, v16
    v_mfma_f32_16x16x32_f16 v[88:91], v[12:15], v[28:31], v[204:207]
    s_nop 0
    v_cvt_pk_bf16_f32 v170, v16, 0
    s_nop 0
    v_mfma_f32_16x16x32_f16 v[88:91], v[152:155], v[150:153], v[88:91]
    s_nop 0
    v_exp_f32 v104, v104
    v_mfma_f32_16x16x32_bf16 v[116:119], v[232:235], v[84:87], 0
    s_waitcnt lgkmcnt(0)
    buffer_store_dwordx4 v[52:55], v125, s[28:31], s60 offen sc1
    buffer_load_dwordx4 v124, s[24:27], s56 offen nt lds
    v_exp_f32 v105, v105
    v_mfma_f32_16x16x32_bf16 v[116:119], v[236:239], v[64:67], v[116:119]
    v_exp_f32 v88, v88
    v_mfma_f32_16x16x32_bf16 v[116:119], v[240:243], v[40:43], v[116:119]
    v_exp_f32 v89, v89
    v_mfma_f32_16x16x32_bf16 v[116:119], v[244:247], v[92:95], v[116:119]
    v_exp_f32 v90, v90
    v_mfma_f32_16x16x32_bf16 v[116:119], v[248:251], v[96:99], v[116:119]
    v_exp_f32 v91, v91
    v_mfma_f32_16x16x32_bf16 v[116:119], v[252:255], v[32:35], v[116:119]
    v_cvt_pk_bf16_f32 v34, v88, v89
    v_cvt_pk_bf16_f32 v35, v90, v91
    v_mfma_f32_16x16x32_f16 v[28:31], v[56:59], v[24:27], v[184:187]
    v_exp_f32 v106, v106
    v_mfma_f32_16x16x32_f16 v[28:31], v[140:143], v[144:147], v[28:31]
    v_exp_f32 v107, v107
    v_mfma_f32_16x16x32_f16 v[40:43], v[56:59], v[76:79], v[172:175]
    buffer_store_dwordx4 v[44:47], v124, s[28:31], s60 offen sc1
    v_cvt_pk_bf16_f32 v168, v104, v105
    v_cvt_pk_bf16_f32 v169, v106, v107
    s_nop 0
    v_mfma_f32_16x16x32_f16 v[40:43], v[140:143], v[138:141], v[40:43]
    s_mov_b32 s53, s47
    v_exp_f32 v28, v28
    v_mfma_f32_16x16x32_f16 v[44:47], v[12:15], v[24:27], v[192:195]
    s_mov_b32 s47, s46
    v_exp_f32 v29, v29
    v_mfma_f32_16x16x32_f16 v[44:47], v[152:155], v[144:147], v[44:47]
    s_mov_b32 s46, s45
    v_exp_f32 v30, v30
    v_mfma_f32_16x16x32_f16 v[52:55], v[68:71], v[76:79], v[208:211]
    s_mov_b32 s45, s44
    v_exp_f32 v31, v31
    v_mfma_f32_16x16x32_f16 v[52:55], v[60:63], v[56:59], v[52:55]
    s_mov_b32 s44, s53
    v_exp_f32 v40, v40
    v_mfma_f32_16x16x32_f16 v[52:55], v[72:75], v[140:143], v[52:55]
    s_sub_u32 s48, s44, s46
    v_exp_f32 v44, v44
    v_mfma_f32_16x16x32_f16 v[64:67], v[68:71], v[24:27], v[208:211]
    s_sub_u32 s49, s46, s45
    v_exp_f32 v45, v45
    v_mfma_f32_16x16x32_f16 v[64:67], v[60:63], v[8:11], v[64:67]
    s_cmp_lg_u32 s5, -1
    v_exp_f32 v46, v46
    v_mfma_f32_16x16x32_f16 v[64:67], v[72:75], v[146:149], v[64:67]
    ds_read_b128 v[60:63], v136 offset:1536
    v_cvt_pk_bf16_f32 v16, v44, v45
    v_mfma_f32_16x16x32_bf16 v[98:101], v[220:223], v[34:37], 0
    ds_read_b128 v[68:71], v137 offset:1664
    v_fma_f32 v32, v48, v48, s42
    v_mfma_f32_16x16x32_bf16 v[98:101], v[220:223], v[168:171], v[98:101]
    s_nop 0
    ds_read_b128 v[88:91], v137 offset:1536
    v_mov_b32_dpp v19, v67 quad_perm:[0,1,2,3] row_mask:0x2 bank_mask:0xf
    v_mfma_f32_16x16x32_bf16 v[104:107], v[0:3], v[34:37], 0
    ds_read_b128 v[72:75], v136 offset:1664
    v_mov_b32_dpp v19, v55 quad_perm:[0,1,2,3] row_mask:0x4 bank_mask:0xf
    v_mfma_f32_16x16x32_bf16 v[104:107], v[164:167], v[168:171], v[104:107]
    ds_read_b128 v[84:87], v136 offset:1792
    v_fmac_f32 v32, v49, v49
    v_mfma_f32_16x16x32_bf16 v[92:95], v[20:23], v[34:37], 0
    v_exp_f32 v47, v47
    v_mfma_f32_16x16x32_bf16 v[92:95], v[160:163], v[168:171], v[92:95]
    v_cvt_pk_bf16_f32 v17, v46, v47
    v_fmac_f32 v32, v50, v50
    v_mfma_f32_16x16x32_bf16 v[44:47], v[4:7], v[34:37], 0
    ds_read_b128 v[36:39], v137 offset:1792
    v_fmac_f32 v32, v51, v51
    v_mfma_f32_16x16x32_bf16 v[44:47], v[156:159], v[168:171], v[44:47]
    v_exp_f32 v65, v65
    v_mfma_f32_16x16x32_f16 v[108:111], v[12:15], v[76:79], v[180:183]
    v_exp_f32 v19, v19
    v_mfma_f32_16x16x32_f16 v[108:111], v[152:155], v[138:141], v[108:111]
    v_cvt_pk_bf16_f32 v19, v19, v19
    v_cvt_pk_bf16_f32 v168, v28, v29
    v_mfma_f32_16x16x32_f16 v[152:155], v[8:11], v[76:79], v[176:179]
    ds_write_b16 v131, v19 offset:64
    v_mfma_f32_16x16x32_f16 v[152:155], v[146:149], v[138:141], v[152:155]
    s_waitcnt lgkmcnt(3)
    v_rcp_f32 v98, v98
    v_mfma_f32_16x16x32_bf16 v[140:143], a[216:219], v[88:91], 0
    v_mul_f32 v104, v104, v98
    v_mul_f32 v105, v105, v98
    v_mfma_f32_16x16x32_bf16 v[140:143], a[220:223], v[60:63], v[140:143]
    ds_read_b128 v[12:15], v132 offset:48
    v_cvt_pk_bf16_f32 v104, v104, v105
    v_mfma_f32_16x16x32_bf16 v[140:143], a[224:227], v[68:71], v[140:143]
    ds_read_b128 v[76:79], v132 offset:64
    v_mul_f32 v106, v106, v98
    v_mfma_f32_16x16x32_bf16 v[140:143], a[228:231], v[72:75], v[140:143]
    s_waitcnt lgkmcnt(3)
    v_mul_f32 v107, v107, v98
    v_cvt_pk_bf16_f32 v105, v106, v107
    v_mfma_f32_16x16x32_bf16 v[140:143], a[232:235], v[36:39], v[140:143]
    v_mul_f32 v92, v92, v98
    v_mul_f32 v93, v93, v98
    v_mfma_f32_16x16x32_bf16 v[140:143], a[236:239], v[84:87], v[140:143]
    v_cvt_pk_bf16_f32 v106, v92, v93
    v_mul_f32 v94, v94, v98
    v_mfma_f32_16x16x32_bf16 v[56:59], v[232:235], v[88:91], 0
    ds_write_b64 v135, v[104:105] offset:0
    v_mfma_f32_16x16x32_bf16 v[56:59], v[236:239], v[60:63], v[56:59]
    v_mul_f32 v95, v95, v98
    v_cvt_pk_bf16_f32 v107, v94, v95
    v_mfma_f32_16x16x32_bf16 v[56:59], v[240:243], v[68:71], v[56:59]
    v_mul_f32 v44, v44, v98
    v_mul_f32 v45, v45, v98
    v_mfma_f32_16x16x32_bf16 v[56:59], v[244:247], v[72:75], v[56:59]
    ds_read_b128 v[92:95], v137 offset:3200
    v_cvt_pk_bf16_f32 v18, v44, v45
    v_mfma_f32_16x16x32_bf16 v[56:59], v[248:251], v[36:39], v[56:59]
    v_mul_f32 v46, v46, v98
    v_mul_f32 v47, v47, v98
    v_mfma_f32_16x16x32_bf16 v[56:59], v[252:255], v[84:87], v[56:59]
    s_waitcnt lgkmcnt(2)
    v_cvt_pk_bf16_f32 v19, v46, v47
    v_cvt_pk_bf16_f32 v169, v30, v31
    v_mfma_f32_16x16x32_bf16 v[28:31], v[12:15], v[0:3], 0
    v_cvt_pk_bf16_f32 v170, v65, 0
    v_fmac_f32 v32, v80, v80
    v_mfma_f32_16x16x32_bf16 v[28:31], v[76:79], v[164:167], v[28:31]
    ds_write_b64 v135, v[106:107] offset:8
    v_mfma_f32_16x16x32_bf16 v[44:47], v[12:15], v[20:23], 0
    v_exp_f32 v41, v41
    v_mfma_f32_16x16x32_bf16 v[44:47], v[76:79], v[160:163], v[44:47]
    v_exp_f32 v42, v42
    v_mfma_f32_16x16x32_bf16 v[64:67], v[12:15], v[4:7], 0
    s_nop 0
    ds_read_b128 v[12:15], v137 offset:3072
    v_fmac_f32 v32, v81, v81
    v_mfma_f32_16x16x32_bf16 v[64:67], v[76:79], v[156:159], v[64:67]
    s_nop 0
    ds_read_b128 v[98:101], v136 offset:3072
    v_mov_b32_dpp v31, v47 quad_perm:[0,1,2,3] row_mask:0x2 bank_mask:0xf
    v_mfma_f32_16x16x32_bf16 v[44:47], a[240:243], v[88:91], 0
    ds_read_b128 v[104:107], v136 offset:3200
    v_fmac_f32 v32, v82, v82
    v_mfma_f32_16x16x32_bf16 v[44:47], a[244:247], v[60:63], v[44:47]
    s_nop 0
    ds_read_b128 v[62:65], v137 offset:3328
    v_mov_b32_dpp v31, v67 quad_perm:[0,1,2,3] row_mask:0x4 bank_mask:0xf
    v_mfma_f32_16x16x32_bf16 v[44:47], a[248:251], v[68:71], v[44:47]
    ds_read_b128 v[66:69], v136 offset:3328
    v_cvt_pk_bf16_f32 v31, v31, v31
    v_mfma_f32_16x16x32_bf16 v[44:47], a[252:255], v[72:75], v[44:47]
    v_exp_f32 v43, v43
    v_mfma_f32_16x16x32_bf16 v[44:47], v[224:227], v[36:39], v[44:47]
    v_exp_f32 v54, v54
    v_mfma_f32_16x16x32_bf16 v[44:47], v[228:231], v[84:87], v[44:47]
    v_exp_f32 v152, v152
    v_mfma_f32_16x16x32_f16 v[36:39], v[8:11], v[24:27], v[188:191]
    ds_write_b16 v131, v31
    v_mfma_f32_16x16x32_f16 v[36:39], v[146:149], v[144:147], v[36:39]
    s_waitcnt lgkmcnt(5)
    v_exp_f32 v153, v153
    v_mfma_f32_16x16x32_bf16 v[88:91], a[240:243], v[12:15], 0
    s_waitcnt lgkmcnt(4)
    v_exp_f32 v154, v154
    v_mfma_f32_16x16x32_bf16 v[88:91], a[244:247], v[98:101], v[88:91]
    v_exp_f32 v155, v155
    v_mfma_f32_16x16x32_bf16 v[88:91], a[248:251], v[92:95], v[88:91]
    s_waitcnt lgkmcnt(2)
    ds_write_b32 v134, v18 offset:0
    v_mfma_f32_16x16x32_bf16 v[88:91], a[252:255], v[104:107], v[88:91]
    v_cvt_pk_bf16_f32 v30, v152, v153
    v_cvt_pk_bf16_f32 v31, v154, v155
    v_mfma_f32_16x16x32_bf16 v[88:91], v[224:227], v[62:65], v[88:91]
    s_waitcnt lgkmcnt(2)
    v_exp_f32 v36, v36
    v_mfma_f32_16x16x32_bf16 v[88:91], v[228:231], v[66:69], v[88:91]
    v_exp_f32 v37, v37
    v_mfma_f32_16x16x32_bf16 v[24:27], a[216:219], v[12:15], 0
    ds_write_b32 v134, v19 offset:4
    v_mfma_f32_16x16x32_bf16 v[24:27], a[220:223], v[98:101], v[24:27]
    v_exp_f32 v38, v38
    v_mfma_f32_16x16x32_bf16 v[24:27], a[224:227], v[92:95], v[24:27]
    v_exp_f32 v39, v39
    v_mfma_f32_16x16x32_bf16 v[24:27], a[228:231], v[104:107], v[24:27]
    v_cvt_pk_bf16_f32 v18, v36, v37
    v_cvt_pk_bf16_f32 v19, v38, v39
    v_mfma_f32_16x16x32_bf16 v[24:27], a[232:235], v[62:65], v[24:27]
    v_exp_f32 v108, v108
    v_mfma_f32_16x16x32_bf16 v[24:27], a[236:239], v[66:69], v[24:27]
    v_exp_f32 v109, v109
    v_mfma_f32_16x16x32_bf16 v[152:155], v[220:223], v[16:19], 0
    v_exp_f32 v110, v110
    v_mfma_f32_16x16x32_bf16 v[152:155], v[220:223], v[168:171], v[152:155]
    s_nop 0
    v_exp_f32 v111, v111
    v_mfma_f32_16x16x32_bf16 v[36:39], v[0:3], v[16:19], 0
    s_nop 0
    v_cvt_pk_bf16_f32 v28, v108, v109
    v_cvt_pk_bf16_f32 v29, v110, v111
    v_mfma_f32_16x16x32_bf16 v[36:39], v[164:167], v[168:171], v[36:39]
    s_nop 0
    v_rcp_f32 v152, v152
    v_mfma_f32_16x16x32_bf16 v[146:149], v[20:23], v[16:19], 0
    v_add_u32 v137, s48, v137
    v_add_u32 v136, s48, v136
    v_mfma_f32_16x16x32_bf16 v[146:149], v[160:163], v[168:171], v[146:149]
    s_nop 0
    ds_read_b128 v[84:87], v137 offset:0
    v_mul_f32 v36, v36, v152
    v_mfma_f32_16x16x32_bf16 v[76:79], v[4:7], v[16:19], 0
    ds_read_b128 v[108:111], v136 offset:0
    v_mul_f32 v37, v37, v152
    v_mfma_f32_16x16x32_bf16 v[76:79], v[156:159], v[168:171], v[76:79]
    ds_read_b128 v[8:11], v137 offset:128
    v_cvt_pk_bf16_f32 v168, v40, v41
    v_mfma_f32_16x16x32_bf16 v[72:75], v[232:235], v[12:15], 0
    ds_read_b128 v[112:115], v136 offset:128
    v_cvt_pk_bf16_f32 v169, v42, v43
    v_mfma_f32_16x16x32_bf16 v[72:75], v[236:239], v[98:101], v[72:75]
    ds_read_b128 v[40:43], v137 offset:256
    v_cvt_pk_bf16_f32 v170, v54, 0
    v_mfma_f32_16x16x32_bf16 v[72:75], v[240:243], v[92:95], v[72:75]
    ds_read_b128 v[52:55], v136 offset:256
    v_cvt_pk_bf16_f32 v12, v36, v37
    v_mfma_f32_16x16x32_bf16 v[72:75], v[244:247], v[104:107], v[72:75]
    ds_read_b128 v[104:107], v136 offset:1792
    v_mul_f32 v38, v38, v152
    v_mfma_f32_16x16x32_bf16 v[72:75], v[248:251], v[62:65], v[72:75]
    ds_read_b128 v[60:63], v136 offset:1536
    v_mul_f32 v39, v39, v152
    v_mfma_f32_16x16x32_bf16 v[72:75], v[252:255], v[66:69], v[72:75]
    ds_read_b128 v[98:101], v137 offset:1664
    v_cvt_pk_bf16_f32 v13, v38, v39
    v_mfma_f32_16x16x32_bf16 v[36:39], v[220:223], v[28:31], 0
    ds_read_b128 v[68:71], v137 offset:1536
    v_mul_f32 v146, v146, v152
    v_mfma_f32_16x16x32_bf16 v[36:39], v[220:223], v[168:171], v[36:39]
    v_mul_f32 v147, v147, v152
    v_cvt_pk_bf16_f32 v14, v146, v147
    v_mfma_f32_16x16x32_bf16 v[64:67], v[0:3], v[28:31], 0
    v_mul_f32 v148, v148, v152
    v_mul_f32 v149, v149, v152
    v_mfma_f32_16x16x32_bf16 v[64:67], v[164:167], v[168:171], v[64:67]
    v_cvt_pk_bf16_f32 v15, v148, v149
    v_mul_f32 v76, v76, v152
    v_mfma_f32_16x16x32_bf16 v[0:3], v[20:23], v[28:31], 0
    ds_write_b32 v135, v12 offset:1536
    v_mfma_f32_16x16x32_bf16 v[0:3], v[160:163], v[168:171], v[0:3]
    v_mul_f32 v77, v77, v152
    v_cvt_pk_bf16_f32 v154, v76, v77
    v_mfma_f32_16x16x32_bf16 v[146:149], v[4:7], v[28:31], 0
    v_mul_f32 v78, v78, v152
    v_mul_f32 v79, v79, v152
    v_mfma_f32_16x16x32_bf16 v[146:149], v[156:159], v[168:171], v[146:149]
    s_waitcnt lgkmcnt(3)
    v_cvt_pk_bf16_f32 v155, v78, v79
    v_fmac_f32 v32, v83, v83
    v_mfma_f32_16x16x32_bf16 v[28:31], a[0:3], v[84:87], 0
    s_cbranch_scc1 L_loopF0
    ds_write_b32 v135, v13 offset:1540
    v_rcp_f32 v36, v36
    s_mov_b32 s30, 100270464
    s_mul_i32 s89, s68, 7168
    ds_write_b64 v135, v[14:15] offset:1544
    v_mul_f32 v64, v64, v36
    v_mul_f32 v65, v65, v36
    v_cvt_pk_bf16_f32 v4, v64, v65
    s_add_u32 s89, s89, 135168
    s_movk_i32 s90, 112
    ds_write_b64 v134, v[154:155] offset:1536
    v_mul_f32 v66, v66, v36
    v_mul_f32 v67, v67, v36
    v_cvt_pk_bf16_f32 v5, v66, v67
    v_mul_f32 v0, v0, v36
    v_mul_f32 v1, v1, v36
    v_cvt_pk_bf16_f32 v6, v0, v1
    v_mul_f32 v2, v2, v36
    v_mul_f32 v3, v3, v36
    v_cvt_pk_bf16_f32 v7, v2, v3
    v_mul_f32 v146, v146, v36
    v_mul_f32 v147, v147, v36
    v_cvt_pk_bf16_f32 v120, v146, v147
    v_mul_f32 v148, v148, v36
    v_mul_f32 v149, v149, v36
    v_cvt_pk_bf16_f32 v121, v148, v149
    s_lshr_b32 s91, s64, 16
    s_lshl_b32 s92, s68, 10
    ds_write_b64 v135, v[4:5] offset:3072
    v_fmac_f32 v32, v116, v116
    s_sub_u32 s84, s45, s44
    s_sub_u32 s85, s46, s45
    ds_write_b64 v135, v[6:7] offset:3080
    v_fmac_f32 v32, v117, v117
    v_fmac_f32 v32, v118, v118
    v_fmac_f32 v32, v119, v119
    s_sub_u32 s86, s44, s45
    s_sub_u32 s93, s44, s47
    ds_write_b32 v134, v120 offset:3072
    ds_write_b32 v134, v121 offset:3076
    v_fma_f32 v131, v140, v140, s42
    v_fmac_f32 v131, v141, v141
    v_fmac_f32 v131, v142, v142
    v_fmac_f32 v131, v143, v143
    v_fmac_f32 v131, v44, v44
    v_fmac_f32 v131, v45, v45
    v_fmac_f32 v131, v46, v46
    v_fmac_f32 v131, v47, v47
    v_fmac_f32 v131, v56, v56
    v_fmac_f32 v131, v57, v57
    v_fmac_f32 v131, v58, v58
    v_fmac_f32 v131, v59, v59
    v_fma_f32 v121, v24, v24, s42
    v_fmac_f32 v121, v25, v25
    v_fmac_f32 v121, v26, v26
    v_fmac_f32 v121, v27, v27
    v_fmac_f32 v121, v88, v88
    v_fmac_f32 v121, v89, v89
    v_fmac_f32 v121, v90, v90
    v_fmac_f32 v121, v91, v91
    v_fmac_f32 v121, v72, v72
    v_fmac_f32 v121, v73, v73
    v_fmac_f32 v121, v74, v74
    v_fmac_f32 v121, v75, v75
    v_cvt_pk_bf16_f32 v120, v32, v131
    v_cvt_pk_bf16_f32 v121, v121, v122
    s_sub_u32 s94, s45, s47
    s_sub_u32 s95, s46, s47
    ds_write_b64 v130, v[120:121]
    v_mbcnt_lo_u32_b32 v131, -1, 0
    v_mbcnt_hi_u32_b32 v131, -1, v131
    v_and_b32 v138, 15, v131
    v_lshrrev_b32 v131, 4, v131
    v_mul_u32_u24 v131, 1792, v131
    v_add_u32 v131, s89, v131
    v_mad_u32_u24 v132, v138, s90, v131
    v_lshrrev_b32 v139, v138, s64
    v_and_b32 v139, 1, v139
    v_cmp_eq_u32 vcc, 1, v139
    v_mad_u32_u24 v52, v138, s90, v131
    v_lshrrev_b32 v138, v138, s91
    v_cndmask_b32 v132, v131, v132, vcc
    v_and_b32 v138, 1, v138
    v_subrev_u32 v52, 28672, v52
    v_cmp_eq_u32 vcc, 1, v138
    ds_read_b128 v[20:23], v132 offset:64
    ds_read_b128 v[16:19], v132 offset:80
    v_cndmask_b32 v52, v131, v52, vcc
    v_add_u32 v131, s92, v129
    s_waitcnt lgkmcnt(2)
    s_barrier
    ds_read_b128 v[98:101], v132
    v_add_u32 v54, s84, v137
    ds_read_b64 v[102:103], v132 offset:16
    ds_read_b128 v[4:7], v131 offset:6144
    v_add_u32 v53, s84, v136
    v_add_u32 v120, s85, v135
    ds_read_b128 v[8:11], v129 offset:0
    v_add_u32 v55, s85, v134
    ds_read_b128 v[0:3], v129 offset:1024
    v_add_u32 v138, s86, v135
    v_add_u32 v132, s86, v134
    v_add_u32 v131, s93, v133
    v_add_u32 v139, s94, v133
    s_waitcnt lgkmcnt(6)
    v_mfma_f32_16x16x32_bf16 v[12:15], v[220:223], v[20:23], 0
    s_waitcnt lgkmcnt(5)
    ds_read_b128 v[92:95], v54 offset:1536
    ds_read_b128 v[68:71], v53 offset:1536
    v_mfma_f32_16x16x32_bf16 v[12:15], v[220:223], v[16:19], v[12:15]
    s_waitcnt lgkmcnt(3)
    ds_read_b128 v[64:67], v54 offset:1664
    v_lshlrev_b32 v76, 16, v98
    v_and_b32 v98, 0xffff0000, v98
    v_lshlrev_b32 v77, 16, v99
    v_and_b32 v99, 0xffff0000, v99
    v_lshlrev_b32 v78, 16, v100
    v_and_b32 v100, 0xffff0000, v100
    v_rcp_f32 v12, v12
    v_lshlrev_b32 v79, 16, v101
    v_mfma_f32_16x16x32_bf16 v[16:19], v[216:219], v[8:11], 0
    s_waitcnt lgkmcnt(3)
    ds_read_b128 v[60:63], v53 offset:1664
    ds_read_b128 v[40:43], v54 offset:1792
    v_mfma_f32_16x16x32_bf16 v[16:19], v[216:219], v[0:3], v[16:19]
    s_waitcnt lgkmcnt(4)
    ds_read_b128 v[28:31], v53 offset:1792
    v_mul_f32 v76, v76, v12
    v_mul_f32 v98, v98, v12
    v_cvt_pk_bf16_f32 v76, v76, v98
    v_mul_f32 v77, v77, v12
    v_mfma_f32_16x16x32_bf16 v[8:11], a[216:219], v[92:95], 0
    s_waitcnt lgkmcnt(4)
    v_mul_f32 v99, v99, v12
    v_cvt_pk_bf16_f32 v77, v77, v99
    v_mfma_f32_16x16x32_bf16 v[8:11], a[220:223], v[68:71], v[8:11]
    s_waitcnt lgkmcnt(3)
    ds_read_b128 v[108:111], v54 offset:0
    ds_read_b128 v[96:99], v53 offset:0
    v_mfma_f32_16x16x32_bf16 v[8:11], a[224:227], v[64:67], v[8:11]
    s_waitcnt lgkmcnt(4)
    ds_read_b128 v[84:87], v54 offset:128
    v_mul_f32 v78, v78, v12
    v_mul_f32 v100, v100, v12
    v_cvt_pk_bf16_f32 v78, v78, v100
    v_and_b32 v101, 0xffff0000, v101
    v_mul_f32 v79, v79, v12
    v_mfma_f32_16x16x32_bf16 v[8:11], a[228:231], v[60:63], v[8:11]
    s_waitcnt lgkmcnt(4)
    ds_read_b128 v[36:39], v53 offset:128
    ds_read_b128 v[20:23], v54 offset:256
    v_mfma_f32_16x16x32_bf16 v[8:11], a[232:235], v[40:43], v[8:11]
    s_waitcnt lgkmcnt(5)
    ds_read_b128 v[0:3], v53 offset:256
    v_mul_f32 v101, v101, v12
    v_mfma_f32_16x16x32_bf16 v[8:11], a[236:239], v[28:31], v[8:11]
    v_cvt_pk_bf16_f32 v79, v79, v101
    v_lshlrev_b32 v19, 16, v102
    v_mfma_f32_16x16x32_bf16 v[32:35], a[240:243], v[92:95], 0
    ds_write_b128 v138, v[76:79] offset:0
    v_mfma_f32_16x16x32_bf16 v[32:35], a[244:247], v[68:71], v[32:35]
    v_and_b32 v102, 0xffff0000, v102
    v_mul_f32 v19, v19, v12
    v_mfma_f32_16x16x32_bf16 v[32:35], a[248:251], v[64:67], v[32:35]
    v_mul_f32 v102, v102, v12
    v_cvt_pk_bf16_f32 v76, v19, v102
    v_mfma_f32_16x16x32_bf16 v[32:35], a[252:255], v[60:63], v[32:35]
    v_lshlrev_b32 v19, 16, v103
    v_and_b32 v103, 0xffff0000, v103
    v_mfma_f32_16x16x32_bf16 v[32:35], v[224:227], v[40:43], v[32:35]
    v_mul_f32 v19, v19, v12
    v_mul_f32 v103, v103, v12
    v_mfma_f32_16x16x32_bf16 v[32:35], v[228:231], v[28:31], v[32:35]
    v_cvt_pk_bf16_f32 v77, v19, v103
    v_lshrrev_b32 v19, 0, v7
    v_mfma_f32_16x16x32_bf16 v[12:15], v[232:235], v[92:95], 0
    ds_write_b64 v132, v[76:77] offset:0
    v_mfma_f32_16x16x32_bf16 v[12:15], v[236:239], v[68:71], v[12:15]
    v_lshrrev_b32 v19, v19, s64
    v_and_b32 v19, 1, v19
    v_mfma_f32_16x16x32_bf16 v[12:15], v[240:243], v[64:67], v[12:15]
    v_cmp_eq_u32 vcc, 1, v19
    v_lshrrev_b32 v19, 8, v7
    v_mfma_f32_16x16x32_bf16 v[12:15], v[244:247], v[60:63], v[12:15]
    v_cndmask_b32 v4, 2.0, v4, vcc
    v_lshrrev_b32 v19, v19, s64
    v_mfma_f32_16x16x32_bf16 v[12:15], v[248:251], v[40:43], v[12:15]
    v_and_b32 v19, 1, v19
    v_cmp_eq_u32 vcc, 1, v19
    v_mfma_f32_16x16x32_bf16 v[12:15], v[252:255], v[28:31], v[12:15]
    s_waitcnt lgkmcnt(1)
    v_cndmask_b32 v5, 2.0, v5, vcc
    v_lshrrev_b32 v7, 16, v7
    v_mfma_f32_16x16x32_bf16 v[68:71], a[216:219], v[108:111], 0
    v_lshrrev_b32 v7, v7, s64
    v_and_b32 v7, 1, v7
    v_mfma_f32_16x16x32_bf16 v[68:71], a[220:223], v[96:99], v[68:71]
    ds_read_b128 v[104:107], v54 offset:3072
    ds_read_b128 v[100:103], v53 offset:3072
    v_mfma_f32_16x16x32_bf16 v[68:71], a[224:227], v[84:87], v[68:71]
    ds_read_b128 v[92:95], v54 offset:3200
    v_cmp_eq_u32 vcc, 1, v7
    v_mfma_f32_16x16x32_bf16 v[68:71], a[228:231], v[36:39], v[68:71]
    ds_read_b128 v[64:67], v53 offset:3200
    v_cndmask_b32 v6, 2.0, v6, vcc
    v_mfma_f32_16x16x32_bf16 v[68:71], a[232:235], v[20:23], v[68:71]
L_pg2:
    s_cbranch_execz L_main
    ds_read_b128 v[60:63], v54 offset:3328
    v_add_u32 v7, s95, v133
    v_mfma_f32_16x16x32_bf16 v[68:71], a[236:239], v[0:3], v[68:71]
    ds_read_b128 v[28:31], v53 offset:3328
    v_fma_f32 v133, v8, v8, s42
    v_mfma_f32_16x16x32_bf16 v[76:79], a[240:243], v[108:111], 0
    v_rsq_f32 v16, v16
    v_mfma_f32_16x16x32_bf16 v[76:79], a[244:247], v[96:99], v[76:79]
    v_mul_f32 v16, s43, v16
    v_mul_f32 v48, v48, v16
    v_mfma_f32_16x16x32_bf16 v[76:79], a[248:251], v[84:87], v[76:79]
    v_mul_f32 v49, v49, v16
    v_cvt_pk_bf16_f32 v48, v48, v49
    v_mfma_f32_16x16x32_bf16 v[76:79], a[252:255], v[36:39], v[76:79]
    v_mul_f32 v50, v50, v16
    v_mul_f32 v51, v51, v16
    v_mfma_f32_16x16x32_bf16 v[76:79], v[224:227], v[20:23], v[76:79]
    v_cvt_pk_bf16_f32 v49, v50, v51
    v_mul_f32 v80, v80, v16
    v_mfma_f32_16x16x32_bf16 v[76:79], v[228:231], v[0:3], v[76:79]
    v_mul_f32 v81, v81, v16
    v_cvt_pk_bf16_f32 v50, v80, v81
    v_mfma_f32_16x16x32_bf16 v[40:43], v[232:235], v[108:111], 0
    v_mul_f32 v82, v82, v16
    v_mul_f32 v83, v83, v16
    v_mfma_f32_16x16x32_bf16 v[40:43], v[236:239], v[96:99], v[40:43]
    v_cvt_pk_bf16_f32 v51, v82, v83
    v_mul_f32 v116, v116, v16
    v_mfma_f32_16x16x32_bf16 v[40:43], v[240:243], v[84:87], v[40:43]
    ds_write_b128 v120, v[48:51] offset:0
    v_mfma_f32_16x16x32_bf16 v[40:43], v[244:247], v[36:39], v[40:43]
    v_mul_f32 v117, v117, v16
    v_cvt_pk_bf16_f32 v116, v116, v117
    v_mfma_f32_16x16x32_bf16 v[40:43], v[248:251], v[20:23], v[40:43]
    v_mul_f32 v118, v118, v16
    v_mul_f32 v119, v119, v16
    v_mfma_f32_16x16x32_bf16 v[40:43], v[252:255], v[0:3], v[40:43]
    s_waitcnt lgkmcnt(1)
    v_cvt_pk_bf16_f32 v117, v118, v119
    v_fma_f32 v54, v68, v68, s42
    v_mfma_f32_16x16x32_bf16 v[20:23], a[216:219], v[104:107], 0
    ds_write_b64 v55, v[116:117] offset:0
    v_mfma_f32_16x16x32_bf16 v[20:23], a[220:223], v[100:103], v[20:23]
    ds_read_b128 v[36:39], v52 offset:64
    v_fmac_f32 v54, v69, v69
    v_mfma_f32_16x16x32_bf16 v[20:23], a[224:227], v[92:95], v[20:23]
    ds_read_b128 v[0:3], v52 offset:80
    v_fmac_f32 v54, v70, v70
    v_mfma_f32_16x16x32_bf16 v[20:23], a[228:231], v[64:67], v[20:23]
    ds_read_b128 v[48:51], v52
    v_fmac_f32 v54, v71, v71
    v_mfma_f32_16x16x32_bf16 v[20:23], a[232:235], v[60:63], v[20:23]
    ds_read_b64 v[52:53], v52 offset:16
    v_fmac_f32 v54, v76, v76
    v_mfma_f32_16x16x32_bf16 v[20:23], a[236:239], v[28:31], v[20:23]
    v_rsq_f32 v17, v17
    v_mfma_f32_16x16x32_bf16 v[96:99], a[240:243], v[104:107], 0
    v_mul_f32 v17, s43, v17
    v_mul_f32 v140, v140, v17
    v_mfma_f32_16x16x32_bf16 v[96:99], a[244:247], v[100:103], v[96:99]
    v_mul_f32 v141, v141, v17
    v_cvt_pk_bf16_f32 v84, v140, v141
    v_mfma_f32_16x16x32_bf16 v[96:99], a[248:251], v[92:95], v[96:99]
    v_mul_f32 v142, v142, v17
    v_mul_f32 v143, v143, v17
    v_mfma_f32_16x16x32_bf16 v[96:99], a[252:255], v[64:67], v[96:99]
    v_cvt_pk_bf16_f32 v85, v142, v143
    v_mul_f32 v44, v44, v17
    v_mfma_f32_16x16x32_bf16 v[96:99], v[224:227], v[60:63], v[96:99]
    v_mul_f32 v45, v45, v17
    v_cvt_pk_bf16_f32 v86, v44, v45
    v_mfma_f32_16x16x32_bf16 v[96:99], v[228:231], v[28:31], v[96:99]
    v_mul_f32 v46, v46, v17
    v_mul_f32 v47, v47, v17
    v_mfma_f32_16x16x32_bf16 v[80:83], v[232:235], v[104:107], 0
    v_cvt_pk_bf16_f32 v87, v46, v47
    v_mul_f32 v56, v56, v17
    v_mfma_f32_16x16x32_bf16 v[80:83], v[236:239], v[100:103], v[80:83]
    ds_write_b128 v120, v[84:87] offset:1536
    v_mfma_f32_16x16x32_bf16 v[80:83], v[240:243], v[92:95], v[80:83]
    v_mul_f32 v57, v57, v17
    v_cvt_pk_bf16_f32 v56, v56, v57
    v_mfma_f32_16x16x32_bf16 v[80:83], v[244:247], v[64:67], v[80:83]
    v_mul_f32 v58, v58, v17
    v_mul_f32 v59, v59, v17
    v_mfma_f32_16x16x32_bf16 v[80:83], v[248:251], v[60:63], v[80:83]
    v_cvt_pk_bf16_f32 v57, v58, v59
    v_fmac_f32 v54, v77, v77
    v_mfma_f32_16x16x32_bf16 v[80:83], v[252:255], v[28:31], v[80:83]
    s_waitcnt lgkmcnt(1)
    ds_write_b64 v55, v[56:57] offset:1536
    v_mfma_f32_16x16x32_bf16 v[28:31], v[220:223], v[36:39], 0
    v_rsq_f32 v18, v18
    v_mfma_f32_16x16x32_bf16 v[28:31], v[220:223], v[0:3], v[28:31]
    v_mul_f32 v18, s43, v18
    v_mul_f32 v24, v24, v18
    v_mul_f32 v25, v25, v18
    v_cvt_pk_bf16_f32 v0, v24, v25
    v_mul_f32 v26, v26, v18
    v_mul_f32 v27, v27, v18
    v_cvt_pk_bf16_f32 v1, v26, v27
    v_mul_f32 v88, v88, v18
    v_mul_f32 v89, v89, v18
    v_cvt_pk_bf16_f32 v2, v88, v89
    v_mul_f32 v90, v90, v18
    v_mul_f32 v91, v91, v18
    v_cvt_pk_bf16_f32 v3, v90, v91
    v_mul_f32 v72, v72, v18
    v_mul_f32 v73, v73, v18
    v_cvt_pk_bf16_f32 v72, v72, v73
    v_mul_f32 v74, v74, v18
    v_mul_f32 v75, v75, v18
    v_cvt_pk_bf16_f32 v73, v74, v75
    ds_write_b128 v120, v[0:3] offset:3072
    v_fmac_f32 v54, v78, v78
    v_fmac_f32 v54, v79, v79
    v_fmac_f32 v54, v40, v40
    v_fmac_f32 v54, v41, v41
    ds_write_b64 v55, v[72:73] offset:3072
    v_fmac_f32 v54, v42, v42
    v_fmac_f32 v54, v43, v43
    v_fmac_f32 v133, v9, v9
    v_fmac_f32 v133, v10, v10
    v_fmac_f32 v133, v11, v11
    v_fmac_f32 v133, v32, v32
    v_fmac_f32 v133, v33, v33
    v_fmac_f32 v133, v34, v34
    v_fmac_f32 v133, v35, v35
    v_fmac_f32 v133, v12, v12
    v_fmac_f32 v133, v13, v13
    v_fmac_f32 v133, v14, v14
    v_fmac_f32 v133, v15, v15
    v_cvt_pk_bf16_f32 v54, v54, v133
    v_fma_f32 v133, v20, v20, s42
    v_fmac_f32 v133, v21, v21
    v_fmac_f32 v133, v22, v22
    v_fmac_f32 v133, v23, v23
    v_fmac_f32 v133, v96, v96
    v_fmac_f32 v133, v97, v97
    v_fmac_f32 v133, v98, v98
    v_fmac_f32 v133, v99, v99
    v_fmac_f32 v133, v80, v80
    v_fmac_f32 v133, v81, v81
    v_fmac_f32 v133, v82, v82
    v_fmac_f32 v133, v83, v83
    v_cvt_pk_bf16_f32 v55, v133, v133
    ds_write_b64 v130, v[54:55] offset:2048
    v_rcp_f32 v28, v28
    v_lshlrev_b32 v133, 16, v48
    v_and_b32 v48, 0xffff0000, v48
    v_mul_f32 v133, v133, v28
    v_mul_f32 v48, v48, v28
    v_cvt_pk_bf16_f32 v16, v133, v48
    v_lshlrev_b32 v48, 16, v49
    v_and_b32 v49, 0xffff0000, v49
    v_mul_f32 v48, v48, v28
    v_mul_f32 v49, v49, v28
    v_cvt_pk_bf16_f32 v17, v48, v49
    v_lshlrev_b32 v133, 16, v50
    v_and_b32 v50, 0xffff0000, v50
    v_mul_f32 v133, v133, v28
    v_mul_f32 v50, v50, v28
    v_cvt_pk_bf16_f32 v18, v133, v50
    v_lshlrev_b32 v19, 16, v51
    v_and_b32 v51, 0xffff0000, v51
    v_mul_f32 v19, v19, v28
    v_mul_f32 v51, v51, v28
    v_cvt_pk_bf16_f32 v19, v19, v51
    v_lshlrev_b32 v133, 16, v52
    v_and_b32 v52, 0xffff0000, v52
    v_mul_f32 v133, v133, v28
    v_mul_f32 v52, v52, v28
    v_cvt_pk_bf16_f32 v0, v133, v52
    v_lshlrev_b32 v133, 16, v53
    v_and_b32 v53, 0xffff0000, v53
    v_mul_f32 v133, v133, v28
    v_mul_f32 v53, v53, v28
    v_cvt_pk_bf16_f32 v1, v133, v53
    s_waitcnt lgkmcnt(0)
    s_barrier
    ds_write_b128 v138, v[16:19] offset:1536
    v_and_b32 v123, 0xb8000000, v123
    v_mov_b32 v121, 0x3f803f80
    v_cmp_ne_u32 vcc, 0, v123
    s_nop 0
    ds_write_b64 v132, v[0:1] offset:1536
    v_cndmask_b32 v121, 0, v121, vcc
    ds_read_b128 v[36:39], v7 offset:0
    ds_read_b128 v[0:3], v7 offset:1024
    ds_read_b128 v[24:27], v7 offset:2048
    ds_read_b128 v[108:111], v7 offset:3072
    ds_read_b128 v[72:75], v7 offset:4096
    s_waitcnt lgkmcnt(5)
    s_barrier
    s_waitcnt lgkmcnt(4)
    buffer_store_dwordx4 v[36:39], v128, s[28:31], s59 offen sc1
    ds_read_b128 v[28:31], v129 offset:2048
    ds_read_b128 v[16:19], v129 offset:3072
    ds_read_b128 v[104:107], v137 offset:1536
    ds_read_b128 v[100:103], v136 offset:1536
    ds_read_b128 v[92:95], v137 offset:1664
    ds_read_b128 v[84:87], v136 offset:1664
    ds_read_b128 v[44:47], v137 offset:1792
    s_waitcnt lgkmcnt(9)
    buffer_store_dwordx4 v[0:3], v127, s[28:31], s59 offen sc1
    ds_read_b128 v[36:39], v136 offset:1792
    s_waitcnt lgkmcnt(7)
    v_mfma_f32_16x16x32_bf16 v[0:3], v[216:219], v[28:31], 0
    s_waitcnt lgkmcnt(6)
    v_mfma_f32_16x16x32_bf16 v[0:3], v[216:219], v[16:19], v[0:3]
    s_waitcnt lgkmcnt(5)
    v_mfma_f32_16x16x32_bf16 v[16:19], a[216:219], v[104:107], 0
    s_waitcnt lgkmcnt(4)
    v_mfma_f32_16x16x32_bf16 v[16:19], a[220:223], v[100:103], v[16:19]
    s_waitcnt lgkmcnt(3)
    ds_read_b128 v[64:67], v137 offset:0
    ds_read_b128 v[60:63], v136 offset:0
    v_mfma_f32_16x16x32_bf16 v[16:19], a[224:227], v[92:95], v[16:19]
    s_waitcnt lgkmcnt(4)
    ds_read_b128 v[56:59], v137 offset:128
    v_mfma_f32_16x16x32_bf16 v[16:19], a[228:231], v[84:87], v[16:19]
    s_waitcnt lgkmcnt(4)
    buffer_store_dwordx4 v[24:27], v126, s[28:31], s59 offen sc1
    ds_read_b128 v[52:55], v136 offset:128
    v_rsq_f32 v0, v0
    v_mfma_f32_16x16x32_bf16 v[16:19], a[232:235], v[44:47], v[16:19]
    s_waitcnt lgkmcnt(4)
    ds_read_b128 v[48:51], v137 offset:256
    ds_read_b128 v[24:27], v136 offset:256
    v_mfma_f32_16x16x32_bf16 v[16:19], a[236:239], v[36:39], v[16:19]
    v_rsq_f32 v1, v1
    v_mfma_f32_16x16x32_bf16 v[28:31], a[240:243], v[104:107], 0
    v_mul_f32 v0, s43, v0
    v_mul_f32 v1, s43, v1
    v_mfma_f32_16x16x32_bf16 v[28:31], a[244:247], v[100:103], v[28:31]
    v_rsq_f32 v2, v2
    v_mfma_f32_16x16x32_bf16 v[28:31], a[248:251], v[92:95], v[28:31]
    v_mul_f32 v2, s43, v2
    v_mul_f32 v20, v20, v2
    v_mfma_f32_16x16x32_bf16 v[28:31], a[252:255], v[84:87], v[28:31]
    buffer_store_dwordx4 v[108:111], v125, s[28:31], s59 offen sc1
    v_mul_f32 v21, v21, v2
    v_cvt_pk_bf16_f32 v88, v20, v21
    v_mul_f32 v22, v22, v2
    v_mul_f32 v23, v23, v2
    v_mfma_f32_16x16x32_bf16 v[28:31], v[224:227], v[44:47], v[28:31]
    v_cvt_pk_bf16_f32 v89, v22, v23
    v_mul_f32 v96, v96, v2
    v_mfma_f32_16x16x32_bf16 v[28:31], v[228:231], v[36:39], v[28:31]
    v_mul_f32 v97, v97, v2
    v_cvt_pk_bf16_f32 v90, v96, v97
    v_mfma_f32_16x16x32_bf16 v[20:23], v[232:235], v[104:107], 0
    v_mul_f32 v98, v98, v2
    v_mul_f32 v99, v99, v2
    v_mfma_f32_16x16x32_bf16 v[20:23], v[236:239], v[100:103], v[20:23]
    v_cvt_pk_bf16_f32 v91, v98, v99
    v_mul_f32 v80, v80, v2
    v_mfma_f32_16x16x32_bf16 v[20:23], v[240:243], v[92:95], v[20:23]
    ds_write_b128 v135, v[88:91] offset:3072
    v_mfma_f32_16x16x32_bf16 v[20:23], v[244:247], v[84:87], v[20:23]
    buffer_store_dwordx4 v[72:75], v124, s[28:31], s59 offen sc1
    v_mul_f32 v81, v81, v2
    v_cvt_pk_bf16_f32 v136, v80, v81
    v_mul_f32 v82, v82, v2
    v_mul_f32 v83, v83, v2
    v_mfma_f32_16x16x32_bf16 v[20:23], v[248:251], v[44:47], v[20:23]
    v_cvt_pk_bf16_f32 v137, v82, v83
    v_mul_f32 v68, v68, v0
    v_mfma_f32_16x16x32_bf16 v[20:23], v[252:255], v[36:39], v[20:23]
    s_waitcnt lgkmcnt(1)
    ds_write_b64 v134, v[136:137] offset:3072
    v_mfma_f32_16x16x32_bf16 v[36:39], a[216:219], v[64:67], 0
    v_mul_f32 v69, v69, v0
    v_cvt_pk_bf16_f32 v68, v68, v69
    v_mfma_f32_16x16x32_bf16 v[36:39], a[220:223], v[60:63], v[36:39]
    v_mul_f32 v70, v70, v0
    v_mul_f32 v71, v71, v0
    v_mfma_f32_16x16x32_bf16 v[36:39], a[224:227], v[56:59], v[36:39]
    v_cvt_pk_bf16_f32 v69, v70, v71
    v_mul_f32 v76, v76, v0
    v_mfma_f32_16x16x32_bf16 v[36:39], a[228:231], v[52:55], v[36:39]
    v_mul_f32 v77, v77, v0
    v_cvt_pk_bf16_f32 v70, v76, v77
    v_mfma_f32_16x16x32_bf16 v[36:39], a[232:235], v[48:51], v[36:39]
    v_mul_f32 v78, v78, v0
    v_mul_f32 v79, v79, v0
    v_mfma_f32_16x16x32_bf16 v[36:39], a[236:239], v[24:27], v[36:39]
    v_cvt_pk_bf16_f32 v71, v78, v79
    v_mul_f32 v40, v40, v0
    v_mfma_f32_16x16x32_bf16 v[44:47], a[240:243], v[64:67], 0
    ds_write_b128 v135, v[68:71] offset:0
    v_mfma_f32_16x16x32_bf16 v[44:47], a[244:247], v[60:63], v[44:47]
    v_mul_f32 v41, v41, v0
    v_cvt_pk_bf16_f32 v2, v40, v41
    v_mfma_f32_16x16x32_bf16 v[44:47], a[248:251], v[56:59], v[44:47]
    v_mul_f32 v42, v42, v0
    v_mul_f32 v43, v43, v0
    v_mfma_f32_16x16x32_bf16 v[44:47], a[252:255], v[52:55], v[44:47]
    v_cvt_pk_bf16_f32 v3, v42, v43
    v_fma_f32 v7, v16, v16, s42
    v_mfma_f32_16x16x32_bf16 v[44:47], v[224:227], v[48:51], v[44:47]
    ds_write_b64 v134, v[2:3] offset:0
    v_mfma_f32_16x16x32_bf16 v[44:47], v[228:231], v[24:27], v[44:47]
    v_fmac_f32 v7, v17, v17
    v_fmac_f32 v7, v18, v18
    v_mfma_f32_16x16x32_bf16 v[40:43], v[232:235], v[64:67], 0
    v_fmac_f32 v7, v19, v19
    v_fmac_f32 v7, v28, v28
    v_mfma_f32_16x16x32_bf16 v[40:43], v[236:239], v[60:63], v[40:43]
    v_fmac_f32 v7, v29, v29
    v_fmac_f32 v7, v30, v30
    v_mfma_f32_16x16x32_bf16 v[40:43], v[240:243], v[56:59], v[40:43]
    v_fmac_f32 v7, v31, v31
    v_fmac_f32 v7, v20, v20
    v_mfma_f32_16x16x32_bf16 v[40:43], v[244:247], v[52:55], v[40:43]
    v_fmac_f32 v7, v21, v21
    v_fmac_f32 v7, v22, v22
    v_mfma_f32_16x16x32_bf16 v[40:43], v[248:251], v[48:51], v[40:43]
    v_fmac_f32 v7, v23, v23
    v_fma_f32 v133, v36, v36, s42
    v_mfma_f32_16x16x32_bf16 v[40:43], v[252:255], v[24:27], v[40:43]
    s_nop 0
    v_fmac_f32 v133, v37, v37
    v_fmac_f32 v133, v38, v38
    v_fmac_f32 v133, v39, v39
    v_fmac_f32 v133, v44, v44
    v_fmac_f32 v133, v45, v45
    v_fmac_f32 v133, v46, v46
    v_fmac_f32 v133, v47, v47
    v_fmac_f32 v133, v40, v40
    v_fmac_f32 v133, v41, v41
    v_fmac_f32 v133, v42, v42
    v_fmac_f32 v133, v43, v43
    v_cvt_pk_bf16_f32 v120, v133, v7
    ds_write_b64 v130, v[120:121] offset:4096
    v_mul_f32 v8, v8, v1
    v_mul_f32 v9, v9, v1
    v_cvt_pk_bf16_f32 v8, v8, v9
    v_mul_f32 v10, v10, v1
    v_mul_f32 v11, v11, v1
    v_cvt_pk_bf16_f32 v9, v10, v11
    v_mul_f32 v32, v32, v1
    v_mul_f32 v33, v33, v1
    v_cvt_pk_bf16_f32 v10, v32, v33
    v_mul_f32 v34, v34, v1
    v_mul_f32 v35, v35, v1
    v_cvt_pk_bf16_f32 v11, v34, v35
    v_mul_f32 v12, v12, v1
    v_mul_f32 v13, v13, v1
    v_cvt_pk_bf16_f32 v136, v12, v13
    v_mul_f32 v14, v14, v1
    v_mul_f32 v15, v15, v1
    v_cvt_pk_bf16_f32 v137, v14, v15
    ds_write_b128 v135, v[8:11] offset:1536
    s_waitcnt lgkmcnt(1)
    s_barrier
    ds_write_b64 v134, v[136:137] offset:1536
    ds_read_b128 v[8:11], v129 offset:4096
    ds_read_b128 v[0:3], v129 offset:5120
    s_waitcnt lgkmcnt(2)
    s_barrier
    s_waitcnt lgkmcnt(1)
    v_mfma_f32_16x16x32_bf16 v[24:27], v[216:219], v[8:11], 0
    s_waitcnt lgkmcnt(0)
    ds_read_b128 v[48:51], v139 offset:0
    ds_read_b128 v[32:35], v139 offset:1024
    v_mfma_f32_16x16x32_bf16 v[24:27], v[216:219], v[0:3], v[24:27]
    s_nop 0
    ds_read_b128 v[12:15], v139 offset:2048
    s_nop 2
    ds_read_b128 v[8:11], v139 offset:3072
    s_nop 1
    v_rsq_f32 v24, v24
    ds_read_b128 v[0:3], v139 offset:4096
    v_mul_f32 v24, s43, v24
    v_mul_f32 v36, v36, v24
    v_mul_f32 v37, v37, v24
    v_cvt_pk_bf16_f32 v36, v36, v37
    v_mul_f32 v38, v38, v24
    v_mul_f32 v39, v39, v24
    v_cvt_pk_bf16_f32 v37, v38, v39
    v_mul_f32 v44, v44, v24
    v_mul_f32 v45, v45, v24
    s_waitcnt lgkmcnt(4)
    buffer_store_dwordx4 v[48:51], v128, s[28:31], s58 offen sc1
    v_cvt_pk_bf16_f32 v38, v44, v45
    v_mul_f32 v46, v46, v24
    v_mul_f32 v47, v47, v24
    v_cvt_pk_bf16_f32 v39, v46, v47
    v_mul_f32 v40, v40, v24
    v_mul_f32 v41, v41, v24
    v_cvt_pk_bf16_f32 v128, v40, v41
    v_mul_f32 v42, v42, v24
    v_mul_f32 v43, v43, v24
    v_cvt_pk_bf16_f32 v129, v42, v43
    ds_write_b128 v138, v[36:39] offset:0
    v_rsq_f32 v25, v25
    v_cmp_neq_f32 vcc, 0, v26
    v_mul_f32 v25, s43, v25
    s_waitcnt lgkmcnt(1)
    buffer_store_dwordx4 v[32:35], v127, s[28:31], s58 offen sc1
    ds_write_b64 v132, v[128:129] offset:0
    v_mul_f32 v16, v16, v25
    v_mul_f32 v17, v17, v25
    v_cvt_pk_bf16_f32 v16, v16, v17
    v_mul_f32 v18, v18, v25
    v_mul_f32 v19, v19, v25
    v_cvt_pk_bf16_f32 v17, v18, v19
    v_mul_f32 v28, v28, v25
    v_mul_f32 v29, v29, v25
    v_cvt_pk_bf16_f32 v18, v28, v29
    v_mul_f32 v30, v30, v25
    v_mul_f32 v31, v31, v25
    v_cvt_pk_bf16_f32 v19, v30, v31
    v_mul_f32 v20, v20, v25
    v_mul_f32 v21, v21, v25
    v_cvt_pk_bf16_f32 v128, v20, v21
    v_mul_f32 v22, v22, v25
    v_mul_f32 v23, v23, v25
    v_cvt_pk_bf16_f32 v129, v22, v23
    buffer_store_dwordx4 v[12:15], v126, s[28:31], s58 offen sc1
    ds_write_b128 v138, v[16:19] offset:1536
    ds_write_b64 v132, v[128:129] offset:1536
    buffer_store_dwordx4 v[8:11], v125, s[28:31], s58 offen sc1
    s_waitcnt lgkmcnt(0)
    s_barrier
    buffer_store_dwordx4 v[0:3], v124, s[28:31], s58 offen sc1
    ds_read_b128 v[12:15], v131 offset:0
    ds_read_b128 v[8:11], v131 offset:1024
    ds_read_b128 v[0:3], v131 offset:2048
    s_waitcnt lgkmcnt(2)
    buffer_store_dwordx4 v[12:15], v4, s[28:31], 0 offen sc1
    s_waitcnt lgkmcnt(0)
    buffer_store_dwordx4 v[8:11], v5, s[28:31], 0 offen sc1
    buffer_store_dwordx4 v[0:3], v6, s[28:31], 0 offen sc1
    s_nop 4
    s_cbranch_vccnz L_slow
L_fin:
    s_cmp_eq_u32 s2, 255
    s_cbranch_scc1 L_again
L_end:
    s_endpgm
L_slow:
    s_waitcnt vmcnt(0) lgkmcnt(0)
    s_nop 15
    s_barrier
    s_lshr_b32 s66, s64, 20
    v_mbcnt_lo_u32_b32 v157, -1, 0
    v_mbcnt_hi_u32_b32 v157, -1, v157
    s_load_dwordx16 s[4:19], s[0:1], 0
    s_load_dwordx4 s[20:23], s[0:1], 64
    s_load_dwordx2 s[38:39], s[0:1], 80
    s_bfe_u32 s88, s2, 0x50003
    s_lshl2_add_u32 s88, s88, s68
    v_lshlrev_b32 v72, 7, v157
    s_mul_i32 s89, s88, 576
    s_mul_i32 s88, s88, 1728
    v_min_u32 v74, 1664, v72
    v_min_u32 v73, 512, v72
    s_mov_b32 s34, 221184
    s_mov_b32 s35, 0x20000
    s_mov_b32 s78, 73728
    s_mov_b32 s79, 0x20000
    v_and_b32 v75, 15, v157
    v_lshrrev_b32 v160, 4, v157
    v_lshrrev_b32 v72, 2, v75
    v_and_b32 v5, 3, v75
    s_mul_i32 s87, s68, 192
    v_mad_u32_u24 v19, v75, 12, s87
    v_lshlrev_b32 v31, 1, v75
    v_lshlrev_b32 v11, 1, v72
    v_lshl_add_u32 v11, v160, 5, v11
    s_movk_i32 s86, 384
    s_mov_b32 s26, 100270464
    s_mov_b32 s27, 0x20000
    s_mov_b32 s30, 0
    s_mov_b32 s31, 0x20000
    s_mul_i32 s96, s68, 288
    s_and_b32 s97, s68, 1
    s_lshl_b32 s97, s97, 2
    s_mov_b32 s98, 193536
    s_waitcnt lgkmcnt(0)
    s_mov_b32 s24, s4
    s_mov_b32 s25, s5
    s_mov_b32 s32, s6
    s_mov_b32 s33, s7
    s_mov_b32 s76, s8
    s_mov_b32 s77, s9
    buffer_load_dword a254, v74, s[32:35], s88 offen
    buffer_load_dword a253, v73, s[76:79], s89 offen
    s_load_dwordx2 s[82:83], s[10:11], 0
    s_movk_i32 s18, 676
    s_mov_b32 s19, 0x20000
    buffer_load_dwordx3 v[28:30], v19, s[16:19], 0 offen
    s_mov_b32 s99, 589824
    v_add_u32 v124, s96, v157
    v_mul_u32_u24 v74, 2731, v124
    v_mul_u32_u24 v73, 6242, v124
    v_lshrrev_b32 v74, 16, v74
    s_lshr_b32 s94, s2, 3
    s_mul_i32 s70, s94, 167
    global_load_ushort v16, v31, s[12:13]
    v_lshrrev_b32 v73, 20, v73
    v_and_or_b32 v8, v74, 3, s97
    v_xor_b32 v8, v124, v8
    v_lshl_add_u32 v128, v8, 4, s99
    v_mad_u32_u24 v128, v73, s98, v128
    s_min_u32 s95, s94, 7
    s_add_u32 s70, s70, s95
    global_load_ushort v17, v31, s[12:13] offset:32
    v_add_u32 v10, 64, v124
    v_mul_u32_u24 v150, 2731, v10
    v_mul_u32_u24 v156, 6242, v10
    v_lshrrev_b32 v150, 16, v150
    v_lshrrev_b32 v156, 20, v156
    s_and_b32 s95, s2, 7
    s_mul_i32 s95, s95, 20
    global_load_ushort v148, v11, s[14:15] offset:0
    v_and_or_b32 v9, v150, 3, s97
    v_xor_b32 v9, v10, v9
    v_lshl_add_u32 v127, v9, 4, s99
    v_mad_u32_u24 v127, v156, s98, v127
    v_add_u32 v18, 128, v124
    s_add_u32 s69, s70, s95
    s_add_u32 s70, s70, 140
    global_load_ushort v158, v11, s[14:15] offset:8
    v_mul_u32_u24 v10, 2731, v18
    v_mul_u32_u24 v4, 6242, v18
    v_lshrrev_b32 v10, 16, v10
    v_lshrrev_b32 v4, 20, v4
    v_and_or_b32 v31, v10, 3, s97
    s_movk_i32 s62, 2688
    s_movk_i32 s71, 20
    global_load_ushort v149, v11, s[14:15] offset:16
    v_xor_b32 v31, v18, v31
    v_lshl_add_u32 v126, v31, 4, s99
    v_mad_u32_u24 v126, v4, s98, v126
    v_add_u32 v125, 192, v124
    v_mul_u32_u24 v159, 2731, v125
    s_cmp_lt_u32 s94, 7
    s_cselect_b32 s73, 28, 27
    global_load_ushort v132, v11, s[14:15] offset:24
    v_mul_u32_u24 v18, 6242, v125
    v_lshrrev_b32 v159, 16, v159
    v_lshrrev_b32 v18, 20, v18
    v_and_or_b32 v11, v159, 3, s97
    v_xor_b32 v11, v125, v11
    v_lshl_add_u32 v125, v11, 4, s99
    v_mad_u32_u24 v125, v18, s98, v125
    v_add_u32 v6, 256, v124
    v_mul_u32_u24 v151, 2731, v6
    v_mul_u32_u24 v11, 6242, v6
    v_lshrrev_b32 v151, 16, v151
    v_lshrrev_b32 v11, 20, v11
    v_and_or_b32 v124, v151, 3, s97
    v_xor_b32 v124, v6, v124
    v_lshl_add_u32 v124, v124, 4, s99
    v_mad_u32_u24 v124, v11, s98, v124
    s_mov_b32 s93, 1769472
    s_mul_i32 s54, s68, 5120
    s_cmp_ge_u32 s2, 248
    s_cbranch_scc1 L_bndS
L_bndrS:
    s_mov_b32 s63, 1180032
    s_mul_i32 s94, s69, 58255
    s_lshr_b32 s94, s94, 22
    s_mul_i32 s94, s94, s63
    s_mul_i32 s72, s69, s62
    s_add_u32 s72, s72, s94
    v_lshl_or_b32 v73, v157, 4, 2.0
    s_sub_u32 s94, s73, 1
    s_max_u32 s94, s94, 20
    s_mul_i32 s95, s68, -44
    s_movk_i32 s99, -24
    s_add_u32 m0, s54, 0
    v_and_b32 v18, -4, v10
    s_mul_i32 s85, s68, 96
    s_sub_u32 s100, s85, 1024
    buffer_load_dwordx4 v128, s[24:27], s72 offen nt lds
    s_add_u32 m0, s54, 1024
    v_mad_u32_u24 v11, v18, 3, v10
    v_add_u32 v11, s95, v11
    v_mad_i32_i24 v10, v10, s99, v31
    v_med3_u32 v18, v11, 20, s94
    v_add_u32 v18, s70, v18
    v_add_u32 v31, s69, v11
    s_sub_u32 s87, s85, 2048
    s_movk_i32 s91, 1152
    buffer_load_dwordx4 v127, s[24:27], s72 offen nt lds
    v_cmp_gt_u32 vcc, s71, v11
    v_lshl_add_u32 v10, v10, 4, s93
    s_add_u32 m0, s54, 43008
    v_cndmask_b32 v31, v18, v31, vcc
    v_mul_u32_u24 v18, 58255, v31
    v_mad_u32_u24 v10, v31, s62, v10
    v_lshrrev_b32 v18, 22, v18
    v_mad_u32_u24 v10, v18, s63, v10
    s_mul_i32 s90, s68, 3072
    s_add_u32 s90, s90, 61440
    buffer_load_dwordx4 v10, s[24:27], 0 offen  lds
    v_lshlrev_b32 v11, 16, v11
    s_add_u32 m0, s54, 2048
    v_and_b32 v31, -4, v150
    v_mad_u32_u24 v18, v31, 3, v150
    v_add_u32 v18, s95, v18
    v_mad_i32_i24 v9, v150, s99, v9
    v_med3_u32 v31, v18, 20, s94
    s_mov_b32 s28, s22
    s_mov_b32 s29, s23
    buffer_load_dwordx4 v126, s[24:27], s72 offen nt lds
    v_add_u32 v31, s70, v31
    v_add_u32 v150, s69, v18
    v_cmp_gt_u32 vcc, s71, v18
    v_lshl_add_u32 v9, v9, 4, s93
    s_add_u32 m0, s54, 41984
    v_cndmask_b32 v150, v31, v150, vcc
    v_mul_u32_u24 v31, 58255, v150
    v_mad_u32_u24 v9, v150, s62, v9
    v_lshrrev_b32 v31, 22, v31
    v_mad_u32_u24 v9, v31, s63, v9
    s_mov_b32 s41, 0x2a8cbccc
    s_mov_b32 s42, 0x38fba882
    buffer_load_dwordx4 v9, s[24:27], 0 offen  lds
    v_lshl_or_b32 v11, v18, 8, v11
    s_add_u32 m0, s54, 3072
    v_cmp_gt_u32 vcc, 32, v157
    v_and_b32 v31, -4, v74
    v_mad_u32_u24 v18, v31, 3, v74
    v_cndmask_b32 v124, v73, v124, vcc
    v_add_u32 v18, s95, v18
    s_mov_b32 s43, 0x415db3d7
    s_mov_b32 s44, 61440
    buffer_load_dwordx4 v125, s[24:27], s72 offen nt lds
    s_add_u32 m0, s54, 4096
    v_mad_i32_i24 v8, v74, s99, v8
    v_med3_u32 v31, v18, 20, s94
    v_add_u32 v31, s70, v31
    v_add_u32 v74, s69, v18
    v_cmp_gt_u32 vcc, s71, v18
    v_lshl_add_u32 v8, v8, 4, s93
    s_mul_i32 s93, s68, 6
    s_lshl_b32 s94, s97, 1
    buffer_load_dwordx4 v124, s[24:27], s72 offen nt lds
    v_cndmask_b32 v74, v31, v74, vcc
    v_mul_u32_u24 v31, 58255, v74
    v_mad_u32_u24 v8, v74, s62, v8
    v_lshrrev_b32 v31, 22, v31
    v_mad_u32_u24 v8, v31, s63, v8
    s_add_u32 m0, s54, 40960
    v_lshl_or_b32 v11, v18, 0, v11
    s_mov_b32 s45, 40960
    s_mov_b32 s46, 20480
    buffer_load_dwordx4 v8, s[24:27], 0 offen nt lds
    v_mul_u32_u24 v6, 10923, v157
    v_lshrrev_b32 v4, 17, v6
    v_lshrrev_b32 v6, 16, v6
    v_mad_i32_i24 v7, v6, -6, v157
    v_bitop3_b32 v4, v4, v6, 4 bitop3:0x28
    v_lshl_add_u32 v7, v7, 4, s85
    v_mul_u32_u24 v4, 3, v4
    v_xor_b32 v6, v6, v4
    v_mad_u32_u24 v4, v6, s91, v7
    v_add_u32 v18, 64, v157
    v_mul_u32_u24 v31, 10923, v18
    v_lshrrev_b32 v156, 17, v31
    v_lshrrev_b32 v31, 16, v31
    v_mad_i32_i24 v159, v31, -6, v18
    v_bitop3_b32 v156, v156, v31, 4 bitop3:0x28
    v_lshl_add_u32 v159, v159, 4, s100
    v_mul_u32_u24 v156, 3, v156
    v_xor_b32 v31, v31, v156
    v_mad_u32_u24 v156, v31, s91, v159
    v_add_u32 v18, 128, v157
    v_mul_u32_u24 v74, 10923, v18
    v_lshrrev_b32 v120, 17, v74
    v_lshrrev_b32 v74, 16, v74
    v_mad_i32_i24 v18, v74, -6, v18
    v_bitop3_b32 v120, v120, v74, 4 bitop3:0x28
    v_lshl_add_u32 v18, v18, 4, s87
    v_mul_u32_u24 v120, 3, v120
    v_xor_b32 v74, v74, v120
    v_mad_u32_u24 v120, v74, s91, v18
    v_mad_u32_u24 v121, v6, s86, v7
    v_mad_u32_u24 v25, v31, s86, v159
    v_mad_u32_u24 v24, v74, s86, v18
    s_add_u32 m0, s90, 0
    s_mov_b32 s92, 0
    buffer_load_dwordx4 v4, s[32:35], s92 offen offset:0 lds
    v_mov_b32 v18, 0x3f803f80
    v_cmp_eq_u32 vcc, 0, v5
    v_and_b32 v31, 1, v157
    v_lshlrev_b32 v31, 4, v31
    v_cndmask_b32 v220, 0, v18, vcc
    v_cndmask_b32 v221, 0, v18, vcc
    v_cndmask_b32 v222, 0, v18, vcc
    v_cndmask_b32 v223, 0, v18, vcc
    v_mov_b32 v18, 0x3f80
    v_lshlrev_b32 v18, v31, v18
    v_cmp_gt_u32 vcc, 2, v5
    v_mov_b32 v171, 0
    v_mov_b32 v167, 0
    v_cndmask_b32 v216, 0, v18, vcc
    v_cndmask_b32 v218, 0, v18, vcc
    v_cmp_le_u32 vcc, 2, v5
    v_mov_b32 v163, 0
    v_mov_b32 v159, 0
    v_cndmask_b32 v217, 0, v18, vcc
    v_cndmask_b32 v219, 0, v18, vcc
    v_cmp_eq_u32 vcc, v160, v72
    v_mov_b32 v150, 0
    v_mov_b32 v151, 0
    v_cndmask_b32 v26, 0, v216, vcc
    v_cndmask_b32 v27, 0, v217, vcc
    v_mov_b32 v144, 0
    v_mov_b32 v145, 0
    v_mov_b32 v138, 0
    v_mov_b32 v139, 0
    v_lshrrev_b32 v6, 1, v160
    v_lshl_add_u32 v7, v160, 2, v72
    v_lshl_add_u32 v7, v6, 3, v7
    v_mul_u32_u24 v7, 96, v7
    v_add_u32 v7, s90, v7
    v_lshl_add_u32 v6, v5, 4, v7
    v_lshl_add_u32 v7, v5, 3, v7
    s_waitcnt lgkmcnt(0)
    s_lshl_b32 s84, s68, 4
    s_lshr_b64 s[82:83], s[82:83], s84
    s_lshl_b32 s82, s82, 16
    v_mov_b32 v74, s82
    v_min_f32 v74, 0x40930000, v74
    v_max_f32 v74, 0xc2c80000, v74
    v_mul_f32 v74, 0x3fb8aa3b, v74
    v_exp_f32 v74, v74
    v_mov_b32 v18, 0
    v_cvt_pk_bf16_f32 v74, v74, v74
    v_lshlrev_b32 v74, 16, v74
    v_mul_f32 v74, 0x4038aa3b, v74
    v_mov_b32 v31, 0
    v_readfirstlane_b32 s55, v74
    v_add_f32 v74, v74, v74
    v_mul_u32_u24 v122, 5120, v160
    v_readfirstlane_b32 s52, v74
    v_add_u32 v122, v19, v122
    s_mov_b32 s84, 0x41b8aa3b
    v_mov_b32 v131, 0xc138aa3b
    v_mul_u32_u24 v74, 5120, v72
    v_mad_u32_u24 v74, v5, s86, v74
    v_and_b32 v19, 7, v75
    s_mov_b32 s47, 0
    s_mov_b32 s57, s72
    buffer_load_dwordx4 v156, s[32:35], s92 offen offset:1024 lds
    v_xor_b32 v123, v19, v160
    v_lshl_add_u32 v147, v123, 4, v74
    v_xor_b32 v146, 64, v147
    v_add_u32 v137, 40960, v147
    v_xor_b32 v136, 64, v137
    v_add_u32 v74, 61440, v74
    v_add_u32 v123, s93, v160
    s_mov_b32 s58, 0
    s_mov_b32 s59, 0
    buffer_load_dwordx4 v120, s[32:35], s92 offen offset:2048 lds
    s_add_u32 m0, s90, 12288
    s_mov_b32 s92, 36864
    v_xor_b32 v123, v19, v123
    v_lshl_add_u32 v135, v123, 4, v74
    v_lshrrev_b32 v123, 1, v160
    v_add3_u32 v123, v123, s93, 4
    v_xor_b32 v123, v19, v123
    s_add_u32 s93, s54, 20480
    s_mov_b32 s60, 0
    buffer_load_dwordx4 v4, s[32:35], s92 offen offset:0 lds
    s_waitcnt vmcnt(16)
    v_lshl_or_b32 v16, v17, 16, v16
    v_cmp_gt_u32 vcc, 16, v157
    v_mov_b32 v17, 0
    v_lshl_add_u32 v123, v123, 4, v74
    v_cndmask_b32 v19, 0, v16, vcc
    v_cndmask_b32 v16, 0, v16, vcc
    v_and_b32 v74, 1, v160
    v_mfma_f32_16x16x16_bf16 v[0:3], v[18:19], v[28:29], 0
    s_waitcnt vmcnt(14)
    s_mov_b32 s65, -1
    v_lshl_or_b32 v148, v158, 16, v148
    v_lshl_add_u32 v134, v74, 3, v123
    v_mfma_f32_16x16x16_bf16 v[12:15], v[16:17], v[28:29], 0
    s_mov_b32 s61, 1
    v_lshlrev_b32 v74, 4, v157
    v_add_u32 v133, s93, v74
    v_mfma_f32_16x16x16_bf16 v[20:23], v[16:17], v[30:31], 0
    s_waitcnt vmcnt(12)
    s_lshr_b32 s93, s68, 1
    buffer_load_dwordx4 v156, s[32:35], s92 offen offset:1024 lds
    v_lshl_or_b32 v149, v132, 16, v149
    v_max_f32 v0, 0, v0
    v_max_f32 v12, 0, v12
    v_max_f32 v13, 0, v13
    v_max_f32 v14, 0, v14
    v_max_f32 v15, 0, v15
    v_cvt_pk_bf16_f32 v12, v12, v13
    v_cvt_pk_bf16_f32 v13, v14, v15
    v_max_f32 v1, 0, v1
    v_max_f32 v2, 0, v2
    v_mfma_f32_16x16x16_bf16 v[16:19], v[148:149], v[12:13], 0
    s_lshl_b32 s93, s93, 10
    v_max_f32 v3, 0, v3
    v_cvt_pk_bf16_f32 v0, v0, v1
    v_cvt_pk_bf16_f32 v1, v2, v3
    v_max_f32 v20, 0, v20
    v_max_f32 v21, 0, v21
    v_mfma_f32_16x16x16_bf16 v[12:15], v[148:149], v[0:1], 0
    s_add_u32 s93, s93, s94
    v_max_f32 v22, 0, v22
    v_max_f32 v23, 0, v23
    v_cvt_pk_bf16_f32 v20, v20, v21
    v_cvt_pk_bf16_f32 v21, v22, v23
    v_cvt_pk_bf16_f32 v16, v16, v16
    v_lshlrev_b32 v16, 16, v16
    v_mfma_f32_16x16x16_bf16 v[0:3], v[148:149], v[20:21], 0
    s_movk_i32 s4, 112
    v_mul_f32 v16, 0xbfb8aa3b, v16
    v_cvt_pk_bf16_f32 v12, v12, v12
    v_exp_f32 v16, v16
    v_lshlrev_b32 v12, 16, v12
    v_add_f32 v16, 1.0, v16
    v_rcp_f32 v16, v16
    v_mul_f32 v12, 0xbfb8aa3b, v12
    v_cvt_pk_bf16_f32 v16, v16, v16
    v_lshlrev_b32 v16, 16, v16
    v_fma_f32 v16, v16, s84, v131
    s_mov_b32 s5, 0
    s_mov_b32 s6, 0
    ds_write_b32 v122, v16 offset:44032
    v_exp_f32 v12, v12
    v_cvt_pk_bf16_f32 v0, v0, v0
    v_add_f32 v12, 1.0, v12
    v_rcp_f32 v12, v12
    v_lshlrev_b32 v0, 16, v0
    v_cvt_pk_bf16_f32 v12, v12, v12
    v_lshlrev_b32 v12, 16, v12
    v_fma_f32 v12, v12, s84, v131
    s_mov_b32 s12, 0
    s_mov_b32 s64, 3
    ds_write_b32 v122, v12 offset:44036
    v_mul_f32 v0, 0xbfb8aa3b, v0
    v_exp_f32 v0, v0
    v_add_u32 v129, 81920, v74
    v_add_f32 v0, 1.0, v0
    v_rcp_f32 v0, v0
    v_add_u32 v130, s93, v129
    v_cvt_pk_bf16_f32 v0, v0, v0
    v_lshlrev_b32 v0, 16, v0
    v_fma_f32 v0, v0, s84, v131
    s_mul_i32 s93, s68, 7168
    s_add_u32 s93, s93, 135168
    ds_write_b32 v122, v0 offset:44040
    v_mul_u32_u24 v74, 1792, v160
    v_add_u32 v123, s93, v74
    v_mul_u32_u24 v74, 112, v75
    v_add_u32 v158, v74, v123
    v_subrev_u32 v158, 28672, v158
    v_cmp_eq_u32 vcc, 0, v72
    v_add_u32 v74, 16, v123
    v_mov_b32 v122, 0
    v_cndmask_b32 v132, v73, v123, vcc
    v_cmp_eq_u32 vcc, 3, v5
    s_mov_b32 s10, 81924
    s_mov_b32 s11, 0x20000
    v_cndmask_b32 v132, v132, v74, vcc
    v_mul_u32_u24 v74, 1792, v72
    v_lshl_add_u32 v74, v160, 3, v74
    v_lshl_add_u32 v74, v5, 1, v74
    v_add_u32 v74, s93, v74
    v_cmp_gt_u32 vcc, 3, v160
    v_mov_b32 v123, v74
    s_add_u32 s93, s69, 1
    v_cndmask_b32 v131, v73, v74, vcc
    s_mul_i32 s94, s93, 58255
    s_lshr_b32 s94, s94, 22
    s_mul_i32 s94, s94, s63
    s_mul_i32 s56, s93, s62
    s_add_u32 s56, s56, s94
    s_sub_u32 s93, s71, 1
    s_cmp_eq_u32 s68, 0
    s_cselect_b32 s13, s93, -1
    s_cmp_gt_u32 s73, 20
    s_cselect_b32 s13, s13, -1
    s_and_b32 s93, s2, -8
    s_sub_u32 s93, 81920, s93
    s_waitcnt lgkmcnt(0)
    s_barrier
    s_sub_u32 s8, s38, s93
    s_subb_u32 s9, s39, 0
    s_mov_b32 s3, 0x00010001
    s_add_u32 s101, s54, 44032
    v_mul_u32_u24 v149, 48, v72
    v_lshl_add_u32 v149, v5, 2, v149
    v_mul_u32_u24 v5, 48, v160
    v_add_u32 v199, 0, v149
    v_mul_u32_u24 v148, 37, v199
    v_lshrrev_b32 v148, 10, v148
    v_mad_u32_u24 v199, v148, 24, v199
    v_add_u32 v199, s101, v199
    v_add_u32 v161, 16, v149
    v_mul_u32_u24 v148, 37, v161
    v_lshrrev_b32 v148, 10, v148
    v_mad_u32_u24 v161, v148, 24, v161
    v_add_u32 v161, s101, v161
    v_add_u32 v148, 32, v149
    v_mul_u32_u24 v162, 37, v148
    v_lshrrev_b32 v162, 10, v162
    v_mad_u32_u24 v148, v162, 24, v148
    v_add_u32 v148, s101, v148
    v_add_u32 v176, 0, v5
    v_mul_u32_u24 v162, 37, v176
    v_lshrrev_b32 v162, 10, v162
    v_mad_u32_u24 v176, v162, 24, v176
    v_add_u32 v169, 4, v5
    v_mul_u32_u24 v162, 37, v169
    v_lshrrev_b32 v162, 10, v162
    v_mad_u32_u24 v169, v162, 24, v169
    v_add_u32 v170, 8, v5
    v_mul_u32_u24 v162, 37, v170
    v_lshrrev_b32 v162, 10, v162
    v_mad_u32_u24 v170, v162, 24, v170
    v_add_u32 v183, 12, v5
    v_mul_u32_u24 v162, 37, v183
    v_lshrrev_b32 v162, 10, v162
    v_mad_u32_u24 v183, v162, 24, v183
    v_add_u32 v168, 16, v5
    v_mul_u32_u24 v162, 37, v168
    v_lshrrev_b32 v162, 10, v162
    v_mad_u32_u24 v168, v162, 24, v168
    v_add_u32 v165, 20, v5
    v_mul_u32_u24 v162, 37, v165
    v_lshrrev_b32 v162, 10, v162
    v_mad_u32_u24 v165, v162, 24, v165
    v_add_u32 v166, 24, v5
    v_mul_u32_u24 v162, 37, v166
    v_lshrrev_b32 v162, 10, v162
    v_mad_u32_u24 v166, v162, 24, v166
    v_add_u32 v179, 28, v5
    v_mul_u32_u24 v162, 37, v179
    v_lshrrev_b32 v162, 10, v162
    v_mad_u32_u24 v179, v162, 24, v179
    v_add_u32 v164, 32, v5
    v_mul_u32_u24 v162, 37, v164
    v_lshrrev_b32 v162, 10, v162
    v_mad_u32_u24 v164, v162, 24, v164
    v_add_u32 v74, 36, v5
    v_mul_u32_u24 v72, 37, v74
    v_lshrrev_b32 v72, 10, v72
    v_mad_u32_u24 v74, v72, 24, v74
    v_add_u32 v162, 40, v5
    v_mul_u32_u24 v72, 37, v162
    v_lshrrev_b32 v72, 10, v72
    s_lshr_b32 s93, s68, 1
    s_mul_i32 s93, s93, 30720
    buffer_load_dwordx4 v120, s[32:35], s92 offen offset:2048 lds
    s_add_u32 m0, s90, 24576
    s_mov_b32 s92, 73728
    ds_read_b32 v208, v199
    v_mad_u32_u24 v162, v72, 24, v162
    v_add_u32 v5, 44, v5
    v_mul_u32_u24 v72, 37, v5
    v_lshrrev_b32 v72, 10, v72
    v_mad_u32_u24 v5, v72, 24, v5
    v_lshl_add_u32 v72, v160, 4, v149
    v_mul_u32_u24 v177, 37, v72
    v_lshrrev_b32 v177, 10, v177
    v_mad_u32_u24 v72, v177, 24, v72
    v_mov_b32 v177, 336
    v_cmp_gt_u32 vcc, 3, v160
    v_sub_u32 v204, v199, v176
    s_and_b32 s94, s68, 1
    v_cndmask_b32 v72, v177, v72, vcc
    v_sub_u32 v72, s101, v72
    s_mul_i32 s94, s94, -2304
    s_add_u32 s93, s93, s94
    ds_read_b32 v204, v204 offset:336
    buffer_load_dwordx4 v4, s[32:35], s92 offen offset:0 lds
    v_sub_u32 v205, v199, v169
    v_sub_u32 v206, v199, v170
    v_sub_u32 v207, v199, v183
    v_sub_u32 v200, v199, v168
    s_lshl_b32 s94, s97, 4
    ds_read_b32 v205, v205 offset:336
    v_sub_u32 v201, v199, v165
    v_sub_u32 v202, v199, v166
    v_sub_u32 v203, v199, v179
    v_sub_u32 v196, v199, v164
    buffer_load_dwordx4 v156, s[32:35], s92 offen offset:1024 lds
    ds_read_b32 v206, v206 offset:336
    v_sub_u32 v197, v199, v74
    v_sub_u32 v198, v199, v162
    v_sub_u32 v199, v199, v5
    v_sub_u32 v192, v161, v176
    v_sub_u32 v193, v161, v169
    ds_read_b32 v207, v207 offset:336
    v_sub_u32 v194, v161, v170
    v_sub_u32 v195, v161, v183
    v_sub_u32 v188, v161, v168
    v_sub_u32 v189, v161, v165
    v_sub_u32 v190, v161, v166
    ds_read_b32 v200, v200 offset:336
    v_sub_u32 v191, v161, v179
    v_sub_u32 v184, v161, v164
    v_sub_u32 v185, v161, v74
    v_sub_u32 v186, v161, v162
    buffer_load_dwordx4 v120, s[32:35], s92 offen offset:2048 lds
    s_add_u32 m0, s90, 36864
    s_mov_b32 s92, 110592
    ds_read_b32 v201, v201 offset:336
    v_sub_u32 v187, v161, v5
    v_sub_u32 v180, v148, v176
    v_sub_u32 v181, v148, v169
    v_sub_u32 v182, v148, v170
    v_sub_u32 v183, v148, v183
    s_waitcnt vmcnt(9)
    s_barrier
    ds_read_b32 v202, v202 offset:336
    v_sub_u32 v176, v148, v168
    v_sub_u32 v177, v148, v165
    v_sub_u32 v178, v148, v166
    v_sub_u32 v179, v148, v179
    v_sub_u32 v172, v148, v164
    ds_read_b32 v203, v203 offset:336
    v_sub_u32 v173, v148, v74
    v_sub_u32 v174, v148, v162
    v_sub_u32 v175, v148, v5
    v_mov_b32 v5, 0xf149f2ca
    v_and_b32 v74, 8, v75
    ds_read_b32 v196, v196 offset:336
    v_add_u32 v74, v74, v75
    v_mul_u32_u24 v74, 96, v74
    buffer_load_dwordx4 v4, s[32:35], s92 offen offset:0 lds
    ds_read_b32 v197, v197 offset:336
    v_add_u32 v74, s90, v74
    v_lshl_add_u32 v19, v160, 4, v74
    v_lshl_add_u32 v18, v160, 3, v74
    v_add_u32 v17, s93, v19
    v_add_u32 v16, s93, v18
    s_lshr_b32 s93, s68, 1
    s_mul_i32 s93, s93, 5120
    ds_read_b32 v198, v198 offset:336
    v_lshlrev_b32 v162, 4, v160
    v_add_u32 v162, 4608, v162
    s_add_u32 s93, s93, s94
    v_add_u32 v74, s93, v162
    v_cmp_eq_u32 vcc, 0, v75
    ds_read_b32 v199, v199 offset:336
    buffer_load_dwordx4 v156, s[32:35], s92 offen offset:1024 lds
    v_cndmask_b32 v74, v73, v74, vcc
    ds_read_b32 v211, v72 offset:672
    ds_read_b32 v192, v192 offset:336
    ds_read_b32 v193, v193 offset:336
    buffer_load_dwordx4 v120, s[32:35], s92 offen offset:2048 lds
    s_add_u32 m0, s90, 49152
    s_mov_b32 s92, 147456
    ds_read_b32 v194, v194 offset:336
    ds_read_b32 v195, v195 offset:336
    ds_read_b32 v188, v188 offset:336
    buffer_load_dwordx4 v4, s[32:35], s92 offen offset:0 lds
    ds_read_b32 v189, v189 offset:336
    ds_read_b32 v190, v190 offset:336
    ds_read_b32 v191, v191 offset:336
    ds_read_b32 v184, v184 offset:336
    buffer_load_dwordx4 v156, s[32:35], s92 offen offset:1024 lds
    ds_read_b32 v185, v185 offset:336
    ds_read_b32 v186, v186 offset:336
    ds_read_b32 v187, v187 offset:336
    buffer_load_dwordx4 v120, s[32:35], s92 offen offset:2048 lds
    s_add_u32 m0, s90, 61440
    s_mov_b32 s92, 184320
    ds_read_b32 v209, v161
    ds_read_b32 v180, v180 offset:336
    ds_read_b32 v181, v181 offset:336
    buffer_load_dwordx4 v4, s[32:35], s92 offen offset:0 lds
    ds_read_b32 v182, v182 offset:336
    ds_read_b32 v183, v183 offset:336
    ds_read_b32 v176, v176 offset:336
    ds_read_b32 v177, v177 offset:336
    buffer_load_dwordx4 v156, s[32:35], s92 offen offset:1024 lds
    ds_read_b32 v178, v178 offset:336
    ds_read_b32 v179, v179 offset:336
    ds_read_b32 v172, v172 offset:336
    buffer_load_dwordx4 v120, s[32:35], s92 offen offset:2048 lds
    ds_read_b32 v173, v173 offset:336
    ds_read_b32 v174, v174 offset:336
    ds_read_b32 v175, v175 offset:336
    ds_read_b32 v210, v148
    s_waitcnt vmcnt(15)
    ds_read_b64_tr_b16 a[0:1], v7 offset:0
    ds_read_b64_tr_b16 a[2:3], v7 offset:768
    ds_read_b64_tr_b16 a[24:25], v7 offset:32
    ds_read_b64_tr_b16 a[26:27], v7 offset:800
    ds_read_b64_tr_b16 a[48:49], v7 offset:64
    ds_read_b64_tr_b16 a[50:51], v7 offset:832
    s_add_u32 m0, s90, 0
    s_mov_b32 s92, 384
    s_waitcnt vmcnt(12)
    ds_read_b64_tr_b16 a[4:5], v7 offset:12288
    ds_read_b64_tr_b16 a[6:7], v7 offset:13056
    ds_read_b64_tr_b16 a[28:29], v7 offset:12320
    ds_read_b64_tr_b16 a[30:31], v7 offset:13088
    ds_read_b64_tr_b16 a[52:53], v7 offset:12352
    ds_read_b64_tr_b16 a[54:55], v7 offset:13120
    s_waitcnt vmcnt(9)
    ds_read_b64_tr_b16 a[8:9], v7 offset:24576
    ds_read_b64_tr_b16 a[10:11], v7 offset:25344
    ds_read_b64_tr_b16 a[32:33], v7 offset:24608
    s_waitcnt lgkmcnt(15)
    s_cmp_ge_u32 s2, 248
    s_cbranch_scc1 L_maskS
L_nomaskS:
    v_cmp_gt_u32 vcc, 16, v157
    v_readlane_b32 s84, v211, 48
    ds_read_b64_tr_b16 a[34:35], v7 offset:25376
    v_cndmask_b32 v208, v5, v208, vcc
    v_cndmask_b32 v209, v5, v209, vcc
    v_cndmask_b32 v210, v5, v210, vcc
    v_cmp_gt_u32 vcc, 49, v157
    ds_read_b64_tr_b16 a[56:57], v7 offset:24640
    s_waitcnt lgkmcnt(10)
    buffer_load_dwordx4 v4, s[32:35], s92 offen offset:0 lds
    ds_read_b64_tr_b16 a[58:59], v7 offset:25408
    v_cndmask_b32 v211, v5, v211, vcc
    s_waitcnt vmcnt(7)
    ds_read_b64_tr_b16 a[12:13], v7 offset:36864
    ds_read_b64_tr_b16 a[14:15], v7 offset:37632
    buffer_load_dwordx4 v156, s[32:35], s92 offen offset:1024 lds
    ds_read_b64_tr_b16 a[36:37], v7 offset:36896
    ds_read_b64_tr_b16 a[38:39], v7 offset:37664
    ds_read_b64_tr_b16 a[60:61], v7 offset:36928
    ds_read_b64_tr_b16 a[62:63], v7 offset:37696
    buffer_load_dwordx4 v120, s[32:35], s92 offen offset:2048 lds
    s_add_u32 m0, s90, 12288
    s_mov_b32 s92, 37248
    ds_read_b128 v[60:63], v147 offset:40960
    ds_read_b128 v[56:59], v146 offset:40960
    s_waitcnt lgkmcnt(10)
    buffer_load_dwordx4 v4, s[32:35], s92 offen offset:0 lds
    ds_read_b128 v[52:55], v147 offset:41088
    ds_read_b128 v[48:51], v146 offset:41088
    buffer_load_dwordx4 v156, s[32:35], s92 offen offset:1024 lds
    ds_read_b128 v[40:43], v147 offset:41216
    ds_read_b128 v[0:3], v146 offset:41216
    buffer_load_dwordx4 v120, s[32:35], s92 offen offset:2048 lds
    s_add_u32 m0, s90, 24576
    s_mov_b32 s92, 74112
    s_waitcnt vmcnt(9)
    ds_read_b64_tr_b16 a[16:17], v7 offset:49152
    ds_read_b64_tr_b16 a[18:19], v7 offset:49920
    ds_read_b64_tr_b16 a[40:41], v7 offset:49184
    ds_read_b64_tr_b16 a[42:43], v7 offset:49952
    ds_read_b64_tr_b16 a[64:65], v7 offset:49216
    ds_read_b64_tr_b16 a[66:67], v7 offset:49984
    s_waitcnt lgkmcnt(7)
    buffer_load_dwordx4 v4, s[32:35], s92 offen offset:0 lds
    buffer_load_dwordx4 v156, s[32:35], s92 offen offset:1024 lds
    buffer_load_dwordx4 v120, s[32:35], s92 offen offset:2048 lds
    s_add_u32 m0, s90, 36864
    s_mov_b32 s92, 110976
    s_waitcnt vmcnt(9)
    ds_read_b64_tr_b16 a[20:21], v7 offset:61440
    ds_read_b64_tr_b16 a[22:23], v7 offset:62208
    v_mfma_f32_16x16x32_bf16 v[68:71], a[0:3], v[60:63], 0
    ds_read_b64_tr_b16 a[44:45], v7 offset:61472
    v_mfma_f32_16x16x32_bf16 v[68:71], a[4:7], v[56:59], v[68:71]
    ds_read_b64_tr_b16 a[46:47], v7 offset:62240
    v_mfma_f32_16x16x32_bf16 v[68:71], a[8:11], v[52:55], v[68:71]
    ds_read_b64_tr_b16 a[68:69], v7 offset:61504
    v_mfma_f32_16x16x32_bf16 v[68:71], a[12:15], v[48:51], v[68:71]
    s_waitcnt lgkmcnt(5)
    ds_read_b64_tr_b16 a[70:71], v7 offset:62272
    v_mfma_f32_16x16x32_bf16 v[68:71], a[16:19], v[40:43], v[68:71]
    ds_read_b128 v[44:47], v147 offset:42496
    ds_read_b128 v[36:39], v146 offset:42496
    ds_read_b128 v[32:35], v147 offset:42624
    ds_read_b128 v[28:31], v146 offset:42624
    s_waitcnt lgkmcnt(7)
    v_mfma_f32_16x16x32_bf16 v[68:71], a[20:23], v[0:3], v[68:71]
    ds_read_b128 v[20:23], v147 offset:42752
    s_nop 0
    v_mfma_f32_16x16x32_bf16 v[92:95], a[24:27], v[60:63], 0
    s_nop 0
    ds_read_b128 v[12:15], v146 offset:42752
    s_nop 0
    v_mfma_f32_16x16x32_bf16 v[92:95], a[28:31], v[56:59], v[92:95]
    s_nop 0
    v_fma_f32 v5, v68, v68, s41
    v_fmac_f32 v5, v69, v69
    v_mfma_f32_16x16x32_bf16 v[92:95], a[32:35], v[52:55], v[92:95]
    v_fmac_f32 v5, v70, v70
    v_fmac_f32 v5, v71, v71
    v_mfma_f32_16x16x32_bf16 v[92:95], a[36:39], v[48:51], v[92:95]
    v_mfma_f32_16x16x32_bf16 v[92:95], a[40:43], v[40:43], v[92:95]
    s_waitcnt lgkmcnt(4)
    v_mfma_f32_16x16x32_bf16 v[92:95], a[44:47], v[0:3], v[92:95]
    s_nop 0
    buffer_load_dwordx4 v4, s[32:35], s92 offen offset:0 lds
    v_mfma_f32_16x16x32_bf16 v[88:91], a[48:51], v[60:63], 0
    s_nop 2
    v_mfma_f32_16x16x32_bf16 v[88:91], a[52:55], v[56:59], v[88:91]
    s_nop 0
    v_fmac_f32 v5, v92, v92
    v_fmac_f32 v5, v93, v93
    v_mfma_f32_16x16x32_bf16 v[88:91], a[56:59], v[52:55], v[88:91]
    v_fmac_f32 v5, v94, v94
    v_fmac_f32 v5, v95, v95
    v_mfma_f32_16x16x32_bf16 v[88:91], a[60:63], v[48:51], v[88:91]
    v_mfma_f32_16x16x32_bf16 v[88:91], a[64:67], v[40:43], v[88:91]
    buffer_load_dwordx4 v156, s[32:35], s92 offen offset:1024 lds
    v_mfma_f32_16x16x32_bf16 v[88:91], a[68:71], v[0:3], v[88:91]
    s_nop 0
    v_mfma_f32_16x16x32_bf16 v[0:3], a[0:3], v[44:47], 0
    s_nop 2
    v_mfma_f32_16x16x32_bf16 v[0:3], a[4:7], v[36:39], v[0:3]
    s_waitcnt lgkmcnt(0)
    s_nop 0
    v_fmac_f32 v5, v88, v88
    v_fmac_f32 v5, v89, v89
    v_mfma_f32_16x16x32_bf16 v[0:3], a[8:11], v[32:35], v[0:3]
    v_fmac_f32 v5, v90, v90
    v_fmac_f32 v5, v91, v91
    v_mfma_f32_16x16x32_bf16 v[0:3], a[12:15], v[28:31], v[0:3]
    ds_read_b128 v[100:103], v147 offset:40960
    buffer_load_dwordx4 v120, s[32:35], s92 offen offset:2048 lds
    v_mfma_f32_16x16x32_bf16 v[0:3], a[16:19], v[20:23], v[0:3]
    s_waitcnt vmcnt(9)
    s_add_u32 m0, s90, 49152
    ds_read_b64_tr_b16 a[72:73], v7 offset:0
    v_mfma_f32_16x16x32_bf16 v[0:3], a[20:23], v[12:15], v[0:3]
    s_mov_b32 s92, 147840
    ds_read_b64_tr_b16 a[74:75], v7 offset:768
    v_mfma_f32_16x16x32_bf16 v[56:59], a[24:27], v[44:47], 0
    ds_read_b64_tr_b16 a[96:97], v7 offset:32
    s_nop 0
    v_mfma_f32_16x16x32_bf16 v[56:59], a[28:31], v[36:39], v[56:59]
    s_nop 0
    ds_read_b64_tr_b16 a[98:99], v7 offset:800
    v_fma_f32 v72, v0, v0, s41
    v_mfma_f32_16x16x32_bf16 v[56:59], a[32:35], v[32:35], v[56:59]
    ds_read_b64_tr_b16 a[120:121], v7 offset:64
    buffer_load_dwordx4 v4, s[32:35], s92 offen offset:0 lds
    v_mfma_f32_16x16x32_bf16 v[56:59], a[36:39], v[28:31], v[56:59]
    ds_read_b64_tr_b16 a[122:123], v7 offset:832
    v_fmac_f32 v72, v1, v1
    v_mfma_f32_16x16x32_bf16 v[56:59], a[40:43], v[20:23], v[56:59]
    ds_read_b128 v[64:67], v146 offset:40960
    v_fmac_f32 v72, v2, v2
    v_mfma_f32_16x16x32_bf16 v[56:59], a[44:47], v[12:15], v[56:59]
    ds_read_b128 v[52:55], v147 offset:41088
    v_fmac_f32 v72, v3, v3
    v_mfma_f32_16x16x32_bf16 v[40:43], a[48:51], v[44:47], 0
    ds_read_b128 v[48:51], v146 offset:41088
    v_mfma_f32_16x16x32_bf16 v[40:43], a[52:55], v[36:39], v[40:43]
    ds_read_b128 v[44:47], v147 offset:41216
    buffer_load_dwordx4 v156, s[32:35], s92 offen offset:1024 lds
    v_mfma_f32_16x16x32_bf16 v[40:43], a[56:59], v[32:35], v[40:43]
    ds_read_b128 v[32:35], v146 offset:41216
    v_fmac_f32 v72, v56, v56
    v_mfma_f32_16x16x32_bf16 v[40:43], a[60:63], v[28:31], v[40:43]
    v_fmac_f32 v72, v57, v57
    v_fmac_f32 v72, v58, v58
    v_mfma_f32_16x16x32_bf16 v[40:43], a[64:67], v[20:23], v[40:43]
    v_fmac_f32 v72, v59, v59
    v_mfma_f32_16x16x32_bf16 v[40:43], a[68:71], v[12:15], v[40:43]
    s_waitcnt vmcnt(8)
    s_nop 2
    buffer_load_dwordx4 v120, s[32:35], s92 offen offset:2048 lds
    s_add_u32 m0, s90, 61440
    s_mov_b32 s92, 184704
    ds_read_b64_tr_b16 a[76:77], v7 offset:12288
    v_fmac_f32 v72, v40, v40
    ds_read_b64_tr_b16 a[78:79], v7 offset:13056
    v_fmac_f32 v72, v41, v41
    ds_read_b64_tr_b16 a[100:101], v7 offset:12320
    v_fmac_f32 v72, v42, v42
    ds_read_b64_tr_b16 a[102:103], v7 offset:13088
    v_fmac_f32 v72, v43, v43
    ds_read_b64_tr_b16 a[124:125], v7 offset:12352
    buffer_load_dwordx4 v4, s[32:35], s92 offen offset:0 lds
    ds_read_b64_tr_b16 a[126:127], v7 offset:13120
    buffer_load_dwordx4 v156, s[32:35], s92 offen offset:1024 lds
    buffer_load_dwordx4 v120, s[32:35], s92 offen offset:2048 lds
    s_add_u32 m0, s90, 0
    s_mov_b32 s92, 768
    s_waitcnt vmcnt(9)
    ds_read_b64_tr_b16 a[80:81], v7 offset:24576
    ds_read_b64_tr_b16 a[82:83], v7 offset:25344
    ds_read_b64_tr_b16 a[104:105], v7 offset:24608
    ds_read_b64_tr_b16 a[106:107], v7 offset:25376
    ds_read_b64_tr_b16 a[128:129], v7 offset:24640
    ds_read_b64_tr_b16 a[130:131], v7 offset:25408
    s_waitcnt lgkmcnt(6)
    buffer_load_dwordx4 v4, s[32:35], s92 offen offset:0 lds
    buffer_load_dwordx4 v156, s[32:35], s92 offen offset:1024 lds
    buffer_load_dwordx4 v120, s[32:35], s92 offen offset:2048 lds
    s_add_u32 m0, s90, 12288
    s_mov_b32 s92, 37632
    s_waitcnt vmcnt(9)
    ds_read_b64_tr_b16 a[84:85], v7 offset:36864
    ds_read_b64_tr_b16 a[86:87], v7 offset:37632
    ds_read_b64_tr_b16 a[108:109], v7 offset:36896
    ds_read_b64_tr_b16 a[110:111], v7 offset:37664
    ds_read_b64_tr_b16 a[132:133], v7 offset:36928
    ds_read_b64_tr_b16 a[134:135], v7 offset:37696
    buffer_load_dwordx4 v4, s[32:35], s92 offen offset:0 lds
    buffer_load_dwordx4 v156, s[32:35], s92 offen offset:1024 lds
    buffer_load_dwordx4 v120, s[32:35], s92 offen offset:2048 lds
    s_add_u32 m0, s90, 24576
    s_mov_b32 s92, 74496
    s_waitcnt vmcnt(9)
    ds_read_b64_tr_b16 a[88:89], v7 offset:49152
    ds_read_b64_tr_b16 a[90:91], v7 offset:49920
    ds_read_b64_tr_b16 a[112:113], v7 offset:49184
    ds_read_b64_tr_b16 a[114:115], v7 offset:49952
    ds_read_b64_tr_b16 a[136:137], v7 offset:49216
    ds_read_b64_tr_b16 a[138:139], v7 offset:49984
    s_waitcnt lgkmcnt(6)
    buffer_load_dwordx4 v4, s[32:35], s92 offen offset:0 lds
    buffer_load_dwordx4 v156, s[32:35], s92 offen offset:1024 lds
    buffer_load_dwordx4 v120, s[32:35], s92 offen offset:2048 lds
    s_add_u32 m0, s90, 36864
    s_mov_b32 s92, 111360
    s_waitcnt vmcnt(9)
    ds_read_b64_tr_b16 a[92:93], v7 offset:61440
    ds_read_b64_tr_b16 a[94:95], v7 offset:62208
    v_mfma_f32_16x16x32_bf16 v[36:39], a[72:75], v[100:103], 0
    ds_read_b64_tr_b16 a[116:117], v7 offset:61472
    v_mfma_f32_16x16x32_bf16 v[36:39], a[76:79], v[64:67], v[36:39]
    ds_read_b64_tr_b16 a[118:119], v7 offset:62240
    v_mfma_f32_16x16x32_bf16 v[36:39], a[80:83], v[52:55], v[36:39]
    ds_read_b64_tr_b16 a[140:141], v7 offset:61504
    v_mfma_f32_16x16x32_bf16 v[36:39], a[84:87], v[48:51], v[36:39]
    s_waitcnt lgkmcnt(5)
    buffer_load_dwordx4 v4, s[32:35], s92 offen offset:0 lds
    ds_read_b64_tr_b16 a[142:143], v7 offset:62272
    v_mfma_f32_16x16x32_bf16 v[36:39], a[88:91], v[44:47], v[36:39]
    ds_read_b128 v[96:99], v147 offset:42496
    ds_read_b128 v[80:83], v146 offset:42496
    ds_read_b128 v[28:31], v147 offset:42624
    ds_read_b128 v[20:23], v146 offset:42624
    s_waitcnt lgkmcnt(7)
    v_mfma_f32_16x16x32_bf16 v[36:39], a[92:95], v[32:35], v[36:39]
    buffer_load_dwordx4 v156, s[32:35], s92 offen offset:1024 lds
    ds_read_b128 v[60:63], v147 offset:42752
    v_mfma_f32_16x16x32_bf16 v[84:87], a[96:99], v[100:103], 0
    s_nop 1
    ds_read_b128 v[12:15], v146 offset:42752
    v_mfma_f32_16x16x32_bf16 v[84:87], a[100:103], v[64:67], v[84:87]
    s_nop 0
    v_fma_f32 v157, v36, v36, s41
    v_fmac_f32 v157, v37, v37
    v_mfma_f32_16x16x32_bf16 v[84:87], a[104:107], v[52:55], v[84:87]
    v_fmac_f32 v157, v38, v38
    v_fmac_f32 v157, v39, v39
    v_mfma_f32_16x16x32_bf16 v[84:87], a[108:111], v[48:51], v[84:87]
    v_mfma_f32_16x16x32_bf16 v[84:87], a[112:115], v[44:47], v[84:87]
    s_waitcnt vmcnt(8) lgkmcnt(4)
    buffer_load_dwordx4 v120, s[32:35], s92 offen offset:2048 lds
    ds_read_b64_tr_b16 a[144:145], v6 offset:0
    v_mfma_f32_16x16x32_bf16 v[84:87], a[116:119], v[32:35], v[84:87]
    s_add_u32 m0, s90, 49152
    ds_read_b64_tr_b16 a[146:147], v6 offset:768
    v_mfma_f32_16x16x32_bf16 v[76:79], a[120:123], v[100:103], 0
    s_mov_b32 s92, 148224
    s_nop 0
    ds_read_b64_tr_b16 a[168:169], v6 offset:8
    v_mfma_f32_16x16x32_bf16 v[76:79], a[124:127], v[64:67], v[76:79]
    s_nop 0
    v_fmac_f32 v157, v84, v84
    v_fmac_f32 v157, v85, v85
    v_mfma_f32_16x16x32_bf16 v[76:79], a[128:131], v[52:55], v[76:79]
    ds_read_b64_tr_b16 a[170:171], v6 offset:776
    v_fmac_f32 v157, v86, v86
    v_mfma_f32_16x16x32_bf16 v[76:79], a[132:135], v[48:51], v[76:79]
    buffer_load_dwordx4 v4, s[32:35], s92 offen offset:0 lds
    ds_read_b64_tr_b16 a[192:193], v7 offset:64
    v_mfma_f32_16x16x32_bf16 v[76:79], a[136:139], v[44:47], v[76:79]
    ds_read_b64_tr_b16 a[194:195], v7 offset:832
    v_fmac_f32 v157, v87, v87
    v_mfma_f32_16x16x32_bf16 v[76:79], a[140:143], v[32:35], v[76:79]
    s_nop 0
    v_mfma_f32_16x16x32_bf16 v[52:55], a[72:75], v[96:99], 0
    s_nop 2
    v_mfma_f32_16x16x32_bf16 v[52:55], a[76:79], v[80:83], v[52:55]
    s_waitcnt lgkmcnt(5)
    s_nop 0
    v_fmac_f32 v157, v76, v76
    v_fmac_f32 v157, v77, v77
    v_mfma_f32_16x16x32_bf16 v[52:55], a[80:83], v[28:31], v[52:55]
    buffer_load_dwordx4 v156, s[32:35], s92 offen offset:1024 lds
    v_fmac_f32 v157, v78, v78
    v_mfma_f32_16x16x32_bf16 v[52:55], a[84:87], v[20:23], v[52:55]
    v_fmac_f32 v157, v79, v79
    v_cvt_pk_bf16_f32 v170, v5, v157
    v_mfma_f32_16x16x32_bf16 v[52:55], a[88:91], v[60:63], v[52:55]
    v_mfma_f32_16x16x32_bf16 v[52:55], a[92:95], v[12:15], v[52:55]
    ds_read_b128 v[64:67], v147 offset:40960
    v_mfma_f32_16x16x32_bf16 v[48:51], a[96:99], v[96:99], 0
    ds_read_b128 v[32:35], v146 offset:40960
    v_mfma_f32_16x16x32_bf16 v[48:51], a[100:103], v[80:83], v[48:51]
    s_waitcnt vmcnt(8)
    buffer_load_dwordx4 v120, s[32:35], s92 offen offset:2048 lds
    ds_read_b64_tr_b16 a[148:149], v6 offset:12288
    v_mfma_f32_16x16x32_bf16 v[48:51], a[104:107], v[28:31], v[48:51]
    s_add_u32 m0, s90, 61440
    v_fma_f32 v157, v52, v52, s41
    v_fmac_f32 v157, v53, v53
    v_mfma_f32_16x16x32_bf16 v[48:51], a[108:111], v[20:23], v[48:51]
    s_mov_b32 s92, 185088
    ds_read_b64_tr_b16 a[150:151], v6 offset:13056
    v_fmac_f32 v157, v54, v54
    v_mfma_f32_16x16x32_bf16 v[48:51], a[112:115], v[60:63], v[48:51]
    ds_read_b64_tr_b16 a[172:173], v6 offset:12296
    v_fmac_f32 v157, v55, v55
    v_mfma_f32_16x16x32_bf16 v[48:51], a[116:119], v[12:15], v[48:51]
    ds_read_b64_tr_b16 a[174:175], v6 offset:13064
    v_mfma_f32_16x16x32_bf16 v[44:47], a[120:123], v[96:99], 0
    s_nop 0
    buffer_load_dwordx4 v4, s[32:35], s92 offen offset:0 lds
    ds_read_b64_tr_b16 a[196:197], v7 offset:12352
    v_mfma_f32_16x16x32_bf16 v[44:47], a[124:127], v[80:83], v[44:47]
    s_nop 0
    ds_read_b64_tr_b16 a[198:199], v7 offset:13120
    v_fmac_f32 v157, v48, v48
    v_mfma_f32_16x16x32_bf16 v[44:47], a[128:131], v[28:31], v[44:47]
    ds_read_b128 v[28:31], v147 offset:41088
    v_fmac_f32 v157, v49, v49
    v_mfma_f32_16x16x32_bf16 v[44:47], a[132:135], v[20:23], v[44:47]
    ds_read_b128 v[20:23], v146 offset:41088
    v_fmac_f32 v157, v50, v50
    v_mfma_f32_16x16x32_bf16 v[44:47], a[136:139], v[60:63], v[44:47]
    ds_read_b128 v[60:63], v147 offset:41216
    v_fmac_f32 v157, v51, v51
    v_mfma_f32_16x16x32_bf16 v[44:47], a[140:143], v[12:15], v[44:47]
    s_nop 0
    buffer_load_dwordx4 v156, s[32:35], s92 offen offset:1024 lds
    ds_read_b128 v[12:15], v146 offset:41216
    v_mfma_f32_16x16x16_bf16 v[80:83], v[216:217], v[170:171], 0
    s_nop 0
    v_mov_b32 v168, 0
    v_mov_b32 v169, 0
    v_mov_b32 v149, 0
    v_fmac_f32 v157, v44, v44
    v_fmac_f32 v157, v45, v45
    v_fmac_f32 v157, v46, v46
    v_fmac_f32 v157, v47, v47
    v_rsq_f32 v80, v80
    v_rsq_f32 v81, v81
    v_mul_f32 v80, s55, v80
    v_mul_f32 v81, 0.5, v81
    v_mul_f32 v68, v68, v80
    buffer_load_dwordx4 v120, s[32:35], s92 offen offset:2048 lds
    s_add_u32 m0, s90, 0
    s_mov_b32 s92, 0
    s_waitcnt vmcnt(9)
    ds_read_b64_tr_b16 a[152:153], v6 offset:24576
    v_mul_f32 v69, v69, v80
    v_cvt_pk_f16_f32 v68, v68, v69
    v_mul_f32 v70, v70, v80
    ds_read_b64_tr_b16 a[154:155], v6 offset:25344
    v_mul_f32 v71, v71, v80
    v_cvt_pk_f16_f32 v69, v70, v71
    v_mul_f32 v92, v92, v80
    ds_read_b64_tr_b16 a[176:177], v6 offset:24584
    v_mul_f32 v93, v93, v80
    v_cvt_pk_f16_f32 v70, v92, v93
    s_waitcnt lgkmcnt(3)
    buffer_load_dwordx4 v121, s[76:79], s92 offen offset:0 lds
    ds_read_b64_tr_b16 a[178:179], v6 offset:25352
    v_mul_f32 v94, v94, v80
    v_mul_f32 v95, v95, v80
    v_cvt_pk_f16_f32 v71, v94, v95
    ds_read_b64_tr_b16 a[200:201], v7 offset:24640
    v_mul_f32 v88, v88, v80
    ds_read_b64_tr_b16 a[202:203], v7 offset:25408
    v_mul_f32 v89, v89, v80
    v_cvt_pk_f16_f32 v160, v88, v89
    v_mul_f32 v90, v90, v80
    v_mul_f32 v91, v91, v80
    v_cvt_pk_f16_f32 v161, v90, v91
    v_mul_f32 v36, v36, v81
    buffer_load_dwordx4 v25, s[76:79], s92 offen offset:1024 lds
    v_mul_f32 v37, v37, v81
    v_cvt_pk_f16_f32 v36, v36, v37
    v_mul_f32 v38, v38, v81
    v_mul_f32 v39, v39, v81
    v_cvt_pk_f16_f32 v37, v38, v39
    v_mul_f32 v84, v84, v81
    v_mul_f32 v85, v85, v81
    v_cvt_pk_f16_f32 v38, v84, v85
    v_mul_f32 v86, v86, v81
    v_mul_f32 v87, v87, v81
    v_cvt_pk_f16_f32 v39, v86, v87
    v_mul_f32 v76, v76, v81
    v_mul_f32 v77, v77, v81
    v_cvt_pk_f16_f32 v4, v76, v77
    v_mul_f32 v78, v78, v81
    v_mul_f32 v79, v79, v81
    v_cvt_pk_f16_f32 v5, v78, v79
    buffer_load_dwordx4 v24, s[76:79], s92 offen offset:2048 lds
    s_add_u32 m0, s90, 12288
    s_mov_b32 s92, 12288
    s_waitcnt vmcnt(9)
    ds_read_b64_tr_b16 a[156:157], v6 offset:36864
    v_fma_mix_f32 v148, v68, v36, 0 op_sel:[0,0,0] op_sel_hi:[1,1,0]
    v_fma_mix_f32 v148, v68, v36, v148 op_sel:[1,1,0] op_sel_hi:[1,1,0]
    v_fma_mix_f32 v148, v69, v37, v148 op_sel:[0,0,0] op_sel_hi:[1,1,0]
    ds_read_b64_tr_b16 a[158:159], v6 offset:37632
    v_fma_mix_f32 v148, v69, v37, v148 op_sel:[1,1,0] op_sel_hi:[1,1,0]
    v_fma_mix_f32 v148, v70, v38, v148 op_sel:[0,0,0] op_sel_hi:[1,1,0]
    v_fma_mix_f32 v148, v70, v38, v148 op_sel:[1,1,0] op_sel_hi:[1,1,0]
    ds_read_b64_tr_b16 a[180:181], v6 offset:36872
    v_fma_mix_f32 v148, v71, v39, v148 op_sel:[0,0,0] op_sel_hi:[1,1,0]
    v_fma_mix_f32 v148, v71, v39, v148 op_sel:[1,1,0] op_sel_hi:[1,1,0]
    buffer_load_dwordx4 v121, s[76:79], s92 offen offset:0 lds
    ds_read_b64_tr_b16 a[182:183], v6 offset:37640
    v_fma_mix_f32 v148, v160, v4, v148 op_sel:[0,0,0] op_sel_hi:[1,1,0]
    v_fma_mix_f32 v148, v160, v4, v148 op_sel:[1,1,0] op_sel_hi:[1,1,0]
    v_fma_mix_f32 v148, v161, v5, v148 op_sel:[0,0,0] op_sel_hi:[1,1,0]
    ds_read_b64_tr_b16 a[204:205], v7 offset:36928
    v_fma_mix_f32 v148, v161, v5, v148 op_sel:[1,1,0] op_sel_hi:[1,1,0]
    ds_read_b64_tr_b16 a[206:207], v7 offset:37696
    v_mov_b32 v120, v148
    v_add_u32 v156, 28672, v158
    ds_write_b128 v156, v[36:39]
    buffer_load_dwordx4 v25, s[76:79], s92 offen offset:1024 lds
    v_permlane32_swap_b32 v120, v148
    v_add_f32 v148, v120, v148
    v_mov_b32 v120, v148
    v_cvt_pk_bf16_f32 v170, v72, v157
    s_nop 0
    v_permlane16_swap_b32 v120, v148
    v_mfma_f32_16x16x16_bf16 v[36:39], v[216:217], v[170:171], 0
    s_waitcnt vmcnt(8)
    ds_write2_b64 v156, v[168:169], v[168:169] offset0:2 offset1:3
    v_add_f32 v148, v120, v148
    buffer_load_dwordx4 v24, s[76:79], s92 offen offset:2048 lds
    s_add_u32 m0, s90, 24576
    s_mov_b32 s92, 24576
    v_and_b32 v120, 0xffff0000, v148
    v_sub_f32 v148, v148, v120
    ds_read_b64_tr_b16 a[160:161], v6 offset:49152
    v_cvt_pk_bf16_f32 v148, v148, v120
    v_rsq_f32 v36, v36
    ds_read_b64_tr_b16 a[162:163], v6 offset:49920
    v_rsq_f32 v37, v37
    v_mul_f32 v36, s55, v36
    s_waitcnt lgkmcnt(3)
    buffer_load_dwordx4 v121, s[76:79], s92 offen offset:0 lds
    ds_read_b64_tr_b16 a[184:185], v6 offset:49160
    v_mul_f32 v37, 0.5, v37
    v_mul_f32 v0, v0, v36
    v_mul_f32 v1, v1, v36
    ds_read_b64_tr_b16 a[186:187], v6 offset:49928
    v_cvt_pk_f16_f32 v0, v0, v1
    v_mul_f32 v2, v2, v36
    v_mul_f32 v3, v3, v36
    ds_read_b64_tr_b16 a[208:209], v7 offset:49216
    v_cvt_pk_f16_f32 v1, v2, v3
    ds_read_b64_tr_b16 a[210:211], v7 offset:49984
    v_mul_f32 v56, v56, v36
    buffer_load_dwordx4 v25, s[76:79], s92 offen offset:1024 lds
    ds_write_b128 v156, v[68:71] offset:32
    v_mul_f32 v57, v57, v36
    v_cvt_pk_f16_f32 v2, v56, v57
    v_mul_f32 v58, v58, v36
    v_mul_f32 v59, v59, v36
    v_cvt_pk_f16_f32 v3, v58, v59
    v_mul_f32 v40, v40, v36
    v_mul_f32 v41, v41, v36
    v_cvt_pk_f16_f32 v254, v40, v41
    ds_write2_b64 v156, v[4:5], v[168:169] offset0:6 offset1:7
    buffer_load_dwordx4 v24, s[76:79], s92 offen offset:2048 lds
    s_add_u32 m0, s90, 36864
    s_mov_b32 s92, 36864
    v_mul_f32 v42, v42, v36
    v_mul_f32 v43, v43, v36
    v_cvt_pk_f16_f32 v255, v42, v43
    v_mul_f32 v52, v52, v37
    v_mul_f32 v53, v53, v37
    s_waitcnt vmcnt(9)
    ds_read_b64_tr_b16 a[164:165], v6 offset:61440
    v_cvt_pk_f16_f32 v4, v52, v53
    v_mul_f32 v54, v54, v37
    v_mul_f32 v55, v55, v37
    ds_read_b64_tr_b16 a[166:167], v6 offset:62208
    v_mfma_f32_16x16x32_bf16 v[40:43], a[144:147], v[64:67], 0
    buffer_load_dwordx4 v121, s[76:79], s92 offen offset:0 lds
    ds_read_b64_tr_b16 a[188:189], v6 offset:61448
    v_mfma_f32_16x16x32_bf16 v[40:43], a[148:151], v[32:35], v[40:43]
    v_cvt_pk_f16_f32 v5, v54, v55
    v_mul_f32 v48, v48, v37
    v_mfma_f32_16x16x32_bf16 v[40:43], a[152:155], v[28:31], v[40:43]
    ds_read_b64_tr_b16 a[190:191], v6 offset:62216
    v_mul_f32 v49, v49, v37
    v_mfma_f32_16x16x32_bf16 v[40:43], a[156:159], v[20:23], v[40:43]
    s_waitcnt lgkmcnt(4)
    ds_read_b64_tr_b16 a[212:213], v7 offset:61504
    v_cvt_pk_f16_f32 v6, v48, v49
    v_mfma_f32_16x16x32_bf16 v[40:43], a[160:163], v[60:63], v[40:43]
    ds_read_b64_tr_b16 a[214:215], v7 offset:62272
    v_mul_f32 v50, v50, v37
    v_mul_f32 v51, v51, v37
    v_cvt_pk_f16_f32 v7, v50, v51
    buffer_load_dwordx4 v25, s[76:79], s92 offen offset:1024 lds
    ds_write2_b64 v156, v[168:169], v[160:161] offset0:8 offset1:9
    v_mul_f32 v44, v44, v37
    v_mul_f32 v45, v45, v37
    v_cvt_pk_f16_f32 v160, v44, v45
    v_mul_f32 v46, v46, v37
    s_waitcnt lgkmcnt(5)
    v_mfma_f32_16x16x32_bf16 v[40:43], a[164:167], v[12:15], v[40:43]
    v_mul_f32 v47, v47, v37
    v_cvt_pk_f16_f32 v161, v46, v47
    v_mfma_f32_16x16x32_bf16 v[52:55], a[168:171], v[64:67], 0
    buffer_load_dwordx4 v24, s[76:79], s92 offen offset:2048 lds
    ds_read_b128 v[48:51], v147 offset:42496
    v_mfma_f32_16x16x32_bf16 v[52:55], a[172:175], v[32:35], v[52:55]
    s_add_u32 m0, s90, 49152
    v_fma_mix_f32 v120, v0, v4, 0 op_sel:[0,0,0] op_sel_hi:[1,1,0]
    v_fma_mix_f32 v120, v0, v4, v120 op_sel:[1,1,0] op_sel_hi:[1,1,0]
    v_mfma_f32_16x16x32_bf16 v[52:55], a[176:179], v[28:31], v[52:55]
    s_mov_b32 s92, 49152
    ds_write_b64 v156, v[148:149] offset:88
    v_mfma_f32_16x16x32_bf16 v[52:55], a[180:183], v[20:23], v[52:55]
    s_lshl_b32 s93, s68, 10
    v_fma_mix_f32 v120, v1, v5, v120 op_sel:[0,0,0] op_sel_hi:[1,1,0]
    v_fma_mix_f32 v120, v1, v5, v120 op_sel:[1,1,0] op_sel_hi:[1,1,0]
    v_mfma_f32_16x16x32_bf16 v[52:55], a[184:187], v[60:63], v[52:55]
    s_waitcnt lgkmcnt(3)
    s_mov_b32 s53, s47
    ds_read_b128 v[44:47], v146 offset:42496
    v_fma_mix_f32 v120, v2, v6, v120 op_sel:[0,0,0] op_sel_hi:[1,1,0]
    v_mfma_f32_16x16x32_bf16 v[52:55], a[188:191], v[12:15], v[52:55]
    s_mov_b32 s47, s46
    buffer_load_dwordx4 v121, s[76:79], s92 offen offset:0 lds
    ds_read_b128 v[36:39], v147 offset:42624
    v_mfma_f32_16x16x32_bf16 v[56:59], a[192:195], v[64:67], 0
    s_mov_b32 s46, s45
    v_fma_mix_f32 v120, v2, v6, v120 op_sel:[1,1,0] op_sel_hi:[1,1,0]
    v_fma_mix_f32 v120, v3, v7, v120 op_sel:[0,0,0] op_sel_hi:[1,1,0]
    v_mfma_f32_16x16x32_bf16 v[56:59], a[196:199], v[32:35], v[56:59]
    s_mov_b32 s45, s44
    ds_read_b128 v[32:35], v146 offset:42624
    v_fma_mix_f32 v120, v3, v7, v120 op_sel:[1,1,0] op_sel_hi:[1,1,0]
    v_mfma_f32_16x16x32_bf16 v[56:59], a[200:203], v[28:31], v[56:59]
    s_mov_b32 s44, s53
    ds_read_b128 v[28:31], v147 offset:42752
    v_fma_mix_f32 v120, v254, v160, v120 op_sel:[0,0,0] op_sel_hi:[1,1,0]
    v_mfma_f32_16x16x32_bf16 v[56:59], a[204:207], v[20:23], v[56:59]
    s_sub_u32 s48, s44, s46
    ds_read_b128 v[20:23], v146 offset:42752
    v_fma_mix_f32 v120, v254, v160, v120 op_sel:[1,1,0] op_sel_hi:[1,1,0]
    v_mfma_f32_16x16x32_bf16 v[56:59], a[208:211], v[60:63], v[56:59]
    s_sub_u32 s49, s46, s45
    buffer_load_dwordx4 v25, s[76:79], s92 offen offset:1024 lds
    v_fma_mix_f32 v120, v255, v161, v120 op_sel:[0,0,0] op_sel_hi:[1,1,0]
    v_mfma_f32_16x16x32_bf16 v[56:59], a[212:215], v[12:15], v[56:59]
    s_waitcnt lgkmcnt(5)
    v_fma_mix_f32 v120, v255, v161, v120 op_sel:[1,1,0] op_sel_hi:[1,1,0]
    v_mov_b32 v146, v120
    v_mfma_f32_16x16x32_bf16 v[12:15], a[144:147], v[48:51], 0
    s_waitcnt lgkmcnt(4)
    v_permlane32_swap_b32 v146, v120
    v_add_f32 v120, v146, v120
    v_mfma_f32_16x16x32_bf16 v[12:15], a[148:151], v[44:47], v[12:15]
    s_waitcnt lgkmcnt(3)
    v_mov_b32 v146, v120
    v_cvt_pk_bf16_f32 v148, v40, v41
    v_cvt_pk_bf16_f32 v149, v42, v43
    v_mfma_f32_16x16x32_bf16 v[12:15], a[152:155], v[36:39], v[12:15]
    s_waitcnt lgkmcnt(2)
    ds_write_b64 v158, v[148:149] offset:28752
    buffer_load_dwordx4 v24, s[76:79], s92 offen offset:2048 lds
    s_add_u32 m0, s90, 61440
    v_mfma_f32_16x16x32_bf16 v[12:15], a[156:159], v[32:35], v[12:15]
    s_waitcnt lgkmcnt(2)
    s_mov_b32 s92, 61440
    v_permlane16_swap_b32 v146, v120
    v_mfma_f32_16x16x32_bf16 v[12:15], a[160:163], v[28:31], v[12:15]
    s_waitcnt lgkmcnt(1)
    v_add_f32 v120, v146, v120
    v_and_b32 v146, 0xffff0000, v120
    v_mfma_f32_16x16x32_bf16 v[12:15], a[164:167], v[20:23], v[12:15]
    v_sub_f32 v120, v120, v146
    v_cvt_pk_bf16_f32 v120, v120, v146
    v_mfma_f32_16x16x32_bf16 v[40:43], a[168:171], v[48:51], 0
    v_cvt_pk_bf16_f32 v52, v52, v53
    v_cvt_pk_bf16_f32 v53, v54, v55
    v_mfma_f32_16x16x32_bf16 v[40:43], a[172:175], v[44:47], v[40:43]
    buffer_load_dwordx4 v121, s[76:79], s92 offen offset:0 lds
    v_cvt_pk_bf16_f32 v54, v56, v57
    v_mfma_f32_16x16x32_bf16 v[40:43], a[176:179], v[36:39], v[40:43]
    v_cvt_pk_bf16_f32 v55, v58, v59
    v_cvt_pk_bf16_f32 v156, v12, v13
    v_mfma_f32_16x16x32_bf16 v[40:43], a[180:183], v[32:35], v[40:43]
    ds_write_b128 v158, v[52:55] offset:28768
    v_mfma_f32_16x16x32_bf16 v[40:43], a[184:187], v[28:31], v[40:43]
    v_cvt_pk_bf16_f32 v157, v14, v15
    v_add_u32 v121, s93, v129
    v_mfma_f32_16x16x32_bf16 v[40:43], a[188:191], v[20:23], v[40:43]
    buffer_load_dwordx4 v25, s[76:79], s92 offen offset:1024 lds
    v_add_u32 v137, s48, v137
    v_mfma_f32_16x16x32_bf16 v[12:15], a[192:195], v[48:51], 0
    s_nop 0
    v_add_u32 v136, s48, v136
    s_nop 0
    v_mfma_f32_16x16x32_bf16 v[12:15], a[196:199], v[44:47], v[12:15]
    s_nop 0
    v_cvt_pk_bf16_f32 v76, v40, v41
    v_cvt_pk_bf16_f32 v77, v42, v43
    v_mfma_f32_16x16x32_bf16 v[12:15], a[200:203], v[36:39], v[12:15]
    v_mfma_f32_16x16x32_bf16 v[12:15], a[204:207], v[32:35], v[12:15]
    v_mfma_f32_16x16x32_bf16 v[12:15], a[208:211], v[28:31], v[12:15]
    buffer_load_dwordx4 v24, s[76:79], s92 offen offset:2048 lds
    v_mfma_f32_16x16x32_bf16 v[12:15], a[212:215], v[20:23], v[12:15]
    s_add_u32 m0, s54, 20480
    s_nop 6
    v_cvt_pk_bf16_f32 v78, v12, v13
    v_cvt_pk_bf16_f32 v79, v14, v15
    buffer_load_dwordx4 v128, s[24:27], s56 offen nt lds
    s_add_u32 m0, s54, 21504
    s_nop 0
    buffer_load_dwordx4 v127, s[24:27], s56 offen nt lds
    s_add_u32 m0, s54, 22528
    s_nop 0
    buffer_load_dwordx4 v126, s[24:27], s56 offen nt lds
    s_add_u32 m0, s54, 23552
    s_nop 0
    buffer_load_dwordx4 v125, s[24:27], s56 offen nt lds
    s_add_u32 m0, s54, 24576
    s_nop 0
    buffer_load_dwordx4 v124, s[24:27], s56 offen nt lds
    s_waitcnt vmcnt(5)
    s_barrier
    ds_read_b128 v[36:39], v17 offset:0
    ds_read_b64 v[12:13], v16 offset:64
    ds_read_b128 v[28:31], v17 offset:3072
    ds_read_b64 v[14:15], v16 offset:3136
    ds_read_b128 v[48:51], v17 offset:6144
    ds_read_b64 v[32:33], v16 offset:6208
    ds_read_b128 v[40:43], v17 offset:9216
    ds_read_b64 v[34:35], v16 offset:9280
    ds_read_b128 v[44:47], v17 offset:12288
    ds_read_b64 v[52:53], v16 offset:12352
    ds_read_b128 v[20:23], v17 offset:15360
    ds_read_b64 v[54:55], v16 offset:15424
    s_waitcnt lgkmcnt(11)
    v_mfma_f32_16x16x32_bf16 v[56:59], v[36:39], v[220:223], 0
    s_waitcnt lgkmcnt(9)
    ds_read_b128 v[36:39], v17 offset:18432
    v_mfma_f32_16x16x32_bf16 v[56:59], v[28:31], v[220:223], v[56:59]
    s_waitcnt lgkmcnt(8)
    ds_read_b64 v[28:29], v16 offset:18496
    ds_read_b128 v[60:63], v17 offset:21504
    v_mfma_f32_16x16x32_bf16 v[56:59], v[48:51], v[220:223], v[56:59]
    s_waitcnt lgkmcnt(8)
    ds_read_b64 v[30:31], v16 offset:21568
    ds_read_b128 v[48:51], v17 offset:24576
    v_mfma_f32_16x16x32_bf16 v[56:59], v[40:43], v[220:223], v[56:59]
    ds_read_b64 v[40:41], v16 offset:24640
    v_mfma_f32_16x16x32_bf16 v[56:59], v[12:15], v[220:223], v[56:59]
    s_waitcnt lgkmcnt(9)
    ds_read_b128 v[12:15], v17 offset:27648
    v_mfma_f32_16x16x32_bf16 v[56:59], v[32:35], v[220:223], v[56:59]
    ds_read_b64 v[42:43], v16 offset:27712
    v_mfma_f32_16x16x32_bf16 v[32:35], v[44:47], v[220:223], 0
    s_waitcnt lgkmcnt(8)
    ds_read_b128 v[44:47], v17 offset:30720
    v_mfma_f32_16x16x32_bf16 v[32:35], v[20:23], v[220:223], v[32:35]
    s_waitcnt lgkmcnt(8)
    s_nop 0
    ds_read_b64 v[20:21], v16 offset:30784
    v_mul_f32 v56, 0xbbaaaaab, v56
    v_mfma_f32_16x16x32_bf16 v[32:35], v[36:39], v[220:223], v[32:35]
    s_waitcnt lgkmcnt(7)
    ds_read_b128 v[36:39], v17 offset:33792
    v_mul_f32 v57, 0xbbaaaaab, v57
    v_mul_f32 v58, 0xbbaaaaab, v58
    v_mul_f32 v59, 0xbbaaaaab, v59
    v_mfma_f32_16x16x32_bf16 v[32:35], v[60:63], v[220:223], v[32:35]
    ds_write_b128 v74, v[56:59] offset:0
    v_mfma_f32_16x16x32_bf16 v[32:35], v[52:55], v[220:223], v[32:35]
    s_waitcnt lgkmcnt(6)
    v_mfma_f32_16x16x32_bf16 v[32:35], v[28:31], v[220:223], v[32:35]
    v_mfma_f32_16x16x32_bf16 v[28:31], v[48:51], v[220:223], 0
    s_waitcnt lgkmcnt(4)
    ds_read_b64 v[22:23], v16 offset:33856
    s_nop 0
    v_mfma_f32_16x16x32_bf16 v[28:31], v[12:15], v[220:223], v[28:31]
    s_waitcnt lgkmcnt(4)
    s_nop 0
    ds_read_b128 v[12:15], v19 offset:0
    v_mul_f32 v32, 0xbbaaaaab, v32
    v_mfma_f32_16x16x32_bf16 v[28:31], v[44:47], v[220:223], v[28:31]
    s_waitcnt lgkmcnt(3)
    ds_read_b64 v[16:17], v18 offset:64
    v_mul_f32 v33, 0xbbaaaaab, v33
    v_mul_f32 v34, 0xbbaaaaab, v34
    v_mul_f32 v35, 0xbbaaaaab, v35
    v_mfma_f32_16x16x32_bf16 v[28:31], v[36:39], v[220:223], v[28:31]
    ds_write_b128 v74, v[32:35] offset:128
    v_mfma_f32_16x16x32_bf16 v[28:31], v[40:43], v[220:223], v[28:31]
    ds_read_b128 v[80:83], v19 offset:768
    ds_read_b64 v[84:85], v18 offset:832
    ds_read_b128 v[68:71], v19 offset:12288
    s_waitcnt lgkmcnt(6)
    v_mfma_f32_16x16x32_bf16 v[28:31], v[20:23], v[220:223], v[28:31]
    s_nop 0
    ds_read_b64 v[72:73], v18 offset:12352
    s_nop 0
    ds_read_b128 v[20:23], v19 offset:13056
    s_nop 2
    ds_read_b64 v[24:25], v18 offset:13120
    v_mul_f32 v28, 0xbbaaaaab, v28
    v_mul_f32 v29, 0xbbaaaaab, v29
    v_mul_f32 v30, 0xbbaaaaab, v30
    v_mul_f32 v31, 0xbbaaaaab, v31
    ds_write_b128 v74, v[28:31] offset:256
    s_waitcnt lgkmcnt(0)
    s_barrier
    ds_read_b128 v[40:43], v162 offset:0
    ds_read_b128 v[28:31], v162 offset:64
    ds_read_b128 v[64:67], v162 offset:128
    ds_read_b128 v[56:59], v162 offset:192
    s_waitcnt lgkmcnt(3)
    v_mfma_f32_16x16x16_bf16 v[32:35], v[12:13], v[26:27], v[40:43]
    v_mfma_f32_16x16x16_bf16 v[36:39], v[14:15], v[26:27], v[40:43]
    s_nop 2
    v_mfma_f32_16x16x16_bf16 v[60:63], v[16:17], v[26:27], v[40:43]
    s_waitcnt lgkmcnt(0)
    s_nop 0
    ds_read_b128 v[12:15], v19 offset:24576
    v_cvt_pk_bf16_f32 v32, v32, v33
    v_mfma_f32_16x16x16_bf16 v[52:55], v[80:81], v[26:27], v[28:31]
    ds_read_b64 v[16:17], v18 offset:24640
    v_accvgpr_write_b32 a216, v32
    v_mfma_f32_16x16x16_bf16 v[48:51], v[82:83], v[26:27], v[28:31]
    ds_read_b128 v[44:47], v162 offset:256
    v_cvt_pk_bf16_f32 v34, v34, v35
    v_mfma_f32_16x16x16_bf16 v[40:43], v[84:85], v[26:27], v[28:31]
    ds_read_b128 v[104:107], v19 offset:25344
    v_accvgpr_write_b32 a217, v34
    v_mfma_f32_16x16x16_bf16 v[84:87], v[68:69], v[26:27], v[64:67]
    ds_read_b64 v[108:109], v18 offset:25408
    v_cvt_pk_bf16_f32 v36, v36, v37
    v_mfma_f32_16x16x16_bf16 v[32:35], v[70:71], v[26:27], v[64:67]
    ds_read_b128 v[100:103], v162 offset:320
    v_accvgpr_write_b32 a240, v36
    v_mfma_f32_16x16x16_bf16 v[28:31], v[72:73], v[26:27], v[64:67]
    ds_read_b128 v[92:95], v19 offset:36864
    v_cvt_pk_bf16_f32 v38, v38, v39
    v_mfma_f32_16x16x16_bf16 v[68:71], v[20:21], v[26:27], v[56:59]
    ds_read_b64 v[96:97], v18 offset:36928
    v_accvgpr_write_b32 a241, v38
    v_mfma_f32_16x16x16_bf16 v[64:67], v[22:23], v[26:27], v[56:59]
    ds_read_b128 v[80:83], v162 offset:5120
    v_cvt_pk_bf16_f32 v232, v60, v61
    v_mfma_f32_16x16x16_bf16 v[36:39], v[24:25], v[26:27], v[56:59]
    s_waitcnt lgkmcnt(6)
    ds_read_b128 v[20:23], v19 offset:37632
    v_cvt_pk_bf16_f32 v233, v62, v63
    v_cvt_pk_bf16_f32 v52, v52, v53
    v_accvgpr_write_b32 a218, v52
    v_cvt_pk_bf16_f32 v54, v54, v55
    v_accvgpr_write_b32 a219, v54
    v_cvt_pk_bf16_f32 v48, v48, v49
    v_mfma_f32_16x16x16_bf16 v[60:63], v[12:13], v[26:27], v[44:47]
    ds_read_b64 v[24:25], v18 offset:37696
    v_accvgpr_write_b32 a242, v48
    v_mfma_f32_16x16x16_bf16 v[56:59], v[14:15], v[26:27], v[44:47]
    ds_read_b128 v[88:91], v162 offset:5184
    v_cvt_pk_bf16_f32 v50, v50, v51
    v_mfma_f32_16x16x16_bf16 v[52:55], v[16:17], v[26:27], v[44:47]
    s_waitcnt lgkmcnt(6)
    ds_read_b128 v[12:15], v19 offset:49152
    v_accvgpr_write_b32 a243, v50
    v_cvt_pk_bf16_f32 v234, v40, v41
    v_cvt_pk_bf16_f32 v235, v42, v43
    v_mfma_f32_16x16x16_bf16 v[72:75], v[104:105], v[26:27], v[100:103]
    ds_read_b64 v[16:17], v18 offset:49216
    v_cvt_pk_bf16_f32 v84, v84, v85
    v_mfma_f32_16x16x16_bf16 v[40:43], v[106:107], v[26:27], v[100:103]
    ds_read_b128 v[48:51], v162 offset:5248
    v_accvgpr_write_b32 a220, v84
    v_mfma_f32_16x16x16_bf16 v[44:47], v[108:109], v[26:27], v[100:103]
    s_waitcnt lgkmcnt(6)
    ds_read_b128 v[104:107], v19 offset:49920
    v_cvt_pk_bf16_f32 v86, v86, v87
    v_accvgpr_write_b32 a221, v86
    v_cvt_pk_bf16_f32 v32, v32, v33
    v_accvgpr_write_b32 a244, v32
    v_cvt_pk_bf16_f32 v34, v34, v35
    v_accvgpr_write_b32 a245, v34
    v_cvt_pk_bf16_f32 v236, v28, v29
    v_cvt_pk_bf16_f32 v237, v30, v31
    v_mfma_f32_16x16x16_bf16 v[84:87], v[92:93], v[26:27], v[80:83]
    ds_read_b64 v[108:109], v18 offset:49984
    v_cvt_pk_bf16_f32 v68, v68, v69
    v_mfma_f32_16x16x16_bf16 v[32:35], v[94:95], v[26:27], v[80:83]
    ds_read_b128 v[100:103], v162 offset:5312
    v_accvgpr_write_b32 a222, v68
    v_mfma_f32_16x16x16_bf16 v[28:31], v[96:97], v[26:27], v[80:83]
    s_waitcnt lgkmcnt(5)
    ds_read_b128 v[92:95], v19 offset:61440
    v_cvt_pk_bf16_f32 v70, v70, v71
    v_accvgpr_write_b32 a223, v70
    v_cvt_pk_bf16_f32 v64, v64, v65
    v_accvgpr_write_b32 a246, v64
    v_cvt_pk_bf16_f32 v66, v66, v67
    v_accvgpr_write_b32 a247, v66
    v_cvt_pk_bf16_f32 v238, v36, v37
    v_cvt_pk_bf16_f32 v239, v38, v39
    v_mfma_f32_16x16x16_bf16 v[36:39], v[20:21], v[26:27], v[88:91]
    ds_read_b64 v[96:97], v18 offset:61504
    v_cvt_pk_bf16_f32 v60, v60, v61
    v_mfma_f32_16x16x16_bf16 v[68:71], v[22:23], v[26:27], v[88:91]
    ds_read_b128 v[80:83], v162 offset:5376
    v_accvgpr_write_b32 a224, v60
    v_mfma_f32_16x16x16_bf16 v[64:67], v[24:25], v[26:27], v[88:91]
    s_waitcnt lgkmcnt(5)
    ds_read_b128 v[20:23], v19 offset:62208
    v_cvt_pk_bf16_f32 v62, v62, v63
    v_accvgpr_write_b32 a225, v62
    v_cvt_pk_bf16_f32 v56, v56, v57
    v_accvgpr_write_b32 a248, v56
    v_cvt_pk_bf16_f32 v58, v58, v59
    v_accvgpr_write_b32 a249, v58
    v_cvt_pk_bf16_f32 v240, v52, v53
    v_cvt_pk_bf16_f32 v241, v54, v55
    v_mfma_f32_16x16x16_bf16 v[60:63], v[12:13], v[26:27], v[48:51]
    ds_read_b64 v[24:25], v18 offset:62272
    v_cvt_pk_bf16_f32 v72, v72, v73
    v_mfma_f32_16x16x16_bf16 v[56:59], v[14:15], v[26:27], v[48:51]
    ds_read_b128 v[12:15], v162 offset:5440
    v_accvgpr_write_b32 a226, v72
    v_mfma_f32_16x16x16_bf16 v[52:55], v[16:17], v[26:27], v[48:51]
    s_waitcnt lgkmcnt(5)
    ds_read_b128 v[16:19], v137 offset:0
    v_cvt_pk_bf16_f32 v74, v74, v75
    v_accvgpr_write_b32 a227, v74
    v_cvt_pk_bf16_f32 v40, v40, v41
    v_accvgpr_write_b32 a250, v40
    v_cvt_pk_bf16_f32 v42, v42, v43
    v_accvgpr_write_b32 a251, v42
    v_cvt_pk_bf16_f32 v242, v44, v45
    v_cvt_pk_bf16_f32 v243, v46, v47
    v_mfma_f32_16x16x16_bf16 v[48:51], v[104:105], v[26:27], v[100:103]
    ds_read_b128 v[146:149], v136 offset:0
    v_cvt_pk_bf16_f32 v84, v84, v85
    v_mfma_f32_16x16x16_bf16 v[44:47], v[106:107], v[26:27], v[100:103]
    ds_read_b128 v[72:75], v137 offset:128
    v_accvgpr_write_b32 a228, v84
    v_mfma_f32_16x16x16_bf16 v[40:43], v[108:109], v[26:27], v[100:103]
    s_waitcnt lgkmcnt(5)
    ds_read_b128 v[88:91], v136 offset:128
    v_cvt_pk_bf16_f32 v86, v86, v87
    v_accvgpr_write_b32 a229, v86
    v_cvt_pk_bf16_f32 v32, v32, v33
    v_accvgpr_write_b32 a252, v32
    v_cvt_pk_bf16_f32 v34, v34, v35
    v_accvgpr_write_b32 a253, v34
    v_cvt_pk_bf16_f32 v244, v28, v29
    v_cvt_pk_bf16_f32 v245, v30, v31
    v_mfma_f32_16x16x16_bf16 v[32:35], v[92:93], v[26:27], v[80:83]
    s_waitcnt vmcnt(0) lgkmcnt(4)
    s_barrier
    ds_write_b128 v121, v[8:11] offset:6144
    v_mfma_f32_16x16x16_bf16 v[28:31], v[94:95], v[26:27], v[80:83]
    v_cvt_pk_bf16_f32 v36, v36, v37
    v_accvgpr_write_b32 a230, v36
    v_mfma_f32_16x16x16_bf16 v[8:11], v[96:97], v[26:27], v[80:83]
    s_waitcnt lgkmcnt(4)
    v_cvt_pk_bf16_f32 v38, v38, v39
    v_accvgpr_write_b32 a231, v38
    v_cvt_pk_bf16_f32 v68, v68, v69
    v_mfma_f32_16x16x32_bf16 v[36:39], a[0:3], v[16:19], 0
    s_waitcnt lgkmcnt(3)
    ds_write_b64 v158, v[156:157] offset:80
    v_mfma_f32_16x16x32_bf16 v[36:39], a[4:7], v[146:149], v[36:39]
    s_waitcnt lgkmcnt(3)
    v_accvgpr_write_b32 a254, v68
    v_cvt_pk_bf16_f32 v70, v70, v71
    v_mfma_f32_16x16x32_bf16 v[36:39], a[8:11], v[72:75], v[36:39]
    s_waitcnt lgkmcnt(2)
    ds_write_b128 v158, v[76:79] offset:96
    v_mfma_f32_16x16x32_bf16 v[36:39], a[12:15], v[88:91], v[36:39]
    v_accvgpr_write_b32 a255, v70
    v_cvt_pk_bf16_f32 v246, v64, v65
    v_cvt_pk_bf16_f32 v247, v66, v67
    v_cvt_pk_bf16_f32 v60, v60, v61
    v_accvgpr_write_b32 a232, v60
    v_cvt_pk_bf16_f32 v62, v62, v63
    v_accvgpr_write_b32 a233, v62
    v_cvt_pk_bf16_f32 v224, v56, v57
    v_cvt_pk_bf16_f32 v225, v58, v59
    v_cvt_pk_bf16_f32 v248, v52, v53
    v_cvt_pk_bf16_f32 v249, v54, v55
    v_cvt_pk_bf16_f32 v48, v48, v49
    v_accvgpr_write_b32 a234, v48
    v_cvt_pk_bf16_f32 v50, v50, v51
    v_accvgpr_write_b32 a235, v50
    v_cvt_pk_bf16_f32 v226, v44, v45
    v_cvt_pk_bf16_f32 v227, v46, v47
    v_cvt_pk_bf16_f32 v250, v40, v41
    v_cvt_pk_bf16_f32 v251, v42, v43
    v_cvt_pk_bf16_f32 v32, v32, v33
    v_accvgpr_write_b32 a236, v32
    v_cvt_pk_bf16_f32 v34, v34, v35
    v_accvgpr_write_b32 a237, v34
    v_cvt_pk_bf16_f32 v228, v28, v29
    v_cvt_pk_bf16_f32 v229, v30, v31
    v_cvt_pk_bf16_f32 v252, v8, v9
    v_cvt_pk_bf16_f32 v253, v10, v11
    v_mov_b32 v156, 0
    v_mov_b32 v157, 0
    v_mov_b32 v121, 0
    v_add_u32 v230, 0, v158
    ds_write_b128 v230, v[4:7]
    v_add_u32 v135, s49, v135
    v_add_u32 v134, s49, v134
    ds_write2_b64 v230, v[156:157], v[156:157] offset0:2 offset1:3
    ds_write_b128 v230, v[0:3] offset:32
    ds_write2_b64 v230, v[160:161], v[156:157] offset0:6 offset1:7
    ds_write2_b64 v230, v[156:157], v[254:255] offset0:8 offset1:9
    ds_write_b64 v230, v[120:121] offset:88
    ds_read_b128 v[76:79], v137 offset:256
    ds_read_b128 v[56:59], v136 offset:256
    s_waitcnt lgkmcnt(1)
    v_mfma_f32_16x16x32_bf16 v[36:39], a[16:19], v[76:79], v[36:39]
    s_waitcnt lgkmcnt(0)
    v_mfma_f32_16x16x32_bf16 v[36:39], a[20:23], v[56:59], v[36:39]
    s_nop 0
    v_mfma_f32_16x16x16_bf16 v[8:11], v[20:21], v[26:27], v[12:15]
    s_nop 3
    v_mfma_f32_16x16x16_bf16 v[4:7], v[22:23], v[26:27], v[12:15]
    s_nop 0
    v_fma_f32 v121, v36, v36, s41
    v_fmac_f32 v121, v37, v37
    v_mfma_f32_16x16x16_bf16 v[0:3], v[24:25], v[26:27], v[12:15]
    v_cvt_pk_bf16_f32 v8, v8, v9
    v_accvgpr_write_b32 a238, v8
    v_cvt_pk_bf16_f32 v10, v10, v11
    v_mfma_f32_16x16x32_bf16 v[48:51], a[24:27], v[16:19], 0
    v_accvgpr_write_b32 a239, v10
    v_cvt_pk_bf16_f32 v230, v4, v5
    v_mfma_f32_16x16x32_bf16 v[48:51], a[28:31], v[146:149], v[48:51]
    v_cvt_pk_bf16_f32 v231, v6, v7
    v_cvt_pk_bf16_f32 v254, v0, v1
    v_mfma_f32_16x16x32_bf16 v[48:51], a[32:35], v[72:75], v[48:51]
    v_cvt_pk_bf16_f32 v255, v2, v3
    v_fmac_f32 v121, v38, v38
    v_mfma_f32_16x16x32_bf16 v[48:51], a[36:39], v[88:91], v[48:51]
    v_fmac_f32 v121, v39, v39
    v_mfma_f32_16x16x32_bf16 v[48:51], a[40:43], v[76:79], v[48:51]
    v_mfma_f32_16x16x32_bf16 v[48:51], a[44:47], v[56:59], v[48:51]
    s_nop 1
    v_mfma_f32_16x16x32_bf16 v[40:43], a[48:51], v[16:19], 0
    s_nop 2
    v_mfma_f32_16x16x32_bf16 v[40:43], a[52:55], v[146:149], v[40:43]
    s_nop 0
    v_fmac_f32 v121, v48, v48
    v_fmac_f32 v121, v49, v49
    v_mfma_f32_16x16x32_bf16 v[40:43], a[56:59], v[72:75], v[40:43]
    v_fmac_f32 v121, v50, v50
    v_fmac_f32 v121, v51, v51
    v_mfma_f32_16x16x32_bf16 v[40:43], a[60:63], v[88:91], v[40:43]
    v_mfma_f32_16x16x32_bf16 v[40:43], a[64:67], v[76:79], v[40:43]
    v_mfma_f32_16x16x32_bf16 v[40:43], a[68:71], v[56:59], v[40:43]
    s_nop 1
    v_mfma_f32_16x16x32_bf16 v[28:31], a[72:75], v[16:19], 0
    s_nop 2
    v_mfma_f32_16x16x32_bf16 v[28:31], a[76:79], v[146:149], v[28:31]
    s_nop 0
    v_fmac_f32 v121, v40, v40
    v_fmac_f32 v121, v41, v41
    v_mfma_f32_16x16x32_bf16 v[28:31], a[80:83], v[72:75], v[28:31]
    v_fmac_f32 v121, v42, v42
    v_fmac_f32 v121, v43, v43
    v_mfma_f32_16x16x32_bf16 v[28:31], a[84:87], v[88:91], v[28:31]
    v_mfma_f32_16x16x32_bf16 v[28:31], a[88:91], v[76:79], v[28:31]
    v_mfma_f32_16x16x32_bf16 v[28:31], a[92:95], v[56:59], v[28:31]
    s_nop 1
    v_mfma_f32_16x16x32_bf16 v[32:35], a[96:99], v[16:19], 0
    s_nop 2
    v_mfma_f32_16x16x32_bf16 v[32:35], a[100:103], v[146:149], v[32:35]
    s_nop 0
    v_fma_f32 v120, v28, v28, s41
    v_fmac_f32 v120, v29, v29
    v_mfma_f32_16x16x32_bf16 v[32:35], a[104:107], v[72:75], v[32:35]
    v_fmac_f32 v120, v30, v30
    v_fmac_f32 v120, v31, v31
    v_mfma_f32_16x16x32_bf16 v[32:35], a[108:111], v[88:91], v[32:35]
    v_mfma_f32_16x16x32_bf16 v[32:35], a[112:115], v[76:79], v[32:35]
    v_mfma_f32_16x16x32_bf16 v[32:35], a[116:119], v[56:59], v[32:35]
    s_nop 1
    v_mfma_f32_16x16x32_bf16 v[20:23], a[120:123], v[16:19], 0
    s_nop 2
    v_mfma_f32_16x16x32_bf16 v[20:23], a[124:127], v[146:149], v[20:23]
    s_nop 0
    v_fmac_f32 v120, v32, v32
    v_fmac_f32 v120, v33, v33
    v_mfma_f32_16x16x32_bf16 v[20:23], a[128:131], v[72:75], v[20:23]
    v_fmac_f32 v120, v34, v34
    v_fmac_f32 v120, v35, v35
    v_mfma_f32_16x16x32_bf16 v[20:23], a[132:135], v[88:91], v[20:23]
    v_mfma_f32_16x16x32_bf16 v[20:23], a[136:139], v[76:79], v[20:23]
    v_mfma_f32_16x16x32_bf16 v[20:23], a[140:143], v[56:59], v[20:23]
    s_nop 1
    v_mfma_f32_16x16x32_bf16 v[8:11], v[16:19], a[144:147], 0
    s_nop 2
    v_mfma_f32_16x16x32_bf16 v[8:11], v[146:149], a[148:151], v[8:11]
    s_nop 0
    v_fmac_f32 v120, v20, v20
    v_fmac_f32 v120, v21, v21
    v_mfma_f32_16x16x32_bf16 v[8:11], v[72:75], a[152:155], v[8:11]
    v_fmac_f32 v120, v22, v22
    v_fmac_f32 v120, v23, v23
    v_mfma_f32_16x16x32_bf16 v[8:11], v[88:91], a[156:159], v[8:11]
    v_cvt_pk_bf16_f32 v170, v121, v120
    v_mfma_f32_16x16x32_bf16 v[8:11], v[76:79], a[160:163], v[8:11]
    ds_read_b128 v[104:107], v137 offset:1536
    v_mfma_f32_16x16x32_bf16 v[8:11], v[56:59], a[164:167], v[8:11]
    s_nop 0
    ds_read_b128 v[100:103], v136 offset:1536
    s_nop 0
    v_mfma_f32_16x16x16_bf16 v[24:27], v[216:217], v[170:171], 0
    s_nop 0
    ds_read_b128 v[44:47], v137 offset:1664
    s_nop 1
    v_cvt_pk_bf16_f32 v0, v8, v9
    v_mfma_f32_16x16x32_bf16 v[4:7], v[16:19], a[168:171], 0
    ds_read_b128 v[84:87], v136 offset:1664
    v_cvt_pk_bf16_f32 v1, v10, v11
    v_mfma_f32_16x16x32_bf16 v[4:7], v[146:149], a[172:175], v[4:7]
    ds_read_b128 v[68:71], v137 offset:1792
    v_mfma_f32_16x16x32_bf16 v[4:7], v[72:75], a[176:179], v[4:7]
    ds_read_b128 v[64:67], v136 offset:1792
    v_mfma_f32_16x16x32_bf16 v[4:7], v[88:91], a[180:183], v[4:7]
    v_rsq_f32 v24, v24
    v_mfma_f32_16x16x32_bf16 v[4:7], v[76:79], a[184:187], v[4:7]
    v_rsq_f32 v25, v25
    v_mfma_f32_16x16x32_bf16 v[4:7], v[56:59], a[188:191], v[4:7]
    v_mul_f32 v24, s55, v24
    v_mul_f32 v25, 0.5, v25
    v_mfma_f32_16x16x32_bf16 v[12:15], v[16:19], a[192:195], 0
    s_nop 0
    v_mul_f32 v36, v36, v24
    v_mul_f32 v37, v37, v24
    v_mfma_f32_16x16x32_bf16 v[12:15], v[146:149], a[196:199], v[12:15]
    s_nop 0
    v_cvt_pk_bf16_f32 v8, v4, v5
    v_cvt_pk_bf16_f32 v9, v6, v7
    v_mfma_f32_16x16x32_bf16 v[12:15], v[72:75], a[200:203], v[12:15]
    v_cvt_pk_f16_f32 v4, v36, v37
    v_mul_f32 v38, v38, v24
    v_mfma_f32_16x16x32_bf16 v[12:15], v[88:91], a[204:207], v[12:15]
    v_mul_f32 v39, v39, v24
    v_cvt_pk_f16_f32 v5, v38, v39
    v_mfma_f32_16x16x32_bf16 v[12:15], v[76:79], a[208:211], v[12:15]
    v_mul_f32 v48, v48, v24
    v_mul_f32 v49, v49, v24
    v_mfma_f32_16x16x32_bf16 v[12:15], v[56:59], a[212:215], v[12:15]
    s_waitcnt lgkmcnt(0)
    v_cvt_pk_f16_f32 v6, v48, v49
    v_mul_f32 v50, v50, v24
    v_mfma_f32_16x16x32_bf16 v[16:19], a[0:3], v[104:107], 0
    v_mul_f32 v51, v51, v24
    v_cvt_pk_f16_f32 v7, v50, v51
    v_mfma_f32_16x16x32_bf16 v[16:19], a[4:7], v[100:103], v[16:19]
    v_mul_f32 v40, v40, v24
    v_mul_f32 v41, v41, v24
    v_mfma_f32_16x16x32_bf16 v[16:19], a[8:11], v[44:47], v[16:19]
    v_cvt_pk_f16_f32 v152, v40, v41
    v_mul_f32 v42, v42, v24
    v_mfma_f32_16x16x32_bf16 v[16:19], a[12:15], v[84:87], v[16:19]
    v_mul_f32 v43, v43, v24
    v_cvt_pk_f16_f32 v153, v42, v43
    v_mfma_f32_16x16x32_bf16 v[16:19], a[16:19], v[68:71], v[16:19]
    v_mul_f32 v28, v28, v25
    v_mul_f32 v29, v29, v25
    v_mfma_f32_16x16x32_bf16 v[16:19], a[20:23], v[64:67], v[16:19]
    v_cvt_pk_f16_f32 v28, v28, v29
    v_mul_f32 v30, v30, v25
    v_mfma_f32_16x16x32_bf16 v[60:63], a[24:27], v[104:107], 0
    v_mul_f32 v31, v31, v25
    v_cvt_pk_f16_f32 v29, v30, v31
    v_mfma_f32_16x16x32_bf16 v[60:63], a[28:31], v[100:103], v[60:63]
    v_mul_f32 v32, v32, v25
    v_mul_f32 v33, v33, v25
    v_mfma_f32_16x16x32_bf16 v[60:63], a[32:35], v[44:47], v[60:63]
    v_cvt_pk_f16_f32 v30, v32, v33
    v_mul_f32 v34, v34, v25
    v_mfma_f32_16x16x32_bf16 v[60:63], a[36:39], v[84:87], v[60:63]
    v_mul_f32 v35, v35, v25
    v_cvt_pk_f16_f32 v31, v34, v35
    v_mfma_f32_16x16x32_bf16 v[60:63], a[40:43], v[68:71], v[60:63]
    v_mul_f32 v20, v20, v25
    v_mul_f32 v21, v21, v25
    v_mfma_f32_16x16x32_bf16 v[60:63], a[44:47], v[64:67], v[60:63]
    v_cvt_pk_f16_f32 v154, v20, v21
    v_mul_f32 v22, v22, v25
    v_mfma_f32_16x16x32_bf16 v[36:39], a[48:51], v[104:107], 0
    v_mul_f32 v23, v23, v25
    v_cvt_pk_f16_f32 v155, v22, v23
    v_mfma_f32_16x16x32_bf16 v[36:39], a[52:55], v[100:103], v[36:39]
    v_cvt_pk_bf16_f32 v20, v12, v13
    v_cvt_pk_bf16_f32 v21, v14, v15
    v_mfma_f32_16x16x32_bf16 v[36:39], a[56:59], v[44:47], v[36:39]
    v_fma_f32 v2, v16, v16, s41
    v_fmac_f32 v2, v17, v17
    v_mfma_f32_16x16x32_bf16 v[36:39], a[60:63], v[84:87], v[36:39]
    v_fmac_f32 v2, v18, v18
    v_fmac_f32 v2, v19, v19
    v_mfma_f32_16x16x32_bf16 v[36:39], a[64:67], v[68:71], v[36:39]
    v_fmac_f32 v2, v60, v60
    v_fmac_f32 v2, v61, v61
    v_mfma_f32_16x16x32_bf16 v[36:39], a[68:71], v[64:67], v[36:39]
    v_fmac_f32 v2, v62, v62
    v_fmac_f32 v2, v63, v63
    v_mfma_f32_16x16x32_bf16 v[52:55], a[72:75], v[104:107], 0
    s_nop 2
    v_mfma_f32_16x16x32_bf16 v[52:55], a[76:79], v[100:103], v[52:55]
    s_nop 0
    v_fmac_f32 v2, v36, v36
    v_fmac_f32 v2, v37, v37
    v_mfma_f32_16x16x32_bf16 v[52:55], a[80:83], v[44:47], v[52:55]
    v_fmac_f32 v2, v38, v38
    v_fmac_f32 v2, v39, v39
    v_mfma_f32_16x16x32_bf16 v[52:55], a[84:87], v[84:87], v[52:55]
    v_mfma_f32_16x16x32_bf16 v[52:55], a[88:91], v[68:71], v[52:55]
    v_mfma_f32_16x16x32_bf16 v[52:55], a[92:95], v[64:67], v[52:55]
    s_nop 1
    v_mfma_f32_16x16x32_bf16 v[12:15], a[96:99], v[104:107], 0
    s_nop 2
    v_mfma_f32_16x16x32_bf16 v[12:15], a[100:103], v[100:103], v[12:15]
    s_nop 0
    v_fma_f32 v3, v52, v52, s41
    v_fmac_f32 v3, v53, v53
    v_mfma_f32_16x16x32_bf16 v[12:15], a[104:107], v[44:47], v[12:15]
    v_fmac_f32 v3, v54, v54
    v_fmac_f32 v3, v55, v55
    v_mfma_f32_16x16x32_bf16 v[12:15], a[108:111], v[84:87], v[12:15]
    v_mfma_f32_16x16x32_bf16 v[12:15], a[112:115], v[68:71], v[12:15]
    v_mfma_f32_16x16x32_bf16 v[12:15], a[116:119], v[64:67], v[12:15]
    s_sub_u32 s50, s45, s44
    v_add_u32 v135, s48, v135
    v_add_u32 v134, s48, v134
    v_mfma_f32_16x16x32_bf16 v[48:51], a[120:123], v[104:107], 0
    s_sub_u32 s51, s46, s47
    v_add_u32 v133, s51, v133
    v_mfma_f32_16x16x32_bf16 v[48:51], a[124:127], v[100:103], v[48:51]
    s_mov_b32 s60, s59
    v_fmac_f32 v3, v12, v12
    v_fmac_f32 v3, v13, v13
    v_mfma_f32_16x16x32_bf16 v[48:51], a[128:131], v[44:47], v[48:51]
    s_mov_b32 s59, s58
    v_fmac_f32 v3, v14, v14
    v_fmac_f32 v3, v15, v15
    v_mfma_f32_16x16x32_bf16 v[48:51], a[132:135], v[84:87], v[48:51]
    s_mov_b32 s58, s57
    v_mfma_f32_16x16x32_bf16 v[48:51], a[136:139], v[68:71], v[48:51]
    s_mov_b32 s57, s56
    v_mfma_f32_16x16x32_bf16 v[48:51], a[140:143], v[64:67], v[48:51]
    s_mov_b32 s7, s6
    s_nop 0
    v_mfma_f32_16x16x32_bf16 v[24:27], v[104:107], a[144:147], 0
    s_mov_b32 s6, s5
    s_nop 1
    v_mfma_f32_16x16x32_bf16 v[24:27], v[100:103], a[148:151], v[24:27]
    s_mov_b32 s5, s4
    v_fmac_f32 v3, v48, v48
    v_fmac_f32 v3, v49, v49
    v_mfma_f32_16x16x32_bf16 v[24:27], v[44:47], a[152:155], v[24:27]
    s_sub_u32 s14, s6, s7
    v_fmac_f32 v3, v50, v50
    v_fmac_f32 v3, v51, v51
    v_mfma_f32_16x16x32_bf16 v[24:27], v[84:87], a[156:159], v[24:27]
    s_add_u32 s61, s61, 1
    v_cvt_pk_bf16_f32 v170, v2, v3
    v_add_u32 v132, s14, v132
    v_mfma_f32_16x16x32_bf16 v[24:27], v[68:71], a[160:163], v[24:27]
    s_ff1_i32_b32 s15, s66
    ds_read_b128 v[96:99], v137 offset:3072
    v_add_u32 v131, s14, v131
    v_mfma_f32_16x16x32_bf16 v[24:27], v[64:67], a[164:167], v[24:27]
    s_cmp_lg_u32 s66, 0
    ds_read_b128 v[92:95], v136 offset:3072
    v_add_u32 v123, s14, v123
    v_mfma_f32_16x16x16_bf16 v[40:43], v[216:217], v[170:171], 0
    s_cselect_b32 s12, s15, s12
    ds_read_b128 v[88:91], v137 offset:3200
    s_nop 1
    v_cvt_pk_bf16_f32 v2, v24, v25
    v_mfma_f32_16x16x32_bf16 v[72:75], v[104:107], a[168:171], 0
    s_cmp_lt_u32 s61, s71
    ds_read_b128 v[80:83], v136 offset:3200
    v_cvt_pk_bf16_f32 v3, v26, v27
    v_mfma_f32_16x16x32_bf16 v[72:75], v[100:103], a[172:175], v[72:75]
    s_cselect_b32 s15, 31, s15
    ds_read_b128 v[56:59], v137 offset:3328
    v_add_u32 v137, s50, v137
    v_mfma_f32_16x16x32_bf16 v[72:75], v[44:47], a[176:179], v[72:75]
    s_bitset0_b32 s66, s15
    ds_read_b128 v[24:27], v136 offset:3328
    v_add_u32 v136, s50, v136
    v_mfma_f32_16x16x32_bf16 v[72:75], v[84:87], a[180:183], v[72:75]
    s_add_u32 s12, s12, 20
    v_rsq_f32 v40, v40
    v_mfma_f32_16x16x32_bf16 v[72:75], v[68:71], a[184:187], v[72:75]
    s_max_u32 s12, s12, s61
    v_rsq_f32 v41, v41
    v_mfma_f32_16x16x32_bf16 v[72:75], v[64:67], a[188:191], v[72:75]
    s_cmp_lt_u32 s61, s71
    v_mul_f32 v40, s55, v40
    v_mul_f32 v41, 0.5, v41
    v_mfma_f32_16x16x32_bf16 v[32:35], v[104:107], a[192:195], 0
    s_cselect_b32 s15, s61, s12
    v_mul_f32 v16, v16, v40
    v_mul_f32 v17, v17, v40
    v_mfma_f32_16x16x32_bf16 v[32:35], v[100:103], a[196:199], v[32:35]
    s_cselect_b32 s56, s69, s70
    v_cvt_pk_bf16_f32 v10, v72, v73
    v_cvt_pk_bf16_f32 v11, v74, v75
    v_mfma_f32_16x16x32_bf16 v[32:35], v[44:47], a[200:203], v[32:35]
    s_add_u32 s56, s56, s15
    v_cvt_pk_f16_f32 v44, v16, v17
    v_mul_f32 v18, v18, v40
    v_mfma_f32_16x16x32_bf16 v[32:35], v[84:87], a[204:207], v[32:35]
    s_mul_i32 s53, s56, 58255
    v_mul_f32 v19, v19, v40
    v_cvt_pk_f16_f32 v45, v18, v19
    v_mfma_f32_16x16x32_bf16 v[32:35], v[68:71], a[208:211], v[32:35]
    s_waitcnt lgkmcnt(0)
    s_lshr_b32 s53, s53, 22
    v_mul_f32 v60, v60, v40
    v_mul_f32 v61, v61, v40
    v_mfma_f32_16x16x32_bf16 v[32:35], v[64:67], a[212:215], v[32:35]
    s_barrier
    v_cvt_pk_f16_f32 v46, v60, v61
    v_mul_f32 v62, v62, v40
    v_mfma_f32_16x16x32_bf16 v[16:19], a[0:3], v[96:99], 0
    s_mul_i32 s53, s53, s63
    v_mul_f32 v63, v63, v40
    v_cvt_pk_f16_f32 v47, v62, v63
    v_mfma_f32_16x16x32_bf16 v[16:19], a[4:7], v[92:95], v[16:19]
    s_mul_i32 s56, s56, s62
    v_mul_f32 v36, v36, v40
    v_mul_f32 v37, v37, v40
    v_mfma_f32_16x16x32_bf16 v[16:19], a[8:11], v[88:91], v[16:19]
    s_add_u32 s56, s56, s53
    v_cvt_pk_f16_f32 v146, v36, v37
    v_mul_f32 v38, v38, v40
    v_mfma_f32_16x16x32_bf16 v[16:19], a[12:15], v[80:83], v[16:19]
    s_mul_i32 s4, s15, 112
    v_mul_f32 v39, v39, v40
    v_cvt_pk_f16_f32 v147, v38, v39
    v_mfma_f32_16x16x32_bf16 v[16:19], a[16:19], v[56:59], v[16:19]
    s_cmp_ge_u32 s15, 16
    v_mul_f32 v52, v52, v41
    v_mul_f32 v53, v53, v41
    v_mfma_f32_16x16x32_bf16 v[16:19], a[20:23], v[24:27], v[16:19]
    s_cselect_b32 s53, -30464, 0
    v_cvt_pk_f16_f32 v72, v52, v53
    v_mul_f32 v54, v54, v41
    v_mfma_f32_16x16x32_bf16 v[36:39], a[24:27], v[96:99], 0
    s_add_u32 s4, s4, s53
    v_mul_f32 v55, v55, v41
    v_cvt_pk_f16_f32 v73, v54, v55
    v_mfma_f32_16x16x32_bf16 v[36:39], a[28:31], v[92:95], v[36:39]
    s_cmp_lt_u32 s15, s73
    v_mul_f32 v12, v12, v41
    v_mul_f32 v13, v13, v41
    v_mfma_f32_16x16x32_bf16 v[36:39], a[32:35], v[88:91], v[36:39]
    s_cselect_b32 s26, 100270464, 0
    v_cvt_pk_f16_f32 v74, v12, v13
    v_mul_f32 v14, v14, v41
    v_mfma_f32_16x16x32_bf16 v[36:39], a[36:39], v[80:83], v[36:39]
    s_cselect_b32 s56, s56, 0
    v_mul_f32 v15, v15, v41
    v_cvt_pk_f16_f32 v75, v14, v15
    v_mfma_f32_16x16x32_bf16 v[36:39], a[40:43], v[56:59], v[36:39]
    s_cselect_b32 s4, s4, -1
    v_mul_f32 v48, v48, v41
    v_mul_f32 v49, v49, v41
    v_mfma_f32_16x16x32_bf16 v[36:39], a[44:47], v[24:27], v[36:39]
    s_cselect_b32 s15, s15, 0
    v_cvt_pk_f16_f32 v148, v48, v49
    v_mul_f32 v50, v50, v41
    v_mfma_f32_16x16x32_bf16 v[12:15], a[48:51], v[96:99], 0
    s_cselect_b32 s13, s13, -1
    v_mul_f32 v51, v51, v41
    v_cvt_pk_f16_f32 v149, v50, v51
    v_mfma_f32_16x16x32_bf16 v[12:15], a[52:55], v[92:95], v[12:15]
    s_bitset1_b32 s64, s15
    v_cvt_pk_bf16_f32 v22, v32, v33
    v_cvt_pk_bf16_f32 v23, v34, v35
    v_mfma_f32_16x16x32_bf16 v[12:15], a[56:59], v[88:91], v[12:15]
    s_add_u32 s65, s65, 1
    v_fma_f32 v156, v16, v16, s41
    v_fmac_f32 v156, v17, v17
    v_mfma_f32_16x16x32_bf16 v[12:15], a[60:63], v[80:83], v[12:15]
    s_cmp_ge_i32 s65, 2
    v_fmac_f32 v156, v18, v18
    v_fmac_f32 v156, v19, v19
    v_mfma_f32_16x16x32_bf16 v[12:15], a[64:67], v[56:59], v[12:15]
    s_cselect_b32 s30, 100270464, 0
    v_fmac_f32 v156, v36, v36
    v_fmac_f32 v156, v37, v37
    v_mfma_f32_16x16x32_bf16 v[12:15], a[68:71], v[24:27], v[12:15]
    s_add_u32 s67, s46, s54
    v_fmac_f32 v156, v38, v38
    v_fmac_f32 v156, v39, v39
    v_mfma_f32_16x16x32_bf16 v[64:67], a[72:75], v[96:99], 0
    s_add_u32 m0, s67, 0
    v_and_b32 v120, -8, v123
    v_mfma_f32_16x16x32_bf16 v[64:67], a[76:79], v[92:95], v[64:67]
    buffer_load_dwordx4 v128, s[24:27], s56 offen nt lds
    v_fmac_f32 v156, v12, v12
    v_mfma_f32_16x16x32_bf16 v[64:67], a[80:83], v[88:91], v[64:67]
    s_add_u32 m0, s67, 1024
    v_fmac_f32 v156, v13, v13
    v_fmac_f32 v156, v14, v14
    v_mfma_f32_16x16x32_bf16 v[64:67], a[84:87], v[80:83], v[64:67]
    buffer_load_dwordx4 v127, s[24:27], s56 offen nt lds
    v_fmac_f32 v156, v15, v15
    v_mfma_f32_16x16x32_bf16 v[64:67], a[88:91], v[56:59], v[64:67]
    s_add_u32 m0, s67, 2048
    v_mfma_f32_16x16x32_bf16 v[64:67], a[92:95], v[24:27], v[64:67]
    buffer_load_dwordx4 v126, s[24:27], s56 offen nt lds
    v_mfma_f32_16x16x32_bf16 v[32:35], a[96:99], v[96:99], 0
    s_add_u32 m0, s67, 3072
    s_nop 1
    v_mfma_f32_16x16x32_bf16 v[32:35], a[100:103], v[92:95], v[32:35]
    s_nop 0
    buffer_load_dwordx4 v125, s[24:27], s56 offen nt lds
    v_fma_f32 v121, v64, v64, s41
    v_mfma_f32_16x16x32_bf16 v[32:35], a[104:107], v[88:91], v[32:35]
    s_add_u32 m0, s67, 4096
    v_fmac_f32 v121, v65, v65
    v_fmac_f32 v121, v66, v66
    v_mfma_f32_16x16x32_bf16 v[32:35], a[108:111], v[80:83], v[32:35]
    buffer_load_dwordx4 v124, s[24:27], s56 offen nt lds
    v_fmac_f32 v121, v67, v67
    v_mfma_f32_16x16x32_bf16 v[32:35], a[112:115], v[56:59], v[32:35]
    v_mfma_f32_16x16x32_bf16 v[32:35], a[116:119], v[24:27], v[32:35]
    s_nop 1
    v_mfma_f32_16x16x32_bf16 v[40:43], a[120:123], v[96:99], 0
    s_nop 2
    v_mfma_f32_16x16x32_bf16 v[40:43], a[124:127], v[92:95], v[40:43]
    s_mov_b32 s53, s47
    v_fmac_f32 v121, v32, v32
    v_fmac_f32 v121, v33, v33
    v_mfma_f32_16x16x32_bf16 v[40:43], a[128:131], v[88:91], v[40:43]
    s_mov_b32 s47, s46
    v_fmac_f32 v121, v34, v34
    v_fmac_f32 v121, v35, v35
    v_mfma_f32_16x16x32_bf16 v[40:43], a[132:135], v[80:83], v[40:43]
    s_mov_b32 s46, s45
    v_mfma_f32_16x16x32_bf16 v[40:43], a[136:139], v[56:59], v[40:43]
    s_mov_b32 s45, s44
    v_mfma_f32_16x16x32_bf16 v[40:43], a[140:143], v[24:27], v[40:43]
    s_mov_b32 s44, s53
    s_nop 0
    v_mfma_f32_16x16x32_bf16 v[68:71], v[96:99], a[144:147], 0
    s_sub_u32 s48, s44, s46
    v_add_u32 v137, s48, v137
    v_add_u32 v136, s48, v136
    v_mfma_f32_16x16x32_bf16 v[68:71], v[92:95], a[148:151], v[68:71]
    s_sub_u32 s49, s46, s45
    v_fmac_f32 v121, v40, v40
    v_fmac_f32 v121, v41, v41
    v_mfma_f32_16x16x32_bf16 v[68:71], v[88:91], a[152:155], v[68:71]
    v_fmac_f32 v121, v42, v42
    v_fmac_f32 v121, v43, v43
    v_mfma_f32_16x16x32_bf16 v[68:71], v[80:83], a[156:159], v[68:71]
    v_cvt_pk_bf16_f32 v170, v156, v121
    v_mfma_f32_16x16x32_bf16 v[68:71], v[56:59], a[160:163], v[68:71]
    ds_read_b128 v[60:63], v132 offset:0
    v_mfma_f32_16x16x32_bf16 v[68:71], v[24:27], a[164:167], v[68:71]
    s_nop 0
    ds_read_b128 v[52:55], v132 offset:16
    s_nop 0
    v_mfma_f32_16x16x16_bf16 v[76:79], v[216:217], v[170:171], 0
    s_nop 0
    ds_read_b128 v[48:51], v132 offset:48
    s_nop 1
    v_cvt_pk_bf16_f32 v164, v68, v69
    v_mfma_f32_16x16x32_bf16 v[84:87], v[96:99], a[168:171], 0
    v_cvt_pk_bf16_f32 v165, v70, v71
    v_mfma_f32_16x16x32_bf16 v[84:87], v[92:95], a[172:175], v[84:87]
    v_rsq_f32 v76, v76
    v_mfma_f32_16x16x32_bf16 v[84:87], v[88:91], a[176:179], v[84:87]
    v_rsq_f32 v77, v77
    v_mfma_f32_16x16x32_bf16 v[84:87], v[80:83], a[180:183], v[84:87]
    v_mul_f32 v76, s55, v76
    v_mul_f32 v77, 0.5, v77
    v_mfma_f32_16x16x32_bf16 v[84:87], v[56:59], a[184:187], v[84:87]
    v_mul_f32 v64, v64, v77
    v_mul_f32 v65, v65, v77
    v_mfma_f32_16x16x32_bf16 v[84:87], v[24:27], a[188:191], v[84:87]
    v_cvt_pk_f16_f32 v64, v64, v65
    v_mul_f32 v66, v66, v77
    v_mfma_f32_16x16x32_bf16 v[68:71], v[96:99], a[192:195], 0
    s_nop 0
    v_mul_f32 v67, v67, v77
    v_cvt_pk_f16_f32 v65, v66, v67
    v_mfma_f32_16x16x32_bf16 v[68:71], v[92:95], a[196:199], v[68:71]
    s_nop 0
    v_cvt_pk_bf16_f32 v160, v84, v85
    v_cvt_pk_bf16_f32 v161, v86, v87
    v_mfma_f32_16x16x32_bf16 v[68:71], v[88:91], a[200:203], v[68:71]
    v_mul_f32 v32, v32, v77
    v_mul_f32 v33, v33, v77
    v_mfma_f32_16x16x32_bf16 v[68:71], v[80:83], a[204:207], v[68:71]
    v_cvt_pk_f16_f32 v66, v32, v33
    v_mul_f32 v34, v34, v77
    v_mfma_f32_16x16x32_bf16 v[68:71], v[56:59], a[208:211], v[68:71]
    v_mul_f32 v35, v35, v77
    v_cvt_pk_f16_f32 v67, v34, v35
    v_mfma_f32_16x16x32_bf16 v[68:71], v[24:27], a[212:215], v[68:71]
    v_mul_f32 v40, v40, v77
    v_mul_f32 v41, v41, v77
    v_mfma_f32_16x16x32_f16 v[32:35], v[28:31], v[4:7], v[204:207]
    ds_read_u16 v166, v131 offset:80
    v_cvt_pk_f16_f32 v142, v40, v41
    v_mfma_f32_16x16x32_f16 v[32:35], v[152:155], v[150:153], v[32:35]
    ds_read_u16 v162, v131 offset:96
    v_mul_f32 v42, v42, v77
    v_mfma_f32_16x16x32_f16 v[24:27], v[72:75], v[4:7], v[200:203]
    ds_read_u16 v158, v131 offset:104
    v_mul_f32 v43, v43, v77
    v_mfma_f32_16x16x32_f16 v[24:27], v[146:149], v[150:153], v[24:27]
    s_waitcnt lgkmcnt(3)
    ds_read_b32 v120, v120 offset:64
    v_cvt_pk_f16_f32 v143, v42, v43
    v_mfma_f32_16x16x32_f16 v[56:59], v[60:63], v[4:7], v[208:211]
    v_mul_f32 v16, v16, v76
    v_mul_f32 v17, v17, v76
    v_mfma_f32_16x16x32_f16 v[56:59], v[52:55], v[28:31], v[56:59]
    v_cvt_pk_f16_f32 v16, v16, v17
    v_mul_f32 v18, v18, v76
    v_mfma_f32_16x16x32_f16 v[56:59], v[48:51], v[152:155], v[56:59]
    v_mul_f32 v19, v19, v76
    v_cvt_pk_f16_f32 v17, v18, v19
    v_mfma_f32_16x16x32_f16 v[40:43], v[60:63], v[44:47], v[208:211]
    v_mul_f32 v36, v36, v76
    v_mul_f32 v37, v37, v76
    v_mfma_f32_16x16x32_f16 v[40:43], v[52:55], v[72:75], v[40:43]
    v_cvt_pk_f16_f32 v18, v36, v37
    v_mul_f32 v38, v38, v76
    v_mfma_f32_16x16x32_f16 v[40:43], v[48:51], v[146:149], v[40:43]
    v_mul_f32 v39, v39, v76
    v_cvt_pk_f16_f32 v19, v38, v39
    v_mfma_f32_16x16x32_f16 v[36:39], v[28:31], v[44:47], v[192:195]
    v_mul_f32 v12, v12, v76
    v_mul_f32 v13, v13, v76
    v_mfma_f32_16x16x32_f16 v[36:39], v[152:155], v[144:147], v[36:39]
    v_cvt_pk_f16_f32 v140, v12, v13
    v_mul_f32 v14, v14, v76
    v_mul_f32 v15, v15, v76
    v_cvt_pk_f16_f32 v141, v14, v15
    v_mfma_f32_16x16x32_f16 v[12:15], v[64:67], v[4:7], v[196:199]
    v_cvt_pk_bf16_f32 v156, v68, v69
    v_cvt_pk_bf16_f32 v157, v70, v71
    v_mfma_f32_16x16x32_f16 v[12:15], v[140:143], v[150:153], v[12:15]
    v_max3_f32 v121, v32, v33, v34
    v_max3_f32 v121, v121, v35, v24
    v_mfma_f32_16x16x32_f16 v[4:7], v[60:63], v[16:19], v[208:211]
    s_nop 0
    v_max3_f32 v121, v121, v25, v26
    v_mov_b32_dpp v59, v43 quad_perm:[0,1,2,3] row_mask:0x2 bank_mask:0xf
    v_mfma_f32_16x16x32_f16 v[4:7], v[52:55], v[64:67], v[4:7]
    s_nop 0
    v_max3_f32 v121, v121, v27, v12
    v_max3_f32 v121, v121, v13, v14
    v_mfma_f32_16x16x32_f16 v[4:7], v[48:51], v[140:143], v[4:7]
    v_max3_f32 v121, v121, v15, v56
    v_mov_b32 v57, v121
    v_mfma_f32_16x16x32_f16 v[52:55], v[72:75], v[44:47], v[188:191]
    s_nop 0
    v_permlane32_swap_b32 v57, v121
    v_mfma_f32_16x16x32_f16 v[52:55], v[146:149], v[144:147], v[52:55]
    v_max_f32 v121, v57, v121
    v_mov_b32 v57, v121
    v_mfma_f32_16x16x32_f16 v[48:51], v[64:67], v[44:47], v[184:187]
    s_nop 0
    v_permlane16_swap_b32 v57, v121
    v_mfma_f32_16x16x32_f16 v[48:51], v[140:143], v[144:147], v[48:51]
    v_max_f32 v121, v57, v121
    v_sub_f32 v32, v32, v121
    v_sub_f32 v33, v33, v121
    v_sub_f32 v34, v34, v121
    v_sub_f32 v35, v35, v121
    v_sub_f32 v24, v24, v121
    v_sub_f32 v25, v25, v121
    v_sub_f32 v26, v26, v121
    v_sub_f32 v27, v27, v121
    v_sub_f32 v12, v12, v121
    v_sub_f32 v13, v13, v121
    v_sub_f32 v14, v14, v121
    v_sub_f32 v15, v15, v121
    v_sub_f32 v56, v56, v121
    v_exp_f32 v32, v32
    v_exp_f32 v33, v33
    v_exp_f32 v34, v34
    v_exp_f32 v35, v35
    v_cvt_pk_bf16_f32 v60, v32, v33
    v_cvt_pk_bf16_f32 v61, v34, v35
    v_exp_f32 v24, v24
    v_exp_f32 v25, v25
    v_exp_f32 v26, v26
    v_exp_f32 v27, v27
    v_cvt_pk_bf16_f32 v62, v24, v25
    v_cvt_pk_bf16_f32 v63, v26, v27
    v_exp_f32 v12, v12
    v_exp_f32 v13, v13
    v_exp_f32 v14, v14
    v_exp_f32 v15, v15
    v_cvt_pk_bf16_f32 v168, v12, v13
    v_cvt_pk_bf16_f32 v169, v14, v15
    v_exp_f32 v56, v56
    v_mov_b32_dpp v59, v7 quad_perm:[0,1,2,3] row_mask:0x4 bank_mask:0xf
    v_cvt_pk_bf16_f32 v170, v56, 0
    v_mfma_f32_16x16x32_bf16 v[44:47], v[220:223], v[60:63], 0
    s_waitcnt lgkmcnt(0)
    v_and_b32 v121, 0xffff0000, v120
    v_lshlrev_b32 v120, 16, v120
    v_mfma_f32_16x16x32_bf16 v[44:47], v[220:223], v[168:171], v[44:47]
    v_add_f32 v120, v120, v121
    v_add_f32 v120, v120, v211
    v_mfma_f32_16x16x32_bf16 v[12:15], v[0:3], v[60:63], 0
    s_nop 0
    v_mov_b32_dpp v59, v120 quad_perm:[0,1,2,3] row_mask:0x8 bank_mask:0xf
    v_mov_b32 v4, v59
    v_mfma_f32_16x16x32_bf16 v[12:15], v[164:167], v[168:171], v[12:15]
    s_nop 0
    v_max_f32_dpp v4, v4, v4 row_ror:8 row_mask:0xf bank_mask:0xf
    v_max3_f32 v121, v36, v37, v38
    v_mfma_f32_16x16x32_bf16 v[24:27], v[8:11], v[60:63], 0
    v_max_f32_dpp v4, v4, v4 row_ror:4 row_mask:0xf bank_mask:0xf
    v_max3_f32 v121, v121, v39, v52
    v_mfma_f32_16x16x32_bf16 v[24:27], v[160:163], v[168:171], v[24:27]
    v_max_f32_dpp v4, v4, v4 row_ror:2 row_mask:0xf bank_mask:0xf
    v_max3_f32 v121, v121, v53, v54
    v_mfma_f32_16x16x32_bf16 v[32:35], v[20:23], v[60:63], 0
    v_max_f32_dpp v4, v4, v4 row_ror:1 row_mask:0xf bank_mask:0xf
    v_mov_b32 v120, v4
    v_mfma_f32_16x16x32_bf16 v[32:35], v[156:159], v[168:171], v[32:35]
    s_nop 0
    v_permlane32_swap_b32 v120, v4
    v_max_f32 v4, v120, v4
    v_mov_b32 v120, v4
    v_rcp_f32 v44, v44
    v_max3_f32 v121, v121, v55, v48
    v_permlane16_swap_b32 v120, v4
    v_max_f32 v4, v120, v4
    v_sub_f32 v59, v59, v4
    v_exp_f32 v59, v59
    v_mul_f32 v12, v12, v44
    v_cvt_pk_bf16_f32 v59, v59, v59
    ds_write_b16 v123, v59 offset:64
    v_mul_f32 v13, v13, v44
    v_cvt_pk_bf16_f32 v68, v12, v13
    ds_read_b128 v[60:63], v132 offset:48
    v_mul_f32 v14, v14, v44
    v_mul_f32 v15, v15, v44
    v_cvt_pk_bf16_f32 v69, v14, v15
    ds_read_b128 v[56:59], v132 offset:64
    v_mfma_f32_16x16x32_f16 v[12:15], v[28:31], v[16:19], v[180:183]
    v_mul_f32 v24, v24, v44
    v_mul_f32 v25, v25, v44
    v_mfma_f32_16x16x32_f16 v[12:15], v[152:155], v[138:141], v[12:15]
    ds_write_b64 v135, v[68:69] offset:0
    v_mfma_f32_16x16x32_f16 v[28:31], v[72:75], v[16:19], v[176:179]
    v_cvt_pk_bf16_f32 v70, v24, v25
    v_mul_f32 v26, v26, v44
    v_mfma_f32_16x16x32_f16 v[28:31], v[146:149], v[138:141], v[28:31]
    v_mul_f32 v27, v27, v44
    v_cvt_pk_bf16_f32 v71, v26, v27
    v_mfma_f32_16x16x32_f16 v[24:27], v[64:67], v[16:19], v[172:175]
    ds_write_b64 v135, v[70:71] offset:8
    v_mfma_f32_16x16x32_f16 v[24:27], v[140:143], v[138:141], v[24:27]
    s_waitcnt lgkmcnt(3)
    v_mul_f32 v32, v32, v44
    v_mul_f32 v33, v33, v44
    v_cvt_pk_bf16_f32 v146, v32, v33
    v_mul_f32 v34, v34, v44
    v_mfma_f32_16x16x32_bf16 v[16:19], v[60:63], v[0:3], 0
    s_waitcnt lgkmcnt(2)
    v_mul_f32 v35, v35, v44
    v_cvt_pk_bf16_f32 v147, v34, v35
    v_max3_f32 v121, v121, v49, v50
    v_max3_f32 v121, v121, v51, v41
    v_mfma_f32_16x16x32_bf16 v[16:19], v[56:59], v[164:167], v[16:19]
    ds_write_b64 v134, v[146:147] offset:0
    v_mfma_f32_16x16x32_bf16 v[44:47], v[60:63], v[8:11], 0
    v_mov_b32 v146, v121
    v_max3_f32 v120, v12, v13, v14
    v_mfma_f32_16x16x32_bf16 v[44:47], v[56:59], v[160:163], v[44:47]
    v_permlane32_swap_b32 v146, v121
    v_mfma_f32_16x16x32_bf16 v[32:35], v[60:63], v[20:23], 0
    v_max_f32 v121, v146, v121
    v_mov_b32 v146, v121
    v_mfma_f32_16x16x32_bf16 v[32:35], v[56:59], v[156:159], v[32:35]
    s_nop 0
    v_permlane16_swap_b32 v146, v121
    v_max_f32 v121, v146, v121
    v_sub_f32 v36, v36, v121
    v_sub_f32 v37, v37, v121
    v_sub_f32 v38, v38, v121
    v_sub_f32 v39, v39, v121
    v_sub_f32 v52, v52, v121
    v_sub_f32 v53, v53, v121
    v_sub_f32 v54, v54, v121
    v_sub_f32 v55, v55, v121
    v_sub_f32 v48, v48, v121
    v_sub_f32 v49, v49, v121
    v_sub_f32 v50, v50, v121
    v_sub_f32 v51, v51, v121
    v_sub_f32 v41, v41, v121
    v_exp_f32 v36, v36
    v_exp_f32 v37, v37
    v_exp_f32 v38, v38
    v_exp_f32 v39, v39
    v_cvt_pk_bf16_f32 v36, v36, v37
    v_cvt_pk_bf16_f32 v37, v38, v39
    v_exp_f32 v52, v52
    v_exp_f32 v53, v53
    v_exp_f32 v54, v54
    v_exp_f32 v55, v55
    v_cvt_pk_bf16_f32 v38, v52, v53
    v_cvt_pk_bf16_f32 v39, v54, v55
    v_exp_f32 v48, v48
    v_exp_f32 v49, v49
    v_exp_f32 v50, v50
    v_exp_f32 v51, v51
    v_cvt_pk_bf16_f32 v168, v48, v49
    v_cvt_pk_bf16_f32 v169, v50, v51
    v_exp_f32 v41, v41
    v_mov_b32_dpp v19, v47 quad_perm:[0,1,2,3] row_mask:0x2 bank_mask:0xf
    v_cvt_pk_bf16_f32 v170, v41, 0
    v_mfma_f32_16x16x32_bf16 v[44:47], v[220:223], v[36:39], 0
    v_mov_b32_dpp v19, v35 quad_perm:[0,1,2,3] row_mask:0x4 bank_mask:0xf
    v_cvt_pk_bf16_f32 v19, v19, v19
    v_mfma_f32_16x16x32_bf16 v[44:47], v[220:223], v[168:171], v[44:47]
    ds_write_b16 v131, v19
    v_mfma_f32_16x16x32_bf16 v[32:35], v[0:3], v[36:39], 0
    ds_read_b128 v[16:19], v137 offset:0
    v_max3_f32 v120, v120, v15, v28
    v_mfma_f32_16x16x32_bf16 v[32:35], v[164:167], v[168:171], v[32:35]
    ds_read_b128 v[146:149], v136 offset:0
    v_max3_f32 v120, v120, v29, v30
    v_mfma_f32_16x16x32_bf16 v[48:51], v[8:11], v[36:39], 0
    ds_read_b128 v[72:75], v137 offset:128
    v_max3_f32 v120, v120, v31, v24
    v_mfma_f32_16x16x32_bf16 v[48:51], v[160:163], v[168:171], v[48:51]
    ds_read_b128 v[88:91], v136 offset:128
    v_max3_f32 v120, v120, v25, v26
    v_mfma_f32_16x16x32_bf16 v[40:43], v[20:23], v[36:39], 0
    ds_read_b128 v[76:79], v137 offset:256
    v_max3_f32 v120, v120, v27, v6
    v_mfma_f32_16x16x32_bf16 v[40:43], v[156:159], v[168:171], v[40:43]
    ds_read_b128 v[56:59], v136 offset:256
    v_mov_b32 v121, v120
    v_rcp_f32 v44, v44
    s_nop 0
    v_mul_f32 v32, v32, v44
    v_mul_f32 v33, v33, v44
    v_cvt_pk_bf16_f32 v32, v32, v33
    v_mul_f32 v34, v34, v44
    v_mul_f32 v35, v35, v44
    v_cvt_pk_bf16_f32 v33, v34, v35
    v_mul_f32 v48, v48, v44
    v_mul_f32 v49, v49, v44
    v_cvt_pk_bf16_f32 v34, v48, v49
    v_mul_f32 v50, v50, v44
    s_waitcnt lgkmcnt(5)
    v_mfma_f32_16x16x32_bf16 v[36:39], a[0:3], v[16:19], 0
    ds_write_b64 v135, v[32:33] offset:1536
    v_mul_f32 v51, v51, v44
    v_cvt_pk_bf16_f32 v35, v50, v51
    v_mul_f32 v40, v40, v44
    v_mul_f32 v41, v41, v44
    v_cvt_pk_bf16_f32 v4, v40, v41
    v_mul_f32 v42, v42, v44
    v_mul_f32 v43, v43, v44
    v_cvt_pk_bf16_f32 v5, v42, v43
    ds_write_b64 v135, v[34:35] offset:1544
    v_permlane32_swap_b32 v121, v120
    v_max_f32 v120, v121, v120
    v_mov_b32 v121, v120
    s_nop 0
    ds_write_b64 v134, v[4:5] offset:1536
    v_permlane16_swap_b32 v121, v120
    v_max_f32 v120, v121, v120
    v_sub_f32 v12, v12, v120
    v_sub_f32 v13, v13, v120
    v_sub_f32 v14, v14, v120
    v_sub_f32 v15, v15, v120
    v_sub_f32 v28, v28, v120
    v_sub_f32 v29, v29, v120
    v_sub_f32 v30, v30, v120
    v_sub_f32 v31, v31, v120
    v_sub_f32 v24, v24, v120
    v_sub_f32 v25, v25, v120
    v_sub_f32 v26, v26, v120
    v_sub_f32 v27, v27, v120
    v_sub_f32 v6, v6, v120
    v_exp_f32 v12, v12
    v_exp_f32 v13, v13
    v_exp_f32 v14, v14
    v_exp_f32 v15, v15
    v_cvt_pk_bf16_f32 v12, v12, v13
    v_cvt_pk_bf16_f32 v13, v14, v15
    v_exp_f32 v28, v28
    v_exp_f32 v29, v29
    v_exp_f32 v30, v30
    v_exp_f32 v31, v31
    v_cvt_pk_bf16_f32 v14, v28, v29
    v_cvt_pk_bf16_f32 v15, v30, v31
    v_exp_f32 v24, v24
    v_exp_f32 v25, v25
    v_exp_f32 v26, v26
    v_exp_f32 v27, v27
    v_cvt_pk_bf16_f32 v168, v24, v25
    v_cvt_pk_bf16_f32 v169, v26, v27
    v_exp_f32 v6, v6
    s_nop 0
    v_cvt_pk_bf16_f32 v170, v6, 0
    v_mfma_f32_16x16x32_bf16 v[152:155], v[220:223], v[12:15], 0
    s_nop 0
    v_mfma_f32_16x16x32_bf16 v[152:155], v[220:223], v[168:171], v[152:155]
    s_nop 1
    v_mfma_f32_16x16x32_bf16 v[4:7], v[0:3], v[12:15], 0
    s_nop 2
    v_mfma_f32_16x16x32_bf16 v[4:7], v[164:167], v[168:171], v[4:7]
    s_nop 0
    v_rcp_f32 v152, v152
    v_mfma_f32_16x16x32_bf16 v[0:3], v[8:11], v[12:15], 0
    s_nop 2
    v_mfma_f32_16x16x32_bf16 v[0:3], v[160:163], v[168:171], v[0:3]
    s_nop 0
    v_mul_f32 v4, v4, v152
    v_mul_f32 v5, v5, v152
    v_mfma_f32_16x16x32_bf16 v[8:11], v[20:23], v[12:15], 0
    v_cvt_pk_bf16_f32 v12, v4, v5
    v_mul_f32 v6, v6, v152
    v_mfma_f32_16x16x32_bf16 v[8:11], v[156:159], v[168:171], v[8:11]
    v_mul_f32 v7, v7, v152
    v_cvt_pk_bf16_f32 v13, v6, v7
    s_waitcnt lgkmcnt(0)
.p2align 6
L_loopS0:
    v_mfma_f32_16x16x32_bf16 v[36:39], a[4:7], v[146:149], v[36:39]
    ds_write_b64 v135, v[12:13] offset:3072
    v_mfma_f32_16x16x32_bf16 v[36:39], a[8:11], v[72:75], v[36:39]
    v_mul_f32 v0, v0, v152
    v_mul_f32 v1, v1, v152
    v_mfma_f32_16x16x32_bf16 v[36:39], a[12:15], v[88:91], v[36:39]
    v_cvt_pk_bf16_f32 v14, v0, v1
    v_mul_f32 v2, v2, v152
    v_mfma_f32_16x16x32_bf16 v[36:39], a[16:19], v[76:79], v[36:39]
    v_mul_f32 v3, v3, v152
    v_cvt_pk_bf16_f32 v15, v2, v3
    v_mfma_f32_16x16x32_bf16 v[36:39], a[20:23], v[56:59], v[36:39]
    ds_write_b64 v135, v[14:15] offset:3080
    v_mfma_f32_16x16x32_bf16 v[12:15], a[24:27], v[16:19], 0
    v_mul_f32 v8, v8, v152
    v_mul_f32 v9, v9, v152
    v_mfma_f32_16x16x32_bf16 v[12:15], a[28:31], v[146:149], v[12:15]
    v_cvt_pk_bf16_f32 v8, v8, v9
    v_mul_f32 v10, v10, v152
    v_mfma_f32_16x16x32_bf16 v[12:15], a[32:35], v[72:75], v[12:15]
    v_mul_f32 v11, v11, v152
    v_cvt_pk_bf16_f32 v9, v10, v11
    v_mfma_f32_16x16x32_bf16 v[12:15], a[36:39], v[88:91], v[12:15]
    ds_write_b64 v134, v[8:9] offset:3072
    v_mfma_f32_16x16x32_bf16 v[12:15], a[40:43], v[76:79], v[12:15]
    v_fma_f32 v170, v40, v40, s42
    v_fmac_f32 v170, v41, v41
    v_mfma_f32_16x16x32_bf16 v[12:15], a[44:47], v[56:59], v[12:15]
    v_fmac_f32 v170, v42, v42
    v_fmac_f32 v170, v43, v43
    v_mfma_f32_16x16x32_bf16 v[152:155], a[48:51], v[16:19], 0
    v_fmac_f32 v170, v140, v140
    v_fmac_f32 v170, v141, v141
    v_mfma_f32_16x16x32_bf16 v[152:155], a[52:55], v[146:149], v[152:155]
    v_fmac_f32 v170, v142, v142
    v_fmac_f32 v170, v143, v143
    v_mfma_f32_16x16x32_bf16 v[152:155], a[56:59], v[72:75], v[152:155]
    s_waitcnt vmcnt(10)
    v_fmac_f32 v170, v44, v44
    v_fmac_f32 v170, v45, v45
    v_mfma_f32_16x16x32_bf16 v[152:155], a[60:63], v[88:91], v[152:155]
    v_fmac_f32 v170, v46, v46
    v_fmac_f32 v170, v47, v47
    v_mfma_f32_16x16x32_bf16 v[152:155], a[64:67], v[76:79], v[152:155]
    v_cvt_pk_bf16_f32 v0, v92, v93
    v_cvt_pk_bf16_f32 v1, v170, v122
    v_mfma_f32_16x16x32_bf16 v[152:155], a[68:71], v[56:59], v[152:155]
    ds_write_b64 v130, v[0:1]
    v_mfma_f32_16x16x32_bf16 v[60:63], a[72:75], v[16:19], 0
    v_add_u32 v135, s49, v135
    v_add_u32 v134, s49, v134
    v_mfma_f32_16x16x32_bf16 v[60:63], a[76:79], v[146:149], v[60:63]
    v_fma_f32 v170, v36, v36, s41
    v_fmac_f32 v170, v37, v37
    v_mfma_f32_16x16x32_bf16 v[60:63], a[80:83], v[72:75], v[60:63]
    v_fmac_f32 v170, v38, v38
    v_fmac_f32 v170, v39, v39
    v_mfma_f32_16x16x32_bf16 v[60:63], a[84:87], v[88:91], v[60:63]
    v_fmac_f32 v170, v12, v12
    v_fmac_f32 v170, v13, v13
    v_mfma_f32_16x16x32_bf16 v[60:63], a[88:91], v[76:79], v[60:63]
    v_fmac_f32 v170, v14, v14
    v_fmac_f32 v170, v15, v15
    v_mfma_f32_16x16x32_bf16 v[60:63], a[92:95], v[56:59], v[60:63]
    v_fmac_f32 v170, v152, v152
    v_fmac_f32 v170, v153, v153
    v_mfma_f32_16x16x32_bf16 v[92:95], a[96:99], v[16:19], 0
    v_fmac_f32 v170, v154, v154
    v_fmac_f32 v170, v155, v155
    v_mfma_f32_16x16x32_bf16 v[92:95], a[100:103], v[146:149], v[92:95]
    s_waitcnt lgkmcnt(0)
    s_nop 0
    v_fma_f32 v0, v60, v60, s41
    v_fmac_f32 v0, v61, v61
    v_mfma_f32_16x16x32_bf16 v[92:95], a[104:107], v[72:75], v[92:95]
    s_barrier
    ds_read_b128 v[8:11], v129 offset:0
    v_fmac_f32 v0, v62, v62
    v_mfma_f32_16x16x32_bf16 v[92:95], a[108:111], v[88:91], v[92:95]
    ds_read_b128 v[64:67], v129 offset:1024
    v_fmac_f32 v0, v63, v63
    v_mfma_f32_16x16x32_bf16 v[92:95], a[112:115], v[76:79], v[92:95]
    v_mfma_f32_16x16x32_bf16 v[92:95], a[116:119], v[56:59], v[92:95]
    s_nop 1
    v_mfma_f32_16x16x32_bf16 v[80:83], a[120:123], v[16:19], 0
    s_nop 2
    v_mfma_f32_16x16x32_bf16 v[80:83], a[124:127], v[146:149], v[80:83]
    s_nop 0
    v_fmac_f32 v0, v92, v92
    v_fmac_f32 v0, v93, v93
    v_mfma_f32_16x16x32_bf16 v[80:83], a[128:131], v[72:75], v[80:83]
    v_fmac_f32 v0, v94, v94
    v_fmac_f32 v0, v95, v95
    v_mfma_f32_16x16x32_bf16 v[80:83], a[132:135], v[88:91], v[80:83]
    v_mfma_f32_16x16x32_bf16 v[80:83], a[136:139], v[76:79], v[80:83]
    v_mfma_f32_16x16x32_bf16 v[80:83], a[140:143], v[56:59], v[80:83]
    s_waitcnt lgkmcnt(1)
    v_readfirstlane_b32 s12, v9
    v_mfma_f32_16x16x32_bf16 v[84:87], v[216:219], v[8:11], 0
    s_waitcnt lgkmcnt(0)
    s_nop 1
    v_mfma_f32_16x16x32_bf16 v[84:87], v[216:219], v[64:67], v[84:87]
    s_lshr_b32 s12, s12, 23
    v_fmac_f32 v0, v80, v80
    v_fmac_f32 v0, v81, v81
    v_mfma_f32_16x16x32_bf16 v[8:11], v[16:19], a[144:147], 0
    v_fmac_f32 v0, v82, v82
    v_fmac_f32 v0, v83, v83
    v_mfma_f32_16x16x32_bf16 v[8:11], v[146:149], a[148:151], v[8:11]
    s_nop 0
    v_rsq_f32 v84, v84
    v_mfma_f32_16x16x32_bf16 v[8:11], v[72:75], a[152:155], v[8:11]
    v_rsq_f32 v85, v85
    v_mfma_f32_16x16x32_bf16 v[8:11], v[88:91], a[156:159], v[8:11]
    v_rsq_f32 v86, v86
    v_mfma_f32_16x16x32_bf16 v[8:11], v[76:79], a[160:163], v[8:11]
    ds_read_b128 v[64:67], v137 offset:1536
    v_mul_f32 v84, s43, v84
    v_mfma_f32_16x16x32_bf16 v[8:11], v[56:59], a[164:167], v[8:11]
    ds_read_b128 v[68:71], v136 offset:1536
    v_mul_f32 v85, s43, v85
    v_mfma_f32_16x16x32_bf16 v[48:51], v[16:19], a[168:171], 0
    ds_read_b128 v[52:55], v137 offset:1664
    v_mul_f32 v86, s43, v86
    v_mfma_f32_16x16x32_bf16 v[48:51], v[146:149], a[172:175], v[48:51]
    ds_read_b128 v[96:99], v136 offset:1664
    v_cvt_pk_bf16_f32 v170, v170, v0
    v_mfma_f32_16x16x32_bf16 v[48:51], v[72:75], a[176:179], v[48:51]
    ds_read_b128 v[108:111], v137 offset:1792
    v_cvt_pk_bf16_f32 v0, v8, v9
    v_mfma_f32_16x16x32_bf16 v[48:51], v[88:91], a[180:183], v[48:51]
    ds_read_b128 v[104:107], v136 offset:1792
    v_cvt_pk_bf16_f32 v1, v10, v11
    v_mfma_f32_16x16x32_bf16 v[48:51], v[76:79], a[184:187], v[48:51]
    v_mul_f32 v32, v32, v84
    v_mul_f32 v33, v33, v84
    v_mfma_f32_16x16x32_bf16 v[48:51], v[56:59], a[188:191], v[48:51]
    s_nop 0
    v_cvt_pk_bf16_f32 v2, v32, v33
    v_mul_f32 v34, v34, v84
    v_mfma_f32_16x16x16_bf16 v[118:121], v[216:217], v[170:171], 0
    s_nop 0
    v_mul_f32 v35, v35, v84
    v_cvt_pk_bf16_f32 v3, v34, v35
    v_mul_f32 v4, v4, v84
    v_cvt_pk_bf16_f32 v8, v48, v49
    v_mfma_f32_16x16x32_bf16 v[32:35], v[16:19], a[192:195], 0
    ds_write_b64 v135, v[2:3] offset:0
    v_mfma_f32_16x16x32_bf16 v[32:35], v[146:149], a[196:199], v[32:35]
    v_rsq_f32 v118, v118
    v_mfma_f32_16x16x32_bf16 v[32:35], v[72:75], a[200:203], v[32:35]
    v_rsq_f32 v119, v119
    v_mfma_f32_16x16x32_bf16 v[32:35], v[88:91], a[204:207], v[32:35]
    v_mul_f32 v118, s55, v118
    v_mul_f32 v119, 0.5, v119
    v_mfma_f32_16x16x32_bf16 v[32:35], v[76:79], a[208:211], v[32:35]
    v_cvt_pk_bf16_f32 v9, v50, v51
    v_mul_f32 v36, v36, v118
    v_mfma_f32_16x16x32_bf16 v[32:35], v[56:59], a[212:215], v[32:35]
    s_waitcnt lgkmcnt(1)
    v_mul_f32 v37, v37, v118
    v_cvt_pk_f16_f32 v76, v36, v37
    v_mfma_f32_16x16x32_bf16 v[146:149], a[0:3], v[64:67], 0
    v_mul_f32 v38, v38, v118
    v_mul_f32 v39, v39, v118
    v_mfma_f32_16x16x32_bf16 v[146:149], a[4:7], v[68:71], v[146:149]
    v_cvt_pk_f16_f32 v77, v38, v39
    v_mul_f32 v12, v12, v118
    v_mfma_f32_16x16x32_bf16 v[146:149], a[8:11], v[52:55], v[146:149]
    v_mul_f32 v13, v13, v118
    v_cvt_pk_f16_f32 v78, v12, v13
    v_mfma_f32_16x16x32_bf16 v[146:149], a[12:15], v[96:99], v[146:149]
    v_mul_f32 v14, v14, v118
    v_mul_f32 v15, v15, v118
    v_mfma_f32_16x16x32_bf16 v[146:149], a[16:19], v[108:111], v[146:149]
    v_cvt_pk_f16_f32 v79, v14, v15
    v_mul_f32 v152, v152, v118
    v_mfma_f32_16x16x32_bf16 v[146:149], a[20:23], v[104:107], v[146:149]
    v_mul_f32 v153, v153, v118
    v_cvt_pk_f16_f32 v152, v152, v153
    v_mfma_f32_16x16x32_bf16 v[36:39], a[24:27], v[64:67], 0
    v_mul_f32 v154, v154, v118
    v_mul_f32 v155, v155, v118
    v_mfma_f32_16x16x32_bf16 v[36:39], a[28:31], v[68:71], v[36:39]
    v_cvt_pk_f16_f32 v153, v154, v155
    v_mul_f32 v60, v60, v119
    v_mfma_f32_16x16x32_bf16 v[36:39], a[32:35], v[52:55], v[36:39]
    v_mul_f32 v61, v61, v119
    v_cvt_pk_f16_f32 v16, v60, v61
    v_mfma_f32_16x16x32_bf16 v[36:39], a[36:39], v[96:99], v[36:39]
    v_mul_f32 v62, v62, v119
    v_mul_f32 v63, v63, v119
    v_mfma_f32_16x16x32_bf16 v[36:39], a[40:43], v[108:111], v[36:39]
    v_cvt_pk_f16_f32 v17, v62, v63
    v_mul_f32 v92, v92, v119
    v_mfma_f32_16x16x32_bf16 v[36:39], a[44:47], v[104:107], v[36:39]
    v_mul_f32 v93, v93, v119
    v_cvt_pk_f16_f32 v18, v92, v93
    v_mfma_f32_16x16x32_bf16 v[72:75], a[48:51], v[64:67], 0
    v_mul_f32 v94, v94, v119
    v_mul_f32 v95, v95, v119
    v_mfma_f32_16x16x32_bf16 v[72:75], a[52:55], v[68:71], v[72:75]
    v_cvt_pk_f16_f32 v19, v94, v95
    v_mul_f32 v80, v80, v119
    v_mfma_f32_16x16x32_bf16 v[72:75], a[56:59], v[52:55], v[72:75]
    v_mul_f32 v81, v81, v119
    v_cvt_pk_f16_f32 v154, v80, v81
    v_mfma_f32_16x16x32_bf16 v[72:75], a[60:63], v[96:99], v[72:75]
    v_mul_f32 v82, v82, v119
    v_mul_f32 v83, v83, v119
    v_mfma_f32_16x16x32_bf16 v[72:75], a[64:67], v[108:111], v[72:75]
    v_cvt_pk_f16_f32 v155, v82, v83
    v_cvt_pk_bf16_f32 v12, v32, v33
    v_mfma_f32_16x16x32_bf16 v[72:75], a[68:71], v[104:107], v[72:75]
    v_cvt_pk_bf16_f32 v13, v34, v35
    v_mul_f32 v5, v5, v84
    v_mfma_f32_16x16x32_bf16 v[32:35], a[72:75], v[64:67], 0
    v_cvt_pk_bf16_f32 v4, v4, v5
    v_mul_f32 v6, v6, v84
    v_mfma_f32_16x16x32_bf16 v[32:35], a[76:79], v[68:71], v[32:35]
    v_mul_f32 v7, v7, v84
    v_cvt_pk_bf16_f32 v5, v6, v7
    v_mfma_f32_16x16x32_bf16 v[32:35], a[80:83], v[52:55], v[32:35]
    ds_write_b64 v135, v[4:5] offset:8
    v_mfma_f32_16x16x32_bf16 v[32:35], a[84:87], v[96:99], v[32:35]
    v_mul_f32 v24, v24, v84
    v_mul_f32 v25, v25, v84
    v_mfma_f32_16x16x32_bf16 v[32:35], a[88:91], v[108:111], v[32:35]
    v_cvt_pk_bf16_f32 v2, v24, v25
    v_mul_f32 v26, v26, v84
    v_mfma_f32_16x16x32_bf16 v[32:35], a[92:95], v[104:107], v[32:35]
    v_mul_f32 v27, v27, v84
    v_cvt_pk_bf16_f32 v3, v26, v27
    v_mfma_f32_16x16x32_bf16 v[4:7], a[96:99], v[64:67], 0
    ds_write_b64 v134, v[2:3] offset:0
    v_mfma_f32_16x16x32_bf16 v[4:7], a[100:103], v[68:71], v[4:7]
    v_fma_f32 v2, v146, v146, s41
    v_fmac_f32 v2, v147, v147
    v_mfma_f32_16x16x32_bf16 v[4:7], a[104:107], v[52:55], v[4:7]
    v_fmac_f32 v2, v148, v148
    v_fmac_f32 v2, v149, v149
    v_mfma_f32_16x16x32_bf16 v[4:7], a[108:111], v[96:99], v[4:7]
    v_fmac_f32 v2, v36, v36
    v_fmac_f32 v2, v37, v37
    v_mfma_f32_16x16x32_bf16 v[4:7], a[112:115], v[108:111], v[4:7]
    v_fmac_f32 v2, v38, v38
    v_fmac_f32 v2, v39, v39
    v_mfma_f32_16x16x32_bf16 v[4:7], a[116:119], v[104:107], v[4:7]
    v_fmac_f32 v2, v72, v72
    v_fmac_f32 v2, v73, v73
    v_mfma_f32_16x16x32_bf16 v[24:27], a[120:123], v[64:67], 0
    v_fmac_f32 v2, v74, v74
    v_fmac_f32 v2, v75, v75
    v_mfma_f32_16x16x32_bf16 v[24:27], a[124:127], v[68:71], v[24:27]
    v_mul_f32 v28, v28, v85
    v_mul_f32 v29, v29, v85
    v_mfma_f32_16x16x32_bf16 v[24:27], a[128:131], v[52:55], v[24:27]
    v_cvt_pk_bf16_f32 v88, v28, v29
    v_mul_f32 v30, v30, v85
    v_mfma_f32_16x16x32_bf16 v[24:27], a[132:135], v[96:99], v[24:27]
    v_mul_f32 v31, v31, v85
    v_cvt_pk_bf16_f32 v89, v30, v31
    v_mfma_f32_16x16x32_bf16 v[24:27], a[136:139], v[108:111], v[24:27]
    ds_write_b64 v135, v[88:89] offset:1536
    v_mfma_f32_16x16x32_bf16 v[24:27], a[140:143], v[104:107], v[24:27]
    v_mul_f32 v20, v20, v85
    v_mul_f32 v21, v21, v85
    v_mfma_f32_16x16x32_bf16 v[60:63], v[64:67], a[144:147], 0
    v_cvt_pk_bf16_f32 v90, v20, v21
    v_mul_f32 v22, v22, v85
    v_mfma_f32_16x16x32_bf16 v[60:63], v[68:71], a[148:151], v[60:63]
    v_mul_f32 v23, v23, v85
    v_cvt_pk_bf16_f32 v91, v22, v23
    v_mfma_f32_16x16x32_bf16 v[60:63], v[52:55], a[152:155], v[60:63]
    ds_write_b64 v135, v[90:91] offset:1544
    v_mfma_f32_16x16x32_bf16 v[60:63], v[96:99], a[156:159], v[60:63]
    v_mul_f32 v114, v114, v85
    v_mul_f32 v115, v115, v85
    v_mfma_f32_16x16x32_bf16 v[60:63], v[108:111], a[160:163], v[60:63]
    ds_read_b128 v[88:91], v137 offset:3072
    v_cvt_pk_bf16_f32 v10, v114, v115
    v_mfma_f32_16x16x32_bf16 v[60:63], v[104:107], a[164:167], v[60:63]
    ds_read_b128 v[56:59], v136 offset:3072
    v_mul_f32 v116, v116, v85
    v_mfma_f32_16x16x32_bf16 v[92:95], v[64:67], a[168:171], 0
    ds_read_b128 v[80:83], v137 offset:3200
    v_mul_f32 v117, v117, v85
    v_mfma_f32_16x16x32_bf16 v[92:95], v[68:71], a[172:175], v[92:95]
    ds_read_b128 v[28:31], v136 offset:3200
    v_cvt_pk_bf16_f32 v11, v116, v117
    v_mfma_f32_16x16x32_bf16 v[92:95], v[52:55], a[176:179], v[92:95]
    ds_write_b64 v134, v[10:11] offset:1536
    v_mfma_f32_16x16x32_bf16 v[92:95], v[96:99], a[180:183], v[92:95]
    v_fma_f32 v3, v32, v32, s41
    v_fmac_f32 v3, v33, v33
    v_mfma_f32_16x16x32_bf16 v[92:95], v[108:111], a[184:187], v[92:95]
    ds_read_b128 v[48:51], v137 offset:3328
    v_fmac_f32 v3, v34, v34
    v_mfma_f32_16x16x32_bf16 v[92:95], v[104:107], a[188:191], v[92:95]
    ds_read_b128 v[20:23], v136 offset:3328
    v_fmac_f32 v3, v35, v35
    v_mfma_f32_16x16x32_bf16 v[112:115], v[64:67], a[192:195], 0
    v_fmac_f32 v3, v4, v4
    v_fmac_f32 v3, v5, v5
    v_mfma_f32_16x16x32_bf16 v[112:115], v[68:71], a[196:199], v[112:115]
    s_sub_u32 s50, s45, s44
    v_fmac_f32 v3, v6, v6
    v_fmac_f32 v3, v7, v7
    v_mfma_f32_16x16x32_bf16 v[112:115], v[52:55], a[200:203], v[112:115]
    s_sub_u32 s51, s46, s47
    v_fmac_f32 v3, v24, v24
    v_fmac_f32 v3, v25, v25
    v_mfma_f32_16x16x32_bf16 v[112:115], v[96:99], a[204:207], v[112:115]
    s_mov_b32 s60, s59
    v_fmac_f32 v3, v26, v26
    v_fmac_f32 v3, v27, v27
    v_mfma_f32_16x16x32_bf16 v[112:115], v[108:111], a[208:211], v[112:115]
    s_mov_b32 s59, s58
    v_cvt_pk_bf16_f32 v170, v2, v3
    v_cvt_pk_bf16_f32 v2, v60, v61
    v_mfma_f32_16x16x32_bf16 v[112:115], v[104:107], a[212:215], v[112:115]
    s_mov_b32 s58, s57
    v_cvt_pk_bf16_f32 v3, v62, v63
    v_cvt_pk_bf16_f32 v10, v92, v93
    v_mfma_f32_16x16x16_bf16 v[60:63], v[216:217], v[170:171], 0
    s_waitcnt lgkmcnt(2)
    s_mov_b32 s57, s56
    v_cvt_pk_bf16_f32 v11, v94, v95
    v_mul_f32 v40, v40, v86
    v_mul_f32 v41, v41, v86
    v_cvt_pk_bf16_f32 v14, v112, v113
    v_mfma_f32_16x16x32_bf16 v[92:95], a[0:3], v[88:91], 0
    s_mov_b32 s7, s6
    v_cvt_pk_bf16_f32 v15, v114, v115
    v_cvt_pk_bf16_f32 v40, v40, v41
    v_mfma_f32_16x16x32_bf16 v[92:95], a[4:7], v[56:59], v[92:95]
    s_mov_b32 s6, s5
    v_rsq_f32 v60, v60
    v_mfma_f32_16x16x32_bf16 v[92:95], a[8:11], v[80:83], v[92:95]
    s_mov_b32 s5, s4
    v_rsq_f32 v61, v61
    v_mfma_f32_16x16x32_bf16 v[92:95], a[12:15], v[28:31], v[92:95]
    s_waitcnt lgkmcnt(0)
    s_sub_u32 s14, s6, s7
    v_mul_f32 v60, s55, v60
    v_mul_f32 v61, 0.5, v61
    v_mfma_f32_16x16x32_bf16 v[92:95], a[16:19], v[48:51], v[92:95]
    s_add_u32 s61, s61, 1
    v_mul_f32 v146, v146, v60
    v_mul_f32 v147, v147, v60
    v_mfma_f32_16x16x32_bf16 v[92:95], a[20:23], v[20:23], v[92:95]
    s_ff1_i32_b32 s15, s66
    v_cvt_pk_f16_f32 v96, v146, v147
    v_mul_f32 v148, v148, v60
    v_mfma_f32_16x16x32_bf16 v[64:67], a[24:27], v[88:91], 0
    s_cmp_lg_u32 s66, 0
    v_mul_f32 v149, v149, v60
    v_cvt_pk_f16_f32 v97, v148, v149
    v_mfma_f32_16x16x32_bf16 v[64:67], a[28:31], v[56:59], v[64:67]
    s_cselect_b32 s12, s15, s12
    v_mul_f32 v36, v36, v60
    v_mul_f32 v37, v37, v60
    v_mfma_f32_16x16x32_bf16 v[64:67], a[32:35], v[80:83], v[64:67]
    s_cmp_lt_u32 s61, s71
    v_cvt_pk_f16_f32 v98, v36, v37
    v_mul_f32 v38, v38, v60
    v_mfma_f32_16x16x32_bf16 v[64:67], a[36:39], v[28:31], v[64:67]
    s_cselect_b32 s15, 31, s15
    v_mul_f32 v39, v39, v60
    v_cvt_pk_f16_f32 v99, v38, v39
    v_mfma_f32_16x16x32_bf16 v[64:67], a[40:43], v[48:51], v[64:67]
    s_bitset0_b32 s66, s15
    v_mul_f32 v72, v72, v60
    v_mul_f32 v73, v73, v60
    v_mfma_f32_16x16x32_bf16 v[64:67], a[44:47], v[20:23], v[64:67]
    s_add_u32 s12, s12, 20
    v_cvt_pk_f16_f32 v146, v72, v73
    v_mul_f32 v74, v74, v60
    v_mfma_f32_16x16x32_bf16 v[68:71], a[48:51], v[88:91], 0
    s_max_u32 s12, s12, s61
    v_mul_f32 v75, v75, v60
    v_cvt_pk_f16_f32 v147, v74, v75
    v_mfma_f32_16x16x32_bf16 v[68:71], a[52:55], v[56:59], v[68:71]
    s_cmp_lt_u32 s61, s71
    v_mul_f32 v32, v32, v61
    v_mul_f32 v33, v33, v61
    v_mfma_f32_16x16x32_bf16 v[68:71], a[56:59], v[80:83], v[68:71]
    s_cselect_b32 s15, s61, s12
    v_cvt_pk_f16_f32 v36, v32, v33
    v_mul_f32 v34, v34, v61
    v_mfma_f32_16x16x32_bf16 v[68:71], a[60:63], v[28:31], v[68:71]
    s_cselect_b32 s56, s69, s70
    v_mul_f32 v35, v35, v61
    v_cvt_pk_f16_f32 v37, v34, v35
    v_mfma_f32_16x16x32_bf16 v[68:71], a[64:67], v[48:51], v[68:71]
    s_add_u32 s56, s56, s15
    v_mul_f32 v4, v4, v61
    v_mul_f32 v5, v5, v61
    v_mfma_f32_16x16x32_bf16 v[68:71], a[68:71], v[20:23], v[68:71]
    s_mul_i32 s53, s56, 58255
    v_cvt_pk_f16_f32 v38, v4, v5
    v_mul_f32 v6, v6, v61
    v_mfma_f32_16x16x32_bf16 v[72:75], a[72:75], v[88:91], 0
    s_lshr_b32 s53, s53, 22
    v_mul_f32 v7, v7, v61
    v_cvt_pk_f16_f32 v39, v6, v7
    v_mfma_f32_16x16x32_bf16 v[72:75], a[76:79], v[56:59], v[72:75]
    s_mul_i32 s53, s53, s63
    v_mul_f32 v24, v24, v61
    v_mul_f32 v25, v25, v61
    v_mfma_f32_16x16x32_bf16 v[72:75], a[80:83], v[80:83], v[72:75]
    s_mul_i32 s56, s56, s62
    v_cvt_pk_f16_f32 v148, v24, v25
    v_mul_f32 v26, v26, v61
    v_mfma_f32_16x16x32_bf16 v[72:75], a[84:87], v[28:31], v[72:75]
    s_add_u32 s56, s56, s53
    v_mul_f32 v27, v27, v61
    v_cvt_pk_f16_f32 v149, v26, v27
    v_mfma_f32_16x16x32_bf16 v[72:75], a[88:91], v[48:51], v[72:75]
    s_mul_i32 s4, s15, 112
    v_mul_f32 v42, v42, v86
    v_mul_f32 v43, v43, v86
    v_mfma_f32_16x16x32_bf16 v[72:75], a[92:95], v[20:23], v[72:75]
    s_cmp_ge_u32 s15, 16
    v_cvt_pk_bf16_f32 v41, v42, v43
    v_mul_f32 v140, v140, v86
    v_mfma_f32_16x16x32_bf16 v[4:7], a[96:99], v[88:91], 0
    s_cselect_b32 s53, -30464, 0
    ds_write_b64 v135, v[40:41] offset:3072
    v_mfma_f32_16x16x32_bf16 v[4:7], a[100:103], v[56:59], v[4:7]
    s_add_u32 s4, s4, s53
    v_mul_f32 v141, v141, v86
    v_cvt_pk_bf16_f32 v42, v140, v141
    v_mfma_f32_16x16x32_bf16 v[4:7], a[104:107], v[80:83], v[4:7]
    s_cmp_lt_u32 s15, s73
    v_mul_f32 v142, v142, v86
    v_mul_f32 v143, v143, v86
    v_mfma_f32_16x16x32_bf16 v[4:7], a[108:111], v[28:31], v[4:7]
    s_cselect_b32 s26, 100270464, 0
    v_cvt_pk_bf16_f32 v43, v142, v143
    v_mul_f32 v44, v44, v86
    v_mfma_f32_16x16x32_bf16 v[4:7], a[112:115], v[48:51], v[4:7]
    s_cselect_b32 s56, s56, 0
    ds_write_b64 v135, v[42:43] offset:3080
    v_mfma_f32_16x16x32_bf16 v[4:7], a[116:119], v[20:23], v[4:7]
    s_cselect_b32 s4, s4, -1
    v_mul_f32 v45, v45, v86
    v_cvt_pk_bf16_f32 v44, v44, v45
    v_mul_f32 v46, v46, v86
    v_mul_f32 v47, v47, v86
    v_cvt_pk_bf16_f32 v45, v46, v47
    s_cselect_b32 s15, s15, 0
    s_cselect_b32 s13, s13, -1
    ds_write_b64 v134, v[44:45] offset:3072
    v_fma_f32 v120, v92, v92, s41
    v_fmac_f32 v120, v93, v93
    v_fmac_f32 v120, v94, v94
    v_fmac_f32 v120, v95, v95
    v_mfma_f32_16x16x32_bf16 v[24:27], a[120:123], v[88:91], 0
    s_waitcnt vmcnt(0)
    v_fmac_f32 v120, v64, v64
    v_fmac_f32 v120, v65, v65
    v_mfma_f32_16x16x32_bf16 v[24:27], a[124:127], v[56:59], v[24:27]
    s_bitset1_b32 s64, s15
    v_fmac_f32 v120, v66, v66
    v_fmac_f32 v120, v67, v67
    v_mfma_f32_16x16x32_bf16 v[24:27], a[128:131], v[80:83], v[24:27]
    s_add_u32 s65, s65, 1
    v_fmac_f32 v120, v68, v68
    v_fmac_f32 v120, v69, v69
    v_mfma_f32_16x16x32_bf16 v[24:27], a[132:135], v[28:31], v[24:27]
    s_cmp_ge_i32 s65, 2
    v_fmac_f32 v120, v70, v70
    v_fmac_f32 v120, v71, v71
    v_mfma_f32_16x16x32_bf16 v[24:27], a[136:139], v[48:51], v[24:27]
    s_cselect_b32 s30, 100270464, 0
    v_fma_f32 v121, v72, v72, s41
    v_fmac_f32 v121, v73, v73
    v_mfma_f32_16x16x32_bf16 v[24:27], a[140:143], v[20:23], v[24:27]
    s_add_u32 s67, s46, s54
    v_fmac_f32 v121, v74, v74
    v_fmac_f32 v121, v75, v75
    v_mfma_f32_16x16x32_bf16 v[32:35], v[88:91], a[144:147], 0
    s_waitcnt lgkmcnt(0)
    s_add_u32 m0, s67, 0
    v_fmac_f32 v121, v4, v4
    v_fmac_f32 v121, v5, v5
    v_mfma_f32_16x16x32_bf16 v[32:35], v[56:59], a[148:151], v[32:35]
    s_barrier
    v_fmac_f32 v121, v6, v6
    v_fmac_f32 v121, v7, v7
    v_mfma_f32_16x16x32_bf16 v[32:35], v[80:83], a[152:155], v[32:35]
    s_cmp_ge_u32 s61, s13
    v_fmac_f32 v121, v24, v24
    v_fmac_f32 v121, v25, v25
    v_mfma_f32_16x16x32_bf16 v[32:35], v[28:31], a[156:159], v[32:35]
    s_cbranch_scc1 L_atomS0
L_atomS0r:
    v_mfma_f32_16x16x32_bf16 v[32:35], v[48:51], a[160:163], v[32:35]
    v_fmac_f32 v121, v26, v26
    v_fmac_f32 v121, v27, v27
    v_mfma_f32_16x16x32_bf16 v[32:35], v[20:23], a[164:167], v[32:35]
    v_cvt_pk_bf16_f32 v170, v120, v121
    v_add_u32 v137, s50, v137
    v_mfma_f32_16x16x32_bf16 v[40:43], v[88:91], a[168:171], 0
    ds_read_b128 v[60:63], v137 offset:0
    v_add_u32 v136, s50, v136
    v_mfma_f32_16x16x32_bf16 v[40:43], v[56:59], a[172:175], v[40:43]
    s_nop 0
    ds_read_b128 v[84:87], v136 offset:0
    v_cvt_pk_bf16_f32 v164, v32, v33
    v_mfma_f32_16x16x32_bf16 v[40:43], v[80:83], a[176:179], v[40:43]
    ds_read_b128 v[52:55], v137 offset:128
    v_cvt_pk_bf16_f32 v165, v34, v35
    v_mfma_f32_16x16x32_bf16 v[40:43], v[28:31], a[180:183], v[40:43]
    ds_read_b128 v[112:115], v136 offset:128
    v_add_u32 v135, s48, v135
    v_mfma_f32_16x16x32_bf16 v[40:43], v[48:51], a[184:187], v[40:43]
    ds_read_b128 v[108:111], v137 offset:256
    v_add_u32 v134, s48, v134
    v_mfma_f32_16x16x32_bf16 v[40:43], v[20:23], a[188:191], v[40:43]
    s_nop 0
    ds_read_b128 v[104:107], v136 offset:256
    v_add_u32 v133, s51, v133
    v_mfma_f32_16x16x16_bf16 v[118:121], v[216:217], v[170:171], 0
    s_nop 0
    v_add_u32 v132, s14, v132
    v_add_u32 v131, s14, v131
    v_add_u32 v123, s14, v123
    v_cvt_pk_bf16_f32 v160, v40, v41
    v_mfma_f32_16x16x32_bf16 v[100:103], v[88:91], a[192:195], 0
    v_cvt_pk_bf16_f32 v161, v42, v43
    v_and_b32 v116, -8, v123
    v_mfma_f32_16x16x32_bf16 v[100:103], v[56:59], a[196:199], v[100:103]
    v_rsq_f32 v118, v118
    v_mfma_f32_16x16x32_bf16 v[100:103], v[80:83], a[200:203], v[100:103]
    v_rsq_f32 v119, v119
    v_mfma_f32_16x16x32_bf16 v[100:103], v[28:31], a[204:207], v[100:103]
    ds_read_b128 v[28:31], v132 offset:0
    v_mul_f32 v118, s55, v118
    v_mfma_f32_16x16x32_bf16 v[100:103], v[48:51], a[208:211], v[100:103]
    ds_read_b128 v[48:51], v132 offset:16
    v_mul_f32 v119, 0.5, v119
    v_mfma_f32_16x16x32_bf16 v[100:103], v[20:23], a[212:215], v[100:103]
    s_waitcnt lgkmcnt(3)
    ds_read_b128 v[20:23], v132 offset:48
    v_mul_f32 v72, v72, v119
    v_mfma_f32_16x16x32_bf16 v[32:35], a[216:219], v[60:63], 0
    ds_read_b128 v[88:91], v133 offset:0
    v_mul_f32 v73, v73, v119
    v_mfma_f32_16x16x32_bf16 v[32:35], a[220:223], v[84:87], v[32:35]
    v_cvt_pk_f16_f32 v40, v72, v73
    v_mul_f32 v74, v74, v119
    v_mfma_f32_16x16x32_bf16 v[32:35], a[224:227], v[52:55], v[32:35]
    v_mul_f32 v75, v75, v119
    v_cvt_pk_f16_f32 v41, v74, v75
    v_mfma_f32_16x16x32_bf16 v[32:35], a[228:231], v[112:115], v[32:35]
    v_mul_f32 v4, v4, v119
    v_mul_f32 v5, v5, v119
    v_mfma_f32_16x16x32_bf16 v[32:35], a[232:235], v[108:111], v[32:35]
    s_waitcnt lgkmcnt(4)
    v_cvt_pk_f16_f32 v42, v4, v5
    v_mul_f32 v6, v6, v119
    v_mfma_f32_16x16x32_bf16 v[32:35], a[236:239], v[104:107], v[32:35]
    v_mul_f32 v7, v7, v119
    v_cvt_pk_f16_f32 v43, v6, v7
    v_mfma_f32_16x16x32_bf16 v[4:7], a[240:243], v[60:63], 0
    v_mul_f32 v24, v24, v119
    v_mul_f32 v25, v25, v119
    v_mfma_f32_16x16x32_bf16 v[4:7], a[244:247], v[84:87], v[4:7]
    v_cvt_pk_f16_f32 v142, v24, v25
    v_mul_f32 v26, v26, v119
    v_mfma_f32_16x16x32_bf16 v[4:7], a[248:251], v[52:55], v[4:7]
    v_mul_f32 v27, v27, v119
    v_cvt_pk_f16_f32 v143, v26, v27
    v_mfma_f32_16x16x32_bf16 v[4:7], a[252:255], v[112:115], v[4:7]
    s_waitcnt lgkmcnt(0)
    buffer_load_dwordx4 v128, s[24:27], s56 offen nt lds
    v_mul_f32 v92, v92, v118
    v_mfma_f32_16x16x32_bf16 v[4:7], v[224:227], v[108:111], v[4:7]
    v_mul_f32 v93, v93, v118
    v_cvt_pk_f16_f32 v44, v92, v93
    v_mfma_f32_16x16x32_bf16 v[4:7], v[228:231], v[104:107], v[4:7]
    v_mul_f32 v94, v94, v118
    v_mul_f32 v95, v95, v118
    v_mfma_f32_16x16x32_bf16 v[24:27], v[232:235], v[60:63], 0
    v_cvt_pk_f16_f32 v45, v94, v95
    v_mul_f32 v64, v64, v118
    v_mfma_f32_16x16x32_bf16 v[24:27], v[236:239], v[84:87], v[24:27]
    v_mul_f32 v65, v65, v118
    v_cvt_pk_f16_f32 v46, v64, v65
    v_mfma_f32_16x16x32_bf16 v[24:27], v[240:243], v[52:55], v[24:27]
    v_mul_f32 v66, v66, v118
    v_mul_f32 v67, v67, v118
    v_mfma_f32_16x16x32_bf16 v[24:27], v[244:247], v[112:115], v[24:27]
    v_cvt_pk_f16_f32 v47, v66, v67
    v_mul_f32 v68, v68, v118
    v_mfma_f32_16x16x32_bf16 v[24:27], v[248:251], v[108:111], v[24:27]
    buffer_store_dwordx4 v[88:91], v128, s[28:31], s60 offen sc1
    v_mul_f32 v69, v69, v118
    v_cvt_pk_f16_f32 v140, v68, v69
    v_mul_f32 v70, v70, v118
    v_mul_f32 v71, v71, v118
    v_mfma_f32_16x16x32_bf16 v[24:27], v[252:255], v[104:107], v[24:27]
    s_add_u32 m0, s67, 1024
    v_cvt_pk_f16_f32 v141, v70, v71
    v_cvt_pk_bf16_f32 v156, v100, v101
    v_mfma_f32_16x16x32_f16 v[112:115], v[16:19], v[76:79], v[204:207]
    ds_read_u16 v166, v131 offset:80
    v_cvt_pk_bf16_f32 v157, v102, v103
    v_mfma_f32_16x16x32_f16 v[112:115], v[152:155], v[150:153], v[112:115]
    ds_read_u16 v162, v131 offset:96
    v_mfma_f32_16x16x32_f16 v[108:111], v[36:39], v[76:79], v[200:203]
    s_nop 0
    ds_read_u16 v158, v131 offset:104
    s_nop 0
    v_mfma_f32_16x16x32_f16 v[108:111], v[146:149], v[150:153], v[108:111]
    s_nop 0
    ds_read_b32 v116, v116 offset:64
    v_max3_f32 v120, v112, v113, v114
    v_mfma_f32_16x16x32_f16 v[104:107], v[40:43], v[76:79], v[196:199]
    ds_read_b128 v[68:71], v133 offset:1024
    v_mfma_f32_16x16x32_f16 v[104:107], v[140:143], v[150:153], v[104:107]
    s_nop 0
    ds_read_b128 v[72:75], v137 offset:1536
    v_max3_f32 v120, v120, v115, v108
    v_mfma_f32_16x16x32_f16 v[88:91], v[28:31], v[76:79], v[208:211]
    ds_read_b128 v[76:79], v136 offset:1536
    v_max3_f32 v120, v120, v109, v110
    v_mfma_f32_16x16x32_f16 v[88:91], v[48:51], v[16:19], v[88:91]
    ds_read_b128 v[60:63], v137 offset:1664
    v_max3_f32 v120, v120, v111, v104
    v_mfma_f32_16x16x32_f16 v[88:91], v[20:23], v[152:155], v[88:91]
    ds_read_b128 v[56:59], v136 offset:1664
    v_max3_f32 v120, v120, v105, v106
    v_mfma_f32_16x16x32_f16 v[92:95], v[28:31], v[96:99], v[208:211]
    ds_read_b128 v[64:67], v137 offset:1792
    s_nop 0
    v_mfma_f32_16x16x32_f16 v[92:95], v[48:51], v[36:39], v[92:95]
    s_nop 0
    ds_read_b128 v[80:83], v136 offset:1792
    v_max3_f32 v120, v120, v107, v88
    v_mfma_f32_16x16x32_f16 v[92:95], v[20:23], v[146:149], v[92:95]
    v_mov_b32 v121, v120
    v_mfma_f32_16x16x32_f16 v[84:87], v[28:31], v[44:47], v[208:211]
    s_nop 0
    v_permlane32_swap_b32 v121, v120
    v_mfma_f32_16x16x32_f16 v[84:87], v[48:51], v[40:43], v[84:87]
    s_waitcnt lgkmcnt(6)
    buffer_load_dwordx4 v127, s[24:27], s56 offen nt lds
    v_max_f32 v120, v121, v120
    v_mfma_f32_16x16x32_f16 v[84:87], v[20:23], v[140:143], v[84:87]
    s_waitcnt lgkmcnt(5)
    v_mov_b32 v121, v120
    v_mov_b32_dpp v91, v95 quad_perm:[0,1,2,3] row_mask:0x2 bank_mask:0xf
    v_mfma_f32_16x16x32_bf16 v[28:31], a[216:219], v[72:75], 0
    s_waitcnt lgkmcnt(4)
    v_permlane16_swap_b32 v121, v120
    v_mfma_f32_16x16x32_bf16 v[28:31], a[220:223], v[76:79], v[28:31]
    s_waitcnt lgkmcnt(3)
    v_max_f32 v120, v121, v120
    v_sub_f32 v112, v112, v120
    v_mfma_f32_16x16x32_bf16 v[28:31], a[224:227], v[60:63], v[28:31]
    s_waitcnt lgkmcnt(2)
    v_sub_f32 v113, v113, v120
    v_sub_f32 v114, v114, v120
    v_mfma_f32_16x16x32_bf16 v[28:31], a[228:231], v[56:59], v[28:31]
    s_waitcnt lgkmcnt(1)
    v_sub_f32 v115, v115, v120
    v_sub_f32 v108, v108, v120
    v_mfma_f32_16x16x32_bf16 v[28:31], a[232:235], v[64:67], v[28:31]
    s_waitcnt lgkmcnt(0)
    v_sub_f32 v109, v109, v120
    v_sub_f32 v110, v110, v120
    v_mfma_f32_16x16x32_bf16 v[28:31], a[236:239], v[80:83], v[28:31]
    buffer_store_dwordx4 v[68:71], v127, s[28:31], s60 offen sc1
    ds_read_b128 v[100:103], v133 offset:2048
    v_sub_f32 v111, v111, v120
    v_sub_f32 v104, v104, v120
    v_sub_f32 v105, v105, v120
    v_mfma_f32_16x16x32_f16 v[48:51], v[16:19], v[96:99], v[192:195]
    s_add_u32 m0, s67, 2048
    v_sub_f32 v106, v106, v120
    v_sub_f32 v107, v107, v120
    v_mfma_f32_16x16x32_f16 v[48:51], v[152:155], v[144:147], v[48:51]
    v_sub_f32 v88, v88, v120
    v_mov_b32_dpp v91, v87 quad_perm:[0,1,2,3] row_mask:0x4 bank_mask:0xf
    v_mfma_f32_16x16x32_f16 v[68:71], v[36:39], v[96:99], v[188:191]
    v_exp_f32 v112, v112
    v_mfma_f32_16x16x32_f16 v[68:71], v[146:149], v[144:147], v[68:71]
    v_exp_f32 v113, v113
    v_mfma_f32_16x16x32_f16 v[52:55], v[40:43], v[96:99], v[184:187]
    v_exp_f32 v114, v114
    v_mfma_f32_16x16x32_f16 v[52:55], v[140:143], v[144:147], v[52:55]
    v_exp_f32 v115, v115
    v_mfma_f32_16x16x32_bf16 v[20:23], a[240:243], v[72:75], 0
    v_cvt_pk_bf16_f32 v96, v112, v113
    v_cvt_pk_bf16_f32 v97, v114, v115
    v_mfma_f32_16x16x32_bf16 v[20:23], a[244:247], v[76:79], v[20:23]
    v_exp_f32 v108, v108
    v_mfma_f32_16x16x32_bf16 v[20:23], a[248:251], v[60:63], v[20:23]
    s_waitcnt lgkmcnt(0)
    buffer_load_dwordx4 v126, s[24:27], s56 offen nt lds
    v_and_b32 v120, 0xffff0000, v116
    v_mfma_f32_16x16x32_bf16 v[20:23], a[252:255], v[56:59], v[20:23]
    v_exp_f32 v109, v109
    v_mfma_f32_16x16x32_bf16 v[20:23], v[224:227], v[64:67], v[20:23]
    v_exp_f32 v110, v110
    v_mfma_f32_16x16x32_bf16 v[20:23], v[228:231], v[80:83], v[20:23]
    s_mov_b32 s53, s47
    v_exp_f32 v111, v111
    v_cvt_pk_bf16_f32 v98, v108, v109
    v_cvt_pk_bf16_f32 v99, v110, v111
    v_exp_f32 v104, v104
    v_exp_f32 v105, v105
    v_exp_f32 v106, v106
    v_exp_f32 v107, v107
    v_cvt_pk_bf16_f32 v168, v104, v105
    v_cvt_pk_bf16_f32 v169, v106, v107
    v_exp_f32 v88, v88
    v_lshlrev_b32 v116, 16, v116
    v_cvt_pk_bf16_f32 v170, v88, 0
    v_mfma_f32_16x16x32_bf16 v[112:115], v[220:223], v[96:99], 0
    s_add_u32 m0, s67, 3072
    buffer_store_dwordx4 v[100:103], v126, s[28:31], s60 offen sc1
    v_add_f32 v116, v116, v120
    v_add_f32 v116, v116, v211
    v_max3_f32 v120, v48, v49, v50
    v_max3_f32 v120, v120, v51, v68
    v_mfma_f32_16x16x32_bf16 v[112:115], v[220:223], v[168:171], v[112:115]
    s_mov_b32 s47, s46
    v_mov_b32_dpp v91, v116 quad_perm:[0,1,2,3] row_mask:0x8 bank_mask:0xf
    v_mov_b32 v121, v91
    v_mfma_f32_16x16x32_bf16 v[108:111], v[0:3], v[96:99], 0
    s_mov_b32 s46, s45
    v_max_f32_dpp v121, v121, v121 row_ror:8 row_mask:0xf bank_mask:0xf
    v_max3_f32 v120, v120, v69, v70
    v_mfma_f32_16x16x32_bf16 v[108:111], v[164:167], v[168:171], v[108:111]
    s_mov_b32 s45, s44
    v_max_f32_dpp v121, v121, v121 row_ror:4 row_mask:0xf bank_mask:0xf
    v_max3_f32 v120, v120, v71, v52
    v_mfma_f32_16x16x32_bf16 v[104:107], v[8:11], v[96:99], 0
    s_mov_b32 s44, s53
    v_max_f32_dpp v121, v121, v121 row_ror:2 row_mask:0xf bank_mask:0xf
    v_max3_f32 v120, v120, v53, v54
    v_mfma_f32_16x16x32_bf16 v[104:107], v[160:163], v[168:171], v[104:107]
    s_sub_u32 s48, s44, s46
    v_max_f32_dpp v121, v121, v121 row_ror:1 row_mask:0xf bank_mask:0xf
    v_mov_b32 v84, v121
    v_mfma_f32_16x16x32_bf16 v[100:103], v[12:15], v[96:99], 0
    s_sub_u32 s49, s46, s45
    v_permlane32_swap_b32 v84, v121
    v_mfma_f32_16x16x32_bf16 v[100:103], v[156:159], v[168:171], v[100:103]
    v_max_f32 v121, v84, v121
    v_mov_b32 v84, v121
    v_rcp_f32 v112, v112
    v_max3_f32 v120, v120, v55, v93
    v_permlane16_swap_b32 v84, v121
    v_max_f32 v121, v84, v121
    v_sub_f32 v91, v91, v121
    v_exp_f32 v91, v91
    v_mul_f32 v108, v108, v112
    v_cvt_pk_bf16_f32 v91, v91, v91
    ds_write_b16 v123, v91 offset:64
    v_mul_f32 v109, v109, v112
    v_cvt_pk_bf16_f32 v88, v108, v109
    ds_read_b128 v[94:97], v132 offset:48
    v_mul_f32 v110, v110, v112
    v_mul_f32 v111, v111, v112
    v_cvt_pk_bf16_f32 v89, v110, v111
    ds_read_b128 v[108:111], v132 offset:64
    v_mfma_f32_16x16x32_bf16 v[114:117], v[232:235], v[72:75], 0
    v_mul_f32 v104, v104, v112
    v_mul_f32 v105, v105, v112
    v_mfma_f32_16x16x32_bf16 v[114:117], v[236:239], v[76:79], v[114:117]
    ds_write_b64 v135, v[88:89] offset:0
    v_mfma_f32_16x16x32_bf16 v[114:117], v[240:243], v[60:63], v[114:117]
    v_cvt_pk_bf16_f32 v90, v104, v105
    v_mul_f32 v106, v106, v112
    v_mfma_f32_16x16x32_bf16 v[114:117], v[244:247], v[56:59], v[114:117]
    v_mul_f32 v107, v107, v112
    v_cvt_pk_bf16_f32 v91, v106, v107
    v_mfma_f32_16x16x32_bf16 v[114:117], v[248:251], v[64:67], v[114:117]
    ds_write_b64 v135, v[90:91] offset:8
    v_mfma_f32_16x16x32_bf16 v[114:117], v[252:255], v[80:83], v[114:117]
    s_waitcnt lgkmcnt(3)
    v_mul_f32 v100, v100, v112
    v_mul_f32 v101, v101, v112
    v_cvt_pk_bf16_f32 v168, v100, v101
    v_mul_f32 v102, v102, v112
    v_mfma_f32_16x16x32_bf16 v[72:75], v[94:97], v[0:3], 0
    s_waitcnt lgkmcnt(2)
    v_mul_f32 v103, v103, v112
    v_cvt_pk_bf16_f32 v169, v102, v103
    v_mov_b32 v170, v120
    v_fma_f32 v92, v32, v32, s42
    v_mfma_f32_16x16x32_bf16 v[72:75], v[108:111], v[164:167], v[72:75]
    ds_write_b64 v134, v[168:169] offset:0
    v_mfma_f32_16x16x32_bf16 v[88:91], v[94:97], v[8:11], 0
    v_permlane32_swap_b32 v170, v120
    v_mfma_f32_16x16x32_bf16 v[88:91], v[108:111], v[160:163], v[88:91]
    v_max_f32 v120, v170, v120
    v_mov_b32 v170, v120
    v_mfma_f32_16x16x32_bf16 v[76:79], v[94:97], v[12:15], 0
    s_nop 0
    v_permlane16_swap_b32 v170, v120
    v_mfma_f32_16x16x32_bf16 v[76:79], v[108:111], v[156:159], v[76:79]
    ds_read_b128 v[60:63], v133 offset:3072
    v_max_f32 v120, v170, v120
    v_sub_f32 v48, v48, v120
    v_sub_f32 v49, v49, v120
    v_sub_f32 v50, v50, v120
    v_sub_f32 v51, v51, v120
    v_sub_f32 v68, v68, v120
    v_sub_f32 v69, v69, v120
    v_sub_f32 v70, v70, v120
    v_sub_f32 v71, v71, v120
    v_sub_f32 v52, v52, v120
    v_sub_f32 v53, v53, v120
    v_sub_f32 v54, v54, v120
    v_sub_f32 v55, v55, v120
    v_sub_f32 v93, v93, v120
    v_exp_f32 v48, v48
    v_exp_f32 v49, v49
    v_exp_f32 v50, v50
    v_exp_f32 v51, v51
    v_cvt_pk_bf16_f32 v56, v48, v49
    v_cvt_pk_bf16_f32 v57, v50, v51
    v_exp_f32 v68, v68
    v_exp_f32 v69, v69
    v_exp_f32 v70, v70
    v_exp_f32 v71, v71
    v_cvt_pk_bf16_f32 v58, v68, v69
    v_cvt_pk_bf16_f32 v59, v70, v71
    v_exp_f32 v52, v52
    v_exp_f32 v53, v53
    v_exp_f32 v54, v54
    v_exp_f32 v55, v55
    v_cvt_pk_bf16_f32 v168, v52, v53
    v_cvt_pk_bf16_f32 v169, v54, v55
    v_exp_f32 v93, v93
    v_mov_b32_dpp v75, v91 quad_perm:[0,1,2,3] row_mask:0x2 bank_mask:0xf
    v_cvt_pk_bf16_f32 v170, v93, 0
    v_mfma_f32_16x16x32_bf16 v[88:91], v[220:223], v[56:59], 0
    s_waitcnt lgkmcnt(0)
    buffer_load_dwordx4 v125, s[24:27], s56 offen nt lds
    ds_read_b128 v[64:67], v137 offset:3072
    v_mfma_f32_16x16x32_bf16 v[88:91], v[220:223], v[168:171], v[88:91]
    v_mov_b32_dpp v75, v79 quad_perm:[0,1,2,3] row_mask:0x4 bank_mask:0xf
    v_cvt_pk_bf16_f32 v75, v75, v75
    v_mfma_f32_16x16x32_bf16 v[76:79], v[0:3], v[56:59], 0
    ds_write_b16 v131, v75
    v_mfma_f32_16x16x32_bf16 v[76:79], v[164:167], v[168:171], v[76:79]
    ds_read_b128 v[72:75], v136 offset:3072
    v_fmac_f32 v92, v33, v33
    v_mfma_f32_16x16x32_bf16 v[80:83], v[8:11], v[56:59], 0
    ds_read_b128 v[48:51], v137 offset:3200
    v_fmac_f32 v92, v34, v34
    v_mfma_f32_16x16x32_bf16 v[80:83], v[160:163], v[168:171], v[80:83]
    ds_read_b128 v[68:71], v136 offset:3200
    v_fmac_f32 v92, v35, v35
    v_mfma_f32_16x16x32_bf16 v[52:55], v[12:15], v[56:59], 0
    ds_read_b128 v[56:59], v137 offset:3328
    v_add_u32 v137, s48, v137
    v_mfma_f32_16x16x32_bf16 v[52:55], v[156:159], v[168:171], v[52:55]
    buffer_store_dwordx4 v[60:63], v125, s[28:31], s60 offen sc1
    ds_read_b128 v[94:97], v136 offset:3328
    v_rcp_f32 v88, v88
    v_add_u32 v136, s48, v136
    v_mfma_f32_16x16x32_f16 v[60:63], v[16:19], v[44:47], v[180:183]
    s_add_u32 m0, s67, 4096
    ds_read_b128 v[16:19], v133 offset:4096
    v_mul_f32 v76, v76, v88
    v_mfma_f32_16x16x32_f16 v[60:63], v[152:155], v[138:141], v[60:63]
    s_cmp_lg_u32 s5, -1
    v_mul_f32 v77, v77, v88
    v_cvt_pk_bf16_f32 v76, v76, v77
    v_mfma_f32_16x16x32_f16 v[152:155], v[36:39], v[44:47], v[176:179]
    v_mul_f32 v78, v78, v88
    v_mul_f32 v79, v79, v88
    v_mfma_f32_16x16x32_f16 v[152:155], v[146:149], v[138:141], v[152:155]
    v_cvt_pk_bf16_f32 v77, v78, v79
    v_mul_f32 v80, v80, v88
    v_mfma_f32_16x16x32_f16 v[36:39], v[40:43], v[44:47], v[172:175]
    ds_write_b64 v135, v[76:77] offset:1536
    v_mfma_f32_16x16x32_f16 v[36:39], v[140:143], v[138:141], v[36:39]
    s_waitcnt lgkmcnt(4)
    v_mul_f32 v81, v81, v88
    v_cvt_pk_bf16_f32 v78, v80, v81
    v_mfma_f32_16x16x32_bf16 v[40:43], a[216:219], v[64:67], 0
    v_mul_f32 v82, v82, v88
    v_mul_f32 v83, v83, v88
    v_mfma_f32_16x16x32_bf16 v[40:43], a[220:223], v[72:75], v[40:43]
    v_cvt_pk_bf16_f32 v79, v82, v83
    v_mul_f32 v52, v52, v88
    v_mfma_f32_16x16x32_bf16 v[40:43], a[224:227], v[48:51], v[40:43]
    ds_write_b64 v135, v[78:79] offset:1544
    v_mfma_f32_16x16x32_bf16 v[40:43], a[228:231], v[68:71], v[40:43]
    s_waitcnt lgkmcnt(2)
    buffer_load_dwordx4 v124, s[24:27], s56 offen nt lds
    v_mul_f32 v53, v53, v88
    v_mfma_f32_16x16x32_bf16 v[40:43], a[232:235], v[56:59], v[40:43]
    v_cvt_pk_bf16_f32 v168, v52, v53
    v_mul_f32 v54, v54, v88
    v_mfma_f32_16x16x32_bf16 v[40:43], a[236:239], v[94:97], v[40:43]
    v_mul_f32 v55, v55, v88
    v_cvt_pk_bf16_f32 v169, v54, v55
    v_mfma_f32_16x16x32_bf16 v[140:143], a[240:243], v[64:67], 0
    ds_write_b64 v134, v[168:169] offset:1536
    v_mfma_f32_16x16x32_bf16 v[140:143], a[244:247], v[72:75], v[140:143]
    v_max3_f32 v168, v60, v61, v62
    v_max3_f32 v168, v168, v63, v152
    v_mfma_f32_16x16x32_bf16 v[140:143], a[248:251], v[48:51], v[140:143]
    v_max3_f32 v168, v168, v153, v154
    v_max3_f32 v168, v168, v155, v36
    v_mfma_f32_16x16x32_bf16 v[140:143], a[252:255], v[68:71], v[140:143]
    v_max3_f32 v168, v168, v37, v38
    v_max3_f32 v168, v168, v39, v86
    v_mfma_f32_16x16x32_bf16 v[140:143], v[224:227], v[56:59], v[140:143]
    buffer_store_dwordx4 v[16:19], v124, s[28:31], s60 offen sc1
    v_mov_b32 v169, v168
    v_fmac_f32 v92, v4, v4
    v_fmac_f32 v92, v5, v5
    v_fmac_f32 v92, v6, v6
    v_mfma_f32_16x16x32_bf16 v[140:143], v[228:231], v[94:97], v[140:143]
    ds_read_b128 v[16:19], v137 offset:0
    v_fmac_f32 v92, v7, v7
    v_mfma_f32_16x16x32_bf16 v[44:47], v[232:235], v[64:67], 0
    ds_read_b128 v[146:149], v136 offset:0
    v_fmac_f32 v92, v24, v24
    v_mfma_f32_16x16x32_bf16 v[44:47], v[236:239], v[72:75], v[44:47]
    ds_read_b128 v[72:75], v137 offset:128
    v_fmac_f32 v92, v25, v25
    v_mfma_f32_16x16x32_bf16 v[44:47], v[240:243], v[48:51], v[44:47]
    ds_read_b128 v[88:91], v136 offset:128
    v_fmac_f32 v92, v26, v26
    v_mfma_f32_16x16x32_bf16 v[44:47], v[244:247], v[68:71], v[44:47]
    ds_read_b128 v[76:79], v137 offset:256
    v_fmac_f32 v92, v27, v27
    v_mfma_f32_16x16x32_bf16 v[44:47], v[248:251], v[56:59], v[44:47]
    ds_read_b128 v[56:59], v136 offset:256
    v_fma_f32 v93, v28, v28, s42
    v_mfma_f32_16x16x32_bf16 v[44:47], v[252:255], v[94:97], v[44:47]
    v_permlane32_swap_b32 v169, v168
    v_max_f32 v168, v169, v168
    v_mov_b32 v169, v168
    v_fmac_f32 v93, v29, v29
    v_fmac_f32 v93, v30, v30
    v_permlane16_swap_b32 v169, v168
    v_max_f32 v168, v169, v168
    v_sub_f32 v60, v60, v168
    v_sub_f32 v61, v61, v168
    v_sub_f32 v62, v62, v168
    v_sub_f32 v63, v63, v168
    v_sub_f32 v152, v152, v168
    v_sub_f32 v153, v153, v168
    v_sub_f32 v154, v154, v168
    v_sub_f32 v155, v155, v168
    v_sub_f32 v36, v36, v168
    v_sub_f32 v37, v37, v168
    v_sub_f32 v38, v38, v168
    v_sub_f32 v39, v39, v168
    v_sub_f32 v86, v86, v168
    v_exp_f32 v60, v60
    v_exp_f32 v61, v61
    v_exp_f32 v62, v62
    v_exp_f32 v63, v63
    v_cvt_pk_bf16_f32 v60, v60, v61
    v_cvt_pk_bf16_f32 v61, v62, v63
    v_exp_f32 v152, v152
    v_exp_f32 v153, v153
    v_exp_f32 v154, v154
    v_exp_f32 v155, v155
    v_cvt_pk_bf16_f32 v62, v152, v153
    v_cvt_pk_bf16_f32 v63, v154, v155
    v_exp_f32 v36, v36
    v_exp_f32 v37, v37
    v_exp_f32 v38, v38
    v_exp_f32 v39, v39
    v_cvt_pk_bf16_f32 v168, v36, v37
    v_cvt_pk_bf16_f32 v169, v38, v39
    v_exp_f32 v86, v86
    v_fmac_f32 v93, v31, v31
    v_cvt_pk_bf16_f32 v170, v86, 0
    v_mfma_f32_16x16x32_bf16 v[152:155], v[220:223], v[60:63], 0
    v_fmac_f32 v93, v20, v20
    v_fmac_f32 v93, v21, v21
    v_mfma_f32_16x16x32_bf16 v[152:155], v[220:223], v[168:171], v[152:155]
    v_fmac_f32 v93, v22, v22
    v_fmac_f32 v93, v23, v23
    v_mfma_f32_16x16x32_bf16 v[36:39], v[0:3], v[60:63], 0
    s_nop 0
    v_fmac_f32 v93, v114, v114
    v_fmac_f32 v93, v115, v115
    v_mfma_f32_16x16x32_bf16 v[36:39], v[164:167], v[168:171], v[36:39]
    s_nop 0
    v_rcp_f32 v152, v152
    v_mfma_f32_16x16x32_bf16 v[0:3], v[8:11], v[60:63], 0
    s_nop 0
    v_fmac_f32 v93, v116, v116
    v_fmac_f32 v93, v117, v117
    v_mfma_f32_16x16x32_bf16 v[0:3], v[160:163], v[168:171], v[0:3]
    s_nop 0
    v_mul_f32 v36, v36, v152
    v_mul_f32 v37, v37, v152
    v_mfma_f32_16x16x32_bf16 v[8:11], v[12:15], v[60:63], 0
    v_cvt_pk_bf16_f32 v12, v36, v37
    v_mul_f32 v38, v38, v152
    v_mfma_f32_16x16x32_bf16 v[8:11], v[156:159], v[168:171], v[8:11]
    s_waitcnt lgkmcnt(0)
    v_mul_f32 v39, v39, v152
    v_cvt_pk_bf16_f32 v13, v38, v39
    v_mfma_f32_16x16x32_bf16 v[36:39], a[0:3], v[16:19], 0
    s_cbranch_scc1 L_loopS0
    ds_write_b64 v135, v[12:13] offset:3072
    v_mul_f32 v0, v0, v152
    v_mul_f32 v1, v1, v152
    v_cvt_pk_bf16_f32 v14, v0, v1
    v_mul_f32 v2, v2, v152
    v_mul_f32 v3, v3, v152
    v_cvt_pk_bf16_f32 v15, v2, v3
    v_mul_f32 v8, v8, v152
    v_mul_f32 v9, v9, v152
    v_cvt_pk_bf16_f32 v8, v8, v9
    v_mul_f32 v10, v10, v152
    v_mul_f32 v11, v11, v152
    v_cvt_pk_bf16_f32 v9, v10, v11
    s_mov_b32 s30, 100270464
    s_mul_i32 s89, s68, 7168
    ds_write_b64 v135, v[14:15] offset:3080
    v_fma_f32 v113, v40, v40, s42
    s_add_u32 s89, s89, 135168
    s_movk_i32 s90, 112
    ds_write_b64 v134, v[8:9] offset:3072
    v_fmac_f32 v113, v41, v41
    v_fmac_f32 v113, v42, v42
    v_fmac_f32 v113, v43, v43
    v_fmac_f32 v113, v140, v140
    v_fmac_f32 v113, v141, v141
    v_fmac_f32 v113, v142, v142
    v_fmac_f32 v113, v143, v143
    v_fmac_f32 v113, v44, v44
    v_fmac_f32 v113, v45, v45
    v_fmac_f32 v113, v46, v46
    v_fmac_f32 v113, v47, v47
    v_cvt_pk_bf16_f32 v112, v92, v93
    v_cvt_pk_bf16_f32 v113, v113, v122
    s_lshr_b32 s91, s64, 16
    s_lshl_b32 s92, s68, 10
    ds_write_b64 v130, v[112:113]
    v_mbcnt_lo_u32_b32 v131, -1, 0
    v_mbcnt_hi_u32_b32 v131, -1, v131
    v_and_b32 v132, 15, v131
    v_lshrrev_b32 v131, 4, v131
    v_mul_u32_u24 v118, 1792, v131
    v_add_u32 v118, s89, v118
    v_mad_u32_u24 v131, v132, s90, v118
    v_lshrrev_b32 v119, v132, s64
    v_and_b32 v119, 1, v119
    v_cmp_eq_u32 vcc, 1, v119
    v_mad_u32_u24 v119, v132, s90, v118
    v_lshrrev_b32 v132, v132, s91
    v_cndmask_b32 v131, v118, v131, vcc
    v_and_b32 v132, 1, v132
    v_subrev_u32 v119, 28672, v119
    v_cmp_eq_u32 vcc, 1, v132
    s_sub_u32 s84, s45, s44
    s_sub_u32 s85, s46, s45
    ds_read_b128 v[48:51], v131 offset:64
    ds_read_b128 v[36:39], v131 offset:80
    v_cndmask_b32 v119, v118, v119, vcc
    v_add_u32 v118, s92, v129
    s_waitcnt lgkmcnt(2)
    s_barrier
    s_sub_u32 s86, s44, s45
    ds_read_b128 v[86:89], v131
    v_add_u32 v139, s84, v137
    s_sub_u32 s93, s44, s47
    s_sub_u32 s94, s45, s47
    ds_read_b64 v[90:91], v131 offset:16
    ds_read_b128 v[8:11], v118 offset:6144
    v_add_u32 v138, s84, v136
    v_add_u32 v118, s85, v135
    s_sub_u32 s95, s46, s47
    ds_read_b128 v[16:19], v129 offset:0
    v_add_u32 v63, s85, v134
    ds_read_b128 v[0:3], v129 offset:1024
    v_add_u32 v112, s86, v135
    v_add_u32 v132, s86, v134
    v_add_u32 v131, s93, v133
    v_add_u32 v113, s94, v133
    s_waitcnt lgkmcnt(6)
    v_mfma_f32_16x16x32_bf16 v[12:15], v[220:223], v[48:51], 0
    s_waitcnt lgkmcnt(5)
    ds_read_b128 v[80:83], v139 offset:1536
    ds_read_b128 v[76:79], v138 offset:1536
    v_mfma_f32_16x16x32_bf16 v[12:15], v[220:223], v[36:39], v[12:15]
    s_waitcnt lgkmcnt(3)
    ds_read_b128 v[72:75], v139 offset:1664
    v_lshlrev_b32 v92, 16, v86
    v_and_b32 v86, 0xffff0000, v86
    v_lshlrev_b32 v93, 16, v87
    v_and_b32 v87, 0xffff0000, v87
    v_lshlrev_b32 v94, 16, v88
    v_and_b32 v88, 0xffff0000, v88
    v_rcp_f32 v12, v12
    v_lshlrev_b32 v95, 16, v89
    v_mfma_f32_16x16x32_bf16 v[64:67], v[216:219], v[16:19], 0
    s_waitcnt lgkmcnt(3)
    ds_read_b128 v[68:71], v138 offset:1664
    ds_read_b128 v[48:51], v139 offset:1792
    v_mfma_f32_16x16x32_bf16 v[64:67], v[216:219], v[0:3], v[64:67]
    s_waitcnt lgkmcnt(4)
    ds_read_b128 v[16:19], v138 offset:1792
    v_mul_f32 v92, v92, v12
    v_mul_f32 v86, v86, v12
    v_cvt_pk_bf16_f32 v92, v92, v86
    v_mul_f32 v93, v93, v12
    v_mfma_f32_16x16x32_bf16 v[0:3], a[216:219], v[80:83], 0
    s_waitcnt lgkmcnt(4)
    v_mul_f32 v87, v87, v12
    v_cvt_pk_bf16_f32 v93, v93, v87
    v_mfma_f32_16x16x32_bf16 v[0:3], a[220:223], v[76:79], v[0:3]
    s_waitcnt lgkmcnt(3)
    ds_read_b128 v[108:111], v139 offset:0
    ds_read_b128 v[104:107], v138 offset:0
    v_mfma_f32_16x16x32_bf16 v[0:3], a[224:227], v[72:75], v[0:3]
    s_waitcnt lgkmcnt(4)
    ds_read_b128 v[96:99], v139 offset:128
    v_mul_f32 v94, v94, v12
    v_mul_f32 v88, v88, v12
    v_cvt_pk_bf16_f32 v94, v94, v88
    v_and_b32 v89, 0xffff0000, v89
    v_mul_f32 v95, v95, v12
    v_mfma_f32_16x16x32_bf16 v[0:3], a[228:231], v[68:71], v[0:3]
    s_waitcnt lgkmcnt(4)
    ds_read_b128 v[84:87], v138 offset:128
    ds_read_b128 v[56:59], v139 offset:256
    v_mfma_f32_16x16x32_bf16 v[0:3], a[232:235], v[48:51], v[0:3]
    s_waitcnt lgkmcnt(5)
    ds_read_b128 v[36:39], v138 offset:256
    v_mul_f32 v89, v89, v12
    v_mfma_f32_16x16x32_bf16 v[0:3], a[236:239], v[16:19], v[0:3]
    v_cvt_pk_bf16_f32 v95, v95, v89
    v_lshlrev_b32 v67, 16, v90
    v_mfma_f32_16x16x32_bf16 v[52:55], a[240:243], v[80:83], 0
    ds_write_b128 v112, v[92:95] offset:0
    v_mfma_f32_16x16x32_bf16 v[52:55], a[244:247], v[76:79], v[52:55]
    v_and_b32 v90, 0xffff0000, v90
    v_mul_f32 v67, v67, v12
    v_mfma_f32_16x16x32_bf16 v[52:55], a[248:251], v[72:75], v[52:55]
    v_mul_f32 v90, v90, v12
    v_cvt_pk_bf16_f32 v60, v67, v90
    v_mfma_f32_16x16x32_bf16 v[52:55], a[252:255], v[68:71], v[52:55]
    v_lshlrev_b32 v67, 16, v91
    v_and_b32 v91, 0xffff0000, v91
    v_mfma_f32_16x16x32_bf16 v[52:55], v[224:227], v[48:51], v[52:55]
    v_mul_f32 v67, v67, v12
    v_mul_f32 v91, v91, v12
    v_mfma_f32_16x16x32_bf16 v[52:55], v[228:231], v[16:19], v[52:55]
    v_cvt_pk_bf16_f32 v61, v67, v91
    v_lshrrev_b32 v67, 0, v11
    v_mfma_f32_16x16x32_bf16 v[12:15], v[232:235], v[80:83], 0
    ds_write_b64 v132, v[60:61] offset:0
    v_mfma_f32_16x16x32_bf16 v[12:15], v[236:239], v[76:79], v[12:15]
    v_lshrrev_b32 v67, v67, s64
    v_and_b32 v67, 1, v67
    v_mfma_f32_16x16x32_bf16 v[12:15], v[240:243], v[72:75], v[12:15]
    v_cmp_eq_u32 vcc, 1, v67
    v_lshrrev_b32 v67, 8, v11
    v_mfma_f32_16x16x32_bf16 v[12:15], v[244:247], v[68:71], v[12:15]
    v_cndmask_b32 v8, 2.0, v8, vcc
    v_lshrrev_b32 v67, v67, s64
    v_mfma_f32_16x16x32_bf16 v[12:15], v[248:251], v[48:51], v[12:15]
    v_and_b32 v67, 1, v67
    v_cmp_eq_u32 vcc, 1, v67
    v_mfma_f32_16x16x32_bf16 v[12:15], v[252:255], v[16:19], v[12:15]
    s_waitcnt lgkmcnt(1)
    v_cndmask_b32 v9, 2.0, v9, vcc
    v_lshrrev_b32 v11, 16, v11
    v_mfma_f32_16x16x32_bf16 v[72:75], a[216:219], v[108:111], 0
    v_lshrrev_b32 v11, v11, s64
    v_and_b32 v11, 1, v11
    v_mfma_f32_16x16x32_bf16 v[72:75], a[220:223], v[104:107], v[72:75]
    ds_read_b128 v[100:103], v139 offset:3072
    ds_read_b128 v[92:95], v138 offset:3072
    v_mfma_f32_16x16x32_bf16 v[72:75], a[224:227], v[96:99], v[72:75]
    ds_read_b128 v[88:91], v139 offset:3200
    v_cmp_eq_u32 vcc, 1, v11
    v_mfma_f32_16x16x32_bf16 v[72:75], a[228:231], v[84:87], v[72:75]
    ds_read_b128 v[80:83], v138 offset:3200
    v_cndmask_b32 v10, 2.0, v10, vcc
    v_mfma_f32_16x16x32_bf16 v[72:75], a[232:235], v[56:59], v[72:75]
    ds_read_b128 v[76:79], v139 offset:3328
    v_add_u32 v11, s95, v133
    v_mfma_f32_16x16x32_bf16 v[72:75], a[236:239], v[36:39], v[72:75]
    ds_read_b128 v[16:19], v138 offset:3328
    v_fma_f32 v133, v0, v0, s42
    v_mfma_f32_16x16x32_bf16 v[48:51], a[240:243], v[108:111], 0
    v_rsq_f32 v64, v64
    v_mfma_f32_16x16x32_bf16 v[48:51], a[244:247], v[104:107], v[48:51]
    v_mul_f32 v64, s43, v64
    v_mul_f32 v32, v32, v64
    v_mfma_f32_16x16x32_bf16 v[48:51], a[248:251], v[96:99], v[48:51]
    v_mul_f32 v33, v33, v64
    v_cvt_pk_bf16_f32 v32, v32, v33
    v_mfma_f32_16x16x32_bf16 v[48:51], a[252:255], v[84:87], v[48:51]
    v_mul_f32 v34, v34, v64
    v_mul_f32 v35, v35, v64
    v_mfma_f32_16x16x32_bf16 v[48:51], v[224:227], v[56:59], v[48:51]
    v_cvt_pk_bf16_f32 v33, v34, v35
    v_mul_f32 v4, v4, v64
    v_mfma_f32_16x16x32_bf16 v[48:51], v[228:231], v[36:39], v[48:51]
    v_mul_f32 v5, v5, v64
    v_cvt_pk_bf16_f32 v34, v4, v5
    v_mfma_f32_16x16x32_bf16 v[68:71], v[232:235], v[108:111], 0
    v_mul_f32 v6, v6, v64
    v_mul_f32 v7, v7, v64
    v_mfma_f32_16x16x32_bf16 v[68:71], v[236:239], v[104:107], v[68:71]
    v_cvt_pk_bf16_f32 v35, v6, v7
    v_mul_f32 v24, v24, v64
    v_mfma_f32_16x16x32_bf16 v[68:71], v[240:243], v[96:99], v[68:71]
    ds_write_b128 v118, v[32:35] offset:0
    v_mfma_f32_16x16x32_bf16 v[68:71], v[244:247], v[84:87], v[68:71]
    v_mul_f32 v25, v25, v64
    v_cvt_pk_bf16_f32 v24, v24, v25
    v_mfma_f32_16x16x32_bf16 v[68:71], v[248:251], v[56:59], v[68:71]
    v_mul_f32 v26, v26, v64
    v_mul_f32 v27, v27, v64
    v_mfma_f32_16x16x32_bf16 v[68:71], v[252:255], v[36:39], v[68:71]
    s_waitcnt lgkmcnt(1)
    v_cvt_pk_bf16_f32 v25, v26, v27
    v_fma_f32 v62, v72, v72, s42
    v_mfma_f32_16x16x32_bf16 v[84:87], a[216:219], v[100:103], 0
    ds_write_b64 v63, v[24:25] offset:0
    v_mfma_f32_16x16x32_bf16 v[84:87], a[220:223], v[92:95], v[84:87]
    ds_read_b128 v[24:27], v119 offset:64
    v_fmac_f32 v62, v73, v73
    v_mfma_f32_16x16x32_bf16 v[84:87], a[224:227], v[88:91], v[84:87]
    ds_read_b128 v[4:7], v119 offset:80
    v_fmac_f32 v62, v74, v74
    v_mfma_f32_16x16x32_bf16 v[84:87], a[228:231], v[80:83], v[84:87]
    ds_read_b128 v[56:59], v119
    v_fmac_f32 v62, v75, v75
    v_mfma_f32_16x16x32_bf16 v[84:87], a[232:235], v[76:79], v[84:87]
    ds_read_b64 v[60:61], v119 offset:16
    v_fmac_f32 v62, v48, v48
    v_mfma_f32_16x16x32_bf16 v[84:87], a[236:239], v[16:19], v[84:87]
    v_rsq_f32 v65, v65
    v_mfma_f32_16x16x32_bf16 v[96:99], a[240:243], v[100:103], 0
    v_mul_f32 v65, s43, v65
    v_mul_f32 v28, v28, v65
    v_mfma_f32_16x16x32_bf16 v[96:99], a[244:247], v[92:95], v[96:99]
    v_mul_f32 v29, v29, v65
    v_cvt_pk_bf16_f32 v28, v28, v29
    v_mfma_f32_16x16x32_bf16 v[96:99], a[248:251], v[88:91], v[96:99]
    v_mul_f32 v30, v30, v65
    v_mul_f32 v31, v31, v65
    v_mfma_f32_16x16x32_bf16 v[96:99], a[252:255], v[80:83], v[96:99]
    v_cvt_pk_bf16_f32 v29, v30, v31
    v_mul_f32 v20, v20, v65
    v_mfma_f32_16x16x32_bf16 v[96:99], v[224:227], v[76:79], v[96:99]
    v_mul_f32 v21, v21, v65
    v_cvt_pk_bf16_f32 v30, v20, v21
    v_mfma_f32_16x16x32_bf16 v[96:99], v[228:231], v[16:19], v[96:99]
    v_mul_f32 v22, v22, v65
    v_mul_f32 v23, v23, v65
    v_mfma_f32_16x16x32_bf16 v[36:39], v[232:235], v[100:103], 0
    v_cvt_pk_bf16_f32 v31, v22, v23
    v_mul_f32 v114, v114, v65
    v_mfma_f32_16x16x32_bf16 v[36:39], v[236:239], v[92:95], v[36:39]
    ds_write_b128 v118, v[28:31] offset:1536
    v_mfma_f32_16x16x32_bf16 v[36:39], v[240:243], v[88:91], v[36:39]
    v_mul_f32 v115, v115, v65
    v_cvt_pk_bf16_f32 v114, v114, v115
    v_mfma_f32_16x16x32_bf16 v[36:39], v[244:247], v[80:83], v[36:39]
    v_mul_f32 v116, v116, v65
    v_mul_f32 v117, v117, v65
    v_mfma_f32_16x16x32_bf16 v[36:39], v[248:251], v[76:79], v[36:39]
    v_cvt_pk_bf16_f32 v115, v116, v117
    v_fmac_f32 v62, v49, v49
    v_mfma_f32_16x16x32_bf16 v[36:39], v[252:255], v[16:19], v[36:39]
    s_waitcnt lgkmcnt(1)
    ds_write_b64 v63, v[114:115] offset:1536
    v_mfma_f32_16x16x32_bf16 v[16:19], v[220:223], v[24:27], 0
    v_rsq_f32 v66, v66
    v_mfma_f32_16x16x32_bf16 v[16:19], v[220:223], v[4:7], v[16:19]
    v_mul_f32 v66, s43, v66
    v_mul_f32 v40, v40, v66
    v_mul_f32 v41, v41, v66
    v_cvt_pk_bf16_f32 v4, v40, v41
    v_mul_f32 v42, v42, v66
    v_mul_f32 v43, v43, v66
    v_cvt_pk_bf16_f32 v5, v42, v43
    v_mul_f32 v140, v140, v66
    v_mul_f32 v141, v141, v66
    v_cvt_pk_bf16_f32 v6, v140, v141
    v_mul_f32 v142, v142, v66
    v_mul_f32 v143, v143, v66
    v_cvt_pk_bf16_f32 v7, v142, v143
    v_mul_f32 v44, v44, v66
    v_mul_f32 v45, v45, v66
    v_cvt_pk_bf16_f32 v44, v44, v45
    v_mul_f32 v46, v46, v66
    v_mul_f32 v47, v47, v66
    v_cvt_pk_bf16_f32 v45, v46, v47
    ds_write_b128 v118, v[4:7] offset:3072
    v_fmac_f32 v62, v50, v50
    v_fmac_f32 v62, v51, v51
    v_fmac_f32 v62, v68, v68
    v_fmac_f32 v62, v69, v69
    ds_write_b64 v63, v[44:45] offset:3072
    v_fmac_f32 v62, v70, v70
    v_fmac_f32 v62, v71, v71
    v_fmac_f32 v133, v1, v1
    v_fmac_f32 v133, v2, v2
    v_fmac_f32 v133, v3, v3
    v_fmac_f32 v133, v52, v52
    v_fmac_f32 v133, v53, v53
    v_fmac_f32 v133, v54, v54
    v_fmac_f32 v133, v55, v55
    v_fmac_f32 v133, v12, v12
    v_fmac_f32 v133, v13, v13
    v_fmac_f32 v133, v14, v14
    v_fmac_f32 v133, v15, v15
    v_cvt_pk_bf16_f32 v62, v62, v133
    v_fma_f32 v63, v84, v84, s42
    v_fmac_f32 v63, v85, v85
    v_fmac_f32 v63, v86, v86
    v_fmac_f32 v63, v87, v87
    v_fmac_f32 v63, v96, v96
    v_fmac_f32 v63, v97, v97
    v_fmac_f32 v63, v98, v98
    v_fmac_f32 v63, v99, v99
    v_fmac_f32 v63, v36, v36
    v_fmac_f32 v63, v37, v37
    v_fmac_f32 v63, v38, v38
    v_fmac_f32 v63, v39, v39
    v_cvt_pk_bf16_f32 v63, v63, v63
    ds_write_b64 v130, v[62:63] offset:2048
    v_rcp_f32 v16, v16
    v_lshlrev_b32 v133, 16, v56
    v_and_b32 v56, 0xffff0000, v56
    v_mul_f32 v133, v133, v16
    v_mul_f32 v56, v56, v16
    v_cvt_pk_bf16_f32 v4, v133, v56
    v_lshlrev_b32 v56, 16, v57
    v_and_b32 v57, 0xffff0000, v57
    v_mul_f32 v56, v56, v16
    v_mul_f32 v57, v57, v16
    v_cvt_pk_bf16_f32 v5, v56, v57
    v_lshlrev_b32 v133, 16, v58
    v_and_b32 v58, 0xffff0000, v58
    v_mul_f32 v133, v133, v16
    v_mul_f32 v58, v58, v16
    v_cvt_pk_bf16_f32 v6, v133, v58
    v_lshlrev_b32 v7, 16, v59
    v_and_b32 v59, 0xffff0000, v59
    v_mul_f32 v7, v7, v16
    v_mul_f32 v59, v59, v16
    v_cvt_pk_bf16_f32 v7, v7, v59
    v_lshlrev_b32 v133, 16, v60
    v_and_b32 v60, 0xffff0000, v60
    v_mul_f32 v133, v133, v16
    v_mul_f32 v60, v60, v16
    v_cvt_pk_bf16_f32 v138, v133, v60
    v_lshlrev_b32 v133, 16, v61
    v_and_b32 v61, 0xffff0000, v61
    v_mul_f32 v133, v133, v16
    v_mul_f32 v61, v61, v16
    v_cvt_pk_bf16_f32 v139, v133, v61
    s_waitcnt lgkmcnt(0)
    s_barrier
    ds_write_b128 v112, v[4:7] offset:1536
    v_mov_b32 v115, 0
    ds_write_b64 v132, v[138:139] offset:1536
    ds_read_b128 v[32:35], v11 offset:0
    ds_read_b128 v[4:7], v11 offset:1024
    ds_read_b128 v[24:27], v11 offset:2048
    ds_read_b128 v[20:23], v11 offset:3072
    ds_read_b128 v[80:83], v11 offset:4096
    s_waitcnt lgkmcnt(5)
    s_barrier
    s_waitcnt lgkmcnt(4)
    buffer_store_dwordx4 v[32:35], v128, s[28:31], s59 offen sc1
    ds_read_b128 v[28:31], v129 offset:2048
    ds_read_b128 v[16:19], v129 offset:3072
    ds_read_b128 v[104:107], v137 offset:1536
    ds_read_b128 v[100:103], v136 offset:1536
    ds_read_b128 v[92:95], v137 offset:1664
    ds_read_b128 v[88:91], v136 offset:1664
    ds_read_b128 v[76:79], v137 offset:1792
    s_waitcnt lgkmcnt(9)
    buffer_store_dwordx4 v[4:7], v127, s[28:31], s59 offen sc1
    ds_read_b128 v[40:43], v136 offset:1792
    s_waitcnt lgkmcnt(7)
    v_mfma_f32_16x16x32_bf16 v[4:7], v[216:219], v[28:31], 0
    s_waitcnt lgkmcnt(6)
    v_mfma_f32_16x16x32_bf16 v[4:7], v[216:219], v[16:19], v[4:7]
    s_waitcnt lgkmcnt(5)
    v_mfma_f32_16x16x32_bf16 v[16:19], a[216:219], v[104:107], 0
    s_waitcnt lgkmcnt(4)
    v_mfma_f32_16x16x32_bf16 v[16:19], a[220:223], v[100:103], v[16:19]
    s_waitcnt lgkmcnt(3)
    ds_read_b128 v[64:67], v137 offset:0
    ds_read_b128 v[60:63], v136 offset:0
    v_mfma_f32_16x16x32_bf16 v[16:19], a[224:227], v[92:95], v[16:19]
    s_waitcnt lgkmcnt(4)
    ds_read_b128 v[56:59], v137 offset:128
    v_mfma_f32_16x16x32_bf16 v[16:19], a[228:231], v[88:91], v[16:19]
    s_waitcnt lgkmcnt(4)
    buffer_store_dwordx4 v[24:27], v126, s[28:31], s59 offen sc1
    ds_read_b128 v[44:47], v136 offset:128
    v_rsq_f32 v4, v4
    v_mfma_f32_16x16x32_bf16 v[16:19], a[232:235], v[76:79], v[16:19]
    s_waitcnt lgkmcnt(4)
    ds_read_b128 v[32:35], v137 offset:256
    ds_read_b128 v[24:27], v136 offset:256
    v_mfma_f32_16x16x32_bf16 v[16:19], a[236:239], v[40:43], v[16:19]
    v_rsq_f32 v5, v5
    v_mfma_f32_16x16x32_bf16 v[28:31], a[240:243], v[104:107], 0
    v_mul_f32 v4, s43, v4
    v_mul_f32 v5, s43, v5
    v_mfma_f32_16x16x32_bf16 v[28:31], a[244:247], v[100:103], v[28:31]
    v_rsq_f32 v6, v6
    v_mfma_f32_16x16x32_bf16 v[28:31], a[248:251], v[92:95], v[28:31]
    v_mul_f32 v6, s43, v6
    v_mul_f32 v84, v84, v6
    v_mfma_f32_16x16x32_bf16 v[28:31], a[252:255], v[88:91], v[28:31]
    buffer_store_dwordx4 v[20:23], v125, s[28:31], s59 offen sc1
    v_mul_f32 v85, v85, v6
    v_cvt_pk_bf16_f32 v84, v84, v85
    v_mul_f32 v86, v86, v6
    v_mul_f32 v87, v87, v6
    v_mfma_f32_16x16x32_bf16 v[28:31], v[224:227], v[76:79], v[28:31]
    v_cvt_pk_bf16_f32 v85, v86, v87
    v_mul_f32 v96, v96, v6
    v_mfma_f32_16x16x32_bf16 v[28:31], v[228:231], v[40:43], v[28:31]
    v_mul_f32 v97, v97, v6
    v_cvt_pk_bf16_f32 v86, v96, v97
    v_mfma_f32_16x16x32_bf16 v[20:23], v[232:235], v[104:107], 0
    v_mul_f32 v98, v98, v6
    v_mul_f32 v99, v99, v6
    v_mfma_f32_16x16x32_bf16 v[20:23], v[236:239], v[100:103], v[20:23]
    v_cvt_pk_bf16_f32 v87, v98, v99
    v_mul_f32 v36, v36, v6
    v_mfma_f32_16x16x32_bf16 v[20:23], v[240:243], v[92:95], v[20:23]
    ds_write_b128 v135, v[84:87] offset:3072
    v_mfma_f32_16x16x32_bf16 v[20:23], v[244:247], v[88:91], v[20:23]
    buffer_store_dwordx4 v[80:83], v124, s[28:31], s59 offen sc1
    v_mul_f32 v37, v37, v6
    v_cvt_pk_bf16_f32 v36, v36, v37
    v_mul_f32 v38, v38, v6
    v_mul_f32 v39, v39, v6
    v_mfma_f32_16x16x32_bf16 v[20:23], v[248:251], v[76:79], v[20:23]
    v_cvt_pk_bf16_f32 v37, v38, v39
    v_mul_f32 v72, v72, v4
    v_mfma_f32_16x16x32_bf16 v[20:23], v[252:255], v[40:43], v[20:23]
    s_waitcnt lgkmcnt(1)
    ds_write_b64 v134, v[36:37] offset:3072
    v_mfma_f32_16x16x32_bf16 v[36:39], a[216:219], v[64:67], 0
    v_mul_f32 v73, v73, v4
    v_cvt_pk_bf16_f32 v40, v72, v73
    v_mfma_f32_16x16x32_bf16 v[36:39], a[220:223], v[60:63], v[36:39]
    v_mul_f32 v74, v74, v4
    v_mul_f32 v75, v75, v4
    v_mfma_f32_16x16x32_bf16 v[36:39], a[224:227], v[56:59], v[36:39]
    v_cvt_pk_bf16_f32 v41, v74, v75
    v_mul_f32 v48, v48, v4
    v_mfma_f32_16x16x32_bf16 v[36:39], a[228:231], v[44:47], v[36:39]
    v_mul_f32 v49, v49, v4
    v_cvt_pk_bf16_f32 v42, v48, v49
    v_mfma_f32_16x16x32_bf16 v[36:39], a[232:235], v[32:35], v[36:39]
    v_mul_f32 v50, v50, v4
    v_mul_f32 v51, v51, v4
    v_mfma_f32_16x16x32_bf16 v[36:39], a[236:239], v[24:27], v[36:39]
    v_cvt_pk_bf16_f32 v43, v50, v51
    v_mul_f32 v68, v68, v4
    v_mfma_f32_16x16x32_bf16 v[48:51], a[240:243], v[64:67], 0
    ds_write_b128 v135, v[40:43] offset:0
    v_mfma_f32_16x16x32_bf16 v[48:51], a[244:247], v[60:63], v[48:51]
    v_mul_f32 v69, v69, v4
    v_cvt_pk_bf16_f32 v6, v68, v69
    v_mfma_f32_16x16x32_bf16 v[48:51], a[248:251], v[56:59], v[48:51]
    v_mul_f32 v70, v70, v4
    v_mul_f32 v71, v71, v4
    v_mfma_f32_16x16x32_bf16 v[48:51], a[252:255], v[44:47], v[48:51]
    v_cvt_pk_bf16_f32 v7, v70, v71
    v_fma_f32 v11, v16, v16, s42
    v_mfma_f32_16x16x32_bf16 v[48:51], v[224:227], v[32:35], v[48:51]
    ds_write_b64 v134, v[6:7] offset:0
    v_mfma_f32_16x16x32_bf16 v[48:51], v[228:231], v[24:27], v[48:51]
    v_fmac_f32 v11, v17, v17
    v_fmac_f32 v11, v18, v18
    v_mfma_f32_16x16x32_bf16 v[40:43], v[232:235], v[64:67], 0
    v_fmac_f32 v11, v19, v19
    v_fmac_f32 v11, v28, v28
    v_mfma_f32_16x16x32_bf16 v[40:43], v[236:239], v[60:63], v[40:43]
    v_fmac_f32 v11, v29, v29
    v_fmac_f32 v11, v30, v30
    v_mfma_f32_16x16x32_bf16 v[40:43], v[240:243], v[56:59], v[40:43]
    v_fmac_f32 v11, v31, v31
    v_fmac_f32 v11, v20, v20
    v_mfma_f32_16x16x32_bf16 v[40:43], v[244:247], v[44:47], v[40:43]
    v_fmac_f32 v11, v21, v21
    v_fmac_f32 v11, v22, v22
    v_mfma_f32_16x16x32_bf16 v[40:43], v[248:251], v[32:35], v[40:43]
    v_fmac_f32 v11, v23, v23
    v_fma_f32 v114, v36, v36, s42
    v_mfma_f32_16x16x32_bf16 v[40:43], v[252:255], v[24:27], v[40:43]
    s_nop 0
    v_fmac_f32 v114, v37, v37
    v_fmac_f32 v114, v38, v38
    v_fmac_f32 v114, v39, v39
    v_fmac_f32 v114, v48, v48
    v_fmac_f32 v114, v49, v49
    v_fmac_f32 v114, v50, v50
    v_fmac_f32 v114, v51, v51
    v_fmac_f32 v114, v40, v40
    v_fmac_f32 v114, v41, v41
    v_fmac_f32 v114, v42, v42
    v_fmac_f32 v114, v43, v43
    v_cvt_pk_bf16_f32 v114, v114, v11
    ds_write_b64 v130, v[114:115] offset:4096
    v_mul_f32 v0, v0, v5
    v_mul_f32 v1, v1, v5
    v_cvt_pk_bf16_f32 v0, v0, v1
    v_mul_f32 v2, v2, v5
    v_mul_f32 v3, v3, v5
    v_cvt_pk_bf16_f32 v1, v2, v3
    v_mul_f32 v52, v52, v5
    v_mul_f32 v53, v53, v5
    v_cvt_pk_bf16_f32 v2, v52, v53
    v_mul_f32 v54, v54, v5
    v_mul_f32 v55, v55, v5
    v_cvt_pk_bf16_f32 v3, v54, v55
    v_mul_f32 v12, v12, v5
    v_mul_f32 v13, v13, v5
    v_cvt_pk_bf16_f32 v114, v12, v13
    v_mul_f32 v14, v14, v5
    v_mul_f32 v15, v15, v5
    v_cvt_pk_bf16_f32 v115, v14, v15
    ds_write_b128 v135, v[0:3] offset:1536
    s_waitcnt lgkmcnt(1)
    s_barrier
    ds_write_b64 v134, v[114:115] offset:1536
    ds_read_b128 v[4:7], v129 offset:4096
    ds_read_b128 v[0:3], v129 offset:5120
    s_waitcnt lgkmcnt(2)
    s_barrier
    s_waitcnt lgkmcnt(1)
    v_mfma_f32_16x16x32_bf16 v[24:27], v[216:219], v[4:7], 0
    s_waitcnt lgkmcnt(0)
    ds_read_b128 v[44:47], v113 offset:0
    ds_read_b128 v[32:35], v113 offset:1024
    v_mfma_f32_16x16x32_bf16 v[24:27], v[216:219], v[0:3], v[24:27]
    s_nop 0
    ds_read_b128 v[12:15], v113 offset:2048
    s_nop 2
    ds_read_b128 v[4:7], v113 offset:3072
    s_nop 1
    v_rsq_f32 v24, v24
    ds_read_b128 v[0:3], v113 offset:4096
    v_mul_f32 v24, s43, v24
    v_mul_f32 v36, v36, v24
    v_mul_f32 v37, v37, v24
    v_cvt_pk_bf16_f32 v36, v36, v37
    v_mul_f32 v38, v38, v24
    v_mul_f32 v39, v39, v24
    v_cvt_pk_bf16_f32 v37, v38, v39
    v_mul_f32 v48, v48, v24
    v_mul_f32 v49, v49, v24
    s_waitcnt lgkmcnt(4)
    buffer_store_dwordx4 v[44:47], v128, s[28:31], s58 offen sc1
    v_cvt_pk_bf16_f32 v38, v48, v49
    v_mul_f32 v50, v50, v24
    v_mul_f32 v51, v51, v24
    v_cvt_pk_bf16_f32 v39, v50, v51
    v_mul_f32 v40, v40, v24
    v_mul_f32 v41, v41, v24
    v_cvt_pk_bf16_f32 v26, v40, v41
    v_mul_f32 v42, v42, v24
    v_mul_f32 v43, v43, v24
    v_cvt_pk_bf16_f32 v27, v42, v43
    ds_write_b128 v112, v[36:39] offset:0
    v_rsq_f32 v25, v25
    s_nop 0
    v_mul_f32 v25, s43, v25
    s_waitcnt lgkmcnt(1)
    buffer_store_dwordx4 v[32:35], v127, s[28:31], s58 offen sc1
    ds_write_b64 v132, v[26:27] offset:0
    v_mul_f32 v16, v16, v25
    v_mul_f32 v17, v17, v25
    v_cvt_pk_bf16_f32 v16, v16, v17
    v_mul_f32 v18, v18, v25
    v_mul_f32 v19, v19, v25
    v_cvt_pk_bf16_f32 v17, v18, v19
    v_mul_f32 v28, v28, v25
    v_mul_f32 v29, v29, v25
    v_cvt_pk_bf16_f32 v18, v28, v29
    v_mul_f32 v30, v30, v25
    v_mul_f32 v31, v31, v25
    v_cvt_pk_bf16_f32 v19, v30, v31
    v_mul_f32 v20, v20, v25
    v_mul_f32 v21, v21, v25
    v_cvt_pk_bf16_f32 v128, v20, v21
    v_mul_f32 v22, v22, v25
    v_mul_f32 v23, v23, v25
    v_cvt_pk_bf16_f32 v129, v22, v23
    buffer_store_dwordx4 v[12:15], v126, s[28:31], s58 offen sc1
    ds_write_b128 v112, v[16:19] offset:1536
    ds_write_b64 v132, v[128:129] offset:1536
    buffer_store_dwordx4 v[4:7], v125, s[28:31], s58 offen sc1
    s_waitcnt lgkmcnt(0)
    s_barrier
    buffer_store_dwordx4 v[0:3], v124, s[28:31], s58 offen sc1
    ds_read_b128 v[12:15], v131 offset:0
    ds_read_b128 v[4:7], v131 offset:1024
    ds_read_b128 v[0:3], v131 offset:2048
    s_waitcnt lgkmcnt(2)
    buffer_store_dwordx4 v[12:15], v8, s[28:31], 0 offen sc1
    s_waitcnt lgkmcnt(0)
    buffer_store_dwordx4 v[4:7], v9, s[28:31], 0 offen sc1
    buffer_store_dwordx4 v[0:3], v10, s[28:31], 0 offen sc1
    s_branch L_fin
L_again:
    s_waitcnt vmcnt(0) lgkmcnt(0)
    s_nop 15
    s_barrier
    s_movk_i32 s2, 256
    s_branch L_top
L_bndS:
    s_movk_i32 s73, 20
    s_movk_i32 s71, 18
    s_movk_i32 s70, -20
    s_mov_b32 s74, 0
    s_bitcmp1_b32 s2, 2
    s_cbranch_scc1 L_bndcS
    s_sub_u32 s94, s2, 248
    s_mul_i32 s69, s94, 18
    s_mov_b32 s74, 2
    s_sub_u32 s93, s93, 1373568
    v_cmp_le_u32 vcc, 4, v73
    v_add_u32 v6, 98896896, v128
    v_subrev_u32 v7, 1373568, v128
    v_cndmask_b32 v128, v6, v7, vcc
    v_cmp_le_u32 vcc, 4, v156
    v_add_u32 v6, 98896896, v127
    v_subrev_u32 v7, 1373568, v127
    v_cndmask_b32 v127, v6, v7, vcc
    v_cmp_le_u32 vcc, 4, v4
    v_add_u32 v6, 98896896, v126
    v_subrev_u32 v7, 1373568, v126
    v_cndmask_b32 v126, v6, v7, vcc
    v_cmp_le_u32 vcc, 4, v18
    v_add_u32 v6, 98896896, v125
    v_subrev_u32 v7, 1373568, v125
    v_cndmask_b32 v125, v6, v7, vcc
    v_cmp_le_u32 vcc, 4, v11
    v_add_u32 v6, 98896896, v124
    v_subrev_u32 v7, 1373568, v124
    v_cndmask_b32 v124, v6, v7, vcc
    s_cmp_lt_u32 s2, 256
    s_cbranch_scc1 L_bndrS
L_bndcS:
    s_sub_u32 s94, s2, 252
    s_mul_i32 s69, s94, 20
    s_lshr_b32 s71, s94, 1
    s_sub_u32 s69, s69, s71
    s_and_b32 s94, s94, 1
    s_sub_u32 s71, 20, s94
    s_cmp_eq_u32 s2, 255
    s_cselect_b32 s71, 13, s71
    s_mov_b32 s62, 1373568
    s_add_u32 s74, s74, 1
    s_sub_u32 s93, s93, 2688
    v_mad_i32_i24 v6, v73, -7, v74
    v_cmp_le_u32 vcc, 4, v6
    v_add_u32 v6, 193536, v128
    v_subrev_u32 v7, 2688, v128
    v_cndmask_b32 v128, v6, v7, vcc
    v_mad_i32_i24 v6, v156, -7, v150
    v_cmp_le_u32 vcc, 4, v6
    v_add_u32 v6, 193536, v127
    v_subrev_u32 v7, 2688, v127
    v_cndmask_b32 v127, v6, v7, vcc
    v_mad_i32_i24 v6, v4, -7, v10
    v_cmp_le_u32 vcc, 4, v6
    v_add_u32 v6, 193536, v126
    v_subrev_u32 v7, 2688, v126
    v_cndmask_b32 v126, v6, v7, vcc
    v_mad_i32_i24 v6, v18, -7, v159
    v_cmp_le_u32 vcc, 4, v6
    v_add_u32 v6, 193536, v125
    v_subrev_u32 v7, 2688, v125
    v_cndmask_b32 v125, v6, v7, vcc
    v_mad_i32_i24 v6, v11, -7, v151
    v_cmp_le_u32 vcc, 4, v6
    v_add_u32 v6, 193536, v124
    v_subrev_u32 v7, 2688, v124
    v_cndmask_b32 v124, v6, v7, vcc
    s_cmp_eq_u32 s2, 256
    s_cselect_b32 s62, 0, s62
    s_cselect_b32 s69, 0, s69
    s_cselect_b32 s71, 2, s71
    s_branch L_bndrS
L_maskS:
    s_and_b32 s20, s74, 2
    s_and_b32 s21, s74, 1
    s_mov_b32 s22, 0xc31044fe
    v_lshrrev_b32 v161, 2, v149
    v_add_u32 v161, 0, v161
    v_mul_u32_u24 v148, 37, v161
    v_lshrrev_b32 v72, 8, v148
    v_mad_i32_i24 v72, v72, -7, v161
    v_lshrrev_b32 v148, 10, v148
    v_lshrrev_b32 v72, 2, v72
    v_mul_u32_u24 v148, s20, v148
    v_mad_u32_u24 v161, v72, s21, v148
    v_cvt_f32_u32 v161, v161
    v_lshrrev_b32 v164, 2, v149
    v_add_u32 v164, 4, v164
    v_mul_u32_u24 v148, 37, v164
    v_lshrrev_b32 v72, 8, v148
    v_mad_i32_i24 v72, v72, -7, v164
    v_lshrrev_b32 v148, 10, v148
    v_lshrrev_b32 v72, 2, v72
    v_mul_u32_u24 v148, s20, v148
    v_mad_u32_u24 v164, v72, s21, v148
    v_cvt_f32_u32 v164, v164
    v_lshrrev_b32 v75, 2, v149
    v_add_u32 v75, 8, v75
    v_mul_u32_u24 v148, 37, v75
    v_lshrrev_b32 v72, 8, v148
    v_mad_i32_i24 v72, v72, -7, v75
    v_lshrrev_b32 v148, 10, v148
    v_lshrrev_b32 v72, 2, v72
    v_mul_u32_u24 v148, s20, v148
    v_mad_u32_u24 v75, v72, s21, v148
    v_cvt_f32_u32 v75, v75
    v_mad_u32_u24 v73, v160, 12, 0
    v_mul_u32_u24 v148, 37, v73
    v_lshrrev_b32 v72, 8, v148
    v_mad_i32_i24 v72, v72, -7, v73
    v_lshrrev_b32 v148, 10, v148
    v_lshrrev_b32 v72, 2, v72
    v_mul_u32_u24 v148, s20, v148
    v_mad_u32_u24 v73, v72, s21, v148
    v_cvt_f32_u32 v73, v73
    v_sub_f32 v148, v161, v73
    v_mul_f32 v148, v148, v148 clamp
    v_fmac_f32 v204, s22, v148
    v_sub_f32 v148, v164, v73
    v_mul_f32 v148, v148, v148 clamp
    v_fmac_f32 v192, s22, v148
    v_sub_f32 v148, v75, v73
    v_mul_f32 v148, v148, v148 clamp
    v_fmac_f32 v180, s22, v148
    v_mad_u32_u24 v73, v160, 12, 1
    v_mul_u32_u24 v148, 37, v73
    v_lshrrev_b32 v72, 8, v148
    v_mad_i32_i24 v72, v72, -7, v73
    v_lshrrev_b32 v148, 10, v148
    v_lshrrev_b32 v72, 2, v72
    v_mul_u32_u24 v148, s20, v148
    v_mad_u32_u24 v73, v72, s21, v148
    v_cvt_f32_u32 v73, v73
    v_sub_f32 v148, v161, v73
    v_mul_f32 v148, v148, v148 clamp
    v_fmac_f32 v205, s22, v148
    v_sub_f32 v148, v164, v73
    v_mul_f32 v148, v148, v148 clamp
    v_fmac_f32 v193, s22, v148
    v_sub_f32 v148, v75, v73
    v_mul_f32 v148, v148, v148 clamp
    v_fmac_f32 v181, s22, v148
    v_mad_u32_u24 v73, v160, 12, 2
    v_mul_u32_u24 v148, 37, v73
    v_lshrrev_b32 v72, 8, v148
    v_mad_i32_i24 v72, v72, -7, v73
    v_lshrrev_b32 v148, 10, v148
    v_lshrrev_b32 v72, 2, v72
    v_mul_u32_u24 v148, s20, v148
    v_mad_u32_u24 v73, v72, s21, v148
    v_cvt_f32_u32 v73, v73
    v_sub_f32 v148, v161, v73
    v_mul_f32 v148, v148, v148 clamp
    v_fmac_f32 v206, s22, v148
    v_sub_f32 v148, v164, v73
    v_mul_f32 v148, v148, v148 clamp
    v_fmac_f32 v194, s22, v148
    v_sub_f32 v148, v75, v73
    v_mul_f32 v148, v148, v148 clamp
    v_fmac_f32 v182, s22, v148
    v_mad_u32_u24 v73, v160, 12, 3
    v_mul_u32_u24 v148, 37, v73
    v_lshrrev_b32 v72, 8, v148
    v_mad_i32_i24 v72, v72, -7, v73
    v_lshrrev_b32 v148, 10, v148
    v_lshrrev_b32 v72, 2, v72
    v_mul_u32_u24 v148, s20, v148
    v_mad_u32_u24 v73, v72, s21, v148
    v_cvt_f32_u32 v73, v73
    v_sub_f32 v148, v161, v73
    v_mul_f32 v148, v148, v148 clamp
    v_fmac_f32 v207, s22, v148
    v_sub_f32 v148, v164, v73
    v_mul_f32 v148, v148, v148 clamp
    v_fmac_f32 v195, s22, v148
    v_sub_f32 v148, v75, v73
    v_mul_f32 v148, v148, v148 clamp
    v_fmac_f32 v183, s22, v148
    v_mad_u32_u24 v73, v160, 12, 4
    v_mul_u32_u24 v148, 37, v73
    v_lshrrev_b32 v72, 8, v148
    v_mad_i32_i24 v72, v72, -7, v73
    v_lshrrev_b32 v148, 10, v148
    v_lshrrev_b32 v72, 2, v72
    v_mul_u32_u24 v148, s20, v148
    v_mad_u32_u24 v73, v72, s21, v148
    v_cvt_f32_u32 v73, v73
    v_sub_f32 v148, v161, v73
    v_mul_f32 v148, v148, v148 clamp
    v_fmac_f32 v200, s22, v148
    v_sub_f32 v148, v164, v73
    v_mul_f32 v148, v148, v148 clamp
    v_fmac_f32 v188, s22, v148
    v_sub_f32 v148, v75, v73
    v_mul_f32 v148, v148, v148 clamp
    v_fmac_f32 v176, s22, v148
    v_mad_u32_u24 v73, v160, 12, 5
    v_mul_u32_u24 v148, 37, v73
    v_lshrrev_b32 v72, 8, v148
    v_mad_i32_i24 v72, v72, -7, v73
    v_lshrrev_b32 v148, 10, v148
    v_lshrrev_b32 v72, 2, v72
    v_mul_u32_u24 v148, s20, v148
    v_mad_u32_u24 v73, v72, s21, v148
    v_cvt_f32_u32 v73, v73
    v_sub_f32 v148, v161, v73
    v_mul_f32 v148, v148, v148 clamp
    v_fmac_f32 v201, s22, v148
    v_sub_f32 v148, v164, v73
    v_mul_f32 v148, v148, v148 clamp
    v_fmac_f32 v189, s22, v148
    v_sub_f32 v148, v75, v73
    v_mul_f32 v148, v148, v148 clamp
    v_fmac_f32 v177, s22, v148
    v_mad_u32_u24 v73, v160, 12, 6
    v_mul_u32_u24 v148, 37, v73
    v_lshrrev_b32 v72, 8, v148
    v_mad_i32_i24 v72, v72, -7, v73
    v_lshrrev_b32 v148, 10, v148
    v_lshrrev_b32 v72, 2, v72
    v_mul_u32_u24 v148, s20, v148
    v_mad_u32_u24 v73, v72, s21, v148
    v_cvt_f32_u32 v73, v73
    v_sub_f32 v148, v161, v73
    v_mul_f32 v148, v148, v148 clamp
    v_fmac_f32 v202, s22, v148
    v_sub_f32 v148, v164, v73
    v_mul_f32 v148, v148, v148 clamp
    v_fmac_f32 v190, s22, v148
    v_sub_f32 v148, v75, v73
    v_mul_f32 v148, v148, v148 clamp
    v_fmac_f32 v178, s22, v148
    v_mad_u32_u24 v73, v160, 12, 7
    v_mul_u32_u24 v148, 37, v73
    v_lshrrev_b32 v72, 8, v148
    v_mad_i32_i24 v72, v72, -7, v73
    v_lshrrev_b32 v148, 10, v148
    v_lshrrev_b32 v72, 2, v72
    v_mul_u32_u24 v148, s20, v148
    v_mad_u32_u24 v73, v72, s21, v148
    v_cvt_f32_u32 v73, v73
    v_sub_f32 v148, v161, v73
    v_mul_f32 v148, v148, v148 clamp
    v_fmac_f32 v203, s22, v148
    v_sub_f32 v148, v164, v73
    v_mul_f32 v148, v148, v148 clamp
    v_fmac_f32 v191, s22, v148
    v_sub_f32 v148, v75, v73
    v_mul_f32 v148, v148, v148 clamp
    v_fmac_f32 v179, s22, v148
    v_mad_u32_u24 v73, v160, 12, 8
    v_mul_u32_u24 v148, 37, v73
    v_lshrrev_b32 v72, 8, v148
    v_mad_i32_i24 v72, v72, -7, v73
    v_lshrrev_b32 v148, 10, v148
    v_lshrrev_b32 v72, 2, v72
    v_mul_u32_u24 v148, s20, v148
    v_mad_u32_u24 v73, v72, s21, v148
    v_cvt_f32_u32 v73, v73
    v_sub_f32 v148, v161, v73
    v_mul_f32 v148, v148, v148 clamp
    v_fmac_f32 v196, s22, v148
    v_sub_f32 v148, v164, v73
    v_mul_f32 v148, v148, v148 clamp
    v_fmac_f32 v184, s22, v148
    v_sub_f32 v148, v75, v73
    v_mul_f32 v148, v148, v148 clamp
    v_fmac_f32 v172, s22, v148
    v_mad_u32_u24 v73, v160, 12, 9
    v_mul_u32_u24 v148, 37, v73
    v_lshrrev_b32 v72, 8, v148
    v_mad_i32_i24 v72, v72, -7, v73
    v_lshrrev_b32 v148, 10, v148
    v_lshrrev_b32 v72, 2, v72
    v_mul_u32_u24 v148, s20, v148
    v_mad_u32_u24 v73, v72, s21, v148
    v_cvt_f32_u32 v73, v73
    v_sub_f32 v148, v161, v73
    v_mul_f32 v148, v148, v148 clamp
    v_fmac_f32 v197, s22, v148
    v_sub_f32 v148, v164, v73
    v_mul_f32 v148, v148, v148 clamp
    v_fmac_f32 v185, s22, v148
    v_sub_f32 v148, v75, v73
    v_mul_f32 v148, v148, v148 clamp
    v_fmac_f32 v173, s22, v148
    v_mad_u32_u24 v73, v160, 12, 10
    v_mul_u32_u24 v148, 37, v73
    v_lshrrev_b32 v72, 8, v148
    v_mad_i32_i24 v72, v72, -7, v73
    v_lshrrev_b32 v148, 10, v148
    v_lshrrev_b32 v72, 2, v72
    v_mul_u32_u24 v148, s20, v148
    v_mad_u32_u24 v73, v72, s21, v148
    v_cvt_f32_u32 v73, v73
    v_sub_f32 v148, v161, v73
    v_mul_f32 v148, v148, v148 clamp
    v_fmac_f32 v198, s22, v148
    v_sub_f32 v148, v164, v73
    v_mul_f32 v148, v148, v148 clamp
    v_fmac_f32 v186, s22, v148
    v_sub_f32 v148, v75, v73
    v_mul_f32 v148, v148, v148 clamp
    v_fmac_f32 v174, s22, v148
    v_mad_u32_u24 v73, v160, 12, 11
    v_mul_u32_u24 v148, 37, v73
    v_lshrrev_b32 v72, 8, v148
    v_mad_i32_i24 v72, v72, -7, v73
    v_lshrrev_b32 v148, 10, v148
    v_lshrrev_b32 v72, 2, v72
    v_mul_u32_u24 v148, s20, v148
    v_mad_u32_u24 v73, v72, s21, v148
    v_cvt_f32_u32 v73, v73
    v_sub_f32 v148, v161, v73
    v_mul_f32 v148, v148, v148 clamp
    v_fmac_f32 v199, s22, v148
    v_sub_f32 v148, v164, v73
    v_mul_f32 v148, v148, v148 clamp
    v_fmac_f32 v187, s22, v148
    v_sub_f32 v148, v75, v73
    v_mul_f32 v148, v148, v148 clamp
    v_fmac_f32 v175, s22, v148
    v_cvt_f32_u32 v73, s74
    v_sub_f32 v148, v161, v73
    v_mul_f32 v148, v148, v148 clamp
    v_fmac_f32 v208, s22, v148
    v_sub_f32 v148, v164, v73
    v_mul_f32 v148, v148, v148 clamp
    v_fmac_f32 v209, s22, v148
    v_sub_f32 v148, v75, v73
    v_mul_f32 v148, v148, v148 clamp
    v_fmac_f32 v210, s22, v148
    v_lshrrev_b32 v161, 2, v149
    v_lshl_add_u32 v161, v160, 2, v161
    v_add_u32 v148, 1, v160
    v_lshrrev_b32 v148, 2, v148
    v_mad_u32_u24 v161, v148, 36, v161
    v_min_u32 v161, 48, v161
    v_mul_u32_u24 v148, 37, v161
    v_lshrrev_b32 v72, 8, v148
    v_mad_i32_i24 v72, v72, -7, v161
    v_lshrrev_b32 v148, 10, v148
    v_lshrrev_b32 v72, 2, v72
    v_mul_u32_u24 v148, s20, v148
    v_mad_u32_u24 v161, v72, s21, v148
    v_cvt_f32_u32 v161, v161
    v_sub_f32 v148, v161, v73
    v_mul_f32 v148, v148, v148 clamp
    v_fmac_f32 v211, s22, v148
    s_branch L_nomaskS
L_atomS0:
    v_mov_b32 v122, 0x800000
    buffer_atomic_add v122, v129, s[8:11], 0 offen sc0 sc1
    s_branch L_atomS0r
.section .rodata,"a"
.p2align 6
.amdhsa_kernel standalone__window_attn_swin_v2__vision_kernel
  .amdhsa_next_free_vgpr 512
  .amdhsa_next_free_sgpr 102
  .amdhsa_accum_offset 256
  .amdhsa_group_segment_fixed_size 0
  .amdhsa_kernarg_size 96
  .amdhsa_user_sgpr_count 2
  .amdhsa_user_sgpr_kernarg_segment_ptr 1
  .amdhsa_system_sgpr_workgroup_id_x 1
.end_amdhsa_kernel
```

```asm
; @launch grid=(256,1,1) block=(256,1,1) lds=163840
.amdgcn_target "amdgcn-amd-amdhsa--gfx950"
.text
.globl standalone__window_attn_swin_v2__vision_kernel
.p2align 8
.type standalone__window_attn_swin_v2__vision_kernel,@function
standalone__window_attn_swin_v2__vision_kernel:
    v_lshrrev_b32 v0, 6, v0
    s_cmp_ge_u32 s2, 256
    s_cbranch_scc1 L_end
    v_readfirstlane_b32 s68, v0
L_top:
    s_mov_b32 s64, 0
    s_nop 0
L_top2:
    v_mbcnt_lo_u32_b32 v156, -1, 0
    v_mbcnt_hi_u32_b32 v156, -1, v156
    s_load_dwordx16 s[4:19], s[0:1], 0
    s_load_dwordx4 s[20:23], s[0:1], 64
    s_load_dwordx2 s[38:39], s[0:1], 80
    s_load_dwordx2 s[76:77], s[0:1], 88
    s_add_u32 s84, s2, s64
    s_sub_u32 s84, s84, 248
    s_cmp_lt_u32 s84, 3
    s_cbranch_scc1 L_prod
    s_bfe_u32 s88, s2, 0x50003
    s_lshl2_add_u32 s88, s88, s68
    v_lshlrev_b32 v157, 7, v156
    s_getpc_b64 s[80:81]
    s_mul_i32 s84, s88, 288
    v_min_u32 v158, 256, v157
    v_add_u32 v158, s84, v158
    v_min_u32 v158, L_slow-standalone__window_attn_swin_v2__vision_kernel-256, v158
    s_mul_i32 s88, s88, 1728
    s_mov_b32 s34, 221184
    global_load_dword a255, v158, s[80:81]
    v_min_u32 v141, 1664, v157
    s_mov_b32 s35, 0x20000
    s_mov_b32 s78, 73728
    s_mov_b32 s79, 0x20000
    v_and_b32 v132, 15, v156
    v_lshrrev_b32 v142, 4, v156
    v_lshrrev_b32 v143, 2, v132
    v_and_b32 v152, 3, v132
    s_mul_i32 s87, s68, 192
    v_mad_u32_u24 v153, v132, 12, s87
    v_lshlrev_b32 v140, 1, v132
    v_lshlrev_b32 v23, 1, v143
    v_lshl_add_u32 v23, v142, 5, v23
    s_movk_i32 s86, 384
    s_mov_b32 s26, 100270464
    s_mov_b32 s27, 0x20000
    s_mov_b32 s30, 0
    s_mov_b32 s31, 0x20000
    s_waitcnt lgkmcnt(0)
    s_mov_b32 s24, s4
    s_mov_b32 s25, s5
    s_mov_b32 s32, s6
    s_mov_b32 s33, s7
    buffer_load_dword a254, v141, s[32:35], s88 offen
    s_load_dwordx2 s[82:83], s[10:11], 0
    s_movk_i32 s18, 676
    s_mov_b32 s19, 0x20000
    buffer_load_dwordx3 v[20:22], v153, s[16:19], 0 offen
    s_mul_i32 s96, s68, 288
    s_and_b32 s97, s68, 1
    s_lshl_b32 s97, s97, 2
    s_mov_b32 s98, 193536
    s_mov_b32 s99, 589824
    global_load_ushort v12, v140, s[12:13]
    v_add_u32 v124, s96, v156
    v_mul_u32_u24 v104, 2731, v124
    v_mul_u32_u24 v141, 6242, v124
    v_lshrrev_b32 v104, 16, v104
    v_lshrrev_b32 v141, 20, v141
    s_lshr_b32 s94, s2, 3
    s_mul_i32 s70, s94, 167
    global_load_ushort v13, v140, s[12:13] offset:32
    v_and_or_b32 v15, v104, 3, s97
    v_xor_b32 v15, v124, v15
    v_lshl_add_u32 v128, v15, 4, s99
    v_mad_u32_u24 v128, v141, s98, v128
    v_add_u32 v140, 64, v124
    s_min_u32 s95, s94, 7
    s_add_u32 s70, s70, s95
    global_load_ushort v136, v23, s[14:15] offset:0
    v_mul_u32_u24 v105, 2731, v140
    v_mul_u32_u24 v14, 6242, v140
    v_lshrrev_b32 v105, 16, v105
    v_lshrrev_b32 v14, 20, v14
    v_and_or_b32 v155, v105, 3, s97
    s_and_b32 s95, s2, 7
    s_mul_i32 s95, s95, 20
    global_load_ushort v154, v23, s[14:15] offset:8
    v_xor_b32 v155, v140, v155
    v_lshl_add_u32 v127, v155, 4, s99
    v_mad_u32_u24 v127, v14, s98, v127
    v_add_u32 v125, 128, v124
    v_mul_u32_u24 v140, 2731, v125
    s_add_u32 s69, s70, s95
    s_add_u32 s70, s70, 140
    global_load_ushort v137, v23, s[14:15] offset:16
    v_mul_u32_u24 v107, 6242, v125
    v_lshrrev_b32 v140, 16, v140
    v_lshrrev_b32 v107, 20, v107
    v_and_or_b32 v106, v140, 3, s97
    v_xor_b32 v106, v125, v106
    s_movk_i32 s62, 2688
    s_movk_i32 s71, 20
    global_load_ushort v23, v23, s[14:15] offset:24
    v_lshl_add_u32 v126, v106, 4, s99
    v_mad_u32_u24 v126, v107, s98, v126
    v_add_u32 v129, 192, v124
    v_mul_u32_u24 v133, 2731, v129
    v_mul_u32_u24 v131, 6242, v129
    v_lshrrev_b32 v133, 16, v133
    v_lshrrev_b32 v131, 20, v131
    v_and_or_b32 v125, v133, 3, s97
    v_xor_b32 v125, v129, v125
    v_lshl_add_u32 v125, v125, 4, s99
    v_mad_u32_u24 v125, v131, s98, v125
    v_add_u32 v124, 256, v124
    v_mul_u32_u24 v130, 2731, v124
    v_mul_u32_u24 v129, 6242, v124
    v_lshrrev_b32 v130, 16, v130
    v_lshrrev_b32 v129, 20, v129
    v_and_or_b32 v134, v130, 3, s97
    v_xor_b32 v134, v124, v134
    v_lshl_add_u32 v124, v134, 4, s99
    v_mad_u32_u24 v124, v129, s98, v124
    s_cmp_lt_u32 s94, 7
    s_cselect_b32 s73, 28, 27
    s_mov_b32 s93, 1769472
    s_mul_i32 s54, s68, 5120
    s_cmp_ge_u32 s2, 248
    s_cbranch_scc1 L_bndF
L_bndrF:
    s_mov_b32 s63, 1180032
    s_mul_i32 s94, s69, 58255
    s_lshr_b32 s94, s94, 22
    s_mul_i32 s94, s94, s63
    s_mul_i32 s72, s69, s62
    s_add_u32 s72, s72, s94
    v_lshl_or_b32 v141, v156, 4, 2.0
    s_sub_u32 s94, s73, 1
    s_max_u32 s94, s94, 20
    s_mul_i32 s95, s68, -44
    s_movk_i32 s99, -24
    s_add_u32 m0, s54, 0
    v_and_b32 v107, -4, v140
    s_mul_i32 s85, s68, 96
    s_sub_u32 s100, s85, 1024
    buffer_load_dwordx4 v128, s[24:27], s72 offen nt lds
    s_add_u32 m0, s54, 1024
    v_mad_u32_u24 v14, v107, 3, v140
    v_add_u32 v14, s95, v14
    v_mad_i32_i24 v106, v140, s99, v106
    v_med3_u32 v107, v14, 20, s94
    v_add_u32 v107, s70, v107
    v_add_u32 v140, s69, v14
    s_sub_u32 s87, s85, 2048
    s_movk_i32 s91, 1152
    buffer_load_dwordx4 v127, s[24:27], s72 offen nt lds
    v_cmp_gt_u32 vcc, s71, v14
    v_lshl_add_u32 v106, v106, 4, s93
    s_add_u32 m0, s54, 43008
    v_cndmask_b32 v140, v107, v140, vcc
    v_mul_u32_u24 v107, 58255, v140
    v_mad_u32_u24 v106, v140, s62, v106
    v_lshrrev_b32 v107, 22, v107
    v_mad_u32_u24 v106, v107, s63, v106
    s_mul_i32 s90, s68, 3072
    s_add_u32 s90, s90, 61440
    buffer_load_dwordx4 v106, s[24:27], 0 offen  lds
    v_lshlrev_b32 v107, 16, v14
    s_add_u32 m0, s54, 2048
    v_and_b32 v140, -4, v105
    v_mad_u32_u24 v14, v140, 3, v105
    v_add_u32 v14, s95, v14
    v_mad_i32_i24 v105, v105, s99, v155
    v_med3_u32 v140, v14, 20, s94
    s_mov_b32 s30, 100270464
    s_add_u32 s101, s54, 44032
    buffer_load_dwordx4 v126, s[24:27], s72 offen nt lds
    v_add_u32 v140, s70, v140
    v_add_u32 v155, s69, v14
    v_cmp_gt_u32 vcc, s71, v14
    v_lshl_add_u32 v105, v105, 4, s93
    s_add_u32 m0, s54, 41984
    v_cndmask_b32 v155, v140, v155, vcc
    v_mul_u32_u24 v140, 58255, v155
    v_mad_u32_u24 v105, v155, s62, v105
    v_lshrrev_b32 v140, 22, v140
    v_mad_u32_u24 v105, v140, s63, v105
    s_mov_b32 s28, s22
    s_mov_b32 s29, s23
    buffer_load_dwordx4 v105, s[24:27], 0 offen  lds
    v_lshl_or_b32 v107, v14, 8, v107
    s_add_u32 m0, s54, 3072
    v_cmp_gt_u32 vcc, 32, v156
    v_and_b32 v14, -4, v104
    v_mad_u32_u24 v140, v14, 3, v104
    v_cndmask_b32 v124, v141, v124, vcc
    v_add_u32 v140, s95, v140
    s_mov_b32 s41, 0x2a8cbccc
    s_mov_b32 s42, 0x38fba882
    buffer_load_dwordx4 v125, s[24:27], s72 offen nt lds
    s_add_u32 m0, s54, 4096
    v_mad_i32_i24 v104, v104, s99, v15
    v_med3_u32 v14, v140, 20, s94
    v_add_u32 v14, s70, v14
    v_add_u32 v155, s69, v140
    v_cmp_gt_u32 vcc, s71, v140
    v_lshl_add_u32 v104, v104, 4, s93
    s_mov_b32 s43, 0x415db3d7
    s_mul_i32 s93, s68, 6
    buffer_load_dwordx4 v124, s[24:27], s72 offen nt lds
    v_cndmask_b32 v155, v14, v155, vcc
    v_mul_u32_u24 v14, 58255, v155
    v_mad_u32_u24 v104, v155, s62, v104
    v_lshrrev_b32 v14, 22, v14
    v_mad_u32_u24 v104, v14, s63, v104
    s_add_u32 m0, s54, 40960
    v_lshl_or_b32 v107, v140, 0, v107
    s_lshl_b32 s94, s97, 1
    s_mov_b32 s44, 61440
    buffer_load_dwordx4 v104, s[24:27], 0 offen nt lds
    v_mul_u32_u24 v14, 10923, v156
    v_lshrrev_b32 v155, 17, v14
    v_lshrrev_b32 v14, 16, v14
    v_mad_i32_i24 v140, v14, -6, v156
    v_bitop3_b32 v155, v155, v14, 4 bitop3:0x28
    v_lshl_add_u32 v140, v140, 4, s85
    v_mul_u32_u24 v155, 3, v155
    v_xor_b32 v14, v14, v155
    v_mad_u32_u24 v155, v14, s91, v140
    v_add_u32 v140, 64, v156
    v_mul_u32_u24 v138, 10923, v140
    v_lshrrev_b32 v139, 17, v138
    v_lshrrev_b32 v138, 16, v138
    v_mad_i32_i24 v140, v138, -6, v140
    v_bitop3_b32 v139, v139, v138, 4 bitop3:0x28
    v_lshl_add_u32 v140, v140, 4, s100
    v_mul_u32_u24 v139, 3, v139
    v_xor_b32 v138, v138, v139
    v_mad_u32_u24 v139, v138, s91, v140
    v_add_u32 v140, 128, v156
    v_mul_u32_u24 v138, 10923, v140
    v_lshrrev_b32 v77, 17, v138
    v_lshrrev_b32 v138, 16, v138
    v_mad_i32_i24 v140, v138, -6, v140
    v_bitop3_b32 v77, v77, v138, 4 bitop3:0x28
    v_lshl_add_u32 v140, v140, 4, s87
    v_mul_u32_u24 v77, 3, v77
    v_xor_b32 v138, v138, v77
    v_mad_u32_u24 v77, v138, s91, v140
    s_add_u32 m0, s90, 0
    s_mov_b32 s92, 0
    buffer_load_dwordx4 v155, s[32:35], s92 offen offset:0 lds
    v_lshrrev_b32 v138, 1, v142
    v_lshl_add_u32 v140, v142, 2, v143
    v_lshl_add_u32 v140, v138, 3, v140
    v_mul_u32_u24 v140, 96, v140
    v_add_u32 v140, s90, v140
    v_lshl_add_u32 v138, v152, 4, v140
    v_lshl_add_u32 v121, v152, 3, v140
    s_waitcnt lgkmcnt(0)
    s_sext_i32_i16 s84, s82
    s_ashr_i32 s85, s82, 16
    s_max_i32 s84, s84, s85
    s_sext_i32_i16 s85, s83
    s_max_i32 s84, s84, s85
    s_ashr_i32 s85, s83, 16
    s_max_i32 s84, s84, s85
    s_cmp_gt_i32 s84, 16492
    s_cbranch_scc1 L_slow
    s_lshl_b32 s84, s68, 4
    buffer_load_dwordx4 v139, s[32:35], s92 offen offset:1024 lds
    v_mov_b32 v15, 0x3f803f80
    v_cmp_eq_u32 vcc, 0, v152
    v_and_b32 v14, 1, v156
    v_lshlrev_b32 v14, 4, v14
    v_cndmask_b32 v220, 0, v15, vcc
    v_cndmask_b32 v221, 0, v15, vcc
    v_cndmask_b32 v222, 0, v15, vcc
    s_lshr_b64 s[82:83], s[82:83], s84
    s_lshl_b32 s82, s82, 16
    buffer_load_dwordx4 v77, s[32:35], s92 offen offset:2048 lds
    s_add_u32 m0, s90, 12288
    s_mov_b32 s92, 36864
    v_cndmask_b32 v223, 0, v15, vcc
    v_mov_b32 v140, 0x3f80
    v_lshlrev_b32 v140, v14, v140
    v_cmp_gt_u32 vcc, 2, v152
    v_mov_b32 v215, 0x44004400
    v_mul_u32_u24 v63, 48, v143
    v_cndmask_b32 v216, 0, v140, vcc
    v_cndmask_b32 v218, 0, v140, vcc
    v_cmp_le_u32 vcc, 2, v152
    v_lshl_add_u32 v63, v152, 2, v63
    v_mul_u32_u24 v3, 48, v142
    v_cndmask_b32 v217, 0, v140, vcc
    v_cndmask_b32 v219, 0, v140, vcc
    v_cmp_eq_u32 vcc, 0, v152
    v_add_u32 v199, 0, v63
    v_mul_u32_u24 v140, 37, v199
    v_cndmask_b32 v212, 0, v215, vcc
    v_cmp_eq_u32 vcc, 1, v152
    v_lshrrev_b32 v140, 10, v140
    v_mad_u32_u24 v199, v140, 24, v199
    v_cndmask_b32 v213, 0, v215, vcc
    v_cmp_eq_u32 vcc, 2, v152
    v_add_u32 v199, s101, v199
    v_add_u32 v62, 16, v63
    v_cndmask_b32 v214, 0, v215, vcc
    v_cmp_eq_u32 vcc, 3, v152
    v_mul_u32_u24 v140, 37, v62
    v_lshrrev_b32 v140, 10, v140
    v_cndmask_b32 v215, 0, v215, vcc
    v_mad_u32_u24 v62, v140, 24, v62
    v_add_u32 v62, s101, v62
    v_add_u32 v60, 32, v63
    v_mul_u32_u24 v61, 37, v60
    v_lshrrev_b32 v61, 10, v61
    v_mad_u32_u24 v60, v61, 24, v60
    v_add_u32 v60, s101, v60
    v_add_u32 v140, 0, v3
    v_mul_u32_u24 v61, 37, v140
    v_lshrrev_b32 v61, 10, v61
    v_mad_u32_u24 v140, v61, 24, v140
    v_add_u32 v78, 4, v3
    v_mul_u32_u24 v61, 37, v78
    v_lshrrev_b32 v61, 10, v61
    v_mad_u32_u24 v78, v61, 24, v78
    v_add_u32 v194, 8, v3
    v_mul_u32_u24 v61, 37, v194
    v_lshrrev_b32 v61, 10, v61
    v_mad_u32_u24 v194, v61, 24, v194
    v_add_u32 v79, 12, v3
    v_mul_u32_u24 v61, 37, v79
    v_lshrrev_b32 v61, 10, v61
    v_mad_u32_u24 v79, v61, 24, v79
    v_add_u32 v76, 16, v3
    v_mul_u32_u24 v61, 37, v76
    v_lshrrev_b32 v61, 10, v61
    v_mad_u32_u24 v76, v61, 24, v76
    v_add_u32 v2, 20, v3
    v_mul_u32_u24 v61, 37, v2
    v_lshrrev_b32 v61, 10, v61
    v_mad_u32_u24 v2, v61, 24, v2
    v_add_u32 v1, 24, v3
    v_mul_u32_u24 v0, 37, v1
    v_lshrrev_b32 v0, 10, v0
    v_mad_u32_u24 v1, v0, 24, v1
    v_add_u32 v185, 28, v3
    v_mul_u32_u24 v0, 37, v185
    v_lshrrev_b32 v0, 10, v0
    v_mad_u32_u24 v185, v0, 24, v185
    v_add_u32 v184, 32, v3
    s_mov_b32 s84, 0x41b8aa3b
    s_mov_b32 s45, 40960
    buffer_load_dwordx4 v155, s[32:35], s92 offen offset:0 lds
    v_mul_u32_u24 v0, 37, v184
    v_lshrrev_b32 v0, 10, v0
    v_mad_u32_u24 v184, v0, 24, v184
    v_add_u32 v0, 36, v3
    v_mul_u32_u24 v61, 37, v0
    v_lshrrev_b32 v61, 10, v61
    v_mad_u32_u24 v0, v61, 24, v0
    s_mov_b32 s46, 20480
    s_mov_b32 s47, 0
    buffer_load_dwordx4 v139, s[32:35], s92 offen offset:1024 lds
    v_add_u32 v186, 40, v3
    v_mul_u32_u24 v61, 37, v186
    v_lshrrev_b32 v61, 10, v61
    v_mad_u32_u24 v186, v61, 24, v186
    v_add_u32 v187, 44, v3
    v_mul_u32_u24 v3, 37, v187
    v_lshrrev_b32 v3, 10, v3
    v_mad_u32_u24 v187, v3, 24, v187
    v_lshl_add_u32 v61, v142, 4, v63
    v_mul_u32_u24 v3, 37, v61
    v_lshrrev_b32 v3, 10, v3
    v_mad_u32_u24 v61, v3, 24, v61
    v_mov_b32 v14, 336
    v_cmp_gt_u32 vcc, 3, v142
    v_mov_b32 v3, s82
    s_mov_b32 s57, s72
    s_mov_b32 s58, 0
    buffer_load_dwordx4 v77, s[32:35], s92 offen offset:2048 lds
    s_add_u32 m0, s90, 24576
    s_mov_b32 s92, 73728
    v_cndmask_b32 v61, v14, v61, vcc
    v_sub_u32 v61, s101, v61
    v_min_f32 v3, 0x40930000, v3
    v_max_f32 v3, 0xc2c80000, v3
    v_mul_f32 v3, 0x3fb8aa3b, v3
    v_exp_f32 v3, v3
    s_waitcnt vmcnt(18)
    v_lshl_or_b32 v12, v13, 16, v12
    v_cvt_pk_bf16_f32 v3, v3, v3
    v_lshlrev_b32 v3, 16, v3
    v_mul_f32 v3, 0x4038aa3b, v3
    s_waitcnt vmcnt(16)
    v_lshl_or_b32 v136, v154, 16, v136
    v_readfirstlane_b32 s55, v3
    v_add_f32 v3, v3, v3
    s_waitcnt vmcnt(14)
    v_lshl_or_b32 v137, v23, 16, v137
    v_readfirstlane_b32 s52, v3
    v_cmp_gt_u32 vcc, 16, v156
    v_mov_b32 v13, 0
    v_mov_b32 v14, 0
    v_cndmask_b32 v15, 0, v12, vcc
    v_cndmask_b32 v12, 0, v12, vcc
    v_mov_b32 v23, 0
    v_mfma_f32_16x16x16_bf16 v[4:7], v[14:15], v[20:21], 0
    s_mov_b32 s59, 0
    v_mul_u32_u24 v3, 5120, v142
    v_add_u32 v3, v153, v3
    v_mfma_f32_16x16x16_bf16 v[8:11], v[12:13], v[20:21], 0
    s_mov_b32 s60, 0
    v_mov_b32 v122, 0xc138aa3b
    v_mul_u32_u24 v131, 5120, v143
    v_mfma_f32_16x16x16_bf16 v[16:19], v[12:13], v[22:23], 0
    s_mov_b32 s65, -1
    v_max_f32 v4, 0, v4
    v_max_f32 v5, 0, v5
    v_max_f32 v6, 0, v6
    v_max_f32 v8, 0, v8
    v_max_f32 v9, 0, v9
    v_max_f32 v10, 0, v10
    v_max_f32 v11, 0, v11
    v_cvt_pk_bf16_f32 v8, v8, v9
    v_cvt_pk_bf16_f32 v9, v10, v11
    v_max_f32 v7, 0, v7
    v_cvt_pk_bf16_f32 v4, v4, v5
    v_mfma_f32_16x16x16_bf16 v[12:15], v[136:137], v[8:9], 0
    s_mov_b32 s61, 1
    v_cvt_pk_bf16_f32 v5, v6, v7
    v_max_f32 v16, 0, v16
    v_max_f32 v17, 0, v17
    v_mfma_f32_16x16x16_bf16 v[8:11], v[136:137], v[4:5], 0
    s_movk_i32 s4, 112
    v_max_f32 v18, 0, v18
    v_max_f32 v19, 0, v19
    v_cvt_pk_bf16_f32 v16, v16, v17
    v_cvt_pk_bf16_f32 v17, v18, v19
    v_cvt_pk_bf16_f32 v12, v12, v12
    v_lshlrev_b32 v12, 16, v12
    v_mfma_f32_16x16x16_bf16 v[4:7], v[136:137], v[16:17], 0
    s_mov_b32 s5, 0
    v_mul_f32 v12, 0xbfb8aa3b, v12
    v_cvt_pk_bf16_f32 v8, v8, v8
    v_exp_f32 v12, v12
    v_lshlrev_b32 v8, 16, v8
    v_add_f32 v12, 1.0, v12
    v_rcp_f32 v12, v12
    v_mul_f32 v8, 0xbfb8aa3b, v8
    v_cvt_pk_bf16_f32 v12, v12, v12
    v_lshlrev_b32 v12, 16, v12
    v_fma_f32 v12, v12, s84, v122
    s_mov_b32 s6, 0
    s_mov_b32 s12, 0
    ds_write_b32 v3, v12 offset:44032
    v_exp_f32 v8, v8
    v_cvt_pk_bf16_f32 v4, v4, v4
    v_add_f32 v8, 1.0, v8
    v_rcp_f32 v8, v8
    v_lshlrev_b32 v4, 16, v4
    v_cvt_pk_bf16_f32 v8, v8, v8
    v_lshlrev_b32 v8, 16, v8
    v_fma_f32 v8, v8, s84, v122
    s_mov_b32 s64, 3
    s_mov_b32 s10, 81924
    ds_write_b32 v3, v8 offset:44036
    v_mul_f32 v4, 0xbfb8aa3b, v4
    v_exp_f32 v4, v4
    v_mad_u32_u24 v131, v152, s86, v131
    v_add_f32 v4, 1.0, v4
    v_rcp_f32 v4, v4
    v_and_b32 v120, 7, v132
    v_cvt_pk_bf16_f32 v4, v4, v4
    v_lshlrev_b32 v4, 16, v4
    v_fma_f32 v4, v4, s84, v122
    s_mov_b32 s11, 0x20000
    s_mov_b32 s3, 0x00010001
    ds_write_b32 v3, v4 offset:44040
    v_xor_b32 v122, v120, v142
    v_lshl_add_u32 v3, v122, 4, v131
    v_xor_b32 v170, 64, v3
    v_add_u32 v137, 40960, v3
    v_xor_b32 v136, 64, v137
    v_add_u32 v131, 61440, v131
    v_add_u32 v122, s93, v142
    v_xor_b32 v122, v120, v122
    v_lshl_add_u32 v135, v122, 4, v131
    v_lshrrev_b32 v122, 1, v142
    v_add3_u32 v122, v122, s93, 4
    v_xor_b32 v122, v120, v122
    v_lshl_add_u32 v122, v122, 4, v131
    v_and_b32 v131, 1, v142
    v_lshl_add_u32 v134, v131, 3, v122
    v_lshlrev_b32 v153, 4, v156
    s_add_u32 s93, s54, 20480
    v_add_u32 v133, s93, v153
    v_add_u32 v129, 81920, v153
    s_lshr_b32 s93, s68, 1
    s_lshl_b32 s93, s93, 10
    s_add_u32 s93, s93, s94
    v_add_u32 v130, s93, v129
    s_mul_i32 s93, s68, 7168
    s_add_u32 s93, s93, 135168
    v_mul_u32_u24 v131, 1792, v142
    v_add_u32 v122, s93, v131
    v_mul_u32_u24 v131, 112, v132
    v_add_u32 v120, v131, v122
    v_subrev_u32 v120, 28672, v120
    v_cmp_eq_u32 vcc, 0, v143
    v_add_u32 v131, 16, v122
    v_mov_b32 v123, 0
    s_waitcnt lgkmcnt(0)
    s_barrier
    v_cndmask_b32 v132, v141, v122, vcc
    v_cmp_eq_u32 vcc, 3, v152
    v_mov_b32 v122, 0
    v_sub_u32 v204, v199, v140
    v_cndmask_b32 v132, v132, v131, vcc
    v_mul_u32_u24 v131, 1792, v143
    v_lshl_add_u32 v131, v142, 3, v131
    v_lshl_add_u32 v131, v152, 1, v131
    v_add_u32 v131, s93, v131
    v_cmp_gt_u32 vcc, 3, v142
    s_add_u32 s93, s69, 1
    s_mul_i32 s94, s93, 58255
    buffer_load_dwordx4 v155, s[32:35], s92 offen offset:0 lds
    ds_read_b32 v204, v204 offset:336
    v_cndmask_b32 v131, v141, v131, vcc
    s_lshr_b32 s94, s94, 22
    s_mul_i32 s94, s94, s63
    s_mul_i32 s56, s93, s62
    s_add_u32 s56, s56, s94
    s_sub_u32 s93, s71, 1
    s_cmp_eq_u32 s68, 0
    s_cselect_b32 s13, s93, -1
    s_cmp_gt_u32 s73, 20
    s_cselect_b32 s13, s13, -1
    s_and_b32 s93, s2, -8
    s_sub_u32 s93, 81920, s93
    s_sub_u32 s8, s38, s93
    s_subb_u32 s9, s39, 0
    ds_read_b32 v208, v199
    v_sub_u32 v205, v199, v78
    v_sub_u32 v206, v199, v194
    v_sub_u32 v207, v199, v79
    v_sub_u32 v200, v199, v76
    v_sub_u32 v201, v199, v2
    buffer_load_dwordx4 v139, s[32:35], s92 offen offset:1024 lds
    ds_read_b32 v205, v205 offset:336
    v_sub_u32 v202, v199, v1
    v_sub_u32 v203, v199, v185
    v_sub_u32 v196, v199, v184
    v_sub_u32 v197, v199, v0
    v_sub_u32 v198, v199, v186
    ds_read_b32 v206, v206 offset:336
    v_sub_u32 v199, v199, v187
    v_sub_u32 v180, v60, v140
    buffer_load_dwordx4 v77, s[32:35], s92 offen offset:2048 lds
    s_add_u32 m0, s90, 36864
    s_mov_b32 s92, 110592
    ds_read_b32 v207, v207 offset:336
    v_sub_u32 v181, v60, v78
    v_sub_u32 v182, v60, v194
    v_sub_u32 v183, v60, v79
    v_sub_u32 v176, v60, v76
    v_sub_u32 v177, v60, v2
    ds_read_b32 v200, v200 offset:336
    v_sub_u32 v178, v60, v1
    v_sub_u32 v179, v60, v185
    v_sub_u32 v172, v60, v184
    v_sub_u32 v173, v60, v0
    v_sub_u32 v174, v60, v186
    ds_read_b32 v201, v201 offset:336
    v_sub_u32 v175, v60, v187
    v_sub_u32 v192, v62, v140
    buffer_load_dwordx4 v155, s[32:35], s92 offen offset:0 lds
    ds_read_b32 v202, v202 offset:336
    v_sub_u32 v193, v62, v78
    v_sub_u32 v194, v62, v194
    v_sub_u32 v195, v62, v79
    v_sub_u32 v188, v62, v76
    v_sub_u32 v189, v62, v2
    ds_read_b32 v203, v203 offset:336
    s_mov_b64 exec, 0
    s_cmp_eq_u32 s68, 2
    s_cbranch_scc1 L_pga
    s_cmp_eq_u32 s68, 3
    s_cbranch_scc1 L_pg2
    s_cmp_eq_u32 s68, 1
    s_cbranch_scc1 L_pg1
    s_branch L_pg0
L_prod:
    v_mbcnt_lo_u32_b32 v1, -1, 0
    v_mbcnt_hi_u32_b32 v1, -1, v1
    v_and_b32 v2, 15, v1
    v_lshrrev_b32 v3, 4, v1
    v_lshrrev_b32 v4, 2, v2
    v_and_b32 v5, 3, v2
    v_lshl_add_u32 v6, v4, 3, v5
    v_mul_u32_u24 v6, 384, v6
    s_lshr_b32 s85, s68, 1
    s_lshl1_add_u32 s84, s84, s85
    s_mul_i32 s85, s84, 12288
    v_add_u32 v6, s85, v6
    v_lshl_add_u32 v7, v3, 4, v6
    v_lshl_add_u32 v8, v3, 3, v6
    s_and_b32 s85, s68, 1
    s_mul_i32 s86, s85, 192
    s_sub_u32 s87, 192, s86
    s_mul_i32 s85, s85, 36
    s_add_u32 s85, s85, s84
    s_lshl_b32 s85, s85, 10
    v_lshl_add_u32 v18, v1, 4, s85
    v_mov_b32 v10, 0
    s_waitcnt lgkmcnt(0)
    s_mov_b32 s10, 73728
    s_mov_b32 s11, 0x20000
    s_mov_b32 s78, 73728
    s_mov_b32 s79, 0x20000
    buffer_load_dwordx4 v[20:23], v7, s[8:11], s86 offen offset:0
    buffer_load_dwordx2 v[36:37], v8, s[8:11], s86 offen offset:64
    buffer_load_dwordx4 v[24:27], v7, s[8:11], s86 offen offset:96
    buffer_load_dwordx2 v[38:39], v8, s[8:11], s86 offen offset:160
    buffer_load_dwordx4 v[28:31], v7, s[8:11], s87 offen offset:0
    buffer_load_dwordx2 v[40:41], v8, s[8:11], s87 offen offset:64
    buffer_load_dwordx4 v[32:35], v7, s[8:11], s87 offen offset:96
    buffer_load_dwordx2 v[42:43], v8, s[8:11], s87 offen offset:160
    buffer_load_dwordx4 v[44:47], v7, s[8:11], s86 offen offset:1536
    buffer_load_dwordx2 v[60:61], v8, s[8:11], s86 offen offset:1600
    buffer_load_dwordx4 v[48:51], v7, s[8:11], s86 offen offset:1632
    buffer_load_dwordx2 v[62:63], v8, s[8:11], s86 offen offset:1696
    buffer_load_dwordx4 v[52:55], v7, s[8:11], s87 offen offset:1536
    buffer_load_dwordx2 v[64:65], v8, s[8:11], s87 offen offset:1600
    buffer_load_dwordx4 v[56:59], v7, s[8:11], s87 offen offset:1632
    buffer_load_dwordx2 v[66:67], v8, s[8:11], s87 offen offset:1696
    s_add_u32 s88, s76, 0x18000
    s_addc_u32 s89, s77, 0
    global_load_dword v9, v10, s[88:89]
    global_load_dword v19, v10, s[38:39] offset:248 sc1
    v_mov_b32 v12, 0x3f803f80
    v_mov_b32 v13, 0x3f803f80
    v_mov_b32 v14, 0x3f803f80
    v_mov_b32 v15, 0x3f803f80
    v_and_b32 v10, 1, v1
    v_lshlrev_b32 v10, 4, v10
    v_mov_b32 v11, 0x3f80
    v_lshlrev_b32 v10, v10, v11
    v_cmp_eq_u32 vcc, v3, v4
    s_nop 1
    v_cndmask_b32 v10, 0, v10, vcc
    v_cmp_gt_u32 vcc, 2, v5
    s_nop 1
    v_cndmask_b32 v16, 0, v10, vcc
    v_cmp_le_u32 vcc, 2, v5
    s_nop 1
    v_cndmask_b32 v17, 0, v10, vcc
    s_waitcnt vmcnt(2)
    v_mfma_f32_16x16x32_bf16 v[68:71], v[20:23], v[12:15], 0
    v_mfma_f32_16x16x32_bf16 v[68:71], v[24:27], v[12:15], v[68:71]
    v_mfma_f32_16x16x32_bf16 v[68:71], v[28:31], v[12:15], v[68:71]
    v_mfma_f32_16x16x32_bf16 v[68:71], v[32:35], v[12:15], v[68:71]
    v_mfma_f32_16x16x32_bf16 v[68:71], v[36:39], v[12:15], v[68:71]
    v_mfma_f32_16x16x32_bf16 v[68:71], v[40:43], v[12:15], v[68:71]
    v_mfma_f32_16x16x32_bf16 v[72:75], v[44:47], v[12:15], 0
    v_mfma_f32_16x16x32_bf16 v[72:75], v[48:51], v[12:15], v[72:75]
    v_mfma_f32_16x16x32_bf16 v[72:75], v[52:55], v[12:15], v[72:75]
    v_mfma_f32_16x16x32_bf16 v[72:75], v[56:59], v[12:15], v[72:75]
    v_mfma_f32_16x16x32_bf16 v[72:75], v[60:63], v[12:15], v[72:75]
    v_mfma_f32_16x16x32_bf16 v[72:75], v[64:67], v[12:15], v[72:75]
    s_nop 1
    v_mul_f32 v68, 0xbbaaaaab, v68
    v_mul_f32 v69, 0xbbaaaaab, v69
    v_mul_f32 v70, 0xbbaaaaab, v70
    v_mul_f32 v71, 0xbbaaaaab, v71
    s_nop 1
    v_mfma_f32_16x16x16_bf16 v[76:79], v[20:21], v[16:17], v[68:71]
    v_mfma_f32_16x16x16_bf16 v[80:83], v[22:23], v[16:17], v[68:71]
    v_mfma_f32_16x16x16_bf16 v[84:87], v[36:37], v[16:17], v[68:71]
    v_mfma_f32_16x16x16_bf16 v[88:91], v[24:25], v[16:17], v[68:71]
    v_mfma_f32_16x16x16_bf16 v[92:95], v[26:27], v[16:17], v[68:71]
    v_mfma_f32_16x16x16_bf16 v[96:99], v[38:39], v[16:17], v[68:71]
    v_mul_f32 v72, 0xbbaaaaab, v72
    v_mul_f32 v73, 0xbbaaaaab, v73
    v_mul_f32 v74, 0xbbaaaaab, v74
    v_mul_f32 v75, 0xbbaaaaab, v75
    s_nop 1
    v_mfma_f32_16x16x16_bf16 v[100:103], v[44:45], v[16:17], v[72:75]
    v_mfma_f32_16x16x16_bf16 v[104:107], v[46:47], v[16:17], v[72:75]
    v_mfma_f32_16x16x16_bf16 v[108:111], v[60:61], v[16:17], v[72:75]
    v_mfma_f32_16x16x16_bf16 v[112:115], v[48:49], v[16:17], v[72:75]
    v_mfma_f32_16x16x16_bf16 v[116:119], v[50:51], v[16:17], v[72:75]
    v_mfma_f32_16x16x16_bf16 v[120:123], v[62:63], v[16:17], v[72:75]
    v_cvt_pk_bf16_f32 v124, v76, v77
    v_cvt_pk_bf16_f32 v125, v78, v79
    s_nop 0
    v_cvt_pk_bf16_f32 v126, v100, v101
    v_cvt_pk_bf16_f32 v127, v102, v103
    s_movk_i32 s85, 0
    buffer_store_dwordx4 v[124:127], v18, s[76:79], s85 offen sc1
    v_cvt_pk_bf16_f32 v128, v80, v81
    v_cvt_pk_bf16_f32 v129, v82, v83
    v_cvt_pk_bf16_f32 v130, v104, v105
    v_cvt_pk_bf16_f32 v131, v106, v107
    s_movk_i32 s85, 6144
    buffer_store_dwordx4 v[128:131], v18, s[76:79], s85 offen sc1
    v_cvt_pk_bf16_f32 v132, v84, v85
    v_cvt_pk_bf16_f32 v133, v86, v87
    v_cvt_pk_bf16_f32 v134, v108, v109
    v_cvt_pk_bf16_f32 v135, v110, v111
    s_movk_i32 s85, 12288
    buffer_store_dwordx4 v[132:135], v18, s[76:79], s85 offen sc1
    v_cvt_pk_bf16_f32 v136, v88, v89
    v_cvt_pk_bf16_f32 v137, v90, v91
    v_cvt_pk_bf16_f32 v138, v112, v113
    v_cvt_pk_bf16_f32 v139, v114, v115
    s_movk_i32 s85, 18432
    buffer_store_dwordx4 v[136:139], v18, s[76:79], s85 offen sc1
    v_cvt_pk_bf16_f32 v140, v92, v93
    v_cvt_pk_bf16_f32 v141, v94, v95
    v_cvt_pk_bf16_f32 v142, v116, v117
    v_cvt_pk_bf16_f32 v143, v118, v119
    s_movk_i32 s85, 24576
    buffer_store_dwordx4 v[140:143], v18, s[76:79], s85 offen sc1
    v_cvt_pk_bf16_f32 v144, v96, v97
    v_cvt_pk_bf16_f32 v145, v98, v99
    v_cvt_pk_bf16_f32 v146, v120, v121
    v_cvt_pk_bf16_f32 v147, v122, v123
    s_movk_i32 s85, 30720
    buffer_store_dwordx4 v[144:147], v18, s[76:79], s85 offen sc1
    v_mov_b32 v10, 0
    v_mov_b32 v11, 1
    s_mov_b32 s64, 8
    s_waitcnt vmcnt(0)
    s_barrier
    s_cmp_lg_u32 s68, 0
    s_cbranch_scc1 L_top2
    s_mov_b64 exec, 1
    global_atomic_add v10, v11, s[38:39] offset:248 sc1
    s_mov_b64 exec, -1
    s_branch L_top2
.p2align 12
L_main:
    s_mov_b64 exec, -1
    s_waitcnt vmcnt(10)
    s_barrier
    v_sub_u32 v190, v62, v1
    v_sub_u32 v191, v62, v185
    v_sub_u32 v184, v62, v184
    v_sub_u32 v185, v62, v0
    ds_read_b128 v[16:19], v3 offset:40960
    v_sub_u32 v186, v62, v186
    v_sub_u32 v187, v62, v187
    ds_read_b128 v[20:23], v3 offset:42496
    ds_read_b128 v[12:15], v3 offset:0
    buffer_load_dwordx4 v139, s[32:35], s92 offen offset:1024 lds
    ds_read_b128 v[8:11], v3 offset:1536
    ds_read_b128 v[36:39], v3 offset:3072
    ds_read_b32 v196, v196 offset:336
    ds_read_b32 v197, v197 offset:336
    buffer_load_dwordx4 v77, s[32:35], s92 offen offset:2048 lds
    s_add_u32 m0, s90, 49152
    s_mov_b32 s92, 147456
    ds_read_b32 v198, v198 offset:336
    ds_read_b32 v199, v199 offset:336
    ds_read_b32 v211, v61 offset:672
    buffer_load_dwordx4 v155, s[32:35], s92 offen offset:0 lds
    s_waitcnt vmcnt(10)
    ds_read_b64_tr_b16 a[0:1], v121 offset:0
    ds_read_b64_tr_b16 a[2:3], v121 offset:768
    ds_read_b64_tr_b16 a[24:25], v121 offset:32
    ds_read_b64_tr_b16 a[26:27], v121 offset:800
    ds_read_b64_tr_b16 a[48:49], v121 offset:64
    ds_read_b64_tr_b16 a[50:51], v121 offset:832
    ds_read_b32 v180, v180 offset:336
    ds_read_b32 v181, v181 offset:336
    buffer_load_dwordx4 v139, s[32:35], s92 offen offset:1024 lds
    ds_read_b32 v182, v182 offset:336
    ds_read_b32 v183, v183 offset:336
    ds_read_b32 v176, v176 offset:336
    s_waitcnt lgkmcnt(8)
    v_mfma_f32_16x16x32_bf16 v[52:55], a[0:3], v[16:19], 0
    s_waitcnt lgkmcnt(7)
    buffer_load_dwordx4 v77, s[32:35], s92 offen offset:2048 lds
    v_mfma_f32_16x16x32_bf16 v[32:35], a[24:27], v[16:19], 0
    s_waitcnt lgkmcnt(5)
    s_add_u32 m0, s90, 61440
    ds_read_b128 v[64:67], v170 offset:40960
    v_mfma_f32_16x16x32_bf16 v[4:7], a[48:51], v[16:19], 0
    s_mov_b32 s92, 184320
    ds_read_b32 v177, v177 offset:336
    v_mfma_f32_16x16x32_bf16 v[16:19], a[0:3], v[20:23], 0
    v_mfma_f32_16x16x32_bf16 v[40:43], a[24:27], v[20:23], 0
    ds_read_b128 v[48:51], v170 offset:42496
    v_mfma_f32_16x16x32_bf16 v[24:27], a[48:51], v[20:23], 0
    s_waitcnt vmcnt(9)
    buffer_load_dwordx4 v155, s[32:35], s92 offen offset:0 lds
    ds_read_b64_tr_b16 a[4:5], v121 offset:12288
    v_mfma_f32_16x16x32_bf16 v[28:31], a[0:3], v[12:15], 0
    ds_read_b64_tr_b16 a[6:7], v121 offset:13056
    v_mfma_f32_16x16x32_bf16 v[148:151], a[24:27], v[12:15], 0
    ds_read_b64_tr_b16 a[28:29], v121 offset:12320
    v_mfma_f32_16x16x32_bf16 v[96:99], a[48:51], v[12:15], 0
    ds_read_b64_tr_b16 a[30:31], v121 offset:13088
    v_mfma_f32_16x16x32_bf16 v[92:95], a[0:3], v[8:11], 0
    ds_read_b64_tr_b16 a[52:53], v121 offset:12352
    v_mfma_f32_16x16x32_bf16 v[112:115], a[24:27], v[8:11], 0
    buffer_load_dwordx4 v139, s[32:35], s92 offen offset:1024 lds
    ds_read_b64_tr_b16 a[54:55], v121 offset:13120
    v_mfma_f32_16x16x32_bf16 v[80:83], a[48:51], v[8:11], 0
    ds_read_b128 v[20:23], v170 offset:0
    v_mfma_f32_16x16x32_bf16 v[8:11], a[0:3], v[36:39], 0
    ds_read_b128 v[12:15], v170 offset:1536
    v_mfma_f32_16x16x32_bf16 v[68:71], a[24:27], v[36:39], 0
    ds_read_b128 v[44:47], v170 offset:3072
    v_mfma_f32_16x16x32_bf16 v[116:119], a[48:51], v[36:39], 0
    s_waitcnt lgkmcnt(7)
    ds_read_b32 v178, v178 offset:336
    v_mfma_f32_16x16x32_bf16 v[52:55], a[4:7], v[64:67], v[52:55]
    buffer_load_dwordx4 v77, s[32:35], s92 offen offset:2048 lds
    ds_read_b128 v[56:59], v3 offset:41088
    v_mfma_f32_16x16x32_bf16 v[16:19], a[4:7], v[48:51], v[16:19]
    s_waitcnt lgkmcnt(7)
    s_add_u32 m0, s90, 0
    ds_read_b32 v179, v179 offset:336
    v_mfma_f32_16x16x32_bf16 v[32:35], a[28:31], v[64:67], v[32:35]
    s_mov_b32 s92, 384
    v_mfma_f32_16x16x32_bf16 v[40:43], a[28:31], v[48:51], v[40:43]
    s_waitcnt lgkmcnt(6)
    ds_read_b128 v[36:39], v3 offset:42624
    v_mfma_f32_16x16x32_bf16 v[4:7], a[52:55], v[64:67], v[4:7]
    ds_read_b32 v172, v172 offset:336
    v_mfma_f32_16x16x32_bf16 v[24:27], a[52:55], v[48:51], v[24:27]
    s_waitcnt lgkmcnt(6)
    buffer_load_dwordx4 v155, s[32:35], s92 offen offset:0 lds
    v_mfma_f32_16x16x32_bf16 v[28:31], a[4:7], v[20:23], v[28:31]
    s_waitcnt vmcnt(10)
    ds_read_b64_tr_b16 a[8:9], v121 offset:24576
    v_mfma_f32_16x16x32_bf16 v[148:151], a[28:31], v[20:23], v[148:151]
    ds_read_b64_tr_b16 a[10:11], v121 offset:25344
    v_mfma_f32_16x16x32_bf16 v[96:99], a[52:55], v[20:23], v[96:99]
    ds_read_b64_tr_b16 a[32:33], v121 offset:24608
    v_mfma_f32_16x16x32_bf16 v[92:95], a[4:7], v[12:15], v[92:95]
    ds_read_b64_tr_b16 a[34:35], v121 offset:25376
    v_mfma_f32_16x16x32_bf16 v[112:115], a[28:31], v[12:15], v[112:115]
    buffer_load_dwordx4 v139, s[32:35], s92 offen offset:1024 lds
    ds_read_b64_tr_b16 a[56:57], v121 offset:24640
    v_mfma_f32_16x16x32_bf16 v[80:83], a[52:55], v[12:15], v[80:83]
    s_waitcnt lgkmcnt(6)
    ds_read_b64_tr_b16 a[58:59], v121 offset:25408
    v_mfma_f32_16x16x32_bf16 v[8:11], a[4:7], v[44:47], v[8:11]
    ds_read_b128 v[20:23], v3 offset:128
    v_mfma_f32_16x16x32_bf16 v[68:71], a[28:31], v[44:47], v[68:71]
    ds_read_b128 v[12:15], v3 offset:1664
    v_mfma_f32_16x16x32_bf16 v[116:119], a[52:55], v[44:47], v[116:119]
    s_waitcnt lgkmcnt(6)
    ds_read_b128 v[48:51], v3 offset:3200
    buffer_load_dwordx4 v77, s[32:35], s92 offen offset:2048 lds
    s_add_u32 m0, s90, 12288
    s_mov_b32 s92, 37248
    ds_read_b32 v173, v173 offset:336
    v_mfma_f32_16x16x32_bf16 v[52:55], a[8:11], v[56:59], v[52:55]
    v_mfma_f32_16x16x32_bf16 v[16:19], a[8:11], v[36:39], v[16:19]
    s_waitcnt lgkmcnt(6)
    ds_read_b128 v[44:47], v170 offset:41088
    v_mfma_f32_16x16x32_bf16 v[32:35], a[32:35], v[56:59], v[32:35]
    ds_read_b32 v174, v174 offset:336
    v_mfma_f32_16x16x32_bf16 v[40:43], a[32:35], v[36:39], v[40:43]
    s_waitcnt lgkmcnt(6)
    buffer_load_dwordx4 v155, s[32:35], s92 offen offset:0 lds
    v_mfma_f32_16x16x32_bf16 v[4:7], a[56:59], v[56:59], v[4:7]
    s_waitcnt vmcnt(10)
    ds_read_b64_tr_b16 a[12:13], v121 offset:36864
    v_mfma_f32_16x16x32_bf16 v[24:27], a[56:59], v[36:39], v[24:27]
    s_waitcnt lgkmcnt(5)
    ds_read_b64_tr_b16 a[14:15], v121 offset:37632
    v_mfma_f32_16x16x32_bf16 v[28:31], a[8:11], v[20:23], v[28:31]
    ds_read_b64_tr_b16 a[36:37], v121 offset:36896
    v_mfma_f32_16x16x32_bf16 v[148:151], a[32:35], v[20:23], v[148:151]
    ds_read_b64_tr_b16 a[38:39], v121 offset:37664
    v_mfma_f32_16x16x32_bf16 v[96:99], a[56:59], v[20:23], v[96:99]
    ds_read_b64_tr_b16 a[60:61], v121 offset:36928
    buffer_load_dwordx4 v139, s[32:35], s92 offen offset:1024 lds
    v_mfma_f32_16x16x32_bf16 v[92:95], a[8:11], v[12:15], v[92:95]
    ds_read_b64_tr_b16 a[62:63], v121 offset:37696
    v_mfma_f32_16x16x32_bf16 v[112:115], a[32:35], v[12:15], v[112:115]
    ds_read_b128 v[20:23], v170 offset:42624
    v_mfma_f32_16x16x32_bf16 v[80:83], a[56:59], v[12:15], v[80:83]
    s_waitcnt lgkmcnt(7)
    ds_read_b128 v[12:15], v170 offset:128
    v_mfma_f32_16x16x32_bf16 v[8:11], a[8:11], v[48:51], v[8:11]
    ds_read_b128 v[36:39], v170 offset:1664
    v_mfma_f32_16x16x32_bf16 v[68:71], a[32:35], v[48:51], v[68:71]
    ds_read_b128 v[56:59], v170 offset:3200
    buffer_load_dwordx4 v77, s[32:35], s92 offen offset:2048 lds
    v_mfma_f32_16x16x32_bf16 v[116:119], a[56:59], v[48:51], v[116:119]
    s_waitcnt lgkmcnt(8)
    s_add_u32 m0, s90, 24576
    ds_read_b32 v175, v175 offset:336
    v_mfma_f32_16x16x32_bf16 v[52:55], a[12:15], v[44:47], v[52:55]
    s_waitcnt lgkmcnt(7)
    s_mov_b32 s92, 74112
    ds_read_b128 v[48:51], v3 offset:41216
    v_mfma_f32_16x16x32_bf16 v[32:35], a[36:39], v[44:47], v[32:35]
    s_waitcnt lgkmcnt(6)
    ds_read_b32 v210, v60
    v_mfma_f32_16x16x32_bf16 v[4:7], a[60:63], v[44:47], v[4:7]
    s_waitcnt vmcnt(9) lgkmcnt(6)
    buffer_load_dwordx4 v155, s[32:35], s92 offen offset:0 lds
    ds_read_b64_tr_b16 a[16:17], v121 offset:49152
    v_mfma_f32_16x16x32_bf16 v[16:19], a[12:15], v[20:23], v[16:19]
    ds_read_b64_tr_b16 a[18:19], v121 offset:49920
    v_mfma_f32_16x16x32_bf16 v[40:43], a[36:39], v[20:23], v[40:43]
    ds_read_b64_tr_b16 a[40:41], v121 offset:49184
    v_mfma_f32_16x16x32_bf16 v[24:27], a[60:63], v[20:23], v[24:27]
    s_waitcnt lgkmcnt(6)
    ds_read_b64_tr_b16 a[42:43], v121 offset:49952
    v_mfma_f32_16x16x32_bf16 v[28:31], a[12:15], v[12:15], v[28:31]
    ds_read_b64_tr_b16 a[64:65], v121 offset:49216
    v_mfma_f32_16x16x32_bf16 v[148:151], a[36:39], v[12:15], v[148:151]
    buffer_load_dwordx4 v139, s[32:35], s92 offen offset:1024 lds
    ds_read_b64_tr_b16 a[66:67], v121 offset:49984
    v_mfma_f32_16x16x32_bf16 v[96:99], a[60:63], v[12:15], v[96:99]
    ds_read_b128 v[44:47], v3 offset:42752
    v_mfma_f32_16x16x32_bf16 v[92:95], a[12:15], v[36:39], v[92:95]
    ds_read_b128 v[12:15], v3 offset:256
    v_mfma_f32_16x16x32_bf16 v[112:115], a[36:39], v[36:39], v[112:115]
    ds_read_b128 v[20:23], v3 offset:1792
    v_mfma_f32_16x16x32_bf16 v[80:83], a[60:63], v[36:39], v[80:83]
    ds_read_b32 v192, v192 offset:336
    v_mfma_f32_16x16x32_bf16 v[8:11], a[12:15], v[56:59], v[8:11]
    buffer_load_dwordx4 v77, s[32:35], s92 offen offset:2048 lds
    v_mfma_f32_16x16x32_bf16 v[68:71], a[36:39], v[56:59], v[68:71]
    s_add_u32 m0, s90, 36864
    ds_read_b128 v[36:39], v3 offset:3328
    v_mfma_f32_16x16x32_bf16 v[116:119], a[60:63], v[56:59], v[116:119]
    s_waitcnt lgkmcnt(7)
    s_mov_b32 s92, 110976
    ds_read_b32 v193, v193 offset:336
    v_mfma_f32_16x16x32_bf16 v[52:55], a[16:19], v[48:51], v[52:55]
    v_mfma_f32_16x16x32_bf16 v[32:35], a[40:43], v[48:51], v[32:35]
    s_waitcnt lgkmcnt(6)
    ds_read_b128 v[56:59], v170 offset:41216
    v_mfma_f32_16x16x32_bf16 v[4:7], a[64:67], v[48:51], v[4:7]
    s_waitcnt vmcnt(9) lgkmcnt(6)
    buffer_load_dwordx4 v155, s[32:35], s92 offen offset:0 lds
    ds_read_b64_tr_b16 a[20:21], v121 offset:61440
    v_mfma_f32_16x16x32_bf16 v[16:19], a[16:19], v[44:47], v[16:19]
    ds_read_b64_tr_b16 a[22:23], v121 offset:62208
    v_mfma_f32_16x16x32_bf16 v[40:43], a[40:43], v[44:47], v[40:43]
    ds_read_b64_tr_b16 a[44:45], v121 offset:61472
    v_mfma_f32_16x16x32_bf16 v[24:27], a[64:67], v[44:47], v[24:27]
    s_waitcnt lgkmcnt(6)
    ds_read_b64_tr_b16 a[46:47], v121 offset:62240
    v_mfma_f32_16x16x32_bf16 v[28:31], a[16:19], v[12:15], v[28:31]
    ds_read_b64_tr_b16 a[68:69], v121 offset:61504
    v_mfma_f32_16x16x32_bf16 v[148:151], a[40:43], v[12:15], v[148:151]
    buffer_load_dwordx4 v139, s[32:35], s92 offen offset:1024 lds
    ds_read_b64_tr_b16 a[70:71], v121 offset:62272
    v_mfma_f32_16x16x32_bf16 v[96:99], a[64:67], v[12:15], v[96:99]
    ds_read_b128 v[44:47], v170 offset:42752
    v_mfma_f32_16x16x32_bf16 v[92:95], a[16:19], v[20:23], v[92:95]
    ds_read_b128 v[12:15], v170 offset:256
    v_mov_b32 v154, 0xf149f2ca
    v_mfma_f32_16x16x32_bf16 v[112:115], a[40:43], v[20:23], v[112:115]
    ds_read_b128 v[48:51], v170 offset:1792
    v_mfma_f32_16x16x32_bf16 v[80:83], a[64:67], v[20:23], v[80:83]
    s_waitcnt lgkmcnt(8)
    ds_read_b32 v194, v194 offset:336
    v_mfma_f32_16x16x32_bf16 v[8:11], a[16:19], v[36:39], v[8:11]
    buffer_load_dwordx4 v77, s[32:35], s92 offen offset:2048 lds
    v_mfma_f32_16x16x32_bf16 v[68:71], a[40:43], v[36:39], v[68:71]
    s_add_u32 m0, s90, 49152
    ds_read_b128 v[20:23], v170 offset:3328
    v_mfma_f32_16x16x32_bf16 v[116:119], a[64:67], v[36:39], v[116:119]
    s_waitcnt lgkmcnt(7)
    s_mov_b32 s92, 147840
    ds_read_b32 v195, v195 offset:336
    v_mfma_f32_16x16x32_bf16 v[52:55], a[20:23], v[56:59], v[52:55]
    v_mfma_f32_16x16x32_bf16 v[32:35], a[44:47], v[56:59], v[32:35]
    s_waitcnt lgkmcnt(6)
    ds_read_b128 v[36:39], v3 offset:40960
    v_mfma_f32_16x16x32_bf16 v[4:7], a[68:71], v[56:59], v[4:7]
    s_waitcnt vmcnt(9) lgkmcnt(6)
    buffer_load_dwordx4 v155, s[32:35], s92 offen offset:0 lds
    ds_read_b64_tr_b16 a[72:73], v121 offset:0
    v_mfma_f32_16x16x32_bf16 v[16:19], a[20:23], v[44:47], v[16:19]
    ds_read_b64_tr_b16 a[74:75], v121 offset:768
    v_cvt_pk_f16_f32 v100, v52, v53
    v_mfma_f32_16x16x32_bf16 v[40:43], a[44:47], v[44:47], v[40:43]
    ds_read_b64_tr_b16 a[96:97], v121 offset:32
    v_cvt_pk_f16_f32 v101, v54, v55
    v_mfma_f32_16x16x32_bf16 v[24:27], a[68:71], v[44:47], v[24:27]
    s_waitcnt lgkmcnt(6)
    ds_read_b64_tr_b16 a[98:99], v121 offset:800
    v_pk_fma_f16 v240, v100, v100, s3
    v_mfma_f32_16x16x32_bf16 v[28:31], a[20:23], v[12:15], v[28:31]
    ds_read_b64_tr_b16 a[120:121], v121 offset:64
    v_pk_fmac_f16 v240, v101, v101
    v_mfma_f32_16x16x32_bf16 v[148:151], a[44:47], v[12:15], v[148:151]
    buffer_load_dwordx4 v139, s[32:35], s92 offen offset:1024 lds
    ds_read_b64_tr_b16 a[122:123], v121 offset:832
    v_mfma_f32_16x16x32_bf16 v[96:99], a[68:71], v[12:15], v[96:99]
    ds_read_b128 v[44:47], v3 offset:42496
    v_cvt_pk_f16_f32 v102, v32, v33
    v_mfma_f32_16x16x32_bf16 v[92:95], a[20:23], v[48:51], v[92:95]
    ds_read_b128 v[12:15], v3 offset:0
    v_cvt_pk_f16_f32 v103, v34, v35
    v_mfma_f32_16x16x32_bf16 v[112:115], a[44:47], v[48:51], v[112:115]
    ds_read_b128 v[32:35], v3 offset:1536
    v_pk_fmac_f16 v240, v102, v102
    v_mfma_f32_16x16x32_bf16 v[80:83], a[68:71], v[48:51], v[80:83]
    s_waitcnt lgkmcnt(8)
    ds_read_b32 v188, v188 offset:336
    v_pk_fmac_f16 v240, v103, v103
    v_mfma_f32_16x16x32_bf16 v[8:11], a[20:23], v[20:23], v[8:11]
    buffer_load_dwordx4 v77, s[32:35], s92 offen offset:2048 lds
    v_cvt_pk_f16_f32 v144, v4, v5
    v_mfma_f32_16x16x32_bf16 v[68:71], a[44:47], v[20:23], v[68:71]
    s_add_u32 m0, s90, 61440
    ds_read_b128 v[72:75], v3 offset:3072
    v_cvt_pk_f16_f32 v145, v6, v7
    v_mfma_f32_16x16x32_bf16 v[116:119], a[68:71], v[20:23], v[116:119]
    s_waitcnt lgkmcnt(7)
    s_mov_b32 s92, 184704
    ds_read_b32 v189, v189 offset:336
    v_pk_fmac_f16 v240, v144, v144
    v_mfma_f32_16x16x32_bf16 v[4:7], a[72:75], v[36:39], 0
    v_pk_fmac_f16 v240, v145, v145
    v_cvt_pk_f16_f32 v16, v16, v17
    v_mfma_f32_16x16x32_bf16 v[20:23], a[96:99], v[36:39], 0
    s_waitcnt lgkmcnt(6)
    ds_read_b128 v[160:163], v170 offset:40960
    v_cvt_pk_f16_f32 v17, v18, v19
    v_mfma_f32_16x16x32_bf16 v[56:59], a[120:123], v[36:39], 0
    s_waitcnt vmcnt(9) lgkmcnt(6)
    buffer_load_dwordx4 v155, s[32:35], s92 offen offset:0 lds
    ds_read_b64_tr_b16 a[76:77], v121 offset:12288
    v_mfma_f32_16x16x32_bf16 v[88:91], a[72:75], v[44:47], 0
    ds_read_b64_tr_b16 a[78:79], v121 offset:13056
    v_pk_fma_f16 v242, v16, v16, s3
    v_mfma_f32_16x16x32_bf16 v[64:67], a[96:99], v[44:47], 0
    ds_read_b64_tr_b16 a[100:101], v121 offset:12320
    v_pk_fmac_f16 v242, v17, v17
    v_mfma_f32_16x16x32_bf16 v[36:39], a[120:123], v[44:47], 0
    s_waitcnt lgkmcnt(6)
    ds_read_b64_tr_b16 a[102:103], v121 offset:13088
    v_cvt_pk_f16_f32 v18, v40, v41
    v_mfma_f32_16x16x32_bf16 v[48:51], a[72:75], v[12:15], 0
    ds_read_b64_tr_b16 a[124:125], v121 offset:12352
    v_cvt_pk_f16_f32 v19, v42, v43
    v_pk_fmac_f16 v242, v18, v18
    v_pk_fmac_f16 v242, v19, v19
    buffer_load_dwordx4 v139, s[32:35], s92 offen offset:1024 lds
    ds_read_b64_tr_b16 a[126:127], v121 offset:13120
    v_cvt_pk_f16_f32 v60, v24, v25
    v_cvt_pk_f16_f32 v61, v26, v27
    v_pk_fmac_f16 v242, v60, v60
    v_pk_fmac_f16 v242, v61, v61
    v_mfma_f32_16x16x32_bf16 v[108:111], a[96:99], v[12:15], 0
    ds_read_b128 v[44:47], v170 offset:42496
    v_cvt_pk_f16_f32 v24, v28, v29
    v_mfma_f32_16x16x32_bf16 v[52:55], a[120:123], v[12:15], 0
    ds_read_b128 v[84:87], v170 offset:0
    v_cvt_pk_f16_f32 v25, v30, v31
    v_mfma_f32_16x16x32_bf16 v[40:43], a[72:75], v[32:35], 0
    s_waitcnt lgkmcnt(6)
    ds_read_b128 v[12:15], v170 offset:1536
    v_pk_fma_f16 v232, v24, v24, s3
    v_mfma_f32_16x16x32_bf16 v[4:7], a[76:79], v[160:163], v[4:7]
    s_waitcnt lgkmcnt(5)
    buffer_load_dwordx4 v77, s[32:35], s92 offen offset:2048 lds
    ds_read_b32 v190, v190 offset:336
    v_pk_fmac_f16 v232, v25, v25
    v_cvt_pk_f16_f32 v26, v148, v149
    s_add_u32 m0, s90, 0
    v_mfma_f32_16x16x32_bf16 v[20:23], a[100:103], v[160:163], v[20:23]
    s_mov_b32 s92, 768
    ds_read_b32 v191, v191 offset:336
    v_cvt_pk_f16_f32 v27, v150, v151
    v_pk_fmac_f16 v232, v26, v26
    v_pk_fmac_f16 v232, v27, v27
    v_cvt_pk_f16_f32 v152, v96, v97
    v_cvt_pk_f16_f32 v153, v98, v99
    v_pk_fmac_f16 v232, v152, v152
    v_pk_fmac_f16 v232, v153, v153
    v_mfma_f32_16x16x32_bf16 v[228:231], a[96:99], v[32:35], 0
    ds_read_b128 v[148:151], v170 offset:3072
    buffer_load_dwordx4 v155, s[32:35], s92 offen offset:0 lds
    v_mfma_f32_16x16x32_bf16 v[96:99], a[120:123], v[32:35], 0
    s_waitcnt vmcnt(10)
    ds_read_b64_tr_b16 a[80:81], v121 offset:24576
    v_cvt_pk_f16_f32 v92, v92, v93
    v_mfma_f32_16x16x32_bf16 v[32:35], a[72:75], v[72:75], 0
    s_waitcnt lgkmcnt(5)
    ds_read_b64_tr_b16 a[82:83], v121 offset:25344
    v_cvt_pk_f16_f32 v93, v94, v95
    v_mfma_f32_16x16x32_bf16 v[56:59], a[124:127], v[160:163], v[56:59]
    ds_read_b64_tr_b16 a[104:105], v121 offset:24608
    v_pk_fma_f16 v234, v92, v92, s3
    v_mfma_f32_16x16x32_bf16 v[88:91], a[76:79], v[44:47], v[88:91]
    ds_read_b64_tr_b16 a[106:107], v121 offset:25376
    v_pk_fmac_f16 v234, v93, v93
    v_mfma_f32_16x16x32_bf16 v[64:67], a[100:103], v[44:47], v[64:67]
    ds_read_b64_tr_b16 a[128:129], v121 offset:24640
    buffer_load_dwordx4 v139, s[32:35], s92 offen offset:1024 lds
    v_mfma_f32_16x16x32_bf16 v[36:39], a[124:127], v[44:47], v[36:39]
    ds_read_b64_tr_b16 a[130:131], v121 offset:25408
    v_cvt_pk_f16_f32 v94, v112, v113
    v_mfma_f32_16x16x32_bf16 v[48:51], a[76:79], v[84:87], v[48:51]
    ds_read_b128 v[44:47], v3 offset:41088
    v_cvt_pk_f16_f32 v95, v114, v115
    v_mfma_f32_16x16x32_bf16 v[108:111], a[100:103], v[84:87], v[108:111]
    ds_read_b128 v[28:31], v3 offset:42624
    v_pk_fmac_f16 v234, v94, v94
    v_mfma_f32_16x16x32_bf16 v[52:55], a[124:127], v[84:87], v[52:55]
    s_waitcnt lgkmcnt(8)
    ds_read_b128 v[84:87], v3 offset:128
    v_pk_fmac_f16 v234, v95, v95
    v_mfma_f32_16x16x32_bf16 v[40:43], a[76:79], v[12:15], v[40:43]
    ds_read_b32 v184, v184 offset:336
    buffer_load_dwordx4 v77, s[32:35], s92 offen offset:2048 lds
    v_mfma_f32_16x16x32_bf16 v[228:231], a[100:103], v[12:15], v[228:231]
    s_add_u32 m0, s90, 12288
    v_cvt_pk_f16_f32 v146, v80, v81
    v_cvt_pk_f16_f32 v147, v82, v83
    v_mfma_f32_16x16x32_bf16 v[96:99], a[124:127], v[12:15], v[96:99]
    s_mov_b32 s92, 37632
    ds_read_b128 v[112:115], v3 offset:1664
    v_pk_fmac_f16 v234, v146, v146
    v_mfma_f32_16x16x32_bf16 v[32:35], a[76:79], v[148:151], v[32:35]
    ds_read_b32 v185, v185 offset:336
    v_pk_fmac_f16 v234, v147, v147
    v_mfma_f32_16x16x32_bf16 v[12:15], a[96:99], v[72:75], 0
    v_cvt_pk_f16_f32 v80, v8, v9
    v_cvt_pk_f16_f32 v81, v10, v11
    v_mfma_f32_16x16x32_bf16 v[8:11], a[120:123], v[72:75], 0
    ds_read_b128 v[72:75], v3 offset:3200
    buffer_load_dwordx4 v155, s[32:35], s92 offen offset:0 lds
    v_mfma_f32_16x16x32_bf16 v[12:15], a[100:103], v[148:151], v[12:15]
    s_waitcnt vmcnt(10)
    ds_read_b64_tr_b16 a[84:85], v121 offset:36864
    v_pk_fma_f16 v76, v80, v80, s3
    v_mfma_f32_16x16x32_bf16 v[8:11], a[124:127], v[148:151], v[8:11]
    s_waitcnt lgkmcnt(6)
    ds_read_b64_tr_b16 a[86:87], v121 offset:37632
    v_pk_fmac_f16 v76, v81, v81
    v_mfma_f32_16x16x32_bf16 v[4:7], a[80:83], v[44:47], v[4:7]
    ds_read_b64_tr_b16 a[108:109], v121 offset:36896
    v_cvt_pk_f16_f32 v82, v68, v69
    v_mfma_f32_16x16x32_bf16 v[20:23], a[104:107], v[44:47], v[20:23]
    ds_read_b64_tr_b16 a[110:111], v121 offset:37664
    v_cvt_pk_f16_f32 v83, v70, v71
    v_mfma_f32_16x16x32_bf16 v[56:59], a[128:131], v[44:47], v[56:59]
    ds_read_b64_tr_b16 a[132:133], v121 offset:36928
    buffer_load_dwordx4 v139, s[32:35], s92 offen offset:1024 lds
    v_mfma_f32_16x16x32_bf16 v[88:91], a[80:83], v[28:31], v[88:91]
    ds_read_b64_tr_b16 a[134:135], v121 offset:37696
    v_pk_fmac_f16 v76, v82, v82
    v_mfma_f32_16x16x32_bf16 v[64:67], a[104:107], v[28:31], v[64:67]
    ds_read_b128 v[44:47], v170 offset:41088
    v_pk_fmac_f16 v76, v83, v83
    v_mfma_f32_16x16x32_bf16 v[36:39], a[128:131], v[28:31], v[36:39]
    s_waitcnt lgkmcnt(8)
    ds_read_b128 v[28:31], v170 offset:42624
    v_cvt_pk_f16_f32 v140, v116, v117
    v_mfma_f32_16x16x32_bf16 v[48:51], a[80:83], v[84:87], v[48:51]
    ds_read_b128 v[68:71], v170 offset:128
    v_cvt_pk_f16_f32 v141, v118, v119
    v_pk_fmac_f16 v76, v140, v140
    v_pk_fmac_f16 v76, v141, v141
    v_mfma_f32_16x16x32_bf16 v[108:111], a[104:107], v[84:87], v[108:111]
    buffer_load_dwordx4 v77, s[32:35], s92 offen offset:2048 lds
    ds_read_b32 v186, v186 offset:336
    v_mfma_f32_16x16x32_bf16 v[52:55], a[128:131], v[84:87], v[52:55]
    s_add_u32 m0, s90, 24576
    v_mfma_f32_16x16x32_bf16 v[40:43], a[80:83], v[112:115], v[40:43]
    s_mov_b32 s92, 74496
    ds_read_b128 v[84:87], v170 offset:1664
    v_mfma_f32_16x16x32_bf16 v[228:231], a[104:107], v[112:115], v[228:231]
    ds_read_b32 v187, v187 offset:336
    v_mfma_f32_16x16x32_bf16 v[96:99], a[128:131], v[112:115], v[96:99]
    s_waitcnt lgkmcnt(6)
    v_mfma_f32_16x16x32_bf16 v[32:35], a[80:83], v[72:75], v[32:35]
    s_waitcnt vmcnt(9)
    buffer_load_dwordx4 v155, s[32:35], s92 offen offset:0 lds
    ds_read_b64_tr_b16 a[88:89], v121 offset:49152
    v_mfma_f32_16x16x32_bf16 v[12:15], a[104:107], v[72:75], v[12:15]
    ds_read_b64_tr_b16 a[90:91], v121 offset:49920
    v_mfma_f32_16x16x32_bf16 v[8:11], a[128:131], v[72:75], v[8:11]
    s_waitcnt lgkmcnt(5)
    ds_read_b64_tr_b16 a[112:113], v121 offset:49184
    v_mfma_f32_16x16x32_bf16 v[4:7], a[84:87], v[44:47], v[4:7]
    ds_read_b64_tr_b16 a[114:115], v121 offset:49952
    v_mfma_f32_16x16x32_bf16 v[20:23], a[108:111], v[44:47], v[20:23]
    ds_read_b64_tr_b16 a[136:137], v121 offset:49216
    v_mfma_f32_16x16x32_bf16 v[56:59], a[132:135], v[44:47], v[56:59]
    buffer_load_dwordx4 v139, s[32:35], s92 offen offset:1024 lds
    ds_read_b64_tr_b16 a[138:139], v121 offset:49984
    v_mfma_f32_16x16x32_bf16 v[88:91], a[84:87], v[28:31], v[88:91]
    ds_read_b128 v[72:75], v170 offset:3200
    v_mfma_f32_16x16x32_bf16 v[64:67], a[108:111], v[28:31], v[64:67]
    ds_read_b32 v209, v62
    v_mfma_f32_16x16x32_bf16 v[36:39], a[132:135], v[28:31], v[36:39]
    v_mfma_f32_16x16x32_bf16 v[48:51], a[84:87], v[68:71], v[48:51]
    ds_read_b128 v[44:47], v3 offset:41216
    v_mfma_f32_16x16x32_bf16 v[108:111], a[108:111], v[68:71], v[108:111]
    buffer_load_dwordx4 v77, s[32:35], s92 offen offset:2048 lds
    ds_read_b128 v[28:31], v3 offset:42752
    v_mfma_f32_16x16x32_bf16 v[52:55], a[132:135], v[68:71], v[52:55]
    s_waitcnt lgkmcnt(7)
    s_add_u32 m0, s90, 36864
    ds_read_b128 v[68:71], v3 offset:256
    v_mfma_f32_16x16x32_bf16 v[40:43], a[84:87], v[84:87], v[40:43]
    s_mov_b32 s92, 111360
    ds_read_b128 v[112:115], v3 offset:1792
    v_mfma_f32_16x16x32_bf16 v[228:231], a[108:111], v[84:87], v[228:231]
    v_mfma_f32_16x16x32_bf16 v[96:99], a[132:135], v[84:87], v[96:99]
    s_waitcnt lgkmcnt(5)
    v_mfma_f32_16x16x32_bf16 v[32:35], a[84:87], v[72:75], v[32:35]
    s_waitcnt vmcnt(9)
    buffer_load_dwordx4 v155, s[32:35], s92 offen offset:0 lds
    ds_read_b64_tr_b16 a[92:93], v121 offset:61440
    v_mfma_f32_16x16x32_bf16 v[12:15], a[108:111], v[72:75], v[12:15]
    ds_read_b64_tr_b16 a[94:95], v121 offset:62208
    v_mov_b32 v78, 0
    v_mfma_f32_16x16x32_bf16 v[8:11], a[132:135], v[72:75], v[8:11]
    s_waitcnt lgkmcnt(5)
    ds_read_b64_tr_b16 a[116:117], v121 offset:61472
    v_mov_b32 v79, 0
    v_mfma_f32_16x16x32_bf16 v[4:7], a[88:91], v[44:47], v[4:7]
    s_mov_b32 s53, s47
    ds_read_b64_tr_b16 a[118:119], v121 offset:62240
    v_mfma_f32_16x16x32_bf16 v[20:23], a[112:115], v[44:47], v[20:23]
    s_mov_b32 s47, s46
    ds_read_b64_tr_b16 a[140:141], v121 offset:61504
    v_mfma_f32_16x16x32_bf16 v[56:59], a[136:139], v[44:47], v[56:59]
    s_waitcnt lgkmcnt(6)
    s_mov_b32 s46, s45
    buffer_load_dwordx4 v139, s[32:35], s92 offen offset:1024 lds
    ds_read_b64_tr_b16 a[142:143], v121 offset:62272
    v_mfma_f32_16x16x32_bf16 v[88:91], a[88:91], v[28:31], v[88:91]
    s_mov_b32 s45, s44
    ds_read_b128 v[84:87], v3 offset:3328
    v_mfma_f32_16x16x32_bf16 v[64:67], a[112:115], v[28:31], v[64:67]
    s_mov_b32 s44, s53
    ds_read_b128 v[44:47], v170 offset:41216
    v_mfma_f32_16x16x32_bf16 v[36:39], a[136:139], v[28:31], v[36:39]
    s_sub_u32 s48, s44, s46
    ds_read_b128 v[28:31], v170 offset:42752
    v_add_u32 v137, s48, v137
    v_mfma_f32_16x16x32_bf16 v[48:51], a[88:91], v[68:71], v[48:51]
    s_sub_u32 s49, s46, s45
    ds_read_b128 v[72:75], v170 offset:256
    v_add_u32 v136, s48, v136
    v_mfma_f32_16x16x32_bf16 v[108:111], a[112:115], v[68:71], v[108:111]
    s_sub_u32 s50, s45, s44
    buffer_load_dwordx4 v77, s[32:35], s92 offen offset:2048 lds
    v_add_u32 v135, s49, v135
    v_mfma_f32_16x16x32_bf16 v[52:55], a[136:139], v[68:71], v[52:55]
    s_waitcnt lgkmcnt(7)
    s_add_u32 m0, s90, 49152
    s_cmp_ge_u32 s2, 248
    s_cbranch_scc1 L_maskF
L_nomaskF:
    v_mfma_f32_16x16x32_bf16 v[40:43], a[88:91], v[112:115], v[40:43]
    s_mov_b32 s92, 148224
    ds_read_b128 v[68:71], v170 offset:1792
    v_readlane_b32 s84, v211, 48
    v_mfma_f32_16x16x32_bf16 v[228:231], a[112:115], v[112:115], v[228:231]
    s_sub_u32 s51, s46, s47
    v_cmp_gt_u32 vcc, 16, v156
    v_add_u32 v134, s49, v134
    v_mfma_f32_16x16x32_bf16 v[96:99], a[136:139], v[112:115], v[96:99]
    s_waitcnt lgkmcnt(4)
    s_mov_b32 s60, s59
    v_cndmask_b32 v208, v154, v208, vcc
    v_cndmask_b32 v209, v154, v209, vcc
    v_cndmask_b32 v210, v154, v210, vcc
    v_mfma_f32_16x16x32_bf16 v[32:35], a[88:91], v[84:87], v[32:35]
    s_waitcnt vmcnt(9)
    s_mov_b32 s59, s58
    buffer_load_dwordx4 v155, s[32:35], s92 offen offset:0 lds
    ds_read_b64_tr_b16 a[144:145], v138 offset:0
    v_mfma_f32_16x16x32_bf16 v[12:15], a[112:115], v[84:87], v[12:15]
    s_mov_b32 s58, s57
    v_cmp_gt_u32 vcc, 49, v156
    v_add_u32 v137, s50, v137
    v_mfma_f32_16x16x32_bf16 v[8:11], a[136:139], v[84:87], v[8:11]
    s_waitcnt lgkmcnt(2)
    s_mov_b32 s57, s56
    ds_read_b64_tr_b16 a[146:147], v138 offset:768
    v_cndmask_b32 v211, v154, v211, vcc
    v_mfma_f32_16x16x32_bf16 v[4:7], a[92:95], v[44:47], v[4:7]
    s_mov_b32 s7, s6
    ds_read_b64_tr_b16 a[168:169], v138 offset:8
    v_add_u32 v136, s50, v136
    v_mfma_f32_16x16x32_bf16 v[20:23], a[116:119], v[44:47], v[20:23]
    s_mov_b32 s6, s5
    ds_read_b64_tr_b16 a[170:171], v138 offset:776
    buffer_load_dwordx4 v139, s[32:35], s92 offen offset:1024 lds
    v_mfma_f32_16x16x32_bf16 v[56:59], a[140:143], v[44:47], v[56:59]
    s_mov_b32 s5, s4
    ds_read_b64_tr_b16 a[192:193], v121 offset:64
    v_cvt_pk_f16_f32 v164, v4, v5
    v_mfma_f32_16x16x32_bf16 v[88:91], a[92:95], v[28:31], v[88:91]
    s_sub_u32 s14, s6, s7
    ds_read_b64_tr_b16 a[194:195], v121 offset:832
    v_cvt_pk_f16_f32 v165, v6, v7
    v_mfma_f32_16x16x32_bf16 v[64:67], a[116:119], v[28:31], v[64:67]
    s_add_u32 s61, s61, 1
    ds_read_b128 v[4:7], v170 offset:3328
    v_pk_fma_f16 v241, v164, v164, s3
    v_mfma_f32_16x16x32_bf16 v[36:39], a[140:143], v[28:31], v[36:39]
    s_add_u32 s12, s12, 20
    ds_read_b128 v[84:87], v3 offset:40960
    v_cvt_pk_f16_f32 v88, v88, v89
    v_mfma_f32_16x16x32_bf16 v[48:51], a[92:95], v[72:75], v[48:51]
    s_max_u32 s12, s12, s61
    ds_read_b128 v[28:31], v3 offset:0
    buffer_load_dwordx4 v77, s[32:35], s92 offen offset:2048 lds
    v_mfma_f32_16x16x32_bf16 v[108:111], a[116:119], v[72:75], v[108:111]
L_pg0:
    s_cbranch_execz L_main
    s_add_u32 m0, s90, 61440
    ds_read_b128 v[44:47], v3 offset:1536
    v_cvt_pk_f16_f32 v89, v90, v91
    v_mfma_f32_16x16x32_bf16 v[52:55], a[140:143], v[72:75], v[52:55]
    s_waitcnt lgkmcnt(8)
    s_mov_b32 s92, 185088
    v_cvt_pk_f16_f32 v48, v48, v49
    v_cvt_pk_f16_f32 v49, v50, v51
    v_mfma_f32_16x16x32_bf16 v[40:43], a[92:95], v[68:71], v[40:43]
    s_add_u32 s65, s65, 1
    ds_read_b128 v[72:75], v3 offset:3072
    v_pk_fma_f16 v233, v48, v48, s3
    v_mfma_f32_16x16x32_bf16 v[228:231], a[116:119], v[68:71], v[228:231]
    s_add_u32 s67, s46, s54
    v_pk_fmac_f16 v233, v49, v49
    v_cvt_pk_f16_f32 v50, v108, v109
    v_mfma_f32_16x16x32_bf16 v[96:99], a[140:143], v[68:71], v[96:99]
    s_waitcnt lgkmcnt(4)
    v_cvt_pk_f16_f32 v51, v110, v111
    v_pk_fmac_f16 v233, v50, v50
    v_pk_fmac_f16 v233, v51, v51
    v_cvt_pk_f16_f32 v154, v52, v53
    buffer_load_dwordx4 v155, s[32:35], s92 offen offset:0 lds
    v_mfma_f32_16x16x32_bf16 v[32:35], a[92:95], v[4:7], v[32:35]
    s_waitcnt vmcnt(10)
    ds_read_b64_tr_b16 a[148:149], v138 offset:12288
    v_cvt_pk_f16_f32 v155, v54, v55
    v_mfma_f32_16x16x32_bf16 v[12:15], a[116:119], v[4:7], v[12:15]
    ds_read_b64_tr_b16 a[150:151], v138 offset:13056
    v_pk_fmac_f16 v233, v154, v154
    v_mfma_f32_16x16x32_bf16 v[8:11], a[140:143], v[4:7], v[8:11]
    s_waitcnt lgkmcnt(3)
    ds_read_b64_tr_b16 a[172:173], v138 offset:12296
    v_pk_fmac_f16 v233, v155, v155
    v_mfma_f32_16x16x32_bf16 v[68:71], a[144:147], v[84:87], 0
    buffer_load_dwordx4 v139, s[32:35], s92 offen offset:1024 lds
    ds_read_b64_tr_b16 a[174:175], v138 offset:13064
    v_mfma_f32_16x16x32_bf16 v[52:55], a[168:171], v[84:87], 0
    v_pk_fma_f16 v243, v88, v88, s3
    v_pk_fmac_f16 v243, v89, v89
    v_mfma_f32_16x16x32_bf16 v[4:7], a[192:195], v[84:87], 0
    ds_read_b64_tr_b16 a[196:197], v121 offset:12352
    v_cvt_pk_f16_f32 v90, v64, v65
    v_mfma_f32_16x16x32_bf16 v[116:119], v[28:31], a[144:147], 0
    ds_read_b64_tr_b16 a[198:199], v121 offset:13120
    v_cvt_pk_f16_f32 v91, v66, v67
    v_pk_fmac_f16 v243, v90, v90
    v_pk_fmac_f16 v243, v91, v91
    v_cvt_pk_f16_f32 v62, v36, v37
    v_cvt_pk_f16_f32 v63, v38, v39
    v_pk_fmac_f16 v243, v62, v62
    v_pk_fmac_f16 v243, v63, v63
    buffer_load_dwordx4 v77, s[32:35], s92 offen offset:2048 lds
    s_add_u32 m0, s54, 20480
    ds_read_b128 v[36:39], v170 offset:40960
    v_cvt_pk_f16_f32 v84, v32, v33
    v_cvt_pk_f16_f32 v85, v34, v35
    v_pk_fma_f16 v77, v84, v84, s3
    v_pk_fmac_f16 v77, v85, v85
    v_cvt_pk_f16_f32 v86, v12, v13
    v_cvt_pk_f16_f32 v87, v14, v15
    v_pk_fmac_f16 v77, v86, v86
    v_pk_fmac_f16 v77, v87, v87
    v_cvt_pk_f16_f32 v142, v8, v9
    v_cvt_pk_f16_f32 v143, v10, v11
    v_pk_fmac_f16 v77, v142, v142
    v_pk_fmac_f16 v77, v143, v143
    v_mfma_f32_16x16x32_bf16 v[8:11], v[28:31], a[168:171], 0
    ds_read_b128 v[32:35], v170 offset:0
    buffer_load_dwordx4 v128, s[24:27], s56 offen nt lds
    v_mfma_f32_16x16x32_bf16 v[12:15], v[28:31], a[192:195], 0
    s_waitcnt vmcnt(10)
    s_add_u32 m0, s54, 21504
    ds_read_b64_tr_b16 a[152:153], v138 offset:24576
    v_pk_fmac_f16 v241, v165, v165
    v_mfma_f32_16x16x32_bf16 v[28:31], v[44:47], a[144:147], 0
    ds_read_b64_tr_b16 a[154:155], v138 offset:25344
    v_cvt_pk_f16_f32 v166, v20, v21
    v_mfma_f32_16x16x32_bf16 v[236:239], v[44:47], a[168:171], 0
    ds_read_b64_tr_b16 a[176:177], v138 offset:24584
    v_cvt_pk_f16_f32 v167, v22, v23
    v_mfma_f32_16x16x32_bf16 v[108:111], v[44:47], a[192:195], 0
    s_waitcnt lgkmcnt(5)
    ds_read_b64_tr_b16 a[178:179], v138 offset:25352
    v_pk_fmac_f16 v241, v166, v166
    v_mfma_f32_16x16x32_bf16 v[20:23], v[72:75], a[144:147], 0
    ds_read_b64_tr_b16 a[200:201], v121 offset:24640
    buffer_load_dwordx4 v127, s[24:27], s56 offen nt lds
    v_mfma_f32_16x16x32_bf16 v[64:67], v[72:75], a[168:171], 0
    s_add_u32 m0, s54, 22528
    ds_read_b64_tr_b16 a[202:203], v121 offset:25408
    v_pk_fmac_f16 v241, v167, v167
    v_mfma_f32_16x16x32_bf16 v[44:47], v[72:75], a[192:195], 0
    s_waitcnt lgkmcnt(7)
    ds_read_b128 v[160:163], v170 offset:1536
    v_cvt_pk_f16_f32 v150, v56, v57
    v_mfma_f32_16x16x32_bf16 v[68:71], a[148:151], v[36:39], v[68:71]
    ds_read_b128 v[72:75], v170 offset:3072
    v_cvt_pk_f16_f32 v151, v58, v59
    v_mfma_f32_16x16x32_bf16 v[52:55], a[172:175], v[36:39], v[52:55]
    ds_read_b128 v[56:59], v3 offset:41088
    v_pk_fmac_f16 v241, v150, v150
    v_mfma_f32_16x16x32_bf16 v[4:7], a[196:199], v[36:39], v[4:7]
    s_waitcnt lgkmcnt(8)
    ds_read_b128 v[36:39], v3 offset:128
    buffer_load_dwordx4 v126, s[24:27], s56 offen nt lds
    v_mfma_f32_16x16x32_bf16 v[116:119], v[32:35], a[148:151], v[116:119]
    s_add_u32 m0, s54, 23552
    ds_read_b128 v[112:115], v3 offset:1664
    v_pk_fmac_f16 v241, v151, v151
    v_mfma_f32_16x16x32_bf16 v[8:11], v[32:35], a[172:175], v[8:11]
    v_cvt_pk_f16_f32 v40, v40, v41
    v_cvt_pk_f16_f32 v41, v42, v43
    v_mfma_f32_16x16x32_bf16 v[12:15], v[32:35], a[196:199], v[12:15]
    v_pk_fma_f16 v235, v40, v40, s3
    v_pk_fmac_f16 v235, v41, v41
    v_mfma_f32_16x16x32_f16 v[32:35], v[212:215], v[76:79], 0
    ds_read_b128 v[76:79], v3 offset:3200
    v_cvt_pk_f16_f32 v42, v228, v229
    v_mfma_f32_16x16x32_f16 v[224:227], v[212:215], v[240:243], 0
    s_waitcnt lgkmcnt(5)
    v_cvt_pk_f16_f32 v43, v230, v231
    v_pk_fmac_f16 v235, v42, v42
    v_pk_fmac_f16 v235, v43, v43
    v_mfma_f32_16x16x32_bf16 v[28:31], v[160:163], a[148:151], v[28:31]
    s_waitcnt vmcnt(9)
    buffer_load_dwordx4 v125, s[24:27], s56 offen nt lds
    ds_read_b64_tr_b16 a[156:157], v138 offset:36864
    v_mfma_f32_16x16x32_bf16 v[236:239], v[160:163], a[172:175], v[236:239]
    s_add_u32 m0, s54, 24576
    v_or3_b32 v123, v123, v224, v225
    v_or3_b32 v123, v123, v226, v227
    v_mfma_f32_16x16x32_bf16 v[108:111], v[160:163], a[196:199], v[108:111]
    s_waitcnt lgkmcnt(3)
    ds_read_b64_tr_b16 a[158:159], v138 offset:37632
    v_cvt_pk_f16_f32 v148, v96, v97
    v_mfma_f32_16x16x32_bf16 v[20:23], v[72:75], a[148:151], v[20:23]
    ds_read_b64_tr_b16 a[180:181], v138 offset:36872
    v_cvt_pk_f16_f32 v149, v98, v99
    v_mfma_f32_16x16x32_bf16 v[64:67], v[72:75], a[172:175], v[64:67]
    buffer_load_dwordx4 v124, s[24:27], s56 offen nt lds
    ds_read_b64_tr_b16 a[182:183], v138 offset:37640
    v_mfma_f32_16x16x32_bf16 v[44:47], v[72:75], a[196:199], v[44:47]
    s_cmp_lt_u32 s61, s71
    v_rsq_f32 v224, v224
    v_mfma_f32_16x16x32_bf16 v[68:71], a[152:155], v[56:59], v[68:71]
    s_cselect_b32 s15, s61, s12
    ds_read_b64_tr_b16 a[204:205], v121 offset:36928
    v_mul_f32 v224, s52, v224
    v_mfma_f32_16x16x32_bf16 v[52:55], a[176:179], v[56:59], v[52:55]
    s_cselect_b32 s56, s69, s70
    ds_read_b64_tr_b16 a[206:207], v121 offset:37696
    v_pk_fmac_f16 v235, v148, v148
    v_mfma_f32_16x16x32_bf16 v[4:7], a[200:203], v[56:59], v[4:7]
    s_add_u32 s56, s56, s15
    ds_read_b128 v[72:75], v170 offset:41088
    v_pk_fmac_f16 v235, v149, v149
    v_mfma_f32_16x16x32_bf16 v[116:119], v[36:39], a[152:155], v[116:119]
    s_mul_i32 s53, s56, 58255
    buffer_load_dword v96, v126, s[28:31], s72 offen nt
    ds_read_b128 v[56:59], v170 offset:128
    v_mfma_f32_16x16x32_bf16 v[8:11], v[36:39], a[176:179], v[8:11]
    s_lshr_b32 s53, s53, 22
    v_rsq_f32 v225, v225
    v_mfma_f32_16x16x32_bf16 v[12:15], v[36:39], a[200:203], v[12:15]
    s_waitcnt lgkmcnt(6)
    s_mul_i32 s53, s53, s63
    ds_read_b128 v[228:231], v170 offset:1664
    v_cvt_pk_f16_f32 v224, v224, v225
    v_mfma_f32_16x16x32_bf16 v[28:31], v[112:115], a[152:155], v[28:31]
    s_mul_i32 s56, s56, s62
    ds_read_b128 v[36:39], v170 offset:3200
    v_pk_mul_f16 v100, v100, v224 op_sel:[0,0] op_sel_hi:[1,0]
    v_mfma_f32_16x16x32_bf16 v[236:239], v[112:115], a[176:179], v[236:239]
    s_add_u32 s56, s56, s53
    v_rsq_f32 v226, v226
    v_mfma_f32_16x16x32_bf16 v[108:111], v[112:115], a[200:203], v[108:111]
    s_waitcnt vmcnt(9)
    s_mul_i32 s4, s15, 112
    ds_read_b64_tr_b16 a[160:161], v138 offset:49152
    v_mul_f32 v226, s52, v226
    v_mfma_f32_16x16x32_bf16 v[20:23], v[76:79], a[152:155], v[20:23]
    s_cmp_ge_u32 s15, 16
    ds_read_b64_tr_b16 a[162:163], v138 offset:49920
    v_pk_mul_f16 v101, v101, v224 op_sel:[0,0] op_sel_hi:[1,0]
    v_mfma_f32_16x16x32_bf16 v[64:67], v[76:79], a[176:179], v[64:67]
    s_cselect_b32 s53, -30464, 0
    ds_read_b64_tr_b16 a[184:185], v138 offset:49160
    v_pk_mul_f16 v102, v102, v224 op_sel:[0,0] op_sel_hi:[1,0]
    v_mfma_f32_16x16x32_bf16 v[44:47], v[76:79], a[200:203], v[44:47]
    s_waitcnt lgkmcnt(6)
    s_add_u32 s4, s4, s53
    ds_read_b64_tr_b16 a[186:187], v138 offset:49928
    v_pk_mul_f16 v103, v103, v224 op_sel:[0,0] op_sel_hi:[1,0]
    v_mfma_f32_16x16x32_bf16 v[68:71], a[156:159], v[72:75], v[68:71]
    s_cmp_lt_u32 s15, s73
    ds_read_b64_tr_b16 a[208:209], v121 offset:49216
    v_pk_mul_f16 v144, v144, v224 op_sel:[0,0] op_sel_hi:[1,0]
    v_mfma_f32_16x16x32_bf16 v[52:55], a[180:183], v[72:75], v[52:55]
    s_cselect_b32 s26, 100270464, 0
    ds_read_b64_tr_b16 a[210:211], v121 offset:49984
    v_pk_mul_f16 v145, v145, v224 op_sel:[0,0] op_sel_hi:[1,0]
    v_mfma_f32_16x16x32_bf16 v[4:7], a[204:207], v[72:75], v[4:7]
    s_waitcnt lgkmcnt(7)
    s_cselect_b32 s56, s56, 0
    ds_read_b128 v[160:163], v170 offset:41216
    v_pk_mul_f16 v164, v164, v224 op_sel:[0,1] op_sel_hi:[1,1]
    v_mfma_f32_16x16x32_bf16 v[116:119], v[56:59], a[156:159], v[116:119]
    s_cselect_b32 s4, s4, -1
    ds_read_b128 v[112:115], v170 offset:256
    v_pk_mul_f16 v165, v165, v224 op_sel:[0,1] op_sel_hi:[1,1]
    v_mfma_f32_16x16x32_bf16 v[8:11], v[56:59], a[180:183], v[8:11]
    s_cselect_b32 s15, s15, 0
    ds_read_b128 v[72:75], v170 offset:1792
    v_pk_mul_f16 v166, v166, v224 op_sel:[0,1] op_sel_hi:[1,1]
    v_mfma_f32_16x16x32_bf16 v[12:15], v[56:59], a[204:207], v[12:15]
    s_cselect_b32 s13, s13, -1
    ds_read_b128 v[56:59], v170 offset:3328
    v_pk_mul_f16 v167, v167, v224 op_sel:[0,1] op_sel_hi:[1,1]
    v_mfma_f32_16x16x32_bf16 v[28:31], v[228:231], a[156:159], v[28:31]
    s_bitset1_b32 s64, s15
    ds_read_b128 v[76:79], v3 offset:41216
    v_pk_mul_f16 v150, v150, v224 op_sel:[0,1] op_sel_hi:[1,1]
    v_mfma_f32_16x16x32_bf16 v[236:239], v[228:231], a[180:183], v[236:239]
    s_cmp_ge_i32 s65, 2
    v_rsq_f32 v227, v227
    v_mfma_f32_16x16x32_bf16 v[108:111], v[228:231], a[204:207], v[108:111]
    s_waitcnt lgkmcnt(7)
    s_cselect_b32 s30, 100270464, 0
    v_cvt_pk_f16_f32 v226, v226, v227
    v_pk_mul_f16 v151, v151, v224 op_sel:[0,1] op_sel_hi:[1,1]
    v_mfma_f32_16x16x32_bf16 v[20:23], v[36:39], a[156:159], v[20:23]
    s_mul_i32 s93, s68, 18432
    v_fma_mix_f32 v34, v100, v164, 0 op_sel:[0,0,0] op_sel_hi:[1,1,0]
    v_fma_mix_f32 v34, v100, v164, v34 op_sel:[1,1,0] op_sel_hi:[1,1,0]
    v_mfma_f32_16x16x32_bf16 v[64:67], v[36:39], a[180:183], v[64:67]
    s_movk_i32 s92, 0
    ds_read_b128 v[228:231], v3 offset:256
    v_fma_mix_f32 v34, v101, v165, v34 op_sel:[0,0,0] op_sel_hi:[1,1,0]
    v_mfma_f32_16x16x32_bf16 v[44:47], v[36:39], a[204:207], v[44:47]
    s_waitcnt vmcnt(6)
    s_add_u32 m0, s67, 0
    ds_read_b64_tr_b16 a[164:165], v138 offset:61440
    v_fma_mix_f32 v34, v101, v165, v34 op_sel:[1,1,0] op_sel_hi:[1,1,0]
    v_mfma_f32_16x16x32_f16 v[36:39], v[212:215], v[232:235], 0
    s_waitcnt lgkmcnt(2)
    ds_read_b64_tr_b16 a[166:167], v138 offset:62208
    v_fma_mix_f32 v34, v102, v166, v34 op_sel:[0,0,0] op_sel_hi:[1,1,0]
    v_fma_mix_f32 v34, v102, v166, v34 op_sel:[1,1,0] op_sel_hi:[1,1,0]
    v_fma_mix_f32 v34, v103, v167, v34 op_sel:[0,0,0] op_sel_hi:[1,1,0]
    ds_read_b64_tr_b16 a[188:189], v138 offset:61448
    v_fma_mix_f32 v34, v103, v167, v34 op_sel:[1,1,0] op_sel_hi:[1,1,0]
    v_fma_mix_f32 v34, v144, v150, v34 op_sel:[0,0,0] op_sel_hi:[1,1,0]
    v_fma_mix_f32 v34, v144, v150, v34 op_sel:[1,1,0] op_sel_hi:[1,1,0]
    v_mfma_f32_16x16x32_bf16 v[68:71], a[160:163], v[76:79], v[68:71]
    ds_read_b64_tr_b16 a[190:191], v138 offset:62216
    v_fma_mix_f32 v34, v145, v151, v34 op_sel:[0,0,0] op_sel_hi:[1,1,0]
    v_mfma_f32_16x16x32_bf16 v[52:55], a[184:187], v[76:79], v[52:55]
    ds_read_b64_tr_b16 a[212:213], v121 offset:61504
    v_fma_mix_f32 v34, v145, v151, v34 op_sel:[1,1,0] op_sel_hi:[1,1,0]
    v_mfma_f32_16x16x32_bf16 v[4:7], a[208:211], v[76:79], v[4:7]
    s_waitcnt lgkmcnt(5)
    ds_read_b64_tr_b16 a[214:215], v121 offset:62272
    v_mov_b32 v121, v34
    v_mov_b32 v138, 0
    v_mov_b32 v139, 0
    v_permlane32_swap_b32 v121, v34
    v_mfma_f32_16x16x32_bf16 v[116:119], v[228:231], a[160:163], v[116:119]
    ds_read_b128 v[76:79], v3 offset:1792
    v_add_f32 v34, v121, v34
    v_mfma_f32_16x16x32_bf16 v[8:11], v[228:231], a[184:187], v[8:11]
    s_waitcnt lgkmcnt(5)
    v_mov_b32 v121, v34
    v_mov_b32 v35, 0
    v_mfma_f32_16x16x32_bf16 v[68:71], a[164:167], v[160:163], v[68:71]
    v_permlane16_swap_b32 v121, v34
    v_mfma_f32_16x16x32_bf16 v[116:119], v[112:115], a[164:167], v[116:119]
    v_add_f32 v34, v121, v34
    v_add_f32 v34, s84, v34
    v_mfma_f32_16x16x32_bf16 v[12:15], v[228:231], a[208:211], v[12:15]
    s_waitcnt lgkmcnt(3)
    v_exp_f32 v34, v34
    v_add_u32 v121, 28672, v120
    v_mfma_f32_16x16x32_bf16 v[52:55], a[188:191], v[160:163], v[52:55]
    ds_write_b128 v121, v[164:167]
    v_mfma_f32_16x16x32_bf16 v[8:11], v[112:115], a[188:191], v[8:11]
    s_waitcnt lgkmcnt(2)
    v_cvt_pk_bf16_f32 v34, v34, 0
    v_cmp_gt_u32 vcc, 16, v156
    v_mfma_f32_16x16x32_bf16 v[4:7], a[212:215], v[160:163], v[4:7]
    s_nop 0
    v_cndmask_b32 v34, 0, v34, vcc
    v_or3_b32 v123, v123, v36, v37
    v_mfma_f32_16x16x32_bf16 v[12:15], v[112:115], a[212:215], v[12:15]
    s_waitcnt lgkmcnt(1)
    ds_write2_b64 v121, v[138:139], v[138:139] offset0:2 offset1:3
    v_mfma_f32_16x16x32_bf16 v[28:31], v[76:79], a[160:163], v[28:31]
    v_rsq_f32 v36, v36
    v_mfma_f32_16x16x32_bf16 v[28:31], v[72:75], a[164:167], v[28:31]
    v_rsq_f32 v37, v37
    v_mfma_f32_16x16x32_bf16 v[236:239], v[76:79], a[184:187], v[236:239]
    ds_write_b128 v121, v[100:103] offset:32
    v_mfma_f32_16x16x32_bf16 v[236:239], v[72:75], a[188:191], v[236:239]
    v_mul_f32 v36, s52, v36
    v_cvt_pk_f16_f32 v36, v36, v37
    v_mfma_f32_16x16x32_bf16 v[108:111], v[76:79], a[208:211], v[108:111]
    v_or3_b32 v123, v123, v38, v39
    v_pk_mul_f16 v48, v48, v36 op_sel:[0,1] op_sel_hi:[1,1]
    v_mfma_f32_16x16x32_bf16 v[108:111], v[72:75], a[212:215], v[108:111]
    ds_write2_b64 v121, v[150:151], v[138:139] offset0:6 offset1:7
    v_rsq_f32 v38, v38
    v_rsq_f32 v39, v39
    v_mul_f32 v38, s52, v38
    v_cvt_pk_f16_f32 v38, v38, v39
    v_pk_mul_f16 v49, v49, v36 op_sel:[0,1] op_sel_hi:[1,1]
    v_pk_mul_f16 v50, v50, v36 op_sel:[0,1] op_sel_hi:[1,1]
    ds_write2_b64 v121, v[138:139], v[144:145] offset0:8 offset1:9
    v_pk_mul_f16 v51, v51, v36 op_sel:[0,1] op_sel_hi:[1,1]
    v_pk_mul_f16 v154, v154, v36 op_sel:[0,1] op_sel_hi:[1,1]
    v_pk_mul_f16 v155, v155, v36 op_sel:[0,1] op_sel_hi:[1,1]
    v_pk_mul_f16 v24, v24, v36 op_sel:[0,0] op_sel_hi:[1,0]
    v_pk_mul_f16 v25, v25, v36 op_sel:[0,0] op_sel_hi:[1,0]
    v_pk_mul_f16 v26, v26, v36 op_sel:[0,0] op_sel_hi:[1,0]
    v_pk_mul_f16 v27, v27, v36 op_sel:[0,0] op_sel_hi:[1,0]
    v_pk_mul_f16 v152, v152, v36 op_sel:[0,0] op_sel_hi:[1,0]
    ds_write_b64 v121, v[34:35] offset:88
    v_pk_mul_f16 v153, v153, v36 op_sel:[0,0] op_sel_hi:[1,0]
    v_pk_mul_f16 v40, v40, v38 op_sel:[0,1] op_sel_hi:[1,1]
    v_pk_mul_f16 v41, v41, v38 op_sel:[0,1] op_sel_hi:[1,1]
    v_pk_mul_f16 v42, v42, v38 op_sel:[0,1] op_sel_hi:[1,1]
    v_pk_mul_f16 v43, v43, v38 op_sel:[0,1] op_sel_hi:[1,1]
    v_pk_mul_f16 v148, v148, v38 op_sel:[0,1] op_sel_hi:[1,1]
    v_pk_mul_f16 v149, v149, v38 op_sel:[0,1] op_sel_hi:[1,1]
    v_pk_mul_f16 v92, v92, v38 op_sel:[0,0] op_sel_hi:[1,0]
    v_pk_mul_f16 v93, v93, v38 op_sel:[0,0] op_sel_hi:[1,0]
    v_pk_mul_f16 v94, v94, v38 op_sel:[0,0] op_sel_hi:[1,0]
    v_pk_mul_f16 v95, v95, v38 op_sel:[0,0] op_sel_hi:[1,0]
    v_pk_mul_f16 v146, v146, v38 op_sel:[0,0] op_sel_hi:[1,0]
    v_pk_mul_f16 v147, v147, v38 op_sel:[0,0] op_sel_hi:[1,0]
    v_or3_b32 v123, v123, v32, v33
    v_rsq_f32 v32, v32
    v_rsq_f32 v33, v33
    v_mul_f32 v32, s52, v32
    v_cvt_pk_f16_f32 v32, v32, v33
    v_pk_mul_f16 v84, v84, v32 op_sel:[0,1] op_sel_hi:[1,1]
    v_pk_mul_f16 v85, v85, v32 op_sel:[0,1] op_sel_hi:[1,1]
    v_pk_mul_f16 v86, v86, v32 op_sel:[0,1] op_sel_hi:[1,1]
    v_pk_mul_f16 v87, v87, v32 op_sel:[0,1] op_sel_hi:[1,1]
    v_pk_mul_f16 v142, v142, v32 op_sel:[0,1] op_sel_hi:[1,1]
    v_pk_mul_f16 v143, v143, v32 op_sel:[0,1] op_sel_hi:[1,1]
    v_pk_mul_f16 v80, v80, v32 op_sel:[0,0] op_sel_hi:[1,0]
    v_pk_mul_f16 v81, v81, v32 op_sel:[0,0] op_sel_hi:[1,0]
    v_pk_mul_f16 v82, v82, v32 op_sel:[0,0] op_sel_hi:[1,0]
    v_pk_mul_f16 v83, v83, v32 op_sel:[0,0] op_sel_hi:[1,0]
    v_pk_mul_f16 v140, v140, v32 op_sel:[0,0] op_sel_hi:[1,0]
    v_pk_mul_f16 v141, v141, v32 op_sel:[0,0] op_sel_hi:[1,0]
    v_mov_b32 v171, 0
    v_mov_b32 v167, 0
    v_mov_b32 v163, 0
    v_mov_b32 v159, 0
    v_mov_b32 v150, 0
    v_mov_b32 v151, 0
    v_mfma_f32_16x16x32_f16 v[32:35], v[48:51], v[24:27], v[204:207]
    s_mov_b32 s53, s47
    ds_read_b128 v[72:75], v3 offset:3328
    v_mov_b32 v144, 0
    v_mfma_f32_16x16x32_f16 v[32:35], v[152:155], v[150:153], v[32:35]
    s_mov_b32 s47, s46
    v_mov_b32 v145, 0
    v_mov_b32 v138, 0
    v_mfma_f32_16x16x32_f16 v[112:115], v[40:43], v[24:27], v[200:203]
    s_mov_b32 s46, s45
    v_mov_b32 v139, 0
    v_add_u32 v135, s48, v135
    v_mfma_f32_16x16x32_f16 v[112:115], v[146:149], v[150:153], v[112:115]
    s_mov_b32 s45, s44
    v_add_u32 v134, s48, v134
    v_add_u32 v133, s51, v133
    v_mfma_f32_16x16x32_f16 v[36:39], v[84:87], v[24:27], v[196:199]
    s_mov_b32 s44, s53
    v_add_u32 v132, s14, v132
    v_add_u32 v131, s14, v131
    v_mfma_f32_16x16x32_f16 v[36:39], v[140:143], v[150:153], v[36:39]
    s_sub_u32 s48, s44, s46
    ds_read_b128 v[240:243], v132 offset:0
    v_cvt_pk_bf16_f32 v0, v116, v117
    v_exp_f32 v32, v32
    v_exp_f32 v33, v33
    v_exp_f32 v34, v34
    v_exp_f32 v35, v35
    v_cvt_pk_bf16_f32 v32, v32, v33
    v_cvt_pk_bf16_f32 v33, v34, v35
    v_exp_f32 v112, v112
    v_exp_f32 v113, v113
    s_waitcnt lgkmcnt(1)
    v_mfma_f32_16x16x32_bf16 v[20:23], v[72:75], a[160:163], v[20:23]
    s_sub_u32 s49, s46, s45
    ds_read_b128 v[100:103], v132 offset:16
    v_cvt_pk_bf16_f32 v34, v112, v113
    v_mfma_f32_16x16x32_bf16 v[20:23], v[56:59], a[164:167], v[20:23]
    ds_read_b128 v[76:79], v132 offset:48
    v_cvt_pk_bf16_f32 v1, v118, v119
    v_mfma_f32_16x16x32_bf16 v[64:67], v[72:75], a[184:187], v[64:67]
    v_exp_f32 v114, v114
    v_mfma_f32_16x16x32_bf16 v[64:67], v[56:59], a[188:191], v[64:67]
    v_exp_f32 v115, v115
    v_mfma_f32_16x16x32_bf16 v[44:47], v[72:75], a[208:211], v[44:47]
    v_cvt_pk_bf16_f32 v35, v114, v115
    v_cvt_pk_bf16_f32 v8, v8, v9
    v_mfma_f32_16x16x32_bf16 v[44:47], v[56:59], a[212:215], v[44:47]
    s_waitcnt lgkmcnt(2)
    global_load_dword v121, v122, s[38:39] offset:248 sc1
    v_cvt_pk_bf16_f32 v9, v10, v11
    v_mfma_f32_16x16x32_f16 v[56:59], v[240:243], v[24:27], v[208:211]
    s_waitcnt lgkmcnt(1)
    ds_read_b128 v[232:235], v3 offset:42496
    v_cvt_pk_bf16_f32 v24, v12, v13
    v_exp_f32 v36, v36
    v_exp_f32 v37, v37
    v_exp_f32 v38, v38
    v_exp_f32 v39, v39
    v_cvt_pk_bf16_f32 v168, v36, v37
    v_mfma_f32_16x16x32_f16 v[56:59], v[100:103], v[48:51], v[56:59]
    s_waitcnt lgkmcnt(1)
    ds_read_b128 v[228:231], v170 offset:42496
    v_cvt_pk_bf16_f32 v169, v38, v39
    v_mfma_f32_16x16x32_f16 v[56:59], v[76:79], v[152:155], v[56:59]
    ds_read_b128 v[116:119], v3 offset:42624
    v_cvt_pk_bf16_f32 v25, v14, v15
    v_mfma_f32_16x16x32_f16 v[12:15], v[240:243], v[92:95], v[208:211]
    ds_read_b128 v[112:115], v170 offset:42624
    v_cvt_pk_bf16_f32 v2, v28, v29
    v_mfma_f32_16x16x32_f16 v[12:15], v[100:103], v[40:43], v[12:15]
    ds_read_b128 v[72:75], v3 offset:42752
    v_cvt_pk_bf16_f32 v3, v30, v31
    v_mfma_f32_16x16x32_f16 v[12:15], v[76:79], v[146:149], v[12:15]
    ds_read_b128 v[28:31], v170 offset:42752
    v_cvt_pk_bf16_f32 v10, v236, v237
    v_mfma_f32_16x16x32_f16 v[36:39], v[240:243], v[80:83], v[208:211]
    v_cvt_pk_bf16_f32 v11, v238, v239
    v_cvt_pk_bf16_f32 v26, v108, v109
    v_mfma_f32_16x16x32_f16 v[36:39], v[100:103], v[84:87], v[36:39]
    v_cvt_pk_bf16_f32 v27, v110, v111
    v_cvt_pk_bf16_f32 v98, v68, v69
    v_mfma_f32_16x16x32_f16 v[36:39], v[76:79], v[140:143], v[36:39]
    v_exp_f32 v56, v56
    v_mfma_f32_16x16x32_f16 v[76:79], v[48:51], v[92:95], v[192:195]
    v_cvt_pk_bf16_f32 v170, v56, 0
    v_cvt_pk_bf16_f32 v99, v70, v71
    v_mfma_f32_16x16x32_f16 v[76:79], v[152:155], v[144:147], v[76:79]
    ds_write_b64 v120, v[98:99] offset:28752
    v_mfma_f32_16x16x32_f16 v[68:71], v[40:43], v[92:95], v[188:191]
    v_cvt_pk_bf16_f32 v52, v52, v53
    v_cvt_pk_bf16_f32 v53, v54, v55
    v_mfma_f32_16x16x32_f16 v[68:71], v[146:149], v[144:147], v[68:71]
    v_cvt_pk_bf16_f32 v54, v4, v5
    v_cvt_pk_bf16_f32 v55, v6, v7
    v_mfma_f32_16x16x32_f16 v[4:7], v[84:87], v[92:95], v[184:187]
    s_waitcnt lgkmcnt(1)
    ds_write_b128 v120, v[52:55] offset:28768
    v_mfma_f32_16x16x32_f16 v[4:7], v[140:143], v[144:147], v[4:7]
    s_barrier
    buffer_load_dwordx4 v128, s[24:27], s56 offen nt lds
    v_mov_b32_dpp v59, v15 quad_perm:[0,1,2,3] row_mask:0x2 bank_mask:0xf
    v_mfma_f32_16x16x32_bf16 v[108:111], a[144:147], v[232:235], 0
    s_add_u32 m0, s67, 1024
    v_mov_b32_dpp v59, v39 quad_perm:[0,1,2,3] row_mask:0x4 bank_mask:0xf
    v_pk_mul_f16 v16, v16, v226 op_sel:[0,0] op_sel_hi:[1,0]
    v_mfma_f32_16x16x32_bf16 v[108:111], a[148:151], v[228:231], v[108:111]
    ds_read_u16 v166, v131 offset:80
    buffer_load_dwordx4 v127, s[24:27], s56 offen nt lds
    v_mfma_f32_16x16x32_bf16 v[108:111], a[152:155], v[116:119], v[108:111]
    s_add_u32 m0, s67, 2048
    ds_read_u16 v162, v131 offset:96
    v_pk_mul_f16 v17, v17, v226 op_sel:[0,0] op_sel_hi:[1,0]
    v_mfma_f32_16x16x32_bf16 v[108:111], a[156:159], v[112:115], v[108:111]
    ds_read_u16 v158, v131 offset:104
    buffer_load_dwordx4 v126, s[24:27], s56 offen nt lds
    v_mfma_f32_16x16x32_bf16 v[108:111], a[160:163], v[72:75], v[108:111]
    s_add_u32 m0, s67, 3072
    v_exp_f32 v59, v59
    v_mfma_f32_16x16x32_bf16 v[108:111], a[164:167], v[28:31], v[108:111]
    v_cvt_pk_bf16_f32 v59, v59, v59
    v_pk_mul_f16 v18, v18, v226 op_sel:[0,0] op_sel_hi:[1,0]
    v_mfma_f32_16x16x32_bf16 v[52:55], a[168:171], v[232:235], 0
    ds_write_b16 v131, v59 offset:64
    v_mfma_f32_16x16x32_bf16 v[52:55], a[172:175], v[228:231], v[52:55]
    ds_read_b128 v[100:103], v132 offset:48
    buffer_load_dwordx4 v125, s[24:27], s56 offen nt lds
    v_mfma_f32_16x16x32_bf16 v[52:55], a[176:179], v[116:119], v[52:55]
    s_add_u32 m0, s67, 4096
    ds_read_b128 v[92:95], v132 offset:64
    v_pk_mul_f16 v19, v19, v226 op_sel:[0,0] op_sel_hi:[1,0]
    v_mfma_f32_16x16x32_bf16 v[52:55], a[180:183], v[112:115], v[52:55]
    v_pk_mul_f16 v60, v60, v226 op_sel:[0,0] op_sel_hi:[1,0]
    v_pk_mul_f16 v61, v61, v226 op_sel:[0,0] op_sel_hi:[1,0]
    v_mfma_f32_16x16x32_bf16 v[52:55], a[184:187], v[72:75], v[52:55]
    buffer_load_dwordx4 v124, s[24:27], s56 offen nt lds
    v_pk_mul_f16 v88, v88, v226 op_sel:[0,1] op_sel_hi:[1,1]
    v_mfma_f32_16x16x32_bf16 v[52:55], a[188:191], v[28:31], v[52:55]
    v_pk_mul_f16 v89, v89, v226 op_sel:[0,1] op_sel_hi:[1,1]
    v_pk_mul_f16 v90, v90, v226 op_sel:[0,1] op_sel_hi:[1,1]
    v_mfma_f32_16x16x32_bf16 v[56:59], a[192:195], v[232:235], 0
    v_pk_mul_f16 v91, v91, v226 op_sel:[0,1] op_sel_hi:[1,1]
    v_pk_mul_f16 v62, v62, v226 op_sel:[0,1] op_sel_hi:[1,1]
    v_mfma_f32_16x16x32_bf16 v[56:59], a[196:199], v[228:231], v[56:59]
    v_pk_mul_f16 v63, v63, v226 op_sel:[0,1] op_sel_hi:[1,1]
    v_fma_mix_f32 v36, v16, v88, 0 op_sel:[0,0,0] op_sel_hi:[1,1,0]
    v_mfma_f32_16x16x32_bf16 v[56:59], a[200:203], v[116:119], v[56:59]
    v_fma_mix_f32 v36, v16, v88, v36 op_sel:[1,1,0] op_sel_hi:[1,1,0]
    v_fma_mix_f32 v36, v17, v89, v36 op_sel:[0,0,0] op_sel_hi:[1,1,0]
    v_mfma_f32_16x16x32_bf16 v[56:59], a[204:207], v[112:115], v[56:59]
    v_fma_mix_f32 v36, v17, v89, v36 op_sel:[1,1,0] op_sel_hi:[1,1,0]
    v_fma_mix_f32 v36, v18, v90, v36 op_sel:[0,0,0] op_sel_hi:[1,1,0]
    v_mfma_f32_16x16x32_bf16 v[56:59], a[208:211], v[72:75], v[56:59]
    v_fma_mix_f32 v36, v18, v90, v36 op_sel:[1,1,0] op_sel_hi:[1,1,0]
    v_fma_mix_f32 v36, v19, v91, v36 op_sel:[0,0,0] op_sel_hi:[1,1,0]
    v_mfma_f32_16x16x32_bf16 v[56:59], a[212:215], v[28:31], v[56:59]
    v_fma_mix_f32 v36, v19, v91, v36 op_sel:[1,1,0] op_sel_hi:[1,1,0]
    v_fma_mix_f32 v36, v60, v62, v36 op_sel:[0,0,0] op_sel_hi:[1,1,0]
    v_mfma_f32_16x16x32_bf16 v[72:75], v[220:223], v[32:35], 0
    v_fma_mix_f32 v36, v60, v62, v36 op_sel:[1,1,0] op_sel_hi:[1,1,0]
    v_fma_mix_f32 v36, v61, v63, v36 op_sel:[0,0,0] op_sel_hi:[1,1,0]
    v_mfma_f32_16x16x32_bf16 v[72:75], v[220:223], v[168:171], v[72:75]
    v_fma_mix_f32 v36, v61, v63, v36 op_sel:[1,1,0] op_sel_hi:[1,1,0]
    v_mov_b32 v157, v36
    v_cvt_pk_bf16_f32 v30, v108, v109
    v_cvt_pk_bf16_f32 v31, v110, v111
    v_permlane32_swap_b32 v157, v36
    v_add_f32 v36, v157, v36
    v_mov_b32 v157, v36
    v_cvt_pk_bf16_f32 v52, v52, v53
    v_cvt_pk_bf16_f32 v53, v54, v55
    v_permlane16_swap_b32 v157, v36
    v_add_f32 v36, v157, v36
    v_add_f32 v36, s84, v36
    v_exp_f32 v36, v36
    v_cvt_pk_bf16_f32 v54, v56, v57
    v_cvt_pk_bf16_f32 v36, v36, 0
    v_cmp_gt_u32 vcc, 16, v156
    v_cvt_pk_bf16_f32 v55, v58, v59
    v_lshl_add_u32 v97, v156, 4, s93
    v_cndmask_b32 v36, 0, v36, vcc
    v_mfma_f32_16x16x32_f16 v[56:59], v[48:51], v[80:83], v[180:183]
    s_waitcnt vmcnt(5)
    s_lshl_b32 s93, s68, 10
    v_readfirstlane_b32 s94, v121
    s_nop 1
    s_cmp_lt_u32 s94, 3
    s_cbranch_scc1 L_spin
L_spinr:
    v_mfma_f32_16x16x32_f16 v[56:59], v[152:155], v[138:141], v[56:59]
    buffer_load_dwordx4 a[216:219], v97, s[76:79], s92 offen offset:0 sc1
    v_and_b32 v28, 0xb8000000, v123
    v_mfma_f32_16x16x32_f16 v[48:51], v[40:43], v[80:83], v[176:179]
    v_exp_f32 v76, v76
    v_mfma_f32_16x16x32_f16 v[48:51], v[146:149], v[138:141], v[48:51]
    buffer_load_dwordx4 a[220:223], v97, s[76:79], s92 offen offset:1024 sc1
    v_cmp_ne_u32 s[94:95], 0, v28
    v_mfma_f32_16x16x32_f16 v[40:43], v[84:87], v[80:83], v[172:175]
    v_exp_f32 v77, v77
    v_mfma_f32_16x16x32_f16 v[40:43], v[140:143], v[138:141], v[40:43]
    s_or_b32 s94, s94, s95
    buffer_load_dwordx4 a[224:227], v97, s[76:79], s92 offen offset:2048 sc1
    v_cvt_pk_bf16_f32 v76, v76, v77
    v_exp_f32 v78, v78
    v_exp_f32 v79, v79
    v_exp_f32 v68, v68
    s_lshl_b32 s95, s68, 2
    buffer_load_dwordx4 a[228:231], v97, s[76:79], s92 offen offset:3072 sc1
    s_movk_i32 s92, 4096
    v_cvt_pk_bf16_f32 v77, v78, v79
    v_exp_f32 v69, v69
    v_exp_f32 v70, v70
    v_exp_f32 v71, v71
    buffer_load_dwordx4 a[232:235], v97, s[76:79], s92 offen offset:0 sc1
    v_cvt_pk_bf16_f32 v78, v68, v69
    v_cvt_pk_bf16_f32 v79, v70, v71
    v_exp_f32 v4, v4
    v_exp_f32 v5, v5
    v_exp_f32 v6, v6
    v_exp_f32 v7, v7
    v_exp_f32 v13, v13
    v_rcp_f32 v72, v72
    v_mov_b32 v28, s94
    v_mov_b32 v121, s95
    ds_write_b32 v121, v28 offset:14848
    v_add_u32 v121, s93, v129
    v_cvt_pk_bf16_f32 v164, v20, v21
    v_cvt_pk_bf16_f32 v165, v22, v23
    v_mfma_f32_16x16x32_bf16 v[20:23], v[0:3], v[32:35], 0
    s_waitcnt lgkmcnt(1)
    buffer_load_dwordx4 a[236:239], v97, s[76:79], s92 offen offset:1024 sc1
    v_cvt_pk_bf16_f32 v160, v64, v65
    v_mfma_f32_16x16x32_bf16 v[20:23], v[164:167], v[168:171], v[20:23]
    v_cvt_pk_bf16_f32 v161, v66, v67
    v_cvt_pk_bf16_f32 v156, v44, v45
    v_mfma_f32_16x16x32_bf16 v[84:87], v[8:11], v[32:35], 0
    s_nop 0
    v_cvt_pk_bf16_f32 v157, v46, v47
    v_add_u32 v137, s48, v137
    v_mfma_f32_16x16x32_bf16 v[84:87], v[160:163], v[168:171], v[84:87]
L_pg1:
    s_cbranch_execz L_main
    s_nop 0
    v_mul_f32 v20, v20, v72
    v_mul_f32 v21, v21, v72
    v_mfma_f32_16x16x32_bf16 v[68:71], v[24:27], v[32:35], 0
    v_cvt_pk_bf16_f32 v44, v20, v21
    v_mul_f32 v22, v22, v72
    v_mfma_f32_16x16x32_bf16 v[68:71], v[156:159], v[168:171], v[68:71]
    buffer_load_dwordx4 a[240:243], v97, s[76:79], s92 offen offset:2048 sc1
    v_mul_f32 v23, v23, v72
    v_mfma_f32_16x16x32_bf16 v[32:35], v[100:103], v[0:3], 0
    v_cvt_pk_bf16_f32 v45, v22, v23
    v_mul_f32 v84, v84, v72
    v_mfma_f32_16x16x32_bf16 v[32:35], v[92:95], v[164:167], v[32:35]
    s_waitcnt lgkmcnt(0)
    ds_write_b64 v135, v[44:45] offset:0
    v_mfma_f32_16x16x32_bf16 v[80:83], v[100:103], v[8:11], 0
    s_barrier
    v_mov_b32 v44, 0
    v_mov_b32 v45, 0
    v_mfma_f32_16x16x32_bf16 v[80:83], v[92:95], v[160:163], v[80:83]
    ds_read_b128 v[20:23], v122 offset:14848
    buffer_load_dwordx4 a[244:247], v97, s[76:79], s92 offen offset:3072 sc1
    v_mfma_f32_16x16x32_bf16 v[64:67], v[100:103], v[24:27], 0
    s_movk_i32 s92, 8192
    ds_write_b128 v121, v[104:107] offset:6144
    v_mfma_f32_16x16x32_bf16 v[64:67], v[92:95], v[156:159], v[64:67]
    v_mov_b32 v37, 0
    v_add_u32 v29, 0, v120
    v_mul_f32 v85, v85, v72
    v_cvt_pk_bf16_f32 v46, v84, v85
    v_mul_f32 v86, v86, v72
    v_mul_f32 v87, v87, v72
    ds_write_b128 v29, v[88:91]
    buffer_load_dwordx4 a[248:251], v97, s[76:79], s92 offen offset:0 sc1
    v_cvt_pk_bf16_f32 v47, v86, v87
    v_mov_b32_dpp v35, v83 quad_perm:[0,1,2,3] row_mask:0x2 bank_mask:0xf
    v_cvt_pk_bf16_f32 v168, v4, v5
    v_cvt_pk_bf16_f32 v169, v6, v7
    v_cvt_pk_bf16_f32 v170, v13, 0
    v_mfma_f32_16x16x32_bf16 v[4:7], v[220:223], v[76:79], 0
    ds_write2_b64 v29, v[44:45], v[44:45] offset0:2 offset1:3
    v_mfma_f32_16x16x32_bf16 v[4:7], v[220:223], v[168:171], v[4:7]
    s_waitcnt lgkmcnt(2)
    v_or3_b32 v20, v20, v21, v22
    v_or_b32 v20, v20, v23
    v_mfma_f32_16x16x32_bf16 v[12:15], v[0:3], v[76:79], 0
    buffer_load_dwordx4 a[252:255], v97, s[76:79], s92 offen offset:1024 sc1
    v_readfirstlane_b32 s75, v20
    v_mfma_f32_16x16x32_bf16 v[12:15], v[164:167], v[168:171], v[12:15]
    ds_write_b128 v29, v[16:19] offset:32
    v_mfma_f32_16x16x32_bf16 v[20:23], v[8:11], v[76:79], 0
    v_mul_f32 v68, v68, v72
    v_mul_f32 v69, v69, v72
    v_mfma_f32_16x16x32_bf16 v[20:23], v[160:163], v[168:171], v[20:23]
    v_cvt_pk_bf16_f32 v98, v68, v69
    v_mul_f32 v70, v70, v72
    v_mfma_f32_16x16x32_bf16 v[16:19], v[24:27], v[76:79], 0
    ds_write2_b64 v29, v[62:63], v[44:45] offset0:6 offset1:7
    v_mfma_f32_16x16x32_bf16 v[16:19], v[156:159], v[168:171], v[16:19]
    v_mul_f32 v71, v71, v72
    v_cvt_pk_bf16_f32 v99, v70, v71
    v_mov_b32_dpp v35, v67 quad_perm:[0,1,2,3] row_mask:0x4 bank_mask:0xf
    v_cvt_pk_bf16_f32 v35, v35, v35
    v_exp_f32 v56, v56
    ds_write2_b64 v29, v[44:45], v[60:61] offset0:8 offset1:9
    buffer_load_dwordx4 v[224:227], v97, s[76:79], s92 offen offset:2048 sc1
    v_exp_f32 v57, v57
    v_exp_f32 v58, v58
    v_exp_f32 v59, v59
    v_cvt_pk_bf16_f32 v28, v56, v57
    ds_write_b64 v29, v[36:37] offset:88
    buffer_load_dwordx4 v[228:231], v97, s[76:79], s92 offen offset:3072 sc1
    v_cvt_pk_bf16_f32 v29, v58, v59
    v_exp_f32 v48, v48
    v_exp_f32 v49, v49
    s_movk_i32 s92, 12288
    ds_write_b64 v120, v[30:31] offset:80
    v_exp_f32 v50, v50
    v_exp_f32 v51, v51
    v_cvt_pk_bf16_f32 v30, v48, v49
    ds_write_b128 v120, v[52:55] offset:96
    buffer_load_dwordx4 v[232:235], v97, s[76:79], s92 offen offset:0 sc1
    v_cvt_pk_bf16_f32 v31, v50, v51
    v_exp_f32 v40, v40
    v_exp_f32 v41, v41
    v_exp_f32 v42, v42
    ds_write_b64 v135, v[46:47] offset:8
    v_exp_f32 v43, v43
    v_cvt_pk_bf16_f32 v168, v40, v41
    v_cvt_pk_bf16_f32 v169, v42, v43
    v_exp_f32 v38, v38
    ds_write_b32 v134, v98 offset:0
    buffer_load_dwordx4 v[236:239], v97, s[76:79], s92 offen offset:1024 sc1
    v_cvt_pk_bf16_f32 v170, v38, 0
    v_mfma_f32_16x16x32_bf16 v[36:39], v[220:223], v[28:31], 0
    ds_write_b32 v134, v99 offset:4
    v_mfma_f32_16x16x32_bf16 v[36:39], v[220:223], v[168:171], v[36:39]
    ds_write_b16 v131, v35
    v_mfma_f32_16x16x32_bf16 v[64:67], v[0:3], v[28:31], 0
    ds_read_b128 v[84:87], v137 offset:0
    v_add_u32 v136, s48, v136
    v_mfma_f32_16x16x32_bf16 v[64:67], v[164:167], v[168:171], v[64:67]
    buffer_load_dwordx4 v[240:243], v97, s[76:79], s92 offen offset:2048 sc1
    ds_read_b128 v[108:111], v136 offset:0
    v_mfma_f32_16x16x32_bf16 v[0:3], v[8:11], v[28:31], 0
    v_rcp_f32 v4, v4
    v_mfma_f32_16x16x32_bf16 v[0:3], v[160:163], v[168:171], v[0:3]
    ds_read_b128 v[8:11], v137 offset:128
    v_mul_f32 v12, v12, v4
    v_mfma_f32_16x16x32_bf16 v[146:149], v[24:27], v[28:31], 0
    ds_read_b128 v[112:115], v136 offset:128
    v_mul_f32 v13, v13, v4
    v_mfma_f32_16x16x32_bf16 v[146:149], v[156:159], v[168:171], v[146:149]
    ds_read_b128 v[40:43], v137 offset:256
    v_cvt_pk_bf16_f32 v12, v12, v13
    v_mul_f32 v14, v14, v4
    v_mul_f32 v15, v15, v4
    buffer_load_dwordx4 v[244:247], v97, s[76:79], s92 offen offset:3072 sc1
    s_movk_i32 s92, 16384
    ds_write_b32 v135, v12 offset:1536
    v_cvt_pk_bf16_f32 v13, v14, v15
    v_mul_f32 v20, v20, v4
    v_mul_f32 v21, v21, v4
    v_cvt_pk_bf16_f32 v14, v20, v21
    v_mul_f32 v22, v22, v4
    s_waitcnt lgkmcnt(5)
    v_mfma_f32_16x16x32_bf16 v[28:31], a[0:3], v[84:87], 0
    ds_read_b128 v[52:55], v136 offset:256
    v_mul_f32 v23, v23, v4
    v_cvt_pk_bf16_f32 v15, v22, v23
    v_mul_f32 v16, v16, v4
    v_mul_f32 v17, v17, v4
    buffer_load_dwordx4 v[248:251], v97, s[76:79], s92 offen offset:0 sc1
    ds_read_b128 v[68:71], v137 offset:1536
    v_cvt_pk_bf16_f32 v154, v16, v17
    v_mul_f32 v18, v18, v4
    v_mul_f32 v19, v19, v4
    v_cvt_pk_bf16_f32 v155, v18, v19
    ds_read_b128 v[60:63], v136 offset:1536
    ds_read_b128 v[98:101], v137 offset:1664
    ds_read_b128 v[104:107], v136 offset:1792
    buffer_load_dwordx4 v[252:255], v97, s[76:79], s92 offen offset:1024 sc1
    s_waitcnt lgkmcnt(0)
    s_cmp_lg_u32 s75, 0
    s_cbranch_scc0 L_loopF0
    s_branch L_slow
L_bndF:
    s_movk_i32 s73, 20
    s_movk_i32 s71, 18
    s_movk_i32 s70, -20
    s_mov_b32 s74, 0
    s_bitcmp1_b32 s2, 2
    s_cbranch_scc1 L_bndcF
    s_sub_u32 s94, s2, 248
    s_mul_i32 s69, s94, 18
    s_mov_b32 s74, 2
    s_sub_u32 s93, s93, 1373568
    v_cmp_le_u32 vcc, 4, v141
    v_add_u32 v138, 98896896, v128
    v_subrev_u32 v139, 1373568, v128
    v_cndmask_b32 v128, v138, v139, vcc
    v_cmp_le_u32 vcc, 4, v14
    v_add_u32 v138, 98896896, v127
    v_subrev_u32 v139, 1373568, v127
    v_cndmask_b32 v127, v138, v139, vcc
    v_cmp_le_u32 vcc, 4, v107
    v_add_u32 v138, 98896896, v126
    v_subrev_u32 v139, 1373568, v126
    v_cndmask_b32 v126, v138, v139, vcc
    v_cmp_le_u32 vcc, 4, v131
    v_add_u32 v138, 98896896, v125
    v_subrev_u32 v139, 1373568, v125
    v_cndmask_b32 v125, v138, v139, vcc
    v_cmp_le_u32 vcc, 4, v129
    v_add_u32 v138, 98896896, v124
    v_subrev_u32 v139, 1373568, v124
    v_cndmask_b32 v124, v138, v139, vcc
    s_cmp_lt_u32 s2, 256
    s_cbranch_scc1 L_bndrF
L_bndcF:
    s_sub_u32 s94, s2, 252
    s_mul_i32 s69, s94, 20
    s_lshr_b32 s71, s94, 1
    s_sub_u32 s69, s69, s71
    s_and_b32 s94, s94, 1
    s_sub_u32 s71, 20, s94
    s_cmp_eq_u32 s2, 255
    s_cselect_b32 s71, 13, s71
    s_mov_b32 s62, 1373568
    s_add_u32 s74, s74, 1
    s_sub_u32 s93, s93, 2688
    v_mad_i32_i24 v138, v141, -7, v104
    v_cmp_le_u32 vcc, 4, v138
    v_add_u32 v138, 193536, v128
    v_subrev_u32 v139, 2688, v128
    v_cndmask_b32 v128, v138, v139, vcc
    v_mad_i32_i24 v138, v14, -7, v105
    v_cmp_le_u32 vcc, 4, v138
    v_add_u32 v138, 193536, v127
    v_subrev_u32 v139, 2688, v127
    v_cndmask_b32 v127, v138, v139, vcc
    v_mad_i32_i24 v138, v107, -7, v140
    v_cmp_le_u32 vcc, 4, v138
    v_add_u32 v138, 193536, v126
    v_subrev_u32 v139, 2688, v126
    v_cndmask_b32 v126, v138, v139, vcc
    v_mad_i32_i24 v138, v131, -7, v133
    v_cmp_le_u32 vcc, 4, v138
    v_add_u32 v138, 193536, v125
    v_subrev_u32 v139, 2688, v125
    v_cndmask_b32 v125, v138, v139, vcc
    v_mad_i32_i24 v138, v129, -7, v130
    v_cmp_le_u32 vcc, 4, v138
    v_add_u32 v138, 193536, v124
    v_subrev_u32 v139, 2688, v124
    v_cndmask_b32 v124, v138, v139, vcc
    s_cmp_eq_u32 s2, 256
    s_cselect_b32 s62, 0, s62
    s_cselect_b32 s69, 0, s69
    s_cselect_b32 s71, 2, s71
    s_branch L_bndrF
L_maskF:
    s_and_b32 s20, s74, 2
    s_and_b32 s21, s74, 1
    s_mov_b32 s22, 0xc31044fe
    v_lshrrev_b32 v62, 2, v63
    v_add_u32 v62, 0, v62
    v_mul_u32_u24 v243, 37, v62
    v_lshrrev_b32 v143, 8, v243
    v_mad_i32_i24 v143, v143, -7, v62
    v_lshrrev_b32 v243, 10, v243
    v_lshrrev_b32 v143, 2, v143
    v_mul_u32_u24 v243, s20, v243
    v_mad_u32_u24 v62, v143, s21, v243
    v_cvt_f32_u32 v62, v62
    v_lshrrev_b32 v241, 2, v63
    v_add_u32 v241, 4, v241
    v_mul_u32_u24 v243, 37, v241
    v_lshrrev_b32 v143, 8, v243
    v_mad_i32_i24 v143, v143, -7, v241
    v_lshrrev_b32 v243, 10, v243
    v_lshrrev_b32 v143, 2, v143
    v_mul_u32_u24 v243, s20, v243
    v_mad_u32_u24 v241, v143, s21, v243
    v_cvt_f32_u32 v241, v241
    v_lshrrev_b32 v235, 2, v63
    v_add_u32 v235, 8, v235
    v_mul_u32_u24 v243, 37, v235
    v_lshrrev_b32 v143, 8, v243
    v_mad_i32_i24 v143, v143, -7, v235
    v_lshrrev_b32 v243, 10, v243
    v_lshrrev_b32 v143, 2, v143
    v_mul_u32_u24 v243, s20, v243
    v_mad_u32_u24 v235, v143, s21, v243
    v_cvt_f32_u32 v235, v235
    v_mad_u32_u24 v233, v142, 12, 0
    v_mul_u32_u24 v243, 37, v233
    v_lshrrev_b32 v143, 8, v243
    v_mad_i32_i24 v143, v143, -7, v233
    v_lshrrev_b32 v243, 10, v243
    v_lshrrev_b32 v143, 2, v143
    v_mul_u32_u24 v243, s20, v243
    v_mad_u32_u24 v233, v143, s21, v243
    v_cvt_f32_u32 v233, v233
    v_sub_f32 v243, v62, v233
    v_mul_f32 v243, v243, v243 clamp
    v_fmac_f32 v204, s22, v243
    v_sub_f32 v243, v241, v233
    v_mul_f32 v243, v243, v243 clamp
    v_fmac_f32 v192, s22, v243
    v_sub_f32 v243, v235, v233
    v_mul_f32 v243, v243, v243 clamp
    v_fmac_f32 v180, s22, v243
    v_mad_u32_u24 v233, v142, 12, 1
    v_mul_u32_u24 v243, 37, v233
    v_lshrrev_b32 v143, 8, v243
    v_mad_i32_i24 v143, v143, -7, v233
    v_lshrrev_b32 v243, 10, v243
    v_lshrrev_b32 v143, 2, v143
    v_mul_u32_u24 v243, s20, v243
    v_mad_u32_u24 v233, v143, s21, v243
    v_cvt_f32_u32 v233, v233
    v_sub_f32 v243, v62, v233
    v_mul_f32 v243, v243, v243 clamp
    v_fmac_f32 v205, s22, v243
    v_sub_f32 v243, v241, v233
    v_mul_f32 v243, v243, v243 clamp
    v_fmac_f32 v193, s22, v243
    v_sub_f32 v243, v235, v233
    v_mul_f32 v243, v243, v243 clamp
    v_fmac_f32 v181, s22, v243
    v_mad_u32_u24 v233, v142, 12, 2
    v_mul_u32_u24 v243, 37, v233
    v_lshrrev_b32 v143, 8, v243
    v_mad_i32_i24 v143, v143, -7, v233
    v_lshrrev_b32 v243, 10, v243
    v_lshrrev_b32 v143, 2, v143
    v_mul_u32_u24 v243, s20, v243
    v_mad_u32_u24 v233, v143, s21, v243
    v_cvt_f32_u32 v233, v233
    v_sub_f32 v243, v62, v233
    v_mul_f32 v243, v243, v243 clamp
    v_fmac_f32 v206, s22, v243
    v_sub_f32 v243, v241, v233
    v_mul_f32 v243, v243, v243 clamp
    v_fmac_f32 v194, s22, v243
    v_sub_f32 v243, v235, v233
    v_mul_f32 v243, v243, v243 clamp
    v_fmac_f32 v182, s22, v243
    v_mad_u32_u24 v233, v142, 12, 3
    v_mul_u32_u24 v243, 37, v233
    v_lshrrev_b32 v143, 8, v243
    v_mad_i32_i24 v143, v143, -7, v233
    v_lshrrev_b32 v243, 10, v243
    v_lshrrev_b32 v143, 2, v143
    v_mul_u32_u24 v243, s20, v243
    v_mad_u32_u24 v233, v143, s21, v243
    v_cvt_f32_u32 v233, v233
    v_sub_f32 v243, v62, v233
    v_mul_f32 v243, v243, v243 clamp
    v_fmac_f32 v207, s22, v243
    v_sub_f32 v243, v241, v233
    v_mul_f32 v243, v243, v243 clamp
    v_fmac_f32 v195, s22, v243
    v_sub_f32 v243, v235, v233
    v_mul_f32 v243, v243, v243 clamp
    v_fmac_f32 v183, s22, v243
    v_mad_u32_u24 v233, v142, 12, 4
    v_mul_u32_u24 v243, 37, v233
    v_lshrrev_b32 v143, 8, v243
    v_mad_i32_i24 v143, v143, -7, v233
    v_lshrrev_b32 v243, 10, v243
    v_lshrrev_b32 v143, 2, v143
    v_mul_u32_u24 v243, s20, v243
    v_mad_u32_u24 v233, v143, s21, v243
    v_cvt_f32_u32 v233, v233
    v_sub_f32 v243, v62, v233
    v_mul_f32 v243, v243, v243 clamp
    v_fmac_f32 v200, s22, v243
    v_sub_f32 v243, v241, v233
    v_mul_f32 v243, v243, v243 clamp
    v_fmac_f32 v188, s22, v243
    v_sub_f32 v243, v235, v233
    v_mul_f32 v243, v243, v243 clamp
    v_fmac_f32 v176, s22, v243
    v_mad_u32_u24 v233, v142, 12, 5
    v_mul_u32_u24 v243, 37, v233
    v_lshrrev_b32 v143, 8, v243
    v_mad_i32_i24 v143, v143, -7, v233
    v_lshrrev_b32 v243, 10, v243
    v_lshrrev_b32 v143, 2, v143
    v_mul_u32_u24 v243, s20, v243
    v_mad_u32_u24 v233, v143, s21, v243
    v_cvt_f32_u32 v233, v233
    v_sub_f32 v243, v62, v233
    v_mul_f32 v243, v243, v243 clamp
    v_fmac_f32 v201, s22, v243
    v_sub_f32 v243, v241, v233
    v_mul_f32 v243, v243, v243 clamp
    v_fmac_f32 v189, s22, v243
    v_sub_f32 v243, v235, v233
    v_mul_f32 v243, v243, v243 clamp
    v_fmac_f32 v177, s22, v243
    v_mad_u32_u24 v233, v142, 12, 6
    v_mul_u32_u24 v243, 37, v233
    v_lshrrev_b32 v143, 8, v243
    v_mad_i32_i24 v143, v143, -7, v233
    v_lshrrev_b32 v243, 10, v243
    v_lshrrev_b32 v143, 2, v143
    v_mul_u32_u24 v243, s20, v243
    v_mad_u32_u24 v233, v143, s21, v243
    v_cvt_f32_u32 v233, v233
    v_sub_f32 v243, v62, v233
    v_mul_f32 v243, v243, v243 clamp
    v_fmac_f32 v202, s22, v243
    v_sub_f32 v243, v241, v233
    v_mul_f32 v243, v243, v243 clamp
    v_fmac_f32 v190, s22, v243
    v_sub_f32 v243, v235, v233
    v_mul_f32 v243, v243, v243 clamp
    v_fmac_f32 v178, s22, v243
    v_mad_u32_u24 v233, v142, 12, 7
    v_mul_u32_u24 v243, 37, v233
    v_lshrrev_b32 v143, 8, v243
    v_mad_i32_i24 v143, v143, -7, v233
    v_lshrrev_b32 v243, 10, v243
    v_lshrrev_b32 v143, 2, v143
    v_mul_u32_u24 v243, s20, v243
    v_mad_u32_u24 v233, v143, s21, v243
    v_cvt_f32_u32 v233, v233
    v_sub_f32 v243, v62, v233
    v_mul_f32 v243, v243, v243 clamp
    v_fmac_f32 v203, s22, v243
    v_sub_f32 v243, v241, v233
    v_mul_f32 v243, v243, v243 clamp
    v_fmac_f32 v191, s22, v243
    v_sub_f32 v243, v235, v233
    v_mul_f32 v243, v243, v243 clamp
    v_fmac_f32 v179, s22, v243
    v_mad_u32_u24 v233, v142, 12, 8
    v_mul_u32_u24 v243, 37, v233
    v_lshrrev_b32 v143, 8, v243
    v_mad_i32_i24 v143, v143, -7, v233
    v_lshrrev_b32 v243, 10, v243
    v_lshrrev_b32 v143, 2, v143
    v_mul_u32_u24 v243, s20, v243
    v_mad_u32_u24 v233, v143, s21, v243
    v_cvt_f32_u32 v233, v233
    v_sub_f32 v243, v62, v233
    v_mul_f32 v243, v243, v243 clamp
    v_fmac_f32 v196, s22, v243
    v_sub_f32 v243, v241, v233
    v_mul_f32 v243, v243, v243 clamp
    v_fmac_f32 v184, s22, v243
    v_sub_f32 v243, v235, v233
    v_mul_f32 v243, v243, v243 clamp
    v_fmac_f32 v172, s22, v243
    v_mad_u32_u24 v233, v142, 12, 9
    v_mul_u32_u24 v243, 37, v233
    v_lshrrev_b32 v143, 8, v243
    v_mad_i32_i24 v143, v143, -7, v233
    v_lshrrev_b32 v243, 10, v243
    v_lshrrev_b32 v143, 2, v143
    v_mul_u32_u24 v243, s20, v243
    v_mad_u32_u24 v233, v143, s21, v243
    v_cvt_f32_u32 v233, v233
    v_sub_f32 v243, v62, v233
    v_mul_f32 v243, v243, v243 clamp
    v_fmac_f32 v197, s22, v243
    v_sub_f32 v243, v241, v233
    v_mul_f32 v243, v243, v243 clamp
    v_fmac_f32 v185, s22, v243
    v_sub_f32 v243, v235, v233
    v_mul_f32 v243, v243, v243 clamp
    v_fmac_f32 v173, s22, v243
    v_mad_u32_u24 v233, v142, 12, 10
    v_mul_u32_u24 v243, 37, v233
    v_lshrrev_b32 v143, 8, v243
    v_mad_i32_i24 v143, v143, -7, v233
    v_lshrrev_b32 v243, 10, v243
    v_lshrrev_b32 v143, 2, v143
    v_mul_u32_u24 v243, s20, v243
    v_mad_u32_u24 v233, v143, s21, v243
    v_cvt_f32_u32 v233, v233
    v_sub_f32 v243, v62, v233
    v_mul_f32 v243, v243, v243 clamp
    v_fmac_f32 v198, s22, v243
    v_sub_f32 v243, v241, v233
    v_mul_f32 v243, v243, v243 clamp
    v_fmac_f32 v186, s22, v243
    v_sub_f32 v243, v235, v233
    v_mul_f32 v243, v243, v243 clamp
    v_fmac_f32 v174, s22, v243
    v_mad_u32_u24 v233, v142, 12, 11
    v_mul_u32_u24 v243, 37, v233
    v_lshrrev_b32 v143, 8, v243
    v_mad_i32_i24 v143, v143, -7, v233
    v_lshrrev_b32 v243, 10, v243
    v_lshrrev_b32 v143, 2, v143
    v_mul_u32_u24 v243, s20, v243
    v_mad_u32_u24 v233, v143, s21, v243
    v_cvt_f32_u32 v233, v233
    v_sub_f32 v243, v62, v233
    v_mul_f32 v243, v243, v243 clamp
    v_fmac_f32 v199, s22, v243
    v_sub_f32 v243, v241, v233
    v_mul_f32 v243, v243, v243 clamp
    v_fmac_f32 v187, s22, v243
    v_sub_f32 v243, v235, v233
    v_mul_f32 v243, v243, v243 clamp
    v_fmac_f32 v175, s22, v243
    v_cvt_f32_u32 v233, s74
    v_sub_f32 v243, v62, v233
    v_mul_f32 v243, v243, v243 clamp
    v_fmac_f32 v208, s22, v243
    v_sub_f32 v243, v241, v233
    v_mul_f32 v243, v243, v243 clamp
    v_fmac_f32 v209, s22, v243
    v_sub_f32 v243, v235, v233
    v_mul_f32 v243, v243, v243 clamp
    v_fmac_f32 v210, s22, v243
    v_lshrrev_b32 v62, 2, v63
    v_lshl_add_u32 v62, v142, 2, v62
    v_add_u32 v243, 1, v142
    v_lshrrev_b32 v243, 2, v243
    v_mad_u32_u24 v62, v243, 36, v62
    v_min_u32 v62, 48, v62
    v_mul_u32_u24 v243, 37, v62
    v_lshrrev_b32 v143, 8, v243
    v_mad_i32_i24 v143, v143, -7, v62
    v_lshrrev_b32 v243, 10, v243
    v_lshrrev_b32 v143, 2, v143
    v_mul_u32_u24 v243, s20, v243
    v_mad_u32_u24 v62, v143, s21, v243
    v_cvt_f32_u32 v62, v62
    v_sub_f32 v243, v62, v233
    v_mul_f32 v243, v243, v243 clamp
    v_fmac_f32 v211, s22, v243
    s_branch L_nomaskF
L_spin:
    s_movk_i32 s95, 300
L_spin1:
    global_load_dword v121, v122, s[38:39] offset:248 sc1
    s_waitcnt vmcnt(0)
    v_readfirstlane_b32 s94, v121
    s_nop 1
    s_cmp_ge_u32 s94, 3
    s_cbranch_scc1 L_spinr
    s_sub_u32 s95, s95, 1
    s_cmp_lg_u32 s95, 0
    s_cbranch_scc1 L_spin1
    v_mov_b32 v123, -1
    s_branch L_spinr
.fill 636, 4, 0xbf800000
L_atomF0:
    s_cbranch_execz L_main
    v_mov_b32 v122, 0x800000
    buffer_atomic_add v122, v129, s[8:11], 0 offen sc0 sc1
    s_branch L_atomF0r
.p2align 6
L_loopF0:
    v_mfma_f32_16x16x32_bf16 v[28:31], a[4:7], v[108:111], v[28:31]
    ds_write_b32 v135, v13 offset:1540
    v_mfma_f32_16x16x32_bf16 v[28:31], a[8:11], v[8:11], v[28:31]
    v_rcp_f32 v36, v36
    v_mfma_f32_16x16x32_bf16 v[28:31], a[12:15], v[112:115], v[28:31]
    v_mul_f32 v64, v64, v36
    v_mul_f32 v65, v65, v36
    v_mfma_f32_16x16x32_bf16 v[28:31], a[16:19], v[40:43], v[28:31]
    ds_read_b128 v[76:79], v136 offset:1664
    v_cvt_pk_bf16_f32 v4, v64, v65
    v_mfma_f32_16x16x32_bf16 v[28:31], a[20:23], v[52:55], v[28:31]
    v_mul_f32 v66, v66, v36
    v_mul_f32 v67, v67, v36
    v_mfma_f32_16x16x32_bf16 v[16:19], v[84:87], a[168:171], 0
    v_cvt_pk_bf16_f32 v5, v66, v67
    v_mul_f32 v0, v0, v36
    v_mfma_f32_16x16x32_bf16 v[16:19], v[108:111], a[172:175], v[16:19]
    v_mul_f32 v1, v1, v36
    v_cvt_pk_bf16_f32 v6, v0, v1
    v_mfma_f32_16x16x32_bf16 v[16:19], v[8:11], a[176:179], v[16:19]
    ds_write_b64 v135, v[14:15] offset:1544
    v_mfma_f32_16x16x32_bf16 v[16:19], v[112:115], a[180:183], v[16:19]
    v_mul_f32 v2, v2, v36
    v_mul_f32 v3, v3, v36
    v_mfma_f32_16x16x32_bf16 v[16:19], v[40:43], a[184:187], v[16:19]
    v_cvt_pk_bf16_f32 v7, v2, v3
    v_mul_f32 v146, v146, v36
    v_mfma_f32_16x16x32_bf16 v[16:19], v[52:55], a[188:191], v[16:19]
    v_mul_f32 v147, v147, v36
    v_cvt_pk_bf16_f32 v152, v146, v147
    v_mfma_f32_16x16x32_bf16 v[12:15], a[120:123], v[84:87], 0
    ds_write_b64 v134, v[154:155] offset:1536
    v_mfma_f32_16x16x32_bf16 v[12:15], a[124:127], v[108:111], v[12:15]
    v_mul_f32 v148, v148, v36
    v_mul_f32 v149, v149, v36
    v_mfma_f32_16x16x32_bf16 v[12:15], a[128:131], v[8:11], v[12:15]
    v_cvt_pk_bf16_f32 v153, v148, v149
    v_fmac_f32 v32, v116, v116
    v_mfma_f32_16x16x32_bf16 v[12:15], a[132:135], v[112:115], v[12:15]
    ds_read_b128 v[92:95], v137 offset:1792
    v_fmac_f32 v32, v117, v117
    v_mfma_f32_16x16x32_bf16 v[12:15], a[136:139], v[40:43], v[12:15]
    v_fmac_f32 v32, v118, v118
    v_fmac_f32 v32, v119, v119
    v_mfma_f32_16x16x32_bf16 v[12:15], a[140:143], v[52:55], v[12:15]
    v_fma_f32 v154, v140, v140, s42
    v_fmac_f32 v154, v141, v141
    v_mfma_f32_16x16x32_bf16 v[0:3], a[48:51], v[84:87], 0
    v_fmac_f32 v154, v142, v142
    v_fmac_f32 v154, v143, v143
    v_mfma_f32_16x16x32_bf16 v[0:3], a[52:55], v[108:111], v[0:3]
    ds_write_b64 v135, v[4:5] offset:3072
    v_mfma_f32_16x16x32_bf16 v[0:3], a[56:59], v[8:11], v[0:3]
    v_fmac_f32 v154, v44, v44
    v_fmac_f32 v154, v45, v45
    v_mfma_f32_16x16x32_bf16 v[0:3], a[60:63], v[112:115], v[0:3]
    v_fmac_f32 v154, v46, v46
    v_fmac_f32 v154, v47, v47
    v_mfma_f32_16x16x32_bf16 v[0:3], a[64:67], v[40:43], v[0:3]
    v_fmac_f32 v154, v56, v56
    v_fmac_f32 v154, v57, v57
    v_mfma_f32_16x16x32_bf16 v[0:3], a[68:71], v[52:55], v[0:3]
    ds_write_b64 v135, v[6:7] offset:3080
    v_mfma_f32_16x16x32_bf16 v[4:7], a[24:27], v[84:87], 0
    v_fmac_f32 v154, v58, v58
    v_fmac_f32 v154, v59, v59
    v_mfma_f32_16x16x32_bf16 v[4:7], a[28:31], v[108:111], v[4:7]
    v_fma_f32 v155, v24, v24, s42
    v_fmac_f32 v155, v25, v25
    v_mfma_f32_16x16x32_bf16 v[4:7], a[32:35], v[8:11], v[4:7]
    v_fmac_f32 v155, v26, v26
    v_fmac_f32 v155, v27, v27
    v_mfma_f32_16x16x32_bf16 v[4:7], a[36:39], v[112:115], v[4:7]
    ds_write_b32 v134, v152 offset:3072
    v_mfma_f32_16x16x32_bf16 v[4:7], a[40:43], v[40:43], v[4:7]
    v_fmac_f32 v155, v88, v88
    v_fmac_f32 v155, v89, v89
    v_mfma_f32_16x16x32_bf16 v[4:7], a[44:47], v[52:55], v[4:7]
    v_fmac_f32 v155, v90, v90
    v_fmac_f32 v155, v91, v91
    v_mfma_f32_16x16x32_bf16 v[146:149], v[84:87], a[192:195], 0
    s_waitcnt vmcnt(10)
    v_fmac_f32 v155, v72, v72
    v_fmac_f32 v155, v73, v73
    v_mfma_f32_16x16x32_bf16 v[146:149], v[108:111], a[196:199], v[146:149]
    ds_write_b32 v134, v153 offset:3076
    v_mfma_f32_16x16x32_bf16 v[146:149], v[8:11], a[200:203], v[146:149]
    v_fmac_f32 v155, v74, v74
    v_fmac_f32 v155, v75, v75
    v_mfma_f32_16x16x32_bf16 v[146:149], v[112:115], a[204:207], v[146:149]
    v_cvt_pk_bf16_f32 v152, v32, v154
    v_cvt_pk_bf16_f32 v153, v155, v122
    v_mfma_f32_16x16x32_bf16 v[146:149], v[40:43], a[208:211], v[146:149]
    v_add_u32 v135, s49, v135
    v_add_u32 v134, s49, v134
    v_mfma_f32_16x16x32_bf16 v[146:149], v[52:55], a[212:215], v[146:149]
    ds_write_b64 v130, v[152:153]
    v_mfma_f32_16x16x32_bf16 v[32:35], a[72:75], v[84:87], 0
    v_cvt_pk_f16_f32 v28, v28, v29
    v_cvt_pk_f16_f32 v29, v30, v31
    v_mfma_f32_16x16x32_bf16 v[32:35], a[76:79], v[108:111], v[32:35]
    v_pk_fma_f16 v36, v28, v28, s3
    v_pk_fmac_f16 v36, v29, v29
    v_mfma_f32_16x16x32_bf16 v[32:35], a[80:83], v[8:11], v[32:35]
    v_cvt_pk_f16_f32 v154, v12, v13
    v_cvt_pk_f16_f32 v155, v14, v15
    v_mfma_f32_16x16x32_bf16 v[32:35], a[84:87], v[112:115], v[32:35]
    v_cvt_pk_f16_f32 v30, v4, v5
    v_cvt_pk_f16_f32 v31, v6, v7
    v_mfma_f32_16x16x32_bf16 v[32:35], a[88:91], v[40:43], v[32:35]
    v_pk_fmac_f16 v36, v30, v30
    v_pk_fmac_f16 v36, v31, v31
    v_mfma_f32_16x16x32_bf16 v[32:35], a[92:95], v[52:55], v[32:35]
    v_cvt_pk_bf16_f32 v4, v146, v147
    v_cvt_pk_bf16_f32 v5, v148, v149
    v_mfma_f32_16x16x32_bf16 v[146:149], a[96:99], v[84:87], 0
    v_cvt_pk_f16_f32 v152, v0, v1
    v_cvt_pk_f16_f32 v153, v2, v3
    v_mfma_f32_16x16x32_bf16 v[146:149], a[100:103], v[108:111], v[146:149]
    s_waitcnt lgkmcnt(0)
    v_pk_fmac_f16 v36, v152, v152
    v_pk_fmac_f16 v36, v153, v153
    v_mfma_f32_16x16x32_bf16 v[146:149], a[104:107], v[8:11], v[146:149]
    s_barrier
    ds_read_b128 v[0:3], v129 offset:0
    v_cvt_pk_f16_f32 v12, v32, v33
    v_mfma_f32_16x16x32_bf16 v[146:149], a[108:111], v[112:115], v[146:149]
    ds_read_b128 v[64:67], v129 offset:1024
    v_cvt_pk_f16_f32 v13, v34, v35
    v_mfma_f32_16x16x32_bf16 v[146:149], a[112:115], v[40:43], v[146:149]
    v_pk_fma_f16 v37, v12, v12, s3
    v_pk_fmac_f16 v37, v13, v13
    v_mfma_f32_16x16x32_bf16 v[146:149], a[116:119], v[52:55], v[146:149]
    s_nop 1
    v_mfma_f32_16x16x32_bf16 v[32:35], v[84:87], a[144:147], 0
    s_nop 2
    v_mfma_f32_16x16x32_bf16 v[32:35], v[108:111], a[148:151], v[32:35]
    s_nop 0
    v_cvt_pk_f16_f32 v14, v146, v147
    v_cvt_pk_f16_f32 v15, v148, v149
    v_mfma_f32_16x16x32_bf16 v[32:35], v[8:11], a[152:155], v[32:35]
    v_pk_fmac_f16 v37, v14, v14
    v_pk_fmac_f16 v37, v15, v15
    v_mfma_f32_16x16x32_bf16 v[32:35], v[112:115], a[156:159], v[32:35]
    v_pk_fmac_f16 v37, v154, v154
    v_pk_fmac_f16 v37, v155, v155
    v_mfma_f32_16x16x32_bf16 v[32:35], v[40:43], a[160:163], v[32:35]
    v_mfma_f32_16x16x32_bf16 v[32:35], v[52:55], a[164:167], v[32:35]
    s_waitcnt lgkmcnt(1)
    v_readfirstlane_b32 s12, v1
    v_mfma_f32_16x16x32_bf16 v[84:87], v[216:219], v[0:3], 0
    s_waitcnt lgkmcnt(0)
    s_nop 1
    v_mfma_f32_16x16x32_bf16 v[84:87], v[216:219], v[64:67], v[84:87]
    s_lshr_b32 s12, s12, 23
    v_cvt_pk_bf16_f32 v0, v32, v33
    v_cvt_pk_bf16_f32 v1, v34, v35
    v_mfma_f32_16x16x32_bf16 v[32:35], a[96:99], v[68:71], 0
    s_nop 1
    v_mfma_f32_16x16x32_bf16 v[32:35], a[100:103], v[60:63], v[32:35]
    s_nop 0
    v_rsq_f32 v84, v84
    v_mfma_f32_16x16x32_bf16 v[32:35], a[104:107], v[98:101], v[32:35]
    v_rsq_f32 v85, v85
    v_mfma_f32_16x16x32_bf16 v[32:35], a[108:111], v[76:79], v[32:35]
    v_rsq_f32 v86, v86
    v_mfma_f32_16x16x32_bf16 v[32:35], a[112:115], v[92:95], v[32:35]
    v_mul_f32 v84, s43, v84
    v_mul_f32 v85, s43, v85
    v_mfma_f32_16x16x32_bf16 v[32:35], a[116:119], v[104:107], v[32:35]
    v_mul_f32 v86, s43, v86
    v_mul_f32 v140, v140, v85
    v_mfma_f32_16x16x32_bf16 v[40:43], v[68:71], a[168:171], 0
    s_nop 0
    v_mul_f32 v141, v141, v85
    v_cvt_pk_bf16_f32 v52, v140, v141
    v_mfma_f32_16x16x32_bf16 v[40:43], v[60:63], a[172:175], v[40:43]
    s_nop 0
    v_cvt_pk_f16_f32 v10, v32, v33
    v_cvt_pk_f16_f32 v11, v34, v35
    v_mfma_f32_16x16x32_bf16 v[40:43], v[98:101], a[176:179], v[40:43]
    v_mul_f32 v142, v142, v85
    v_mul_f32 v143, v143, v85
    v_mfma_f32_16x16x32_bf16 v[40:43], v[76:79], a[180:183], v[40:43]
    v_cvt_pk_bf16_f32 v53, v142, v143
    v_mul_f32 v44, v44, v85
    v_mfma_f32_16x16x32_bf16 v[40:43], v[92:95], a[184:187], v[40:43]
    ds_write_b32 v135, v52 offset:1536
    v_mfma_f32_16x16x32_bf16 v[40:43], v[104:107], a[188:191], v[40:43]
    v_mul_f32 v45, v45, v85
    v_cvt_pk_bf16_f32 v54, v44, v45
    v_mfma_f32_16x16x32_bf16 v[140:143], a[24:27], v[68:71], 0
    s_nop 0
    v_mul_f32 v46, v46, v85
    v_mul_f32 v47, v47, v85
    v_mfma_f32_16x16x32_bf16 v[140:143], a[28:31], v[60:63], v[140:143]
    s_nop 0
    v_cvt_pk_bf16_f32 v22, v40, v41
    v_cvt_pk_bf16_f32 v23, v42, v43
    v_mfma_f32_16x16x32_bf16 v[140:143], a[32:35], v[98:101], v[140:143]
    v_cvt_pk_bf16_f32 v55, v46, v47
    v_mul_f32 v56, v56, v85
    v_mfma_f32_16x16x32_bf16 v[140:143], a[36:39], v[76:79], v[140:143]
    ds_write_b64 v135, v[54:55] offset:1544
    v_mfma_f32_16x16x32_bf16 v[140:143], a[40:43], v[92:95], v[140:143]
    s_sub_u32 s50, s45, s44
    v_mul_f32 v57, v57, v85
    v_cvt_pk_bf16_f32 v38, v56, v57
    v_mfma_f32_16x16x32_bf16 v[140:143], a[44:47], v[104:107], v[140:143]
    s_sub_u32 s51, s46, s47
    v_mul_f32 v58, v58, v85
    v_mul_f32 v59, v59, v85
    v_mfma_f32_16x16x32_bf16 v[32:35], a[72:75], v[68:71], 0
    s_mov_b32 s60, s59
    v_cvt_pk_bf16_f32 v39, v58, v59
    v_mul_f32 v48, v48, v84
    v_mfma_f32_16x16x32_bf16 v[32:35], a[76:79], v[60:63], v[32:35]
    s_mov_b32 s59, s58
    ds_write_b32 v134, v39 offset:1540
    v_mfma_f32_16x16x32_bf16 v[32:35], a[80:83], v[98:101], v[32:35]
    s_mov_b32 s58, s57
    v_mul_f32 v49, v49, v84
    v_cvt_pk_bf16_f32 v64, v48, v49
    v_mfma_f32_16x16x32_bf16 v[32:35], a[84:87], v[76:79], v[32:35]
    s_mov_b32 s57, s56
    v_mul_f32 v50, v50, v84
    v_mul_f32 v51, v51, v84
    v_mfma_f32_16x16x32_bf16 v[32:35], a[88:91], v[92:95], v[32:35]
    s_mov_b32 s7, s6
    v_cvt_pk_bf16_f32 v65, v50, v51
    v_mul_f32 v80, v80, v84
    v_mfma_f32_16x16x32_bf16 v[32:35], a[92:95], v[104:107], v[32:35]
    s_mov_b32 s6, s5
    ds_write_b32 v135, v53 offset:1540
    v_mfma_f32_16x16x32_bf16 v[146:149], a[48:51], v[68:71], 0
    s_mov_b32 s5, s4
    v_mul_f32 v81, v81, v84
    v_cvt_pk_bf16_f32 v66, v80, v81
    v_mfma_f32_16x16x32_bf16 v[146:149], a[52:55], v[60:63], v[146:149]
    s_sub_u32 s14, s6, s7
    v_cvt_pk_f16_f32 v8, v32, v33
    v_cvt_pk_f16_f32 v9, v34, v35
    v_mfma_f32_16x16x32_bf16 v[146:149], a[56:59], v[98:101], v[146:149]
    s_add_u32 s61, s61, 1
    ds_read_b128 v[32:35], v137 offset:3328
    v_pk_fma_f16 v39, v8, v8, s3
    v_mfma_f32_16x16x32_bf16 v[146:149], a[60:63], v[76:79], v[146:149]
    s_add_u32 s12, s12, 20
    ds_read_b128 v[40:43], v137 offset:3200
    v_pk_fmac_f16 v39, v9, v9
    v_mfma_f32_16x16x32_bf16 v[146:149], a[64:67], v[92:95], v[146:149]
    s_max_u32 s12, s12, s61
    ds_read_b128 v[48:51], v136 offset:3200
    v_pk_fmac_f16 v39, v10, v10
    v_mfma_f32_16x16x32_bf16 v[146:149], a[68:71], v[104:107], v[146:149]
    s_cmp_lt_u32 s61, s71
    ds_read_b128 v[44:47], v136 offset:3328
    v_pk_fmac_f16 v39, v11, v11
    v_mfma_f32_16x16x32_bf16 v[108:111], a[120:123], v[68:71], 0
    s_cselect_b32 s15, s61, s12
    ds_read_b128 v[52:55], v136 offset:3072
    v_mul_f32 v82, v82, v84
    v_mfma_f32_16x16x32_bf16 v[108:111], a[124:127], v[60:63], v[108:111]
    s_cselect_b32 s56, s69, s70
    v_cvt_pk_f16_f32 v146, v146, v147
    v_cvt_pk_f16_f32 v147, v148, v149
    v_mfma_f32_16x16x32_bf16 v[108:111], a[128:131], v[98:101], v[108:111]
    s_add_u32 s56, s56, s15
    v_mul_f32 v83, v83, v84
    v_cvt_pk_bf16_f32 v67, v82, v83
    v_mfma_f32_16x16x32_bf16 v[108:111], a[132:135], v[76:79], v[108:111]
    s_mul_i32 s53, s56, 58255
    v_mul_f32 v116, v116, v84
    v_mul_f32 v117, v117, v84
    v_mfma_f32_16x16x32_bf16 v[108:111], a[136:139], v[92:95], v[108:111]
    s_lshr_b32 s53, s53, 22
    ds_write_b32 v134, v38 offset:1536
    v_mfma_f32_16x16x32_bf16 v[108:111], a[140:143], v[104:107], v[108:111]
    s_mul_i32 s53, s53, s63
    v_cvt_pk_bf16_f32 v2, v116, v117
    v_mul_f32 v118, v118, v84
    v_mfma_f32_16x16x32_bf16 v[80:83], a[0:3], v[68:71], 0
    s_mul_i32 s56, s56, s62
    v_mul_f32 v119, v119, v84
    v_cvt_pk_bf16_f32 v3, v118, v119
    v_mfma_f32_16x16x32_bf16 v[80:83], a[4:7], v[60:63], v[80:83]
    s_add_u32 s56, s56, s53
    v_cvt_pk_f16_f32 v148, v108, v109
    v_cvt_pk_f16_f32 v149, v110, v111
    v_mfma_f32_16x16x32_bf16 v[80:83], a[8:11], v[98:101], v[80:83]
    s_mul_i32 s4, s15, 112
    ds_write_b64 v135, v[64:65] offset:0
    v_mfma_f32_16x16x32_bf16 v[80:83], a[12:15], v[76:79], v[80:83]
    s_cmp_ge_u32 s15, 16
    v_pk_fmac_f16 v39, v148, v148
    v_pk_fmac_f16 v39, v149, v149
    v_mfma_f32_16x16x32_bf16 v[80:83], a[16:19], v[92:95], v[80:83]
    s_cselect_b32 s53, -30464, 0
    v_mul_f32 v24, v24, v86
    v_mul_f32 v25, v25, v86
    v_mfma_f32_16x16x32_bf16 v[80:83], a[20:23], v[104:107], v[80:83]
    s_add_u32 s4, s4, s53
    v_cvt_pk_bf16_f32 v116, v24, v25
    v_mul_f32 v26, v26, v86
    v_mfma_f32_16x16x32_bf16 v[108:111], v[68:71], a[144:147], 0
    s_cmp_lt_u32 s15, s73
    ds_write_b64 v135, v[66:67] offset:8
    v_mfma_f32_16x16x32_bf16 v[108:111], v[60:63], a[148:151], v[108:111]
    s_cselect_b32 s26, 100270464, 0
    v_cvt_pk_f16_f32 v24, v80, v81
    v_cvt_pk_f16_f32 v25, v82, v83
    v_mfma_f32_16x16x32_bf16 v[108:111], v[98:101], a[152:155], v[108:111]
    s_cselect_b32 s56, s56, 0
    v_pk_fma_f16 v38, v24, v24, s3
    v_pk_fmac_f16 v38, v25, v25
    v_mfma_f32_16x16x32_bf16 v[108:111], v[76:79], a[156:159], v[108:111]
    s_cselect_b32 s4, s4, -1
    ds_read_b128 v[64:67], v137 offset:3072
    v_mul_f32 v27, v27, v86
    v_mfma_f32_16x16x32_bf16 v[108:111], v[92:95], a[160:163], v[108:111]
    s_cselect_b32 s15, s15, 0
    v_cvt_pk_bf16_f32 v117, v26, v27
    v_mul_f32 v88, v88, v86
    v_mfma_f32_16x16x32_bf16 v[108:111], v[104:107], a[164:167], v[108:111]
    s_cselect_b32 s13, s13, -1
    v_mul_f32 v89, v89, v86
    v_cvt_pk_bf16_f32 v118, v88, v89
    v_mfma_f32_16x16x32_bf16 v[80:83], v[68:71], a[192:195], 0
    s_bitset1_b32 s64, s15
    v_mul_f32 v90, v90, v86
    v_mul_f32 v91, v91, v86
    v_mfma_f32_16x16x32_bf16 v[80:83], v[60:63], a[196:199], v[80:83]
    s_add_u32 s65, s65, 1
    ds_write_b64 v134, v[2:3] offset:0
    v_mfma_f32_16x16x32_bf16 v[80:83], v[98:101], a[200:203], v[80:83]
    s_cmp_ge_i32 s65, 2
    v_cvt_pk_bf16_f32 v119, v90, v91
    v_mul_f32 v72, v72, v86
    v_mfma_f32_16x16x32_bf16 v[80:83], v[76:79], a[204:207], v[80:83]
    s_cselect_b32 s30, 100270464, 0
    v_mul_f32 v73, v73, v86
    v_cvt_pk_bf16_f32 v72, v72, v73
    v_mfma_f32_16x16x32_bf16 v[80:83], v[92:95], a[208:211], v[80:83]
    s_add_u32 s67, s46, s54
    v_mul_f32 v74, v74, v86
    v_mul_f32 v75, v75, v86
    v_mfma_f32_16x16x32_bf16 v[80:83], v[104:107], a[212:215], v[80:83]
    s_waitcnt lgkmcnt(1)
    ds_write_b64 v135, v[116:117] offset:3072
    v_mfma_f32_16x16x32_bf16 v[60:63], a[72:75], v[64:67], 0
    s_add_u32 m0, s67, 0
    v_cvt_pk_bf16_f32 v73, v74, v75
    v_cvt_pk_bf16_f32 v2, v108, v109
    v_mfma_f32_16x16x32_bf16 v[60:63], a[76:79], v[52:55], v[60:63]
    v_cvt_pk_bf16_f32 v3, v110, v111
    v_cvt_pk_f16_f32 v26, v140, v141
    v_mfma_f32_16x16x32_bf16 v[60:63], a[80:83], v[40:43], v[60:63]
    v_cvt_pk_f16_f32 v27, v142, v143
    v_pk_fmac_f16 v38, v26, v26
    v_mfma_f32_16x16x32_bf16 v[60:63], a[84:87], v[48:51], v[60:63]
    ds_write_b32 v135, v118 offset:3080
    v_mfma_f32_16x16x32_bf16 v[60:63], a[88:91], v[32:35], v[60:63]
    v_pk_fmac_f16 v38, v27, v27
    v_pk_fmac_f16 v38, v146, v146
    v_mfma_f32_16x16x32_bf16 v[60:63], a[92:95], v[44:47], v[60:63]
    v_pk_fmac_f16 v38, v147, v147
    v_cvt_pk_bf16_f32 v6, v80, v81
    v_mfma_f32_16x16x32_bf16 v[98:101], a[120:123], v[64:67], 0
    v_cvt_pk_bf16_f32 v7, v82, v83
    v_add_u32 v137, s50, v137
    v_mfma_f32_16x16x32_bf16 v[98:101], a[124:127], v[52:55], v[98:101]
    ds_write_b32 v135, v119 offset:3084
    v_mfma_f32_16x16x32_bf16 v[98:101], a[128:131], v[40:43], v[98:101]
    v_cvt_pk_f16_f32 v56, v60, v61
    v_cvt_pk_f16_f32 v57, v62, v63
    v_mfma_f32_16x16x32_bf16 v[98:101], a[132:135], v[48:51], v[98:101]
    v_add_u32 v136, s50, v136
    v_add_u32 v135, s48, v135
    v_mfma_f32_16x16x32_bf16 v[98:101], a[136:139], v[32:35], v[98:101]
    v_add_u32 v133, s51, v133
    v_add_u32 v132, s14, v132
    v_mfma_f32_16x16x32_bf16 v[98:101], a[140:143], v[44:47], v[98:101]
    s_nop 0
    ds_write_b32 v134, v72 offset:3072
    v_mfma_f32_16x16x32_f16 v[76:79], v[212:215], v[36:39], 0
    s_nop 0
    v_pk_fma_f16 v37, v56, v56, s3
    v_pk_fmac_f16 v37, v57, v57
    v_mfma_f32_16x16x32_bf16 v[80:83], v[64:67], a[168:171], 0
    s_nop 0
    v_cvt_pk_f16_f32 v142, v98, v99
    v_cvt_pk_f16_f32 v143, v100, v101
    v_mfma_f32_16x16x32_bf16 v[80:83], v[52:55], a[172:175], v[80:83]
    v_or3_b32 v123, v123, v76, v77
    v_or3_b32 v123, v123, v78, v79
    v_mfma_f32_16x16x32_bf16 v[80:83], v[40:43], a[176:179], v[80:83]
    ds_write_b32 v134, v73 offset:3076
    v_mfma_f32_16x16x32_bf16 v[80:83], v[48:51], a[180:183], v[80:83]
    s_waitcnt vmcnt(0)
    v_rsq_f32 v76, v76
    v_mfma_f32_16x16x32_bf16 v[80:83], v[32:35], a[184:187], v[80:83]
    v_rsq_f32 v77, v77
    v_mfma_f32_16x16x32_bf16 v[80:83], v[44:47], a[188:191], v[80:83]
    v_mul_f32 v76, s52, v76
    v_cvt_pk_f16_f32 v76, v76, v77
    v_mfma_f32_16x16x32_bf16 v[98:101], v[64:67], a[144:147], 0
    v_rsq_f32 v78, v78
    v_mfma_f32_16x16x32_bf16 v[98:101], v[52:55], a[148:151], v[98:101]
    v_rsq_f32 v79, v79
    v_mfma_f32_16x16x32_bf16 v[98:101], v[40:43], a[152:155], v[98:101]
    v_mul_f32 v78, s52, v78
    v_cvt_pk_f16_f32 v78, v78, v79
    v_mfma_f32_16x16x32_bf16 v[98:101], v[48:51], a[156:159], v[98:101]
    v_pk_mul_f16 v8, v8, v78 op_sel:[0,1] op_sel_hi:[1,1]
    v_pk_mul_f16 v9, v9, v78 op_sel:[0,1] op_sel_hi:[1,1]
    v_mfma_f32_16x16x32_bf16 v[98:101], v[32:35], a[160:163], v[98:101]
    s_waitcnt lgkmcnt(0)
    v_pk_mul_f16 v10, v10, v78 op_sel:[0,1] op_sel_hi:[1,1]
    v_pk_mul_f16 v11, v11, v78 op_sel:[0,1] op_sel_hi:[1,1]
    v_mfma_f32_16x16x32_bf16 v[98:101], v[44:47], a[164:167], v[98:101]
    s_barrier
    v_pk_mul_f16 v148, v148, v78 op_sel:[0,1] op_sel_hi:[1,1]
    v_pk_mul_f16 v149, v149, v78 op_sel:[0,1] op_sel_hi:[1,1]
    v_mfma_f32_16x16x32_bf16 v[92:95], a[0:3], v[64:67], 0
    s_cmp_ge_u32 s61, s13
    v_pk_mul_f16 v12, v12, v76 op_sel:[0,1] op_sel_hi:[1,1]
    v_pk_mul_f16 v13, v13, v76 op_sel:[0,1] op_sel_hi:[1,1]
    v_mfma_f32_16x16x32_bf16 v[92:95], a[4:7], v[52:55], v[92:95]
L_pga:
    s_cbranch_scc1 L_atomF0
L_atomF0r:
    v_mfma_f32_16x16x32_bf16 v[92:95], a[8:11], v[40:43], v[92:95]
    ds_read_b128 v[60:63], v132 offset:16
    v_pk_mul_f16 v14, v14, v76 op_sel:[0,1] op_sel_hi:[1,1]
    v_mfma_f32_16x16x32_bf16 v[92:95], a[12:15], v[48:51], v[92:95]
    ds_read_b128 v[68:71], v132 offset:0
    v_pk_mul_f16 v15, v15, v76 op_sel:[0,1] op_sel_hi:[1,1]
    v_mfma_f32_16x16x32_bf16 v[92:95], a[16:19], v[32:35], v[92:95]
    v_pk_mul_f16 v154, v154, v76 op_sel:[0,1] op_sel_hi:[1,1]
    v_pk_mul_f16 v155, v155, v76 op_sel:[0,1] op_sel_hi:[1,1]
    v_mfma_f32_16x16x32_bf16 v[92:95], a[20:23], v[44:47], v[92:95]
    ds_read_b128 v[104:107], v133 offset:0
    v_pk_mul_f16 v28, v28, v76 op_sel:[0,0] op_sel_hi:[1,0]
    v_mfma_f32_16x16x32_bf16 v[116:119], a[48:51], v[64:67], 0
    v_pk_mul_f16 v29, v29, v76 op_sel:[0,0] op_sel_hi:[1,0]
    v_pk_mul_f16 v30, v30, v76 op_sel:[0,0] op_sel_hi:[1,0]
    v_mfma_f32_16x16x32_bf16 v[116:119], a[52:55], v[52:55], v[116:119]
    ds_read_b128 v[88:91], v133 offset:2048
    v_pk_mul_f16 v31, v31, v76 op_sel:[0,0] op_sel_hi:[1,0]
    v_mfma_f32_16x16x32_bf16 v[116:119], a[56:59], v[40:43], v[116:119]
    v_pk_mul_f16 v152, v152, v76 op_sel:[0,0] op_sel_hi:[1,0]
    v_pk_mul_f16 v153, v153, v76 op_sel:[0,0] op_sel_hi:[1,0]
    v_mfma_f32_16x16x32_bf16 v[116:119], a[60:63], v[48:51], v[116:119]
    ds_read_b128 v[72:75], v132 offset:48
    v_cvt_pk_f16_f32 v76, v92, v93
    v_mfma_f32_16x16x32_bf16 v[116:119], a[64:67], v[32:35], v[116:119]
    ds_read_b128 v[84:87], v137 offset:0
    v_cvt_pk_f16_f32 v77, v94, v95
    v_mfma_f32_16x16x32_bf16 v[116:119], a[68:71], v[44:47], v[116:119]
    v_pk_fma_f16 v36, v76, v76, s3
    v_pk_fmac_f16 v36, v77, v77
    v_mfma_f32_16x16x32_bf16 v[112:115], a[24:27], v[64:67], 0
    s_nop 0
    v_add_u32 v134, s48, v134
    v_add_u32 v131, s14, v131
    v_mfma_f32_16x16x32_bf16 v[112:115], a[28:31], v[52:55], v[112:115]
    s_nop 0
    v_cvt_pk_f16_f32 v140, v116, v117
    v_cvt_pk_f16_f32 v141, v118, v119
    v_mfma_f32_16x16x32_bf16 v[112:115], a[32:35], v[40:43], v[112:115]
    s_waitcnt lgkmcnt(3)
    buffer_load_dwordx4 v128, s[24:27], s56 offen nt lds
    v_pk_mul_f16 v24, v24, v78 op_sel:[0,0] op_sel_hi:[1,0]
    v_mfma_f32_16x16x32_bf16 v[112:115], a[36:39], v[48:51], v[112:115]
    ds_read_b128 v[92:95], v136 offset:128
    v_pk_mul_f16 v25, v25, v78 op_sel:[0,0] op_sel_hi:[1,0]
    v_mfma_f32_16x16x32_bf16 v[112:115], a[40:43], v[32:35], v[112:115]
    v_pk_mul_f16 v26, v26, v78 op_sel:[0,0] op_sel_hi:[1,0]
    v_pk_mul_f16 v27, v27, v78 op_sel:[0,0] op_sel_hi:[1,0]
    v_mfma_f32_16x16x32_bf16 v[112:115], a[44:47], v[44:47], v[112:115]
    v_pk_mul_f16 v146, v146, v78 op_sel:[0,0] op_sel_hi:[1,0]
    v_pk_mul_f16 v147, v147, v78 op_sel:[0,0] op_sel_hi:[1,0]
    v_mfma_f32_16x16x32_bf16 v[116:119], a[96:99], v[64:67], 0
    ds_read_b128 v[108:111], v133 offset:1024
    v_cvt_pk_bf16_f32 v164, v98, v99
    v_mfma_f32_16x16x32_bf16 v[116:119], a[100:103], v[52:55], v[116:119]
    s_nop 0
    ds_read_u16 v166, v131 offset:80
    v_cvt_pk_f16_f32 v78, v112, v113
    v_mfma_f32_16x16x32_bf16 v[116:119], a[104:107], v[40:43], v[116:119]
    ds_read_u16 v162, v131 offset:96
    v_cvt_pk_f16_f32 v79, v114, v115
    v_mfma_f32_16x16x32_bf16 v[116:119], a[108:111], v[48:51], v[116:119]
    ds_read_u16 v158, v131 offset:104
    v_pk_fmac_f16 v36, v78, v78
    v_mfma_f32_16x16x32_bf16 v[116:119], a[112:115], v[32:35], v[116:119]
    ds_read_b128 v[96:99], v137 offset:256
    v_pk_fmac_f16 v36, v79, v79
    v_mfma_f32_16x16x32_bf16 v[116:119], a[116:119], v[44:47], v[116:119]
    s_add_u32 m0, s67, 1024
    v_pk_fmac_f16 v36, v140, v140
    v_pk_fmac_f16 v36, v141, v141
    v_mfma_f32_16x16x32_bf16 v[112:115], v[64:67], a[192:195], 0
    ds_read_b128 v[64:67], v136 offset:0
    v_cvt_pk_bf16_f32 v165, v100, v101
    v_mfma_f32_16x16x32_bf16 v[112:115], v[52:55], a[196:199], v[112:115]
    ds_read_b128 v[52:55], v133 offset:3072
    v_cvt_pk_f16_f32 v58, v116, v117
    v_mfma_f32_16x16x32_bf16 v[112:115], v[40:43], a[200:203], v[112:115]
    ds_read_b128 v[40:43], v137 offset:128
    v_cvt_pk_f16_f32 v59, v118, v119
    v_mfma_f32_16x16x32_bf16 v[112:115], v[48:51], a[204:207], v[112:115]
    s_waitcnt lgkmcnt(7)
    buffer_store_dwordx4 v[104:107], v128, s[28:31], s60 offen sc1
    buffer_load_dwordx4 v127, s[24:27], s56 offen nt lds
    v_pk_fmac_f16 v37, v58, v58
    v_pk_fmac_f16 v37, v59, v59
    v_pk_fmac_f16 v37, v142, v142
    v_mfma_f32_16x16x32_bf16 v[112:115], v[32:35], a[208:211], v[112:115]
    v_pk_fmac_f16 v37, v143, v143
    v_cvt_pk_bf16_f32 v20, v16, v17
    v_mfma_f32_16x16x32_bf16 v[112:115], v[44:47], a[212:215], v[112:115]
    ds_read_b128 v[32:35], v136 offset:256
    v_cvt_pk_bf16_f32 v21, v18, v19
    v_mfma_f32_16x16x32_f16 v[16:19], v[212:215], v[36:39], 0
    s_nop 0
    v_cvt_pk_bf16_f32 v160, v80, v81
    v_cvt_pk_bf16_f32 v161, v82, v83
    v_mfma_f32_16x16x32_f16 v[36:39], v[8:11], v[28:31], v[200:203]
    s_nop 0
    v_cvt_pk_bf16_f32 v156, v112, v113
    v_cvt_pk_bf16_f32 v157, v114, v115
    v_mfma_f32_16x16x32_f16 v[36:39], v[146:149], v[150:153], v[36:39]
    s_add_u32 m0, s67, 2048
    v_or3_b32 v123, v123, v16, v17
    v_mfma_f32_16x16x32_bf16 v[48:51], a[216:219], v[84:87], 0
    s_waitcnt lgkmcnt(2)
    ds_read_b128 v[44:47], v133 offset:4096
    v_mfma_f32_16x16x32_bf16 v[48:51], a[220:223], v[64:67], v[48:51]
    s_waitcnt lgkmcnt(2)
    buffer_store_dwordx4 v[108:111], v127, s[28:31], s60 offen sc1
    buffer_load_dwordx4 v126, s[24:27], s56 offen nt lds
    v_rsq_f32 v16, v16
    v_mfma_f32_16x16x32_bf16 v[48:51], a[224:227], v[40:43], v[48:51]
    v_rsq_f32 v17, v17
    v_mfma_f32_16x16x32_bf16 v[48:51], a[228:231], v[92:95], v[48:51]
    v_exp_f32 v36, v36
    v_mfma_f32_16x16x32_bf16 v[48:51], a[232:235], v[96:99], v[48:51]
    s_waitcnt lgkmcnt(1)
    v_exp_f32 v37, v37
    v_mfma_f32_16x16x32_bf16 v[48:51], a[236:239], v[32:35], v[48:51]
    v_mul_f32 v16, s52, v16
    v_cvt_pk_f16_f32 v16, v16, v17
    v_mfma_f32_16x16x32_bf16 v[80:83], a[240:243], v[84:87], 0
    v_pk_mul_f16 v76, v76, v16 op_sel:[0,0] op_sel_hi:[1,0]
    v_pk_mul_f16 v77, v77, v16 op_sel:[0,0] op_sel_hi:[1,0]
    v_mfma_f32_16x16x32_bf16 v[80:83], a[244:247], v[64:67], v[80:83]
    v_pk_mul_f16 v78, v78, v16 op_sel:[0,0] op_sel_hi:[1,0]
    v_pk_mul_f16 v79, v79, v16 op_sel:[0,0] op_sel_hi:[1,0]
    v_mfma_f32_16x16x32_bf16 v[80:83], a[248:251], v[40:43], v[80:83]
    v_pk_mul_f16 v140, v140, v16 op_sel:[0,0] op_sel_hi:[1,0]
    v_pk_mul_f16 v141, v141, v16 op_sel:[0,0] op_sel_hi:[1,0]
    v_mfma_f32_16x16x32_bf16 v[80:83], a[252:255], v[92:95], v[80:83]
    v_pk_mul_f16 v56, v56, v16 op_sel:[0,1] op_sel_hi:[1,1]
    v_pk_mul_f16 v57, v57, v16 op_sel:[0,1] op_sel_hi:[1,1]
    v_mfma_f32_16x16x32_bf16 v[80:83], v[224:227], v[96:99], v[80:83]
    v_pk_mul_f16 v58, v58, v16 op_sel:[0,1] op_sel_hi:[1,1]
    v_pk_mul_f16 v59, v59, v16 op_sel:[0,1] op_sel_hi:[1,1]
    v_mfma_f32_16x16x32_bf16 v[80:83], v[228:231], v[32:35], v[80:83]
    s_add_u32 m0, s67, 3072
    buffer_store_dwordx4 v[88:91], v126, s[28:31], s60 offen sc1
    v_pk_mul_f16 v142, v142, v16 op_sel:[0,1] op_sel_hi:[1,1]
    v_pk_mul_f16 v143, v143, v16 op_sel:[0,1] op_sel_hi:[1,1]
    v_exp_f32 v38, v38
    v_mfma_f32_16x16x32_f16 v[16:19], v[68:71], v[28:31], v[208:211]
    v_exp_f32 v39, v39
    v_mfma_f32_16x16x32_f16 v[16:19], v[60:63], v[12:15], v[16:19]
    v_cvt_pk_bf16_f32 v36, v36, v37
    v_cvt_pk_bf16_f32 v37, v38, v39
    v_mfma_f32_16x16x32_f16 v[16:19], v[72:75], v[152:155], v[16:19]
    s_nop 0
    buffer_load_dwordx4 v125, s[24:27], s56 offen nt lds
    v_mfma_f32_16x16x32_f16 v[104:107], v[56:59], v[28:31], v[196:199]
    s_add_u32 m0, s67, 4096
    s_nop 1
    v_mfma_f32_16x16x32_f16 v[104:107], v[140:143], v[150:153], v[104:107]
    s_nop 0
    v_exp_f32 v16, v16
    v_mfma_f32_16x16x32_f16 v[88:91], v[12:15], v[28:31], v[204:207]
    s_nop 0
    v_cvt_pk_bf16_f32 v170, v16, 0
    s_nop 0
    v_mfma_f32_16x16x32_f16 v[88:91], v[152:155], v[150:153], v[88:91]
    s_nop 0
    v_exp_f32 v104, v104
    v_mfma_f32_16x16x32_bf16 v[116:119], v[232:235], v[84:87], 0
    s_waitcnt lgkmcnt(0)
    buffer_store_dwordx4 v[52:55], v125, s[28:31], s60 offen sc1
    buffer_load_dwordx4 v124, s[24:27], s56 offen nt lds
    v_exp_f32 v105, v105
    v_mfma_f32_16x16x32_bf16 v[116:119], v[236:239], v[64:67], v[116:119]
    v_exp_f32 v88, v88
    v_mfma_f32_16x16x32_bf16 v[116:119], v[240:243], v[40:43], v[116:119]
    v_exp_f32 v89, v89
    v_mfma_f32_16x16x32_bf16 v[116:119], v[244:247], v[92:95], v[116:119]
    v_exp_f32 v90, v90
    v_mfma_f32_16x16x32_bf16 v[116:119], v[248:251], v[96:99], v[116:119]
    v_exp_f32 v91, v91
    v_mfma_f32_16x16x32_bf16 v[116:119], v[252:255], v[32:35], v[116:119]
    v_cvt_pk_bf16_f32 v34, v88, v89
    v_cvt_pk_bf16_f32 v35, v90, v91
    v_mfma_f32_16x16x32_f16 v[28:31], v[56:59], v[24:27], v[184:187]
    v_exp_f32 v106, v106
    v_mfma_f32_16x16x32_f16 v[28:31], v[140:143], v[144:147], v[28:31]
    v_exp_f32 v107, v107
    v_mfma_f32_16x16x32_f16 v[40:43], v[56:59], v[76:79], v[172:175]
    buffer_store_dwordx4 v[44:47], v124, s[28:31], s60 offen sc1
    v_cvt_pk_bf16_f32 v168, v104, v105
    v_cvt_pk_bf16_f32 v169, v106, v107
    s_nop 0
    v_mfma_f32_16x16x32_f16 v[40:43], v[140:143], v[138:141], v[40:43]
    s_mov_b32 s53, s47
    v_exp_f32 v28, v28
    v_mfma_f32_16x16x32_f16 v[44:47], v[12:15], v[24:27], v[192:195]
    s_mov_b32 s47, s46
    v_exp_f32 v29, v29
    v_mfma_f32_16x16x32_f16 v[44:47], v[152:155], v[144:147], v[44:47]
    s_mov_b32 s46, s45
    v_exp_f32 v30, v30
    v_mfma_f32_16x16x32_f16 v[52:55], v[68:71], v[76:79], v[208:211]
    s_mov_b32 s45, s44
    v_exp_f32 v31, v31
    v_mfma_f32_16x16x32_f16 v[52:55], v[60:63], v[56:59], v[52:55]
    s_mov_b32 s44, s53
    v_exp_f32 v40, v40
    v_mfma_f32_16x16x32_f16 v[52:55], v[72:75], v[140:143], v[52:55]
    s_sub_u32 s48, s44, s46
    v_exp_f32 v44, v44
    v_mfma_f32_16x16x32_f16 v[64:67], v[68:71], v[24:27], v[208:211]
    s_sub_u32 s49, s46, s45
    v_exp_f32 v45, v45
    v_mfma_f32_16x16x32_f16 v[64:67], v[60:63], v[8:11], v[64:67]
    s_cmp_lg_u32 s5, -1
    v_exp_f32 v46, v46
    v_mfma_f32_16x16x32_f16 v[64:67], v[72:75], v[146:149], v[64:67]
    ds_read_b128 v[60:63], v136 offset:1536
    v_cvt_pk_bf16_f32 v16, v44, v45
    v_mfma_f32_16x16x32_bf16 v[98:101], v[220:223], v[34:37], 0
    ds_read_b128 v[68:71], v137 offset:1664
    v_fma_f32 v32, v48, v48, s42
    v_mfma_f32_16x16x32_bf16 v[98:101], v[220:223], v[168:171], v[98:101]
    s_nop 0
    ds_read_b128 v[88:91], v137 offset:1536
    v_mov_b32_dpp v19, v67 quad_perm:[0,1,2,3] row_mask:0x2 bank_mask:0xf
    v_mfma_f32_16x16x32_bf16 v[104:107], v[0:3], v[34:37], 0
    ds_read_b128 v[72:75], v136 offset:1664
    v_mov_b32_dpp v19, v55 quad_perm:[0,1,2,3] row_mask:0x4 bank_mask:0xf
    v_mfma_f32_16x16x32_bf16 v[104:107], v[164:167], v[168:171], v[104:107]
    ds_read_b128 v[84:87], v136 offset:1792
    v_fmac_f32 v32, v49, v49
    v_mfma_f32_16x16x32_bf16 v[92:95], v[20:23], v[34:37], 0
    v_exp_f32 v47, v47
    v_mfma_f32_16x16x32_bf16 v[92:95], v[160:163], v[168:171], v[92:95]
    v_cvt_pk_bf16_f32 v17, v46, v47
    v_fmac_f32 v32, v50, v50
    v_mfma_f32_16x16x32_bf16 v[44:47], v[4:7], v[34:37], 0
    ds_read_b128 v[36:39], v137 offset:1792
    v_fmac_f32 v32, v51, v51
    v_mfma_f32_16x16x32_bf16 v[44:47], v[156:159], v[168:171], v[44:47]
    v_exp_f32 v65, v65
    v_mfma_f32_16x16x32_f16 v[108:111], v[12:15], v[76:79], v[180:183]
    v_exp_f32 v19, v19
    v_mfma_f32_16x16x32_f16 v[108:111], v[152:155], v[138:141], v[108:111]
    v_cvt_pk_bf16_f32 v19, v19, v19
    v_cvt_pk_bf16_f32 v168, v28, v29
    v_mfma_f32_16x16x32_f16 v[152:155], v[8:11], v[76:79], v[176:179]
    ds_write_b16 v131, v19 offset:64
    v_mfma_f32_16x16x32_f16 v[152:155], v[146:149], v[138:141], v[152:155]
    s_waitcnt lgkmcnt(3)
    v_rcp_f32 v98, v98
    v_mfma_f32_16x16x32_bf16 v[140:143], a[216:219], v[88:91], 0
    v_mul_f32 v104, v104, v98
    v_mul_f32 v105, v105, v98
    v_mfma_f32_16x16x32_bf16 v[140:143], a[220:223], v[60:63], v[140:143]
    ds_read_b128 v[12:15], v132 offset:48
    v_cvt_pk_bf16_f32 v104, v104, v105
    v_mfma_f32_16x16x32_bf16 v[140:143], a[224:227], v[68:71], v[140:143]
    ds_read_b128 v[76:79], v132 offset:64
    v_mul_f32 v106, v106, v98
    v_mfma_f32_16x16x32_bf16 v[140:143], a[228:231], v[72:75], v[140:143]
    s_waitcnt lgkmcnt(3)
    v_mul_f32 v107, v107, v98
    v_cvt_pk_bf16_f32 v105, v106, v107
    v_mfma_f32_16x16x32_bf16 v[140:143], a[232:235], v[36:39], v[140:143]
    v_mul_f32 v92, v92, v98
    v_mul_f32 v93, v93, v98
    v_mfma_f32_16x16x32_bf16 v[140:143], a[236:239], v[84:87], v[140:143]
    v_cvt_pk_bf16_f32 v106, v92, v93
    v_mul_f32 v94, v94, v98
    v_mfma_f32_16x16x32_bf16 v[56:59], v[232:235], v[88:91], 0
    ds_write_b64 v135, v[104:105] offset:0
    v_mfma_f32_16x16x32_bf16 v[56:59], v[236:239], v[60:63], v[56:59]
    v_mul_f32 v95, v95, v98
    v_cvt_pk_bf16_f32 v107, v94, v95
    v_mfma_f32_16x16x32_bf16 v[56:59], v[240:243], v[68:71], v[56:59]
    v_mul_f32 v44, v44, v98
    v_mul_f32 v45, v45, v98
    v_mfma_f32_16x16x32_bf16 v[56:59], v[244:247], v[72:75], v[56:59]
    ds_read_b128 v[92:95], v137 offset:3200
    v_cvt_pk_bf16_f32 v18, v44, v45
    v_mfma_f32_16x16x32_bf16 v[56:59], v[248:251], v[36:39], v[56:59]
    v_mul_f32 v46, v46, v98
    v_mul_f32 v47, v47, v98
    v_mfma_f32_16x16x32_bf16 v[56:59], v[252:255], v[84:87], v[56:59]
    s_waitcnt lgkmcnt(2)
    v_cvt_pk_bf16_f32 v19, v46, v47
    v_cvt_pk_bf16_f32 v169, v30, v31
    v_mfma_f32_16x16x32_bf16 v[28:31], v[12:15], v[0:3], 0
    v_cvt_pk_bf16_f32 v170, v65, 0
    v_fmac_f32 v32, v80, v80
    v_mfma_f32_16x16x32_bf16 v[28:31], v[76:79], v[164:167], v[28:31]
    ds_write_b64 v135, v[106:107] offset:8
    v_mfma_f32_16x16x32_bf16 v[44:47], v[12:15], v[20:23], 0
    v_exp_f32 v41, v41
    v_mfma_f32_16x16x32_bf16 v[44:47], v[76:79], v[160:163], v[44:47]
    v_exp_f32 v42, v42
    v_mfma_f32_16x16x32_bf16 v[64:67], v[12:15], v[4:7], 0
    s_nop 0
    ds_read_b128 v[12:15], v137 offset:3072
    v_fmac_f32 v32, v81, v81
    v_mfma_f32_16x16x32_bf16 v[64:67], v[76:79], v[156:159], v[64:67]
    s_nop 0
    ds_read_b128 v[98:101], v136 offset:3072
    v_mov_b32_dpp v31, v47 quad_perm:[0,1,2,3] row_mask:0x2 bank_mask:0xf
    v_mfma_f32_16x16x32_bf16 v[44:47], a[240:243], v[88:91], 0
    ds_read_b128 v[104:107], v136 offset:3200
    v_fmac_f32 v32, v82, v82
    v_mfma_f32_16x16x32_bf16 v[44:47], a[244:247], v[60:63], v[44:47]
    s_nop 0
    ds_read_b128 v[62:65], v137 offset:3328
    v_mov_b32_dpp v31, v67 quad_perm:[0,1,2,3] row_mask:0x4 bank_mask:0xf
    v_mfma_f32_16x16x32_bf16 v[44:47], a[248:251], v[68:71], v[44:47]
    ds_read_b128 v[66:69], v136 offset:3328
    v_cvt_pk_bf16_f32 v31, v31, v31
    v_mfma_f32_16x16x32_bf16 v[44:47], a[252:255], v[72:75], v[44:47]
    v_exp_f32 v43, v43
    v_mfma_f32_16x16x32_bf16 v[44:47], v[224:227], v[36:39], v[44:47]
    v_exp_f32 v54, v54
    v_mfma_f32_16x16x32_bf16 v[44:47], v[228:231], v[84:87], v[44:47]
    v_exp_f32 v152, v152
    v_mfma_f32_16x16x32_f16 v[36:39], v[8:11], v[24:27], v[188:191]
    ds_write_b16 v131, v31
    v_mfma_f32_16x16x32_f16 v[36:39], v[146:149], v[144:147], v[36:39]
    s_waitcnt lgkmcnt(5)
    v_exp_f32 v153, v153
    v_mfma_f32_16x16x32_bf16 v[88:91], a[240:243], v[12:15], 0
    s_waitcnt lgkmcnt(4)
    v_exp_f32 v154, v154
    v_mfma_f32_16x16x32_bf16 v[88:91], a[244:247], v[98:101], v[88:91]
    v_exp_f32 v155, v155
    v_mfma_f32_16x16x32_bf16 v[88:91], a[248:251], v[92:95], v[88:91]
    s_waitcnt lgkmcnt(2)
    ds_write_b32 v134, v18 offset:0
    v_mfma_f32_16x16x32_bf16 v[88:91], a[252:255], v[104:107], v[88:91]
    v_cvt_pk_bf16_f32 v30, v152, v153
    v_cvt_pk_bf16_f32 v31, v154, v155
    v_mfma_f32_16x16x32_bf16 v[88:91], v[224:227], v[62:65], v[88:91]
    s_waitcnt lgkmcnt(2)
    v_exp_f32 v36, v36
    v_mfma_f32_16x16x32_bf16 v[88:91], v[228:231], v[66:69], v[88:91]
    v_exp_f32 v37, v37
    v_mfma_f32_16x16x32_bf16 v[24:27], a[216:219], v[12:15], 0
    ds_write_b32 v134, v19 offset:4
    v_mfma_f32_16x16x32_bf16 v[24:27], a[220:223], v[98:101], v[24:27]
    v_exp_f32 v38, v38
    v_mfma_f32_16x16x32_bf16 v[24:27], a[224:227], v[92:95], v[24:27]
    v_exp_f32 v39, v39
    v_mfma_f32_16x16x32_bf16 v[24:27], a[228:231], v[104:107], v[24:27]
    v_cvt_pk_bf16_f32 v18, v36, v37
    v_cvt_pk_bf16_f32 v19, v38, v39
    v_mfma_f32_16x16x32_bf16 v[24:27], a[232:235], v[62:65], v[24:27]
    v_exp_f32 v108, v108
    v_mfma_f32_16x16x32_bf16 v[24:27], a[236:239], v[66:69], v[24:27]
    v_exp_f32 v109, v109
    v_mfma_f32_16x16x32_bf16 v[152:155], v[220:223], v[16:19], 0
    v_exp_f32 v110, v110
    v_mfma_f32_16x16x32_bf16 v[152:155], v[220:223], v[168:171], v[152:155]
    s_nop 0
    v_exp_f32 v111, v111
    v_mfma_f32_16x16x32_bf16 v[36:39], v[0:3], v[16:19], 0
    s_nop 0
    v_cvt_pk_bf16_f32 v28, v108, v109
    v_cvt_pk_bf16_f32 v29, v110, v111
    v_mfma_f32_16x16x32_bf16 v[36:39], v[164:167], v[168:171], v[36:39]
    s_nop 0
    v_rcp_f32 v152, v152
    v_mfma_f32_16x16x32_bf16 v[146:149], v[20:23], v[16:19], 0
    v_add_u32 v137, s48, v137
    v_add_u32 v136, s48, v136
    v_mfma_f32_16x16x32_bf16 v[146:149], v[160:163], v[168:171], v[146:149]
    s_nop 0
    ds_read_b128 v[84:87], v137 offset:0
    v_mul_f32 v36, v36, v152
    v_mfma_f32_16x16x32_bf16 v[76:79], v[4:7], v[16:19], 0
    ds_read_b128 v[108:111], v136 offset:0
    v_mul_f32 v37, v37, v152
    v_mfma_f32_16x16x32_bf16 v[76:79], v[156:159], v[168:171], v[76:79]
    ds_read_b128 v[8:11], v137 offset:128
    v_cvt_pk_bf16_f32 v168, v40, v41
    v_mfma_f32_16x16x32_bf16 v[72:75], v[232:235], v[12:15], 0
    ds_read_b128 v[112:115], v136 offset:128
    v_cvt_pk_bf16_f32 v169, v42, v43
    v_mfma_f32_16x16x32_bf16 v[72:75], v[236:239], v[98:101], v[72:75]
    ds_read_b128 v[40:43], v137 offset:256
    v_cvt_pk_bf16_f32 v170, v54, 0
    v_mfma_f32_16x16x32_bf16 v[72:75], v[240:243], v[92:95], v[72:75]
    ds_read_b128 v[52:55], v136 offset:256
    v_cvt_pk_bf16_f32 v12, v36, v37
    v_mfma_f32_16x16x32_bf16 v[72:75], v[244:247], v[104:107], v[72:75]
    ds_read_b128 v[104:107], v136 offset:1792
    v_mul_f32 v38, v38, v152
    v_mfma_f32_16x16x32_bf16 v[72:75], v[248:251], v[62:65], v[72:75]
    ds_read_b128 v[60:63], v136 offset:1536
    v_mul_f32 v39, v39, v152
    v_mfma_f32_16x16x32_bf16 v[72:75], v[252:255], v[66:69], v[72:75]
    ds_read_b128 v[98:101], v137 offset:1664
    v_cvt_pk_bf16_f32 v13, v38, v39
    v_mfma_f32_16x16x32_bf16 v[36:39], v[220:223], v[28:31], 0
    ds_read_b128 v[68:71], v137 offset:1536
    v_mul_f32 v146, v146, v152
    v_mfma_f32_16x16x32_bf16 v[36:39], v[220:223], v[168:171], v[36:39]
    v_mul_f32 v147, v147, v152
    v_cvt_pk_bf16_f32 v14, v146, v147
    v_mfma_f32_16x16x32_bf16 v[64:67], v[0:3], v[28:31], 0
    v_mul_f32 v148, v148, v152
    v_mul_f32 v149, v149, v152
    v_mfma_f32_16x16x32_bf16 v[64:67], v[164:167], v[168:171], v[64:67]
    v_cvt_pk_bf16_f32 v15, v148, v149
    v_mul_f32 v76, v76, v152
    v_mfma_f32_16x16x32_bf16 v[0:3], v[20:23], v[28:31], 0
    ds_write_b32 v135, v12 offset:1536
    v_mfma_f32_16x16x32_bf16 v[0:3], v[160:163], v[168:171], v[0:3]
    v_mul_f32 v77, v77, v152
    v_cvt_pk_bf16_f32 v154, v76, v77
    v_mfma_f32_16x16x32_bf16 v[146:149], v[4:7], v[28:31], 0
    v_mul_f32 v78, v78, v152
    v_mul_f32 v79, v79, v152
    v_mfma_f32_16x16x32_bf16 v[146:149], v[156:159], v[168:171], v[146:149]
    s_waitcnt lgkmcnt(3)
    v_cvt_pk_bf16_f32 v155, v78, v79
    v_fmac_f32 v32, v83, v83
    v_mfma_f32_16x16x32_bf16 v[28:31], a[0:3], v[84:87], 0
    s_cbranch_scc1 L_loopF0
    ds_write_b32 v135, v13 offset:1540
    v_rcp_f32 v36, v36
    s_mov_b32 s30, 100270464
    s_mul_i32 s89, s68, 7168
    ds_write_b64 v135, v[14:15] offset:1544
    v_mul_f32 v64, v64, v36
    v_mul_f32 v65, v65, v36
    v_cvt_pk_bf16_f32 v4, v64, v65
    s_add_u32 s89, s89, 135168
    s_movk_i32 s90, 112
    ds_write_b64 v134, v[154:155] offset:1536
    v_mul_f32 v66, v66, v36
    v_mul_f32 v67, v67, v36
    v_cvt_pk_bf16_f32 v5, v66, v67
    v_mul_f32 v0, v0, v36
    v_mul_f32 v1, v1, v36
    v_cvt_pk_bf16_f32 v6, v0, v1
    v_mul_f32 v2, v2, v36
    v_mul_f32 v3, v3, v36
    v_cvt_pk_bf16_f32 v7, v2, v3
    v_mul_f32 v146, v146, v36
    v_mul_f32 v147, v147, v36
    v_cvt_pk_bf16_f32 v120, v146, v147
    v_mul_f32 v148, v148, v36
    v_mul_f32 v149, v149, v36
    v_cvt_pk_bf16_f32 v121, v148, v149
    s_lshr_b32 s91, s64, 16
    s_lshl_b32 s92, s68, 10
    ds_write_b64 v135, v[4:5] offset:3072
    v_fmac_f32 v32, v116, v116
    s_sub_u32 s84, s45, s44
    s_sub_u32 s85, s46, s45
    ds_write_b64 v135, v[6:7] offset:3080
    v_fmac_f32 v32, v117, v117
    v_fmac_f32 v32, v118, v118
    v_fmac_f32 v32, v119, v119
    s_sub_u32 s86, s44, s45
    s_sub_u32 s93, s44, s47
    ds_write_b32 v134, v120 offset:3072
    ds_write_b32 v134, v121 offset:3076
    v_fma_f32 v131, v140, v140, s42
    v_fmac_f32 v131, v141, v141
    v_fmac_f32 v131, v142, v142
    v_fmac_f32 v131, v143, v143
    v_fmac_f32 v131, v44, v44
    v_fmac_f32 v131, v45, v45
    v_fmac_f32 v131, v46, v46
    v_fmac_f32 v131, v47, v47
    v_fmac_f32 v131, v56, v56
    v_fmac_f32 v131, v57, v57
    v_fmac_f32 v131, v58, v58
    v_fmac_f32 v131, v59, v59
    v_fma_f32 v121, v24, v24, s42
    v_fmac_f32 v121, v25, v25
    v_fmac_f32 v121, v26, v26
    v_fmac_f32 v121, v27, v27
    v_fmac_f32 v121, v88, v88
    v_fmac_f32 v121, v89, v89
    v_fmac_f32 v121, v90, v90
    v_fmac_f32 v121, v91, v91
    v_fmac_f32 v121, v72, v72
    v_fmac_f32 v121, v73, v73
    v_fmac_f32 v121, v74, v74
    v_fmac_f32 v121, v75, v75
    v_cvt_pk_bf16_f32 v120, v32, v131
    v_cvt_pk_bf16_f32 v121, v121, v122
    s_sub_u32 s94, s45, s47
    s_sub_u32 s95, s46, s47
    ds_write_b64 v130, v[120:121]
    v_mbcnt_lo_u32_b32 v131, -1, 0
    v_mbcnt_hi_u32_b32 v131, -1, v131
    v_and_b32 v138, 15, v131
    v_lshrrev_b32 v131, 4, v131
    v_mul_u32_u24 v131, 1792, v131
    v_add_u32 v131, s89, v131
    v_mad_u32_u24 v132, v138, s90, v131
    v_lshrrev_b32 v139, v138, s64
    v_and_b32 v139, 1, v139
    v_cmp_eq_u32 vcc, 1, v139
    v_mad_u32_u24 v52, v138, s90, v131
    v_lshrrev_b32 v138, v138, s91
    v_cndmask_b32 v132, v131, v132, vcc
    v_and_b32 v138, 1, v138
    v_subrev_u32 v52, 28672, v52
    v_cmp_eq_u32 vcc, 1, v138
    ds_read_b128 v[20:23], v132 offset:64
    ds_read_b128 v[16:19], v132 offset:80
    v_cndmask_b32 v52, v131, v52, vcc
    v_add_u32 v131, s92, v129
    s_waitcnt lgkmcnt(2)
    s_barrier
    ds_read_b128 v[98:101], v132
    v_add_u32 v54, s84, v137
    ds_read_b64 v[102:103], v132 offset:16
    ds_read_b128 v[4:7], v131 offset:6144
    v_add_u32 v53, s84, v136
    v_add_u32 v120, s85, v135
    ds_read_b128 v[8:11], v129 offset:0
    v_add_u32 v55, s85, v134
    ds_read_b128 v[0:3], v129 offset:1024
    v_add_u32 v138, s86, v135
    v_add_u32 v132, s86, v134
    v_add_u32 v131, s93, v133
    v_add_u32 v139, s94, v133
    s_waitcnt lgkmcnt(6)
    v_mfma_f32_16x16x32_bf16 v[12:15], v[220:223], v[20:23], 0
    s_waitcnt lgkmcnt(5)
    ds_read_b128 v[92:95], v54 offset:1536
    ds_read_b128 v[68:71], v53 offset:1536
    v_mfma_f32_16x16x32_bf16 v[12:15], v[220:223], v[16:19], v[12:15]
    s_waitcnt lgkmcnt(3)
    ds_read_b128 v[64:67], v54 offset:1664
    v_lshlrev_b32 v76, 16, v98
    v_and_b32 v98, 0xffff0000, v98
    v_lshlrev_b32 v77, 16, v99
    v_and_b32 v99, 0xffff0000, v99
    v_lshlrev_b32 v78, 16, v100
    v_and_b32 v100, 0xffff0000, v100
    v_rcp_f32 v12, v12
    v_lshlrev_b32 v79, 16, v101
    v_mfma_f32_16x16x32_bf16 v[16:19], v[216:219], v[8:11], 0
    s_waitcnt lgkmcnt(3)
    ds_read_b128 v[60:63], v53 offset:1664
    ds_read_b128 v[40:43], v54 offset:1792
    v_mfma_f32_16x16x32_bf16 v[16:19], v[216:219], v[0:3], v[16:19]
    s_waitcnt lgkmcnt(4)
    ds_read_b128 v[28:31], v53 offset:1792
    v_mul_f32 v76, v76, v12
    v_mul_f32 v98, v98, v12
    v_cvt_pk_bf16_f32 v76, v76, v98
    v_mul_f32 v77, v77, v12
    v_mfma_f32_16x16x32_bf16 v[8:11], a[216:219], v[92:95], 0
    s_waitcnt lgkmcnt(4)
    v_mul_f32 v99, v99, v12
    v_cvt_pk_bf16_f32 v77, v77, v99
    v_mfma_f32_16x16x32_bf16 v[8:11], a[220:223], v[68:71], v[8:11]
    s_waitcnt lgkmcnt(3)
    ds_read_b128 v[108:111], v54 offset:0
    ds_read_b128 v[96:99], v53 offset:0
    v_mfma_f32_16x16x32_bf16 v[8:11], a[224:227], v[64:67], v[8:11]
    s_waitcnt lgkmcnt(4)
    ds_read_b128 v[84:87], v54 offset:128
    v_mul_f32 v78, v78, v12
    v_mul_f32 v100, v100, v12
    v_cvt_pk_bf16_f32 v78, v78, v100
    v_and_b32 v101, 0xffff0000, v101
    v_mul_f32 v79, v79, v12
    v_mfma_f32_16x16x32_bf16 v[8:11], a[228:231], v[60:63], v[8:11]
    s_waitcnt lgkmcnt(4)
    ds_read_b128 v[36:39], v53 offset:128
    ds_read_b128 v[20:23], v54 offset:256
    v_mfma_f32_16x16x32_bf16 v[8:11], a[232:235], v[40:43], v[8:11]
    s_waitcnt lgkmcnt(5)
    ds_read_b128 v[0:3], v53 offset:256
    v_mul_f32 v101, v101, v12
    v_mfma_f32_16x16x32_bf16 v[8:11], a[236:239], v[28:31], v[8:11]
    v_cvt_pk_bf16_f32 v79, v79, v101
    v_lshlrev_b32 v19, 16, v102
    v_mfma_f32_16x16x32_bf16 v[32:35], a[240:243], v[92:95], 0
    ds_write_b128 v138, v[76:79] offset:0
    v_mfma_f32_16x16x32_bf16 v[32:35], a[244:247], v[68:71], v[32:35]
    v_and_b32 v102, 0xffff0000, v102
    v_mul_f32 v19, v19, v12
    v_mfma_f32_16x16x32_bf16 v[32:35], a[248:251], v[64:67], v[32:35]
    v_mul_f32 v102, v102, v12
    v_cvt_pk_bf16_f32 v76, v19, v102
    v_mfma_f32_16x16x32_bf16 v[32:35], a[252:255], v[60:63], v[32:35]
    v_lshlrev_b32 v19, 16, v103
    v_and_b32 v103, 0xffff0000, v103
    v_mfma_f32_16x16x32_bf16 v[32:35], v[224:227], v[40:43], v[32:35]
    v_mul_f32 v19, v19, v12
    v_mul_f32 v103, v103, v12
    v_mfma_f32_16x16x32_bf16 v[32:35], v[228:231], v[28:31], v[32:35]
    v_cvt_pk_bf16_f32 v77, v19, v103
    v_lshrrev_b32 v19, 0, v7
    v_mfma_f32_16x16x32_bf16 v[12:15], v[232:235], v[92:95], 0
    ds_write_b64 v132, v[76:77] offset:0
    v_mfma_f32_16x16x32_bf16 v[12:15], v[236:239], v[68:71], v[12:15]
    v_lshrrev_b32 v19, v19, s64
    v_and_b32 v19, 1, v19
    v_mfma_f32_16x16x32_bf16 v[12:15], v[240:243], v[64:67], v[12:15]
    v_cmp_eq_u32 vcc, 1, v19
    v_lshrrev_b32 v19, 8, v7
    v_mfma_f32_16x16x32_bf16 v[12:15], v[244:247], v[60:63], v[12:15]
    v_cndmask_b32 v4, 2.0, v4, vcc
    v_lshrrev_b32 v19, v19, s64
    v_mfma_f32_16x16x32_bf16 v[12:15], v[248:251], v[40:43], v[12:15]
    v_and_b32 v19, 1, v19
    v_cmp_eq_u32 vcc, 1, v19
    v_mfma_f32_16x16x32_bf16 v[12:15], v[252:255], v[28:31], v[12:15]
    s_waitcnt lgkmcnt(1)
    v_cndmask_b32 v5, 2.0, v5, vcc
    v_lshrrev_b32 v7, 16, v7
    v_mfma_f32_16x16x32_bf16 v[68:71], a[216:219], v[108:111], 0
    v_lshrrev_b32 v7, v7, s64
    v_and_b32 v7, 1, v7
    v_mfma_f32_16x16x32_bf16 v[68:71], a[220:223], v[96:99], v[68:71]
    ds_read_b128 v[104:107], v54 offset:3072
    ds_read_b128 v[100:103], v53 offset:3072
    v_mfma_f32_16x16x32_bf16 v[68:71], a[224:227], v[84:87], v[68:71]
    ds_read_b128 v[92:95], v54 offset:3200
    v_cmp_eq_u32 vcc, 1, v7
    v_mfma_f32_16x16x32_bf16 v[68:71], a[228:231], v[36:39], v[68:71]
    ds_read_b128 v[64:67], v53 offset:3200
    v_cndmask_b32 v6, 2.0, v6, vcc
    v_mfma_f32_16x16x32_bf16 v[68:71], a[232:235], v[20:23], v[68:71]
L_pg2:
    s_cbranch_execz L_main
    ds_read_b128 v[60:63], v54 offset:3328
    v_add_u32 v7, s95, v133
    v_mfma_f32_16x16x32_bf16 v[68:71], a[236:239], v[0:3], v[68:71]
    ds_read_b128 v[28:31], v53 offset:3328
    v_fma_f32 v133, v8, v8, s42
    v_mfma_f32_16x16x32_bf16 v[76:79], a[240:243], v[108:111], 0
    v_rsq_f32 v16, v16
    v_mfma_f32_16x16x32_bf16 v[76:79], a[244:247], v[96:99], v[76:79]
    v_mul_f32 v16, s43, v16
    v_mul_f32 v48, v48, v16
    v_mfma_f32_16x16x32_bf16 v[76:79], a[248:251], v[84:87], v[76:79]
    v_mul_f32 v49, v49, v16
    v_cvt_pk_bf16_f32 v48, v48, v49
    v_mfma_f32_16x16x32_bf16 v[76:79], a[252:255], v[36:39], v[76:79]
    v_mul_f32 v50, v50, v16
    v_mul_f32 v51, v51, v16
    v_mfma_f32_16x16x32_bf16 v[76:79], v[224:227], v[20:23], v[76:79]
    v_cvt_pk_bf16_f32 v49, v50, v51
    v_mul_f32 v80, v80, v16
    v_mfma_f32_16x16x32_bf16 v[76:79], v[228:231], v[0:3], v[76:79]
    v_mul_f32 v81, v81, v16
    v_cvt_pk_bf16_f32 v50, v80, v81
    v_mfma_f32_16x16x32_bf16 v[40:43], v[232:235], v[108:111], 0
    v_mul_f32 v82, v82, v16
    v_mul_f32 v83, v83, v16
    v_mfma_f32_16x16x32_bf16 v[40:43], v[236:239], v[96:99], v[40:43]
    v_cvt_pk_bf16_f32 v51, v82, v83
    v_mul_f32 v116, v116, v16
    v_mfma_f32_16x16x32_bf16 v[40:43], v[240:243], v[84:87], v[40:43]
    ds_write_b128 v120, v[48:51] offset:0
    v_mfma_f32_16x16x32_bf16 v[40:43], v[244:247], v[36:39], v[40:43]
    v_mul_f32 v117, v117, v16
    v_cvt_pk_bf16_f32 v116, v116, v117
    v_mfma_f32_16x16x32_bf16 v[40:43], v[248:251], v[20:23], v[40:43]
    v_mul_f32 v118, v118, v16
    v_mul_f32 v119, v119, v16
    v_mfma_f32_16x16x32_bf16 v[40:43], v[252:255], v[0:3], v[40:43]
    s_waitcnt lgkmcnt(1)
    v_cvt_pk_bf16_f32 v117, v118, v119
    v_fma_f32 v54, v68, v68, s42
    v_mfma_f32_16x16x32_bf16 v[20:23], a[216:219], v[104:107], 0
    ds_write_b64 v55, v[116:117] offset:0
    v_mfma_f32_16x16x32_bf16 v[20:23], a[220:223], v[100:103], v[20:23]
    ds_read_b128 v[36:39], v52 offset:64
    v_fmac_f32 v54, v69, v69
    v_mfma_f32_16x16x32_bf16 v[20:23], a[224:227], v[92:95], v[20:23]
    ds_read_b128 v[0:3], v52 offset:80
    v_fmac_f32 v54, v70, v70
    v_mfma_f32_16x16x32_bf16 v[20:23], a[228:231], v[64:67], v[20:23]
    ds_read_b128 v[48:51], v52
    v_fmac_f32 v54, v71, v71
    v_mfma_f32_16x16x32_bf16 v[20:23], a[232:235], v[60:63], v[20:23]
    ds_read_b64 v[52:53], v52 offset:16
    v_fmac_f32 v54, v76, v76
    v_mfma_f32_16x16x32_bf16 v[20:23], a[236:239], v[28:31], v[20:23]
    v_rsq_f32 v17, v17
    v_mfma_f32_16x16x32_bf16 v[96:99], a[240:243], v[104:107], 0
    v_mul_f32 v17, s43, v17
    v_mul_f32 v140, v140, v17
    v_mfma_f32_16x16x32_bf16 v[96:99], a[244:247], v[100:103], v[96:99]
    v_mul_f32 v141, v141, v17
    v_cvt_pk_bf16_f32 v84, v140, v141
    v_mfma_f32_16x16x32_bf16 v[96:99], a[248:251], v[92:95], v[96:99]
    v_mul_f32 v142, v142, v17
    v_mul_f32 v143, v143, v17
    v_mfma_f32_16x16x32_bf16 v[96:99], a[252:255], v[64:67], v[96:99]
    v_cvt_pk_bf16_f32 v85, v142, v143
    v_mul_f32 v44, v44, v17
    v_mfma_f32_16x16x32_bf16 v[96:99], v[224:227], v[60:63], v[96:99]
    v_mul_f32 v45, v45, v17
    v_cvt_pk_bf16_f32 v86, v44, v45
    v_mfma_f32_16x16x32_bf16 v[96:99], v[228:231], v[28:31], v[96:99]
    v_mul_f32 v46, v46, v17
    v_mul_f32 v47, v47, v17
    v_mfma_f32_16x16x32_bf16 v[80:83], v[232:235], v[104:107], 0
    v_cvt_pk_bf16_f32 v87, v46, v47
    v_mul_f32 v56, v56, v17
    v_mfma_f32_16x16x32_bf16 v[80:83], v[236:239], v[100:103], v[80:83]
    ds_write_b128 v120, v[84:87] offset:1536
    v_mfma_f32_16x16x32_bf16 v[80:83], v[240:243], v[92:95], v[80:83]
    v_mul_f32 v57, v57, v17
    v_cvt_pk_bf16_f32 v56, v56, v57
    v_mfma_f32_16x16x32_bf16 v[80:83], v[244:247], v[64:67], v[80:83]
    v_mul_f32 v58, v58, v17
    v_mul_f32 v59, v59, v17
    v_mfma_f32_16x16x32_bf16 v[80:83], v[248:251], v[60:63], v[80:83]
    v_cvt_pk_bf16_f32 v57, v58, v59
    v_fmac_f32 v54, v77, v77
    v_mfma_f32_16x16x32_bf16 v[80:83], v[252:255], v[28:31], v[80:83]
    s_waitcnt lgkmcnt(1)
    ds_write_b64 v55, v[56:57] offset:1536
    v_mfma_f32_16x16x32_bf16 v[28:31], v[220:223], v[36:39], 0
    v_rsq_f32 v18, v18
    v_mfma_f32_16x16x32_bf16 v[28:31], v[220:223], v[0:3], v[28:31]
    v_mul_f32 v18, s43, v18
    v_mul_f32 v24, v24, v18
    v_mul_f32 v25, v25, v18
    v_cvt_pk_bf16_f32 v0, v24, v25
    v_mul_f32 v26, v26, v18
    v_mul_f32 v27, v27, v18
    v_cvt_pk_bf16_f32 v1, v26, v27
    v_mul_f32 v88, v88, v18
    v_mul_f32 v89, v89, v18
    v_cvt_pk_bf16_f32 v2, v88, v89
    v_mul_f32 v90, v90, v18
    v_mul_f32 v91, v91, v18
    v_cvt_pk_bf16_f32 v3, v90, v91
    v_mul_f32 v72, v72, v18
    v_mul_f32 v73, v73, v18
    v_cvt_pk_bf16_f32 v72, v72, v73
    v_mul_f32 v74, v74, v18
    v_mul_f32 v75, v75, v18
    v_cvt_pk_bf16_f32 v73, v74, v75
    ds_write_b128 v120, v[0:3] offset:3072
    v_fmac_f32 v54, v78, v78
    v_fmac_f32 v54, v79, v79
    v_fmac_f32 v54, v40, v40
    v_fmac_f32 v54, v41, v41
    ds_write_b64 v55, v[72:73] offset:3072
    v_fmac_f32 v54, v42, v42
    v_fmac_f32 v54, v43, v43
    v_fmac_f32 v133, v9, v9
    v_fmac_f32 v133, v10, v10
    v_fmac_f32 v133, v11, v11
    v_fmac_f32 v133, v32, v32
    v_fmac_f32 v133, v33, v33
    v_fmac_f32 v133, v34, v34
    v_fmac_f32 v133, v35, v35
    v_fmac_f32 v133, v12, v12
    v_fmac_f32 v133, v13, v13
    v_fmac_f32 v133, v14, v14
    v_fmac_f32 v133, v15, v15
    v_cvt_pk_bf16_f32 v54, v54, v133
    v_fma_f32 v133, v20, v20, s42
    v_fmac_f32 v133, v21, v21
    v_fmac_f32 v133, v22, v22
    v_fmac_f32 v133, v23, v23
    v_fmac_f32 v133, v96, v96
    v_fmac_f32 v133, v97, v97
    v_fmac_f32 v133, v98, v98
    v_fmac_f32 v133, v99, v99
    v_fmac_f32 v133, v80, v80
    v_fmac_f32 v133, v81, v81
    v_fmac_f32 v133, v82, v82
    v_fmac_f32 v133, v83, v83
    v_cvt_pk_bf16_f32 v55, v133, v133
    ds_write_b64 v130, v[54:55] offset:2048
    v_rcp_f32 v28, v28
    v_lshlrev_b32 v133, 16, v48
    v_and_b32 v48, 0xffff0000, v48
    v_mul_f32 v133, v133, v28
    v_mul_f32 v48, v48, v28
    v_cvt_pk_bf16_f32 v16, v133, v48
    v_lshlrev_b32 v48, 16, v49
    v_and_b32 v49, 0xffff0000, v49
    v_mul_f32 v48, v48, v28
    v_mul_f32 v49, v49, v28
    v_cvt_pk_bf16_f32 v17, v48, v49
    v_lshlrev_b32 v133, 16, v50
    v_and_b32 v50, 0xffff0000, v50
    v_mul_f32 v133, v133, v28
    v_mul_f32 v50, v50, v28
    v_cvt_pk_bf16_f32 v18, v133, v50
    v_lshlrev_b32 v19, 16, v51
    v_and_b32 v51, 0xffff0000, v51
    v_mul_f32 v19, v19, v28
    v_mul_f32 v51, v51, v28
    v_cvt_pk_bf16_f32 v19, v19, v51
    v_lshlrev_b32 v133, 16, v52
    v_and_b32 v52, 0xffff0000, v52
    v_mul_f32 v133, v133, v28
    v_mul_f32 v52, v52, v28
    v_cvt_pk_bf16_f32 v0, v133, v52
    v_lshlrev_b32 v133, 16, v53
    v_and_b32 v53, 0xffff0000, v53
    v_mul_f32 v133, v133, v28
    v_mul_f32 v53, v53, v28
    v_cvt_pk_bf16_f32 v1, v133, v53
    s_waitcnt lgkmcnt(0)
    s_barrier
    ds_write_b128 v138, v[16:19] offset:1536
    v_and_b32 v123, 0xb8000000, v123
    v_mov_b32 v121, 0x3f803f80
    v_cmp_ne_u32 vcc, 0, v123
    s_nop 0
    ds_write_b64 v132, v[0:1] offset:1536
    v_cndmask_b32 v121, 0, v121, vcc
    ds_read_b128 v[36:39], v7 offset:0
    ds_read_b128 v[0:3], v7 offset:1024
    ds_read_b128 v[24:27], v7 offset:2048
    ds_read_b128 v[108:111], v7 offset:3072
    ds_read_b128 v[72:75], v7 offset:4096
    s_waitcnt lgkmcnt(5)
    s_barrier
    s_waitcnt lgkmcnt(4)
    buffer_store_dwordx4 v[36:39], v128, s[28:31], s59 offen sc1
    ds_read_b128 v[28:31], v129 offset:2048
    ds_read_b128 v[16:19], v129 offset:3072
    ds_read_b128 v[104:107], v137 offset:1536
    ds_read_b128 v[100:103], v136 offset:1536
    ds_read_b128 v[92:95], v137 offset:1664
    ds_read_b128 v[84:87], v136 offset:1664
    ds_read_b128 v[44:47], v137 offset:1792
    s_waitcnt lgkmcnt(9)
    buffer_store_dwordx4 v[0:3], v127, s[28:31], s59 offen sc1
    ds_read_b128 v[36:39], v136 offset:1792
    s_waitcnt lgkmcnt(7)
    v_mfma_f32_16x16x32_bf16 v[0:3], v[216:219], v[28:31], 0
    s_waitcnt lgkmcnt(6)
    v_mfma_f32_16x16x32_bf16 v[0:3], v[216:219], v[16:19], v[0:3]
    s_waitcnt lgkmcnt(5)
    v_mfma_f32_16x16x32_bf16 v[16:19], a[216:219], v[104:107], 0
    s_waitcnt lgkmcnt(4)
    v_mfma_f32_16x16x32_bf16 v[16:19], a[220:223], v[100:103], v[16:19]
    s_waitcnt lgkmcnt(3)
    ds_read_b128 v[64:67], v137 offset:0
    ds_read_b128 v[60:63], v136 offset:0
    v_mfma_f32_16x16x32_bf16 v[16:19], a[224:227], v[92:95], v[16:19]
    s_waitcnt lgkmcnt(4)
    ds_read_b128 v[56:59], v137 offset:128
    v_mfma_f32_16x16x32_bf16 v[16:19], a[228:231], v[84:87], v[16:19]
    s_waitcnt lgkmcnt(4)
    buffer_store_dwordx4 v[24:27], v126, s[28:31], s59 offen sc1
    ds_read_b128 v[52:55], v136 offset:128
    v_rsq_f32 v0, v0
    v_mfma_f32_16x16x32_bf16 v[16:19], a[232:235], v[44:47], v[16:19]
    s_waitcnt lgkmcnt(4)
    ds_read_b128 v[48:51], v137 offset:256
    ds_read_b128 v[24:27], v136 offset:256
    v_mfma_f32_16x16x32_bf16 v[16:19], a[236:239], v[36:39], v[16:19]
    v_rsq_f32 v1, v1
    v_mfma_f32_16x16x32_bf16 v[28:31], a[240:243], v[104:107], 0
    v_mul_f32 v0, s43, v0
    v_mul_f32 v1, s43, v1
    v_mfma_f32_16x16x32_bf16 v[28:31], a[244:247], v[100:103], v[28:31]
    v_rsq_f32 v2, v2
    v_mfma_f32_16x16x32_bf16 v[28:31], a[248:251], v[92:95], v[28:31]
    v_mul_f32 v2, s43, v2
    v_mul_f32 v20, v20, v2
    v_mfma_f32_16x16x32_bf16 v[28:31], a[252:255], v[84:87], v[28:31]
    buffer_store_dwordx4 v[108:111], v125, s[28:31], s59 offen sc1
    v_mul_f32 v21, v21, v2
    v_cvt_pk_bf16_f32 v88, v20, v21
    v_mul_f32 v22, v22, v2
    v_mul_f32 v23, v23, v2
    v_mfma_f32_16x16x32_bf16 v[28:31], v[224:227], v[44:47], v[28:31]
    v_cvt_pk_bf16_f32 v89, v22, v23
    v_mul_f32 v96, v96, v2
    v_mfma_f32_16x16x32_bf16 v[28:31], v[228:231], v[36:39], v[28:31]
    v_mul_f32 v97, v97, v2
    v_cvt_pk_bf16_f32 v90, v96, v97
    v_mfma_f32_16x16x32_bf16 v[20:23], v[232:235], v[104:107], 0
    v_mul_f32 v98, v98, v2
    v_mul_f32 v99, v99, v2
    v_mfma_f32_16x16x32_bf16 v[20:23], v[236:239], v[100:103], v[20:23]
    v_cvt_pk_bf16_f32 v91, v98, v99
    v_mul_f32 v80, v80, v2
    v_mfma_f32_16x16x32_bf16 v[20:23], v[240:243], v[92:95], v[20:23]
    ds_write_b128 v135, v[88:91] offset:3072
    v_mfma_f32_16x16x32_bf16 v[20:23], v[244:247], v[84:87], v[20:23]
    buffer_store_dwordx4 v[72:75], v124, s[28:31], s59 offen sc1
    v_mul_f32 v81, v81, v2
    v_cvt_pk_bf16_f32 v136, v80, v81
    v_mul_f32 v82, v82, v2
    v_mul_f32 v83, v83, v2
    v_mfma_f32_16x16x32_bf16 v[20:23], v[248:251], v[44:47], v[20:23]
    v_cvt_pk_bf16_f32 v137, v82, v83
    v_mul_f32 v68, v68, v0
    v_mfma_f32_16x16x32_bf16 v[20:23], v[252:255], v[36:39], v[20:23]
    s_waitcnt lgkmcnt(1)
    ds_write_b64 v134, v[136:137] offset:3072
    v_mfma_f32_16x16x32_bf16 v[36:39], a[216:219], v[64:67], 0
    v_mul_f32 v69, v69, v0
    v_cvt_pk_bf16_f32 v68, v68, v69
    v_mfma_f32_16x16x32_bf16 v[36:39], a[220:223], v[60:63], v[36:39]
    v_mul_f32 v70, v70, v0
    v_mul_f32 v71, v71, v0
    v_mfma_f32_16x16x32_bf16 v[36:39], a[224:227], v[56:59], v[36:39]
    v_cvt_pk_bf16_f32 v69, v70, v71
    v_mul_f32 v76, v76, v0
    v_mfma_f32_16x16x32_bf16 v[36:39], a[228:231], v[52:55], v[36:39]
    v_mul_f32 v77, v77, v0
    v_cvt_pk_bf16_f32 v70, v76, v77
    v_mfma_f32_16x16x32_bf16 v[36:39], a[232:235], v[48:51], v[36:39]
    v_mul_f32 v78, v78, v0
    v_mul_f32 v79, v79, v0
    v_mfma_f32_16x16x32_bf16 v[36:39], a[236:239], v[24:27], v[36:39]
    v_cvt_pk_bf16_f32 v71, v78, v79
    v_mul_f32 v40, v40, v0
    v_mfma_f32_16x16x32_bf16 v[44:47], a[240:243], v[64:67], 0
    ds_write_b128 v135, v[68:71] offset:0
    v_mfma_f32_16x16x32_bf16 v[44:47], a[244:247], v[60:63], v[44:47]
    v_mul_f32 v41, v41, v0
    v_cvt_pk_bf16_f32 v2, v40, v41
    v_mfma_f32_16x16x32_bf16 v[44:47], a[248:251], v[56:59], v[44:47]
    v_mul_f32 v42, v42, v0
    v_mul_f32 v43, v43, v0
    v_mfma_f32_16x16x32_bf16 v[44:47], a[252:255], v[52:55], v[44:47]
    v_cvt_pk_bf16_f32 v3, v42, v43
    v_fma_f32 v7, v16, v16, s42
    v_mfma_f32_16x16x32_bf16 v[44:47], v[224:227], v[48:51], v[44:47]
    ds_write_b64 v134, v[2:3] offset:0
    v_mfma_f32_16x16x32_bf16 v[44:47], v[228:231], v[24:27], v[44:47]
    v_fmac_f32 v7, v17, v17
    v_fmac_f32 v7, v18, v18
    v_mfma_f32_16x16x32_bf16 v[40:43], v[232:235], v[64:67], 0
    v_fmac_f32 v7, v19, v19
    v_fmac_f32 v7, v28, v28
    v_mfma_f32_16x16x32_bf16 v[40:43], v[236:239], v[60:63], v[40:43]
    v_fmac_f32 v7, v29, v29
    v_fmac_f32 v7, v30, v30
    v_mfma_f32_16x16x32_bf16 v[40:43], v[240:243], v[56:59], v[40:43]
    v_fmac_f32 v7, v31, v31
    v_fmac_f32 v7, v20, v20
    v_mfma_f32_16x16x32_bf16 v[40:43], v[244:247], v[52:55], v[40:43]
    v_fmac_f32 v7, v21, v21
    v_fmac_f32 v7, v22, v22
    v_mfma_f32_16x16x32_bf16 v[40:43], v[248:251], v[48:51], v[40:43]
    v_fmac_f32 v7, v23, v23
    v_fma_f32 v133, v36, v36, s42
    v_mfma_f32_16x16x32_bf16 v[40:43], v[252:255], v[24:27], v[40:43]
    s_nop 0
    v_fmac_f32 v133, v37, v37
    v_fmac_f32 v133, v38, v38
    v_fmac_f32 v133, v39, v39
    v_fmac_f32 v133, v44, v44
    v_fmac_f32 v133, v45, v45
    v_fmac_f32 v133, v46, v46
    v_fmac_f32 v133, v47, v47
    v_fmac_f32 v133, v40, v40
    v_fmac_f32 v133, v41, v41
    v_fmac_f32 v133, v42, v42
    v_fmac_f32 v133, v43, v43
    v_cvt_pk_bf16_f32 v120, v133, v7
    ds_write_b64 v130, v[120:121] offset:4096
    v_mul_f32 v8, v8, v1
    v_mul_f32 v9, v9, v1
    v_cvt_pk_bf16_f32 v8, v8, v9
    v_mul_f32 v10, v10, v1
    v_mul_f32 v11, v11, v1
    v_cvt_pk_bf16_f32 v9, v10, v11
    v_mul_f32 v32, v32, v1
    v_mul_f32 v33, v33, v1
    v_cvt_pk_bf16_f32 v10, v32, v33
    v_mul_f32 v34, v34, v1
    v_mul_f32 v35, v35, v1
    v_cvt_pk_bf16_f32 v11, v34, v35
    v_mul_f32 v12, v12, v1
    v_mul_f32 v13, v13, v1
    v_cvt_pk_bf16_f32 v136, v12, v13
    v_mul_f32 v14, v14, v1
    v_mul_f32 v15, v15, v1
    v_cvt_pk_bf16_f32 v137, v14, v15
    ds_write_b128 v135, v[8:11] offset:1536
    s_waitcnt lgkmcnt(1)
    s_barrier
    ds_write_b64 v134, v[136:137] offset:1536
    ds_read_b128 v[8:11], v129 offset:4096
    ds_read_b128 v[0:3], v129 offset:5120
    s_waitcnt lgkmcnt(2)
    s_barrier
    s_waitcnt lgkmcnt(1)
    v_mfma_f32_16x16x32_bf16 v[24:27], v[216:219], v[8:11], 0
    s_waitcnt lgkmcnt(0)
    ds_read_b128 v[48:51], v139 offset:0
    ds_read_b128 v[32:35], v139 offset:1024
    v_mfma_f32_16x16x32_bf16 v[24:27], v[216:219], v[0:3], v[24:27]
    s_nop 0
    ds_read_b128 v[12:15], v139 offset:2048
    s_nop 2
    ds_read_b128 v[8:11], v139 offset:3072
    s_nop 1
    v_rsq_f32 v24, v24
    ds_read_b128 v[0:3], v139 offset:4096
    v_mul_f32 v24, s43, v24
    v_mul_f32 v36, v36, v24
    v_mul_f32 v37, v37, v24
    v_cvt_pk_bf16_f32 v36, v36, v37
    v_mul_f32 v38, v38, v24
    v_mul_f32 v39, v39, v24
    v_cvt_pk_bf16_f32 v37, v38, v39
    v_mul_f32 v44, v44, v24
    v_mul_f32 v45, v45, v24
    s_waitcnt lgkmcnt(4)
    buffer_store_dwordx4 v[48:51], v128, s[28:31], s58 offen sc1
    v_cvt_pk_bf16_f32 v38, v44, v45
    v_mul_f32 v46, v46, v24
    v_mul_f32 v47, v47, v24
    v_cvt_pk_bf16_f32 v39, v46, v47
    v_mul_f32 v40, v40, v24
    v_mul_f32 v41, v41, v24
    v_cvt_pk_bf16_f32 v128, v40, v41
    v_mul_f32 v42, v42, v24
    v_mul_f32 v43, v43, v24
    v_cvt_pk_bf16_f32 v129, v42, v43
    ds_write_b128 v138, v[36:39] offset:0
    v_rsq_f32 v25, v25
    v_cmp_neq_f32 vcc, 0, v26
    v_mul_f32 v25, s43, v25
    s_waitcnt lgkmcnt(1)
    buffer_store_dwordx4 v[32:35], v127, s[28:31], s58 offen sc1
    ds_write_b64 v132, v[128:129] offset:0
    v_mul_f32 v16, v16, v25
    v_mul_f32 v17, v17, v25
    v_cvt_pk_bf16_f32 v16, v16, v17
    v_mul_f32 v18, v18, v25
    v_mul_f32 v19, v19, v25
    v_cvt_pk_bf16_f32 v17, v18, v19
    v_mul_f32 v28, v28, v25
    v_mul_f32 v29, v29, v25
    v_cvt_pk_bf16_f32 v18, v28, v29
    v_mul_f32 v30, v30, v25
    v_mul_f32 v31, v31, v25
    v_cvt_pk_bf16_f32 v19, v30, v31
    v_mul_f32 v20, v20, v25
    v_mul_f32 v21, v21, v25
    v_cvt_pk_bf16_f32 v128, v20, v21
    v_mul_f32 v22, v22, v25
    v_mul_f32 v23, v23, v25
    v_cvt_pk_bf16_f32 v129, v22, v23
    buffer_store_dwordx4 v[12:15], v126, s[28:31], s58 offen sc1
    ds_write_b128 v138, v[16:19] offset:1536
    ds_write_b64 v132, v[128:129] offset:1536
    buffer_store_dwordx4 v[8:11], v125, s[28:31], s58 offen sc1
    s_waitcnt lgkmcnt(0)
    s_barrier
    buffer_store_dwordx4 v[0:3], v124, s[28:31], s58 offen sc1
    ds_read_b128 v[12:15], v131 offset:0
    ds_read_b128 v[8:11], v131 offset:1024
    ds_read_b128 v[0:3], v131 offset:2048
    s_waitcnt lgkmcnt(2)
    buffer_store_dwordx4 v[12:15], v4, s[28:31], 0 offen sc1
    s_waitcnt lgkmcnt(0)
    buffer_store_dwordx4 v[8:11], v5, s[28:31], 0 offen sc1
    buffer_store_dwordx4 v[0:3], v6, s[28:31], 0 offen sc1
    s_nop 4
    s_cbranch_vccnz L_slow
L_fin:
    s_cmp_eq_u32 s2, 255
    s_cbranch_scc1 L_again
L_end:
    s_endpgm
L_slow:
    s_waitcnt vmcnt(0) lgkmcnt(0)
    s_nop 15
    s_barrier
    s_lshr_b32 s66, s64, 20
    v_mbcnt_lo_u32_b32 v157, -1, 0
    v_mbcnt_hi_u32_b32 v157, -1, v157
    s_load_dwordx16 s[4:19], s[0:1], 0
    s_load_dwordx4 s[20:23], s[0:1], 64
    s_load_dwordx2 s[38:39], s[0:1], 80
    s_bfe_u32 s88, s2, 0x50003
    s_lshl2_add_u32 s88, s88, s68
    v_lshlrev_b32 v72, 7, v157
    s_mul_i32 s89, s88, 576
    s_mul_i32 s88, s88, 1728
    v_min_u32 v74, 1664, v72
    v_min_u32 v73, 512, v72
    s_mov_b32 s34, 221184
    s_mov_b32 s35, 0x20000
    s_mov_b32 s78, 73728
    s_mov_b32 s79, 0x20000
    v_and_b32 v75, 15, v157
    v_lshrrev_b32 v160, 4, v157
    v_lshrrev_b32 v72, 2, v75
    v_and_b32 v5, 3, v75
    s_mul_i32 s87, s68, 192
    v_mad_u32_u24 v19, v75, 12, s87
    v_lshlrev_b32 v31, 1, v75
    v_lshlrev_b32 v11, 1, v72
    v_lshl_add_u32 v11, v160, 5, v11
    s_movk_i32 s86, 384
    s_mov_b32 s26, 100270464
    s_mov_b32 s27, 0x20000
    s_mov_b32 s30, 0
    s_mov_b32 s31, 0x20000
    s_mul_i32 s96, s68, 288
    s_and_b32 s97, s68, 1
    s_lshl_b32 s97, s97, 2
    s_mov_b32 s98, 193536
    s_waitcnt lgkmcnt(0)
    s_mov_b32 s24, s4
    s_mov_b32 s25, s5
    s_mov_b32 s32, s6
    s_mov_b32 s33, s7
    s_mov_b32 s76, s8
    s_mov_b32 s77, s9
    buffer_load_dword a254, v74, s[32:35], s88 offen
    buffer_load_dword a253, v73, s[76:79], s89 offen
    s_load_dwordx2 s[82:83], s[10:11], 0
    s_movk_i32 s18, 676
    s_mov_b32 s19, 0x20000
    buffer_load_dwordx3 v[28:30], v19, s[16:19], 0 offen
    s_mov_b32 s99, 589824
    v_add_u32 v124, s96, v157
    v_mul_u32_u24 v74, 2731, v124
    v_mul_u32_u24 v73, 6242, v124
    v_lshrrev_b32 v74, 16, v74
    s_lshr_b32 s94, s2, 3
    s_mul_i32 s70, s94, 167
    global_load_ushort v16, v31, s[12:13]
    v_lshrrev_b32 v73, 20, v73
    v_and_or_b32 v8, v74, 3, s97
    v_xor_b32 v8, v124, v8
    v_lshl_add_u32 v128, v8, 4, s99
    v_mad_u32_u24 v128, v73, s98, v128
    s_min_u32 s95, s94, 7
    s_add_u32 s70, s70, s95
    global_load_ushort v17, v31, s[12:13] offset:32
    v_add_u32 v10, 64, v124
    v_mul_u32_u24 v150, 2731, v10
    v_mul_u32_u24 v156, 6242, v10
    v_lshrrev_b32 v150, 16, v150
    v_lshrrev_b32 v156, 20, v156
    s_and_b32 s95, s2, 7
    s_mul_i32 s95, s95, 20
    global_load_ushort v148, v11, s[14:15] offset:0
    v_and_or_b32 v9, v150, 3, s97
    v_xor_b32 v9, v10, v9
    v_lshl_add_u32 v127, v9, 4, s99
    v_mad_u32_u24 v127, v156, s98, v127
    v_add_u32 v18, 128, v124
    s_add_u32 s69, s70, s95
    s_add_u32 s70, s70, 140
    global_load_ushort v158, v11, s[14:15] offset:8
    v_mul_u32_u24 v10, 2731, v18
    v_mul_u32_u24 v4, 6242, v18
    v_lshrrev_b32 v10, 16, v10
    v_lshrrev_b32 v4, 20, v4
    v_and_or_b32 v31, v10, 3, s97
    s_movk_i32 s62, 2688
    s_movk_i32 s71, 20
    global_load_ushort v149, v11, s[14:15] offset:16
    v_xor_b32 v31, v18, v31
    v_lshl_add_u32 v126, v31, 4, s99
    v_mad_u32_u24 v126, v4, s98, v126
    v_add_u32 v125, 192, v124
    v_mul_u32_u24 v159, 2731, v125
    s_cmp_lt_u32 s94, 7
    s_cselect_b32 s73, 28, 27
    global_load_ushort v132, v11, s[14:15] offset:24
    v_mul_u32_u24 v18, 6242, v125
    v_lshrrev_b32 v159, 16, v159
    v_lshrrev_b32 v18, 20, v18
    v_and_or_b32 v11, v159, 3, s97
    v_xor_b32 v11, v125, v11
    v_lshl_add_u32 v125, v11, 4, s99
    v_mad_u32_u24 v125, v18, s98, v125
    v_add_u32 v6, 256, v124
    v_mul_u32_u24 v151, 2731, v6
    v_mul_u32_u24 v11, 6242, v6
    v_lshrrev_b32 v151, 16, v151
    v_lshrrev_b32 v11, 20, v11
    v_and_or_b32 v124, v151, 3, s97
    v_xor_b32 v124, v6, v124
    v_lshl_add_u32 v124, v124, 4, s99
    v_mad_u32_u24 v124, v11, s98, v124
    s_mov_b32 s93, 1769472
    s_mul_i32 s54, s68, 5120
    s_cmp_ge_u32 s2, 248
    s_cbranch_scc1 L_bndS
L_bndrS:
    s_mov_b32 s63, 1180032
    s_mul_i32 s94, s69, 58255
    s_lshr_b32 s94, s94, 22
    s_mul_i32 s94, s94, s63
    s_mul_i32 s72, s69, s62
    s_add_u32 s72, s72, s94
    v_lshl_or_b32 v73, v157, 4, 2.0
    s_sub_u32 s94, s73, 1
    s_max_u32 s94, s94, 20
    s_mul_i32 s95, s68, -44
    s_movk_i32 s99, -24
    s_add_u32 m0, s54, 0
    v_and_b32 v18, -4, v10
    s_mul_i32 s85, s68, 96
    s_sub_u32 s100, s85, 1024
    buffer_load_dwordx4 v128, s[24:27], s72 offen nt lds
    s_add_u32 m0, s54, 1024
    v_mad_u32_u24 v11, v18, 3, v10
    v_add_u32 v11, s95, v11
    v_mad_i32_i24 v10, v10, s99, v31
    v_med3_u32 v18, v11, 20, s94
    v_add_u32 v18, s70, v18
    v_add_u32 v31, s69, v11
    s_sub_u32 s87, s85, 2048
    s_movk_i32 s91, 1152
    buffer_load_dwordx4 v127, s[24:27], s72 offen nt lds
    v_cmp_gt_u32 vcc, s71, v11
    v_lshl_add_u32 v10, v10, 4, s93
    s_add_u32 m0, s54, 43008
    v_cndmask_b32 v31, v18, v31, vcc
    v_mul_u32_u24 v18, 58255, v31
    v_mad_u32_u24 v10, v31, s62, v10
    v_lshrrev_b32 v18, 22, v18
    v_mad_u32_u24 v10, v18, s63, v10
    s_mul_i32 s90, s68, 3072
    s_add_u32 s90, s90, 61440
    buffer_load_dwordx4 v10, s[24:27], 0 offen  lds
    v_lshlrev_b32 v11, 16, v11
    s_add_u32 m0, s54, 2048
    v_and_b32 v31, -4, v150
    v_mad_u32_u24 v18, v31, 3, v150
    v_add_u32 v18, s95, v18
    v_mad_i32_i24 v9, v150, s99, v9
    v_med3_u32 v31, v18, 20, s94
    s_mov_b32 s28, s22
    s_mov_b32 s29, s23
    buffer_load_dwordx4 v126, s[24:27], s72 offen nt lds
    v_add_u32 v31, s70, v31
    v_add_u32 v150, s69, v18
    v_cmp_gt_u32 vcc, s71, v18
    v_lshl_add_u32 v9, v9, 4, s93
    s_add_u32 m0, s54, 41984
    v_cndmask_b32 v150, v31, v150, vcc
    v_mul_u32_u24 v31, 58255, v150
    v_mad_u32_u24 v9, v150, s62, v9
    v_lshrrev_b32 v31, 22, v31
    v_mad_u32_u24 v9, v31, s63, v9
    s_mov_b32 s41, 0x2a8cbccc
    s_mov_b32 s42, 0x38fba882
    buffer_load_dwordx4 v9, s[24:27], 0 offen  lds
    v_lshl_or_b32 v11, v18, 8, v11
    s_add_u32 m0, s54, 3072
    v_cmp_gt_u32 vcc, 32, v157
    v_and_b32 v31, -4, v74
    v_mad_u32_u24 v18, v31, 3, v74
    v_cndmask_b32 v124, v73, v124, vcc
    v_add_u32 v18, s95, v18
    s_mov_b32 s43, 0x415db3d7
    s_mov_b32 s44, 61440
    buffer_load_dwordx4 v125, s[24:27], s72 offen nt lds
    s_add_u32 m0, s54, 4096
    v_mad_i32_i24 v8, v74, s99, v8
    v_med3_u32 v31, v18, 20, s94
    v_add_u32 v31, s70, v31
    v_add_u32 v74, s69, v18
    v_cmp_gt_u32 vcc, s71, v18
    v_lshl_add_u32 v8, v8, 4, s93
    s_mul_i32 s93, s68, 6
    s_lshl_b32 s94, s97, 1
    buffer_load_dwordx4 v124, s[24:27], s72 offen nt lds
    v_cndmask_b32 v74, v31, v74, vcc
    v_mul_u32_u24 v31, 58255, v74
    v_mad_u32_u24 v8, v74, s62, v8
    v_lshrrev_b32 v31, 22, v31
    v_mad_u32_u24 v8, v31, s63, v8
    s_add_u32 m0, s54, 40960
    v_lshl_or_b32 v11, v18, 0, v11
    s_mov_b32 s45, 40960
    s_mov_b32 s46, 20480
    buffer_load_dwordx4 v8, s[24:27], 0 offen nt lds
    v_mul_u32_u24 v6, 10923, v157
    v_lshrrev_b32 v4, 17, v6
    v_lshrrev_b32 v6, 16, v6
    v_mad_i32_i24 v7, v6, -6, v157
    v_bitop3_b32 v4, v4, v6, 4 bitop3:0x28
    v_lshl_add_u32 v7, v7, 4, s85
    v_mul_u32_u24 v4, 3, v4
    v_xor_b32 v6, v6, v4
    v_mad_u32_u24 v4, v6, s91, v7
    v_add_u32 v18, 64, v157
    v_mul_u32_u24 v31, 10923, v18
    v_lshrrev_b32 v156, 17, v31
    v_lshrrev_b32 v31, 16, v31
    v_mad_i32_i24 v159, v31, -6, v18
    v_bitop3_b32 v156, v156, v31, 4 bitop3:0x28
    v_lshl_add_u32 v159, v159, 4, s100
    v_mul_u32_u24 v156, 3, v156
    v_xor_b32 v31, v31, v156
    v_mad_u32_u24 v156, v31, s91, v159
    v_add_u32 v18, 128, v157
    v_mul_u32_u24 v74, 10923, v18
    v_lshrrev_b32 v120, 17, v74
    v_lshrrev_b32 v74, 16, v74
    v_mad_i32_i24 v18, v74, -6, v18
    v_bitop3_b32 v120, v120, v74, 4 bitop3:0x28
    v_lshl_add_u32 v18, v18, 4, s87
    v_mul_u32_u24 v120, 3, v120
    v_xor_b32 v74, v74, v120
    v_mad_u32_u24 v120, v74, s91, v18
    v_mad_u32_u24 v121, v6, s86, v7
    v_mad_u32_u24 v25, v31, s86, v159
    v_mad_u32_u24 v24, v74, s86, v18
    s_add_u32 m0, s90, 0
    s_mov_b32 s92, 0
    buffer_load_dwordx4 v4, s[32:35], s92 offen offset:0 lds
    v_mov_b32 v18, 0x3f803f80
    v_cmp_eq_u32 vcc, 0, v5
    v_and_b32 v31, 1, v157
    v_lshlrev_b32 v31, 4, v31
    v_cndmask_b32 v220, 0, v18, vcc
    v_cndmask_b32 v221, 0, v18, vcc
    v_cndmask_b32 v222, 0, v18, vcc
    v_cndmask_b32 v223, 0, v18, vcc
    v_mov_b32 v18, 0x3f80
    v_lshlrev_b32 v18, v31, v18
    v_cmp_gt_u32 vcc, 2, v5
    v_mov_b32 v171, 0
    v_mov_b32 v167, 0
    v_cndmask_b32 v216, 0, v18, vcc
    v_cndmask_b32 v218, 0, v18, vcc
    v_cmp_le_u32 vcc, 2, v5
    v_mov_b32 v163, 0
    v_mov_b32 v159, 0
    v_cndmask_b32 v217, 0, v18, vcc
    v_cndmask_b32 v219, 0, v18, vcc
    v_cmp_eq_u32 vcc, v160, v72
    v_mov_b32 v150, 0
    v_mov_b32 v151, 0
    v_cndmask_b32 v26, 0, v216, vcc
    v_cndmask_b32 v27, 0, v217, vcc
    v_mov_b32 v144, 0
    v_mov_b32 v145, 0
    v_mov_b32 v138, 0
    v_mov_b32 v139, 0
    v_lshrrev_b32 v6, 1, v160
    v_lshl_add_u32 v7, v160, 2, v72
    v_lshl_add_u32 v7, v6, 3, v7
    v_mul_u32_u24 v7, 96, v7
    v_add_u32 v7, s90, v7
    v_lshl_add_u32 v6, v5, 4, v7
    v_lshl_add_u32 v7, v5, 3, v7
    s_waitcnt lgkmcnt(0)
    s_lshl_b32 s84, s68, 4
    s_lshr_b64 s[82:83], s[82:83], s84
    s_lshl_b32 s82, s82, 16
    v_mov_b32 v74, s82
    v_min_f32 v74, 0x40930000, v74
    v_max_f32 v74, 0xc2c80000, v74
    v_mul_f32 v74, 0x3fb8aa3b, v74
    v_exp_f32 v74, v74
    v_mov_b32 v18, 0
    v_cvt_pk_bf16_f32 v74, v74, v74
    v_lshlrev_b32 v74, 16, v74
    v_mul_f32 v74, 0x4038aa3b, v74
    v_mov_b32 v31, 0
    v_readfirstlane_b32 s55, v74
    v_add_f32 v74, v74, v74
    v_mul_u32_u24 v122, 5120, v160
    v_readfirstlane_b32 s52, v74
    v_add_u32 v122, v19, v122
    s_mov_b32 s84, 0x41b8aa3b
    v_mov_b32 v131, 0xc138aa3b
    v_mul_u32_u24 v74, 5120, v72
    v_mad_u32_u24 v74, v5, s86, v74
    v_and_b32 v19, 7, v75
    s_mov_b32 s47, 0
    s_mov_b32 s57, s72
    buffer_load_dwordx4 v156, s[32:35], s92 offen offset:1024 lds
    v_xor_b32 v123, v19, v160
    v_lshl_add_u32 v147, v123, 4, v74
    v_xor_b32 v146, 64, v147
    v_add_u32 v137, 40960, v147
    v_xor_b32 v136, 64, v137
    v_add_u32 v74, 61440, v74
    v_add_u32 v123, s93, v160
    s_mov_b32 s58, 0
    s_mov_b32 s59, 0
    buffer_load_dwordx4 v120, s[32:35], s92 offen offset:2048 lds
    s_add_u32 m0, s90, 12288
    s_mov_b32 s92, 36864
    v_xor_b32 v123, v19, v123
    v_lshl_add_u32 v135, v123, 4, v74
    v_lshrrev_b32 v123, 1, v160
    v_add3_u32 v123, v123, s93, 4
    v_xor_b32 v123, v19, v123
    s_add_u32 s93, s54, 20480
    s_mov_b32 s60, 0
    buffer_load_dwordx4 v4, s[32:35], s92 offen offset:0 lds
    s_waitcnt vmcnt(16)
    v_lshl_or_b32 v16, v17, 16, v16
    v_cmp_gt_u32 vcc, 16, v157
    v_mov_b32 v17, 0
    v_lshl_add_u32 v123, v123, 4, v74
    v_cndmask_b32 v19, 0, v16, vcc
    v_cndmask_b32 v16, 0, v16, vcc
    v_and_b32 v74, 1, v160
    v_mfma_f32_16x16x16_bf16 v[0:3], v[18:19], v[28:29], 0
    s_waitcnt vmcnt(14)
    s_mov_b32 s65, -1
    v_lshl_or_b32 v148, v158, 16, v148
    v_lshl_add_u32 v134, v74, 3, v123
    v_mfma_f32_16x16x16_bf16 v[12:15], v[16:17], v[28:29], 0
    s_mov_b32 s61, 1
    v_lshlrev_b32 v74, 4, v157
    v_add_u32 v133, s93, v74
    v_mfma_f32_16x16x16_bf16 v[20:23], v[16:17], v[30:31], 0
    s_waitcnt vmcnt(12)
    s_lshr_b32 s93, s68, 1
    buffer_load_dwordx4 v156, s[32:35], s92 offen offset:1024 lds
    v_lshl_or_b32 v149, v132, 16, v149
    v_max_f32 v0, 0, v0
    v_max_f32 v12, 0, v12
    v_max_f32 v13, 0, v13
    v_max_f32 v14, 0, v14
    v_max_f32 v15, 0, v15
    v_cvt_pk_bf16_f32 v12, v12, v13
    v_cvt_pk_bf16_f32 v13, v14, v15
    v_max_f32 v1, 0, v1
    v_max_f32 v2, 0, v2
    v_mfma_f32_16x16x16_bf16 v[16:19], v[148:149], v[12:13], 0
    s_lshl_b32 s93, s93, 10
    v_max_f32 v3, 0, v3
    v_cvt_pk_bf16_f32 v0, v0, v1
    v_cvt_pk_bf16_f32 v1, v2, v3
    v_max_f32 v20, 0, v20
    v_max_f32 v21, 0, v21
    v_mfma_f32_16x16x16_bf16 v[12:15], v[148:149], v[0:1], 0
    s_add_u32 s93, s93, s94
    v_max_f32 v22, 0, v22
    v_max_f32 v23, 0, v23
    v_cvt_pk_bf16_f32 v20, v20, v21
    v_cvt_pk_bf16_f32 v21, v22, v23
    v_cvt_pk_bf16_f32 v16, v16, v16
    v_lshlrev_b32 v16, 16, v16
    v_mfma_f32_16x16x16_bf16 v[0:3], v[148:149], v[20:21], 0
    s_movk_i32 s4, 112
    v_mul_f32 v16, 0xbfb8aa3b, v16
    v_cvt_pk_bf16_f32 v12, v12, v12
    v_exp_f32 v16, v16
    v_lshlrev_b32 v12, 16, v12
    v_add_f32 v16, 1.0, v16
    v_rcp_f32 v16, v16
    v_mul_f32 v12, 0xbfb8aa3b, v12
    v_cvt_pk_bf16_f32 v16, v16, v16
    v_lshlrev_b32 v16, 16, v16
    v_fma_f32 v16, v16, s84, v131
    s_mov_b32 s5, 0
    s_mov_b32 s6, 0
    ds_write_b32 v122, v16 offset:44032
    v_exp_f32 v12, v12
    v_cvt_pk_bf16_f32 v0, v0, v0
    v_add_f32 v12, 1.0, v12
    v_rcp_f32 v12, v12
    v_lshlrev_b32 v0, 16, v0
    v_cvt_pk_bf16_f32 v12, v12, v12
    v_lshlrev_b32 v12, 16, v12
    v_fma_f32 v12, v12, s84, v131
    s_mov_b32 s12, 0
    s_mov_b32 s64, 3
    ds_write_b32 v122, v12 offset:44036
    v_mul_f32 v0, 0xbfb8aa3b, v0
    v_exp_f32 v0, v0
    v_add_u32 v129, 81920, v74
    v_add_f32 v0, 1.0, v0
    v_rcp_f32 v0, v0
    v_add_u32 v130, s93, v129
    v_cvt_pk_bf16_f32 v0, v0, v0
    v_lshlrev_b32 v0, 16, v0
    v_fma_f32 v0, v0, s84, v131
    s_mul_i32 s93, s68, 7168
    s_add_u32 s93, s93, 135168
    ds_write_b32 v122, v0 offset:44040
    v_mul_u32_u24 v74, 1792, v160
    v_add_u32 v123, s93, v74
    v_mul_u32_u24 v74, 112, v75
    v_add_u32 v158, v74, v123
    v_subrev_u32 v158, 28672, v158
    v_cmp_eq_u32 vcc, 0, v72
    v_add_u32 v74, 16, v123
    v_mov_b32 v122, 0
    v_cndmask_b32 v132, v73, v123, vcc
    v_cmp_eq_u32 vcc, 3, v5
    s_mov_b32 s10, 81924
    s_mov_b32 s11, 0x20000
    v_cndmask_b32 v132, v132, v74, vcc
    v_mul_u32_u24 v74, 1792, v72
    v_lshl_add_u32 v74, v160, 3, v74
    v_lshl_add_u32 v74, v5, 1, v74
    v_add_u32 v74, s93, v74
    v_cmp_gt_u32 vcc, 3, v160
    v_mov_b32 v123, v74
    s_add_u32 s93, s69, 1
    v_cndmask_b32 v131, v73, v74, vcc
    s_mul_i32 s94, s93, 58255
    s_lshr_b32 s94, s94, 22
    s_mul_i32 s94, s94, s63
    s_mul_i32 s56, s93, s62
    s_add_u32 s56, s56, s94
    s_sub_u32 s93, s71, 1
    s_cmp_eq_u32 s68, 0
    s_cselect_b32 s13, s93, -1
    s_cmp_gt_u32 s73, 20
    s_cselect_b32 s13, s13, -1
    s_and_b32 s93, s2, -8
    s_sub_u32 s93, 81920, s93
    s_waitcnt lgkmcnt(0)
    s_barrier
    s_sub_u32 s8, s38, s93
    s_subb_u32 s9, s39, 0
    s_mov_b32 s3, 0x00010001
    s_add_u32 s101, s54, 44032
    v_mul_u32_u24 v149, 48, v72
    v_lshl_add_u32 v149, v5, 2, v149
    v_mul_u32_u24 v5, 48, v160
    v_add_u32 v199, 0, v149
    v_mul_u32_u24 v148, 37, v199
    v_lshrrev_b32 v148, 10, v148
    v_mad_u32_u24 v199, v148, 24, v199
    v_add_u32 v199, s101, v199
    v_add_u32 v161, 16, v149
    v_mul_u32_u24 v148, 37, v161
    v_lshrrev_b32 v148, 10, v148
    v_mad_u32_u24 v161, v148, 24, v161
    v_add_u32 v161, s101, v161
    v_add_u32 v148, 32, v149
    v_mul_u32_u24 v162, 37, v148
    v_lshrrev_b32 v162, 10, v162
    v_mad_u32_u24 v148, v162, 24, v148
    v_add_u32 v148, s101, v148
    v_add_u32 v176, 0, v5
    v_mul_u32_u24 v162, 37, v176
    v_lshrrev_b32 v162, 10, v162
    v_mad_u32_u24 v176, v162, 24, v176
    v_add_u32 v169, 4, v5
    v_mul_u32_u24 v162, 37, v169
    v_lshrrev_b32 v162, 10, v162
    v_mad_u32_u24 v169, v162, 24, v169
    v_add_u32 v170, 8, v5
    v_mul_u32_u24 v162, 37, v170
    v_lshrrev_b32 v162, 10, v162
    v_mad_u32_u24 v170, v162, 24, v170
    v_add_u32 v183, 12, v5
    v_mul_u32_u24 v162, 37, v183
    v_lshrrev_b32 v162, 10, v162
    v_mad_u32_u24 v183, v162, 24, v183
    v_add_u32 v168, 16, v5
    v_mul_u32_u24 v162, 37, v168
    v_lshrrev_b32 v162, 10, v162
    v_mad_u32_u24 v168, v162, 24, v168
    v_add_u32 v165, 20, v5
    v_mul_u32_u24 v162, 37, v165
    v_lshrrev_b32 v162, 10, v162
    v_mad_u32_u24 v165, v162, 24, v165
    v_add_u32 v166, 24, v5
    v_mul_u32_u24 v162, 37, v166
    v_lshrrev_b32 v162, 10, v162
    v_mad_u32_u24 v166, v162, 24, v166
    v_add_u32 v179, 28, v5
    v_mul_u32_u24 v162, 37, v179
    v_lshrrev_b32 v162, 10, v162
    v_mad_u32_u24 v179, v162, 24, v179
    v_add_u32 v164, 32, v5
    v_mul_u32_u24 v162, 37, v164
    v_lshrrev_b32 v162, 10, v162
    v_mad_u32_u24 v164, v162, 24, v164
    v_add_u32 v74, 36, v5
    v_mul_u32_u24 v72, 37, v74
    v_lshrrev_b32 v72, 10, v72
    v_mad_u32_u24 v74, v72, 24, v74
    v_add_u32 v162, 40, v5
    v_mul_u32_u24 v72, 37, v162
    v_lshrrev_b32 v72, 10, v72
    s_lshr_b32 s93, s68, 1
    s_mul_i32 s93, s93, 30720
    buffer_load_dwordx4 v120, s[32:35], s92 offen offset:2048 lds
    s_add_u32 m0, s90, 24576
    s_mov_b32 s92, 73728
    ds_read_b32 v208, v199
    v_mad_u32_u24 v162, v72, 24, v162
    v_add_u32 v5, 44, v5
    v_mul_u32_u24 v72, 37, v5
    v_lshrrev_b32 v72, 10, v72
    v_mad_u32_u24 v5, v72, 24, v5
    v_lshl_add_u32 v72, v160, 4, v149
    v_mul_u32_u24 v177, 37, v72
    v_lshrrev_b32 v177, 10, v177
    v_mad_u32_u24 v72, v177, 24, v72
    v_mov_b32 v177, 336
    v_cmp_gt_u32 vcc, 3, v160
    v_sub_u32 v204, v199, v176
    s_and_b32 s94, s68, 1
    v_cndmask_b32 v72, v177, v72, vcc
    v_sub_u32 v72, s101, v72
    s_mul_i32 s94, s94, -2304
    s_add_u32 s93, s93, s94
    ds_read_b32 v204, v204 offset:336
    buffer_load_dwordx4 v4, s[32:35], s92 offen offset:0 lds
    v_sub_u32 v205, v199, v169
    v_sub_u32 v206, v199, v170
    v_sub_u32 v207, v199, v183
    v_sub_u32 v200, v199, v168
    s_lshl_b32 s94, s97, 4
    ds_read_b32 v205, v205 offset:336
    v_sub_u32 v201, v199, v165
    v_sub_u32 v202, v199, v166
    v_sub_u32 v203, v199, v179
    v_sub_u32 v196, v199, v164
    buffer_load_dwordx4 v156, s[32:35], s92 offen offset:1024 lds
    ds_read_b32 v206, v206 offset:336
    v_sub_u32 v197, v199, v74
    v_sub_u32 v198, v199, v162
    v_sub_u32 v199, v199, v5
    v_sub_u32 v192, v161, v176
    v_sub_u32 v193, v161, v169
    ds_read_b32 v207, v207 offset:336
    v_sub_u32 v194, v161, v170
    v_sub_u32 v195, v161, v183
    v_sub_u32 v188, v161, v168
    v_sub_u32 v189, v161, v165
    v_sub_u32 v190, v161, v166
    ds_read_b32 v200, v200 offset:336
    v_sub_u32 v191, v161, v179
    v_sub_u32 v184, v161, v164
    v_sub_u32 v185, v161, v74
    v_sub_u32 v186, v161, v162
    buffer_load_dwordx4 v120, s[32:35], s92 offen offset:2048 lds
    s_add_u32 m0, s90, 36864
    s_mov_b32 s92, 110592
    ds_read_b32 v201, v201 offset:336
    v_sub_u32 v187, v161, v5
    v_sub_u32 v180, v148, v176
    v_sub_u32 v181, v148, v169
    v_sub_u32 v182, v148, v170
    v_sub_u32 v183, v148, v183
    s_waitcnt vmcnt(9)
    s_barrier
    ds_read_b32 v202, v202 offset:336
    v_sub_u32 v176, v148, v168
    v_sub_u32 v177, v148, v165
    v_sub_u32 v178, v148, v166
    v_sub_u32 v179, v148, v179
    v_sub_u32 v172, v148, v164
    ds_read_b32 v203, v203 offset:336
    v_sub_u32 v173, v148, v74
    v_sub_u32 v174, v148, v162
    v_sub_u32 v175, v148, v5
    v_mov_b32 v5, 0xf149f2ca
    v_and_b32 v74, 8, v75
    ds_read_b32 v196, v196 offset:336
    v_add_u32 v74, v74, v75
    v_mul_u32_u24 v74, 96, v74
    buffer_load_dwordx4 v4, s[32:35], s92 offen offset:0 lds
    ds_read_b32 v197, v197 offset:336
    v_add_u32 v74, s90, v74
    v_lshl_add_u32 v19, v160, 4, v74
    v_lshl_add_u32 v18, v160, 3, v74
    v_add_u32 v17, s93, v19
    v_add_u32 v16, s93, v18
    s_lshr_b32 s93, s68, 1
    s_mul_i32 s93, s93, 5120
    ds_read_b32 v198, v198 offset:336
    v_lshlrev_b32 v162, 4, v160
    v_add_u32 v162, 4608, v162
    s_add_u32 s93, s93, s94
    v_add_u32 v74, s93, v162
    v_cmp_eq_u32 vcc, 0, v75
    ds_read_b32 v199, v199 offset:336
    buffer_load_dwordx4 v156, s[32:35], s92 offen offset:1024 lds
    v_cndmask_b32 v74, v73, v74, vcc
    ds_read_b32 v211, v72 offset:672
    ds_read_b32 v192, v192 offset:336
    ds_read_b32 v193, v193 offset:336
    buffer_load_dwordx4 v120, s[32:35], s92 offen offset:2048 lds
    s_add_u32 m0, s90, 49152
    s_mov_b32 s92, 147456
    ds_read_b32 v194, v194 offset:336
    ds_read_b32 v195, v195 offset:336
    ds_read_b32 v188, v188 offset:336
    buffer_load_dwordx4 v4, s[32:35], s92 offen offset:0 lds
    ds_read_b32 v189, v189 offset:336
    ds_read_b32 v190, v190 offset:336
    ds_read_b32 v191, v191 offset:336
    ds_read_b32 v184, v184 offset:336
    buffer_load_dwordx4 v156, s[32:35], s92 offen offset:1024 lds
    ds_read_b32 v185, v185 offset:336
    ds_read_b32 v186, v186 offset:336
    ds_read_b32 v187, v187 offset:336
    buffer_load_dwordx4 v120, s[32:35], s92 offen offset:2048 lds
    s_add_u32 m0, s90, 61440
    s_mov_b32 s92, 184320
    ds_read_b32 v209, v161
    ds_read_b32 v180, v180 offset:336
    ds_read_b32 v181, v181 offset:336
    buffer_load_dwordx4 v4, s[32:35], s92 offen offset:0 lds
    ds_read_b32 v182, v182 offset:336
    ds_read_b32 v183, v183 offset:336
    ds_read_b32 v176, v176 offset:336
    ds_read_b32 v177, v177 offset:336
    buffer_load_dwordx4 v156, s[32:35], s92 offen offset:1024 lds
    ds_read_b32 v178, v178 offset:336
    ds_read_b32 v179, v179 offset:336
    ds_read_b32 v172, v172 offset:336
    buffer_load_dwordx4 v120, s[32:35], s92 offen offset:2048 lds
    ds_read_b32 v173, v173 offset:336
    ds_read_b32 v174, v174 offset:336
    ds_read_b32 v175, v175 offset:336
    ds_read_b32 v210, v148
    s_waitcnt vmcnt(15)
    ds_read_b64_tr_b16 a[0:1], v7 offset:0
    ds_read_b64_tr_b16 a[2:3], v7 offset:768
    ds_read_b64_tr_b16 a[24:25], v7 offset:32
    ds_read_b64_tr_b16 a[26:27], v7 offset:800
    ds_read_b64_tr_b16 a[48:49], v7 offset:64
    ds_read_b64_tr_b16 a[50:51], v7 offset:832
    s_add_u32 m0, s90, 0
    s_mov_b32 s92, 384
    s_waitcnt vmcnt(12)
    ds_read_b64_tr_b16 a[4:5], v7 offset:12288
    ds_read_b64_tr_b16 a[6:7], v7 offset:13056
    ds_read_b64_tr_b16 a[28:29], v7 offset:12320
    ds_read_b64_tr_b16 a[30:31], v7 offset:13088
    ds_read_b64_tr_b16 a[52:53], v7 offset:12352
    ds_read_b64_tr_b16 a[54:55], v7 offset:13120
    s_waitcnt vmcnt(9)
    ds_read_b64_tr_b16 a[8:9], v7 offset:24576
    ds_read_b64_tr_b16 a[10:11], v7 offset:25344
    ds_read_b64_tr_b16 a[32:33], v7 offset:24608
    s_waitcnt lgkmcnt(15)
    s_cmp_ge_u32 s2, 248
    s_cbranch_scc1 L_maskS
L_nomaskS:
    v_cmp_gt_u32 vcc, 16, v157
    v_readlane_b32 s84, v211, 48
    ds_read_b64_tr_b16 a[34:35], v7 offset:25376
    v_cndmask_b32 v208, v5, v208, vcc
    v_cndmask_b32 v209, v5, v209, vcc
    v_cndmask_b32 v210, v5, v210, vcc
    v_cmp_gt_u32 vcc, 49, v157
    ds_read_b64_tr_b16 a[56:57], v7 offset:24640
    s_waitcnt lgkmcnt(10)
    buffer_load_dwordx4 v4, s[32:35], s92 offen offset:0 lds
    ds_read_b64_tr_b16 a[58:59], v7 offset:25408
    v_cndmask_b32 v211, v5, v211, vcc
    s_waitcnt vmcnt(7)
    ds_read_b64_tr_b16 a[12:13], v7 offset:36864
    ds_read_b64_tr_b16 a[14:15], v7 offset:37632
    buffer_load_dwordx4 v156, s[32:35], s92 offen offset:1024 lds
    ds_read_b64_tr_b16 a[36:37], v7 offset:36896
    ds_read_b64_tr_b16 a[38:39], v7 offset:37664
    ds_read_b64_tr_b16 a[60:61], v7 offset:36928
    ds_read_b64_tr_b16 a[62:63], v7 offset:37696
    buffer_load_dwordx4 v120, s[32:35], s92 offen offset:2048 lds
    s_add_u32 m0, s90, 12288
    s_mov_b32 s92, 37248
    ds_read_b128 v[60:63], v147 offset:40960
    ds_read_b128 v[56:59], v146 offset:40960
    s_waitcnt lgkmcnt(10)
    buffer_load_dwordx4 v4, s[32:35], s92 offen offset:0 lds
    ds_read_b128 v[52:55], v147 offset:41088
    ds_read_b128 v[48:51], v146 offset:41088
    buffer_load_dwordx4 v156, s[32:35], s92 offen offset:1024 lds
    ds_read_b128 v[40:43], v147 offset:41216
    ds_read_b128 v[0:3], v146 offset:41216
    buffer_load_dwordx4 v120, s[32:35], s92 offen offset:2048 lds
    s_add_u32 m0, s90, 24576
    s_mov_b32 s92, 74112
    s_waitcnt vmcnt(9)
    ds_read_b64_tr_b16 a[16:17], v7 offset:49152
    ds_read_b64_tr_b16 a[18:19], v7 offset:49920
    ds_read_b64_tr_b16 a[40:41], v7 offset:49184
    ds_read_b64_tr_b16 a[42:43], v7 offset:49952
    ds_read_b64_tr_b16 a[64:65], v7 offset:49216
    ds_read_b64_tr_b16 a[66:67], v7 offset:49984
    s_waitcnt lgkmcnt(7)
    buffer_load_dwordx4 v4, s[32:35], s92 offen offset:0 lds
    buffer_load_dwordx4 v156, s[32:35], s92 offen offset:1024 lds
    buffer_load_dwordx4 v120, s[32:35], s92 offen offset:2048 lds
    s_add_u32 m0, s90, 36864
    s_mov_b32 s92, 110976
    s_waitcnt vmcnt(9)
    ds_read_b64_tr_b16 a[20:21], v7 offset:61440
    ds_read_b64_tr_b16 a[22:23], v7 offset:62208
    v_mfma_f32_16x16x32_bf16 v[68:71], a[0:3], v[60:63], 0
    ds_read_b64_tr_b16 a[44:45], v7 offset:61472
    v_mfma_f32_16x16x32_bf16 v[68:71], a[4:7], v[56:59], v[68:71]
    ds_read_b64_tr_b16 a[46:47], v7 offset:62240
    v_mfma_f32_16x16x32_bf16 v[68:71], a[8:11], v[52:55], v[68:71]
    ds_read_b64_tr_b16 a[68:69], v7 offset:61504
    v_mfma_f32_16x16x32_bf16 v[68:71], a[12:15], v[48:51], v[68:71]
    s_waitcnt lgkmcnt(5)
    ds_read_b64_tr_b16 a[70:71], v7 offset:62272
    v_mfma_f32_16x16x32_bf16 v[68:71], a[16:19], v[40:43], v[68:71]
    ds_read_b128 v[44:47], v147 offset:42496
    ds_read_b128 v[36:39], v146 offset:42496
    ds_read_b128 v[32:35], v147 offset:42624
    ds_read_b128 v[28:31], v146 offset:42624
    s_waitcnt lgkmcnt(7)
    v_mfma_f32_16x16x32_bf16 v[68:71], a[20:23], v[0:3], v[68:71]
    ds_read_b128 v[20:23], v147 offset:42752
    s_nop 0
    v_mfma_f32_16x16x32_bf16 v[92:95], a[24:27], v[60:63], 0
    s_nop 0
    ds_read_b128 v[12:15], v146 offset:42752
    s_nop 0
    v_mfma_f32_16x16x32_bf16 v[92:95], a[28:31], v[56:59], v[92:95]
    s_nop 0
    v_fma_f32 v5, v68, v68, s41
    v_fmac_f32 v5, v69, v69
    v_mfma_f32_16x16x32_bf16 v[92:95], a[32:35], v[52:55], v[92:95]
    v_fmac_f32 v5, v70, v70
    v_fmac_f32 v5, v71, v71
    v_mfma_f32_16x16x32_bf16 v[92:95], a[36:39], v[48:51], v[92:95]
    v_mfma_f32_16x16x32_bf16 v[92:95], a[40:43], v[40:43], v[92:95]
    s_waitcnt lgkmcnt(4)
    v_mfma_f32_16x16x32_bf16 v[92:95], a[44:47], v[0:3], v[92:95]
    s_nop 0
    buffer_load_dwordx4 v4, s[32:35], s92 offen offset:0 lds
    v_mfma_f32_16x16x32_bf16 v[88:91], a[48:51], v[60:63], 0
    s_nop 2
    v_mfma_f32_16x16x32_bf16 v[88:91], a[52:55], v[56:59], v[88:91]
    s_nop 0
    v_fmac_f32 v5, v92, v92
    v_fmac_f32 v5, v93, v93
    v_mfma_f32_16x16x32_bf16 v[88:91], a[56:59], v[52:55], v[88:91]
    v_fmac_f32 v5, v94, v94
    v_fmac_f32 v5, v95, v95
    v_mfma_f32_16x16x32_bf16 v[88:91], a[60:63], v[48:51], v[88:91]
    v_mfma_f32_16x16x32_bf16 v[88:91], a[64:67], v[40:43], v[88:91]
    buffer_load_dwordx4 v156, s[32:35], s92 offen offset:1024 lds
    v_mfma_f32_16x16x32_bf16 v[88:91], a[68:71], v[0:3], v[88:91]
    s_nop 0
    v_mfma_f32_16x16x32_bf16 v[0:3], a[0:3], v[44:47], 0
    s_nop 2
    v_mfma_f32_16x16x32_bf16 v[0:3], a[4:7], v[36:39], v[0:3]
    s_waitcnt lgkmcnt(0)
    s_nop 0
    v_fmac_f32 v5, v88, v88
    v_fmac_f32 v5, v89, v89
    v_mfma_f32_16x16x32_bf16 v[0:3], a[8:11], v[32:35], v[0:3]
    v_fmac_f32 v5, v90, v90
    v_fmac_f32 v5, v91, v91
    v_mfma_f32_16x16x32_bf16 v[0:3], a[12:15], v[28:31], v[0:3]
    ds_read_b128 v[100:103], v147 offset:40960
    buffer_load_dwordx4 v120, s[32:35], s92 offen offset:2048 lds
    v_mfma_f32_16x16x32_bf16 v[0:3], a[16:19], v[20:23], v[0:3]
    s_waitcnt vmcnt(9)
    s_add_u32 m0, s90, 49152
    ds_read_b64_tr_b16 a[72:73], v7 offset:0
    v_mfma_f32_16x16x32_bf16 v[0:3], a[20:23], v[12:15], v[0:3]
    s_mov_b32 s92, 147840
    ds_read_b64_tr_b16 a[74:75], v7 offset:768
    v_mfma_f32_16x16x32_bf16 v[56:59], a[24:27], v[44:47], 0
    ds_read_b64_tr_b16 a[96:97], v7 offset:32
    s_nop 0
    v_mfma_f32_16x16x32_bf16 v[56:59], a[28:31], v[36:39], v[56:59]
    s_nop 0
    ds_read_b64_tr_b16 a[98:99], v7 offset:800
    v_fma_f32 v72, v0, v0, s41
    v_mfma_f32_16x16x32_bf16 v[56:59], a[32:35], v[32:35], v[56:59]
    ds_read_b64_tr_b16 a[120:121], v7 offset:64
    buffer_load_dwordx4 v4, s[32:35], s92 offen offset:0 lds
    v_mfma_f32_16x16x32_bf16 v[56:59], a[36:39], v[28:31], v[56:59]
    ds_read_b64_tr_b16 a[122:123], v7 offset:832
    v_fmac_f32 v72, v1, v1
    v_mfma_f32_16x16x32_bf16 v[56:59], a[40:43], v[20:23], v[56:59]
    ds_read_b128 v[64:67], v146 offset:40960
    v_fmac_f32 v72, v2, v2
    v_mfma_f32_16x16x32_bf16 v[56:59], a[44:47], v[12:15], v[56:59]
    ds_read_b128 v[52:55], v147 offset:41088
    v_fmac_f32 v72, v3, v3
    v_mfma_f32_16x16x32_bf16 v[40:43], a[48:51], v[44:47], 0
    ds_read_b128 v[48:51], v146 offset:41088
    v_mfma_f32_16x16x32_bf16 v[40:43], a[52:55], v[36:39], v[40:43]
    ds_read_b128 v[44:47], v147 offset:41216
    buffer_load_dwordx4 v156, s[32:35], s92 offen offset:1024 lds
    v_mfma_f32_16x16x32_bf16 v[40:43], a[56:59], v[32:35], v[40:43]
    ds_read_b128 v[32:35], v146 offset:41216
    v_fmac_f32 v72, v56, v56
    v_mfma_f32_16x16x32_bf16 v[40:43], a[60:63], v[28:31], v[40:43]
    v_fmac_f32 v72, v57, v57
    v_fmac_f32 v72, v58, v58
    v_mfma_f32_16x16x32_bf16 v[40:43], a[64:67], v[20:23], v[40:43]
    v_fmac_f32 v72, v59, v59
    v_mfma_f32_16x16x32_bf16 v[40:43], a[68:71], v[12:15], v[40:43]
    s_waitcnt vmcnt(8)
    s_nop 2
    buffer_load_dwordx4 v120, s[32:35], s92 offen offset:2048 lds
    s_add_u32 m0, s90, 61440
    s_mov_b32 s92, 184704
    ds_read_b64_tr_b16 a[76:77], v7 offset:12288
    v_fmac_f32 v72, v40, v40
    ds_read_b64_tr_b16 a[78:79], v7 offset:13056
    v_fmac_f32 v72, v41, v41
    ds_read_b64_tr_b16 a[100:101], v7 offset:12320
    v_fmac_f32 v72, v42, v42
    ds_read_b64_tr_b16 a[102:103], v7 offset:13088
    v_fmac_f32 v72, v43, v43
    ds_read_b64_tr_b16 a[124:125], v7 offset:12352
    buffer_load_dwordx4 v4, s[32:35], s92 offen offset:0 lds
    ds_read_b64_tr_b16 a[126:127], v7 offset:13120
    buffer_load_dwordx4 v156, s[32:35], s92 offen offset:1024 lds
    buffer_load_dwordx4 v120, s[32:35], s92 offen offset:2048 lds
    s_add_u32 m0, s90, 0
    s_mov_b32 s92, 768
    s_waitcnt vmcnt(9)
    ds_read_b64_tr_b16 a[80:81], v7 offset:24576
    ds_read_b64_tr_b16 a[82:83], v7 offset:25344
    ds_read_b64_tr_b16 a[104:105], v7 offset:24608
    ds_read_b64_tr_b16 a[106:107], v7 offset:25376
    ds_read_b64_tr_b16 a[128:129], v7 offset:24640
    ds_read_b64_tr_b16 a[130:131], v7 offset:25408
    s_waitcnt lgkmcnt(6)
    buffer_load_dwordx4 v4, s[32:35], s92 offen offset:0 lds
    buffer_load_dwordx4 v156, s[32:35], s92 offen offset:1024 lds
    buffer_load_dwordx4 v120, s[32:35], s92 offen offset:2048 lds
    s_add_u32 m0, s90, 12288
    s_mov_b32 s92, 37632
    s_waitcnt vmcnt(9)
    ds_read_b64_tr_b16 a[84:85], v7 offset:36864
    ds_read_b64_tr_b16 a[86:87], v7 offset:37632
    ds_read_b64_tr_b16 a[108:109], v7 offset:36896
    ds_read_b64_tr_b16 a[110:111], v7 offset:37664
    ds_read_b64_tr_b16 a[132:133], v7 offset:36928
    ds_read_b64_tr_b16 a[134:135], v7 offset:37696
    buffer_load_dwordx4 v4, s[32:35], s92 offen offset:0 lds
    buffer_load_dwordx4 v156, s[32:35], s92 offen offset:1024 lds
    buffer_load_dwordx4 v120, s[32:35], s92 offen offset:2048 lds
    s_add_u32 m0, s90, 24576
    s_mov_b32 s92, 74496
    s_waitcnt vmcnt(9)
    ds_read_b64_tr_b16 a[88:89], v7 offset:49152
    ds_read_b64_tr_b16 a[90:91], v7 offset:49920
    ds_read_b64_tr_b16 a[112:113], v7 offset:49184
    ds_read_b64_tr_b16 a[114:115], v7 offset:49952
    ds_read_b64_tr_b16 a[136:137], v7 offset:49216
    ds_read_b64_tr_b16 a[138:139], v7 offset:49984
    s_waitcnt lgkmcnt(6)
    buffer_load_dwordx4 v4, s[32:35], s92 offen offset:0 lds
    buffer_load_dwordx4 v156, s[32:35], s92 offen offset:1024 lds
    buffer_load_dwordx4 v120, s[32:35], s92 offen offset:2048 lds
    s_add_u32 m0, s90, 36864
    s_mov_b32 s92, 111360
    s_waitcnt vmcnt(9)
    ds_read_b64_tr_b16 a[92:93], v7 offset:61440
    ds_read_b64_tr_b16 a[94:95], v7 offset:62208
    v_mfma_f32_16x16x32_bf16 v[36:39], a[72:75], v[100:103], 0
    ds_read_b64_tr_b16 a[116:117], v7 offset:61472
    v_mfma_f32_16x16x32_bf16 v[36:39], a[76:79], v[64:67], v[36:39]
    ds_read_b64_tr_b16 a[118:119], v7 offset:62240
    v_mfma_f32_16x16x32_bf16 v[36:39], a[80:83], v[52:55], v[36:39]
    ds_read_b64_tr_b16 a[140:141], v7 offset:61504
    v_mfma_f32_16x16x32_bf16 v[36:39], a[84:87], v[48:51], v[36:39]
    s_waitcnt lgkmcnt(5)
    buffer_load_dwordx4 v4, s[32:35], s92 offen offset:0 lds
    ds_read_b64_tr_b16 a[142:143], v7 offset:62272
    v_mfma_f32_16x16x32_bf16 v[36:39], a[88:91], v[44:47], v[36:39]
    ds_read_b128 v[96:99], v147 offset:42496
    ds_read_b128 v[80:83], v146 offset:42496
    ds_read_b128 v[28:31], v147 offset:42624
    ds_read_b128 v[20:23], v146 offset:42624
    s_waitcnt lgkmcnt(7)
    v_mfma_f32_16x16x32_bf16 v[36:39], a[92:95], v[32:35], v[36:39]
    buffer_load_dwordx4 v156, s[32:35], s92 offen offset:1024 lds
    ds_read_b128 v[60:63], v147 offset:42752
    v_mfma_f32_16x16x32_bf16 v[84:87], a[96:99], v[100:103], 0
    s_nop 1
    ds_read_b128 v[12:15], v146 offset:42752
    v_mfma_f32_16x16x32_bf16 v[84:87], a[100:103], v[64:67], v[84:87]
    s_nop 0
    v_fma_f32 v157, v36, v36, s41
    v_fmac_f32 v157, v37, v37
    v_mfma_f32_16x16x32_bf16 v[84:87], a[104:107], v[52:55], v[84:87]
    v_fmac_f32 v157, v38, v38
    v_fmac_f32 v157, v39, v39
    v_mfma_f32_16x16x32_bf16 v[84:87], a[108:111], v[48:51], v[84:87]
    v_mfma_f32_16x16x32_bf16 v[84:87], a[112:115], v[44:47], v[84:87]
    s_waitcnt vmcnt(8) lgkmcnt(4)
    buffer_load_dwordx4 v120, s[32:35], s92 offen offset:2048 lds
    ds_read_b64_tr_b16 a[144:145], v6 offset:0
    v_mfma_f32_16x16x32_bf16 v[84:87], a[116:119], v[32:35], v[84:87]
    s_add_u32 m0, s90, 49152
    ds_read_b64_tr_b16 a[146:147], v6 offset:768
    v_mfma_f32_16x16x32_bf16 v[76:79], a[120:123], v[100:103], 0
    s_mov_b32 s92, 148224
    s_nop 0
    ds_read_b64_tr_b16 a[168:169], v6 offset:8
    v_mfma_f32_16x16x32_bf16 v[76:79], a[124:127], v[64:67], v[76:79]
    s_nop 0
    v_fmac_f32 v157, v84, v84
    v_fmac_f32 v157, v85, v85
    v_mfma_f32_16x16x32_bf16 v[76:79], a[128:131], v[52:55], v[76:79]
    ds_read_b64_tr_b16 a[170:171], v6 offset:776
    v_fmac_f32 v157, v86, v86
    v_mfma_f32_16x16x32_bf16 v[76:79], a[132:135], v[48:51], v[76:79]
    buffer_load_dwordx4 v4, s[32:35], s92 offen offset:0 lds
    ds_read_b64_tr_b16 a[192:193], v7 offset:64
    v_mfma_f32_16x16x32_bf16 v[76:79], a[136:139], v[44:47], v[76:79]
    ds_read_b64_tr_b16 a[194:195], v7 offset:832
    v_fmac_f32 v157, v87, v87
    v_mfma_f32_16x16x32_bf16 v[76:79], a[140:143], v[32:35], v[76:79]
    s_nop 0
    v_mfma_f32_16x16x32_bf16 v[52:55], a[72:75], v[96:99], 0
    s_nop 2
    v_mfma_f32_16x16x32_bf16 v[52:55], a[76:79], v[80:83], v[52:55]
    s_waitcnt lgkmcnt(5)
    s_nop 0
    v_fmac_f32 v157, v76, v76
    v_fmac_f32 v157, v77, v77
    v_mfma_f32_16x16x32_bf16 v[52:55], a[80:83], v[28:31], v[52:55]
    buffer_load_dwordx4 v156, s[32:35], s92 offen offset:1024 lds
    v_fmac_f32 v157, v78, v78
    v_mfma_f32_16x16x32_bf16 v[52:55], a[84:87], v[20:23], v[52:55]
    v_fmac_f32 v157, v79, v79
    v_cvt_pk_bf16_f32 v170, v5, v157
    v_mfma_f32_16x16x32_bf16 v[52:55], a[88:91], v[60:63], v[52:55]
    v_mfma_f32_16x16x32_bf16 v[52:55], a[92:95], v[12:15], v[52:55]
    ds_read_b128 v[64:67], v147 offset:40960
    v_mfma_f32_16x16x32_bf16 v[48:51], a[96:99], v[96:99], 0
    ds_read_b128 v[32:35], v146 offset:40960
    v_mfma_f32_16x16x32_bf16 v[48:51], a[100:103], v[80:83], v[48:51]
    s_waitcnt vmcnt(8)
    buffer_load_dwordx4 v120, s[32:35], s92 offen offset:2048 lds
    ds_read_b64_tr_b16 a[148:149], v6 offset:12288
    v_mfma_f32_16x16x32_bf16 v[48:51], a[104:107], v[28:31], v[48:51]
    s_add_u32 m0, s90, 61440
    v_fma_f32 v157, v52, v52, s41
    v_fmac_f32 v157, v53, v53
    v_mfma_f32_16x16x32_bf16 v[48:51], a[108:111], v[20:23], v[48:51]
    s_mov_b32 s92, 185088
    ds_read_b64_tr_b16 a[150:151], v6 offset:13056
    v_fmac_f32 v157, v54, v54
    v_mfma_f32_16x16x32_bf16 v[48:51], a[112:115], v[60:63], v[48:51]
    ds_read_b64_tr_b16 a[172:173], v6 offset:12296
    v_fmac_f32 v157, v55, v55
    v_mfma_f32_16x16x32_bf16 v[48:51], a[116:119], v[12:15], v[48:51]
    ds_read_b64_tr_b16 a[174:175], v6 offset:13064
    v_mfma_f32_16x16x32_bf16 v[44:47], a[120:123], v[96:99], 0
    s_nop 0
    buffer_load_dwordx4 v4, s[32:35], s92 offen offset:0 lds
    ds_read_b64_tr_b16 a[196:197], v7 offset:12352
    v_mfma_f32_16x16x32_bf16 v[44:47], a[124:127], v[80:83], v[44:47]
    s_nop 0
    ds_read_b64_tr_b16 a[198:199], v7 offset:13120
    v_fmac_f32 v157, v48, v48
    v_mfma_f32_16x16x32_bf16 v[44:47], a[128:131], v[28:31], v[44:47]
    ds_read_b128 v[28:31], v147 offset:41088
    v_fmac_f32 v157, v49, v49
    v_mfma_f32_16x16x32_bf16 v[44:47], a[132:135], v[20:23], v[44:47]
    ds_read_b128 v[20:23], v146 offset:41088
    v_fmac_f32 v157, v50, v50
    v_mfma_f32_16x16x32_bf16 v[44:47], a[136:139], v[60:63], v[44:47]
    ds_read_b128 v[60:63], v147 offset:41216
    v_fmac_f32 v157, v51, v51
    v_mfma_f32_16x16x32_bf16 v[44:47], a[140:143], v[12:15], v[44:47]
    s_nop 0
    buffer_load_dwordx4 v156, s[32:35], s92 offen offset:1024 lds
    ds_read_b128 v[12:15], v146 offset:41216
    v_mfma_f32_16x16x16_bf16 v[80:83], v[216:217], v[170:171], 0
    s_nop 0
    v_mov_b32 v168, 0
    v_mov_b32 v169, 0
    v_mov_b32 v149, 0
    v_fmac_f32 v157, v44, v44
    v_fmac_f32 v157, v45, v45
    v_fmac_f32 v157, v46, v46
    v_fmac_f32 v157, v47, v47
    v_rsq_f32 v80, v80
    v_rsq_f32 v81, v81
    v_mul_f32 v80, s55, v80
    v_mul_f32 v81, 0.5, v81
    v_mul_f32 v68, v68, v80
    buffer_load_dwordx4 v120, s[32:35], s92 offen offset:2048 lds
    s_add_u32 m0, s90, 0
    s_mov_b32 s92, 0
    s_waitcnt vmcnt(9)
    ds_read_b64_tr_b16 a[152:153], v6 offset:24576
    v_mul_f32 v69, v69, v80
    v_cvt_pk_f16_f32 v68, v68, v69
    v_mul_f32 v70, v70, v80
    ds_read_b64_tr_b16 a[154:155], v6 offset:25344
    v_mul_f32 v71, v71, v80
    v_cvt_pk_f16_f32 v69, v70, v71
    v_mul_f32 v92, v92, v80
    ds_read_b64_tr_b16 a[176:177], v6 offset:24584
    v_mul_f32 v93, v93, v80
    v_cvt_pk_f16_f32 v70, v92, v93
    s_waitcnt lgkmcnt(3)
    buffer_load_dwordx4 v121, s[76:79], s92 offen offset:0 lds
    ds_read_b64_tr_b16 a[178:179], v6 offset:25352
    v_mul_f32 v94, v94, v80
    v_mul_f32 v95, v95, v80
    v_cvt_pk_f16_f32 v71, v94, v95
    ds_read_b64_tr_b16 a[200:201], v7 offset:24640
    v_mul_f32 v88, v88, v80
    ds_read_b64_tr_b16 a[202:203], v7 offset:25408
    v_mul_f32 v89, v89, v80
    v_cvt_pk_f16_f32 v160, v88, v89
    v_mul_f32 v90, v90, v80
    v_mul_f32 v91, v91, v80
    v_cvt_pk_f16_f32 v161, v90, v91
    v_mul_f32 v36, v36, v81
    buffer_load_dwordx4 v25, s[76:79], s92 offen offset:1024 lds
    v_mul_f32 v37, v37, v81
    v_cvt_pk_f16_f32 v36, v36, v37
    v_mul_f32 v38, v38, v81
    v_mul_f32 v39, v39, v81
    v_cvt_pk_f16_f32 v37, v38, v39
    v_mul_f32 v84, v84, v81
    v_mul_f32 v85, v85, v81
    v_cvt_pk_f16_f32 v38, v84, v85
    v_mul_f32 v86, v86, v81
    v_mul_f32 v87, v87, v81
    v_cvt_pk_f16_f32 v39, v86, v87
    v_mul_f32 v76, v76, v81
    v_mul_f32 v77, v77, v81
    v_cvt_pk_f16_f32 v4, v76, v77
    v_mul_f32 v78, v78, v81
    v_mul_f32 v79, v79, v81
    v_cvt_pk_f16_f32 v5, v78, v79
    buffer_load_dwordx4 v24, s[76:79], s92 offen offset:2048 lds
    s_add_u32 m0, s90, 12288
    s_mov_b32 s92, 12288
    s_waitcnt vmcnt(9)
    ds_read_b64_tr_b16 a[156:157], v6 offset:36864
    v_fma_mix_f32 v148, v68, v36, 0 op_sel:[0,0,0] op_sel_hi:[1,1,0]
    v_fma_mix_f32 v148, v68, v36, v148 op_sel:[1,1,0] op_sel_hi:[1,1,0]
    v_fma_mix_f32 v148, v69, v37, v148 op_sel:[0,0,0] op_sel_hi:[1,1,0]
    ds_read_b64_tr_b16 a[158:159], v6 offset:37632
    v_fma_mix_f32 v148, v69, v37, v148 op_sel:[1,1,0] op_sel_hi:[1,1,0]
    v_fma_mix_f32 v148, v70, v38, v148 op_sel:[0,0,0] op_sel_hi:[1,1,0]
    v_fma_mix_f32 v148, v70, v38, v148 op_sel:[1,1,0] op_sel_hi:[1,1,0]
    ds_read_b64_tr_b16 a[180:181], v6 offset:36872
    v_fma_mix_f32 v148, v71, v39, v148 op_sel:[0,0,0] op_sel_hi:[1,1,0]
    v_fma_mix_f32 v148, v71, v39, v148 op_sel:[1,1,0] op_sel_hi:[1,1,0]
    buffer_load_dwordx4 v121, s[76:79], s92 offen offset:0 lds
    ds_read_b64_tr_b16 a[182:183], v6 offset:37640
    v_fma_mix_f32 v148, v160, v4, v148 op_sel:[0,0,0] op_sel_hi:[1,1,0]
    v_fma_mix_f32 v148, v160, v4, v148 op_sel:[1,1,0] op_sel_hi:[1,1,0]
    v_fma_mix_f32 v148, v161, v5, v148 op_sel:[0,0,0] op_sel_hi:[1,1,0]
    ds_read_b64_tr_b16 a[204:205], v7 offset:36928
    v_fma_mix_f32 v148, v161, v5, v148 op_sel:[1,1,0] op_sel_hi:[1,1,0]
    ds_read_b64_tr_b16 a[206:207], v7 offset:37696
    v_mov_b32 v120, v148
    v_add_u32 v156, 28672, v158
    ds_write_b128 v156, v[36:39]
    buffer_load_dwordx4 v25, s[76:79], s92 offen offset:1024 lds
    v_permlane32_swap_b32 v120, v148
    v_add_f32 v148, v120, v148
    v_mov_b32 v120, v148
    v_cvt_pk_bf16_f32 v170, v72, v157
    s_nop 0
    v_permlane16_swap_b32 v120, v148
    v_mfma_f32_16x16x16_bf16 v[36:39], v[216:217], v[170:171], 0
    s_waitcnt vmcnt(8)
    ds_write2_b64 v156, v[168:169], v[168:169] offset0:2 offset1:3
    v_add_f32 v148, v120, v148
    buffer_load_dwordx4 v24, s[76:79], s92 offen offset:2048 lds
    s_add_u32 m0, s90, 24576
    s_mov_b32 s92, 24576
    v_and_b32 v120, 0xffff0000, v148
    v_sub_f32 v148, v148, v120
    ds_read_b64_tr_b16 a[160:161], v6 offset:49152
    v_cvt_pk_bf16_f32 v148, v148, v120
    v_rsq_f32 v36, v36
    ds_read_b64_tr_b16 a[162:163], v6 offset:49920
    v_rsq_f32 v37, v37
    v_mul_f32 v36, s55, v36
    s_waitcnt lgkmcnt(3)
    buffer_load_dwordx4 v121, s[76:79], s92 offen offset:0 lds
    ds_read_b64_tr_b16 a[184:185], v6 offset:49160
    v_mul_f32 v37, 0.5, v37
    v_mul_f32 v0, v0, v36
    v_mul_f32 v1, v1, v36
    ds_read_b64_tr_b16 a[186:187], v6 offset:49928
    v_cvt_pk_f16_f32 v0, v0, v1
    v_mul_f32 v2, v2, v36
    v_mul_f32 v3, v3, v36
    ds_read_b64_tr_b16 a[208:209], v7 offset:49216
    v_cvt_pk_f16_f32 v1, v2, v3
    ds_read_b64_tr_b16 a[210:211], v7 offset:49984
    v_mul_f32 v56, v56, v36
    buffer_load_dwordx4 v25, s[76:79], s92 offen offset:1024 lds
    ds_write_b128 v156, v[68:71] offset:32
    v_mul_f32 v57, v57, v36
    v_cvt_pk_f16_f32 v2, v56, v57
    v_mul_f32 v58, v58, v36
    v_mul_f32 v59, v59, v36
    v_cvt_pk_f16_f32 v3, v58, v59
    v_mul_f32 v40, v40, v36
    v_mul_f32 v41, v41, v36
    v_cvt_pk_f16_f32 v254, v40, v41
    ds_write2_b64 v156, v[4:5], v[168:169] offset0:6 offset1:7
    buffer_load_dwordx4 v24, s[76:79], s92 offen offset:2048 lds
    s_add_u32 m0, s90, 36864
    s_mov_b32 s92, 36864
    v_mul_f32 v42, v42, v36
    v_mul_f32 v43, v43, v36
    v_cvt_pk_f16_f32 v255, v42, v43
    v_mul_f32 v52, v52, v37
    v_mul_f32 v53, v53, v37
    s_waitcnt vmcnt(9)
    ds_read_b64_tr_b16 a[164:165], v6 offset:61440
    v_cvt_pk_f16_f32 v4, v52, v53
    v_mul_f32 v54, v54, v37
    v_mul_f32 v55, v55, v37
    ds_read_b64_tr_b16 a[166:167], v6 offset:62208
    v_mfma_f32_16x16x32_bf16 v[40:43], a[144:147], v[64:67], 0
    buffer_load_dwordx4 v121, s[76:79], s92 offen offset:0 lds
    ds_read_b64_tr_b16 a[188:189], v6 offset:61448
    v_mfma_f32_16x16x32_bf16 v[40:43], a[148:151], v[32:35], v[40:43]
    v_cvt_pk_f16_f32 v5, v54, v55
    v_mul_f32 v48, v48, v37
    v_mfma_f32_16x16x32_bf16 v[40:43], a[152:155], v[28:31], v[40:43]
    ds_read_b64_tr_b16 a[190:191], v6 offset:62216
    v_mul_f32 v49, v49, v37
    v_mfma_f32_16x16x32_bf16 v[40:43], a[156:159], v[20:23], v[40:43]
    s_waitcnt lgkmcnt(4)
    ds_read_b64_tr_b16 a[212:213], v7 offset:61504
    v_cvt_pk_f16_f32 v6, v48, v49
    v_mfma_f32_16x16x32_bf16 v[40:43], a[160:163], v[60:63], v[40:43]
    ds_read_b64_tr_b16 a[214:215], v7 offset:62272
    v_mul_f32 v50, v50, v37
    v_mul_f32 v51, v51, v37
    v_cvt_pk_f16_f32 v7, v50, v51
    buffer_load_dwordx4 v25, s[76:79], s92 offen offset:1024 lds
    ds_write2_b64 v156, v[168:169], v[160:161] offset0:8 offset1:9
    v_mul_f32 v44, v44, v37
    v_mul_f32 v45, v45, v37
    v_cvt_pk_f16_f32 v160, v44, v45
    v_mul_f32 v46, v46, v37
    s_waitcnt lgkmcnt(5)
    v_mfma_f32_16x16x32_bf16 v[40:43], a[164:167], v[12:15], v[40:43]
    v_mul_f32 v47, v47, v37
    v_cvt_pk_f16_f32 v161, v46, v47
    v_mfma_f32_16x16x32_bf16 v[52:55], a[168:171], v[64:67], 0
    buffer_load_dwordx4 v24, s[76:79], s92 offen offset:2048 lds
    ds_read_b128 v[48:51], v147 offset:42496
    v_mfma_f32_16x16x32_bf16 v[52:55], a[172:175], v[32:35], v[52:55]
    s_add_u32 m0, s90, 49152
    v_fma_mix_f32 v120, v0, v4, 0 op_sel:[0,0,0] op_sel_hi:[1,1,0]
    v_fma_mix_f32 v120, v0, v4, v120 op_sel:[1,1,0] op_sel_hi:[1,1,0]
    v_mfma_f32_16x16x32_bf16 v[52:55], a[176:179], v[28:31], v[52:55]
    s_mov_b32 s92, 49152
    ds_write_b64 v156, v[148:149] offset:88
    v_mfma_f32_16x16x32_bf16 v[52:55], a[180:183], v[20:23], v[52:55]
    s_lshl_b32 s93, s68, 10
    v_fma_mix_f32 v120, v1, v5, v120 op_sel:[0,0,0] op_sel_hi:[1,1,0]
    v_fma_mix_f32 v120, v1, v5, v120 op_sel:[1,1,0] op_sel_hi:[1,1,0]
    v_mfma_f32_16x16x32_bf16 v[52:55], a[184:187], v[60:63], v[52:55]
    s_waitcnt lgkmcnt(3)
    s_mov_b32 s53, s47
    ds_read_b128 v[44:47], v146 offset:42496
    v_fma_mix_f32 v120, v2, v6, v120 op_sel:[0,0,0] op_sel_hi:[1,1,0]
    v_mfma_f32_16x16x32_bf16 v[52:55], a[188:191], v[12:15], v[52:55]
    s_mov_b32 s47, s46
    buffer_load_dwordx4 v121, s[76:79], s92 offen offset:0 lds
    ds_read_b128 v[36:39], v147 offset:42624
    v_mfma_f32_16x16x32_bf16 v[56:59], a[192:195], v[64:67], 0
    s_mov_b32 s46, s45
    v_fma_mix_f32 v120, v2, v6, v120 op_sel:[1,1,0] op_sel_hi:[1,1,0]
    v_fma_mix_f32 v120, v3, v7, v120 op_sel:[0,0,0] op_sel_hi:[1,1,0]
    v_mfma_f32_16x16x32_bf16 v[56:59], a[196:199], v[32:35], v[56:59]
    s_mov_b32 s45, s44
    ds_read_b128 v[32:35], v146 offset:42624
    v_fma_mix_f32 v120, v3, v7, v120 op_sel:[1,1,0] op_sel_hi:[1,1,0]
    v_mfma_f32_16x16x32_bf16 v[56:59], a[200:203], v[28:31], v[56:59]
    s_mov_b32 s44, s53
    ds_read_b128 v[28:31], v147 offset:42752
    v_fma_mix_f32 v120, v254, v160, v120 op_sel:[0,0,0] op_sel_hi:[1,1,0]
    v_mfma_f32_16x16x32_bf16 v[56:59], a[204:207], v[20:23], v[56:59]
    s_sub_u32 s48, s44, s46
    ds_read_b128 v[20:23], v146 offset:42752
    v_fma_mix_f32 v120, v254, v160, v120 op_sel:[1,1,0] op_sel_hi:[1,1,0]
    v_mfma_f32_16x16x32_bf16 v[56:59], a[208:211], v[60:63], v[56:59]
    s_sub_u32 s49, s46, s45
    buffer_load_dwordx4 v25, s[76:79], s92 offen offset:1024 lds
    v_fma_mix_f32 v120, v255, v161, v120 op_sel:[0,0,0] op_sel_hi:[1,1,0]
    v_mfma_f32_16x16x32_bf16 v[56:59], a[212:215], v[12:15], v[56:59]
    s_waitcnt lgkmcnt(5)
    v_fma_mix_f32 v120, v255, v161, v120 op_sel:[1,1,0] op_sel_hi:[1,1,0]
    v_mov_b32 v146, v120
    v_mfma_f32_16x16x32_bf16 v[12:15], a[144:147], v[48:51], 0
    s_waitcnt lgkmcnt(4)
    v_permlane32_swap_b32 v146, v120
    v_add_f32 v120, v146, v120
    v_mfma_f32_16x16x32_bf16 v[12:15], a[148:151], v[44:47], v[12:15]
    s_waitcnt lgkmcnt(3)
    v_mov_b32 v146, v120
    v_cvt_pk_bf16_f32 v148, v40, v41
    v_cvt_pk_bf16_f32 v149, v42, v43
    v_mfma_f32_16x16x32_bf16 v[12:15], a[152:155], v[36:39], v[12:15]
    s_waitcnt lgkmcnt(2)
    ds_write_b64 v158, v[148:149] offset:28752
    buffer_load_dwordx4 v24, s[76:79], s92 offen offset:2048 lds
    s_add_u32 m0, s90, 61440
    v_mfma_f32_16x16x32_bf16 v[12:15], a[156:159], v[32:35], v[12:15]
    s_waitcnt lgkmcnt(2)
    s_mov_b32 s92, 61440
    v_permlane16_swap_b32 v146, v120
    v_mfma_f32_16x16x32_bf16 v[12:15], a[160:163], v[28:31], v[12:15]
    s_waitcnt lgkmcnt(1)
    v_add_f32 v120, v146, v120
    v_and_b32 v146, 0xffff0000, v120
    v_mfma_f32_16x16x32_bf16 v[12:15], a[164:167], v[20:23], v[12:15]
    v_sub_f32 v120, v120, v146
    v_cvt_pk_bf16_f32 v120, v120, v146
    v_mfma_f32_16x16x32_bf16 v[40:43], a[168:171], v[48:51], 0
    v_cvt_pk_bf16_f32 v52, v52, v53
    v_cvt_pk_bf16_f32 v53, v54, v55
    v_mfma_f32_16x16x32_bf16 v[40:43], a[172:175], v[44:47], v[40:43]
    buffer_load_dwordx4 v121, s[76:79], s92 offen offset:0 lds
    v_cvt_pk_bf16_f32 v54, v56, v57
    v_mfma_f32_16x16x32_bf16 v[40:43], a[176:179], v[36:39], v[40:43]
    v_cvt_pk_bf16_f32 v55, v58, v59
    v_cvt_pk_bf16_f32 v156, v12, v13
    v_mfma_f32_16x16x32_bf16 v[40:43], a[180:183], v[32:35], v[40:43]
    ds_write_b128 v158, v[52:55] offset:28768
    v_mfma_f32_16x16x32_bf16 v[40:43], a[184:187], v[28:31], v[40:43]
    v_cvt_pk_bf16_f32 v157, v14, v15
    v_add_u32 v121, s93, v129
    v_mfma_f32_16x16x32_bf16 v[40:43], a[188:191], v[20:23], v[40:43]
    buffer_load_dwordx4 v25, s[76:79], s92 offen offset:1024 lds
    v_add_u32 v137, s48, v137
    v_mfma_f32_16x16x32_bf16 v[12:15], a[192:195], v[48:51], 0
    s_nop 0
    v_add_u32 v136, s48, v136
    s_nop 0
    v_mfma_f32_16x16x32_bf16 v[12:15], a[196:199], v[44:47], v[12:15]
    s_nop 0
    v_cvt_pk_bf16_f32 v76, v40, v41
    v_cvt_pk_bf16_f32 v77, v42, v43
    v_mfma_f32_16x16x32_bf16 v[12:15], a[200:203], v[36:39], v[12:15]
    v_mfma_f32_16x16x32_bf16 v[12:15], a[204:207], v[32:35], v[12:15]
    v_mfma_f32_16x16x32_bf16 v[12:15], a[208:211], v[28:31], v[12:15]
    buffer_load_dwordx4 v24, s[76:79], s92 offen offset:2048 lds
    v_mfma_f32_16x16x32_bf16 v[12:15], a[212:215], v[20:23], v[12:15]
    s_add_u32 m0, s54, 20480
    s_nop 6
    v_cvt_pk_bf16_f32 v78, v12, v13
    v_cvt_pk_bf16_f32 v79, v14, v15
    buffer_load_dwordx4 v128, s[24:27], s56 offen nt lds
    s_add_u32 m0, s54, 21504
    s_nop 0
    buffer_load_dwordx4 v127, s[24:27], s56 offen nt lds
    s_add_u32 m0, s54, 22528
    s_nop 0
    buffer_load_dwordx4 v126, s[24:27], s56 offen nt lds
    s_add_u32 m0, s54, 23552
    s_nop 0
    buffer_load_dwordx4 v125, s[24:27], s56 offen nt lds
    s_add_u32 m0, s54, 24576
    s_nop 0
    buffer_load_dwordx4 v124, s[24:27], s56 offen nt lds
    s_waitcnt vmcnt(5)
    s_barrier
    ds_read_b128 v[36:39], v17 offset:0
    ds_read_b64 v[12:13], v16 offset:64
    ds_read_b128 v[28:31], v17 offset:3072
    ds_read_b64 v[14:15], v16 offset:3136
    ds_read_b128 v[48:51], v17 offset:6144
    ds_read_b64 v[32:33], v16 offset:6208
    ds_read_b128 v[40:43], v17 offset:9216
    ds_read_b64 v[34:35], v16 offset:9280
    ds_read_b128 v[44:47], v17 offset:12288
    ds_read_b64 v[52:53], v16 offset:12352
    ds_read_b128 v[20:23], v17 offset:15360
    ds_read_b64 v[54:55], v16 offset:15424
    s_waitcnt lgkmcnt(11)
    v_mfma_f32_16x16x32_bf16 v[56:59], v[36:39], v[220:223], 0
    s_waitcnt lgkmcnt(9)
    ds_read_b128 v[36:39], v17 offset:18432
    v_mfma_f32_16x16x32_bf16 v[56:59], v[28:31], v[220:223], v[56:59]
    s_waitcnt lgkmcnt(8)
    ds_read_b64 v[28:29], v16 offset:18496
    ds_read_b128 v[60:63], v17 offset:21504
    v_mfma_f32_16x16x32_bf16 v[56:59], v[48:51], v[220:223], v[56:59]
    s_waitcnt lgkmcnt(8)
    ds_read_b64 v[30:31], v16 offset:21568
    ds_read_b128 v[48:51], v17 offset:24576
    v_mfma_f32_16x16x32_bf16 v[56:59], v[40:43], v[220:223], v[56:59]
    ds_read_b64 v[40:41], v16 offset:24640
    v_mfma_f32_16x16x32_bf16 v[56:59], v[12:15], v[220:223], v[56:59]
    s_waitcnt lgkmcnt(9)
    ds_read_b128 v[12:15], v17 offset:27648
    v_mfma_f32_16x16x32_bf16 v[56:59], v[32:35], v[220:223], v[56:59]
    ds_read_b64 v[42:43], v16 offset:27712
    v_mfma_f32_16x16x32_bf16 v[32:35], v[44:47], v[220:223], 0
    s_waitcnt lgkmcnt(8)
    ds_read_b128 v[44:47], v17 offset:30720
    v_mfma_f32_16x16x32_bf16 v[32:35], v[20:23], v[220:223], v[32:35]
    s_waitcnt lgkmcnt(8)
    s_nop 0
    ds_read_b64 v[20:21], v16 offset:30784
    v_mul_f32 v56, 0xbbaaaaab, v56
    v_mfma_f32_16x16x32_bf16 v[32:35], v[36:39], v[220:223], v[32:35]
    s_waitcnt lgkmcnt(7)
    ds_read_b128 v[36:39], v17 offset:33792
    v_mul_f32 v57, 0xbbaaaaab, v57
    v_mul_f32 v58, 0xbbaaaaab, v58
    v_mul_f32 v59, 0xbbaaaaab, v59
    v_mfma_f32_16x16x32_bf16 v[32:35], v[60:63], v[220:223], v[32:35]
    ds_write_b128 v74, v[56:59] offset:0
    v_mfma_f32_16x16x32_bf16 v[32:35], v[52:55], v[220:223], v[32:35]
    s_waitcnt lgkmcnt(6)
    v_mfma_f32_16x16x32_bf16 v[32:35], v[28:31], v[220:223], v[32:35]
    v_mfma_f32_16x16x32_bf16 v[28:31], v[48:51], v[220:223], 0
    s_waitcnt lgkmcnt(4)
    ds_read_b64 v[22:23], v16 offset:33856
    s_nop 0
    v_mfma_f32_16x16x32_bf16 v[28:31], v[12:15], v[220:223], v[28:31]
    s_waitcnt lgkmcnt(4)
    s_nop 0
    ds_read_b128 v[12:15], v19 offset:0
    v_mul_f32 v32, 0xbbaaaaab, v32
    v_mfma_f32_16x16x32_bf16 v[28:31], v[44:47], v[220:223], v[28:31]
    s_waitcnt lgkmcnt(3)
    ds_read_b64 v[16:17], v18 offset:64
    v_mul_f32 v33, 0xbbaaaaab, v33
    v_mul_f32 v34, 0xbbaaaaab, v34
    v_mul_f32 v35, 0xbbaaaaab, v35
    v_mfma_f32_16x16x32_bf16 v[28:31], v[36:39], v[220:223], v[28:31]
    ds_write_b128 v74, v[32:35] offset:128
    v_mfma_f32_16x16x32_bf16 v[28:31], v[40:43], v[220:223], v[28:31]
    ds_read_b128 v[80:83], v19 offset:768
    ds_read_b64 v[84:85], v18 offset:832
    ds_read_b128 v[68:71], v19 offset:12288
    s_waitcnt lgkmcnt(6)
    v_mfma_f32_16x16x32_bf16 v[28:31], v[20:23], v[220:223], v[28:31]
    s_nop 0
    ds_read_b64 v[72:73], v18 offset:12352
    s_nop 0
    ds_read_b128 v[20:23], v19 offset:13056
    s_nop 2
    ds_read_b64 v[24:25], v18 offset:13120
    v_mul_f32 v28, 0xbbaaaaab, v28
    v_mul_f32 v29, 0xbbaaaaab, v29
    v_mul_f32 v30, 0xbbaaaaab, v30
    v_mul_f32 v31, 0xbbaaaaab, v31
    ds_write_b128 v74, v[28:31] offset:256
    s_waitcnt lgkmcnt(0)
    s_barrier
    ds_read_b128 v[40:43], v162 offset:0
    ds_read_b128 v[28:31], v162 offset:64
    ds_read_b128 v[64:67], v162 offset:128
    ds_read_b128 v[56:59], v162 offset:192
    s_waitcnt lgkmcnt(3)
    v_mfma_f32_16x16x16_bf16 v[32:35], v[12:13], v[26:27], v[40:43]
    v_mfma_f32_16x16x16_bf16 v[36:39], v[14:15], v[26:27], v[40:43]
    s_nop 2
    v_mfma_f32_16x16x16_bf16 v[60:63], v[16:17], v[26:27], v[40:43]
    s_waitcnt lgkmcnt(0)
    s_nop 0
    ds_read_b128 v[12:15], v19 offset:24576
    v_cvt_pk_bf16_f32 v32, v32, v33
    v_mfma_f32_16x16x16_bf16 v[52:55], v[80:81], v[26:27], v[28:31]
    ds_read_b64 v[16:17], v18 offset:24640
    v_accvgpr_write_b32 a216, v32
    v_mfma_f32_16x16x16_bf16 v[48:51], v[82:83], v[26:27], v[28:31]
    ds_read_b128 v[44:47], v162 offset:256
    v_cvt_pk_bf16_f32 v34, v34, v35
    v_mfma_f32_16x16x16_bf16 v[40:43], v[84:85], v[26:27], v[28:31]
    ds_read_b128 v[104:107], v19 offset:25344
    v_accvgpr_write_b32 a217, v34
    v_mfma_f32_16x16x16_bf16 v[84:87], v[68:69], v[26:27], v[64:67]
    ds_read_b64 v[108:109], v18 offset:25408
    v_cvt_pk_bf16_f32 v36, v36, v37
    v_mfma_f32_16x16x16_bf16 v[32:35], v[70:71], v[26:27], v[64:67]
    ds_read_b128 v[100:103], v162 offset:320
    v_accvgpr_write_b32 a240, v36
    v_mfma_f32_16x16x16_bf16 v[28:31], v[72:73], v[26:27], v[64:67]
    ds_read_b128 v[92:95], v19 offset:36864
    v_cvt_pk_bf16_f32 v38, v38, v39
    v_mfma_f32_16x16x16_bf16 v[68:71], v[20:21], v[26:27], v[56:59]
    ds_read_b64 v[96:97], v18 offset:36928
    v_accvgpr_write_b32 a241, v38
    v_mfma_f32_16x16x16_bf16 v[64:67], v[22:23], v[26:27], v[56:59]
    ds_read_b128 v[80:83], v162 offset:5120
    v_cvt_pk_bf16_f32 v232, v60, v61
    v_mfma_f32_16x16x16_bf16 v[36:39], v[24:25], v[26:27], v[56:59]
    s_waitcnt lgkmcnt(6)
    ds_read_b128 v[20:23], v19 offset:37632
    v_cvt_pk_bf16_f32 v233, v62, v63
    v_cvt_pk_bf16_f32 v52, v52, v53
    v_accvgpr_write_b32 a218, v52
    v_cvt_pk_bf16_f32 v54, v54, v55
    v_accvgpr_write_b32 a219, v54
    v_cvt_pk_bf16_f32 v48, v48, v49
    v_mfma_f32_16x16x16_bf16 v[60:63], v[12:13], v[26:27], v[44:47]
    ds_read_b64 v[24:25], v18 offset:37696
    v_accvgpr_write_b32 a242, v48
    v_mfma_f32_16x16x16_bf16 v[56:59], v[14:15], v[26:27], v[44:47]
    ds_read_b128 v[88:91], v162 offset:5184
    v_cvt_pk_bf16_f32 v50, v50, v51
    v_mfma_f32_16x16x16_bf16 v[52:55], v[16:17], v[26:27], v[44:47]
    s_waitcnt lgkmcnt(6)
    ds_read_b128 v[12:15], v19 offset:49152
    v_accvgpr_write_b32 a243, v50
    v_cvt_pk_bf16_f32 v234, v40, v41
    v_cvt_pk_bf16_f32 v235, v42, v43
    v_mfma_f32_16x16x16_bf16 v[72:75], v[104:105], v[26:27], v[100:103]
    ds_read_b64 v[16:17], v18 offset:49216
    v_cvt_pk_bf16_f32 v84, v84, v85
    v_mfma_f32_16x16x16_bf16 v[40:43], v[106:107], v[26:27], v[100:103]
    ds_read_b128 v[48:51], v162 offset:5248
    v_accvgpr_write_b32 a220, v84
    v_mfma_f32_16x16x16_bf16 v[44:47], v[108:109], v[26:27], v[100:103]
    s_waitcnt lgkmcnt(6)
    ds_read_b128 v[104:107], v19 offset:49920
    v_cvt_pk_bf16_f32 v86, v86, v87
    v_accvgpr_write_b32 a221, v86
    v_cvt_pk_bf16_f32 v32, v32, v33
    v_accvgpr_write_b32 a244, v32
    v_cvt_pk_bf16_f32 v34, v34, v35
    v_accvgpr_write_b32 a245, v34
    v_cvt_pk_bf16_f32 v236, v28, v29
    v_cvt_pk_bf16_f32 v237, v30, v31
    v_mfma_f32_16x16x16_bf16 v[84:87], v[92:93], v[26:27], v[80:83]
    ds_read_b64 v[108:109], v18 offset:49984
    v_cvt_pk_bf16_f32 v68, v68, v69
    v_mfma_f32_16x16x16_bf16 v[32:35], v[94:95], v[26:27], v[80:83]
    ds_read_b128 v[100:103], v162 offset:5312
    v_accvgpr_write_b32 a222, v68
    v_mfma_f32_16x16x16_bf16 v[28:31], v[96:97], v[26:27], v[80:83]
    s_waitcnt lgkmcnt(5)
    ds_read_b128 v[92:95], v19 offset:61440
    v_cvt_pk_bf16_f32 v70, v70, v71
    v_accvgpr_write_b32 a223, v70
    v_cvt_pk_bf16_f32 v64, v64, v65
    v_accvgpr_write_b32 a246, v64
    v_cvt_pk_bf16_f32 v66, v66, v67
    v_accvgpr_write_b32 a247, v66
    v_cvt_pk_bf16_f32 v238, v36, v37
    v_cvt_pk_bf16_f32 v239, v38, v39
    v_mfma_f32_16x16x16_bf16 v[36:39], v[20:21], v[26:27], v[88:91]
    ds_read_b64 v[96:97], v18 offset:61504
    v_cvt_pk_bf16_f32 v60, v60, v61
    v_mfma_f32_16x16x16_bf16 v[68:71], v[22:23], v[26:27], v[88:91]
    ds_read_b128 v[80:83], v162 offset:5376
    v_accvgpr_write_b32 a224, v60
    v_mfma_f32_16x16x16_bf16 v[64:67], v[24:25], v[26:27], v[88:91]
    s_waitcnt lgkmcnt(5)
    ds_read_b128 v[20:23], v19 offset:62208
    v_cvt_pk_bf16_f32 v62, v62, v63
    v_accvgpr_write_b32 a225, v62
    v_cvt_pk_bf16_f32 v56, v56, v57
    v_accvgpr_write_b32 a248, v56
    v_cvt_pk_bf16_f32 v58, v58, v59
    v_accvgpr_write_b32 a249, v58
    v_cvt_pk_bf16_f32 v240, v52, v53
    v_cvt_pk_bf16_f32 v241, v54, v55
    v_mfma_f32_16x16x16_bf16 v[60:63], v[12:13], v[26:27], v[48:51]
    ds_read_b64 v[24:25], v18 offset:62272
    v_cvt_pk_bf16_f32 v72, v72, v73
    v_mfma_f32_16x16x16_bf16 v[56:59], v[14:15], v[26:27], v[48:51]
    ds_read_b128 v[12:15], v162 offset:5440
    v_accvgpr_write_b32 a226, v72
    v_mfma_f32_16x16x16_bf16 v[52:55], v[16:17], v[26:27], v[48:51]
    s_waitcnt lgkmcnt(5)
    ds_read_b128 v[16:19], v137 offset:0
    v_cvt_pk_bf16_f32 v74, v74, v75
    v_accvgpr_write_b32 a227, v74
    v_cvt_pk_bf16_f32 v40, v40, v41
    v_accvgpr_write_b32 a250, v40
    v_cvt_pk_bf16_f32 v42, v42, v43
    v_accvgpr_write_b32 a251, v42
    v_cvt_pk_bf16_f32 v242, v44, v45
    v_cvt_pk_bf16_f32 v243, v46, v47
    v_mfma_f32_16x16x16_bf16 v[48:51], v[104:105], v[26:27], v[100:103]
    ds_read_b128 v[146:149], v136 offset:0
    v_cvt_pk_bf16_f32 v84, v84, v85
    v_mfma_f32_16x16x16_bf16 v[44:47], v[106:107], v[26:27], v[100:103]
    ds_read_b128 v[72:75], v137 offset:128
    v_accvgpr_write_b32 a228, v84
    v_mfma_f32_16x16x16_bf16 v[40:43], v[108:109], v[26:27], v[100:103]
    s_waitcnt lgkmcnt(5)
    ds_read_b128 v[88:91], v136 offset:128
    v_cvt_pk_bf16_f32 v86, v86, v87
    v_accvgpr_write_b32 a229, v86
    v_cvt_pk_bf16_f32 v32, v32, v33
    v_accvgpr_write_b32 a252, v32
    v_cvt_pk_bf16_f32 v34, v34, v35
    v_accvgpr_write_b32 a253, v34
    v_cvt_pk_bf16_f32 v244, v28, v29
    v_cvt_pk_bf16_f32 v245, v30, v31
    v_mfma_f32_16x16x16_bf16 v[32:35], v[92:93], v[26:27], v[80:83]
    s_waitcnt vmcnt(0) lgkmcnt(4)
    s_barrier
    ds_write_b128 v121, v[8:11] offset:6144
    v_mfma_f32_16x16x16_bf16 v[28:31], v[94:95], v[26:27], v[80:83]
    v_cvt_pk_bf16_f32 v36, v36, v37
    v_accvgpr_write_b32 a230, v36
    v_mfma_f32_16x16x16_bf16 v[8:11], v[96:97], v[26:27], v[80:83]
    s_waitcnt lgkmcnt(4)
    v_cvt_pk_bf16_f32 v38, v38, v39
    v_accvgpr_write_b32 a231, v38
    v_cvt_pk_bf16_f32 v68, v68, v69
    v_mfma_f32_16x16x32_bf16 v[36:39], a[0:3], v[16:19], 0
    s_waitcnt lgkmcnt(3)
    ds_write_b64 v158, v[156:157] offset:80
    v_mfma_f32_16x16x32_bf16 v[36:39], a[4:7], v[146:149], v[36:39]
    s_waitcnt lgkmcnt(3)
    v_accvgpr_write_b32 a254, v68
    v_cvt_pk_bf16_f32 v70, v70, v71
    v_mfma_f32_16x16x32_bf16 v[36:39], a[8:11], v[72:75], v[36:39]
    s_waitcnt lgkmcnt(2)
    ds_write_b128 v158, v[76:79] offset:96
    v_mfma_f32_16x16x32_bf16 v[36:39], a[12:15], v[88:91], v[36:39]
    v_accvgpr_write_b32 a255, v70
    v_cvt_pk_bf16_f32 v246, v64, v65
    v_cvt_pk_bf16_f32 v247, v66, v67
    v_cvt_pk_bf16_f32 v60, v60, v61
    v_accvgpr_write_b32 a232, v60
    v_cvt_pk_bf16_f32 v62, v62, v63
    v_accvgpr_write_b32 a233, v62
    v_cvt_pk_bf16_f32 v224, v56, v57
    v_cvt_pk_bf16_f32 v225, v58, v59
    v_cvt_pk_bf16_f32 v248, v52, v53
    v_cvt_pk_bf16_f32 v249, v54, v55
    v_cvt_pk_bf16_f32 v48, v48, v49
    v_accvgpr_write_b32 a234, v48
    v_cvt_pk_bf16_f32 v50, v50, v51
    v_accvgpr_write_b32 a235, v50
    v_cvt_pk_bf16_f32 v226, v44, v45
    v_cvt_pk_bf16_f32 v227, v46, v47
    v_cvt_pk_bf16_f32 v250, v40, v41
    v_cvt_pk_bf16_f32 v251, v42, v43
    v_cvt_pk_bf16_f32 v32, v32, v33
    v_accvgpr_write_b32 a236, v32
    v_cvt_pk_bf16_f32 v34, v34, v35
    v_accvgpr_write_b32 a237, v34
    v_cvt_pk_bf16_f32 v228, v28, v29
    v_cvt_pk_bf16_f32 v229, v30, v31
    v_cvt_pk_bf16_f32 v252, v8, v9
    v_cvt_pk_bf16_f32 v253, v10, v11
    v_mov_b32 v156, 0
    v_mov_b32 v157, 0
    v_mov_b32 v121, 0
    v_add_u32 v230, 0, v158
    ds_write_b128 v230, v[4:7]
    v_add_u32 v135, s49, v135
    v_add_u32 v134, s49, v134
    ds_write2_b64 v230, v[156:157], v[156:157] offset0:2 offset1:3
    ds_write_b128 v230, v[0:3] offset:32
    ds_write2_b64 v230, v[160:161], v[156:157] offset0:6 offset1:7
    ds_write2_b64 v230, v[156:157], v[254:255] offset0:8 offset1:9
    ds_write_b64 v230, v[120:121] offset:88
    ds_read_b128 v[76:79], v137 offset:256
    ds_read_b128 v[56:59], v136 offset:256
    s_waitcnt lgkmcnt(1)
    v_mfma_f32_16x16x32_bf16 v[36:39], a[16:19], v[76:79], v[36:39]
    s_waitcnt lgkmcnt(0)
    v_mfma_f32_16x16x32_bf16 v[36:39], a[20:23], v[56:59], v[36:39]
    s_nop 0
    v_mfma_f32_16x16x16_bf16 v[8:11], v[20:21], v[26:27], v[12:15]
    s_nop 3
    v_mfma_f32_16x16x16_bf16 v[4:7], v[22:23], v[26:27], v[12:15]
    s_nop 0
    v_fma_f32 v121, v36, v36, s41
    v_fmac_f32 v121, v37, v37
    v_mfma_f32_16x16x16_bf16 v[0:3], v[24:25], v[26:27], v[12:15]
    v_cvt_pk_bf16_f32 v8, v8, v9
    v_accvgpr_write_b32 a238, v8
    v_cvt_pk_bf16_f32 v10, v10, v11
    v_mfma_f32_16x16x32_bf16 v[48:51], a[24:27], v[16:19], 0
    v_accvgpr_write_b32 a239, v10
    v_cvt_pk_bf16_f32 v230, v4, v5
    v_mfma_f32_16x16x32_bf16 v[48:51], a[28:31], v[146:149], v[48:51]
    v_cvt_pk_bf16_f32 v231, v6, v7
    v_cvt_pk_bf16_f32 v254, v0, v1
    v_mfma_f32_16x16x32_bf16 v[48:51], a[32:35], v[72:75], v[48:51]
    v_cvt_pk_bf16_f32 v255, v2, v3
    v_fmac_f32 v121, v38, v38
    v_mfma_f32_16x16x32_bf16 v[48:51], a[36:39], v[88:91], v[48:51]
    v_fmac_f32 v121, v39, v39
    v_mfma_f32_16x16x32_bf16 v[48:51], a[40:43], v[76:79], v[48:51]
    v_mfma_f32_16x16x32_bf16 v[48:51], a[44:47], v[56:59], v[48:51]
    s_nop 1
    v_mfma_f32_16x16x32_bf16 v[40:43], a[48:51], v[16:19], 0
    s_nop 2
    v_mfma_f32_16x16x32_bf16 v[40:43], a[52:55], v[146:149], v[40:43]
    s_nop 0
    v_fmac_f32 v121, v48, v48
    v_fmac_f32 v121, v49, v49
    v_mfma_f32_16x16x32_bf16 v[40:43], a[56:59], v[72:75], v[40:43]
    v_fmac_f32 v121, v50, v50
    v_fmac_f32 v121, v51, v51
    v_mfma_f32_16x16x32_bf16 v[40:43], a[60:63], v[88:91], v[40:43]
    v_mfma_f32_16x16x32_bf16 v[40:43], a[64:67], v[76:79], v[40:43]
    v_mfma_f32_16x16x32_bf16 v[40:43], a[68:71], v[56:59], v[40:43]
    s_nop 1
    v_mfma_f32_16x16x32_bf16 v[28:31], a[72:75], v[16:19], 0
    s_nop 2
    v_mfma_f32_16x16x32_bf16 v[28:31], a[76:79], v[146:149], v[28:31]
    s_nop 0
    v_fmac_f32 v121, v40, v40
    v_fmac_f32 v121, v41, v41
    v_mfma_f32_16x16x32_bf16 v[28:31], a[80:83], v[72:75], v[28:31]
    v_fmac_f32 v121, v42, v42
    v_fmac_f32 v121, v43, v43
    v_mfma_f32_16x16x32_bf16 v[28:31], a[84:87], v[88:91], v[28:31]
    v_mfma_f32_16x16x32_bf16 v[28:31], a[88:91], v[76:79], v[28:31]
    v_mfma_f32_16x16x32_bf16 v[28:31], a[92:95], v[56:59], v[28:31]
    s_nop 1
    v_mfma_f32_16x16x32_bf16 v[32:35], a[96:99], v[16:19], 0
    s_nop 2
    v_mfma_f32_16x16x32_bf16 v[32:35], a[100:103], v[146:149], v[32:35]
    s_nop 0
    v_fma_f32 v120, v28, v28, s41
    v_fmac_f32 v120, v29, v29
    v_mfma_f32_16x16x32_bf16 v[32:35], a[104:107], v[72:75], v[32:35]
    v_fmac_f32 v120, v30, v30
    v_fmac_f32 v120, v31, v31
    v_mfma_f32_16x16x32_bf16 v[32:35], a[108:111], v[88:91], v[32:35]
    v_mfma_f32_16x16x32_bf16 v[32:35], a[112:115], v[76:79], v[32:35]
    v_mfma_f32_16x16x32_bf16 v[32:35], a[116:119], v[56:59], v[32:35]
    s_nop 1
    v_mfma_f32_16x16x32_bf16 v[20:23], a[120:123], v[16:19], 0
    s_nop 2
    v_mfma_f32_16x16x32_bf16 v[20:23], a[124:127], v[146:149], v[20:23]
    s_nop 0
    v_fmac_f32 v120, v32, v32
    v_fmac_f32 v120, v33, v33
    v_mfma_f32_16x16x32_bf16 v[20:23], a[128:131], v[72:75], v[20:23]
    v_fmac_f32 v120, v34, v34
    v_fmac_f32 v120, v35, v35
    v_mfma_f32_16x16x32_bf16 v[20:23], a[132:135], v[88:91], v[20:23]
    v_mfma_f32_16x16x32_bf16 v[20:23], a[136:139], v[76:79], v[20:23]
    v_mfma_f32_16x16x32_bf16 v[20:23], a[140:143], v[56:59], v[20:23]
    s_nop 1
    v_mfma_f32_16x16x32_bf16 v[8:11], v[16:19], a[144:147], 0
    s_nop 2
    v_mfma_f32_16x16x32_bf16 v[8:11], v[146:149], a[148:151], v[8:11]
    s_nop 0
    v_fmac_f32 v120, v20, v20
    v_fmac_f32 v120, v21, v21
    v_mfma_f32_16x16x32_bf16 v[8:11], v[72:75], a[152:155], v[8:11]
    v_fmac_f32 v120, v22, v22
    v_fmac_f32 v120, v23, v23
    v_mfma_f32_16x16x32_bf16 v[8:11], v[88:91], a[156:159], v[8:11]
    v_cvt_pk_bf16_f32 v170, v121, v120
    v_mfma_f32_16x16x32_bf16 v[8:11], v[76:79], a[160:163], v[8:11]
    ds_read_b128 v[104:107], v137 offset:1536
    v_mfma_f32_16x16x32_bf16 v[8:11], v[56:59], a[164:167], v[8:11]
    s_nop 0
    ds_read_b128 v[100:103], v136 offset:1536
    s_nop 0
    v_mfma_f32_16x16x16_bf16 v[24:27], v[216:217], v[170:171], 0
    s_nop 0
    ds_read_b128 v[44:47], v137 offset:1664
    s_nop 1
    v_cvt_pk_bf16_f32 v0, v8, v9
    v_mfma_f32_16x16x32_bf16 v[4:7], v[16:19], a[168:171], 0
    ds_read_b128 v[84:87], v136 offset:1664
    v_cvt_pk_bf16_f32 v1, v10, v11
    v_mfma_f32_16x16x32_bf16 v[4:7], v[146:149], a[172:175], v[4:7]
    ds_read_b128 v[68:71], v137 offset:1792
    v_mfma_f32_16x16x32_bf16 v[4:7], v[72:75], a[176:179], v[4:7]
    ds_read_b128 v[64:67], v136 offset:1792
    v_mfma_f32_16x16x32_bf16 v[4:7], v[88:91], a[180:183], v[4:7]
    v_rsq_f32 v24, v24
    v_mfma_f32_16x16x32_bf16 v[4:7], v[76:79], a[184:187], v[4:7]
    v_rsq_f32 v25, v25
    v_mfma_f32_16x16x32_bf16 v[4:7], v[56:59], a[188:191], v[4:7]
    v_mul_f32 v24, s55, v24
    v_mul_f32 v25, 0.5, v25
    v_mfma_f32_16x16x32_bf16 v[12:15], v[16:19], a[192:195], 0
    s_nop 0
    v_mul_f32 v36, v36, v24
    v_mul_f32 v37, v37, v24
    v_mfma_f32_16x16x32_bf16 v[12:15], v[146:149], a[196:199], v[12:15]
    s_nop 0
    v_cvt_pk_bf16_f32 v8, v4, v5
    v_cvt_pk_bf16_f32 v9, v6, v7
    v_mfma_f32_16x16x32_bf16 v[12:15], v[72:75], a[200:203], v[12:15]
    v_cvt_pk_f16_f32 v4, v36, v37
    v_mul_f32 v38, v38, v24
    v_mfma_f32_16x16x32_bf16 v[12:15], v[88:91], a[204:207], v[12:15]
    v_mul_f32 v39, v39, v24
    v_cvt_pk_f16_f32 v5, v38, v39
    v_mfma_f32_16x16x32_bf16 v[12:15], v[76:79], a[208:211], v[12:15]
    v_mul_f32 v48, v48, v24
    v_mul_f32 v49, v49, v24
    v_mfma_f32_16x16x32_bf16 v[12:15], v[56:59], a[212:215], v[12:15]
    s_waitcnt lgkmcnt(0)
    v_cvt_pk_f16_f32 v6, v48, v49
    v_mul_f32 v50, v50, v24
    v_mfma_f32_16x16x32_bf16 v[16:19], a[0:3], v[104:107], 0
    v_mul_f32 v51, v51, v24
    v_cvt_pk_f16_f32 v7, v50, v51
    v_mfma_f32_16x16x32_bf16 v[16:19], a[4:7], v[100:103], v[16:19]
    v_mul_f32 v40, v40, v24
    v_mul_f32 v41, v41, v24
    v_mfma_f32_16x16x32_bf16 v[16:19], a[8:11], v[44:47], v[16:19]
    v_cvt_pk_f16_f32 v152, v40, v41
    v_mul_f32 v42, v42, v24
    v_mfma_f32_16x16x32_bf16 v[16:19], a[12:15], v[84:87], v[16:19]
    v_mul_f32 v43, v43, v24
    v_cvt_pk_f16_f32 v153, v42, v43
    v_mfma_f32_16x16x32_bf16 v[16:19], a[16:19], v[68:71], v[16:19]
    v_mul_f32 v28, v28, v25
    v_mul_f32 v29, v29, v25
    v_mfma_f32_16x16x32_bf16 v[16:19], a[20:23], v[64:67], v[16:19]
    v_cvt_pk_f16_f32 v28, v28, v29
    v_mul_f32 v30, v30, v25
    v_mfma_f32_16x16x32_bf16 v[60:63], a[24:27], v[104:107], 0
    v_mul_f32 v31, v31, v25
    v_cvt_pk_f16_f32 v29, v30, v31
    v_mfma_f32_16x16x32_bf16 v[60:63], a[28:31], v[100:103], v[60:63]
    v_mul_f32 v32, v32, v25
    v_mul_f32 v33, v33, v25
    v_mfma_f32_16x16x32_bf16 v[60:63], a[32:35], v[44:47], v[60:63]
    v_cvt_pk_f16_f32 v30, v32, v33
    v_mul_f32 v34, v34, v25
    v_mfma_f32_16x16x32_bf16 v[60:63], a[36:39], v[84:87], v[60:63]
    v_mul_f32 v35, v35, v25
    v_cvt_pk_f16_f32 v31, v34, v35
    v_mfma_f32_16x16x32_bf16 v[60:63], a[40:43], v[68:71], v[60:63]
    v_mul_f32 v20, v20, v25
    v_mul_f32 v21, v21, v25
    v_mfma_f32_16x16x32_bf16 v[60:63], a[44:47], v[64:67], v[60:63]
    v_cvt_pk_f16_f32 v154, v20, v21
    v_mul_f32 v22, v22, v25
    v_mfma_f32_16x16x32_bf16 v[36:39], a[48:51], v[104:107], 0
    v_mul_f32 v23, v23, v25
    v_cvt_pk_f16_f32 v155, v22, v23
    v_mfma_f32_16x16x32_bf16 v[36:39], a[52:55], v[100:103], v[36:39]
    v_cvt_pk_bf16_f32 v20, v12, v13
    v_cvt_pk_bf16_f32 v21, v14, v15
    v_mfma_f32_16x16x32_bf16 v[36:39], a[56:59], v[44:47], v[36:39]
    v_fma_f32 v2, v16, v16, s41
    v_fmac_f32 v2, v17, v17
    v_mfma_f32_16x16x32_bf16 v[36:39], a[60:63], v[84:87], v[36:39]
    v_fmac_f32 v2, v18, v18
    v_fmac_f32 v2, v19, v19
    v_mfma_f32_16x16x32_bf16 v[36:39], a[64:67], v[68:71], v[36:39]
    v_fmac_f32 v2, v60, v60
    v_fmac_f32 v2, v61, v61
    v_mfma_f32_16x16x32_bf16 v[36:39], a[68:71], v[64:67], v[36:39]
    v_fmac_f32 v2, v62, v62
    v_fmac_f32 v2, v63, v63
    v_mfma_f32_16x16x32_bf16 v[52:55], a[72:75], v[104:107], 0
    s_nop 2
    v_mfma_f32_16x16x32_bf16 v[52:55], a[76:79], v[100:103], v[52:55]
    s_nop 0
    v_fmac_f32 v2, v36, v36
    v_fmac_f32 v2, v37, v37
    v_mfma_f32_16x16x32_bf16 v[52:55], a[80:83], v[44:47], v[52:55]
    v_fmac_f32 v2, v38, v38
    v_fmac_f32 v2, v39, v39
    v_mfma_f32_16x16x32_bf16 v[52:55], a[84:87], v[84:87], v[52:55]
    v_mfma_f32_16x16x32_bf16 v[52:55], a[88:91], v[68:71], v[52:55]
    v_mfma_f32_16x16x32_bf16 v[52:55], a[92:95], v[64:67], v[52:55]
    s_nop 1
    v_mfma_f32_16x16x32_bf16 v[12:15], a[96:99], v[104:107], 0
    s_nop 2
    v_mfma_f32_16x16x32_bf16 v[12:15], a[100:103], v[100:103], v[12:15]
    s_nop 0
    v_fma_f32 v3, v52, v52, s41
    v_fmac_f32 v3, v53, v53
    v_mfma_f32_16x16x32_bf16 v[12:15], a[104:107], v[44:47], v[12:15]
    v_fmac_f32 v3, v54, v54
    v_fmac_f32 v3, v55, v55
    v_mfma_f32_16x16x32_bf16 v[12:15], a[108:111], v[84:87], v[12:15]
    v_mfma_f32_16x16x32_bf16 v[12:15], a[112:115], v[68:71], v[12:15]
    v_mfma_f32_16x16x32_bf16 v[12:15], a[116:119], v[64:67], v[12:15]
    s_sub_u32 s50, s45, s44
    v_add_u32 v135, s48, v135
    v_add_u32 v134, s48, v134
    v_mfma_f32_16x16x32_bf16 v[48:51], a[120:123], v[104:107], 0
    s_sub_u32 s51, s46, s47
    v_add_u32 v133, s51, v133
    v_mfma_f32_16x16x32_bf16 v[48:51], a[124:127], v[100:103], v[48:51]
    s_mov_b32 s60, s59
    v_fmac_f32 v3, v12, v12
    v_fmac_f32 v3, v13, v13
    v_mfma_f32_16x16x32_bf16 v[48:51], a[128:131], v[44:47], v[48:51]
    s_mov_b32 s59, s58
    v_fmac_f32 v3, v14, v14
    v_fmac_f32 v3, v15, v15
    v_mfma_f32_16x16x32_bf16 v[48:51], a[132:135], v[84:87], v[48:51]
    s_mov_b32 s58, s57
    v_mfma_f32_16x16x32_bf16 v[48:51], a[136:139], v[68:71], v[48:51]
    s_mov_b32 s57, s56
    v_mfma_f32_16x16x32_bf16 v[48:51], a[140:143], v[64:67], v[48:51]
    s_mov_b32 s7, s6
    s_nop 0
    v_mfma_f32_16x16x32_bf16 v[24:27], v[104:107], a[144:147], 0
    s_mov_b32 s6, s5
    s_nop 1
    v_mfma_f32_16x16x32_bf16 v[24:27], v[100:103], a[148:151], v[24:27]
    s_mov_b32 s5, s4
    v_fmac_f32 v3, v48, v48
    v_fmac_f32 v3, v49, v49
    v_mfma_f32_16x16x32_bf16 v[24:27], v[44:47], a[152:155], v[24:27]
    s_sub_u32 s14, s6, s7
    v_fmac_f32 v3, v50, v50
    v_fmac_f32 v3, v51, v51
    v_mfma_f32_16x16x32_bf16 v[24:27], v[84:87], a[156:159], v[24:27]
    s_add_u32 s61, s61, 1
    v_cvt_pk_bf16_f32 v170, v2, v3
    v_add_u32 v132, s14, v132
    v_mfma_f32_16x16x32_bf16 v[24:27], v[68:71], a[160:163], v[24:27]
    s_ff1_i32_b32 s15, s66
    ds_read_b128 v[96:99], v137 offset:3072
    v_add_u32 v131, s14, v131
    v_mfma_f32_16x16x32_bf16 v[24:27], v[64:67], a[164:167], v[24:27]
    s_cmp_lg_u32 s66, 0
    ds_read_b128 v[92:95], v136 offset:3072
    v_add_u32 v123, s14, v123
    v_mfma_f32_16x16x16_bf16 v[40:43], v[216:217], v[170:171], 0
    s_cselect_b32 s12, s15, s12
    ds_read_b128 v[88:91], v137 offset:3200
    s_nop 1
    v_cvt_pk_bf16_f32 v2, v24, v25
    v_mfma_f32_16x16x32_bf16 v[72:75], v[104:107], a[168:171], 0
    s_cmp_lt_u32 s61, s71
    ds_read_b128 v[80:83], v136 offset:3200
    v_cvt_pk_bf16_f32 v3, v26, v27
    v_mfma_f32_16x16x32_bf16 v[72:75], v[100:103], a[172:175], v[72:75]
    s_cselect_b32 s15, 31, s15
    ds_read_b128 v[56:59], v137 offset:3328
    v_add_u32 v137, s50, v137
    v_mfma_f32_16x16x32_bf16 v[72:75], v[44:47], a[176:179], v[72:75]
    s_bitset0_b32 s66, s15
    ds_read_b128 v[24:27], v136 offset:3328
    v_add_u32 v136, s50, v136
    v_mfma_f32_16x16x32_bf16 v[72:75], v[84:87], a[180:183], v[72:75]
    s_add_u32 s12, s12, 20
    v_rsq_f32 v40, v40
    v_mfma_f32_16x16x32_bf16 v[72:75], v[68:71], a[184:187], v[72:75]
    s_max_u32 s12, s12, s61
    v_rsq_f32 v41, v41
    v_mfma_f32_16x16x32_bf16 v[72:75], v[64:67], a[188:191], v[72:75]
    s_cmp_lt_u32 s61, s71
    v_mul_f32 v40, s55, v40
    v_mul_f32 v41, 0.5, v41
    v_mfma_f32_16x16x32_bf16 v[32:35], v[104:107], a[192:195], 0
    s_cselect_b32 s15, s61, s12
    v_mul_f32 v16, v16, v40
    v_mul_f32 v17, v17, v40
    v_mfma_f32_16x16x32_bf16 v[32:35], v[100:103], a[196:199], v[32:35]
    s_cselect_b32 s56, s69, s70
    v_cvt_pk_bf16_f32 v10, v72, v73
    v_cvt_pk_bf16_f32 v11, v74, v75
    v_mfma_f32_16x16x32_bf16 v[32:35], v[44:47], a[200:203], v[32:35]
    s_add_u32 s56, s56, s15
    v_cvt_pk_f16_f32 v44, v16, v17
    v_mul_f32 v18, v18, v40
    v_mfma_f32_16x16x32_bf16 v[32:35], v[84:87], a[204:207], v[32:35]
    s_mul_i32 s53, s56, 58255
    v_mul_f32 v19, v19, v40
    v_cvt_pk_f16_f32 v45, v18, v19
    v_mfma_f32_16x16x32_bf16 v[32:35], v[68:71], a[208:211], v[32:35]
    s_waitcnt lgkmcnt(0)
    s_lshr_b32 s53, s53, 22
    v_mul_f32 v60, v60, v40
    v_mul_f32 v61, v61, v40
    v_mfma_f32_16x16x32_bf16 v[32:35], v[64:67], a[212:215], v[32:35]
    s_barrier
    v_cvt_pk_f16_f32 v46, v60, v61
    v_mul_f32 v62, v62, v40
    v_mfma_f32_16x16x32_bf16 v[16:19], a[0:3], v[96:99], 0
    s_mul_i32 s53, s53, s63
    v_mul_f32 v63, v63, v40
    v_cvt_pk_f16_f32 v47, v62, v63
    v_mfma_f32_16x16x32_bf16 v[16:19], a[4:7], v[92:95], v[16:19]
    s_mul_i32 s56, s56, s62
    v_mul_f32 v36, v36, v40
    v_mul_f32 v37, v37, v40
    v_mfma_f32_16x16x32_bf16 v[16:19], a[8:11], v[88:91], v[16:19]
    s_add_u32 s56, s56, s53
    v_cvt_pk_f16_f32 v146, v36, v37
    v_mul_f32 v38, v38, v40
    v_mfma_f32_16x16x32_bf16 v[16:19], a[12:15], v[80:83], v[16:19]
    s_mul_i32 s4, s15, 112
    v_mul_f32 v39, v39, v40
    v_cvt_pk_f16_f32 v147, v38, v39
    v_mfma_f32_16x16x32_bf16 v[16:19], a[16:19], v[56:59], v[16:19]
    s_cmp_ge_u32 s15, 16
    v_mul_f32 v52, v52, v41
    v_mul_f32 v53, v53, v41
    v_mfma_f32_16x16x32_bf16 v[16:19], a[20:23], v[24:27], v[16:19]
    s_cselect_b32 s53, -30464, 0
    v_cvt_pk_f16_f32 v72, v52, v53
    v_mul_f32 v54, v54, v41
    v_mfma_f32_16x16x32_bf16 v[36:39], a[24:27], v[96:99], 0
    s_add_u32 s4, s4, s53
    v_mul_f32 v55, v55, v41
    v_cvt_pk_f16_f32 v73, v54, v55
    v_mfma_f32_16x16x32_bf16 v[36:39], a[28:31], v[92:95], v[36:39]
    s_cmp_lt_u32 s15, s73
    v_mul_f32 v12, v12, v41
    v_mul_f32 v13, v13, v41
    v_mfma_f32_16x16x32_bf16 v[36:39], a[32:35], v[88:91], v[36:39]
    s_cselect_b32 s26, 100270464, 0
    v_cvt_pk_f16_f32 v74, v12, v13
    v_mul_f32 v14, v14, v41
    v_mfma_f32_16x16x32_bf16 v[36:39], a[36:39], v[80:83], v[36:39]
    s_cselect_b32 s56, s56, 0
    v_mul_f32 v15, v15, v41
    v_cvt_pk_f16_f32 v75, v14, v15
    v_mfma_f32_16x16x32_bf16 v[36:39], a[40:43], v[56:59], v[36:39]
    s_cselect_b32 s4, s4, -1
    v_mul_f32 v48, v48, v41
    v_mul_f32 v49, v49, v41
    v_mfma_f32_16x16x32_bf16 v[36:39], a[44:47], v[24:27], v[36:39]
    s_cselect_b32 s15, s15, 0
    v_cvt_pk_f16_f32 v148, v48, v49
    v_mul_f32 v50, v50, v41
    v_mfma_f32_16x16x32_bf16 v[12:15], a[48:51], v[96:99], 0
    s_cselect_b32 s13, s13, -1
    v_mul_f32 v51, v51, v41
    v_cvt_pk_f16_f32 v149, v50, v51
    v_mfma_f32_16x16x32_bf16 v[12:15], a[52:55], v[92:95], v[12:15]
    s_bitset1_b32 s64, s15
    v_cvt_pk_bf16_f32 v22, v32, v33
    v_cvt_pk_bf16_f32 v23, v34, v35
    v_mfma_f32_16x16x32_bf16 v[12:15], a[56:59], v[88:91], v[12:15]
    s_add_u32 s65, s65, 1
    v_fma_f32 v156, v16, v16, s41
    v_fmac_f32 v156, v17, v17
    v_mfma_f32_16x16x32_bf16 v[12:15], a[60:63], v[80:83], v[12:15]
    s_cmp_ge_i32 s65, 2
    v_fmac_f32 v156, v18, v18
    v_fmac_f32 v156, v19, v19
    v_mfma_f32_16x16x32_bf16 v[12:15], a[64:67], v[56:59], v[12:15]
    s_cselect_b32 s30, 100270464, 0
    v_fmac_f32 v156, v36, v36
    v_fmac_f32 v156, v37, v37
    v_mfma_f32_16x16x32_bf16 v[12:15], a[68:71], v[24:27], v[12:15]
    s_add_u32 s67, s46, s54
    v_fmac_f32 v156, v38, v38
    v_fmac_f32 v156, v39, v39
    v_mfma_f32_16x16x32_bf16 v[64:67], a[72:75], v[96:99], 0
    s_add_u32 m0, s67, 0
    v_and_b32 v120, -8, v123
    v_mfma_f32_16x16x32_bf16 v[64:67], a[76:79], v[92:95], v[64:67]
    buffer_load_dwordx4 v128, s[24:27], s56 offen nt lds
    v_fmac_f32 v156, v12, v12
    v_mfma_f32_16x16x32_bf16 v[64:67], a[80:83], v[88:91], v[64:67]
    s_add_u32 m0, s67, 1024
    v_fmac_f32 v156, v13, v13
    v_fmac_f32 v156, v14, v14
    v_mfma_f32_16x16x32_bf16 v[64:67], a[84:87], v[80:83], v[64:67]
    buffer_load_dwordx4 v127, s[24:27], s56 offen nt lds
    v_fmac_f32 v156, v15, v15
    v_mfma_f32_16x16x32_bf16 v[64:67], a[88:91], v[56:59], v[64:67]
    s_add_u32 m0, s67, 2048
    v_mfma_f32_16x16x32_bf16 v[64:67], a[92:95], v[24:27], v[64:67]
    buffer_load_dwordx4 v126, s[24:27], s56 offen nt lds
    v_mfma_f32_16x16x32_bf16 v[32:35], a[96:99], v[96:99], 0
    s_add_u32 m0, s67, 3072
    s_nop 1
    v_mfma_f32_16x16x32_bf16 v[32:35], a[100:103], v[92:95], v[32:35]
    s_nop 0
    buffer_load_dwordx4 v125, s[24:27], s56 offen nt lds
    v_fma_f32 v121, v64, v64, s41
    v_mfma_f32_16x16x32_bf16 v[32:35], a[104:107], v[88:91], v[32:35]
    s_add_u32 m0, s67, 4096
    v_fmac_f32 v121, v65, v65
    v_fmac_f32 v121, v66, v66
    v_mfma_f32_16x16x32_bf16 v[32:35], a[108:111], v[80:83], v[32:35]
    buffer_load_dwordx4 v124, s[24:27], s56 offen nt lds
    v_fmac_f32 v121, v67, v67
    v_mfma_f32_16x16x32_bf16 v[32:35], a[112:115], v[56:59], v[32:35]
    v_mfma_f32_16x16x32_bf16 v[32:35], a[116:119], v[24:27], v[32:35]
    s_nop 1
    v_mfma_f32_16x16x32_bf16 v[40:43], a[120:123], v[96:99], 0
    s_nop 2
    v_mfma_f32_16x16x32_bf16 v[40:43], a[124:127], v[92:95], v[40:43]
    s_mov_b32 s53, s47
    v_fmac_f32 v121, v32, v32
    v_fmac_f32 v121, v33, v33
    v_mfma_f32_16x16x32_bf16 v[40:43], a[128:131], v[88:91], v[40:43]
    s_mov_b32 s47, s46
    v_fmac_f32 v121, v34, v34
    v_fmac_f32 v121, v35, v35
    v_mfma_f32_16x16x32_bf16 v[40:43], a[132:135], v[80:83], v[40:43]
    s_mov_b32 s46, s45
    v_mfma_f32_16x16x32_bf16 v[40:43], a[136:139], v[56:59], v[40:43]
    s_mov_b32 s45, s44
    v_mfma_f32_16x16x32_bf16 v[40:43], a[140:143], v[24:27], v[40:43]
    s_mov_b32 s44, s53
    s_nop 0
    v_mfma_f32_16x16x32_bf16 v[68:71], v[96:99], a[144:147], 0
    s_sub_u32 s48, s44, s46
    v_add_u32 v137, s48, v137
    v_add_u32 v136, s48, v136
    v_mfma_f32_16x16x32_bf16 v[68:71], v[92:95], a[148:151], v[68:71]
    s_sub_u32 s49, s46, s45
    v_fmac_f32 v121, v40, v40
    v_fmac_f32 v121, v41, v41
    v_mfma_f32_16x16x32_bf16 v[68:71], v[88:91], a[152:155], v[68:71]
    v_fmac_f32 v121, v42, v42
    v_fmac_f32 v121, v43, v43
    v_mfma_f32_16x16x32_bf16 v[68:71], v[80:83], a[156:159], v[68:71]
    v_cvt_pk_bf16_f32 v170, v156, v121
    v_mfma_f32_16x16x32_bf16 v[68:71], v[56:59], a[160:163], v[68:71]
    ds_read_b128 v[60:63], v132 offset:0
    v_mfma_f32_16x16x32_bf16 v[68:71], v[24:27], a[164:167], v[68:71]
    s_nop 0
    ds_read_b128 v[52:55], v132 offset:16
    s_nop 0
    v_mfma_f32_16x16x16_bf16 v[76:79], v[216:217], v[170:171], 0
    s_nop 0
    ds_read_b128 v[48:51], v132 offset:48
    s_nop 1
    v_cvt_pk_bf16_f32 v164, v68, v69
    v_mfma_f32_16x16x32_bf16 v[84:87], v[96:99], a[168:171], 0
    v_cvt_pk_bf16_f32 v165, v70, v71
    v_mfma_f32_16x16x32_bf16 v[84:87], v[92:95], a[172:175], v[84:87]
    v_rsq_f32 v76, v76
    v_mfma_f32_16x16x32_bf16 v[84:87], v[88:91], a[176:179], v[84:87]
    v_rsq_f32 v77, v77
    v_mfma_f32_16x16x32_bf16 v[84:87], v[80:83], a[180:183], v[84:87]
    v_mul_f32 v76, s55, v76
    v_mul_f32 v77, 0.5, v77
    v_mfma_f32_16x16x32_bf16 v[84:87], v[56:59], a[184:187], v[84:87]
    v_mul_f32 v64, v64, v77
    v_mul_f32 v65, v65, v77
    v_mfma_f32_16x16x32_bf16 v[84:87], v[24:27], a[188:191], v[84:87]
    v_cvt_pk_f16_f32 v64, v64, v65
    v_mul_f32 v66, v66, v77
    v_mfma_f32_16x16x32_bf16 v[68:71], v[96:99], a[192:195], 0
    s_nop 0
    v_mul_f32 v67, v67, v77
    v_cvt_pk_f16_f32 v65, v66, v67
    v_mfma_f32_16x16x32_bf16 v[68:71], v[92:95], a[196:199], v[68:71]
    s_nop 0
    v_cvt_pk_bf16_f32 v160, v84, v85
    v_cvt_pk_bf16_f32 v161, v86, v87
    v_mfma_f32_16x16x32_bf16 v[68:71], v[88:91], a[200:203], v[68:71]
    v_mul_f32 v32, v32, v77
    v_mul_f32 v33, v33, v77
    v_mfma_f32_16x16x32_bf16 v[68:71], v[80:83], a[204:207], v[68:71]
    v_cvt_pk_f16_f32 v66, v32, v33
    v_mul_f32 v34, v34, v77
    v_mfma_f32_16x16x32_bf16 v[68:71], v[56:59], a[208:211], v[68:71]
    v_mul_f32 v35, v35, v77
    v_cvt_pk_f16_f32 v67, v34, v35
    v_mfma_f32_16x16x32_bf16 v[68:71], v[24:27], a[212:215], v[68:71]
    v_mul_f32 v40, v40, v77
    v_mul_f32 v41, v41, v77
    v_mfma_f32_16x16x32_f16 v[32:35], v[28:31], v[4:7], v[204:207]
    ds_read_u16 v166, v131 offset:80
    v_cvt_pk_f16_f32 v142, v40, v41
    v_mfma_f32_16x16x32_f16 v[32:35], v[152:155], v[150:153], v[32:35]
    ds_read_u16 v162, v131 offset:96
    v_mul_f32 v42, v42, v77
    v_mfma_f32_16x16x32_f16 v[24:27], v[72:75], v[4:7], v[200:203]
    ds_read_u16 v158, v131 offset:104
    v_mul_f32 v43, v43, v77
    v_mfma_f32_16x16x32_f16 v[24:27], v[146:149], v[150:153], v[24:27]
    s_waitcnt lgkmcnt(3)
    ds_read_b32 v120, v120 offset:64
    v_cvt_pk_f16_f32 v143, v42, v43
    v_mfma_f32_16x16x32_f16 v[56:59], v[60:63], v[4:7], v[208:211]
    v_mul_f32 v16, v16, v76
    v_mul_f32 v17, v17, v76
    v_mfma_f32_16x16x32_f16 v[56:59], v[52:55], v[28:31], v[56:59]
    v_cvt_pk_f16_f32 v16, v16, v17
    v_mul_f32 v18, v18, v76
    v_mfma_f32_16x16x32_f16 v[56:59], v[48:51], v[152:155], v[56:59]
    v_mul_f32 v19, v19, v76
    v_cvt_pk_f16_f32 v17, v18, v19
    v_mfma_f32_16x16x32_f16 v[40:43], v[60:63], v[44:47], v[208:211]
    v_mul_f32 v36, v36, v76
    v_mul_f32 v37, v37, v76
    v_mfma_f32_16x16x32_f16 v[40:43], v[52:55], v[72:75], v[40:43]
    v_cvt_pk_f16_f32 v18, v36, v37
    v_mul_f32 v38, v38, v76
    v_mfma_f32_16x16x32_f16 v[40:43], v[48:51], v[146:149], v[40:43]
    v_mul_f32 v39, v39, v76
    v_cvt_pk_f16_f32 v19, v38, v39
    v_mfma_f32_16x16x32_f16 v[36:39], v[28:31], v[44:47], v[192:195]
    v_mul_f32 v12, v12, v76
    v_mul_f32 v13, v13, v76
    v_mfma_f32_16x16x32_f16 v[36:39], v[152:155], v[144:147], v[36:39]
    v_cvt_pk_f16_f32 v140, v12, v13
    v_mul_f32 v14, v14, v76
    v_mul_f32 v15, v15, v76
    v_cvt_pk_f16_f32 v141, v14, v15
    v_mfma_f32_16x16x32_f16 v[12:15], v[64:67], v[4:7], v[196:199]
    v_cvt_pk_bf16_f32 v156, v68, v69
    v_cvt_pk_bf16_f32 v157, v70, v71
    v_mfma_f32_16x16x32_f16 v[12:15], v[140:143], v[150:153], v[12:15]
    v_max3_f32 v121, v32, v33, v34
    v_max3_f32 v121, v121, v35, v24
    v_mfma_f32_16x16x32_f16 v[4:7], v[60:63], v[16:19], v[208:211]
    s_nop 0
    v_max3_f32 v121, v121, v25, v26
    v_mov_b32_dpp v59, v43 quad_perm:[0,1,2,3] row_mask:0x2 bank_mask:0xf
    v_mfma_f32_16x16x32_f16 v[4:7], v[52:55], v[64:67], v[4:7]
    s_nop 0
    v_max3_f32 v121, v121, v27, v12
    v_max3_f32 v121, v121, v13, v14
    v_mfma_f32_16x16x32_f16 v[4:7], v[48:51], v[140:143], v[4:7]
    v_max3_f32 v121, v121, v15, v56
    v_mov_b32 v57, v121
    v_mfma_f32_16x16x32_f16 v[52:55], v[72:75], v[44:47], v[188:191]
    s_nop 0
    v_permlane32_swap_b32 v57, v121
    v_mfma_f32_16x16x32_f16 v[52:55], v[146:149], v[144:147], v[52:55]
    v_max_f32 v121, v57, v121
    v_mov_b32 v57, v121
    v_mfma_f32_16x16x32_f16 v[48:51], v[64:67], v[44:47], v[184:187]
    s_nop 0
    v_permlane16_swap_b32 v57, v121
    v_mfma_f32_16x16x32_f16 v[48:51], v[140:143], v[144:147], v[48:51]
    v_max_f32 v121, v57, v121
    v_sub_f32 v32, v32, v121
    v_sub_f32 v33, v33, v121
    v_sub_f32 v34, v34, v121
    v_sub_f32 v35, v35, v121
    v_sub_f32 v24, v24, v121
    v_sub_f32 v25, v25, v121
    v_sub_f32 v26, v26, v121
    v_sub_f32 v27, v27, v121
    v_sub_f32 v12, v12, v121
    v_sub_f32 v13, v13, v121
    v_sub_f32 v14, v14, v121
    v_sub_f32 v15, v15, v121
    v_sub_f32 v56, v56, v121
    v_exp_f32 v32, v32
    v_exp_f32 v33, v33
    v_exp_f32 v34, v34
    v_exp_f32 v35, v35
    v_cvt_pk_bf16_f32 v60, v32, v33
    v_cvt_pk_bf16_f32 v61, v34, v35
    v_exp_f32 v24, v24
    v_exp_f32 v25, v25
    v_exp_f32 v26, v26
    v_exp_f32 v27, v27
    v_cvt_pk_bf16_f32 v62, v24, v25
    v_cvt_pk_bf16_f32 v63, v26, v27
    v_exp_f32 v12, v12
    v_exp_f32 v13, v13
    v_exp_f32 v14, v14
    v_exp_f32 v15, v15
    v_cvt_pk_bf16_f32 v168, v12, v13
    v_cvt_pk_bf16_f32 v169, v14, v15
    v_exp_f32 v56, v56
    v_mov_b32_dpp v59, v7 quad_perm:[0,1,2,3] row_mask:0x4 bank_mask:0xf
    v_cvt_pk_bf16_f32 v170, v56, 0
    v_mfma_f32_16x16x32_bf16 v[44:47], v[220:223], v[60:63], 0
    s_waitcnt lgkmcnt(0)
    v_and_b32 v121, 0xffff0000, v120
    v_lshlrev_b32 v120, 16, v120
    v_mfma_f32_16x16x32_bf16 v[44:47], v[220:223], v[168:171], v[44:47]
    v_add_f32 v120, v120, v121
    v_add_f32 v120, v120, v211
    v_mfma_f32_16x16x32_bf16 v[12:15], v[0:3], v[60:63], 0
    s_nop 0
    v_mov_b32_dpp v59, v120 quad_perm:[0,1,2,3] row_mask:0x8 bank_mask:0xf
    v_mov_b32 v4, v59
    v_mfma_f32_16x16x32_bf16 v[12:15], v[164:167], v[168:171], v[12:15]
    s_nop 0
    v_max_f32_dpp v4, v4, v4 row_ror:8 row_mask:0xf bank_mask:0xf
    v_max3_f32 v121, v36, v37, v38
    v_mfma_f32_16x16x32_bf16 v[24:27], v[8:11], v[60:63], 0
    v_max_f32_dpp v4, v4, v4 row_ror:4 row_mask:0xf bank_mask:0xf
    v_max3_f32 v121, v121, v39, v52
    v_mfma_f32_16x16x32_bf16 v[24:27], v[160:163], v[168:171], v[24:27]
    v_max_f32_dpp v4, v4, v4 row_ror:2 row_mask:0xf bank_mask:0xf
    v_max3_f32 v121, v121, v53, v54
    v_mfma_f32_16x16x32_bf16 v[32:35], v[20:23], v[60:63], 0
    v_max_f32_dpp v4, v4, v4 row_ror:1 row_mask:0xf bank_mask:0xf
    v_mov_b32 v120, v4
    v_mfma_f32_16x16x32_bf16 v[32:35], v[156:159], v[168:171], v[32:35]
    s_nop 0
    v_permlane32_swap_b32 v120, v4
    v_max_f32 v4, v120, v4
    v_mov_b32 v120, v4
    v_rcp_f32 v44, v44
    v_max3_f32 v121, v121, v55, v48
    v_permlane16_swap_b32 v120, v4
    v_max_f32 v4, v120, v4
    v_sub_f32 v59, v59, v4
    v_exp_f32 v59, v59
    v_mul_f32 v12, v12, v44
    v_cvt_pk_bf16_f32 v59, v59, v59
    ds_write_b16 v123, v59 offset:64
    v_mul_f32 v13, v13, v44
    v_cvt_pk_bf16_f32 v68, v12, v13
    ds_read_b128 v[60:63], v132 offset:48
    v_mul_f32 v14, v14, v44
    v_mul_f32 v15, v15, v44
    v_cvt_pk_bf16_f32 v69, v14, v15
    ds_read_b128 v[56:59], v132 offset:64
    v_mfma_f32_16x16x32_f16 v[12:15], v[28:31], v[16:19], v[180:183]
    v_mul_f32 v24, v24, v44
    v_mul_f32 v25, v25, v44
    v_mfma_f32_16x16x32_f16 v[12:15], v[152:155], v[138:141], v[12:15]
    ds_write_b64 v135, v[68:69] offset:0
    v_mfma_f32_16x16x32_f16 v[28:31], v[72:75], v[16:19], v[176:179]
    v_cvt_pk_bf16_f32 v70, v24, v25
    v_mul_f32 v26, v26, v44
    v_mfma_f32_16x16x32_f16 v[28:31], v[146:149], v[138:141], v[28:31]
    v_mul_f32 v27, v27, v44
    v_cvt_pk_bf16_f32 v71, v26, v27
    v_mfma_f32_16x16x32_f16 v[24:27], v[64:67], v[16:19], v[172:175]
    ds_write_b64 v135, v[70:71] offset:8
    v_mfma_f32_16x16x32_f16 v[24:27], v[140:143], v[138:141], v[24:27]
    s_waitcnt lgkmcnt(3)
    v_mul_f32 v32, v32, v44
    v_mul_f32 v33, v33, v44
    v_cvt_pk_bf16_f32 v146, v32, v33
    v_mul_f32 v34, v34, v44
    v_mfma_f32_16x16x32_bf16 v[16:19], v[60:63], v[0:3], 0
    s_waitcnt lgkmcnt(2)
    v_mul_f32 v35, v35, v44
    v_cvt_pk_bf16_f32 v147, v34, v35
    v_max3_f32 v121, v121, v49, v50
    v_max3_f32 v121, v121, v51, v41
    v_mfma_f32_16x16x32_bf16 v[16:19], v[56:59], v[164:167], v[16:19]
    ds_write_b64 v134, v[146:147] offset:0
    v_mfma_f32_16x16x32_bf16 v[44:47], v[60:63], v[8:11], 0
    v_mov_b32 v146, v121
    v_max3_f32 v120, v12, v13, v14
    v_mfma_f32_16x16x32_bf16 v[44:47], v[56:59], v[160:163], v[44:47]
    v_permlane32_swap_b32 v146, v121
    v_mfma_f32_16x16x32_bf16 v[32:35], v[60:63], v[20:23], 0
    v_max_f32 v121, v146, v121
    v_mov_b32 v146, v121
    v_mfma_f32_16x16x32_bf16 v[32:35], v[56:59], v[156:159], v[32:35]
    s_nop 0
    v_permlane16_swap_b32 v146, v121
    v_max_f32 v121, v146, v121
    v_sub_f32 v36, v36, v121
    v_sub_f32 v37, v37, v121
    v_sub_f32 v38, v38, v121
    v_sub_f32 v39, v39, v121
    v_sub_f32 v52, v52, v121
    v_sub_f32 v53, v53, v121
    v_sub_f32 v54, v54, v121
    v_sub_f32 v55, v55, v121
    v_sub_f32 v48, v48, v121
    v_sub_f32 v49, v49, v121
    v_sub_f32 v50, v50, v121
    v_sub_f32 v51, v51, v121
    v_sub_f32 v41, v41, v121
    v_exp_f32 v36, v36
    v_exp_f32 v37, v37
    v_exp_f32 v38, v38
    v_exp_f32 v39, v39
    v_cvt_pk_bf16_f32 v36, v36, v37
    v_cvt_pk_bf16_f32 v37, v38, v39
    v_exp_f32 v52, v52
    v_exp_f32 v53, v53
    v_exp_f32 v54, v54
    v_exp_f32 v55, v55
    v_cvt_pk_bf16_f32 v38, v52, v53
    v_cvt_pk_bf16_f32 v39, v54, v55
    v_exp_f32 v48, v48
    v_exp_f32 v49, v49
    v_exp_f32 v50, v50
    v_exp_f32 v51, v51
    v_cvt_pk_bf16_f32 v168, v48, v49
    v_cvt_pk_bf16_f32 v169, v50, v51
    v_exp_f32 v41, v41
    v_mov_b32_dpp v19, v47 quad_perm:[0,1,2,3] row_mask:0x2 bank_mask:0xf
    v_cvt_pk_bf16_f32 v170, v41, 0
    v_mfma_f32_16x16x32_bf16 v[44:47], v[220:223], v[36:39], 0
    v_mov_b32_dpp v19, v35 quad_perm:[0,1,2,3] row_mask:0x4 bank_mask:0xf
    v_cvt_pk_bf16_f32 v19, v19, v19
    v_mfma_f32_16x16x32_bf16 v[44:47], v[220:223], v[168:171], v[44:47]
    ds_write_b16 v131, v19
    v_mfma_f32_16x16x32_bf16 v[32:35], v[0:3], v[36:39], 0
    ds_read_b128 v[16:19], v137 offset:0
    v_max3_f32 v120, v120, v15, v28
    v_mfma_f32_16x16x32_bf16 v[32:35], v[164:167], v[168:171], v[32:35]
    ds_read_b128 v[146:149], v136 offset:0
    v_max3_f32 v120, v120, v29, v30
    v_mfma_f32_16x16x32_bf16 v[48:51], v[8:11], v[36:39], 0
    ds_read_b128 v[72:75], v137 offset:128
    v_max3_f32 v120, v120, v31, v24
    v_mfma_f32_16x16x32_bf16 v[48:51], v[160:163], v[168:171], v[48:51]
    ds_read_b128 v[88:91], v136 offset:128
    v_max3_f32 v120, v120, v25, v26
    v_mfma_f32_16x16x32_bf16 v[40:43], v[20:23], v[36:39], 0
    ds_read_b128 v[76:79], v137 offset:256
    v_max3_f32 v120, v120, v27, v6
    v_mfma_f32_16x16x32_bf16 v[40:43], v[156:159], v[168:171], v[40:43]
    ds_read_b128 v[56:59], v136 offset:256
    v_mov_b32 v121, v120
    v_rcp_f32 v44, v44
    s_nop 0
    v_mul_f32 v32, v32, v44
    v_mul_f32 v33, v33, v44
    v_cvt_pk_bf16_f32 v32, v32, v33
    v_mul_f32 v34, v34, v44
    v_mul_f32 v35, v35, v44
    v_cvt_pk_bf16_f32 v33, v34, v35
    v_mul_f32 v48, v48, v44
    v_mul_f32 v49, v49, v44
    v_cvt_pk_bf16_f32 v34, v48, v49
    v_mul_f32 v50, v50, v44
    s_waitcnt lgkmcnt(5)
    v_mfma_f32_16x16x32_bf16 v[36:39], a[0:3], v[16:19], 0
    ds_write_b64 v135, v[32:33] offset:1536
    v_mul_f32 v51, v51, v44
    v_cvt_pk_bf16_f32 v35, v50, v51
    v_mul_f32 v40, v40, v44
    v_mul_f32 v41, v41, v44
    v_cvt_pk_bf16_f32 v4, v40, v41
    v_mul_f32 v42, v42, v44
    v_mul_f32 v43, v43, v44
    v_cvt_pk_bf16_f32 v5, v42, v43
    ds_write_b64 v135, v[34:35] offset:1544
    v_permlane32_swap_b32 v121, v120
    v_max_f32 v120, v121, v120
    v_mov_b32 v121, v120
    s_nop 0
    ds_write_b64 v134, v[4:5] offset:1536
    v_permlane16_swap_b32 v121, v120
    v_max_f32 v120, v121, v120
    v_sub_f32 v12, v12, v120
    v_sub_f32 v13, v13, v120
    v_sub_f32 v14, v14, v120
    v_sub_f32 v15, v15, v120
    v_sub_f32 v28, v28, v120
    v_sub_f32 v29, v29, v120
    v_sub_f32 v30, v30, v120
    v_sub_f32 v31, v31, v120
    v_sub_f32 v24, v24, v120
    v_sub_f32 v25, v25, v120
    v_sub_f32 v26, v26, v120
    v_sub_f32 v27, v27, v120
    v_sub_f32 v6, v6, v120
    v_exp_f32 v12, v12
    v_exp_f32 v13, v13
    v_exp_f32 v14, v14
    v_exp_f32 v15, v15
    v_cvt_pk_bf16_f32 v12, v12, v13
    v_cvt_pk_bf16_f32 v13, v14, v15
    v_exp_f32 v28, v28
    v_exp_f32 v29, v29
    v_exp_f32 v30, v30
    v_exp_f32 v31, v31
    v_cvt_pk_bf16_f32 v14, v28, v29
    v_cvt_pk_bf16_f32 v15, v30, v31
    v_exp_f32 v24, v24
    v_exp_f32 v25, v25
    v_exp_f32 v26, v26
    v_exp_f32 v27, v27
    v_cvt_pk_bf16_f32 v168, v24, v25
    v_cvt_pk_bf16_f32 v169, v26, v27
    v_exp_f32 v6, v6
    s_nop 0
    v_cvt_pk_bf16_f32 v170, v6, 0
    v_mfma_f32_16x16x32_bf16 v[152:155], v[220:223], v[12:15], 0
    s_nop 0
    v_mfma_f32_16x16x32_bf16 v[152:155], v[220:223], v[168:171], v[152:155]
    s_nop 1
    v_mfma_f32_16x16x32_bf16 v[4:7], v[0:3], v[12:15], 0
    s_nop 2
    v_mfma_f32_16x16x32_bf16 v[4:7], v[164:167], v[168:171], v[4:7]
    s_nop 0
    v_rcp_f32 v152, v152
    v_mfma_f32_16x16x32_bf16 v[0:3], v[8:11], v[12:15], 0
    s_nop 2
    v_mfma_f32_16x16x32_bf16 v[0:3], v[160:163], v[168:171], v[0:3]
    s_nop 0
    v_mul_f32 v4, v4, v152
    v_mul_f32 v5, v5, v152
    v_mfma_f32_16x16x32_bf16 v[8:11], v[20:23], v[12:15], 0
    v_cvt_pk_bf16_f32 v12, v4, v5
    v_mul_f32 v6, v6, v152
    v_mfma_f32_16x16x32_bf16 v[8:11], v[156:159], v[168:171], v[8:11]
    v_mul_f32 v7, v7, v152
    v_cvt_pk_bf16_f32 v13, v6, v7
    s_waitcnt lgkmcnt(0)
.p2align 6
L_loopS0:
    v_mfma_f32_16x16x32_bf16 v[36:39], a[4:7], v[146:149], v[36:39]
    ds_write_b64 v135, v[12:13] offset:3072
    v_mfma_f32_16x16x32_bf16 v[36:39], a[8:11], v[72:75], v[36:39]
    v_mul_f32 v0, v0, v152
    v_mul_f32 v1, v1, v152
    v_mfma_f32_16x16x32_bf16 v[36:39], a[12:15], v[88:91], v[36:39]
    v_cvt_pk_bf16_f32 v14, v0, v1
    v_mul_f32 v2, v2, v152
    v_mfma_f32_16x16x32_bf16 v[36:39], a[16:19], v[76:79], v[36:39]
    v_mul_f32 v3, v3, v152
    v_cvt_pk_bf16_f32 v15, v2, v3
    v_mfma_f32_16x16x32_bf16 v[36:39], a[20:23], v[56:59], v[36:39]
    ds_write_b64 v135, v[14:15] offset:3080
    v_mfma_f32_16x16x32_bf16 v[12:15], a[24:27], v[16:19], 0
    v_mul_f32 v8, v8, v152
    v_mul_f32 v9, v9, v152
    v_mfma_f32_16x16x32_bf16 v[12:15], a[28:31], v[146:149], v[12:15]
    v_cvt_pk_bf16_f32 v8, v8, v9
    v_mul_f32 v10, v10, v152
    v_mfma_f32_16x16x32_bf16 v[12:15], a[32:35], v[72:75], v[12:15]
    v_mul_f32 v11, v11, v152
    v_cvt_pk_bf16_f32 v9, v10, v11
    v_mfma_f32_16x16x32_bf16 v[12:15], a[36:39], v[88:91], v[12:15]
    ds_write_b64 v134, v[8:9] offset:3072
    v_mfma_f32_16x16x32_bf16 v[12:15], a[40:43], v[76:79], v[12:15]
    v_fma_f32 v170, v40, v40, s42
    v_fmac_f32 v170, v41, v41
    v_mfma_f32_16x16x32_bf16 v[12:15], a[44:47], v[56:59], v[12:15]
    v_fmac_f32 v170, v42, v42
    v_fmac_f32 v170, v43, v43
    v_mfma_f32_16x16x32_bf16 v[152:155], a[48:51], v[16:19], 0
    v_fmac_f32 v170, v140, v140
    v_fmac_f32 v170, v141, v141
    v_mfma_f32_16x16x32_bf16 v[152:155], a[52:55], v[146:149], v[152:155]
    v_fmac_f32 v170, v142, v142
    v_fmac_f32 v170, v143, v143
    v_mfma_f32_16x16x32_bf16 v[152:155], a[56:59], v[72:75], v[152:155]
    s_waitcnt vmcnt(10)
    v_fmac_f32 v170, v44, v44
    v_fmac_f32 v170, v45, v45
    v_mfma_f32_16x16x32_bf16 v[152:155], a[60:63], v[88:91], v[152:155]
    v_fmac_f32 v170, v46, v46
    v_fmac_f32 v170, v47, v47
    v_mfma_f32_16x16x32_bf16 v[152:155], a[64:67], v[76:79], v[152:155]
    v_cvt_pk_bf16_f32 v0, v92, v93
    v_cvt_pk_bf16_f32 v1, v170, v122
    v_mfma_f32_16x16x32_bf16 v[152:155], a[68:71], v[56:59], v[152:155]
    ds_write_b64 v130, v[0:1]
    v_mfma_f32_16x16x32_bf16 v[60:63], a[72:75], v[16:19], 0
    v_add_u32 v135, s49, v135
    v_add_u32 v134, s49, v134
    v_mfma_f32_16x16x32_bf16 v[60:63], a[76:79], v[146:149], v[60:63]
    v_fma_f32 v170, v36, v36, s41
    v_fmac_f32 v170, v37, v37
    v_mfma_f32_16x16x32_bf16 v[60:63], a[80:83], v[72:75], v[60:63]
    v_fmac_f32 v170, v38, v38
    v_fmac_f32 v170, v39, v39
    v_mfma_f32_16x16x32_bf16 v[60:63], a[84:87], v[88:91], v[60:63]
    v_fmac_f32 v170, v12, v12
    v_fmac_f32 v170, v13, v13
    v_mfma_f32_16x16x32_bf16 v[60:63], a[88:91], v[76:79], v[60:63]
    v_fmac_f32 v170, v14, v14
    v_fmac_f32 v170, v15, v15
    v_mfma_f32_16x16x32_bf16 v[60:63], a[92:95], v[56:59], v[60:63]
    v_fmac_f32 v170, v152, v152
    v_fmac_f32 v170, v153, v153
    v_mfma_f32_16x16x32_bf16 v[92:95], a[96:99], v[16:19], 0
    v_fmac_f32 v170, v154, v154
    v_fmac_f32 v170, v155, v155
    v_mfma_f32_16x16x32_bf16 v[92:95], a[100:103], v[146:149], v[92:95]
    s_waitcnt lgkmcnt(0)
    s_nop 0
    v_fma_f32 v0, v60, v60, s41
    v_fmac_f32 v0, v61, v61
    v_mfma_f32_16x16x32_bf16 v[92:95], a[104:107], v[72:75], v[92:95]
    s_barrier
    ds_read_b128 v[8:11], v129 offset:0
    v_fmac_f32 v0, v62, v62
    v_mfma_f32_16x16x32_bf16 v[92:95], a[108:111], v[88:91], v[92:95]
    ds_read_b128 v[64:67], v129 offset:1024
    v_fmac_f32 v0, v63, v63
    v_mfma_f32_16x16x32_bf16 v[92:95], a[112:115], v[76:79], v[92:95]
    v_mfma_f32_16x16x32_bf16 v[92:95], a[116:119], v[56:59], v[92:95]
    s_nop 1
    v_mfma_f32_16x16x32_bf16 v[80:83], a[120:123], v[16:19], 0
    s_nop 2
    v_mfma_f32_16x16x32_bf16 v[80:83], a[124:127], v[146:149], v[80:83]
    s_nop 0
    v_fmac_f32 v0, v92, v92
    v_fmac_f32 v0, v93, v93
    v_mfma_f32_16x16x32_bf16 v[80:83], a[128:131], v[72:75], v[80:83]
    v_fmac_f32 v0, v94, v94
    v_fmac_f32 v0, v95, v95
    v_mfma_f32_16x16x32_bf16 v[80:83], a[132:135], v[88:91], v[80:83]
    v_mfma_f32_16x16x32_bf16 v[80:83], a[136:139], v[76:79], v[80:83]
    v_mfma_f32_16x16x32_bf16 v[80:83], a[140:143], v[56:59], v[80:83]
    s_waitcnt lgkmcnt(1)
    v_readfirstlane_b32 s12, v9
    v_mfma_f32_16x16x32_bf16 v[84:87], v[216:219], v[8:11], 0
    s_waitcnt lgkmcnt(0)
    s_nop 1
    v_mfma_f32_16x16x32_bf16 v[84:87], v[216:219], v[64:67], v[84:87]
    s_lshr_b32 s12, s12, 23
    v_fmac_f32 v0, v80, v80
    v_fmac_f32 v0, v81, v81
    v_mfma_f32_16x16x32_bf16 v[8:11], v[16:19], a[144:147], 0
    v_fmac_f32 v0, v82, v82
    v_fmac_f32 v0, v83, v83
    v_mfma_f32_16x16x32_bf16 v[8:11], v[146:149], a[148:151], v[8:11]
    s_nop 0
    v_rsq_f32 v84, v84
    v_mfma_f32_16x16x32_bf16 v[8:11], v[72:75], a[152:155], v[8:11]
    v_rsq_f32 v85, v85
    v_mfma_f32_16x16x32_bf16 v[8:11], v[88:91], a[156:159], v[8:11]
    v_rsq_f32 v86, v86
    v_mfma_f32_16x16x32_bf16 v[8:11], v[76:79], a[160:163], v[8:11]
    ds_read_b128 v[64:67], v137 offset:1536
    v_mul_f32 v84, s43, v84
    v_mfma_f32_16x16x32_bf16 v[8:11], v[56:59], a[164:167], v[8:11]
    ds_read_b128 v[68:71], v136 offset:1536
    v_mul_f32 v85, s43, v85
    v_mfma_f32_16x16x32_bf16 v[48:51], v[16:19], a[168:171], 0
    ds_read_b128 v[52:55], v137 offset:1664
    v_mul_f32 v86, s43, v86
    v_mfma_f32_16x16x32_bf16 v[48:51], v[146:149], a[172:175], v[48:51]
    ds_read_b128 v[96:99], v136 offset:1664
    v_cvt_pk_bf16_f32 v170, v170, v0
    v_mfma_f32_16x16x32_bf16 v[48:51], v[72:75], a[176:179], v[48:51]
    ds_read_b128 v[108:111], v137 offset:1792
    v_cvt_pk_bf16_f32 v0, v8, v9
    v_mfma_f32_16x16x32_bf16 v[48:51], v[88:91], a[180:183], v[48:51]
    ds_read_b128 v[104:107], v136 offset:1792
    v_cvt_pk_bf16_f32 v1, v10, v11
    v_mfma_f32_16x16x32_bf16 v[48:51], v[76:79], a[184:187], v[48:51]
    v_mul_f32 v32, v32, v84
    v_mul_f32 v33, v33, v84
    v_mfma_f32_16x16x32_bf16 v[48:51], v[56:59], a[188:191], v[48:51]
    s_nop 0
    v_cvt_pk_bf16_f32 v2, v32, v33
    v_mul_f32 v34, v34, v84
    v_mfma_f32_16x16x16_bf16 v[118:121], v[216:217], v[170:171], 0
    s_nop 0
    v_mul_f32 v35, v35, v84
    v_cvt_pk_bf16_f32 v3, v34, v35
    v_mul_f32 v4, v4, v84
    v_cvt_pk_bf16_f32 v8, v48, v49
    v_mfma_f32_16x16x32_bf16 v[32:35], v[16:19], a[192:195], 0
    ds_write_b64 v135, v[2:3] offset:0
    v_mfma_f32_16x16x32_bf16 v[32:35], v[146:149], a[196:199], v[32:35]
    v_rsq_f32 v118, v118
    v_mfma_f32_16x16x32_bf16 v[32:35], v[72:75], a[200:203], v[32:35]
    v_rsq_f32 v119, v119
    v_mfma_f32_16x16x32_bf16 v[32:35], v[88:91], a[204:207], v[32:35]
    v_mul_f32 v118, s55, v118
    v_mul_f32 v119, 0.5, v119
    v_mfma_f32_16x16x32_bf16 v[32:35], v[76:79], a[208:211], v[32:35]
    v_cvt_pk_bf16_f32 v9, v50, v51
    v_mul_f32 v36, v36, v118
    v_mfma_f32_16x16x32_bf16 v[32:35], v[56:59], a[212:215], v[32:35]
    s_waitcnt lgkmcnt(1)
    v_mul_f32 v37, v37, v118
    v_cvt_pk_f16_f32 v76, v36, v37
    v_mfma_f32_16x16x32_bf16 v[146:149], a[0:3], v[64:67], 0
    v_mul_f32 v38, v38, v118
    v_mul_f32 v39, v39, v118
    v_mfma_f32_16x16x32_bf16 v[146:149], a[4:7], v[68:71], v[146:149]
    v_cvt_pk_f16_f32 v77, v38, v39
    v_mul_f32 v12, v12, v118
    v_mfma_f32_16x16x32_bf16 v[146:149], a[8:11], v[52:55], v[146:149]
    v_mul_f32 v13, v13, v118
    v_cvt_pk_f16_f32 v78, v12, v13
    v_mfma_f32_16x16x32_bf16 v[146:149], a[12:15], v[96:99], v[146:149]
    v_mul_f32 v14, v14, v118
    v_mul_f32 v15, v15, v118
    v_mfma_f32_16x16x32_bf16 v[146:149], a[16:19], v[108:111], v[146:149]
    v_cvt_pk_f16_f32 v79, v14, v15
    v_mul_f32 v152, v152, v118
    v_mfma_f32_16x16x32_bf16 v[146:149], a[20:23], v[104:107], v[146:149]
    v_mul_f32 v153, v153, v118
    v_cvt_pk_f16_f32 v152, v152, v153
    v_mfma_f32_16x16x32_bf16 v[36:39], a[24:27], v[64:67], 0
    v_mul_f32 v154, v154, v118
    v_mul_f32 v155, v155, v118
    v_mfma_f32_16x16x32_bf16 v[36:39], a[28:31], v[68:71], v[36:39]
    v_cvt_pk_f16_f32 v153, v154, v155
    v_mul_f32 v60, v60, v119
    v_mfma_f32_16x16x32_bf16 v[36:39], a[32:35], v[52:55], v[36:39]
    v_mul_f32 v61, v61, v119
    v_cvt_pk_f16_f32 v16, v60, v61
    v_mfma_f32_16x16x32_bf16 v[36:39], a[36:39], v[96:99], v[36:39]
    v_mul_f32 v62, v62, v119
    v_mul_f32 v63, v63, v119
    v_mfma_f32_16x16x32_bf16 v[36:39], a[40:43], v[108:111], v[36:39]
    v_cvt_pk_f16_f32 v17, v62, v63
    v_mul_f32 v92, v92, v119
    v_mfma_f32_16x16x32_bf16 v[36:39], a[44:47], v[104:107], v[36:39]
    v_mul_f32 v93, v93, v119
    v_cvt_pk_f16_f32 v18, v92, v93
    v_mfma_f32_16x16x32_bf16 v[72:75], a[48:51], v[64:67], 0
    v_mul_f32 v94, v94, v119
    v_mul_f32 v95, v95, v119
    v_mfma_f32_16x16x32_bf16 v[72:75], a[52:55], v[68:71], v[72:75]
    v_cvt_pk_f16_f32 v19, v94, v95
    v_mul_f32 v80, v80, v119
    v_mfma_f32_16x16x32_bf16 v[72:75], a[56:59], v[52:55], v[72:75]
    v_mul_f32 v81, v81, v119
    v_cvt_pk_f16_f32 v154, v80, v81
    v_mfma_f32_16x16x32_bf16 v[72:75], a[60:63], v[96:99], v[72:75]
    v_mul_f32 v82, v82, v119
    v_mul_f32 v83, v83, v119
    v_mfma_f32_16x16x32_bf16 v[72:75], a[64:67], v[108:111], v[72:75]
    v_cvt_pk_f16_f32 v155, v82, v83
    v_cvt_pk_bf16_f32 v12, v32, v33
    v_mfma_f32_16x16x32_bf16 v[72:75], a[68:71], v[104:107], v[72:75]
    v_cvt_pk_bf16_f32 v13, v34, v35
    v_mul_f32 v5, v5, v84
    v_mfma_f32_16x16x32_bf16 v[32:35], a[72:75], v[64:67], 0
    v_cvt_pk_bf16_f32 v4, v4, v5
    v_mul_f32 v6, v6, v84
    v_mfma_f32_16x16x32_bf16 v[32:35], a[76:79], v[68:71], v[32:35]
    v_mul_f32 v7, v7, v84
    v_cvt_pk_bf16_f32 v5, v6, v7
    v_mfma_f32_16x16x32_bf16 v[32:35], a[80:83], v[52:55], v[32:35]
    ds_write_b64 v135, v[4:5] offset:8
    v_mfma_f32_16x16x32_bf16 v[32:35], a[84:87], v[96:99], v[32:35]
    v_mul_f32 v24, v24, v84
    v_mul_f32 v25, v25, v84
    v_mfma_f32_16x16x32_bf16 v[32:35], a[88:91], v[108:111], v[32:35]
    v_cvt_pk_bf16_f32 v2, v24, v25
    v_mul_f32 v26, v26, v84
    v_mfma_f32_16x16x32_bf16 v[32:35], a[92:95], v[104:107], v[32:35]
    v_mul_f32 v27, v27, v84
    v_cvt_pk_bf16_f32 v3, v26, v27
    v_mfma_f32_16x16x32_bf16 v[4:7], a[96:99], v[64:67], 0
    ds_write_b64 v134, v[2:3] offset:0
    v_mfma_f32_16x16x32_bf16 v[4:7], a[100:103], v[68:71], v[4:7]
    v_fma_f32 v2, v146, v146, s41
    v_fmac_f32 v2, v147, v147
    v_mfma_f32_16x16x32_bf16 v[4:7], a[104:107], v[52:55], v[4:7]
    v_fmac_f32 v2, v148, v148
    v_fmac_f32 v2, v149, v149
    v_mfma_f32_16x16x32_bf16 v[4:7], a[108:111], v[96:99], v[4:7]
    v_fmac_f32 v2, v36, v36
    v_fmac_f32 v2, v37, v37
    v_mfma_f32_16x16x32_bf16 v[4:7], a[112:115], v[108:111], v[4:7]
    v_fmac_f32 v2, v38, v38
    v_fmac_f32 v2, v39, v39
    v_mfma_f32_16x16x32_bf16 v[4:7], a[116:119], v[104:107], v[4:7]
    v_fmac_f32 v2, v72, v72
    v_fmac_f32 v2, v73, v73
    v_mfma_f32_16x16x32_bf16 v[24:27], a[120:123], v[64:67], 0
    v_fmac_f32 v2, v74, v74
    v_fmac_f32 v2, v75, v75
    v_mfma_f32_16x16x32_bf16 v[24:27], a[124:127], v[68:71], v[24:27]
    v_mul_f32 v28, v28, v85
    v_mul_f32 v29, v29, v85
    v_mfma_f32_16x16x32_bf16 v[24:27], a[128:131], v[52:55], v[24:27]
    v_cvt_pk_bf16_f32 v88, v28, v29
    v_mul_f32 v30, v30, v85
    v_mfma_f32_16x16x32_bf16 v[24:27], a[132:135], v[96:99], v[24:27]
    v_mul_f32 v31, v31, v85
    v_cvt_pk_bf16_f32 v89, v30, v31
    v_mfma_f32_16x16x32_bf16 v[24:27], a[136:139], v[108:111], v[24:27]
    ds_write_b64 v135, v[88:89] offset:1536
    v_mfma_f32_16x16x32_bf16 v[24:27], a[140:143], v[104:107], v[24:27]
    v_mul_f32 v20, v20, v85
    v_mul_f32 v21, v21, v85
    v_mfma_f32_16x16x32_bf16 v[60:63], v[64:67], a[144:147], 0
    v_cvt_pk_bf16_f32 v90, v20, v21
    v_mul_f32 v22, v22, v85
    v_mfma_f32_16x16x32_bf16 v[60:63], v[68:71], a[148:151], v[60:63]
    v_mul_f32 v23, v23, v85
    v_cvt_pk_bf16_f32 v91, v22, v23
    v_mfma_f32_16x16x32_bf16 v[60:63], v[52:55], a[152:155], v[60:63]
    ds_write_b64 v135, v[90:91] offset:1544
    v_mfma_f32_16x16x32_bf16 v[60:63], v[96:99], a[156:159], v[60:63]
    v_mul_f32 v114, v114, v85
    v_mul_f32 v115, v115, v85
    v_mfma_f32_16x16x32_bf16 v[60:63], v[108:111], a[160:163], v[60:63]
    ds_read_b128 v[88:91], v137 offset:3072
    v_cvt_pk_bf16_f32 v10, v114, v115
    v_mfma_f32_16x16x32_bf16 v[60:63], v[104:107], a[164:167], v[60:63]
    ds_read_b128 v[56:59], v136 offset:3072
    v_mul_f32 v116, v116, v85
    v_mfma_f32_16x16x32_bf16 v[92:95], v[64:67], a[168:171], 0
    ds_read_b128 v[80:83], v137 offset:3200
    v_mul_f32 v117, v117, v85
    v_mfma_f32_16x16x32_bf16 v[92:95], v[68:71], a[172:175], v[92:95]
    ds_read_b128 v[28:31], v136 offset:3200
    v_cvt_pk_bf16_f32 v11, v116, v117
    v_mfma_f32_16x16x32_bf16 v[92:95], v[52:55], a[176:179], v[92:95]
    ds_write_b64 v134, v[10:11] offset:1536
    v_mfma_f32_16x16x32_bf16 v[92:95], v[96:99], a[180:183], v[92:95]
    v_fma_f32 v3, v32, v32, s41
    v_fmac_f32 v3, v33, v33
    v_mfma_f32_16x16x32_bf16 v[92:95], v[108:111], a[184:187], v[92:95]
    ds_read_b128 v[48:51], v137 offset:3328
    v_fmac_f32 v3, v34, v34
    v_mfma_f32_16x16x32_bf16 v[92:95], v[104:107], a[188:191], v[92:95]
    ds_read_b128 v[20:23], v136 offset:3328
    v_fmac_f32 v3, v35, v35
    v_mfma_f32_16x16x32_bf16 v[112:115], v[64:67], a[192:195], 0
    v_fmac_f32 v3, v4, v4
    v_fmac_f32 v3, v5, v5
    v_mfma_f32_16x16x32_bf16 v[112:115], v[68:71], a[196:199], v[112:115]
    s_sub_u32 s50, s45, s44
    v_fmac_f32 v3, v6, v6
    v_fmac_f32 v3, v7, v7
    v_mfma_f32_16x16x32_bf16 v[112:115], v[52:55], a[200:203], v[112:115]
    s_sub_u32 s51, s46, s47
    v_fmac_f32 v3, v24, v24
    v_fmac_f32 v3, v25, v25
    v_mfma_f32_16x16x32_bf16 v[112:115], v[96:99], a[204:207], v[112:115]
    s_mov_b32 s60, s59
    v_fmac_f32 v3, v26, v26
    v_fmac_f32 v3, v27, v27
    v_mfma_f32_16x16x32_bf16 v[112:115], v[108:111], a[208:211], v[112:115]
    s_mov_b32 s59, s58
    v_cvt_pk_bf16_f32 v170, v2, v3
    v_cvt_pk_bf16_f32 v2, v60, v61
    v_mfma_f32_16x16x32_bf16 v[112:115], v[104:107], a[212:215], v[112:115]
    s_mov_b32 s58, s57
    v_cvt_pk_bf16_f32 v3, v62, v63
    v_cvt_pk_bf16_f32 v10, v92, v93
    v_mfma_f32_16x16x16_bf16 v[60:63], v[216:217], v[170:171], 0
    s_waitcnt lgkmcnt(2)
    s_mov_b32 s57, s56
    v_cvt_pk_bf16_f32 v11, v94, v95
    v_mul_f32 v40, v40, v86
    v_mul_f32 v41, v41, v86
    v_cvt_pk_bf16_f32 v14, v112, v113
    v_mfma_f32_16x16x32_bf16 v[92:95], a[0:3], v[88:91], 0
    s_mov_b32 s7, s6
    v_cvt_pk_bf16_f32 v15, v114, v115
    v_cvt_pk_bf16_f32 v40, v40, v41
    v_mfma_f32_16x16x32_bf16 v[92:95], a[4:7], v[56:59], v[92:95]
    s_mov_b32 s6, s5
    v_rsq_f32 v60, v60
    v_mfma_f32_16x16x32_bf16 v[92:95], a[8:11], v[80:83], v[92:95]
    s_mov_b32 s5, s4
    v_rsq_f32 v61, v61
    v_mfma_f32_16x16x32_bf16 v[92:95], a[12:15], v[28:31], v[92:95]
    s_waitcnt lgkmcnt(0)
    s_sub_u32 s14, s6, s7
    v_mul_f32 v60, s55, v60
    v_mul_f32 v61, 0.5, v61
    v_mfma_f32_16x16x32_bf16 v[92:95], a[16:19], v[48:51], v[92:95]
    s_add_u32 s61, s61, 1
    v_mul_f32 v146, v146, v60
    v_mul_f32 v147, v147, v60
    v_mfma_f32_16x16x32_bf16 v[92:95], a[20:23], v[20:23], v[92:95]
    s_ff1_i32_b32 s15, s66
    v_cvt_pk_f16_f32 v96, v146, v147
    v_mul_f32 v148, v148, v60
    v_mfma_f32_16x16x32_bf16 v[64:67], a[24:27], v[88:91], 0
    s_cmp_lg_u32 s66, 0
    v_mul_f32 v149, v149, v60
    v_cvt_pk_f16_f32 v97, v148, v149
    v_mfma_f32_16x16x32_bf16 v[64:67], a[28:31], v[56:59], v[64:67]
    s_cselect_b32 s12, s15, s12
    v_mul_f32 v36, v36, v60
    v_mul_f32 v37, v37, v60
    v_mfma_f32_16x16x32_bf16 v[64:67], a[32:35], v[80:83], v[64:67]
    s_cmp_lt_u32 s61, s71
    v_cvt_pk_f16_f32 v98, v36, v37
    v_mul_f32 v38, v38, v60
    v_mfma_f32_16x16x32_bf16 v[64:67], a[36:39], v[28:31], v[64:67]
    s_cselect_b32 s15, 31, s15
    v_mul_f32 v39, v39, v60
    v_cvt_pk_f16_f32 v99, v38, v39
    v_mfma_f32_16x16x32_bf16 v[64:67], a[40:43], v[48:51], v[64:67]
    s_bitset0_b32 s66, s15
    v_mul_f32 v72, v72, v60
    v_mul_f32 v73, v73, v60
    v_mfma_f32_16x16x32_bf16 v[64:67], a[44:47], v[20:23], v[64:67]
    s_add_u32 s12, s12, 20
    v_cvt_pk_f16_f32 v146, v72, v73
    v_mul_f32 v74, v74, v60
    v_mfma_f32_16x16x32_bf16 v[68:71], a[48:51], v[88:91], 0
    s_max_u32 s12, s12, s61
    v_mul_f32 v75, v75, v60
    v_cvt_pk_f16_f32 v147, v74, v75
    v_mfma_f32_16x16x32_bf16 v[68:71], a[52:55], v[56:59], v[68:71]
    s_cmp_lt_u32 s61, s71
    v_mul_f32 v32, v32, v61
    v_mul_f32 v33, v33, v61
    v_mfma_f32_16x16x32_bf16 v[68:71], a[56:59], v[80:83], v[68:71]
    s_cselect_b32 s15, s61, s12
    v_cvt_pk_f16_f32 v36, v32, v33
    v_mul_f32 v34, v34, v61
    v_mfma_f32_16x16x32_bf16 v[68:71], a[60:63], v[28:31], v[68:71]
    s_cselect_b32 s56, s69, s70
    v_mul_f32 v35, v35, v61
    v_cvt_pk_f16_f32 v37, v34, v35
    v_mfma_f32_16x16x32_bf16 v[68:71], a[64:67], v[48:51], v[68:71]
    s_add_u32 s56, s56, s15
    v_mul_f32 v4, v4, v61
    v_mul_f32 v5, v5, v61
    v_mfma_f32_16x16x32_bf16 v[68:71], a[68:71], v[20:23], v[68:71]
    s_mul_i32 s53, s56, 58255
    v_cvt_pk_f16_f32 v38, v4, v5
    v_mul_f32 v6, v6, v61
    v_mfma_f32_16x16x32_bf16 v[72:75], a[72:75], v[88:91], 0
    s_lshr_b32 s53, s53, 22
    v_mul_f32 v7, v7, v61
    v_cvt_pk_f16_f32 v39, v6, v7
    v_mfma_f32_16x16x32_bf16 v[72:75], a[76:79], v[56:59], v[72:75]
    s_mul_i32 s53, s53, s63
    v_mul_f32 v24, v24, v61
    v_mul_f32 v25, v25, v61
    v_mfma_f32_16x16x32_bf16 v[72:75], a[80:83], v[80:83], v[72:75]
    s_mul_i32 s56, s56, s62
    v_cvt_pk_f16_f32 v148, v24, v25
    v_mul_f32 v26, v26, v61
    v_mfma_f32_16x16x32_bf16 v[72:75], a[84:87], v[28:31], v[72:75]
    s_add_u32 s56, s56, s53
    v_mul_f32 v27, v27, v61
    v_cvt_pk_f16_f32 v149, v26, v27
    v_mfma_f32_16x16x32_bf16 v[72:75], a[88:91], v[48:51], v[72:75]
    s_mul_i32 s4, s15, 112
    v_mul_f32 v42, v42, v86
    v_mul_f32 v43, v43, v86
    v_mfma_f32_16x16x32_bf16 v[72:75], a[92:95], v[20:23], v[72:75]
    s_cmp_ge_u32 s15, 16
    v_cvt_pk_bf16_f32 v41, v42, v43
    v_mul_f32 v140, v140, v86
    v_mfma_f32_16x16x32_bf16 v[4:7], a[96:99], v[88:91], 0
    s_cselect_b32 s53, -30464, 0
    ds_write_b64 v135, v[40:41] offset:3072
    v_mfma_f32_16x16x32_bf16 v[4:7], a[100:103], v[56:59], v[4:7]
    s_add_u32 s4, s4, s53
    v_mul_f32 v141, v141, v86
    v_cvt_pk_bf16_f32 v42, v140, v141
    v_mfma_f32_16x16x32_bf16 v[4:7], a[104:107], v[80:83], v[4:7]
    s_cmp_lt_u32 s15, s73
    v_mul_f32 v142, v142, v86
    v_mul_f32 v143, v143, v86
    v_mfma_f32_16x16x32_bf16 v[4:7], a[108:111], v[28:31], v[4:7]
    s_cselect_b32 s26, 100270464, 0
    v_cvt_pk_bf16_f32 v43, v142, v143
    v_mul_f32 v44, v44, v86
    v_mfma_f32_16x16x32_bf16 v[4:7], a[112:115], v[48:51], v[4:7]
    s_cselect_b32 s56, s56, 0
    ds_write_b64 v135, v[42:43] offset:3080
    v_mfma_f32_16x16x32_bf16 v[4:7], a[116:119], v[20:23], v[4:7]
    s_cselect_b32 s4, s4, -1
    v_mul_f32 v45, v45, v86
    v_cvt_pk_bf16_f32 v44, v44, v45
    v_mul_f32 v46, v46, v86
    v_mul_f32 v47, v47, v86
    v_cvt_pk_bf16_f32 v45, v46, v47
    s_cselect_b32 s15, s15, 0
    s_cselect_b32 s13, s13, -1
    ds_write_b64 v134, v[44:45] offset:3072
    v_fma_f32 v120, v92, v92, s41
    v_fmac_f32 v120, v93, v93
    v_fmac_f32 v120, v94, v94
    v_fmac_f32 v120, v95, v95
    v_mfma_f32_16x16x32_bf16 v[24:27], a[120:123], v[88:91], 0
    s_waitcnt vmcnt(0)
    v_fmac_f32 v120, v64, v64
    v_fmac_f32 v120, v65, v65
    v_mfma_f32_16x16x32_bf16 v[24:27], a[124:127], v[56:59], v[24:27]
    s_bitset1_b32 s64, s15
    v_fmac_f32 v120, v66, v66
    v_fmac_f32 v120, v67, v67
    v_mfma_f32_16x16x32_bf16 v[24:27], a[128:131], v[80:83], v[24:27]
    s_add_u32 s65, s65, 1
    v_fmac_f32 v120, v68, v68
    v_fmac_f32 v120, v69, v69
    v_mfma_f32_16x16x32_bf16 v[24:27], a[132:135], v[28:31], v[24:27]
    s_cmp_ge_i32 s65, 2
    v_fmac_f32 v120, v70, v70
    v_fmac_f32 v120, v71, v71
    v_mfma_f32_16x16x32_bf16 v[24:27], a[136:139], v[48:51], v[24:27]
    s_cselect_b32 s30, 100270464, 0
    v_fma_f32 v121, v72, v72, s41
    v_fmac_f32 v121, v73, v73
    v_mfma_f32_16x16x32_bf16 v[24:27], a[140:143], v[20:23], v[24:27]
    s_add_u32 s67, s46, s54
    v_fmac_f32 v121, v74, v74
    v_fmac_f32 v121, v75, v75
    v_mfma_f32_16x16x32_bf16 v[32:35], v[88:91], a[144:147], 0
    s_waitcnt lgkmcnt(0)
    s_add_u32 m0, s67, 0
    v_fmac_f32 v121, v4, v4
    v_fmac_f32 v121, v5, v5
    v_mfma_f32_16x16x32_bf16 v[32:35], v[56:59], a[148:151], v[32:35]
    s_barrier
    v_fmac_f32 v121, v6, v6
    v_fmac_f32 v121, v7, v7
    v_mfma_f32_16x16x32_bf16 v[32:35], v[80:83], a[152:155], v[32:35]
    s_cmp_ge_u32 s61, s13
    v_fmac_f32 v121, v24, v24
    v_fmac_f32 v121, v25, v25
    v_mfma_f32_16x16x32_bf16 v[32:35], v[28:31], a[156:159], v[32:35]
    s_cbranch_scc1 L_atomS0
L_atomS0r:
    v_mfma_f32_16x16x32_bf16 v[32:35], v[48:51], a[160:163], v[32:35]
    v_fmac_f32 v121, v26, v26
    v_fmac_f32 v121, v27, v27
    v_mfma_f32_16x16x32_bf16 v[32:35], v[20:23], a[164:167], v[32:35]
    v_cvt_pk_bf16_f32 v170, v120, v121
    v_add_u32 v137, s50, v137
    v_mfma_f32_16x16x32_bf16 v[40:43], v[88:91], a[168:171], 0
    ds_read_b128 v[60:63], v137 offset:0
    v_add_u32 v136, s50, v136
    v_mfma_f32_16x16x32_bf16 v[40:43], v[56:59], a[172:175], v[40:43]
    s_nop 0
    ds_read_b128 v[84:87], v136 offset:0
    v_cvt_pk_bf16_f32 v164, v32, v33
    v_mfma_f32_16x16x32_bf16 v[40:43], v[80:83], a[176:179], v[40:43]
    ds_read_b128 v[52:55], v137 offset:128
    v_cvt_pk_bf16_f32 v165, v34, v35
    v_mfma_f32_16x16x32_bf16 v[40:43], v[28:31], a[180:183], v[40:43]
    ds_read_b128 v[112:115], v136 offset:128
    v_add_u32 v135, s48, v135
    v_mfma_f32_16x16x32_bf16 v[40:43], v[48:51], a[184:187], v[40:43]
    ds_read_b128 v[108:111], v137 offset:256
    v_add_u32 v134, s48, v134
    v_mfma_f32_16x16x32_bf16 v[40:43], v[20:23], a[188:191], v[40:43]
    s_nop 0
    ds_read_b128 v[104:107], v136 offset:256
    v_add_u32 v133, s51, v133
    v_mfma_f32_16x16x16_bf16 v[118:121], v[216:217], v[170:171], 0
    s_nop 0
    v_add_u32 v132, s14, v132
    v_add_u32 v131, s14, v131
    v_add_u32 v123, s14, v123
    v_cvt_pk_bf16_f32 v160, v40, v41
    v_mfma_f32_16x16x32_bf16 v[100:103], v[88:91], a[192:195], 0
    v_cvt_pk_bf16_f32 v161, v42, v43
    v_and_b32 v116, -8, v123
    v_mfma_f32_16x16x32_bf16 v[100:103], v[56:59], a[196:199], v[100:103]
    v_rsq_f32 v118, v118
    v_mfma_f32_16x16x32_bf16 v[100:103], v[80:83], a[200:203], v[100:103]
    v_rsq_f32 v119, v119
    v_mfma_f32_16x16x32_bf16 v[100:103], v[28:31], a[204:207], v[100:103]
    ds_read_b128 v[28:31], v132 offset:0
    v_mul_f32 v118, s55, v118
    v_mfma_f32_16x16x32_bf16 v[100:103], v[48:51], a[208:211], v[100:103]
    ds_read_b128 v[48:51], v132 offset:16
    v_mul_f32 v119, 0.5, v119
    v_mfma_f32_16x16x32_bf16 v[100:103], v[20:23], a[212:215], v[100:103]
    s_waitcnt lgkmcnt(3)
    ds_read_b128 v[20:23], v132 offset:48
    v_mul_f32 v72, v72, v119
    v_mfma_f32_16x16x32_bf16 v[32:35], a[216:219], v[60:63], 0
    ds_read_b128 v[88:91], v133 offset:0
    v_mul_f32 v73, v73, v119
    v_mfma_f32_16x16x32_bf16 v[32:35], a[220:223], v[84:87], v[32:35]
    v_cvt_pk_f16_f32 v40, v72, v73
    v_mul_f32 v74, v74, v119
    v_mfma_f32_16x16x32_bf16 v[32:35], a[224:227], v[52:55], v[32:35]
    v_mul_f32 v75, v75, v119
    v_cvt_pk_f16_f32 v41, v74, v75
    v_mfma_f32_16x16x32_bf16 v[32:35], a[228:231], v[112:115], v[32:35]
    v_mul_f32 v4, v4, v119
    v_mul_f32 v5, v5, v119
    v_mfma_f32_16x16x32_bf16 v[32:35], a[232:235], v[108:111], v[32:35]
    s_waitcnt lgkmcnt(4)
    v_cvt_pk_f16_f32 v42, v4, v5
    v_mul_f32 v6, v6, v119
    v_mfma_f32_16x16x32_bf16 v[32:35], a[236:239], v[104:107], v[32:35]
    v_mul_f32 v7, v7, v119
    v_cvt_pk_f16_f32 v43, v6, v7
    v_mfma_f32_16x16x32_bf16 v[4:7], a[240:243], v[60:63], 0
    v_mul_f32 v24, v24, v119
    v_mul_f32 v25, v25, v119
    v_mfma_f32_16x16x32_bf16 v[4:7], a[244:247], v[84:87], v[4:7]
    v_cvt_pk_f16_f32 v142, v24, v25
    v_mul_f32 v26, v26, v119
    v_mfma_f32_16x16x32_bf16 v[4:7], a[248:251], v[52:55], v[4:7]
    v_mul_f32 v27, v27, v119
    v_cvt_pk_f16_f32 v143, v26, v27
    v_mfma_f32_16x16x32_bf16 v[4:7], a[252:255], v[112:115], v[4:7]
    s_waitcnt lgkmcnt(0)
    buffer_load_dwordx4 v128, s[24:27], s56 offen nt lds
    v_mul_f32 v92, v92, v118
    v_mfma_f32_16x16x32_bf16 v[4:7], v[224:227], v[108:111], v[4:7]
    v_mul_f32 v93, v93, v118
    v_cvt_pk_f16_f32 v44, v92, v93
    v_mfma_f32_16x16x32_bf16 v[4:7], v[228:231], v[104:107], v[4:7]
    v_mul_f32 v94, v94, v118
    v_mul_f32 v95, v95, v118
    v_mfma_f32_16x16x32_bf16 v[24:27], v[232:235], v[60:63], 0
    v_cvt_pk_f16_f32 v45, v94, v95
    v_mul_f32 v64, v64, v118
    v_mfma_f32_16x16x32_bf16 v[24:27], v[236:239], v[84:87], v[24:27]
    v_mul_f32 v65, v65, v118
    v_cvt_pk_f16_f32 v46, v64, v65
    v_mfma_f32_16x16x32_bf16 v[24:27], v[240:243], v[52:55], v[24:27]
    v_mul_f32 v66, v66, v118
    v_mul_f32 v67, v67, v118
    v_mfma_f32_16x16x32_bf16 v[24:27], v[244:247], v[112:115], v[24:27]
    v_cvt_pk_f16_f32 v47, v66, v67
    v_mul_f32 v68, v68, v118
    v_mfma_f32_16x16x32_bf16 v[24:27], v[248:251], v[108:111], v[24:27]
    buffer_store_dwordx4 v[88:91], v128, s[28:31], s60 offen sc1
    v_mul_f32 v69, v69, v118
    v_cvt_pk_f16_f32 v140, v68, v69
    v_mul_f32 v70, v70, v118
    v_mul_f32 v71, v71, v118
    v_mfma_f32_16x16x32_bf16 v[24:27], v[252:255], v[104:107], v[24:27]
    s_add_u32 m0, s67, 1024
    v_cvt_pk_f16_f32 v141, v70, v71
    v_cvt_pk_bf16_f32 v156, v100, v101
    v_mfma_f32_16x16x32_f16 v[112:115], v[16:19], v[76:79], v[204:207]
    ds_read_u16 v166, v131 offset:80
    v_cvt_pk_bf16_f32 v157, v102, v103
    v_mfma_f32_16x16x32_f16 v[112:115], v[152:155], v[150:153], v[112:115]
    ds_read_u16 v162, v131 offset:96
    v_mfma_f32_16x16x32_f16 v[108:111], v[36:39], v[76:79], v[200:203]
    s_nop 0
    ds_read_u16 v158, v131 offset:104
    s_nop 0
    v_mfma_f32_16x16x32_f16 v[108:111], v[146:149], v[150:153], v[108:111]
    s_nop 0
    ds_read_b32 v116, v116 offset:64
    v_max3_f32 v120, v112, v113, v114
    v_mfma_f32_16x16x32_f16 v[104:107], v[40:43], v[76:79], v[196:199]
    ds_read_b128 v[68:71], v133 offset:1024
    v_mfma_f32_16x16x32_f16 v[104:107], v[140:143], v[150:153], v[104:107]
    s_nop 0
    ds_read_b128 v[72:75], v137 offset:1536
    v_max3_f32 v120, v120, v115, v108
    v_mfma_f32_16x16x32_f16 v[88:91], v[28:31], v[76:79], v[208:211]
    ds_read_b128 v[76:79], v136 offset:1536
    v_max3_f32 v120, v120, v109, v110
    v_mfma_f32_16x16x32_f16 v[88:91], v[48:51], v[16:19], v[88:91]
    ds_read_b128 v[60:63], v137 offset:1664
    v_max3_f32 v120, v120, v111, v104
    v_mfma_f32_16x16x32_f16 v[88:91], v[20:23], v[152:155], v[88:91]
    ds_read_b128 v[56:59], v136 offset:1664
    v_max3_f32 v120, v120, v105, v106
    v_mfma_f32_16x16x32_f16 v[92:95], v[28:31], v[96:99], v[208:211]
    ds_read_b128 v[64:67], v137 offset:1792
    s_nop 0
    v_mfma_f32_16x16x32_f16 v[92:95], v[48:51], v[36:39], v[92:95]
    s_nop 0
    ds_read_b128 v[80:83], v136 offset:1792
    v_max3_f32 v120, v120, v107, v88
    v_mfma_f32_16x16x32_f16 v[92:95], v[20:23], v[146:149], v[92:95]
    v_mov_b32 v121, v120
    v_mfma_f32_16x16x32_f16 v[84:87], v[28:31], v[44:47], v[208:211]
    s_nop 0
    v_permlane32_swap_b32 v121, v120
    v_mfma_f32_16x16x32_f16 v[84:87], v[48:51], v[40:43], v[84:87]
    s_waitcnt lgkmcnt(6)
    buffer_load_dwordx4 v127, s[24:27], s56 offen nt lds
    v_max_f32 v120, v121, v120
    v_mfma_f32_16x16x32_f16 v[84:87], v[20:23], v[140:143], v[84:87]
    s_waitcnt lgkmcnt(5)
    v_mov_b32 v121, v120
    v_mov_b32_dpp v91, v95 quad_perm:[0,1,2,3] row_mask:0x2 bank_mask:0xf
    v_mfma_f32_16x16x32_bf16 v[28:31], a[216:219], v[72:75], 0
    s_waitcnt lgkmcnt(4)
    v_permlane16_swap_b32 v121, v120
    v_mfma_f32_16x16x32_bf16 v[28:31], a[220:223], v[76:79], v[28:31]
    s_waitcnt lgkmcnt(3)
    v_max_f32 v120, v121, v120
    v_sub_f32 v112, v112, v120
    v_mfma_f32_16x16x32_bf16 v[28:31], a[224:227], v[60:63], v[28:31]
    s_waitcnt lgkmcnt(2)
    v_sub_f32 v113, v113, v120
    v_sub_f32 v114, v114, v120
    v_mfma_f32_16x16x32_bf16 v[28:31], a[228:231], v[56:59], v[28:31]
    s_waitcnt lgkmcnt(1)
    v_sub_f32 v115, v115, v120
    v_sub_f32 v108, v108, v120
    v_mfma_f32_16x16x32_bf16 v[28:31], a[232:235], v[64:67], v[28:31]
    s_waitcnt lgkmcnt(0)
    v_sub_f32 v109, v109, v120
    v_sub_f32 v110, v110, v120
    v_mfma_f32_16x16x32_bf16 v[28:31], a[236:239], v[80:83], v[28:31]
    buffer_store_dwordx4 v[68:71], v127, s[28:31], s60 offen sc1
    ds_read_b128 v[100:103], v133 offset:2048
    v_sub_f32 v111, v111, v120
    v_sub_f32 v104, v104, v120
    v_sub_f32 v105, v105, v120
    v_mfma_f32_16x16x32_f16 v[48:51], v[16:19], v[96:99], v[192:195]
    s_add_u32 m0, s67, 2048
    v_sub_f32 v106, v106, v120
    v_sub_f32 v107, v107, v120
    v_mfma_f32_16x16x32_f16 v[48:51], v[152:155], v[144:147], v[48:51]
    v_sub_f32 v88, v88, v120
    v_mov_b32_dpp v91, v87 quad_perm:[0,1,2,3] row_mask:0x4 bank_mask:0xf
    v_mfma_f32_16x16x32_f16 v[68:71], v[36:39], v[96:99], v[188:191]
    v_exp_f32 v112, v112
    v_mfma_f32_16x16x32_f16 v[68:71], v[146:149], v[144:147], v[68:71]
    v_exp_f32 v113, v113
    v_mfma_f32_16x16x32_f16 v[52:55], v[40:43], v[96:99], v[184:187]
    v_exp_f32 v114, v114
    v_mfma_f32_16x16x32_f16 v[52:55], v[140:143], v[144:147], v[52:55]
    v_exp_f32 v115, v115
    v_mfma_f32_16x16x32_bf16 v[20:23], a[240:243], v[72:75], 0
    v_cvt_pk_bf16_f32 v96, v112, v113
    v_cvt_pk_bf16_f32 v97, v114, v115
    v_mfma_f32_16x16x32_bf16 v[20:23], a[244:247], v[76:79], v[20:23]
    v_exp_f32 v108, v108
    v_mfma_f32_16x16x32_bf16 v[20:23], a[248:251], v[60:63], v[20:23]
    s_waitcnt lgkmcnt(0)
    buffer_load_dwordx4 v126, s[24:27], s56 offen nt lds
    v_and_b32 v120, 0xffff0000, v116
    v_mfma_f32_16x16x32_bf16 v[20:23], a[252:255], v[56:59], v[20:23]
    v_exp_f32 v109, v109
    v_mfma_f32_16x16x32_bf16 v[20:23], v[224:227], v[64:67], v[20:23]
    v_exp_f32 v110, v110
    v_mfma_f32_16x16x32_bf16 v[20:23], v[228:231], v[80:83], v[20:23]
    s_mov_b32 s53, s47
    v_exp_f32 v111, v111
    v_cvt_pk_bf16_f32 v98, v108, v109
    v_cvt_pk_bf16_f32 v99, v110, v111
    v_exp_f32 v104, v104
    v_exp_f32 v105, v105
    v_exp_f32 v106, v106
    v_exp_f32 v107, v107
    v_cvt_pk_bf16_f32 v168, v104, v105
    v_cvt_pk_bf16_f32 v169, v106, v107
    v_exp_f32 v88, v88
    v_lshlrev_b32 v116, 16, v116
    v_cvt_pk_bf16_f32 v170, v88, 0
    v_mfma_f32_16x16x32_bf16 v[112:115], v[220:223], v[96:99], 0
    s_add_u32 m0, s67, 3072
    buffer_store_dwordx4 v[100:103], v126, s[28:31], s60 offen sc1
    v_add_f32 v116, v116, v120
    v_add_f32 v116, v116, v211
    v_max3_f32 v120, v48, v49, v50
    v_max3_f32 v120, v120, v51, v68
    v_mfma_f32_16x16x32_bf16 v[112:115], v[220:223], v[168:171], v[112:115]
    s_mov_b32 s47, s46
    v_mov_b32_dpp v91, v116 quad_perm:[0,1,2,3] row_mask:0x8 bank_mask:0xf
    v_mov_b32 v121, v91
    v_mfma_f32_16x16x32_bf16 v[108:111], v[0:3], v[96:99], 0
    s_mov_b32 s46, s45
    v_max_f32_dpp v121, v121, v121 row_ror:8 row_mask:0xf bank_mask:0xf
    v_max3_f32 v120, v120, v69, v70
    v_mfma_f32_16x16x32_bf16 v[108:111], v[164:167], v[168:171], v[108:111]
    s_mov_b32 s45, s44
    v_max_f32_dpp v121, v121, v121 row_ror:4 row_mask:0xf bank_mask:0xf
    v_max3_f32 v120, v120, v71, v52
    v_mfma_f32_16x16x32_bf16 v[104:107], v[8:11], v[96:99], 0
    s_mov_b32 s44, s53
    v_max_f32_dpp v121, v121, v121 row_ror:2 row_mask:0xf bank_mask:0xf
    v_max3_f32 v120, v120, v53, v54
    v_mfma_f32_16x16x32_bf16 v[104:107], v[160:163], v[168:171], v[104:107]
    s_sub_u32 s48, s44, s46
    v_max_f32_dpp v121, v121, v121 row_ror:1 row_mask:0xf bank_mask:0xf
    v_mov_b32 v84, v121
    v_mfma_f32_16x16x32_bf16 v[100:103], v[12:15], v[96:99], 0
    s_sub_u32 s49, s46, s45
    v_permlane32_swap_b32 v84, v121
    v_mfma_f32_16x16x32_bf16 v[100:103], v[156:159], v[168:171], v[100:103]
    v_max_f32 v121, v84, v121
    v_mov_b32 v84, v121
    v_rcp_f32 v112, v112
    v_max3_f32 v120, v120, v55, v93
    v_permlane16_swap_b32 v84, v121
    v_max_f32 v121, v84, v121
    v_sub_f32 v91, v91, v121
    v_exp_f32 v91, v91
    v_mul_f32 v108, v108, v112
    v_cvt_pk_bf16_f32 v91, v91, v91
    ds_write_b16 v123, v91 offset:64
    v_mul_f32 v109, v109, v112
    v_cvt_pk_bf16_f32 v88, v108, v109
    ds_read_b128 v[94:97], v132 offset:48
    v_mul_f32 v110, v110, v112
    v_mul_f32 v111, v111, v112
    v_cvt_pk_bf16_f32 v89, v110, v111
    ds_read_b128 v[108:111], v132 offset:64
    v_mfma_f32_16x16x32_bf16 v[114:117], v[232:235], v[72:75], 0
    v_mul_f32 v104, v104, v112
    v_mul_f32 v105, v105, v112
    v_mfma_f32_16x16x32_bf16 v[114:117], v[236:239], v[76:79], v[114:117]
    ds_write_b64 v135, v[88:89] offset:0
    v_mfma_f32_16x16x32_bf16 v[114:117], v[240:243], v[60:63], v[114:117]
    v_cvt_pk_bf16_f32 v90, v104, v105
    v_mul_f32 v106, v106, v112
    v_mfma_f32_16x16x32_bf16 v[114:117], v[244:247], v[56:59], v[114:117]
    v_mul_f32 v107, v107, v112
    v_cvt_pk_bf16_f32 v91, v106, v107
    v_mfma_f32_16x16x32_bf16 v[114:117], v[248:251], v[64:67], v[114:117]
    ds_write_b64 v135, v[90:91] offset:8
    v_mfma_f32_16x16x32_bf16 v[114:117], v[252:255], v[80:83], v[114:117]
    s_waitcnt lgkmcnt(3)
    v_mul_f32 v100, v100, v112
    v_mul_f32 v101, v101, v112
    v_cvt_pk_bf16_f32 v168, v100, v101
    v_mul_f32 v102, v102, v112
    v_mfma_f32_16x16x32_bf16 v[72:75], v[94:97], v[0:3], 0
    s_waitcnt lgkmcnt(2)
    v_mul_f32 v103, v103, v112
    v_cvt_pk_bf16_f32 v169, v102, v103
    v_mov_b32 v170, v120
    v_fma_f32 v92, v32, v32, s42
    v_mfma_f32_16x16x32_bf16 v[72:75], v[108:111], v[164:167], v[72:75]
    ds_write_b64 v134, v[168:169] offset:0
    v_mfma_f32_16x16x32_bf16 v[88:91], v[94:97], v[8:11], 0
    v_permlane32_swap_b32 v170, v120
    v_mfma_f32_16x16x32_bf16 v[88:91], v[108:111], v[160:163], v[88:91]
    v_max_f32 v120, v170, v120
    v_mov_b32 v170, v120
    v_mfma_f32_16x16x32_bf16 v[76:79], v[94:97], v[12:15], 0
    s_nop 0
    v_permlane16_swap_b32 v170, v120
    v_mfma_f32_16x16x32_bf16 v[76:79], v[108:111], v[156:159], v[76:79]
    ds_read_b128 v[60:63], v133 offset:3072
    v_max_f32 v120, v170, v120
    v_sub_f32 v48, v48, v120
    v_sub_f32 v49, v49, v120
    v_sub_f32 v50, v50, v120
    v_sub_f32 v51, v51, v120
    v_sub_f32 v68, v68, v120
    v_sub_f32 v69, v69, v120
    v_sub_f32 v70, v70, v120
    v_sub_f32 v71, v71, v120
    v_sub_f32 v52, v52, v120
    v_sub_f32 v53, v53, v120
    v_sub_f32 v54, v54, v120
    v_sub_f32 v55, v55, v120
    v_sub_f32 v93, v93, v120
    v_exp_f32 v48, v48
    v_exp_f32 v49, v49
    v_exp_f32 v50, v50
    v_exp_f32 v51, v51
    v_cvt_pk_bf16_f32 v56, v48, v49
    v_cvt_pk_bf16_f32 v57, v50, v51
    v_exp_f32 v68, v68
    v_exp_f32 v69, v69
    v_exp_f32 v70, v70
    v_exp_f32 v71, v71
    v_cvt_pk_bf16_f32 v58, v68, v69
    v_cvt_pk_bf16_f32 v59, v70, v71
    v_exp_f32 v52, v52
    v_exp_f32 v53, v53
    v_exp_f32 v54, v54
    v_exp_f32 v55, v55
    v_cvt_pk_bf16_f32 v168, v52, v53
    v_cvt_pk_bf16_f32 v169, v54, v55
    v_exp_f32 v93, v93
    v_mov_b32_dpp v75, v91 quad_perm:[0,1,2,3] row_mask:0x2 bank_mask:0xf
    v_cvt_pk_bf16_f32 v170, v93, 0
    v_mfma_f32_16x16x32_bf16 v[88:91], v[220:223], v[56:59], 0
    s_waitcnt lgkmcnt(0)
    buffer_load_dwordx4 v125, s[24:27], s56 offen nt lds
    ds_read_b128 v[64:67], v137 offset:3072
    v_mfma_f32_16x16x32_bf16 v[88:91], v[220:223], v[168:171], v[88:91]
    v_mov_b32_dpp v75, v79 quad_perm:[0,1,2,3] row_mask:0x4 bank_mask:0xf
    v_cvt_pk_bf16_f32 v75, v75, v75
    v_mfma_f32_16x16x32_bf16 v[76:79], v[0:3], v[56:59], 0
    ds_write_b16 v131, v75
    v_mfma_f32_16x16x32_bf16 v[76:79], v[164:167], v[168:171], v[76:79]
    ds_read_b128 v[72:75], v136 offset:3072
    v_fmac_f32 v92, v33, v33
    v_mfma_f32_16x16x32_bf16 v[80:83], v[8:11], v[56:59], 0
    ds_read_b128 v[48:51], v137 offset:3200
    v_fmac_f32 v92, v34, v34
    v_mfma_f32_16x16x32_bf16 v[80:83], v[160:163], v[168:171], v[80:83]
    ds_read_b128 v[68:71], v136 offset:3200
    v_fmac_f32 v92, v35, v35
    v_mfma_f32_16x16x32_bf16 v[52:55], v[12:15], v[56:59], 0
    ds_read_b128 v[56:59], v137 offset:3328
    v_add_u32 v137, s48, v137
    v_mfma_f32_16x16x32_bf16 v[52:55], v[156:159], v[168:171], v[52:55]
    buffer_store_dwordx4 v[60:63], v125, s[28:31], s60 offen sc1
    ds_read_b128 v[94:97], v136 offset:3328
    v_rcp_f32 v88, v88
    v_add_u32 v136, s48, v136
    v_mfma_f32_16x16x32_f16 v[60:63], v[16:19], v[44:47], v[180:183]
    s_add_u32 m0, s67, 4096
    ds_read_b128 v[16:19], v133 offset:4096
    v_mul_f32 v76, v76, v88
    v_mfma_f32_16x16x32_f16 v[60:63], v[152:155], v[138:141], v[60:63]
    s_cmp_lg_u32 s5, -1
    v_mul_f32 v77, v77, v88
    v_cvt_pk_bf16_f32 v76, v76, v77
    v_mfma_f32_16x16x32_f16 v[152:155], v[36:39], v[44:47], v[176:179]
    v_mul_f32 v78, v78, v88
    v_mul_f32 v79, v79, v88
    v_mfma_f32_16x16x32_f16 v[152:155], v[146:149], v[138:141], v[152:155]
    v_cvt_pk_bf16_f32 v77, v78, v79
    v_mul_f32 v80, v80, v88
    v_mfma_f32_16x16x32_f16 v[36:39], v[40:43], v[44:47], v[172:175]
    ds_write_b64 v135, v[76:77] offset:1536
    v_mfma_f32_16x16x32_f16 v[36:39], v[140:143], v[138:141], v[36:39]
    s_waitcnt lgkmcnt(4)
    v_mul_f32 v81, v81, v88
    v_cvt_pk_bf16_f32 v78, v80, v81
    v_mfma_f32_16x16x32_bf16 v[40:43], a[216:219], v[64:67], 0
    v_mul_f32 v82, v82, v88
    v_mul_f32 v83, v83, v88
    v_mfma_f32_16x16x32_bf16 v[40:43], a[220:223], v[72:75], v[40:43]
    v_cvt_pk_bf16_f32 v79, v82, v83
    v_mul_f32 v52, v52, v88
    v_mfma_f32_16x16x32_bf16 v[40:43], a[224:227], v[48:51], v[40:43]
    ds_write_b64 v135, v[78:79] offset:1544
    v_mfma_f32_16x16x32_bf16 v[40:43], a[228:231], v[68:71], v[40:43]
    s_waitcnt lgkmcnt(2)
    buffer_load_dwordx4 v124, s[24:27], s56 offen nt lds
    v_mul_f32 v53, v53, v88
    v_mfma_f32_16x16x32_bf16 v[40:43], a[232:235], v[56:59], v[40:43]
    v_cvt_pk_bf16_f32 v168, v52, v53
    v_mul_f32 v54, v54, v88
    v_mfma_f32_16x16x32_bf16 v[40:43], a[236:239], v[94:97], v[40:43]
    v_mul_f32 v55, v55, v88
    v_cvt_pk_bf16_f32 v169, v54, v55
    v_mfma_f32_16x16x32_bf16 v[140:143], a[240:243], v[64:67], 0
    ds_write_b64 v134, v[168:169] offset:1536
    v_mfma_f32_16x16x32_bf16 v[140:143], a[244:247], v[72:75], v[140:143]
    v_max3_f32 v168, v60, v61, v62
    v_max3_f32 v168, v168, v63, v152
    v_mfma_f32_16x16x32_bf16 v[140:143], a[248:251], v[48:51], v[140:143]
    v_max3_f32 v168, v168, v153, v154
    v_max3_f32 v168, v168, v155, v36
    v_mfma_f32_16x16x32_bf16 v[140:143], a[252:255], v[68:71], v[140:143]
    v_max3_f32 v168, v168, v37, v38
    v_max3_f32 v168, v168, v39, v86
    v_mfma_f32_16x16x32_bf16 v[140:143], v[224:227], v[56:59], v[140:143]
    buffer_store_dwordx4 v[16:19], v124, s[28:31], s60 offen sc1
    v_mov_b32 v169, v168
    v_fmac_f32 v92, v4, v4
    v_fmac_f32 v92, v5, v5
    v_fmac_f32 v92, v6, v6
    v_mfma_f32_16x16x32_bf16 v[140:143], v[228:231], v[94:97], v[140:143]
    ds_read_b128 v[16:19], v137 offset:0
    v_fmac_f32 v92, v7, v7
    v_mfma_f32_16x16x32_bf16 v[44:47], v[232:235], v[64:67], 0
    ds_read_b128 v[146:149], v136 offset:0
    v_fmac_f32 v92, v24, v24
    v_mfma_f32_16x16x32_bf16 v[44:47], v[236:239], v[72:75], v[44:47]
    ds_read_b128 v[72:75], v137 offset:128
    v_fmac_f32 v92, v25, v25
    v_mfma_f32_16x16x32_bf16 v[44:47], v[240:243], v[48:51], v[44:47]
    ds_read_b128 v[88:91], v136 offset:128
    v_fmac_f32 v92, v26, v26
    v_mfma_f32_16x16x32_bf16 v[44:47], v[244:247], v[68:71], v[44:47]
    ds_read_b128 v[76:79], v137 offset:256
    v_fmac_f32 v92, v27, v27
    v_mfma_f32_16x16x32_bf16 v[44:47], v[248:251], v[56:59], v[44:47]
    ds_read_b128 v[56:59], v136 offset:256
    v_fma_f32 v93, v28, v28, s42
    v_mfma_f32_16x16x32_bf16 v[44:47], v[252:255], v[94:97], v[44:47]
    v_permlane32_swap_b32 v169, v168
    v_max_f32 v168, v169, v168
    v_mov_b32 v169, v168
    v_fmac_f32 v93, v29, v29
    v_fmac_f32 v93, v30, v30
    v_permlane16_swap_b32 v169, v168
    v_max_f32 v168, v169, v168
    v_sub_f32 v60, v60, v168
    v_sub_f32 v61, v61, v168
    v_sub_f32 v62, v62, v168
    v_sub_f32 v63, v63, v168
    v_sub_f32 v152, v152, v168
    v_sub_f32 v153, v153, v168
    v_sub_f32 v154, v154, v168
    v_sub_f32 v155, v155, v168
    v_sub_f32 v36, v36, v168
    v_sub_f32 v37, v37, v168
    v_sub_f32 v38, v38, v168
    v_sub_f32 v39, v39, v168
    v_sub_f32 v86, v86, v168
    v_exp_f32 v60, v60
    v_exp_f32 v61, v61
    v_exp_f32 v62, v62
    v_exp_f32 v63, v63
    v_cvt_pk_bf16_f32 v60, v60, v61
    v_cvt_pk_bf16_f32 v61, v62, v63
    v_exp_f32 v152, v152
    v_exp_f32 v153, v153
    v_exp_f32 v154, v154
    v_exp_f32 v155, v155
    v_cvt_pk_bf16_f32 v62, v152, v153
    v_cvt_pk_bf16_f32 v63, v154, v155
    v_exp_f32 v36, v36
    v_exp_f32 v37, v37
    v_exp_f32 v38, v38
    v_exp_f32 v39, v39
    v_cvt_pk_bf16_f32 v168, v36, v37
    v_cvt_pk_bf16_f32 v169, v38, v39
    v_exp_f32 v86, v86
    v_fmac_f32 v93, v31, v31
    v_cvt_pk_bf16_f32 v170, v86, 0
    v_mfma_f32_16x16x32_bf16 v[152:155], v[220:223], v[60:63], 0
    v_fmac_f32 v93, v20, v20
    v_fmac_f32 v93, v21, v21
    v_mfma_f32_16x16x32_bf16 v[152:155], v[220:223], v[168:171], v[152:155]
    v_fmac_f32 v93, v22, v22
    v_fmac_f32 v93, v23, v23
    v_mfma_f32_16x16x32_bf16 v[36:39], v[0:3], v[60:63], 0
    s_nop 0
    v_fmac_f32 v93, v114, v114
    v_fmac_f32 v93, v115, v115
    v_mfma_f32_16x16x32_bf16 v[36:39], v[164:167], v[168:171], v[36:39]
    s_nop 0
    v_rcp_f32 v152, v152
    v_mfma_f32_16x16x32_bf16 v[0:3], v[8:11], v[60:63], 0
    s_nop 0
    v_fmac_f32 v93, v116, v116
    v_fmac_f32 v93, v117, v117
    v_mfma_f32_16x16x32_bf16 v[0:3], v[160:163], v[168:171], v[0:3]
    s_nop 0
    v_mul_f32 v36, v36, v152
    v_mul_f32 v37, v37, v152
    v_mfma_f32_16x16x32_bf16 v[8:11], v[12:15], v[60:63], 0
    v_cvt_pk_bf16_f32 v12, v36, v37
    v_mul_f32 v38, v38, v152
    v_mfma_f32_16x16x32_bf16 v[8:11], v[156:159], v[168:171], v[8:11]
    s_waitcnt lgkmcnt(0)
    v_mul_f32 v39, v39, v152
    v_cvt_pk_bf16_f32 v13, v38, v39
    v_mfma_f32_16x16x32_bf16 v[36:39], a[0:3], v[16:19], 0
    s_cbranch_scc1 L_loopS0
    ds_write_b64 v135, v[12:13] offset:3072
    v_mul_f32 v0, v0, v152
    v_mul_f32 v1, v1, v152
    v_cvt_pk_bf16_f32 v14, v0, v1
    v_mul_f32 v2, v2, v152
    v_mul_f32 v3, v3, v152
    v_cvt_pk_bf16_f32 v15, v2, v3
    v_mul_f32 v8, v8, v152
    v_mul_f32 v9, v9, v152
    v_cvt_pk_bf16_f32 v8, v8, v9
    v_mul_f32 v10, v10, v152
    v_mul_f32 v11, v11, v152
    v_cvt_pk_bf16_f32 v9, v10, v11
    s_mov_b32 s30, 100270464
    s_mul_i32 s89, s68, 7168
    ds_write_b64 v135, v[14:15] offset:3080
    v_fma_f32 v113, v40, v40, s42
    s_add_u32 s89, s89, 135168
    s_movk_i32 s90, 112
    ds_write_b64 v134, v[8:9] offset:3072
    v_fmac_f32 v113, v41, v41
    v_fmac_f32 v113, v42, v42
    v_fmac_f32 v113, v43, v43
    v_fmac_f32 v113, v140, v140
    v_fmac_f32 v113, v141, v141
    v_fmac_f32 v113, v142, v142
    v_fmac_f32 v113, v143, v143
    v_fmac_f32 v113, v44, v44
    v_fmac_f32 v113, v45, v45
    v_fmac_f32 v113, v46, v46
    v_fmac_f32 v113, v47, v47
    v_cvt_pk_bf16_f32 v112, v92, v93
    v_cvt_pk_bf16_f32 v113, v113, v122
    s_lshr_b32 s91, s64, 16
    s_lshl_b32 s92, s68, 10
    ds_write_b64 v130, v[112:113]
    v_mbcnt_lo_u32_b32 v131, -1, 0
    v_mbcnt_hi_u32_b32 v131, -1, v131
    v_and_b32 v132, 15, v131
    v_lshrrev_b32 v131, 4, v131
    v_mul_u32_u24 v118, 1792, v131
    v_add_u32 v118, s89, v118
    v_mad_u32_u24 v131, v132, s90, v118
    v_lshrrev_b32 v119, v132, s64
    v_and_b32 v119, 1, v119
    v_cmp_eq_u32 vcc, 1, v119
    v_mad_u32_u24 v119, v132, s90, v118
    v_lshrrev_b32 v132, v132, s91
    v_cndmask_b32 v131, v118, v131, vcc
    v_and_b32 v132, 1, v132
    v_subrev_u32 v119, 28672, v119
    v_cmp_eq_u32 vcc, 1, v132
    s_sub_u32 s84, s45, s44
    s_sub_u32 s85, s46, s45
    ds_read_b128 v[48:51], v131 offset:64
    ds_read_b128 v[36:39], v131 offset:80
    v_cndmask_b32 v119, v118, v119, vcc
    v_add_u32 v118, s92, v129
    s_waitcnt lgkmcnt(2)
    s_barrier
    s_sub_u32 s86, s44, s45
    ds_read_b128 v[86:89], v131
    v_add_u32 v139, s84, v137
    s_sub_u32 s93, s44, s47
    s_sub_u32 s94, s45, s47
    ds_read_b64 v[90:91], v131 offset:16
    ds_read_b128 v[8:11], v118 offset:6144
    v_add_u32 v138, s84, v136
    v_add_u32 v118, s85, v135
    s_sub_u32 s95, s46, s47
    ds_read_b128 v[16:19], v129 offset:0
    v_add_u32 v63, s85, v134
    ds_read_b128 v[0:3], v129 offset:1024
    v_add_u32 v112, s86, v135
    v_add_u32 v132, s86, v134
    v_add_u32 v131, s93, v133
    v_add_u32 v113, s94, v133
    s_waitcnt lgkmcnt(6)
    v_mfma_f32_16x16x32_bf16 v[12:15], v[220:223], v[48:51], 0
    s_waitcnt lgkmcnt(5)
    ds_read_b128 v[80:83], v139 offset:1536
    ds_read_b128 v[76:79], v138 offset:1536
    v_mfma_f32_16x16x32_bf16 v[12:15], v[220:223], v[36:39], v[12:15]
    s_waitcnt lgkmcnt(3)
    ds_read_b128 v[72:75], v139 offset:1664
    v_lshlrev_b32 v92, 16, v86
    v_and_b32 v86, 0xffff0000, v86
    v_lshlrev_b32 v93, 16, v87
    v_and_b32 v87, 0xffff0000, v87
    v_lshlrev_b32 v94, 16, v88
    v_and_b32 v88, 0xffff0000, v88
    v_rcp_f32 v12, v12
    v_lshlrev_b32 v95, 16, v89
    v_mfma_f32_16x16x32_bf16 v[64:67], v[216:219], v[16:19], 0
    s_waitcnt lgkmcnt(3)
    ds_read_b128 v[68:71], v138 offset:1664
    ds_read_b128 v[48:51], v139 offset:1792
    v_mfma_f32_16x16x32_bf16 v[64:67], v[216:219], v[0:3], v[64:67]
    s_waitcnt lgkmcnt(4)
    ds_read_b128 v[16:19], v138 offset:1792
    v_mul_f32 v92, v92, v12
    v_mul_f32 v86, v86, v12
    v_cvt_pk_bf16_f32 v92, v92, v86
    v_mul_f32 v93, v93, v12
    v_mfma_f32_16x16x32_bf16 v[0:3], a[216:219], v[80:83], 0
    s_waitcnt lgkmcnt(4)
    v_mul_f32 v87, v87, v12
    v_cvt_pk_bf16_f32 v93, v93, v87
    v_mfma_f32_16x16x32_bf16 v[0:3], a[220:223], v[76:79], v[0:3]
    s_waitcnt lgkmcnt(3)
    ds_read_b128 v[108:111], v139 offset:0
    ds_read_b128 v[104:107], v138 offset:0
    v_mfma_f32_16x16x32_bf16 v[0:3], a[224:227], v[72:75], v[0:3]
    s_waitcnt lgkmcnt(4)
    ds_read_b128 v[96:99], v139 offset:128
    v_mul_f32 v94, v94, v12
    v_mul_f32 v88, v88, v12
    v_cvt_pk_bf16_f32 v94, v94, v88
    v_and_b32 v89, 0xffff0000, v89
    v_mul_f32 v95, v95, v12
    v_mfma_f32_16x16x32_bf16 v[0:3], a[228:231], v[68:71], v[0:3]
    s_waitcnt lgkmcnt(4)
    ds_read_b128 v[84:87], v138 offset:128
    ds_read_b128 v[56:59], v139 offset:256
    v_mfma_f32_16x16x32_bf16 v[0:3], a[232:235], v[48:51], v[0:3]
    s_waitcnt lgkmcnt(5)
    ds_read_b128 v[36:39], v138 offset:256
    v_mul_f32 v89, v89, v12
    v_mfma_f32_16x16x32_bf16 v[0:3], a[236:239], v[16:19], v[0:3]
    v_cvt_pk_bf16_f32 v95, v95, v89
    v_lshlrev_b32 v67, 16, v90
    v_mfma_f32_16x16x32_bf16 v[52:55], a[240:243], v[80:83], 0
    ds_write_b128 v112, v[92:95] offset:0
    v_mfma_f32_16x16x32_bf16 v[52:55], a[244:247], v[76:79], v[52:55]
    v_and_b32 v90, 0xffff0000, v90
    v_mul_f32 v67, v67, v12
    v_mfma_f32_16x16x32_bf16 v[52:55], a[248:251], v[72:75], v[52:55]
    v_mul_f32 v90, v90, v12
    v_cvt_pk_bf16_f32 v60, v67, v90
    v_mfma_f32_16x16x32_bf16 v[52:55], a[252:255], v[68:71], v[52:55]
    v_lshlrev_b32 v67, 16, v91
    v_and_b32 v91, 0xffff0000, v91
    v_mfma_f32_16x16x32_bf16 v[52:55], v[224:227], v[48:51], v[52:55]
    v_mul_f32 v67, v67, v12
    v_mul_f32 v91, v91, v12
    v_mfma_f32_16x16x32_bf16 v[52:55], v[228:231], v[16:19], v[52:55]
    v_cvt_pk_bf16_f32 v61, v67, v91
    v_lshrrev_b32 v67, 0, v11
    v_mfma_f32_16x16x32_bf16 v[12:15], v[232:235], v[80:83], 0
    ds_write_b64 v132, v[60:61] offset:0
    v_mfma_f32_16x16x32_bf16 v[12:15], v[236:239], v[76:79], v[12:15]
    v_lshrrev_b32 v67, v67, s64
    v_and_b32 v67, 1, v67
    v_mfma_f32_16x16x32_bf16 v[12:15], v[240:243], v[72:75], v[12:15]
    v_cmp_eq_u32 vcc, 1, v67
    v_lshrrev_b32 v67, 8, v11
    v_mfma_f32_16x16x32_bf16 v[12:15], v[244:247], v[68:71], v[12:15]
    v_cndmask_b32 v8, 2.0, v8, vcc
    v_lshrrev_b32 v67, v67, s64
    v_mfma_f32_16x16x32_bf16 v[12:15], v[248:251], v[48:51], v[12:15]
    v_and_b32 v67, 1, v67
    v_cmp_eq_u32 vcc, 1, v67
    v_mfma_f32_16x16x32_bf16 v[12:15], v[252:255], v[16:19], v[12:15]
    s_waitcnt lgkmcnt(1)
    v_cndmask_b32 v9, 2.0, v9, vcc
    v_lshrrev_b32 v11, 16, v11
    v_mfma_f32_16x16x32_bf16 v[72:75], a[216:219], v[108:111], 0
    v_lshrrev_b32 v11, v11, s64
    v_and_b32 v11, 1, v11
    v_mfma_f32_16x16x32_bf16 v[72:75], a[220:223], v[104:107], v[72:75]
    ds_read_b128 v[100:103], v139 offset:3072
    ds_read_b128 v[92:95], v138 offset:3072
    v_mfma_f32_16x16x32_bf16 v[72:75], a[224:227], v[96:99], v[72:75]
    ds_read_b128 v[88:91], v139 offset:3200
    v_cmp_eq_u32 vcc, 1, v11
    v_mfma_f32_16x16x32_bf16 v[72:75], a[228:231], v[84:87], v[72:75]
    ds_read_b128 v[80:83], v138 offset:3200
    v_cndmask_b32 v10, 2.0, v10, vcc
    v_mfma_f32_16x16x32_bf16 v[72:75], a[232:235], v[56:59], v[72:75]
    ds_read_b128 v[76:79], v139 offset:3328
    v_add_u32 v11, s95, v133
    v_mfma_f32_16x16x32_bf16 v[72:75], a[236:239], v[36:39], v[72:75]
    ds_read_b128 v[16:19], v138 offset:3328
    v_fma_f32 v133, v0, v0, s42
    v_mfma_f32_16x16x32_bf16 v[48:51], a[240:243], v[108:111], 0
    v_rsq_f32 v64, v64
    v_mfma_f32_16x16x32_bf16 v[48:51], a[244:247], v[104:107], v[48:51]
    v_mul_f32 v64, s43, v64
    v_mul_f32 v32, v32, v64
    v_mfma_f32_16x16x32_bf16 v[48:51], a[248:251], v[96:99], v[48:51]
    v_mul_f32 v33, v33, v64
    v_cvt_pk_bf16_f32 v32, v32, v33
    v_mfma_f32_16x16x32_bf16 v[48:51], a[252:255], v[84:87], v[48:51]
    v_mul_f32 v34, v34, v64
    v_mul_f32 v35, v35, v64
    v_mfma_f32_16x16x32_bf16 v[48:51], v[224:227], v[56:59], v[48:51]
    v_cvt_pk_bf16_f32 v33, v34, v35
    v_mul_f32 v4, v4, v64
    v_mfma_f32_16x16x32_bf16 v[48:51], v[228:231], v[36:39], v[48:51]
    v_mul_f32 v5, v5, v64
    v_cvt_pk_bf16_f32 v34, v4, v5
    v_mfma_f32_16x16x32_bf16 v[68:71], v[232:235], v[108:111], 0
    v_mul_f32 v6, v6, v64
    v_mul_f32 v7, v7, v64
    v_mfma_f32_16x16x32_bf16 v[68:71], v[236:239], v[104:107], v[68:71]
    v_cvt_pk_bf16_f32 v35, v6, v7
    v_mul_f32 v24, v24, v64
    v_mfma_f32_16x16x32_bf16 v[68:71], v[240:243], v[96:99], v[68:71]
    ds_write_b128 v118, v[32:35] offset:0
    v_mfma_f32_16x16x32_bf16 v[68:71], v[244:247], v[84:87], v[68:71]
    v_mul_f32 v25, v25, v64
    v_cvt_pk_bf16_f32 v24, v24, v25
    v_mfma_f32_16x16x32_bf16 v[68:71], v[248:251], v[56:59], v[68:71]
    v_mul_f32 v26, v26, v64
    v_mul_f32 v27, v27, v64
    v_mfma_f32_16x16x32_bf16 v[68:71], v[252:255], v[36:39], v[68:71]
    s_waitcnt lgkmcnt(1)
    v_cvt_pk_bf16_f32 v25, v26, v27
    v_fma_f32 v62, v72, v72, s42
    v_mfma_f32_16x16x32_bf16 v[84:87], a[216:219], v[100:103], 0
    ds_write_b64 v63, v[24:25] offset:0
    v_mfma_f32_16x16x32_bf16 v[84:87], a[220:223], v[92:95], v[84:87]
    ds_read_b128 v[24:27], v119 offset:64
    v_fmac_f32 v62, v73, v73
    v_mfma_f32_16x16x32_bf16 v[84:87], a[224:227], v[88:91], v[84:87]
    ds_read_b128 v[4:7], v119 offset:80
    v_fmac_f32 v62, v74, v74
    v_mfma_f32_16x16x32_bf16 v[84:87], a[228:231], v[80:83], v[84:87]
    ds_read_b128 v[56:59], v119
    v_fmac_f32 v62, v75, v75
    v_mfma_f32_16x16x32_bf16 v[84:87], a[232:235], v[76:79], v[84:87]
    ds_read_b64 v[60:61], v119 offset:16
    v_fmac_f32 v62, v48, v48
    v_mfma_f32_16x16x32_bf16 v[84:87], a[236:239], v[16:19], v[84:87]
    v_rsq_f32 v65, v65
    v_mfma_f32_16x16x32_bf16 v[96:99], a[240:243], v[100:103], 0
    v_mul_f32 v65, s43, v65
    v_mul_f32 v28, v28, v65
    v_mfma_f32_16x16x32_bf16 v[96:99], a[244:247], v[92:95], v[96:99]
    v_mul_f32 v29, v29, v65
    v_cvt_pk_bf16_f32 v28, v28, v29
    v_mfma_f32_16x16x32_bf16 v[96:99], a[248:251], v[88:91], v[96:99]
    v_mul_f32 v30, v30, v65
    v_mul_f32 v31, v31, v65
    v_mfma_f32_16x16x32_bf16 v[96:99], a[252:255], v[80:83], v[96:99]
    v_cvt_pk_bf16_f32 v29, v30, v31
    v_mul_f32 v20, v20, v65
    v_mfma_f32_16x16x32_bf16 v[96:99], v[224:227], v[76:79], v[96:99]
    v_mul_f32 v21, v21, v65
    v_cvt_pk_bf16_f32 v30, v20, v21
    v_mfma_f32_16x16x32_bf16 v[96:99], v[228:231], v[16:19], v[96:99]
    v_mul_f32 v22, v22, v65
    v_mul_f32 v23, v23, v65
    v_mfma_f32_16x16x32_bf16 v[36:39], v[232:235], v[100:103], 0
    v_cvt_pk_bf16_f32 v31, v22, v23
    v_mul_f32 v114, v114, v65
    v_mfma_f32_16x16x32_bf16 v[36:39], v[236:239], v[92:95], v[36:39]
    ds_write_b128 v118, v[28:31] offset:1536
    v_mfma_f32_16x16x32_bf16 v[36:39], v[240:243], v[88:91], v[36:39]
    v_mul_f32 v115, v115, v65
    v_cvt_pk_bf16_f32 v114, v114, v115
    v_mfma_f32_16x16x32_bf16 v[36:39], v[244:247], v[80:83], v[36:39]
    v_mul_f32 v116, v116, v65
    v_mul_f32 v117, v117, v65
    v_mfma_f32_16x16x32_bf16 v[36:39], v[248:251], v[76:79], v[36:39]
    v_cvt_pk_bf16_f32 v115, v116, v117
    v_fmac_f32 v62, v49, v49
    v_mfma_f32_16x16x32_bf16 v[36:39], v[252:255], v[16:19], v[36:39]
    s_waitcnt lgkmcnt(1)
    ds_write_b64 v63, v[114:115] offset:1536
    v_mfma_f32_16x16x32_bf16 v[16:19], v[220:223], v[24:27], 0
    v_rsq_f32 v66, v66
    v_mfma_f32_16x16x32_bf16 v[16:19], v[220:223], v[4:7], v[16:19]
    v_mul_f32 v66, s43, v66
    v_mul_f32 v40, v40, v66
    v_mul_f32 v41, v41, v66
    v_cvt_pk_bf16_f32 v4, v40, v41
    v_mul_f32 v42, v42, v66
    v_mul_f32 v43, v43, v66
    v_cvt_pk_bf16_f32 v5, v42, v43
    v_mul_f32 v140, v140, v66
    v_mul_f32 v141, v141, v66
    v_cvt_pk_bf16_f32 v6, v140, v141
    v_mul_f32 v142, v142, v66
    v_mul_f32 v143, v143, v66
    v_cvt_pk_bf16_f32 v7, v142, v143
    v_mul_f32 v44, v44, v66
    v_mul_f32 v45, v45, v66
    v_cvt_pk_bf16_f32 v44, v44, v45
    v_mul_f32 v46, v46, v66
    v_mul_f32 v47, v47, v66
    v_cvt_pk_bf16_f32 v45, v46, v47
    ds_write_b128 v118, v[4:7] offset:3072
    v_fmac_f32 v62, v50, v50
    v_fmac_f32 v62, v51, v51
    v_fmac_f32 v62, v68, v68
    v_fmac_f32 v62, v69, v69
    ds_write_b64 v63, v[44:45] offset:3072
    v_fmac_f32 v62, v70, v70
    v_fmac_f32 v62, v71, v71
    v_fmac_f32 v133, v1, v1
    v_fmac_f32 v133, v2, v2
    v_fmac_f32 v133, v3, v3
    v_fmac_f32 v133, v52, v52
    v_fmac_f32 v133, v53, v53
    v_fmac_f32 v133, v54, v54
    v_fmac_f32 v133, v55, v55
    v_fmac_f32 v133, v12, v12
    v_fmac_f32 v133, v13, v13
    v_fmac_f32 v133, v14, v14
    v_fmac_f32 v133, v15, v15
    v_cvt_pk_bf16_f32 v62, v62, v133
    v_fma_f32 v63, v84, v84, s42
    v_fmac_f32 v63, v85, v85
    v_fmac_f32 v63, v86, v86
    v_fmac_f32 v63, v87, v87
    v_fmac_f32 v63, v96, v96
    v_fmac_f32 v63, v97, v97
    v_fmac_f32 v63, v98, v98
    v_fmac_f32 v63, v99, v99
    v_fmac_f32 v63, v36, v36
    v_fmac_f32 v63, v37, v37
    v_fmac_f32 v63, v38, v38
    v_fmac_f32 v63, v39, v39
    v_cvt_pk_bf16_f32 v63, v63, v63
    ds_write_b64 v130, v[62:63] offset:2048
    v_rcp_f32 v16, v16
    v_lshlrev_b32 v133, 16, v56
    v_and_b32 v56, 0xffff0000, v56
    v_mul_f32 v133, v133, v16
    v_mul_f32 v56, v56, v16
    v_cvt_pk_bf16_f32 v4, v133, v56
    v_lshlrev_b32 v56, 16, v57
    v_and_b32 v57, 0xffff0000, v57
    v_mul_f32 v56, v56, v16
    v_mul_f32 v57, v57, v16
    v_cvt_pk_bf16_f32 v5, v56, v57
    v_lshlrev_b32 v133, 16, v58
    v_and_b32 v58, 0xffff0000, v58
    v_mul_f32 v133, v133, v16
    v_mul_f32 v58, v58, v16
    v_cvt_pk_bf16_f32 v6, v133, v58
    v_lshlrev_b32 v7, 16, v59
    v_and_b32 v59, 0xffff0000, v59
    v_mul_f32 v7, v7, v16
    v_mul_f32 v59, v59, v16
    v_cvt_pk_bf16_f32 v7, v7, v59
    v_lshlrev_b32 v133, 16, v60
    v_and_b32 v60, 0xffff0000, v60
    v_mul_f32 v133, v133, v16
    v_mul_f32 v60, v60, v16
    v_cvt_pk_bf16_f32 v138, v133, v60
    v_lshlrev_b32 v133, 16, v61
    v_and_b32 v61, 0xffff0000, v61
    v_mul_f32 v133, v133, v16
    v_mul_f32 v61, v61, v16
    v_cvt_pk_bf16_f32 v139, v133, v61
    s_waitcnt lgkmcnt(0)
    s_barrier
    ds_write_b128 v112, v[4:7] offset:1536
    v_mov_b32 v115, 0
    ds_write_b64 v132, v[138:139] offset:1536
    ds_read_b128 v[32:35], v11 offset:0
    ds_read_b128 v[4:7], v11 offset:1024
    ds_read_b128 v[24:27], v11 offset:2048
    ds_read_b128 v[20:23], v11 offset:3072
    ds_read_b128 v[80:83], v11 offset:4096
    s_waitcnt lgkmcnt(5)
    s_barrier
    s_waitcnt lgkmcnt(4)
    buffer_store_dwordx4 v[32:35], v128, s[28:31], s59 offen sc1
    ds_read_b128 v[28:31], v129 offset:2048
    ds_read_b128 v[16:19], v129 offset:3072
    ds_read_b128 v[104:107], v137 offset:1536
    ds_read_b128 v[100:103], v136 offset:1536
    ds_read_b128 v[92:95], v137 offset:1664
    ds_read_b128 v[88:91], v136 offset:1664
    ds_read_b128 v[76:79], v137 offset:1792
    s_waitcnt lgkmcnt(9)
    buffer_store_dwordx4 v[4:7], v127, s[28:31], s59 offen sc1
    ds_read_b128 v[40:43], v136 offset:1792
    s_waitcnt lgkmcnt(7)
    v_mfma_f32_16x16x32_bf16 v[4:7], v[216:219], v[28:31], 0
    s_waitcnt lgkmcnt(6)
    v_mfma_f32_16x16x32_bf16 v[4:7], v[216:219], v[16:19], v[4:7]
    s_waitcnt lgkmcnt(5)
    v_mfma_f32_16x16x32_bf16 v[16:19], a[216:219], v[104:107], 0
    s_waitcnt lgkmcnt(4)
    v_mfma_f32_16x16x32_bf16 v[16:19], a[220:223], v[100:103], v[16:19]
    s_waitcnt lgkmcnt(3)
    ds_read_b128 v[64:67], v137 offset:0
    ds_read_b128 v[60:63], v136 offset:0
    v_mfma_f32_16x16x32_bf16 v[16:19], a[224:227], v[92:95], v[16:19]
    s_waitcnt lgkmcnt(4)
    ds_read_b128 v[56:59], v137 offset:128
    v_mfma_f32_16x16x32_bf16 v[16:19], a[228:231], v[88:91], v[16:19]
    s_waitcnt lgkmcnt(4)
    buffer_store_dwordx4 v[24:27], v126, s[28:31], s59 offen sc1
    ds_read_b128 v[44:47], v136 offset:128
    v_rsq_f32 v4, v4
    v_mfma_f32_16x16x32_bf16 v[16:19], a[232:235], v[76:79], v[16:19]
    s_waitcnt lgkmcnt(4)
    ds_read_b128 v[32:35], v137 offset:256
    ds_read_b128 v[24:27], v136 offset:256
    v_mfma_f32_16x16x32_bf16 v[16:19], a[236:239], v[40:43], v[16:19]
    v_rsq_f32 v5, v5
    v_mfma_f32_16x16x32_bf16 v[28:31], a[240:243], v[104:107], 0
    v_mul_f32 v4, s43, v4
    v_mul_f32 v5, s43, v5
    v_mfma_f32_16x16x32_bf16 v[28:31], a[244:247], v[100:103], v[28:31]
    v_rsq_f32 v6, v6
    v_mfma_f32_16x16x32_bf16 v[28:31], a[248:251], v[92:95], v[28:31]
    v_mul_f32 v6, s43, v6
    v_mul_f32 v84, v84, v6
    v_mfma_f32_16x16x32_bf16 v[28:31], a[252:255], v[88:91], v[28:31]
    buffer_store_dwordx4 v[20:23], v125, s[28:31], s59 offen sc1
    v_mul_f32 v85, v85, v6
    v_cvt_pk_bf16_f32 v84, v84, v85
    v_mul_f32 v86, v86, v6
    v_mul_f32 v87, v87, v6
    v_mfma_f32_16x16x32_bf16 v[28:31], v[224:227], v[76:79], v[28:31]
    v_cvt_pk_bf16_f32 v85, v86, v87
    v_mul_f32 v96, v96, v6
    v_mfma_f32_16x16x32_bf16 v[28:31], v[228:231], v[40:43], v[28:31]
    v_mul_f32 v97, v97, v6
    v_cvt_pk_bf16_f32 v86, v96, v97
    v_mfma_f32_16x16x32_bf16 v[20:23], v[232:235], v[104:107], 0
    v_mul_f32 v98, v98, v6
    v_mul_f32 v99, v99, v6
    v_mfma_f32_16x16x32_bf16 v[20:23], v[236:239], v[100:103], v[20:23]
    v_cvt_pk_bf16_f32 v87, v98, v99
    v_mul_f32 v36, v36, v6
    v_mfma_f32_16x16x32_bf16 v[20:23], v[240:243], v[92:95], v[20:23]
    ds_write_b128 v135, v[84:87] offset:3072
    v_mfma_f32_16x16x32_bf16 v[20:23], v[244:247], v[88:91], v[20:23]
    buffer_store_dwordx4 v[80:83], v124, s[28:31], s59 offen sc1
    v_mul_f32 v37, v37, v6
    v_cvt_pk_bf16_f32 v36, v36, v37
    v_mul_f32 v38, v38, v6
    v_mul_f32 v39, v39, v6
    v_mfma_f32_16x16x32_bf16 v[20:23], v[248:251], v[76:79], v[20:23]
    v_cvt_pk_bf16_f32 v37, v38, v39
    v_mul_f32 v72, v72, v4
    v_mfma_f32_16x16x32_bf16 v[20:23], v[252:255], v[40:43], v[20:23]
    s_waitcnt lgkmcnt(1)
    ds_write_b64 v134, v[36:37] offset:3072
    v_mfma_f32_16x16x32_bf16 v[36:39], a[216:219], v[64:67], 0
    v_mul_f32 v73, v73, v4
    v_cvt_pk_bf16_f32 v40, v72, v73
    v_mfma_f32_16x16x32_bf16 v[36:39], a[220:223], v[60:63], v[36:39]
    v_mul_f32 v74, v74, v4
    v_mul_f32 v75, v75, v4
    v_mfma_f32_16x16x32_bf16 v[36:39], a[224:227], v[56:59], v[36:39]
    v_cvt_pk_bf16_f32 v41, v74, v75
    v_mul_f32 v48, v48, v4
    v_mfma_f32_16x16x32_bf16 v[36:39], a[228:231], v[44:47], v[36:39]
    v_mul_f32 v49, v49, v4
    v_cvt_pk_bf16_f32 v42, v48, v49
    v_mfma_f32_16x16x32_bf16 v[36:39], a[232:235], v[32:35], v[36:39]
    v_mul_f32 v50, v50, v4
    v_mul_f32 v51, v51, v4
    v_mfma_f32_16x16x32_bf16 v[36:39], a[236:239], v[24:27], v[36:39]
    v_cvt_pk_bf16_f32 v43, v50, v51
    v_mul_f32 v68, v68, v4
    v_mfma_f32_16x16x32_bf16 v[48:51], a[240:243], v[64:67], 0
    ds_write_b128 v135, v[40:43] offset:0
    v_mfma_f32_16x16x32_bf16 v[48:51], a[244:247], v[60:63], v[48:51]
    v_mul_f32 v69, v69, v4
    v_cvt_pk_bf16_f32 v6, v68, v69
    v_mfma_f32_16x16x32_bf16 v[48:51], a[248:251], v[56:59], v[48:51]
    v_mul_f32 v70, v70, v4
    v_mul_f32 v71, v71, v4
    v_mfma_f32_16x16x32_bf16 v[48:51], a[252:255], v[44:47], v[48:51]
    v_cvt_pk_bf16_f32 v7, v70, v71
    v_fma_f32 v11, v16, v16, s42
    v_mfma_f32_16x16x32_bf16 v[48:51], v[224:227], v[32:35], v[48:51]
    ds_write_b64 v134, v[6:7] offset:0
    v_mfma_f32_16x16x32_bf16 v[48:51], v[228:231], v[24:27], v[48:51]
    v_fmac_f32 v11, v17, v17
    v_fmac_f32 v11, v18, v18
    v_mfma_f32_16x16x32_bf16 v[40:43], v[232:235], v[64:67], 0
    v_fmac_f32 v11, v19, v19
    v_fmac_f32 v11, v28, v28
    v_mfma_f32_16x16x32_bf16 v[40:43], v[236:239], v[60:63], v[40:43]
    v_fmac_f32 v11, v29, v29
    v_fmac_f32 v11, v30, v30
    v_mfma_f32_16x16x32_bf16 v[40:43], v[240:243], v[56:59], v[40:43]
    v_fmac_f32 v11, v31, v31
    v_fmac_f32 v11, v20, v20
    v_mfma_f32_16x16x32_bf16 v[40:43], v[244:247], v[44:47], v[40:43]
    v_fmac_f32 v11, v21, v21
    v_fmac_f32 v11, v22, v22
    v_mfma_f32_16x16x32_bf16 v[40:43], v[248:251], v[32:35], v[40:43]
    v_fmac_f32 v11, v23, v23
    v_fma_f32 v114, v36, v36, s42
    v_mfma_f32_16x16x32_bf16 v[40:43], v[252:255], v[24:27], v[40:43]
    s_nop 0
    v_fmac_f32 v114, v37, v37
    v_fmac_f32 v114, v38, v38
    v_fmac_f32 v114, v39, v39
    v_fmac_f32 v114, v48, v48
    v_fmac_f32 v114, v49, v49
    v_fmac_f32 v114, v50, v50
    v_fmac_f32 v114, v51, v51
    v_fmac_f32 v114, v40, v40
    v_fmac_f32 v114, v41, v41
    v_fmac_f32 v114, v42, v42
    v_fmac_f32 v114, v43, v43
    v_cvt_pk_bf16_f32 v114, v114, v11
    ds_write_b64 v130, v[114:115] offset:4096
    v_mul_f32 v0, v0, v5
    v_mul_f32 v1, v1, v5
    v_cvt_pk_bf16_f32 v0, v0, v1
    v_mul_f32 v2, v2, v5
    v_mul_f32 v3, v3, v5
    v_cvt_pk_bf16_f32 v1, v2, v3
    v_mul_f32 v52, v52, v5
    v_mul_f32 v53, v53, v5
    v_cvt_pk_bf16_f32 v2, v52, v53
    v_mul_f32 v54, v54, v5
    v_mul_f32 v55, v55, v5
    v_cvt_pk_bf16_f32 v3, v54, v55
    v_mul_f32 v12, v12, v5
    v_mul_f32 v13, v13, v5
    v_cvt_pk_bf16_f32 v114, v12, v13
    v_mul_f32 v14, v14, v5
    v_mul_f32 v15, v15, v5
    v_cvt_pk_bf16_f32 v115, v14, v15
    ds_write_b128 v135, v[0:3] offset:1536
    s_waitcnt lgkmcnt(1)
    s_barrier
    ds_write_b64 v134, v[114:115] offset:1536
    ds_read_b128 v[4:7], v129 offset:4096
    ds_read_b128 v[0:3], v129 offset:5120
    s_waitcnt lgkmcnt(2)
    s_barrier
    s_waitcnt lgkmcnt(1)
    v_mfma_f32_16x16x32_bf16 v[24:27], v[216:219], v[4:7], 0
    s_waitcnt lgkmcnt(0)
    ds_read_b128 v[44:47], v113 offset:0
    ds_read_b128 v[32:35], v113 offset:1024
    v_mfma_f32_16x16x32_bf16 v[24:27], v[216:219], v[0:3], v[24:27]
    s_nop 0
    ds_read_b128 v[12:15], v113 offset:2048
    s_nop 2
    ds_read_b128 v[4:7], v113 offset:3072
    s_nop 1
    v_rsq_f32 v24, v24
    ds_read_b128 v[0:3], v113 offset:4096
    v_mul_f32 v24, s43, v24
    v_mul_f32 v36, v36, v24
    v_mul_f32 v37, v37, v24
    v_cvt_pk_bf16_f32 v36, v36, v37
    v_mul_f32 v38, v38, v24
    v_mul_f32 v39, v39, v24
    v_cvt_pk_bf16_f32 v37, v38, v39
    v_mul_f32 v48, v48, v24
    v_mul_f32 v49, v49, v24
    s_waitcnt lgkmcnt(4)
    buffer_store_dwordx4 v[44:47], v128, s[28:31], s58 offen sc1
    v_cvt_pk_bf16_f32 v38, v48, v49
    v_mul_f32 v50, v50, v24
    v_mul_f32 v51, v51, v24
    v_cvt_pk_bf16_f32 v39, v50, v51
    v_mul_f32 v40, v40, v24
    v_mul_f32 v41, v41, v24
    v_cvt_pk_bf16_f32 v26, v40, v41
    v_mul_f32 v42, v42, v24
    v_mul_f32 v43, v43, v24
    v_cvt_pk_bf16_f32 v27, v42, v43
    ds_write_b128 v112, v[36:39] offset:0
    v_rsq_f32 v25, v25
    s_nop 0
    v_mul_f32 v25, s43, v25
    s_waitcnt lgkmcnt(1)
    buffer_store_dwordx4 v[32:35], v127, s[28:31], s58 offen sc1
    ds_write_b64 v132, v[26:27] offset:0
    v_mul_f32 v16, v16, v25
    v_mul_f32 v17, v17, v25
    v_cvt_pk_bf16_f32 v16, v16, v17
    v_mul_f32 v18, v18, v25
    v_mul_f32 v19, v19, v25
    v_cvt_pk_bf16_f32 v17, v18, v19
    v_mul_f32 v28, v28, v25
    v_mul_f32 v29, v29, v25
    v_cvt_pk_bf16_f32 v18, v28, v29
    v_mul_f32 v30, v30, v25
    v_mul_f32 v31, v31, v25
    v_cvt_pk_bf16_f32 v19, v30, v31
    v_mul_f32 v20, v20, v25
    v_mul_f32 v21, v21, v25
    v_cvt_pk_bf16_f32 v128, v20, v21
    v_mul_f32 v22, v22, v25
    v_mul_f32 v23, v23, v25
    v_cvt_pk_bf16_f32 v129, v22, v23
    buffer_store_dwordx4 v[12:15], v126, s[28:31], s58 offen sc1
    ds_write_b128 v112, v[16:19] offset:1536
    ds_write_b64 v132, v[128:129] offset:1536
    buffer_store_dwordx4 v[4:7], v125, s[28:31], s58 offen sc1
    s_waitcnt lgkmcnt(0)
    s_barrier
    buffer_store_dwordx4 v[0:3], v124, s[28:31], s58 offen sc1
    ds_read_b128 v[12:15], v131 offset:0
    ds_read_b128 v[4:7], v131 offset:1024
    ds_read_b128 v[0:3], v131 offset:2048
    s_waitcnt lgkmcnt(2)
    buffer_store_dwordx4 v[12:15], v8, s[28:31], 0 offen sc1
    s_waitcnt lgkmcnt(0)
    buffer_store_dwordx4 v[4:7], v9, s[28:31], 0 offen sc1
    buffer_store_dwordx4 v[0:3], v10, s[28:31], 0 offen sc1
    s_branch L_fin
L_again:
    s_waitcnt vmcnt(0) lgkmcnt(0)
    s_nop 15
    s_barrier
    s_movk_i32 s2, 256
    s_branch L_top
L_bndS:
    s_movk_i32 s73, 20
    s_movk_i32 s71, 18
    s_movk_i32 s70, -20
    s_mov_b32 s74, 0
    s_bitcmp1_b32 s2, 2
    s_cbranch_scc1 L_bndcS
    s_sub_u32 s94, s2, 248
    s_mul_i32 s69, s94, 18
    s_mov_b32 s74, 2
    s_sub_u32 s93, s93, 1373568
    v_cmp_le_u32 vcc, 4, v73
    v_add_u32 v6, 98896896, v128
    v_subrev_u32 v7, 1373568, v128
    v_cndmask_b32 v128, v6, v7, vcc
    v_cmp_le_u32 vcc, 4, v156
    v_add_u32 v6, 98896896, v127
    v_subrev_u32 v7, 1373568, v127
    v_cndmask_b32 v127, v6, v7, vcc
    v_cmp_le_u32 vcc, 4, v4
    v_add_u32 v6, 98896896, v126
    v_subrev_u32 v7, 1373568, v126
    v_cndmask_b32 v126, v6, v7, vcc
    v_cmp_le_u32 vcc, 4, v18
    v_add_u32 v6, 98896896, v125
    v_subrev_u32 v7, 1373568, v125
    v_cndmask_b32 v125, v6, v7, vcc
    v_cmp_le_u32 vcc, 4, v11
    v_add_u32 v6, 98896896, v124
    v_subrev_u32 v7, 1373568, v124
    v_cndmask_b32 v124, v6, v7, vcc
    s_cmp_lt_u32 s2, 256
    s_cbranch_scc1 L_bndrS
L_bndcS:
    s_sub_u32 s94, s2, 252
    s_mul_i32 s69, s94, 20
    s_lshr_b32 s71, s94, 1
    s_sub_u32 s69, s69, s71
    s_and_b32 s94, s94, 1
    s_sub_u32 s71, 20, s94
    s_cmp_eq_u32 s2, 255
    s_cselect_b32 s71, 13, s71
    s_mov_b32 s62, 1373568
    s_add_u32 s74, s74, 1
    s_sub_u32 s93, s93, 2688
    v_mad_i32_i24 v6, v73, -7, v74
    v_cmp_le_u32 vcc, 4, v6
    v_add_u32 v6, 193536, v128
    v_subrev_u32 v7, 2688, v128
    v_cndmask_b32 v128, v6, v7, vcc
    v_mad_i32_i24 v6, v156, -7, v150
    v_cmp_le_u32 vcc, 4, v6
    v_add_u32 v6, 193536, v127
    v_subrev_u32 v7, 2688, v127
    v_cndmask_b32 v127, v6, v7, vcc
    v_mad_i32_i24 v6, v4, -7, v10
    v_cmp_le_u32 vcc, 4, v6
    v_add_u32 v6, 193536, v126
    v_subrev_u32 v7, 2688, v126
    v_cndmask_b32 v126, v6, v7, vcc
    v_mad_i32_i24 v6, v18, -7, v159
    v_cmp_le_u32 vcc, 4, v6
    v_add_u32 v6, 193536, v125
    v_subrev_u32 v7, 2688, v125
    v_cndmask_b32 v125, v6, v7, vcc
    v_mad_i32_i24 v6, v11, -7, v151
    v_cmp_le_u32 vcc, 4, v6
    v_add_u32 v6, 193536, v124
    v_subrev_u32 v7, 2688, v124
    v_cndmask_b32 v124, v6, v7, vcc
    s_cmp_eq_u32 s2, 256
    s_cselect_b32 s62, 0, s62
    s_cselect_b32 s69, 0, s69
    s_cselect_b32 s71, 2, s71
    s_branch L_bndrS
L_maskS:
    s_and_b32 s20, s74, 2
    s_and_b32 s21, s74, 1
    s_mov_b32 s22, 0xc31044fe
    v_lshrrev_b32 v161, 2, v149
    v_add_u32 v161, 0, v161
    v_mul_u32_u24 v148, 37, v161
    v_lshrrev_b32 v72, 8, v148
    v_mad_i32_i24 v72, v72, -7, v161
    v_lshrrev_b32 v148, 10, v148
    v_lshrrev_b32 v72, 2, v72
    v_mul_u32_u24 v148, s20, v148
    v_mad_u32_u24 v161, v72, s21, v148
    v_cvt_f32_u32 v161, v161
    v_lshrrev_b32 v164, 2, v149
    v_add_u32 v164, 4, v164
    v_mul_u32_u24 v148, 37, v164
    v_lshrrev_b32 v72, 8, v148
    v_mad_i32_i24 v72, v72, -7, v164
    v_lshrrev_b32 v148, 10, v148
    v_lshrrev_b32 v72, 2, v72
    v_mul_u32_u24 v148, s20, v148
    v_mad_u32_u24 v164, v72, s21, v148
    v_cvt_f32_u32 v164, v164
    v_lshrrev_b32 v75, 2, v149
    v_add_u32 v75, 8, v75
    v_mul_u32_u24 v148, 37, v75
    v_lshrrev_b32 v72, 8, v148
    v_mad_i32_i24 v72, v72, -7, v75
    v_lshrrev_b32 v148, 10, v148
    v_lshrrev_b32 v72, 2, v72
    v_mul_u32_u24 v148, s20, v148
    v_mad_u32_u24 v75, v72, s21, v148
    v_cvt_f32_u32 v75, v75
    v_mad_u32_u24 v73, v160, 12, 0
    v_mul_u32_u24 v148, 37, v73
    v_lshrrev_b32 v72, 8, v148
    v_mad_i32_i24 v72, v72, -7, v73
    v_lshrrev_b32 v148, 10, v148
    v_lshrrev_b32 v72, 2, v72
    v_mul_u32_u24 v148, s20, v148
    v_mad_u32_u24 v73, v72, s21, v148
    v_cvt_f32_u32 v73, v73
    v_sub_f32 v148, v161, v73
    v_mul_f32 v148, v148, v148 clamp
    v_fmac_f32 v204, s22, v148
    v_sub_f32 v148, v164, v73
    v_mul_f32 v148, v148, v148 clamp
    v_fmac_f32 v192, s22, v148
    v_sub_f32 v148, v75, v73
    v_mul_f32 v148, v148, v148 clamp
    v_fmac_f32 v180, s22, v148
    v_mad_u32_u24 v73, v160, 12, 1
    v_mul_u32_u24 v148, 37, v73
    v_lshrrev_b32 v72, 8, v148
    v_mad_i32_i24 v72, v72, -7, v73
    v_lshrrev_b32 v148, 10, v148
    v_lshrrev_b32 v72, 2, v72
    v_mul_u32_u24 v148, s20, v148
    v_mad_u32_u24 v73, v72, s21, v148
    v_cvt_f32_u32 v73, v73
    v_sub_f32 v148, v161, v73
    v_mul_f32 v148, v148, v148 clamp
    v_fmac_f32 v205, s22, v148
    v_sub_f32 v148, v164, v73
    v_mul_f32 v148, v148, v148 clamp
    v_fmac_f32 v193, s22, v148
    v_sub_f32 v148, v75, v73
    v_mul_f32 v148, v148, v148 clamp
    v_fmac_f32 v181, s22, v148
    v_mad_u32_u24 v73, v160, 12, 2
    v_mul_u32_u24 v148, 37, v73
    v_lshrrev_b32 v72, 8, v148
    v_mad_i32_i24 v72, v72, -7, v73
    v_lshrrev_b32 v148, 10, v148
    v_lshrrev_b32 v72, 2, v72
    v_mul_u32_u24 v148, s20, v148
    v_mad_u32_u24 v73, v72, s21, v148
    v_cvt_f32_u32 v73, v73
    v_sub_f32 v148, v161, v73
    v_mul_f32 v148, v148, v148 clamp
    v_fmac_f32 v206, s22, v148
    v_sub_f32 v148, v164, v73
    v_mul_f32 v148, v148, v148 clamp
    v_fmac_f32 v194, s22, v148
    v_sub_f32 v148, v75, v73
    v_mul_f32 v148, v148, v148 clamp
    v_fmac_f32 v182, s22, v148
    v_mad_u32_u24 v73, v160, 12, 3
    v_mul_u32_u24 v148, 37, v73
    v_lshrrev_b32 v72, 8, v148
    v_mad_i32_i24 v72, v72, -7, v73
    v_lshrrev_b32 v148, 10, v148
    v_lshrrev_b32 v72, 2, v72
    v_mul_u32_u24 v148, s20, v148
    v_mad_u32_u24 v73, v72, s21, v148
    v_cvt_f32_u32 v73, v73
    v_sub_f32 v148, v161, v73
    v_mul_f32 v148, v148, v148 clamp
    v_fmac_f32 v207, s22, v148
    v_sub_f32 v148, v164, v73
    v_mul_f32 v148, v148, v148 clamp
    v_fmac_f32 v195, s22, v148
    v_sub_f32 v148, v75, v73
    v_mul_f32 v148, v148, v148 clamp
    v_fmac_f32 v183, s22, v148
    v_mad_u32_u24 v73, v160, 12, 4
    v_mul_u32_u24 v148, 37, v73
    v_lshrrev_b32 v72, 8, v148
    v_mad_i32_i24 v72, v72, -7, v73
    v_lshrrev_b32 v148, 10, v148
    v_lshrrev_b32 v72, 2, v72
    v_mul_u32_u24 v148, s20, v148
    v_mad_u32_u24 v73, v72, s21, v148
    v_cvt_f32_u32 v73, v73
    v_sub_f32 v148, v161, v73
    v_mul_f32 v148, v148, v148 clamp
    v_fmac_f32 v200, s22, v148
    v_sub_f32 v148, v164, v73
    v_mul_f32 v148, v148, v148 clamp
    v_fmac_f32 v188, s22, v148
    v_sub_f32 v148, v75, v73
    v_mul_f32 v148, v148, v148 clamp
    v_fmac_f32 v176, s22, v148
    v_mad_u32_u24 v73, v160, 12, 5
    v_mul_u32_u24 v148, 37, v73
    v_lshrrev_b32 v72, 8, v148
    v_mad_i32_i24 v72, v72, -7, v73
    v_lshrrev_b32 v148, 10, v148
    v_lshrrev_b32 v72, 2, v72
    v_mul_u32_u24 v148, s20, v148
    v_mad_u32_u24 v73, v72, s21, v148
    v_cvt_f32_u32 v73, v73
    v_sub_f32 v148, v161, v73
    v_mul_f32 v148, v148, v148 clamp
    v_fmac_f32 v201, s22, v148
    v_sub_f32 v148, v164, v73
    v_mul_f32 v148, v148, v148 clamp
    v_fmac_f32 v189, s22, v148
    v_sub_f32 v148, v75, v73
    v_mul_f32 v148, v148, v148 clamp
    v_fmac_f32 v177, s22, v148
    v_mad_u32_u24 v73, v160, 12, 6
    v_mul_u32_u24 v148, 37, v73
    v_lshrrev_b32 v72, 8, v148
    v_mad_i32_i24 v72, v72, -7, v73
    v_lshrrev_b32 v148, 10, v148
    v_lshrrev_b32 v72, 2, v72
    v_mul_u32_u24 v148, s20, v148
    v_mad_u32_u24 v73, v72, s21, v148
    v_cvt_f32_u32 v73, v73
    v_sub_f32 v148, v161, v73
    v_mul_f32 v148, v148, v148 clamp
    v_fmac_f32 v202, s22, v148
    v_sub_f32 v148, v164, v73
    v_mul_f32 v148, v148, v148 clamp
    v_fmac_f32 v190, s22, v148
    v_sub_f32 v148, v75, v73
    v_mul_f32 v148, v148, v148 clamp
    v_fmac_f32 v178, s22, v148
    v_mad_u32_u24 v73, v160, 12, 7
    v_mul_u32_u24 v148, 37, v73
    v_lshrrev_b32 v72, 8, v148
    v_mad_i32_i24 v72, v72, -7, v73
    v_lshrrev_b32 v148, 10, v148
    v_lshrrev_b32 v72, 2, v72
    v_mul_u32_u24 v148, s20, v148
    v_mad_u32_u24 v73, v72, s21, v148
    v_cvt_f32_u32 v73, v73
    v_sub_f32 v148, v161, v73
    v_mul_f32 v148, v148, v148 clamp
    v_fmac_f32 v203, s22, v148
    v_sub_f32 v148, v164, v73
    v_mul_f32 v148, v148, v148 clamp
    v_fmac_f32 v191, s22, v148
    v_sub_f32 v148, v75, v73
    v_mul_f32 v148, v148, v148 clamp
    v_fmac_f32 v179, s22, v148
    v_mad_u32_u24 v73, v160, 12, 8
    v_mul_u32_u24 v148, 37, v73
    v_lshrrev_b32 v72, 8, v148
    v_mad_i32_i24 v72, v72, -7, v73
    v_lshrrev_b32 v148, 10, v148
    v_lshrrev_b32 v72, 2, v72
    v_mul_u32_u24 v148, s20, v148
    v_mad_u32_u24 v73, v72, s21, v148
    v_cvt_f32_u32 v73, v73
    v_sub_f32 v148, v161, v73
    v_mul_f32 v148, v148, v148 clamp
    v_fmac_f32 v196, s22, v148
    v_sub_f32 v148, v164, v73
    v_mul_f32 v148, v148, v148 clamp
    v_fmac_f32 v184, s22, v148
    v_sub_f32 v148, v75, v73
    v_mul_f32 v148, v148, v148 clamp
    v_fmac_f32 v172, s22, v148
    v_mad_u32_u24 v73, v160, 12, 9
    v_mul_u32_u24 v148, 37, v73
    v_lshrrev_b32 v72, 8, v148
    v_mad_i32_i24 v72, v72, -7, v73
    v_lshrrev_b32 v148, 10, v148
    v_lshrrev_b32 v72, 2, v72
    v_mul_u32_u24 v148, s20, v148
    v_mad_u32_u24 v73, v72, s21, v148
    v_cvt_f32_u32 v73, v73
    v_sub_f32 v148, v161, v73
    v_mul_f32 v148, v148, v148 clamp
    v_fmac_f32 v197, s22, v148
    v_sub_f32 v148, v164, v73
    v_mul_f32 v148, v148, v148 clamp
    v_fmac_f32 v185, s22, v148
    v_sub_f32 v148, v75, v73
    v_mul_f32 v148, v148, v148 clamp
    v_fmac_f32 v173, s22, v148
    v_mad_u32_u24 v73, v160, 12, 10
    v_mul_u32_u24 v148, 37, v73
    v_lshrrev_b32 v72, 8, v148
    v_mad_i32_i24 v72, v72, -7, v73
    v_lshrrev_b32 v148, 10, v148
    v_lshrrev_b32 v72, 2, v72
    v_mul_u32_u24 v148, s20, v148
    v_mad_u32_u24 v73, v72, s21, v148
    v_cvt_f32_u32 v73, v73
    v_sub_f32 v148, v161, v73
    v_mul_f32 v148, v148, v148 clamp
    v_fmac_f32 v198, s22, v148
    v_sub_f32 v148, v164, v73
    v_mul_f32 v148, v148, v148 clamp
    v_fmac_f32 v186, s22, v148
    v_sub_f32 v148, v75, v73
    v_mul_f32 v148, v148, v148 clamp
    v_fmac_f32 v174, s22, v148
    v_mad_u32_u24 v73, v160, 12, 11
    v_mul_u32_u24 v148, 37, v73
    v_lshrrev_b32 v72, 8, v148
    v_mad_i32_i24 v72, v72, -7, v73
    v_lshrrev_b32 v148, 10, v148
    v_lshrrev_b32 v72, 2, v72
    v_mul_u32_u24 v148, s20, v148
    v_mad_u32_u24 v73, v72, s21, v148
    v_cvt_f32_u32 v73, v73
    v_sub_f32 v148, v161, v73
    v_mul_f32 v148, v148, v148 clamp
    v_fmac_f32 v199, s22, v148
    v_sub_f32 v148, v164, v73
    v_mul_f32 v148, v148, v148 clamp
    v_fmac_f32 v187, s22, v148
    v_sub_f32 v148, v75, v73
    v_mul_f32 v148, v148, v148 clamp
    v_fmac_f32 v175, s22, v148
    v_cvt_f32_u32 v73, s74
    v_sub_f32 v148, v161, v73
    v_mul_f32 v148, v148, v148 clamp
    v_fmac_f32 v208, s22, v148
    v_sub_f32 v148, v164, v73
    v_mul_f32 v148, v148, v148 clamp
    v_fmac_f32 v209, s22, v148
    v_sub_f32 v148, v75, v73
    v_mul_f32 v148, v148, v148 clamp
    v_fmac_f32 v210, s22, v148
    v_lshrrev_b32 v161, 2, v149
    v_lshl_add_u32 v161, v160, 2, v161
    v_add_u32 v148, 1, v160
    v_lshrrev_b32 v148, 2, v148
    v_mad_u32_u24 v161, v148, 36, v161
    v_min_u32 v161, 48, v161
    v_mul_u32_u24 v148, 37, v161
    v_lshrrev_b32 v72, 8, v148
    v_mad_i32_i24 v72, v72, -7, v161
    v_lshrrev_b32 v148, 10, v148
    v_lshrrev_b32 v72, 2, v72
    v_mul_u32_u24 v148, s20, v148
    v_mad_u32_u24 v161, v72, s21, v148
    v_cvt_f32_u32 v161, v161
    v_sub_f32 v148, v161, v73
    v_mul_f32 v148, v148, v148 clamp
    v_fmac_f32 v211, s22, v148
    s_branch L_nomaskS
L_atomS0:
    v_mov_b32 v122, 0x800000
    buffer_atomic_add v122, v129, s[8:11], 0 offen sc0 sc1
    s_branch L_atomS0r
.section .rodata,"a"
.p2align 6
.amdhsa_kernel standalone__window_attn_swin_v2__vision_kernel
  .amdhsa_next_free_vgpr 512
  .amdhsa_next_free_sgpr 102
  .amdhsa_accum_offset 256
  .amdhsa_group_segment_fixed_size 0
  .amdhsa_kernarg_size 96
  .amdhsa_user_sgpr_count 2
  .amdhsa_user_sgpr_kernarg_segment_ptr 1
  .amdhsa_system_sgpr_workgroup_id_x 1
.end_amdhsa_kernel
```

```asm
; @launch grid=(256,1,1) block=(256,1,1) lds=163840
.amdgcn_target "amdgcn-amd-amdhsa--gfx950"
.text
.globl standalone__window_attn_swin_v2__vision_kernel
.p2align 8
.type standalone__window_attn_swin_v2__vision_kernel,@function
standalone__window_attn_swin_v2__vision_kernel:
    v_lshrrev_b32 v0, 6, v0
    s_cmp_ge_u32 s2, 256
    s_cbranch_scc1 L_end
    v_readfirstlane_b32 s68, v0
L_top:
    s_mov_b32 s64, 0
    s_nop 0
L_top2:
    v_mbcnt_lo_u32_b32 v97, -1, 0
    v_mbcnt_hi_u32_b32 v97, -1, v97
    s_load_dwordx16 s[4:19], s[0:1], 0
    s_load_dwordx4 s[20:23], s[0:1], 64
    s_load_dwordx2 s[38:39], s[0:1], 80
    s_load_dwordx2 s[76:77], s[0:1], 88
    s_add_u32 s84, s2, s64
    s_sub_u32 s84, s84, 248
    s_cmp_lt_u32 s84, 3
    s_cbranch_scc1 L_prod
    s_bfe_u32 s88, s2, 0x50003
    s_lshl2_add_u32 s88, s88, s68
    v_lshlrev_b32 v98, 7, v97
    s_getpc_b64 s[80:81]
    s_mul_i32 s84, s88, 320
    v_min_u32 v96, 256, v98
    v_add_u32 v96, s84, v96
    v_min_u32 v96, L_slow-standalone__window_attn_swin_v2__vision_kernel-256, v96
    s_mul_i32 s88, s88, 1728
    s_mov_b32 s34, 221184
    global_load_dword a255, v96, s[80:81]
    v_min_u32 v39, 1664, v98
    s_mov_b32 s35, 0x20000
    s_mov_b32 s78, 73728
    s_mov_b32 s79, 0x20000
    v_and_b32 v38, 15, v97
    v_lshrrev_b32 v139, 4, v97
    v_lshrrev_b32 v37, 2, v38
    v_and_b32 v36, 3, v38
    s_mul_i32 s87, s68, 192
    v_mad_u32_u24 v7, v38, 12, s87
    v_lshlrev_b32 v4, 1, v38
    v_lshlrev_b32 v50, 1, v37
    v_lshl_add_u32 v50, v139, 5, v50
    s_movk_i32 s86, 384
    s_mov_b32 s26, 100270464
    s_mov_b32 s27, 0x20000
    s_mov_b32 s30, 0
    s_mov_b32 s31, 0x20000
    s_waitcnt lgkmcnt(0)
    s_mov_b32 s24, s4
    s_mov_b32 s25, s5
    s_mov_b32 s32, s6
    s_mov_b32 s33, s7
    buffer_load_dword a254, v39, s[32:35], s88 offen
    s_load_dwordx2 s[82:83], s[10:11], 0
    s_movk_i32 s18, 676
    s_mov_b32 s19, 0x20000
    buffer_load_dwordx3 v[20:22], v7, s[16:19], 0 offen
    s_mul_i32 s96, s68, 288
    s_and_b32 s97, s68, 1
    s_lshl_b32 s97, s97, 2
    s_mov_b32 s98, 193536
    s_mov_b32 s99, 589824
    global_load_ushort v12, v4, s[12:13]
    v_add_u32 v23, s96, v97
    v_mul_u32_u24 v39, 2731, v23
    v_mul_u32_u24 v105, 6242, v23
    v_lshrrev_b32 v39, 16, v39
    v_lshrrev_b32 v105, 20, v105
    s_lshr_b32 s94, s2, 3
    s_mul_i32 s70, s94, 167
    global_load_ushort v13, v4, s[12:13] offset:32
    v_and_or_b32 v104, v39, 3, s97
    v_xor_b32 v104, v23, v104
    v_lshl_add_u32 v128, v104, 4, s99
    v_mad_u32_u24 v128, v105, s98, v128
    v_add_u32 v49, 64, v23
    s_min_u32 s95, s94, 7
    s_add_u32 s70, s70, s95
    global_load_ushort v48, v50, s[14:15] offset:0
    v_mul_u32_u24 v51, 2731, v49
    v_mul_u32_u24 v4, 6242, v49
    v_lshrrev_b32 v51, 16, v51
    v_lshrrev_b32 v4, 20, v4
    v_and_or_b32 v5, v51, 3, s97
    s_and_b32 s95, s2, 7
    s_mul_i32 s95, s95, 20
    global_load_ushort v6, v50, s[14:15] offset:8
    v_xor_b32 v5, v49, v5
    v_lshl_add_u32 v127, v5, 4, s99
    v_mad_u32_u24 v127, v4, s98, v127
    v_add_u32 v106, 128, v23
    v_mul_u32_u24 v15, 2731, v106
    s_add_u32 s69, s70, s95
    s_add_u32 s70, s70, 140
    global_load_ushort v49, v50, s[14:15] offset:16
    v_mul_u32_u24 v129, 6242, v106
    v_lshrrev_b32 v15, 16, v15
    v_lshrrev_b32 v129, 20, v129
    v_and_or_b32 v14, v15, 3, s97
    v_xor_b32 v14, v106, v14
    s_movk_i32 s62, 2688
    s_movk_i32 s71, 20
    global_load_ushort v50, v50, s[14:15] offset:24
    v_lshl_add_u32 v126, v14, 4, s99
    v_mad_u32_u24 v126, v129, s98, v126
    v_add_u32 v125, 192, v23
    v_mul_u32_u24 v107, 2731, v125
    v_mul_u32_u24 v106, 6242, v125
    v_lshrrev_b32 v107, 16, v107
    v_lshrrev_b32 v106, 20, v106
    v_and_or_b32 v124, v107, 3, s97
    v_xor_b32 v124, v125, v124
    v_lshl_add_u32 v125, v124, 4, s99
    v_mad_u32_u24 v125, v106, s98, v125
    v_add_u32 v98, 256, v23
    v_mul_u32_u24 v23, 2731, v98
    v_mul_u32_u24 v96, 6242, v98
    v_lshrrev_b32 v23, 16, v23
    v_lshrrev_b32 v96, 20, v96
    v_and_or_b32 v124, v23, 3, s97
    v_xor_b32 v124, v98, v124
    v_lshl_add_u32 v124, v124, 4, s99
    v_mad_u32_u24 v124, v96, s98, v124
    s_cmp_lt_u32 s94, 7
    s_cselect_b32 s73, 28, 27
    s_mov_b32 s93, 1769472
    s_mul_i32 s54, s68, 5120
    s_cmp_ge_u32 s2, 248
    s_cbranch_scc1 L_bndF
L_bndrF:
    s_mov_b32 s63, 1180032
    s_mul_i32 s94, s69, 58255
    s_lshr_b32 s94, s94, 22
    s_mul_i32 s94, s94, s63
    s_mul_i32 s72, s69, s62
    s_add_u32 s72, s72, s94
    v_lshl_or_b32 v131, v97, 4, 2.0
    s_sub_u32 s94, s73, 1
    s_max_u32 s94, s94, 20
    s_mul_i32 s95, s68, -44
    s_movk_i32 s99, -24
    s_add_u32 m0, s54, 0
    v_and_b32 v23, -4, v15
    s_mul_i32 s85, s68, 96
    s_sub_u32 s100, s85, 1024
    buffer_load_dwordx4 v128, s[24:27], s72 offen nt lds
    s_add_u32 m0, s54, 1024
    v_mad_u32_u24 v4, v23, 3, v15
    v_add_u32 v4, s95, v4
    v_mad_i32_i24 v106, v15, s99, v14
    v_med3_u32 v23, v4, 20, s94
    v_add_u32 v23, s70, v23
    v_add_u32 v14, s69, v4
    s_sub_u32 s87, s85, 2048
    s_movk_i32 s91, 1152
    buffer_load_dwordx4 v127, s[24:27], s72 offen nt lds
    v_cmp_gt_u32 vcc, s71, v4
    v_lshl_add_u32 v106, v106, 4, s93
    s_add_u32 m0, s54, 43008
    v_cndmask_b32 v14, v23, v14, vcc
    v_mul_u32_u24 v23, 58255, v14
    v_mad_u32_u24 v106, v14, s62, v106
    v_lshrrev_b32 v23, 22, v23
    v_mad_u32_u24 v106, v23, s63, v106
    s_mul_i32 s90, s68, 3072
    s_add_u32 s90, s90, 61440
    buffer_load_dwordx4 v106, s[24:27], 0 offen  lds
    v_lshlrev_b32 v107, 16, v4
    s_add_u32 m0, s54, 2048
    v_and_b32 v4, -4, v51
    v_mad_u32_u24 v23, v4, 3, v51
    v_add_u32 v23, s95, v23
    v_mad_i32_i24 v105, v51, s99, v5
    v_med3_u32 v4, v23, 20, s94
    s_mov_b32 s28, s22
    s_mov_b32 s29, s23
    buffer_load_dwordx4 v126, s[24:27], s72 offen nt lds
    v_add_u32 v4, s70, v4
    v_add_u32 v51, s69, v23
    v_cmp_gt_u32 vcc, s71, v23
    v_lshl_add_u32 v105, v105, 4, s93
    s_add_u32 m0, s54, 41984
    v_cndmask_b32 v51, v4, v51, vcc
    v_mul_u32_u24 v4, 58255, v51
    v_mad_u32_u24 v105, v51, s62, v105
    v_lshrrev_b32 v4, 22, v4
    v_mad_u32_u24 v105, v4, s63, v105
    s_mov_b32 s41, 0x2a8cbccc
    s_mov_b32 s42, 0x38fba882
    buffer_load_dwordx4 v105, s[24:27], 0 offen  lds
    v_lshl_or_b32 v107, v23, 8, v107
    s_add_u32 m0, s54, 3072
    v_cmp_gt_u32 vcc, 32, v97
    v_and_b32 v51, -4, v39
    v_mad_u32_u24 v23, v51, 3, v39
    v_cndmask_b32 v124, v131, v124, vcc
    v_add_u32 v23, s95, v23
    s_mov_b32 s43, 0x415db3d7
    s_mov_b32 s30, 100270464
    buffer_load_dwordx4 v125, s[24:27], s72 offen nt lds
    s_add_u32 m0, s54, 4096
    v_mad_i32_i24 v104, v39, s99, v104
    v_med3_u32 v51, v23, 20, s94
    v_add_u32 v51, s70, v51
    v_add_u32 v39, s69, v23
    v_cmp_gt_u32 vcc, s71, v23
    v_lshl_add_u32 v104, v104, 4, s93
    s_add_u32 s101, s54, 44032
    s_mul_i32 s93, s68, 6
    buffer_load_dwordx4 v124, s[24:27], s72 offen nt lds
    v_cndmask_b32 v39, v51, v39, vcc
    v_mul_u32_u24 v51, 58255, v39
    v_mad_u32_u24 v104, v39, s62, v104
    v_lshrrev_b32 v51, 22, v51
    v_mad_u32_u24 v104, v51, s63, v104
    s_add_u32 m0, s54, 40960
    v_lshl_or_b32 v107, v23, 0, v107
    s_lshl_b32 s94, s97, 1
    s_mov_b32 s44, 61440
    buffer_load_dwordx4 v104, s[24:27], 0 offen nt lds
    v_mul_u32_u24 v4, 10923, v97
    v_lshrrev_b32 v5, 17, v4
    v_lshrrev_b32 v4, 16, v4
    v_mad_i32_i24 v23, v4, -6, v97
    v_bitop3_b32 v5, v5, v4, 4 bitop3:0x28
    v_lshl_add_u32 v23, v23, 4, s85
    v_mul_u32_u24 v5, 3, v5
    v_xor_b32 v4, v4, v5
    v_mad_u32_u24 v5, v4, s91, v23
    v_add_u32 v39, 64, v97
    v_mul_u32_u24 v23, 10923, v39
    v_lshrrev_b32 v4, 17, v23
    v_lshrrev_b32 v23, 16, v23
    v_mad_i32_i24 v39, v23, -6, v39
    v_bitop3_b32 v4, v4, v23, 4 bitop3:0x28
    v_lshl_add_u32 v39, v39, 4, s100
    v_mul_u32_u24 v4, 3, v4
    v_xor_b32 v23, v23, v4
    v_mad_u32_u24 v4, v23, s91, v39
    v_add_u32 v23, 128, v97
    v_mul_u32_u24 v39, 10923, v23
    v_lshrrev_b32 v33, 17, v39
    v_lshrrev_b32 v39, 16, v39
    v_mad_i32_i24 v23, v39, -6, v23
    v_bitop3_b32 v33, v33, v39, 4 bitop3:0x28
    v_lshl_add_u32 v23, v23, 4, s87
    v_mul_u32_u24 v33, 3, v33
    v_xor_b32 v39, v39, v33
    v_mad_u32_u24 v33, v39, s91, v23
    s_add_u32 m0, s90, 0
    s_mov_b32 s92, 0
    buffer_load_dwordx4 v5, s[32:35], s92 offen offset:0 lds
    v_lshrrev_b32 v39, 1, v139
    v_lshl_add_u32 v23, v139, 2, v37
    v_lshl_add_u32 v23, v39, 3, v23
    v_mul_u32_u24 v23, 96, v23
    v_add_u32 v23, s90, v23
    v_lshl_add_u32 v120, v36, 4, v23
    v_lshl_add_u32 v91, v36, 3, v23
    s_waitcnt lgkmcnt(0)
    s_sext_i32_i16 s84, s82
    s_ashr_i32 s85, s82, 16
    s_max_i32 s84, s84, s85
    s_sext_i32_i16 s85, s83
    s_max_i32 s84, s84, s85
    s_ashr_i32 s85, s83, 16
    s_max_i32 s84, s84, s85
    s_cmp_gt_i32 s84, 16492
    s_cbranch_scc1 L_slow
    s_lshl_b32 s84, s68, 4
    buffer_load_dwordx4 v4, s[32:35], s92 offen offset:1024 lds
    s_lshr_b64 s[82:83], s[82:83], s84
    s_lshl_b32 s82, s82, 16
    v_mov_b32 v15, s82
    v_min_f32 v15, 0x40930000, v15
    v_max_f32 v15, 0xc2c80000, v15
    v_mul_f32 v15, 0x3fb8aa3b, v15
    v_exp_f32 v15, v15
    s_mov_b32 s84, 0x41b8aa3b
    s_mov_b32 s45, 40960
    buffer_load_dwordx4 v33, s[32:35], s92 offen offset:2048 lds
    s_add_u32 m0, s90, 12288
    s_mov_b32 s92, 36864
    v_cvt_pk_bf16_f32 v15, v15, v15
    v_lshlrev_b32 v15, 16, v15
    v_mul_f32 v15, 0x4038aa3b, v15
    v_mov_b32 v14, 0
    v_readfirstlane_b32 s55, v15
    v_add_f32 v15, v15, v15
    v_mov_b32 v23, 0
    v_readfirstlane_b32 s52, v15
    v_mul_u32_u24 v39, 5120, v139
    v_add_u32 v39, v7, v39
    v_mov_b32 v90, 0xc138aa3b
    v_mul_u32_u24 v142, 48, v37
    v_lshl_add_u32 v142, v36, 2, v142
    v_mul_u32_u24 v15, 48, v139
    v_add_u32 v35, 0, v142
    v_mul_u32_u24 v7, 37, v35
    v_lshrrev_b32 v7, 10, v7
    v_mad_u32_u24 v35, v7, 24, v35
    v_add_u32 v35, s101, v35
    v_add_u32 v51, 16, v142
    v_mul_u32_u24 v7, 37, v51
    v_lshrrev_b32 v7, 10, v7
    v_mad_u32_u24 v51, v7, 24, v51
    v_add_u32 v51, s101, v51
    v_add_u32 v175, 32, v142
    v_mul_u32_u24 v7, 37, v175
    v_lshrrev_b32 v7, 10, v7
    v_mad_u32_u24 v175, v7, 24, v175
    v_add_u32 v175, s101, v175
    v_add_u32 v32, 0, v15
    v_mul_u32_u24 v7, 37, v32
    v_lshrrev_b32 v7, 10, v7
    v_mad_u32_u24 v32, v7, 24, v32
    v_add_u32 v34, 4, v15
    v_mul_u32_u24 v7, 37, v34
    v_lshrrev_b32 v7, 10, v7
    v_mad_u32_u24 v34, v7, 24, v34
    v_add_u32 v211, 8, v15
    v_mul_u32_u24 v7, 37, v211
    v_lshrrev_b32 v7, 10, v7
    v_mad_u32_u24 v211, v7, 24, v211
    v_add_u32 v195, 12, v15
    v_mul_u32_u24 v7, 37, v195
    v_lshrrev_b32 v7, 10, v7
    v_mad_u32_u24 v195, v7, 24, v195
    v_add_u32 v188, 16, v15
    v_mul_u32_u24 v7, 37, v188
    v_lshrrev_b32 v7, 10, v7
    v_mad_u32_u24 v188, v7, 24, v188
    v_add_u32 v189, 20, v15
    v_mul_u32_u24 v7, 37, v189
    v_lshrrev_b32 v7, 10, v7
    v_mad_u32_u24 v189, v7, 24, v189
    v_add_u32 v190, 24, v15
    v_mul_u32_u24 v7, 37, v190
    v_lshrrev_b32 v7, 10, v7
    v_mad_u32_u24 v190, v7, 24, v190
    v_add_u32 v191, 28, v15
    v_mul_u32_u24 v7, 37, v191
    v_lshrrev_b32 v7, 10, v7
    v_mad_u32_u24 v191, v7, 24, v191
    v_add_u32 v89, 32, v15
    v_mul_u32_u24 v7, 37, v89
    v_lshrrev_b32 v7, 10, v7
    v_mad_u32_u24 v89, v7, 24, v89
    v_add_u32 v209, 36, v15
    v_mul_u32_u24 v7, 37, v209
    v_lshrrev_b32 v7, 10, v7
    s_mov_b32 s46, 20480
    s_mov_b32 s47, 0
    buffer_load_dwordx4 v5, s[32:35], s92 offen offset:0 lds
    v_mad_u32_u24 v209, v7, 24, v209
    v_add_u32 v88, 40, v15
    v_mul_u32_u24 v7, 37, v88
    v_lshrrev_b32 v7, 10, v7
    v_mad_u32_u24 v88, v7, 24, v88
    v_add_u32 v7, 44, v15
    v_mul_u32_u24 v129, 37, v7
    s_mov_b32 s57, s72
    s_mov_b32 s58, 0
    buffer_load_dwordx4 v4, s[32:35], s92 offen offset:1024 lds
    s_waitcnt vmcnt(17)
    v_lshl_or_b32 v12, v13, 16, v12
    v_cmp_gt_u32 vcc, 16, v97
    v_mov_b32 v13, 0
    v_lshrrev_b32 v129, 10, v129
    v_cndmask_b32 v15, 0, v12, vcc
    v_cndmask_b32 v12, 0, v12, vcc
    v_mad_u32_u24 v7, v129, 24, v7
    v_mfma_f32_16x16x16_bf16 v[0:3], v[14:15], v[20:21], 0
    s_waitcnt vmcnt(15)
    s_mov_b32 s59, 0
    v_lshl_or_b32 v48, v6, 16, v48
    v_lshl_add_u32 v6, v139, 4, v142
    v_mfma_f32_16x16x16_bf16 v[8:11], v[12:13], v[20:21], 0
    s_mov_b32 s60, 0
    v_mul_u32_u24 v129, 37, v6
    v_lshrrev_b32 v129, 10, v129
    v_mfma_f32_16x16x16_bf16 v[16:19], v[12:13], v[22:23], 0
    s_waitcnt vmcnt(13)
    s_mov_b32 s65, -1
    buffer_load_dwordx4 v33, s[32:35], s92 offen offset:2048 lds
    v_lshl_or_b32 v49, v50, 16, v49
    v_max_f32 v0, 0, v0
    v_max_f32 v8, 0, v8
    s_add_u32 m0, s90, 24576
    s_mov_b32 s92, 73728
    v_max_f32 v9, 0, v9
    v_max_f32 v10, 0, v10
    v_max_f32 v11, 0, v11
    v_cvt_pk_bf16_f32 v8, v8, v9
    v_cvt_pk_bf16_f32 v9, v10, v11
    v_max_f32 v1, 0, v1
    v_max_f32 v2, 0, v2
    v_mfma_f32_16x16x16_bf16 v[12:15], v[48:49], v[8:9], 0
    s_mov_b32 s61, 1
    v_max_f32 v3, 0, v3
    v_cvt_pk_bf16_f32 v0, v0, v1
    v_cvt_pk_bf16_f32 v1, v2, v3
    v_max_f32 v16, 0, v16
    v_max_f32 v17, 0, v17
    v_mfma_f32_16x16x16_bf16 v[8:11], v[48:49], v[0:1], 0
    s_movk_i32 s4, 112
    v_max_f32 v18, 0, v18
    v_max_f32 v19, 0, v19
    v_cvt_pk_bf16_f32 v16, v16, v17
    v_cvt_pk_bf16_f32 v17, v18, v19
    v_cvt_pk_bf16_f32 v12, v12, v12
    v_lshlrev_b32 v12, 16, v12
    v_mfma_f32_16x16x16_bf16 v[0:3], v[48:49], v[16:17], 0
    s_mov_b32 s5, 0
    v_mul_f32 v12, 0xbfb8aa3b, v12
    v_cvt_pk_bf16_f32 v8, v8, v8
    v_exp_f32 v12, v12
    v_lshlrev_b32 v8, 16, v8
    v_add_f32 v12, 1.0, v12
    v_rcp_f32 v12, v12
    v_mul_f32 v8, 0xbfb8aa3b, v8
    v_cvt_pk_bf16_f32 v12, v12, v12
    v_lshlrev_b32 v12, 16, v12
    v_fma_f32 v12, v12, s84, v90
    s_mov_b32 s6, 0
    s_mov_b32 s12, 0
    ds_write_b32 v39, v12 offset:44032
    v_exp_f32 v8, v8
    v_cvt_pk_bf16_f32 v0, v0, v0
    v_add_f32 v8, 1.0, v8
    v_rcp_f32 v8, v8
    v_lshlrev_b32 v0, 16, v0
    v_cvt_pk_bf16_f32 v8, v8, v8
    v_lshlrev_b32 v8, 16, v8
    v_fma_f32 v8, v8, s84, v90
    s_mov_b32 s64, 3
    s_mov_b32 s10, 81924
    ds_write_b32 v39, v8 offset:44036
    v_mul_f32 v0, 0xbfb8aa3b, v0
    v_exp_f32 v0, v0
    v_mad_u32_u24 v6, v129, 24, v6
    v_add_f32 v0, 1.0, v0
    v_rcp_f32 v0, v0
    v_mov_b32 v129, 336
    v_cvt_pk_bf16_f32 v0, v0, v0
    v_lshlrev_b32 v0, 16, v0
    v_fma_f32 v0, v0, s84, v90
    s_mov_b32 s11, 0x20000
    s_mov_b32 s3, 0x00010001
    ds_write_b32 v39, v0 offset:44040
    v_cmp_gt_u32 vcc, 3, v139
    v_mov_b32 v90, 0x3f803f80
    v_and_b32 v39, 1, v97
    v_cndmask_b32 v6, v129, v6, vcc
    v_sub_u32 v6, s101, v6
    v_cmp_eq_u32 vcc, 0, v36
    v_lshlrev_b32 v39, 4, v39
    v_mov_b32 v129, 0x3f80
    v_cndmask_b32 v220, 0, v90, vcc
    v_cndmask_b32 v221, 0, v90, vcc
    v_cndmask_b32 v222, 0, v90, vcc
    v_cndmask_b32 v223, 0, v90, vcc
    v_lshlrev_b32 v39, v39, v129
    v_cmp_gt_u32 vcc, 2, v36
    v_mov_b32 v215, 0x44004400
    v_mov_b32 v138, 0xf149f2ca
    v_cndmask_b32 v216, 0, v39, vcc
    v_cndmask_b32 v218, 0, v39, vcc
    v_cmp_le_u32 vcc, 2, v36
    v_mul_u32_u24 v208, 5120, v37
    v_mad_u32_u24 v208, v36, s86, v208
    v_cndmask_b32 v217, 0, v39, vcc
    v_cndmask_b32 v219, 0, v39, vcc
    v_cmp_eq_u32 vcc, 0, v36
    v_and_b32 v210, 7, v38
    v_xor_b32 v39, v210, v139
    v_cndmask_b32 v212, 0, v215, vcc
    v_cmp_eq_u32 vcc, 1, v36
    v_lshl_add_u32 v90, v39, 4, v208
    v_xor_b32 v121, 64, v90
    v_cndmask_b32 v213, 0, v215, vcc
    v_cmp_eq_u32 vcc, 2, v36
    v_add_u32 v137, 40960, v90
    s_waitcnt lgkmcnt(0)
    s_barrier
    v_cndmask_b32 v214, 0, v215, vcc
    v_cmp_eq_u32 vcc, 3, v36
    v_xor_b32 v136, 64, v137
    v_add_u32 v208, 61440, v208
    v_cndmask_b32 v215, 0, v215, vcc
    v_add_u32 v39, s93, v139
    v_xor_b32 v39, v210, v39
    v_lshl_add_u32 v135, v39, 4, v208
    v_lshrrev_b32 v39, 1, v139
    v_add3_u32 v39, v39, s93, 4
    v_xor_b32 v39, v210, v39
    v_lshl_add_u32 v39, v39, 4, v208
    v_and_b32 v208, 1, v139
    v_lshl_add_u32 v134, v208, 3, v39
    v_lshlrev_b32 v39, 4, v97
    s_add_u32 s93, s54, 20480
    v_add_u32 v133, s93, v39
    v_add_u32 v129, 81920, v39
    s_lshr_b32 s93, s68, 1
    s_lshl_b32 s93, s93, 10
    s_add_u32 s93, s93, s94
    ds_read_b32 v210, v175
    v_add_u32 v130, s93, v129
    s_mul_i32 s93, s68, 7168
    s_add_u32 s93, s93, 135168
    v_mul_u32_u24 v208, 1792, v139
    v_add_u32 v39, s93, v208
    v_mul_u32_u24 v208, 112, v38
    v_add_u32 v38, v208, v39
    v_subrev_u32 v38, 28672, v38
    v_cmp_eq_u32 vcc, 0, v37
    v_add_u32 v208, 16, v39
    v_mov_b32 v123, 0
    v_cndmask_b32 v132, v131, v39, vcc
    v_cmp_eq_u32 vcc, 3, v36
    v_mov_b32 v122, 0
    v_sub_u32 v180, v175, v32
    v_cndmask_b32 v132, v132, v208, vcc
    v_mul_u32_u24 v208, 1792, v37
    v_lshl_add_u32 v208, v139, 3, v208
    v_lshl_add_u32 v208, v36, 1, v208
    v_add_u32 v208, s93, v208
    v_cmp_gt_u32 vcc, 3, v139
    s_add_u32 s93, s69, 1
    s_mul_i32 s94, s93, 58255
    buffer_load_dwordx4 v5, s[32:35], s92 offen offset:0 lds
    ds_read_b32 v180, v180 offset:336
    v_cndmask_b32 v131, v131, v208, vcc
    s_lshr_b32 s94, s94, 22
    s_mul_i32 s94, s94, s63
    s_mul_i32 s56, s93, s62
    s_add_u32 s56, s56, s94
    s_sub_u32 s93, s71, 1
    s_cmp_eq_u32 s68, 0
    s_cselect_b32 s13, s93, -1
    s_cmp_gt_u32 s73, 20
    s_cselect_b32 s13, s13, -1
    s_and_b32 s93, s2, -8
    s_sub_u32 s93, 81920, s93
    s_sub_u32 s8, s38, s93
    s_subb_u32 s9, s39, 0
    ds_read_b32 v208, v35
    v_sub_u32 v181, v175, v34
    v_sub_u32 v182, v175, v211
    v_sub_u32 v183, v175, v195
    v_sub_u32 v176, v175, v188
    v_sub_u32 v177, v175, v189
    buffer_load_dwordx4 v4, s[32:35], s92 offen offset:1024 lds
    ds_read_b32 v181, v181 offset:336
    v_sub_u32 v178, v175, v190
    v_sub_u32 v179, v175, v191
    v_sub_u32 v172, v175, v89
    v_sub_u32 v173, v175, v209
    v_sub_u32 v174, v175, v88
    ds_read_b32 v182, v182 offset:336
    buffer_load_dwordx4 v33, s[32:35], s92 offen offset:2048 lds
    s_add_u32 m0, s90, 36864
    s_mov_b32 s92, 110592
    v_sub_u32 v175, v175, v7
    v_sub_u32 v204, v35, v32
    ds_read_b32 v183, v183 offset:336
    v_sub_u32 v205, v35, v34
    v_sub_u32 v206, v35, v211
    v_sub_u32 v207, v35, v195
    v_sub_u32 v200, v35, v188
    v_sub_u32 v201, v35, v189
    ds_read_b32 v176, v176 offset:336
    v_sub_u32 v202, v35, v190
    v_sub_u32 v203, v35, v191
    v_sub_u32 v196, v35, v89
    v_sub_u32 v197, v35, v209
    v_sub_u32 v198, v35, v88
    ds_read_b32 v177, v177 offset:336
    buffer_load_dwordx4 v5, s[32:35], s92 offen offset:0 lds
    v_sub_u32 v199, v35, v7
    v_sub_u32 v192, v51, v32
    v_sub_u32 v193, v51, v34
    v_sub_u32 v194, v51, v211
    ds_read_b32 v178, v178 offset:336
    v_sub_u32 v195, v51, v195
    v_sub_u32 v188, v51, v188
    v_sub_u32 v189, v51, v189
    v_sub_u32 v190, v51, v190
    s_mov_b64 exec, 0
    s_cmp_eq_u32 s68, 2
    s_cbranch_scc1 L_pga
    s_cmp_eq_u32 s68, 3
    s_cbranch_scc1 L_pg2
    s_cmp_eq_u32 s68, 1
    s_cbranch_scc1 L_pg1
    s_branch L_pg0
L_prod:
    v_mbcnt_lo_u32_b32 v1, -1, 0
    v_mbcnt_hi_u32_b32 v1, -1, v1
    v_and_b32 v2, 15, v1
    v_lshrrev_b32 v3, 4, v1
    v_lshrrev_b32 v4, 2, v2
    v_and_b32 v5, 3, v2
    v_lshl_add_u32 v6, v4, 3, v5
    v_mul_u32_u24 v6, 384, v6
    s_lshr_b32 s85, s68, 1
    s_lshl1_add_u32 s84, s84, s85
    s_mul_i32 s85, s84, 12288
    v_add_u32 v6, s85, v6
    v_lshl_add_u32 v7, v3, 4, v6
    v_lshl_add_u32 v8, v3, 3, v6
    s_and_b32 s85, s68, 1
    s_mul_i32 s86, s85, 192
    s_sub_u32 s87, 192, s86
    s_mul_i32 s85, s85, 36
    s_add_u32 s85, s85, s84
    s_lshl_b32 s85, s85, 10
    v_lshl_add_u32 v18, v1, 4, s85
    v_mov_b32 v10, 0
    s_waitcnt lgkmcnt(0)
    s_mov_b32 s10, 73728
    s_mov_b32 s11, 0x20000
    s_mov_b32 s78, 73728
    s_mov_b32 s79, 0x20000
    buffer_load_dwordx4 v[20:23], v7, s[8:11], s86 offen offset:0
    buffer_load_dwordx2 v[36:37], v8, s[8:11], s86 offen offset:64
    buffer_load_dwordx4 v[24:27], v7, s[8:11], s86 offen offset:96
    buffer_load_dwordx2 v[38:39], v8, s[8:11], s86 offen offset:160
    buffer_load_dwordx4 v[28:31], v7, s[8:11], s87 offen offset:0
    buffer_load_dwordx2 v[40:41], v8, s[8:11], s87 offen offset:64
    buffer_load_dwordx4 v[32:35], v7, s[8:11], s87 offen offset:96
    buffer_load_dwordx2 v[42:43], v8, s[8:11], s87 offen offset:160
    buffer_load_dwordx4 v[44:47], v7, s[8:11], s86 offen offset:1536
    buffer_load_dwordx2 v[60:61], v8, s[8:11], s86 offen offset:1600
    buffer_load_dwordx4 v[48:51], v7, s[8:11], s86 offen offset:1632
    buffer_load_dwordx2 v[62:63], v8, s[8:11], s86 offen offset:1696
    buffer_load_dwordx4 v[52:55], v7, s[8:11], s87 offen offset:1536
    buffer_load_dwordx2 v[64:65], v8, s[8:11], s87 offen offset:1600
    buffer_load_dwordx4 v[56:59], v7, s[8:11], s87 offen offset:1632
    buffer_load_dwordx2 v[66:67], v8, s[8:11], s87 offen offset:1696
    s_add_u32 s88, s76, 0x18000
    s_addc_u32 s89, s77, 0
    global_load_dword v9, v10, s[88:89]
    global_load_dword v19, v10, s[38:39] offset:248 sc1
    v_mov_b32 v12, 0x3f803f80
    v_mov_b32 v13, 0x3f803f80
    v_mov_b32 v14, 0x3f803f80
    v_mov_b32 v15, 0x3f803f80
    v_and_b32 v10, 1, v1
    v_lshlrev_b32 v10, 4, v10
    v_mov_b32 v11, 0x3f80
    v_lshlrev_b32 v10, v10, v11
    v_cmp_eq_u32 vcc, v3, v4
    s_nop 1
    v_cndmask_b32 v10, 0, v10, vcc
    v_cmp_gt_u32 vcc, 2, v5
    s_nop 1
    v_cndmask_b32 v16, 0, v10, vcc
    v_cmp_le_u32 vcc, 2, v5
    s_nop 1
    v_cndmask_b32 v17, 0, v10, vcc
    s_waitcnt vmcnt(2)
    v_mfma_f32_16x16x32_bf16 v[68:71], v[20:23], v[12:15], 0
    v_mfma_f32_16x16x32_bf16 v[68:71], v[24:27], v[12:15], v[68:71]
    v_mfma_f32_16x16x32_bf16 v[68:71], v[28:31], v[12:15], v[68:71]
    v_mfma_f32_16x16x32_bf16 v[68:71], v[32:35], v[12:15], v[68:71]
    v_mfma_f32_16x16x32_bf16 v[68:71], v[36:39], v[12:15], v[68:71]
    v_mfma_f32_16x16x32_bf16 v[68:71], v[40:43], v[12:15], v[68:71]
    v_mfma_f32_16x16x32_bf16 v[72:75], v[44:47], v[12:15], 0
    v_mfma_f32_16x16x32_bf16 v[72:75], v[48:51], v[12:15], v[72:75]
    v_mfma_f32_16x16x32_bf16 v[72:75], v[52:55], v[12:15], v[72:75]
    v_mfma_f32_16x16x32_bf16 v[72:75], v[56:59], v[12:15], v[72:75]
    v_mfma_f32_16x16x32_bf16 v[72:75], v[60:63], v[12:15], v[72:75]
    v_mfma_f32_16x16x32_bf16 v[72:75], v[64:67], v[12:15], v[72:75]
    s_nop 1
    v_mul_f32 v68, 0xbbaaaaab, v68
    v_mul_f32 v69, 0xbbaaaaab, v69
    v_mul_f32 v70, 0xbbaaaaab, v70
    v_mul_f32 v71, 0xbbaaaaab, v71
    s_nop 1
    v_mfma_f32_16x16x16_bf16 v[76:79], v[20:21], v[16:17], v[68:71]
    v_mfma_f32_16x16x16_bf16 v[80:83], v[22:23], v[16:17], v[68:71]
    v_mfma_f32_16x16x16_bf16 v[84:87], v[36:37], v[16:17], v[68:71]
    v_mfma_f32_16x16x16_bf16 v[88:91], v[24:25], v[16:17], v[68:71]
    v_mfma_f32_16x16x16_bf16 v[92:95], v[26:27], v[16:17], v[68:71]
    v_mfma_f32_16x16x16_bf16 v[96:99], v[38:39], v[16:17], v[68:71]
    v_mul_f32 v72, 0xbbaaaaab, v72
    v_mul_f32 v73, 0xbbaaaaab, v73
    v_mul_f32 v74, 0xbbaaaaab, v74
    v_mul_f32 v75, 0xbbaaaaab, v75
    s_nop 1
    v_mfma_f32_16x16x16_bf16 v[100:103], v[44:45], v[16:17], v[72:75]
    v_mfma_f32_16x16x16_bf16 v[104:107], v[46:47], v[16:17], v[72:75]
    v_mfma_f32_16x16x16_bf16 v[108:111], v[60:61], v[16:17], v[72:75]
    v_mfma_f32_16x16x16_bf16 v[112:115], v[48:49], v[16:17], v[72:75]
    v_mfma_f32_16x16x16_bf16 v[116:119], v[50:51], v[16:17], v[72:75]
    v_mfma_f32_16x16x16_bf16 v[120:123], v[62:63], v[16:17], v[72:75]
    v_cvt_pk_bf16_f32 v124, v76, v77
    v_cvt_pk_bf16_f32 v125, v78, v79
    s_nop 0
    v_cvt_pk_bf16_f32 v126, v100, v101
    v_cvt_pk_bf16_f32 v127, v102, v103
    s_movk_i32 s85, 0
    buffer_store_dwordx4 v[124:127], v18, s[76:79], s85 offen sc1
    v_cvt_pk_bf16_f32 v128, v80, v81
    v_cvt_pk_bf16_f32 v129, v82, v83
    v_cvt_pk_bf16_f32 v130, v104, v105
    v_cvt_pk_bf16_f32 v131, v106, v107
    s_movk_i32 s85, 6144
    buffer_store_dwordx4 v[128:131], v18, s[76:79], s85 offen sc1
    v_cvt_pk_bf16_f32 v132, v84, v85
    v_cvt_pk_bf16_f32 v133, v86, v87
    v_cvt_pk_bf16_f32 v134, v108, v109
    v_cvt_pk_bf16_f32 v135, v110, v111
    s_movk_i32 s85, 12288
    buffer_store_dwordx4 v[132:135], v18, s[76:79], s85 offen sc1
    v_cvt_pk_bf16_f32 v136, v88, v89
    v_cvt_pk_bf16_f32 v137, v90, v91
    v_cvt_pk_bf16_f32 v138, v112, v113
    v_cvt_pk_bf16_f32 v139, v114, v115
    s_movk_i32 s85, 18432
    buffer_store_dwordx4 v[136:139], v18, s[76:79], s85 offen sc1
    v_cvt_pk_bf16_f32 v140, v92, v93
    v_cvt_pk_bf16_f32 v141, v94, v95
    v_cvt_pk_bf16_f32 v142, v116, v117
    v_cvt_pk_bf16_f32 v143, v118, v119
    s_movk_i32 s85, 24576
    buffer_store_dwordx4 v[140:143], v18, s[76:79], s85 offen sc1
    v_cvt_pk_bf16_f32 v144, v96, v97
    v_cvt_pk_bf16_f32 v145, v98, v99
    v_cvt_pk_bf16_f32 v146, v120, v121
    v_cvt_pk_bf16_f32 v147, v122, v123
    s_movk_i32 s85, 30720
    buffer_store_dwordx4 v[144:147], v18, s[76:79], s85 offen sc1
    v_mov_b32 v10, 0
    v_mov_b32 v11, 1
    s_mov_b32 s64, 8
    s_waitcnt vmcnt(0)
    s_barrier
    s_cmp_lg_u32 s68, 0
    s_cbranch_scc1 L_top2
    s_mov_b64 exec, 1
    global_atomic_add v10, v11, s[38:39] offset:248 sc1
    s_mov_b64 exec, -1
    s_branch L_top2
.p2align 12
L_main:
    s_mov_b64 exec, -1
    s_waitcnt vmcnt(10)
    s_barrier
    ds_read_b128 v[16:19], v90 offset:40960
    v_sub_u32 v191, v51, v191
    v_sub_u32 v184, v51, v89
    v_sub_u32 v185, v51, v209
    ds_read_b128 v[8:11], v90 offset:42496
    v_sub_u32 v186, v51, v88
    v_sub_u32 v187, v51, v7
    ds_read_b128 v[12:15], v90 offset:0
    ds_read_b128 v[0:3], v90 offset:1536
    buffer_load_dwordx4 v4, s[32:35], s92 offen offset:1024 lds
    ds_read_b128 v[40:43], v90 offset:3072
    ds_read_b32 v179, v179 offset:336
    ds_read_b32 v172, v172 offset:336
    ds_read_b32 v173, v173 offset:336
    buffer_load_dwordx4 v33, s[32:35], s92 offen offset:2048 lds
    s_add_u32 m0, s90, 49152
    s_mov_b32 s92, 147456
    ds_read_b32 v174, v174 offset:336
    ds_read_b32 v175, v175 offset:336
    ds_read_b32 v204, v204 offset:336
    buffer_load_dwordx4 v5, s[32:35], s92 offen offset:0 lds
    s_waitcnt vmcnt(10)
    ds_read_b64_tr_b16 a[0:1], v91 offset:0
    ds_read_b64_tr_b16 a[2:3], v91 offset:768
    ds_read_b64_tr_b16 a[24:25], v91 offset:32
    ds_read_b64_tr_b16 a[26:27], v91 offset:800
    ds_read_b64_tr_b16 a[48:49], v91 offset:64
    ds_read_b64_tr_b16 a[50:51], v91 offset:832
    ds_read_b32 v205, v205 offset:336
    ds_read_b32 v206, v206 offset:336
    buffer_load_dwordx4 v4, s[32:35], s92 offen offset:1024 lds
    ds_read_b32 v207, v207 offset:336
    ds_read_b32 v200, v200 offset:336
    ds_read_b32 v201, v201 offset:336
    s_waitcnt lgkmcnt(8)
    v_mfma_f32_16x16x32_bf16 v[76:79], a[0:3], v[16:19], 0
    s_waitcnt lgkmcnt(7)
    buffer_load_dwordx4 v33, s[32:35], s92 offen offset:2048 lds
    v_mfma_f32_16x16x32_bf16 v[68:71], a[24:27], v[16:19], 0
    s_waitcnt lgkmcnt(5)
    s_add_u32 m0, s90, 61440
    ds_read_b32 v202, v202 offset:336
    v_mfma_f32_16x16x32_bf16 v[56:59], a[48:51], v[16:19], 0
    s_mov_b32 s92, 184320
    v_mfma_f32_16x16x32_bf16 v[24:27], a[0:3], v[8:11], 0
    ds_read_b128 v[44:47], v121 offset:40960
    v_mfma_f32_16x16x32_bf16 v[16:19], a[24:27], v[8:11], 0
    ds_read_b32 v203, v203 offset:336
    v_mfma_f32_16x16x32_bf16 v[28:31], a[48:51], v[8:11], 0
    buffer_load_dwordx4 v5, s[32:35], s92 offen offset:0 lds
    v_mfma_f32_16x16x32_bf16 v[20:23], a[0:3], v[12:15], 0
    s_waitcnt vmcnt(10)
    ds_read_b64_tr_b16 a[4:5], v91 offset:12288
    v_mfma_f32_16x16x32_bf16 v[116:119], a[24:27], v[12:15], 0
    ds_read_b64_tr_b16 a[6:7], v91 offset:13056
    v_mfma_f32_16x16x32_bf16 v[8:11], a[48:51], v[12:15], 0
    ds_read_b64_tr_b16 a[28:29], v91 offset:12320
    v_mfma_f32_16x16x32_bf16 v[108:111], a[0:3], v[0:3], 0
    ds_read_b64_tr_b16 a[30:31], v91 offset:13088
    v_mfma_f32_16x16x32_bf16 v[60:63], a[24:27], v[0:3], 0
    buffer_load_dwordx4 v4, s[32:35], s92 offen offset:1024 lds
    ds_read_b64_tr_b16 a[52:53], v91 offset:12352
    v_mfma_f32_16x16x32_bf16 v[72:75], a[48:51], v[0:3], 0
    ds_read_b64_tr_b16 a[54:55], v91 offset:13120
    v_mfma_f32_16x16x32_bf16 v[92:95], a[0:3], v[40:43], 0
    ds_read_b128 v[12:15], v121 offset:42496
    v_mfma_f32_16x16x32_bf16 v[168:171], a[24:27], v[40:43], 0
    ds_read_b128 v[0:3], v121 offset:0
    v_mfma_f32_16x16x32_bf16 v[64:67], a[48:51], v[40:43], 0
    s_waitcnt lgkmcnt(6)
    ds_read_b128 v[52:55], v121 offset:1536
    buffer_load_dwordx4 v33, s[32:35], s92 offen offset:2048 lds
    s_add_u32 m0, s90, 0
    s_mov_b32 s92, 384
    v_mfma_f32_16x16x32_bf16 v[76:79], a[4:7], v[44:47], v[76:79]
    s_waitcnt lgkmcnt(5)
    ds_read_b128 v[40:43], v121 offset:3072
    ds_read_b32 v196, v196 offset:336
    v_mfma_f32_16x16x32_bf16 v[68:71], a[28:31], v[44:47], v[68:71]
    s_waitcnt lgkmcnt(5)
    ds_read_b32 v197, v197 offset:336
    v_mfma_f32_16x16x32_bf16 v[56:59], a[52:55], v[44:47], v[56:59]
    s_waitcnt vmcnt(9) lgkmcnt(5)
    buffer_load_dwordx4 v5, s[32:35], s92 offen offset:0 lds
    ds_read_b64_tr_b16 a[8:9], v91 offset:24576
    v_mfma_f32_16x16x32_bf16 v[24:27], a[4:7], v[12:15], v[24:27]
    ds_read_b64_tr_b16 a[10:11], v91 offset:25344
    v_mfma_f32_16x16x32_bf16 v[16:19], a[28:31], v[12:15], v[16:19]
    ds_read_b64_tr_b16 a[32:33], v91 offset:24608
    v_mfma_f32_16x16x32_bf16 v[28:31], a[52:55], v[12:15], v[28:31]
    s_waitcnt lgkmcnt(6)
    ds_read_b64_tr_b16 a[34:35], v91 offset:25376
    v_mfma_f32_16x16x32_bf16 v[20:23], a[4:7], v[0:3], v[20:23]
    ds_read_b64_tr_b16 a[56:57], v91 offset:24640
    v_mfma_f32_16x16x32_bf16 v[116:119], a[28:31], v[0:3], v[116:119]
    buffer_load_dwordx4 v4, s[32:35], s92 offen offset:1024 lds
    ds_read_b64_tr_b16 a[58:59], v91 offset:25408
    v_mfma_f32_16x16x32_bf16 v[8:11], a[52:55], v[0:3], v[8:11]
    ds_read_b128 v[44:47], v90 offset:41088
    v_mfma_f32_16x16x32_bf16 v[108:111], a[4:7], v[52:55], v[108:111]
    ds_read_b128 v[12:15], v90 offset:42624
    v_mfma_f32_16x16x32_bf16 v[60:63], a[28:31], v[52:55], v[60:63]
    ds_read_b128 v[0:3], v90 offset:128
    v_mfma_f32_16x16x32_bf16 v[72:75], a[52:55], v[52:55], v[72:75]
    s_waitcnt lgkmcnt(8)
    ds_read_b128 v[52:55], v90 offset:1664
    v_mfma_f32_16x16x32_bf16 v[92:95], a[4:7], v[40:43], v[92:95]
    buffer_load_dwordx4 v33, s[32:35], s92 offen offset:2048 lds
    ds_read_b32 v198, v198 offset:336
    v_mfma_f32_16x16x32_bf16 v[168:171], a[28:31], v[40:43], v[168:171]
    s_add_u32 m0, s90, 12288
    v_mfma_f32_16x16x32_bf16 v[64:67], a[52:55], v[40:43], v[64:67]
    s_mov_b32 s92, 37248
    ds_read_b128 v[40:43], v90 offset:3200
    ds_read_b32 v199, v199 offset:336
    ds_read_b32 v211, v6 offset:672
    s_waitcnt lgkmcnt(7)
    v_mfma_f32_16x16x32_bf16 v[76:79], a[8:11], v[44:47], v[76:79]
    buffer_load_dwordx4 v5, s[32:35], s92 offen offset:0 lds
    v_mfma_f32_16x16x32_bf16 v[68:71], a[32:35], v[44:47], v[68:71]
    s_waitcnt vmcnt(10)
    ds_read_b64_tr_b16 a[12:13], v91 offset:36864
    v_mfma_f32_16x16x32_bf16 v[56:59], a[56:59], v[44:47], v[56:59]
    s_waitcnt lgkmcnt(5)
    ds_read_b64_tr_b16 a[14:15], v91 offset:37632
    v_mfma_f32_16x16x32_bf16 v[24:27], a[8:11], v[12:15], v[24:27]
    ds_read_b64_tr_b16 a[36:37], v91 offset:36896
    v_mfma_f32_16x16x32_bf16 v[16:19], a[32:35], v[12:15], v[16:19]
    ds_read_b64_tr_b16 a[38:39], v91 offset:37664
    v_mfma_f32_16x16x32_bf16 v[28:31], a[56:59], v[12:15], v[28:31]
    buffer_load_dwordx4 v4, s[32:35], s92 offen offset:1024 lds
    ds_read_b64_tr_b16 a[60:61], v91 offset:36928
    v_mfma_f32_16x16x32_bf16 v[20:23], a[8:11], v[0:3], v[20:23]
    ds_read_b64_tr_b16 a[62:63], v91 offset:37696
    v_mfma_f32_16x16x32_bf16 v[116:119], a[32:35], v[0:3], v[116:119]
    ds_read_b128 v[12:15], v121 offset:41088
    v_mfma_f32_16x16x32_bf16 v[8:11], a[56:59], v[0:3], v[8:11]
    ds_read_b128 v[0:3], v121 offset:42624
    v_mfma_f32_16x16x32_bf16 v[108:111], a[8:11], v[52:55], v[108:111]
    ds_read_b128 v[44:47], v121 offset:128
    v_mfma_f32_16x16x32_bf16 v[60:63], a[32:35], v[52:55], v[60:63]
    buffer_load_dwordx4 v33, s[32:35], s92 offen offset:2048 lds
    ds_read_b32 v192, v192 offset:336
    v_mfma_f32_16x16x32_bf16 v[72:75], a[56:59], v[52:55], v[72:75]
    s_waitcnt lgkmcnt(8)
    s_add_u32 m0, s90, 24576
    v_mfma_f32_16x16x32_bf16 v[92:95], a[8:11], v[40:43], v[92:95]
    s_mov_b32 s92, 74112
    ds_read_b128 v[52:55], v121 offset:1664
    v_mfma_f32_16x16x32_bf16 v[168:171], a[32:35], v[40:43], v[168:171]
    ds_read_b32 v193, v193 offset:336
    v_mfma_f32_16x16x32_bf16 v[64:67], a[56:59], v[40:43], v[64:67]
    s_waitcnt vmcnt(9) lgkmcnt(5)
    buffer_load_dwordx4 v5, s[32:35], s92 offen offset:0 lds
    ds_read_b64_tr_b16 a[16:17], v91 offset:49152
    ds_read_b64_tr_b16 a[18:19], v91 offset:49920
    v_mfma_f32_16x16x32_bf16 v[76:79], a[12:15], v[12:15], v[76:79]
    ds_read_b64_tr_b16 a[40:41], v91 offset:49184
    v_mfma_f32_16x16x32_bf16 v[68:71], a[36:39], v[12:15], v[68:71]
    ds_read_b64_tr_b16 a[42:43], v91 offset:49952
    v_mfma_f32_16x16x32_bf16 v[56:59], a[60:63], v[12:15], v[56:59]
    s_waitcnt lgkmcnt(7)
    ds_read_b64_tr_b16 a[64:65], v91 offset:49216
    v_mfma_f32_16x16x32_bf16 v[24:27], a[12:15], v[0:3], v[24:27]
    ds_read_b64_tr_b16 a[66:67], v91 offset:49984
    buffer_load_dwordx4 v4, s[32:35], s92 offen offset:1024 lds
    v_mfma_f32_16x16x32_bf16 v[16:19], a[36:39], v[0:3], v[16:19]
    ds_read_b128 v[40:43], v121 offset:3200
    v_mfma_f32_16x16x32_bf16 v[28:31], a[60:63], v[0:3], v[28:31]
    ds_read_b128 v[12:15], v90 offset:41216
    v_mfma_f32_16x16x32_bf16 v[20:23], a[12:15], v[44:47], v[20:23]
    ds_read_b128 v[0:3], v90 offset:42752
    v_mfma_f32_16x16x32_bf16 v[116:119], a[36:39], v[44:47], v[116:119]
    ds_read_b32 v194, v194 offset:336
    v_mfma_f32_16x16x32_bf16 v[8:11], a[60:63], v[44:47], v[8:11]
    s_waitcnt lgkmcnt(8)
    buffer_load_dwordx4 v33, s[32:35], s92 offen offset:2048 lds
    v_mfma_f32_16x16x32_bf16 v[108:111], a[12:15], v[52:55], v[108:111]
    s_add_u32 m0, s90, 36864
    ds_read_b128 v[44:47], v90 offset:256
    v_mfma_f32_16x16x32_bf16 v[60:63], a[36:39], v[52:55], v[60:63]
    s_mov_b32 s92, 110976
    ds_read_b32 v195, v195 offset:336
    v_mfma_f32_16x16x32_bf16 v[72:75], a[60:63], v[52:55], v[72:75]
    s_waitcnt lgkmcnt(5)
    ds_read_b128 v[52:55], v90 offset:1792
    ds_read_b32 v188, v188 offset:336
    v_mfma_f32_16x16x32_bf16 v[92:95], a[12:15], v[40:43], v[92:95]
    buffer_load_dwordx4 v5, s[32:35], s92 offen offset:0 lds
    v_mfma_f32_16x16x32_bf16 v[168:171], a[36:39], v[40:43], v[168:171]
    s_waitcnt vmcnt(10)
    ds_read_b64_tr_b16 a[20:21], v91 offset:61440
    v_mfma_f32_16x16x32_bf16 v[64:67], a[60:63], v[40:43], v[64:67]
    s_waitcnt lgkmcnt(5)
    ds_read_b64_tr_b16 a[22:23], v91 offset:62208
    v_mfma_f32_16x16x32_bf16 v[76:79], a[16:19], v[12:15], v[76:79]
    ds_read_b64_tr_b16 a[44:45], v91 offset:61472
    v_mfma_f32_16x16x32_bf16 v[68:71], a[40:43], v[12:15], v[68:71]
    ds_read_b64_tr_b16 a[46:47], v91 offset:62240
    v_mfma_f32_16x16x32_bf16 v[56:59], a[64:67], v[12:15], v[56:59]
    buffer_load_dwordx4 v4, s[32:35], s92 offen offset:1024 lds
    ds_read_b64_tr_b16 a[68:69], v91 offset:61504
    v_mfma_f32_16x16x32_bf16 v[24:27], a[16:19], v[0:3], v[24:27]
    ds_read_b64_tr_b16 a[70:71], v91 offset:62272
    v_mfma_f32_16x16x32_bf16 v[16:19], a[40:43], v[0:3], v[16:19]
    ds_read_b128 v[40:43], v90 offset:3328
    v_mfma_f32_16x16x32_bf16 v[28:31], a[64:67], v[0:3], v[28:31]
    s_waitcnt lgkmcnt(7)
    ds_read_b128 v[0:3], v121 offset:41216
    v_mfma_f32_16x16x32_bf16 v[20:23], a[16:19], v[44:47], v[20:23]
    ds_read_b128 v[12:15], v121 offset:42752
    v_mfma_f32_16x16x32_bf16 v[116:119], a[40:43], v[44:47], v[116:119]
    buffer_load_dwordx4 v33, s[32:35], s92 offen offset:2048 lds
    ds_read_b32 v189, v189 offset:336
    v_mfma_f32_16x16x32_bf16 v[8:11], a[64:67], v[44:47], v[8:11]
    s_add_u32 m0, s90, 49152
    v_mfma_f32_16x16x32_bf16 v[108:111], a[16:19], v[52:55], v[108:111]
    s_mov_b32 s92, 147840
    ds_read_b128 v[44:47], v121 offset:256
    v_mfma_f32_16x16x32_bf16 v[60:63], a[40:43], v[52:55], v[60:63]
    ds_read_b32 v190, v190 offset:336
    v_mfma_f32_16x16x32_bf16 v[72:75], a[64:67], v[52:55], v[72:75]
    s_waitcnt vmcnt(9) lgkmcnt(5)
    ds_read_b128 v[52:55], v121 offset:1792
    buffer_load_dwordx4 v5, s[32:35], s92 offen offset:0 lds
    ds_read_b64_tr_b16 a[72:73], v91 offset:0
    v_mfma_f32_16x16x32_bf16 v[92:95], a[16:19], v[40:43], v[92:95]
    ds_read_b64_tr_b16 a[74:75], v91 offset:768
    v_mfma_f32_16x16x32_bf16 v[168:171], a[40:43], v[40:43], v[168:171]
    ds_read_b64_tr_b16 a[96:97], v91 offset:32
    v_mfma_f32_16x16x32_bf16 v[64:67], a[64:67], v[40:43], v[64:67]
    s_waitcnt lgkmcnt(7)
    ds_read_b64_tr_b16 a[98:99], v91 offset:800
    v_mfma_f32_16x16x32_bf16 v[76:79], a[20:23], v[0:3], v[76:79]
    ds_read_b64_tr_b16 a[120:121], v91 offset:64
    v_mfma_f32_16x16x32_bf16 v[68:71], a[44:47], v[0:3], v[68:71]
    s_nop 0
    ds_read_b64_tr_b16 a[122:123], v91 offset:832
    buffer_load_dwordx4 v4, s[32:35], s92 offen offset:1024 lds
    v_mfma_f32_16x16x32_bf16 v[56:59], a[68:71], v[0:3], v[56:59]
    s_nop 0
    ds_read_b128 v[40:43], v121 offset:3328
    v_cvt_pk_f16_f32 v156, v76, v77
    v_mfma_f32_16x16x32_bf16 v[24:27], a[20:23], v[12:15], v[24:27]
    ds_read_b128 v[0:3], v90 offset:40960
    v_cvt_pk_f16_f32 v157, v78, v79
    v_mfma_f32_16x16x32_bf16 v[16:19], a[44:47], v[12:15], v[16:19]
    ds_read_b32 v191, v191 offset:336
    v_pk_fma_f16 v232, v156, v156, s3
    v_mfma_f32_16x16x32_bf16 v[28:31], a[68:71], v[12:15], v[28:31]
    s_waitcnt lgkmcnt(8)
    v_pk_fmac_f16 v232, v157, v157
    v_cvt_pk_f16_f32 v158, v68, v69
    v_mfma_f32_16x16x32_bf16 v[20:23], a[20:23], v[44:47], v[20:23]
    buffer_load_dwordx4 v33, s[32:35], s92 offen offset:2048 lds
    ds_read_b128 v[12:15], v90 offset:42496
    v_mfma_f32_16x16x32_bf16 v[116:119], a[44:47], v[44:47], v[116:119]
    s_add_u32 m0, s90, 61440
    v_cvt_pk_f16_f32 v159, v70, v71
    v_pk_fmac_f16 v232, v158, v158
    v_mfma_f32_16x16x32_bf16 v[8:11], a[68:71], v[44:47], v[8:11]
    s_mov_b32 s92, 184704
    ds_read_b128 v[44:47], v90 offset:0
    v_pk_fmac_f16 v232, v159, v159
    v_mfma_f32_16x16x32_bf16 v[108:111], a[20:23], v[52:55], v[108:111]
    ds_read_b32 v184, v184 offset:336
    v_cvt_pk_f16_f32 v6, v56, v57
    v_mfma_f32_16x16x32_bf16 v[60:63], a[44:47], v[52:55], v[60:63]
    v_cvt_pk_f16_f32 v7, v58, v59
    v_pk_fmac_f16 v232, v6, v6
    v_mfma_f32_16x16x32_bf16 v[72:75], a[68:71], v[52:55], v[72:75]
    s_waitcnt vmcnt(9) lgkmcnt(5)
    ds_read_b64_tr_b16 a[76:77], v91 offset:12288
    buffer_load_dwordx4 v5, s[32:35], s92 offen offset:0 lds
    v_mfma_f32_16x16x32_bf16 v[92:95], a[20:23], v[40:43], v[92:95]
    ds_read_b64_tr_b16 a[78:79], v91 offset:13056
    v_pk_fmac_f16 v232, v7, v7
    v_mfma_f32_16x16x32_bf16 v[168:171], a[44:47], v[40:43], v[168:171]
    ds_read_b64_tr_b16 a[100:101], v91 offset:12320
    v_cvt_pk_f16_f32 v112, v24, v25
    v_mfma_f32_16x16x32_bf16 v[64:67], a[68:71], v[40:43], v[64:67]
    s_waitcnt lgkmcnt(6)
    ds_read_b64_tr_b16 a[102:103], v91 offset:13088
    v_cvt_pk_f16_f32 v113, v26, v27
    v_mfma_f32_16x16x32_bf16 v[164:167], a[72:75], v[0:3], 0
    ds_read_b64_tr_b16 a[124:125], v91 offset:12352
    v_pk_fma_f16 v234, v112, v112, s3
    v_mfma_f32_16x16x32_bf16 v[148:151], a[96:99], v[0:3], 0
    ds_read_b64_tr_b16 a[126:127], v91 offset:13120
    buffer_load_dwordx4 v4, s[32:35], s92 offen offset:1024 lds
    v_mfma_f32_16x16x32_bf16 v[40:43], a[120:123], v[0:3], 0
    s_waitcnt lgkmcnt(7)
    ds_read_b128 v[24:27], v90 offset:1536
    v_pk_fmac_f16 v234, v113, v113
    v_mfma_f32_16x16x32_bf16 v[84:87], a[72:75], v[12:15], 0
    ds_read_b128 v[236:239], v90 offset:3072
    v_cvt_pk_f16_f32 v114, v16, v17
    v_mfma_f32_16x16x32_bf16 v[100:103], a[96:99], v[12:15], 0
    ds_read_b128 v[0:3], v121 offset:40960
    v_cvt_pk_f16_f32 v115, v18, v19
    v_mfma_f32_16x16x32_bf16 v[80:83], a[120:123], v[12:15], 0
    ds_read_b128 v[12:15], v121 offset:42496
    v_pk_fmac_f16 v234, v114, v114
    v_mfma_f32_16x16x32_bf16 v[16:19], a[72:75], v[44:47], 0
    buffer_load_dwordx4 v33, s[32:35], s92 offen offset:2048 lds
    ds_read_b32 v185, v185 offset:336
    v_mfma_f32_16x16x32_bf16 v[228:231], a[96:99], v[44:47], 0
    s_add_u32 m0, s90, 0
    v_pk_fmac_f16 v234, v115, v115
    v_cvt_pk_f16_f32 v88, v28, v29
    v_mfma_f32_16x16x32_bf16 v[224:227], a[120:123], v[44:47], 0
    s_mov_b32 s92, 768
    ds_read_b128 v[144:147], v121 offset:0
    v_cvt_pk_f16_f32 v89, v30, v31
    v_pk_fmac_f16 v234, v88, v88
    v_pk_fmac_f16 v234, v89, v89
    v_cvt_pk_f16_f32 v28, v20, v21
    v_cvt_pk_f16_f32 v29, v22, v23
    v_pk_fma_f16 v160, v28, v28, s3
    v_pk_fmac_f16 v160, v29, v29
    v_cvt_pk_f16_f32 v30, v116, v117
    v_cvt_pk_f16_f32 v31, v118, v119
    v_pk_fmac_f16 v160, v30, v30
    s_waitcnt lgkmcnt(5)
    v_mfma_f32_16x16x32_bf16 v[252:255], a[72:75], v[24:27], 0
    s_waitcnt vmcnt(9)
    ds_read_b64_tr_b16 a[80:81], v91 offset:24576
    buffer_load_dwordx4 v5, s[32:35], s92 offen offset:0 lds
    v_mfma_f32_16x16x32_bf16 v[20:23], a[96:99], v[24:27], 0
    ds_read_b64_tr_b16 a[82:83], v91 offset:25344
    v_pk_fmac_f16 v160, v31, v31
    v_mfma_f32_16x16x32_bf16 v[76:79], a[120:123], v[24:27], 0
    s_waitcnt lgkmcnt(4)
    ds_read_b64_tr_b16 a[104:105], v91 offset:24608
    v_cvt_pk_f16_f32 v152, v8, v9
    v_mfma_f32_16x16x32_bf16 v[56:59], a[72:75], v[236:239], 0
    ds_read_b64_tr_b16 a[106:107], v91 offset:25376
    v_cvt_pk_f16_f32 v153, v10, v11
    v_mfma_f32_16x16x32_bf16 v[164:167], a[76:79], v[0:3], v[164:167]
    ds_read_b64_tr_b16 a[128:129], v91 offset:24640
    v_pk_fmac_f16 v160, v152, v152
    v_mfma_f32_16x16x32_bf16 v[148:151], a[100:103], v[0:3], v[148:151]
    ds_read_b64_tr_b16 a[130:131], v91 offset:25408
    buffer_load_dwordx4 v4, s[32:35], s92 offen offset:1024 lds
    v_mfma_f32_16x16x32_bf16 v[40:43], a[124:127], v[0:3], v[40:43]
    ds_read_b128 v[44:47], v121 offset:1536
    v_pk_fmac_f16 v160, v153, v153
    v_mfma_f32_16x16x32_bf16 v[52:55], a[96:99], v[236:239], 0
    ds_read_b128 v[0:3], v121 offset:3072
    v_cvt_pk_f16_f32 v24, v108, v109
    v_mfma_f32_16x16x32_bf16 v[68:71], a[120:123], v[236:239], 0
    ds_read_b128 v[8:11], v90 offset:41088
    v_cvt_pk_f16_f32 v25, v110, v111
    v_mfma_f32_16x16x32_bf16 v[84:87], a[76:79], v[12:15], v[84:87]
    ds_read_b32 v186, v186 offset:336
    v_pk_fma_f16 v162, v24, v24, s3
    v_mfma_f32_16x16x32_bf16 v[100:103], a[100:103], v[12:15], v[100:103]
    buffer_load_dwordx4 v33, s[32:35], s92 offen offset:2048 lds
    v_pk_fmac_f16 v162, v25, v25
    v_mfma_f32_16x16x32_bf16 v[80:83], a[124:127], v[12:15], v[80:83]
    s_waitcnt lgkmcnt(7)
    s_add_u32 m0, s90, 12288
    ds_read_b128 v[12:15], v90 offset:42624
    v_cvt_pk_f16_f32 v26, v60, v61
    v_mfma_f32_16x16x32_bf16 v[16:19], a[76:79], v[144:147], v[16:19]
    s_mov_b32 s92, 37632
    ds_read_b32 v187, v187 offset:336
    v_cvt_pk_f16_f32 v27, v62, v63
    v_mfma_f32_16x16x32_bf16 v[228:231], a[100:103], v[144:147], v[228:231]
    v_pk_fmac_f16 v162, v26, v26
    v_pk_fmac_f16 v162, v27, v27
    v_mfma_f32_16x16x32_bf16 v[224:227], a[124:127], v[144:147], v[224:227]
    s_waitcnt lgkmcnt(5)
    ds_read_b128 v[60:63], v90 offset:128
    v_cvt_pk_f16_f32 v146, v72, v73
    v_cvt_pk_f16_f32 v147, v74, v75
    v_mfma_f32_16x16x32_bf16 v[252:255], a[76:79], v[44:47], v[252:255]
    s_waitcnt vmcnt(9)
    ds_read_b64_tr_b16 a[84:85], v91 offset:36864
    buffer_load_dwordx4 v5, s[32:35], s92 offen offset:0 lds
    v_mfma_f32_16x16x32_bf16 v[20:23], a[100:103], v[44:47], v[20:23]
    ds_read_b64_tr_b16 a[86:87], v91 offset:37632
    v_pk_fmac_f16 v162, v146, v146
    v_mfma_f32_16x16x32_bf16 v[76:79], a[124:127], v[44:47], v[76:79]
    s_waitcnt lgkmcnt(5)
    ds_read_b64_tr_b16 a[108:109], v91 offset:36896
    v_pk_fmac_f16 v162, v147, v147
    v_mfma_f32_16x16x32_bf16 v[56:59], a[76:79], v[0:3], v[56:59]
    ds_read_b64_tr_b16 a[110:111], v91 offset:37664
    v_cvt_pk_f16_f32 v48, v92, v93
    v_mfma_f32_16x16x32_bf16 v[52:55], a[100:103], v[0:3], v[52:55]
    ds_read_b64_tr_b16 a[132:133], v91 offset:36928
    buffer_load_dwordx4 v4, s[32:35], s92 offen offset:1024 lds
    v_mfma_f32_16x16x32_bf16 v[68:71], a[124:127], v[0:3], v[68:71]
    ds_read_b64_tr_b16 a[134:135], v91 offset:37696
    v_cvt_pk_f16_f32 v49, v94, v95
    v_mfma_f32_16x16x32_bf16 v[164:167], a[80:83], v[8:11], v[164:167]
    ds_read_b128 v[44:47], v90 offset:1664
    v_pk_fma_f16 v32, v48, v48, s3
    v_mfma_f32_16x16x32_bf16 v[148:151], a[104:107], v[8:11], v[148:151]
    ds_read_b128 v[0:3], v90 offset:3200
    v_pk_fmac_f16 v32, v49, v49
    v_mfma_f32_16x16x32_bf16 v[40:43], a[128:131], v[8:11], v[40:43]
    s_waitcnt lgkmcnt(8)
    ds_read_b128 v[8:11], v121 offset:41088
    v_cvt_pk_f16_f32 v50, v168, v169
    v_mfma_f32_16x16x32_bf16 v[84:87], a[80:83], v[12:15], v[84:87]
    ds_read_b32 v209, v51
    buffer_load_dwordx4 v33, s[32:35], s92 offen offset:2048 lds
    v_mfma_f32_16x16x32_bf16 v[100:103], a[104:107], v[12:15], v[100:103]
    s_add_u32 m0, s90, 24576
    v_cvt_pk_f16_f32 v51, v170, v171
    v_pk_fmac_f16 v32, v50, v50
    v_mfma_f32_16x16x32_bf16 v[80:83], a[128:131], v[12:15], v[80:83]
    s_mov_b32 s92, 74496
    ds_read_b128 v[12:15], v121 offset:42624
    v_pk_fmac_f16 v32, v51, v51
    v_mfma_f32_16x16x32_bf16 v[16:19], a[80:83], v[60:63], v[16:19]
    v_cvt_pk_f16_f32 v140, v64, v65
    v_cvt_pk_f16_f32 v141, v66, v67
    v_pk_fmac_f16 v32, v140, v140
    v_pk_fmac_f16 v32, v141, v141
    v_mfma_f32_16x16x32_bf16 v[228:231], a[104:107], v[60:63], v[228:231]
    v_mov_b32 v34, 0
    v_mov_b32 v35, 0
    v_mfma_f32_16x16x32_bf16 v[224:227], a[128:131], v[60:63], v[224:227]
    s_waitcnt vmcnt(9) lgkmcnt(4)
    ds_read_b64_tr_b16 a[88:89], v91 offset:49152
    buffer_load_dwordx4 v5, s[32:35], s92 offen offset:0 lds
    v_mfma_f32_16x16x32_bf16 v[252:255], a[80:83], v[44:47], v[252:255]
    ds_read_b64_tr_b16 a[90:91], v91 offset:49920
    v_mfma_f32_16x16x32_bf16 v[20:23], a[104:107], v[44:47], v[20:23]
    ds_read_b64_tr_b16 a[112:113], v91 offset:49184
    v_mfma_f32_16x16x32_bf16 v[76:79], a[128:131], v[44:47], v[76:79]
    s_waitcnt lgkmcnt(4)
    ds_read_b64_tr_b16 a[114:115], v91 offset:49952
    v_mfma_f32_16x16x32_bf16 v[56:59], a[80:83], v[0:3], v[56:59]
    ds_read_b64_tr_b16 a[136:137], v91 offset:49216
    v_mfma_f32_16x16x32_bf16 v[52:55], a[104:107], v[0:3], v[52:55]
    ds_read_b64_tr_b16 a[138:139], v91 offset:49984
    buffer_load_dwordx4 v4, s[32:35], s92 offen offset:1024 lds
    v_mfma_f32_16x16x32_bf16 v[68:71], a[128:131], v[0:3], v[68:71]
    ds_read_b128 v[72:75], v121 offset:128
    v_mfma_f32_16x16x32_bf16 v[164:167], a[84:87], v[8:11], v[164:167]
    ds_read_b128 v[0:3], v121 offset:1664
    v_mfma_f32_16x16x32_bf16 v[148:151], a[108:111], v[8:11], v[148:151]
    ds_read_b128 v[64:67], v121 offset:3200
    v_mfma_f32_16x16x32_bf16 v[40:43], a[132:135], v[8:11], v[40:43]
    s_waitcnt lgkmcnt(8)
    ds_read_b128 v[8:11], v121 offset:41216
    v_mfma_f32_16x16x32_bf16 v[84:87], a[84:87], v[12:15], v[84:87]
    buffer_load_dwordx4 v33, s[32:35], s92 offen offset:2048 lds
    ds_read_b128 v[44:47], v121 offset:42752
    v_mfma_f32_16x16x32_bf16 v[100:103], a[108:111], v[12:15], v[100:103]
    s_add_u32 m0, s90, 36864
    s_cmp_ge_u32 s2, 248
    s_cbranch_scc1 L_maskF
L_nomaskF:
    v_mfma_f32_16x16x32_bf16 v[80:83], a[132:135], v[12:15], v[80:83]
    s_waitcnt lgkmcnt(4)
    s_mov_b32 s92, 111360
    ds_read_b128 v[12:15], v121 offset:256
    v_readlane_b32 s84, v211, 48
    v_cmp_gt_u32 vcc, 16, v97
    s_nop 0
    ds_read_b128 v[60:63], v121 offset:1792
    v_cndmask_b32 v208, v138, v208, vcc
    v_cndmask_b32 v209, v138, v209, vcc
    v_cndmask_b32 v210, v138, v210, vcc
    v_mfma_f32_16x16x32_bf16 v[16:19], a[84:87], v[72:75], v[16:19]
    s_waitcnt vmcnt(9)
    buffer_load_dwordx4 v5, s[32:35], s92 offen offset:0 lds
    ds_read_b64_tr_b16 a[92:93], v91 offset:61440
    v_mfma_f32_16x16x32_bf16 v[228:231], a[108:111], v[72:75], v[228:231]
    ds_read_b64_tr_b16 a[94:95], v91 offset:62208
    v_cmp_gt_u32 vcc, 49, v97
    v_mfma_f32_16x16x32_bf16 v[224:227], a[132:135], v[72:75], v[224:227]
    s_waitcnt lgkmcnt(6)
    ds_read_b64_tr_b16 a[116:117], v91 offset:61472
    v_cndmask_b32 v211, v138, v211, vcc
    v_mfma_f32_16x16x32_bf16 v[252:255], a[84:87], v[0:3], v[252:255]
    ds_read_b64_tr_b16 a[118:119], v91 offset:62240
    v_mfma_f32_16x16x32_bf16 v[20:23], a[108:111], v[0:3], v[20:23]
    ds_read_b64_tr_b16 a[140:141], v91 offset:61504
    v_mfma_f32_16x16x32_bf16 v[76:79], a[132:135], v[0:3], v[76:79]
    buffer_load_dwordx4 v4, s[32:35], s92 offen offset:1024 lds
    ds_read_b64_tr_b16 a[142:143], v91 offset:62272
    v_mfma_f32_16x16x32_bf16 v[56:59], a[84:87], v[64:67], v[56:59]
    ds_read_b128 v[0:3], v121 offset:3328
    v_mfma_f32_16x16x32_bf16 v[52:55], a[108:111], v[64:67], v[52:55]
    ds_read_b128 v[92:95], v90 offset:41216
    v_mfma_f32_16x16x32_bf16 v[68:71], a[132:135], v[64:67], v[68:71]
    ds_read_b128 v[72:75], v90 offset:42752
    ds_read_b128 v[64:67], v90 offset:256
    buffer_load_dwordx4 v33, s[32:35], s92 offen offset:2048 lds
    s_add_u32 m0, s90, 49152
    s_mov_b32 s92, 148224
    buffer_load_dwordx4 v5, s[32:35], s92 offen offset:0 lds
    s_waitcnt vmcnt(10)
    ds_read_b64_tr_b16 a[144:145], v120 offset:0
    s_waitcnt lgkmcnt(3)
    v_mfma_f32_16x16x32_bf16 v[164:167], a[88:91], v[92:95], v[164:167]
    ds_read_b64_tr_b16 a[146:147], v120 offset:768
    v_mfma_f32_16x16x32_bf16 v[164:167], a[92:95], v[8:11], v[164:167]
    ds_read_b64_tr_b16 a[168:169], v120 offset:8
    v_mfma_f32_16x16x32_bf16 v[148:151], a[112:115], v[92:95], v[148:151]
    ds_read_b64_tr_b16 a[170:171], v120 offset:776
    v_mfma_f32_16x16x32_bf16 v[148:151], a[116:119], v[8:11], v[148:151]
    ds_read_b64_tr_b16 a[192:193], v91 offset:64
    buffer_load_dwordx4 v4, s[32:35], s92 offen offset:1024 lds
    v_mfma_f32_16x16x32_bf16 v[40:43], a[136:139], v[92:95], v[40:43]
    ds_read_b64_tr_b16 a[194:195], v91 offset:832
    v_cvt_pk_f16_f32 v164, v164, v165
    v_mfma_f32_16x16x32_bf16 v[40:43], a[140:143], v[8:11], v[40:43]
    s_waitcnt lgkmcnt(6)
    ds_read_b128 v[8:11], v90 offset:1792
    v_cvt_pk_f16_f32 v165, v166, v167
    v_mfma_f32_16x16x32_bf16 v[84:87], a[88:91], v[72:75], v[84:87]
    v_pk_fma_f16 v233, v164, v164, s3
    v_pk_fmac_f16 v233, v165, v165
    v_mfma_f32_16x16x32_bf16 v[84:87], a[92:95], v[44:47], v[84:87]
    v_cvt_pk_f16_f32 v166, v148, v149
    v_cvt_pk_f16_f32 v167, v150, v151
    v_mfma_f32_16x16x32_bf16 v[100:103], a[112:115], v[72:75], v[100:103]
    v_pk_fmac_f16 v233, v166, v166
    v_pk_fmac_f16 v233, v167, v167
    v_mfma_f32_16x16x32_bf16 v[100:103], a[116:119], v[44:47], v[100:103]
    s_nop 0
    buffer_load_dwordx4 v33, s[32:35], s92 offen offset:2048 lds
    v_cvt_pk_f16_f32 v84, v84, v85
    v_mfma_f32_16x16x32_bf16 v[80:83], a[136:139], v[72:75], v[80:83]
    s_add_u32 m0, s90, 61440
    v_cvt_pk_f16_f32 v85, v86, v87
    v_pk_fma_f16 v235, v84, v84, s3
    v_mfma_f32_16x16x32_bf16 v[80:83], a[140:143], v[44:47], v[80:83]
    s_mov_b32 s92, 185088
    ds_read_b128 v[44:47], v90 offset:3328
    v_pk_fmac_f16 v235, v85, v85
    v_mfma_f32_16x16x32_bf16 v[16:19], a[88:91], v[64:67], v[16:19]
    v_cvt_pk_f16_f32 v86, v100, v101
    v_cvt_pk_f16_f32 v87, v102, v103
    v_mfma_f32_16x16x32_bf16 v[16:19], a[92:95], v[12:15], v[16:19]
    v_pk_fmac_f16 v235, v86, v86
    v_pk_fmac_f16 v235, v87, v87
    v_mfma_f32_16x16x32_bf16 v[228:231], a[112:115], v[64:67], v[228:231]
    s_waitcnt vmcnt(9)
    buffer_load_dwordx4 v5, s[32:35], s92 offen offset:0 lds
    ds_read_b64_tr_b16 a[148:149], v120 offset:12288
    v_mfma_f32_16x16x32_bf16 v[228:231], a[116:119], v[12:15], v[228:231]
    v_cvt_pk_f16_f32 v102, v80, v81
    v_cvt_pk_f16_f32 v103, v82, v83
    v_mfma_f32_16x16x32_bf16 v[224:227], a[136:139], v[64:67], v[224:227]
    ds_read_b64_tr_b16 a[150:151], v120 offset:13056
    v_pk_fmac_f16 v235, v102, v102
    v_mfma_f32_16x16x32_bf16 v[224:227], a[140:143], v[12:15], v[224:227]
    s_waitcnt lgkmcnt(3)
    ds_read_b64_tr_b16 a[172:173], v120 offset:12296
    v_pk_fmac_f16 v235, v103, v103
    v_mfma_f32_16x16x32_bf16 v[252:255], a[88:91], v[8:11], v[252:255]
    ds_read_b64_tr_b16 a[174:175], v120 offset:13064
    buffer_load_dwordx4 v4, s[32:35], s92 offen offset:1024 lds
    v_mfma_f32_16x16x32_bf16 v[252:255], a[92:95], v[60:63], v[252:255]
    ds_read_b64_tr_b16 a[196:197], v91 offset:12352
    v_cvt_pk_f16_f32 v12, v16, v17
    v_mfma_f32_16x16x32_bf16 v[20:23], a[112:115], v[8:11], v[20:23]
L_pg0:
    s_cbranch_execz L_main
    ds_read_b64_tr_b16 a[198:199], v91 offset:13120
    v_cvt_pk_f16_f32 v13, v18, v19
    v_mfma_f32_16x16x32_bf16 v[20:23], a[116:119], v[60:63], v[20:23]
    ds_read_b128 v[16:19], v90 offset:40960
    v_pk_fma_f16 v161, v12, v12, s3
    v_mfma_f32_16x16x32_bf16 v[76:79], a[136:139], v[8:11], v[76:79]
    ds_read_b128 v[8:11], v90 offset:0
    v_pk_fmac_f16 v161, v13, v13
    v_mfma_f32_16x16x32_bf16 v[76:79], a[140:143], v[60:63], v[76:79]
    s_waitcnt lgkmcnt(7)
    s_mov_b32 s53, s47
    ds_read_b128 v[80:83], v90 offset:1536
    buffer_load_dwordx4 v33, s[32:35], s92 offen offset:2048 lds
    v_mfma_f32_16x16x32_bf16 v[56:59], a[88:91], v[44:47], v[56:59]
    s_add_u32 m0, s54, 20480
    v_cvt_pk_f16_f32 v14, v228, v229
    v_cvt_pk_f16_f32 v15, v230, v231
    v_mfma_f32_16x16x32_bf16 v[56:59], a[92:95], v[0:3], v[56:59]
    s_mov_b32 s47, s46
    v_pk_fmac_f16 v161, v14, v14
    v_pk_fmac_f16 v161, v15, v15
    v_mfma_f32_16x16x32_bf16 v[52:55], a[112:115], v[44:47], v[52:55]
    s_mov_b32 s46, s45
    ds_read_b128 v[72:75], v90 offset:3072
    v_cvt_pk_f16_f32 v154, v224, v225
    v_mfma_f32_16x16x32_bf16 v[52:55], a[116:119], v[0:3], v[52:55]
    s_mov_b32 s45, s44
    v_cvt_pk_f16_f32 v155, v226, v227
    v_pk_fmac_f16 v161, v154, v154
    v_mfma_f32_16x16x32_bf16 v[68:71], a[136:139], v[44:47], v[68:71]
    s_mov_b32 s44, s53
    v_pk_fmac_f16 v161, v155, v155
    v_cvt_pk_f16_f32 v56, v56, v57
    v_mfma_f32_16x16x32_bf16 v[68:71], a[140:143], v[0:3], v[68:71]
    s_waitcnt vmcnt(9) lgkmcnt(3)
    s_sub_u32 s48, s44, s46
    ds_read_b64_tr_b16 a[152:153], v120 offset:24576
    buffer_load_dwordx4 v128, s[24:27], s56 offen nt lds
    v_cvt_pk_f16_f32 v57, v58, v59
    v_mfma_f32_16x16x32_bf16 v[0:3], a[144:147], v[16:19], 0
    s_add_u32 m0, s54, 21504
    ds_read_b64_tr_b16 a[154:155], v120 offset:25344
    v_pk_fma_f16 v33, v56, v56, s3
    v_mfma_f32_16x16x32_bf16 v[116:119], a[168:171], v[16:19], 0
    s_sub_u32 s49, s46, s45
    ds_read_b64_tr_b16 a[176:177], v120 offset:24584
    v_pk_fmac_f16 v33, v57, v57
    v_mfma_f32_16x16x32_bf16 v[44:47], a[192:195], v[16:19], 0
    s_waitcnt lgkmcnt(4)
    s_sub_u32 s50, s45, s44
    ds_read_b64_tr_b16 a[178:179], v120 offset:25352
    v_cvt_pk_f16_f32 v58, v52, v53
    v_mfma_f32_16x16x32_bf16 v[244:247], v[8:11], a[144:147], 0
    s_sub_u32 s51, s46, s47
    ds_read_b64_tr_b16 a[200:201], v91 offset:24640
    buffer_load_dwordx4 v127, s[24:27], s56 offen nt lds
    v_mfma_f32_16x16x32_bf16 v[16:19], v[8:11], a[168:171], 0
    s_add_u32 m0, s54, 22528
    ds_read_b64_tr_b16 a[202:203], v91 offset:25408
    v_cvt_pk_f16_f32 v59, v54, v55
    v_pk_fmac_f16 v33, v58, v58
    v_pk_fmac_f16 v33, v59, v59
    v_mfma_f32_16x16x32_bf16 v[240:243], v[8:11], a[192:195], 0
    s_mov_b32 s60, s59
    ds_read_b128 v[64:67], v121 offset:40960
    v_cvt_pk_f16_f32 v142, v68, v69
    v_mfma_f32_16x16x32_bf16 v[60:63], v[80:83], a[144:147], 0
    s_mov_b32 s59, s58
    ds_read_b128 v[8:11], v121 offset:0
    v_cvt_pk_f16_f32 v143, v70, v71
    v_pk_fmac_f16 v33, v142, v142
    v_pk_fmac_f16 v33, v143, v143
    v_cvt_pk_f16_f32 v150, v40, v41
    v_cvt_pk_f16_f32 v151, v42, v43
    v_mfma_f32_16x16x32_f16 v[40:43], v[212:215], v[32:35], 0
    s_mov_b32 s58, s57
    buffer_load_dwordx4 v126, s[24:27], s56 offen nt lds
    ds_read_b128 v[52:55], v121 offset:1536
    v_pk_fmac_f16 v233, v150, v150
    v_pk_fmac_f16 v233, v151, v151
    v_mfma_f32_16x16x32_bf16 v[68:71], v[80:83], a[168:171], 0
    s_add_u32 m0, s54, 23552
    ds_read_b128 v[32:35], v121 offset:3072
    v_add_u32 v137, s48, v137
    v_mfma_f32_16x16x32_bf16 v[108:111], v[80:83], a[192:195], 0
    s_waitcnt lgkmcnt(6)
    s_mov_b32 s57, s56
    v_add_u32 v136, s48, v136
    v_add_u32 v135, s49, v135
    v_mfma_f32_16x16x32_bf16 v[98:101], v[72:75], a[144:147], 0
    s_mov_b32 s7, s6
    v_add_u32 v134, s49, v134
    v_add_u32 v137, s50, v137
    v_mfma_f32_16x16x32_bf16 v[80:83], v[72:75], a[168:171], 0
    s_waitcnt vmcnt(9)
    s_mov_b32 s6, s5
    ds_read_b64_tr_b16 a[156:157], v120 offset:36864
    buffer_load_dwordx4 v125, s[24:27], s56 offen nt lds
    v_mfma_f32_16x16x32_bf16 v[236:239], v[72:75], a[192:195], 0
    s_waitcnt lgkmcnt(4)
    s_add_u32 m0, s54, 24576
    ds_read_b64_tr_b16 a[158:159], v120 offset:37632
    v_add_u32 v136, s50, v136
    v_mfma_f32_16x16x32_bf16 v[0:3], a[148:151], v[64:67], v[0:3]
    s_mov_b32 s5, s4
    ds_read_b64_tr_b16 a[180:181], v120 offset:36872
    v_add_u32 v135, s48, v135
    v_mfma_f32_16x16x32_bf16 v[116:119], a[172:175], v[64:67], v[116:119]
    s_sub_u32 s14, s6, s7
    ds_read_b64_tr_b16 a[182:183], v120 offset:37640
    v_add_u32 v134, s48, v134
    v_mfma_f32_16x16x32_bf16 v[44:47], a[196:199], v[64:67], v[44:47]
    s_waitcnt lgkmcnt(5)
    s_add_u32 s61, s61, 1
    ds_read_b64_tr_b16 a[204:205], v91 offset:36928
    v_add_u32 v133, s51, v133
    v_mfma_f32_16x16x32_bf16 v[244:247], v[8:11], a[148:151], v[244:247]
    s_add_u32 s12, s12, 20
    ds_read_b64_tr_b16 a[206:207], v91 offset:37696
    buffer_load_dwordx4 v124, s[24:27], s56 offen nt lds
    v_mfma_f32_16x16x32_bf16 v[16:19], v[8:11], a[172:175], v[16:19]
    s_max_u32 s12, s12, s61
    ds_read_b128 v[92:95], v90 offset:41088
    v_add_u32 v132, s14, v132
    v_mfma_f32_16x16x32_bf16 v[240:243], v[8:11], a[196:199], v[240:243]
    s_cmp_lt_u32 s61, s71
    ds_read_b128 v[64:67], v90 offset:128
    v_add_u32 v131, s14, v131
    v_mfma_f32_16x16x32_bf16 v[60:63], v[52:55], a[148:151], v[60:63]
    s_cselect_b32 s15, s61, s12
    ds_read_b128 v[168:171], v90 offset:1664
    v_cvt_pk_f16_f32 v8, v252, v253
    v_mfma_f32_16x16x32_bf16 v[68:71], v[52:55], a[172:175], v[68:71]
    s_cselect_b32 s56, s69, s70
    v_cvt_pk_f16_f32 v9, v254, v255
    v_pk_fma_f16 v163, v8, v8, s3
    v_mfma_f32_16x16x32_bf16 v[108:111], v[52:55], a[196:199], v[108:111]
    s_waitcnt lgkmcnt(7)
    s_add_u32 s56, s56, s15
    buffer_load_dword v96, v126, s[28:31], s72 offen nt
    ds_read_b128 v[72:75], v90 offset:3200
    v_mfma_f32_16x16x32_bf16 v[98:101], v[32:35], a[148:151], v[98:101]
    s_mul_i32 s53, s56, 58255
    v_pk_fmac_f16 v163, v9, v9
    v_cvt_pk_f16_f32 v10, v20, v21
    v_mfma_f32_16x16x32_bf16 v[80:83], v[32:35], a[172:175], v[80:83]
    s_lshr_b32 s53, s53, 22
    v_cvt_pk_f16_f32 v11, v22, v23
    v_pk_fmac_f16 v163, v10, v10
    v_mfma_f32_16x16x32_bf16 v[236:239], v[32:35], a[196:199], v[236:239]
    s_mul_i32 s53, s53, s63
    ds_read_b128 v[52:55], v121 offset:41088
    v_pk_fmac_f16 v163, v11, v11
    v_mfma_f32_16x16x32_f16 v[32:35], v[212:215], v[232:235], 0
    s_waitcnt lgkmcnt(4)
    s_mul_i32 s56, s56, s62
    v_cvt_pk_f16_f32 v148, v76, v77
    v_cvt_pk_f16_f32 v149, v78, v79
    v_pk_fmac_f16 v163, v148, v148
    v_mfma_f32_16x16x32_bf16 v[0:3], a[152:155], v[92:95], v[0:3]
    s_waitcnt vmcnt(9)
    s_add_u32 s56, s56, s53
    ds_read_b64_tr_b16 a[160:161], v120 offset:49152
    v_pk_fmac_f16 v163, v149, v149
    v_mfma_f32_16x16x32_bf16 v[116:119], a[176:179], v[92:95], v[116:119]
    s_mul_i32 s4, s15, 112
    ds_read_b64_tr_b16 a[162:163], v120 offset:49920
    v_or3_b32 v123, v123, v32, v33
    v_mfma_f32_16x16x32_bf16 v[44:47], a[200:203], v[92:95], v[44:47]
    s_waitcnt lgkmcnt(4)
    s_cmp_ge_u32 s15, 16
    ds_read_b64_tr_b16 a[184:185], v120 offset:49160
    v_or3_b32 v123, v123, v34, v35
    v_mfma_f32_16x16x32_bf16 v[244:247], v[64:67], a[152:155], v[244:247]
    s_cselect_b32 s53, -30464, 0
    ds_read_b64_tr_b16 a[186:187], v120 offset:49928
    v_mfma_f32_16x16x32_bf16 v[16:19], v[64:67], a[176:179], v[16:19]
    s_add_u32 s4, s4, s53
    ds_read_b64_tr_b16 a[208:209], v91 offset:49216
    v_mfma_f32_16x16x32_bf16 v[240:243], v[64:67], a[200:203], v[240:243]
    s_cmp_lt_u32 s15, s73
    ds_read_b64_tr_b16 a[210:211], v91 offset:49984
    v_mfma_f32_16x16x32_bf16 v[60:63], v[168:171], a[152:155], v[60:63]
    s_cselect_b32 s26, 100270464, 0
    ds_read_b128 v[92:95], v121 offset:128
    v_mfma_f32_16x16x32_bf16 v[68:71], v[168:171], a[176:179], v[68:71]
    s_cselect_b32 s56, s56, 0
    ds_read_b128 v[64:67], v121 offset:1664
    v_mfma_f32_16x16x32_bf16 v[108:111], v[168:171], a[200:203], v[108:111]
    s_waitcnt lgkmcnt(8)
    s_cselect_b32 s4, s4, -1
    ds_read_b128 v[224:227], v121 offset:3200
    v_mfma_f32_16x16x32_bf16 v[98:101], v[72:75], a[152:155], v[98:101]
    s_cselect_b32 s15, s15, 0
    v_rsq_f32 v32, v32
    v_mfma_f32_16x16x32_bf16 v[80:83], v[72:75], a[176:179], v[80:83]
    s_cselect_b32 s13, s13, -1
    v_rsq_f32 v33, v33
    v_mfma_f32_16x16x32_bf16 v[236:239], v[72:75], a[200:203], v[236:239]
    s_bitset1_b32 s64, s15
    ds_read_b128 v[168:171], v121 offset:41216
    v_mul_f32 v32, s52, v32
    v_mfma_f32_16x16x32_bf16 v[0:3], a[156:159], v[52:55], v[0:3]
    s_add_u32 s65, s65, 1
    ds_read_b128 v[20:23], v121 offset:256
    v_cvt_pk_f16_f32 v32, v32, v33
    v_mfma_f32_16x16x32_bf16 v[116:119], a[180:183], v[52:55], v[116:119]
    s_cmp_ge_i32 s65, 2
    ds_read_b128 v[72:75], v121 offset:1792
    v_pk_mul_f16 v156, v156, v32 op_sel:[0,0] op_sel_hi:[1,0]
    v_mfma_f32_16x16x32_bf16 v[44:47], a[204:207], v[52:55], v[44:47]
    s_cselect_b32 s30, 100270464, 0
    ds_read_b128 v[52:55], v121 offset:3328
    v_pk_mul_f16 v157, v157, v32 op_sel:[0,0] op_sel_hi:[1,0]
    v_mfma_f32_16x16x32_f16 v[76:79], v[212:215], v[160:163], 0
    s_waitcnt vmcnt(6) lgkmcnt(6)
    s_add_u32 s67, s46, s54
    ds_read_b64_tr_b16 a[164:165], v120 offset:61440
    v_pk_mul_f16 v158, v158, v32 op_sel:[0,0] op_sel_hi:[1,0]
    v_mfma_f32_16x16x32_bf16 v[244:247], v[92:95], a[156:159], v[244:247]
    ds_read_b64_tr_b16 a[166:167], v120 offset:62208
    v_pk_mul_f16 v159, v159, v32 op_sel:[0,0] op_sel_hi:[1,0]
    v_mfma_f32_16x16x32_bf16 v[16:19], v[92:95], a[180:183], v[16:19]
    ds_read_b64_tr_b16 a[188:189], v120 offset:61448
    v_pk_mul_f16 v6, v6, v32 op_sel:[0,0] op_sel_hi:[1,0]
    v_mfma_f32_16x16x32_bf16 v[240:243], v[92:95], a[204:207], v[240:243]
    s_waitcnt lgkmcnt(7)
    ds_read_b64_tr_b16 a[190:191], v120 offset:62216
    v_pk_mul_f16 v7, v7, v32 op_sel:[0,0] op_sel_hi:[1,0]
    v_mfma_f32_16x16x32_bf16 v[60:63], v[64:67], a[156:159], v[60:63]
    ds_read_b64_tr_b16 a[212:213], v91 offset:61504
    v_pk_mul_f16 v164, v164, v32 op_sel:[0,1] op_sel_hi:[1,1]
    v_mfma_f32_16x16x32_bf16 v[68:71], v[64:67], a[180:183], v[68:71]
    ds_read_b64_tr_b16 a[214:215], v91 offset:62272
    v_pk_mul_f16 v165, v165, v32 op_sel:[0,1] op_sel_hi:[1,1]
    v_mfma_f32_16x16x32_bf16 v[108:111], v[64:67], a[204:207], v[108:111]
    ds_read_b128 v[64:67], v90 offset:41216
    v_pk_mul_f16 v166, v166, v32 op_sel:[0,1] op_sel_hi:[1,1]
    v_mfma_f32_16x16x32_bf16 v[98:101], v[224:227], a[156:159], v[98:101]
    ds_read_b128 v[160:163], v90 offset:256
    v_pk_mul_f16 v167, v167, v32 op_sel:[0,1] op_sel_hi:[1,1]
    v_mfma_f32_16x16x32_bf16 v[80:83], v[224:227], a[180:183], v[80:83]
    ds_read_b128 v[92:95], v90 offset:1792
    v_pk_mul_f16 v150, v150, v32 op_sel:[0,1] op_sel_hi:[1,1]
    v_mfma_f32_16x16x32_bf16 v[236:239], v[224:227], a[204:207], v[236:239]
    v_rsq_f32 v34, v34
    v_rsq_f32 v35, v35
    v_mul_f32 v34, s52, v34
    v_cvt_pk_f16_f32 v34, v34, v35
    v_pk_mul_f16 v151, v151, v32 op_sel:[0,1] op_sel_hi:[1,1]
    v_fma_mix_f32 v138, v156, v164, 0 op_sel:[0,0,0] op_sel_hi:[1,1,0]
    v_fma_mix_f32 v138, v156, v164, v138 op_sel:[1,1,0] op_sel_hi:[1,1,0]
    v_fma_mix_f32 v138, v157, v165, v138 op_sel:[0,0,0] op_sel_hi:[1,1,0]
    v_fma_mix_f32 v138, v157, v165, v138 op_sel:[1,1,0] op_sel_hi:[1,1,0]
    v_fma_mix_f32 v138, v158, v166, v138 op_sel:[0,0,0] op_sel_hi:[1,1,0]
    v_fma_mix_f32 v138, v158, v166, v138 op_sel:[1,1,0] op_sel_hi:[1,1,0]
    v_fma_mix_f32 v138, v159, v167, v138 op_sel:[0,0,0] op_sel_hi:[1,1,0]
    v_fma_mix_f32 v138, v159, v167, v138 op_sel:[1,1,0] op_sel_hi:[1,1,0]
    v_fma_mix_f32 v138, v6, v150, v138 op_sel:[0,0,0] op_sel_hi:[1,1,0]
    v_fma_mix_f32 v138, v6, v150, v138 op_sel:[1,1,0] op_sel_hi:[1,1,0]
    v_fma_mix_f32 v138, v7, v151, v138 op_sel:[0,0,0] op_sel_hi:[1,1,0]
    v_fma_mix_f32 v138, v7, v151, v138 op_sel:[1,1,0] op_sel_hi:[1,1,0]
    v_mov_b32 v91, v138
    v_mov_b32 v144, 0
    v_mov_b32 v145, 0
    v_permlane32_swap_b32 v91, v138
    s_waitcnt lgkmcnt(1)
    v_mfma_f32_16x16x32_bf16 v[0:3], a[160:163], v[64:67], v[0:3]
    v_add_f32 v138, v91, v138
    v_mov_b32 v91, v138
    v_mfma_f32_16x16x32_bf16 v[0:3], a[164:167], v[168:171], v[0:3]
    s_nop 0
    v_permlane16_swap_b32 v91, v138
    v_mfma_f32_16x16x32_bf16 v[116:119], a[184:187], v[64:67], v[116:119]
    v_add_f32 v138, v91, v138
    v_add_f32 v138, s84, v138
    v_mfma_f32_16x16x32_bf16 v[116:119], a[188:191], v[168:171], v[116:119]
    v_exp_f32 v138, v138
    v_mfma_f32_16x16x32_bf16 v[44:47], a[208:211], v[64:67], v[44:47]
    s_mov_b32 s53, s47
    ds_read_b128 v[64:67], v90 offset:3328
    v_cvt_pk_bf16_f32 v138, v138, 0
    v_mfma_f32_16x16x32_bf16 v[44:47], a[212:215], v[168:171], v[44:47]
    s_mov_b32 s47, s46
    v_cmp_gt_u32 vcc, 16, v97
    v_mov_b32 v139, 0
    v_mfma_f32_16x16x32_bf16 v[244:247], v[160:163], a[160:163], v[244:247]
    s_mov_b32 s46, s45
    v_cndmask_b32 v138, 0, v138, vcc
    v_add_u32 v91, 28672, v38
    v_mfma_f32_16x16x32_bf16 v[244:247], v[20:23], a[164:167], v[244:247]
    s_mov_b32 s45, s44
    ds_write_b128 v91, v[164:167]
    v_mfma_f32_16x16x32_bf16 v[16:19], v[160:163], a[184:187], v[16:19]
    s_sub_u32 s49, s46, s45
    v_cvt_pk_bf16_f32 v42, v0, v1
    v_cvt_pk_bf16_f32 v43, v2, v3
    v_mfma_f32_16x16x32_bf16 v[16:19], v[20:23], a[188:191], v[16:19]
    s_mov_b32 s44, s53
    v_cvt_pk_bf16_f32 v0, v244, v245
    v_cvt_pk_bf16_f32 v1, v246, v247
    v_mfma_f32_16x16x32_bf16 v[240:243], v[160:163], a[208:211], v[240:243]
    s_sub_u32 s48, s44, s46
    ds_write2_b64 v91, v[144:145], v[144:145] offset0:2 offset1:3
    v_mfma_f32_16x16x32_bf16 v[240:243], v[20:23], a[212:215], v[240:243]
    s_waitcnt lgkmcnt(2)
    s_mul_i32 s93, s68, 18432
    v_cvt_pk_bf16_f32 v20, v16, v17
    v_cvt_pk_bf16_f32 v21, v18, v19
    v_mfma_f32_16x16x32_bf16 v[60:63], v[92:95], a[160:163], v[60:63]
    s_movk_i32 s92, 0
    v_cvt_pk_bf16_f32 v16, v116, v117
    v_cvt_pk_bf16_f32 v17, v118, v119
    v_mfma_f32_16x16x32_bf16 v[60:63], v[72:75], a[164:167], v[60:63]
    s_nop 0
    ds_write_b128 v91, v[156:159] offset:32
    v_mfma_f32_16x16x32_bf16 v[68:71], v[92:95], a[184:187], v[68:71]
    s_nop 0
    v_cvt_pk_bf16_f32 v4, v240, v241
    v_cvt_pk_bf16_f32 v5, v242, v243
    v_mfma_f32_16x16x32_bf16 v[68:71], v[72:75], a[188:191], v[68:71]
    s_nop 0
    v_cvt_pk_bf16_f32 v2, v60, v61
    v_cvt_pk_bf16_f32 v3, v62, v63
    v_mfma_f32_16x16x32_bf16 v[108:111], v[92:95], a[208:211], v[108:111]
    s_nop 0
    ds_write2_b64 v91, v[150:151], v[144:145] offset0:6 offset1:7
    v_mfma_f32_16x16x32_bf16 v[108:111], v[72:75], a[212:215], v[108:111]
    s_nop 0
    v_cvt_pk_bf16_f32 v22, v68, v69
    v_cvt_pk_bf16_f32 v23, v70, v71
    v_mfma_f32_16x16x32_bf16 v[98:101], v[64:67], a[160:163], v[98:101]
    v_mov_b32 v171, 0
    v_mov_b32 v167, 0
    v_mfma_f32_16x16x32_bf16 v[98:101], v[52:55], a[164:167], v[98:101]
    ds_write2_b64 v91, v[144:145], v[6:7] offset0:8 offset1:9
    v_mfma_f32_16x16x32_bf16 v[80:83], v[64:67], a[184:187], v[80:83]
    v_cvt_pk_bf16_f32 v6, v108, v109
    v_cvt_pk_bf16_f32 v7, v110, v111
    v_mfma_f32_16x16x32_bf16 v[80:83], v[52:55], a[188:191], v[80:83]
    v_mov_b32 v163, 0
    v_mov_b32 v159, 0
    v_mfma_f32_16x16x32_bf16 v[236:239], v[64:67], a[208:211], v[236:239]
    ds_write_b64 v91, v[138:139] offset:88
    v_mfma_f32_16x16x32_bf16 v[236:239], v[52:55], a[212:215], v[236:239]
    global_load_dword v120, v122, s[38:39] offset:248 sc1
    v_mov_b32 v150, 0
    v_mov_b32 v151, 0
    v_mov_b32 v144, 0
    v_mov_b32 v145, 0
    v_mov_b32 v138, 0
    v_mov_b32 v139, 0
    v_cvt_pk_bf16_f32 v18, v44, v45
    v_cvt_pk_bf16_f32 v19, v46, v47
    ds_write_b64 v38, v[42:43] offset:28752
    v_or3_b32 v123, v123, v76, v77
    v_rsq_f32 v76, v76
    v_rsq_f32 v77, v77
    ds_write_b128 v38, v[16:19] offset:28768
    v_mul_f32 v76, s52, v76
    v_cvt_pk_f16_f32 v76, v76, v77
    v_or3_b32 v123, v123, v78, v79
    v_or3_b32 v123, v123, v40, v41
    v_rsq_f32 v40, v40
    v_rsq_f32 v41, v41
    ds_read_b128 v[68:71], v132 offset:0
    v_mul_f32 v40, s52, v40
    v_cvt_pk_f16_f32 v40, v40, v41
    v_pk_mul_f16 v56, v56, v40 op_sel:[0,1] op_sel_hi:[1,1]
    ds_read_b128 v[60:63], v132 offset:16
    v_pk_mul_f16 v57, v57, v40 op_sel:[0,1] op_sel_hi:[1,1]
    v_pk_mul_f16 v58, v58, v40 op_sel:[0,1] op_sel_hi:[1,1]
    v_pk_mul_f16 v59, v59, v40 op_sel:[0,1] op_sel_hi:[1,1]
    ds_read_b128 v[16:19], v132 offset:48
    v_pk_mul_f16 v142, v142, v40 op_sel:[0,1] op_sel_hi:[1,1]
    v_pk_mul_f16 v143, v143, v40 op_sel:[0,1] op_sel_hi:[1,1]
    v_pk_mul_f16 v48, v48, v40 op_sel:[0,0] op_sel_hi:[1,0]
    v_pk_mul_f16 v49, v49, v40 op_sel:[0,0] op_sel_hi:[1,0]
    v_pk_mul_f16 v50, v50, v40 op_sel:[0,0] op_sel_hi:[1,0]
    v_pk_mul_f16 v51, v51, v40 op_sel:[0,0] op_sel_hi:[1,0]
    v_pk_mul_f16 v140, v140, v40 op_sel:[0,0] op_sel_hi:[1,0]
    v_pk_mul_f16 v141, v141, v40 op_sel:[0,0] op_sel_hi:[1,0]
    v_rsq_f32 v78, v78
    v_rsq_f32 v79, v79
    v_mul_f32 v78, s52, v78
    v_cvt_pk_f16_f32 v78, v78, v79
    v_pk_mul_f16 v12, v12, v76 op_sel:[0,1] op_sel_hi:[1,1]
    v_pk_mul_f16 v13, v13, v76 op_sel:[0,1] op_sel_hi:[1,1]
    v_pk_mul_f16 v14, v14, v76 op_sel:[0,1] op_sel_hi:[1,1]
    v_pk_mul_f16 v15, v15, v76 op_sel:[0,1] op_sel_hi:[1,1]
    v_pk_mul_f16 v154, v154, v76 op_sel:[0,1] op_sel_hi:[1,1]
    v_pk_mul_f16 v155, v155, v76 op_sel:[0,1] op_sel_hi:[1,1]
    v_pk_mul_f16 v28, v28, v76 op_sel:[0,0] op_sel_hi:[1,0]
    v_pk_mul_f16 v29, v29, v76 op_sel:[0,0] op_sel_hi:[1,0]
    v_pk_mul_f16 v30, v30, v76 op_sel:[0,0] op_sel_hi:[1,0]
    v_pk_mul_f16 v31, v31, v76 op_sel:[0,0] op_sel_hi:[1,0]
    v_pk_mul_f16 v152, v152, v76 op_sel:[0,0] op_sel_hi:[1,0]
    v_pk_mul_f16 v153, v153, v76 op_sel:[0,0] op_sel_hi:[1,0]
    v_mfma_f32_16x16x32_f16 v[52:55], v[12:15], v[28:31], v[204:207]
    ds_read_b128 v[232:235], v90 offset:42496
    v_pk_mul_f16 v8, v8, v78 op_sel:[0,1] op_sel_hi:[1,1]
    v_mfma_f32_16x16x32_f16 v[52:55], v[152:155], v[150:153], v[52:55]
    ds_read_b128 v[228:231], v121 offset:42496
    v_pk_mul_f16 v9, v9, v78 op_sel:[0,1] op_sel_hi:[1,1]
    v_mfma_f32_16x16x32_f16 v[44:47], v[56:59], v[28:31], v[196:199]
    ds_read_b128 v[224:227], v90 offset:42624
    v_pk_mul_f16 v10, v10, v78 op_sel:[0,1] op_sel_hi:[1,1]
    v_mfma_f32_16x16x32_f16 v[44:47], v[140:143], v[150:153], v[44:47]
    s_waitcnt lgkmcnt(3)
    ds_read_b128 v[116:119], v121 offset:42624
    v_pk_mul_f16 v11, v11, v78 op_sel:[0,1] op_sel_hi:[1,1]
    v_mfma_f32_16x16x32_f16 v[40:43], v[68:71], v[28:31], v[208:211]
    s_add_u32 m0, s67, 0
    ds_read_b128 v[108:111], v90 offset:42752
    v_pk_mul_f16 v148, v148, v78 op_sel:[0,1] op_sel_hi:[1,1]
    v_mfma_f32_16x16x32_f16 v[40:43], v[60:63], v[12:15], v[40:43]
    ds_read_b128 v[92:95], v121 offset:42752
    v_pk_mul_f16 v149, v149, v78 op_sel:[0,1] op_sel_hi:[1,1]
    v_mfma_f32_16x16x32_f16 v[40:43], v[16:19], v[152:155], v[40:43]
    v_pk_mul_f16 v24, v24, v78 op_sel:[0,0] op_sel_hi:[1,0]
    v_pk_mul_f16 v25, v25, v78 op_sel:[0,0] op_sel_hi:[1,0]
    v_pk_mul_f16 v26, v26, v78 op_sel:[0,0] op_sel_hi:[1,0]
    v_pk_mul_f16 v27, v27, v78 op_sel:[0,0] op_sel_hi:[1,0]
    v_pk_mul_f16 v146, v146, v78 op_sel:[0,0] op_sel_hi:[1,0]
    v_pk_mul_f16 v147, v147, v78 op_sel:[0,0] op_sel_hi:[1,0]
    v_mfma_f32_16x16x32_f16 v[64:67], v[8:11], v[28:31], v[200:203]
    v_cvt_pk_bf16_f32 v164, v98, v99
    v_cvt_pk_bf16_f32 v165, v100, v101
    v_mfma_f32_16x16x32_f16 v[64:67], v[146:149], v[150:153], v[64:67]
    s_waitcnt lgkmcnt(5)
    v_cvt_pk_bf16_f32 v160, v80, v81
    v_cvt_pk_bf16_f32 v161, v82, v83
    v_mfma_f32_16x16x32_bf16 v[72:75], a[144:147], v[232:235], 0
    s_waitcnt lgkmcnt(4)
    v_cvt_pk_bf16_f32 v156, v236, v237
    v_cvt_pk_bf16_f32 v157, v238, v239
    v_mfma_f32_16x16x32_bf16 v[72:75], a[148:151], v[228:231], v[72:75]
    s_waitcnt lgkmcnt(3)
    v_exp_f32 v52, v52
    v_mfma_f32_16x16x32_bf16 v[72:75], a[152:155], v[224:227], v[72:75]
    s_waitcnt lgkmcnt(2)
    v_exp_f32 v53, v53
    v_mfma_f32_16x16x32_bf16 v[72:75], a[156:159], v[116:119], v[72:75]
    s_waitcnt vmcnt(1) lgkmcnt(0)
    v_exp_f32 v54, v54
    v_mfma_f32_16x16x32_bf16 v[72:75], a[160:163], v[108:111], v[72:75]
    s_barrier
    buffer_load_dwordx4 v128, s[24:27], s56 offen nt lds
    v_cvt_pk_bf16_f32 v52, v52, v53
    v_mfma_f32_16x16x32_bf16 v[72:75], a[164:167], v[92:95], v[72:75]
    s_add_u32 m0, s67, 1024
    v_exp_f32 v55, v55
    v_mfma_f32_16x16x32_bf16 v[28:31], a[168:171], v[232:235], 0
    s_nop 0
    v_cvt_pk_bf16_f32 v53, v54, v55
    v_add_u32 v137, s48, v137
    v_mfma_f32_16x16x32_bf16 v[28:31], a[172:175], v[228:231], v[28:31]
    s_nop 0
    v_cvt_pk_bf16_f32 v90, v72, v73
    v_cvt_pk_bf16_f32 v91, v74, v75
    v_mfma_f32_16x16x32_bf16 v[28:31], a[176:179], v[224:227], v[28:31]
    v_exp_f32 v64, v64
    v_mfma_f32_16x16x32_bf16 v[28:31], a[180:183], v[116:119], v[28:31]
    buffer_load_dwordx4 v127, s[24:27], s56 offen nt lds
    v_add_u32 v136, s48, v136
    v_mfma_f32_16x16x32_bf16 v[28:31], a[184:187], v[108:111], v[28:31]
    s_add_u32 m0, s67, 2048
    v_exp_f32 v65, v65
    v_mfma_f32_16x16x32_bf16 v[28:31], a[188:191], v[92:95], v[28:31]
    ds_read_u16 v166, v131 offset:80
    v_cvt_pk_bf16_f32 v54, v64, v65
    v_mfma_f32_16x16x32_bf16 v[72:75], a[192:195], v[232:235], 0
    ds_read_u16 v162, v131 offset:96
    v_lshl_add_u32 v121, v97, 4, s93
    v_mfma_f32_16x16x32_bf16 v[72:75], a[196:199], v[228:231], v[72:75]
    s_mov_b32 s93, 0
    ds_read_u16 v158, v131 offset:104
    v_cvt_pk_bf16_f32 v76, v28, v29
    v_mfma_f32_16x16x32_bf16 v[72:75], a[200:203], v[224:227], v[72:75]
    buffer_load_dwordx4 v126, s[24:27], s56 offen nt lds
    v_cvt_pk_bf16_f32 v77, v30, v31
    v_mfma_f32_16x16x32_bf16 v[72:75], a[204:207], v[116:119], v[72:75]
    s_add_u32 m0, s67, 3072
    v_exp_f32 v66, v66
    v_mfma_f32_16x16x32_bf16 v[72:75], a[208:211], v[108:111], v[72:75]
    v_exp_f32 v67, v67
    v_mfma_f32_16x16x32_bf16 v[72:75], a[212:215], v[92:95], v[72:75]
    s_nop 0
    v_exp_f32 v44, v44
    v_mfma_f32_16x16x32_f16 v[28:31], v[68:71], v[24:27], v[208:211]
    s_nop 0
    v_exp_f32 v45, v45
    v_mfma_f32_16x16x32_f16 v[28:31], v[60:63], v[8:11], v[28:31]
    s_nop 0
    buffer_load_dwordx4 v125, s[24:27], s56 offen nt lds
    v_cvt_pk_bf16_f32 v78, v72, v73
    v_mfma_f32_16x16x32_f16 v[28:31], v[16:19], v[146:149], v[28:31]
    s_add_u32 m0, s67, 4096
    v_cvt_pk_bf16_f32 v79, v74, v75
    v_cvt_pk_bf16_f32 v55, v66, v67
    v_mfma_f32_16x16x32_f16 v[228:231], v[68:71], v[48:51], v[208:211]
    s_nop 0
    v_exp_f32 v46, v46
    v_mfma_f32_16x16x32_f16 v[228:231], v[60:63], v[56:59], v[228:231]
    s_nop 0
    v_mov_b32_dpp v43, v31 quad_perm:[0,1,2,3] row_mask:0x2 bank_mask:0xf
    v_cvt_pk_bf16_f32 v168, v44, v45
    v_mfma_f32_16x16x32_f16 v[228:231], v[16:19], v[140:143], v[228:231]
    v_exp_f32 v47, v47
    v_mfma_f32_16x16x32_f16 v[16:19], v[12:15], v[24:27], v[192:195]
    buffer_load_dwordx4 v124, s[24:27], s56 offen nt lds
    v_cvt_pk_bf16_f32 v169, v46, v47
    v_mfma_f32_16x16x32_f16 v[16:19], v[152:155], v[144:147], v[16:19]
    v_exp_f32 v40, v40
    v_mfma_f32_16x16x32_f16 v[92:95], v[8:11], v[24:27], v[188:191]
    ds_read_b128 v[64:67], v137 offset:0
    v_mov_b32_dpp v43, v231 quad_perm:[0,1,2,3] row_mask:0x4 bank_mask:0xf
    v_mfma_f32_16x16x32_f16 v[92:95], v[146:149], v[144:147], v[92:95]
    v_exp_f32 v43, v43
    v_mfma_f32_16x16x32_f16 v[72:75], v[56:59], v[24:27], v[184:187]
    ds_read_b128 v[44:47], v137 offset:256
    v_cvt_pk_bf16_f32 v43, v43, v43
    v_mfma_f32_16x16x32_f16 v[72:75], v[140:143], v[144:147], v[72:75]
    ds_write_b16 v131, v43 offset:64
    v_mfma_f32_16x16x32_f16 v[80:83], v[12:15], v[48:51], v[180:183]
    ds_read_b128 v[236:239], v132 offset:48
    v_cvt_pk_bf16_f32 v170, v40, 0
    v_mfma_f32_16x16x32_f16 v[80:83], v[152:155], v[138:141], v[80:83]
    ds_read_b128 v[60:63], v132 offset:64
    s_nop 0
    v_mfma_f32_16x16x32_bf16 v[12:15], v[220:223], v[52:55], 0
    s_nop 0
    ds_read_b128 v[24:27], v136 offset:0
    s_nop 0
    v_mfma_f32_16x16x32_bf16 v[12:15], v[220:223], v[168:171], v[12:15]
    s_nop 0
    v_exp_f32 v80, v80
    v_mfma_f32_16x16x32_bf16 v[68:71], v[0:3], v[52:55], 0
    s_waitcnt lgkmcnt(6)
    v_exp_f32 v81, v81
    v_mfma_f32_16x16x32_bf16 v[68:71], v[164:167], v[168:171], v[68:71]
    v_exp_f32 v82, v82
    v_mfma_f32_16x16x32_bf16 v[240:243], v[20:23], v[52:55], 0
    v_exp_f32 v83, v83
    v_mfma_f32_16x16x32_bf16 v[240:243], v[160:163], v[168:171], v[240:243]
    ds_read_b128 v[40:43], v136 offset:256
    v_cvt_pk_bf16_f32 v80, v80, v81
    v_mfma_f32_16x16x32_bf16 v[108:111], v[4:7], v[52:55], 0
    v_exp_f32 v230, v230
    v_mfma_f32_16x16x32_bf16 v[108:111], v[156:159], v[168:171], v[108:111]
    v_exp_f32 v16, v16
    v_mfma_f32_16x16x32_f16 v[152:155], v[8:11], v[48:51], v[176:179]
    v_exp_f32 v17, v17
    v_mfma_f32_16x16x32_f16 v[152:155], v[146:149], v[138:141], v[152:155]
    ds_read_b128 v[52:55], v137 offset:128
    v_cvt_pk_bf16_f32 v81, v82, v83
    v_mfma_f32_16x16x32_f16 v[232:235], v[56:59], v[48:51], v[172:175]
    ds_read_b128 v[48:51], v136 offset:128
    v_cvt_pk_bf16_f32 v16, v16, v17
    v_mfma_f32_16x16x32_f16 v[232:235], v[140:143], v[138:141], v[232:235]
    s_waitcnt lgkmcnt(3)
    s_nop 0
    v_exp_f32 v152, v152
    v_mfma_f32_16x16x32_bf16 v[116:119], a[24:27], v[64:67], 0
    v_exp_f32 v153, v153
    v_mfma_f32_16x16x32_bf16 v[116:119], a[28:31], v[24:27], v[116:119]
    v_exp_f32 v154, v154
    v_exp_f32 v155, v155
    v_cvt_pk_bf16_f32 v82, v152, v153
    v_cvt_pk_bf16_f32 v83, v154, v155
    v_exp_f32 v232, v232
    v_exp_f32 v233, v233
    v_exp_f32 v234, v234
    v_exp_f32 v235, v235
    v_exp_f32 v18, v18
    v_exp_f32 v19, v19
    v_exp_f32 v92, v92
    s_waitcnt lgkmcnt(0)
    v_mfma_f32_16x16x32_bf16 v[116:119], a[32:35], v[52:55], v[116:119]
    v_exp_f32 v93, v93
    v_mfma_f32_16x16x32_bf16 v[116:119], a[36:39], v[48:51], v[116:119]
    v_cvt_pk_bf16_f32 v17, v18, v19
    v_cvt_pk_bf16_f32 v18, v92, v93
    v_mfma_f32_16x16x32_bf16 v[116:119], a[40:43], v[44:47], v[116:119]
    v_exp_f32 v94, v94
    v_mfma_f32_16x16x32_bf16 v[116:119], a[44:47], v[40:43], v[116:119]
    v_exp_f32 v95, v95
    v_mfma_f32_16x16x32_bf16 v[8:11], a[48:51], v[64:67], 0
    v_exp_f32 v72, v72
    v_mfma_f32_16x16x32_bf16 v[8:11], a[52:55], v[24:27], v[8:11]
    v_exp_f32 v73, v73
    v_mfma_f32_16x16x32_bf16 v[8:11], a[56:59], v[52:55], v[8:11]
    v_cvt_pk_bf16_f32 v19, v94, v95
    v_cvt_pk_bf16_f32 v168, v72, v73
    v_mfma_f32_16x16x32_bf16 v[8:11], a[60:63], v[48:51], v[8:11]
    v_exp_f32 v74, v74
    v_mfma_f32_16x16x32_bf16 v[8:11], a[64:67], v[44:47], v[8:11]
    v_exp_f32 v75, v75
    v_mfma_f32_16x16x32_bf16 v[8:11], a[68:71], v[40:43], v[8:11]
    v_cvt_pk_bf16_f32 v169, v74, v75
    v_cvt_pk_f16_f32 v30, v116, v117
    v_mfma_f32_16x16x32_bf16 v[224:227], a[120:123], v[64:67], 0
    s_nop 0
    v_exp_f32 v29, v29
    v_mfma_f32_16x16x32_bf16 v[224:227], a[124:127], v[24:27], v[224:227]
    s_nop 0
    v_cvt_pk_bf16_f32 v170, v29, 0
    v_cvt_pk_f16_f32 v152, v8, v9
    v_mfma_f32_16x16x32_bf16 v[224:227], a[128:131], v[52:55], v[224:227]
    s_waitcnt vmcnt(5)
    v_readfirstlane_b32 s94, v120
    s_nop 1
    s_cmp_lt_u32 s94, 3
    s_cbranch_scc1 L_spin
L_spinr:
    v_mfma_f32_16x16x32_bf16 v[224:227], a[132:135], v[48:51], v[224:227]
L_pg1:
    s_cbranch_execz L_main
    buffer_load_dwordx4 a[216:219], v121, s[76:79], s92 offen offset:0 sc1
    v_cvt_pk_f16_f32 v153, v10, v11
    v_mfma_f32_16x16x32_bf16 v[224:227], a[136:139], v[44:47], v[224:227]
    v_rcp_f32 v12, v12
    v_mfma_f32_16x16x32_bf16 v[224:227], a[140:143], v[40:43], v[224:227]
    v_mul_f32 v68, v68, v12
    v_mul_f32 v69, v69, v12
    v_mfma_f32_16x16x32_bf16 v[92:95], v[220:223], v[16:19], 0
    v_cvt_pk_bf16_f32 v68, v68, v69
    v_mul_f32 v70, v70, v12
    v_mfma_f32_16x16x32_bf16 v[92:95], v[220:223], v[168:171], v[92:95]
    v_mul_f32 v71, v71, v12
    v_cvt_pk_bf16_f32 v69, v70, v71
    v_mfma_f32_16x16x32_bf16 v[72:75], v[0:3], v[16:19], 0
    buffer_load_dwordx4 a[220:223], v121, s[76:79], s92 offen offset:1024 sc1
    v_mul_f32 v240, v240, v12
    v_mfma_f32_16x16x32_bf16 v[72:75], v[164:167], v[168:171], v[72:75]
    v_mul_f32 v241, v241, v12
    v_cvt_pk_bf16_f32 v70, v240, v241
    v_mfma_f32_16x16x32_bf16 v[56:59], v[20:23], v[16:19], 0
    v_mul_f32 v242, v242, v12
    v_mul_f32 v243, v243, v12
    v_mfma_f32_16x16x32_bf16 v[56:59], v[160:163], v[168:171], v[56:59]
    v_cvt_pk_bf16_f32 v71, v242, v243
    v_mul_f32 v108, v108, v12
    v_mfma_f32_16x16x32_bf16 v[8:11], v[4:7], v[16:19], 0
    v_mul_f32 v109, v109, v12
    v_cvt_pk_bf16_f32 v14, v108, v109
    v_mfma_f32_16x16x32_bf16 v[8:11], v[156:159], v[168:171], v[8:11]
    buffer_load_dwordx4 a[224:227], v121, s[76:79], s92 offen offset:2048 sc1
    v_cvt_pk_bf16_f32 v168, v232, v233
    v_mfma_f32_16x16x32_bf16 v[16:19], a[72:75], v[64:67], 0
    v_cvt_pk_bf16_f32 v169, v234, v235
    v_cvt_pk_bf16_f32 v170, v230, 0
    v_mfma_f32_16x16x32_bf16 v[16:19], a[76:79], v[24:27], v[16:19]
    v_mul_f32 v110, v110, v12
    v_mul_f32 v111, v111, v12
    v_mfma_f32_16x16x32_bf16 v[16:19], a[80:83], v[52:55], v[16:19]
    v_cvt_pk_bf16_f32 v15, v110, v111
    v_cvt_pk_f16_f32 v154, v224, v225
    v_mfma_f32_16x16x32_bf16 v[16:19], a[84:87], v[48:51], v[16:19]
    v_cvt_pk_f16_f32 v155, v226, v227
    v_cvt_pk_f16_f32 v31, v118, v119
    v_mfma_f32_16x16x32_bf16 v[16:19], a[88:91], v[44:47], v[16:19]
    buffer_load_dwordx4 a[228:231], v121, s[76:79], s92 offen offset:3072 sc1
    v_mfma_f32_16x16x32_bf16 v[16:19], a[92:95], v[40:43], v[16:19]
    s_movk_i32 s92, 4096
    ds_write_b32 v134, v15 offset:4
    v_mfma_f32_16x16x32_bf16 v[244:247], v[64:67], a[144:147], 0
    s_nop 0
    v_rcp_f32 v92, v92
    v_mfma_f32_16x16x32_bf16 v[244:247], v[24:27], a[148:151], v[244:247]
    s_nop 0
    v_mul_f32 v72, v72, v92
    v_cvt_pk_f16_f32 v12, v16, v17
    v_mfma_f32_16x16x32_bf16 v[244:247], v[52:55], a[152:155], v[244:247]
    v_cvt_pk_f16_f32 v13, v18, v19
    v_pk_fma_f16 v37, v12, v12, s3
    v_mfma_f32_16x16x32_bf16 v[244:247], v[48:51], a[156:159], v[244:247]
    buffer_load_dwordx4 a[232:235], v121, s[76:79], s92 offen offset:0 sc1
    v_pk_fmac_f16 v37, v13, v13
    v_mfma_f32_16x16x32_bf16 v[244:247], v[44:47], a[160:163], v[244:247]
    v_mul_f32 v73, v73, v92
    v_cvt_pk_bf16_f32 v248, v72, v73
    v_mfma_f32_16x16x32_bf16 v[244:247], v[40:43], a[164:167], v[244:247]
    v_mul_f32 v74, v74, v92
    v_mul_f32 v75, v75, v92
    v_mfma_f32_16x16x32_bf16 v[16:19], v[64:67], a[168:171], 0
    ds_read_b128 v[98:101], v137 offset:1536
    v_cvt_pk_bf16_f32 v249, v74, v75
    v_mfma_f32_16x16x32_bf16 v[16:19], v[24:27], a[172:175], v[16:19]
    ds_read_b128 v[140:143], v136 offset:1536
    v_mul_f32 v56, v56, v92
    v_mfma_f32_16x16x32_bf16 v[16:19], v[52:55], a[176:179], v[16:19]
    buffer_load_dwordx4 a[236:239], v121, s[76:79], s92 offen offset:1024 sc1
    v_mul_f32 v57, v57, v92
    v_mfma_f32_16x16x32_bf16 v[16:19], v[48:51], a[180:183], v[16:19]
    ds_read_b128 v[116:119], v137 offset:1664
    v_cvt_pk_bf16_f32 v250, v56, v57
    v_mfma_f32_16x16x32_bf16 v[16:19], v[44:47], a[184:187], v[16:19]
    v_mul_f32 v58, v58, v92
    v_mul_f32 v59, v59, v92
    v_mfma_f32_16x16x32_bf16 v[16:19], v[40:43], a[188:191], v[16:19]
    s_lshl_b32 s93, s68, 10
    v_cvt_pk_bf16_f32 v251, v58, v59
    v_mul_f32 v8, v8, v92
    v_mfma_f32_16x16x32_bf16 v[108:111], v[220:223], v[80:83], 0
    v_mul_f32 v9, v9, v92
    v_cvt_pk_bf16_f32 v28, v8, v9
    v_mfma_f32_16x16x32_bf16 v[108:111], v[220:223], v[168:171], v[108:111]
    buffer_load_dwordx4 a[240:243], v121, s[76:79], s92 offen offset:2048 sc1
    ds_read_b128 v[56:59], v136 offset:1792
    v_mfma_f32_16x16x32_bf16 v[72:75], v[0:3], v[80:83], 0
    v_mul_f32 v10, v10, v92
    v_mul_f32 v11, v11, v92
    v_mfma_f32_16x16x32_bf16 v[72:75], v[164:167], v[168:171], v[72:75]
    ds_write_b64 v135, v[68:69] offset:0
    v_mfma_f32_16x16x32_bf16 v[224:227], v[20:23], v[80:83], 0
    v_rcp_f32 v108, v108
    v_mfma_f32_16x16x32_bf16 v[224:227], v[160:163], v[168:171], v[224:227]
    ds_write_b64 v135, v[70:71] offset:8
    v_mfma_f32_16x16x32_bf16 v[68:71], v[4:7], v[80:83], 0
    s_nop 0
    buffer_load_dwordx4 a[244:247], v121, s[76:79], s92 offen offset:3072 sc1
    v_mul_f32 v72, v72, v108
    v_mfma_f32_16x16x32_bf16 v[68:71], v[156:159], v[168:171], v[68:71]
    s_movk_i32 s92, 8192
    ds_write_b32 v134, v14 offset:0
    v_mfma_f32_16x16x32_bf16 v[240:243], v[64:67], a[192:195], 0
    ds_read_b128 v[92:95], v136 offset:1664
    v_mul_f32 v73, v73, v108
    v_mfma_f32_16x16x32_bf16 v[240:243], v[24:27], a[196:199], v[240:243]
    v_cvt_pk_bf16_f32 v72, v72, v73
    v_mul_f32 v74, v74, v108
    v_mfma_f32_16x16x32_bf16 v[240:243], v[52:55], a[200:203], v[240:243]
    v_mul_f32 v75, v75, v108
    v_cvt_pk_bf16_f32 v73, v74, v75
    v_mfma_f32_16x16x32_bf16 v[240:243], v[48:51], a[204:207], v[240:243]
    buffer_load_dwordx4 a[248:251], v121, s[76:79], s92 offen offset:0 sc1
    v_mul_f32 v224, v224, v108
    v_mfma_f32_16x16x32_bf16 v[240:243], v[44:47], a[208:211], v[240:243]
    ds_write_b64 v135, v[72:73] offset:3072
    v_mfma_f32_16x16x32_bf16 v[240:243], v[40:43], a[212:215], v[240:243]
    v_mul_f32 v225, v225, v108
    v_cvt_pk_bf16_f32 v74, v224, v225
    v_mfma_f32_16x16x32_bf16 v[228:231], a[96:99], v[64:67], 0
    v_mul_f32 v226, v226, v108
    v_mul_f32 v227, v227, v108
    v_mfma_f32_16x16x32_bf16 v[228:231], a[100:103], v[24:27], v[228:231]
    ds_read_b128 v[80:83], v137 offset:1792
    v_cvt_pk_bf16_f32 v75, v226, v227
    v_mfma_f32_16x16x32_bf16 v[228:231], a[104:107], v[52:55], v[228:231]
    buffer_load_dwordx4 a[252:255], v121, s[76:79], s92 offen offset:1024 sc1
    v_mul_f32 v68, v68, v108
    v_mfma_f32_16x16x32_bf16 v[228:231], a[108:111], v[48:51], v[228:231]
    ds_write_b64 v135, v[74:75] offset:3080
    v_mfma_f32_16x16x32_bf16 v[228:231], a[112:115], v[44:47], v[228:231]
    v_mul_f32 v69, v69, v108
    v_cvt_pk_bf16_f32 v8, v68, v69
    v_mfma_f32_16x16x32_bf16 v[228:231], a[116:119], v[40:43], v[228:231]
    s_waitcnt lgkmcnt(3)
    ds_write_b32 v134, v8 offset:3072
    v_mfma_f32_16x16x32_bf16 v[72:75], a[48:51], v[98:101], 0
    v_mul_f32 v70, v70, v108
    v_mul_f32 v71, v71, v108
    v_mfma_f32_16x16x32_bf16 v[72:75], a[52:55], v[140:143], v[72:75]
    buffer_load_dwordx4 v[224:227], v121, s[76:79], s92 offen offset:2048 sc1
    v_cvt_pk_bf16_f32 v9, v70, v71
    v_mfma_f32_16x16x32_bf16 v[72:75], a[56:59], v[116:119], v[72:75]
    ds_write_b32 v134, v9 offset:3076
    v_mfma_f32_16x16x32_bf16 v[72:75], a[60:63], v[92:95], v[72:75]
    s_waitcnt lgkmcnt(3)
    v_cvt_pk_f16_f32 v14, v228, v229
    v_cvt_pk_f16_f32 v15, v230, v231
    v_mfma_f32_16x16x32_bf16 v[72:75], a[64:67], v[80:83], v[72:75]
    v_pk_fmac_f16 v37, v14, v14
    v_pk_fmac_f16 v37, v15, v15
    v_mfma_f32_16x16x32_bf16 v[72:75], a[68:71], v[56:59], v[72:75]
    v_pk_fmac_f16 v37, v154, v154
    v_pk_fmac_f16 v37, v155, v155
    v_mfma_f32_16x16x32_bf16 v[252:255], a[72:75], v[98:101], 0
    buffer_load_dwordx4 v[228:231], v121, s[76:79], s92 offen offset:3072 sc1
    v_cvt_pk_bf16_f32 v29, v10, v11
    v_mfma_f32_16x16x32_bf16 v[252:255], a[76:79], v[140:143], v[252:255]
    s_movk_i32 s92, 12288
    ds_write_b32 v135, v249 offset:1540
    v_mfma_f32_16x16x32_bf16 v[252:255], a[80:83], v[116:119], v[252:255]
    v_and_b32 v11, 0xb8000000, v123
    v_cmp_ne_u32 s[94:95], 0, v11
    v_mfma_f32_16x16x32_bf16 v[252:255], a[84:87], v[92:95], v[252:255]
    ds_write_b64 v134, v[28:29] offset:1536
    v_mfma_f32_16x16x32_bf16 v[252:255], a[88:91], v[80:83], v[252:255]
    s_or_b32 s94, s94, s95
    v_mov_b32 v11, s94
    v_add_u32 v147, s93, v129
    v_mfma_f32_16x16x32_bf16 v[252:255], a[92:95], v[56:59], v[252:255]
    s_lshl_b32 s95, s68, 2
    buffer_load_dwordx4 v[232:235], v121, s[76:79], s92 offen offset:0 sc1
    v_mov_b32 v10, s95
    v_mfma_f32_16x16x32_bf16 v[68:71], v[236:239], v[0:3], 0
    s_sub_u32 s50, s45, s44
    ds_write_b32 v135, v248 offset:1536
    v_mfma_f32_16x16x32_bf16 v[68:71], v[60:63], v[164:167], v[68:71]
    s_sub_u32 s51, s46, s47
    v_cvt_pk_f16_f32 v8, v252, v253
    v_cvt_pk_f16_f32 v9, v254, v255
    v_mfma_f32_16x16x32_bf16 v[108:111], v[236:239], v[20:23], 0
    s_mov_b32 s60, s59
    ds_write_b64 v135, v[250:251] offset:1544
    v_mfma_f32_16x16x32_bf16 v[108:111], v[60:63], v[160:163], v[108:111]
    s_mov_b32 s59, s58
    v_pk_fma_f16 v39, v8, v8, s3
    v_pk_fmac_f16 v39, v9, v9
    v_mfma_f32_16x16x32_bf16 v[20:23], v[236:239], v[4:7], 0
    s_mov_b32 s58, s57
    buffer_load_dwordx4 v[236:239], v121, s[76:79], s92 offen offset:1024 sc1
    v_cvt_pk_bf16_f32 v0, v244, v245
    v_mfma_f32_16x16x32_bf16 v[20:23], v[60:63], v[156:159], v[20:23]
    s_mov_b32 s57, s56
    v_cvt_pk_bf16_f32 v1, v246, v247
    v_mov_b32_dpp v71, v111 quad_perm:[0,1,2,3] row_mask:0x2 bank_mask:0xf
    v_mfma_f32_16x16x32_bf16 v[60:63], a[24:27], v[98:101], 0
    s_mov_b32 s7, s6
    v_cvt_pk_bf16_f32 v4, v240, v241
    v_cvt_pk_bf16_f32 v5, v242, v243
    v_mfma_f32_16x16x32_bf16 v[60:63], a[28:31], v[140:143], v[60:63]
    s_mov_b32 s6, s5
    v_mov_b32_dpp v71, v23 quad_perm:[0,1,2,3] row_mask:0x4 bank_mask:0xf
    v_cvt_pk_bf16_f32 v71, v71, v71
    v_mfma_f32_16x16x32_bf16 v[60:63], a[32:35], v[116:119], v[60:63]
    s_mov_b32 s5, s4
    ds_write_b16 v131, v71
    v_mfma_f32_16x16x32_bf16 v[60:63], a[36:39], v[92:95], v[60:63]
    s_sub_u32 s14, s6, s7
    buffer_load_dwordx4 v[240:243], v121, s[76:79], s92 offen offset:2048 sc1
    v_pk_mul_f16 v112, v112, v34 op_sel:[0,0] op_sel_hi:[1,0]
    v_mfma_f32_16x16x32_bf16 v[60:63], a[40:43], v[80:83], v[60:63]
    s_add_u32 s61, s61, 1
    v_pk_mul_f16 v113, v113, v34 op_sel:[0,0] op_sel_hi:[1,0]
    v_pk_mul_f16 v114, v114, v34 op_sel:[0,0] op_sel_hi:[1,0]
    v_mfma_f32_16x16x32_bf16 v[60:63], a[44:47], v[56:59], v[60:63]
    s_add_u32 s12, s12, 20
    v_pk_mul_f16 v115, v115, v34 op_sel:[0,0] op_sel_hi:[1,0]
    v_pk_mul_f16 v88, v88, v34 op_sel:[0,0] op_sel_hi:[1,0]
    v_mfma_f32_16x16x32_bf16 v[20:23], a[0:3], v[64:67], 0
    s_max_u32 s12, s12, s61
    v_add_u32 v135, s49, v135
    v_add_u32 v134, s49, v134
    v_mfma_f32_16x16x32_bf16 v[20:23], a[4:7], v[24:27], v[20:23]
    s_cmp_lt_u32 s61, s71
    v_cvt_pk_f16_f32 v26, v60, v61
    v_cvt_pk_f16_f32 v27, v62, v63
    v_mfma_f32_16x16x32_bf16 v[20:23], a[8:11], v[52:55], v[20:23]
    s_cselect_b32 s15, s61, s12
    buffer_load_dwordx4 v[244:247], v121, s[76:79], s92 offen offset:3072 sc1
    v_pk_mul_f16 v89, v89, v34 op_sel:[0,0] op_sel_hi:[1,0]
    v_mfma_f32_16x16x32_bf16 v[20:23], a[12:15], v[48:51], v[20:23]
    s_movk_i32 s92, 16384
    v_pk_mul_f16 v84, v84, v34 op_sel:[0,1] op_sel_hi:[1,1]
    v_pk_mul_f16 v85, v85, v34 op_sel:[0,1] op_sel_hi:[1,1]
    v_mfma_f32_16x16x32_bf16 v[20:23], a[16:19], v[44:47], v[20:23]
    s_cselect_b32 s56, s69, s70
    v_pk_mul_f16 v86, v86, v34 op_sel:[0,1] op_sel_hi:[1,1]
    v_pk_mul_f16 v87, v87, v34 op_sel:[0,1] op_sel_hi:[1,1]
    v_mfma_f32_16x16x32_bf16 v[20:23], a[20:23], v[40:43], v[20:23]
    s_add_u32 s56, s56, s15
    v_pk_mul_f16 v102, v102, v34 op_sel:[0,1] op_sel_hi:[1,1]
    v_pk_mul_f16 v103, v103, v34 op_sel:[0,1] op_sel_hi:[1,1]
    v_mfma_f32_16x16x32_bf16 v[60:63], v[98:101], a[144:147], 0
    s_mul_i32 s53, s56, 58255
    v_fma_mix_f32 v120, v112, v84, 0 op_sel:[0,0,0] op_sel_hi:[1,1,0]
    v_fma_mix_f32 v120, v112, v84, v120 op_sel:[1,1,0] op_sel_hi:[1,1,0]
    v_mfma_f32_16x16x32_bf16 v[60:63], v[140:143], a[148:151], v[60:63]
    s_lshr_b32 s53, s53, 22
    buffer_load_dwordx4 v[248:251], v121, s[76:79], s92 offen offset:0 sc1
    v_cvt_pk_f16_f32 v28, v20, v21
    v_mfma_f32_16x16x32_bf16 v[60:63], v[116:119], a[152:155], v[60:63]
    s_mul_i32 s53, s53, s63
    ds_read_b128 v[32:35], v137 offset:3328
    v_cvt_pk_f16_f32 v29, v22, v23
    v_mfma_f32_16x16x32_bf16 v[60:63], v[92:95], a[156:159], v[60:63]
    s_mul_i32 s56, s56, s62
    v_pk_fma_f16 v36, v28, v28, s3
    v_pk_fmac_f16 v36, v29, v29
    v_mfma_f32_16x16x32_bf16 v[60:63], v[80:83], a[160:163], v[60:63]
    s_add_u32 s56, s56, s53
    ds_read_b128 v[44:47], v136 offset:3328
    v_pk_fmac_f16 v36, v30, v30
    v_mfma_f32_16x16x32_bf16 v[60:63], v[56:59], a[164:167], v[60:63]
    s_mul_i32 s4, s15, 112
    v_pk_fmac_f16 v36, v31, v31
    v_pk_fmac_f16 v36, v152, v152
    v_mfma_f32_16x16x32_bf16 v[108:111], v[98:101], a[192:195], 0
    s_cmp_ge_u32 s15, 16
    buffer_load_dwordx4 v[252:255], v121, s[76:79], s92 offen offset:1024 sc1
    v_pk_fmac_f16 v36, v153, v153
    v_mfma_f32_16x16x32_bf16 v[108:111], v[140:143], a[196:199], v[108:111]
    s_cselect_b32 s53, -30464, 0
    ds_read_b128 v[40:43], v137 offset:3200
    v_fma_mix_f32 v120, v113, v85, v120 op_sel:[0,0,0] op_sel_hi:[1,1,0]
    v_mfma_f32_16x16x32_bf16 v[108:111], v[116:119], a[200:203], v[108:111]
    s_add_u32 s4, s4, s53
    ds_read_b128 v[48:51], v136 offset:3200
    v_fma_mix_f32 v120, v113, v85, v120 op_sel:[1,1,0] op_sel_hi:[1,1,0]
    v_mfma_f32_16x16x32_bf16 v[108:111], v[92:95], a[204:207], v[108:111]
    s_cmp_lt_u32 s15, s73
    v_fma_mix_f32 v120, v114, v86, v120 op_sel:[0,0,0] op_sel_hi:[1,1,0]
    v_fma_mix_f32 v120, v114, v86, v120 op_sel:[1,1,0] op_sel_hi:[1,1,0]
    v_mfma_f32_16x16x32_bf16 v[108:111], v[80:83], a[208:211], v[108:111]
    s_cselect_b32 s26, 100270464, 0
    v_fma_mix_f32 v120, v115, v87, v120 op_sel:[0,0,0] op_sel_hi:[1,1,0]
    v_fma_mix_f32 v120, v115, v87, v120 op_sel:[1,1,0] op_sel_hi:[1,1,0]
    v_mfma_f32_16x16x32_bf16 v[108:111], v[56:59], a[212:215], v[108:111]
    s_cselect_b32 s56, s56, 0
    ds_read_b128 v[64:67], v137 offset:3072
    v_fma_mix_f32 v120, v88, v102, v120 op_sel:[0,0,0] op_sel_hi:[1,1,0]
    v_mfma_f32_16x16x32_bf16 v[20:23], a[96:99], v[98:101], 0
    s_cselect_b32 s4, s4, -1
    ds_read_b128 v[52:55], v136 offset:3072
    v_fma_mix_f32 v120, v88, v102, v120 op_sel:[1,1,0] op_sel_hi:[1,1,0]
    v_mfma_f32_16x16x32_bf16 v[20:23], a[100:103], v[140:143], v[20:23]
    s_cselect_b32 s15, s15, 0
    v_cvt_pk_bf16_f32 v6, v108, v109
    v_cvt_pk_bf16_f32 v7, v110, v111
    v_mfma_f32_16x16x32_bf16 v[20:23], a[104:107], v[116:119], v[20:23]
    s_cselect_b32 s13, s13, -1
    v_fma_mix_f32 v120, v89, v103, v120 op_sel:[0,0,0] op_sel_hi:[1,1,0]
    v_fma_mix_f32 v120, v89, v103, v120 op_sel:[1,1,0] op_sel_hi:[1,1,0]
    v_mfma_f32_16x16x32_bf16 v[20:23], a[108:111], v[92:95], v[20:23]
    s_bitset1_b32 s64, s15
    v_mov_b32 v121, v120
    v_cvt_pk_f16_f32 v146, v72, v73
    v_mfma_f32_16x16x32_bf16 v[20:23], a[112:115], v[80:83], v[20:23]
    s_add_u32 s65, s65, 1
    v_permlane32_swap_b32 v121, v120
    v_mfma_f32_16x16x32_bf16 v[20:23], a[116:119], v[56:59], v[20:23]
    s_cmp_ge_i32 s65, 2
    ds_write_b32 v10, v11 offset:14848
    v_mfma_f32_16x16x32_bf16 v[68:71], v[98:101], a[168:171], 0
    s_cselect_b32 s30, 100270464, 0
    v_add_f32 v120, v121, v120
    v_mov_b32 v121, v120
    v_mfma_f32_16x16x32_bf16 v[68:71], v[140:143], a[172:175], v[68:71]
    s_add_u32 s67, s46, s54
    v_cvt_pk_f16_f32 v10, v20, v21
    v_cvt_pk_f16_f32 v11, v22, v23
    v_mfma_f32_16x16x32_bf16 v[68:71], v[116:119], a[176:179], v[68:71]
    s_add_u32 m0, s67, 0
    v_pk_fmac_f16 v39, v10, v10
    v_pk_fmac_f16 v39, v11, v11
    v_mfma_f32_16x16x32_bf16 v[68:71], v[92:95], a[180:183], v[68:71]
    ds_write_b128 v147, v[104:107] offset:6144
    v_mfma_f32_16x16x32_bf16 v[68:71], v[80:83], a[184:187], v[68:71]
    v_permlane16_swap_b32 v121, v120
    v_mfma_f32_16x16x32_bf16 v[68:71], v[56:59], a[188:191], v[68:71]
    s_nop 0
    v_add_f32 v120, v121, v120
    v_add_f32 v120, s84, v120
    v_mfma_f32_16x16x32_bf16 v[108:111], a[0:3], v[98:101], 0
    s_nop 0
    ds_write_b64 v38, v[90:91] offset:80
    v_mfma_f32_16x16x32_bf16 v[108:111], a[4:7], v[140:143], v[108:111]
    s_nop 0
    v_cvt_pk_bf16_f32 v22, v68, v69
    v_cvt_pk_bf16_f32 v23, v70, v71
    v_mfma_f32_16x16x32_bf16 v[108:111], a[8:11], v[116:119], v[108:111]
    ds_write_b128 v38, v[76:79] offset:96
    v_mfma_f32_16x16x32_bf16 v[108:111], a[12:15], v[92:95], v[108:111]
    v_mov_b32 v2, 0
    v_mov_b32 v3, 0
    v_mfma_f32_16x16x32_bf16 v[108:111], a[16:19], v[80:83], v[108:111]
    v_mov_b32 v121, 0
    v_add_u32 v20, 0, v38
    v_mfma_f32_16x16x32_bf16 v[108:111], a[20:23], v[56:59], v[108:111]
    s_nop 0
    ds_write2_b64 v20, v[2:3], v[2:3] offset0:2 offset1:3
    v_mfma_f32_16x16x32_bf16 v[76:79], a[120:123], v[98:101], 0
    s_nop 0
    v_exp_f32 v120, v120
    v_mfma_f32_16x16x32_bf16 v[76:79], a[124:127], v[140:143], v[76:79]
    s_nop 0
    v_cvt_pk_bf16_f32 v120, v120, 0
    v_cvt_pk_f16_f32 v24, v108, v109
    v_mfma_f32_16x16x32_bf16 v[76:79], a[128:131], v[116:119], v[76:79]
    ds_write_b128 v20, v[112:115] offset:32
    v_mfma_f32_16x16x32_bf16 v[76:79], a[132:135], v[92:95], v[76:79]
    v_cvt_pk_f16_f32 v25, v110, v111
    v_pk_fma_f16 v38, v24, v24, s3
    v_mfma_f32_16x16x32_bf16 v[76:79], a[136:139], v[80:83], v[76:79]
    v_pk_fmac_f16 v38, v25, v25
    v_pk_fmac_f16 v38, v26, v26
    v_mfma_f32_16x16x32_bf16 v[76:79], a[140:143], v[56:59], v[76:79]
    s_waitcnt lgkmcnt(2)
    ds_write2_b64 v20, v[2:3], v[88:89] offset0:8 offset1:9
    v_mfma_f32_16x16x32_bf16 v[68:71], a[120:123], v[64:67], 0
    v_pk_fmac_f16 v38, v27, v27
    v_cmp_gt_u32 vcc, 16, v97
    v_mfma_f32_16x16x32_bf16 v[68:71], a[124:127], v[52:55], v[68:71]
    s_nop 0
    v_cndmask_b32 v120, 0, v120, vcc
    v_cvt_pk_f16_f32 v148, v76, v77
    v_mfma_f32_16x16x32_bf16 v[68:71], a[128:131], v[40:43], v[68:71]
    ds_write_b128 v20, v[84:87]
    v_mfma_f32_16x16x32_bf16 v[68:71], a[132:135], v[48:51], v[68:71]
    v_cvt_pk_f16_f32 v149, v78, v79
    v_pk_fmac_f16 v39, v148, v148
    v_mfma_f32_16x16x32_bf16 v[68:71], a[136:139], v[32:35], v[68:71]
    v_pk_fmac_f16 v39, v149, v149
    v_cvt_pk_f16_f32 v147, v74, v75
    v_mfma_f32_16x16x32_bf16 v[68:71], a[140:143], v[44:47], v[68:71]
    ds_write2_b64 v20, v[102:103], v[2:3] offset0:6 offset1:7
    v_mfma_f32_16x16x32_bf16 v[56:59], a[72:75], v[64:67], 0
    v_pk_fmac_f16 v38, v146, v146
    v_pk_fmac_f16 v38, v147, v147
    v_mfma_f32_16x16x32_bf16 v[56:59], a[76:79], v[52:55], v[56:59]
    v_cvt_pk_bf16_f32 v2, v60, v61
    v_cvt_pk_bf16_f32 v3, v62, v63
    v_mfma_f32_16x16x32_bf16 v[56:59], a[80:83], v[40:43], v[56:59]
    s_waitcnt vmcnt(0)
    ds_write_b64 v20, v[120:121] offset:88
    v_mfma_f32_16x16x32_bf16 v[56:59], a[84:87], v[48:51], v[56:59]
    s_barrier
    v_add_u32 v137, s50, v137
    v_add_u32 v136, s50, v136
    v_mfma_f32_16x16x32_bf16 v[56:59], a[88:91], v[32:35], v[56:59]
    ds_read_b128 v[60:63], v122 offset:14848
    v_add_u32 v135, s48, v135
    v_mfma_f32_16x16x32_bf16 v[56:59], a[92:95], v[44:47], v[56:59]
    v_add_u32 v133, s51, v133
    v_add_u32 v132, s14, v132
    v_mfma_f32_16x16x32_f16 v[76:79], v[212:215], v[36:39], 0
    s_nop 0
    v_cvt_pk_f16_f32 v142, v68, v69
    v_cvt_pk_f16_f32 v143, v70, v71
    v_mfma_f32_16x16x32_bf16 v[92:95], a[0:3], v[64:67], 0
    s_nop 0
    v_cvt_pk_f16_f32 v56, v56, v57
    v_cvt_pk_f16_f32 v57, v58, v59
    v_mfma_f32_16x16x32_bf16 v[92:95], a[4:7], v[52:55], v[92:95]
    v_or3_b32 v123, v123, v76, v77
    v_or3_b32 v123, v123, v78, v79
    v_mfma_f32_16x16x32_bf16 v[80:83], v[64:67], a[168:171], 0
    v_rsq_f32 v76, v76
    v_mfma_f32_16x16x32_bf16 v[80:83], v[52:55], a[172:175], v[80:83]
    v_rsq_f32 v77, v77
    v_mfma_f32_16x16x32_bf16 v[80:83], v[40:43], a[176:179], v[80:83]
    v_mul_f32 v76, s52, v76
    v_cvt_pk_f16_f32 v76, v76, v77
    v_mfma_f32_16x16x32_bf16 v[80:83], v[48:51], a[180:183], v[80:83]
    v_pk_mul_f16 v12, v12, v76 op_sel:[0,1] op_sel_hi:[1,1]
    v_pk_mul_f16 v13, v13, v76 op_sel:[0,1] op_sel_hi:[1,1]
    v_mfma_f32_16x16x32_bf16 v[80:83], v[32:35], a[184:187], v[80:83]
    v_rsq_f32 v78, v78
    v_mfma_f32_16x16x32_bf16 v[80:83], v[44:47], a[188:191], v[80:83]
    v_rsq_f32 v79, v79
    v_mfma_f32_16x16x32_bf16 v[98:101], v[64:67], a[144:147], 0
    v_mul_f32 v78, s52, v78
    v_cvt_pk_f16_f32 v78, v78, v79
    v_mfma_f32_16x16x32_bf16 v[98:101], v[52:55], a[148:151], v[98:101]
    s_waitcnt lgkmcnt(0)
    v_or3_b32 v60, v60, v61, v62
    v_or_b32 v60, v60, v63
    v_mfma_f32_16x16x32_bf16 v[98:101], v[40:43], a[152:155], v[98:101]
    v_readfirstlane_b32 s75, v60
    v_pk_mul_f16 v8, v8, v78 op_sel:[0,1] op_sel_hi:[1,1]
    v_mfma_f32_16x16x32_bf16 v[98:101], v[48:51], a[156:159], v[98:101]
    v_pk_mul_f16 v9, v9, v78 op_sel:[0,1] op_sel_hi:[1,1]
    v_pk_mul_f16 v10, v10, v78 op_sel:[0,1] op_sel_hi:[1,1]
    v_mfma_f32_16x16x32_bf16 v[98:101], v[32:35], a[160:163], v[98:101]
    v_pk_mul_f16 v11, v11, v78 op_sel:[0,1] op_sel_hi:[1,1]
    v_pk_mul_f16 v148, v148, v78 op_sel:[0,1] op_sel_hi:[1,1]
    v_mfma_f32_16x16x32_bf16 v[98:101], v[44:47], a[164:167], v[98:101]
    v_pk_mul_f16 v149, v149, v78 op_sel:[0,1] op_sel_hi:[1,1]
    v_pk_fma_f16 v37, v56, v56, s3
    v_pk_fmac_f16 v37, v57, v57
    s_waitcnt lgkmcnt(0)
    s_cmp_lg_u32 s75, 0
    s_cbranch_scc0 L_atomF0r
    s_branch L_slow
L_bndF:
    s_movk_i32 s73, 20
    s_movk_i32 s71, 18
    s_movk_i32 s70, -20
    s_mov_b32 s74, 0
    s_bitcmp1_b32 s2, 2
    s_cbranch_scc1 L_bndcF
    s_sub_u32 s94, s2, 248
    s_mul_i32 s69, s94, 18
    s_mov_b32 s74, 2
    s_sub_u32 s93, s93, 1373568
    v_cmp_le_u32 vcc, 4, v105
    v_add_u32 v98, 98896896, v128
    v_subrev_u32 v99, 1373568, v128
    v_cndmask_b32 v128, v98, v99, vcc
    v_cmp_le_u32 vcc, 4, v4
    v_add_u32 v98, 98896896, v127
    v_subrev_u32 v99, 1373568, v127
    v_cndmask_b32 v127, v98, v99, vcc
    v_cmp_le_u32 vcc, 4, v129
    v_add_u32 v98, 98896896, v126
    v_subrev_u32 v99, 1373568, v126
    v_cndmask_b32 v126, v98, v99, vcc
    v_cmp_le_u32 vcc, 4, v106
    v_add_u32 v98, 98896896, v125
    v_subrev_u32 v99, 1373568, v125
    v_cndmask_b32 v125, v98, v99, vcc
    v_cmp_le_u32 vcc, 4, v96
    v_add_u32 v98, 98896896, v124
    v_subrev_u32 v99, 1373568, v124
    v_cndmask_b32 v124, v98, v99, vcc
    s_cmp_lt_u32 s2, 256
    s_cbranch_scc1 L_bndrF
L_bndcF:
    s_sub_u32 s94, s2, 252
    s_mul_i32 s69, s94, 20
    s_lshr_b32 s71, s94, 1
    s_sub_u32 s69, s69, s71
    s_and_b32 s94, s94, 1
    s_sub_u32 s71, 20, s94
    s_cmp_eq_u32 s2, 255
    s_cselect_b32 s71, 13, s71
    s_mov_b32 s62, 1373568
    s_add_u32 s74, s74, 1
    s_sub_u32 s93, s93, 2688
    v_mad_i32_i24 v98, v105, -7, v39
    v_cmp_le_u32 vcc, 4, v98
    v_add_u32 v98, 193536, v128
    v_subrev_u32 v99, 2688, v128
    v_cndmask_b32 v128, v98, v99, vcc
    v_mad_i32_i24 v98, v4, -7, v51
    v_cmp_le_u32 vcc, 4, v98
    v_add_u32 v98, 193536, v127
    v_subrev_u32 v99, 2688, v127
    v_cndmask_b32 v127, v98, v99, vcc
    v_mad_i32_i24 v98, v129, -7, v15
    v_cmp_le_u32 vcc, 4, v98
    v_add_u32 v98, 193536, v126
    v_subrev_u32 v99, 2688, v126
    v_cndmask_b32 v126, v98, v99, vcc
    v_mad_i32_i24 v98, v106, -7, v107
    v_cmp_le_u32 vcc, 4, v98
    v_add_u32 v98, 193536, v125
    v_subrev_u32 v99, 2688, v125
    v_cndmask_b32 v125, v98, v99, vcc
    v_mad_i32_i24 v98, v96, -7, v23
    v_cmp_le_u32 vcc, 4, v98
    v_add_u32 v98, 193536, v124
    v_subrev_u32 v99, 2688, v124
    v_cndmask_b32 v124, v98, v99, vcc
    s_cmp_eq_u32 s2, 256
    s_cselect_b32 s62, 0, s62
    s_cselect_b32 s69, 0, s69
    s_cselect_b32 s71, 2, s71
    s_branch L_bndrF
L_maskF:
    s_and_b32 s20, s74, 2
    s_and_b32 s21, s74, 1
    s_mov_b32 s22, 0xc31044fe
    v_lshrrev_b32 v154, 2, v142
    v_add_u32 v154, 0, v154
    v_mul_u32_u24 v145, 37, v154
    v_lshrrev_b32 v144, 8, v145
    v_mad_i32_i24 v144, v144, -7, v154
    v_lshrrev_b32 v145, 10, v145
    v_lshrrev_b32 v144, 2, v144
    v_mul_u32_u24 v145, s20, v145
    v_mad_u32_u24 v154, v144, s21, v145
    v_cvt_f32_u32 v154, v154
    v_lshrrev_b32 v155, 2, v142
    v_add_u32 v155, 4, v155
    v_mul_u32_u24 v145, 37, v155
    v_lshrrev_b32 v144, 8, v145
    v_mad_i32_i24 v144, v144, -7, v155
    v_lshrrev_b32 v145, 10, v145
    v_lshrrev_b32 v144, 2, v144
    v_mul_u32_u24 v145, s20, v145
    v_mad_u32_u24 v155, v144, s21, v145
    v_cvt_f32_u32 v155, v155
    v_lshrrev_b32 v143, 2, v142
    v_add_u32 v143, 8, v143
    v_mul_u32_u24 v145, 37, v143
    v_lshrrev_b32 v144, 8, v145
    v_mad_i32_i24 v144, v144, -7, v143
    v_lshrrev_b32 v145, 10, v145
    v_lshrrev_b32 v144, 2, v144
    v_mul_u32_u24 v145, s20, v145
    v_mad_u32_u24 v143, v144, s21, v145
    v_cvt_f32_u32 v143, v143
    v_mad_u32_u24 v161, v139, 12, 0
    v_mul_u32_u24 v145, 37, v161
    v_lshrrev_b32 v144, 8, v145
    v_mad_i32_i24 v144, v144, -7, v161
    v_lshrrev_b32 v145, 10, v145
    v_lshrrev_b32 v144, 2, v144
    v_mul_u32_u24 v145, s20, v145
    v_mad_u32_u24 v161, v144, s21, v145
    v_cvt_f32_u32 v161, v161
    v_sub_f32 v145, v154, v161
    v_mul_f32 v145, v145, v145 clamp
    v_fmac_f32 v204, s22, v145
    v_sub_f32 v145, v155, v161
    v_mul_f32 v145, v145, v145 clamp
    v_fmac_f32 v192, s22, v145
    v_sub_f32 v145, v143, v161
    v_mul_f32 v145, v145, v145 clamp
    v_fmac_f32 v180, s22, v145
    v_mad_u32_u24 v161, v139, 12, 1
    v_mul_u32_u24 v145, 37, v161
    v_lshrrev_b32 v144, 8, v145
    v_mad_i32_i24 v144, v144, -7, v161
    v_lshrrev_b32 v145, 10, v145
    v_lshrrev_b32 v144, 2, v144
    v_mul_u32_u24 v145, s20, v145
    v_mad_u32_u24 v161, v144, s21, v145
    v_cvt_f32_u32 v161, v161
    v_sub_f32 v145, v154, v161
    v_mul_f32 v145, v145, v145 clamp
    v_fmac_f32 v205, s22, v145
    v_sub_f32 v145, v155, v161
    v_mul_f32 v145, v145, v145 clamp
    v_fmac_f32 v193, s22, v145
    v_sub_f32 v145, v143, v161
    v_mul_f32 v145, v145, v145 clamp
    v_fmac_f32 v181, s22, v145
    v_mad_u32_u24 v161, v139, 12, 2
    v_mul_u32_u24 v145, 37, v161
    v_lshrrev_b32 v144, 8, v145
    v_mad_i32_i24 v144, v144, -7, v161
    v_lshrrev_b32 v145, 10, v145
    v_lshrrev_b32 v144, 2, v144
    v_mul_u32_u24 v145, s20, v145
    v_mad_u32_u24 v161, v144, s21, v145
    v_cvt_f32_u32 v161, v161
    v_sub_f32 v145, v154, v161
    v_mul_f32 v145, v145, v145 clamp
    v_fmac_f32 v206, s22, v145
    v_sub_f32 v145, v155, v161
    v_mul_f32 v145, v145, v145 clamp
    v_fmac_f32 v194, s22, v145
    v_sub_f32 v145, v143, v161
    v_mul_f32 v145, v145, v145 clamp
    v_fmac_f32 v182, s22, v145
    v_mad_u32_u24 v161, v139, 12, 3
    v_mul_u32_u24 v145, 37, v161
    v_lshrrev_b32 v144, 8, v145
    v_mad_i32_i24 v144, v144, -7, v161
    v_lshrrev_b32 v145, 10, v145
    v_lshrrev_b32 v144, 2, v144
    v_mul_u32_u24 v145, s20, v145
    v_mad_u32_u24 v161, v144, s21, v145
    v_cvt_f32_u32 v161, v161
    v_sub_f32 v145, v154, v161
    v_mul_f32 v145, v145, v145 clamp
    v_fmac_f32 v207, s22, v145
    v_sub_f32 v145, v155, v161
    v_mul_f32 v145, v145, v145 clamp
    v_fmac_f32 v195, s22, v145
    v_sub_f32 v145, v143, v161
    v_mul_f32 v145, v145, v145 clamp
    v_fmac_f32 v183, s22, v145
    v_mad_u32_u24 v161, v139, 12, 4
    v_mul_u32_u24 v145, 37, v161
    v_lshrrev_b32 v144, 8, v145
    v_mad_i32_i24 v144, v144, -7, v161
    v_lshrrev_b32 v145, 10, v145
    v_lshrrev_b32 v144, 2, v144
    v_mul_u32_u24 v145, s20, v145
    v_mad_u32_u24 v161, v144, s21, v145
    v_cvt_f32_u32 v161, v161
    v_sub_f32 v145, v154, v161
    v_mul_f32 v145, v145, v145 clamp
    v_fmac_f32 v200, s22, v145
    v_sub_f32 v145, v155, v161
    v_mul_f32 v145, v145, v145 clamp
    v_fmac_f32 v188, s22, v145
    v_sub_f32 v145, v143, v161
    v_mul_f32 v145, v145, v145 clamp
    v_fmac_f32 v176, s22, v145
    v_mad_u32_u24 v161, v139, 12, 5
    v_mul_u32_u24 v145, 37, v161
    v_lshrrev_b32 v144, 8, v145
    v_mad_i32_i24 v144, v144, -7, v161
    v_lshrrev_b32 v145, 10, v145
    v_lshrrev_b32 v144, 2, v144
    v_mul_u32_u24 v145, s20, v145
    v_mad_u32_u24 v161, v144, s21, v145
    v_cvt_f32_u32 v161, v161
    v_sub_f32 v145, v154, v161
    v_mul_f32 v145, v145, v145 clamp
    v_fmac_f32 v201, s22, v145
    v_sub_f32 v145, v155, v161
    v_mul_f32 v145, v145, v145 clamp
    v_fmac_f32 v189, s22, v145
    v_sub_f32 v145, v143, v161
    v_mul_f32 v145, v145, v145 clamp
    v_fmac_f32 v177, s22, v145
    v_mad_u32_u24 v161, v139, 12, 6
    v_mul_u32_u24 v145, 37, v161
    v_lshrrev_b32 v144, 8, v145
    v_mad_i32_i24 v144, v144, -7, v161
    v_lshrrev_b32 v145, 10, v145
    v_lshrrev_b32 v144, 2, v144
    v_mul_u32_u24 v145, s20, v145
    v_mad_u32_u24 v161, v144, s21, v145
    v_cvt_f32_u32 v161, v161
    v_sub_f32 v145, v154, v161
    v_mul_f32 v145, v145, v145 clamp
    v_fmac_f32 v202, s22, v145
    v_sub_f32 v145, v155, v161
    v_mul_f32 v145, v145, v145 clamp
    v_fmac_f32 v190, s22, v145
    v_sub_f32 v145, v143, v161
    v_mul_f32 v145, v145, v145 clamp
    v_fmac_f32 v178, s22, v145
    v_mad_u32_u24 v161, v139, 12, 7
    v_mul_u32_u24 v145, 37, v161
    v_lshrrev_b32 v144, 8, v145
    v_mad_i32_i24 v144, v144, -7, v161
    v_lshrrev_b32 v145, 10, v145
    v_lshrrev_b32 v144, 2, v144
    v_mul_u32_u24 v145, s20, v145
    v_mad_u32_u24 v161, v144, s21, v145
    v_cvt_f32_u32 v161, v161
    v_sub_f32 v145, v154, v161
    v_mul_f32 v145, v145, v145 clamp
    v_fmac_f32 v203, s22, v145
    v_sub_f32 v145, v155, v161
    v_mul_f32 v145, v145, v145 clamp
    v_fmac_f32 v191, s22, v145
    v_sub_f32 v145, v143, v161
    v_mul_f32 v145, v145, v145 clamp
    v_fmac_f32 v179, s22, v145
    v_mad_u32_u24 v161, v139, 12, 8
    v_mul_u32_u24 v145, 37, v161
    v_lshrrev_b32 v144, 8, v145
    v_mad_i32_i24 v144, v144, -7, v161
    v_lshrrev_b32 v145, 10, v145
    v_lshrrev_b32 v144, 2, v144
    v_mul_u32_u24 v145, s20, v145
    v_mad_u32_u24 v161, v144, s21, v145
    v_cvt_f32_u32 v161, v161
    v_sub_f32 v145, v154, v161
    v_mul_f32 v145, v145, v145 clamp
    v_fmac_f32 v196, s22, v145
    v_sub_f32 v145, v155, v161
    v_mul_f32 v145, v145, v145 clamp
    v_fmac_f32 v184, s22, v145
    v_sub_f32 v145, v143, v161
    v_mul_f32 v145, v145, v145 clamp
    v_fmac_f32 v172, s22, v145
    v_mad_u32_u24 v161, v139, 12, 9
    v_mul_u32_u24 v145, 37, v161
    v_lshrrev_b32 v144, 8, v145
    v_mad_i32_i24 v144, v144, -7, v161
    v_lshrrev_b32 v145, 10, v145
    v_lshrrev_b32 v144, 2, v144
    v_mul_u32_u24 v145, s20, v145
    v_mad_u32_u24 v161, v144, s21, v145
    v_cvt_f32_u32 v161, v161
    v_sub_f32 v145, v154, v161
    v_mul_f32 v145, v145, v145 clamp
    v_fmac_f32 v197, s22, v145
    v_sub_f32 v145, v155, v161
    v_mul_f32 v145, v145, v145 clamp
    v_fmac_f32 v185, s22, v145
    v_sub_f32 v145, v143, v161
    v_mul_f32 v145, v145, v145 clamp
    v_fmac_f32 v173, s22, v145
    v_mad_u32_u24 v161, v139, 12, 10
    v_mul_u32_u24 v145, 37, v161
    v_lshrrev_b32 v144, 8, v145
    v_mad_i32_i24 v144, v144, -7, v161
    v_lshrrev_b32 v145, 10, v145
    v_lshrrev_b32 v144, 2, v144
    v_mul_u32_u24 v145, s20, v145
    v_mad_u32_u24 v161, v144, s21, v145
    v_cvt_f32_u32 v161, v161
    v_sub_f32 v145, v154, v161
    v_mul_f32 v145, v145, v145 clamp
    v_fmac_f32 v198, s22, v145
    v_sub_f32 v145, v155, v161
    v_mul_f32 v145, v145, v145 clamp
    v_fmac_f32 v186, s22, v145
    v_sub_f32 v145, v143, v161
    v_mul_f32 v145, v145, v145 clamp
    v_fmac_f32 v174, s22, v145
    v_mad_u32_u24 v161, v139, 12, 11
    v_mul_u32_u24 v145, 37, v161
    v_lshrrev_b32 v144, 8, v145
    v_mad_i32_i24 v144, v144, -7, v161
    v_lshrrev_b32 v145, 10, v145
    v_lshrrev_b32 v144, 2, v144
    v_mul_u32_u24 v145, s20, v145
    v_mad_u32_u24 v161, v144, s21, v145
    v_cvt_f32_u32 v161, v161
    v_sub_f32 v145, v154, v161
    v_mul_f32 v145, v145, v145 clamp
    v_fmac_f32 v199, s22, v145
    v_sub_f32 v145, v155, v161
    v_mul_f32 v145, v145, v145 clamp
    v_fmac_f32 v187, s22, v145
    v_sub_f32 v145, v143, v161
    v_mul_f32 v145, v145, v145 clamp
    v_fmac_f32 v175, s22, v145
    v_cvt_f32_u32 v161, s74
    v_sub_f32 v145, v154, v161
    v_mul_f32 v145, v145, v145 clamp
    v_fmac_f32 v208, s22, v145
    v_sub_f32 v145, v155, v161
    v_mul_f32 v145, v145, v145 clamp
    v_fmac_f32 v209, s22, v145
    v_sub_f32 v145, v143, v161
    v_mul_f32 v145, v145, v145 clamp
    v_fmac_f32 v210, s22, v145
    v_lshrrev_b32 v154, 2, v142
    v_lshl_add_u32 v154, v139, 2, v154
    v_add_u32 v145, 1, v139
    v_lshrrev_b32 v145, 2, v145
    v_mad_u32_u24 v154, v145, 36, v154
    v_min_u32 v154, 48, v154
    v_mul_u32_u24 v145, 37, v154
    v_lshrrev_b32 v144, 8, v145
    v_mad_i32_i24 v144, v144, -7, v154
    v_lshrrev_b32 v145, 10, v145
    v_lshrrev_b32 v144, 2, v144
    v_mul_u32_u24 v145, s20, v145
    v_mad_u32_u24 v154, v144, s21, v145
    v_cvt_f32_u32 v154, v154
    v_sub_f32 v145, v154, v161
    v_mul_f32 v145, v145, v145 clamp
    v_fmac_f32 v211, s22, v145
    s_branch L_nomaskF
L_spin:
    s_movk_i32 s95, 300
L_spin1:
    global_load_dword v120, v122, s[38:39] offset:248 sc1
    s_waitcnt vmcnt(0)
    v_readfirstlane_b32 s94, v120
    s_nop 1
    s_cmp_ge_u32 s94, 3
    s_cbranch_scc1 L_spinr
    s_sub_u32 s95, s95, 1
    s_cmp_lg_u32 s95, 0
    s_cbranch_scc1 L_spin1
    v_mov_b32 v123, -1
    s_branch L_spinr
.fill 106, 4, 0xbf800000
L_atomF0:
    s_cbranch_execz L_main
    v_mov_b32 v122, 0x800000
    buffer_atomic_add v122, v129, s[8:11], 0 offen sc0 sc1
    s_branch L_atomF0r
.p2align 6
L_loopF0:
    v_mfma_f32_16x16x32_bf16 v[28:31], a[4:7], v[108:111], v[28:31]
    ds_write_b32 v135, v13 offset:1540
    v_mfma_f32_16x16x32_bf16 v[28:31], a[8:11], v[8:11], v[28:31]
    v_rcp_f32 v36, v36
    v_mfma_f32_16x16x32_bf16 v[28:31], a[12:15], v[112:115], v[28:31]
    v_mul_f32 v64, v64, v36
    v_mul_f32 v65, v65, v36
    v_mfma_f32_16x16x32_bf16 v[28:31], a[16:19], v[40:43], v[28:31]
    ds_read_b128 v[76:79], v136 offset:1664
    v_cvt_pk_bf16_f32 v4, v64, v65
    v_mfma_f32_16x16x32_bf16 v[28:31], a[20:23], v[52:55], v[28:31]
    v_mul_f32 v66, v66, v36
    v_mul_f32 v67, v67, v36
    v_mfma_f32_16x16x32_bf16 v[16:19], v[84:87], a[168:171], 0
    v_cvt_pk_bf16_f32 v5, v66, v67
    v_mul_f32 v0, v0, v36
    v_mfma_f32_16x16x32_bf16 v[16:19], v[108:111], a[172:175], v[16:19]
    v_mul_f32 v1, v1, v36
    v_cvt_pk_bf16_f32 v6, v0, v1
    v_mfma_f32_16x16x32_bf16 v[16:19], v[8:11], a[176:179], v[16:19]
    ds_write_b64 v135, v[14:15] offset:1544
    v_mfma_f32_16x16x32_bf16 v[16:19], v[112:115], a[180:183], v[16:19]
    v_mul_f32 v2, v2, v36
    v_mul_f32 v3, v3, v36
    v_mfma_f32_16x16x32_bf16 v[16:19], v[40:43], a[184:187], v[16:19]
    v_cvt_pk_bf16_f32 v7, v2, v3
    v_mul_f32 v146, v146, v36
    v_mfma_f32_16x16x32_bf16 v[16:19], v[52:55], a[188:191], v[16:19]
    v_mul_f32 v147, v147, v36
    v_cvt_pk_bf16_f32 v152, v146, v147
    v_mfma_f32_16x16x32_bf16 v[12:15], a[120:123], v[84:87], 0
    ds_write_b64 v134, v[154:155] offset:1536
    v_mfma_f32_16x16x32_bf16 v[12:15], a[124:127], v[108:111], v[12:15]
    v_mul_f32 v148, v148, v36
    v_mul_f32 v149, v149, v36
    v_mfma_f32_16x16x32_bf16 v[12:15], a[128:131], v[8:11], v[12:15]
    v_cvt_pk_bf16_f32 v153, v148, v149
    v_fmac_f32 v32, v116, v116
    v_mfma_f32_16x16x32_bf16 v[12:15], a[132:135], v[112:115], v[12:15]
    ds_read_b128 v[92:95], v137 offset:1792
    v_fmac_f32 v32, v117, v117
    v_mfma_f32_16x16x32_bf16 v[12:15], a[136:139], v[40:43], v[12:15]
    v_fmac_f32 v32, v118, v118
    v_fmac_f32 v32, v119, v119
    v_mfma_f32_16x16x32_bf16 v[12:15], a[140:143], v[52:55], v[12:15]
    v_fma_f32 v154, v140, v140, s42
    v_fmac_f32 v154, v141, v141
    v_mfma_f32_16x16x32_bf16 v[0:3], a[48:51], v[84:87], 0
    v_fmac_f32 v154, v142, v142
    v_fmac_f32 v154, v143, v143
    v_mfma_f32_16x16x32_bf16 v[0:3], a[52:55], v[108:111], v[0:3]
    ds_write_b64 v135, v[4:5] offset:3072
    v_mfma_f32_16x16x32_bf16 v[0:3], a[56:59], v[8:11], v[0:3]
    v_fmac_f32 v154, v44, v44
    v_fmac_f32 v154, v45, v45
    v_mfma_f32_16x16x32_bf16 v[0:3], a[60:63], v[112:115], v[0:3]
    v_fmac_f32 v154, v46, v46
    v_fmac_f32 v154, v47, v47
    v_mfma_f32_16x16x32_bf16 v[0:3], a[64:67], v[40:43], v[0:3]
    v_fmac_f32 v154, v56, v56
    v_fmac_f32 v154, v57, v57
    v_mfma_f32_16x16x32_bf16 v[0:3], a[68:71], v[52:55], v[0:3]
    ds_write_b64 v135, v[6:7] offset:3080
    v_mfma_f32_16x16x32_bf16 v[4:7], a[24:27], v[84:87], 0
    v_fmac_f32 v154, v58, v58
    v_fmac_f32 v154, v59, v59
    v_mfma_f32_16x16x32_bf16 v[4:7], a[28:31], v[108:111], v[4:7]
    v_fma_f32 v155, v24, v24, s42
    v_fmac_f32 v155, v25, v25
    v_mfma_f32_16x16x32_bf16 v[4:7], a[32:35], v[8:11], v[4:7]
    v_fmac_f32 v155, v26, v26
    v_fmac_f32 v155, v27, v27
    v_mfma_f32_16x16x32_bf16 v[4:7], a[36:39], v[112:115], v[4:7]
    ds_write_b32 v134, v152 offset:3072
    v_mfma_f32_16x16x32_bf16 v[4:7], a[40:43], v[40:43], v[4:7]
    v_fmac_f32 v155, v88, v88
    v_fmac_f32 v155, v89, v89
    v_mfma_f32_16x16x32_bf16 v[4:7], a[44:47], v[52:55], v[4:7]
    v_fmac_f32 v155, v90, v90
    v_fmac_f32 v155, v91, v91
    v_mfma_f32_16x16x32_bf16 v[146:149], v[84:87], a[192:195], 0
    s_waitcnt vmcnt(10)
    v_fmac_f32 v155, v72, v72
    v_fmac_f32 v155, v73, v73
    v_mfma_f32_16x16x32_bf16 v[146:149], v[108:111], a[196:199], v[146:149]
    ds_write_b32 v134, v153 offset:3076
    v_mfma_f32_16x16x32_bf16 v[146:149], v[8:11], a[200:203], v[146:149]
    v_fmac_f32 v155, v74, v74
    v_fmac_f32 v155, v75, v75
    v_mfma_f32_16x16x32_bf16 v[146:149], v[112:115], a[204:207], v[146:149]
    v_cvt_pk_bf16_f32 v152, v32, v154
    v_cvt_pk_bf16_f32 v153, v155, v122
    v_mfma_f32_16x16x32_bf16 v[146:149], v[40:43], a[208:211], v[146:149]
    v_add_u32 v135, s49, v135
    v_add_u32 v134, s49, v134
    v_mfma_f32_16x16x32_bf16 v[146:149], v[52:55], a[212:215], v[146:149]
    ds_write_b64 v130, v[152:153]
    v_mfma_f32_16x16x32_bf16 v[32:35], a[72:75], v[84:87], 0
    v_cvt_pk_f16_f32 v28, v28, v29
    v_cvt_pk_f16_f32 v29, v30, v31
    v_mfma_f32_16x16x32_bf16 v[32:35], a[76:79], v[108:111], v[32:35]
    v_pk_fma_f16 v36, v28, v28, s3
    v_pk_fmac_f16 v36, v29, v29
    v_mfma_f32_16x16x32_bf16 v[32:35], a[80:83], v[8:11], v[32:35]
    v_cvt_pk_f16_f32 v154, v12, v13
    v_cvt_pk_f16_f32 v155, v14, v15
    v_mfma_f32_16x16x32_bf16 v[32:35], a[84:87], v[112:115], v[32:35]
    v_cvt_pk_f16_f32 v30, v4, v5
    v_cvt_pk_f16_f32 v31, v6, v7
    v_mfma_f32_16x16x32_bf16 v[32:35], a[88:91], v[40:43], v[32:35]
    v_pk_fmac_f16 v36, v30, v30
    v_pk_fmac_f16 v36, v31, v31
    v_mfma_f32_16x16x32_bf16 v[32:35], a[92:95], v[52:55], v[32:35]
    v_cvt_pk_bf16_f32 v4, v146, v147
    v_cvt_pk_bf16_f32 v5, v148, v149
    v_mfma_f32_16x16x32_bf16 v[146:149], a[96:99], v[84:87], 0
    v_cvt_pk_f16_f32 v152, v0, v1
    v_cvt_pk_f16_f32 v153, v2, v3
    v_mfma_f32_16x16x32_bf16 v[146:149], a[100:103], v[108:111], v[146:149]
    s_waitcnt lgkmcnt(0)
    v_pk_fmac_f16 v36, v152, v152
    v_pk_fmac_f16 v36, v153, v153
    v_mfma_f32_16x16x32_bf16 v[146:149], a[104:107], v[8:11], v[146:149]
    s_barrier
    ds_read_b128 v[0:3], v129 offset:0
    v_cvt_pk_f16_f32 v12, v32, v33
    v_mfma_f32_16x16x32_bf16 v[146:149], a[108:111], v[112:115], v[146:149]
    ds_read_b128 v[64:67], v129 offset:1024
    v_cvt_pk_f16_f32 v13, v34, v35
    v_mfma_f32_16x16x32_bf16 v[146:149], a[112:115], v[40:43], v[146:149]
    v_pk_fma_f16 v37, v12, v12, s3
    v_pk_fmac_f16 v37, v13, v13
    v_mfma_f32_16x16x32_bf16 v[146:149], a[116:119], v[52:55], v[146:149]
    s_nop 1
    v_mfma_f32_16x16x32_bf16 v[32:35], v[84:87], a[144:147], 0
    s_nop 2
    v_mfma_f32_16x16x32_bf16 v[32:35], v[108:111], a[148:151], v[32:35]
    s_nop 0
    v_cvt_pk_f16_f32 v14, v146, v147
    v_cvt_pk_f16_f32 v15, v148, v149
    v_mfma_f32_16x16x32_bf16 v[32:35], v[8:11], a[152:155], v[32:35]
    v_pk_fmac_f16 v37, v14, v14
    v_pk_fmac_f16 v37, v15, v15
    v_mfma_f32_16x16x32_bf16 v[32:35], v[112:115], a[156:159], v[32:35]
    v_pk_fmac_f16 v37, v154, v154
    v_pk_fmac_f16 v37, v155, v155
    v_mfma_f32_16x16x32_bf16 v[32:35], v[40:43], a[160:163], v[32:35]
    v_mfma_f32_16x16x32_bf16 v[32:35], v[52:55], a[164:167], v[32:35]
    s_waitcnt lgkmcnt(1)
    v_readfirstlane_b32 s12, v1
    v_mfma_f32_16x16x32_bf16 v[84:87], v[216:219], v[0:3], 0
    s_waitcnt lgkmcnt(0)
    s_nop 1
    v_mfma_f32_16x16x32_bf16 v[84:87], v[216:219], v[64:67], v[84:87]
    s_lshr_b32 s12, s12, 23
    v_cvt_pk_bf16_f32 v0, v32, v33
    v_cvt_pk_bf16_f32 v1, v34, v35
    v_mfma_f32_16x16x32_bf16 v[32:35], a[96:99], v[68:71], 0
    s_nop 1
    v_mfma_f32_16x16x32_bf16 v[32:35], a[100:103], v[60:63], v[32:35]
    s_nop 0
    v_rsq_f32 v84, v84
    v_mfma_f32_16x16x32_bf16 v[32:35], a[104:107], v[98:101], v[32:35]
    v_rsq_f32 v85, v85
    v_mfma_f32_16x16x32_bf16 v[32:35], a[108:111], v[76:79], v[32:35]
    v_rsq_f32 v86, v86
    v_mfma_f32_16x16x32_bf16 v[32:35], a[112:115], v[92:95], v[32:35]
    v_mul_f32 v84, s43, v84
    v_mul_f32 v85, s43, v85
    v_mfma_f32_16x16x32_bf16 v[32:35], a[116:119], v[104:107], v[32:35]
    v_mul_f32 v86, s43, v86
    v_mul_f32 v140, v140, v85
    v_mfma_f32_16x16x32_bf16 v[40:43], v[68:71], a[168:171], 0
    s_nop 0
    v_mul_f32 v141, v141, v85
    v_cvt_pk_bf16_f32 v52, v140, v141
    v_mfma_f32_16x16x32_bf16 v[40:43], v[60:63], a[172:175], v[40:43]
    s_nop 0
    v_cvt_pk_f16_f32 v10, v32, v33
    v_cvt_pk_f16_f32 v11, v34, v35
    v_mfma_f32_16x16x32_bf16 v[40:43], v[98:101], a[176:179], v[40:43]
    v_mul_f32 v142, v142, v85
    v_mul_f32 v143, v143, v85
    v_mfma_f32_16x16x32_bf16 v[40:43], v[76:79], a[180:183], v[40:43]
    v_cvt_pk_bf16_f32 v53, v142, v143
    v_mul_f32 v44, v44, v85
    v_mfma_f32_16x16x32_bf16 v[40:43], v[92:95], a[184:187], v[40:43]
    ds_write_b32 v135, v52 offset:1536
    v_mfma_f32_16x16x32_bf16 v[40:43], v[104:107], a[188:191], v[40:43]
    v_mul_f32 v45, v45, v85
    v_cvt_pk_bf16_f32 v54, v44, v45
    v_mfma_f32_16x16x32_bf16 v[140:143], a[24:27], v[68:71], 0
    s_nop 0
    v_mul_f32 v46, v46, v85
    v_mul_f32 v47, v47, v85
    v_mfma_f32_16x16x32_bf16 v[140:143], a[28:31], v[60:63], v[140:143]
    s_nop 0
    v_cvt_pk_bf16_f32 v22, v40, v41
    v_cvt_pk_bf16_f32 v23, v42, v43
    v_mfma_f32_16x16x32_bf16 v[140:143], a[32:35], v[98:101], v[140:143]
    v_cvt_pk_bf16_f32 v55, v46, v47
    v_mul_f32 v56, v56, v85
    v_mfma_f32_16x16x32_bf16 v[140:143], a[36:39], v[76:79], v[140:143]
    ds_write_b64 v135, v[54:55] offset:1544
    v_mfma_f32_16x16x32_bf16 v[140:143], a[40:43], v[92:95], v[140:143]
    s_sub_u32 s50, s45, s44
    v_mul_f32 v57, v57, v85
    v_cvt_pk_bf16_f32 v38, v56, v57
    v_mfma_f32_16x16x32_bf16 v[140:143], a[44:47], v[104:107], v[140:143]
    s_sub_u32 s51, s46, s47
    v_mul_f32 v58, v58, v85
    v_mul_f32 v59, v59, v85
    v_mfma_f32_16x16x32_bf16 v[32:35], a[72:75], v[68:71], 0
    s_mov_b32 s60, s59
    v_cvt_pk_bf16_f32 v39, v58, v59
    v_mul_f32 v48, v48, v84
    v_mfma_f32_16x16x32_bf16 v[32:35], a[76:79], v[60:63], v[32:35]
    s_mov_b32 s59, s58
    ds_write_b32 v134, v39 offset:1540
    v_mfma_f32_16x16x32_bf16 v[32:35], a[80:83], v[98:101], v[32:35]
    s_mov_b32 s58, s57
    v_mul_f32 v49, v49, v84
    v_cvt_pk_bf16_f32 v64, v48, v49
    v_mfma_f32_16x16x32_bf16 v[32:35], a[84:87], v[76:79], v[32:35]
    s_mov_b32 s57, s56
    v_mul_f32 v50, v50, v84
    v_mul_f32 v51, v51, v84
    v_mfma_f32_16x16x32_bf16 v[32:35], a[88:91], v[92:95], v[32:35]
    s_mov_b32 s7, s6
    v_cvt_pk_bf16_f32 v65, v50, v51
    v_mul_f32 v80, v80, v84
    v_mfma_f32_16x16x32_bf16 v[32:35], a[92:95], v[104:107], v[32:35]
    s_mov_b32 s6, s5
    ds_write_b32 v135, v53 offset:1540
    v_mfma_f32_16x16x32_bf16 v[146:149], a[48:51], v[68:71], 0
    s_mov_b32 s5, s4
    v_mul_f32 v81, v81, v84
    v_cvt_pk_bf16_f32 v66, v80, v81
    v_mfma_f32_16x16x32_bf16 v[146:149], a[52:55], v[60:63], v[146:149]
    s_sub_u32 s14, s6, s7
    v_cvt_pk_f16_f32 v8, v32, v33
    v_cvt_pk_f16_f32 v9, v34, v35
    v_mfma_f32_16x16x32_bf16 v[146:149], a[56:59], v[98:101], v[146:149]
    s_add_u32 s61, s61, 1
    ds_read_b128 v[32:35], v137 offset:3328
    v_pk_fma_f16 v39, v8, v8, s3
    v_mfma_f32_16x16x32_bf16 v[146:149], a[60:63], v[76:79], v[146:149]
    s_add_u32 s12, s12, 20
    ds_read_b128 v[40:43], v137 offset:3200
    v_pk_fmac_f16 v39, v9, v9
    v_mfma_f32_16x16x32_bf16 v[146:149], a[64:67], v[92:95], v[146:149]
    s_max_u32 s12, s12, s61
    ds_read_b128 v[48:51], v136 offset:3200
    v_pk_fmac_f16 v39, v10, v10
    v_mfma_f32_16x16x32_bf16 v[146:149], a[68:71], v[104:107], v[146:149]
    s_cmp_lt_u32 s61, s71
    ds_read_b128 v[44:47], v136 offset:3328
    v_pk_fmac_f16 v39, v11, v11
    v_mfma_f32_16x16x32_bf16 v[108:111], a[120:123], v[68:71], 0
    s_cselect_b32 s15, s61, s12
    ds_read_b128 v[52:55], v136 offset:3072
    v_mul_f32 v82, v82, v84
    v_mfma_f32_16x16x32_bf16 v[108:111], a[124:127], v[60:63], v[108:111]
    s_cselect_b32 s56, s69, s70
    v_cvt_pk_f16_f32 v146, v146, v147
    v_cvt_pk_f16_f32 v147, v148, v149
    v_mfma_f32_16x16x32_bf16 v[108:111], a[128:131], v[98:101], v[108:111]
    s_add_u32 s56, s56, s15
    v_mul_f32 v83, v83, v84
    v_cvt_pk_bf16_f32 v67, v82, v83
    v_mfma_f32_16x16x32_bf16 v[108:111], a[132:135], v[76:79], v[108:111]
    s_mul_i32 s53, s56, 58255
    v_mul_f32 v116, v116, v84
    v_mul_f32 v117, v117, v84
    v_mfma_f32_16x16x32_bf16 v[108:111], a[136:139], v[92:95], v[108:111]
    s_lshr_b32 s53, s53, 22
    ds_write_b32 v134, v38 offset:1536
    v_mfma_f32_16x16x32_bf16 v[108:111], a[140:143], v[104:107], v[108:111]
    s_mul_i32 s53, s53, s63
    v_cvt_pk_bf16_f32 v2, v116, v117
    v_mul_f32 v118, v118, v84
    v_mfma_f32_16x16x32_bf16 v[80:83], a[0:3], v[68:71], 0
    s_mul_i32 s56, s56, s62
    v_mul_f32 v119, v119, v84
    v_cvt_pk_bf16_f32 v3, v118, v119
    v_mfma_f32_16x16x32_bf16 v[80:83], a[4:7], v[60:63], v[80:83]
    s_add_u32 s56, s56, s53
    v_cvt_pk_f16_f32 v148, v108, v109
    v_cvt_pk_f16_f32 v149, v110, v111
    v_mfma_f32_16x16x32_bf16 v[80:83], a[8:11], v[98:101], v[80:83]
    s_mul_i32 s4, s15, 112
    ds_write_b64 v135, v[64:65] offset:0
    v_mfma_f32_16x16x32_bf16 v[80:83], a[12:15], v[76:79], v[80:83]
    s_cmp_ge_u32 s15, 16
    v_pk_fmac_f16 v39, v148, v148
    v_pk_fmac_f16 v39, v149, v149
    v_mfma_f32_16x16x32_bf16 v[80:83], a[16:19], v[92:95], v[80:83]
    s_cselect_b32 s53, -30464, 0
    v_mul_f32 v24, v24, v86
    v_mul_f32 v25, v25, v86
    v_mfma_f32_16x16x32_bf16 v[80:83], a[20:23], v[104:107], v[80:83]
    s_add_u32 s4, s4, s53
    v_cvt_pk_bf16_f32 v116, v24, v25
    v_mul_f32 v26, v26, v86
    v_mfma_f32_16x16x32_bf16 v[108:111], v[68:71], a[144:147], 0
    s_cmp_lt_u32 s15, s73
    ds_write_b64 v135, v[66:67] offset:8
    v_mfma_f32_16x16x32_bf16 v[108:111], v[60:63], a[148:151], v[108:111]
    s_cselect_b32 s26, 100270464, 0
    v_cvt_pk_f16_f32 v24, v80, v81
    v_cvt_pk_f16_f32 v25, v82, v83
    v_mfma_f32_16x16x32_bf16 v[108:111], v[98:101], a[152:155], v[108:111]
    s_cselect_b32 s56, s56, 0
    v_pk_fma_f16 v38, v24, v24, s3
    v_pk_fmac_f16 v38, v25, v25
    v_mfma_f32_16x16x32_bf16 v[108:111], v[76:79], a[156:159], v[108:111]
    s_cselect_b32 s4, s4, -1
    ds_read_b128 v[64:67], v137 offset:3072
    v_mul_f32 v27, v27, v86
    v_mfma_f32_16x16x32_bf16 v[108:111], v[92:95], a[160:163], v[108:111]
    s_cselect_b32 s15, s15, 0
    v_cvt_pk_bf16_f32 v117, v26, v27
    v_mul_f32 v88, v88, v86
    v_mfma_f32_16x16x32_bf16 v[108:111], v[104:107], a[164:167], v[108:111]
    s_cselect_b32 s13, s13, -1
    v_mul_f32 v89, v89, v86
    v_cvt_pk_bf16_f32 v118, v88, v89
    v_mfma_f32_16x16x32_bf16 v[80:83], v[68:71], a[192:195], 0
    s_bitset1_b32 s64, s15
    v_mul_f32 v90, v90, v86
    v_mul_f32 v91, v91, v86
    v_mfma_f32_16x16x32_bf16 v[80:83], v[60:63], a[196:199], v[80:83]
    s_add_u32 s65, s65, 1
    ds_write_b64 v134, v[2:3] offset:0
    v_mfma_f32_16x16x32_bf16 v[80:83], v[98:101], a[200:203], v[80:83]
    s_cmp_ge_i32 s65, 2
    v_cvt_pk_bf16_f32 v119, v90, v91
    v_mul_f32 v72, v72, v86
    v_mfma_f32_16x16x32_bf16 v[80:83], v[76:79], a[204:207], v[80:83]
    s_cselect_b32 s30, 100270464, 0
    v_mul_f32 v73, v73, v86
    v_cvt_pk_bf16_f32 v72, v72, v73
    v_mfma_f32_16x16x32_bf16 v[80:83], v[92:95], a[208:211], v[80:83]
    s_add_u32 s67, s46, s54
    v_mul_f32 v74, v74, v86
    v_mul_f32 v75, v75, v86
    v_mfma_f32_16x16x32_bf16 v[80:83], v[104:107], a[212:215], v[80:83]
    s_waitcnt lgkmcnt(1)
    ds_write_b64 v135, v[116:117] offset:3072
    v_mfma_f32_16x16x32_bf16 v[60:63], a[72:75], v[64:67], 0
    s_add_u32 m0, s67, 0
    v_cvt_pk_bf16_f32 v73, v74, v75
    v_cvt_pk_bf16_f32 v2, v108, v109
    v_mfma_f32_16x16x32_bf16 v[60:63], a[76:79], v[52:55], v[60:63]
    v_cvt_pk_bf16_f32 v3, v110, v111
    v_cvt_pk_f16_f32 v26, v140, v141
    v_mfma_f32_16x16x32_bf16 v[60:63], a[80:83], v[40:43], v[60:63]
    v_cvt_pk_f16_f32 v27, v142, v143
    v_pk_fmac_f16 v38, v26, v26
    v_mfma_f32_16x16x32_bf16 v[60:63], a[84:87], v[48:51], v[60:63]
    ds_write_b32 v135, v118 offset:3080
    v_mfma_f32_16x16x32_bf16 v[60:63], a[88:91], v[32:35], v[60:63]
    v_pk_fmac_f16 v38, v27, v27
    v_pk_fmac_f16 v38, v146, v146
    v_mfma_f32_16x16x32_bf16 v[60:63], a[92:95], v[44:47], v[60:63]
    v_pk_fmac_f16 v38, v147, v147
    v_cvt_pk_bf16_f32 v6, v80, v81
    v_mfma_f32_16x16x32_bf16 v[98:101], a[120:123], v[64:67], 0
    v_cvt_pk_bf16_f32 v7, v82, v83
    v_add_u32 v137, s50, v137
    v_mfma_f32_16x16x32_bf16 v[98:101], a[124:127], v[52:55], v[98:101]
    ds_write_b32 v135, v119 offset:3084
    v_mfma_f32_16x16x32_bf16 v[98:101], a[128:131], v[40:43], v[98:101]
    v_cvt_pk_f16_f32 v56, v60, v61
    v_cvt_pk_f16_f32 v57, v62, v63
    v_mfma_f32_16x16x32_bf16 v[98:101], a[132:135], v[48:51], v[98:101]
    v_add_u32 v136, s50, v136
    v_add_u32 v135, s48, v135
    v_mfma_f32_16x16x32_bf16 v[98:101], a[136:139], v[32:35], v[98:101]
    v_add_u32 v133, s51, v133
    v_add_u32 v132, s14, v132
    v_mfma_f32_16x16x32_bf16 v[98:101], a[140:143], v[44:47], v[98:101]
    s_nop 0
    ds_write_b32 v134, v72 offset:3072
    v_mfma_f32_16x16x32_f16 v[76:79], v[212:215], v[36:39], 0
    s_nop 0
    v_pk_fma_f16 v37, v56, v56, s3
    v_pk_fmac_f16 v37, v57, v57
    v_mfma_f32_16x16x32_bf16 v[80:83], v[64:67], a[168:171], 0
    s_nop 0
    v_cvt_pk_f16_f32 v142, v98, v99
    v_cvt_pk_f16_f32 v143, v100, v101
    v_mfma_f32_16x16x32_bf16 v[80:83], v[52:55], a[172:175], v[80:83]
    v_or3_b32 v123, v123, v76, v77
    v_or3_b32 v123, v123, v78, v79
    v_mfma_f32_16x16x32_bf16 v[80:83], v[40:43], a[176:179], v[80:83]
    ds_write_b32 v134, v73 offset:3076
    v_mfma_f32_16x16x32_bf16 v[80:83], v[48:51], a[180:183], v[80:83]
    s_waitcnt vmcnt(0)
    v_rsq_f32 v76, v76
    v_mfma_f32_16x16x32_bf16 v[80:83], v[32:35], a[184:187], v[80:83]
    v_rsq_f32 v77, v77
    v_mfma_f32_16x16x32_bf16 v[80:83], v[44:47], a[188:191], v[80:83]
    v_mul_f32 v76, s52, v76
    v_cvt_pk_f16_f32 v76, v76, v77
    v_mfma_f32_16x16x32_bf16 v[98:101], v[64:67], a[144:147], 0
    v_rsq_f32 v78, v78
    v_mfma_f32_16x16x32_bf16 v[98:101], v[52:55], a[148:151], v[98:101]
    v_rsq_f32 v79, v79
    v_mfma_f32_16x16x32_bf16 v[98:101], v[40:43], a[152:155], v[98:101]
    v_mul_f32 v78, s52, v78
    v_cvt_pk_f16_f32 v78, v78, v79
    v_mfma_f32_16x16x32_bf16 v[98:101], v[48:51], a[156:159], v[98:101]
    v_pk_mul_f16 v8, v8, v78 op_sel:[0,1] op_sel_hi:[1,1]
    v_pk_mul_f16 v9, v9, v78 op_sel:[0,1] op_sel_hi:[1,1]
    v_mfma_f32_16x16x32_bf16 v[98:101], v[32:35], a[160:163], v[98:101]
    s_waitcnt lgkmcnt(0)
    v_pk_mul_f16 v10, v10, v78 op_sel:[0,1] op_sel_hi:[1,1]
    v_pk_mul_f16 v11, v11, v78 op_sel:[0,1] op_sel_hi:[1,1]
    v_mfma_f32_16x16x32_bf16 v[98:101], v[44:47], a[164:167], v[98:101]
    s_barrier
    v_pk_mul_f16 v148, v148, v78 op_sel:[0,1] op_sel_hi:[1,1]
    v_pk_mul_f16 v149, v149, v78 op_sel:[0,1] op_sel_hi:[1,1]
    v_mfma_f32_16x16x32_bf16 v[92:95], a[0:3], v[64:67], 0
    s_cmp_ge_u32 s61, s13
    v_pk_mul_f16 v12, v12, v76 op_sel:[0,1] op_sel_hi:[1,1]
    v_pk_mul_f16 v13, v13, v76 op_sel:[0,1] op_sel_hi:[1,1]
    v_mfma_f32_16x16x32_bf16 v[92:95], a[4:7], v[52:55], v[92:95]
L_pga:
    s_cbranch_scc1 L_atomF0
L_atomF0r:
    v_mfma_f32_16x16x32_bf16 v[92:95], a[8:11], v[40:43], v[92:95]
    ds_read_b128 v[60:63], v132 offset:16
    v_pk_mul_f16 v14, v14, v76 op_sel:[0,1] op_sel_hi:[1,1]
    v_mfma_f32_16x16x32_bf16 v[92:95], a[12:15], v[48:51], v[92:95]
    ds_read_b128 v[68:71], v132 offset:0
    v_pk_mul_f16 v15, v15, v76 op_sel:[0,1] op_sel_hi:[1,1]
    v_mfma_f32_16x16x32_bf16 v[92:95], a[16:19], v[32:35], v[92:95]
    v_pk_mul_f16 v154, v154, v76 op_sel:[0,1] op_sel_hi:[1,1]
    v_pk_mul_f16 v155, v155, v76 op_sel:[0,1] op_sel_hi:[1,1]
    v_mfma_f32_16x16x32_bf16 v[92:95], a[20:23], v[44:47], v[92:95]
    ds_read_b128 v[104:107], v133 offset:0
    v_pk_mul_f16 v28, v28, v76 op_sel:[0,0] op_sel_hi:[1,0]
    v_mfma_f32_16x16x32_bf16 v[116:119], a[48:51], v[64:67], 0
    v_pk_mul_f16 v29, v29, v76 op_sel:[0,0] op_sel_hi:[1,0]
    v_pk_mul_f16 v30, v30, v76 op_sel:[0,0] op_sel_hi:[1,0]
    v_mfma_f32_16x16x32_bf16 v[116:119], a[52:55], v[52:55], v[116:119]
    ds_read_b128 v[88:91], v133 offset:2048
    v_pk_mul_f16 v31, v31, v76 op_sel:[0,0] op_sel_hi:[1,0]
    v_mfma_f32_16x16x32_bf16 v[116:119], a[56:59], v[40:43], v[116:119]
    v_pk_mul_f16 v152, v152, v76 op_sel:[0,0] op_sel_hi:[1,0]
    v_pk_mul_f16 v153, v153, v76 op_sel:[0,0] op_sel_hi:[1,0]
    v_mfma_f32_16x16x32_bf16 v[116:119], a[60:63], v[48:51], v[116:119]
    ds_read_b128 v[72:75], v132 offset:48
    v_cvt_pk_f16_f32 v76, v92, v93
    v_mfma_f32_16x16x32_bf16 v[116:119], a[64:67], v[32:35], v[116:119]
    ds_read_b128 v[84:87], v137 offset:0
    v_cvt_pk_f16_f32 v77, v94, v95
    v_mfma_f32_16x16x32_bf16 v[116:119], a[68:71], v[44:47], v[116:119]
    v_pk_fma_f16 v36, v76, v76, s3
    v_pk_fmac_f16 v36, v77, v77
    v_mfma_f32_16x16x32_bf16 v[112:115], a[24:27], v[64:67], 0
    s_nop 0
    v_add_u32 v134, s48, v134
    v_add_u32 v131, s14, v131
    v_mfma_f32_16x16x32_bf16 v[112:115], a[28:31], v[52:55], v[112:115]
    s_nop 0
    v_cvt_pk_f16_f32 v140, v116, v117
    v_cvt_pk_f16_f32 v141, v118, v119
    v_mfma_f32_16x16x32_bf16 v[112:115], a[32:35], v[40:43], v[112:115]
    s_waitcnt lgkmcnt(3)
    buffer_load_dwordx4 v128, s[24:27], s56 offen nt lds
    v_pk_mul_f16 v24, v24, v78 op_sel:[0,0] op_sel_hi:[1,0]
    v_mfma_f32_16x16x32_bf16 v[112:115], a[36:39], v[48:51], v[112:115]
    ds_read_b128 v[92:95], v136 offset:128
    v_pk_mul_f16 v25, v25, v78 op_sel:[0,0] op_sel_hi:[1,0]
    v_mfma_f32_16x16x32_bf16 v[112:115], a[40:43], v[32:35], v[112:115]
    v_pk_mul_f16 v26, v26, v78 op_sel:[0,0] op_sel_hi:[1,0]
    v_pk_mul_f16 v27, v27, v78 op_sel:[0,0] op_sel_hi:[1,0]
    v_mfma_f32_16x16x32_bf16 v[112:115], a[44:47], v[44:47], v[112:115]
    v_pk_mul_f16 v146, v146, v78 op_sel:[0,0] op_sel_hi:[1,0]
    v_pk_mul_f16 v147, v147, v78 op_sel:[0,0] op_sel_hi:[1,0]
    v_mfma_f32_16x16x32_bf16 v[116:119], a[96:99], v[64:67], 0
    ds_read_b128 v[108:111], v133 offset:1024
    v_cvt_pk_bf16_f32 v164, v98, v99
    v_mfma_f32_16x16x32_bf16 v[116:119], a[100:103], v[52:55], v[116:119]
    s_nop 0
    ds_read_u16 v166, v131 offset:80
    v_cvt_pk_f16_f32 v78, v112, v113
    v_mfma_f32_16x16x32_bf16 v[116:119], a[104:107], v[40:43], v[116:119]
    ds_read_u16 v162, v131 offset:96
    v_cvt_pk_f16_f32 v79, v114, v115
    v_mfma_f32_16x16x32_bf16 v[116:119], a[108:111], v[48:51], v[116:119]
    ds_read_u16 v158, v131 offset:104
    v_pk_fmac_f16 v36, v78, v78
    v_mfma_f32_16x16x32_bf16 v[116:119], a[112:115], v[32:35], v[116:119]
    ds_read_b128 v[96:99], v137 offset:256
    v_pk_fmac_f16 v36, v79, v79
    v_mfma_f32_16x16x32_bf16 v[116:119], a[116:119], v[44:47], v[116:119]
    s_add_u32 m0, s67, 1024
    v_pk_fmac_f16 v36, v140, v140
    v_pk_fmac_f16 v36, v141, v141
    v_mfma_f32_16x16x32_bf16 v[112:115], v[64:67], a[192:195], 0
    ds_read_b128 v[64:67], v136 offset:0
    v_cvt_pk_bf16_f32 v165, v100, v101
    v_mfma_f32_16x16x32_bf16 v[112:115], v[52:55], a[196:199], v[112:115]
    ds_read_b128 v[52:55], v133 offset:3072
    v_cvt_pk_f16_f32 v58, v116, v117
    v_mfma_f32_16x16x32_bf16 v[112:115], v[40:43], a[200:203], v[112:115]
    ds_read_b128 v[40:43], v137 offset:128
    v_cvt_pk_f16_f32 v59, v118, v119
    v_mfma_f32_16x16x32_bf16 v[112:115], v[48:51], a[204:207], v[112:115]
    s_waitcnt lgkmcnt(7)
    buffer_store_dwordx4 v[104:107], v128, s[28:31], s60 offen sc1
    buffer_load_dwordx4 v127, s[24:27], s56 offen nt lds
    v_pk_fmac_f16 v37, v58, v58
    v_pk_fmac_f16 v37, v59, v59
    v_pk_fmac_f16 v37, v142, v142
    v_mfma_f32_16x16x32_bf16 v[112:115], v[32:35], a[208:211], v[112:115]
    v_pk_fmac_f16 v37, v143, v143
    v_cvt_pk_bf16_f32 v20, v16, v17
    v_mfma_f32_16x16x32_bf16 v[112:115], v[44:47], a[212:215], v[112:115]
    ds_read_b128 v[32:35], v136 offset:256
    v_cvt_pk_bf16_f32 v21, v18, v19
    v_mfma_f32_16x16x32_f16 v[16:19], v[212:215], v[36:39], 0
    s_nop 0
    v_cvt_pk_bf16_f32 v160, v80, v81
    v_cvt_pk_bf16_f32 v161, v82, v83
    v_mfma_f32_16x16x32_f16 v[36:39], v[8:11], v[28:31], v[200:203]
    s_nop 0
    v_cvt_pk_bf16_f32 v156, v112, v113
    v_cvt_pk_bf16_f32 v157, v114, v115
    v_mfma_f32_16x16x32_f16 v[36:39], v[146:149], v[150:153], v[36:39]
    s_add_u32 m0, s67, 2048
    v_or3_b32 v123, v123, v16, v17
    v_mfma_f32_16x16x32_bf16 v[48:51], a[216:219], v[84:87], 0
    s_waitcnt lgkmcnt(2)
    ds_read_b128 v[44:47], v133 offset:4096
    v_mfma_f32_16x16x32_bf16 v[48:51], a[220:223], v[64:67], v[48:51]
    s_waitcnt lgkmcnt(2)
    buffer_store_dwordx4 v[108:111], v127, s[28:31], s60 offen sc1
    buffer_load_dwordx4 v126, s[24:27], s56 offen nt lds
    v_rsq_f32 v16, v16
    v_mfma_f32_16x16x32_bf16 v[48:51], a[224:227], v[40:43], v[48:51]
    v_rsq_f32 v17, v17
    v_mfma_f32_16x16x32_bf16 v[48:51], a[228:231], v[92:95], v[48:51]
    v_exp_f32 v36, v36
    v_mfma_f32_16x16x32_bf16 v[48:51], a[232:235], v[96:99], v[48:51]
    s_waitcnt lgkmcnt(1)
    v_exp_f32 v37, v37
    v_mfma_f32_16x16x32_bf16 v[48:51], a[236:239], v[32:35], v[48:51]
    v_mul_f32 v16, s52, v16
    v_cvt_pk_f16_f32 v16, v16, v17
    v_mfma_f32_16x16x32_bf16 v[80:83], a[240:243], v[84:87], 0
    v_pk_mul_f16 v76, v76, v16 op_sel:[0,0] op_sel_hi:[1,0]
    v_pk_mul_f16 v77, v77, v16 op_sel:[0,0] op_sel_hi:[1,0]
    v_mfma_f32_16x16x32_bf16 v[80:83], a[244:247], v[64:67], v[80:83]
    v_pk_mul_f16 v78, v78, v16 op_sel:[0,0] op_sel_hi:[1,0]
    v_pk_mul_f16 v79, v79, v16 op_sel:[0,0] op_sel_hi:[1,0]
    v_mfma_f32_16x16x32_bf16 v[80:83], a[248:251], v[40:43], v[80:83]
    v_pk_mul_f16 v140, v140, v16 op_sel:[0,0] op_sel_hi:[1,0]
    v_pk_mul_f16 v141, v141, v16 op_sel:[0,0] op_sel_hi:[1,0]
    v_mfma_f32_16x16x32_bf16 v[80:83], a[252:255], v[92:95], v[80:83]
    v_pk_mul_f16 v56, v56, v16 op_sel:[0,1] op_sel_hi:[1,1]
    v_pk_mul_f16 v57, v57, v16 op_sel:[0,1] op_sel_hi:[1,1]
    v_mfma_f32_16x16x32_bf16 v[80:83], v[224:227], v[96:99], v[80:83]
    v_pk_mul_f16 v58, v58, v16 op_sel:[0,1] op_sel_hi:[1,1]
    v_pk_mul_f16 v59, v59, v16 op_sel:[0,1] op_sel_hi:[1,1]
    v_mfma_f32_16x16x32_bf16 v[80:83], v[228:231], v[32:35], v[80:83]
    s_add_u32 m0, s67, 3072
    buffer_store_dwordx4 v[88:91], v126, s[28:31], s60 offen sc1
    v_pk_mul_f16 v142, v142, v16 op_sel:[0,1] op_sel_hi:[1,1]
    v_pk_mul_f16 v143, v143, v16 op_sel:[0,1] op_sel_hi:[1,1]
    v_exp_f32 v38, v38
    v_mfma_f32_16x16x32_f16 v[16:19], v[68:71], v[28:31], v[208:211]
    v_exp_f32 v39, v39
    v_mfma_f32_16x16x32_f16 v[16:19], v[60:63], v[12:15], v[16:19]
    v_cvt_pk_bf16_f32 v36, v36, v37
    v_cvt_pk_bf16_f32 v37, v38, v39
    v_mfma_f32_16x16x32_f16 v[16:19], v[72:75], v[152:155], v[16:19]
    s_nop 0
    buffer_load_dwordx4 v125, s[24:27], s56 offen nt lds
    v_mfma_f32_16x16x32_f16 v[104:107], v[56:59], v[28:31], v[196:199]
    s_add_u32 m0, s67, 4096
    s_nop 1
    v_mfma_f32_16x16x32_f16 v[104:107], v[140:143], v[150:153], v[104:107]
    s_nop 0
    v_exp_f32 v16, v16
    v_mfma_f32_16x16x32_f16 v[88:91], v[12:15], v[28:31], v[204:207]
    s_nop 0
    v_cvt_pk_bf16_f32 v170, v16, 0
    s_nop 0
    v_mfma_f32_16x16x32_f16 v[88:91], v[152:155], v[150:153], v[88:91]
    s_nop 0
    v_exp_f32 v104, v104
    v_mfma_f32_16x16x32_bf16 v[116:119], v[232:235], v[84:87], 0
    s_waitcnt lgkmcnt(0)
    buffer_store_dwordx4 v[52:55], v125, s[28:31], s60 offen sc1
    buffer_load_dwordx4 v124, s[24:27], s56 offen nt lds
    v_exp_f32 v105, v105
    v_mfma_f32_16x16x32_bf16 v[116:119], v[236:239], v[64:67], v[116:119]
    v_exp_f32 v88, v88
    v_mfma_f32_16x16x32_bf16 v[116:119], v[240:243], v[40:43], v[116:119]
    v_exp_f32 v89, v89
    v_mfma_f32_16x16x32_bf16 v[116:119], v[244:247], v[92:95], v[116:119]
    v_exp_f32 v90, v90
    v_mfma_f32_16x16x32_bf16 v[116:119], v[248:251], v[96:99], v[116:119]
    v_exp_f32 v91, v91
    v_mfma_f32_16x16x32_bf16 v[116:119], v[252:255], v[32:35], v[116:119]
    v_cvt_pk_bf16_f32 v34, v88, v89
    v_cvt_pk_bf16_f32 v35, v90, v91
    v_mfma_f32_16x16x32_f16 v[28:31], v[56:59], v[24:27], v[184:187]
    v_exp_f32 v106, v106
    v_mfma_f32_16x16x32_f16 v[28:31], v[140:143], v[144:147], v[28:31]
    v_exp_f32 v107, v107
    v_mfma_f32_16x16x32_f16 v[40:43], v[56:59], v[76:79], v[172:175]
    buffer_store_dwordx4 v[44:47], v124, s[28:31], s60 offen sc1
    v_cvt_pk_bf16_f32 v168, v104, v105
    v_cvt_pk_bf16_f32 v169, v106, v107
    s_nop 0
    v_mfma_f32_16x16x32_f16 v[40:43], v[140:143], v[138:141], v[40:43]
    s_mov_b32 s53, s47
    v_exp_f32 v28, v28
    v_mfma_f32_16x16x32_f16 v[44:47], v[12:15], v[24:27], v[192:195]
    s_mov_b32 s47, s46
    v_exp_f32 v29, v29
    v_mfma_f32_16x16x32_f16 v[44:47], v[152:155], v[144:147], v[44:47]
    s_mov_b32 s46, s45
    v_exp_f32 v30, v30
    v_mfma_f32_16x16x32_f16 v[52:55], v[68:71], v[76:79], v[208:211]
    s_mov_b32 s45, s44
    v_exp_f32 v31, v31
    v_mfma_f32_16x16x32_f16 v[52:55], v[60:63], v[56:59], v[52:55]
    s_mov_b32 s44, s53
    v_exp_f32 v40, v40
    v_mfma_f32_16x16x32_f16 v[52:55], v[72:75], v[140:143], v[52:55]
    s_sub_u32 s48, s44, s46
    v_exp_f32 v44, v44
    v_mfma_f32_16x16x32_f16 v[64:67], v[68:71], v[24:27], v[208:211]
    s_sub_u32 s49, s46, s45
    v_exp_f32 v45, v45
    v_mfma_f32_16x16x32_f16 v[64:67], v[60:63], v[8:11], v[64:67]
    s_cmp_lg_u32 s5, -1
    v_exp_f32 v46, v46
    v_mfma_f32_16x16x32_f16 v[64:67], v[72:75], v[146:149], v[64:67]
    ds_read_b128 v[60:63], v136 offset:1536
    v_cvt_pk_bf16_f32 v16, v44, v45
    v_mfma_f32_16x16x32_bf16 v[98:101], v[220:223], v[34:37], 0
    ds_read_b128 v[68:71], v137 offset:1664
    v_fma_f32 v32, v48, v48, s42
    v_mfma_f32_16x16x32_bf16 v[98:101], v[220:223], v[168:171], v[98:101]
    s_nop 0
    ds_read_b128 v[88:91], v137 offset:1536
    v_mov_b32_dpp v19, v67 quad_perm:[0,1,2,3] row_mask:0x2 bank_mask:0xf
    v_mfma_f32_16x16x32_bf16 v[104:107], v[0:3], v[34:37], 0
    ds_read_b128 v[72:75], v136 offset:1664
    v_mov_b32_dpp v19, v55 quad_perm:[0,1,2,3] row_mask:0x4 bank_mask:0xf
    v_mfma_f32_16x16x32_bf16 v[104:107], v[164:167], v[168:171], v[104:107]
    ds_read_b128 v[84:87], v136 offset:1792
    v_fmac_f32 v32, v49, v49
    v_mfma_f32_16x16x32_bf16 v[92:95], v[20:23], v[34:37], 0
    v_exp_f32 v47, v47
    v_mfma_f32_16x16x32_bf16 v[92:95], v[160:163], v[168:171], v[92:95]
    v_cvt_pk_bf16_f32 v17, v46, v47
    v_fmac_f32 v32, v50, v50
    v_mfma_f32_16x16x32_bf16 v[44:47], v[4:7], v[34:37], 0
    ds_read_b128 v[36:39], v137 offset:1792
    v_fmac_f32 v32, v51, v51
    v_mfma_f32_16x16x32_bf16 v[44:47], v[156:159], v[168:171], v[44:47]
    v_exp_f32 v65, v65
    v_mfma_f32_16x16x32_f16 v[108:111], v[12:15], v[76:79], v[180:183]
    v_exp_f32 v19, v19
    v_mfma_f32_16x16x32_f16 v[108:111], v[152:155], v[138:141], v[108:111]
    v_cvt_pk_bf16_f32 v19, v19, v19
    v_cvt_pk_bf16_f32 v168, v28, v29
    v_mfma_f32_16x16x32_f16 v[152:155], v[8:11], v[76:79], v[176:179]
    ds_write_b16 v131, v19 offset:64
    v_mfma_f32_16x16x32_f16 v[152:155], v[146:149], v[138:141], v[152:155]
    s_waitcnt lgkmcnt(3)
    v_rcp_f32 v98, v98
    v_mfma_f32_16x16x32_bf16 v[140:143], a[216:219], v[88:91], 0
    v_mul_f32 v104, v104, v98
    v_mul_f32 v105, v105, v98
    v_mfma_f32_16x16x32_bf16 v[140:143], a[220:223], v[60:63], v[140:143]
    ds_read_b128 v[12:15], v132 offset:48
    v_cvt_pk_bf16_f32 v104, v104, v105
    v_mfma_f32_16x16x32_bf16 v[140:143], a[224:227], v[68:71], v[140:143]
    ds_read_b128 v[76:79], v132 offset:64
    v_mul_f32 v106, v106, v98
    v_mfma_f32_16x16x32_bf16 v[140:143], a[228:231], v[72:75], v[140:143]
    s_waitcnt lgkmcnt(3)
    v_mul_f32 v107, v107, v98
    v_cvt_pk_bf16_f32 v105, v106, v107
    v_mfma_f32_16x16x32_bf16 v[140:143], a[232:235], v[36:39], v[140:143]
    v_mul_f32 v92, v92, v98
    v_mul_f32 v93, v93, v98
    v_mfma_f32_16x16x32_bf16 v[140:143], a[236:239], v[84:87], v[140:143]
    v_cvt_pk_bf16_f32 v106, v92, v93
    v_mul_f32 v94, v94, v98
    v_mfma_f32_16x16x32_bf16 v[56:59], v[232:235], v[88:91], 0
    ds_write_b64 v135, v[104:105] offset:0
    v_mfma_f32_16x16x32_bf16 v[56:59], v[236:239], v[60:63], v[56:59]
    v_mul_f32 v95, v95, v98
    v_cvt_pk_bf16_f32 v107, v94, v95
    v_mfma_f32_16x16x32_bf16 v[56:59], v[240:243], v[68:71], v[56:59]
    v_mul_f32 v44, v44, v98
    v_mul_f32 v45, v45, v98
    v_mfma_f32_16x16x32_bf16 v[56:59], v[244:247], v[72:75], v[56:59]
    ds_read_b128 v[92:95], v137 offset:3200
    v_cvt_pk_bf16_f32 v18, v44, v45
    v_mfma_f32_16x16x32_bf16 v[56:59], v[248:251], v[36:39], v[56:59]
    v_mul_f32 v46, v46, v98
    v_mul_f32 v47, v47, v98
    v_mfma_f32_16x16x32_bf16 v[56:59], v[252:255], v[84:87], v[56:59]
    s_waitcnt lgkmcnt(2)
    v_cvt_pk_bf16_f32 v19, v46, v47
    v_cvt_pk_bf16_f32 v169, v30, v31
    v_mfma_f32_16x16x32_bf16 v[28:31], v[12:15], v[0:3], 0
    v_cvt_pk_bf16_f32 v170, v65, 0
    v_fmac_f32 v32, v80, v80
    v_mfma_f32_16x16x32_bf16 v[28:31], v[76:79], v[164:167], v[28:31]
    ds_write_b64 v135, v[106:107] offset:8
    v_mfma_f32_16x16x32_bf16 v[44:47], v[12:15], v[20:23], 0
    v_exp_f32 v41, v41
    v_mfma_f32_16x16x32_bf16 v[44:47], v[76:79], v[160:163], v[44:47]
    v_exp_f32 v42, v42
    v_mfma_f32_16x16x32_bf16 v[64:67], v[12:15], v[4:7], 0
    s_nop 0
    ds_read_b128 v[12:15], v137 offset:3072
    v_fmac_f32 v32, v81, v81
    v_mfma_f32_16x16x32_bf16 v[64:67], v[76:79], v[156:159], v[64:67]
    s_nop 0
    ds_read_b128 v[98:101], v136 offset:3072
    v_mov_b32_dpp v31, v47 quad_perm:[0,1,2,3] row_mask:0x2 bank_mask:0xf
    v_mfma_f32_16x16x32_bf16 v[44:47], a[240:243], v[88:91], 0
    ds_read_b128 v[104:107], v136 offset:3200
    v_fmac_f32 v32, v82, v82
    v_mfma_f32_16x16x32_bf16 v[44:47], a[244:247], v[60:63], v[44:47]
    s_nop 0
    ds_read_b128 v[62:65], v137 offset:3328
    v_mov_b32_dpp v31, v67 quad_perm:[0,1,2,3] row_mask:0x4 bank_mask:0xf
    v_mfma_f32_16x16x32_bf16 v[44:47], a[248:251], v[68:71], v[44:47]
    ds_read_b128 v[66:69], v136 offset:3328
    v_cvt_pk_bf16_f32 v31, v31, v31
    v_mfma_f32_16x16x32_bf16 v[44:47], a[252:255], v[72:75], v[44:47]
    v_exp_f32 v43, v43
    v_mfma_f32_16x16x32_bf16 v[44:47], v[224:227], v[36:39], v[44:47]
    v_exp_f32 v54, v54
    v_mfma_f32_16x16x32_bf16 v[44:47], v[228:231], v[84:87], v[44:47]
    v_exp_f32 v152, v152
    v_mfma_f32_16x16x32_f16 v[36:39], v[8:11], v[24:27], v[188:191]
    ds_write_b16 v131, v31
    v_mfma_f32_16x16x32_f16 v[36:39], v[146:149], v[144:147], v[36:39]
    s_waitcnt lgkmcnt(5)
    v_exp_f32 v153, v153
    v_mfma_f32_16x16x32_bf16 v[88:91], a[240:243], v[12:15], 0
    s_waitcnt lgkmcnt(4)
    v_exp_f32 v154, v154
    v_mfma_f32_16x16x32_bf16 v[88:91], a[244:247], v[98:101], v[88:91]
    v_exp_f32 v155, v155
    v_mfma_f32_16x16x32_bf16 v[88:91], a[248:251], v[92:95], v[88:91]
    s_waitcnt lgkmcnt(2)
    ds_write_b32 v134, v18 offset:0
    v_mfma_f32_16x16x32_bf16 v[88:91], a[252:255], v[104:107], v[88:91]
    v_cvt_pk_bf16_f32 v30, v152, v153
    v_cvt_pk_bf16_f32 v31, v154, v155
    v_mfma_f32_16x16x32_bf16 v[88:91], v[224:227], v[62:65], v[88:91]
    s_waitcnt lgkmcnt(2)
    v_exp_f32 v36, v36
    v_mfma_f32_16x16x32_bf16 v[88:91], v[228:231], v[66:69], v[88:91]
    v_exp_f32 v37, v37
    v_mfma_f32_16x16x32_bf16 v[24:27], a[216:219], v[12:15], 0
    ds_write_b32 v134, v19 offset:4
    v_mfma_f32_16x16x32_bf16 v[24:27], a[220:223], v[98:101], v[24:27]
    v_exp_f32 v38, v38
    v_mfma_f32_16x16x32_bf16 v[24:27], a[224:227], v[92:95], v[24:27]
    v_exp_f32 v39, v39
    v_mfma_f32_16x16x32_bf16 v[24:27], a[228:231], v[104:107], v[24:27]
    v_cvt_pk_bf16_f32 v18, v36, v37
    v_cvt_pk_bf16_f32 v19, v38, v39
    v_mfma_f32_16x16x32_bf16 v[24:27], a[232:235], v[62:65], v[24:27]
    v_exp_f32 v108, v108
    v_mfma_f32_16x16x32_bf16 v[24:27], a[236:239], v[66:69], v[24:27]
    v_exp_f32 v109, v109
    v_mfma_f32_16x16x32_bf16 v[152:155], v[220:223], v[16:19], 0
    v_exp_f32 v110, v110
    v_mfma_f32_16x16x32_bf16 v[152:155], v[220:223], v[168:171], v[152:155]
    s_nop 0
    v_exp_f32 v111, v111
    v_mfma_f32_16x16x32_bf16 v[36:39], v[0:3], v[16:19], 0
    s_nop 0
    v_cvt_pk_bf16_f32 v28, v108, v109
    v_cvt_pk_bf16_f32 v29, v110, v111
    v_mfma_f32_16x16x32_bf16 v[36:39], v[164:167], v[168:171], v[36:39]
    s_nop 0
    v_rcp_f32 v152, v152
    v_mfma_f32_16x16x32_bf16 v[146:149], v[20:23], v[16:19], 0
    v_add_u32 v137, s48, v137
    v_add_u32 v136, s48, v136
    v_mfma_f32_16x16x32_bf16 v[146:149], v[160:163], v[168:171], v[146:149]
    s_nop 0
    ds_read_b128 v[84:87], v137 offset:0
    v_mul_f32 v36, v36, v152
    v_mfma_f32_16x16x32_bf16 v[76:79], v[4:7], v[16:19], 0
    ds_read_b128 v[108:111], v136 offset:0
    v_mul_f32 v37, v37, v152
    v_mfma_f32_16x16x32_bf16 v[76:79], v[156:159], v[168:171], v[76:79]
    ds_read_b128 v[8:11], v137 offset:128
    v_cvt_pk_bf16_f32 v168, v40, v41
    v_mfma_f32_16x16x32_bf16 v[72:75], v[232:235], v[12:15], 0
    ds_read_b128 v[112:115], v136 offset:128
    v_cvt_pk_bf16_f32 v169, v42, v43
    v_mfma_f32_16x16x32_bf16 v[72:75], v[236:239], v[98:101], v[72:75]
    ds_read_b128 v[40:43], v137 offset:256
    v_cvt_pk_bf16_f32 v170, v54, 0
    v_mfma_f32_16x16x32_bf16 v[72:75], v[240:243], v[92:95], v[72:75]
    ds_read_b128 v[52:55], v136 offset:256
    v_cvt_pk_bf16_f32 v12, v36, v37
    v_mfma_f32_16x16x32_bf16 v[72:75], v[244:247], v[104:107], v[72:75]
    ds_read_b128 v[104:107], v136 offset:1792
    v_mul_f32 v38, v38, v152
    v_mfma_f32_16x16x32_bf16 v[72:75], v[248:251], v[62:65], v[72:75]
    ds_read_b128 v[60:63], v136 offset:1536
    v_mul_f32 v39, v39, v152
    v_mfma_f32_16x16x32_bf16 v[72:75], v[252:255], v[66:69], v[72:75]
    ds_read_b128 v[98:101], v137 offset:1664
    v_cvt_pk_bf16_f32 v13, v38, v39
    v_mfma_f32_16x16x32_bf16 v[36:39], v[220:223], v[28:31], 0
    ds_read_b128 v[68:71], v137 offset:1536
    v_mul_f32 v146, v146, v152
    v_mfma_f32_16x16x32_bf16 v[36:39], v[220:223], v[168:171], v[36:39]
    v_mul_f32 v147, v147, v152
    v_cvt_pk_bf16_f32 v14, v146, v147
    v_mfma_f32_16x16x32_bf16 v[64:67], v[0:3], v[28:31], 0
    v_mul_f32 v148, v148, v152
    v_mul_f32 v149, v149, v152
    v_mfma_f32_16x16x32_bf16 v[64:67], v[164:167], v[168:171], v[64:67]
    v_cvt_pk_bf16_f32 v15, v148, v149
    v_mul_f32 v76, v76, v152
    v_mfma_f32_16x16x32_bf16 v[0:3], v[20:23], v[28:31], 0
    ds_write_b32 v135, v12 offset:1536
    v_mfma_f32_16x16x32_bf16 v[0:3], v[160:163], v[168:171], v[0:3]
    v_mul_f32 v77, v77, v152
    v_cvt_pk_bf16_f32 v154, v76, v77
    v_mfma_f32_16x16x32_bf16 v[146:149], v[4:7], v[28:31], 0
    v_mul_f32 v78, v78, v152
    v_mul_f32 v79, v79, v152
    v_mfma_f32_16x16x32_bf16 v[146:149], v[156:159], v[168:171], v[146:149]
    s_waitcnt lgkmcnt(3)
    v_cvt_pk_bf16_f32 v155, v78, v79
    v_fmac_f32 v32, v83, v83
    v_mfma_f32_16x16x32_bf16 v[28:31], a[0:3], v[84:87], 0
    s_cbranch_scc1 L_loopF0
    ds_write_b32 v135, v13 offset:1540
    v_rcp_f32 v36, v36
    s_mov_b32 s30, 100270464
    s_mul_i32 s89, s68, 7168
    ds_write_b64 v135, v[14:15] offset:1544
    v_mul_f32 v64, v64, v36
    v_mul_f32 v65, v65, v36
    v_cvt_pk_bf16_f32 v4, v64, v65
    s_add_u32 s89, s89, 135168
    s_movk_i32 s90, 112
    ds_write_b64 v134, v[154:155] offset:1536
    v_mul_f32 v66, v66, v36
    v_mul_f32 v67, v67, v36
    v_cvt_pk_bf16_f32 v5, v66, v67
    v_mul_f32 v0, v0, v36
    v_mul_f32 v1, v1, v36
    v_cvt_pk_bf16_f32 v6, v0, v1
    v_mul_f32 v2, v2, v36
    v_mul_f32 v3, v3, v36
    v_cvt_pk_bf16_f32 v7, v2, v3
    v_mul_f32 v146, v146, v36
    v_mul_f32 v147, v147, v36
    v_cvt_pk_bf16_f32 v120, v146, v147
    v_mul_f32 v148, v148, v36
    v_mul_f32 v149, v149, v36
    v_cvt_pk_bf16_f32 v121, v148, v149
    s_lshr_b32 s91, s64, 16
    s_lshl_b32 s92, s68, 10
    ds_write_b64 v135, v[4:5] offset:3072
    v_fmac_f32 v32, v116, v116
    s_sub_u32 s84, s45, s44
    s_sub_u32 s85, s46, s45
    ds_write_b64 v135, v[6:7] offset:3080
    v_fmac_f32 v32, v117, v117
    v_fmac_f32 v32, v118, v118
    v_fmac_f32 v32, v119, v119
    s_sub_u32 s86, s44, s45
    s_sub_u32 s93, s44, s47
    ds_write_b32 v134, v120 offset:3072
    ds_write_b32 v134, v121 offset:3076
    v_fma_f32 v131, v140, v140, s42
    v_fmac_f32 v131, v141, v141
    v_fmac_f32 v131, v142, v142
    v_fmac_f32 v131, v143, v143
    v_fmac_f32 v131, v44, v44
    v_fmac_f32 v131, v45, v45
    v_fmac_f32 v131, v46, v46
    v_fmac_f32 v131, v47, v47
    v_fmac_f32 v131, v56, v56
    v_fmac_f32 v131, v57, v57
    v_fmac_f32 v131, v58, v58
    v_fmac_f32 v131, v59, v59
    v_fma_f32 v121, v24, v24, s42
    v_fmac_f32 v121, v25, v25
    v_fmac_f32 v121, v26, v26
    v_fmac_f32 v121, v27, v27
    v_fmac_f32 v121, v88, v88
    v_fmac_f32 v121, v89, v89
    v_fmac_f32 v121, v90, v90
    v_fmac_f32 v121, v91, v91
    v_fmac_f32 v121, v72, v72
    v_fmac_f32 v121, v73, v73
    v_fmac_f32 v121, v74, v74
    v_fmac_f32 v121, v75, v75
    v_cvt_pk_bf16_f32 v120, v32, v131
    v_cvt_pk_bf16_f32 v121, v121, v122
    s_sub_u32 s94, s45, s47
    s_sub_u32 s95, s46, s47
    ds_write_b64 v130, v[120:121]
    v_mbcnt_lo_u32_b32 v131, -1, 0
    v_mbcnt_hi_u32_b32 v131, -1, v131
    v_and_b32 v138, 15, v131
    v_lshrrev_b32 v131, 4, v131
    v_mul_u32_u24 v131, 1792, v131
    v_add_u32 v131, s89, v131
    v_mad_u32_u24 v132, v138, s90, v131
    v_lshrrev_b32 v139, v138, s64
    v_and_b32 v139, 1, v139
    v_cmp_eq_u32 vcc, 1, v139
    v_mad_u32_u24 v52, v138, s90, v131
    v_lshrrev_b32 v138, v138, s91
    v_cndmask_b32 v132, v131, v132, vcc
    v_and_b32 v138, 1, v138
    v_subrev_u32 v52, 28672, v52
    v_cmp_eq_u32 vcc, 1, v138
    ds_read_b128 v[20:23], v132 offset:64
    ds_read_b128 v[16:19], v132 offset:80
    v_cndmask_b32 v52, v131, v52, vcc
    v_add_u32 v131, s92, v129
    s_waitcnt lgkmcnt(2)
    s_barrier
    ds_read_b128 v[98:101], v132
    v_add_u32 v54, s84, v137
    ds_read_b64 v[102:103], v132 offset:16
    ds_read_b128 v[4:7], v131 offset:6144
    v_add_u32 v53, s84, v136
    v_add_u32 v120, s85, v135
    ds_read_b128 v[8:11], v129 offset:0
    v_add_u32 v55, s85, v134
    ds_read_b128 v[0:3], v129 offset:1024
    v_add_u32 v138, s86, v135
    v_add_u32 v132, s86, v134
    v_add_u32 v131, s93, v133
    v_add_u32 v139, s94, v133
    s_waitcnt lgkmcnt(6)
    v_mfma_f32_16x16x32_bf16 v[12:15], v[220:223], v[20:23], 0
    s_waitcnt lgkmcnt(5)
    ds_read_b128 v[92:95], v54 offset:1536
    ds_read_b128 v[68:71], v53 offset:1536
    v_mfma_f32_16x16x32_bf16 v[12:15], v[220:223], v[16:19], v[12:15]
    s_waitcnt lgkmcnt(3)
    ds_read_b128 v[64:67], v54 offset:1664
    v_lshlrev_b32 v76, 16, v98
    v_and_b32 v98, 0xffff0000, v98
    v_lshlrev_b32 v77, 16, v99
    v_and_b32 v99, 0xffff0000, v99
    v_lshlrev_b32 v78, 16, v100
    v_and_b32 v100, 0xffff0000, v100
    v_rcp_f32 v12, v12
    v_lshlrev_b32 v79, 16, v101
    v_mfma_f32_16x16x32_bf16 v[16:19], v[216:219], v[8:11], 0
    s_waitcnt lgkmcnt(3)
    ds_read_b128 v[60:63], v53 offset:1664
    ds_read_b128 v[40:43], v54 offset:1792
    v_mfma_f32_16x16x32_bf16 v[16:19], v[216:219], v[0:3], v[16:19]
    s_waitcnt lgkmcnt(4)
    ds_read_b128 v[28:31], v53 offset:1792
    v_mul_f32 v76, v76, v12
    v_mul_f32 v98, v98, v12
    v_cvt_pk_bf16_f32 v76, v76, v98
    v_mul_f32 v77, v77, v12
    v_mfma_f32_16x16x32_bf16 v[8:11], a[216:219], v[92:95], 0
    s_waitcnt lgkmcnt(4)
    v_mul_f32 v99, v99, v12
    v_cvt_pk_bf16_f32 v77, v77, v99
    v_mfma_f32_16x16x32_bf16 v[8:11], a[220:223], v[68:71], v[8:11]
    s_waitcnt lgkmcnt(3)
    ds_read_b128 v[108:111], v54 offset:0
    ds_read_b128 v[96:99], v53 offset:0
    v_mfma_f32_16x16x32_bf16 v[8:11], a[224:227], v[64:67], v[8:11]
    s_waitcnt lgkmcnt(4)
    ds_read_b128 v[84:87], v54 offset:128
    v_mul_f32 v78, v78, v12
    v_mul_f32 v100, v100, v12
    v_cvt_pk_bf16_f32 v78, v78, v100
    v_and_b32 v101, 0xffff0000, v101
    v_mul_f32 v79, v79, v12
    v_mfma_f32_16x16x32_bf16 v[8:11], a[228:231], v[60:63], v[8:11]
    s_waitcnt lgkmcnt(4)
    ds_read_b128 v[36:39], v53 offset:128
    ds_read_b128 v[20:23], v54 offset:256
    v_mfma_f32_16x16x32_bf16 v[8:11], a[232:235], v[40:43], v[8:11]
    s_waitcnt lgkmcnt(5)
    ds_read_b128 v[0:3], v53 offset:256
    v_mul_f32 v101, v101, v12
    v_mfma_f32_16x16x32_bf16 v[8:11], a[236:239], v[28:31], v[8:11]
    v_cvt_pk_bf16_f32 v79, v79, v101
    v_lshlrev_b32 v19, 16, v102
    v_mfma_f32_16x16x32_bf16 v[32:35], a[240:243], v[92:95], 0
    ds_write_b128 v138, v[76:79] offset:0
    v_mfma_f32_16x16x32_bf16 v[32:35], a[244:247], v[68:71], v[32:35]
    v_and_b32 v102, 0xffff0000, v102
    v_mul_f32 v19, v19, v12
    v_mfma_f32_16x16x32_bf16 v[32:35], a[248:251], v[64:67], v[32:35]
    v_mul_f32 v102, v102, v12
    v_cvt_pk_bf16_f32 v76, v19, v102
    v_mfma_f32_16x16x32_bf16 v[32:35], a[252:255], v[60:63], v[32:35]
    v_lshlrev_b32 v19, 16, v103
    v_and_b32 v103, 0xffff0000, v103
    v_mfma_f32_16x16x32_bf16 v[32:35], v[224:227], v[40:43], v[32:35]
    v_mul_f32 v19, v19, v12
    v_mul_f32 v103, v103, v12
    v_mfma_f32_16x16x32_bf16 v[32:35], v[228:231], v[28:31], v[32:35]
    v_cvt_pk_bf16_f32 v77, v19, v103
    v_lshrrev_b32 v19, 0, v7
    v_mfma_f32_16x16x32_bf16 v[12:15], v[232:235], v[92:95], 0
    ds_write_b64 v132, v[76:77] offset:0
    v_mfma_f32_16x16x32_bf16 v[12:15], v[236:239], v[68:71], v[12:15]
    v_lshrrev_b32 v19, v19, s64
    v_and_b32 v19, 1, v19
    v_mfma_f32_16x16x32_bf16 v[12:15], v[240:243], v[64:67], v[12:15]
    v_cmp_eq_u32 vcc, 1, v19
    v_lshrrev_b32 v19, 8, v7
    v_mfma_f32_16x16x32_bf16 v[12:15], v[244:247], v[60:63], v[12:15]
    v_cndmask_b32 v4, 2.0, v4, vcc
    v_lshrrev_b32 v19, v19, s64
    v_mfma_f32_16x16x32_bf16 v[12:15], v[248:251], v[40:43], v[12:15]
    v_and_b32 v19, 1, v19
    v_cmp_eq_u32 vcc, 1, v19
    v_mfma_f32_16x16x32_bf16 v[12:15], v[252:255], v[28:31], v[12:15]
    s_waitcnt lgkmcnt(1)
    v_cndmask_b32 v5, 2.0, v5, vcc
    v_lshrrev_b32 v7, 16, v7
    v_mfma_f32_16x16x32_bf16 v[68:71], a[216:219], v[108:111], 0
    v_lshrrev_b32 v7, v7, s64
    v_and_b32 v7, 1, v7
    v_mfma_f32_16x16x32_bf16 v[68:71], a[220:223], v[96:99], v[68:71]
    ds_read_b128 v[104:107], v54 offset:3072
    ds_read_b128 v[100:103], v53 offset:3072
    v_mfma_f32_16x16x32_bf16 v[68:71], a[224:227], v[84:87], v[68:71]
    ds_read_b128 v[92:95], v54 offset:3200
    v_cmp_eq_u32 vcc, 1, v7
    v_mfma_f32_16x16x32_bf16 v[68:71], a[228:231], v[36:39], v[68:71]
    ds_read_b128 v[64:67], v53 offset:3200
    v_cndmask_b32 v6, 2.0, v6, vcc
    v_mfma_f32_16x16x32_bf16 v[68:71], a[232:235], v[20:23], v[68:71]
L_pg2:
    s_cbranch_execz L_main
    ds_read_b128 v[60:63], v54 offset:3328
    v_add_u32 v7, s95, v133
    v_mfma_f32_16x16x32_bf16 v[68:71], a[236:239], v[0:3], v[68:71]
    ds_read_b128 v[28:31], v53 offset:3328
    v_fma_f32 v133, v8, v8, s42
    v_mfma_f32_16x16x32_bf16 v[76:79], a[240:243], v[108:111], 0
    v_rsq_f32 v16, v16
    v_mfma_f32_16x16x32_bf16 v[76:79], a[244:247], v[96:99], v[76:79]
    v_mul_f32 v16, s43, v16
    v_mul_f32 v48, v48, v16
    v_mfma_f32_16x16x32_bf16 v[76:79], a[248:251], v[84:87], v[76:79]
    v_mul_f32 v49, v49, v16
    v_cvt_pk_bf16_f32 v48, v48, v49
    v_mfma_f32_16x16x32_bf16 v[76:79], a[252:255], v[36:39], v[76:79]
    v_mul_f32 v50, v50, v16
    v_mul_f32 v51, v51, v16
    v_mfma_f32_16x16x32_bf16 v[76:79], v[224:227], v[20:23], v[76:79]
    v_cvt_pk_bf16_f32 v49, v50, v51
    v_mul_f32 v80, v80, v16
    v_mfma_f32_16x16x32_bf16 v[76:79], v[228:231], v[0:3], v[76:79]
    v_mul_f32 v81, v81, v16
    v_cvt_pk_bf16_f32 v50, v80, v81
    v_mfma_f32_16x16x32_bf16 v[40:43], v[232:235], v[108:111], 0
    v_mul_f32 v82, v82, v16
    v_mul_f32 v83, v83, v16
    v_mfma_f32_16x16x32_bf16 v[40:43], v[236:239], v[96:99], v[40:43]
    v_cvt_pk_bf16_f32 v51, v82, v83
    v_mul_f32 v116, v116, v16
    v_mfma_f32_16x16x32_bf16 v[40:43], v[240:243], v[84:87], v[40:43]
    ds_write_b128 v120, v[48:51] offset:0
    v_mfma_f32_16x16x32_bf16 v[40:43], v[244:247], v[36:39], v[40:43]
    v_mul_f32 v117, v117, v16
    v_cvt_pk_bf16_f32 v116, v116, v117
    v_mfma_f32_16x16x32_bf16 v[40:43], v[248:251], v[20:23], v[40:43]
    v_mul_f32 v118, v118, v16
    v_mul_f32 v119, v119, v16
    v_mfma_f32_16x16x32_bf16 v[40:43], v[252:255], v[0:3], v[40:43]
    s_waitcnt lgkmcnt(1)
    v_cvt_pk_bf16_f32 v117, v118, v119
    v_fma_f32 v54, v68, v68, s42
    v_mfma_f32_16x16x32_bf16 v[20:23], a[216:219], v[104:107], 0
    ds_write_b64 v55, v[116:117] offset:0
    v_mfma_f32_16x16x32_bf16 v[20:23], a[220:223], v[100:103], v[20:23]
    ds_read_b128 v[36:39], v52 offset:64
    v_fmac_f32 v54, v69, v69
    v_mfma_f32_16x16x32_bf16 v[20:23], a[224:227], v[92:95], v[20:23]
    ds_read_b128 v[0:3], v52 offset:80
    v_fmac_f32 v54, v70, v70
    v_mfma_f32_16x16x32_bf16 v[20:23], a[228:231], v[64:67], v[20:23]
    ds_read_b128 v[48:51], v52
    v_fmac_f32 v54, v71, v71
    v_mfma_f32_16x16x32_bf16 v[20:23], a[232:235], v[60:63], v[20:23]
    ds_read_b64 v[52:53], v52 offset:16
    v_fmac_f32 v54, v76, v76
    v_mfma_f32_16x16x32_bf16 v[20:23], a[236:239], v[28:31], v[20:23]
    v_rsq_f32 v17, v17
    v_mfma_f32_16x16x32_bf16 v[96:99], a[240:243], v[104:107], 0
    v_mul_f32 v17, s43, v17
    v_mul_f32 v140, v140, v17
    v_mfma_f32_16x16x32_bf16 v[96:99], a[244:247], v[100:103], v[96:99]
    v_mul_f32 v141, v141, v17
    v_cvt_pk_bf16_f32 v84, v140, v141
    v_mfma_f32_16x16x32_bf16 v[96:99], a[248:251], v[92:95], v[96:99]
    v_mul_f32 v142, v142, v17
    v_mul_f32 v143, v143, v17
    v_mfma_f32_16x16x32_bf16 v[96:99], a[252:255], v[64:67], v[96:99]
    v_cvt_pk_bf16_f32 v85, v142, v143
    v_mul_f32 v44, v44, v17
    v_mfma_f32_16x16x32_bf16 v[96:99], v[224:227], v[60:63], v[96:99]
    v_mul_f32 v45, v45, v17
    v_cvt_pk_bf16_f32 v86, v44, v45
    v_mfma_f32_16x16x32_bf16 v[96:99], v[228:231], v[28:31], v[96:99]
    v_mul_f32 v46, v46, v17
    v_mul_f32 v47, v47, v17
    v_mfma_f32_16x16x32_bf16 v[80:83], v[232:235], v[104:107], 0
    v_cvt_pk_bf16_f32 v87, v46, v47
    v_mul_f32 v56, v56, v17
    v_mfma_f32_16x16x32_bf16 v[80:83], v[236:239], v[100:103], v[80:83]
    ds_write_b128 v120, v[84:87] offset:1536
    v_mfma_f32_16x16x32_bf16 v[80:83], v[240:243], v[92:95], v[80:83]
    v_mul_f32 v57, v57, v17
    v_cvt_pk_bf16_f32 v56, v56, v57
    v_mfma_f32_16x16x32_bf16 v[80:83], v[244:247], v[64:67], v[80:83]
    v_mul_f32 v58, v58, v17
    v_mul_f32 v59, v59, v17
    v_mfma_f32_16x16x32_bf16 v[80:83], v[248:251], v[60:63], v[80:83]
    v_cvt_pk_bf16_f32 v57, v58, v59
    v_fmac_f32 v54, v77, v77
    v_mfma_f32_16x16x32_bf16 v[80:83], v[252:255], v[28:31], v[80:83]
    s_waitcnt lgkmcnt(1)
    ds_write_b64 v55, v[56:57] offset:1536
    v_mfma_f32_16x16x32_bf16 v[28:31], v[220:223], v[36:39], 0
    v_rsq_f32 v18, v18
    v_mfma_f32_16x16x32_bf16 v[28:31], v[220:223], v[0:3], v[28:31]
    v_mul_f32 v18, s43, v18
    v_mul_f32 v24, v24, v18
    v_mul_f32 v25, v25, v18
    v_cvt_pk_bf16_f32 v0, v24, v25
    v_mul_f32 v26, v26, v18
    v_mul_f32 v27, v27, v18
    v_cvt_pk_bf16_f32 v1, v26, v27
    v_mul_f32 v88, v88, v18
    v_mul_f32 v89, v89, v18
    v_cvt_pk_bf16_f32 v2, v88, v89
    v_mul_f32 v90, v90, v18
    v_mul_f32 v91, v91, v18
    v_cvt_pk_bf16_f32 v3, v90, v91
    v_mul_f32 v72, v72, v18
    v_mul_f32 v73, v73, v18
    v_cvt_pk_bf16_f32 v72, v72, v73
    v_mul_f32 v74, v74, v18
    v_mul_f32 v75, v75, v18
    v_cvt_pk_bf16_f32 v73, v74, v75
    ds_write_b128 v120, v[0:3] offset:3072
    v_fmac_f32 v54, v78, v78
    v_fmac_f32 v54, v79, v79
    v_fmac_f32 v54, v40, v40
    v_fmac_f32 v54, v41, v41
    ds_write_b64 v55, v[72:73] offset:3072
    v_fmac_f32 v54, v42, v42
    v_fmac_f32 v54, v43, v43
    v_fmac_f32 v133, v9, v9
    v_fmac_f32 v133, v10, v10
    v_fmac_f32 v133, v11, v11
    v_fmac_f32 v133, v32, v32
    v_fmac_f32 v133, v33, v33
    v_fmac_f32 v133, v34, v34
    v_fmac_f32 v133, v35, v35
    v_fmac_f32 v133, v12, v12
    v_fmac_f32 v133, v13, v13
    v_fmac_f32 v133, v14, v14
    v_fmac_f32 v133, v15, v15
    v_cvt_pk_bf16_f32 v54, v54, v133
    v_fma_f32 v133, v20, v20, s42
    v_fmac_f32 v133, v21, v21
    v_fmac_f32 v133, v22, v22
    v_fmac_f32 v133, v23, v23
    v_fmac_f32 v133, v96, v96
    v_fmac_f32 v133, v97, v97
    v_fmac_f32 v133, v98, v98
    v_fmac_f32 v133, v99, v99
    v_fmac_f32 v133, v80, v80
    v_fmac_f32 v133, v81, v81
    v_fmac_f32 v133, v82, v82
    v_fmac_f32 v133, v83, v83
    v_cvt_pk_bf16_f32 v55, v133, v133
    ds_write_b64 v130, v[54:55] offset:2048
    v_rcp_f32 v28, v28
    v_lshlrev_b32 v133, 16, v48
    v_and_b32 v48, 0xffff0000, v48
    v_mul_f32 v133, v133, v28
    v_mul_f32 v48, v48, v28
    v_cvt_pk_bf16_f32 v16, v133, v48
    v_lshlrev_b32 v48, 16, v49
    v_and_b32 v49, 0xffff0000, v49
    v_mul_f32 v48, v48, v28
    v_mul_f32 v49, v49, v28
    v_cvt_pk_bf16_f32 v17, v48, v49
    v_lshlrev_b32 v133, 16, v50
    v_and_b32 v50, 0xffff0000, v50
    v_mul_f32 v133, v133, v28
    v_mul_f32 v50, v50, v28
    v_cvt_pk_bf16_f32 v18, v133, v50
    v_lshlrev_b32 v19, 16, v51
    v_and_b32 v51, 0xffff0000, v51
    v_mul_f32 v19, v19, v28
    v_mul_f32 v51, v51, v28
    v_cvt_pk_bf16_f32 v19, v19, v51
    v_lshlrev_b32 v133, 16, v52
    v_and_b32 v52, 0xffff0000, v52
    v_mul_f32 v133, v133, v28
    v_mul_f32 v52, v52, v28
    v_cvt_pk_bf16_f32 v0, v133, v52
    v_lshlrev_b32 v133, 16, v53
    v_and_b32 v53, 0xffff0000, v53
    v_mul_f32 v133, v133, v28
    v_mul_f32 v53, v53, v28
    v_cvt_pk_bf16_f32 v1, v133, v53
    s_waitcnt lgkmcnt(0)
    s_barrier
    ds_write_b128 v138, v[16:19] offset:1536
    v_and_b32 v123, 0xb8000000, v123
    v_mov_b32 v121, 0x3f803f80
    v_cmp_ne_u32 vcc, 0, v123
    s_nop 0
    ds_write_b64 v132, v[0:1] offset:1536
    v_cndmask_b32 v121, 0, v121, vcc
    ds_read_b128 v[36:39], v7 offset:0
    ds_read_b128 v[0:3], v7 offset:1024
    ds_read_b128 v[24:27], v7 offset:2048
    ds_read_b128 v[108:111], v7 offset:3072
    ds_read_b128 v[72:75], v7 offset:4096
    s_waitcnt lgkmcnt(5)
    s_barrier
    s_waitcnt lgkmcnt(4)
    buffer_store_dwordx4 v[36:39], v128, s[28:31], s59 offen sc1
    ds_read_b128 v[28:31], v129 offset:2048
    ds_read_b128 v[16:19], v129 offset:3072
    ds_read_b128 v[104:107], v137 offset:1536
    ds_read_b128 v[100:103], v136 offset:1536
    ds_read_b128 v[92:95], v137 offset:1664
    ds_read_b128 v[84:87], v136 offset:1664
    ds_read_b128 v[44:47], v137 offset:1792
    s_waitcnt lgkmcnt(9)
    buffer_store_dwordx4 v[0:3], v127, s[28:31], s59 offen sc1
    ds_read_b128 v[36:39], v136 offset:1792
    s_waitcnt lgkmcnt(7)
    v_mfma_f32_16x16x32_bf16 v[0:3], v[216:219], v[28:31], 0
    s_waitcnt lgkmcnt(6)
    v_mfma_f32_16x16x32_bf16 v[0:3], v[216:219], v[16:19], v[0:3]
    s_waitcnt lgkmcnt(5)
    v_mfma_f32_16x16x32_bf16 v[16:19], a[216:219], v[104:107], 0
    s_waitcnt lgkmcnt(4)
    v_mfma_f32_16x16x32_bf16 v[16:19], a[220:223], v[100:103], v[16:19]
    s_waitcnt lgkmcnt(3)
    ds_read_b128 v[64:67], v137 offset:0
    ds_read_b128 v[60:63], v136 offset:0
    v_mfma_f32_16x16x32_bf16 v[16:19], a[224:227], v[92:95], v[16:19]
    s_waitcnt lgkmcnt(4)
    ds_read_b128 v[56:59], v137 offset:128
    v_mfma_f32_16x16x32_bf16 v[16:19], a[228:231], v[84:87], v[16:19]
    s_waitcnt lgkmcnt(4)
    buffer_store_dwordx4 v[24:27], v126, s[28:31], s59 offen sc1
    ds_read_b128 v[52:55], v136 offset:128
    v_rsq_f32 v0, v0
    v_mfma_f32_16x16x32_bf16 v[16:19], a[232:235], v[44:47], v[16:19]
    s_waitcnt lgkmcnt(4)
    ds_read_b128 v[48:51], v137 offset:256
    ds_read_b128 v[24:27], v136 offset:256
    v_mfma_f32_16x16x32_bf16 v[16:19], a[236:239], v[36:39], v[16:19]
    v_rsq_f32 v1, v1
    v_mfma_f32_16x16x32_bf16 v[28:31], a[240:243], v[104:107], 0
    v_mul_f32 v0, s43, v0
    v_mul_f32 v1, s43, v1
    v_mfma_f32_16x16x32_bf16 v[28:31], a[244:247], v[100:103], v[28:31]
    v_rsq_f32 v2, v2
    v_mfma_f32_16x16x32_bf16 v[28:31], a[248:251], v[92:95], v[28:31]
    v_mul_f32 v2, s43, v2
    v_mul_f32 v20, v20, v2
    v_mfma_f32_16x16x32_bf16 v[28:31], a[252:255], v[84:87], v[28:31]
    buffer_store_dwordx4 v[108:111], v125, s[28:31], s59 offen sc1
    v_mul_f32 v21, v21, v2
    v_cvt_pk_bf16_f32 v88, v20, v21
    v_mul_f32 v22, v22, v2
    v_mul_f32 v23, v23, v2
    v_mfma_f32_16x16x32_bf16 v[28:31], v[224:227], v[44:47], v[28:31]
    v_cvt_pk_bf16_f32 v89, v22, v23
    v_mul_f32 v96, v96, v2
    v_mfma_f32_16x16x32_bf16 v[28:31], v[228:231], v[36:39], v[28:31]
    v_mul_f32 v97, v97, v2
    v_cvt_pk_bf16_f32 v90, v96, v97
    v_mfma_f32_16x16x32_bf16 v[20:23], v[232:235], v[104:107], 0
    v_mul_f32 v98, v98, v2
    v_mul_f32 v99, v99, v2
    v_mfma_f32_16x16x32_bf16 v[20:23], v[236:239], v[100:103], v[20:23]
    v_cvt_pk_bf16_f32 v91, v98, v99
    v_mul_f32 v80, v80, v2
    v_mfma_f32_16x16x32_bf16 v[20:23], v[240:243], v[92:95], v[20:23]
    ds_write_b128 v135, v[88:91] offset:3072
    v_mfma_f32_16x16x32_bf16 v[20:23], v[244:247], v[84:87], v[20:23]
    buffer_store_dwordx4 v[72:75], v124, s[28:31], s59 offen sc1
    v_mul_f32 v81, v81, v2
    v_cvt_pk_bf16_f32 v136, v80, v81
    v_mul_f32 v82, v82, v2
    v_mul_f32 v83, v83, v2
    v_mfma_f32_16x16x32_bf16 v[20:23], v[248:251], v[44:47], v[20:23]
    v_cvt_pk_bf16_f32 v137, v82, v83
    v_mul_f32 v68, v68, v0
    v_mfma_f32_16x16x32_bf16 v[20:23], v[252:255], v[36:39], v[20:23]
    s_waitcnt lgkmcnt(1)
    ds_write_b64 v134, v[136:137] offset:3072
    v_mfma_f32_16x16x32_bf16 v[36:39], a[216:219], v[64:67], 0
    v_mul_f32 v69, v69, v0
    v_cvt_pk_bf16_f32 v68, v68, v69
    v_mfma_f32_16x16x32_bf16 v[36:39], a[220:223], v[60:63], v[36:39]
    v_mul_f32 v70, v70, v0
    v_mul_f32 v71, v71, v0
    v_mfma_f32_16x16x32_bf16 v[36:39], a[224:227], v[56:59], v[36:39]
    v_cvt_pk_bf16_f32 v69, v70, v71
    v_mul_f32 v76, v76, v0
    v_mfma_f32_16x16x32_bf16 v[36:39], a[228:231], v[52:55], v[36:39]
    v_mul_f32 v77, v77, v0
    v_cvt_pk_bf16_f32 v70, v76, v77
    v_mfma_f32_16x16x32_bf16 v[36:39], a[232:235], v[48:51], v[36:39]
    v_mul_f32 v78, v78, v0
    v_mul_f32 v79, v79, v0
    v_mfma_f32_16x16x32_bf16 v[36:39], a[236:239], v[24:27], v[36:39]
    v_cvt_pk_bf16_f32 v71, v78, v79
    v_mul_f32 v40, v40, v0
    v_mfma_f32_16x16x32_bf16 v[44:47], a[240:243], v[64:67], 0
    ds_write_b128 v135, v[68:71] offset:0
    v_mfma_f32_16x16x32_bf16 v[44:47], a[244:247], v[60:63], v[44:47]
    v_mul_f32 v41, v41, v0
    v_cvt_pk_bf16_f32 v2, v40, v41
    v_mfma_f32_16x16x32_bf16 v[44:47], a[248:251], v[56:59], v[44:47]
    v_mul_f32 v42, v42, v0
    v_mul_f32 v43, v43, v0
    v_mfma_f32_16x16x32_bf16 v[44:47], a[252:255], v[52:55], v[44:47]
    v_cvt_pk_bf16_f32 v3, v42, v43
    v_fma_f32 v7, v16, v16, s42
    v_mfma_f32_16x16x32_bf16 v[44:47], v[224:227], v[48:51], v[44:47]
    ds_write_b64 v134, v[2:3] offset:0
    v_mfma_f32_16x16x32_bf16 v[44:47], v[228:231], v[24:27], v[44:47]
    v_fmac_f32 v7, v17, v17
    v_fmac_f32 v7, v18, v18
    v_mfma_f32_16x16x32_bf16 v[40:43], v[232:235], v[64:67], 0
    v_fmac_f32 v7, v19, v19
    v_fmac_f32 v7, v28, v28
    v_mfma_f32_16x16x32_bf16 v[40:43], v[236:239], v[60:63], v[40:43]
    v_fmac_f32 v7, v29, v29
    v_fmac_f32 v7, v30, v30
    v_mfma_f32_16x16x32_bf16 v[40:43], v[240:243], v[56:59], v[40:43]
    v_fmac_f32 v7, v31, v31
    v_fmac_f32 v7, v20, v20
    v_mfma_f32_16x16x32_bf16 v[40:43], v[244:247], v[52:55], v[40:43]
    v_fmac_f32 v7, v21, v21
    v_fmac_f32 v7, v22, v22
    v_mfma_f32_16x16x32_bf16 v[40:43], v[248:251], v[48:51], v[40:43]
    v_fmac_f32 v7, v23, v23
    v_fma_f32 v133, v36, v36, s42
    v_mfma_f32_16x16x32_bf16 v[40:43], v[252:255], v[24:27], v[40:43]
    s_nop 0
    v_fmac_f32 v133, v37, v37
    v_fmac_f32 v133, v38, v38
    v_fmac_f32 v133, v39, v39
    v_fmac_f32 v133, v44, v44
    v_fmac_f32 v133, v45, v45
    v_fmac_f32 v133, v46, v46
    v_fmac_f32 v133, v47, v47
    v_fmac_f32 v133, v40, v40
    v_fmac_f32 v133, v41, v41
    v_fmac_f32 v133, v42, v42
    v_fmac_f32 v133, v43, v43
    v_cvt_pk_bf16_f32 v120, v133, v7
    ds_write_b64 v130, v[120:121] offset:4096
    v_mul_f32 v8, v8, v1
    v_mul_f32 v9, v9, v1
    v_cvt_pk_bf16_f32 v8, v8, v9
    v_mul_f32 v10, v10, v1
    v_mul_f32 v11, v11, v1
    v_cvt_pk_bf16_f32 v9, v10, v11
    v_mul_f32 v32, v32, v1
    v_mul_f32 v33, v33, v1
    v_cvt_pk_bf16_f32 v10, v32, v33
    v_mul_f32 v34, v34, v1
    v_mul_f32 v35, v35, v1
    v_cvt_pk_bf16_f32 v11, v34, v35
    v_mul_f32 v12, v12, v1
    v_mul_f32 v13, v13, v1
    v_cvt_pk_bf16_f32 v136, v12, v13
    v_mul_f32 v14, v14, v1
    v_mul_f32 v15, v15, v1
    v_cvt_pk_bf16_f32 v137, v14, v15
    ds_write_b128 v135, v[8:11] offset:1536
    s_waitcnt lgkmcnt(1)
    s_barrier
    ds_write_b64 v134, v[136:137] offset:1536
    ds_read_b128 v[8:11], v129 offset:4096
    ds_read_b128 v[0:3], v129 offset:5120
    s_waitcnt lgkmcnt(2)
    s_barrier
    s_waitcnt lgkmcnt(1)
    v_mfma_f32_16x16x32_bf16 v[24:27], v[216:219], v[8:11], 0
    s_waitcnt lgkmcnt(0)
    ds_read_b128 v[48:51], v139 offset:0
    ds_read_b128 v[32:35], v139 offset:1024
    v_mfma_f32_16x16x32_bf16 v[24:27], v[216:219], v[0:3], v[24:27]
    s_nop 0
    ds_read_b128 v[12:15], v139 offset:2048
    s_nop 2
    ds_read_b128 v[8:11], v139 offset:3072
    s_nop 1
    v_rsq_f32 v24, v24
    ds_read_b128 v[0:3], v139 offset:4096
    v_mul_f32 v24, s43, v24
    v_mul_f32 v36, v36, v24
    v_mul_f32 v37, v37, v24
    v_cvt_pk_bf16_f32 v36, v36, v37
    v_mul_f32 v38, v38, v24
    v_mul_f32 v39, v39, v24
    v_cvt_pk_bf16_f32 v37, v38, v39
    v_mul_f32 v44, v44, v24
    v_mul_f32 v45, v45, v24
    s_waitcnt lgkmcnt(4)
    buffer_store_dwordx4 v[48:51], v128, s[28:31], s58 offen sc1
    v_cvt_pk_bf16_f32 v38, v44, v45
    v_mul_f32 v46, v46, v24
    v_mul_f32 v47, v47, v24
    v_cvt_pk_bf16_f32 v39, v46, v47
    v_mul_f32 v40, v40, v24
    v_mul_f32 v41, v41, v24
    v_cvt_pk_bf16_f32 v128, v40, v41
    v_mul_f32 v42, v42, v24
    v_mul_f32 v43, v43, v24
    v_cvt_pk_bf16_f32 v129, v42, v43
    ds_write_b128 v138, v[36:39] offset:0
    v_rsq_f32 v25, v25
    v_cmp_neq_f32 vcc, 0, v26
    v_mul_f32 v25, s43, v25
    s_waitcnt lgkmcnt(1)
    buffer_store_dwordx4 v[32:35], v127, s[28:31], s58 offen sc1
    ds_write_b64 v132, v[128:129] offset:0
    v_mul_f32 v16, v16, v25
    v_mul_f32 v17, v17, v25
    v_cvt_pk_bf16_f32 v16, v16, v17
    v_mul_f32 v18, v18, v25
    v_mul_f32 v19, v19, v25
    v_cvt_pk_bf16_f32 v17, v18, v19
    v_mul_f32 v28, v28, v25
    v_mul_f32 v29, v29, v25
    v_cvt_pk_bf16_f32 v18, v28, v29
    v_mul_f32 v30, v30, v25
    v_mul_f32 v31, v31, v25
    v_cvt_pk_bf16_f32 v19, v30, v31
    v_mul_f32 v20, v20, v25
    v_mul_f32 v21, v21, v25
    v_cvt_pk_bf16_f32 v128, v20, v21
    v_mul_f32 v22, v22, v25
    v_mul_f32 v23, v23, v25
    v_cvt_pk_bf16_f32 v129, v22, v23
    buffer_store_dwordx4 v[12:15], v126, s[28:31], s58 offen sc1
    ds_write_b128 v138, v[16:19] offset:1536
    ds_write_b64 v132, v[128:129] offset:1536
    buffer_store_dwordx4 v[8:11], v125, s[28:31], s58 offen sc1
    s_waitcnt lgkmcnt(0)
    s_barrier
    buffer_store_dwordx4 v[0:3], v124, s[28:31], s58 offen sc1
    ds_read_b128 v[12:15], v131 offset:0
    ds_read_b128 v[8:11], v131 offset:1024
    ds_read_b128 v[0:3], v131 offset:2048
    s_waitcnt lgkmcnt(2)
    buffer_store_dwordx4 v[12:15], v4, s[28:31], 0 offen sc1
    s_waitcnt lgkmcnt(0)
    buffer_store_dwordx4 v[8:11], v5, s[28:31], 0 offen sc1
    buffer_store_dwordx4 v[0:3], v6, s[28:31], 0 offen sc1
    s_nop 4
    s_cbranch_vccnz L_slow
L_fin:
    s_cmp_eq_u32 s2, 255
    s_cbranch_scc1 L_again
L_end:
    s_endpgm
L_slow:
    s_waitcnt vmcnt(0) lgkmcnt(0)
    s_nop 15
    s_barrier
    s_lshr_b32 s66, s64, 20
    v_mbcnt_lo_u32_b32 v157, -1, 0
    v_mbcnt_hi_u32_b32 v157, -1, v157
    s_load_dwordx16 s[4:19], s[0:1], 0
    s_load_dwordx4 s[20:23], s[0:1], 64
    s_load_dwordx2 s[38:39], s[0:1], 80
    s_bfe_u32 s88, s2, 0x50003
    s_lshl2_add_u32 s88, s88, s68
    v_lshlrev_b32 v72, 7, v157
    s_mul_i32 s89, s88, 576
    s_mul_i32 s88, s88, 1728
    v_min_u32 v74, 1664, v72
    v_min_u32 v73, 512, v72
    s_mov_b32 s34, 221184
    s_mov_b32 s35, 0x20000
    s_mov_b32 s78, 73728
    s_mov_b32 s79, 0x20000
    v_and_b32 v75, 15, v157
    v_lshrrev_b32 v160, 4, v157
    v_lshrrev_b32 v72, 2, v75
    v_and_b32 v5, 3, v75
    s_mul_i32 s87, s68, 192
    v_mad_u32_u24 v19, v75, 12, s87
    v_lshlrev_b32 v31, 1, v75
    v_lshlrev_b32 v11, 1, v72
    v_lshl_add_u32 v11, v160, 5, v11
    s_movk_i32 s86, 384
    s_mov_b32 s26, 100270464
    s_mov_b32 s27, 0x20000
    s_mov_b32 s30, 0
    s_mov_b32 s31, 0x20000
    s_mul_i32 s96, s68, 288
    s_and_b32 s97, s68, 1
    s_lshl_b32 s97, s97, 2
    s_mov_b32 s98, 193536
    s_waitcnt lgkmcnt(0)
    s_mov_b32 s24, s4
    s_mov_b32 s25, s5
    s_mov_b32 s32, s6
    s_mov_b32 s33, s7
    s_mov_b32 s76, s8
    s_mov_b32 s77, s9
    buffer_load_dword a254, v74, s[32:35], s88 offen
    buffer_load_dword a253, v73, s[76:79], s89 offen
    s_load_dwordx2 s[82:83], s[10:11], 0
    s_movk_i32 s18, 676
    s_mov_b32 s19, 0x20000
    buffer_load_dwordx3 v[28:30], v19, s[16:19], 0 offen
    s_mov_b32 s99, 589824
    v_add_u32 v124, s96, v157
    v_mul_u32_u24 v74, 2731, v124
    v_mul_u32_u24 v73, 6242, v124
    v_lshrrev_b32 v74, 16, v74
    s_lshr_b32 s94, s2, 3
    s_mul_i32 s70, s94, 167
    global_load_ushort v16, v31, s[12:13]
    v_lshrrev_b32 v73, 20, v73
    v_and_or_b32 v8, v74, 3, s97
    v_xor_b32 v8, v124, v8
    v_lshl_add_u32 v128, v8, 4, s99
    v_mad_u32_u24 v128, v73, s98, v128
    s_min_u32 s95, s94, 7
    s_add_u32 s70, s70, s95
    global_load_ushort v17, v31, s[12:13] offset:32
    v_add_u32 v10, 64, v124
    v_mul_u32_u24 v150, 2731, v10
    v_mul_u32_u24 v156, 6242, v10
    v_lshrrev_b32 v150, 16, v150
    v_lshrrev_b32 v156, 20, v156
    s_and_b32 s95, s2, 7
    s_mul_i32 s95, s95, 20
    global_load_ushort v148, v11, s[14:15] offset:0
    v_and_or_b32 v9, v150, 3, s97
    v_xor_b32 v9, v10, v9
    v_lshl_add_u32 v127, v9, 4, s99
    v_mad_u32_u24 v127, v156, s98, v127
    v_add_u32 v18, 128, v124
    s_add_u32 s69, s70, s95
    s_add_u32 s70, s70, 140
    global_load_ushort v158, v11, s[14:15] offset:8
    v_mul_u32_u24 v10, 2731, v18
    v_mul_u32_u24 v4, 6242, v18
    v_lshrrev_b32 v10, 16, v10
    v_lshrrev_b32 v4, 20, v4
    v_and_or_b32 v31, v10, 3, s97
    s_movk_i32 s62, 2688
    s_movk_i32 s71, 20
    global_load_ushort v149, v11, s[14:15] offset:16
    v_xor_b32 v31, v18, v31
    v_lshl_add_u32 v126, v31, 4, s99
    v_mad_u32_u24 v126, v4, s98, v126
    v_add_u32 v125, 192, v124
    v_mul_u32_u24 v159, 2731, v125
    s_cmp_lt_u32 s94, 7
    s_cselect_b32 s73, 28, 27
    global_load_ushort v132, v11, s[14:15] offset:24
    v_mul_u32_u24 v18, 6242, v125
    v_lshrrev_b32 v159, 16, v159
    v_lshrrev_b32 v18, 20, v18
    v_and_or_b32 v11, v159, 3, s97
    v_xor_b32 v11, v125, v11
    v_lshl_add_u32 v125, v11, 4, s99
    v_mad_u32_u24 v125, v18, s98, v125
    v_add_u32 v6, 256, v124
    v_mul_u32_u24 v151, 2731, v6
    v_mul_u32_u24 v11, 6242, v6
    v_lshrrev_b32 v151, 16, v151
    v_lshrrev_b32 v11, 20, v11
    v_and_or_b32 v124, v151, 3, s97
    v_xor_b32 v124, v6, v124
    v_lshl_add_u32 v124, v124, 4, s99
    v_mad_u32_u24 v124, v11, s98, v124
    s_mov_b32 s93, 1769472
    s_mul_i32 s54, s68, 5120
    s_cmp_ge_u32 s2, 248
    s_cbranch_scc1 L_bndS
L_bndrS:
    s_mov_b32 s63, 1180032
    s_mul_i32 s94, s69, 58255
    s_lshr_b32 s94, s94, 22
    s_mul_i32 s94, s94, s63
    s_mul_i32 s72, s69, s62
    s_add_u32 s72, s72, s94
    v_lshl_or_b32 v73, v157, 4, 2.0
    s_sub_u32 s94, s73, 1
    s_max_u32 s94, s94, 20
    s_mul_i32 s95, s68, -44
    s_movk_i32 s99, -24
    s_add_u32 m0, s54, 0
    v_and_b32 v18, -4, v10
    s_mul_i32 s85, s68, 96
    s_sub_u32 s100, s85, 1024
    buffer_load_dwordx4 v128, s[24:27], s72 offen nt lds
    s_add_u32 m0, s54, 1024
    v_mad_u32_u24 v11, v18, 3, v10
    v_add_u32 v11, s95, v11
    v_mad_i32_i24 v10, v10, s99, v31
    v_med3_u32 v18, v11, 20, s94
    v_add_u32 v18, s70, v18
    v_add_u32 v31, s69, v11
    s_sub_u32 s87, s85, 2048
    s_movk_i32 s91, 1152
    buffer_load_dwordx4 v127, s[24:27], s72 offen nt lds
    v_cmp_gt_u32 vcc, s71, v11
    v_lshl_add_u32 v10, v10, 4, s93
    s_add_u32 m0, s54, 43008
    v_cndmask_b32 v31, v18, v31, vcc
    v_mul_u32_u24 v18, 58255, v31
    v_mad_u32_u24 v10, v31, s62, v10
    v_lshrrev_b32 v18, 22, v18
    v_mad_u32_u24 v10, v18, s63, v10
    s_mul_i32 s90, s68, 3072
    s_add_u32 s90, s90, 61440
    buffer_load_dwordx4 v10, s[24:27], 0 offen  lds
    v_lshlrev_b32 v11, 16, v11
    s_add_u32 m0, s54, 2048
    v_and_b32 v31, -4, v150
    v_mad_u32_u24 v18, v31, 3, v150
    v_add_u32 v18, s95, v18
    v_mad_i32_i24 v9, v150, s99, v9
    v_med3_u32 v31, v18, 20, s94
    s_mov_b32 s28, s22
    s_mov_b32 s29, s23
    buffer_load_dwordx4 v126, s[24:27], s72 offen nt lds
    v_add_u32 v31, s70, v31
    v_add_u32 v150, s69, v18
    v_cmp_gt_u32 vcc, s71, v18
    v_lshl_add_u32 v9, v9, 4, s93
    s_add_u32 m0, s54, 41984
    v_cndmask_b32 v150, v31, v150, vcc
    v_mul_u32_u24 v31, 58255, v150
    v_mad_u32_u24 v9, v150, s62, v9
    v_lshrrev_b32 v31, 22, v31
    v_mad_u32_u24 v9, v31, s63, v9
    s_mov_b32 s41, 0x2a8cbccc
    s_mov_b32 s42, 0x38fba882
    buffer_load_dwordx4 v9, s[24:27], 0 offen  lds
    v_lshl_or_b32 v11, v18, 8, v11
    s_add_u32 m0, s54, 3072
    v_cmp_gt_u32 vcc, 32, v157
    v_and_b32 v31, -4, v74
    v_mad_u32_u24 v18, v31, 3, v74
    v_cndmask_b32 v124, v73, v124, vcc
    v_add_u32 v18, s95, v18
    s_mov_b32 s43, 0x415db3d7
    s_mov_b32 s44, 61440
    buffer_load_dwordx4 v125, s[24:27], s72 offen nt lds
    s_add_u32 m0, s54, 4096
    v_mad_i32_i24 v8, v74, s99, v8
    v_med3_u32 v31, v18, 20, s94
    v_add_u32 v31, s70, v31
    v_add_u32 v74, s69, v18
    v_cmp_gt_u32 vcc, s71, v18
    v_lshl_add_u32 v8, v8, 4, s93
    s_mul_i32 s93, s68, 6
    s_lshl_b32 s94, s97, 1
    buffer_load_dwordx4 v124, s[24:27], s72 offen nt lds
    v_cndmask_b32 v74, v31, v74, vcc
    v_mul_u32_u24 v31, 58255, v74
    v_mad_u32_u24 v8, v74, s62, v8
    v_lshrrev_b32 v31, 22, v31
    v_mad_u32_u24 v8, v31, s63, v8
    s_add_u32 m0, s54, 40960
    v_lshl_or_b32 v11, v18, 0, v11
    s_mov_b32 s45, 40960
    s_mov_b32 s46, 20480
    buffer_load_dwordx4 v8, s[24:27], 0 offen nt lds
    v_mul_u32_u24 v6, 10923, v157
    v_lshrrev_b32 v4, 17, v6
    v_lshrrev_b32 v6, 16, v6
    v_mad_i32_i24 v7, v6, -6, v157
    v_bitop3_b32 v4, v4, v6, 4 bitop3:0x28
    v_lshl_add_u32 v7, v7, 4, s85
    v_mul_u32_u24 v4, 3, v4
    v_xor_b32 v6, v6, v4
    v_mad_u32_u24 v4, v6, s91, v7
    v_add_u32 v18, 64, v157
    v_mul_u32_u24 v31, 10923, v18
    v_lshrrev_b32 v156, 17, v31
    v_lshrrev_b32 v31, 16, v31
    v_mad_i32_i24 v159, v31, -6, v18
    v_bitop3_b32 v156, v156, v31, 4 bitop3:0x28
    v_lshl_add_u32 v159, v159, 4, s100
    v_mul_u32_u24 v156, 3, v156
    v_xor_b32 v31, v31, v156
    v_mad_u32_u24 v156, v31, s91, v159
    v_add_u32 v18, 128, v157
    v_mul_u32_u24 v74, 10923, v18
    v_lshrrev_b32 v120, 17, v74
    v_lshrrev_b32 v74, 16, v74
    v_mad_i32_i24 v18, v74, -6, v18
    v_bitop3_b32 v120, v120, v74, 4 bitop3:0x28
    v_lshl_add_u32 v18, v18, 4, s87
    v_mul_u32_u24 v120, 3, v120
    v_xor_b32 v74, v74, v120
    v_mad_u32_u24 v120, v74, s91, v18
    v_mad_u32_u24 v121, v6, s86, v7
    v_mad_u32_u24 v25, v31, s86, v159
    v_mad_u32_u24 v24, v74, s86, v18
    s_add_u32 m0, s90, 0
    s_mov_b32 s92, 0
    buffer_load_dwordx4 v4, s[32:35], s92 offen offset:0 lds
    v_mov_b32 v18, 0x3f803f80
    v_cmp_eq_u32 vcc, 0, v5
    v_and_b32 v31, 1, v157
    v_lshlrev_b32 v31, 4, v31
    v_cndmask_b32 v220, 0, v18, vcc
    v_cndmask_b32 v221, 0, v18, vcc
    v_cndmask_b32 v222, 0, v18, vcc
    v_cndmask_b32 v223, 0, v18, vcc
    v_mov_b32 v18, 0x3f80
    v_lshlrev_b32 v18, v31, v18
    v_cmp_gt_u32 vcc, 2, v5
    v_mov_b32 v171, 0
    v_mov_b32 v167, 0
    v_cndmask_b32 v216, 0, v18, vcc
    v_cndmask_b32 v218, 0, v18, vcc
    v_cmp_le_u32 vcc, 2, v5
    v_mov_b32 v163, 0
    v_mov_b32 v159, 0
    v_cndmask_b32 v217, 0, v18, vcc
    v_cndmask_b32 v219, 0, v18, vcc
    v_cmp_eq_u32 vcc, v160, v72
    v_mov_b32 v150, 0
    v_mov_b32 v151, 0
    v_cndmask_b32 v26, 0, v216, vcc
    v_cndmask_b32 v27, 0, v217, vcc
    v_mov_b32 v144, 0
    v_mov_b32 v145, 0
    v_mov_b32 v138, 0
    v_mov_b32 v139, 0
    v_lshrrev_b32 v6, 1, v160
    v_lshl_add_u32 v7, v160, 2, v72
    v_lshl_add_u32 v7, v6, 3, v7
    v_mul_u32_u24 v7, 96, v7
    v_add_u32 v7, s90, v7
    v_lshl_add_u32 v6, v5, 4, v7
    v_lshl_add_u32 v7, v5, 3, v7
    s_waitcnt lgkmcnt(0)
    s_lshl_b32 s84, s68, 4
    s_lshr_b64 s[82:83], s[82:83], s84
    s_lshl_b32 s82, s82, 16
    v_mov_b32 v74, s82
    v_min_f32 v74, 0x40930000, v74
    v_max_f32 v74, 0xc2c80000, v74
    v_mul_f32 v74, 0x3fb8aa3b, v74
    v_exp_f32 v74, v74
    v_mov_b32 v18, 0
    v_cvt_pk_bf16_f32 v74, v74, v74
    v_lshlrev_b32 v74, 16, v74
    v_mul_f32 v74, 0x4038aa3b, v74
    v_mov_b32 v31, 0
    v_readfirstlane_b32 s55, v74
    v_add_f32 v74, v74, v74
    v_mul_u32_u24 v122, 5120, v160
    v_readfirstlane_b32 s52, v74
    v_add_u32 v122, v19, v122
    s_mov_b32 s84, 0x41b8aa3b
    v_mov_b32 v131, 0xc138aa3b
    v_mul_u32_u24 v74, 5120, v72
    v_mad_u32_u24 v74, v5, s86, v74
    v_and_b32 v19, 7, v75
    s_mov_b32 s47, 0
    s_mov_b32 s57, s72
    buffer_load_dwordx4 v156, s[32:35], s92 offen offset:1024 lds
    v_xor_b32 v123, v19, v160
    v_lshl_add_u32 v147, v123, 4, v74
    v_xor_b32 v146, 64, v147
    v_add_u32 v137, 40960, v147
    v_xor_b32 v136, 64, v137
    v_add_u32 v74, 61440, v74
    v_add_u32 v123, s93, v160
    s_mov_b32 s58, 0
    s_mov_b32 s59, 0
    buffer_load_dwordx4 v120, s[32:35], s92 offen offset:2048 lds
    s_add_u32 m0, s90, 12288
    s_mov_b32 s92, 36864
    v_xor_b32 v123, v19, v123
    v_lshl_add_u32 v135, v123, 4, v74
    v_lshrrev_b32 v123, 1, v160
    v_add3_u32 v123, v123, s93, 4
    v_xor_b32 v123, v19, v123
    s_add_u32 s93, s54, 20480
    s_mov_b32 s60, 0
    buffer_load_dwordx4 v4, s[32:35], s92 offen offset:0 lds
    s_waitcnt vmcnt(16)
    v_lshl_or_b32 v16, v17, 16, v16
    v_cmp_gt_u32 vcc, 16, v157
    v_mov_b32 v17, 0
    v_lshl_add_u32 v123, v123, 4, v74
    v_cndmask_b32 v19, 0, v16, vcc
    v_cndmask_b32 v16, 0, v16, vcc
    v_and_b32 v74, 1, v160
    v_mfma_f32_16x16x16_bf16 v[0:3], v[18:19], v[28:29], 0
    s_waitcnt vmcnt(14)
    s_mov_b32 s65, -1
    v_lshl_or_b32 v148, v158, 16, v148
    v_lshl_add_u32 v134, v74, 3, v123
    v_mfma_f32_16x16x16_bf16 v[12:15], v[16:17], v[28:29], 0
    s_mov_b32 s61, 1
    v_lshlrev_b32 v74, 4, v157
    v_add_u32 v133, s93, v74
    v_mfma_f32_16x16x16_bf16 v[20:23], v[16:17], v[30:31], 0
    s_waitcnt vmcnt(12)
    s_lshr_b32 s93, s68, 1
    buffer_load_dwordx4 v156, s[32:35], s92 offen offset:1024 lds
    v_lshl_or_b32 v149, v132, 16, v149
    v_max_f32 v0, 0, v0
    v_max_f32 v12, 0, v12
    v_max_f32 v13, 0, v13
    v_max_f32 v14, 0, v14
    v_max_f32 v15, 0, v15
    v_cvt_pk_bf16_f32 v12, v12, v13
    v_cvt_pk_bf16_f32 v13, v14, v15
    v_max_f32 v1, 0, v1
    v_max_f32 v2, 0, v2
    v_mfma_f32_16x16x16_bf16 v[16:19], v[148:149], v[12:13], 0
    s_lshl_b32 s93, s93, 10
    v_max_f32 v3, 0, v3
    v_cvt_pk_bf16_f32 v0, v0, v1
    v_cvt_pk_bf16_f32 v1, v2, v3
    v_max_f32 v20, 0, v20
    v_max_f32 v21, 0, v21
    v_mfma_f32_16x16x16_bf16 v[12:15], v[148:149], v[0:1], 0
    s_add_u32 s93, s93, s94
    v_max_f32 v22, 0, v22
    v_max_f32 v23, 0, v23
    v_cvt_pk_bf16_f32 v20, v20, v21
    v_cvt_pk_bf16_f32 v21, v22, v23
    v_cvt_pk_bf16_f32 v16, v16, v16
    v_lshlrev_b32 v16, 16, v16
    v_mfma_f32_16x16x16_bf16 v[0:3], v[148:149], v[20:21], 0
    s_movk_i32 s4, 112
    v_mul_f32 v16, 0xbfb8aa3b, v16
    v_cvt_pk_bf16_f32 v12, v12, v12
    v_exp_f32 v16, v16
    v_lshlrev_b32 v12, 16, v12
    v_add_f32 v16, 1.0, v16
    v_rcp_f32 v16, v16
    v_mul_f32 v12, 0xbfb8aa3b, v12
    v_cvt_pk_bf16_f32 v16, v16, v16
    v_lshlrev_b32 v16, 16, v16
    v_fma_f32 v16, v16, s84, v131
    s_mov_b32 s5, 0
    s_mov_b32 s6, 0
    ds_write_b32 v122, v16 offset:44032
    v_exp_f32 v12, v12
    v_cvt_pk_bf16_f32 v0, v0, v0
    v_add_f32 v12, 1.0, v12
    v_rcp_f32 v12, v12
    v_lshlrev_b32 v0, 16, v0
    v_cvt_pk_bf16_f32 v12, v12, v12
    v_lshlrev_b32 v12, 16, v12
    v_fma_f32 v12, v12, s84, v131
    s_mov_b32 s12, 0
    s_mov_b32 s64, 3
    ds_write_b32 v122, v12 offset:44036
    v_mul_f32 v0, 0xbfb8aa3b, v0
    v_exp_f32 v0, v0
    v_add_u32 v129, 81920, v74
    v_add_f32 v0, 1.0, v0
    v_rcp_f32 v0, v0
    v_add_u32 v130, s93, v129
    v_cvt_pk_bf16_f32 v0, v0, v0
    v_lshlrev_b32 v0, 16, v0
    v_fma_f32 v0, v0, s84, v131
    s_mul_i32 s93, s68, 7168
    s_add_u32 s93, s93, 135168
    ds_write_b32 v122, v0 offset:44040
    v_mul_u32_u24 v74, 1792, v160
    v_add_u32 v123, s93, v74
    v_mul_u32_u24 v74, 112, v75
    v_add_u32 v158, v74, v123
    v_subrev_u32 v158, 28672, v158
    v_cmp_eq_u32 vcc, 0, v72
    v_add_u32 v74, 16, v123
    v_mov_b32 v122, 0
    v_cndmask_b32 v132, v73, v123, vcc
    v_cmp_eq_u32 vcc, 3, v5
    s_mov_b32 s10, 81924
    s_mov_b32 s11, 0x20000
    v_cndmask_b32 v132, v132, v74, vcc
    v_mul_u32_u24 v74, 1792, v72
    v_lshl_add_u32 v74, v160, 3, v74
    v_lshl_add_u32 v74, v5, 1, v74
    v_add_u32 v74, s93, v74
    v_cmp_gt_u32 vcc, 3, v160
    v_mov_b32 v123, v74
    s_add_u32 s93, s69, 1
    v_cndmask_b32 v131, v73, v74, vcc
    s_mul_i32 s94, s93, 58255
    s_lshr_b32 s94, s94, 22
    s_mul_i32 s94, s94, s63
    s_mul_i32 s56, s93, s62
    s_add_u32 s56, s56, s94
    s_sub_u32 s93, s71, 1
    s_cmp_eq_u32 s68, 0
    s_cselect_b32 s13, s93, -1
    s_cmp_gt_u32 s73, 20
    s_cselect_b32 s13, s13, -1
    s_and_b32 s93, s2, -8
    s_sub_u32 s93, 81920, s93
    s_waitcnt lgkmcnt(0)
    s_barrier
    s_sub_u32 s8, s38, s93
    s_subb_u32 s9, s39, 0
    s_mov_b32 s3, 0x00010001
    s_add_u32 s101, s54, 44032
    v_mul_u32_u24 v149, 48, v72
    v_lshl_add_u32 v149, v5, 2, v149
    v_mul_u32_u24 v5, 48, v160
    v_add_u32 v199, 0, v149
    v_mul_u32_u24 v148, 37, v199
    v_lshrrev_b32 v148, 10, v148
    v_mad_u32_u24 v199, v148, 24, v199
    v_add_u32 v199, s101, v199
    v_add_u32 v161, 16, v149
    v_mul_u32_u24 v148, 37, v161
    v_lshrrev_b32 v148, 10, v148
    v_mad_u32_u24 v161, v148, 24, v161
    v_add_u32 v161, s101, v161
    v_add_u32 v148, 32, v149
    v_mul_u32_u24 v162, 37, v148
    v_lshrrev_b32 v162, 10, v162
    v_mad_u32_u24 v148, v162, 24, v148
    v_add_u32 v148, s101, v148
    v_add_u32 v176, 0, v5
    v_mul_u32_u24 v162, 37, v176
    v_lshrrev_b32 v162, 10, v162
    v_mad_u32_u24 v176, v162, 24, v176
    v_add_u32 v169, 4, v5
    v_mul_u32_u24 v162, 37, v169
    v_lshrrev_b32 v162, 10, v162
    v_mad_u32_u24 v169, v162, 24, v169
    v_add_u32 v170, 8, v5
    v_mul_u32_u24 v162, 37, v170
    v_lshrrev_b32 v162, 10, v162
    v_mad_u32_u24 v170, v162, 24, v170
    v_add_u32 v183, 12, v5
    v_mul_u32_u24 v162, 37, v183
    v_lshrrev_b32 v162, 10, v162
    v_mad_u32_u24 v183, v162, 24, v183
    v_add_u32 v168, 16, v5
    v_mul_u32_u24 v162, 37, v168
    v_lshrrev_b32 v162, 10, v162
    v_mad_u32_u24 v168, v162, 24, v168
    v_add_u32 v165, 20, v5
    v_mul_u32_u24 v162, 37, v165
    v_lshrrev_b32 v162, 10, v162
    v_mad_u32_u24 v165, v162, 24, v165
    v_add_u32 v166, 24, v5
    v_mul_u32_u24 v162, 37, v166
    v_lshrrev_b32 v162, 10, v162
    v_mad_u32_u24 v166, v162, 24, v166
    v_add_u32 v179, 28, v5
    v_mul_u32_u24 v162, 37, v179
    v_lshrrev_b32 v162, 10, v162
    v_mad_u32_u24 v179, v162, 24, v179
    v_add_u32 v164, 32, v5
    v_mul_u32_u24 v162, 37, v164
    v_lshrrev_b32 v162, 10, v162
    v_mad_u32_u24 v164, v162, 24, v164
    v_add_u32 v74, 36, v5
    v_mul_u32_u24 v72, 37, v74
    v_lshrrev_b32 v72, 10, v72
    v_mad_u32_u24 v74, v72, 24, v74
    v_add_u32 v162, 40, v5
    v_mul_u32_u24 v72, 37, v162
    v_lshrrev_b32 v72, 10, v72
    s_lshr_b32 s93, s68, 1
    s_mul_i32 s93, s93, 30720
    buffer_load_dwordx4 v120, s[32:35], s92 offen offset:2048 lds
    s_add_u32 m0, s90, 24576
    s_mov_b32 s92, 73728
    ds_read_b32 v208, v199
    v_mad_u32_u24 v162, v72, 24, v162
    v_add_u32 v5, 44, v5
    v_mul_u32_u24 v72, 37, v5
    v_lshrrev_b32 v72, 10, v72
    v_mad_u32_u24 v5, v72, 24, v5
    v_lshl_add_u32 v72, v160, 4, v149
    v_mul_u32_u24 v177, 37, v72
    v_lshrrev_b32 v177, 10, v177
    v_mad_u32_u24 v72, v177, 24, v72
    v_mov_b32 v177, 336
    v_cmp_gt_u32 vcc, 3, v160
    v_sub_u32 v204, v199, v176
    s_and_b32 s94, s68, 1
    v_cndmask_b32 v72, v177, v72, vcc
    v_sub_u32 v72, s101, v72
    s_mul_i32 s94, s94, -2304
    s_add_u32 s93, s93, s94
    ds_read_b32 v204, v204 offset:336
    buffer_load_dwordx4 v4, s[32:35], s92 offen offset:0 lds
    v_sub_u32 v205, v199, v169
    v_sub_u32 v206, v199, v170
    v_sub_u32 v207, v199, v183
    v_sub_u32 v200, v199, v168
    s_lshl_b32 s94, s97, 4
    ds_read_b32 v205, v205 offset:336
    v_sub_u32 v201, v199, v165
    v_sub_u32 v202, v199, v166
    v_sub_u32 v203, v199, v179
    v_sub_u32 v196, v199, v164
    buffer_load_dwordx4 v156, s[32:35], s92 offen offset:1024 lds
    ds_read_b32 v206, v206 offset:336
    v_sub_u32 v197, v199, v74
    v_sub_u32 v198, v199, v162
    v_sub_u32 v199, v199, v5
    v_sub_u32 v192, v161, v176
    v_sub_u32 v193, v161, v169
    ds_read_b32 v207, v207 offset:336
    v_sub_u32 v194, v161, v170
    v_sub_u32 v195, v161, v183
    v_sub_u32 v188, v161, v168
    v_sub_u32 v189, v161, v165
    v_sub_u32 v190, v161, v166
    ds_read_b32 v200, v200 offset:336
    v_sub_u32 v191, v161, v179
    v_sub_u32 v184, v161, v164
    v_sub_u32 v185, v161, v74
    v_sub_u32 v186, v161, v162
    buffer_load_dwordx4 v120, s[32:35], s92 offen offset:2048 lds
    s_add_u32 m0, s90, 36864
    s_mov_b32 s92, 110592
    ds_read_b32 v201, v201 offset:336
    v_sub_u32 v187, v161, v5
    v_sub_u32 v180, v148, v176
    v_sub_u32 v181, v148, v169
    v_sub_u32 v182, v148, v170
    v_sub_u32 v183, v148, v183
    s_waitcnt vmcnt(9)
    s_barrier
    ds_read_b32 v202, v202 offset:336
    v_sub_u32 v176, v148, v168
    v_sub_u32 v177, v148, v165
    v_sub_u32 v178, v148, v166
    v_sub_u32 v179, v148, v179
    v_sub_u32 v172, v148, v164
    ds_read_b32 v203, v203 offset:336
    v_sub_u32 v173, v148, v74
    v_sub_u32 v174, v148, v162
    v_sub_u32 v175, v148, v5
    v_mov_b32 v5, 0xf149f2ca
    v_and_b32 v74, 8, v75
    ds_read_b32 v196, v196 offset:336
    v_add_u32 v74, v74, v75
    v_mul_u32_u24 v74, 96, v74
    buffer_load_dwordx4 v4, s[32:35], s92 offen offset:0 lds
    ds_read_b32 v197, v197 offset:336
    v_add_u32 v74, s90, v74
    v_lshl_add_u32 v19, v160, 4, v74
    v_lshl_add_u32 v18, v160, 3, v74
    v_add_u32 v17, s93, v19
    v_add_u32 v16, s93, v18
    s_lshr_b32 s93, s68, 1
    s_mul_i32 s93, s93, 5120
    ds_read_b32 v198, v198 offset:336
    v_lshlrev_b32 v162, 4, v160
    v_add_u32 v162, 4608, v162
    s_add_u32 s93, s93, s94
    v_add_u32 v74, s93, v162
    v_cmp_eq_u32 vcc, 0, v75
    ds_read_b32 v199, v199 offset:336
    buffer_load_dwordx4 v156, s[32:35], s92 offen offset:1024 lds
    v_cndmask_b32 v74, v73, v74, vcc
    ds_read_b32 v211, v72 offset:672
    ds_read_b32 v192, v192 offset:336
    ds_read_b32 v193, v193 offset:336
    buffer_load_dwordx4 v120, s[32:35], s92 offen offset:2048 lds
    s_add_u32 m0, s90, 49152
    s_mov_b32 s92, 147456
    ds_read_b32 v194, v194 offset:336
    ds_read_b32 v195, v195 offset:336
    ds_read_b32 v188, v188 offset:336
    buffer_load_dwordx4 v4, s[32:35], s92 offen offset:0 lds
    ds_read_b32 v189, v189 offset:336
    ds_read_b32 v190, v190 offset:336
    ds_read_b32 v191, v191 offset:336
    ds_read_b32 v184, v184 offset:336
    buffer_load_dwordx4 v156, s[32:35], s92 offen offset:1024 lds
    ds_read_b32 v185, v185 offset:336
    ds_read_b32 v186, v186 offset:336
    ds_read_b32 v187, v187 offset:336
    buffer_load_dwordx4 v120, s[32:35], s92 offen offset:2048 lds
    s_add_u32 m0, s90, 61440
    s_mov_b32 s92, 184320
    ds_read_b32 v209, v161
    ds_read_b32 v180, v180 offset:336
    ds_read_b32 v181, v181 offset:336
    buffer_load_dwordx4 v4, s[32:35], s92 offen offset:0 lds
    ds_read_b32 v182, v182 offset:336
    ds_read_b32 v183, v183 offset:336
    ds_read_b32 v176, v176 offset:336
    ds_read_b32 v177, v177 offset:336
    buffer_load_dwordx4 v156, s[32:35], s92 offen offset:1024 lds
    ds_read_b32 v178, v178 offset:336
    ds_read_b32 v179, v179 offset:336
    ds_read_b32 v172, v172 offset:336
    buffer_load_dwordx4 v120, s[32:35], s92 offen offset:2048 lds
    ds_read_b32 v173, v173 offset:336
    ds_read_b32 v174, v174 offset:336
    ds_read_b32 v175, v175 offset:336
    ds_read_b32 v210, v148
    s_waitcnt vmcnt(15)
    ds_read_b64_tr_b16 a[0:1], v7 offset:0
    ds_read_b64_tr_b16 a[2:3], v7 offset:768
    ds_read_b64_tr_b16 a[24:25], v7 offset:32
    ds_read_b64_tr_b16 a[26:27], v7 offset:800
    ds_read_b64_tr_b16 a[48:49], v7 offset:64
    ds_read_b64_tr_b16 a[50:51], v7 offset:832
    s_add_u32 m0, s90, 0
    s_mov_b32 s92, 384
    s_waitcnt vmcnt(12)
    ds_read_b64_tr_b16 a[4:5], v7 offset:12288
    ds_read_b64_tr_b16 a[6:7], v7 offset:13056
    ds_read_b64_tr_b16 a[28:29], v7 offset:12320
    ds_read_b64_tr_b16 a[30:31], v7 offset:13088
    ds_read_b64_tr_b16 a[52:53], v7 offset:12352
    ds_read_b64_tr_b16 a[54:55], v7 offset:13120
    s_waitcnt vmcnt(9)
    ds_read_b64_tr_b16 a[8:9], v7 offset:24576
    ds_read_b64_tr_b16 a[10:11], v7 offset:25344
    ds_read_b64_tr_b16 a[32:33], v7 offset:24608
    s_waitcnt lgkmcnt(15)
    s_cmp_ge_u32 s2, 248
    s_cbranch_scc1 L_maskS
L_nomaskS:
    v_cmp_gt_u32 vcc, 16, v157
    v_readlane_b32 s84, v211, 48
    ds_read_b64_tr_b16 a[34:35], v7 offset:25376
    v_cndmask_b32 v208, v5, v208, vcc
    v_cndmask_b32 v209, v5, v209, vcc
    v_cndmask_b32 v210, v5, v210, vcc
    v_cmp_gt_u32 vcc, 49, v157
    ds_read_b64_tr_b16 a[56:57], v7 offset:24640
    s_waitcnt lgkmcnt(10)
    buffer_load_dwordx4 v4, s[32:35], s92 offen offset:0 lds
    ds_read_b64_tr_b16 a[58:59], v7 offset:25408
    v_cndmask_b32 v211, v5, v211, vcc
    s_waitcnt vmcnt(7)
    ds_read_b64_tr_b16 a[12:13], v7 offset:36864
    ds_read_b64_tr_b16 a[14:15], v7 offset:37632
    buffer_load_dwordx4 v156, s[32:35], s92 offen offset:1024 lds
    ds_read_b64_tr_b16 a[36:37], v7 offset:36896
    ds_read_b64_tr_b16 a[38:39], v7 offset:37664
    ds_read_b64_tr_b16 a[60:61], v7 offset:36928
    ds_read_b64_tr_b16 a[62:63], v7 offset:37696
    buffer_load_dwordx4 v120, s[32:35], s92 offen offset:2048 lds
    s_add_u32 m0, s90, 12288
    s_mov_b32 s92, 37248
    ds_read_b128 v[60:63], v147 offset:40960
    ds_read_b128 v[56:59], v146 offset:40960
    s_waitcnt lgkmcnt(10)
    buffer_load_dwordx4 v4, s[32:35], s92 offen offset:0 lds
    ds_read_b128 v[52:55], v147 offset:41088
    ds_read_b128 v[48:51], v146 offset:41088
    buffer_load_dwordx4 v156, s[32:35], s92 offen offset:1024 lds
    ds_read_b128 v[40:43], v147 offset:41216
    ds_read_b128 v[0:3], v146 offset:41216
    buffer_load_dwordx4 v120, s[32:35], s92 offen offset:2048 lds
    s_add_u32 m0, s90, 24576
    s_mov_b32 s92, 74112
    s_waitcnt vmcnt(9)
    ds_read_b64_tr_b16 a[16:17], v7 offset:49152
    ds_read_b64_tr_b16 a[18:19], v7 offset:49920
    ds_read_b64_tr_b16 a[40:41], v7 offset:49184
    ds_read_b64_tr_b16 a[42:43], v7 offset:49952
    ds_read_b64_tr_b16 a[64:65], v7 offset:49216
    ds_read_b64_tr_b16 a[66:67], v7 offset:49984
    s_waitcnt lgkmcnt(7)
    buffer_load_dwordx4 v4, s[32:35], s92 offen offset:0 lds
    buffer_load_dwordx4 v156, s[32:35], s92 offen offset:1024 lds
    buffer_load_dwordx4 v120, s[32:35], s92 offen offset:2048 lds
    s_add_u32 m0, s90, 36864
    s_mov_b32 s92, 110976
    s_waitcnt vmcnt(9)
    ds_read_b64_tr_b16 a[20:21], v7 offset:61440
    ds_read_b64_tr_b16 a[22:23], v7 offset:62208
    v_mfma_f32_16x16x32_bf16 v[68:71], a[0:3], v[60:63], 0
    ds_read_b64_tr_b16 a[44:45], v7 offset:61472
    v_mfma_f32_16x16x32_bf16 v[68:71], a[4:7], v[56:59], v[68:71]
    ds_read_b64_tr_b16 a[46:47], v7 offset:62240
    v_mfma_f32_16x16x32_bf16 v[68:71], a[8:11], v[52:55], v[68:71]
    ds_read_b64_tr_b16 a[68:69], v7 offset:61504
    v_mfma_f32_16x16x32_bf16 v[68:71], a[12:15], v[48:51], v[68:71]
    s_waitcnt lgkmcnt(5)
    ds_read_b64_tr_b16 a[70:71], v7 offset:62272
    v_mfma_f32_16x16x32_bf16 v[68:71], a[16:19], v[40:43], v[68:71]
    ds_read_b128 v[44:47], v147 offset:42496
    ds_read_b128 v[36:39], v146 offset:42496
    ds_read_b128 v[32:35], v147 offset:42624
    ds_read_b128 v[28:31], v146 offset:42624
    s_waitcnt lgkmcnt(7)
    v_mfma_f32_16x16x32_bf16 v[68:71], a[20:23], v[0:3], v[68:71]
    ds_read_b128 v[20:23], v147 offset:42752
    s_nop 0
    v_mfma_f32_16x16x32_bf16 v[92:95], a[24:27], v[60:63], 0
    s_nop 0
    ds_read_b128 v[12:15], v146 offset:42752
    s_nop 0
    v_mfma_f32_16x16x32_bf16 v[92:95], a[28:31], v[56:59], v[92:95]
    s_nop 0
    v_fma_f32 v5, v68, v68, s41
    v_fmac_f32 v5, v69, v69
    v_mfma_f32_16x16x32_bf16 v[92:95], a[32:35], v[52:55], v[92:95]
    v_fmac_f32 v5, v70, v70
    v_fmac_f32 v5, v71, v71
    v_mfma_f32_16x16x32_bf16 v[92:95], a[36:39], v[48:51], v[92:95]
    v_mfma_f32_16x16x32_bf16 v[92:95], a[40:43], v[40:43], v[92:95]
    s_waitcnt lgkmcnt(4)
    v_mfma_f32_16x16x32_bf16 v[92:95], a[44:47], v[0:3], v[92:95]
    s_nop 0
    buffer_load_dwordx4 v4, s[32:35], s92 offen offset:0 lds
    v_mfma_f32_16x16x32_bf16 v[88:91], a[48:51], v[60:63], 0
    s_nop 2
    v_mfma_f32_16x16x32_bf16 v[88:91], a[52:55], v[56:59], v[88:91]
    s_nop 0
    v_fmac_f32 v5, v92, v92
    v_fmac_f32 v5, v93, v93
    v_mfma_f32_16x16x32_bf16 v[88:91], a[56:59], v[52:55], v[88:91]
    v_fmac_f32 v5, v94, v94
    v_fmac_f32 v5, v95, v95
    v_mfma_f32_16x16x32_bf16 v[88:91], a[60:63], v[48:51], v[88:91]
    v_mfma_f32_16x16x32_bf16 v[88:91], a[64:67], v[40:43], v[88:91]
    buffer_load_dwordx4 v156, s[32:35], s92 offen offset:1024 lds
    v_mfma_f32_16x16x32_bf16 v[88:91], a[68:71], v[0:3], v[88:91]
    s_nop 0
    v_mfma_f32_16x16x32_bf16 v[0:3], a[0:3], v[44:47], 0
    s_nop 2
    v_mfma_f32_16x16x32_bf16 v[0:3], a[4:7], v[36:39], v[0:3]
    s_waitcnt lgkmcnt(0)
    s_nop 0
    v_fmac_f32 v5, v88, v88
    v_fmac_f32 v5, v89, v89
    v_mfma_f32_16x16x32_bf16 v[0:3], a[8:11], v[32:35], v[0:3]
    v_fmac_f32 v5, v90, v90
    v_fmac_f32 v5, v91, v91
    v_mfma_f32_16x16x32_bf16 v[0:3], a[12:15], v[28:31], v[0:3]
    ds_read_b128 v[100:103], v147 offset:40960
    buffer_load_dwordx4 v120, s[32:35], s92 offen offset:2048 lds
    v_mfma_f32_16x16x32_bf16 v[0:3], a[16:19], v[20:23], v[0:3]
    s_waitcnt vmcnt(9)
    s_add_u32 m0, s90, 49152
    ds_read_b64_tr_b16 a[72:73], v7 offset:0
    v_mfma_f32_16x16x32_bf16 v[0:3], a[20:23], v[12:15], v[0:3]
    s_mov_b32 s92, 147840
    ds_read_b64_tr_b16 a[74:75], v7 offset:768
    v_mfma_f32_16x16x32_bf16 v[56:59], a[24:27], v[44:47], 0
    ds_read_b64_tr_b16 a[96:97], v7 offset:32
    s_nop 0
    v_mfma_f32_16x16x32_bf16 v[56:59], a[28:31], v[36:39], v[56:59]
    s_nop 0
    ds_read_b64_tr_b16 a[98:99], v7 offset:800
    v_fma_f32 v72, v0, v0, s41
    v_mfma_f32_16x16x32_bf16 v[56:59], a[32:35], v[32:35], v[56:59]
    ds_read_b64_tr_b16 a[120:121], v7 offset:64
    buffer_load_dwordx4 v4, s[32:35], s92 offen offset:0 lds
    v_mfma_f32_16x16x32_bf16 v[56:59], a[36:39], v[28:31], v[56:59]
    ds_read_b64_tr_b16 a[122:123], v7 offset:832
    v_fmac_f32 v72, v1, v1
    v_mfma_f32_16x16x32_bf16 v[56:59], a[40:43], v[20:23], v[56:59]
    ds_read_b128 v[64:67], v146 offset:40960
    v_fmac_f32 v72, v2, v2
    v_mfma_f32_16x16x32_bf16 v[56:59], a[44:47], v[12:15], v[56:59]
    ds_read_b128 v[52:55], v147 offset:41088
    v_fmac_f32 v72, v3, v3
    v_mfma_f32_16x16x32_bf16 v[40:43], a[48:51], v[44:47], 0
    ds_read_b128 v[48:51], v146 offset:41088
    v_mfma_f32_16x16x32_bf16 v[40:43], a[52:55], v[36:39], v[40:43]
    ds_read_b128 v[44:47], v147 offset:41216
    buffer_load_dwordx4 v156, s[32:35], s92 offen offset:1024 lds
    v_mfma_f32_16x16x32_bf16 v[40:43], a[56:59], v[32:35], v[40:43]
    ds_read_b128 v[32:35], v146 offset:41216
    v_fmac_f32 v72, v56, v56
    v_mfma_f32_16x16x32_bf16 v[40:43], a[60:63], v[28:31], v[40:43]
    v_fmac_f32 v72, v57, v57
    v_fmac_f32 v72, v58, v58
    v_mfma_f32_16x16x32_bf16 v[40:43], a[64:67], v[20:23], v[40:43]
    v_fmac_f32 v72, v59, v59
    v_mfma_f32_16x16x32_bf16 v[40:43], a[68:71], v[12:15], v[40:43]
    s_waitcnt vmcnt(8)
    s_nop 2
    buffer_load_dwordx4 v120, s[32:35], s92 offen offset:2048 lds
    s_add_u32 m0, s90, 61440
    s_mov_b32 s92, 184704
    ds_read_b64_tr_b16 a[76:77], v7 offset:12288
    v_fmac_f32 v72, v40, v40
    ds_read_b64_tr_b16 a[78:79], v7 offset:13056
    v_fmac_f32 v72, v41, v41
    ds_read_b64_tr_b16 a[100:101], v7 offset:12320
    v_fmac_f32 v72, v42, v42
    ds_read_b64_tr_b16 a[102:103], v7 offset:13088
    v_fmac_f32 v72, v43, v43
    ds_read_b64_tr_b16 a[124:125], v7 offset:12352
    buffer_load_dwordx4 v4, s[32:35], s92 offen offset:0 lds
    ds_read_b64_tr_b16 a[126:127], v7 offset:13120
    buffer_load_dwordx4 v156, s[32:35], s92 offen offset:1024 lds
    buffer_load_dwordx4 v120, s[32:35], s92 offen offset:2048 lds
    s_add_u32 m0, s90, 0
    s_mov_b32 s92, 768
    s_waitcnt vmcnt(9)
    ds_read_b64_tr_b16 a[80:81], v7 offset:24576
    ds_read_b64_tr_b16 a[82:83], v7 offset:25344
    ds_read_b64_tr_b16 a[104:105], v7 offset:24608
    ds_read_b64_tr_b16 a[106:107], v7 offset:25376
    ds_read_b64_tr_b16 a[128:129], v7 offset:24640
    ds_read_b64_tr_b16 a[130:131], v7 offset:25408
    s_waitcnt lgkmcnt(6)
    buffer_load_dwordx4 v4, s[32:35], s92 offen offset:0 lds
    buffer_load_dwordx4 v156, s[32:35], s92 offen offset:1024 lds
    buffer_load_dwordx4 v120, s[32:35], s92 offen offset:2048 lds
    s_add_u32 m0, s90, 12288
    s_mov_b32 s92, 37632
    s_waitcnt vmcnt(9)
    ds_read_b64_tr_b16 a[84:85], v7 offset:36864
    ds_read_b64_tr_b16 a[86:87], v7 offset:37632
    ds_read_b64_tr_b16 a[108:109], v7 offset:36896
    ds_read_b64_tr_b16 a[110:111], v7 offset:37664
    ds_read_b64_tr_b16 a[132:133], v7 offset:36928
    ds_read_b64_tr_b16 a[134:135], v7 offset:37696
    buffer_load_dwordx4 v4, s[32:35], s92 offen offset:0 lds
    buffer_load_dwordx4 v156, s[32:35], s92 offen offset:1024 lds
    buffer_load_dwordx4 v120, s[32:35], s92 offen offset:2048 lds
    s_add_u32 m0, s90, 24576
    s_mov_b32 s92, 74496
    s_waitcnt vmcnt(9)
    ds_read_b64_tr_b16 a[88:89], v7 offset:49152
    ds_read_b64_tr_b16 a[90:91], v7 offset:49920
    ds_read_b64_tr_b16 a[112:113], v7 offset:49184
    ds_read_b64_tr_b16 a[114:115], v7 offset:49952
    ds_read_b64_tr_b16 a[136:137], v7 offset:49216
    ds_read_b64_tr_b16 a[138:139], v7 offset:49984
    s_waitcnt lgkmcnt(6)
    buffer_load_dwordx4 v4, s[32:35], s92 offen offset:0 lds
    buffer_load_dwordx4 v156, s[32:35], s92 offen offset:1024 lds
    buffer_load_dwordx4 v120, s[32:35], s92 offen offset:2048 lds
    s_add_u32 m0, s90, 36864
    s_mov_b32 s92, 111360
    s_waitcnt vmcnt(9)
    ds_read_b64_tr_b16 a[92:93], v7 offset:61440
    ds_read_b64_tr_b16 a[94:95], v7 offset:62208
    v_mfma_f32_16x16x32_bf16 v[36:39], a[72:75], v[100:103], 0
    ds_read_b64_tr_b16 a[116:117], v7 offset:61472
    v_mfma_f32_16x16x32_bf16 v[36:39], a[76:79], v[64:67], v[36:39]
    ds_read_b64_tr_b16 a[118:119], v7 offset:62240
    v_mfma_f32_16x16x32_bf16 v[36:39], a[80:83], v[52:55], v[36:39]
    ds_read_b64_tr_b16 a[140:141], v7 offset:61504
    v_mfma_f32_16x16x32_bf16 v[36:39], a[84:87], v[48:51], v[36:39]
    s_waitcnt lgkmcnt(5)
    buffer_load_dwordx4 v4, s[32:35], s92 offen offset:0 lds
    ds_read_b64_tr_b16 a[142:143], v7 offset:62272
    v_mfma_f32_16x16x32_bf16 v[36:39], a[88:91], v[44:47], v[36:39]
    ds_read_b128 v[96:99], v147 offset:42496
    ds_read_b128 v[80:83], v146 offset:42496
    ds_read_b128 v[28:31], v147 offset:42624
    ds_read_b128 v[20:23], v146 offset:42624
    s_waitcnt lgkmcnt(7)
    v_mfma_f32_16x16x32_bf16 v[36:39], a[92:95], v[32:35], v[36:39]
    buffer_load_dwordx4 v156, s[32:35], s92 offen offset:1024 lds
    ds_read_b128 v[60:63], v147 offset:42752
    v_mfma_f32_16x16x32_bf16 v[84:87], a[96:99], v[100:103], 0
    s_nop 1
    ds_read_b128 v[12:15], v146 offset:42752
    v_mfma_f32_16x16x32_bf16 v[84:87], a[100:103], v[64:67], v[84:87]
    s_nop 0
    v_fma_f32 v157, v36, v36, s41
    v_fmac_f32 v157, v37, v37
    v_mfma_f32_16x16x32_bf16 v[84:87], a[104:107], v[52:55], v[84:87]
    v_fmac_f32 v157, v38, v38
    v_fmac_f32 v157, v39, v39
    v_mfma_f32_16x16x32_bf16 v[84:87], a[108:111], v[48:51], v[84:87]
    v_mfma_f32_16x16x32_bf16 v[84:87], a[112:115], v[44:47], v[84:87]
    s_waitcnt vmcnt(8) lgkmcnt(4)
    buffer_load_dwordx4 v120, s[32:35], s92 offen offset:2048 lds
    ds_read_b64_tr_b16 a[144:145], v6 offset:0
    v_mfma_f32_16x16x32_bf16 v[84:87], a[116:119], v[32:35], v[84:87]
    s_add_u32 m0, s90, 49152
    ds_read_b64_tr_b16 a[146:147], v6 offset:768
    v_mfma_f32_16x16x32_bf16 v[76:79], a[120:123], v[100:103], 0
    s_mov_b32 s92, 148224
    s_nop 0
    ds_read_b64_tr_b16 a[168:169], v6 offset:8
    v_mfma_f32_16x16x32_bf16 v[76:79], a[124:127], v[64:67], v[76:79]
    s_nop 0
    v_fmac_f32 v157, v84, v84
    v_fmac_f32 v157, v85, v85
    v_mfma_f32_16x16x32_bf16 v[76:79], a[128:131], v[52:55], v[76:79]
    ds_read_b64_tr_b16 a[170:171], v6 offset:776
    v_fmac_f32 v157, v86, v86
    v_mfma_f32_16x16x32_bf16 v[76:79], a[132:135], v[48:51], v[76:79]
    buffer_load_dwordx4 v4, s[32:35], s92 offen offset:0 lds
    ds_read_b64_tr_b16 a[192:193], v7 offset:64
    v_mfma_f32_16x16x32_bf16 v[76:79], a[136:139], v[44:47], v[76:79]
    ds_read_b64_tr_b16 a[194:195], v7 offset:832
    v_fmac_f32 v157, v87, v87
    v_mfma_f32_16x16x32_bf16 v[76:79], a[140:143], v[32:35], v[76:79]
    s_nop 0
    v_mfma_f32_16x16x32_bf16 v[52:55], a[72:75], v[96:99], 0
    s_nop 2
    v_mfma_f32_16x16x32_bf16 v[52:55], a[76:79], v[80:83], v[52:55]
    s_waitcnt lgkmcnt(5)
    s_nop 0
    v_fmac_f32 v157, v76, v76
    v_fmac_f32 v157, v77, v77
    v_mfma_f32_16x16x32_bf16 v[52:55], a[80:83], v[28:31], v[52:55]
    buffer_load_dwordx4 v156, s[32:35], s92 offen offset:1024 lds
    v_fmac_f32 v157, v78, v78
    v_mfma_f32_16x16x32_bf16 v[52:55], a[84:87], v[20:23], v[52:55]
    v_fmac_f32 v157, v79, v79
    v_cvt_pk_bf16_f32 v170, v5, v157
    v_mfma_f32_16x16x32_bf16 v[52:55], a[88:91], v[60:63], v[52:55]
    v_mfma_f32_16x16x32_bf16 v[52:55], a[92:95], v[12:15], v[52:55]
    ds_read_b128 v[64:67], v147 offset:40960
    v_mfma_f32_16x16x32_bf16 v[48:51], a[96:99], v[96:99], 0
    ds_read_b128 v[32:35], v146 offset:40960
    v_mfma_f32_16x16x32_bf16 v[48:51], a[100:103], v[80:83], v[48:51]
    s_waitcnt vmcnt(8)
    buffer_load_dwordx4 v120, s[32:35], s92 offen offset:2048 lds
    ds_read_b64_tr_b16 a[148:149], v6 offset:12288
    v_mfma_f32_16x16x32_bf16 v[48:51], a[104:107], v[28:31], v[48:51]
    s_add_u32 m0, s90, 61440
    v_fma_f32 v157, v52, v52, s41
    v_fmac_f32 v157, v53, v53
    v_mfma_f32_16x16x32_bf16 v[48:51], a[108:111], v[20:23], v[48:51]
    s_mov_b32 s92, 185088
    ds_read_b64_tr_b16 a[150:151], v6 offset:13056
    v_fmac_f32 v157, v54, v54
    v_mfma_f32_16x16x32_bf16 v[48:51], a[112:115], v[60:63], v[48:51]
    ds_read_b64_tr_b16 a[172:173], v6 offset:12296
    v_fmac_f32 v157, v55, v55
    v_mfma_f32_16x16x32_bf16 v[48:51], a[116:119], v[12:15], v[48:51]
    ds_read_b64_tr_b16 a[174:175], v6 offset:13064
    v_mfma_f32_16x16x32_bf16 v[44:47], a[120:123], v[96:99], 0
    s_nop 0
    buffer_load_dwordx4 v4, s[32:35], s92 offen offset:0 lds
    ds_read_b64_tr_b16 a[196:197], v7 offset:12352
    v_mfma_f32_16x16x32_bf16 v[44:47], a[124:127], v[80:83], v[44:47]
    s_nop 0
    ds_read_b64_tr_b16 a[198:199], v7 offset:13120
    v_fmac_f32 v157, v48, v48
    v_mfma_f32_16x16x32_bf16 v[44:47], a[128:131], v[28:31], v[44:47]
    ds_read_b128 v[28:31], v147 offset:41088
    v_fmac_f32 v157, v49, v49
    v_mfma_f32_16x16x32_bf16 v[44:47], a[132:135], v[20:23], v[44:47]
    ds_read_b128 v[20:23], v146 offset:41088
    v_fmac_f32 v157, v50, v50
    v_mfma_f32_16x16x32_bf16 v[44:47], a[136:139], v[60:63], v[44:47]
    ds_read_b128 v[60:63], v147 offset:41216
    v_fmac_f32 v157, v51, v51
    v_mfma_f32_16x16x32_bf16 v[44:47], a[140:143], v[12:15], v[44:47]
    s_nop 0
    buffer_load_dwordx4 v156, s[32:35], s92 offen offset:1024 lds
    ds_read_b128 v[12:15], v146 offset:41216
    v_mfma_f32_16x16x16_bf16 v[80:83], v[216:217], v[170:171], 0
    s_nop 0
    v_mov_b32 v168, 0
    v_mov_b32 v169, 0
    v_mov_b32 v149, 0
    v_fmac_f32 v157, v44, v44
    v_fmac_f32 v157, v45, v45
    v_fmac_f32 v157, v46, v46
    v_fmac_f32 v157, v47, v47
    v_rsq_f32 v80, v80
    v_rsq_f32 v81, v81
    v_mul_f32 v80, s55, v80
    v_mul_f32 v81, 0.5, v81
    v_mul_f32 v68, v68, v80
    buffer_load_dwordx4 v120, s[32:35], s92 offen offset:2048 lds
    s_add_u32 m0, s90, 0
    s_mov_b32 s92, 0
    s_waitcnt vmcnt(9)
    ds_read_b64_tr_b16 a[152:153], v6 offset:24576
    v_mul_f32 v69, v69, v80
    v_cvt_pk_f16_f32 v68, v68, v69
    v_mul_f32 v70, v70, v80
    ds_read_b64_tr_b16 a[154:155], v6 offset:25344
    v_mul_f32 v71, v71, v80
    v_cvt_pk_f16_f32 v69, v70, v71
    v_mul_f32 v92, v92, v80
    ds_read_b64_tr_b16 a[176:177], v6 offset:24584
    v_mul_f32 v93, v93, v80
    v_cvt_pk_f16_f32 v70, v92, v93
    s_waitcnt lgkmcnt(3)
    buffer_load_dwordx4 v121, s[76:79], s92 offen offset:0 lds
    ds_read_b64_tr_b16 a[178:179], v6 offset:25352
    v_mul_f32 v94, v94, v80
    v_mul_f32 v95, v95, v80
    v_cvt_pk_f16_f32 v71, v94, v95
    ds_read_b64_tr_b16 a[200:201], v7 offset:24640
    v_mul_f32 v88, v88, v80
    ds_read_b64_tr_b16 a[202:203], v7 offset:25408
    v_mul_f32 v89, v89, v80
    v_cvt_pk_f16_f32 v160, v88, v89
    v_mul_f32 v90, v90, v80
    v_mul_f32 v91, v91, v80
    v_cvt_pk_f16_f32 v161, v90, v91
    v_mul_f32 v36, v36, v81
    buffer_load_dwordx4 v25, s[76:79], s92 offen offset:1024 lds
    v_mul_f32 v37, v37, v81
    v_cvt_pk_f16_f32 v36, v36, v37
    v_mul_f32 v38, v38, v81
    v_mul_f32 v39, v39, v81
    v_cvt_pk_f16_f32 v37, v38, v39
    v_mul_f32 v84, v84, v81
    v_mul_f32 v85, v85, v81
    v_cvt_pk_f16_f32 v38, v84, v85
    v_mul_f32 v86, v86, v81
    v_mul_f32 v87, v87, v81
    v_cvt_pk_f16_f32 v39, v86, v87
    v_mul_f32 v76, v76, v81
    v_mul_f32 v77, v77, v81
    v_cvt_pk_f16_f32 v4, v76, v77
    v_mul_f32 v78, v78, v81
    v_mul_f32 v79, v79, v81
    v_cvt_pk_f16_f32 v5, v78, v79
    buffer_load_dwordx4 v24, s[76:79], s92 offen offset:2048 lds
    s_add_u32 m0, s90, 12288
    s_mov_b32 s92, 12288
    s_waitcnt vmcnt(9)
    ds_read_b64_tr_b16 a[156:157], v6 offset:36864
    v_fma_mix_f32 v148, v68, v36, 0 op_sel:[0,0,0] op_sel_hi:[1,1,0]
    v_fma_mix_f32 v148, v68, v36, v148 op_sel:[1,1,0] op_sel_hi:[1,1,0]
    v_fma_mix_f32 v148, v69, v37, v148 op_sel:[0,0,0] op_sel_hi:[1,1,0]
    ds_read_b64_tr_b16 a[158:159], v6 offset:37632
    v_fma_mix_f32 v148, v69, v37, v148 op_sel:[1,1,0] op_sel_hi:[1,1,0]
    v_fma_mix_f32 v148, v70, v38, v148 op_sel:[0,0,0] op_sel_hi:[1,1,0]
    v_fma_mix_f32 v148, v70, v38, v148 op_sel:[1,1,0] op_sel_hi:[1,1,0]
    ds_read_b64_tr_b16 a[180:181], v6 offset:36872
    v_fma_mix_f32 v148, v71, v39, v148 op_sel:[0,0,0] op_sel_hi:[1,1,0]
    v_fma_mix_f32 v148, v71, v39, v148 op_sel:[1,1,0] op_sel_hi:[1,1,0]
    buffer_load_dwordx4 v121, s[76:79], s92 offen offset:0 lds
    ds_read_b64_tr_b16 a[182:183], v6 offset:37640
    v_fma_mix_f32 v148, v160, v4, v148 op_sel:[0,0,0] op_sel_hi:[1,1,0]
    v_fma_mix_f32 v148, v160, v4, v148 op_sel:[1,1,0] op_sel_hi:[1,1,0]
    v_fma_mix_f32 v148, v161, v5, v148 op_sel:[0,0,0] op_sel_hi:[1,1,0]
    ds_read_b64_tr_b16 a[204:205], v7 offset:36928
    v_fma_mix_f32 v148, v161, v5, v148 op_sel:[1,1,0] op_sel_hi:[1,1,0]
    ds_read_b64_tr_b16 a[206:207], v7 offset:37696
    v_mov_b32 v120, v148
    v_add_u32 v156, 28672, v158
    ds_write_b128 v156, v[36:39]
    buffer_load_dwordx4 v25, s[76:79], s92 offen offset:1024 lds
    v_permlane32_swap_b32 v120, v148
    v_add_f32 v148, v120, v148
    v_mov_b32 v120, v148
    v_cvt_pk_bf16_f32 v170, v72, v157
    s_nop 0
    v_permlane16_swap_b32 v120, v148
    v_mfma_f32_16x16x16_bf16 v[36:39], v[216:217], v[170:171], 0
    s_waitcnt vmcnt(8)
    ds_write2_b64 v156, v[168:169], v[168:169] offset0:2 offset1:3
    v_add_f32 v148, v120, v148
    buffer_load_dwordx4 v24, s[76:79], s92 offen offset:2048 lds
    s_add_u32 m0, s90, 24576
    s_mov_b32 s92, 24576
    v_and_b32 v120, 0xffff0000, v148
    v_sub_f32 v148, v148, v120
    ds_read_b64_tr_b16 a[160:161], v6 offset:49152
    v_cvt_pk_bf16_f32 v148, v148, v120
    v_rsq_f32 v36, v36
    ds_read_b64_tr_b16 a[162:163], v6 offset:49920
    v_rsq_f32 v37, v37
    v_mul_f32 v36, s55, v36
    s_waitcnt lgkmcnt(3)
    buffer_load_dwordx4 v121, s[76:79], s92 offen offset:0 lds
    ds_read_b64_tr_b16 a[184:185], v6 offset:49160
    v_mul_f32 v37, 0.5, v37
    v_mul_f32 v0, v0, v36
    v_mul_f32 v1, v1, v36
    ds_read_b64_tr_b16 a[186:187], v6 offset:49928
    v_cvt_pk_f16_f32 v0, v0, v1
    v_mul_f32 v2, v2, v36
    v_mul_f32 v3, v3, v36
    ds_read_b64_tr_b16 a[208:209], v7 offset:49216
    v_cvt_pk_f16_f32 v1, v2, v3
    ds_read_b64_tr_b16 a[210:211], v7 offset:49984
    v_mul_f32 v56, v56, v36
    buffer_load_dwordx4 v25, s[76:79], s92 offen offset:1024 lds
    ds_write_b128 v156, v[68:71] offset:32
    v_mul_f32 v57, v57, v36
    v_cvt_pk_f16_f32 v2, v56, v57
    v_mul_f32 v58, v58, v36
    v_mul_f32 v59, v59, v36
    v_cvt_pk_f16_f32 v3, v58, v59
    v_mul_f32 v40, v40, v36
    v_mul_f32 v41, v41, v36
    v_cvt_pk_f16_f32 v254, v40, v41
    ds_write2_b64 v156, v[4:5], v[168:169] offset0:6 offset1:7
    buffer_load_dwordx4 v24, s[76:79], s92 offen offset:2048 lds
    s_add_u32 m0, s90, 36864
    s_mov_b32 s92, 36864
    v_mul_f32 v42, v42, v36
    v_mul_f32 v43, v43, v36
    v_cvt_pk_f16_f32 v255, v42, v43
    v_mul_f32 v52, v52, v37
    v_mul_f32 v53, v53, v37
    s_waitcnt vmcnt(9)
    ds_read_b64_tr_b16 a[164:165], v6 offset:61440
    v_cvt_pk_f16_f32 v4, v52, v53
    v_mul_f32 v54, v54, v37
    v_mul_f32 v55, v55, v37
    ds_read_b64_tr_b16 a[166:167], v6 offset:62208
    v_mfma_f32_16x16x32_bf16 v[40:43], a[144:147], v[64:67], 0
    buffer_load_dwordx4 v121, s[76:79], s92 offen offset:0 lds
    ds_read_b64_tr_b16 a[188:189], v6 offset:61448
    v_mfma_f32_16x16x32_bf16 v[40:43], a[148:151], v[32:35], v[40:43]
    v_cvt_pk_f16_f32 v5, v54, v55
    v_mul_f32 v48, v48, v37
    v_mfma_f32_16x16x32_bf16 v[40:43], a[152:155], v[28:31], v[40:43]
    ds_read_b64_tr_b16 a[190:191], v6 offset:62216
    v_mul_f32 v49, v49, v37
    v_mfma_f32_16x16x32_bf16 v[40:43], a[156:159], v[20:23], v[40:43]
    s_waitcnt lgkmcnt(4)
    ds_read_b64_tr_b16 a[212:213], v7 offset:61504
    v_cvt_pk_f16_f32 v6, v48, v49
    v_mfma_f32_16x16x32_bf16 v[40:43], a[160:163], v[60:63], v[40:43]
    ds_read_b64_tr_b16 a[214:215], v7 offset:62272
    v_mul_f32 v50, v50, v37
    v_mul_f32 v51, v51, v37
    v_cvt_pk_f16_f32 v7, v50, v51
    buffer_load_dwordx4 v25, s[76:79], s92 offen offset:1024 lds
    ds_write2_b64 v156, v[168:169], v[160:161] offset0:8 offset1:9
    v_mul_f32 v44, v44, v37
    v_mul_f32 v45, v45, v37
    v_cvt_pk_f16_f32 v160, v44, v45
    v_mul_f32 v46, v46, v37
    s_waitcnt lgkmcnt(5)
    v_mfma_f32_16x16x32_bf16 v[40:43], a[164:167], v[12:15], v[40:43]
    v_mul_f32 v47, v47, v37
    v_cvt_pk_f16_f32 v161, v46, v47
    v_mfma_f32_16x16x32_bf16 v[52:55], a[168:171], v[64:67], 0
    buffer_load_dwordx4 v24, s[76:79], s92 offen offset:2048 lds
    ds_read_b128 v[48:51], v147 offset:42496
    v_mfma_f32_16x16x32_bf16 v[52:55], a[172:175], v[32:35], v[52:55]
    s_add_u32 m0, s90, 49152
    v_fma_mix_f32 v120, v0, v4, 0 op_sel:[0,0,0] op_sel_hi:[1,1,0]
    v_fma_mix_f32 v120, v0, v4, v120 op_sel:[1,1,0] op_sel_hi:[1,1,0]
    v_mfma_f32_16x16x32_bf16 v[52:55], a[176:179], v[28:31], v[52:55]
    s_mov_b32 s92, 49152
    ds_write_b64 v156, v[148:149] offset:88
    v_mfma_f32_16x16x32_bf16 v[52:55], a[180:183], v[20:23], v[52:55]
    s_lshl_b32 s93, s68, 10
    v_fma_mix_f32 v120, v1, v5, v120 op_sel:[0,0,0] op_sel_hi:[1,1,0]
    v_fma_mix_f32 v120, v1, v5, v120 op_sel:[1,1,0] op_sel_hi:[1,1,0]
    v_mfma_f32_16x16x32_bf16 v[52:55], a[184:187], v[60:63], v[52:55]
    s_waitcnt lgkmcnt(3)
    s_mov_b32 s53, s47
    ds_read_b128 v[44:47], v146 offset:42496
    v_fma_mix_f32 v120, v2, v6, v120 op_sel:[0,0,0] op_sel_hi:[1,1,0]
    v_mfma_f32_16x16x32_bf16 v[52:55], a[188:191], v[12:15], v[52:55]
    s_mov_b32 s47, s46
    buffer_load_dwordx4 v121, s[76:79], s92 offen offset:0 lds
    ds_read_b128 v[36:39], v147 offset:42624
    v_mfma_f32_16x16x32_bf16 v[56:59], a[192:195], v[64:67], 0
    s_mov_b32 s46, s45
    v_fma_mix_f32 v120, v2, v6, v120 op_sel:[1,1,0] op_sel_hi:[1,1,0]
    v_fma_mix_f32 v120, v3, v7, v120 op_sel:[0,0,0] op_sel_hi:[1,1,0]
    v_mfma_f32_16x16x32_bf16 v[56:59], a[196:199], v[32:35], v[56:59]
    s_mov_b32 s45, s44
    ds_read_b128 v[32:35], v146 offset:42624
    v_fma_mix_f32 v120, v3, v7, v120 op_sel:[1,1,0] op_sel_hi:[1,1,0]
    v_mfma_f32_16x16x32_bf16 v[56:59], a[200:203], v[28:31], v[56:59]
    s_mov_b32 s44, s53
    ds_read_b128 v[28:31], v147 offset:42752
    v_fma_mix_f32 v120, v254, v160, v120 op_sel:[0,0,0] op_sel_hi:[1,1,0]
    v_mfma_f32_16x16x32_bf16 v[56:59], a[204:207], v[20:23], v[56:59]
    s_sub_u32 s48, s44, s46
    ds_read_b128 v[20:23], v146 offset:42752
    v_fma_mix_f32 v120, v254, v160, v120 op_sel:[1,1,0] op_sel_hi:[1,1,0]
    v_mfma_f32_16x16x32_bf16 v[56:59], a[208:211], v[60:63], v[56:59]
    s_sub_u32 s49, s46, s45
    buffer_load_dwordx4 v25, s[76:79], s92 offen offset:1024 lds
    v_fma_mix_f32 v120, v255, v161, v120 op_sel:[0,0,0] op_sel_hi:[1,1,0]
    v_mfma_f32_16x16x32_bf16 v[56:59], a[212:215], v[12:15], v[56:59]
    s_waitcnt lgkmcnt(5)
    v_fma_mix_f32 v120, v255, v161, v120 op_sel:[1,1,0] op_sel_hi:[1,1,0]
    v_mov_b32 v146, v120
    v_mfma_f32_16x16x32_bf16 v[12:15], a[144:147], v[48:51], 0
    s_waitcnt lgkmcnt(4)
    v_permlane32_swap_b32 v146, v120
    v_add_f32 v120, v146, v120
    v_mfma_f32_16x16x32_bf16 v[12:15], a[148:151], v[44:47], v[12:15]
    s_waitcnt lgkmcnt(3)
    v_mov_b32 v146, v120
    v_cvt_pk_bf16_f32 v148, v40, v41
    v_cvt_pk_bf16_f32 v149, v42, v43
    v_mfma_f32_16x16x32_bf16 v[12:15], a[152:155], v[36:39], v[12:15]
    s_waitcnt lgkmcnt(2)
    ds_write_b64 v158, v[148:149] offset:28752
    buffer_load_dwordx4 v24, s[76:79], s92 offen offset:2048 lds
    s_add_u32 m0, s90, 61440
    v_mfma_f32_16x16x32_bf16 v[12:15], a[156:159], v[32:35], v[12:15]
    s_waitcnt lgkmcnt(2)
    s_mov_b32 s92, 61440
    v_permlane16_swap_b32 v146, v120
    v_mfma_f32_16x16x32_bf16 v[12:15], a[160:163], v[28:31], v[12:15]
    s_waitcnt lgkmcnt(1)
    v_add_f32 v120, v146, v120
    v_and_b32 v146, 0xffff0000, v120
    v_mfma_f32_16x16x32_bf16 v[12:15], a[164:167], v[20:23], v[12:15]
    v_sub_f32 v120, v120, v146
    v_cvt_pk_bf16_f32 v120, v120, v146
    v_mfma_f32_16x16x32_bf16 v[40:43], a[168:171], v[48:51], 0
    v_cvt_pk_bf16_f32 v52, v52, v53
    v_cvt_pk_bf16_f32 v53, v54, v55
    v_mfma_f32_16x16x32_bf16 v[40:43], a[172:175], v[44:47], v[40:43]
    buffer_load_dwordx4 v121, s[76:79], s92 offen offset:0 lds
    v_cvt_pk_bf16_f32 v54, v56, v57
    v_mfma_f32_16x16x32_bf16 v[40:43], a[176:179], v[36:39], v[40:43]
    v_cvt_pk_bf16_f32 v55, v58, v59
    v_cvt_pk_bf16_f32 v156, v12, v13
    v_mfma_f32_16x16x32_bf16 v[40:43], a[180:183], v[32:35], v[40:43]
    ds_write_b128 v158, v[52:55] offset:28768
    v_mfma_f32_16x16x32_bf16 v[40:43], a[184:187], v[28:31], v[40:43]
    v_cvt_pk_bf16_f32 v157, v14, v15
    v_add_u32 v121, s93, v129
    v_mfma_f32_16x16x32_bf16 v[40:43], a[188:191], v[20:23], v[40:43]
    buffer_load_dwordx4 v25, s[76:79], s92 offen offset:1024 lds
    v_add_u32 v137, s48, v137
    v_mfma_f32_16x16x32_bf16 v[12:15], a[192:195], v[48:51], 0
    s_nop 0
    v_add_u32 v136, s48, v136
    s_nop 0
    v_mfma_f32_16x16x32_bf16 v[12:15], a[196:199], v[44:47], v[12:15]
    s_nop 0
    v_cvt_pk_bf16_f32 v76, v40, v41
    v_cvt_pk_bf16_f32 v77, v42, v43
    v_mfma_f32_16x16x32_bf16 v[12:15], a[200:203], v[36:39], v[12:15]
    v_mfma_f32_16x16x32_bf16 v[12:15], a[204:207], v[32:35], v[12:15]
    v_mfma_f32_16x16x32_bf16 v[12:15], a[208:211], v[28:31], v[12:15]
    buffer_load_dwordx4 v24, s[76:79], s92 offen offset:2048 lds
    v_mfma_f32_16x16x32_bf16 v[12:15], a[212:215], v[20:23], v[12:15]
    s_add_u32 m0, s54, 20480
    s_nop 6
    v_cvt_pk_bf16_f32 v78, v12, v13
    v_cvt_pk_bf16_f32 v79, v14, v15
    buffer_load_dwordx4 v128, s[24:27], s56 offen nt lds
    s_add_u32 m0, s54, 21504
    s_nop 0
    buffer_load_dwordx4 v127, s[24:27], s56 offen nt lds
    s_add_u32 m0, s54, 22528
    s_nop 0
    buffer_load_dwordx4 v126, s[24:27], s56 offen nt lds
    s_add_u32 m0, s54, 23552
    s_nop 0
    buffer_load_dwordx4 v125, s[24:27], s56 offen nt lds
    s_add_u32 m0, s54, 24576
    s_nop 0
    buffer_load_dwordx4 v124, s[24:27], s56 offen nt lds
    s_waitcnt vmcnt(5)
    s_barrier
    ds_read_b128 v[36:39], v17 offset:0
    ds_read_b64 v[12:13], v16 offset:64
    ds_read_b128 v[28:31], v17 offset:3072
    ds_read_b64 v[14:15], v16 offset:3136
    ds_read_b128 v[48:51], v17 offset:6144
    ds_read_b64 v[32:33], v16 offset:6208
    ds_read_b128 v[40:43], v17 offset:9216
    ds_read_b64 v[34:35], v16 offset:9280
    ds_read_b128 v[44:47], v17 offset:12288
    ds_read_b64 v[52:53], v16 offset:12352
    ds_read_b128 v[20:23], v17 offset:15360
    ds_read_b64 v[54:55], v16 offset:15424
    s_waitcnt lgkmcnt(11)
    v_mfma_f32_16x16x32_bf16 v[56:59], v[36:39], v[220:223], 0
    s_waitcnt lgkmcnt(9)
    ds_read_b128 v[36:39], v17 offset:18432
    v_mfma_f32_16x16x32_bf16 v[56:59], v[28:31], v[220:223], v[56:59]
    s_waitcnt lgkmcnt(8)
    ds_read_b64 v[28:29], v16 offset:18496
    ds_read_b128 v[60:63], v17 offset:21504
    v_mfma_f32_16x16x32_bf16 v[56:59], v[48:51], v[220:223], v[56:59]
    s_waitcnt lgkmcnt(8)
    ds_read_b64 v[30:31], v16 offset:21568
    ds_read_b128 v[48:51], v17 offset:24576
    v_mfma_f32_16x16x32_bf16 v[56:59], v[40:43], v[220:223], v[56:59]
    ds_read_b64 v[40:41], v16 offset:24640
    v_mfma_f32_16x16x32_bf16 v[56:59], v[12:15], v[220:223], v[56:59]
    s_waitcnt lgkmcnt(9)
    ds_read_b128 v[12:15], v17 offset:27648
    v_mfma_f32_16x16x32_bf16 v[56:59], v[32:35], v[220:223], v[56:59]
    ds_read_b64 v[42:43], v16 offset:27712
    v_mfma_f32_16x16x32_bf16 v[32:35], v[44:47], v[220:223], 0
    s_waitcnt lgkmcnt(8)
    ds_read_b128 v[44:47], v17 offset:30720
    v_mfma_f32_16x16x32_bf16 v[32:35], v[20:23], v[220:223], v[32:35]
    s_waitcnt lgkmcnt(8)
    s_nop 0
    ds_read_b64 v[20:21], v16 offset:30784
    v_mul_f32 v56, 0xbbaaaaab, v56
    v_mfma_f32_16x16x32_bf16 v[32:35], v[36:39], v[220:223], v[32:35]
    s_waitcnt lgkmcnt(7)
    ds_read_b128 v[36:39], v17 offset:33792
    v_mul_f32 v57, 0xbbaaaaab, v57
    v_mul_f32 v58, 0xbbaaaaab, v58
    v_mul_f32 v59, 0xbbaaaaab, v59
    v_mfma_f32_16x16x32_bf16 v[32:35], v[60:63], v[220:223], v[32:35]
    ds_write_b128 v74, v[56:59] offset:0
    v_mfma_f32_16x16x32_bf16 v[32:35], v[52:55], v[220:223], v[32:35]
    s_waitcnt lgkmcnt(6)
    v_mfma_f32_16x16x32_bf16 v[32:35], v[28:31], v[220:223], v[32:35]
    v_mfma_f32_16x16x32_bf16 v[28:31], v[48:51], v[220:223], 0
    s_waitcnt lgkmcnt(4)
    ds_read_b64 v[22:23], v16 offset:33856
    s_nop 0
    v_mfma_f32_16x16x32_bf16 v[28:31], v[12:15], v[220:223], v[28:31]
    s_waitcnt lgkmcnt(4)
    s_nop 0
    ds_read_b128 v[12:15], v19 offset:0
    v_mul_f32 v32, 0xbbaaaaab, v32
    v_mfma_f32_16x16x32_bf16 v[28:31], v[44:47], v[220:223], v[28:31]
    s_waitcnt lgkmcnt(3)
    ds_read_b64 v[16:17], v18 offset:64
    v_mul_f32 v33, 0xbbaaaaab, v33
    v_mul_f32 v34, 0xbbaaaaab, v34
    v_mul_f32 v35, 0xbbaaaaab, v35
    v_mfma_f32_16x16x32_bf16 v[28:31], v[36:39], v[220:223], v[28:31]
    ds_write_b128 v74, v[32:35] offset:128
    v_mfma_f32_16x16x32_bf16 v[28:31], v[40:43], v[220:223], v[28:31]
    ds_read_b128 v[80:83], v19 offset:768
    ds_read_b64 v[84:85], v18 offset:832
    ds_read_b128 v[68:71], v19 offset:12288
    s_waitcnt lgkmcnt(6)
    v_mfma_f32_16x16x32_bf16 v[28:31], v[20:23], v[220:223], v[28:31]
    s_nop 0
    ds_read_b64 v[72:73], v18 offset:12352
    s_nop 0
    ds_read_b128 v[20:23], v19 offset:13056
    s_nop 2
    ds_read_b64 v[24:25], v18 offset:13120
    v_mul_f32 v28, 0xbbaaaaab, v28
    v_mul_f32 v29, 0xbbaaaaab, v29
    v_mul_f32 v30, 0xbbaaaaab, v30
    v_mul_f32 v31, 0xbbaaaaab, v31
    ds_write_b128 v74, v[28:31] offset:256
    s_waitcnt lgkmcnt(0)
    s_barrier
    ds_read_b128 v[40:43], v162 offset:0
    ds_read_b128 v[28:31], v162 offset:64
    ds_read_b128 v[64:67], v162 offset:128
    ds_read_b128 v[56:59], v162 offset:192
    s_waitcnt lgkmcnt(3)
    v_mfma_f32_16x16x16_bf16 v[32:35], v[12:13], v[26:27], v[40:43]
    v_mfma_f32_16x16x16_bf16 v[36:39], v[14:15], v[26:27], v[40:43]
    s_nop 2
    v_mfma_f32_16x16x16_bf16 v[60:63], v[16:17], v[26:27], v[40:43]
    s_waitcnt lgkmcnt(0)
    s_nop 0
    ds_read_b128 v[12:15], v19 offset:24576
    v_cvt_pk_bf16_f32 v32, v32, v33
    v_mfma_f32_16x16x16_bf16 v[52:55], v[80:81], v[26:27], v[28:31]
    ds_read_b64 v[16:17], v18 offset:24640
    v_accvgpr_write_b32 a216, v32
    v_mfma_f32_16x16x16_bf16 v[48:51], v[82:83], v[26:27], v[28:31]
    ds_read_b128 v[44:47], v162 offset:256
    v_cvt_pk_bf16_f32 v34, v34, v35
    v_mfma_f32_16x16x16_bf16 v[40:43], v[84:85], v[26:27], v[28:31]
    ds_read_b128 v[104:107], v19 offset:25344
    v_accvgpr_write_b32 a217, v34
    v_mfma_f32_16x16x16_bf16 v[84:87], v[68:69], v[26:27], v[64:67]
    ds_read_b64 v[108:109], v18 offset:25408
    v_cvt_pk_bf16_f32 v36, v36, v37
    v_mfma_f32_16x16x16_bf16 v[32:35], v[70:71], v[26:27], v[64:67]
    ds_read_b128 v[100:103], v162 offset:320
    v_accvgpr_write_b32 a240, v36
    v_mfma_f32_16x16x16_bf16 v[28:31], v[72:73], v[26:27], v[64:67]
    ds_read_b128 v[92:95], v19 offset:36864
    v_cvt_pk_bf16_f32 v38, v38, v39
    v_mfma_f32_16x16x16_bf16 v[68:71], v[20:21], v[26:27], v[56:59]
    ds_read_b64 v[96:97], v18 offset:36928
    v_accvgpr_write_b32 a241, v38
    v_mfma_f32_16x16x16_bf16 v[64:67], v[22:23], v[26:27], v[56:59]
    ds_read_b128 v[80:83], v162 offset:5120
    v_cvt_pk_bf16_f32 v232, v60, v61
    v_mfma_f32_16x16x16_bf16 v[36:39], v[24:25], v[26:27], v[56:59]
    s_waitcnt lgkmcnt(6)
    ds_read_b128 v[20:23], v19 offset:37632
    v_cvt_pk_bf16_f32 v233, v62, v63
    v_cvt_pk_bf16_f32 v52, v52, v53
    v_accvgpr_write_b32 a218, v52
    v_cvt_pk_bf16_f32 v54, v54, v55
    v_accvgpr_write_b32 a219, v54
    v_cvt_pk_bf16_f32 v48, v48, v49
    v_mfma_f32_16x16x16_bf16 v[60:63], v[12:13], v[26:27], v[44:47]
    ds_read_b64 v[24:25], v18 offset:37696
    v_accvgpr_write_b32 a242, v48
    v_mfma_f32_16x16x16_bf16 v[56:59], v[14:15], v[26:27], v[44:47]
    ds_read_b128 v[88:91], v162 offset:5184
    v_cvt_pk_bf16_f32 v50, v50, v51
    v_mfma_f32_16x16x16_bf16 v[52:55], v[16:17], v[26:27], v[44:47]
    s_waitcnt lgkmcnt(6)
    ds_read_b128 v[12:15], v19 offset:49152
    v_accvgpr_write_b32 a243, v50
    v_cvt_pk_bf16_f32 v234, v40, v41
    v_cvt_pk_bf16_f32 v235, v42, v43
    v_mfma_f32_16x16x16_bf16 v[72:75], v[104:105], v[26:27], v[100:103]
    ds_read_b64 v[16:17], v18 offset:49216
    v_cvt_pk_bf16_f32 v84, v84, v85
    v_mfma_f32_16x16x16_bf16 v[40:43], v[106:107], v[26:27], v[100:103]
    ds_read_b128 v[48:51], v162 offset:5248
    v_accvgpr_write_b32 a220, v84
    v_mfma_f32_16x16x16_bf16 v[44:47], v[108:109], v[26:27], v[100:103]
    s_waitcnt lgkmcnt(6)
    ds_read_b128 v[104:107], v19 offset:49920
    v_cvt_pk_bf16_f32 v86, v86, v87
    v_accvgpr_write_b32 a221, v86
    v_cvt_pk_bf16_f32 v32, v32, v33
    v_accvgpr_write_b32 a244, v32
    v_cvt_pk_bf16_f32 v34, v34, v35
    v_accvgpr_write_b32 a245, v34
    v_cvt_pk_bf16_f32 v236, v28, v29
    v_cvt_pk_bf16_f32 v237, v30, v31
    v_mfma_f32_16x16x16_bf16 v[84:87], v[92:93], v[26:27], v[80:83]
    ds_read_b64 v[108:109], v18 offset:49984
    v_cvt_pk_bf16_f32 v68, v68, v69
    v_mfma_f32_16x16x16_bf16 v[32:35], v[94:95], v[26:27], v[80:83]
    ds_read_b128 v[100:103], v162 offset:5312
    v_accvgpr_write_b32 a222, v68
    v_mfma_f32_16x16x16_bf16 v[28:31], v[96:97], v[26:27], v[80:83]
    s_waitcnt lgkmcnt(5)
    ds_read_b128 v[92:95], v19 offset:61440
    v_cvt_pk_bf16_f32 v70, v70, v71
    v_accvgpr_write_b32 a223, v70
    v_cvt_pk_bf16_f32 v64, v64, v65
    v_accvgpr_write_b32 a246, v64
    v_cvt_pk_bf16_f32 v66, v66, v67
    v_accvgpr_write_b32 a247, v66
    v_cvt_pk_bf16_f32 v238, v36, v37
    v_cvt_pk_bf16_f32 v239, v38, v39
    v_mfma_f32_16x16x16_bf16 v[36:39], v[20:21], v[26:27], v[88:91]
    ds_read_b64 v[96:97], v18 offset:61504
    v_cvt_pk_bf16_f32 v60, v60, v61
    v_mfma_f32_16x16x16_bf16 v[68:71], v[22:23], v[26:27], v[88:91]
    ds_read_b128 v[80:83], v162 offset:5376
    v_accvgpr_write_b32 a224, v60
    v_mfma_f32_16x16x16_bf16 v[64:67], v[24:25], v[26:27], v[88:91]
    s_waitcnt lgkmcnt(5)
    ds_read_b128 v[20:23], v19 offset:62208
    v_cvt_pk_bf16_f32 v62, v62, v63
    v_accvgpr_write_b32 a225, v62
    v_cvt_pk_bf16_f32 v56, v56, v57
    v_accvgpr_write_b32 a248, v56
    v_cvt_pk_bf16_f32 v58, v58, v59
    v_accvgpr_write_b32 a249, v58
    v_cvt_pk_bf16_f32 v240, v52, v53
    v_cvt_pk_bf16_f32 v241, v54, v55
    v_mfma_f32_16x16x16_bf16 v[60:63], v[12:13], v[26:27], v[48:51]
    ds_read_b64 v[24:25], v18 offset:62272
    v_cvt_pk_bf16_f32 v72, v72, v73
    v_mfma_f32_16x16x16_bf16 v[56:59], v[14:15], v[26:27], v[48:51]
    ds_read_b128 v[12:15], v162 offset:5440
    v_accvgpr_write_b32 a226, v72
    v_mfma_f32_16x16x16_bf16 v[52:55], v[16:17], v[26:27], v[48:51]
    s_waitcnt lgkmcnt(5)
    ds_read_b128 v[16:19], v137 offset:0
    v_cvt_pk_bf16_f32 v74, v74, v75
    v_accvgpr_write_b32 a227, v74
    v_cvt_pk_bf16_f32 v40, v40, v41
    v_accvgpr_write_b32 a250, v40
    v_cvt_pk_bf16_f32 v42, v42, v43
    v_accvgpr_write_b32 a251, v42
    v_cvt_pk_bf16_f32 v242, v44, v45
    v_cvt_pk_bf16_f32 v243, v46, v47
    v_mfma_f32_16x16x16_bf16 v[48:51], v[104:105], v[26:27], v[100:103]
    ds_read_b128 v[146:149], v136 offset:0
    v_cvt_pk_bf16_f32 v84, v84, v85
    v_mfma_f32_16x16x16_bf16 v[44:47], v[106:107], v[26:27], v[100:103]
    ds_read_b128 v[72:75], v137 offset:128
    v_accvgpr_write_b32 a228, v84
    v_mfma_f32_16x16x16_bf16 v[40:43], v[108:109], v[26:27], v[100:103]
    s_waitcnt lgkmcnt(5)
    ds_read_b128 v[88:91], v136 offset:128
    v_cvt_pk_bf16_f32 v86, v86, v87
    v_accvgpr_write_b32 a229, v86
    v_cvt_pk_bf16_f32 v32, v32, v33
    v_accvgpr_write_b32 a252, v32
    v_cvt_pk_bf16_f32 v34, v34, v35
    v_accvgpr_write_b32 a253, v34
    v_cvt_pk_bf16_f32 v244, v28, v29
    v_cvt_pk_bf16_f32 v245, v30, v31
    v_mfma_f32_16x16x16_bf16 v[32:35], v[92:93], v[26:27], v[80:83]
    s_waitcnt vmcnt(0) lgkmcnt(4)
    s_barrier
    ds_write_b128 v121, v[8:11] offset:6144
    v_mfma_f32_16x16x16_bf16 v[28:31], v[94:95], v[26:27], v[80:83]
    v_cvt_pk_bf16_f32 v36, v36, v37
    v_accvgpr_write_b32 a230, v36
    v_mfma_f32_16x16x16_bf16 v[8:11], v[96:97], v[26:27], v[80:83]
    s_waitcnt lgkmcnt(4)
    v_cvt_pk_bf16_f32 v38, v38, v39
    v_accvgpr_write_b32 a231, v38
    v_cvt_pk_bf16_f32 v68, v68, v69
    v_mfma_f32_16x16x32_bf16 v[36:39], a[0:3], v[16:19], 0
    s_waitcnt lgkmcnt(3)
    ds_write_b64 v158, v[156:157] offset:80
    v_mfma_f32_16x16x32_bf16 v[36:39], a[4:7], v[146:149], v[36:39]
    s_waitcnt lgkmcnt(3)
    v_accvgpr_write_b32 a254, v68
    v_cvt_pk_bf16_f32 v70, v70, v71
    v_mfma_f32_16x16x32_bf16 v[36:39], a[8:11], v[72:75], v[36:39]
    s_waitcnt lgkmcnt(2)
    ds_write_b128 v158, v[76:79] offset:96
    v_mfma_f32_16x16x32_bf16 v[36:39], a[12:15], v[88:91], v[36:39]
    v_accvgpr_write_b32 a255, v70
    v_cvt_pk_bf16_f32 v246, v64, v65
    v_cvt_pk_bf16_f32 v247, v66, v67
    v_cvt_pk_bf16_f32 v60, v60, v61
    v_accvgpr_write_b32 a232, v60
    v_cvt_pk_bf16_f32 v62, v62, v63
    v_accvgpr_write_b32 a233, v62
    v_cvt_pk_bf16_f32 v224, v56, v57
    v_cvt_pk_bf16_f32 v225, v58, v59
    v_cvt_pk_bf16_f32 v248, v52, v53
    v_cvt_pk_bf16_f32 v249, v54, v55
    v_cvt_pk_bf16_f32 v48, v48, v49
    v_accvgpr_write_b32 a234, v48
    v_cvt_pk_bf16_f32 v50, v50, v51
    v_accvgpr_write_b32 a235, v50
    v_cvt_pk_bf16_f32 v226, v44, v45
    v_cvt_pk_bf16_f32 v227, v46, v47
    v_cvt_pk_bf16_f32 v250, v40, v41
    v_cvt_pk_bf16_f32 v251, v42, v43
    v_cvt_pk_bf16_f32 v32, v32, v33
    v_accvgpr_write_b32 a236, v32
    v_cvt_pk_bf16_f32 v34, v34, v35
    v_accvgpr_write_b32 a237, v34
    v_cvt_pk_bf16_f32 v228, v28, v29
    v_cvt_pk_bf16_f32 v229, v30, v31
    v_cvt_pk_bf16_f32 v252, v8, v9
    v_cvt_pk_bf16_f32 v253, v10, v11
    v_mov_b32 v156, 0
    v_mov_b32 v157, 0
    v_mov_b32 v121, 0
    v_add_u32 v230, 0, v158
    ds_write_b128 v230, v[4:7]
    v_add_u32 v135, s49, v135
    v_add_u32 v134, s49, v134
    ds_write2_b64 v230, v[156:157], v[156:157] offset0:2 offset1:3
    ds_write_b128 v230, v[0:3] offset:32
    ds_write2_b64 v230, v[160:161], v[156:157] offset0:6 offset1:7
    ds_write2_b64 v230, v[156:157], v[254:255] offset0:8 offset1:9
    ds_write_b64 v230, v[120:121] offset:88
    ds_read_b128 v[76:79], v137 offset:256
    ds_read_b128 v[56:59], v136 offset:256
    s_waitcnt lgkmcnt(1)
    v_mfma_f32_16x16x32_bf16 v[36:39], a[16:19], v[76:79], v[36:39]
    s_waitcnt lgkmcnt(0)
    v_mfma_f32_16x16x32_bf16 v[36:39], a[20:23], v[56:59], v[36:39]
    s_nop 0
    v_mfma_f32_16x16x16_bf16 v[8:11], v[20:21], v[26:27], v[12:15]
    s_nop 3
    v_mfma_f32_16x16x16_bf16 v[4:7], v[22:23], v[26:27], v[12:15]
    s_nop 0
    v_fma_f32 v121, v36, v36, s41
    v_fmac_f32 v121, v37, v37
    v_mfma_f32_16x16x16_bf16 v[0:3], v[24:25], v[26:27], v[12:15]
    v_cvt_pk_bf16_f32 v8, v8, v9
    v_accvgpr_write_b32 a238, v8
    v_cvt_pk_bf16_f32 v10, v10, v11
    v_mfma_f32_16x16x32_bf16 v[48:51], a[24:27], v[16:19], 0
    v_accvgpr_write_b32 a239, v10
    v_cvt_pk_bf16_f32 v230, v4, v5
    v_mfma_f32_16x16x32_bf16 v[48:51], a[28:31], v[146:149], v[48:51]
    v_cvt_pk_bf16_f32 v231, v6, v7
    v_cvt_pk_bf16_f32 v254, v0, v1
    v_mfma_f32_16x16x32_bf16 v[48:51], a[32:35], v[72:75], v[48:51]
    v_cvt_pk_bf16_f32 v255, v2, v3
    v_fmac_f32 v121, v38, v38
    v_mfma_f32_16x16x32_bf16 v[48:51], a[36:39], v[88:91], v[48:51]
    v_fmac_f32 v121, v39, v39
    v_mfma_f32_16x16x32_bf16 v[48:51], a[40:43], v[76:79], v[48:51]
    v_mfma_f32_16x16x32_bf16 v[48:51], a[44:47], v[56:59], v[48:51]
    s_nop 1
    v_mfma_f32_16x16x32_bf16 v[40:43], a[48:51], v[16:19], 0
    s_nop 2
    v_mfma_f32_16x16x32_bf16 v[40:43], a[52:55], v[146:149], v[40:43]
    s_nop 0
    v_fmac_f32 v121, v48, v48
    v_fmac_f32 v121, v49, v49
    v_mfma_f32_16x16x32_bf16 v[40:43], a[56:59], v[72:75], v[40:43]
    v_fmac_f32 v121, v50, v50
    v_fmac_f32 v121, v51, v51
    v_mfma_f32_16x16x32_bf16 v[40:43], a[60:63], v[88:91], v[40:43]
    v_mfma_f32_16x16x32_bf16 v[40:43], a[64:67], v[76:79], v[40:43]
    v_mfma_f32_16x16x32_bf16 v[40:43], a[68:71], v[56:59], v[40:43]
    s_nop 1
    v_mfma_f32_16x16x32_bf16 v[28:31], a[72:75], v[16:19], 0
    s_nop 2
    v_mfma_f32_16x16x32_bf16 v[28:31], a[76:79], v[146:149], v[28:31]
    s_nop 0
    v_fmac_f32 v121, v40, v40
    v_fmac_f32 v121, v41, v41
    v_mfma_f32_16x16x32_bf16 v[28:31], a[80:83], v[72:75], v[28:31]
    v_fmac_f32 v121, v42, v42
    v_fmac_f32 v121, v43, v43
    v_mfma_f32_16x16x32_bf16 v[28:31], a[84:87], v[88:91], v[28:31]
    v_mfma_f32_16x16x32_bf16 v[28:31], a[88:91], v[76:79], v[28:31]
    v_mfma_f32_16x16x32_bf16 v[28:31], a[92:95], v[56:59], v[28:31]
    s_nop 1
    v_mfma_f32_16x16x32_bf16 v[32:35], a[96:99], v[16:19], 0
    s_nop 2
    v_mfma_f32_16x16x32_bf16 v[32:35], a[100:103], v[146:149], v[32:35]
    s_nop 0
    v_fma_f32 v120, v28, v28, s41
    v_fmac_f32 v120, v29, v29
    v_mfma_f32_16x16x32_bf16 v[32:35], a[104:107], v[72:75], v[32:35]
    v_fmac_f32 v120, v30, v30
    v_fmac_f32 v120, v31, v31
    v_mfma_f32_16x16x32_bf16 v[32:35], a[108:111], v[88:91], v[32:35]
    v_mfma_f32_16x16x32_bf16 v[32:35], a[112:115], v[76:79], v[32:35]
    v_mfma_f32_16x16x32_bf16 v[32:35], a[116:119], v[56:59], v[32:35]
    s_nop 1
    v_mfma_f32_16x16x32_bf16 v[20:23], a[120:123], v[16:19], 0
    s_nop 2
    v_mfma_f32_16x16x32_bf16 v[20:23], a[124:127], v[146:149], v[20:23]
    s_nop 0
    v_fmac_f32 v120, v32, v32
    v_fmac_f32 v120, v33, v33
    v_mfma_f32_16x16x32_bf16 v[20:23], a[128:131], v[72:75], v[20:23]
    v_fmac_f32 v120, v34, v34
    v_fmac_f32 v120, v35, v35
    v_mfma_f32_16x16x32_bf16 v[20:23], a[132:135], v[88:91], v[20:23]
    v_mfma_f32_16x16x32_bf16 v[20:23], a[136:139], v[76:79], v[20:23]
    v_mfma_f32_16x16x32_bf16 v[20:23], a[140:143], v[56:59], v[20:23]
    s_nop 1
    v_mfma_f32_16x16x32_bf16 v[8:11], v[16:19], a[144:147], 0
    s_nop 2
    v_mfma_f32_16x16x32_bf16 v[8:11], v[146:149], a[148:151], v[8:11]
    s_nop 0
    v_fmac_f32 v120, v20, v20
    v_fmac_f32 v120, v21, v21
    v_mfma_f32_16x16x32_bf16 v[8:11], v[72:75], a[152:155], v[8:11]
    v_fmac_f32 v120, v22, v22
    v_fmac_f32 v120, v23, v23
    v_mfma_f32_16x16x32_bf16 v[8:11], v[88:91], a[156:159], v[8:11]
    v_cvt_pk_bf16_f32 v170, v121, v120
    v_mfma_f32_16x16x32_bf16 v[8:11], v[76:79], a[160:163], v[8:11]
    ds_read_b128 v[104:107], v137 offset:1536
    v_mfma_f32_16x16x32_bf16 v[8:11], v[56:59], a[164:167], v[8:11]
    s_nop 0
    ds_read_b128 v[100:103], v136 offset:1536
    s_nop 0
    v_mfma_f32_16x16x16_bf16 v[24:27], v[216:217], v[170:171], 0
    s_nop 0
    ds_read_b128 v[44:47], v137 offset:1664
    s_nop 1
    v_cvt_pk_bf16_f32 v0, v8, v9
    v_mfma_f32_16x16x32_bf16 v[4:7], v[16:19], a[168:171], 0
    ds_read_b128 v[84:87], v136 offset:1664
    v_cvt_pk_bf16_f32 v1, v10, v11
    v_mfma_f32_16x16x32_bf16 v[4:7], v[146:149], a[172:175], v[4:7]
    ds_read_b128 v[68:71], v137 offset:1792
    v_mfma_f32_16x16x32_bf16 v[4:7], v[72:75], a[176:179], v[4:7]
    ds_read_b128 v[64:67], v136 offset:1792
    v_mfma_f32_16x16x32_bf16 v[4:7], v[88:91], a[180:183], v[4:7]
    v_rsq_f32 v24, v24
    v_mfma_f32_16x16x32_bf16 v[4:7], v[76:79], a[184:187], v[4:7]
    v_rsq_f32 v25, v25
    v_mfma_f32_16x16x32_bf16 v[4:7], v[56:59], a[188:191], v[4:7]
    v_mul_f32 v24, s55, v24
    v_mul_f32 v25, 0.5, v25
    v_mfma_f32_16x16x32_bf16 v[12:15], v[16:19], a[192:195], 0
    s_nop 0
    v_mul_f32 v36, v36, v24
    v_mul_f32 v37, v37, v24
    v_mfma_f32_16x16x32_bf16 v[12:15], v[146:149], a[196:199], v[12:15]
    s_nop 0
    v_cvt_pk_bf16_f32 v8, v4, v5
    v_cvt_pk_bf16_f32 v9, v6, v7
    v_mfma_f32_16x16x32_bf16 v[12:15], v[72:75], a[200:203], v[12:15]
    v_cvt_pk_f16_f32 v4, v36, v37
    v_mul_f32 v38, v38, v24
    v_mfma_f32_16x16x32_bf16 v[12:15], v[88:91], a[204:207], v[12:15]
    v_mul_f32 v39, v39, v24
    v_cvt_pk_f16_f32 v5, v38, v39
    v_mfma_f32_16x16x32_bf16 v[12:15], v[76:79], a[208:211], v[12:15]
    v_mul_f32 v48, v48, v24
    v_mul_f32 v49, v49, v24
    v_mfma_f32_16x16x32_bf16 v[12:15], v[56:59], a[212:215], v[12:15]
    s_waitcnt lgkmcnt(0)
    v_cvt_pk_f16_f32 v6, v48, v49
    v_mul_f32 v50, v50, v24
    v_mfma_f32_16x16x32_bf16 v[16:19], a[0:3], v[104:107], 0
    v_mul_f32 v51, v51, v24
    v_cvt_pk_f16_f32 v7, v50, v51
    v_mfma_f32_16x16x32_bf16 v[16:19], a[4:7], v[100:103], v[16:19]
    v_mul_f32 v40, v40, v24
    v_mul_f32 v41, v41, v24
    v_mfma_f32_16x16x32_bf16 v[16:19], a[8:11], v[44:47], v[16:19]
    v_cvt_pk_f16_f32 v152, v40, v41
    v_mul_f32 v42, v42, v24
    v_mfma_f32_16x16x32_bf16 v[16:19], a[12:15], v[84:87], v[16:19]
    v_mul_f32 v43, v43, v24
    v_cvt_pk_f16_f32 v153, v42, v43
    v_mfma_f32_16x16x32_bf16 v[16:19], a[16:19], v[68:71], v[16:19]
    v_mul_f32 v28, v28, v25
    v_mul_f32 v29, v29, v25
    v_mfma_f32_16x16x32_bf16 v[16:19], a[20:23], v[64:67], v[16:19]
    v_cvt_pk_f16_f32 v28, v28, v29
    v_mul_f32 v30, v30, v25
    v_mfma_f32_16x16x32_bf16 v[60:63], a[24:27], v[104:107], 0
    v_mul_f32 v31, v31, v25
    v_cvt_pk_f16_f32 v29, v30, v31
    v_mfma_f32_16x16x32_bf16 v[60:63], a[28:31], v[100:103], v[60:63]
    v_mul_f32 v32, v32, v25
    v_mul_f32 v33, v33, v25
    v_mfma_f32_16x16x32_bf16 v[60:63], a[32:35], v[44:47], v[60:63]
    v_cvt_pk_f16_f32 v30, v32, v33
    v_mul_f32 v34, v34, v25
    v_mfma_f32_16x16x32_bf16 v[60:63], a[36:39], v[84:87], v[60:63]
    v_mul_f32 v35, v35, v25
    v_cvt_pk_f16_f32 v31, v34, v35
    v_mfma_f32_16x16x32_bf16 v[60:63], a[40:43], v[68:71], v[60:63]
    v_mul_f32 v20, v20, v25
    v_mul_f32 v21, v21, v25
    v_mfma_f32_16x16x32_bf16 v[60:63], a[44:47], v[64:67], v[60:63]
    v_cvt_pk_f16_f32 v154, v20, v21
    v_mul_f32 v22, v22, v25
    v_mfma_f32_16x16x32_bf16 v[36:39], a[48:51], v[104:107], 0
    v_mul_f32 v23, v23, v25
    v_cvt_pk_f16_f32 v155, v22, v23
    v_mfma_f32_16x16x32_bf16 v[36:39], a[52:55], v[100:103], v[36:39]
    v_cvt_pk_bf16_f32 v20, v12, v13
    v_cvt_pk_bf16_f32 v21, v14, v15
    v_mfma_f32_16x16x32_bf16 v[36:39], a[56:59], v[44:47], v[36:39]
    v_fma_f32 v2, v16, v16, s41
    v_fmac_f32 v2, v17, v17
    v_mfma_f32_16x16x32_bf16 v[36:39], a[60:63], v[84:87], v[36:39]
    v_fmac_f32 v2, v18, v18
    v_fmac_f32 v2, v19, v19
    v_mfma_f32_16x16x32_bf16 v[36:39], a[64:67], v[68:71], v[36:39]
    v_fmac_f32 v2, v60, v60
    v_fmac_f32 v2, v61, v61
    v_mfma_f32_16x16x32_bf16 v[36:39], a[68:71], v[64:67], v[36:39]
    v_fmac_f32 v2, v62, v62
    v_fmac_f32 v2, v63, v63
    v_mfma_f32_16x16x32_bf16 v[52:55], a[72:75], v[104:107], 0
    s_nop 2
    v_mfma_f32_16x16x32_bf16 v[52:55], a[76:79], v[100:103], v[52:55]
    s_nop 0
    v_fmac_f32 v2, v36, v36
    v_fmac_f32 v2, v37, v37
    v_mfma_f32_16x16x32_bf16 v[52:55], a[80:83], v[44:47], v[52:55]
    v_fmac_f32 v2, v38, v38
    v_fmac_f32 v2, v39, v39
    v_mfma_f32_16x16x32_bf16 v[52:55], a[84:87], v[84:87], v[52:55]
    v_mfma_f32_16x16x32_bf16 v[52:55], a[88:91], v[68:71], v[52:55]
    v_mfma_f32_16x16x32_bf16 v[52:55], a[92:95], v[64:67], v[52:55]
    s_nop 1
    v_mfma_f32_16x16x32_bf16 v[12:15], a[96:99], v[104:107], 0
    s_nop 2
    v_mfma_f32_16x16x32_bf16 v[12:15], a[100:103], v[100:103], v[12:15]
    s_nop 0
    v_fma_f32 v3, v52, v52, s41
    v_fmac_f32 v3, v53, v53
    v_mfma_f32_16x16x32_bf16 v[12:15], a[104:107], v[44:47], v[12:15]
    v_fmac_f32 v3, v54, v54
    v_fmac_f32 v3, v55, v55
    v_mfma_f32_16x16x32_bf16 v[12:15], a[108:111], v[84:87], v[12:15]
    v_mfma_f32_16x16x32_bf16 v[12:15], a[112:115], v[68:71], v[12:15]
    v_mfma_f32_16x16x32_bf16 v[12:15], a[116:119], v[64:67], v[12:15]
    s_sub_u32 s50, s45, s44
    v_add_u32 v135, s48, v135
    v_add_u32 v134, s48, v134
    v_mfma_f32_16x16x32_bf16 v[48:51], a[120:123], v[104:107], 0
    s_sub_u32 s51, s46, s47
    v_add_u32 v133, s51, v133
    v_mfma_f32_16x16x32_bf16 v[48:51], a[124:127], v[100:103], v[48:51]
    s_mov_b32 s60, s59
    v_fmac_f32 v3, v12, v12
    v_fmac_f32 v3, v13, v13
    v_mfma_f32_16x16x32_bf16 v[48:51], a[128:131], v[44:47], v[48:51]
    s_mov_b32 s59, s58
    v_fmac_f32 v3, v14, v14
    v_fmac_f32 v3, v15, v15
    v_mfma_f32_16x16x32_bf16 v[48:51], a[132:135], v[84:87], v[48:51]
    s_mov_b32 s58, s57
    v_mfma_f32_16x16x32_bf16 v[48:51], a[136:139], v[68:71], v[48:51]
    s_mov_b32 s57, s56
    v_mfma_f32_16x16x32_bf16 v[48:51], a[140:143], v[64:67], v[48:51]
    s_mov_b32 s7, s6
    s_nop 0
    v_mfma_f32_16x16x32_bf16 v[24:27], v[104:107], a[144:147], 0
    s_mov_b32 s6, s5
    s_nop 1
    v_mfma_f32_16x16x32_bf16 v[24:27], v[100:103], a[148:151], v[24:27]
    s_mov_b32 s5, s4
    v_fmac_f32 v3, v48, v48
    v_fmac_f32 v3, v49, v49
    v_mfma_f32_16x16x32_bf16 v[24:27], v[44:47], a[152:155], v[24:27]
    s_sub_u32 s14, s6, s7
    v_fmac_f32 v3, v50, v50
    v_fmac_f32 v3, v51, v51
    v_mfma_f32_16x16x32_bf16 v[24:27], v[84:87], a[156:159], v[24:27]
    s_add_u32 s61, s61, 1
    v_cvt_pk_bf16_f32 v170, v2, v3
    v_add_u32 v132, s14, v132
    v_mfma_f32_16x16x32_bf16 v[24:27], v[68:71], a[160:163], v[24:27]
    s_ff1_i32_b32 s15, s66
    ds_read_b128 v[96:99], v137 offset:3072
    v_add_u32 v131, s14, v131
    v_mfma_f32_16x16x32_bf16 v[24:27], v[64:67], a[164:167], v[24:27]
    s_cmp_lg_u32 s66, 0
    ds_read_b128 v[92:95], v136 offset:3072
    v_add_u32 v123, s14, v123
    v_mfma_f32_16x16x16_bf16 v[40:43], v[216:217], v[170:171], 0
    s_cselect_b32 s12, s15, s12
    ds_read_b128 v[88:91], v137 offset:3200
    s_nop 1
    v_cvt_pk_bf16_f32 v2, v24, v25
    v_mfma_f32_16x16x32_bf16 v[72:75], v[104:107], a[168:171], 0
    s_cmp_lt_u32 s61, s71
    ds_read_b128 v[80:83], v136 offset:3200
    v_cvt_pk_bf16_f32 v3, v26, v27
    v_mfma_f32_16x16x32_bf16 v[72:75], v[100:103], a[172:175], v[72:75]
    s_cselect_b32 s15, 31, s15
    ds_read_b128 v[56:59], v137 offset:3328
    v_add_u32 v137, s50, v137
    v_mfma_f32_16x16x32_bf16 v[72:75], v[44:47], a[176:179], v[72:75]
    s_bitset0_b32 s66, s15
    ds_read_b128 v[24:27], v136 offset:3328
    v_add_u32 v136, s50, v136
    v_mfma_f32_16x16x32_bf16 v[72:75], v[84:87], a[180:183], v[72:75]
    s_add_u32 s12, s12, 20
    v_rsq_f32 v40, v40
    v_mfma_f32_16x16x32_bf16 v[72:75], v[68:71], a[184:187], v[72:75]
    s_max_u32 s12, s12, s61
    v_rsq_f32 v41, v41
    v_mfma_f32_16x16x32_bf16 v[72:75], v[64:67], a[188:191], v[72:75]
    s_cmp_lt_u32 s61, s71
    v_mul_f32 v40, s55, v40
    v_mul_f32 v41, 0.5, v41
    v_mfma_f32_16x16x32_bf16 v[32:35], v[104:107], a[192:195], 0
    s_cselect_b32 s15, s61, s12
    v_mul_f32 v16, v16, v40
    v_mul_f32 v17, v17, v40
    v_mfma_f32_16x16x32_bf16 v[32:35], v[100:103], a[196:199], v[32:35]
    s_cselect_b32 s56, s69, s70
    v_cvt_pk_bf16_f32 v10, v72, v73
    v_cvt_pk_bf16_f32 v11, v74, v75
    v_mfma_f32_16x16x32_bf16 v[32:35], v[44:47], a[200:203], v[32:35]
    s_add_u32 s56, s56, s15
    v_cvt_pk_f16_f32 v44, v16, v17
    v_mul_f32 v18, v18, v40
    v_mfma_f32_16x16x32_bf16 v[32:35], v[84:87], a[204:207], v[32:35]
    s_mul_i32 s53, s56, 58255
    v_mul_f32 v19, v19, v40
    v_cvt_pk_f16_f32 v45, v18, v19
    v_mfma_f32_16x16x32_bf16 v[32:35], v[68:71], a[208:211], v[32:35]
    s_waitcnt lgkmcnt(0)
    s_lshr_b32 s53, s53, 22
    v_mul_f32 v60, v60, v40
    v_mul_f32 v61, v61, v40
    v_mfma_f32_16x16x32_bf16 v[32:35], v[64:67], a[212:215], v[32:35]
    s_barrier
    v_cvt_pk_f16_f32 v46, v60, v61
    v_mul_f32 v62, v62, v40
    v_mfma_f32_16x16x32_bf16 v[16:19], a[0:3], v[96:99], 0
    s_mul_i32 s53, s53, s63
    v_mul_f32 v63, v63, v40
    v_cvt_pk_f16_f32 v47, v62, v63
    v_mfma_f32_16x16x32_bf16 v[16:19], a[4:7], v[92:95], v[16:19]
    s_mul_i32 s56, s56, s62
    v_mul_f32 v36, v36, v40
    v_mul_f32 v37, v37, v40
    v_mfma_f32_16x16x32_bf16 v[16:19], a[8:11], v[88:91], v[16:19]
    s_add_u32 s56, s56, s53
    v_cvt_pk_f16_f32 v146, v36, v37
    v_mul_f32 v38, v38, v40
    v_mfma_f32_16x16x32_bf16 v[16:19], a[12:15], v[80:83], v[16:19]
    s_mul_i32 s4, s15, 112
    v_mul_f32 v39, v39, v40
    v_cvt_pk_f16_f32 v147, v38, v39
    v_mfma_f32_16x16x32_bf16 v[16:19], a[16:19], v[56:59], v[16:19]
    s_cmp_ge_u32 s15, 16
    v_mul_f32 v52, v52, v41
    v_mul_f32 v53, v53, v41
    v_mfma_f32_16x16x32_bf16 v[16:19], a[20:23], v[24:27], v[16:19]
    s_cselect_b32 s53, -30464, 0
    v_cvt_pk_f16_f32 v72, v52, v53
    v_mul_f32 v54, v54, v41
    v_mfma_f32_16x16x32_bf16 v[36:39], a[24:27], v[96:99], 0
    s_add_u32 s4, s4, s53
    v_mul_f32 v55, v55, v41
    v_cvt_pk_f16_f32 v73, v54, v55
    v_mfma_f32_16x16x32_bf16 v[36:39], a[28:31], v[92:95], v[36:39]
    s_cmp_lt_u32 s15, s73
    v_mul_f32 v12, v12, v41
    v_mul_f32 v13, v13, v41
    v_mfma_f32_16x16x32_bf16 v[36:39], a[32:35], v[88:91], v[36:39]
    s_cselect_b32 s26, 100270464, 0
    v_cvt_pk_f16_f32 v74, v12, v13
    v_mul_f32 v14, v14, v41
    v_mfma_f32_16x16x32_bf16 v[36:39], a[36:39], v[80:83], v[36:39]
    s_cselect_b32 s56, s56, 0
    v_mul_f32 v15, v15, v41
    v_cvt_pk_f16_f32 v75, v14, v15
    v_mfma_f32_16x16x32_bf16 v[36:39], a[40:43], v[56:59], v[36:39]
    s_cselect_b32 s4, s4, -1
    v_mul_f32 v48, v48, v41
    v_mul_f32 v49, v49, v41
    v_mfma_f32_16x16x32_bf16 v[36:39], a[44:47], v[24:27], v[36:39]
    s_cselect_b32 s15, s15, 0
    v_cvt_pk_f16_f32 v148, v48, v49
    v_mul_f32 v50, v50, v41
    v_mfma_f32_16x16x32_bf16 v[12:15], a[48:51], v[96:99], 0
    s_cselect_b32 s13, s13, -1
    v_mul_f32 v51, v51, v41
    v_cvt_pk_f16_f32 v149, v50, v51
    v_mfma_f32_16x16x32_bf16 v[12:15], a[52:55], v[92:95], v[12:15]
    s_bitset1_b32 s64, s15
    v_cvt_pk_bf16_f32 v22, v32, v33
    v_cvt_pk_bf16_f32 v23, v34, v35
    v_mfma_f32_16x16x32_bf16 v[12:15], a[56:59], v[88:91], v[12:15]
    s_add_u32 s65, s65, 1
    v_fma_f32 v156, v16, v16, s41
    v_fmac_f32 v156, v17, v17
    v_mfma_f32_16x16x32_bf16 v[12:15], a[60:63], v[80:83], v[12:15]
    s_cmp_ge_i32 s65, 2
    v_fmac_f32 v156, v18, v18
    v_fmac_f32 v156, v19, v19
    v_mfma_f32_16x16x32_bf16 v[12:15], a[64:67], v[56:59], v[12:15]
    s_cselect_b32 s30, 100270464, 0
    v_fmac_f32 v156, v36, v36
    v_fmac_f32 v156, v37, v37
    v_mfma_f32_16x16x32_bf16 v[12:15], a[68:71], v[24:27], v[12:15]
    s_add_u32 s67, s46, s54
    v_fmac_f32 v156, v38, v38
    v_fmac_f32 v156, v39, v39
    v_mfma_f32_16x16x32_bf16 v[64:67], a[72:75], v[96:99], 0
    s_add_u32 m0, s67, 0
    v_and_b32 v120, -8, v123
    v_mfma_f32_16x16x32_bf16 v[64:67], a[76:79], v[92:95], v[64:67]
    buffer_load_dwordx4 v128, s[24:27], s56 offen nt lds
    v_fmac_f32 v156, v12, v12
    v_mfma_f32_16x16x32_bf16 v[64:67], a[80:83], v[88:91], v[64:67]
    s_add_u32 m0, s67, 1024
    v_fmac_f32 v156, v13, v13
    v_fmac_f32 v156, v14, v14
    v_mfma_f32_16x16x32_bf16 v[64:67], a[84:87], v[80:83], v[64:67]
    v_fmac_f32 v156, v15, v15
    v_mfma_f32_16x16x32_bf16 v[64:67], a[88:91], v[56:59], v[64:67]
    v_mfma_f32_16x16x32_bf16 v[64:67], a[92:95], v[24:27], v[64:67]
    s_nop 1
    v_mfma_f32_16x16x32_bf16 v[32:35], a[96:99], v[96:99], 0
    s_nop 0
    buffer_load_dwordx4 v127, s[24:27], s56 offen nt lds
    s_nop 0
    v_mfma_f32_16x16x32_bf16 v[32:35], a[100:103], v[92:95], v[32:35]
    s_add_u32 m0, s67, 2048
    v_fma_f32 v121, v64, v64, s41
    v_fmac_f32 v121, v65, v65
    v_mfma_f32_16x16x32_bf16 v[32:35], a[104:107], v[88:91], v[32:35]
    v_fmac_f32 v121, v66, v66
    v_fmac_f32 v121, v67, v67
    v_mfma_f32_16x16x32_bf16 v[32:35], a[108:111], v[80:83], v[32:35]
    v_mfma_f32_16x16x32_bf16 v[32:35], a[112:115], v[56:59], v[32:35]
    v_mfma_f32_16x16x32_bf16 v[32:35], a[116:119], v[24:27], v[32:35]
    buffer_load_dwordx4 v126, s[24:27], s56 offen nt lds
    s_nop 0
    v_mfma_f32_16x16x32_bf16 v[40:43], a[120:123], v[96:99], 0
    s_add_u32 m0, s67, 3072
    s_nop 1
    v_mfma_f32_16x16x32_bf16 v[40:43], a[124:127], v[92:95], v[40:43]
    s_mov_b32 s53, s47
    v_fmac_f32 v121, v32, v32
    v_fmac_f32 v121, v33, v33
    v_mfma_f32_16x16x32_bf16 v[40:43], a[128:131], v[88:91], v[40:43]
    s_mov_b32 s47, s46
    v_fmac_f32 v121, v34, v34
    v_fmac_f32 v121, v35, v35
    v_mfma_f32_16x16x32_bf16 v[40:43], a[132:135], v[80:83], v[40:43]
    s_mov_b32 s46, s45
    v_mfma_f32_16x16x32_bf16 v[40:43], a[136:139], v[56:59], v[40:43]
    s_mov_b32 s45, s44
    buffer_load_dwordx4 v125, s[24:27], s56 offen nt lds
    v_mfma_f32_16x16x32_bf16 v[40:43], a[140:143], v[24:27], v[40:43]
    s_add_u32 m0, s67, 4096
    s_nop 0
    v_mfma_f32_16x16x32_bf16 v[68:71], v[96:99], a[144:147], 0
    s_mov_b32 s44, s53
    s_nop 1
    v_mfma_f32_16x16x32_bf16 v[68:71], v[92:95], a[148:151], v[68:71]
    s_sub_u32 s48, s44, s46
    v_fmac_f32 v121, v40, v40
    v_fmac_f32 v121, v41, v41
    v_mfma_f32_16x16x32_bf16 v[68:71], v[88:91], a[152:155], v[68:71]
    s_sub_u32 s49, s46, s45
    v_fmac_f32 v121, v42, v42
    v_fmac_f32 v121, v43, v43
    v_mfma_f32_16x16x32_bf16 v[68:71], v[80:83], a[156:159], v[68:71]
    buffer_load_dwordx4 v124, s[24:27], s56 offen nt lds
    v_cvt_pk_bf16_f32 v170, v156, v121
    v_mfma_f32_16x16x32_bf16 v[68:71], v[56:59], a[160:163], v[68:71]
    ds_read_b128 v[60:63], v132 offset:0
    v_add_u32 v137, s48, v137
    v_mfma_f32_16x16x32_bf16 v[68:71], v[24:27], a[164:167], v[68:71]
    s_nop 0
    ds_read_b128 v[52:55], v132 offset:16
    v_add_u32 v136, s48, v136
    v_mfma_f32_16x16x16_bf16 v[76:79], v[216:217], v[170:171], 0
    s_nop 0
    ds_read_b128 v[48:51], v132 offset:48
    s_nop 1
    v_cvt_pk_bf16_f32 v164, v68, v69
    v_mfma_f32_16x16x32_bf16 v[84:87], v[96:99], a[168:171], 0
    v_cvt_pk_bf16_f32 v165, v70, v71
    v_mfma_f32_16x16x32_bf16 v[84:87], v[92:95], a[172:175], v[84:87]
    v_rsq_f32 v76, v76
    v_mfma_f32_16x16x32_bf16 v[84:87], v[88:91], a[176:179], v[84:87]
    v_rsq_f32 v77, v77
    v_mfma_f32_16x16x32_bf16 v[84:87], v[80:83], a[180:183], v[84:87]
    v_mul_f32 v76, s55, v76
    v_mul_f32 v77, 0.5, v77
    v_mfma_f32_16x16x32_bf16 v[84:87], v[56:59], a[184:187], v[84:87]
    v_mul_f32 v64, v64, v77
    v_mul_f32 v65, v65, v77
    v_mfma_f32_16x16x32_bf16 v[84:87], v[24:27], a[188:191], v[84:87]
    v_cvt_pk_f16_f32 v64, v64, v65
    v_mul_f32 v66, v66, v77
    v_mfma_f32_16x16x32_bf16 v[68:71], v[96:99], a[192:195], 0
    s_nop 0
    v_mul_f32 v67, v67, v77
    v_cvt_pk_f16_f32 v65, v66, v67
    v_mfma_f32_16x16x32_bf16 v[68:71], v[92:95], a[196:199], v[68:71]
    s_nop 0
    v_cvt_pk_bf16_f32 v160, v84, v85
    v_cvt_pk_bf16_f32 v161, v86, v87
    v_mfma_f32_16x16x32_bf16 v[68:71], v[88:91], a[200:203], v[68:71]
    v_mul_f32 v32, v32, v77
    v_mul_f32 v33, v33, v77
    v_mfma_f32_16x16x32_bf16 v[68:71], v[80:83], a[204:207], v[68:71]
    v_cvt_pk_f16_f32 v66, v32, v33
    v_mul_f32 v34, v34, v77
    v_mfma_f32_16x16x32_bf16 v[68:71], v[56:59], a[208:211], v[68:71]
    v_mul_f32 v35, v35, v77
    v_cvt_pk_f16_f32 v67, v34, v35
    v_mfma_f32_16x16x32_bf16 v[68:71], v[24:27], a[212:215], v[68:71]
    v_mul_f32 v40, v40, v77
    v_mul_f32 v41, v41, v77
    v_mfma_f32_16x16x32_f16 v[32:35], v[28:31], v[4:7], v[204:207]
    ds_read_u16 v166, v131 offset:80
    v_cvt_pk_f16_f32 v142, v40, v41
    v_mfma_f32_16x16x32_f16 v[32:35], v[152:155], v[150:153], v[32:35]
    ds_read_u16 v162, v131 offset:96
    v_mul_f32 v42, v42, v77
    v_mfma_f32_16x16x32_f16 v[24:27], v[72:75], v[4:7], v[200:203]
    ds_read_u16 v158, v131 offset:104
    v_mul_f32 v43, v43, v77
    v_mfma_f32_16x16x32_f16 v[24:27], v[146:149], v[150:153], v[24:27]
    s_waitcnt lgkmcnt(3)
    ds_read_b32 v120, v120 offset:64
    v_cvt_pk_f16_f32 v143, v42, v43
    v_mfma_f32_16x16x32_f16 v[56:59], v[60:63], v[4:7], v[208:211]
    v_mul_f32 v16, v16, v76
    v_mul_f32 v17, v17, v76
    v_mfma_f32_16x16x32_f16 v[56:59], v[52:55], v[28:31], v[56:59]
    v_cvt_pk_f16_f32 v16, v16, v17
    v_mul_f32 v18, v18, v76
    v_mfma_f32_16x16x32_f16 v[56:59], v[48:51], v[152:155], v[56:59]
    v_mul_f32 v19, v19, v76
    v_cvt_pk_f16_f32 v17, v18, v19
    v_mfma_f32_16x16x32_f16 v[40:43], v[60:63], v[44:47], v[208:211]
    v_mul_f32 v36, v36, v76
    v_mul_f32 v37, v37, v76
    v_mfma_f32_16x16x32_f16 v[40:43], v[52:55], v[72:75], v[40:43]
    v_cvt_pk_f16_f32 v18, v36, v37
    v_mul_f32 v38, v38, v76
    v_mfma_f32_16x16x32_f16 v[40:43], v[48:51], v[146:149], v[40:43]
    v_mul_f32 v39, v39, v76
    v_cvt_pk_f16_f32 v19, v38, v39
    v_mfma_f32_16x16x32_f16 v[36:39], v[28:31], v[44:47], v[192:195]
    v_mul_f32 v12, v12, v76
    v_mul_f32 v13, v13, v76
    v_mfma_f32_16x16x32_f16 v[36:39], v[152:155], v[144:147], v[36:39]
    v_cvt_pk_f16_f32 v140, v12, v13
    v_mul_f32 v14, v14, v76
    v_mul_f32 v15, v15, v76
    v_cvt_pk_f16_f32 v141, v14, v15
    v_mfma_f32_16x16x32_f16 v[12:15], v[64:67], v[4:7], v[196:199]
    v_cvt_pk_bf16_f32 v156, v68, v69
    v_cvt_pk_bf16_f32 v157, v70, v71
    v_mfma_f32_16x16x32_f16 v[12:15], v[140:143], v[150:153], v[12:15]
    v_max3_f32 v121, v32, v33, v34
    v_max3_f32 v121, v121, v35, v24
    v_mfma_f32_16x16x32_f16 v[4:7], v[60:63], v[16:19], v[208:211]
    s_nop 0
    v_max3_f32 v121, v121, v25, v26
    v_mov_b32_dpp v59, v43 quad_perm:[0,1,2,3] row_mask:0x2 bank_mask:0xf
    v_mfma_f32_16x16x32_f16 v[4:7], v[52:55], v[64:67], v[4:7]
    s_nop 0
    v_max3_f32 v121, v121, v27, v12
    v_max3_f32 v121, v121, v13, v14
    v_mfma_f32_16x16x32_f16 v[4:7], v[48:51], v[140:143], v[4:7]
    v_max3_f32 v121, v121, v15, v56
    v_mov_b32 v57, v121
    v_mfma_f32_16x16x32_f16 v[52:55], v[72:75], v[44:47], v[188:191]
    s_nop 0
    v_permlane32_swap_b32 v57, v121
    v_mfma_f32_16x16x32_f16 v[52:55], v[146:149], v[144:147], v[52:55]
    v_max_f32 v121, v57, v121
    v_mov_b32 v57, v121
    v_mfma_f32_16x16x32_f16 v[48:51], v[64:67], v[44:47], v[184:187]
    s_nop 0
    v_permlane16_swap_b32 v57, v121
    v_mfma_f32_16x16x32_f16 v[48:51], v[140:143], v[144:147], v[48:51]
    v_max_f32 v121, v57, v121
    v_sub_f32 v32, v32, v121
    v_sub_f32 v33, v33, v121
    v_sub_f32 v34, v34, v121
    v_sub_f32 v35, v35, v121
    v_sub_f32 v24, v24, v121
    v_sub_f32 v25, v25, v121
    v_sub_f32 v26, v26, v121
    v_sub_f32 v27, v27, v121
    v_sub_f32 v12, v12, v121
    v_sub_f32 v13, v13, v121
    v_sub_f32 v14, v14, v121
    v_sub_f32 v15, v15, v121
    v_sub_f32 v56, v56, v121
    v_exp_f32 v32, v32
    v_exp_f32 v33, v33
    v_exp_f32 v34, v34
    v_exp_f32 v35, v35
    v_cvt_pk_bf16_f32 v60, v32, v33
    v_cvt_pk_bf16_f32 v61, v34, v35
    v_exp_f32 v24, v24
    v_exp_f32 v25, v25
    v_exp_f32 v26, v26
    v_exp_f32 v27, v27
    v_cvt_pk_bf16_f32 v62, v24, v25
    v_cvt_pk_bf16_f32 v63, v26, v27
    v_exp_f32 v12, v12
    v_exp_f32 v13, v13
    v_exp_f32 v14, v14
    v_exp_f32 v15, v15
    v_cvt_pk_bf16_f32 v168, v12, v13
    v_cvt_pk_bf16_f32 v169, v14, v15
    v_exp_f32 v56, v56
    v_mov_b32_dpp v59, v7 quad_perm:[0,1,2,3] row_mask:0x4 bank_mask:0xf
    v_cvt_pk_bf16_f32 v170, v56, 0
    v_mfma_f32_16x16x32_bf16 v[44:47], v[220:223], v[60:63], 0
    s_waitcnt lgkmcnt(0)
    v_and_b32 v121, 0xffff0000, v120
    v_lshlrev_b32 v120, 16, v120
    v_mfma_f32_16x16x32_bf16 v[44:47], v[220:223], v[168:171], v[44:47]
    v_add_f32 v120, v120, v121
    v_add_f32 v120, v120, v211
    v_mfma_f32_16x16x32_bf16 v[12:15], v[0:3], v[60:63], 0
    s_nop 0
    v_mov_b32_dpp v59, v120 quad_perm:[0,1,2,3] row_mask:0x8 bank_mask:0xf
    v_mov_b32 v4, v59
    v_mfma_f32_16x16x32_bf16 v[12:15], v[164:167], v[168:171], v[12:15]
    s_nop 0
    v_max_f32_dpp v4, v4, v4 row_ror:8 row_mask:0xf bank_mask:0xf
    v_max3_f32 v121, v36, v37, v38
    v_mfma_f32_16x16x32_bf16 v[24:27], v[8:11], v[60:63], 0
    v_max_f32_dpp v4, v4, v4 row_ror:4 row_mask:0xf bank_mask:0xf
    v_max3_f32 v121, v121, v39, v52
    v_mfma_f32_16x16x32_bf16 v[24:27], v[160:163], v[168:171], v[24:27]
    v_max_f32_dpp v4, v4, v4 row_ror:2 row_mask:0xf bank_mask:0xf
    v_max3_f32 v121, v121, v53, v54
    v_mfma_f32_16x16x32_bf16 v[32:35], v[20:23], v[60:63], 0
    v_max_f32_dpp v4, v4, v4 row_ror:1 row_mask:0xf bank_mask:0xf
    v_mov_b32 v120, v4
    v_mfma_f32_16x16x32_bf16 v[32:35], v[156:159], v[168:171], v[32:35]
    s_nop 0
    v_permlane32_swap_b32 v120, v4
    v_max_f32 v4, v120, v4
    v_mov_b32 v120, v4
    v_rcp_f32 v44, v44
    v_max3_f32 v121, v121, v55, v48
    v_permlane16_swap_b32 v120, v4
    v_max_f32 v4, v120, v4
    v_sub_f32 v59, v59, v4
    v_exp_f32 v59, v59
    v_mul_f32 v12, v12, v44
    v_cvt_pk_bf16_f32 v59, v59, v59
    ds_write_b16 v123, v59 offset:64
    v_mul_f32 v13, v13, v44
    v_cvt_pk_bf16_f32 v68, v12, v13
    ds_read_b128 v[60:63], v132 offset:48
    v_mul_f32 v14, v14, v44
    v_mul_f32 v15, v15, v44
    v_cvt_pk_bf16_f32 v69, v14, v15
    ds_read_b128 v[56:59], v132 offset:64
    v_mfma_f32_16x16x32_f16 v[12:15], v[28:31], v[16:19], v[180:183]
    v_mul_f32 v24, v24, v44
    v_mul_f32 v25, v25, v44
    v_mfma_f32_16x16x32_f16 v[12:15], v[152:155], v[138:141], v[12:15]
    ds_write_b64 v135, v[68:69] offset:0
    v_mfma_f32_16x16x32_f16 v[28:31], v[72:75], v[16:19], v[176:179]
    v_cvt_pk_bf16_f32 v70, v24, v25
    v_mul_f32 v26, v26, v44
    v_mfma_f32_16x16x32_f16 v[28:31], v[146:149], v[138:141], v[28:31]
    v_mul_f32 v27, v27, v44
    v_cvt_pk_bf16_f32 v71, v26, v27
    v_mfma_f32_16x16x32_f16 v[24:27], v[64:67], v[16:19], v[172:175]
    ds_write_b64 v135, v[70:71] offset:8
    v_mfma_f32_16x16x32_f16 v[24:27], v[140:143], v[138:141], v[24:27]
    s_waitcnt lgkmcnt(3)
    v_mul_f32 v32, v32, v44
    v_mul_f32 v33, v33, v44
    v_cvt_pk_bf16_f32 v146, v32, v33
    v_mul_f32 v34, v34, v44
    v_mfma_f32_16x16x32_bf16 v[16:19], v[60:63], v[0:3], 0
    s_waitcnt lgkmcnt(2)
    v_mul_f32 v35, v35, v44
    v_cvt_pk_bf16_f32 v147, v34, v35
    v_max3_f32 v121, v121, v49, v50
    v_max3_f32 v121, v121, v51, v41
    v_mfma_f32_16x16x32_bf16 v[16:19], v[56:59], v[164:167], v[16:19]
    ds_write_b64 v134, v[146:147] offset:0
    v_mfma_f32_16x16x32_bf16 v[44:47], v[60:63], v[8:11], 0
    v_mov_b32 v146, v121
    v_max3_f32 v120, v12, v13, v14
    v_mfma_f32_16x16x32_bf16 v[44:47], v[56:59], v[160:163], v[44:47]
    v_permlane32_swap_b32 v146, v121
    v_mfma_f32_16x16x32_bf16 v[32:35], v[60:63], v[20:23], 0
    v_max_f32 v121, v146, v121
    v_mov_b32 v146, v121
    v_mfma_f32_16x16x32_bf16 v[32:35], v[56:59], v[156:159], v[32:35]
    s_nop 0
    v_permlane16_swap_b32 v146, v121
    v_max_f32 v121, v146, v121
    v_sub_f32 v36, v36, v121
    v_sub_f32 v37, v37, v121
    v_sub_f32 v38, v38, v121
    v_sub_f32 v39, v39, v121
    v_sub_f32 v52, v52, v121
    v_sub_f32 v53, v53, v121
    v_sub_f32 v54, v54, v121
    v_sub_f32 v55, v55, v121
    v_sub_f32 v48, v48, v121
    v_sub_f32 v49, v49, v121
    v_sub_f32 v50, v50, v121
    v_sub_f32 v51, v51, v121
    v_sub_f32 v41, v41, v121
    v_exp_f32 v36, v36
    v_exp_f32 v37, v37
    v_exp_f32 v38, v38
    v_exp_f32 v39, v39
    v_cvt_pk_bf16_f32 v36, v36, v37
    v_cvt_pk_bf16_f32 v37, v38, v39
    v_exp_f32 v52, v52
    v_exp_f32 v53, v53
    v_exp_f32 v54, v54
    v_exp_f32 v55, v55
    v_cvt_pk_bf16_f32 v38, v52, v53
    v_cvt_pk_bf16_f32 v39, v54, v55
    v_exp_f32 v48, v48
    v_exp_f32 v49, v49
    v_exp_f32 v50, v50
    v_exp_f32 v51, v51
    v_cvt_pk_bf16_f32 v168, v48, v49
    v_cvt_pk_bf16_f32 v169, v50, v51
    v_exp_f32 v41, v41
    v_mov_b32_dpp v19, v47 quad_perm:[0,1,2,3] row_mask:0x2 bank_mask:0xf
    v_cvt_pk_bf16_f32 v170, v41, 0
    v_mfma_f32_16x16x32_bf16 v[44:47], v[220:223], v[36:39], 0
    v_mov_b32_dpp v19, v35 quad_perm:[0,1,2,3] row_mask:0x4 bank_mask:0xf
    v_cvt_pk_bf16_f32 v19, v19, v19
    v_mfma_f32_16x16x32_bf16 v[44:47], v[220:223], v[168:171], v[44:47]
    ds_write_b16 v131, v19
    v_mfma_f32_16x16x32_bf16 v[32:35], v[0:3], v[36:39], 0
    ds_read_b128 v[16:19], v137 offset:0
    v_max3_f32 v120, v120, v15, v28
    v_mfma_f32_16x16x32_bf16 v[32:35], v[164:167], v[168:171], v[32:35]
    ds_read_b128 v[146:149], v136 offset:0
    v_max3_f32 v120, v120, v29, v30
    v_mfma_f32_16x16x32_bf16 v[48:51], v[8:11], v[36:39], 0
    ds_read_b128 v[72:75], v137 offset:128
    v_max3_f32 v120, v120, v31, v24
    v_mfma_f32_16x16x32_bf16 v[48:51], v[160:163], v[168:171], v[48:51]
    ds_read_b128 v[88:91], v136 offset:128
    v_max3_f32 v120, v120, v25, v26
    v_mfma_f32_16x16x32_bf16 v[40:43], v[20:23], v[36:39], 0
    ds_read_b128 v[76:79], v137 offset:256
    v_max3_f32 v120, v120, v27, v6
    v_mfma_f32_16x16x32_bf16 v[40:43], v[156:159], v[168:171], v[40:43]
    ds_read_b128 v[56:59], v136 offset:256
    v_mov_b32 v121, v120
    v_rcp_f32 v44, v44
    s_nop 0
    v_mul_f32 v32, v32, v44
    v_mul_f32 v33, v33, v44
    v_cvt_pk_bf16_f32 v32, v32, v33
    v_mul_f32 v34, v34, v44
    v_mul_f32 v35, v35, v44
    v_cvt_pk_bf16_f32 v33, v34, v35
    v_mul_f32 v48, v48, v44
    v_mul_f32 v49, v49, v44
    v_cvt_pk_bf16_f32 v34, v48, v49
    v_mul_f32 v50, v50, v44
    s_waitcnt lgkmcnt(5)
    v_mfma_f32_16x16x32_bf16 v[36:39], a[0:3], v[16:19], 0
    ds_write_b64 v135, v[32:33] offset:1536
    v_mul_f32 v51, v51, v44
    v_cvt_pk_bf16_f32 v35, v50, v51
    v_mul_f32 v40, v40, v44
    v_mul_f32 v41, v41, v44
    v_cvt_pk_bf16_f32 v4, v40, v41
    v_mul_f32 v42, v42, v44
    v_mul_f32 v43, v43, v44
    v_cvt_pk_bf16_f32 v5, v42, v43
    ds_write_b64 v135, v[34:35] offset:1544
    v_permlane32_swap_b32 v121, v120
    v_max_f32 v120, v121, v120
    v_mov_b32 v121, v120
    s_nop 0
    ds_write_b64 v134, v[4:5] offset:1536
    v_permlane16_swap_b32 v121, v120
    v_max_f32 v120, v121, v120
    v_sub_f32 v12, v12, v120
    v_sub_f32 v13, v13, v120
    v_sub_f32 v14, v14, v120
    v_sub_f32 v15, v15, v120
    v_sub_f32 v28, v28, v120
    v_sub_f32 v29, v29, v120
    v_sub_f32 v30, v30, v120
    v_sub_f32 v31, v31, v120
    v_sub_f32 v24, v24, v120
    v_sub_f32 v25, v25, v120
    v_sub_f32 v26, v26, v120
    v_sub_f32 v27, v27, v120
    v_sub_f32 v6, v6, v120
    v_exp_f32 v12, v12
    v_exp_f32 v13, v13
    v_exp_f32 v14, v14
    v_exp_f32 v15, v15
    v_cvt_pk_bf16_f32 v12, v12, v13
    v_cvt_pk_bf16_f32 v13, v14, v15
    v_exp_f32 v28, v28
    v_exp_f32 v29, v29
    v_exp_f32 v30, v30
    v_exp_f32 v31, v31
    v_cvt_pk_bf16_f32 v14, v28, v29
    v_cvt_pk_bf16_f32 v15, v30, v31
    v_exp_f32 v24, v24
    v_exp_f32 v25, v25
    v_exp_f32 v26, v26
    v_exp_f32 v27, v27
    v_cvt_pk_bf16_f32 v168, v24, v25
    v_cvt_pk_bf16_f32 v169, v26, v27
    v_exp_f32 v6, v6
    s_nop 0
    v_cvt_pk_bf16_f32 v170, v6, 0
    v_mfma_f32_16x16x32_bf16 v[152:155], v[220:223], v[12:15], 0
    s_nop 0
    v_mfma_f32_16x16x32_bf16 v[152:155], v[220:223], v[168:171], v[152:155]
    s_nop 1
    v_mfma_f32_16x16x32_bf16 v[4:7], v[0:3], v[12:15], 0
    s_nop 2
    v_mfma_f32_16x16x32_bf16 v[4:7], v[164:167], v[168:171], v[4:7]
    s_nop 0
    v_rcp_f32 v152, v152
    v_mfma_f32_16x16x32_bf16 v[0:3], v[8:11], v[12:15], 0
    s_nop 2
    v_mfma_f32_16x16x32_bf16 v[0:3], v[160:163], v[168:171], v[0:3]
    s_nop 0
    v_mul_f32 v4, v4, v152
    v_mul_f32 v5, v5, v152
    v_mfma_f32_16x16x32_bf16 v[8:11], v[20:23], v[12:15], 0
    v_cvt_pk_bf16_f32 v12, v4, v5
    v_mul_f32 v6, v6, v152
    v_mfma_f32_16x16x32_bf16 v[8:11], v[156:159], v[168:171], v[8:11]
    v_mul_f32 v7, v7, v152
    v_cvt_pk_bf16_f32 v13, v6, v7
    s_waitcnt lgkmcnt(0)
.p2align 6
L_loopS0:
    v_mfma_f32_16x16x32_bf16 v[36:39], a[4:7], v[146:149], v[36:39]
    ds_write_b64 v135, v[12:13] offset:3072
    v_mfma_f32_16x16x32_bf16 v[36:39], a[8:11], v[72:75], v[36:39]
    v_mul_f32 v0, v0, v152
    v_mul_f32 v1, v1, v152
    v_mfma_f32_16x16x32_bf16 v[36:39], a[12:15], v[88:91], v[36:39]
    v_cvt_pk_bf16_f32 v14, v0, v1
    v_mul_f32 v2, v2, v152
    v_mfma_f32_16x16x32_bf16 v[36:39], a[16:19], v[76:79], v[36:39]
    v_mul_f32 v3, v3, v152
    v_cvt_pk_bf16_f32 v15, v2, v3
    v_mfma_f32_16x16x32_bf16 v[36:39], a[20:23], v[56:59], v[36:39]
    ds_write_b64 v135, v[14:15] offset:3080
    v_mfma_f32_16x16x32_bf16 v[12:15], a[24:27], v[16:19], 0
    v_mul_f32 v8, v8, v152
    v_mul_f32 v9, v9, v152
    v_mfma_f32_16x16x32_bf16 v[12:15], a[28:31], v[146:149], v[12:15]
    v_cvt_pk_bf16_f32 v8, v8, v9
    v_mul_f32 v10, v10, v152
    v_mfma_f32_16x16x32_bf16 v[12:15], a[32:35], v[72:75], v[12:15]
    v_mul_f32 v11, v11, v152
    v_cvt_pk_bf16_f32 v9, v10, v11
    v_mfma_f32_16x16x32_bf16 v[12:15], a[36:39], v[88:91], v[12:15]
    ds_write_b64 v134, v[8:9] offset:3072
    v_mfma_f32_16x16x32_bf16 v[12:15], a[40:43], v[76:79], v[12:15]
    v_fma_f32 v170, v40, v40, s42
    v_fmac_f32 v170, v41, v41
    v_mfma_f32_16x16x32_bf16 v[12:15], a[44:47], v[56:59], v[12:15]
    v_fmac_f32 v170, v42, v42
    v_fmac_f32 v170, v43, v43
    v_mfma_f32_16x16x32_bf16 v[152:155], a[48:51], v[16:19], 0
    v_fmac_f32 v170, v140, v140
    v_fmac_f32 v170, v141, v141
    v_mfma_f32_16x16x32_bf16 v[152:155], a[52:55], v[146:149], v[152:155]
    v_fmac_f32 v170, v142, v142
    v_fmac_f32 v170, v143, v143
    v_mfma_f32_16x16x32_bf16 v[152:155], a[56:59], v[72:75], v[152:155]
    s_waitcnt vmcnt(10)
    v_fmac_f32 v170, v44, v44
    v_fmac_f32 v170, v45, v45
    v_mfma_f32_16x16x32_bf16 v[152:155], a[60:63], v[88:91], v[152:155]
    v_fmac_f32 v170, v46, v46
    v_fmac_f32 v170, v47, v47
    v_mfma_f32_16x16x32_bf16 v[152:155], a[64:67], v[76:79], v[152:155]
    v_cvt_pk_bf16_f32 v0, v92, v93
    v_cvt_pk_bf16_f32 v1, v170, v122
    v_mfma_f32_16x16x32_bf16 v[152:155], a[68:71], v[56:59], v[152:155]
    ds_write_b64 v130, v[0:1]
    v_mfma_f32_16x16x32_bf16 v[60:63], a[72:75], v[16:19], 0
    v_add_u32 v135, s49, v135
    v_add_u32 v134, s49, v134
    v_mfma_f32_16x16x32_bf16 v[60:63], a[76:79], v[146:149], v[60:63]
    v_fma_f32 v170, v36, v36, s41
    v_fmac_f32 v170, v37, v37
    v_mfma_f32_16x16x32_bf16 v[60:63], a[80:83], v[72:75], v[60:63]
    v_fmac_f32 v170, v38, v38
    v_fmac_f32 v170, v39, v39
    v_mfma_f32_16x16x32_bf16 v[60:63], a[84:87], v[88:91], v[60:63]
    v_fmac_f32 v170, v12, v12
    v_fmac_f32 v170, v13, v13
    v_mfma_f32_16x16x32_bf16 v[60:63], a[88:91], v[76:79], v[60:63]
    v_fmac_f32 v170, v14, v14
    v_fmac_f32 v170, v15, v15
    v_mfma_f32_16x16x32_bf16 v[60:63], a[92:95], v[56:59], v[60:63]
    v_fmac_f32 v170, v152, v152
    v_fmac_f32 v170, v153, v153
    v_mfma_f32_16x16x32_bf16 v[92:95], a[96:99], v[16:19], 0
    v_fmac_f32 v170, v154, v154
    v_fmac_f32 v170, v155, v155
    v_mfma_f32_16x16x32_bf16 v[92:95], a[100:103], v[146:149], v[92:95]
    s_waitcnt lgkmcnt(0)
    s_nop 0
    v_fma_f32 v0, v60, v60, s41
    v_fmac_f32 v0, v61, v61
    v_mfma_f32_16x16x32_bf16 v[92:95], a[104:107], v[72:75], v[92:95]
    s_barrier
    ds_read_b128 v[8:11], v129 offset:0
    v_fmac_f32 v0, v62, v62
    v_mfma_f32_16x16x32_bf16 v[92:95], a[108:111], v[88:91], v[92:95]
    ds_read_b128 v[64:67], v129 offset:1024
    v_fmac_f32 v0, v63, v63
    v_mfma_f32_16x16x32_bf16 v[92:95], a[112:115], v[76:79], v[92:95]
    v_mfma_f32_16x16x32_bf16 v[92:95], a[116:119], v[56:59], v[92:95]
    s_nop 1
    v_mfma_f32_16x16x32_bf16 v[80:83], a[120:123], v[16:19], 0
    s_nop 2
    v_mfma_f32_16x16x32_bf16 v[80:83], a[124:127], v[146:149], v[80:83]
    s_nop 0
    v_fmac_f32 v0, v92, v92
    v_fmac_f32 v0, v93, v93
    v_mfma_f32_16x16x32_bf16 v[80:83], a[128:131], v[72:75], v[80:83]
    v_fmac_f32 v0, v94, v94
    v_fmac_f32 v0, v95, v95
    v_mfma_f32_16x16x32_bf16 v[80:83], a[132:135], v[88:91], v[80:83]
    v_mfma_f32_16x16x32_bf16 v[80:83], a[136:139], v[76:79], v[80:83]
    v_mfma_f32_16x16x32_bf16 v[80:83], a[140:143], v[56:59], v[80:83]
    s_waitcnt lgkmcnt(1)
    v_readfirstlane_b32 s12, v9
    v_mfma_f32_16x16x32_bf16 v[84:87], v[216:219], v[8:11], 0
    s_waitcnt lgkmcnt(0)
    s_nop 1
    v_mfma_f32_16x16x32_bf16 v[84:87], v[216:219], v[64:67], v[84:87]
    s_lshr_b32 s12, s12, 23
    v_fmac_f32 v0, v80, v80
    v_fmac_f32 v0, v81, v81
    v_mfma_f32_16x16x32_bf16 v[8:11], v[16:19], a[144:147], 0
    v_fmac_f32 v0, v82, v82
    v_fmac_f32 v0, v83, v83
    v_mfma_f32_16x16x32_bf16 v[8:11], v[146:149], a[148:151], v[8:11]
    s_nop 0
    v_rsq_f32 v84, v84
    v_mfma_f32_16x16x32_bf16 v[8:11], v[72:75], a[152:155], v[8:11]
    v_rsq_f32 v85, v85
    v_mfma_f32_16x16x32_bf16 v[8:11], v[88:91], a[156:159], v[8:11]
    v_rsq_f32 v86, v86
    v_mfma_f32_16x16x32_bf16 v[8:11], v[76:79], a[160:163], v[8:11]
    ds_read_b128 v[64:67], v137 offset:1536
    v_mul_f32 v84, s43, v84
    v_mfma_f32_16x16x32_bf16 v[8:11], v[56:59], a[164:167], v[8:11]
    ds_read_b128 v[68:71], v136 offset:1536
    v_mul_f32 v85, s43, v85
    v_mfma_f32_16x16x32_bf16 v[48:51], v[16:19], a[168:171], 0
    ds_read_b128 v[52:55], v137 offset:1664
    v_mul_f32 v86, s43, v86
    v_mfma_f32_16x16x32_bf16 v[48:51], v[146:149], a[172:175], v[48:51]
    ds_read_b128 v[96:99], v136 offset:1664
    v_cvt_pk_bf16_f32 v170, v170, v0
    v_mfma_f32_16x16x32_bf16 v[48:51], v[72:75], a[176:179], v[48:51]
    ds_read_b128 v[108:111], v137 offset:1792
    v_cvt_pk_bf16_f32 v0, v8, v9
    v_mfma_f32_16x16x32_bf16 v[48:51], v[88:91], a[180:183], v[48:51]
    ds_read_b128 v[104:107], v136 offset:1792
    v_cvt_pk_bf16_f32 v1, v10, v11
    v_mfma_f32_16x16x32_bf16 v[48:51], v[76:79], a[184:187], v[48:51]
    v_mul_f32 v32, v32, v84
    v_mul_f32 v33, v33, v84
    v_mfma_f32_16x16x32_bf16 v[48:51], v[56:59], a[188:191], v[48:51]
    s_nop 0
    v_cvt_pk_bf16_f32 v2, v32, v33
    v_mul_f32 v34, v34, v84
    v_mfma_f32_16x16x16_bf16 v[118:121], v[216:217], v[170:171], 0
    s_nop 0
    v_mul_f32 v35, v35, v84
    v_cvt_pk_bf16_f32 v3, v34, v35
    v_mul_f32 v4, v4, v84
    v_cvt_pk_bf16_f32 v8, v48, v49
    v_mfma_f32_16x16x32_bf16 v[32:35], v[16:19], a[192:195], 0
    ds_write_b64 v135, v[2:3] offset:0
    v_mfma_f32_16x16x32_bf16 v[32:35], v[146:149], a[196:199], v[32:35]
    v_rsq_f32 v118, v118
    v_mfma_f32_16x16x32_bf16 v[32:35], v[72:75], a[200:203], v[32:35]
    v_rsq_f32 v119, v119
    v_mfma_f32_16x16x32_bf16 v[32:35], v[88:91], a[204:207], v[32:35]
    v_mul_f32 v118, s55, v118
    v_mul_f32 v119, 0.5, v119
    v_mfma_f32_16x16x32_bf16 v[32:35], v[76:79], a[208:211], v[32:35]
    v_cvt_pk_bf16_f32 v9, v50, v51
    v_mul_f32 v36, v36, v118
    v_mfma_f32_16x16x32_bf16 v[32:35], v[56:59], a[212:215], v[32:35]
    s_waitcnt lgkmcnt(1)
    v_mul_f32 v37, v37, v118
    v_cvt_pk_f16_f32 v76, v36, v37
    v_mfma_f32_16x16x32_bf16 v[146:149], a[0:3], v[64:67], 0
    v_mul_f32 v38, v38, v118
    v_mul_f32 v39, v39, v118
    v_mfma_f32_16x16x32_bf16 v[146:149], a[4:7], v[68:71], v[146:149]
    v_cvt_pk_f16_f32 v77, v38, v39
    v_mul_f32 v12, v12, v118
    v_mfma_f32_16x16x32_bf16 v[146:149], a[8:11], v[52:55], v[146:149]
    v_mul_f32 v13, v13, v118
    v_cvt_pk_f16_f32 v78, v12, v13
    v_mfma_f32_16x16x32_bf16 v[146:149], a[12:15], v[96:99], v[146:149]
    v_mul_f32 v14, v14, v118
    v_mul_f32 v15, v15, v118
    v_mfma_f32_16x16x32_bf16 v[146:149], a[16:19], v[108:111], v[146:149]
    v_cvt_pk_f16_f32 v79, v14, v15
    v_mul_f32 v152, v152, v118
    v_mfma_f32_16x16x32_bf16 v[146:149], a[20:23], v[104:107], v[146:149]
    v_mul_f32 v153, v153, v118
    v_cvt_pk_f16_f32 v152, v152, v153
    v_mfma_f32_16x16x32_bf16 v[36:39], a[24:27], v[64:67], 0
    v_mul_f32 v154, v154, v118
    v_mul_f32 v155, v155, v118
    v_mfma_f32_16x16x32_bf16 v[36:39], a[28:31], v[68:71], v[36:39]
    v_cvt_pk_f16_f32 v153, v154, v155
    v_mul_f32 v60, v60, v119
    v_mfma_f32_16x16x32_bf16 v[36:39], a[32:35], v[52:55], v[36:39]
    v_mul_f32 v61, v61, v119
    v_cvt_pk_f16_f32 v16, v60, v61
    v_mfma_f32_16x16x32_bf16 v[36:39], a[36:39], v[96:99], v[36:39]
    v_mul_f32 v62, v62, v119
    v_mul_f32 v63, v63, v119
    v_mfma_f32_16x16x32_bf16 v[36:39], a[40:43], v[108:111], v[36:39]
    v_cvt_pk_f16_f32 v17, v62, v63
    v_mul_f32 v92, v92, v119
    v_mfma_f32_16x16x32_bf16 v[36:39], a[44:47], v[104:107], v[36:39]
    v_mul_f32 v93, v93, v119
    v_cvt_pk_f16_f32 v18, v92, v93
    v_mfma_f32_16x16x32_bf16 v[72:75], a[48:51], v[64:67], 0
    v_mul_f32 v94, v94, v119
    v_mul_f32 v95, v95, v119
    v_mfma_f32_16x16x32_bf16 v[72:75], a[52:55], v[68:71], v[72:75]
    v_cvt_pk_f16_f32 v19, v94, v95
    v_mul_f32 v80, v80, v119
    v_mfma_f32_16x16x32_bf16 v[72:75], a[56:59], v[52:55], v[72:75]
    v_mul_f32 v81, v81, v119
    v_cvt_pk_f16_f32 v154, v80, v81
    v_mfma_f32_16x16x32_bf16 v[72:75], a[60:63], v[96:99], v[72:75]
    v_mul_f32 v82, v82, v119
    v_mul_f32 v83, v83, v119
    v_mfma_f32_16x16x32_bf16 v[72:75], a[64:67], v[108:111], v[72:75]
    v_cvt_pk_f16_f32 v155, v82, v83
    v_cvt_pk_bf16_f32 v12, v32, v33
    v_mfma_f32_16x16x32_bf16 v[72:75], a[68:71], v[104:107], v[72:75]
    v_cvt_pk_bf16_f32 v13, v34, v35
    v_mul_f32 v5, v5, v84
    v_mfma_f32_16x16x32_bf16 v[32:35], a[72:75], v[64:67], 0
    v_cvt_pk_bf16_f32 v4, v4, v5
    v_mul_f32 v6, v6, v84
    v_mfma_f32_16x16x32_bf16 v[32:35], a[76:79], v[68:71], v[32:35]
    v_mul_f32 v7, v7, v84
    v_cvt_pk_bf16_f32 v5, v6, v7
    v_mfma_f32_16x16x32_bf16 v[32:35], a[80:83], v[52:55], v[32:35]
    ds_write_b64 v135, v[4:5] offset:8
    v_mfma_f32_16x16x32_bf16 v[32:35], a[84:87], v[96:99], v[32:35]
    v_mul_f32 v24, v24, v84
    v_mul_f32 v25, v25, v84
    v_mfma_f32_16x16x32_bf16 v[32:35], a[88:91], v[108:111], v[32:35]
    v_cvt_pk_bf16_f32 v2, v24, v25
    v_mul_f32 v26, v26, v84
    v_mfma_f32_16x16x32_bf16 v[32:35], a[92:95], v[104:107], v[32:35]
    v_mul_f32 v27, v27, v84
    v_cvt_pk_bf16_f32 v3, v26, v27
    v_mfma_f32_16x16x32_bf16 v[4:7], a[96:99], v[64:67], 0
    ds_write_b64 v134, v[2:3] offset:0
    v_mfma_f32_16x16x32_bf16 v[4:7], a[100:103], v[68:71], v[4:7]
    v_fma_f32 v2, v146, v146, s41
    v_fmac_f32 v2, v147, v147
    v_mfma_f32_16x16x32_bf16 v[4:7], a[104:107], v[52:55], v[4:7]
    v_fmac_f32 v2, v148, v148
    v_fmac_f32 v2, v149, v149
    v_mfma_f32_16x16x32_bf16 v[4:7], a[108:111], v[96:99], v[4:7]
    v_fmac_f32 v2, v36, v36
    v_fmac_f32 v2, v37, v37
    v_mfma_f32_16x16x32_bf16 v[4:7], a[112:115], v[108:111], v[4:7]
    v_fmac_f32 v2, v38, v38
    v_fmac_f32 v2, v39, v39
    v_mfma_f32_16x16x32_bf16 v[4:7], a[116:119], v[104:107], v[4:7]
    v_fmac_f32 v2, v72, v72
    v_fmac_f32 v2, v73, v73
    v_mfma_f32_16x16x32_bf16 v[24:27], a[120:123], v[64:67], 0
    v_fmac_f32 v2, v74, v74
    v_fmac_f32 v2, v75, v75
    v_mfma_f32_16x16x32_bf16 v[24:27], a[124:127], v[68:71], v[24:27]
    v_mul_f32 v28, v28, v85
    v_mul_f32 v29, v29, v85
    v_mfma_f32_16x16x32_bf16 v[24:27], a[128:131], v[52:55], v[24:27]
    v_cvt_pk_bf16_f32 v88, v28, v29
    v_mul_f32 v30, v30, v85
    v_mfma_f32_16x16x32_bf16 v[24:27], a[132:135], v[96:99], v[24:27]
    v_mul_f32 v31, v31, v85
    v_cvt_pk_bf16_f32 v89, v30, v31
    v_mfma_f32_16x16x32_bf16 v[24:27], a[136:139], v[108:111], v[24:27]
    ds_write_b64 v135, v[88:89] offset:1536
    v_mfma_f32_16x16x32_bf16 v[24:27], a[140:143], v[104:107], v[24:27]
    v_mul_f32 v20, v20, v85
    v_mul_f32 v21, v21, v85
    v_mfma_f32_16x16x32_bf16 v[60:63], v[64:67], a[144:147], 0
    v_cvt_pk_bf16_f32 v90, v20, v21
    v_mul_f32 v22, v22, v85
    v_mfma_f32_16x16x32_bf16 v[60:63], v[68:71], a[148:151], v[60:63]
    v_mul_f32 v23, v23, v85
    v_cvt_pk_bf16_f32 v91, v22, v23
    v_mfma_f32_16x16x32_bf16 v[60:63], v[52:55], a[152:155], v[60:63]
    ds_write_b64 v135, v[90:91] offset:1544
    v_mfma_f32_16x16x32_bf16 v[60:63], v[96:99], a[156:159], v[60:63]
    v_mul_f32 v114, v114, v85
    v_mul_f32 v115, v115, v85
    v_mfma_f32_16x16x32_bf16 v[60:63], v[108:111], a[160:163], v[60:63]
    ds_read_b128 v[88:91], v137 offset:3072
    v_cvt_pk_bf16_f32 v10, v114, v115
    v_mfma_f32_16x16x32_bf16 v[60:63], v[104:107], a[164:167], v[60:63]
    ds_read_b128 v[56:59], v136 offset:3072
    v_mul_f32 v116, v116, v85
    v_mfma_f32_16x16x32_bf16 v[92:95], v[64:67], a[168:171], 0
    ds_read_b128 v[80:83], v137 offset:3200
    v_mul_f32 v117, v117, v85
    v_mfma_f32_16x16x32_bf16 v[92:95], v[68:71], a[172:175], v[92:95]
    ds_read_b128 v[28:31], v136 offset:3200
    v_cvt_pk_bf16_f32 v11, v116, v117
    v_mfma_f32_16x16x32_bf16 v[92:95], v[52:55], a[176:179], v[92:95]
    ds_write_b64 v134, v[10:11] offset:1536
    v_mfma_f32_16x16x32_bf16 v[92:95], v[96:99], a[180:183], v[92:95]
    v_fma_f32 v3, v32, v32, s41
    v_fmac_f32 v3, v33, v33
    v_mfma_f32_16x16x32_bf16 v[92:95], v[108:111], a[184:187], v[92:95]
    ds_read_b128 v[48:51], v137 offset:3328
    v_fmac_f32 v3, v34, v34
    v_mfma_f32_16x16x32_bf16 v[92:95], v[104:107], a[188:191], v[92:95]
    ds_read_b128 v[20:23], v136 offset:3328
    v_fmac_f32 v3, v35, v35
    v_mfma_f32_16x16x32_bf16 v[112:115], v[64:67], a[192:195], 0
    v_fmac_f32 v3, v4, v4
    v_fmac_f32 v3, v5, v5
    v_mfma_f32_16x16x32_bf16 v[112:115], v[68:71], a[196:199], v[112:115]
    s_sub_u32 s50, s45, s44
    v_fmac_f32 v3, v6, v6
    v_fmac_f32 v3, v7, v7
    v_mfma_f32_16x16x32_bf16 v[112:115], v[52:55], a[200:203], v[112:115]
    s_sub_u32 s51, s46, s47
    v_fmac_f32 v3, v24, v24
    v_fmac_f32 v3, v25, v25
    v_mfma_f32_16x16x32_bf16 v[112:115], v[96:99], a[204:207], v[112:115]
    s_mov_b32 s60, s59
    v_fmac_f32 v3, v26, v26
    v_fmac_f32 v3, v27, v27
    v_mfma_f32_16x16x32_bf16 v[112:115], v[108:111], a[208:211], v[112:115]
    s_mov_b32 s59, s58
    v_cvt_pk_bf16_f32 v170, v2, v3
    v_cvt_pk_bf16_f32 v2, v60, v61
    v_mfma_f32_16x16x32_bf16 v[112:115], v[104:107], a[212:215], v[112:115]
    s_mov_b32 s58, s57
    v_cvt_pk_bf16_f32 v3, v62, v63
    v_cvt_pk_bf16_f32 v10, v92, v93
    v_mfma_f32_16x16x16_bf16 v[60:63], v[216:217], v[170:171], 0
    s_waitcnt lgkmcnt(2)
    s_mov_b32 s57, s56
    v_cvt_pk_bf16_f32 v11, v94, v95
    v_mul_f32 v40, v40, v86
    v_mul_f32 v41, v41, v86
    v_cvt_pk_bf16_f32 v14, v112, v113
    v_mfma_f32_16x16x32_bf16 v[92:95], a[0:3], v[88:91], 0
    s_mov_b32 s7, s6
    v_cvt_pk_bf16_f32 v15, v114, v115
    v_cvt_pk_bf16_f32 v40, v40, v41
    v_mfma_f32_16x16x32_bf16 v[92:95], a[4:7], v[56:59], v[92:95]
    s_mov_b32 s6, s5
    v_rsq_f32 v60, v60
    v_mfma_f32_16x16x32_bf16 v[92:95], a[8:11], v[80:83], v[92:95]
    s_mov_b32 s5, s4
    v_rsq_f32 v61, v61
    v_mfma_f32_16x16x32_bf16 v[92:95], a[12:15], v[28:31], v[92:95]
    s_waitcnt lgkmcnt(0)
    s_sub_u32 s14, s6, s7
    v_mul_f32 v60, s55, v60
    v_mul_f32 v61, 0.5, v61
    v_mfma_f32_16x16x32_bf16 v[92:95], a[16:19], v[48:51], v[92:95]
    s_add_u32 s61, s61, 1
    v_mul_f32 v146, v146, v60
    v_mul_f32 v147, v147, v60
    v_mfma_f32_16x16x32_bf16 v[92:95], a[20:23], v[20:23], v[92:95]
    s_ff1_i32_b32 s15, s66
    v_cvt_pk_f16_f32 v96, v146, v147
    v_mul_f32 v148, v148, v60
    v_mfma_f32_16x16x32_bf16 v[64:67], a[24:27], v[88:91], 0
    s_cmp_lg_u32 s66, 0
    v_mul_f32 v149, v149, v60
    v_cvt_pk_f16_f32 v97, v148, v149
    v_mfma_f32_16x16x32_bf16 v[64:67], a[28:31], v[56:59], v[64:67]
    s_cselect_b32 s12, s15, s12
    v_mul_f32 v36, v36, v60
    v_mul_f32 v37, v37, v60
    v_mfma_f32_16x16x32_bf16 v[64:67], a[32:35], v[80:83], v[64:67]
    s_cmp_lt_u32 s61, s71
    v_cvt_pk_f16_f32 v98, v36, v37
    v_mul_f32 v38, v38, v60
    v_mfma_f32_16x16x32_bf16 v[64:67], a[36:39], v[28:31], v[64:67]
    s_cselect_b32 s15, 31, s15
    v_mul_f32 v39, v39, v60
    v_cvt_pk_f16_f32 v99, v38, v39
    v_mfma_f32_16x16x32_bf16 v[64:67], a[40:43], v[48:51], v[64:67]
    s_bitset0_b32 s66, s15
    v_mul_f32 v72, v72, v60
    v_mul_f32 v73, v73, v60
    v_mfma_f32_16x16x32_bf16 v[64:67], a[44:47], v[20:23], v[64:67]
    s_add_u32 s12, s12, 20
    v_cvt_pk_f16_f32 v146, v72, v73
    v_mul_f32 v74, v74, v60
    v_mfma_f32_16x16x32_bf16 v[68:71], a[48:51], v[88:91], 0
    s_max_u32 s12, s12, s61
    v_mul_f32 v75, v75, v60
    v_cvt_pk_f16_f32 v147, v74, v75
    v_mfma_f32_16x16x32_bf16 v[68:71], a[52:55], v[56:59], v[68:71]
    s_cmp_lt_u32 s61, s71
    v_mul_f32 v32, v32, v61
    v_mul_f32 v33, v33, v61
    v_mfma_f32_16x16x32_bf16 v[68:71], a[56:59], v[80:83], v[68:71]
    s_cselect_b32 s15, s61, s12
    v_cvt_pk_f16_f32 v36, v32, v33
    v_mul_f32 v34, v34, v61
    v_mfma_f32_16x16x32_bf16 v[68:71], a[60:63], v[28:31], v[68:71]
    s_cselect_b32 s56, s69, s70
    v_mul_f32 v35, v35, v61
    v_cvt_pk_f16_f32 v37, v34, v35
    v_mfma_f32_16x16x32_bf16 v[68:71], a[64:67], v[48:51], v[68:71]
    s_add_u32 s56, s56, s15
    v_mul_f32 v4, v4, v61
    v_mul_f32 v5, v5, v61
    v_mfma_f32_16x16x32_bf16 v[68:71], a[68:71], v[20:23], v[68:71]
    s_mul_i32 s53, s56, 58255
    v_cvt_pk_f16_f32 v38, v4, v5
    v_mul_f32 v6, v6, v61
    v_mfma_f32_16x16x32_bf16 v[72:75], a[72:75], v[88:91], 0
    s_lshr_b32 s53, s53, 22
    v_mul_f32 v7, v7, v61
    v_cvt_pk_f16_f32 v39, v6, v7
    v_mfma_f32_16x16x32_bf16 v[72:75], a[76:79], v[56:59], v[72:75]
    s_mul_i32 s53, s53, s63
    v_mul_f32 v24, v24, v61
    v_mul_f32 v25, v25, v61
    v_mfma_f32_16x16x32_bf16 v[72:75], a[80:83], v[80:83], v[72:75]
    s_mul_i32 s56, s56, s62
    v_cvt_pk_f16_f32 v148, v24, v25
    v_mul_f32 v26, v26, v61
    v_mfma_f32_16x16x32_bf16 v[72:75], a[84:87], v[28:31], v[72:75]
    s_add_u32 s56, s56, s53
    v_mul_f32 v27, v27, v61
    v_cvt_pk_f16_f32 v149, v26, v27
    v_mfma_f32_16x16x32_bf16 v[72:75], a[88:91], v[48:51], v[72:75]
    s_mul_i32 s4, s15, 112
    v_mul_f32 v42, v42, v86
    v_mul_f32 v43, v43, v86
    v_mfma_f32_16x16x32_bf16 v[72:75], a[92:95], v[20:23], v[72:75]
    s_cmp_ge_u32 s15, 16
    v_cvt_pk_bf16_f32 v41, v42, v43
    v_mul_f32 v140, v140, v86
    v_mfma_f32_16x16x32_bf16 v[4:7], a[96:99], v[88:91], 0
    s_cselect_b32 s53, -30464, 0
    ds_write_b64 v135, v[40:41] offset:3072
    v_mfma_f32_16x16x32_bf16 v[4:7], a[100:103], v[56:59], v[4:7]
    s_add_u32 s4, s4, s53
    v_mul_f32 v141, v141, v86
    v_cvt_pk_bf16_f32 v42, v140, v141
    v_mfma_f32_16x16x32_bf16 v[4:7], a[104:107], v[80:83], v[4:7]
    s_cmp_lt_u32 s15, s73
    v_mul_f32 v142, v142, v86
    v_mul_f32 v143, v143, v86
    v_mfma_f32_16x16x32_bf16 v[4:7], a[108:111], v[28:31], v[4:7]
    s_cselect_b32 s26, 100270464, 0
    v_cvt_pk_bf16_f32 v43, v142, v143
    v_mul_f32 v44, v44, v86
    v_mfma_f32_16x16x32_bf16 v[4:7], a[112:115], v[48:51], v[4:7]
    s_cselect_b32 s56, s56, 0
    ds_write_b64 v135, v[42:43] offset:3080
    v_mfma_f32_16x16x32_bf16 v[4:7], a[116:119], v[20:23], v[4:7]
    s_cselect_b32 s4, s4, -1
    v_mul_f32 v45, v45, v86
    v_cvt_pk_bf16_f32 v44, v44, v45
    v_mul_f32 v46, v46, v86
    v_mul_f32 v47, v47, v86
    v_cvt_pk_bf16_f32 v45, v46, v47
    s_cselect_b32 s15, s15, 0
    s_cselect_b32 s13, s13, -1
    ds_write_b64 v134, v[44:45] offset:3072
    v_fma_f32 v120, v92, v92, s41
    v_fmac_f32 v120, v93, v93
    v_fmac_f32 v120, v94, v94
    v_fmac_f32 v120, v95, v95
    v_mfma_f32_16x16x32_bf16 v[24:27], a[120:123], v[88:91], 0
    s_waitcnt vmcnt(0)
    v_fmac_f32 v120, v64, v64
    v_fmac_f32 v120, v65, v65
    v_mfma_f32_16x16x32_bf16 v[24:27], a[124:127], v[56:59], v[24:27]
    s_bitset1_b32 s64, s15
    v_fmac_f32 v120, v66, v66
    v_fmac_f32 v120, v67, v67
    v_mfma_f32_16x16x32_bf16 v[24:27], a[128:131], v[80:83], v[24:27]
    s_add_u32 s65, s65, 1
    v_fmac_f32 v120, v68, v68
    v_fmac_f32 v120, v69, v69
    v_mfma_f32_16x16x32_bf16 v[24:27], a[132:135], v[28:31], v[24:27]
    s_cmp_ge_i32 s65, 2
    v_fmac_f32 v120, v70, v70
    v_fmac_f32 v120, v71, v71
    v_mfma_f32_16x16x32_bf16 v[24:27], a[136:139], v[48:51], v[24:27]
    s_cselect_b32 s30, 100270464, 0
    v_fma_f32 v121, v72, v72, s41
    v_fmac_f32 v121, v73, v73
    v_mfma_f32_16x16x32_bf16 v[24:27], a[140:143], v[20:23], v[24:27]
    s_add_u32 s67, s46, s54
    v_fmac_f32 v121, v74, v74
    v_fmac_f32 v121, v75, v75
    v_mfma_f32_16x16x32_bf16 v[32:35], v[88:91], a[144:147], 0
    s_waitcnt lgkmcnt(0)
    s_add_u32 m0, s67, 0
    v_fmac_f32 v121, v4, v4
    v_fmac_f32 v121, v5, v5
    v_mfma_f32_16x16x32_bf16 v[32:35], v[56:59], a[148:151], v[32:35]
    s_barrier
    v_fmac_f32 v121, v6, v6
    v_fmac_f32 v121, v7, v7
    v_mfma_f32_16x16x32_bf16 v[32:35], v[80:83], a[152:155], v[32:35]
    s_cmp_ge_u32 s61, s13
    v_fmac_f32 v121, v24, v24
    v_fmac_f32 v121, v25, v25
    v_mfma_f32_16x16x32_bf16 v[32:35], v[28:31], a[156:159], v[32:35]
    s_cbranch_scc1 L_atomS0
L_atomS0r:
    v_mfma_f32_16x16x32_bf16 v[32:35], v[48:51], a[160:163], v[32:35]
    v_fmac_f32 v121, v26, v26
    v_fmac_f32 v121, v27, v27
    v_mfma_f32_16x16x32_bf16 v[32:35], v[20:23], a[164:167], v[32:35]
    v_cvt_pk_bf16_f32 v170, v120, v121
    v_add_u32 v137, s50, v137
    v_mfma_f32_16x16x32_bf16 v[40:43], v[88:91], a[168:171], 0
    ds_read_b128 v[60:63], v137 offset:0
    v_add_u32 v136, s50, v136
    v_mfma_f32_16x16x32_bf16 v[40:43], v[56:59], a[172:175], v[40:43]
    s_nop 0
    ds_read_b128 v[84:87], v136 offset:0
    v_cvt_pk_bf16_f32 v164, v32, v33
    v_mfma_f32_16x16x32_bf16 v[40:43], v[80:83], a[176:179], v[40:43]
    ds_read_b128 v[52:55], v137 offset:128
    v_cvt_pk_bf16_f32 v165, v34, v35
    v_mfma_f32_16x16x32_bf16 v[40:43], v[28:31], a[180:183], v[40:43]
    ds_read_b128 v[112:115], v136 offset:128
    v_add_u32 v135, s48, v135
    v_mfma_f32_16x16x32_bf16 v[40:43], v[48:51], a[184:187], v[40:43]
    ds_read_b128 v[108:111], v137 offset:256
    v_add_u32 v134, s48, v134
    v_mfma_f32_16x16x32_bf16 v[40:43], v[20:23], a[188:191], v[40:43]
    s_nop 0
    ds_read_b128 v[104:107], v136 offset:256
    v_add_u32 v133, s51, v133
    v_mfma_f32_16x16x16_bf16 v[118:121], v[216:217], v[170:171], 0
    s_nop 0
    v_add_u32 v132, s14, v132
    v_add_u32 v131, s14, v131
    v_add_u32 v123, s14, v123
    v_cvt_pk_bf16_f32 v160, v40, v41
    v_mfma_f32_16x16x32_bf16 v[100:103], v[88:91], a[192:195], 0
    v_cvt_pk_bf16_f32 v161, v42, v43
    v_and_b32 v116, -8, v123
    v_mfma_f32_16x16x32_bf16 v[100:103], v[56:59], a[196:199], v[100:103]
    v_rsq_f32 v118, v118
    v_mfma_f32_16x16x32_bf16 v[100:103], v[80:83], a[200:203], v[100:103]
    v_rsq_f32 v119, v119
    v_mfma_f32_16x16x32_bf16 v[100:103], v[28:31], a[204:207], v[100:103]
    ds_read_b128 v[28:31], v132 offset:0
    v_mul_f32 v118, s55, v118
    v_mfma_f32_16x16x32_bf16 v[100:103], v[48:51], a[208:211], v[100:103]
    ds_read_b128 v[48:51], v132 offset:16
    v_mul_f32 v119, 0.5, v119
    v_mfma_f32_16x16x32_bf16 v[100:103], v[20:23], a[212:215], v[100:103]
    s_waitcnt lgkmcnt(3)
    ds_read_b128 v[20:23], v132 offset:48
    v_mul_f32 v72, v72, v119
    v_mfma_f32_16x16x32_bf16 v[32:35], a[216:219], v[60:63], 0
    ds_read_b128 v[88:91], v133 offset:0
    v_mul_f32 v73, v73, v119
    v_mfma_f32_16x16x32_bf16 v[32:35], a[220:223], v[84:87], v[32:35]
    v_cvt_pk_f16_f32 v40, v72, v73
    v_mul_f32 v74, v74, v119
    v_mfma_f32_16x16x32_bf16 v[32:35], a[224:227], v[52:55], v[32:35]
    v_mul_f32 v75, v75, v119
    v_cvt_pk_f16_f32 v41, v74, v75
    v_mfma_f32_16x16x32_bf16 v[32:35], a[228:231], v[112:115], v[32:35]
    v_mul_f32 v4, v4, v119
    v_mul_f32 v5, v5, v119
    v_mfma_f32_16x16x32_bf16 v[32:35], a[232:235], v[108:111], v[32:35]
    s_waitcnt lgkmcnt(4)
    v_cvt_pk_f16_f32 v42, v4, v5
    v_mul_f32 v6, v6, v119
    v_mfma_f32_16x16x32_bf16 v[32:35], a[236:239], v[104:107], v[32:35]
    v_mul_f32 v7, v7, v119
    v_cvt_pk_f16_f32 v43, v6, v7
    v_mfma_f32_16x16x32_bf16 v[4:7], a[240:243], v[60:63], 0
    v_mul_f32 v24, v24, v119
    v_mul_f32 v25, v25, v119
    v_mfma_f32_16x16x32_bf16 v[4:7], a[244:247], v[84:87], v[4:7]
    v_cvt_pk_f16_f32 v142, v24, v25
    v_mul_f32 v26, v26, v119
    v_mfma_f32_16x16x32_bf16 v[4:7], a[248:251], v[52:55], v[4:7]
    v_mul_f32 v27, v27, v119
    v_cvt_pk_f16_f32 v143, v26, v27
    v_mfma_f32_16x16x32_bf16 v[4:7], a[252:255], v[112:115], v[4:7]
    s_waitcnt lgkmcnt(0)
    buffer_load_dwordx4 v128, s[24:27], s56 offen nt lds
    v_mul_f32 v92, v92, v118
    v_mfma_f32_16x16x32_bf16 v[4:7], v[224:227], v[108:111], v[4:7]
    v_mul_f32 v93, v93, v118
    v_cvt_pk_f16_f32 v44, v92, v93
    v_mfma_f32_16x16x32_bf16 v[4:7], v[228:231], v[104:107], v[4:7]
    v_mul_f32 v94, v94, v118
    v_mul_f32 v95, v95, v118
    v_mfma_f32_16x16x32_bf16 v[24:27], v[232:235], v[60:63], 0
    v_cvt_pk_f16_f32 v45, v94, v95
    v_mul_f32 v64, v64, v118
    v_mfma_f32_16x16x32_bf16 v[24:27], v[236:239], v[84:87], v[24:27]
    v_mul_f32 v65, v65, v118
    v_cvt_pk_f16_f32 v46, v64, v65
    v_mfma_f32_16x16x32_bf16 v[24:27], v[240:243], v[52:55], v[24:27]
    v_mul_f32 v66, v66, v118
    v_mul_f32 v67, v67, v118
    v_mfma_f32_16x16x32_bf16 v[24:27], v[244:247], v[112:115], v[24:27]
    v_cvt_pk_f16_f32 v47, v66, v67
    v_mul_f32 v68, v68, v118
    v_mfma_f32_16x16x32_bf16 v[24:27], v[248:251], v[108:111], v[24:27]
    buffer_store_dwordx4 v[88:91], v128, s[28:31], s60 offen sc1
    v_mul_f32 v69, v69, v118
    v_cvt_pk_f16_f32 v140, v68, v69
    v_mul_f32 v70, v70, v118
    v_mul_f32 v71, v71, v118
    v_mfma_f32_16x16x32_bf16 v[24:27], v[252:255], v[104:107], v[24:27]
    s_add_u32 m0, s67, 1024
    v_cvt_pk_f16_f32 v141, v70, v71
    v_cvt_pk_bf16_f32 v156, v100, v101
    v_mfma_f32_16x16x32_f16 v[112:115], v[16:19], v[76:79], v[204:207]
    ds_read_u16 v166, v131 offset:80
    v_cvt_pk_bf16_f32 v157, v102, v103
    v_mfma_f32_16x16x32_f16 v[112:115], v[152:155], v[150:153], v[112:115]
    ds_read_u16 v162, v131 offset:96
    v_mfma_f32_16x16x32_f16 v[108:111], v[36:39], v[76:79], v[200:203]
    s_nop 0
    ds_read_u16 v158, v131 offset:104
    s_nop 0
    v_mfma_f32_16x16x32_f16 v[108:111], v[146:149], v[150:153], v[108:111]
    s_nop 0
    ds_read_b32 v116, v116 offset:64
    v_max3_f32 v120, v112, v113, v114
    v_mfma_f32_16x16x32_f16 v[104:107], v[40:43], v[76:79], v[196:199]
    ds_read_b128 v[68:71], v133 offset:1024
    v_mfma_f32_16x16x32_f16 v[104:107], v[140:143], v[150:153], v[104:107]
    s_nop 0
    ds_read_b128 v[72:75], v137 offset:1536
    v_max3_f32 v120, v120, v115, v108
    v_mfma_f32_16x16x32_f16 v[88:91], v[28:31], v[76:79], v[208:211]
    ds_read_b128 v[76:79], v136 offset:1536
    v_max3_f32 v120, v120, v109, v110
    v_mfma_f32_16x16x32_f16 v[88:91], v[48:51], v[16:19], v[88:91]
    ds_read_b128 v[60:63], v137 offset:1664
    v_max3_f32 v120, v120, v111, v104
    v_mfma_f32_16x16x32_f16 v[88:91], v[20:23], v[152:155], v[88:91]
    ds_read_b128 v[56:59], v136 offset:1664
    v_max3_f32 v120, v120, v105, v106
    v_mfma_f32_16x16x32_f16 v[92:95], v[28:31], v[96:99], v[208:211]
    ds_read_b128 v[64:67], v137 offset:1792
    s_nop 0
    v_mfma_f32_16x16x32_f16 v[92:95], v[48:51], v[36:39], v[92:95]
    s_nop 0
    ds_read_b128 v[80:83], v136 offset:1792
    v_max3_f32 v120, v120, v107, v88
    v_mfma_f32_16x16x32_f16 v[92:95], v[20:23], v[146:149], v[92:95]
    v_mov_b32 v121, v120
    v_mfma_f32_16x16x32_f16 v[84:87], v[28:31], v[44:47], v[208:211]
    s_nop 0
    v_permlane32_swap_b32 v121, v120
    v_mfma_f32_16x16x32_f16 v[84:87], v[48:51], v[40:43], v[84:87]
    s_waitcnt lgkmcnt(6)
    buffer_load_dwordx4 v127, s[24:27], s56 offen nt lds
    v_max_f32 v120, v121, v120
    v_mfma_f32_16x16x32_f16 v[84:87], v[20:23], v[140:143], v[84:87]
    s_waitcnt lgkmcnt(5)
    v_mov_b32 v121, v120
    v_mov_b32_dpp v91, v95 quad_perm:[0,1,2,3] row_mask:0x2 bank_mask:0xf
    v_mfma_f32_16x16x32_bf16 v[28:31], a[216:219], v[72:75], 0
    s_waitcnt lgkmcnt(4)
    v_permlane16_swap_b32 v121, v120
    v_mfma_f32_16x16x32_bf16 v[28:31], a[220:223], v[76:79], v[28:31]
    s_waitcnt lgkmcnt(3)
    v_max_f32 v120, v121, v120
    v_sub_f32 v112, v112, v120
    v_mfma_f32_16x16x32_bf16 v[28:31], a[224:227], v[60:63], v[28:31]
    s_waitcnt lgkmcnt(2)
    v_sub_f32 v113, v113, v120
    v_sub_f32 v114, v114, v120
    v_mfma_f32_16x16x32_bf16 v[28:31], a[228:231], v[56:59], v[28:31]
    s_waitcnt lgkmcnt(1)
    v_sub_f32 v115, v115, v120
    v_sub_f32 v108, v108, v120
    v_mfma_f32_16x16x32_bf16 v[28:31], a[232:235], v[64:67], v[28:31]
    s_waitcnt lgkmcnt(0)
    v_sub_f32 v109, v109, v120
    v_sub_f32 v110, v110, v120
    v_mfma_f32_16x16x32_bf16 v[28:31], a[236:239], v[80:83], v[28:31]
    buffer_store_dwordx4 v[68:71], v127, s[28:31], s60 offen sc1
    ds_read_b128 v[100:103], v133 offset:2048
    v_sub_f32 v111, v111, v120
    v_sub_f32 v104, v104, v120
    v_sub_f32 v105, v105, v120
    v_mfma_f32_16x16x32_f16 v[48:51], v[16:19], v[96:99], v[192:195]
    s_add_u32 m0, s67, 2048
    v_sub_f32 v106, v106, v120
    v_sub_f32 v107, v107, v120
    v_mfma_f32_16x16x32_f16 v[48:51], v[152:155], v[144:147], v[48:51]
    v_sub_f32 v88, v88, v120
    v_mov_b32_dpp v91, v87 quad_perm:[0,1,2,3] row_mask:0x4 bank_mask:0xf
    v_mfma_f32_16x16x32_f16 v[68:71], v[36:39], v[96:99], v[188:191]
    v_exp_f32 v112, v112
    v_mfma_f32_16x16x32_f16 v[68:71], v[146:149], v[144:147], v[68:71]
    v_exp_f32 v113, v113
    v_mfma_f32_16x16x32_f16 v[52:55], v[40:43], v[96:99], v[184:187]
    v_exp_f32 v114, v114
    v_mfma_f32_16x16x32_f16 v[52:55], v[140:143], v[144:147], v[52:55]
    v_exp_f32 v115, v115
    v_mfma_f32_16x16x32_bf16 v[20:23], a[240:243], v[72:75], 0
    v_cvt_pk_bf16_f32 v96, v112, v113
    v_cvt_pk_bf16_f32 v97, v114, v115
    v_mfma_f32_16x16x32_bf16 v[20:23], a[244:247], v[76:79], v[20:23]
    v_exp_f32 v108, v108
    v_mfma_f32_16x16x32_bf16 v[20:23], a[248:251], v[60:63], v[20:23]
    s_waitcnt lgkmcnt(0)
    buffer_load_dwordx4 v126, s[24:27], s56 offen nt lds
    v_and_b32 v120, 0xffff0000, v116
    v_mfma_f32_16x16x32_bf16 v[20:23], a[252:255], v[56:59], v[20:23]
    v_exp_f32 v109, v109
    v_mfma_f32_16x16x32_bf16 v[20:23], v[224:227], v[64:67], v[20:23]
    v_exp_f32 v110, v110
    v_mfma_f32_16x16x32_bf16 v[20:23], v[228:231], v[80:83], v[20:23]
    s_mov_b32 s53, s47
    v_exp_f32 v111, v111
    v_cvt_pk_bf16_f32 v98, v108, v109
    v_cvt_pk_bf16_f32 v99, v110, v111
    v_exp_f32 v104, v104
    v_exp_f32 v105, v105
    v_exp_f32 v106, v106
    v_exp_f32 v107, v107
    v_cvt_pk_bf16_f32 v168, v104, v105
    v_cvt_pk_bf16_f32 v169, v106, v107
    v_exp_f32 v88, v88
    v_lshlrev_b32 v116, 16, v116
    v_cvt_pk_bf16_f32 v170, v88, 0
    v_mfma_f32_16x16x32_bf16 v[112:115], v[220:223], v[96:99], 0
    s_add_u32 m0, s67, 3072
    buffer_store_dwordx4 v[100:103], v126, s[28:31], s60 offen sc1
    v_add_f32 v116, v116, v120
    v_add_f32 v116, v116, v211
    v_max3_f32 v120, v48, v49, v50
    v_max3_f32 v120, v120, v51, v68
    v_mfma_f32_16x16x32_bf16 v[112:115], v[220:223], v[168:171], v[112:115]
    s_mov_b32 s47, s46
    v_mov_b32_dpp v91, v116 quad_perm:[0,1,2,3] row_mask:0x8 bank_mask:0xf
    v_mov_b32 v121, v91
    v_mfma_f32_16x16x32_bf16 v[108:111], v[0:3], v[96:99], 0
    s_mov_b32 s46, s45
    v_max_f32_dpp v121, v121, v121 row_ror:8 row_mask:0xf bank_mask:0xf
    v_max3_f32 v120, v120, v69, v70
    v_mfma_f32_16x16x32_bf16 v[108:111], v[164:167], v[168:171], v[108:111]
    s_mov_b32 s45, s44
    v_max_f32_dpp v121, v121, v121 row_ror:4 row_mask:0xf bank_mask:0xf
    v_max3_f32 v120, v120, v71, v52
    v_mfma_f32_16x16x32_bf16 v[104:107], v[8:11], v[96:99], 0
    s_mov_b32 s44, s53
    v_max_f32_dpp v121, v121, v121 row_ror:2 row_mask:0xf bank_mask:0xf
    v_max3_f32 v120, v120, v53, v54
    v_mfma_f32_16x16x32_bf16 v[104:107], v[160:163], v[168:171], v[104:107]
    s_sub_u32 s48, s44, s46
    v_max_f32_dpp v121, v121, v121 row_ror:1 row_mask:0xf bank_mask:0xf
    v_mov_b32 v84, v121
    v_mfma_f32_16x16x32_bf16 v[100:103], v[12:15], v[96:99], 0
    s_sub_u32 s49, s46, s45
    v_permlane32_swap_b32 v84, v121
    v_mfma_f32_16x16x32_bf16 v[100:103], v[156:159], v[168:171], v[100:103]
    v_max_f32 v121, v84, v121
    v_mov_b32 v84, v121
    v_rcp_f32 v112, v112
    v_max3_f32 v120, v120, v55, v93
    v_permlane16_swap_b32 v84, v121
    v_max_f32 v121, v84, v121
    v_sub_f32 v91, v91, v121
    v_exp_f32 v91, v91
    v_mul_f32 v108, v108, v112
    v_cvt_pk_bf16_f32 v91, v91, v91
    ds_write_b16 v123, v91 offset:64
    v_mul_f32 v109, v109, v112
    v_cvt_pk_bf16_f32 v88, v108, v109
    ds_read_b128 v[94:97], v132 offset:48
    v_mul_f32 v110, v110, v112
    v_mul_f32 v111, v111, v112
    v_cvt_pk_bf16_f32 v89, v110, v111
    ds_read_b128 v[108:111], v132 offset:64
    v_mfma_f32_16x16x32_bf16 v[114:117], v[232:235], v[72:75], 0
    v_mul_f32 v104, v104, v112
    v_mul_f32 v105, v105, v112
    v_mfma_f32_16x16x32_bf16 v[114:117], v[236:239], v[76:79], v[114:117]
    ds_write_b64 v135, v[88:89] offset:0
    v_mfma_f32_16x16x32_bf16 v[114:117], v[240:243], v[60:63], v[114:117]
    v_cvt_pk_bf16_f32 v90, v104, v105
    v_mul_f32 v106, v106, v112
    v_mfma_f32_16x16x32_bf16 v[114:117], v[244:247], v[56:59], v[114:117]
    v_mul_f32 v107, v107, v112
    v_cvt_pk_bf16_f32 v91, v106, v107
    v_mfma_f32_16x16x32_bf16 v[114:117], v[248:251], v[64:67], v[114:117]
    ds_write_b64 v135, v[90:91] offset:8
    v_mfma_f32_16x16x32_bf16 v[114:117], v[252:255], v[80:83], v[114:117]
    s_waitcnt lgkmcnt(3)
    v_mul_f32 v100, v100, v112
    v_mul_f32 v101, v101, v112
    v_cvt_pk_bf16_f32 v168, v100, v101
    v_mul_f32 v102, v102, v112
    v_mfma_f32_16x16x32_bf16 v[72:75], v[94:97], v[0:3], 0
    s_waitcnt lgkmcnt(2)
    v_mul_f32 v103, v103, v112
    v_cvt_pk_bf16_f32 v169, v102, v103
    v_mov_b32 v170, v120
    v_fma_f32 v92, v32, v32, s42
    v_mfma_f32_16x16x32_bf16 v[72:75], v[108:111], v[164:167], v[72:75]
    ds_write_b64 v134, v[168:169] offset:0
    v_mfma_f32_16x16x32_bf16 v[88:91], v[94:97], v[8:11], 0
    v_permlane32_swap_b32 v170, v120
    v_mfma_f32_16x16x32_bf16 v[88:91], v[108:111], v[160:163], v[88:91]
    v_max_f32 v120, v170, v120
    v_mov_b32 v170, v120
    v_mfma_f32_16x16x32_bf16 v[76:79], v[94:97], v[12:15], 0
    s_nop 0
    v_permlane16_swap_b32 v170, v120
    v_mfma_f32_16x16x32_bf16 v[76:79], v[108:111], v[156:159], v[76:79]
    ds_read_b128 v[60:63], v133 offset:3072
    v_max_f32 v120, v170, v120
    v_sub_f32 v48, v48, v120
    v_sub_f32 v49, v49, v120
    v_sub_f32 v50, v50, v120
    v_sub_f32 v51, v51, v120
    v_sub_f32 v68, v68, v120
    v_sub_f32 v69, v69, v120
    v_sub_f32 v70, v70, v120
    v_sub_f32 v71, v71, v120
    v_sub_f32 v52, v52, v120
    v_sub_f32 v53, v53, v120
    v_sub_f32 v54, v54, v120
    v_sub_f32 v55, v55, v120
    v_sub_f32 v93, v93, v120
    v_exp_f32 v48, v48
    v_exp_f32 v49, v49
    v_exp_f32 v50, v50
    v_exp_f32 v51, v51
    v_cvt_pk_bf16_f32 v56, v48, v49
    v_cvt_pk_bf16_f32 v57, v50, v51
    v_exp_f32 v68, v68
    v_exp_f32 v69, v69
    v_exp_f32 v70, v70
    v_exp_f32 v71, v71
    v_cvt_pk_bf16_f32 v58, v68, v69
    v_cvt_pk_bf16_f32 v59, v70, v71
    v_exp_f32 v52, v52
    v_exp_f32 v53, v53
    v_exp_f32 v54, v54
    v_exp_f32 v55, v55
    v_cvt_pk_bf16_f32 v168, v52, v53
    v_cvt_pk_bf16_f32 v169, v54, v55
    v_exp_f32 v93, v93
    v_mov_b32_dpp v75, v91 quad_perm:[0,1,2,3] row_mask:0x2 bank_mask:0xf
    v_cvt_pk_bf16_f32 v170, v93, 0
    v_mfma_f32_16x16x32_bf16 v[88:91], v[220:223], v[56:59], 0
    s_waitcnt lgkmcnt(0)
    buffer_load_dwordx4 v125, s[24:27], s56 offen nt lds
    ds_read_b128 v[64:67], v137 offset:3072
    v_mfma_f32_16x16x32_bf16 v[88:91], v[220:223], v[168:171], v[88:91]
    v_mov_b32_dpp v75, v79 quad_perm:[0,1,2,3] row_mask:0x4 bank_mask:0xf
    v_cvt_pk_bf16_f32 v75, v75, v75
    v_mfma_f32_16x16x32_bf16 v[76:79], v[0:3], v[56:59], 0
    ds_write_b16 v131, v75
    v_mfma_f32_16x16x32_bf16 v[76:79], v[164:167], v[168:171], v[76:79]
    ds_read_b128 v[72:75], v136 offset:3072
    v_fmac_f32 v92, v33, v33
    v_mfma_f32_16x16x32_bf16 v[80:83], v[8:11], v[56:59], 0
    ds_read_b128 v[48:51], v137 offset:3200
    v_fmac_f32 v92, v34, v34
    v_mfma_f32_16x16x32_bf16 v[80:83], v[160:163], v[168:171], v[80:83]
    ds_read_b128 v[68:71], v136 offset:3200
    v_fmac_f32 v92, v35, v35
    v_mfma_f32_16x16x32_bf16 v[52:55], v[12:15], v[56:59], 0
    ds_read_b128 v[56:59], v137 offset:3328
    v_add_u32 v137, s48, v137
    v_mfma_f32_16x16x32_bf16 v[52:55], v[156:159], v[168:171], v[52:55]
    buffer_store_dwordx4 v[60:63], v125, s[28:31], s60 offen sc1
    ds_read_b128 v[94:97], v136 offset:3328
    v_rcp_f32 v88, v88
    v_add_u32 v136, s48, v136
    v_mfma_f32_16x16x32_f16 v[60:63], v[16:19], v[44:47], v[180:183]
    s_add_u32 m0, s67, 4096
    ds_read_b128 v[16:19], v133 offset:4096
    v_mul_f32 v76, v76, v88
    v_mfma_f32_16x16x32_f16 v[60:63], v[152:155], v[138:141], v[60:63]
    s_cmp_lg_u32 s5, -1
    v_mul_f32 v77, v77, v88
    v_cvt_pk_bf16_f32 v76, v76, v77
    v_mfma_f32_16x16x32_f16 v[152:155], v[36:39], v[44:47], v[176:179]
    v_mul_f32 v78, v78, v88
    v_mul_f32 v79, v79, v88
    v_mfma_f32_16x16x32_f16 v[152:155], v[146:149], v[138:141], v[152:155]
    v_cvt_pk_bf16_f32 v77, v78, v79
    v_mul_f32 v80, v80, v88
    v_mfma_f32_16x16x32_f16 v[36:39], v[40:43], v[44:47], v[172:175]
    ds_write_b64 v135, v[76:77] offset:1536
    v_mfma_f32_16x16x32_f16 v[36:39], v[140:143], v[138:141], v[36:39]
    s_waitcnt lgkmcnt(4)
    v_mul_f32 v81, v81, v88
    v_cvt_pk_bf16_f32 v78, v80, v81
    v_mfma_f32_16x16x32_bf16 v[40:43], a[216:219], v[64:67], 0
    v_mul_f32 v82, v82, v88
    v_mul_f32 v83, v83, v88
    v_mfma_f32_16x16x32_bf16 v[40:43], a[220:223], v[72:75], v[40:43]
    v_cvt_pk_bf16_f32 v79, v82, v83
    v_mul_f32 v52, v52, v88
    v_mfma_f32_16x16x32_bf16 v[40:43], a[224:227], v[48:51], v[40:43]
    ds_write_b64 v135, v[78:79] offset:1544
    v_mfma_f32_16x16x32_bf16 v[40:43], a[228:231], v[68:71], v[40:43]
    s_waitcnt lgkmcnt(2)
    buffer_load_dwordx4 v124, s[24:27], s56 offen nt lds
    v_mul_f32 v53, v53, v88
    v_mfma_f32_16x16x32_bf16 v[40:43], a[232:235], v[56:59], v[40:43]
    v_cvt_pk_bf16_f32 v168, v52, v53
    v_mul_f32 v54, v54, v88
    v_mfma_f32_16x16x32_bf16 v[40:43], a[236:239], v[94:97], v[40:43]
    v_mul_f32 v55, v55, v88
    v_cvt_pk_bf16_f32 v169, v54, v55
    v_mfma_f32_16x16x32_bf16 v[140:143], a[240:243], v[64:67], 0
    ds_write_b64 v134, v[168:169] offset:1536
    v_mfma_f32_16x16x32_bf16 v[140:143], a[244:247], v[72:75], v[140:143]
    v_max3_f32 v168, v60, v61, v62
    v_max3_f32 v168, v168, v63, v152
    v_mfma_f32_16x16x32_bf16 v[140:143], a[248:251], v[48:51], v[140:143]
    v_max3_f32 v168, v168, v153, v154
    v_max3_f32 v168, v168, v155, v36
    v_mfma_f32_16x16x32_bf16 v[140:143], a[252:255], v[68:71], v[140:143]
    v_max3_f32 v168, v168, v37, v38
    v_max3_f32 v168, v168, v39, v86
    v_mfma_f32_16x16x32_bf16 v[140:143], v[224:227], v[56:59], v[140:143]
    buffer_store_dwordx4 v[16:19], v124, s[28:31], s60 offen sc1
    v_mov_b32 v169, v168
    v_fmac_f32 v92, v4, v4
    v_fmac_f32 v92, v5, v5
    v_fmac_f32 v92, v6, v6
    v_mfma_f32_16x16x32_bf16 v[140:143], v[228:231], v[94:97], v[140:143]
    ds_read_b128 v[16:19], v137 offset:0
    v_fmac_f32 v92, v7, v7
    v_mfma_f32_16x16x32_bf16 v[44:47], v[232:235], v[64:67], 0
    ds_read_b128 v[146:149], v136 offset:0
    v_fmac_f32 v92, v24, v24
    v_mfma_f32_16x16x32_bf16 v[44:47], v[236:239], v[72:75], v[44:47]
    ds_read_b128 v[72:75], v137 offset:128
    v_fmac_f32 v92, v25, v25
    v_mfma_f32_16x16x32_bf16 v[44:47], v[240:243], v[48:51], v[44:47]
    ds_read_b128 v[88:91], v136 offset:128
    v_fmac_f32 v92, v26, v26
    v_mfma_f32_16x16x32_bf16 v[44:47], v[244:247], v[68:71], v[44:47]
    ds_read_b128 v[76:79], v137 offset:256
    v_fmac_f32 v92, v27, v27
    v_mfma_f32_16x16x32_bf16 v[44:47], v[248:251], v[56:59], v[44:47]
    ds_read_b128 v[56:59], v136 offset:256
    v_fma_f32 v93, v28, v28, s42
    v_mfma_f32_16x16x32_bf16 v[44:47], v[252:255], v[94:97], v[44:47]
    v_permlane32_swap_b32 v169, v168
    v_max_f32 v168, v169, v168
    v_mov_b32 v169, v168
    v_fmac_f32 v93, v29, v29
    v_fmac_f32 v93, v30, v30
    v_permlane16_swap_b32 v169, v168
    v_max_f32 v168, v169, v168
    v_sub_f32 v60, v60, v168
    v_sub_f32 v61, v61, v168
    v_sub_f32 v62, v62, v168
    v_sub_f32 v63, v63, v168
    v_sub_f32 v152, v152, v168
    v_sub_f32 v153, v153, v168
    v_sub_f32 v154, v154, v168
    v_sub_f32 v155, v155, v168
    v_sub_f32 v36, v36, v168
    v_sub_f32 v37, v37, v168
    v_sub_f32 v38, v38, v168
    v_sub_f32 v39, v39, v168
    v_sub_f32 v86, v86, v168
    v_exp_f32 v60, v60
    v_exp_f32 v61, v61
    v_exp_f32 v62, v62
    v_exp_f32 v63, v63
    v_cvt_pk_bf16_f32 v60, v60, v61
    v_cvt_pk_bf16_f32 v61, v62, v63
    v_exp_f32 v152, v152
    v_exp_f32 v153, v153
    v_exp_f32 v154, v154
    v_exp_f32 v155, v155
    v_cvt_pk_bf16_f32 v62, v152, v153
    v_cvt_pk_bf16_f32 v63, v154, v155
    v_exp_f32 v36, v36
    v_exp_f32 v37, v37
    v_exp_f32 v38, v38
    v_exp_f32 v39, v39
    v_cvt_pk_bf16_f32 v168, v36, v37
    v_cvt_pk_bf16_f32 v169, v38, v39
    v_exp_f32 v86, v86
    v_fmac_f32 v93, v31, v31
    v_cvt_pk_bf16_f32 v170, v86, 0
    v_mfma_f32_16x16x32_bf16 v[152:155], v[220:223], v[60:63], 0
    v_fmac_f32 v93, v20, v20
    v_fmac_f32 v93, v21, v21
    v_mfma_f32_16x16x32_bf16 v[152:155], v[220:223], v[168:171], v[152:155]
    v_fmac_f32 v93, v22, v22
    v_fmac_f32 v93, v23, v23
    v_mfma_f32_16x16x32_bf16 v[36:39], v[0:3], v[60:63], 0
    s_nop 0
    v_fmac_f32 v93, v114, v114
    v_fmac_f32 v93, v115, v115
    v_mfma_f32_16x16x32_bf16 v[36:39], v[164:167], v[168:171], v[36:39]
    s_nop 0
    v_rcp_f32 v152, v152
    v_mfma_f32_16x16x32_bf16 v[0:3], v[8:11], v[60:63], 0
    s_nop 0
    v_fmac_f32 v93, v116, v116
    v_fmac_f32 v93, v117, v117
    v_mfma_f32_16x16x32_bf16 v[0:3], v[160:163], v[168:171], v[0:3]
    s_nop 0
    v_mul_f32 v36, v36, v152
    v_mul_f32 v37, v37, v152
    v_mfma_f32_16x16x32_bf16 v[8:11], v[12:15], v[60:63], 0
    v_cvt_pk_bf16_f32 v12, v36, v37
    v_mul_f32 v38, v38, v152
    v_mfma_f32_16x16x32_bf16 v[8:11], v[156:159], v[168:171], v[8:11]
    s_waitcnt lgkmcnt(0)
    v_mul_f32 v39, v39, v152
    v_cvt_pk_bf16_f32 v13, v38, v39
    v_mfma_f32_16x16x32_bf16 v[36:39], a[0:3], v[16:19], 0
    s_cbranch_scc1 L_loopS0
    ds_write_b64 v135, v[12:13] offset:3072
    v_mul_f32 v0, v0, v152
    v_mul_f32 v1, v1, v152
    v_cvt_pk_bf16_f32 v14, v0, v1
    v_mul_f32 v2, v2, v152
    v_mul_f32 v3, v3, v152
    v_cvt_pk_bf16_f32 v15, v2, v3
    v_mul_f32 v8, v8, v152
    v_mul_f32 v9, v9, v152
    v_cvt_pk_bf16_f32 v8, v8, v9
    v_mul_f32 v10, v10, v152
    v_mul_f32 v11, v11, v152
    v_cvt_pk_bf16_f32 v9, v10, v11
    s_mov_b32 s30, 100270464
    s_mul_i32 s89, s68, 7168
    ds_write_b64 v135, v[14:15] offset:3080
    v_fma_f32 v113, v40, v40, s42
    s_add_u32 s89, s89, 135168
    s_movk_i32 s90, 112
    ds_write_b64 v134, v[8:9] offset:3072
    v_fmac_f32 v113, v41, v41
    v_fmac_f32 v113, v42, v42
    v_fmac_f32 v113, v43, v43
    v_fmac_f32 v113, v140, v140
    v_fmac_f32 v113, v141, v141
    v_fmac_f32 v113, v142, v142
    v_fmac_f32 v113, v143, v143
    v_fmac_f32 v113, v44, v44
    v_fmac_f32 v113, v45, v45
    v_fmac_f32 v113, v46, v46
    v_fmac_f32 v113, v47, v47
    v_cvt_pk_bf16_f32 v112, v92, v93
    v_cvt_pk_bf16_f32 v113, v113, v122
    s_lshr_b32 s91, s64, 16
    s_lshl_b32 s92, s68, 10
    ds_write_b64 v130, v[112:113]
    v_mbcnt_lo_u32_b32 v131, -1, 0
    v_mbcnt_hi_u32_b32 v131, -1, v131
    v_and_b32 v132, 15, v131
    v_lshrrev_b32 v131, 4, v131
    v_mul_u32_u24 v118, 1792, v131
    v_add_u32 v118, s89, v118
    v_mad_u32_u24 v131, v132, s90, v118
    v_lshrrev_b32 v119, v132, s64
    v_and_b32 v119, 1, v119
    v_cmp_eq_u32 vcc, 1, v119
    v_mad_u32_u24 v119, v132, s90, v118
    v_lshrrev_b32 v132, v132, s91
    v_cndmask_b32 v131, v118, v131, vcc
    v_and_b32 v132, 1, v132
    v_subrev_u32 v119, 28672, v119
    v_cmp_eq_u32 vcc, 1, v132
    s_sub_u32 s84, s45, s44
    s_sub_u32 s85, s46, s45
    ds_read_b128 v[48:51], v131 offset:64
    ds_read_b128 v[36:39], v131 offset:80
    v_cndmask_b32 v119, v118, v119, vcc
    v_add_u32 v118, s92, v129
    s_waitcnt lgkmcnt(2)
    s_barrier
    s_sub_u32 s86, s44, s45
    ds_read_b128 v[86:89], v131
    v_add_u32 v139, s84, v137
    s_sub_u32 s93, s44, s47
    s_sub_u32 s94, s45, s47
    ds_read_b64 v[90:91], v131 offset:16
    ds_read_b128 v[8:11], v118 offset:6144
    v_add_u32 v138, s84, v136
    v_add_u32 v118, s85, v135
    s_sub_u32 s95, s46, s47
    ds_read_b128 v[16:19], v129 offset:0
    v_add_u32 v63, s85, v134
    ds_read_b128 v[0:3], v129 offset:1024
    v_add_u32 v112, s86, v135
    v_add_u32 v132, s86, v134
    v_add_u32 v131, s93, v133
    v_add_u32 v113, s94, v133
    s_waitcnt lgkmcnt(6)
    v_mfma_f32_16x16x32_bf16 v[12:15], v[220:223], v[48:51], 0
    s_waitcnt lgkmcnt(5)
    ds_read_b128 v[80:83], v139 offset:1536
    ds_read_b128 v[76:79], v138 offset:1536
    v_mfma_f32_16x16x32_bf16 v[12:15], v[220:223], v[36:39], v[12:15]
    s_waitcnt lgkmcnt(3)
    ds_read_b128 v[72:75], v139 offset:1664
    v_lshlrev_b32 v92, 16, v86
    v_and_b32 v86, 0xffff0000, v86
    v_lshlrev_b32 v93, 16, v87
    v_and_b32 v87, 0xffff0000, v87
    v_lshlrev_b32 v94, 16, v88
    v_and_b32 v88, 0xffff0000, v88
    v_rcp_f32 v12, v12
    v_lshlrev_b32 v95, 16, v89
    v_mfma_f32_16x16x32_bf16 v[64:67], v[216:219], v[16:19], 0
    s_waitcnt lgkmcnt(3)
    ds_read_b128 v[68:71], v138 offset:1664
    ds_read_b128 v[48:51], v139 offset:1792
    v_mfma_f32_16x16x32_bf16 v[64:67], v[216:219], v[0:3], v[64:67]
    s_waitcnt lgkmcnt(4)
    ds_read_b128 v[16:19], v138 offset:1792
    v_mul_f32 v92, v92, v12
    v_mul_f32 v86, v86, v12
    v_cvt_pk_bf16_f32 v92, v92, v86
    v_mul_f32 v93, v93, v12
    v_mfma_f32_16x16x32_bf16 v[0:3], a[216:219], v[80:83], 0
    s_waitcnt lgkmcnt(4)
    v_mul_f32 v87, v87, v12
    v_cvt_pk_bf16_f32 v93, v93, v87
    v_mfma_f32_16x16x32_bf16 v[0:3], a[220:223], v[76:79], v[0:3]
    s_waitcnt lgkmcnt(3)
    ds_read_b128 v[108:111], v139 offset:0
    ds_read_b128 v[104:107], v138 offset:0
    v_mfma_f32_16x16x32_bf16 v[0:3], a[224:227], v[72:75], v[0:3]
    s_waitcnt lgkmcnt(4)
    ds_read_b128 v[96:99], v139 offset:128
    v_mul_f32 v94, v94, v12
    v_mul_f32 v88, v88, v12
    v_cvt_pk_bf16_f32 v94, v94, v88
    v_and_b32 v89, 0xffff0000, v89
    v_mul_f32 v95, v95, v12
    v_mfma_f32_16x16x32_bf16 v[0:3], a[228:231], v[68:71], v[0:3]
    s_waitcnt lgkmcnt(4)
    ds_read_b128 v[84:87], v138 offset:128
    ds_read_b128 v[56:59], v139 offset:256
    v_mfma_f32_16x16x32_bf16 v[0:3], a[232:235], v[48:51], v[0:3]
    s_waitcnt lgkmcnt(5)
    ds_read_b128 v[36:39], v138 offset:256
    v_mul_f32 v89, v89, v12
    v_mfma_f32_16x16x32_bf16 v[0:3], a[236:239], v[16:19], v[0:3]
    v_cvt_pk_bf16_f32 v95, v95, v89
    v_lshlrev_b32 v67, 16, v90
    v_mfma_f32_16x16x32_bf16 v[52:55], a[240:243], v[80:83], 0
    ds_write_b128 v112, v[92:95] offset:0
    v_mfma_f32_16x16x32_bf16 v[52:55], a[244:247], v[76:79], v[52:55]
    v_and_b32 v90, 0xffff0000, v90
    v_mul_f32 v67, v67, v12
    v_mfma_f32_16x16x32_bf16 v[52:55], a[248:251], v[72:75], v[52:55]
    v_mul_f32 v90, v90, v12
    v_cvt_pk_bf16_f32 v60, v67, v90
    v_mfma_f32_16x16x32_bf16 v[52:55], a[252:255], v[68:71], v[52:55]
    v_lshlrev_b32 v67, 16, v91
    v_and_b32 v91, 0xffff0000, v91
    v_mfma_f32_16x16x32_bf16 v[52:55], v[224:227], v[48:51], v[52:55]
    v_mul_f32 v67, v67, v12
    v_mul_f32 v91, v91, v12
    v_mfma_f32_16x16x32_bf16 v[52:55], v[228:231], v[16:19], v[52:55]
    v_cvt_pk_bf16_f32 v61, v67, v91
    v_lshrrev_b32 v67, 0, v11
    v_mfma_f32_16x16x32_bf16 v[12:15], v[232:235], v[80:83], 0
    ds_write_b64 v132, v[60:61] offset:0
    v_mfma_f32_16x16x32_bf16 v[12:15], v[236:239], v[76:79], v[12:15]
    v_lshrrev_b32 v67, v67, s64
    v_and_b32 v67, 1, v67
    v_mfma_f32_16x16x32_bf16 v[12:15], v[240:243], v[72:75], v[12:15]
    v_cmp_eq_u32 vcc, 1, v67
    v_lshrrev_b32 v67, 8, v11
    v_mfma_f32_16x16x32_bf16 v[12:15], v[244:247], v[68:71], v[12:15]
    v_cndmask_b32 v8, 2.0, v8, vcc
    v_lshrrev_b32 v67, v67, s64
    v_mfma_f32_16x16x32_bf16 v[12:15], v[248:251], v[48:51], v[12:15]
    v_and_b32 v67, 1, v67
    v_cmp_eq_u32 vcc, 1, v67
    v_mfma_f32_16x16x32_bf16 v[12:15], v[252:255], v[16:19], v[12:15]
    s_waitcnt lgkmcnt(1)
    v_cndmask_b32 v9, 2.0, v9, vcc
    v_lshrrev_b32 v11, 16, v11
    v_mfma_f32_16x16x32_bf16 v[72:75], a[216:219], v[108:111], 0
    v_lshrrev_b32 v11, v11, s64
    v_and_b32 v11, 1, v11
    v_mfma_f32_16x16x32_bf16 v[72:75], a[220:223], v[104:107], v[72:75]
    ds_read_b128 v[100:103], v139 offset:3072
    ds_read_b128 v[92:95], v138 offset:3072
    v_mfma_f32_16x16x32_bf16 v[72:75], a[224:227], v[96:99], v[72:75]
    ds_read_b128 v[88:91], v139 offset:3200
    v_cmp_eq_u32 vcc, 1, v11
    v_mfma_f32_16x16x32_bf16 v[72:75], a[228:231], v[84:87], v[72:75]
    ds_read_b128 v[80:83], v138 offset:3200
    v_cndmask_b32 v10, 2.0, v10, vcc
    v_mfma_f32_16x16x32_bf16 v[72:75], a[232:235], v[56:59], v[72:75]
    ds_read_b128 v[76:79], v139 offset:3328
    v_add_u32 v11, s95, v133
    v_mfma_f32_16x16x32_bf16 v[72:75], a[236:239], v[36:39], v[72:75]
    ds_read_b128 v[16:19], v138 offset:3328
    v_fma_f32 v133, v0, v0, s42
    v_mfma_f32_16x16x32_bf16 v[48:51], a[240:243], v[108:111], 0
    v_rsq_f32 v64, v64
    v_mfma_f32_16x16x32_bf16 v[48:51], a[244:247], v[104:107], v[48:51]
    v_mul_f32 v64, s43, v64
    v_mul_f32 v32, v32, v64
    v_mfma_f32_16x16x32_bf16 v[48:51], a[248:251], v[96:99], v[48:51]
    v_mul_f32 v33, v33, v64
    v_cvt_pk_bf16_f32 v32, v32, v33
    v_mfma_f32_16x16x32_bf16 v[48:51], a[252:255], v[84:87], v[48:51]
    v_mul_f32 v34, v34, v64
    v_mul_f32 v35, v35, v64
    v_mfma_f32_16x16x32_bf16 v[48:51], v[224:227], v[56:59], v[48:51]
    v_cvt_pk_bf16_f32 v33, v34, v35
    v_mul_f32 v4, v4, v64
    v_mfma_f32_16x16x32_bf16 v[48:51], v[228:231], v[36:39], v[48:51]
    v_mul_f32 v5, v5, v64
    v_cvt_pk_bf16_f32 v34, v4, v5
    v_mfma_f32_16x16x32_bf16 v[68:71], v[232:235], v[108:111], 0
    v_mul_f32 v6, v6, v64
    v_mul_f32 v7, v7, v64
    v_mfma_f32_16x16x32_bf16 v[68:71], v[236:239], v[104:107], v[68:71]
    v_cvt_pk_bf16_f32 v35, v6, v7
    v_mul_f32 v24, v24, v64
    v_mfma_f32_16x16x32_bf16 v[68:71], v[240:243], v[96:99], v[68:71]
    ds_write_b128 v118, v[32:35] offset:0
    v_mfma_f32_16x16x32_bf16 v[68:71], v[244:247], v[84:87], v[68:71]
    v_mul_f32 v25, v25, v64
    v_cvt_pk_bf16_f32 v24, v24, v25
    v_mfma_f32_16x16x32_bf16 v[68:71], v[248:251], v[56:59], v[68:71]
    v_mul_f32 v26, v26, v64
    v_mul_f32 v27, v27, v64
    v_mfma_f32_16x16x32_bf16 v[68:71], v[252:255], v[36:39], v[68:71]
    s_waitcnt lgkmcnt(1)
    v_cvt_pk_bf16_f32 v25, v26, v27
    v_fma_f32 v62, v72, v72, s42
    v_mfma_f32_16x16x32_bf16 v[84:87], a[216:219], v[100:103], 0
    ds_write_b64 v63, v[24:25] offset:0
    v_mfma_f32_16x16x32_bf16 v[84:87], a[220:223], v[92:95], v[84:87]
    ds_read_b128 v[24:27], v119 offset:64
    v_fmac_f32 v62, v73, v73
    v_mfma_f32_16x16x32_bf16 v[84:87], a[224:227], v[88:91], v[84:87]
    ds_read_b128 v[4:7], v119 offset:80
    v_fmac_f32 v62, v74, v74
    v_mfma_f32_16x16x32_bf16 v[84:87], a[228:231], v[80:83], v[84:87]
    ds_read_b128 v[56:59], v119
    v_fmac_f32 v62, v75, v75
    v_mfma_f32_16x16x32_bf16 v[84:87], a[232:235], v[76:79], v[84:87]
    ds_read_b64 v[60:61], v119 offset:16
    v_fmac_f32 v62, v48, v48
    v_mfma_f32_16x16x32_bf16 v[84:87], a[236:239], v[16:19], v[84:87]
    v_rsq_f32 v65, v65
    v_mfma_f32_16x16x32_bf16 v[96:99], a[240:243], v[100:103], 0
    v_mul_f32 v65, s43, v65
    v_mul_f32 v28, v28, v65
    v_mfma_f32_16x16x32_bf16 v[96:99], a[244:247], v[92:95], v[96:99]
    v_mul_f32 v29, v29, v65
    v_cvt_pk_bf16_f32 v28, v28, v29
    v_mfma_f32_16x16x32_bf16 v[96:99], a[248:251], v[88:91], v[96:99]
    v_mul_f32 v30, v30, v65
    v_mul_f32 v31, v31, v65
    v_mfma_f32_16x16x32_bf16 v[96:99], a[252:255], v[80:83], v[96:99]
    v_cvt_pk_bf16_f32 v29, v30, v31
    v_mul_f32 v20, v20, v65
    v_mfma_f32_16x16x32_bf16 v[96:99], v[224:227], v[76:79], v[96:99]
    v_mul_f32 v21, v21, v65
    v_cvt_pk_bf16_f32 v30, v20, v21
    v_mfma_f32_16x16x32_bf16 v[96:99], v[228:231], v[16:19], v[96:99]
    v_mul_f32 v22, v22, v65
    v_mul_f32 v23, v23, v65
    v_mfma_f32_16x16x32_bf16 v[36:39], v[232:235], v[100:103], 0
    v_cvt_pk_bf16_f32 v31, v22, v23
    v_mul_f32 v114, v114, v65
    v_mfma_f32_16x16x32_bf16 v[36:39], v[236:239], v[92:95], v[36:39]
    ds_write_b128 v118, v[28:31] offset:1536
    v_mfma_f32_16x16x32_bf16 v[36:39], v[240:243], v[88:91], v[36:39]
    v_mul_f32 v115, v115, v65
    v_cvt_pk_bf16_f32 v114, v114, v115
    v_mfma_f32_16x16x32_bf16 v[36:39], v[244:247], v[80:83], v[36:39]
    v_mul_f32 v116, v116, v65
    v_mul_f32 v117, v117, v65
    v_mfma_f32_16x16x32_bf16 v[36:39], v[248:251], v[76:79], v[36:39]
    v_cvt_pk_bf16_f32 v115, v116, v117
    v_fmac_f32 v62, v49, v49
    v_mfma_f32_16x16x32_bf16 v[36:39], v[252:255], v[16:19], v[36:39]
    s_waitcnt lgkmcnt(1)
    ds_write_b64 v63, v[114:115] offset:1536
    v_mfma_f32_16x16x32_bf16 v[16:19], v[220:223], v[24:27], 0
    v_rsq_f32 v66, v66
    v_mfma_f32_16x16x32_bf16 v[16:19], v[220:223], v[4:7], v[16:19]
    v_mul_f32 v66, s43, v66
    v_mul_f32 v40, v40, v66
    v_mul_f32 v41, v41, v66
    v_cvt_pk_bf16_f32 v4, v40, v41
    v_mul_f32 v42, v42, v66
    v_mul_f32 v43, v43, v66
    v_cvt_pk_bf16_f32 v5, v42, v43
    v_mul_f32 v140, v140, v66
    v_mul_f32 v141, v141, v66
    v_cvt_pk_bf16_f32 v6, v140, v141
    v_mul_f32 v142, v142, v66
    v_mul_f32 v143, v143, v66
    v_cvt_pk_bf16_f32 v7, v142, v143
    v_mul_f32 v44, v44, v66
    v_mul_f32 v45, v45, v66
    v_cvt_pk_bf16_f32 v44, v44, v45
    v_mul_f32 v46, v46, v66
    v_mul_f32 v47, v47, v66
    v_cvt_pk_bf16_f32 v45, v46, v47
    ds_write_b128 v118, v[4:7] offset:3072
    v_fmac_f32 v62, v50, v50
    v_fmac_f32 v62, v51, v51
    v_fmac_f32 v62, v68, v68
    v_fmac_f32 v62, v69, v69
    ds_write_b64 v63, v[44:45] offset:3072
    v_fmac_f32 v62, v70, v70
    v_fmac_f32 v62, v71, v71
    v_fmac_f32 v133, v1, v1
    v_fmac_f32 v133, v2, v2
    v_fmac_f32 v133, v3, v3
    v_fmac_f32 v133, v52, v52
    v_fmac_f32 v133, v53, v53
    v_fmac_f32 v133, v54, v54
    v_fmac_f32 v133, v55, v55
    v_fmac_f32 v133, v12, v12
    v_fmac_f32 v133, v13, v13
    v_fmac_f32 v133, v14, v14
    v_fmac_f32 v133, v15, v15
    v_cvt_pk_bf16_f32 v62, v62, v133
    v_fma_f32 v63, v84, v84, s42
    v_fmac_f32 v63, v85, v85
    v_fmac_f32 v63, v86, v86
    v_fmac_f32 v63, v87, v87
    v_fmac_f32 v63, v96, v96
    v_fmac_f32 v63, v97, v97
    v_fmac_f32 v63, v98, v98
    v_fmac_f32 v63, v99, v99
    v_fmac_f32 v63, v36, v36
    v_fmac_f32 v63, v37, v37
    v_fmac_f32 v63, v38, v38
    v_fmac_f32 v63, v39, v39
    v_cvt_pk_bf16_f32 v63, v63, v63
    ds_write_b64 v130, v[62:63] offset:2048
    v_rcp_f32 v16, v16
    v_lshlrev_b32 v133, 16, v56
    v_and_b32 v56, 0xffff0000, v56
    v_mul_f32 v133, v133, v16
    v_mul_f32 v56, v56, v16
    v_cvt_pk_bf16_f32 v4, v133, v56
    v_lshlrev_b32 v56, 16, v57
    v_and_b32 v57, 0xffff0000, v57
    v_mul_f32 v56, v56, v16
    v_mul_f32 v57, v57, v16
    v_cvt_pk_bf16_f32 v5, v56, v57
    v_lshlrev_b32 v133, 16, v58
    v_and_b32 v58, 0xffff0000, v58
    v_mul_f32 v133, v133, v16
    v_mul_f32 v58, v58, v16
    v_cvt_pk_bf16_f32 v6, v133, v58
    v_lshlrev_b32 v7, 16, v59
    v_and_b32 v59, 0xffff0000, v59
    v_mul_f32 v7, v7, v16
    v_mul_f32 v59, v59, v16
    v_cvt_pk_bf16_f32 v7, v7, v59
    v_lshlrev_b32 v133, 16, v60
    v_and_b32 v60, 0xffff0000, v60
    v_mul_f32 v133, v133, v16
    v_mul_f32 v60, v60, v16
    v_cvt_pk_bf16_f32 v138, v133, v60
    v_lshlrev_b32 v133, 16, v61
    v_and_b32 v61, 0xffff0000, v61
    v_mul_f32 v133, v133, v16
    v_mul_f32 v61, v61, v16
    v_cvt_pk_bf16_f32 v139, v133, v61
    s_waitcnt lgkmcnt(0)
    s_barrier
    ds_write_b128 v112, v[4:7] offset:1536
    v_mov_b32 v115, 0
    ds_write_b64 v132, v[138:139] offset:1536
    ds_read_b128 v[32:35], v11 offset:0
    ds_read_b128 v[4:7], v11 offset:1024
    ds_read_b128 v[24:27], v11 offset:2048
    ds_read_b128 v[20:23], v11 offset:3072
    ds_read_b128 v[80:83], v11 offset:4096
    s_waitcnt lgkmcnt(5)
    s_barrier
    s_waitcnt lgkmcnt(4)
    buffer_store_dwordx4 v[32:35], v128, s[28:31], s59 offen sc1
    ds_read_b128 v[28:31], v129 offset:2048
    ds_read_b128 v[16:19], v129 offset:3072
    ds_read_b128 v[104:107], v137 offset:1536
    ds_read_b128 v[100:103], v136 offset:1536
    ds_read_b128 v[92:95], v137 offset:1664
    ds_read_b128 v[88:91], v136 offset:1664
    ds_read_b128 v[76:79], v137 offset:1792
    s_waitcnt lgkmcnt(9)
    buffer_store_dwordx4 v[4:7], v127, s[28:31], s59 offen sc1
    ds_read_b128 v[40:43], v136 offset:1792
    s_waitcnt lgkmcnt(7)
    v_mfma_f32_16x16x32_bf16 v[4:7], v[216:219], v[28:31], 0
    s_waitcnt lgkmcnt(6)
    v_mfma_f32_16x16x32_bf16 v[4:7], v[216:219], v[16:19], v[4:7]
    s_waitcnt lgkmcnt(5)
    v_mfma_f32_16x16x32_bf16 v[16:19], a[216:219], v[104:107], 0
    s_waitcnt lgkmcnt(4)
    v_mfma_f32_16x16x32_bf16 v[16:19], a[220:223], v[100:103], v[16:19]
    s_waitcnt lgkmcnt(3)
    ds_read_b128 v[64:67], v137 offset:0
    ds_read_b128 v[60:63], v136 offset:0
    v_mfma_f32_16x16x32_bf16 v[16:19], a[224:227], v[92:95], v[16:19]
    s_waitcnt lgkmcnt(4)
    ds_read_b128 v[56:59], v137 offset:128
    v_mfma_f32_16x16x32_bf16 v[16:19], a[228:231], v[88:91], v[16:19]
    s_waitcnt lgkmcnt(4)
    buffer_store_dwordx4 v[24:27], v126, s[28:31], s59 offen sc1
    ds_read_b128 v[44:47], v136 offset:128
    v_rsq_f32 v4, v4
    v_mfma_f32_16x16x32_bf16 v[16:19], a[232:235], v[76:79], v[16:19]
    s_waitcnt lgkmcnt(4)
    ds_read_b128 v[32:35], v137 offset:256
    ds_read_b128 v[24:27], v136 offset:256
    v_mfma_f32_16x16x32_bf16 v[16:19], a[236:239], v[40:43], v[16:19]
    v_rsq_f32 v5, v5
    v_mfma_f32_16x16x32_bf16 v[28:31], a[240:243], v[104:107], 0
    v_mul_f32 v4, s43, v4
    v_mul_f32 v5, s43, v5
    v_mfma_f32_16x16x32_bf16 v[28:31], a[244:247], v[100:103], v[28:31]
    v_rsq_f32 v6, v6
    v_mfma_f32_16x16x32_bf16 v[28:31], a[248:251], v[92:95], v[28:31]
    v_mul_f32 v6, s43, v6
    v_mul_f32 v84, v84, v6
    v_mfma_f32_16x16x32_bf16 v[28:31], a[252:255], v[88:91], v[28:31]
    buffer_store_dwordx4 v[20:23], v125, s[28:31], s59 offen sc1
    v_mul_f32 v85, v85, v6
    v_cvt_pk_bf16_f32 v84, v84, v85
    v_mul_f32 v86, v86, v6
    v_mul_f32 v87, v87, v6
    v_mfma_f32_16x16x32_bf16 v[28:31], v[224:227], v[76:79], v[28:31]
    v_cvt_pk_bf16_f32 v85, v86, v87
    v_mul_f32 v96, v96, v6
    v_mfma_f32_16x16x32_bf16 v[28:31], v[228:231], v[40:43], v[28:31]
    v_mul_f32 v97, v97, v6
    v_cvt_pk_bf16_f32 v86, v96, v97
    v_mfma_f32_16x16x32_bf16 v[20:23], v[232:235], v[104:107], 0
    v_mul_f32 v98, v98, v6
    v_mul_f32 v99, v99, v6
    v_mfma_f32_16x16x32_bf16 v[20:23], v[236:239], v[100:103], v[20:23]
    v_cvt_pk_bf16_f32 v87, v98, v99
    v_mul_f32 v36, v36, v6
    v_mfma_f32_16x16x32_bf16 v[20:23], v[240:243], v[92:95], v[20:23]
    ds_write_b128 v135, v[84:87] offset:3072
    v_mfma_f32_16x16x32_bf16 v[20:23], v[244:247], v[88:91], v[20:23]
    buffer_store_dwordx4 v[80:83], v124, s[28:31], s59 offen sc1
    v_mul_f32 v37, v37, v6
    v_cvt_pk_bf16_f32 v36, v36, v37
    v_mul_f32 v38, v38, v6
    v_mul_f32 v39, v39, v6
    v_mfma_f32_16x16x32_bf16 v[20:23], v[248:251], v[76:79], v[20:23]
    v_cvt_pk_bf16_f32 v37, v38, v39
    v_mul_f32 v72, v72, v4
    v_mfma_f32_16x16x32_bf16 v[20:23], v[252:255], v[40:43], v[20:23]
    s_waitcnt lgkmcnt(1)
    ds_write_b64 v134, v[36:37] offset:3072
    v_mfma_f32_16x16x32_bf16 v[36:39], a[216:219], v[64:67], 0
    v_mul_f32 v73, v73, v4
    v_cvt_pk_bf16_f32 v40, v72, v73
    v_mfma_f32_16x16x32_bf16 v[36:39], a[220:223], v[60:63], v[36:39]
    v_mul_f32 v74, v74, v4
    v_mul_f32 v75, v75, v4
    v_mfma_f32_16x16x32_bf16 v[36:39], a[224:227], v[56:59], v[36:39]
    v_cvt_pk_bf16_f32 v41, v74, v75
    v_mul_f32 v48, v48, v4
    v_mfma_f32_16x16x32_bf16 v[36:39], a[228:231], v[44:47], v[36:39]
    v_mul_f32 v49, v49, v4
    v_cvt_pk_bf16_f32 v42, v48, v49
    v_mfma_f32_16x16x32_bf16 v[36:39], a[232:235], v[32:35], v[36:39]
    v_mul_f32 v50, v50, v4
    v_mul_f32 v51, v51, v4
    v_mfma_f32_16x16x32_bf16 v[36:39], a[236:239], v[24:27], v[36:39]
    v_cvt_pk_bf16_f32 v43, v50, v51
    v_mul_f32 v68, v68, v4
    v_mfma_f32_16x16x32_bf16 v[48:51], a[240:243], v[64:67], 0
    ds_write_b128 v135, v[40:43] offset:0
    v_mfma_f32_16x16x32_bf16 v[48:51], a[244:247], v[60:63], v[48:51]
    v_mul_f32 v69, v69, v4
    v_cvt_pk_bf16_f32 v6, v68, v69
    v_mfma_f32_16x16x32_bf16 v[48:51], a[248:251], v[56:59], v[48:51]
    v_mul_f32 v70, v70, v4
    v_mul_f32 v71, v71, v4
    v_mfma_f32_16x16x32_bf16 v[48:51], a[252:255], v[44:47], v[48:51]
    v_cvt_pk_bf16_f32 v7, v70, v71
    v_fma_f32 v11, v16, v16, s42
    v_mfma_f32_16x16x32_bf16 v[48:51], v[224:227], v[32:35], v[48:51]
    ds_write_b64 v134, v[6:7] offset:0
    v_mfma_f32_16x16x32_bf16 v[48:51], v[228:231], v[24:27], v[48:51]
    v_fmac_f32 v11, v17, v17
    v_fmac_f32 v11, v18, v18
    v_mfma_f32_16x16x32_bf16 v[40:43], v[232:235], v[64:67], 0
    v_fmac_f32 v11, v19, v19
    v_fmac_f32 v11, v28, v28
    v_mfma_f32_16x16x32_bf16 v[40:43], v[236:239], v[60:63], v[40:43]
    v_fmac_f32 v11, v29, v29
    v_fmac_f32 v11, v30, v30
    v_mfma_f32_16x16x32_bf16 v[40:43], v[240:243], v[56:59], v[40:43]
    v_fmac_f32 v11, v31, v31
    v_fmac_f32 v11, v20, v20
    v_mfma_f32_16x16x32_bf16 v[40:43], v[244:247], v[44:47], v[40:43]
    v_fmac_f32 v11, v21, v21
    v_fmac_f32 v11, v22, v22
    v_mfma_f32_16x16x32_bf16 v[40:43], v[248:251], v[32:35], v[40:43]
    v_fmac_f32 v11, v23, v23
    v_fma_f32 v114, v36, v36, s42
    v_mfma_f32_16x16x32_bf16 v[40:43], v[252:255], v[24:27], v[40:43]
    s_nop 0
    v_fmac_f32 v114, v37, v37
    v_fmac_f32 v114, v38, v38
    v_fmac_f32 v114, v39, v39
    v_fmac_f32 v114, v48, v48
    v_fmac_f32 v114, v49, v49
    v_fmac_f32 v114, v50, v50
    v_fmac_f32 v114, v51, v51
    v_fmac_f32 v114, v40, v40
    v_fmac_f32 v114, v41, v41
    v_fmac_f32 v114, v42, v42
    v_fmac_f32 v114, v43, v43
    v_cvt_pk_bf16_f32 v114, v114, v11
    ds_write_b64 v130, v[114:115] offset:4096
    v_mul_f32 v0, v0, v5
    v_mul_f32 v1, v1, v5
    v_cvt_pk_bf16_f32 v0, v0, v1
    v_mul_f32 v2, v2, v5
    v_mul_f32 v3, v3, v5
    v_cvt_pk_bf16_f32 v1, v2, v3
    v_mul_f32 v52, v52, v5
    v_mul_f32 v53, v53, v5
    v_cvt_pk_bf16_f32 v2, v52, v53
    v_mul_f32 v54, v54, v5
    v_mul_f32 v55, v55, v5
    v_cvt_pk_bf16_f32 v3, v54, v55
    v_mul_f32 v12, v12, v5
    v_mul_f32 v13, v13, v5
    v_cvt_pk_bf16_f32 v114, v12, v13
    v_mul_f32 v14, v14, v5
    v_mul_f32 v15, v15, v5
    v_cvt_pk_bf16_f32 v115, v14, v15
    ds_write_b128 v135, v[0:3] offset:1536
    s_waitcnt lgkmcnt(1)
    s_barrier
    ds_write_b64 v134, v[114:115] offset:1536
    ds_read_b128 v[4:7], v129 offset:4096
    ds_read_b128 v[0:3], v129 offset:5120
    s_waitcnt lgkmcnt(2)
    s_barrier
    s_waitcnt lgkmcnt(1)
    v_mfma_f32_16x16x32_bf16 v[24:27], v[216:219], v[4:7], 0
    s_waitcnt lgkmcnt(0)
    ds_read_b128 v[44:47], v113 offset:0
    ds_read_b128 v[32:35], v113 offset:1024
    v_mfma_f32_16x16x32_bf16 v[24:27], v[216:219], v[0:3], v[24:27]
    s_nop 0
    ds_read_b128 v[12:15], v113 offset:2048
    s_nop 2
    ds_read_b128 v[4:7], v113 offset:3072
    s_nop 1
    v_rsq_f32 v24, v24
    ds_read_b128 v[0:3], v113 offset:4096
    v_mul_f32 v24, s43, v24
    v_mul_f32 v36, v36, v24
    v_mul_f32 v37, v37, v24
    v_cvt_pk_bf16_f32 v36, v36, v37
    v_mul_f32 v38, v38, v24
    v_mul_f32 v39, v39, v24
    v_cvt_pk_bf16_f32 v37, v38, v39
    v_mul_f32 v48, v48, v24
    v_mul_f32 v49, v49, v24
    s_waitcnt lgkmcnt(4)
    buffer_store_dwordx4 v[44:47], v128, s[28:31], s58 offen sc1
    v_cvt_pk_bf16_f32 v38, v48, v49
    v_mul_f32 v50, v50, v24
    v_mul_f32 v51, v51, v24
    v_cvt_pk_bf16_f32 v39, v50, v51
    v_mul_f32 v40, v40, v24
    v_mul_f32 v41, v41, v24
    v_cvt_pk_bf16_f32 v26, v40, v41
    v_mul_f32 v42, v42, v24
    v_mul_f32 v43, v43, v24
    v_cvt_pk_bf16_f32 v27, v42, v43
    ds_write_b128 v112, v[36:39] offset:0
    v_rsq_f32 v25, v25
    s_nop 0
    v_mul_f32 v25, s43, v25
    s_waitcnt lgkmcnt(1)
    buffer_store_dwordx4 v[32:35], v127, s[28:31], s58 offen sc1
    ds_write_b64 v132, v[26:27] offset:0
    v_mul_f32 v16, v16, v25
    v_mul_f32 v17, v17, v25
    v_cvt_pk_bf16_f32 v16, v16, v17
    v_mul_f32 v18, v18, v25
    v_mul_f32 v19, v19, v25
    v_cvt_pk_bf16_f32 v17, v18, v19
    v_mul_f32 v28, v28, v25
    v_mul_f32 v29, v29, v25
    v_cvt_pk_bf16_f32 v18, v28, v29
    v_mul_f32 v30, v30, v25
    v_mul_f32 v31, v31, v25
    v_cvt_pk_bf16_f32 v19, v30, v31
    v_mul_f32 v20, v20, v25
    v_mul_f32 v21, v21, v25
    v_cvt_pk_bf16_f32 v128, v20, v21
    v_mul_f32 v22, v22, v25
    v_mul_f32 v23, v23, v25
    v_cvt_pk_bf16_f32 v129, v22, v23
    buffer_store_dwordx4 v[12:15], v126, s[28:31], s58 offen sc1
    ds_write_b128 v112, v[16:19] offset:1536
    ds_write_b64 v132, v[128:129] offset:1536
    buffer_store_dwordx4 v[4:7], v125, s[28:31], s58 offen sc1
    s_waitcnt lgkmcnt(0)
    s_barrier
    buffer_store_dwordx4 v[0:3], v124, s[28:31], s58 offen sc1
    ds_read_b128 v[12:15], v131 offset:0
    ds_read_b128 v[4:7], v131 offset:1024
    ds_read_b128 v[0:3], v131 offset:2048
    s_waitcnt lgkmcnt(2)
    buffer_store_dwordx4 v[12:15], v8, s[28:31], 0 offen sc1
    s_waitcnt lgkmcnt(0)
    buffer_store_dwordx4 v[4:7], v9, s[28:31], 0 offen sc1
    buffer_store_dwordx4 v[0:3], v10, s[28:31], 0 offen sc1
    s_branch L_fin
L_again:
    s_waitcnt vmcnt(0) lgkmcnt(0)
    s_nop 15
    s_barrier
    s_movk_i32 s2, 256
    s_branch L_top
L_bndS:
    s_movk_i32 s73, 20
    s_movk_i32 s71, 18
    s_movk_i32 s70, -20
    s_mov_b32 s74, 0
    s_bitcmp1_b32 s2, 2
    s_cbranch_scc1 L_bndcS
    s_sub_u32 s94, s2, 248
    s_mul_i32 s69, s94, 18
    s_mov_b32 s74, 2
    s_sub_u32 s93, s93, 1373568
    v_cmp_le_u32 vcc, 4, v73
    v_add_u32 v6, 98896896, v128
    v_subrev_u32 v7, 1373568, v128
    v_cndmask_b32 v128, v6, v7, vcc
    v_cmp_le_u32 vcc, 4, v156
    v_add_u32 v6, 98896896, v127
    v_subrev_u32 v7, 1373568, v127
    v_cndmask_b32 v127, v6, v7, vcc
    v_cmp_le_u32 vcc, 4, v4
    v_add_u32 v6, 98896896, v126
    v_subrev_u32 v7, 1373568, v126
    v_cndmask_b32 v126, v6, v7, vcc
    v_cmp_le_u32 vcc, 4, v18
    v_add_u32 v6, 98896896, v125
    v_subrev_u32 v7, 1373568, v125
    v_cndmask_b32 v125, v6, v7, vcc
    v_cmp_le_u32 vcc, 4, v11
    v_add_u32 v6, 98896896, v124
    v_subrev_u32 v7, 1373568, v124
    v_cndmask_b32 v124, v6, v7, vcc
    s_cmp_lt_u32 s2, 256
    s_cbranch_scc1 L_bndrS
L_bndcS:
    s_sub_u32 s94, s2, 252
    s_mul_i32 s69, s94, 20
    s_lshr_b32 s71, s94, 1
    s_sub_u32 s69, s69, s71
    s_and_b32 s94, s94, 1
    s_sub_u32 s71, 20, s94
    s_cmp_eq_u32 s2, 255
    s_cselect_b32 s71, 13, s71
    s_mov_b32 s62, 1373568
    s_add_u32 s74, s74, 1
    s_sub_u32 s93, s93, 2688
    v_mad_i32_i24 v6, v73, -7, v74
    v_cmp_le_u32 vcc, 4, v6
    v_add_u32 v6, 193536, v128
    v_subrev_u32 v7, 2688, v128
    v_cndmask_b32 v128, v6, v7, vcc
    v_mad_i32_i24 v6, v156, -7, v150
    v_cmp_le_u32 vcc, 4, v6
    v_add_u32 v6, 193536, v127
    v_subrev_u32 v7, 2688, v127
    v_cndmask_b32 v127, v6, v7, vcc
    v_mad_i32_i24 v6, v4, -7, v10
    v_cmp_le_u32 vcc, 4, v6
    v_add_u32 v6, 193536, v126
    v_subrev_u32 v7, 2688, v126
    v_cndmask_b32 v126, v6, v7, vcc
    v_mad_i32_i24 v6, v18, -7, v159
    v_cmp_le_u32 vcc, 4, v6
    v_add_u32 v6, 193536, v125
    v_subrev_u32 v7, 2688, v125
    v_cndmask_b32 v125, v6, v7, vcc
    v_mad_i32_i24 v6, v11, -7, v151
    v_cmp_le_u32 vcc, 4, v6
    v_add_u32 v6, 193536, v124
    v_subrev_u32 v7, 2688, v124
    v_cndmask_b32 v124, v6, v7, vcc
    s_cmp_eq_u32 s2, 256
    s_cselect_b32 s62, 0, s62
    s_cselect_b32 s69, 0, s69
    s_cselect_b32 s71, 2, s71
    s_branch L_bndrS
L_maskS:
    s_and_b32 s20, s74, 2
    s_and_b32 s21, s74, 1
    s_mov_b32 s22, 0xc31044fe
    v_lshrrev_b32 v161, 2, v149
    v_add_u32 v161, 0, v161
    v_mul_u32_u24 v148, 37, v161
    v_lshrrev_b32 v72, 8, v148
    v_mad_i32_i24 v72, v72, -7, v161
    v_lshrrev_b32 v148, 10, v148
    v_lshrrev_b32 v72, 2, v72
    v_mul_u32_u24 v148, s20, v148
    v_mad_u32_u24 v161, v72, s21, v148
    v_cvt_f32_u32 v161, v161
    v_lshrrev_b32 v164, 2, v149
    v_add_u32 v164, 4, v164
    v_mul_u32_u24 v148, 37, v164
    v_lshrrev_b32 v72, 8, v148
    v_mad_i32_i24 v72, v72, -7, v164
    v_lshrrev_b32 v148, 10, v148
    v_lshrrev_b32 v72, 2, v72
    v_mul_u32_u24 v148, s20, v148
    v_mad_u32_u24 v164, v72, s21, v148
    v_cvt_f32_u32 v164, v164
    v_lshrrev_b32 v75, 2, v149
    v_add_u32 v75, 8, v75
    v_mul_u32_u24 v148, 37, v75
    v_lshrrev_b32 v72, 8, v148
    v_mad_i32_i24 v72, v72, -7, v75
    v_lshrrev_b32 v148, 10, v148
    v_lshrrev_b32 v72, 2, v72
    v_mul_u32_u24 v148, s20, v148
    v_mad_u32_u24 v75, v72, s21, v148
    v_cvt_f32_u32 v75, v75
    v_mad_u32_u24 v73, v160, 12, 0
    v_mul_u32_u24 v148, 37, v73
    v_lshrrev_b32 v72, 8, v148
    v_mad_i32_i24 v72, v72, -7, v73
    v_lshrrev_b32 v148, 10, v148
    v_lshrrev_b32 v72, 2, v72
    v_mul_u32_u24 v148, s20, v148
    v_mad_u32_u24 v73, v72, s21, v148
    v_cvt_f32_u32 v73, v73
    v_sub_f32 v148, v161, v73
    v_mul_f32 v148, v148, v148 clamp
    v_fmac_f32 v204, s22, v148
    v_sub_f32 v148, v164, v73
    v_mul_f32 v148, v148, v148 clamp
    v_fmac_f32 v192, s22, v148
    v_sub_f32 v148, v75, v73
    v_mul_f32 v148, v148, v148 clamp
    v_fmac_f32 v180, s22, v148
    v_mad_u32_u24 v73, v160, 12, 1
    v_mul_u32_u24 v148, 37, v73
    v_lshrrev_b32 v72, 8, v148
    v_mad_i32_i24 v72, v72, -7, v73
    v_lshrrev_b32 v148, 10, v148
    v_lshrrev_b32 v72, 2, v72
    v_mul_u32_u24 v148, s20, v148
    v_mad_u32_u24 v73, v72, s21, v148
    v_cvt_f32_u32 v73, v73
    v_sub_f32 v148, v161, v73
    v_mul_f32 v148, v148, v148 clamp
    v_fmac_f32 v205, s22, v148
    v_sub_f32 v148, v164, v73
    v_mul_f32 v148, v148, v148 clamp
    v_fmac_f32 v193, s22, v148
    v_sub_f32 v148, v75, v73
    v_mul_f32 v148, v148, v148 clamp
    v_fmac_f32 v181, s22, v148
    v_mad_u32_u24 v73, v160, 12, 2
    v_mul_u32_u24 v148, 37, v73
    v_lshrrev_b32 v72, 8, v148
    v_mad_i32_i24 v72, v72, -7, v73
    v_lshrrev_b32 v148, 10, v148
    v_lshrrev_b32 v72, 2, v72
    v_mul_u32_u24 v148, s20, v148
    v_mad_u32_u24 v73, v72, s21, v148
    v_cvt_f32_u32 v73, v73
    v_sub_f32 v148, v161, v73
    v_mul_f32 v148, v148, v148 clamp
    v_fmac_f32 v206, s22, v148
    v_sub_f32 v148, v164, v73
    v_mul_f32 v148, v148, v148 clamp
    v_fmac_f32 v194, s22, v148
    v_sub_f32 v148, v75, v73
    v_mul_f32 v148, v148, v148 clamp
    v_fmac_f32 v182, s22, v148
    v_mad_u32_u24 v73, v160, 12, 3
    v_mul_u32_u24 v148, 37, v73
    v_lshrrev_b32 v72, 8, v148
    v_mad_i32_i24 v72, v72, -7, v73
    v_lshrrev_b32 v148, 10, v148
    v_lshrrev_b32 v72, 2, v72
    v_mul_u32_u24 v148, s20, v148
    v_mad_u32_u24 v73, v72, s21, v148
    v_cvt_f32_u32 v73, v73
    v_sub_f32 v148, v161, v73
    v_mul_f32 v148, v148, v148 clamp
    v_fmac_f32 v207, s22, v148
    v_sub_f32 v148, v164, v73
    v_mul_f32 v148, v148, v148 clamp
    v_fmac_f32 v195, s22, v148
    v_sub_f32 v148, v75, v73
    v_mul_f32 v148, v148, v148 clamp
    v_fmac_f32 v183, s22, v148
    v_mad_u32_u24 v73, v160, 12, 4
    v_mul_u32_u24 v148, 37, v73
    v_lshrrev_b32 v72, 8, v148
    v_mad_i32_i24 v72, v72, -7, v73
    v_lshrrev_b32 v148, 10, v148
    v_lshrrev_b32 v72, 2, v72
    v_mul_u32_u24 v148, s20, v148
    v_mad_u32_u24 v73, v72, s21, v148
    v_cvt_f32_u32 v73, v73
    v_sub_f32 v148, v161, v73
    v_mul_f32 v148, v148, v148 clamp
    v_fmac_f32 v200, s22, v148
    v_sub_f32 v148, v164, v73
    v_mul_f32 v148, v148, v148 clamp
    v_fmac_f32 v188, s22, v148
    v_sub_f32 v148, v75, v73
    v_mul_f32 v148, v148, v148 clamp
    v_fmac_f32 v176, s22, v148
    v_mad_u32_u24 v73, v160, 12, 5
    v_mul_u32_u24 v148, 37, v73
    v_lshrrev_b32 v72, 8, v148
    v_mad_i32_i24 v72, v72, -7, v73
    v_lshrrev_b32 v148, 10, v148
    v_lshrrev_b32 v72, 2, v72
    v_mul_u32_u24 v148, s20, v148
    v_mad_u32_u24 v73, v72, s21, v148
    v_cvt_f32_u32 v73, v73
    v_sub_f32 v148, v161, v73
    v_mul_f32 v148, v148, v148 clamp
    v_fmac_f32 v201, s22, v148
    v_sub_f32 v148, v164, v73
    v_mul_f32 v148, v148, v148 clamp
    v_fmac_f32 v189, s22, v148
    v_sub_f32 v148, v75, v73
    v_mul_f32 v148, v148, v148 clamp
    v_fmac_f32 v177, s22, v148
    v_mad_u32_u24 v73, v160, 12, 6
    v_mul_u32_u24 v148, 37, v73
    v_lshrrev_b32 v72, 8, v148
    v_mad_i32_i24 v72, v72, -7, v73
    v_lshrrev_b32 v148, 10, v148
    v_lshrrev_b32 v72, 2, v72
    v_mul_u32_u24 v148, s20, v148
    v_mad_u32_u24 v73, v72, s21, v148
    v_cvt_f32_u32 v73, v73
    v_sub_f32 v148, v161, v73
    v_mul_f32 v148, v148, v148 clamp
    v_fmac_f32 v202, s22, v148
    v_sub_f32 v148, v164, v73
    v_mul_f32 v148, v148, v148 clamp
    v_fmac_f32 v190, s22, v148
    v_sub_f32 v148, v75, v73
    v_mul_f32 v148, v148, v148 clamp
    v_fmac_f32 v178, s22, v148
    v_mad_u32_u24 v73, v160, 12, 7
    v_mul_u32_u24 v148, 37, v73
    v_lshrrev_b32 v72, 8, v148
    v_mad_i32_i24 v72, v72, -7, v73
    v_lshrrev_b32 v148, 10, v148
    v_lshrrev_b32 v72, 2, v72
    v_mul_u32_u24 v148, s20, v148
    v_mad_u32_u24 v73, v72, s21, v148
    v_cvt_f32_u32 v73, v73
    v_sub_f32 v148, v161, v73
    v_mul_f32 v148, v148, v148 clamp
    v_fmac_f32 v203, s22, v148
    v_sub_f32 v148, v164, v73
    v_mul_f32 v148, v148, v148 clamp
    v_fmac_f32 v191, s22, v148
    v_sub_f32 v148, v75, v73
    v_mul_f32 v148, v148, v148 clamp
    v_fmac_f32 v179, s22, v148
    v_mad_u32_u24 v73, v160, 12, 8
    v_mul_u32_u24 v148, 37, v73
    v_lshrrev_b32 v72, 8, v148
    v_mad_i32_i24 v72, v72, -7, v73
    v_lshrrev_b32 v148, 10, v148
    v_lshrrev_b32 v72, 2, v72
    v_mul_u32_u24 v148, s20, v148
    v_mad_u32_u24 v73, v72, s21, v148
    v_cvt_f32_u32 v73, v73
    v_sub_f32 v148, v161, v73
    v_mul_f32 v148, v148, v148 clamp
    v_fmac_f32 v196, s22, v148
    v_sub_f32 v148, v164, v73
    v_mul_f32 v148, v148, v148 clamp
    v_fmac_f32 v184, s22, v148
    v_sub_f32 v148, v75, v73
    v_mul_f32 v148, v148, v148 clamp
    v_fmac_f32 v172, s22, v148
    v_mad_u32_u24 v73, v160, 12, 9
    v_mul_u32_u24 v148, 37, v73
    v_lshrrev_b32 v72, 8, v148
    v_mad_i32_i24 v72, v72, -7, v73
    v_lshrrev_b32 v148, 10, v148
    v_lshrrev_b32 v72, 2, v72
    v_mul_u32_u24 v148, s20, v148
    v_mad_u32_u24 v73, v72, s21, v148
    v_cvt_f32_u32 v73, v73
    v_sub_f32 v148, v161, v73
    v_mul_f32 v148, v148, v148 clamp
    v_fmac_f32 v197, s22, v148
    v_sub_f32 v148, v164, v73
    v_mul_f32 v148, v148, v148 clamp
    v_fmac_f32 v185, s22, v148
    v_sub_f32 v148, v75, v73
    v_mul_f32 v148, v148, v148 clamp
    v_fmac_f32 v173, s22, v148
    v_mad_u32_u24 v73, v160, 12, 10
    v_mul_u32_u24 v148, 37, v73
    v_lshrrev_b32 v72, 8, v148
    v_mad_i32_i24 v72, v72, -7, v73
    v_lshrrev_b32 v148, 10, v148
    v_lshrrev_b32 v72, 2, v72
    v_mul_u32_u24 v148, s20, v148
    v_mad_u32_u24 v73, v72, s21, v148
    v_cvt_f32_u32 v73, v73
    v_sub_f32 v148, v161, v73
    v_mul_f32 v148, v148, v148 clamp
    v_fmac_f32 v198, s22, v148
    v_sub_f32 v148, v164, v73
    v_mul_f32 v148, v148, v148 clamp
    v_fmac_f32 v186, s22, v148
    v_sub_f32 v148, v75, v73
    v_mul_f32 v148, v148, v148 clamp
    v_fmac_f32 v174, s22, v148
    v_mad_u32_u24 v73, v160, 12, 11
    v_mul_u32_u24 v148, 37, v73
    v_lshrrev_b32 v72, 8, v148
    v_mad_i32_i24 v72, v72, -7, v73
    v_lshrrev_b32 v148, 10, v148
    v_lshrrev_b32 v72, 2, v72
    v_mul_u32_u24 v148, s20, v148
    v_mad_u32_u24 v73, v72, s21, v148
    v_cvt_f32_u32 v73, v73
    v_sub_f32 v148, v161, v73
    v_mul_f32 v148, v148, v148 clamp
    v_fmac_f32 v199, s22, v148
    v_sub_f32 v148, v164, v73
    v_mul_f32 v148, v148, v148 clamp
    v_fmac_f32 v187, s22, v148
    v_sub_f32 v148, v75, v73
    v_mul_f32 v148, v148, v148 clamp
    v_fmac_f32 v175, s22, v148
    v_cvt_f32_u32 v73, s74
    v_sub_f32 v148, v161, v73
    v_mul_f32 v148, v148, v148 clamp
    v_fmac_f32 v208, s22, v148
    v_sub_f32 v148, v164, v73
    v_mul_f32 v148, v148, v148 clamp
    v_fmac_f32 v209, s22, v148
    v_sub_f32 v148, v75, v73
    v_mul_f32 v148, v148, v148 clamp
    v_fmac_f32 v210, s22, v148
    v_lshrrev_b32 v161, 2, v149
    v_lshl_add_u32 v161, v160, 2, v161
    v_add_u32 v148, 1, v160
    v_lshrrev_b32 v148, 2, v148
    v_mad_u32_u24 v161, v148, 36, v161
    v_min_u32 v161, 48, v161
    v_mul_u32_u24 v148, 37, v161
    v_lshrrev_b32 v72, 8, v148
    v_mad_i32_i24 v72, v72, -7, v161
    v_lshrrev_b32 v148, 10, v148
    v_lshrrev_b32 v72, 2, v72
    v_mul_u32_u24 v148, s20, v148
    v_mad_u32_u24 v161, v72, s21, v148
    v_cvt_f32_u32 v161, v161
    v_sub_f32 v148, v161, v73
    v_mul_f32 v148, v148, v148 clamp
    v_fmac_f32 v211, s22, v148
    s_branch L_nomaskS
L_atomS0:
    v_mov_b32 v122, 0x800000
    buffer_atomic_add v122, v129, s[8:11], 0 offen sc0 sc1
    s_branch L_atomS0r
.section .rodata,"a"
.p2align 6
.amdhsa_kernel standalone__window_attn_swin_v2__vision_kernel
  .amdhsa_next_free_vgpr 512
  .amdhsa_next_free_sgpr 102
  .amdhsa_accum_offset 256
  .amdhsa_group_segment_fixed_size 0
  .amdhsa_kernarg_size 96
  .amdhsa_user_sgpr_count 2
  .amdhsa_user_sgpr_kernarg_segment_ptr 1
  .amdhsa_system_sgpr_workgroup_id_x 1
.end_amdhsa_kernel
```

```asm
; @launch grid=(256,1,1) block=(256,1,1) lds=163840
.amdgcn_target "amdgcn-amd-amdhsa--gfx950"
.text
.globl standalone__window_attn_swin_v2__vision_kernel
.p2align 8
.type standalone__window_attn_swin_v2__vision_kernel,@function
standalone__window_attn_swin_v2__vision_kernel:
    v_lshrrev_b32 v0, 6, v0
    s_cmp_ge_u32 s2, 256
    s_cbranch_scc1 L_end
    v_readfirstlane_b32 s68, v0
L_top:
    s_mov_b32 s64, 0
    s_nop 0
L_top2:
    v_mbcnt_lo_u32_b32 v97, -1, 0
    v_mbcnt_hi_u32_b32 v97, -1, v97
    s_load_dwordx16 s[4:19], s[0:1], 0
    s_load_dwordx4 s[20:23], s[0:1], 64
    s_load_dwordx2 s[38:39], s[0:1], 80
    s_load_dwordx2 s[76:77], s[0:1], 88
    s_add_u32 s84, s2, s64
    s_sub_u32 s84, s84, 248
    s_cmp_lt_u32 s84, 3
    s_cbranch_scc1 L_prod
    s_bfe_u32 s88, s2, 0x50003
    s_lshl2_add_u32 s88, s88, s68
    v_lshlrev_b32 v98, 7, v97
    s_getpc_b64 s[80:81]
    s_mul_i32 s84, s88, 320
    v_min_u32 v96, 256, v98
    v_add_u32 v96, s84, v96
    v_min_u32 v96, L_slow-standalone__window_attn_swin_v2__vision_kernel-256, v96
    s_mul_i32 s88, s88, 1728
    s_mov_b32 s34, 221184
    global_load_dword a255, v96, s[80:81]
    v_min_u32 v1, 1664, v98
    s_mov_b32 s35, 0x20000
    s_mov_b32 s78, 73728
    s_mov_b32 s79, 0x20000
    v_and_b32 v123, 15, v97
    v_lshrrev_b32 v3, 4, v97
    v_lshrrev_b32 v35, 2, v123
    v_and_b32 v34, 3, v123
    s_mul_i32 s87, s68, 192
    v_mad_u32_u24 v19, v123, 12, s87
    v_lshlrev_b32 v0, 1, v123
    v_lshlrev_b32 v2, 1, v35
    v_lshl_add_u32 v2, v3, 5, v2
    s_movk_i32 s86, 384
    s_mov_b32 s26, 100270464
    s_mov_b32 s27, 0x20000
    s_mov_b32 s30, 0
    s_mov_b32 s31, 0x20000
    s_lshr_b32 s93, s2, 3
    s_mul_i32 s93, s93, 3185912
    s_min_u32 s44, s93, 100270460
    s_add_u32 s93, s93, 2097152
    s_min_u32 s45, s93, 100270460
    s_add_u32 s93, s93, 2097152
    s_min_u32 s46, s93, 100270460
    s_waitcnt lgkmcnt(0)
    s_load_dword s44, s[4:5], s44
    s_load_dword s45, s[4:5], s45
    s_load_dword s46, s[4:5], s46
    s_mov_b32 s24, s4
    s_mov_b32 s25, s5
    s_mov_b32 s32, s6
    s_mov_b32 s33, s7
    buffer_load_dword a254, v1, s[32:35], s88 offen
    s_load_dwordx2 s[82:83], s[10:11], 0
    s_movk_i32 s18, 676
    s_mov_b32 s19, 0x20000
    buffer_load_dwordx3 v[24:26], v19, s[16:19], 0 offen
    s_mul_i32 s96, s68, 288
    s_and_b32 s97, s68, 1
    s_lshl_b32 s97, s97, 2
    s_mov_b32 s98, 193536
    s_mov_b32 s99, 589824
    global_load_ushort v16, v0, s[12:13]
    v_add_u32 v32, s96, v97
    v_mul_u32_u24 v1, 2731, v32
    v_mul_u32_u24 v96, 6242, v32
    v_lshrrev_b32 v1, 16, v1
    v_lshrrev_b32 v96, 20, v96
    s_lshr_b32 s94, s2, 3
    s_mul_i32 s70, s94, 167
    global_load_ushort v17, v0, s[12:13] offset:32
    v_and_or_b32 v27, v1, 3, s97
    v_xor_b32 v27, v32, v27
    v_lshl_add_u32 v128, v27, 4, s99
    v_mad_u32_u24 v128, v96, s98, v128
    v_add_u32 v33, 64, v32
    s_min_u32 s95, s94, 7
    s_add_u32 s70, s70, s95
    global_load_ushort v136, v2, s[14:15] offset:0
    v_mul_u32_u24 v105, 2731, v33
    v_mul_u32_u24 v0, 6242, v33
    v_lshrrev_b32 v105, 16, v105
    v_lshrrev_b32 v0, 20, v0
    v_and_or_b32 v18, v105, 3, s97
    s_and_b32 s95, s2, 7
    s_mul_i32 s95, s95, 20
    global_load_ushort v121, v2, s[14:15] offset:8
    v_xor_b32 v18, v33, v18
    v_lshl_add_u32 v127, v18, 4, s99
    v_mad_u32_u24 v127, v0, s98, v127
    v_add_u32 v122, 128, v32
    v_mul_u32_u24 v120, 2731, v122
    s_add_u32 s69, s70, s95
    s_add_u32 s70, s70, 140
    global_load_ushort v137, v2, s[14:15] offset:16
    v_mul_u32_u24 v104, 6242, v122
    v_lshrrev_b32 v120, 16, v120
    v_lshrrev_b32 v104, 20, v104
    v_and_or_b32 v33, v120, 3, s97
    v_xor_b32 v33, v122, v33
    s_movk_i32 s62, 2688
    s_movk_i32 s71, 20
    global_load_ushort v2, v2, s[14:15] offset:24
    v_lshl_add_u32 v126, v33, 4, s99
    v_mad_u32_u24 v126, v104, s98, v126
    v_add_u32 v106, 192, v32
    v_mul_u32_u24 v99, 2731, v106
    v_mul_u32_u24 v98, 6242, v106
    v_lshrrev_b32 v99, 16, v99
    v_lshrrev_b32 v98, 20, v98
    v_and_or_b32 v122, v99, 3, s97
    v_xor_b32 v122, v106, v122
    v_lshl_add_u32 v125, v122, 4, s99
    v_mad_u32_u24 v125, v98, s98, v125
    v_add_u32 v106, 256, v32
    v_mul_u32_u24 v32, 2731, v106
    v_mul_u32_u24 v122, 6242, v106
    v_lshrrev_b32 v32, 16, v32
    v_lshrrev_b32 v122, 20, v122
    v_and_or_b32 v124, v32, 3, s97
    v_xor_b32 v124, v106, v124
    v_lshl_add_u32 v124, v124, 4, s99
    v_mad_u32_u24 v124, v122, s98, v124
    s_cmp_lt_u32 s94, 7
    s_cselect_b32 s73, 28, 27
    s_mov_b32 s93, 1769472
    s_mul_i32 s54, s68, 5120
    s_cmp_ge_u32 s2, 248
    s_cbranch_scc1 L_bndF
L_bndrF:
    s_mov_b32 s63, 1180032
    s_mul_i32 s94, s69, 58255
    s_lshr_b32 s94, s94, 22
    s_mul_i32 s94, s94, s63
    s_mul_i32 s72, s69, s62
    s_add_u32 s72, s72, s94
    v_lshl_or_b32 v131, v97, 4, 2.0
    s_sub_u32 s94, s73, 1
    s_max_u32 s94, s94, 20
    s_mul_i32 s95, s68, -44
    s_movk_i32 s99, -24
    s_add_u32 m0, s54, 0
    v_and_b32 v32, -4, v120
    s_mul_i32 s85, s68, 96
    s_sub_u32 s100, s85, 1024
    buffer_load_dwordx4 v128, s[24:27], s72 offen nt lds
    s_add_u32 m0, s54, 1024
    v_mad_u32_u24 v0, v32, 3, v120
    v_add_u32 v0, s95, v0
    v_mad_i32_i24 v106, v120, s99, v33
    v_med3_u32 v32, v0, 20, s94
    v_add_u32 v32, s70, v32
    v_add_u32 v33, s69, v0
    s_sub_u32 s87, s85, 2048
    s_movk_i32 s91, 1152
    buffer_load_dwordx4 v127, s[24:27], s72 offen nt lds
    v_cmp_gt_u32 vcc, s71, v0
    v_lshl_add_u32 v106, v106, 4, s93
    s_add_u32 m0, s54, 43008
    v_cndmask_b32 v33, v32, v33, vcc
    v_mul_u32_u24 v32, 58255, v33
    v_mad_u32_u24 v106, v33, s62, v106
    v_lshrrev_b32 v32, 22, v32
    v_mad_u32_u24 v106, v32, s63, v106
    s_mul_i32 s90, s68, 3072
    s_add_u32 s90, s90, 61440
    buffer_load_dwordx4 v106, s[24:27], 0 offen  lds
    v_lshlrev_b32 v107, 16, v0
    s_add_u32 m0, s54, 2048
    v_and_b32 v104, -4, v105
    v_mad_u32_u24 v0, v104, 3, v105
    v_add_u32 v0, s95, v0
    v_mad_i32_i24 v105, v105, s99, v18
    v_med3_u32 v104, v0, 20, s94
    s_mov_b32 s28, s22
    s_mov_b32 s29, s23
    buffer_load_dwordx4 v126, s[24:27], s72 offen nt lds
    v_add_u32 v104, s70, v104
    v_add_u32 v18, s69, v0
    v_cmp_gt_u32 vcc, s71, v0
    v_lshl_add_u32 v105, v105, 4, s93
    s_add_u32 m0, s54, 41984
    v_cndmask_b32 v18, v104, v18, vcc
    v_mul_u32_u24 v104, 58255, v18
    v_mad_u32_u24 v105, v18, s62, v105
    v_lshrrev_b32 v104, 22, v104
    v_mad_u32_u24 v105, v104, s63, v105
    s_mov_b32 s41, 0x2a8cbccc
    s_mov_b32 s42, 0x38fba882
    buffer_load_dwordx4 v105, s[24:27], 0 offen  lds
    v_lshl_or_b32 v107, v0, 8, v107
    s_add_u32 m0, s54, 3072
    v_cmp_gt_u32 vcc, 32, v97
    v_and_b32 v0, -4, v1
    v_mad_u32_u24 v18, v0, 3, v1
    v_cndmask_b32 v124, v131, v124, vcc
    v_add_u32 v18, s95, v18
    s_mov_b32 s43, 0x415db3d7
    s_mov_b32 s30, 100270464
    buffer_load_dwordx4 v125, s[24:27], s72 offen nt lds
    s_add_u32 m0, s54, 4096
    v_mad_i32_i24 v104, v1, s99, v27
    v_med3_u32 v0, v18, 20, s94
    v_add_u32 v0, s70, v0
    v_add_u32 v27, s69, v18
    v_cmp_gt_u32 vcc, s71, v18
    v_lshl_add_u32 v104, v104, 4, s93
    s_add_u32 s101, s54, 44032
    s_mul_i32 s93, s68, 6
    buffer_load_dwordx4 v124, s[24:27], s72 offen nt lds
    v_cndmask_b32 v27, v0, v27, vcc
    v_mul_u32_u24 v0, 58255, v27
    v_mad_u32_u24 v104, v27, s62, v104
    v_lshrrev_b32 v0, 22, v0
    v_mad_u32_u24 v104, v0, s63, v104
    s_add_u32 m0, s54, 40960
    v_lshl_or_b32 v107, v18, 0, v107
    s_lshl_b32 s94, s97, 1
    s_mov_b32 s57, s72
    buffer_load_dwordx4 v104, s[24:27], 0 offen nt lds
    v_mul_u32_u24 v0, 10923, v97
    v_lshrrev_b32 v1, 17, v0
    v_lshrrev_b32 v0, 16, v0
    v_mad_i32_i24 v18, v0, -6, v97
    v_bitop3_b32 v1, v1, v0, 4 bitop3:0x28
    v_lshl_add_u32 v18, v18, 4, s85
    v_mul_u32_u24 v1, 3, v1
    v_xor_b32 v0, v0, v1
    v_mad_u32_u24 v1, v0, s91, v18
    v_add_u32 v27, 64, v97
    v_mul_u32_u24 v18, 10923, v27
    v_lshrrev_b32 v0, 17, v18
    v_lshrrev_b32 v18, 16, v18
    v_mad_i32_i24 v27, v18, -6, v27
    v_bitop3_b32 v0, v0, v18, 4 bitop3:0x28
    v_lshl_add_u32 v27, v27, 4, s100
    v_mul_u32_u24 v0, 3, v0
    v_xor_b32 v18, v18, v0
    v_mad_u32_u24 v0, v18, s91, v27
    v_add_u32 v18, 128, v97
    v_mul_u32_u24 v27, 10923, v18
    v_lshrrev_b32 v33, 17, v27
    v_lshrrev_b32 v27, 16, v27
    v_mad_i32_i24 v18, v27, -6, v18
    v_bitop3_b32 v33, v33, v27, 4 bitop3:0x28
    v_lshl_add_u32 v18, v18, 4, s87
    v_mul_u32_u24 v33, 3, v33
    v_xor_b32 v27, v27, v33
    v_mad_u32_u24 v33, v27, s91, v18
    s_add_u32 m0, s90, 0
    s_mov_b32 s92, 0
    buffer_load_dwordx4 v1, s[32:35], s92 offen offset:0 lds
    v_lshrrev_b32 v27, 1, v3
    v_lshl_add_u32 v18, v3, 2, v35
    v_lshl_add_u32 v18, v27, 3, v18
    v_mul_u32_u24 v18, 96, v18
    v_add_u32 v18, s90, v18
    v_lshl_add_u32 v120, v34, 4, v18
    v_lshl_add_u32 v91, v34, 3, v18
    s_waitcnt lgkmcnt(0)
    s_sext_i32_i16 s84, s82
    s_ashr_i32 s85, s82, 16
    s_max_i32 s84, s84, s85
    s_sext_i32_i16 s85, s83
    s_max_i32 s84, s84, s85
    s_ashr_i32 s85, s83, 16
    s_max_i32 s84, s84, s85
    s_cmp_gt_i32 s84, 16492
    s_cbranch_scc1 L_slow
    s_lshl_b32 s84, s68, 4
    buffer_load_dwordx4 v0, s[32:35], s92 offen offset:1024 lds
    s_lshr_b64 s[82:83], s[82:83], s84
    s_lshl_b32 s82, s82, 16
    v_mov_b32 v32, s82
    v_min_f32 v32, 0x40930000, v32
    v_max_f32 v32, 0xc2c80000, v32
    v_mul_f32 v32, 0x3fb8aa3b, v32
    v_exp_f32 v32, v32
    s_mov_b32 s84, 0x41b8aa3b
    s_mov_b32 s44, 61440
    buffer_load_dwordx4 v33, s[32:35], s92 offen offset:2048 lds
    s_add_u32 m0, s90, 12288
    s_mov_b32 s92, 36864
    v_cvt_pk_bf16_f32 v32, v32, v32
    v_lshlrev_b32 v32, 16, v32
    v_mul_f32 v32, 0x4038aa3b, v32
    v_mov_b32 v18, 0
    v_readfirstlane_b32 s55, v32
    v_add_f32 v32, v32, v32
    v_mov_b32 v27, 0
    v_readfirstlane_b32 s52, v32
    v_mul_u32_u24 v32, 5120, v3
    v_add_u32 v32, v19, v32
    v_mov_b32 v187, 0xc138aa3b
    v_mul_u32_u24 v4, 48, v35
    v_lshl_add_u32 v4, v34, 2, v4
    v_mul_u32_u24 v90, 48, v3
    v_add_u32 v199, 0, v4
    v_mul_u32_u24 v19, 37, v199
    v_lshrrev_b32 v19, 10, v19
    v_mad_u32_u24 v199, v19, 24, v199
    v_add_u32 v199, s101, v199
    v_add_u32 v5, 16, v4
    v_mul_u32_u24 v19, 37, v5
    v_lshrrev_b32 v19, 10, v19
    v_mad_u32_u24 v5, v19, 24, v5
    v_add_u32 v5, s101, v5
    v_add_u32 v175, 32, v4
    v_mul_u32_u24 v19, 37, v175
    v_lshrrev_b32 v19, 10, v19
    v_mad_u32_u24 v175, v19, 24, v175
    v_add_u32 v175, s101, v175
    v_add_u32 v138, 0, v90
    v_mul_u32_u24 v19, 37, v138
    v_lshrrev_b32 v19, 10, v19
    v_mad_u32_u24 v138, v19, 24, v138
    v_add_u32 v139, 4, v90
    v_mul_u32_u24 v19, 37, v139
    v_lshrrev_b32 v19, 10, v19
    v_mad_u32_u24 v139, v19, 24, v139
    v_add_u32 v89, 8, v90
    v_mul_u32_u24 v19, 37, v89
    v_lshrrev_b32 v19, 10, v19
    v_mad_u32_u24 v89, v19, 24, v89
    v_add_u32 v195, 12, v90
    v_mul_u32_u24 v19, 37, v195
    v_lshrrev_b32 v19, 10, v19
    v_mad_u32_u24 v195, v19, 24, v195
    v_add_u32 v88, 16, v90
    v_mul_u32_u24 v19, 37, v88
    v_lshrrev_b32 v19, 10, v19
    v_mad_u32_u24 v88, v19, 24, v88
    v_add_u32 v7, 20, v90
    v_mul_u32_u24 v6, 37, v7
    v_lshrrev_b32 v6, 10, v6
    v_mad_u32_u24 v7, v6, 24, v7
    v_add_u32 v6, 24, v90
    v_mul_u32_u24 v19, 37, v6
    v_lshrrev_b32 v19, 10, v19
    v_mad_u32_u24 v6, v19, 24, v6
    v_add_u32 v184, 28, v90
    s_mov_b32 s45, 40960
    s_mov_b32 s46, 20480
    buffer_load_dwordx4 v1, s[32:35], s92 offen offset:0 lds
    v_mul_u32_u24 v19, 37, v184
    v_lshrrev_b32 v19, 10, v19
    v_mad_u32_u24 v184, v19, 24, v184
    v_add_u32 v209, 32, v90
    v_mul_u32_u24 v19, 37, v209
    v_lshrrev_b32 v19, 10, v19
    v_mad_u32_u24 v209, v19, 24, v209
    s_mov_b32 s47, 0
    s_mov_b32 s58, 0
    buffer_load_dwordx4 v0, s[32:35], s92 offen offset:1024 lds
    s_waitcnt vmcnt(17)
    v_lshl_or_b32 v16, v17, 16, v16
    v_cmp_gt_u32 vcc, 16, v97
    v_mov_b32 v17, 0
    v_add_u32 v185, 36, v90
    v_cndmask_b32 v19, 0, v16, vcc
    v_cndmask_b32 v16, 0, v16, vcc
    v_mul_u32_u24 v186, 37, v185
    v_mfma_f32_16x16x16_bf16 v[8:11], v[18:19], v[24:25], 0
    s_waitcnt vmcnt(15)
    s_mov_b32 s59, 0
    v_lshl_or_b32 v136, v121, 16, v136
    v_lshrrev_b32 v186, 10, v186
    v_mfma_f32_16x16x16_bf16 v[12:15], v[16:17], v[24:25], 0
    s_mov_b32 s60, 0
    v_mad_u32_u24 v185, v186, 24, v185
    v_add_u32 v186, 40, v90
    v_mfma_f32_16x16x16_bf16 v[20:23], v[16:17], v[26:27], 0
    s_waitcnt vmcnt(13)
    s_mov_b32 s65, -1
    buffer_load_dwordx4 v33, s[32:35], s92 offen offset:2048 lds
    v_lshl_or_b32 v137, v2, 16, v137
    v_max_f32 v8, 0, v8
    v_max_f32 v12, 0, v12
    s_add_u32 m0, s90, 24576
    s_mov_b32 s92, 73728
    v_max_f32 v13, 0, v13
    v_max_f32 v14, 0, v14
    v_max_f32 v15, 0, v15
    v_cvt_pk_bf16_f32 v12, v12, v13
    v_cvt_pk_bf16_f32 v13, v14, v15
    v_max_f32 v9, 0, v9
    v_max_f32 v10, 0, v10
    v_mfma_f32_16x16x16_bf16 v[16:19], v[136:137], v[12:13], 0
    s_mov_b32 s61, 1
    v_max_f32 v11, 0, v11
    v_cvt_pk_bf16_f32 v8, v8, v9
    v_cvt_pk_bf16_f32 v9, v10, v11
    v_max_f32 v20, 0, v20
    v_max_f32 v21, 0, v21
    v_mfma_f32_16x16x16_bf16 v[12:15], v[136:137], v[8:9], 0
    s_movk_i32 s4, 112
    v_max_f32 v22, 0, v22
    v_max_f32 v23, 0, v23
    v_cvt_pk_bf16_f32 v20, v20, v21
    v_cvt_pk_bf16_f32 v21, v22, v23
    v_cvt_pk_bf16_f32 v16, v16, v16
    v_lshlrev_b32 v16, 16, v16
    v_mfma_f32_16x16x16_bf16 v[8:11], v[136:137], v[20:21], 0
    s_mov_b32 s5, 0
    v_mul_f32 v16, 0xbfb8aa3b, v16
    v_cvt_pk_bf16_f32 v12, v12, v12
    v_exp_f32 v16, v16
    v_lshlrev_b32 v12, 16, v12
    v_add_f32 v16, 1.0, v16
    v_rcp_f32 v16, v16
    v_mul_f32 v12, 0xbfb8aa3b, v12
    v_cvt_pk_bf16_f32 v16, v16, v16
    v_lshlrev_b32 v16, 16, v16
    v_fma_f32 v16, v16, s84, v187
    s_mov_b32 s6, 0
    s_mov_b32 s12, 0
    ds_write_b32 v32, v16 offset:44032
    v_exp_f32 v12, v12
    v_cvt_pk_bf16_f32 v8, v8, v8
    v_add_f32 v12, 1.0, v12
    v_rcp_f32 v12, v12
    v_lshlrev_b32 v8, 16, v8
    v_cvt_pk_bf16_f32 v12, v12, v12
    v_lshlrev_b32 v12, 16, v12
    v_fma_f32 v12, v12, s84, v187
    s_mov_b32 s64, 3
    s_mov_b32 s10, 81924
    ds_write_b32 v32, v12 offset:44036
    v_mul_f32 v8, 0xbfb8aa3b, v8
    v_exp_f32 v8, v8
    v_mul_u32_u24 v2, 37, v186
    v_add_f32 v8, 1.0, v8
    v_rcp_f32 v8, v8
    v_lshrrev_b32 v2, 10, v2
    v_cvt_pk_bf16_f32 v8, v8, v8
    v_lshlrev_b32 v8, 16, v8
    v_fma_f32 v8, v8, s84, v187
    s_mov_b32 s11, 0x20000
    s_mov_b32 s3, 0x00010001
    ds_write_b32 v32, v8 offset:44040
    v_mad_u32_u24 v186, v2, 24, v186
    v_add_u32 v187, 44, v90
    v_mul_u32_u24 v2, 37, v187
    v_lshrrev_b32 v2, 10, v2
    v_mad_u32_u24 v187, v2, 24, v187
    v_lshl_add_u32 v211, v3, 4, v4
    v_mul_u32_u24 v2, 37, v211
    v_lshrrev_b32 v2, 10, v2
    v_mad_u32_u24 v211, v2, 24, v211
    v_mov_b32 v90, 336
    v_cmp_gt_u32 vcc, 3, v3
    v_mov_b32 v32, 0x3f803f80
    v_and_b32 v2, 1, v97
    v_cndmask_b32 v211, v90, v211, vcc
    v_sub_u32 v211, s101, v211
    v_cmp_eq_u32 vcc, 0, v34
    v_lshlrev_b32 v2, 4, v2
    v_mov_b32 v90, 0x3f80
    v_cndmask_b32 v220, 0, v32, vcc
    v_cndmask_b32 v221, 0, v32, vcc
    v_cndmask_b32 v222, 0, v32, vcc
    v_cndmask_b32 v223, 0, v32, vcc
    v_lshlrev_b32 v90, v2, v90
    v_cmp_gt_u32 vcc, 2, v34
    v_mov_b32 v130, 0x44004400
    v_mov_b32 v2, 0xf149f2ca
    v_cndmask_b32 v216, 0, v90, vcc
    v_cndmask_b32 v218, 0, v90, vcc
    v_cmp_le_u32 vcc, 2, v34
    v_mul_u32_u24 v32, 5120, v35
    v_mad_u32_u24 v32, v34, s86, v32
    v_cndmask_b32 v217, 0, v90, vcc
    v_cndmask_b32 v219, 0, v90, vcc
    s_waitcnt lgkmcnt(0)
    s_barrier
    v_cmp_eq_u32 vcc, 0, v34
    v_and_b32 v129, 7, v123
    v_xor_b32 v122, v129, v3
    v_cndmask_b32 v212, 0, v130, vcc
    v_cmp_eq_u32 vcc, 1, v34
    v_lshl_add_u32 v90, v122, 4, v32
    v_xor_b32 v121, 64, v90
    v_cndmask_b32 v213, 0, v130, vcc
    v_cmp_eq_u32 vcc, 2, v34
    v_add_u32 v137, 40960, v90
    v_xor_b32 v136, 64, v137
    v_cndmask_b32 v214, 0, v130, vcc
    v_cmp_eq_u32 vcc, 3, v34
    v_add_u32 v32, 61440, v32
    v_add_u32 v122, s93, v3
    v_cndmask_b32 v215, 0, v130, vcc
    v_xor_b32 v122, v129, v122
    v_lshl_add_u32 v135, v122, 4, v32
    v_lshrrev_b32 v122, 1, v3
    v_add3_u32 v122, v122, s93, 4
    v_xor_b32 v122, v129, v122
    v_lshl_add_u32 v122, v122, 4, v32
    v_and_b32 v32, 1, v3
    v_lshl_add_u32 v134, v32, 3, v122
    v_lshlrev_b32 v32, 4, v97
    s_add_u32 s93, s54, 20480
    v_add_u32 v133, s93, v32
    v_add_u32 v129, 81920, v32
    s_lshr_b32 s93, s68, 1
    s_lshl_b32 s93, s93, 10
    s_add_u32 s93, s93, s94
    ds_read_b32 v210, v175
    v_add_u32 v130, s93, v129
    s_mul_i32 s93, s68, 7168
    s_add_u32 s93, s93, 135168
    v_mul_u32_u24 v32, 1792, v3
    v_add_u32 v122, s93, v32
    v_mul_u32_u24 v32, 112, v123
    v_add_u32 v38, v32, v122
    v_subrev_u32 v38, 28672, v38
    v_cmp_eq_u32 vcc, 0, v35
    v_add_u32 v32, 16, v122
    v_mov_b32 v123, 0
    buffer_load_dwordx4 v1, s[32:35], s92 offen offset:0 lds
    ds_read_b32 v208, v199
    v_cndmask_b32 v132, v131, v122, vcc
    v_cmp_eq_u32 vcc, 3, v34
    v_mov_b32 v122, 0
    v_sub_u32 v180, v175, v138
    v_cndmask_b32 v132, v132, v32, vcc
    v_mul_u32_u24 v32, 1792, v35
    v_lshl_add_u32 v32, v3, 3, v32
    v_lshl_add_u32 v32, v34, 1, v32
    v_add_u32 v32, s93, v32
    v_cmp_gt_u32 vcc, 3, v3
    s_add_u32 s93, s69, 1
    s_mul_i32 s94, s93, 58255
    ds_read_b32 v180, v180 offset:336
    v_cndmask_b32 v131, v131, v32, vcc
    s_lshr_b32 s94, s94, 22
    s_mul_i32 s94, s94, s63
    s_mul_i32 s56, s93, s62
    s_add_u32 s56, s56, s94
    s_sub_u32 s93, s71, 1
    s_cmp_eq_u32 s68, 0
    buffer_load_dwordx4 v0, s[32:35], s92 offen offset:1024 lds
    s_cselect_b32 s13, s93, -1
    s_cmp_gt_u32 s73, 20
    s_cselect_b32 s13, s13, -1
    s_and_b32 s93, s2, -8
    s_sub_u32 s93, 81920, s93
    s_sub_u32 s8, s38, s93
    s_subb_u32 s9, s39, 0
    ds_read_b32 v211, v211 offset:672
    v_sub_u32 v181, v175, v139
    v_sub_u32 v182, v175, v89
    v_sub_u32 v183, v175, v195
    buffer_load_dwordx4 v33, s[32:35], s92 offen offset:2048 lds
    s_add_u32 m0, s90, 36864
    s_mov_b32 s92, 110592
    ds_read_b32 v181, v181 offset:336
    v_sub_u32 v176, v175, v88
    v_sub_u32 v177, v175, v7
    v_sub_u32 v178, v175, v6
    v_sub_u32 v179, v175, v184
    v_sub_u32 v172, v175, v209
    ds_read_b32 v182, v182 offset:336
    v_sub_u32 v173, v175, v185
    v_sub_u32 v174, v175, v186
    v_sub_u32 v175, v175, v187
    v_sub_u32 v204, v199, v138
    v_sub_u32 v205, v199, v139
    ds_read_b32 v183, v183 offset:336
    v_sub_u32 v206, v199, v89
    v_sub_u32 v207, v199, v195
    buffer_load_dwordx4 v1, s[32:35], s92 offen offset:0 lds
    ds_read_b32 v176, v176 offset:336
    v_sub_u32 v200, v199, v88
    v_sub_u32 v201, v199, v7
    v_sub_u32 v202, v199, v6
    v_sub_u32 v203, v199, v184
    v_sub_u32 v196, v199, v209
    ds_read_b32 v177, v177 offset:336
    s_mov_b64 exec, 0
    s_cmp_eq_u32 s68, 2
    s_cbranch_scc1 L_pga
    s_cmp_eq_u32 s68, 3
    s_cbranch_scc1 L_pg2
    s_cmp_eq_u32 s68, 1
    s_cbranch_scc1 L_pg1
    s_branch L_pg0
L_prod:
    v_mbcnt_lo_u32_b32 v1, -1, 0
    v_mbcnt_hi_u32_b32 v1, -1, v1
    v_and_b32 v2, 15, v1
    v_lshrrev_b32 v3, 4, v1
    v_lshrrev_b32 v4, 2, v2
    v_and_b32 v5, 3, v2
    v_lshl_add_u32 v6, v4, 3, v5
    v_mul_u32_u24 v6, 384, v6
    s_lshr_b32 s85, s68, 1
    s_lshl1_add_u32 s84, s84, s85
    s_mul_i32 s85, s84, 12288
    v_add_u32 v6, s85, v6
    v_lshl_add_u32 v7, v3, 4, v6
    v_lshl_add_u32 v8, v3, 3, v6
    s_and_b32 s85, s68, 1
    s_mul_i32 s86, s85, 192
    s_sub_u32 s87, 192, s86
    s_mul_i32 s85, s85, 36
    s_add_u32 s85, s85, s84
    s_lshl_b32 s85, s85, 10
    v_lshl_add_u32 v18, v1, 4, s85
    v_mov_b32 v10, 0
    s_waitcnt lgkmcnt(0)
    s_mov_b32 s10, 73728
    s_mov_b32 s11, 0x20000
    s_mov_b32 s78, 73728
    s_mov_b32 s79, 0x20000
    buffer_load_dwordx4 v[20:23], v7, s[8:11], s86 offen offset:0
    buffer_load_dwordx2 v[36:37], v8, s[8:11], s86 offen offset:64
    buffer_load_dwordx4 v[24:27], v7, s[8:11], s86 offen offset:96
    buffer_load_dwordx2 v[38:39], v8, s[8:11], s86 offen offset:160
    buffer_load_dwordx4 v[28:31], v7, s[8:11], s87 offen offset:0
    buffer_load_dwordx2 v[40:41], v8, s[8:11], s87 offen offset:64
    buffer_load_dwordx4 v[32:35], v7, s[8:11], s87 offen offset:96
    buffer_load_dwordx2 v[42:43], v8, s[8:11], s87 offen offset:160
    buffer_load_dwordx4 v[44:47], v7, s[8:11], s86 offen offset:1536
    buffer_load_dwordx2 v[60:61], v8, s[8:11], s86 offen offset:1600
    buffer_load_dwordx4 v[48:51], v7, s[8:11], s86 offen offset:1632
    buffer_load_dwordx2 v[62:63], v8, s[8:11], s86 offen offset:1696
    buffer_load_dwordx4 v[52:55], v7, s[8:11], s87 offen offset:1536
    buffer_load_dwordx2 v[64:65], v8, s[8:11], s87 offen offset:1600
    buffer_load_dwordx4 v[56:59], v7, s[8:11], s87 offen offset:1632
    buffer_load_dwordx2 v[66:67], v8, s[8:11], s87 offen offset:1696
    s_add_u32 s88, s76, 0x18000
    s_addc_u32 s89, s77, 0
    global_load_dword v9, v10, s[88:89]
    global_load_dword v19, v10, s[38:39] offset:248 sc1
    v_mov_b32 v12, 0x3f803f80
    v_mov_b32 v13, 0x3f803f80
    v_mov_b32 v14, 0x3f803f80
    v_mov_b32 v15, 0x3f803f80
    v_and_b32 v10, 1, v1
    v_lshlrev_b32 v10, 4, v10
    v_mov_b32 v11, 0x3f80
    v_lshlrev_b32 v10, v10, v11
    v_cmp_eq_u32 vcc, v3, v4
    s_nop 1
    v_cndmask_b32 v10, 0, v10, vcc
    v_cmp_gt_u32 vcc, 2, v5
    s_nop 1
    v_cndmask_b32 v16, 0, v10, vcc
    v_cmp_le_u32 vcc, 2, v5
    s_nop 1
    v_cndmask_b32 v17, 0, v10, vcc
    s_waitcnt vmcnt(2)
    v_mfma_f32_16x16x32_bf16 v[68:71], v[20:23], v[12:15], 0
    v_mfma_f32_16x16x32_bf16 v[68:71], v[24:27], v[12:15], v[68:71]
    v_mfma_f32_16x16x32_bf16 v[68:71], v[28:31], v[12:15], v[68:71]
    v_mfma_f32_16x16x32_bf16 v[68:71], v[32:35], v[12:15], v[68:71]
    v_mfma_f32_16x16x32_bf16 v[68:71], v[36:39], v[12:15], v[68:71]
    v_mfma_f32_16x16x32_bf16 v[68:71], v[40:43], v[12:15], v[68:71]
    v_mfma_f32_16x16x32_bf16 v[72:75], v[44:47], v[12:15], 0
    v_mfma_f32_16x16x32_bf16 v[72:75], v[48:51], v[12:15], v[72:75]
    v_mfma_f32_16x16x32_bf16 v[72:75], v[52:55], v[12:15], v[72:75]
    v_mfma_f32_16x16x32_bf16 v[72:75], v[56:59], v[12:15], v[72:75]
    v_mfma_f32_16x16x32_bf16 v[72:75], v[60:63], v[12:15], v[72:75]
    v_mfma_f32_16x16x32_bf16 v[72:75], v[64:67], v[12:15], v[72:75]
    s_nop 1
    v_mul_f32 v68, 0xbbaaaaab, v68
    v_mul_f32 v69, 0xbbaaaaab, v69
    v_mul_f32 v70, 0xbbaaaaab, v70
    v_mul_f32 v71, 0xbbaaaaab, v71
    s_nop 1
    v_mfma_f32_16x16x16_bf16 v[76:79], v[20:21], v[16:17], v[68:71]
    v_mfma_f32_16x16x16_bf16 v[80:83], v[22:23], v[16:17], v[68:71]
    v_mfma_f32_16x16x16_bf16 v[84:87], v[36:37], v[16:17], v[68:71]
    v_mfma_f32_16x16x16_bf16 v[88:91], v[24:25], v[16:17], v[68:71]
    v_mfma_f32_16x16x16_bf16 v[92:95], v[26:27], v[16:17], v[68:71]
    v_mfma_f32_16x16x16_bf16 v[96:99], v[38:39], v[16:17], v[68:71]
    v_mul_f32 v72, 0xbbaaaaab, v72
    v_mul_f32 v73, 0xbbaaaaab, v73
    v_mul_f32 v74, 0xbbaaaaab, v74
    v_mul_f32 v75, 0xbbaaaaab, v75
    s_nop 1
    v_mfma_f32_16x16x16_bf16 v[100:103], v[44:45], v[16:17], v[72:75]
    v_mfma_f32_16x16x16_bf16 v[104:107], v[46:47], v[16:17], v[72:75]
    v_mfma_f32_16x16x16_bf16 v[108:111], v[60:61], v[16:17], v[72:75]
    v_mfma_f32_16x16x16_bf16 v[112:115], v[48:49], v[16:17], v[72:75]
    v_mfma_f32_16x16x16_bf16 v[116:119], v[50:51], v[16:17], v[72:75]
    v_mfma_f32_16x16x16_bf16 v[120:123], v[62:63], v[16:17], v[72:75]
    v_cvt_pk_bf16_f32 v124, v76, v77
    v_cvt_pk_bf16_f32 v125, v78, v79
    s_nop 0
    v_cvt_pk_bf16_f32 v126, v100, v101
    v_cvt_pk_bf16_f32 v127, v102, v103
    s_movk_i32 s85, 0
    buffer_store_dwordx4 v[124:127], v18, s[76:79], s85 offen sc1
    v_cvt_pk_bf16_f32 v128, v80, v81
    v_cvt_pk_bf16_f32 v129, v82, v83
    v_cvt_pk_bf16_f32 v130, v104, v105
    v_cvt_pk_bf16_f32 v131, v106, v107
    s_movk_i32 s85, 6144
    buffer_store_dwordx4 v[128:131], v18, s[76:79], s85 offen sc1
    v_cvt_pk_bf16_f32 v132, v84, v85
    v_cvt_pk_bf16_f32 v133, v86, v87
    v_cvt_pk_bf16_f32 v134, v108, v109
    v_cvt_pk_bf16_f32 v135, v110, v111
    s_movk_i32 s85, 12288
    buffer_store_dwordx4 v[132:135], v18, s[76:79], s85 offen sc1
    v_cvt_pk_bf16_f32 v136, v88, v89
    v_cvt_pk_bf16_f32 v137, v90, v91
    v_cvt_pk_bf16_f32 v138, v112, v113
    v_cvt_pk_bf16_f32 v139, v114, v115
    s_movk_i32 s85, 18432
    buffer_store_dwordx4 v[136:139], v18, s[76:79], s85 offen sc1
    v_cvt_pk_bf16_f32 v140, v92, v93
    v_cvt_pk_bf16_f32 v141, v94, v95
    v_cvt_pk_bf16_f32 v142, v116, v117
    v_cvt_pk_bf16_f32 v143, v118, v119
    s_movk_i32 s85, 24576
    buffer_store_dwordx4 v[140:143], v18, s[76:79], s85 offen sc1
    v_cvt_pk_bf16_f32 v144, v96, v97
    v_cvt_pk_bf16_f32 v145, v98, v99
    v_cvt_pk_bf16_f32 v146, v120, v121
    v_cvt_pk_bf16_f32 v147, v122, v123
    s_movk_i32 s85, 30720
    buffer_store_dwordx4 v[144:147], v18, s[76:79], s85 offen sc1
    v_mov_b32 v10, 0
    v_mov_b32 v11, 1
    s_mov_b32 s64, 8
    s_waitcnt vmcnt(0)
    s_barrier
    s_cmp_lg_u32 s68, 0
    s_cbranch_scc1 L_top2
    s_mov_b64 exec, 1
    global_atomic_add v10, v11, s[38:39] offset:248 sc1
    s_mov_b64 exec, -1
    s_branch L_top2
.p2align 12
L_main:
    s_mov_b64 exec, -1
    s_waitcnt vmcnt(10)
    s_barrier
    v_sub_u32 v197, v199, v185
    v_sub_u32 v198, v199, v186
    v_sub_u32 v199, v199, v187
    v_sub_u32 v192, v5, v138
    ds_read_b128 v[12:15], v90 offset:40960
    v_sub_u32 v193, v5, v139
    v_sub_u32 v194, v5, v89
    v_sub_u32 v195, v5, v195
    ds_read_b128 v[8:11], v90 offset:42496
    v_sub_u32 v188, v5, v88
    v_sub_u32 v189, v5, v7
    v_sub_u32 v190, v5, v6
    ds_read_b128 v[24:27], v90 offset:0
    buffer_load_dwordx4 v0, s[32:35], s92 offen offset:1024 lds
    v_sub_u32 v191, v5, v184
    v_sub_u32 v184, v5, v209
    ds_read_b128 v[16:19], v90 offset:1536
    v_sub_u32 v185, v5, v185
    v_sub_u32 v186, v5, v186
    v_sub_u32 v187, v5, v187
    ds_read_b128 v[44:47], v90 offset:3072
    ds_read_b32 v178, v178 offset:336
    buffer_load_dwordx4 v33, s[32:35], s92 offen offset:2048 lds
    s_add_u32 m0, s90, 49152
    s_mov_b32 s92, 147456
    ds_read_b32 v179, v179 offset:336
    ds_read_b32 v172, v172 offset:336
    ds_read_b32 v173, v173 offset:336
    buffer_load_dwordx4 v1, s[32:35], s92 offen offset:0 lds
    s_waitcnt vmcnt(10)
    ds_read_b64_tr_b16 a[0:1], v91 offset:0
    ds_read_b64_tr_b16 a[2:3], v91 offset:768
    ds_read_b64_tr_b16 a[24:25], v91 offset:32
    ds_read_b64_tr_b16 a[26:27], v91 offset:800
    ds_read_b64_tr_b16 a[48:49], v91 offset:64
    ds_read_b64_tr_b16 a[50:51], v91 offset:832
    ds_read_b32 v174, v174 offset:336
    ds_read_b32 v175, v175 offset:336
    buffer_load_dwordx4 v0, s[32:35], s92 offen offset:1024 lds
    ds_read_b32 v204, v204 offset:336
    ds_read_b32 v205, v205 offset:336
    ds_read_b32 v206, v206 offset:336
    s_waitcnt lgkmcnt(8)
    v_mfma_f32_16x16x32_bf16 v[68:71], a[0:3], v[12:15], 0
    s_waitcnt lgkmcnt(7)
    buffer_load_dwordx4 v33, s[32:35], s92 offen offset:2048 lds
    v_mfma_f32_16x16x32_bf16 v[64:67], a[24:27], v[12:15], 0
    s_waitcnt lgkmcnt(5)
    s_add_u32 m0, s90, 61440
    ds_read_b32 v207, v207 offset:336
    v_mfma_f32_16x16x32_bf16 v[56:59], a[48:51], v[12:15], 0
    s_mov_b32 s92, 184320
    v_mfma_f32_16x16x32_bf16 v[40:43], a[0:3], v[8:11], 0
    ds_read_b128 v[48:51], v121 offset:40960
    v_mfma_f32_16x16x32_bf16 v[12:15], a[24:27], v[8:11], 0
    ds_read_b32 v200, v200 offset:336
    v_mfma_f32_16x16x32_bf16 v[28:31], a[48:51], v[8:11], 0
    buffer_load_dwordx4 v1, s[32:35], s92 offen offset:0 lds
    v_mfma_f32_16x16x32_bf16 v[20:23], a[0:3], v[24:27], 0
    s_waitcnt vmcnt(10)
    ds_read_b64_tr_b16 a[4:5], v91 offset:12288
    v_mfma_f32_16x16x32_bf16 v[116:119], a[24:27], v[24:27], 0
    ds_read_b64_tr_b16 a[6:7], v91 offset:13056
    v_mfma_f32_16x16x32_bf16 v[8:11], a[48:51], v[24:27], 0
    ds_read_b64_tr_b16 a[28:29], v91 offset:12320
    v_mfma_f32_16x16x32_bf16 v[108:111], a[0:3], v[16:19], 0
    ds_read_b64_tr_b16 a[30:31], v91 offset:13088
    v_mfma_f32_16x16x32_bf16 v[60:63], a[24:27], v[16:19], 0
    buffer_load_dwordx4 v0, s[32:35], s92 offen offset:1024 lds
    ds_read_b64_tr_b16 a[52:53], v91 offset:12352
    v_mfma_f32_16x16x32_bf16 v[72:75], a[48:51], v[16:19], 0
    ds_read_b64_tr_b16 a[54:55], v91 offset:13120
    v_mfma_f32_16x16x32_bf16 v[92:95], a[0:3], v[44:47], 0
    ds_read_b128 v[24:27], v121 offset:42496
    v_mfma_f32_16x16x32_bf16 v[168:171], a[24:27], v[44:47], 0
    ds_read_b128 v[16:19], v121 offset:0
    v_mfma_f32_16x16x32_bf16 v[140:143], a[48:51], v[44:47], 0
    s_waitcnt lgkmcnt(6)
    ds_read_b128 v[52:55], v121 offset:1536
    buffer_load_dwordx4 v33, s[32:35], s92 offen offset:2048 lds
    s_add_u32 m0, s90, 0
    s_mov_b32 s92, 384
    v_mfma_f32_16x16x32_bf16 v[68:71], a[4:7], v[48:51], v[68:71]
    s_waitcnt lgkmcnt(5)
    ds_read_b128 v[44:47], v121 offset:3072
    ds_read_b32 v201, v201 offset:336
    v_mfma_f32_16x16x32_bf16 v[64:67], a[28:31], v[48:51], v[64:67]
    s_waitcnt lgkmcnt(5)
    ds_read_b32 v202, v202 offset:336
    v_mfma_f32_16x16x32_bf16 v[56:59], a[52:55], v[48:51], v[56:59]
    s_waitcnt vmcnt(9) lgkmcnt(5)
    buffer_load_dwordx4 v1, s[32:35], s92 offen offset:0 lds
    ds_read_b64_tr_b16 a[8:9], v91 offset:24576
    v_mfma_f32_16x16x32_bf16 v[40:43], a[4:7], v[24:27], v[40:43]
    ds_read_b64_tr_b16 a[10:11], v91 offset:25344
    v_mfma_f32_16x16x32_bf16 v[12:15], a[28:31], v[24:27], v[12:15]
    ds_read_b64_tr_b16 a[32:33], v91 offset:24608
    v_mfma_f32_16x16x32_bf16 v[28:31], a[52:55], v[24:27], v[28:31]
    s_waitcnt lgkmcnt(6)
    ds_read_b64_tr_b16 a[34:35], v91 offset:25376
    v_mfma_f32_16x16x32_bf16 v[20:23], a[4:7], v[16:19], v[20:23]
    ds_read_b64_tr_b16 a[56:57], v91 offset:24640
    v_mfma_f32_16x16x32_bf16 v[116:119], a[28:31], v[16:19], v[116:119]
    buffer_load_dwordx4 v0, s[32:35], s92 offen offset:1024 lds
    ds_read_b64_tr_b16 a[58:59], v91 offset:25408
    v_mfma_f32_16x16x32_bf16 v[8:11], a[52:55], v[16:19], v[8:11]
    ds_read_b128 v[48:51], v90 offset:41088
    v_mfma_f32_16x16x32_bf16 v[108:111], a[4:7], v[52:55], v[108:111]
    ds_read_b128 v[24:27], v90 offset:42624
    v_mfma_f32_16x16x32_bf16 v[60:63], a[28:31], v[52:55], v[60:63]
    ds_read_b128 v[16:19], v90 offset:128
    v_mfma_f32_16x16x32_bf16 v[72:75], a[52:55], v[52:55], v[72:75]
    s_waitcnt lgkmcnt(8)
    ds_read_b128 v[52:55], v90 offset:1664
    v_mfma_f32_16x16x32_bf16 v[92:95], a[4:7], v[44:47], v[92:95]
    buffer_load_dwordx4 v33, s[32:35], s92 offen offset:2048 lds
    ds_read_b32 v203, v203 offset:336
    v_mfma_f32_16x16x32_bf16 v[168:171], a[28:31], v[44:47], v[168:171]
    s_add_u32 m0, s90, 12288
    v_mfma_f32_16x16x32_bf16 v[140:143], a[52:55], v[44:47], v[140:143]
    s_mov_b32 s92, 37248
    ds_read_b128 v[44:47], v90 offset:3200
    ds_read_b32 v196, v196 offset:336
    ds_read_b32 v197, v197 offset:336
    s_waitcnt lgkmcnt(7)
    v_mfma_f32_16x16x32_bf16 v[68:71], a[8:11], v[48:51], v[68:71]
    buffer_load_dwordx4 v1, s[32:35], s92 offen offset:0 lds
    v_mfma_f32_16x16x32_bf16 v[64:67], a[32:35], v[48:51], v[64:67]
    s_waitcnt vmcnt(10)
    ds_read_b64_tr_b16 a[12:13], v91 offset:36864
    v_mfma_f32_16x16x32_bf16 v[56:59], a[56:59], v[48:51], v[56:59]
    s_waitcnt lgkmcnt(5)
    ds_read_b64_tr_b16 a[14:15], v91 offset:37632
    v_mfma_f32_16x16x32_bf16 v[40:43], a[8:11], v[24:27], v[40:43]
    ds_read_b64_tr_b16 a[36:37], v91 offset:36896
    v_mfma_f32_16x16x32_bf16 v[12:15], a[32:35], v[24:27], v[12:15]
    ds_read_b64_tr_b16 a[38:39], v91 offset:37664
    v_mfma_f32_16x16x32_bf16 v[28:31], a[56:59], v[24:27], v[28:31]
    buffer_load_dwordx4 v0, s[32:35], s92 offen offset:1024 lds
    ds_read_b64_tr_b16 a[60:61], v91 offset:36928
    v_mfma_f32_16x16x32_bf16 v[20:23], a[8:11], v[16:19], v[20:23]
    ds_read_b64_tr_b16 a[62:63], v91 offset:37696
    v_mfma_f32_16x16x32_bf16 v[116:119], a[32:35], v[16:19], v[116:119]
    ds_read_b128 v[24:27], v121 offset:41088
    v_mfma_f32_16x16x32_bf16 v[8:11], a[56:59], v[16:19], v[8:11]
    ds_read_b128 v[16:19], v121 offset:42624
    v_mfma_f32_16x16x32_bf16 v[108:111], a[8:11], v[52:55], v[108:111]
    ds_read_b128 v[48:51], v121 offset:128
    v_mfma_f32_16x16x32_bf16 v[60:63], a[32:35], v[52:55], v[60:63]
    buffer_load_dwordx4 v33, s[32:35], s92 offen offset:2048 lds
    ds_read_b32 v198, v198 offset:336
    v_mfma_f32_16x16x32_bf16 v[72:75], a[56:59], v[52:55], v[72:75]
    s_waitcnt lgkmcnt(8)
    s_add_u32 m0, s90, 24576
    v_mfma_f32_16x16x32_bf16 v[92:95], a[8:11], v[44:47], v[92:95]
    s_mov_b32 s92, 74112
    ds_read_b128 v[52:55], v121 offset:1664
    v_mfma_f32_16x16x32_bf16 v[168:171], a[32:35], v[44:47], v[168:171]
    ds_read_b32 v199, v199 offset:336
    v_mfma_f32_16x16x32_bf16 v[140:143], a[56:59], v[44:47], v[140:143]
    s_waitcnt vmcnt(9) lgkmcnt(5)
    buffer_load_dwordx4 v1, s[32:35], s92 offen offset:0 lds
    ds_read_b64_tr_b16 a[16:17], v91 offset:49152
    ds_read_b64_tr_b16 a[18:19], v91 offset:49920
    v_mfma_f32_16x16x32_bf16 v[68:71], a[12:15], v[24:27], v[68:71]
    ds_read_b64_tr_b16 a[40:41], v91 offset:49184
    v_mfma_f32_16x16x32_bf16 v[64:67], a[36:39], v[24:27], v[64:67]
    ds_read_b64_tr_b16 a[42:43], v91 offset:49952
    v_mfma_f32_16x16x32_bf16 v[56:59], a[60:63], v[24:27], v[56:59]
    s_waitcnt lgkmcnt(7)
    ds_read_b64_tr_b16 a[64:65], v91 offset:49216
    v_mfma_f32_16x16x32_bf16 v[40:43], a[12:15], v[16:19], v[40:43]
    ds_read_b64_tr_b16 a[66:67], v91 offset:49984
    buffer_load_dwordx4 v0, s[32:35], s92 offen offset:1024 lds
    v_mfma_f32_16x16x32_bf16 v[12:15], a[36:39], v[16:19], v[12:15]
    ds_read_b128 v[44:47], v121 offset:3200
    v_mfma_f32_16x16x32_bf16 v[28:31], a[60:63], v[16:19], v[28:31]
    ds_read_b128 v[24:27], v90 offset:41216
    v_mfma_f32_16x16x32_bf16 v[20:23], a[12:15], v[48:51], v[20:23]
    ds_read_b128 v[16:19], v90 offset:42752
    v_mfma_f32_16x16x32_bf16 v[116:119], a[36:39], v[48:51], v[116:119]
    ds_read_b32 v192, v192 offset:336
    v_mfma_f32_16x16x32_bf16 v[8:11], a[60:63], v[48:51], v[8:11]
    s_waitcnt lgkmcnt(8)
    buffer_load_dwordx4 v33, s[32:35], s92 offen offset:2048 lds
    v_mfma_f32_16x16x32_bf16 v[108:111], a[12:15], v[52:55], v[108:111]
    s_add_u32 m0, s90, 36864
    ds_read_b128 v[48:51], v90 offset:256
    v_mfma_f32_16x16x32_bf16 v[60:63], a[36:39], v[52:55], v[60:63]
    s_mov_b32 s92, 110976
    ds_read_b32 v193, v193 offset:336
    v_mfma_f32_16x16x32_bf16 v[72:75], a[60:63], v[52:55], v[72:75]
    s_waitcnt lgkmcnt(5)
    ds_read_b128 v[52:55], v90 offset:1792
    ds_read_b32 v194, v194 offset:336
    v_mfma_f32_16x16x32_bf16 v[92:95], a[12:15], v[44:47], v[92:95]
    buffer_load_dwordx4 v1, s[32:35], s92 offen offset:0 lds
    v_mfma_f32_16x16x32_bf16 v[168:171], a[36:39], v[44:47], v[168:171]
    s_waitcnt vmcnt(10)
    ds_read_b64_tr_b16 a[20:21], v91 offset:61440
    v_mfma_f32_16x16x32_bf16 v[140:143], a[60:63], v[44:47], v[140:143]
    s_waitcnt lgkmcnt(5)
    ds_read_b64_tr_b16 a[22:23], v91 offset:62208
    v_mfma_f32_16x16x32_bf16 v[68:71], a[16:19], v[24:27], v[68:71]
    ds_read_b64_tr_b16 a[44:45], v91 offset:61472
    v_mfma_f32_16x16x32_bf16 v[64:67], a[40:43], v[24:27], v[64:67]
    ds_read_b64_tr_b16 a[46:47], v91 offset:62240
    v_mfma_f32_16x16x32_bf16 v[56:59], a[64:67], v[24:27], v[56:59]
    buffer_load_dwordx4 v0, s[32:35], s92 offen offset:1024 lds
    ds_read_b64_tr_b16 a[68:69], v91 offset:61504
    v_mfma_f32_16x16x32_bf16 v[40:43], a[16:19], v[16:19], v[40:43]
    ds_read_b64_tr_b16 a[70:71], v91 offset:62272
    v_mfma_f32_16x16x32_bf16 v[12:15], a[40:43], v[16:19], v[12:15]
    ds_read_b128 v[44:47], v90 offset:3328
    v_mfma_f32_16x16x32_bf16 v[28:31], a[64:67], v[16:19], v[28:31]
    s_waitcnt lgkmcnt(7)
    ds_read_b128 v[24:27], v121 offset:41216
    v_mfma_f32_16x16x32_bf16 v[20:23], a[16:19], v[48:51], v[20:23]
    ds_read_b128 v[16:19], v121 offset:42752
    v_mfma_f32_16x16x32_bf16 v[116:119], a[40:43], v[48:51], v[116:119]
    buffer_load_dwordx4 v33, s[32:35], s92 offen offset:2048 lds
    ds_read_b32 v195, v195 offset:336
    v_mfma_f32_16x16x32_bf16 v[8:11], a[64:67], v[48:51], v[8:11]
    s_add_u32 m0, s90, 49152
    v_mfma_f32_16x16x32_bf16 v[108:111], a[16:19], v[52:55], v[108:111]
    s_mov_b32 s92, 147840
    ds_read_b128 v[48:51], v121 offset:256
    v_mfma_f32_16x16x32_bf16 v[60:63], a[40:43], v[52:55], v[60:63]
    ds_read_b32 v188, v188 offset:336
    v_mfma_f32_16x16x32_bf16 v[72:75], a[64:67], v[52:55], v[72:75]
    s_waitcnt vmcnt(9) lgkmcnt(5)
    ds_read_b128 v[52:55], v121 offset:1792
    buffer_load_dwordx4 v1, s[32:35], s92 offen offset:0 lds
    ds_read_b64_tr_b16 a[72:73], v91 offset:0
    v_mfma_f32_16x16x32_bf16 v[92:95], a[16:19], v[44:47], v[92:95]
    ds_read_b64_tr_b16 a[74:75], v91 offset:768
    v_mfma_f32_16x16x32_bf16 v[168:171], a[40:43], v[44:47], v[168:171]
    ds_read_b64_tr_b16 a[96:97], v91 offset:32
    v_mfma_f32_16x16x32_bf16 v[140:143], a[64:67], v[44:47], v[140:143]
    s_waitcnt lgkmcnt(7)
    ds_read_b64_tr_b16 a[98:99], v91 offset:800
    v_mfma_f32_16x16x32_bf16 v[68:71], a[20:23], v[24:27], v[68:71]
    ds_read_b64_tr_b16 a[120:121], v91 offset:64
    v_mfma_f32_16x16x32_bf16 v[64:67], a[44:47], v[24:27], v[64:67]
    s_nop 0
    ds_read_b64_tr_b16 a[122:123], v91 offset:832
    buffer_load_dwordx4 v0, s[32:35], s92 offen offset:1024 lds
    v_mfma_f32_16x16x32_bf16 v[56:59], a[68:71], v[24:27], v[56:59]
    s_nop 0
    ds_read_b128 v[44:47], v121 offset:3328
    v_cvt_pk_f16_f32 v160, v68, v69
    v_mfma_f32_16x16x32_bf16 v[40:43], a[20:23], v[16:19], v[40:43]
    ds_read_b128 v[24:27], v90 offset:40960
    v_cvt_pk_f16_f32 v161, v70, v71
    v_mfma_f32_16x16x32_bf16 v[12:15], a[44:47], v[16:19], v[12:15]
    ds_read_b32 v189, v189 offset:336
    v_pk_fma_f16 v164, v160, v160, s3
    v_mfma_f32_16x16x32_bf16 v[28:31], a[68:71], v[16:19], v[28:31]
    s_waitcnt lgkmcnt(8)
    v_pk_fmac_f16 v164, v161, v161
    v_cvt_pk_f16_f32 v162, v64, v65
    v_mfma_f32_16x16x32_bf16 v[20:23], a[20:23], v[48:51], v[20:23]
    buffer_load_dwordx4 v33, s[32:35], s92 offen offset:2048 lds
    ds_read_b128 v[16:19], v90 offset:42496
    v_mfma_f32_16x16x32_bf16 v[116:119], a[44:47], v[48:51], v[116:119]
    s_add_u32 m0, s90, 61440
    v_cvt_pk_f16_f32 v163, v66, v67
    v_pk_fmac_f16 v164, v162, v162
    v_mfma_f32_16x16x32_bf16 v[8:11], a[68:71], v[48:51], v[8:11]
    s_mov_b32 s92, 184704
    ds_read_b128 v[48:51], v90 offset:0
    v_pk_fmac_f16 v164, v163, v163
    v_mfma_f32_16x16x32_bf16 v[108:111], a[20:23], v[52:55], v[108:111]
    ds_read_b32 v190, v190 offset:336
    v_cvt_pk_f16_f32 v6, v56, v57
    v_mfma_f32_16x16x32_bf16 v[60:63], a[44:47], v[52:55], v[60:63]
    v_cvt_pk_f16_f32 v7, v58, v59
    v_pk_fmac_f16 v164, v6, v6
    v_mfma_f32_16x16x32_bf16 v[72:75], a[68:71], v[52:55], v[72:75]
    s_waitcnt vmcnt(9) lgkmcnt(5)
    ds_read_b64_tr_b16 a[76:77], v91 offset:12288
    buffer_load_dwordx4 v1, s[32:35], s92 offen offset:0 lds
    v_mfma_f32_16x16x32_bf16 v[92:95], a[20:23], v[44:47], v[92:95]
    ds_read_b64_tr_b16 a[78:79], v91 offset:13056
    v_pk_fmac_f16 v164, v7, v7
    v_mfma_f32_16x16x32_bf16 v[168:171], a[44:47], v[44:47], v[168:171]
    ds_read_b64_tr_b16 a[100:101], v91 offset:12320
    v_cvt_pk_f16_f32 v112, v40, v41
    v_mfma_f32_16x16x32_bf16 v[140:143], a[68:71], v[44:47], v[140:143]
    s_waitcnt lgkmcnt(6)
    ds_read_b64_tr_b16 a[102:103], v91 offset:13088
    v_cvt_pk_f16_f32 v113, v42, v43
    v_mfma_f32_16x16x32_bf16 v[156:159], a[72:75], v[24:27], 0
    ds_read_b64_tr_b16 a[124:125], v91 offset:12352
    v_pk_fma_f16 v166, v112, v112, s3
    v_mfma_f32_16x16x32_bf16 v[148:151], a[96:99], v[24:27], 0
    ds_read_b64_tr_b16 a[126:127], v91 offset:13120
    buffer_load_dwordx4 v0, s[32:35], s92 offen offset:1024 lds
    v_mfma_f32_16x16x32_bf16 v[100:103], a[120:123], v[24:27], 0
    s_waitcnt lgkmcnt(7)
    ds_read_b128 v[44:47], v90 offset:1536
    v_pk_fmac_f16 v166, v113, v113
    v_mfma_f32_16x16x32_bf16 v[84:87], a[72:75], v[16:19], 0
    ds_read_b128 v[40:43], v90 offset:3072
    v_cvt_pk_f16_f32 v114, v12, v13
    v_mfma_f32_16x16x32_bf16 v[80:83], a[96:99], v[16:19], 0
    ds_read_b128 v[24:27], v121 offset:40960
    v_cvt_pk_f16_f32 v115, v14, v15
    v_mfma_f32_16x16x32_bf16 v[12:15], a[120:123], v[16:19], 0
    ds_read_b128 v[144:147], v121 offset:42496
    v_pk_fmac_f16 v166, v114, v114
    v_mfma_f32_16x16x32_bf16 v[16:19], a[72:75], v[48:51], 0
    buffer_load_dwordx4 v33, s[32:35], s92 offen offset:2048 lds
    ds_read_b32 v191, v191 offset:336
    v_mfma_f32_16x16x32_bf16 v[228:231], a[96:99], v[48:51], 0
    s_add_u32 m0, s90, 0
    v_pk_fmac_f16 v166, v115, v115
    v_cvt_pk_f16_f32 v88, v28, v29
    v_mfma_f32_16x16x32_bf16 v[224:227], a[120:123], v[48:51], 0
    s_mov_b32 s92, 768
    ds_read_b128 v[64:67], v121 offset:0
    v_cvt_pk_f16_f32 v89, v30, v31
    v_pk_fmac_f16 v166, v88, v88
    v_pk_fmac_f16 v166, v89, v89
    v_cvt_pk_f16_f32 v28, v20, v21
    v_cvt_pk_f16_f32 v29, v22, v23
    v_pk_fma_f16 v248, v28, v28, s3
    v_pk_fmac_f16 v248, v29, v29
    v_cvt_pk_f16_f32 v30, v116, v117
    v_cvt_pk_f16_f32 v31, v118, v119
    v_pk_fmac_f16 v248, v30, v30
    s_waitcnt lgkmcnt(5)
    v_mfma_f32_16x16x32_bf16 v[252:255], a[72:75], v[44:47], 0
    s_waitcnt vmcnt(9)
    ds_read_b64_tr_b16 a[80:81], v91 offset:24576
    buffer_load_dwordx4 v1, s[32:35], s92 offen offset:0 lds
    v_mfma_f32_16x16x32_bf16 v[20:23], a[96:99], v[44:47], 0
    ds_read_b64_tr_b16 a[82:83], v91 offset:25344
    v_pk_fmac_f16 v248, v31, v31
    v_mfma_f32_16x16x32_bf16 v[76:79], a[120:123], v[44:47], 0
    s_waitcnt lgkmcnt(4)
    ds_read_b64_tr_b16 a[104:105], v91 offset:24608
    v_cvt_pk_f16_f32 v152, v8, v9
    v_mfma_f32_16x16x32_bf16 v[56:59], a[72:75], v[40:43], 0
    ds_read_b64_tr_b16 a[106:107], v91 offset:25376
    v_cvt_pk_f16_f32 v153, v10, v11
    v_mfma_f32_16x16x32_bf16 v[156:159], a[76:79], v[24:27], v[156:159]
    ds_read_b64_tr_b16 a[128:129], v91 offset:24640
    v_pk_fmac_f16 v248, v152, v152
    v_mfma_f32_16x16x32_bf16 v[148:151], a[100:103], v[24:27], v[148:151]
    ds_read_b64_tr_b16 a[130:131], v91 offset:25408
    buffer_load_dwordx4 v0, s[32:35], s92 offen offset:1024 lds
    v_mfma_f32_16x16x32_bf16 v[100:103], a[124:127], v[24:27], v[100:103]
    ds_read_b128 v[48:51], v121 offset:1536
    v_pk_fmac_f16 v248, v153, v153
    v_mfma_f32_16x16x32_bf16 v[44:47], a[96:99], v[40:43], 0
    ds_read_b128 v[52:55], v121 offset:3072
    v_cvt_pk_f16_f32 v24, v108, v109
    v_mfma_f32_16x16x32_bf16 v[68:71], a[120:123], v[40:43], 0
    ds_read_b128 v[40:43], v90 offset:41088
    v_cvt_pk_f16_f32 v25, v110, v111
    v_mfma_f32_16x16x32_bf16 v[84:87], a[76:79], v[144:147], v[84:87]
    ds_read_b32 v184, v184 offset:336
    v_pk_fma_f16 v250, v24, v24, s3
    v_mfma_f32_16x16x32_bf16 v[80:83], a[100:103], v[144:147], v[80:83]
    buffer_load_dwordx4 v33, s[32:35], s92 offen offset:2048 lds
    v_pk_fmac_f16 v250, v25, v25
    v_mfma_f32_16x16x32_bf16 v[12:15], a[124:127], v[144:147], v[12:15]
    s_waitcnt lgkmcnt(7)
    s_add_u32 m0, s90, 12288
    ds_read_b128 v[8:11], v90 offset:42624
    v_cvt_pk_f16_f32 v26, v60, v61
    v_mfma_f32_16x16x32_bf16 v[16:19], a[76:79], v[64:67], v[16:19]
    s_mov_b32 s92, 37632
    ds_read_b32 v185, v185 offset:336
    v_cvt_pk_f16_f32 v27, v62, v63
    v_mfma_f32_16x16x32_bf16 v[228:231], a[100:103], v[64:67], v[228:231]
    v_pk_fmac_f16 v250, v26, v26
    v_pk_fmac_f16 v250, v27, v27
    v_mfma_f32_16x16x32_bf16 v[224:227], a[124:127], v[64:67], v[224:227]
    s_waitcnt lgkmcnt(5)
    ds_read_b128 v[64:67], v90 offset:128
    v_cvt_pk_f16_f32 v146, v72, v73
    v_cvt_pk_f16_f32 v147, v74, v75
    v_mfma_f32_16x16x32_bf16 v[252:255], a[76:79], v[48:51], v[252:255]
    s_waitcnt vmcnt(9)
    ds_read_b64_tr_b16 a[84:85], v91 offset:36864
    buffer_load_dwordx4 v1, s[32:35], s92 offen offset:0 lds
    v_mfma_f32_16x16x32_bf16 v[20:23], a[100:103], v[48:51], v[20:23]
    ds_read_b64_tr_b16 a[86:87], v91 offset:37632
    v_pk_fmac_f16 v250, v146, v146
    v_mfma_f32_16x16x32_bf16 v[76:79], a[124:127], v[48:51], v[76:79]
    s_waitcnt lgkmcnt(5)
    ds_read_b64_tr_b16 a[108:109], v91 offset:36896
    v_pk_fmac_f16 v250, v147, v147
    v_mfma_f32_16x16x32_bf16 v[56:59], a[76:79], v[52:55], v[56:59]
    ds_read_b64_tr_b16 a[110:111], v91 offset:37664
    v_cvt_pk_f16_f32 v48, v92, v93
    v_mfma_f32_16x16x32_bf16 v[44:47], a[100:103], v[52:55], v[44:47]
    ds_read_b64_tr_b16 a[132:133], v91 offset:36928
    buffer_load_dwordx4 v0, s[32:35], s92 offen offset:1024 lds
    v_mfma_f32_16x16x32_bf16 v[68:71], a[124:127], v[52:55], v[68:71]
    ds_read_b64_tr_b16 a[134:135], v91 offset:37696
    v_cvt_pk_f16_f32 v49, v94, v95
    v_mfma_f32_16x16x32_bf16 v[156:159], a[80:83], v[40:43], v[156:159]
    ds_read_b128 v[60:63], v90 offset:1664
    v_pk_fma_f16 v32, v48, v48, s3
    v_mfma_f32_16x16x32_bf16 v[148:151], a[104:107], v[40:43], v[148:151]
    ds_read_b128 v[52:55], v90 offset:3200
    v_pk_fmac_f16 v32, v49, v49
    v_mfma_f32_16x16x32_bf16 v[100:103], a[128:131], v[40:43], v[100:103]
    s_waitcnt lgkmcnt(8)
    ds_read_b128 v[40:43], v121 offset:41088
    v_cvt_pk_f16_f32 v50, v168, v169
    v_mfma_f32_16x16x32_bf16 v[84:87], a[80:83], v[8:11], v[84:87]
    ds_read_b32 v186, v186 offset:336
    buffer_load_dwordx4 v33, s[32:35], s92 offen offset:2048 lds
    v_mfma_f32_16x16x32_bf16 v[80:83], a[104:107], v[8:11], v[80:83]
    s_add_u32 m0, s90, 24576
    v_cvt_pk_f16_f32 v51, v170, v171
    v_pk_fmac_f16 v32, v50, v50
    v_mfma_f32_16x16x32_bf16 v[12:15], a[128:131], v[8:11], v[12:15]
    s_mov_b32 s92, 74496
    ds_read_b128 v[8:11], v121 offset:42624
    v_pk_fmac_f16 v32, v51, v51
    v_mfma_f32_16x16x32_bf16 v[16:19], a[80:83], v[64:67], v[16:19]
    ds_read_b32 v187, v187 offset:336
    v_cvt_pk_f16_f32 v140, v140, v141
    v_cvt_pk_f16_f32 v141, v142, v143
    v_pk_fmac_f16 v32, v140, v140
    v_pk_fmac_f16 v32, v141, v141
    v_mfma_f32_16x16x32_bf16 v[228:231], a[104:107], v[64:67], v[228:231]
    ds_read_b32 v209, v5
    v_mov_b32 v34, 0
    v_mfma_f32_16x16x32_bf16 v[224:227], a[128:131], v[64:67], v[224:227]
    s_waitcnt lgkmcnt(6)
    buffer_load_dwordx4 v1, s[32:35], s92 offen offset:0 lds
    v_mov_b32 v35, 0
    v_mfma_f32_16x16x32_bf16 v[252:255], a[80:83], v[60:63], v[252:255]
    s_waitcnt vmcnt(10)
    ds_read_b64_tr_b16 a[88:89], v91 offset:49152
    v_mfma_f32_16x16x32_bf16 v[20:23], a[104:107], v[60:63], v[20:23]
    ds_read_b64_tr_b16 a[90:91], v91 offset:49920
    v_mfma_f32_16x16x32_bf16 v[76:79], a[128:131], v[60:63], v[76:79]
    s_waitcnt lgkmcnt(5)
    ds_read_b64_tr_b16 a[112:113], v91 offset:49184
    v_mfma_f32_16x16x32_bf16 v[56:59], a[80:83], v[52:55], v[56:59]
    ds_read_b64_tr_b16 a[114:115], v91 offset:49952
    v_mfma_f32_16x16x32_bf16 v[44:47], a[104:107], v[52:55], v[44:47]
    ds_read_b64_tr_b16 a[136:137], v91 offset:49216
    buffer_load_dwordx4 v0, s[32:35], s92 offen offset:1024 lds
    v_mfma_f32_16x16x32_bf16 v[68:71], a[128:131], v[52:55], v[68:71]
    ds_read_b64_tr_b16 a[138:139], v91 offset:49984
    v_mfma_f32_16x16x32_bf16 v[156:159], a[84:87], v[40:43], v[156:159]
    ds_read_b128 v[64:67], v121 offset:128
    v_mfma_f32_16x16x32_bf16 v[148:151], a[108:111], v[40:43], v[148:151]
    ds_read_b128 v[52:55], v121 offset:1664
    v_mfma_f32_16x16x32_bf16 v[100:103], a[132:135], v[40:43], v[100:103]
    s_waitcnt lgkmcnt(8)
    ds_read_b128 v[40:43], v121 offset:3200
    v_mfma_f32_16x16x32_bf16 v[84:87], a[84:87], v[8:11], v[84:87]
    buffer_load_dwordx4 v33, s[32:35], s92 offen offset:2048 lds
    ds_read_b128 v[72:75], v121 offset:41216
    v_mfma_f32_16x16x32_bf16 v[80:83], a[108:111], v[8:11], v[80:83]
    s_add_u32 m0, s90, 36864
    s_cmp_ge_u32 s2, 248
    s_cbranch_scc1 L_maskF
L_nomaskF:
    v_mfma_f32_16x16x32_bf16 v[12:15], a[132:135], v[8:11], v[12:15]
    s_waitcnt vmcnt(9)
    s_mov_b32 s92, 111360
    ds_read_b128 v[60:63], v121 offset:42752
    v_readlane_b32 s84, v211, 48
    v_cmp_gt_u32 vcc, 16, v97
    s_nop 0
    ds_read_b128 v[8:11], v121 offset:256
    v_cndmask_b32 v208, v2, v208, vcc
    v_cndmask_b32 v209, v2, v209, vcc
    v_cndmask_b32 v210, v2, v210, vcc
    buffer_load_dwordx4 v1, s[32:35], s92 offen offset:0 lds
    ds_read_b64_tr_b16 a[92:93], v91 offset:61440
    v_cmp_gt_u32 vcc, 49, v97
    s_waitcnt lgkmcnt(6)
    v_mfma_f32_16x16x32_bf16 v[16:19], a[84:87], v[64:67], v[16:19]
    ds_read_b64_tr_b16 a[94:95], v91 offset:62208
    v_cndmask_b32 v211, v2, v211, vcc
    v_mfma_f32_16x16x32_bf16 v[228:231], a[108:111], v[64:67], v[228:231]
    ds_read_b64_tr_b16 a[116:117], v91 offset:61472
    v_mfma_f32_16x16x32_bf16 v[224:227], a[132:135], v[64:67], v[224:227]
    s_waitcnt lgkmcnt(6)
    ds_read_b64_tr_b16 a[118:119], v91 offset:62240
    v_mfma_f32_16x16x32_bf16 v[252:255], a[84:87], v[52:55], v[252:255]
    ds_read_b64_tr_b16 a[140:141], v91 offset:61504
    buffer_load_dwordx4 v0, s[32:35], s92 offen offset:1024 lds
    v_mfma_f32_16x16x32_bf16 v[20:23], a[108:111], v[52:55], v[20:23]
    ds_read_b64_tr_b16 a[142:143], v91 offset:62272
    v_mfma_f32_16x16x32_bf16 v[76:79], a[132:135], v[52:55], v[76:79]
    ds_read_b128 v[64:67], v121 offset:1792
    v_mfma_f32_16x16x32_bf16 v[56:59], a[84:87], v[40:43], v[56:59]
    ds_read_b128 v[52:55], v121 offset:3328
    v_mfma_f32_16x16x32_bf16 v[44:47], a[108:111], v[40:43], v[44:47]
    ds_read_b128 v[108:111], v90 offset:41216
    v_mfma_f32_16x16x32_bf16 v[68:71], a[132:135], v[40:43], v[68:71]
    ds_read_b128 v[92:95], v90 offset:42752
    buffer_load_dwordx4 v33, s[32:35], s92 offen offset:2048 lds
    s_add_u32 m0, s90, 49152
    s_mov_b32 s92, 148224
    ds_read_b128 v[40:43], v90 offset:256
    buffer_load_dwordx4 v1, s[32:35], s92 offen offset:0 lds
    s_waitcnt vmcnt(10)
    ds_read_b64_tr_b16 a[144:145], v120 offset:0
    ds_read_b64_tr_b16 a[146:147], v120 offset:768
    ds_read_b64_tr_b16 a[168:169], v120 offset:8
    s_waitcnt lgkmcnt(5)
    v_mfma_f32_16x16x32_bf16 v[156:159], a[88:91], v[108:111], v[156:159]
    ds_read_b64_tr_b16 a[170:171], v120 offset:776
    v_mfma_f32_16x16x32_bf16 v[156:159], a[92:95], v[72:75], v[156:159]
    s_nop 0
    ds_read_b64_tr_b16 a[192:193], v91 offset:64
    v_mfma_f32_16x16x32_bf16 v[148:151], a[112:115], v[108:111], v[148:151]
    s_nop 0
    buffer_load_dwordx4 v0, s[32:35], s92 offen offset:1024 lds
    ds_read_b64_tr_b16 a[194:195], v91 offset:832
    v_mfma_f32_16x16x32_bf16 v[148:151], a[116:119], v[72:75], v[148:151]
    s_nop 0
    v_cvt_pk_f16_f32 v232, v156, v157
    v_cvt_pk_f16_f32 v233, v158, v159
    v_mfma_f32_16x16x32_bf16 v[100:103], a[136:139], v[108:111], v[100:103]
    v_pk_fma_f16 v165, v232, v232, s3
    v_pk_fmac_f16 v165, v233, v233
    v_mfma_f32_16x16x32_bf16 v[100:103], a[140:143], v[72:75], v[100:103]
    s_waitcnt lgkmcnt(6)
    ds_read_b128 v[72:75], v90 offset:1792
    v_cvt_pk_f16_f32 v234, v148, v149
    v_mfma_f32_16x16x32_bf16 v[84:87], a[88:91], v[92:95], v[84:87]
    v_cvt_pk_f16_f32 v235, v150, v151
    v_pk_fmac_f16 v165, v234, v234
    v_mfma_f32_16x16x32_bf16 v[84:87], a[92:95], v[60:63], v[84:87]
    buffer_load_dwordx4 v33, s[32:35], s92 offen offset:2048 lds
    v_pk_fmac_f16 v165, v235, v235
    v_mfma_f32_16x16x32_bf16 v[80:83], a[112:115], v[92:95], v[80:83]
    s_add_u32 m0, s90, 61440
    v_cvt_pk_f16_f32 v2, v100, v101
    v_cvt_pk_f16_f32 v3, v102, v103
    v_mfma_f32_16x16x32_bf16 v[80:83], a[116:119], v[60:63], v[80:83]
    s_mov_b32 s92, 185088
    v_cvt_pk_f16_f32 v84, v84, v85
    v_cvt_pk_f16_f32 v85, v86, v87
    v_mfma_f32_16x16x32_bf16 v[12:15], a[136:139], v[92:95], v[12:15]
    v_pk_fma_f16 v167, v84, v84, s3
    v_pk_fmac_f16 v167, v85, v85
    v_mfma_f32_16x16x32_bf16 v[12:15], a[140:143], v[60:63], v[12:15]
    ds_read_b128 v[60:63], v90 offset:3328
    v_cvt_pk_f16_f32 v86, v80, v81
    v_mfma_f32_16x16x32_bf16 v[16:19], a[88:91], v[40:43], v[16:19]
    s_waitcnt vmcnt(9)
    buffer_load_dwordx4 v1, s[32:35], s92 offen offset:0 lds
    ds_read_b64_tr_b16 a[148:149], v120 offset:12288
    v_mfma_f32_16x16x32_bf16 v[16:19], a[92:95], v[8:11], v[16:19]
    v_cvt_pk_f16_f32 v87, v82, v83
    v_pk_fmac_f16 v167, v86, v86
    v_mfma_f32_16x16x32_bf16 v[228:231], a[112:115], v[40:43], v[228:231]
    ds_read_b64_tr_b16 a[150:151], v120 offset:13056
    v_pk_fmac_f16 v167, v87, v87
    v_mfma_f32_16x16x32_bf16 v[228:231], a[116:119], v[8:11], v[228:231]
    ds_read_b64_tr_b16 a[172:173], v120 offset:12296
    v_cvt_pk_f16_f32 v102, v12, v13
    v_mfma_f32_16x16x32_bf16 v[224:227], a[136:139], v[40:43], v[224:227]
L_pg0:
    s_cbranch_execz L_main
    ds_read_b64_tr_b16 a[174:175], v120 offset:13064
    v_cvt_pk_f16_f32 v103, v14, v15
    v_mfma_f32_16x16x32_bf16 v[224:227], a[140:143], v[8:11], v[224:227]
    s_waitcnt lgkmcnt(5)
    buffer_load_dwordx4 v0, s[32:35], s92 offen offset:1024 lds
    ds_read_b64_tr_b16 a[196:197], v91 offset:12352
    v_mfma_f32_16x16x32_bf16 v[252:255], a[88:91], v[72:75], v[252:255]
    ds_read_b64_tr_b16 a[198:199], v91 offset:13120
    v_pk_fmac_f16 v167, v102, v102
    v_mfma_f32_16x16x32_bf16 v[252:255], a[92:95], v[64:67], v[252:255]
    ds_read_b128 v[8:11], v90 offset:40960
    v_pk_fmac_f16 v167, v103, v103
    v_mfma_f32_16x16x32_bf16 v[20:23], a[112:115], v[72:75], v[20:23]
    ds_read_b128 v[40:43], v90 offset:0
    v_cvt_pk_f16_f32 v12, v16, v17
    v_mfma_f32_16x16x32_bf16 v[20:23], a[116:119], v[64:67], v[20:23]
    v_cvt_pk_f16_f32 v13, v18, v19
    v_pk_fma_f16 v249, v12, v12, s3
    v_mfma_f32_16x16x32_bf16 v[76:79], a[136:139], v[72:75], v[76:79]
    buffer_load_dwordx4 v33, s[32:35], s92 offen offset:2048 lds
    v_pk_fmac_f16 v249, v13, v13
    v_mfma_f32_16x16x32_bf16 v[76:79], a[140:143], v[64:67], v[76:79]
    s_waitcnt lgkmcnt(6)
    s_add_u32 m0, s54, 20480
    ds_read_b128 v[80:83], v90 offset:1536
    v_cvt_pk_f16_f32 v14, v228, v229
    v_mfma_f32_16x16x32_bf16 v[56:59], a[88:91], v[60:63], v[56:59]
    s_mov_b32 s53, s47
    v_cvt_pk_f16_f32 v15, v230, v231
    v_pk_fmac_f16 v249, v14, v14
    v_mfma_f32_16x16x32_bf16 v[56:59], a[92:95], v[52:55], v[56:59]
    s_mov_b32 s47, s46
    v_pk_fmac_f16 v249, v15, v15
    v_cvt_pk_f16_f32 v154, v224, v225
    v_mfma_f32_16x16x32_bf16 v[44:47], a[112:115], v[60:63], v[44:47]
    s_mov_b32 s46, s45
    ds_read_b128 v[72:75], v90 offset:3072
    v_cvt_pk_f16_f32 v155, v226, v227
    v_mfma_f32_16x16x32_bf16 v[44:47], a[116:119], v[52:55], v[44:47]
    s_waitcnt vmcnt(9)
    s_mov_b32 s45, s44
    ds_read_b64_tr_b16 a[152:153], v120 offset:24576
    buffer_load_dwordx4 v128, s[24:27], s56 offen nt lds
    v_mfma_f32_16x16x32_bf16 v[68:71], a[136:139], v[60:63], v[68:71]
    s_add_u32 m0, s54, 21504
    ds_read_b64_tr_b16 a[154:155], v120 offset:25344
    v_pk_fmac_f16 v249, v154, v154
    v_mfma_f32_16x16x32_bf16 v[68:71], a[140:143], v[52:55], v[68:71]
    s_waitcnt lgkmcnt(4)
    s_mov_b32 s44, s53
    ds_read_b64_tr_b16 a[176:177], v120 offset:24584
    v_pk_fmac_f16 v249, v155, v155
    v_mfma_f32_16x16x32_bf16 v[168:171], a[144:147], v[8:11], 0
    s_sub_u32 s48, s44, s46
    ds_read_b64_tr_b16 a[178:179], v120 offset:25352
    v_cvt_pk_f16_f32 v56, v56, v57
    v_mfma_f32_16x16x32_bf16 v[156:159], a[168:171], v[8:11], 0
    s_sub_u32 s49, s46, s45
    ds_read_b64_tr_b16 a[200:201], v91 offset:24640
    v_cvt_pk_f16_f32 v57, v58, v59
    v_mfma_f32_16x16x32_bf16 v[52:55], a[192:195], v[8:11], 0
    s_sub_u32 s50, s45, s44
    ds_read_b64_tr_b16 a[202:203], v91 offset:25408
    buffer_load_dwordx4 v127, s[24:27], s56 offen nt lds
    ds_read_b128 v[64:67], v121 offset:40960
    v_pk_fma_f16 v33, v56, v56, s3
    s_add_u32 m0, s54, 22528
    v_pk_fmac_f16 v33, v57, v57
    v_mfma_f32_16x16x32_bf16 v[244:247], v[40:43], a[144:147], 0
    s_sub_u32 s51, s46, s47
    ds_read_b128 v[8:11], v121 offset:0
    v_cvt_pk_f16_f32 v58, v44, v45
    v_mfma_f32_16x16x32_bf16 v[16:19], v[40:43], a[168:171], 0
    s_mov_b32 s60, s59
    v_cvt_pk_f16_f32 v59, v46, v47
    v_pk_fmac_f16 v33, v58, v58
    v_pk_fmac_f16 v33, v59, v59
    v_mfma_f32_16x16x32_bf16 v[240:243], v[40:43], a[192:195], 0
    s_waitcnt lgkmcnt(6)
    s_mov_b32 s59, s58
    ds_read_b128 v[44:47], v121 offset:1536
    v_cvt_pk_f16_f32 v142, v68, v69
    v_mfma_f32_16x16x32_bf16 v[60:63], v[80:83], a[144:147], 0
    s_mov_b32 s58, s57
    buffer_load_dwordx4 v126, s[24:27], s56 offen nt lds
    v_cvt_pk_f16_f32 v143, v70, v71
    v_pk_fmac_f16 v33, v142, v142
    v_pk_fmac_f16 v33, v143, v143
    s_add_u32 m0, s54, 23552
    v_pk_fmac_f16 v165, v2, v2
    v_mfma_f32_16x16x32_f16 v[40:43], v[212:215], v[32:35], 0
    s_mov_b32 s57, s56
    v_pk_fmac_f16 v165, v3, v3
    v_add_u32 v137, s48, v137
    v_mfma_f32_16x16x32_bf16 v[68:71], v[80:83], a[168:171], 0
    s_mov_b32 s7, s6
    ds_read_b128 v[32:35], v121 offset:3072
    v_add_u32 v136, s48, v136
    v_mfma_f32_16x16x32_bf16 v[108:111], v[80:83], a[192:195], 0
    s_mov_b32 s6, s5
    v_add_u32 v135, s49, v135
    v_add_u32 v134, s49, v134
    v_mfma_f32_16x16x32_bf16 v[98:101], v[72:75], a[144:147], 0
    s_waitcnt vmcnt(9)
    s_mov_b32 s5, s4
    ds_read_b64_tr_b16 a[156:157], v120 offset:36864
    buffer_load_dwordx4 v125, s[24:27], s56 offen nt lds
    v_mfma_f32_16x16x32_bf16 v[80:83], v[72:75], a[168:171], 0
    s_add_u32 m0, s54, 24576
    ds_read_b64_tr_b16 a[158:159], v120 offset:37632
    v_add_u32 v137, s50, v137
    v_mfma_f32_16x16x32_bf16 v[236:239], v[72:75], a[192:195], 0
    s_waitcnt lgkmcnt(4)
    s_sub_u32 s14, s6, s7
    ds_read_b64_tr_b16 a[180:181], v120 offset:36872
    v_add_u32 v136, s50, v136
    v_mfma_f32_16x16x32_bf16 v[168:171], a[148:151], v[64:67], v[168:171]
    s_add_u32 s61, s61, 1
    ds_read_b64_tr_b16 a[182:183], v120 offset:37640
    v_add_u32 v135, s48, v135
    v_mfma_f32_16x16x32_bf16 v[156:159], a[172:175], v[64:67], v[156:159]
    s_add_u32 s12, s12, 20
    ds_read_b64_tr_b16 a[204:205], v91 offset:36928
    v_add_u32 v134, s48, v134
    v_mfma_f32_16x16x32_bf16 v[52:55], a[196:199], v[64:67], v[52:55]
    s_max_u32 s12, s12, s61
    ds_read_b64_tr_b16 a[206:207], v91 offset:37696
    buffer_load_dwordx4 v124, s[24:27], s56 offen nt lds
    v_mfma_f32_16x16x32_bf16 v[244:247], v[8:11], a[148:151], v[244:247]
    s_cmp_lt_u32 s61, s71
    ds_read_b128 v[72:75], v90 offset:41088
    v_add_u32 v133, s51, v133
    v_mfma_f32_16x16x32_bf16 v[16:19], v[8:11], a[172:175], v[16:19]
    s_cselect_b32 s15, s61, s12
    ds_read_b128 v[64:67], v90 offset:128
    v_add_u32 v132, s14, v132
    v_mfma_f32_16x16x32_bf16 v[240:243], v[8:11], a[196:199], v[240:243]
    s_waitcnt lgkmcnt(8)
    s_cselect_b32 s56, s69, s70
    ds_read_b128 v[92:95], v90 offset:1664
    v_add_u32 v131, s14, v131
    v_mfma_f32_16x16x32_bf16 v[60:63], v[44:47], a[148:151], v[60:63]
    s_add_u32 s56, s56, s15
    v_cvt_pk_f16_f32 v8, v252, v253
    v_cvt_pk_f16_f32 v9, v254, v255
    v_mfma_f32_16x16x32_bf16 v[68:71], v[44:47], a[172:175], v[68:71]
    s_mul_i32 s53, s56, 58255
    buffer_load_dword v96, v126, s[28:31], s72 offen nt
    v_pk_fma_f16 v251, v8, v8, s3
    v_mfma_f32_16x16x32_bf16 v[108:111], v[44:47], a[196:199], v[108:111]
    s_lshr_b32 s53, s53, 22
    ds_read_b128 v[44:47], v90 offset:3200
    v_pk_fmac_f16 v251, v9, v9
    v_mfma_f32_16x16x32_bf16 v[98:101], v[32:35], a[148:151], v[98:101]
    s_mul_i32 s53, s53, s63
    v_cvt_pk_f16_f32 v10, v20, v21
    v_cvt_pk_f16_f32 v11, v22, v23
    v_mfma_f32_16x16x32_bf16 v[80:83], v[32:35], a[172:175], v[80:83]
    s_mul_i32 s56, s56, s62
    v_pk_fmac_f16 v251, v10, v10
    v_pk_fmac_f16 v251, v11, v11
    v_mfma_f32_16x16x32_bf16 v[236:239], v[32:35], a[196:199], v[236:239]
    s_add_u32 s56, s56, s53
    ds_read_b128 v[116:119], v121 offset:41088
    v_cvt_pk_f16_f32 v148, v76, v77
    v_mfma_f32_16x16x32_f16 v[32:35], v[212:215], v[164:167], 0
    s_waitcnt vmcnt(9) lgkmcnt(4)
    s_mul_i32 s4, s15, 112
    ds_read_b64_tr_b16 a[160:161], v120 offset:49152
    v_cvt_pk_f16_f32 v149, v78, v79
    v_mfma_f32_16x16x32_bf16 v[168:171], a[152:155], v[72:75], v[168:171]
    s_cmp_ge_u32 s15, 16
    ds_read_b64_tr_b16 a[162:163], v120 offset:49920
    v_pk_fmac_f16 v251, v148, v148
    v_mfma_f32_16x16x32_bf16 v[156:159], a[176:179], v[72:75], v[156:159]
    s_cselect_b32 s53, -30464, 0
    ds_read_b64_tr_b16 a[184:185], v120 offset:49160
    v_or3_b32 v123, v123, v32, v33
    v_mfma_f32_16x16x32_bf16 v[52:55], a[200:203], v[72:75], v[52:55]
    s_waitcnt lgkmcnt(5)
    s_add_u32 s4, s4, s53
    ds_read_b64_tr_b16 a[186:187], v120 offset:49928
    v_or3_b32 v123, v123, v34, v35
    v_mfma_f32_16x16x32_bf16 v[244:247], v[64:67], a[152:155], v[244:247]
    s_cmp_lt_u32 s15, s73
    ds_read_b64_tr_b16 a[208:209], v91 offset:49216
    v_pk_fmac_f16 v251, v149, v149
    v_mfma_f32_16x16x32_bf16 v[16:19], v[64:67], a[176:179], v[16:19]
    s_cselect_b32 s26, 100270464, 0
    ds_read_b64_tr_b16 a[210:211], v91 offset:49984
    v_mfma_f32_16x16x32_bf16 v[240:243], v[64:67], a[200:203], v[240:243]
    s_cselect_b32 s56, s56, 0
    ds_read_b128 v[72:75], v121 offset:128
    v_mfma_f32_16x16x32_bf16 v[60:63], v[92:95], a[152:155], v[60:63]
    s_cselect_b32 s4, s4, -1
    ds_read_b128 v[64:67], v121 offset:1664
    v_mfma_f32_16x16x32_bf16 v[68:71], v[92:95], a[176:179], v[68:71]
    s_cselect_b32 s15, s15, 0
    ds_read_b128 v[76:79], v121 offset:3200
    v_mfma_f32_16x16x32_bf16 v[108:111], v[92:95], a[200:203], v[108:111]
    s_waitcnt lgkmcnt(8)
    s_cselect_b32 s13, s13, -1
    v_rsq_f32 v32, v32
    v_mfma_f32_16x16x32_bf16 v[98:101], v[44:47], a[152:155], v[98:101]
    s_bitset1_b32 s64, s15
    v_rsq_f32 v33, v33
    v_mfma_f32_16x16x32_bf16 v[80:83], v[44:47], a[176:179], v[80:83]
    s_add_u32 s65, s65, 1
    v_rsq_f32 v34, v34
    v_mfma_f32_16x16x32_bf16 v[236:239], v[44:47], a[200:203], v[236:239]
    s_cmp_ge_i32 s65, 2
    ds_read_b128 v[44:47], v121 offset:41216
    v_mul_f32 v32, s52, v32
    v_mfma_f32_16x16x32_bf16 v[168:171], a[156:159], v[116:119], v[168:171]
    s_cselect_b32 s30, 100270464, 0
    ds_read_b128 v[20:23], v121 offset:256
    v_cvt_pk_f16_f32 v32, v32, v33
    v_mfma_f32_16x16x32_bf16 v[156:159], a[180:183], v[116:119], v[156:159]
    s_add_u32 s67, s46, s54
    ds_read_b128 v[92:95], v121 offset:1792
    v_mul_f32 v34, s52, v34
    v_mfma_f32_16x16x32_bf16 v[52:55], a[204:207], v[116:119], v[52:55]
    s_waitcnt vmcnt(6) lgkmcnt(5)
    ds_read_b64_tr_b16 a[164:165], v120 offset:61440
    v_pk_mul_f16 v160, v160, v32 op_sel:[0,0] op_sel_hi:[1,0]
    v_mfma_f32_16x16x32_bf16 v[244:247], v[72:75], a[156:159], v[244:247]
    ds_read_b64_tr_b16 a[166:167], v120 offset:62208
    v_pk_mul_f16 v161, v161, v32 op_sel:[0,0] op_sel_hi:[1,0]
    v_mfma_f32_16x16x32_bf16 v[16:19], v[72:75], a[180:183], v[16:19]
    ds_read_b64_tr_b16 a[188:189], v120 offset:61448
    v_pk_mul_f16 v162, v162, v32 op_sel:[0,0] op_sel_hi:[1,0]
    v_mfma_f32_16x16x32_bf16 v[240:243], v[72:75], a[204:207], v[240:243]
    s_waitcnt lgkmcnt(6)
    ds_read_b64_tr_b16 a[190:191], v120 offset:62216
    v_pk_mul_f16 v163, v163, v32 op_sel:[0,0] op_sel_hi:[1,0]
    v_mfma_f32_16x16x32_bf16 v[60:63], v[64:67], a[156:159], v[60:63]
    ds_read_b64_tr_b16 a[212:213], v91 offset:61504
    v_pk_mul_f16 v6, v6, v32 op_sel:[0,0] op_sel_hi:[1,0]
    v_mfma_f32_16x16x32_bf16 v[68:71], v[64:67], a[180:183], v[68:71]
    ds_read_b64_tr_b16 a[214:215], v91 offset:62272
    v_pk_mul_f16 v7, v7, v32 op_sel:[0,0] op_sel_hi:[1,0]
    v_mfma_f32_16x16x32_bf16 v[108:111], v[64:67], a[204:207], v[108:111]
    ds_read_b128 v[64:67], v121 offset:3328
    v_pk_mul_f16 v232, v232, v32 op_sel:[0,1] op_sel_hi:[1,1]
    v_mfma_f32_16x16x32_bf16 v[98:101], v[76:79], a[156:159], v[98:101]
    ds_read_b128 v[72:75], v90 offset:41216
    v_pk_mul_f16 v233, v233, v32 op_sel:[0,1] op_sel_hi:[1,1]
    v_mfma_f32_16x16x32_bf16 v[80:83], v[76:79], a[180:183], v[80:83]
    ds_read_b128 v[164:167], v90 offset:256
    v_pk_mul_f16 v234, v234, v32 op_sel:[0,1] op_sel_hi:[1,1]
    v_mfma_f32_16x16x32_bf16 v[236:239], v[76:79], a[204:207], v[236:239]
    ds_read_b128 v[116:119], v90 offset:1792
    v_pk_mul_f16 v235, v235, v32 op_sel:[0,1] op_sel_hi:[1,1]
    v_mfma_f32_16x16x32_f16 v[76:79], v[212:215], v[248:251], 0
    v_rsq_f32 v35, v35
    v_pk_mul_f16 v2, v2, v32 op_sel:[0,1] op_sel_hi:[1,1]
    v_cvt_pk_f16_f32 v34, v34, v35
    v_pk_mul_f16 v3, v3, v32 op_sel:[0,1] op_sel_hi:[1,1]
    v_fma_mix_f32 v138, v160, v232, 0 op_sel:[0,0,0] op_sel_hi:[1,1,0]
    v_fma_mix_f32 v138, v160, v232, v138 op_sel:[1,1,0] op_sel_hi:[1,1,0]
    v_fma_mix_f32 v138, v161, v233, v138 op_sel:[0,0,0] op_sel_hi:[1,1,0]
    v_fma_mix_f32 v138, v161, v233, v138 op_sel:[1,1,0] op_sel_hi:[1,1,0]
    v_fma_mix_f32 v138, v162, v234, v138 op_sel:[0,0,0] op_sel_hi:[1,1,0]
    v_fma_mix_f32 v138, v162, v234, v138 op_sel:[1,1,0] op_sel_hi:[1,1,0]
    v_fma_mix_f32 v138, v163, v235, v138 op_sel:[0,0,0] op_sel_hi:[1,1,0]
    v_fma_mix_f32 v138, v163, v235, v138 op_sel:[1,1,0] op_sel_hi:[1,1,0]
    v_fma_mix_f32 v138, v6, v2, v138 op_sel:[0,0,0] op_sel_hi:[1,1,0]
    v_fma_mix_f32 v138, v6, v2, v138 op_sel:[1,1,0] op_sel_hi:[1,1,0]
    v_fma_mix_f32 v138, v7, v3, v138 op_sel:[0,0,0] op_sel_hi:[1,1,0]
    v_fma_mix_f32 v138, v7, v3, v138 op_sel:[1,1,0] op_sel_hi:[1,1,0]
    v_mov_b32 v91, v138
    v_mov_b32 v144, 0
    v_mov_b32 v145, 0
    v_permlane32_swap_b32 v91, v138
    v_add_f32 v138, v91, v138
    s_waitcnt lgkmcnt(2)
    v_mfma_f32_16x16x32_bf16 v[168:171], a[160:163], v[72:75], v[168:171]
    v_mov_b32 v91, v138
    v_mov_b32 v139, 0
    v_mfma_f32_16x16x32_bf16 v[168:171], a[164:167], v[44:47], v[168:171]
    v_permlane16_swap_b32 v91, v138
    v_mfma_f32_16x16x32_bf16 v[156:159], a[184:187], v[72:75], v[156:159]
    v_add_f32 v138, v91, v138
    v_add_f32 v138, s84, v138
    v_mfma_f32_16x16x32_bf16 v[156:159], a[188:191], v[44:47], v[156:159]
    v_exp_f32 v138, v138
    v_mfma_f32_16x16x32_bf16 v[52:55], a[208:211], v[72:75], v[52:55]
    s_mov_b32 s53, s47
    ds_read_b128 v[72:75], v90 offset:3328
    v_cvt_pk_bf16_f32 v138, v138, 0
    v_mfma_f32_16x16x32_bf16 v[52:55], a[212:215], v[44:47], v[52:55]
    s_waitcnt lgkmcnt(1)
    s_mov_b32 s47, s46
    v_cmp_gt_u32 vcc, 16, v97
    v_add_u32 v47, 28672, v38
    v_mfma_f32_16x16x32_bf16 v[244:247], v[164:167], a[160:163], v[244:247]
    s_mov_b32 s46, s45
    ds_write_b128 v47, v[232:235]
    v_mfma_f32_16x16x32_bf16 v[244:247], v[20:23], a[164:167], v[244:247]
    s_mov_b32 s45, s44
    v_cndmask_b32 v138, 0, v138, vcc
    v_cvt_pk_bf16_f32 v42, v168, v169
    v_mfma_f32_16x16x32_bf16 v[16:19], v[164:167], a[184:187], v[16:19]
    s_sub_u32 s49, s46, s45
    v_cvt_pk_bf16_f32 v43, v170, v171
    v_cvt_pk_bf16_f32 v44, v156, v157
    v_mfma_f32_16x16x32_bf16 v[16:19], v[20:23], a[188:191], v[16:19]
    s_mov_b32 s44, s53
    ds_write2_b64 v47, v[144:145], v[144:145] offset0:2 offset1:3
    v_mfma_f32_16x16x32_bf16 v[240:243], v[164:167], a[208:211], v[240:243]
    s_sub_u32 s48, s44, s46
    v_cvt_pk_bf16_f32 v0, v244, v245
    v_cvt_pk_bf16_f32 v1, v246, v247
    v_mfma_f32_16x16x32_bf16 v[240:243], v[20:23], a[212:215], v[240:243]
    s_mul_i32 s93, s68, 18432
    v_cvt_pk_bf16_f32 v20, v16, v17
    v_cvt_pk_bf16_f32 v21, v18, v19
    v_mfma_f32_16x16x32_bf16 v[60:63], v[116:119], a[160:163], v[60:63]
    s_movk_i32 s92, 0
    ds_write_b128 v47, v[160:163] offset:32
    v_mfma_f32_16x16x32_bf16 v[60:63], v[92:95], a[164:167], v[60:63]
    s_nop 0
    v_cvt_pk_bf16_f32 v4, v240, v241
    v_cvt_pk_bf16_f32 v5, v242, v243
    v_mfma_f32_16x16x32_bf16 v[68:71], v[116:119], a[184:187], v[68:71]
    v_cvt_pk_bf16_f32 v45, v158, v159
    v_cvt_pk_bf16_f32 v46, v52, v53
    v_mfma_f32_16x16x32_bf16 v[68:71], v[92:95], a[188:191], v[68:71]
    ds_write2_b64 v47, v[2:3], v[144:145] offset0:6 offset1:7
    v_mfma_f32_16x16x32_bf16 v[108:111], v[116:119], a[208:211], v[108:111]
    s_nop 0
    v_cvt_pk_bf16_f32 v2, v60, v61
    v_cvt_pk_bf16_f32 v3, v62, v63
    v_mfma_f32_16x16x32_bf16 v[108:111], v[92:95], a[212:215], v[108:111]
    s_waitcnt lgkmcnt(2)
    s_nop 0
    v_cvt_pk_bf16_f32 v22, v68, v69
    v_cvt_pk_bf16_f32 v23, v70, v71
    v_mfma_f32_16x16x32_bf16 v[98:101], v[72:75], a[160:163], v[98:101]
    ds_write2_b64 v47, v[144:145], v[6:7] offset0:8 offset1:9
    v_mfma_f32_16x16x32_bf16 v[98:101], v[64:67], a[164:167], v[98:101]
    s_nop 0
    v_cvt_pk_bf16_f32 v6, v108, v109
    v_cvt_pk_bf16_f32 v7, v110, v111
    v_mfma_f32_16x16x32_bf16 v[80:83], v[72:75], a[184:187], v[80:83]
    v_mov_b32 v171, 0
    v_mov_b32 v167, 0
    v_mfma_f32_16x16x32_bf16 v[80:83], v[64:67], a[188:191], v[80:83]
    ds_write_b64 v47, v[138:139] offset:88
    v_mfma_f32_16x16x32_bf16 v[236:239], v[72:75], a[208:211], v[236:239]
    v_mov_b32 v163, 0
    v_mov_b32 v159, 0
    v_mfma_f32_16x16x32_bf16 v[236:239], v[64:67], a[212:215], v[236:239]
    ds_write_b64 v38, v[42:43] offset:28752
    global_load_dword v120, v122, s[38:39] offset:248 sc1
    v_mov_b32 v150, 0
    v_mov_b32 v151, 0
    v_mov_b32 v144, 0
    v_mov_b32 v145, 0
    v_mov_b32 v138, 0
    v_mov_b32 v139, 0
    v_cvt_pk_bf16_f32 v47, v54, v55
    ds_write_b128 v38, v[44:47] offset:28768
    v_or3_b32 v123, v123, v76, v77
    v_rsq_f32 v76, v76
    v_rsq_f32 v77, v77
    v_mul_f32 v76, s52, v76
    v_cvt_pk_f16_f32 v76, v76, v77
    v_or3_b32 v123, v123, v78, v79
    ds_read_b128 v[68:71], v132 offset:0
    v_or3_b32 v123, v123, v40, v41
    v_rsq_f32 v40, v40
    ds_read_b128 v[60:63], v132 offset:16
    v_rsq_f32 v41, v41
    v_mul_f32 v40, s52, v40
    ds_read_b128 v[16:19], v132 offset:48
    v_cvt_pk_f16_f32 v40, v40, v41
    v_pk_mul_f16 v56, v56, v40 op_sel:[0,1] op_sel_hi:[1,1]
    v_pk_mul_f16 v57, v57, v40 op_sel:[0,1] op_sel_hi:[1,1]
    v_pk_mul_f16 v58, v58, v40 op_sel:[0,1] op_sel_hi:[1,1]
    v_pk_mul_f16 v59, v59, v40 op_sel:[0,1] op_sel_hi:[1,1]
    v_pk_mul_f16 v142, v142, v40 op_sel:[0,1] op_sel_hi:[1,1]
    v_pk_mul_f16 v143, v143, v40 op_sel:[0,1] op_sel_hi:[1,1]
    v_pk_mul_f16 v48, v48, v40 op_sel:[0,0] op_sel_hi:[1,0]
    v_pk_mul_f16 v49, v49, v40 op_sel:[0,0] op_sel_hi:[1,0]
    v_pk_mul_f16 v50, v50, v40 op_sel:[0,0] op_sel_hi:[1,0]
    v_pk_mul_f16 v51, v51, v40 op_sel:[0,0] op_sel_hi:[1,0]
    v_pk_mul_f16 v140, v140, v40 op_sel:[0,0] op_sel_hi:[1,0]
    v_pk_mul_f16 v141, v141, v40 op_sel:[0,0] op_sel_hi:[1,0]
    v_rsq_f32 v78, v78
    v_rsq_f32 v79, v79
    v_mul_f32 v78, s52, v78
    v_cvt_pk_f16_f32 v78, v78, v79
    v_pk_mul_f16 v12, v12, v76 op_sel:[0,1] op_sel_hi:[1,1]
    v_pk_mul_f16 v13, v13, v76 op_sel:[0,1] op_sel_hi:[1,1]
    v_pk_mul_f16 v14, v14, v76 op_sel:[0,1] op_sel_hi:[1,1]
    v_pk_mul_f16 v15, v15, v76 op_sel:[0,1] op_sel_hi:[1,1]
    v_pk_mul_f16 v154, v154, v76 op_sel:[0,1] op_sel_hi:[1,1]
    v_pk_mul_f16 v155, v155, v76 op_sel:[0,1] op_sel_hi:[1,1]
    v_pk_mul_f16 v28, v28, v76 op_sel:[0,0] op_sel_hi:[1,0]
    v_pk_mul_f16 v29, v29, v76 op_sel:[0,0] op_sel_hi:[1,0]
    v_pk_mul_f16 v30, v30, v76 op_sel:[0,0] op_sel_hi:[1,0]
    v_pk_mul_f16 v31, v31, v76 op_sel:[0,0] op_sel_hi:[1,0]
    v_pk_mul_f16 v152, v152, v76 op_sel:[0,0] op_sel_hi:[1,0]
    v_pk_mul_f16 v153, v153, v76 op_sel:[0,0] op_sel_hi:[1,0]
    v_mfma_f32_16x16x32_f16 v[52:55], v[12:15], v[28:31], v[204:207]
    ds_read_b128 v[232:235], v90 offset:42496
    v_pk_mul_f16 v8, v8, v78 op_sel:[0,1] op_sel_hi:[1,1]
    v_mfma_f32_16x16x32_f16 v[52:55], v[152:155], v[150:153], v[52:55]
    ds_read_b128 v[228:231], v121 offset:42496
    v_pk_mul_f16 v9, v9, v78 op_sel:[0,1] op_sel_hi:[1,1]
    v_mfma_f32_16x16x32_f16 v[44:47], v[56:59], v[28:31], v[196:199]
    ds_read_b128 v[224:227], v90 offset:42624
    v_pk_mul_f16 v10, v10, v78 op_sel:[0,1] op_sel_hi:[1,1]
    v_mfma_f32_16x16x32_f16 v[44:47], v[140:143], v[150:153], v[44:47]
    s_waitcnt lgkmcnt(3)
    ds_read_b128 v[116:119], v121 offset:42624
    v_pk_mul_f16 v11, v11, v78 op_sel:[0,1] op_sel_hi:[1,1]
    v_mfma_f32_16x16x32_f16 v[40:43], v[68:71], v[28:31], v[208:211]
    s_add_u32 m0, s67, 0
    ds_read_b128 v[108:111], v90 offset:42752
    v_pk_mul_f16 v148, v148, v78 op_sel:[0,1] op_sel_hi:[1,1]
    v_mfma_f32_16x16x32_f16 v[40:43], v[60:63], v[12:15], v[40:43]
    ds_read_b128 v[92:95], v121 offset:42752
    v_pk_mul_f16 v149, v149, v78 op_sel:[0,1] op_sel_hi:[1,1]
    v_mfma_f32_16x16x32_f16 v[40:43], v[16:19], v[152:155], v[40:43]
    v_pk_mul_f16 v24, v24, v78 op_sel:[0,0] op_sel_hi:[1,0]
    v_pk_mul_f16 v25, v25, v78 op_sel:[0,0] op_sel_hi:[1,0]
    v_pk_mul_f16 v26, v26, v78 op_sel:[0,0] op_sel_hi:[1,0]
    v_pk_mul_f16 v27, v27, v78 op_sel:[0,0] op_sel_hi:[1,0]
    v_pk_mul_f16 v146, v146, v78 op_sel:[0,0] op_sel_hi:[1,0]
    v_pk_mul_f16 v147, v147, v78 op_sel:[0,0] op_sel_hi:[1,0]
    v_mfma_f32_16x16x32_f16 v[64:67], v[8:11], v[28:31], v[200:203]
    v_cvt_pk_bf16_f32 v164, v98, v99
    v_cvt_pk_bf16_f32 v165, v100, v101
    v_mfma_f32_16x16x32_f16 v[64:67], v[146:149], v[150:153], v[64:67]
    s_waitcnt lgkmcnt(5)
    v_cvt_pk_bf16_f32 v160, v80, v81
    v_cvt_pk_bf16_f32 v161, v82, v83
    v_mfma_f32_16x16x32_bf16 v[72:75], a[144:147], v[232:235], 0
    s_waitcnt lgkmcnt(4)
    v_cvt_pk_bf16_f32 v156, v236, v237
    v_cvt_pk_bf16_f32 v157, v238, v239
    v_mfma_f32_16x16x32_bf16 v[72:75], a[148:151], v[228:231], v[72:75]
    s_waitcnt lgkmcnt(3)
    v_exp_f32 v52, v52
    v_mfma_f32_16x16x32_bf16 v[72:75], a[152:155], v[224:227], v[72:75]
    s_waitcnt lgkmcnt(2)
    v_exp_f32 v53, v53
    v_mfma_f32_16x16x32_bf16 v[72:75], a[156:159], v[116:119], v[72:75]
    s_waitcnt vmcnt(1) lgkmcnt(0)
    v_exp_f32 v54, v54
    v_mfma_f32_16x16x32_bf16 v[72:75], a[160:163], v[108:111], v[72:75]
    s_barrier
    buffer_load_dwordx4 v128, s[24:27], s56 offen nt lds
    v_cvt_pk_bf16_f32 v52, v52, v53
    v_mfma_f32_16x16x32_bf16 v[72:75], a[164:167], v[92:95], v[72:75]
    s_add_u32 m0, s67, 1024
    v_exp_f32 v55, v55
    v_mfma_f32_16x16x32_bf16 v[28:31], a[168:171], v[232:235], 0
    s_nop 0
    v_cvt_pk_bf16_f32 v53, v54, v55
    v_add_u32 v137, s48, v137
    v_mfma_f32_16x16x32_bf16 v[28:31], a[172:175], v[228:231], v[28:31]
    s_nop 0
    v_cvt_pk_bf16_f32 v90, v72, v73
    v_cvt_pk_bf16_f32 v91, v74, v75
    v_mfma_f32_16x16x32_bf16 v[28:31], a[176:179], v[224:227], v[28:31]
    v_exp_f32 v64, v64
    v_mfma_f32_16x16x32_bf16 v[28:31], a[180:183], v[116:119], v[28:31]
    buffer_load_dwordx4 v127, s[24:27], s56 offen nt lds
    v_add_u32 v136, s48, v136
    v_mfma_f32_16x16x32_bf16 v[28:31], a[184:187], v[108:111], v[28:31]
    s_add_u32 m0, s67, 2048
    v_exp_f32 v65, v65
    v_mfma_f32_16x16x32_bf16 v[28:31], a[188:191], v[92:95], v[28:31]
    ds_read_u16 v166, v131 offset:80
    v_cvt_pk_bf16_f32 v54, v64, v65
    v_mfma_f32_16x16x32_bf16 v[72:75], a[192:195], v[232:235], 0
    ds_read_u16 v162, v131 offset:96
    v_lshl_add_u32 v121, v97, 4, s93
    v_mfma_f32_16x16x32_bf16 v[72:75], a[196:199], v[228:231], v[72:75]
    s_mov_b32 s93, 0
    ds_read_u16 v158, v131 offset:104
    v_cvt_pk_bf16_f32 v76, v28, v29
    v_mfma_f32_16x16x32_bf16 v[72:75], a[200:203], v[224:227], v[72:75]
    buffer_load_dwordx4 v126, s[24:27], s56 offen nt lds
    v_cvt_pk_bf16_f32 v77, v30, v31
    v_mfma_f32_16x16x32_bf16 v[72:75], a[204:207], v[116:119], v[72:75]
    s_add_u32 m0, s67, 3072
    v_exp_f32 v66, v66
    v_mfma_f32_16x16x32_bf16 v[72:75], a[208:211], v[108:111], v[72:75]
    v_exp_f32 v67, v67
    v_mfma_f32_16x16x32_bf16 v[72:75], a[212:215], v[92:95], v[72:75]
    s_nop 0
    v_exp_f32 v44, v44
    v_mfma_f32_16x16x32_f16 v[28:31], v[68:71], v[24:27], v[208:211]
    s_nop 0
    v_exp_f32 v45, v45
    v_mfma_f32_16x16x32_f16 v[28:31], v[60:63], v[8:11], v[28:31]
    s_nop 0
    buffer_load_dwordx4 v125, s[24:27], s56 offen nt lds
    v_cvt_pk_bf16_f32 v78, v72, v73
    v_mfma_f32_16x16x32_f16 v[28:31], v[16:19], v[146:149], v[28:31]
    s_add_u32 m0, s67, 4096
    v_cvt_pk_bf16_f32 v79, v74, v75
    v_cvt_pk_bf16_f32 v55, v66, v67
    v_mfma_f32_16x16x32_f16 v[228:231], v[68:71], v[48:51], v[208:211]
    s_nop 0
    v_exp_f32 v46, v46
    v_mfma_f32_16x16x32_f16 v[228:231], v[60:63], v[56:59], v[228:231]
    s_nop 0
    v_mov_b32_dpp v43, v31 quad_perm:[0,1,2,3] row_mask:0x2 bank_mask:0xf
    v_cvt_pk_bf16_f32 v168, v44, v45
    v_mfma_f32_16x16x32_f16 v[228:231], v[16:19], v[140:143], v[228:231]
    v_exp_f32 v47, v47
    v_mfma_f32_16x16x32_f16 v[16:19], v[12:15], v[24:27], v[192:195]
    buffer_load_dwordx4 v124, s[24:27], s56 offen nt lds
    v_cvt_pk_bf16_f32 v169, v46, v47
    v_mfma_f32_16x16x32_f16 v[16:19], v[152:155], v[144:147], v[16:19]
    v_exp_f32 v40, v40
    v_mfma_f32_16x16x32_f16 v[92:95], v[8:11], v[24:27], v[188:191]
    ds_read_b128 v[64:67], v137 offset:0
    v_mov_b32_dpp v43, v231 quad_perm:[0,1,2,3] row_mask:0x4 bank_mask:0xf
    v_mfma_f32_16x16x32_f16 v[92:95], v[146:149], v[144:147], v[92:95]
    v_exp_f32 v43, v43
    v_mfma_f32_16x16x32_f16 v[72:75], v[56:59], v[24:27], v[184:187]
    ds_read_b128 v[44:47], v137 offset:256
    v_cvt_pk_bf16_f32 v43, v43, v43
    v_mfma_f32_16x16x32_f16 v[72:75], v[140:143], v[144:147], v[72:75]
    ds_write_b16 v131, v43 offset:64
    v_mfma_f32_16x16x32_f16 v[80:83], v[12:15], v[48:51], v[180:183]
    ds_read_b128 v[236:239], v132 offset:48
    v_cvt_pk_bf16_f32 v170, v40, 0
    v_mfma_f32_16x16x32_f16 v[80:83], v[152:155], v[138:141], v[80:83]
    ds_read_b128 v[60:63], v132 offset:64
    s_nop 0
    v_mfma_f32_16x16x32_bf16 v[12:15], v[220:223], v[52:55], 0
    s_nop 0
    ds_read_b128 v[24:27], v136 offset:0
    s_nop 0
    v_mfma_f32_16x16x32_bf16 v[12:15], v[220:223], v[168:171], v[12:15]
    s_nop 0
    v_exp_f32 v80, v80
    v_mfma_f32_16x16x32_bf16 v[68:71], v[0:3], v[52:55], 0
    s_waitcnt lgkmcnt(6)
    v_exp_f32 v81, v81
    v_mfma_f32_16x16x32_bf16 v[68:71], v[164:167], v[168:171], v[68:71]
    v_exp_f32 v82, v82
    v_mfma_f32_16x16x32_bf16 v[240:243], v[20:23], v[52:55], 0
    v_exp_f32 v83, v83
    v_mfma_f32_16x16x32_bf16 v[240:243], v[160:163], v[168:171], v[240:243]
    ds_read_b128 v[40:43], v136 offset:256
    v_cvt_pk_bf16_f32 v80, v80, v81
    v_mfma_f32_16x16x32_bf16 v[108:111], v[4:7], v[52:55], 0
    v_exp_f32 v230, v230
    v_mfma_f32_16x16x32_bf16 v[108:111], v[156:159], v[168:171], v[108:111]
    v_exp_f32 v16, v16
    v_mfma_f32_16x16x32_f16 v[152:155], v[8:11], v[48:51], v[176:179]
    v_exp_f32 v17, v17
    v_mfma_f32_16x16x32_f16 v[152:155], v[146:149], v[138:141], v[152:155]
    ds_read_b128 v[52:55], v137 offset:128
    v_cvt_pk_bf16_f32 v81, v82, v83
    v_mfma_f32_16x16x32_f16 v[232:235], v[56:59], v[48:51], v[172:175]
    ds_read_b128 v[48:51], v136 offset:128
    v_cvt_pk_bf16_f32 v16, v16, v17
    v_mfma_f32_16x16x32_f16 v[232:235], v[140:143], v[138:141], v[232:235]
    s_waitcnt lgkmcnt(3)
    s_nop 0
    v_exp_f32 v152, v152
    v_mfma_f32_16x16x32_bf16 v[116:119], a[24:27], v[64:67], 0
    v_exp_f32 v153, v153
    v_mfma_f32_16x16x32_bf16 v[116:119], a[28:31], v[24:27], v[116:119]
    v_exp_f32 v154, v154
    v_exp_f32 v155, v155
    v_cvt_pk_bf16_f32 v82, v152, v153
    v_cvt_pk_bf16_f32 v83, v154, v155
    v_exp_f32 v232, v232
    v_exp_f32 v233, v233
    v_exp_f32 v234, v234
    v_exp_f32 v235, v235
    v_exp_f32 v18, v18
    v_exp_f32 v19, v19
    v_exp_f32 v92, v92
    s_waitcnt lgkmcnt(0)
    v_mfma_f32_16x16x32_bf16 v[116:119], a[32:35], v[52:55], v[116:119]
    v_exp_f32 v93, v93
    v_mfma_f32_16x16x32_bf16 v[116:119], a[36:39], v[48:51], v[116:119]
    v_cvt_pk_bf16_f32 v17, v18, v19
    v_cvt_pk_bf16_f32 v18, v92, v93
    v_mfma_f32_16x16x32_bf16 v[116:119], a[40:43], v[44:47], v[116:119]
    v_exp_f32 v94, v94
    v_mfma_f32_16x16x32_bf16 v[116:119], a[44:47], v[40:43], v[116:119]
    v_exp_f32 v95, v95
    v_mfma_f32_16x16x32_bf16 v[8:11], a[48:51], v[64:67], 0
    v_exp_f32 v72, v72
    v_mfma_f32_16x16x32_bf16 v[8:11], a[52:55], v[24:27], v[8:11]
    v_exp_f32 v73, v73
    v_mfma_f32_16x16x32_bf16 v[8:11], a[56:59], v[52:55], v[8:11]
    v_cvt_pk_bf16_f32 v19, v94, v95
    v_cvt_pk_bf16_f32 v168, v72, v73
    v_mfma_f32_16x16x32_bf16 v[8:11], a[60:63], v[48:51], v[8:11]
    v_exp_f32 v74, v74
    v_mfma_f32_16x16x32_bf16 v[8:11], a[64:67], v[44:47], v[8:11]
    v_exp_f32 v75, v75
    v_mfma_f32_16x16x32_bf16 v[8:11], a[68:71], v[40:43], v[8:11]
    v_cvt_pk_bf16_f32 v169, v74, v75
    v_cvt_pk_f16_f32 v30, v116, v117
    v_mfma_f32_16x16x32_bf16 v[224:227], a[120:123], v[64:67], 0
    s_nop 0
    v_exp_f32 v29, v29
    v_mfma_f32_16x16x32_bf16 v[224:227], a[124:127], v[24:27], v[224:227]
L_pg1:
    s_cbranch_execz L_main
    s_nop 0
    v_cvt_pk_bf16_f32 v170, v29, 0
    v_cvt_pk_f16_f32 v152, v8, v9
    v_mfma_f32_16x16x32_bf16 v[224:227], a[128:131], v[52:55], v[224:227]
    s_waitcnt vmcnt(5)
    v_readfirstlane_b32 s94, v120
    s_nop 1
    s_cmp_lt_u32 s94, 3
    s_cbranch_scc1 L_spin
L_spinr:
    v_mfma_f32_16x16x32_bf16 v[224:227], a[132:135], v[48:51], v[224:227]
    buffer_load_dwordx4 a[216:219], v121, s[76:79], s92 offen offset:0 sc1
    v_cvt_pk_f16_f32 v153, v10, v11
    v_mfma_f32_16x16x32_bf16 v[224:227], a[136:139], v[44:47], v[224:227]
    v_rcp_f32 v12, v12
    v_mfma_f32_16x16x32_bf16 v[224:227], a[140:143], v[40:43], v[224:227]
    v_mul_f32 v68, v68, v12
    v_mul_f32 v69, v69, v12
    v_mfma_f32_16x16x32_bf16 v[92:95], v[220:223], v[16:19], 0
    v_cvt_pk_bf16_f32 v68, v68, v69
    v_mul_f32 v70, v70, v12
    v_mfma_f32_16x16x32_bf16 v[92:95], v[220:223], v[168:171], v[92:95]
    v_mul_f32 v71, v71, v12
    v_cvt_pk_bf16_f32 v69, v70, v71
    v_mfma_f32_16x16x32_bf16 v[72:75], v[0:3], v[16:19], 0
    buffer_load_dwordx4 a[220:223], v121, s[76:79], s92 offen offset:1024 sc1
    v_mul_f32 v240, v240, v12
    v_mfma_f32_16x16x32_bf16 v[72:75], v[164:167], v[168:171], v[72:75]
    v_mul_f32 v241, v241, v12
    v_cvt_pk_bf16_f32 v70, v240, v241
    v_mfma_f32_16x16x32_bf16 v[56:59], v[20:23], v[16:19], 0
    v_mul_f32 v242, v242, v12
    v_mul_f32 v243, v243, v12
    v_mfma_f32_16x16x32_bf16 v[56:59], v[160:163], v[168:171], v[56:59]
    v_cvt_pk_bf16_f32 v71, v242, v243
    v_mul_f32 v108, v108, v12
    v_mfma_f32_16x16x32_bf16 v[8:11], v[4:7], v[16:19], 0
    v_mul_f32 v109, v109, v12
    v_cvt_pk_bf16_f32 v14, v108, v109
    v_mfma_f32_16x16x32_bf16 v[8:11], v[156:159], v[168:171], v[8:11]
    buffer_load_dwordx4 a[224:227], v121, s[76:79], s92 offen offset:2048 sc1
    v_cvt_pk_bf16_f32 v168, v232, v233
    v_mfma_f32_16x16x32_bf16 v[16:19], a[72:75], v[64:67], 0
    v_cvt_pk_bf16_f32 v169, v234, v235
    v_cvt_pk_bf16_f32 v170, v230, 0
    v_mfma_f32_16x16x32_bf16 v[16:19], a[76:79], v[24:27], v[16:19]
    v_mul_f32 v110, v110, v12
    v_mul_f32 v111, v111, v12
    v_mfma_f32_16x16x32_bf16 v[16:19], a[80:83], v[52:55], v[16:19]
    v_cvt_pk_bf16_f32 v15, v110, v111
    v_cvt_pk_f16_f32 v154, v224, v225
    v_mfma_f32_16x16x32_bf16 v[16:19], a[84:87], v[48:51], v[16:19]
    v_cvt_pk_f16_f32 v155, v226, v227
    v_cvt_pk_f16_f32 v31, v118, v119
    v_mfma_f32_16x16x32_bf16 v[16:19], a[88:91], v[44:47], v[16:19]
    buffer_load_dwordx4 a[228:231], v121, s[76:79], s92 offen offset:3072 sc1
    v_mfma_f32_16x16x32_bf16 v[16:19], a[92:95], v[40:43], v[16:19]
    s_movk_i32 s92, 4096
    ds_write_b32 v134, v15 offset:4
    v_mfma_f32_16x16x32_bf16 v[244:247], v[64:67], a[144:147], 0
    s_nop 0
    v_rcp_f32 v92, v92
    v_mfma_f32_16x16x32_bf16 v[244:247], v[24:27], a[148:151], v[244:247]
    s_nop 0
    v_mul_f32 v72, v72, v92
    v_cvt_pk_f16_f32 v12, v16, v17
    v_mfma_f32_16x16x32_bf16 v[244:247], v[52:55], a[152:155], v[244:247]
    v_cvt_pk_f16_f32 v13, v18, v19
    v_pk_fma_f16 v37, v12, v12, s3
    v_mfma_f32_16x16x32_bf16 v[244:247], v[48:51], a[156:159], v[244:247]
    buffer_load_dwordx4 a[232:235], v121, s[76:79], s92 offen offset:0 sc1
    v_pk_fmac_f16 v37, v13, v13
    v_mfma_f32_16x16x32_bf16 v[244:247], v[44:47], a[160:163], v[244:247]
    v_mul_f32 v73, v73, v92
    v_cvt_pk_bf16_f32 v248, v72, v73
    v_mfma_f32_16x16x32_bf16 v[244:247], v[40:43], a[164:167], v[244:247]
    v_mul_f32 v74, v74, v92
    v_mul_f32 v75, v75, v92
    v_mfma_f32_16x16x32_bf16 v[16:19], v[64:67], a[168:171], 0
    ds_read_b128 v[98:101], v137 offset:1536
    v_cvt_pk_bf16_f32 v249, v74, v75
    v_mfma_f32_16x16x32_bf16 v[16:19], v[24:27], a[172:175], v[16:19]
    ds_read_b128 v[140:143], v136 offset:1536
    v_mul_f32 v56, v56, v92
    v_mfma_f32_16x16x32_bf16 v[16:19], v[52:55], a[176:179], v[16:19]
    buffer_load_dwordx4 a[236:239], v121, s[76:79], s92 offen offset:1024 sc1
    v_mul_f32 v57, v57, v92
    v_mfma_f32_16x16x32_bf16 v[16:19], v[48:51], a[180:183], v[16:19]
    ds_read_b128 v[116:119], v137 offset:1664
    v_cvt_pk_bf16_f32 v250, v56, v57
    v_mfma_f32_16x16x32_bf16 v[16:19], v[44:47], a[184:187], v[16:19]
    v_mul_f32 v58, v58, v92
    v_mul_f32 v59, v59, v92
    v_mfma_f32_16x16x32_bf16 v[16:19], v[40:43], a[188:191], v[16:19]
    s_lshl_b32 s93, s68, 10
    v_cvt_pk_bf16_f32 v251, v58, v59
    v_mul_f32 v8, v8, v92
    v_mfma_f32_16x16x32_bf16 v[108:111], v[220:223], v[80:83], 0
    v_mul_f32 v9, v9, v92
    v_cvt_pk_bf16_f32 v28, v8, v9
    v_mfma_f32_16x16x32_bf16 v[108:111], v[220:223], v[168:171], v[108:111]
    buffer_load_dwordx4 a[240:243], v121, s[76:79], s92 offen offset:2048 sc1
    ds_read_b128 v[56:59], v136 offset:1792
    v_mfma_f32_16x16x32_bf16 v[72:75], v[0:3], v[80:83], 0
    v_mul_f32 v10, v10, v92
    v_mul_f32 v11, v11, v92
    v_mfma_f32_16x16x32_bf16 v[72:75], v[164:167], v[168:171], v[72:75]
    ds_write_b64 v135, v[68:69] offset:0
    v_mfma_f32_16x16x32_bf16 v[224:227], v[20:23], v[80:83], 0
    v_rcp_f32 v108, v108
    v_mfma_f32_16x16x32_bf16 v[224:227], v[160:163], v[168:171], v[224:227]
    ds_write_b64 v135, v[70:71] offset:8
    v_mfma_f32_16x16x32_bf16 v[68:71], v[4:7], v[80:83], 0
    s_nop 0
    buffer_load_dwordx4 a[244:247], v121, s[76:79], s92 offen offset:3072 sc1
    v_mul_f32 v72, v72, v108
    v_mfma_f32_16x16x32_bf16 v[68:71], v[156:159], v[168:171], v[68:71]
    s_movk_i32 s92, 8192
    ds_write_b32 v134, v14 offset:0
    v_mfma_f32_16x16x32_bf16 v[240:243], v[64:67], a[192:195], 0
    ds_read_b128 v[92:95], v136 offset:1664
    v_mul_f32 v73, v73, v108
    v_mfma_f32_16x16x32_bf16 v[240:243], v[24:27], a[196:199], v[240:243]
    v_cvt_pk_bf16_f32 v72, v72, v73
    v_mul_f32 v74, v74, v108
    v_mfma_f32_16x16x32_bf16 v[240:243], v[52:55], a[200:203], v[240:243]
    v_mul_f32 v75, v75, v108
    v_cvt_pk_bf16_f32 v73, v74, v75
    v_mfma_f32_16x16x32_bf16 v[240:243], v[48:51], a[204:207], v[240:243]
    buffer_load_dwordx4 a[248:251], v121, s[76:79], s92 offen offset:0 sc1
    v_mul_f32 v224, v224, v108
    v_mfma_f32_16x16x32_bf16 v[240:243], v[44:47], a[208:211], v[240:243]
    ds_write_b64 v135, v[72:73] offset:3072
    v_mfma_f32_16x16x32_bf16 v[240:243], v[40:43], a[212:215], v[240:243]
    v_mul_f32 v225, v225, v108
    v_cvt_pk_bf16_f32 v74, v224, v225
    v_mfma_f32_16x16x32_bf16 v[228:231], a[96:99], v[64:67], 0
    v_mul_f32 v226, v226, v108
    v_mul_f32 v227, v227, v108
    v_mfma_f32_16x16x32_bf16 v[228:231], a[100:103], v[24:27], v[228:231]
    ds_read_b128 v[80:83], v137 offset:1792
    v_cvt_pk_bf16_f32 v75, v226, v227
    v_mfma_f32_16x16x32_bf16 v[228:231], a[104:107], v[52:55], v[228:231]
    buffer_load_dwordx4 a[252:255], v121, s[76:79], s92 offen offset:1024 sc1
    v_mul_f32 v68, v68, v108
    v_mfma_f32_16x16x32_bf16 v[228:231], a[108:111], v[48:51], v[228:231]
    ds_write_b64 v135, v[74:75] offset:3080
    v_mfma_f32_16x16x32_bf16 v[228:231], a[112:115], v[44:47], v[228:231]
    v_mul_f32 v69, v69, v108
    v_cvt_pk_bf16_f32 v8, v68, v69
    v_mfma_f32_16x16x32_bf16 v[228:231], a[116:119], v[40:43], v[228:231]
    s_waitcnt lgkmcnt(3)
    ds_write_b32 v134, v8 offset:3072
    v_mfma_f32_16x16x32_bf16 v[72:75], a[48:51], v[98:101], 0
    v_mul_f32 v70, v70, v108
    v_mul_f32 v71, v71, v108
    v_mfma_f32_16x16x32_bf16 v[72:75], a[52:55], v[140:143], v[72:75]
    buffer_load_dwordx4 v[224:227], v121, s[76:79], s92 offen offset:2048 sc1
    v_cvt_pk_bf16_f32 v9, v70, v71
    v_mfma_f32_16x16x32_bf16 v[72:75], a[56:59], v[116:119], v[72:75]
    ds_write_b32 v134, v9 offset:3076
    v_mfma_f32_16x16x32_bf16 v[72:75], a[60:63], v[92:95], v[72:75]
    s_waitcnt lgkmcnt(3)
    v_cvt_pk_f16_f32 v14, v228, v229
    v_cvt_pk_f16_f32 v15, v230, v231
    v_mfma_f32_16x16x32_bf16 v[72:75], a[64:67], v[80:83], v[72:75]
    v_pk_fmac_f16 v37, v14, v14
    v_pk_fmac_f16 v37, v15, v15
    v_mfma_f32_16x16x32_bf16 v[72:75], a[68:71], v[56:59], v[72:75]
    v_pk_fmac_f16 v37, v154, v154
    v_pk_fmac_f16 v37, v155, v155
    v_mfma_f32_16x16x32_bf16 v[252:255], a[72:75], v[98:101], 0
    buffer_load_dwordx4 v[228:231], v121, s[76:79], s92 offen offset:3072 sc1
    v_cvt_pk_bf16_f32 v29, v10, v11
    v_mfma_f32_16x16x32_bf16 v[252:255], a[76:79], v[140:143], v[252:255]
    s_movk_i32 s92, 12288
    ds_write_b32 v135, v249 offset:1540
    v_mfma_f32_16x16x32_bf16 v[252:255], a[80:83], v[116:119], v[252:255]
    v_and_b32 v11, 0xb8000000, v123
    v_cmp_ne_u32 s[94:95], 0, v11
    v_mfma_f32_16x16x32_bf16 v[252:255], a[84:87], v[92:95], v[252:255]
    ds_write_b64 v134, v[28:29] offset:1536
    v_mfma_f32_16x16x32_bf16 v[252:255], a[88:91], v[80:83], v[252:255]
    s_or_b32 s94, s94, s95
    v_mov_b32 v11, s94
    v_add_u32 v147, s93, v129
    v_mfma_f32_16x16x32_bf16 v[252:255], a[92:95], v[56:59], v[252:255]
    s_lshl_b32 s95, s68, 2
    buffer_load_dwordx4 v[232:235], v121, s[76:79], s92 offen offset:0 sc1
    v_mov_b32 v10, s95
    v_mfma_f32_16x16x32_bf16 v[68:71], v[236:239], v[0:3], 0
    s_sub_u32 s50, s45, s44
    ds_write_b32 v135, v248 offset:1536
    v_mfma_f32_16x16x32_bf16 v[68:71], v[60:63], v[164:167], v[68:71]
    s_sub_u32 s51, s46, s47
    v_cvt_pk_f16_f32 v8, v252, v253
    v_cvt_pk_f16_f32 v9, v254, v255
    v_mfma_f32_16x16x32_bf16 v[108:111], v[236:239], v[20:23], 0
    s_mov_b32 s60, s59
    ds_write_b64 v135, v[250:251] offset:1544
    v_mfma_f32_16x16x32_bf16 v[108:111], v[60:63], v[160:163], v[108:111]
    s_mov_b32 s59, s58
    v_pk_fma_f16 v39, v8, v8, s3
    v_pk_fmac_f16 v39, v9, v9
    v_mfma_f32_16x16x32_bf16 v[20:23], v[236:239], v[4:7], 0
    s_mov_b32 s58, s57
    buffer_load_dwordx4 v[236:239], v121, s[76:79], s92 offen offset:1024 sc1
    v_cvt_pk_bf16_f32 v0, v244, v245
    v_mfma_f32_16x16x32_bf16 v[20:23], v[60:63], v[156:159], v[20:23]
    s_mov_b32 s57, s56
    v_cvt_pk_bf16_f32 v1, v246, v247
    v_mov_b32_dpp v71, v111 quad_perm:[0,1,2,3] row_mask:0x2 bank_mask:0xf
    v_mfma_f32_16x16x32_bf16 v[60:63], a[24:27], v[98:101], 0
    s_mov_b32 s7, s6
    v_cvt_pk_bf16_f32 v4, v240, v241
    v_cvt_pk_bf16_f32 v5, v242, v243
    v_mfma_f32_16x16x32_bf16 v[60:63], a[28:31], v[140:143], v[60:63]
    s_mov_b32 s6, s5
    v_mov_b32_dpp v71, v23 quad_perm:[0,1,2,3] row_mask:0x4 bank_mask:0xf
    v_cvt_pk_bf16_f32 v71, v71, v71
    v_mfma_f32_16x16x32_bf16 v[60:63], a[32:35], v[116:119], v[60:63]
    s_mov_b32 s5, s4
    ds_write_b16 v131, v71
    v_mfma_f32_16x16x32_bf16 v[60:63], a[36:39], v[92:95], v[60:63]
    s_sub_u32 s14, s6, s7
    buffer_load_dwordx4 v[240:243], v121, s[76:79], s92 offen offset:2048 sc1
    v_pk_mul_f16 v112, v112, v34 op_sel:[0,0] op_sel_hi:[1,0]
    v_mfma_f32_16x16x32_bf16 v[60:63], a[40:43], v[80:83], v[60:63]
    s_add_u32 s61, s61, 1
    v_pk_mul_f16 v113, v113, v34 op_sel:[0,0] op_sel_hi:[1,0]
    v_pk_mul_f16 v114, v114, v34 op_sel:[0,0] op_sel_hi:[1,0]
    v_mfma_f32_16x16x32_bf16 v[60:63], a[44:47], v[56:59], v[60:63]
    s_add_u32 s12, s12, 20
    v_pk_mul_f16 v115, v115, v34 op_sel:[0,0] op_sel_hi:[1,0]
    v_pk_mul_f16 v88, v88, v34 op_sel:[0,0] op_sel_hi:[1,0]
    v_mfma_f32_16x16x32_bf16 v[20:23], a[0:3], v[64:67], 0
    s_max_u32 s12, s12, s61
    v_add_u32 v135, s49, v135
    v_add_u32 v134, s49, v134
    v_mfma_f32_16x16x32_bf16 v[20:23], a[4:7], v[24:27], v[20:23]
    s_cmp_lt_u32 s61, s71
    v_cvt_pk_f16_f32 v26, v60, v61
    v_cvt_pk_f16_f32 v27, v62, v63
    v_mfma_f32_16x16x32_bf16 v[20:23], a[8:11], v[52:55], v[20:23]
    s_cselect_b32 s15, s61, s12
    buffer_load_dwordx4 v[244:247], v121, s[76:79], s92 offen offset:3072 sc1
    v_pk_mul_f16 v89, v89, v34 op_sel:[0,0] op_sel_hi:[1,0]
    v_mfma_f32_16x16x32_bf16 v[20:23], a[12:15], v[48:51], v[20:23]
    s_movk_i32 s92, 16384
    v_pk_mul_f16 v84, v84, v34 op_sel:[0,1] op_sel_hi:[1,1]
    v_pk_mul_f16 v85, v85, v34 op_sel:[0,1] op_sel_hi:[1,1]
    v_mfma_f32_16x16x32_bf16 v[20:23], a[16:19], v[44:47], v[20:23]
    s_cselect_b32 s56, s69, s70
    v_pk_mul_f16 v86, v86, v34 op_sel:[0,1] op_sel_hi:[1,1]
    v_pk_mul_f16 v87, v87, v34 op_sel:[0,1] op_sel_hi:[1,1]
    v_mfma_f32_16x16x32_bf16 v[20:23], a[20:23], v[40:43], v[20:23]
    s_add_u32 s56, s56, s15
    v_pk_mul_f16 v102, v102, v34 op_sel:[0,1] op_sel_hi:[1,1]
    v_pk_mul_f16 v103, v103, v34 op_sel:[0,1] op_sel_hi:[1,1]
    v_mfma_f32_16x16x32_bf16 v[60:63], v[98:101], a[144:147], 0
    s_mul_i32 s53, s56, 58255
    v_fma_mix_f32 v120, v112, v84, 0 op_sel:[0,0,0] op_sel_hi:[1,1,0]
    v_fma_mix_f32 v120, v112, v84, v120 op_sel:[1,1,0] op_sel_hi:[1,1,0]
    v_mfma_f32_16x16x32_bf16 v[60:63], v[140:143], a[148:151], v[60:63]
    s_lshr_b32 s53, s53, 22
    buffer_load_dwordx4 v[248:251], v121, s[76:79], s92 offen offset:0 sc1
    v_cvt_pk_f16_f32 v28, v20, v21
    v_mfma_f32_16x16x32_bf16 v[60:63], v[116:119], a[152:155], v[60:63]
    s_mul_i32 s53, s53, s63
    ds_read_b128 v[32:35], v137 offset:3328
    v_cvt_pk_f16_f32 v29, v22, v23
    v_mfma_f32_16x16x32_bf16 v[60:63], v[92:95], a[156:159], v[60:63]
    s_mul_i32 s56, s56, s62
    v_pk_fma_f16 v36, v28, v28, s3
    v_pk_fmac_f16 v36, v29, v29
    v_mfma_f32_16x16x32_bf16 v[60:63], v[80:83], a[160:163], v[60:63]
    s_add_u32 s56, s56, s53
    ds_read_b128 v[44:47], v136 offset:3328
    v_pk_fmac_f16 v36, v30, v30
    v_mfma_f32_16x16x32_bf16 v[60:63], v[56:59], a[164:167], v[60:63]
    s_mul_i32 s4, s15, 112
    v_pk_fmac_f16 v36, v31, v31
    v_pk_fmac_f16 v36, v152, v152
    v_mfma_f32_16x16x32_bf16 v[108:111], v[98:101], a[192:195], 0
    s_cmp_ge_u32 s15, 16
    buffer_load_dwordx4 v[252:255], v121, s[76:79], s92 offen offset:1024 sc1
    v_pk_fmac_f16 v36, v153, v153
    v_mfma_f32_16x16x32_bf16 v[108:111], v[140:143], a[196:199], v[108:111]
    s_cselect_b32 s53, -30464, 0
    ds_read_b128 v[40:43], v137 offset:3200
    v_fma_mix_f32 v120, v113, v85, v120 op_sel:[0,0,0] op_sel_hi:[1,1,0]
    v_mfma_f32_16x16x32_bf16 v[108:111], v[116:119], a[200:203], v[108:111]
    s_add_u32 s4, s4, s53
    ds_read_b128 v[48:51], v136 offset:3200
    v_fma_mix_f32 v120, v113, v85, v120 op_sel:[1,1,0] op_sel_hi:[1,1,0]
    v_mfma_f32_16x16x32_bf16 v[108:111], v[92:95], a[204:207], v[108:111]
    s_cmp_lt_u32 s15, s73
    v_fma_mix_f32 v120, v114, v86, v120 op_sel:[0,0,0] op_sel_hi:[1,1,0]
    v_fma_mix_f32 v120, v114, v86, v120 op_sel:[1,1,0] op_sel_hi:[1,1,0]
    v_mfma_f32_16x16x32_bf16 v[108:111], v[80:83], a[208:211], v[108:111]
    s_cselect_b32 s26, 100270464, 0
    v_fma_mix_f32 v120, v115, v87, v120 op_sel:[0,0,0] op_sel_hi:[1,1,0]
    v_fma_mix_f32 v120, v115, v87, v120 op_sel:[1,1,0] op_sel_hi:[1,1,0]
    v_mfma_f32_16x16x32_bf16 v[108:111], v[56:59], a[212:215], v[108:111]
    s_cselect_b32 s56, s56, 0
    ds_read_b128 v[64:67], v137 offset:3072
    v_fma_mix_f32 v120, v88, v102, v120 op_sel:[0,0,0] op_sel_hi:[1,1,0]
    v_mfma_f32_16x16x32_bf16 v[20:23], a[96:99], v[98:101], 0
    s_cselect_b32 s4, s4, -1
    ds_read_b128 v[52:55], v136 offset:3072
    v_fma_mix_f32 v120, v88, v102, v120 op_sel:[1,1,0] op_sel_hi:[1,1,0]
    v_mfma_f32_16x16x32_bf16 v[20:23], a[100:103], v[140:143], v[20:23]
    s_cselect_b32 s15, s15, 0
    v_cvt_pk_bf16_f32 v6, v108, v109
    v_cvt_pk_bf16_f32 v7, v110, v111
    v_mfma_f32_16x16x32_bf16 v[20:23], a[104:107], v[116:119], v[20:23]
    s_cselect_b32 s13, s13, -1
    v_fma_mix_f32 v120, v89, v103, v120 op_sel:[0,0,0] op_sel_hi:[1,1,0]
    v_fma_mix_f32 v120, v89, v103, v120 op_sel:[1,1,0] op_sel_hi:[1,1,0]
    v_mfma_f32_16x16x32_bf16 v[20:23], a[108:111], v[92:95], v[20:23]
    s_bitset1_b32 s64, s15
    v_mov_b32 v121, v120
    v_cvt_pk_f16_f32 v146, v72, v73
    v_mfma_f32_16x16x32_bf16 v[20:23], a[112:115], v[80:83], v[20:23]
    s_add_u32 s65, s65, 1
    v_permlane32_swap_b32 v121, v120
    v_mfma_f32_16x16x32_bf16 v[20:23], a[116:119], v[56:59], v[20:23]
    s_cmp_ge_i32 s65, 2
    ds_write_b32 v10, v11 offset:14848
    v_mfma_f32_16x16x32_bf16 v[68:71], v[98:101], a[168:171], 0
    s_cselect_b32 s30, 100270464, 0
    v_add_f32 v120, v121, v120
    v_mov_b32 v121, v120
    v_mfma_f32_16x16x32_bf16 v[68:71], v[140:143], a[172:175], v[68:71]
    s_add_u32 s67, s46, s54
    v_cvt_pk_f16_f32 v10, v20, v21
    v_cvt_pk_f16_f32 v11, v22, v23
    v_mfma_f32_16x16x32_bf16 v[68:71], v[116:119], a[176:179], v[68:71]
    s_add_u32 m0, s67, 0
    v_pk_fmac_f16 v39, v10, v10
    v_pk_fmac_f16 v39, v11, v11
    v_mfma_f32_16x16x32_bf16 v[68:71], v[92:95], a[180:183], v[68:71]
    ds_write_b128 v147, v[104:107] offset:6144
    v_mfma_f32_16x16x32_bf16 v[68:71], v[80:83], a[184:187], v[68:71]
    v_permlane16_swap_b32 v121, v120
    v_mfma_f32_16x16x32_bf16 v[68:71], v[56:59], a[188:191], v[68:71]
    s_nop 0
    v_add_f32 v120, v121, v120
    v_add_f32 v120, s84, v120
    v_mfma_f32_16x16x32_bf16 v[108:111], a[0:3], v[98:101], 0
    s_nop 0
    ds_write_b64 v38, v[90:91] offset:80
    v_mfma_f32_16x16x32_bf16 v[108:111], a[4:7], v[140:143], v[108:111]
    s_nop 0
    v_cvt_pk_bf16_f32 v22, v68, v69
    v_cvt_pk_bf16_f32 v23, v70, v71
    v_mfma_f32_16x16x32_bf16 v[108:111], a[8:11], v[116:119], v[108:111]
    ds_write_b128 v38, v[76:79] offset:96
    v_mfma_f32_16x16x32_bf16 v[108:111], a[12:15], v[92:95], v[108:111]
    v_mov_b32 v2, 0
    v_mov_b32 v3, 0
    v_mfma_f32_16x16x32_bf16 v[108:111], a[16:19], v[80:83], v[108:111]
    v_mov_b32 v121, 0
    v_add_u32 v20, 0, v38
    v_mfma_f32_16x16x32_bf16 v[108:111], a[20:23], v[56:59], v[108:111]
    s_nop 0
    ds_write2_b64 v20, v[2:3], v[2:3] offset0:2 offset1:3
    v_mfma_f32_16x16x32_bf16 v[76:79], a[120:123], v[98:101], 0
    s_nop 0
    v_exp_f32 v120, v120
    v_mfma_f32_16x16x32_bf16 v[76:79], a[124:127], v[140:143], v[76:79]
    s_nop 0
    v_cvt_pk_bf16_f32 v120, v120, 0
    v_cvt_pk_f16_f32 v24, v108, v109
    v_mfma_f32_16x16x32_bf16 v[76:79], a[128:131], v[116:119], v[76:79]
    ds_write_b128 v20, v[112:115] offset:32
    v_mfma_f32_16x16x32_bf16 v[76:79], a[132:135], v[92:95], v[76:79]
    v_cvt_pk_f16_f32 v25, v110, v111
    v_pk_fma_f16 v38, v24, v24, s3
    v_mfma_f32_16x16x32_bf16 v[76:79], a[136:139], v[80:83], v[76:79]
    v_pk_fmac_f16 v38, v25, v25
    v_pk_fmac_f16 v38, v26, v26
    v_mfma_f32_16x16x32_bf16 v[76:79], a[140:143], v[56:59], v[76:79]
    s_waitcnt lgkmcnt(2)
    ds_write2_b64 v20, v[2:3], v[88:89] offset0:8 offset1:9
    v_mfma_f32_16x16x32_bf16 v[68:71], a[120:123], v[64:67], 0
    v_pk_fmac_f16 v38, v27, v27
    v_cmp_gt_u32 vcc, 16, v97
    v_mfma_f32_16x16x32_bf16 v[68:71], a[124:127], v[52:55], v[68:71]
    s_nop 0
    v_cndmask_b32 v120, 0, v120, vcc
    v_cvt_pk_f16_f32 v148, v76, v77
    v_mfma_f32_16x16x32_bf16 v[68:71], a[128:131], v[40:43], v[68:71]
    ds_write_b128 v20, v[84:87]
    v_mfma_f32_16x16x32_bf16 v[68:71], a[132:135], v[48:51], v[68:71]
    v_cvt_pk_f16_f32 v149, v78, v79
    v_pk_fmac_f16 v39, v148, v148
    v_mfma_f32_16x16x32_bf16 v[68:71], a[136:139], v[32:35], v[68:71]
    v_pk_fmac_f16 v39, v149, v149
    v_cvt_pk_f16_f32 v147, v74, v75
    v_mfma_f32_16x16x32_bf16 v[68:71], a[140:143], v[44:47], v[68:71]
    ds_write2_b64 v20, v[102:103], v[2:3] offset0:6 offset1:7
    v_mfma_f32_16x16x32_bf16 v[56:59], a[72:75], v[64:67], 0
    v_pk_fmac_f16 v38, v146, v146
    v_pk_fmac_f16 v38, v147, v147
    v_mfma_f32_16x16x32_bf16 v[56:59], a[76:79], v[52:55], v[56:59]
    v_cvt_pk_bf16_f32 v2, v60, v61
    v_cvt_pk_bf16_f32 v3, v62, v63
    v_mfma_f32_16x16x32_bf16 v[56:59], a[80:83], v[40:43], v[56:59]
    s_waitcnt vmcnt(0)
    ds_write_b64 v20, v[120:121] offset:88
    v_mfma_f32_16x16x32_bf16 v[56:59], a[84:87], v[48:51], v[56:59]
    s_barrier
    v_add_u32 v137, s50, v137
    v_add_u32 v136, s50, v136
    v_mfma_f32_16x16x32_bf16 v[56:59], a[88:91], v[32:35], v[56:59]
    ds_read_b128 v[60:63], v122 offset:14848
    v_add_u32 v135, s48, v135
    v_mfma_f32_16x16x32_bf16 v[56:59], a[92:95], v[44:47], v[56:59]
    v_add_u32 v133, s51, v133
    v_add_u32 v132, s14, v132
    v_mfma_f32_16x16x32_f16 v[76:79], v[212:215], v[36:39], 0
    s_nop 0
    v_cvt_pk_f16_f32 v142, v68, v69
    v_cvt_pk_f16_f32 v143, v70, v71
    v_mfma_f32_16x16x32_bf16 v[92:95], a[0:3], v[64:67], 0
    s_nop 0
    v_cvt_pk_f16_f32 v56, v56, v57
    v_cvt_pk_f16_f32 v57, v58, v59
    v_mfma_f32_16x16x32_bf16 v[92:95], a[4:7], v[52:55], v[92:95]
    v_or3_b32 v123, v123, v76, v77
    v_or3_b32 v123, v123, v78, v79
    v_mfma_f32_16x16x32_bf16 v[80:83], v[64:67], a[168:171], 0
    v_rsq_f32 v76, v76
    v_mfma_f32_16x16x32_bf16 v[80:83], v[52:55], a[172:175], v[80:83]
    v_rsq_f32 v77, v77
    v_mfma_f32_16x16x32_bf16 v[80:83], v[40:43], a[176:179], v[80:83]
    v_mul_f32 v76, s52, v76
    v_cvt_pk_f16_f32 v76, v76, v77
    v_mfma_f32_16x16x32_bf16 v[80:83], v[48:51], a[180:183], v[80:83]
    v_pk_mul_f16 v12, v12, v76 op_sel:[0,1] op_sel_hi:[1,1]
    v_pk_mul_f16 v13, v13, v76 op_sel:[0,1] op_sel_hi:[1,1]
    v_mfma_f32_16x16x32_bf16 v[80:83], v[32:35], a[184:187], v[80:83]
    v_rsq_f32 v78, v78
    v_mfma_f32_16x16x32_bf16 v[80:83], v[44:47], a[188:191], v[80:83]
    v_rsq_f32 v79, v79
    v_mfma_f32_16x16x32_bf16 v[98:101], v[64:67], a[144:147], 0
    v_mul_f32 v78, s52, v78
    v_cvt_pk_f16_f32 v78, v78, v79
    v_mfma_f32_16x16x32_bf16 v[98:101], v[52:55], a[148:151], v[98:101]
    s_waitcnt lgkmcnt(0)
    v_or3_b32 v60, v60, v61, v62
    v_or_b32 v60, v60, v63
    v_mfma_f32_16x16x32_bf16 v[98:101], v[40:43], a[152:155], v[98:101]
    v_readfirstlane_b32 s75, v60
    v_pk_mul_f16 v8, v8, v78 op_sel:[0,1] op_sel_hi:[1,1]
    v_mfma_f32_16x16x32_bf16 v[98:101], v[48:51], a[156:159], v[98:101]
    v_pk_mul_f16 v9, v9, v78 op_sel:[0,1] op_sel_hi:[1,1]
    v_pk_mul_f16 v10, v10, v78 op_sel:[0,1] op_sel_hi:[1,1]
    v_mfma_f32_16x16x32_bf16 v[98:101], v[32:35], a[160:163], v[98:101]
    v_pk_mul_f16 v11, v11, v78 op_sel:[0,1] op_sel_hi:[1,1]
    v_pk_mul_f16 v148, v148, v78 op_sel:[0,1] op_sel_hi:[1,1]
    v_mfma_f32_16x16x32_bf16 v[98:101], v[44:47], a[164:167], v[98:101]
    v_pk_mul_f16 v149, v149, v78 op_sel:[0,1] op_sel_hi:[1,1]
    v_pk_fma_f16 v37, v56, v56, s3
    v_pk_fmac_f16 v37, v57, v57
    s_waitcnt lgkmcnt(0)
    s_cmp_lg_u32 s75, 0
    s_cbranch_scc0 L_atomF0r
    s_branch L_slow
L_bndF:
    s_movk_i32 s73, 20
    s_movk_i32 s71, 18
    s_movk_i32 s70, -20
    s_mov_b32 s74, 0
    s_bitcmp1_b32 s2, 2
    s_cbranch_scc1 L_bndcF
    s_sub_u32 s94, s2, 248
    s_mul_i32 s69, s94, 18
    s_mov_b32 s74, 2
    s_sub_u32 s93, s93, 1373568
    v_cmp_le_u32 vcc, 4, v96
    v_add_u32 v138, 98896896, v128
    v_subrev_u32 v139, 1373568, v128
    v_cndmask_b32 v128, v138, v139, vcc
    v_cmp_le_u32 vcc, 4, v0
    v_add_u32 v138, 98896896, v127
    v_subrev_u32 v139, 1373568, v127
    v_cndmask_b32 v127, v138, v139, vcc
    v_cmp_le_u32 vcc, 4, v104
    v_add_u32 v138, 98896896, v126
    v_subrev_u32 v139, 1373568, v126
    v_cndmask_b32 v126, v138, v139, vcc
    v_cmp_le_u32 vcc, 4, v98
    v_add_u32 v138, 98896896, v125
    v_subrev_u32 v139, 1373568, v125
    v_cndmask_b32 v125, v138, v139, vcc
    v_cmp_le_u32 vcc, 4, v122
    v_add_u32 v138, 98896896, v124
    v_subrev_u32 v139, 1373568, v124
    v_cndmask_b32 v124, v138, v139, vcc
    s_cmp_lt_u32 s2, 256
    s_cbranch_scc1 L_bndrF
L_bndcF:
    s_sub_u32 s94, s2, 252
    s_mul_i32 s69, s94, 20
    s_lshr_b32 s71, s94, 1
    s_sub_u32 s69, s69, s71
    s_and_b32 s94, s94, 1
    s_sub_u32 s71, 20, s94
    s_cmp_eq_u32 s2, 255
    s_cselect_b32 s71, 13, s71
    s_mov_b32 s62, 1373568
    s_add_u32 s74, s74, 1
    s_sub_u32 s93, s93, 2688
    v_mad_i32_i24 v138, v96, -7, v1
    v_cmp_le_u32 vcc, 4, v138
    v_add_u32 v138, 193536, v128
    v_subrev_u32 v139, 2688, v128
    v_cndmask_b32 v128, v138, v139, vcc
    v_mad_i32_i24 v138, v0, -7, v105
    v_cmp_le_u32 vcc, 4, v138
    v_add_u32 v138, 193536, v127
    v_subrev_u32 v139, 2688, v127
    v_cndmask_b32 v127, v138, v139, vcc
    v_mad_i32_i24 v138, v104, -7, v120
    v_cmp_le_u32 vcc, 4, v138
    v_add_u32 v138, 193536, v126
    v_subrev_u32 v139, 2688, v126
    v_cndmask_b32 v126, v138, v139, vcc
    v_mad_i32_i24 v138, v98, -7, v99
    v_cmp_le_u32 vcc, 4, v138
    v_add_u32 v138, 193536, v125
    v_subrev_u32 v139, 2688, v125
    v_cndmask_b32 v125, v138, v139, vcc
    v_mad_i32_i24 v138, v122, -7, v32
    v_cmp_le_u32 vcc, 4, v138
    v_add_u32 v138, 193536, v124
    v_subrev_u32 v139, 2688, v124
    v_cndmask_b32 v124, v138, v139, vcc
    s_cmp_eq_u32 s2, 256
    s_cselect_b32 s62, 0, s62
    s_cselect_b32 s69, 0, s69
    s_cselect_b32 s71, 2, s71
    s_branch L_bndrF
L_maskF:
    s_and_b32 s20, s74, 2
    s_and_b32 s21, s74, 1
    s_mov_b32 s22, 0xc31044fe
    v_lshrrev_b32 v142, 2, v4
    v_add_u32 v142, 0, v142
    v_mul_u32_u24 v139, 37, v142
    v_lshrrev_b32 v138, 8, v139
    v_mad_i32_i24 v138, v138, -7, v142
    v_lshrrev_b32 v139, 10, v139
    v_lshrrev_b32 v138, 2, v138
    v_mul_u32_u24 v139, s20, v139
    v_mad_u32_u24 v142, v138, s21, v139
    v_cvt_f32_u32 v142, v142
    v_lshrrev_b32 v143, 2, v4
    v_add_u32 v143, 4, v143
    v_mul_u32_u24 v139, 37, v143
    v_lshrrev_b32 v138, 8, v139
    v_mad_i32_i24 v138, v138, -7, v143
    v_lshrrev_b32 v139, 10, v139
    v_lshrrev_b32 v138, 2, v138
    v_mul_u32_u24 v139, s20, v139
    v_mad_u32_u24 v143, v138, s21, v139
    v_cvt_f32_u32 v143, v143
    v_lshrrev_b32 v5, 2, v4
    v_add_u32 v5, 8, v5
    v_mul_u32_u24 v139, 37, v5
    v_lshrrev_b32 v138, 8, v139
    v_mad_i32_i24 v138, v138, -7, v5
    v_lshrrev_b32 v139, 10, v139
    v_lshrrev_b32 v138, 2, v138
    v_mul_u32_u24 v139, s20, v139
    v_mad_u32_u24 v5, v138, s21, v139
    v_cvt_f32_u32 v5, v5
    v_mad_u32_u24 v144, v3, 12, 0
    v_mul_u32_u24 v139, 37, v144
    v_lshrrev_b32 v138, 8, v139
    v_mad_i32_i24 v138, v138, -7, v144
    v_lshrrev_b32 v139, 10, v139
    v_lshrrev_b32 v138, 2, v138
    v_mul_u32_u24 v139, s20, v139
    v_mad_u32_u24 v144, v138, s21, v139
    v_cvt_f32_u32 v144, v144
    v_sub_f32 v139, v142, v144
    v_mul_f32 v139, v139, v139 clamp
    v_fmac_f32 v204, s22, v139
    v_sub_f32 v139, v143, v144
    v_mul_f32 v139, v139, v139 clamp
    v_fmac_f32 v192, s22, v139
    v_sub_f32 v139, v5, v144
    v_mul_f32 v139, v139, v139 clamp
    v_fmac_f32 v180, s22, v139
    v_mad_u32_u24 v144, v3, 12, 1
    v_mul_u32_u24 v139, 37, v144
    v_lshrrev_b32 v138, 8, v139
    v_mad_i32_i24 v138, v138, -7, v144
    v_lshrrev_b32 v139, 10, v139
    v_lshrrev_b32 v138, 2, v138
    v_mul_u32_u24 v139, s20, v139
    v_mad_u32_u24 v144, v138, s21, v139
    v_cvt_f32_u32 v144, v144
    v_sub_f32 v139, v142, v144
    v_mul_f32 v139, v139, v139 clamp
    v_fmac_f32 v205, s22, v139
    v_sub_f32 v139, v143, v144
    v_mul_f32 v139, v139, v139 clamp
    v_fmac_f32 v193, s22, v139
    v_sub_f32 v139, v5, v144
    v_mul_f32 v139, v139, v139 clamp
    v_fmac_f32 v181, s22, v139
    v_mad_u32_u24 v144, v3, 12, 2
    v_mul_u32_u24 v139, 37, v144
    v_lshrrev_b32 v138, 8, v139
    v_mad_i32_i24 v138, v138, -7, v144
    v_lshrrev_b32 v139, 10, v139
    v_lshrrev_b32 v138, 2, v138
    v_mul_u32_u24 v139, s20, v139
    v_mad_u32_u24 v144, v138, s21, v139
    v_cvt_f32_u32 v144, v144
    v_sub_f32 v139, v142, v144
    v_mul_f32 v139, v139, v139 clamp
    v_fmac_f32 v206, s22, v139
    v_sub_f32 v139, v143, v144
    v_mul_f32 v139, v139, v139 clamp
    v_fmac_f32 v194, s22, v139
    v_sub_f32 v139, v5, v144
    v_mul_f32 v139, v139, v139 clamp
    v_fmac_f32 v182, s22, v139
    v_mad_u32_u24 v144, v3, 12, 3
    v_mul_u32_u24 v139, 37, v144
    v_lshrrev_b32 v138, 8, v139
    v_mad_i32_i24 v138, v138, -7, v144
    v_lshrrev_b32 v139, 10, v139
    v_lshrrev_b32 v138, 2, v138
    v_mul_u32_u24 v139, s20, v139
    v_mad_u32_u24 v144, v138, s21, v139
    v_cvt_f32_u32 v144, v144
    v_sub_f32 v139, v142, v144
    v_mul_f32 v139, v139, v139 clamp
    v_fmac_f32 v207, s22, v139
    v_sub_f32 v139, v143, v144
    v_mul_f32 v139, v139, v139 clamp
    v_fmac_f32 v195, s22, v139
    v_sub_f32 v139, v5, v144
    v_mul_f32 v139, v139, v139 clamp
    v_fmac_f32 v183, s22, v139
    v_mad_u32_u24 v144, v3, 12, 4
    v_mul_u32_u24 v139, 37, v144
    v_lshrrev_b32 v138, 8, v139
    v_mad_i32_i24 v138, v138, -7, v144
    v_lshrrev_b32 v139, 10, v139
    v_lshrrev_b32 v138, 2, v138
    v_mul_u32_u24 v139, s20, v139
    v_mad_u32_u24 v144, v138, s21, v139
    v_cvt_f32_u32 v144, v144
    v_sub_f32 v139, v142, v144
    v_mul_f32 v139, v139, v139 clamp
    v_fmac_f32 v200, s22, v139
    v_sub_f32 v139, v143, v144
    v_mul_f32 v139, v139, v139 clamp
    v_fmac_f32 v188, s22, v139
    v_sub_f32 v139, v5, v144
    v_mul_f32 v139, v139, v139 clamp
    v_fmac_f32 v176, s22, v139
    v_mad_u32_u24 v144, v3, 12, 5
    v_mul_u32_u24 v139, 37, v144
    v_lshrrev_b32 v138, 8, v139
    v_mad_i32_i24 v138, v138, -7, v144
    v_lshrrev_b32 v139, 10, v139
    v_lshrrev_b32 v138, 2, v138
    v_mul_u32_u24 v139, s20, v139
    v_mad_u32_u24 v144, v138, s21, v139
    v_cvt_f32_u32 v144, v144
    v_sub_f32 v139, v142, v144
    v_mul_f32 v139, v139, v139 clamp
    v_fmac_f32 v201, s22, v139
    v_sub_f32 v139, v143, v144
    v_mul_f32 v139, v139, v139 clamp
    v_fmac_f32 v189, s22, v139
    v_sub_f32 v139, v5, v144
    v_mul_f32 v139, v139, v139 clamp
    v_fmac_f32 v177, s22, v139
    v_mad_u32_u24 v144, v3, 12, 6
    v_mul_u32_u24 v139, 37, v144
    v_lshrrev_b32 v138, 8, v139
    v_mad_i32_i24 v138, v138, -7, v144
    v_lshrrev_b32 v139, 10, v139
    v_lshrrev_b32 v138, 2, v138
    v_mul_u32_u24 v139, s20, v139
    v_mad_u32_u24 v144, v138, s21, v139
    v_cvt_f32_u32 v144, v144
    v_sub_f32 v139, v142, v144
    v_mul_f32 v139, v139, v139 clamp
    v_fmac_f32 v202, s22, v139
    v_sub_f32 v139, v143, v144
    v_mul_f32 v139, v139, v139 clamp
    v_fmac_f32 v190, s22, v139
    v_sub_f32 v139, v5, v144
    v_mul_f32 v139, v139, v139 clamp
    v_fmac_f32 v178, s22, v139
    v_mad_u32_u24 v144, v3, 12, 7
    v_mul_u32_u24 v139, 37, v144
    v_lshrrev_b32 v138, 8, v139
    v_mad_i32_i24 v138, v138, -7, v144
    v_lshrrev_b32 v139, 10, v139
    v_lshrrev_b32 v138, 2, v138
    v_mul_u32_u24 v139, s20, v139
    v_mad_u32_u24 v144, v138, s21, v139
    v_cvt_f32_u32 v144, v144
    v_sub_f32 v139, v142, v144
    v_mul_f32 v139, v139, v139 clamp
    v_fmac_f32 v203, s22, v139
    v_sub_f32 v139, v143, v144
    v_mul_f32 v139, v139, v139 clamp
    v_fmac_f32 v191, s22, v139
    v_sub_f32 v139, v5, v144
    v_mul_f32 v139, v139, v139 clamp
    v_fmac_f32 v179, s22, v139
    v_mad_u32_u24 v144, v3, 12, 8
    v_mul_u32_u24 v139, 37, v144
    v_lshrrev_b32 v138, 8, v139
    v_mad_i32_i24 v138, v138, -7, v144
    v_lshrrev_b32 v139, 10, v139
    v_lshrrev_b32 v138, 2, v138
    v_mul_u32_u24 v139, s20, v139
    v_mad_u32_u24 v144, v138, s21, v139
    v_cvt_f32_u32 v144, v144
    v_sub_f32 v139, v142, v144
    v_mul_f32 v139, v139, v139 clamp
    v_fmac_f32 v196, s22, v139
    v_sub_f32 v139, v143, v144
    v_mul_f32 v139, v139, v139 clamp
    v_fmac_f32 v184, s22, v139
    v_sub_f32 v139, v5, v144
    v_mul_f32 v139, v139, v139 clamp
    v_fmac_f32 v172, s22, v139
    v_mad_u32_u24 v144, v3, 12, 9
    v_mul_u32_u24 v139, 37, v144
    v_lshrrev_b32 v138, 8, v139
    v_mad_i32_i24 v138, v138, -7, v144
    v_lshrrev_b32 v139, 10, v139
    v_lshrrev_b32 v138, 2, v138
    v_mul_u32_u24 v139, s20, v139
    v_mad_u32_u24 v144, v138, s21, v139
    v_cvt_f32_u32 v144, v144
    v_sub_f32 v139, v142, v144
    v_mul_f32 v139, v139, v139 clamp
    v_fmac_f32 v197, s22, v139
    v_sub_f32 v139, v143, v144
    v_mul_f32 v139, v139, v139 clamp
    v_fmac_f32 v185, s22, v139
    v_sub_f32 v139, v5, v144
    v_mul_f32 v139, v139, v139 clamp
    v_fmac_f32 v173, s22, v139
    v_mad_u32_u24 v144, v3, 12, 10
    v_mul_u32_u24 v139, 37, v144
    v_lshrrev_b32 v138, 8, v139
    v_mad_i32_i24 v138, v138, -7, v144
    v_lshrrev_b32 v139, 10, v139
    v_lshrrev_b32 v138, 2, v138
    v_mul_u32_u24 v139, s20, v139
    v_mad_u32_u24 v144, v138, s21, v139
    v_cvt_f32_u32 v144, v144
    v_sub_f32 v139, v142, v144
    v_mul_f32 v139, v139, v139 clamp
    v_fmac_f32 v198, s22, v139
    v_sub_f32 v139, v143, v144
    v_mul_f32 v139, v139, v139 clamp
    v_fmac_f32 v186, s22, v139
    v_sub_f32 v139, v5, v144
    v_mul_f32 v139, v139, v139 clamp
    v_fmac_f32 v174, s22, v139
    v_mad_u32_u24 v144, v3, 12, 11
    v_mul_u32_u24 v139, 37, v144
    v_lshrrev_b32 v138, 8, v139
    v_mad_i32_i24 v138, v138, -7, v144
    v_lshrrev_b32 v139, 10, v139
    v_lshrrev_b32 v138, 2, v138
    v_mul_u32_u24 v139, s20, v139
    v_mad_u32_u24 v144, v138, s21, v139
    v_cvt_f32_u32 v144, v144
    v_sub_f32 v139, v142, v144
    v_mul_f32 v139, v139, v139 clamp
    v_fmac_f32 v199, s22, v139
    v_sub_f32 v139, v143, v144
    v_mul_f32 v139, v139, v139 clamp
    v_fmac_f32 v187, s22, v139
    v_sub_f32 v139, v5, v144
    v_mul_f32 v139, v139, v139 clamp
    v_fmac_f32 v175, s22, v139
    v_cvt_f32_u32 v144, s74
    v_sub_f32 v139, v142, v144
    v_mul_f32 v139, v139, v139 clamp
    v_fmac_f32 v208, s22, v139
    v_sub_f32 v139, v143, v144
    v_mul_f32 v139, v139, v139 clamp
    v_fmac_f32 v209, s22, v139
    v_sub_f32 v139, v5, v144
    v_mul_f32 v139, v139, v139 clamp
    v_fmac_f32 v210, s22, v139
    v_lshrrev_b32 v142, 2, v4
    v_lshl_add_u32 v142, v3, 2, v142
    v_add_u32 v139, 1, v3
    v_lshrrev_b32 v139, 2, v139
    v_mad_u32_u24 v142, v139, 36, v142
    v_min_u32 v142, 48, v142
    v_mul_u32_u24 v139, 37, v142
    v_lshrrev_b32 v138, 8, v139
    v_mad_i32_i24 v138, v138, -7, v142
    v_lshrrev_b32 v139, 10, v139
    v_lshrrev_b32 v138, 2, v138
    v_mul_u32_u24 v139, s20, v139
    v_mad_u32_u24 v142, v138, s21, v139
    v_cvt_f32_u32 v142, v142
    v_sub_f32 v139, v142, v144
    v_mul_f32 v139, v139, v139 clamp
    v_fmac_f32 v211, s22, v139
    s_branch L_nomaskF
L_spin:
    s_movk_i32 s95, 300
L_spin1:
    global_load_dword v120, v122, s[38:39] offset:248 sc1
    s_waitcnt vmcnt(0)
    v_readfirstlane_b32 s94, v120
    s_nop 1
    s_cmp_ge_u32 s94, 3
    s_cbranch_scc1 L_spinr
    s_sub_u32 s95, s95, 1
    s_cmp_lg_u32 s95, 0
    s_cbranch_scc1 L_spin1
    v_mov_b32 v123, -1
    s_branch L_spinr
.fill 96, 4, 0xbf800000
L_atomF0:
    s_cbranch_execz L_main
    v_mov_b32 v122, 0x800000
    buffer_atomic_add v122, v129, s[8:11], 0 offen sc0 sc1
    s_branch L_atomF0r
.p2align 6
L_loopF0:
    v_mfma_f32_16x16x32_bf16 v[28:31], a[4:7], v[108:111], v[28:31]
    ds_write_b32 v135, v13 offset:1540
    v_mfma_f32_16x16x32_bf16 v[28:31], a[8:11], v[8:11], v[28:31]
    v_rcp_f32 v36, v36
    v_mfma_f32_16x16x32_bf16 v[28:31], a[12:15], v[112:115], v[28:31]
    v_mul_f32 v64, v64, v36
    v_mul_f32 v65, v65, v36
    v_mfma_f32_16x16x32_bf16 v[28:31], a[16:19], v[40:43], v[28:31]
    ds_read_b128 v[76:79], v136 offset:1664
    v_cvt_pk_bf16_f32 v4, v64, v65
    v_mfma_f32_16x16x32_bf16 v[28:31], a[20:23], v[52:55], v[28:31]
    v_mul_f32 v66, v66, v36
    v_mul_f32 v67, v67, v36
    v_mfma_f32_16x16x32_bf16 v[16:19], v[84:87], a[168:171], 0
    v_cvt_pk_bf16_f32 v5, v66, v67
    v_mul_f32 v0, v0, v36
    v_mfma_f32_16x16x32_bf16 v[16:19], v[108:111], a[172:175], v[16:19]
    v_mul_f32 v1, v1, v36
    v_cvt_pk_bf16_f32 v6, v0, v1
    v_mfma_f32_16x16x32_bf16 v[16:19], v[8:11], a[176:179], v[16:19]
    ds_write_b64 v135, v[14:15] offset:1544
    v_mfma_f32_16x16x32_bf16 v[16:19], v[112:115], a[180:183], v[16:19]
    v_mul_f32 v2, v2, v36
    v_mul_f32 v3, v3, v36
    v_mfma_f32_16x16x32_bf16 v[16:19], v[40:43], a[184:187], v[16:19]
    v_cvt_pk_bf16_f32 v7, v2, v3
    v_mul_f32 v146, v146, v36
    v_mfma_f32_16x16x32_bf16 v[16:19], v[52:55], a[188:191], v[16:19]
    v_mul_f32 v147, v147, v36
    v_cvt_pk_bf16_f32 v152, v146, v147
    v_mfma_f32_16x16x32_bf16 v[12:15], a[120:123], v[84:87], 0
    ds_write_b64 v134, v[154:155] offset:1536
    v_mfma_f32_16x16x32_bf16 v[12:15], a[124:127], v[108:111], v[12:15]
    v_mul_f32 v148, v148, v36
    v_mul_f32 v149, v149, v36
    v_mfma_f32_16x16x32_bf16 v[12:15], a[128:131], v[8:11], v[12:15]
    v_cvt_pk_bf16_f32 v153, v148, v149
    v_fmac_f32 v32, v116, v116
    v_mfma_f32_16x16x32_bf16 v[12:15], a[132:135], v[112:115], v[12:15]
    ds_read_b128 v[92:95], v137 offset:1792
    v_fmac_f32 v32, v117, v117
    v_mfma_f32_16x16x32_bf16 v[12:15], a[136:139], v[40:43], v[12:15]
    v_fmac_f32 v32, v118, v118
    v_fmac_f32 v32, v119, v119
    v_mfma_f32_16x16x32_bf16 v[12:15], a[140:143], v[52:55], v[12:15]
    v_fma_f32 v154, v140, v140, s42
    v_fmac_f32 v154, v141, v141
    v_mfma_f32_16x16x32_bf16 v[0:3], a[48:51], v[84:87], 0
    v_fmac_f32 v154, v142, v142
    v_fmac_f32 v154, v143, v143
    v_mfma_f32_16x16x32_bf16 v[0:3], a[52:55], v[108:111], v[0:3]
    ds_write_b64 v135, v[4:5] offset:3072
    v_mfma_f32_16x16x32_bf16 v[0:3], a[56:59], v[8:11], v[0:3]
    v_fmac_f32 v154, v44, v44
    v_fmac_f32 v154, v45, v45
    v_mfma_f32_16x16x32_bf16 v[0:3], a[60:63], v[112:115], v[0:3]
    v_fmac_f32 v154, v46, v46
    v_fmac_f32 v154, v47, v47
    v_mfma_f32_16x16x32_bf16 v[0:3], a[64:67], v[40:43], v[0:3]
    v_fmac_f32 v154, v56, v56
    v_fmac_f32 v154, v57, v57
    v_mfma_f32_16x16x32_bf16 v[0:3], a[68:71], v[52:55], v[0:3]
    ds_write_b64 v135, v[6:7] offset:3080
    v_mfma_f32_16x16x32_bf16 v[4:7], a[24:27], v[84:87], 0
    v_fmac_f32 v154, v58, v58
    v_fmac_f32 v154, v59, v59
    v_mfma_f32_16x16x32_bf16 v[4:7], a[28:31], v[108:111], v[4:7]
    v_fma_f32 v155, v24, v24, s42
    v_fmac_f32 v155, v25, v25
    v_mfma_f32_16x16x32_bf16 v[4:7], a[32:35], v[8:11], v[4:7]
    v_fmac_f32 v155, v26, v26
    v_fmac_f32 v155, v27, v27
    v_mfma_f32_16x16x32_bf16 v[4:7], a[36:39], v[112:115], v[4:7]
    ds_write_b32 v134, v152 offset:3072
    v_mfma_f32_16x16x32_bf16 v[4:7], a[40:43], v[40:43], v[4:7]
    v_fmac_f32 v155, v88, v88
    v_fmac_f32 v155, v89, v89
    v_mfma_f32_16x16x32_bf16 v[4:7], a[44:47], v[52:55], v[4:7]
    v_fmac_f32 v155, v90, v90
    v_fmac_f32 v155, v91, v91
    v_mfma_f32_16x16x32_bf16 v[146:149], v[84:87], a[192:195], 0
    s_waitcnt vmcnt(10)
    v_fmac_f32 v155, v72, v72
    v_fmac_f32 v155, v73, v73
    v_mfma_f32_16x16x32_bf16 v[146:149], v[108:111], a[196:199], v[146:149]
    ds_write_b32 v134, v153 offset:3076
    v_mfma_f32_16x16x32_bf16 v[146:149], v[8:11], a[200:203], v[146:149]
    v_fmac_f32 v155, v74, v74
    v_fmac_f32 v155, v75, v75
    v_mfma_f32_16x16x32_bf16 v[146:149], v[112:115], a[204:207], v[146:149]
    v_cvt_pk_bf16_f32 v152, v32, v154
    v_cvt_pk_bf16_f32 v153, v155, v122
    v_mfma_f32_16x16x32_bf16 v[146:149], v[40:43], a[208:211], v[146:149]
    v_add_u32 v135, s49, v135
    v_add_u32 v134, s49, v134
    v_mfma_f32_16x16x32_bf16 v[146:149], v[52:55], a[212:215], v[146:149]
    ds_write_b64 v130, v[152:153]
    v_mfma_f32_16x16x32_bf16 v[32:35], a[72:75], v[84:87], 0
    v_cvt_pk_f16_f32 v28, v28, v29
    v_cvt_pk_f16_f32 v29, v30, v31
    v_mfma_f32_16x16x32_bf16 v[32:35], a[76:79], v[108:111], v[32:35]
    v_pk_fma_f16 v36, v28, v28, s3
    v_pk_fmac_f16 v36, v29, v29
    v_mfma_f32_16x16x32_bf16 v[32:35], a[80:83], v[8:11], v[32:35]
    v_cvt_pk_f16_f32 v154, v12, v13
    v_cvt_pk_f16_f32 v155, v14, v15
    v_mfma_f32_16x16x32_bf16 v[32:35], a[84:87], v[112:115], v[32:35]
    v_cvt_pk_f16_f32 v30, v4, v5
    v_cvt_pk_f16_f32 v31, v6, v7
    v_mfma_f32_16x16x32_bf16 v[32:35], a[88:91], v[40:43], v[32:35]
    v_pk_fmac_f16 v36, v30, v30
    v_pk_fmac_f16 v36, v31, v31
    v_mfma_f32_16x16x32_bf16 v[32:35], a[92:95], v[52:55], v[32:35]
    v_cvt_pk_bf16_f32 v4, v146, v147
    v_cvt_pk_bf16_f32 v5, v148, v149
    v_mfma_f32_16x16x32_bf16 v[146:149], a[96:99], v[84:87], 0
    v_cvt_pk_f16_f32 v152, v0, v1
    v_cvt_pk_f16_f32 v153, v2, v3
    v_mfma_f32_16x16x32_bf16 v[146:149], a[100:103], v[108:111], v[146:149]
    s_waitcnt lgkmcnt(0)
    v_pk_fmac_f16 v36, v152, v152
    v_pk_fmac_f16 v36, v153, v153
    v_mfma_f32_16x16x32_bf16 v[146:149], a[104:107], v[8:11], v[146:149]
    s_barrier
    ds_read_b128 v[0:3], v129 offset:0
    v_cvt_pk_f16_f32 v12, v32, v33
    v_mfma_f32_16x16x32_bf16 v[146:149], a[108:111], v[112:115], v[146:149]
    ds_read_b128 v[64:67], v129 offset:1024
    v_cvt_pk_f16_f32 v13, v34, v35
    v_mfma_f32_16x16x32_bf16 v[146:149], a[112:115], v[40:43], v[146:149]
    v_pk_fma_f16 v37, v12, v12, s3
    v_pk_fmac_f16 v37, v13, v13
    v_mfma_f32_16x16x32_bf16 v[146:149], a[116:119], v[52:55], v[146:149]
    s_nop 1
    v_mfma_f32_16x16x32_bf16 v[32:35], v[84:87], a[144:147], 0
    s_nop 2
    v_mfma_f32_16x16x32_bf16 v[32:35], v[108:111], a[148:151], v[32:35]
    s_nop 0
    v_cvt_pk_f16_f32 v14, v146, v147
    v_cvt_pk_f16_f32 v15, v148, v149
    v_mfma_f32_16x16x32_bf16 v[32:35], v[8:11], a[152:155], v[32:35]
    v_pk_fmac_f16 v37, v14, v14
    v_pk_fmac_f16 v37, v15, v15
    v_mfma_f32_16x16x32_bf16 v[32:35], v[112:115], a[156:159], v[32:35]
    v_pk_fmac_f16 v37, v154, v154
    v_pk_fmac_f16 v37, v155, v155
    v_mfma_f32_16x16x32_bf16 v[32:35], v[40:43], a[160:163], v[32:35]
    v_mfma_f32_16x16x32_bf16 v[32:35], v[52:55], a[164:167], v[32:35]
    s_waitcnt lgkmcnt(1)
    v_readfirstlane_b32 s12, v1
    v_mfma_f32_16x16x32_bf16 v[84:87], v[216:219], v[0:3], 0
    s_waitcnt lgkmcnt(0)
    s_nop 1
    v_mfma_f32_16x16x32_bf16 v[84:87], v[216:219], v[64:67], v[84:87]
    s_lshr_b32 s12, s12, 23
    v_cvt_pk_bf16_f32 v0, v32, v33
    v_cvt_pk_bf16_f32 v1, v34, v35
    v_mfma_f32_16x16x32_bf16 v[32:35], a[96:99], v[68:71], 0
    s_nop 1
    v_mfma_f32_16x16x32_bf16 v[32:35], a[100:103], v[60:63], v[32:35]
    s_nop 0
    v_rsq_f32 v84, v84
    v_mfma_f32_16x16x32_bf16 v[32:35], a[104:107], v[98:101], v[32:35]
    v_rsq_f32 v85, v85
    v_mfma_f32_16x16x32_bf16 v[32:35], a[108:111], v[76:79], v[32:35]
    v_rsq_f32 v86, v86
    v_mfma_f32_16x16x32_bf16 v[32:35], a[112:115], v[92:95], v[32:35]
    v_mul_f32 v84, s43, v84
    v_mul_f32 v85, s43, v85
    v_mfma_f32_16x16x32_bf16 v[32:35], a[116:119], v[104:107], v[32:35]
    v_mul_f32 v86, s43, v86
    v_mul_f32 v140, v140, v85
    v_mfma_f32_16x16x32_bf16 v[40:43], v[68:71], a[168:171], 0
    s_nop 0
    v_mul_f32 v141, v141, v85
    v_cvt_pk_bf16_f32 v52, v140, v141
    v_mfma_f32_16x16x32_bf16 v[40:43], v[60:63], a[172:175], v[40:43]
    s_nop 0
    v_cvt_pk_f16_f32 v10, v32, v33
    v_cvt_pk_f16_f32 v11, v34, v35
    v_mfma_f32_16x16x32_bf16 v[40:43], v[98:101], a[176:179], v[40:43]
    v_mul_f32 v142, v142, v85
    v_mul_f32 v143, v143, v85
    v_mfma_f32_16x16x32_bf16 v[40:43], v[76:79], a[180:183], v[40:43]
    v_cvt_pk_bf16_f32 v53, v142, v143
    v_mul_f32 v44, v44, v85
    v_mfma_f32_16x16x32_bf16 v[40:43], v[92:95], a[184:187], v[40:43]
    ds_write_b32 v135, v52 offset:1536
    v_mfma_f32_16x16x32_bf16 v[40:43], v[104:107], a[188:191], v[40:43]
    v_mul_f32 v45, v45, v85
    v_cvt_pk_bf16_f32 v54, v44, v45
    v_mfma_f32_16x16x32_bf16 v[140:143], a[24:27], v[68:71], 0
    s_nop 0
    v_mul_f32 v46, v46, v85
    v_mul_f32 v47, v47, v85
    v_mfma_f32_16x16x32_bf16 v[140:143], a[28:31], v[60:63], v[140:143]
    s_nop 0
    v_cvt_pk_bf16_f32 v22, v40, v41
    v_cvt_pk_bf16_f32 v23, v42, v43
    v_mfma_f32_16x16x32_bf16 v[140:143], a[32:35], v[98:101], v[140:143]
    v_cvt_pk_bf16_f32 v55, v46, v47
    v_mul_f32 v56, v56, v85
    v_mfma_f32_16x16x32_bf16 v[140:143], a[36:39], v[76:79], v[140:143]
    ds_write_b64 v135, v[54:55] offset:1544
    v_mfma_f32_16x16x32_bf16 v[140:143], a[40:43], v[92:95], v[140:143]
    s_sub_u32 s50, s45, s44
    v_mul_f32 v57, v57, v85
    v_cvt_pk_bf16_f32 v38, v56, v57
    v_mfma_f32_16x16x32_bf16 v[140:143], a[44:47], v[104:107], v[140:143]
    s_sub_u32 s51, s46, s47
    v_mul_f32 v58, v58, v85
    v_mul_f32 v59, v59, v85
    v_mfma_f32_16x16x32_bf16 v[32:35], a[72:75], v[68:71], 0
    s_mov_b32 s60, s59
    v_cvt_pk_bf16_f32 v39, v58, v59
    v_mul_f32 v48, v48, v84
    v_mfma_f32_16x16x32_bf16 v[32:35], a[76:79], v[60:63], v[32:35]
    s_mov_b32 s59, s58
    ds_write_b32 v134, v39 offset:1540
    v_mfma_f32_16x16x32_bf16 v[32:35], a[80:83], v[98:101], v[32:35]
    s_mov_b32 s58, s57
    v_mul_f32 v49, v49, v84
    v_cvt_pk_bf16_f32 v64, v48, v49
    v_mfma_f32_16x16x32_bf16 v[32:35], a[84:87], v[76:79], v[32:35]
    s_mov_b32 s57, s56
    v_mul_f32 v50, v50, v84
    v_mul_f32 v51, v51, v84
    v_mfma_f32_16x16x32_bf16 v[32:35], a[88:91], v[92:95], v[32:35]
    s_mov_b32 s7, s6
    v_cvt_pk_bf16_f32 v65, v50, v51
    v_mul_f32 v80, v80, v84
    v_mfma_f32_16x16x32_bf16 v[32:35], a[92:95], v[104:107], v[32:35]
    s_mov_b32 s6, s5
    ds_write_b32 v135, v53 offset:1540
    v_mfma_f32_16x16x32_bf16 v[146:149], a[48:51], v[68:71], 0
    s_mov_b32 s5, s4
    v_mul_f32 v81, v81, v84
    v_cvt_pk_bf16_f32 v66, v80, v81
    v_mfma_f32_16x16x32_bf16 v[146:149], a[52:55], v[60:63], v[146:149]
    s_sub_u32 s14, s6, s7
    v_cvt_pk_f16_f32 v8, v32, v33
    v_cvt_pk_f16_f32 v9, v34, v35
    v_mfma_f32_16x16x32_bf16 v[146:149], a[56:59], v[98:101], v[146:149]
    s_add_u32 s61, s61, 1
    ds_read_b128 v[32:35], v137 offset:3328
    v_pk_fma_f16 v39, v8, v8, s3
    v_mfma_f32_16x16x32_bf16 v[146:149], a[60:63], v[76:79], v[146:149]
    s_add_u32 s12, s12, 20
    ds_read_b128 v[40:43], v137 offset:3200
    v_pk_fmac_f16 v39, v9, v9
    v_mfma_f32_16x16x32_bf16 v[146:149], a[64:67], v[92:95], v[146:149]
    s_max_u32 s12, s12, s61
    ds_read_b128 v[48:51], v136 offset:3200
    v_pk_fmac_f16 v39, v10, v10
    v_mfma_f32_16x16x32_bf16 v[146:149], a[68:71], v[104:107], v[146:149]
    s_cmp_lt_u32 s61, s71
    ds_read_b128 v[44:47], v136 offset:3328
    v_pk_fmac_f16 v39, v11, v11
    v_mfma_f32_16x16x32_bf16 v[108:111], a[120:123], v[68:71], 0
    s_cselect_b32 s15, s61, s12
    ds_read_b128 v[52:55], v136 offset:3072
    v_mul_f32 v82, v82, v84
    v_mfma_f32_16x16x32_bf16 v[108:111], a[124:127], v[60:63], v[108:111]
    s_cselect_b32 s56, s69, s70
    v_cvt_pk_f16_f32 v146, v146, v147
    v_cvt_pk_f16_f32 v147, v148, v149
    v_mfma_f32_16x16x32_bf16 v[108:111], a[128:131], v[98:101], v[108:111]
    s_add_u32 s56, s56, s15
    v_mul_f32 v83, v83, v84
    v_cvt_pk_bf16_f32 v67, v82, v83
    v_mfma_f32_16x16x32_bf16 v[108:111], a[132:135], v[76:79], v[108:111]
    s_mul_i32 s53, s56, 58255
    v_mul_f32 v116, v116, v84
    v_mul_f32 v117, v117, v84
    v_mfma_f32_16x16x32_bf16 v[108:111], a[136:139], v[92:95], v[108:111]
    s_lshr_b32 s53, s53, 22
    ds_write_b32 v134, v38 offset:1536
    v_mfma_f32_16x16x32_bf16 v[108:111], a[140:143], v[104:107], v[108:111]
    s_mul_i32 s53, s53, s63
    v_cvt_pk_bf16_f32 v2, v116, v117
    v_mul_f32 v118, v118, v84
    v_mfma_f32_16x16x32_bf16 v[80:83], a[0:3], v[68:71], 0
    s_mul_i32 s56, s56, s62
    v_mul_f32 v119, v119, v84
    v_cvt_pk_bf16_f32 v3, v118, v119
    v_mfma_f32_16x16x32_bf16 v[80:83], a[4:7], v[60:63], v[80:83]
    s_add_u32 s56, s56, s53
    v_cvt_pk_f16_f32 v148, v108, v109
    v_cvt_pk_f16_f32 v149, v110, v111
    v_mfma_f32_16x16x32_bf16 v[80:83], a[8:11], v[98:101], v[80:83]
    s_mul_i32 s4, s15, 112
    ds_write_b64 v135, v[64:65] offset:0
    v_mfma_f32_16x16x32_bf16 v[80:83], a[12:15], v[76:79], v[80:83]
    s_cmp_ge_u32 s15, 16
    v_pk_fmac_f16 v39, v148, v148
    v_pk_fmac_f16 v39, v149, v149
    v_mfma_f32_16x16x32_bf16 v[80:83], a[16:19], v[92:95], v[80:83]
    s_cselect_b32 s53, -30464, 0
    v_mul_f32 v24, v24, v86
    v_mul_f32 v25, v25, v86
    v_mfma_f32_16x16x32_bf16 v[80:83], a[20:23], v[104:107], v[80:83]
    s_add_u32 s4, s4, s53
    v_cvt_pk_bf16_f32 v116, v24, v25
    v_mul_f32 v26, v26, v86
    v_mfma_f32_16x16x32_bf16 v[108:111], v[68:71], a[144:147], 0
    s_cmp_lt_u32 s15, s73
    ds_write_b64 v135, v[66:67] offset:8
    v_mfma_f32_16x16x32_bf16 v[108:111], v[60:63], a[148:151], v[108:111]
    s_cselect_b32 s26, 100270464, 0
    v_cvt_pk_f16_f32 v24, v80, v81
    v_cvt_pk_f16_f32 v25, v82, v83
    v_mfma_f32_16x16x32_bf16 v[108:111], v[98:101], a[152:155], v[108:111]
    s_cselect_b32 s56, s56, 0
    v_pk_fma_f16 v38, v24, v24, s3
    v_pk_fmac_f16 v38, v25, v25
    v_mfma_f32_16x16x32_bf16 v[108:111], v[76:79], a[156:159], v[108:111]
    s_cselect_b32 s4, s4, -1
    ds_read_b128 v[64:67], v137 offset:3072
    v_mul_f32 v27, v27, v86
    v_mfma_f32_16x16x32_bf16 v[108:111], v[92:95], a[160:163], v[108:111]
    s_cselect_b32 s15, s15, 0
    v_cvt_pk_bf16_f32 v117, v26, v27
    v_mul_f32 v88, v88, v86
    v_mfma_f32_16x16x32_bf16 v[108:111], v[104:107], a[164:167], v[108:111]
    s_cselect_b32 s13, s13, -1
    v_mul_f32 v89, v89, v86
    v_cvt_pk_bf16_f32 v118, v88, v89
    v_mfma_f32_16x16x32_bf16 v[80:83], v[68:71], a[192:195], 0
    s_bitset1_b32 s64, s15
    v_mul_f32 v90, v90, v86
    v_mul_f32 v91, v91, v86
    v_mfma_f32_16x16x32_bf16 v[80:83], v[60:63], a[196:199], v[80:83]
    s_add_u32 s65, s65, 1
    ds_write_b64 v134, v[2:3] offset:0
    v_mfma_f32_16x16x32_bf16 v[80:83], v[98:101], a[200:203], v[80:83]
    s_cmp_ge_i32 s65, 2
    v_cvt_pk_bf16_f32 v119, v90, v91
    v_mul_f32 v72, v72, v86
    v_mfma_f32_16x16x32_bf16 v[80:83], v[76:79], a[204:207], v[80:83]
    s_cselect_b32 s30, 100270464, 0
    v_mul_f32 v73, v73, v86
    v_cvt_pk_bf16_f32 v72, v72, v73
    v_mfma_f32_16x16x32_bf16 v[80:83], v[92:95], a[208:211], v[80:83]
    s_add_u32 s67, s46, s54
    v_mul_f32 v74, v74, v86
    v_mul_f32 v75, v75, v86
    v_mfma_f32_16x16x32_bf16 v[80:83], v[104:107], a[212:215], v[80:83]
    s_waitcnt lgkmcnt(1)
    ds_write_b64 v135, v[116:117] offset:3072
    v_mfma_f32_16x16x32_bf16 v[60:63], a[72:75], v[64:67], 0
    s_add_u32 m0, s67, 0
    v_cvt_pk_bf16_f32 v73, v74, v75
    v_cvt_pk_bf16_f32 v2, v108, v109
    v_mfma_f32_16x16x32_bf16 v[60:63], a[76:79], v[52:55], v[60:63]
    v_cvt_pk_bf16_f32 v3, v110, v111
    v_cvt_pk_f16_f32 v26, v140, v141
    v_mfma_f32_16x16x32_bf16 v[60:63], a[80:83], v[40:43], v[60:63]
    v_cvt_pk_f16_f32 v27, v142, v143
    v_pk_fmac_f16 v38, v26, v26
    v_mfma_f32_16x16x32_bf16 v[60:63], a[84:87], v[48:51], v[60:63]
    ds_write_b32 v135, v118 offset:3080
    v_mfma_f32_16x16x32_bf16 v[60:63], a[88:91], v[32:35], v[60:63]
    v_pk_fmac_f16 v38, v27, v27
    v_pk_fmac_f16 v38, v146, v146
    v_mfma_f32_16x16x32_bf16 v[60:63], a[92:95], v[44:47], v[60:63]
    v_pk_fmac_f16 v38, v147, v147
    v_cvt_pk_bf16_f32 v6, v80, v81
    v_mfma_f32_16x16x32_bf16 v[98:101], a[120:123], v[64:67], 0
    v_cvt_pk_bf16_f32 v7, v82, v83
    v_add_u32 v137, s50, v137
    v_mfma_f32_16x16x32_bf16 v[98:101], a[124:127], v[52:55], v[98:101]
    ds_write_b32 v135, v119 offset:3084
    v_mfma_f32_16x16x32_bf16 v[98:101], a[128:131], v[40:43], v[98:101]
    v_cvt_pk_f16_f32 v56, v60, v61
    v_cvt_pk_f16_f32 v57, v62, v63
    v_mfma_f32_16x16x32_bf16 v[98:101], a[132:135], v[48:51], v[98:101]
    v_add_u32 v136, s50, v136
    v_add_u32 v135, s48, v135
    v_mfma_f32_16x16x32_bf16 v[98:101], a[136:139], v[32:35], v[98:101]
    v_add_u32 v133, s51, v133
    v_add_u32 v132, s14, v132
    v_mfma_f32_16x16x32_bf16 v[98:101], a[140:143], v[44:47], v[98:101]
    s_nop 0
    ds_write_b32 v134, v72 offset:3072
    v_mfma_f32_16x16x32_f16 v[76:79], v[212:215], v[36:39], 0
    s_nop 0
    v_pk_fma_f16 v37, v56, v56, s3
    v_pk_fmac_f16 v37, v57, v57
    v_mfma_f32_16x16x32_bf16 v[80:83], v[64:67], a[168:171], 0
    s_nop 0
    v_cvt_pk_f16_f32 v142, v98, v99
    v_cvt_pk_f16_f32 v143, v100, v101
    v_mfma_f32_16x16x32_bf16 v[80:83], v[52:55], a[172:175], v[80:83]
    v_or3_b32 v123, v123, v76, v77
    v_or3_b32 v123, v123, v78, v79
    v_mfma_f32_16x16x32_bf16 v[80:83], v[40:43], a[176:179], v[80:83]
    ds_write_b32 v134, v73 offset:3076
    v_mfma_f32_16x16x32_bf16 v[80:83], v[48:51], a[180:183], v[80:83]
    s_waitcnt vmcnt(0)
    v_rsq_f32 v76, v76
    v_mfma_f32_16x16x32_bf16 v[80:83], v[32:35], a[184:187], v[80:83]
    v_rsq_f32 v77, v77
    v_mfma_f32_16x16x32_bf16 v[80:83], v[44:47], a[188:191], v[80:83]
    v_mul_f32 v76, s52, v76
    v_cvt_pk_f16_f32 v76, v76, v77
    v_mfma_f32_16x16x32_bf16 v[98:101], v[64:67], a[144:147], 0
    v_rsq_f32 v78, v78
    v_mfma_f32_16x16x32_bf16 v[98:101], v[52:55], a[148:151], v[98:101]
    v_rsq_f32 v79, v79
    v_mfma_f32_16x16x32_bf16 v[98:101], v[40:43], a[152:155], v[98:101]
    v_mul_f32 v78, s52, v78
    v_cvt_pk_f16_f32 v78, v78, v79
    v_mfma_f32_16x16x32_bf16 v[98:101], v[48:51], a[156:159], v[98:101]
    v_pk_mul_f16 v8, v8, v78 op_sel:[0,1] op_sel_hi:[1,1]
    v_pk_mul_f16 v9, v9, v78 op_sel:[0,1] op_sel_hi:[1,1]
    v_mfma_f32_16x16x32_bf16 v[98:101], v[32:35], a[160:163], v[98:101]
    s_waitcnt lgkmcnt(0)
    v_pk_mul_f16 v10, v10, v78 op_sel:[0,1] op_sel_hi:[1,1]
    v_pk_mul_f16 v11, v11, v78 op_sel:[0,1] op_sel_hi:[1,1]
    v_mfma_f32_16x16x32_bf16 v[98:101], v[44:47], a[164:167], v[98:101]
    s_barrier
    v_pk_mul_f16 v148, v148, v78 op_sel:[0,1] op_sel_hi:[1,1]
    v_pk_mul_f16 v149, v149, v78 op_sel:[0,1] op_sel_hi:[1,1]
    v_mfma_f32_16x16x32_bf16 v[92:95], a[0:3], v[64:67], 0
    s_cmp_ge_u32 s61, s13
    v_pk_mul_f16 v12, v12, v76 op_sel:[0,1] op_sel_hi:[1,1]
    v_pk_mul_f16 v13, v13, v76 op_sel:[0,1] op_sel_hi:[1,1]
    v_mfma_f32_16x16x32_bf16 v[92:95], a[4:7], v[52:55], v[92:95]
L_pga:
    s_cbranch_scc1 L_atomF0
L_atomF0r:
    v_mfma_f32_16x16x32_bf16 v[92:95], a[8:11], v[40:43], v[92:95]
    ds_read_b128 v[60:63], v132 offset:16
    v_pk_mul_f16 v14, v14, v76 op_sel:[0,1] op_sel_hi:[1,1]
    v_mfma_f32_16x16x32_bf16 v[92:95], a[12:15], v[48:51], v[92:95]
    ds_read_b128 v[68:71], v132 offset:0
    v_pk_mul_f16 v15, v15, v76 op_sel:[0,1] op_sel_hi:[1,1]
    v_mfma_f32_16x16x32_bf16 v[92:95], a[16:19], v[32:35], v[92:95]
    v_pk_mul_f16 v154, v154, v76 op_sel:[0,1] op_sel_hi:[1,1]
    v_pk_mul_f16 v155, v155, v76 op_sel:[0,1] op_sel_hi:[1,1]
    v_mfma_f32_16x16x32_bf16 v[92:95], a[20:23], v[44:47], v[92:95]
    ds_read_b128 v[104:107], v133 offset:0
    v_pk_mul_f16 v28, v28, v76 op_sel:[0,0] op_sel_hi:[1,0]
    v_mfma_f32_16x16x32_bf16 v[116:119], a[48:51], v[64:67], 0
    v_pk_mul_f16 v29, v29, v76 op_sel:[0,0] op_sel_hi:[1,0]
    v_pk_mul_f16 v30, v30, v76 op_sel:[0,0] op_sel_hi:[1,0]
    v_mfma_f32_16x16x32_bf16 v[116:119], a[52:55], v[52:55], v[116:119]
    ds_read_b128 v[88:91], v133 offset:2048
    v_pk_mul_f16 v31, v31, v76 op_sel:[0,0] op_sel_hi:[1,0]
    v_mfma_f32_16x16x32_bf16 v[116:119], a[56:59], v[40:43], v[116:119]
    v_pk_mul_f16 v152, v152, v76 op_sel:[0,0] op_sel_hi:[1,0]
    v_pk_mul_f16 v153, v153, v76 op_sel:[0,0] op_sel_hi:[1,0]
    v_mfma_f32_16x16x32_bf16 v[116:119], a[60:63], v[48:51], v[116:119]
    ds_read_b128 v[72:75], v132 offset:48
    v_cvt_pk_f16_f32 v76, v92, v93
    v_mfma_f32_16x16x32_bf16 v[116:119], a[64:67], v[32:35], v[116:119]
    ds_read_b128 v[84:87], v137 offset:0
    v_cvt_pk_f16_f32 v77, v94, v95
    v_mfma_f32_16x16x32_bf16 v[116:119], a[68:71], v[44:47], v[116:119]
    v_pk_fma_f16 v36, v76, v76, s3
    v_pk_fmac_f16 v36, v77, v77
    v_mfma_f32_16x16x32_bf16 v[112:115], a[24:27], v[64:67], 0
    s_nop 0
    v_add_u32 v134, s48, v134
    v_add_u32 v131, s14, v131
    v_mfma_f32_16x16x32_bf16 v[112:115], a[28:31], v[52:55], v[112:115]
    s_nop 0
    v_cvt_pk_f16_f32 v140, v116, v117
    v_cvt_pk_f16_f32 v141, v118, v119
    v_mfma_f32_16x16x32_bf16 v[112:115], a[32:35], v[40:43], v[112:115]
    s_waitcnt lgkmcnt(3)
    buffer_load_dwordx4 v128, s[24:27], s56 offen nt lds
    v_pk_mul_f16 v24, v24, v78 op_sel:[0,0] op_sel_hi:[1,0]
    v_mfma_f32_16x16x32_bf16 v[112:115], a[36:39], v[48:51], v[112:115]
    ds_read_b128 v[92:95], v136 offset:128
    v_pk_mul_f16 v25, v25, v78 op_sel:[0,0] op_sel_hi:[1,0]
    v_mfma_f32_16x16x32_bf16 v[112:115], a[40:43], v[32:35], v[112:115]
    v_pk_mul_f16 v26, v26, v78 op_sel:[0,0] op_sel_hi:[1,0]
    v_pk_mul_f16 v27, v27, v78 op_sel:[0,0] op_sel_hi:[1,0]
    v_mfma_f32_16x16x32_bf16 v[112:115], a[44:47], v[44:47], v[112:115]
    v_pk_mul_f16 v146, v146, v78 op_sel:[0,0] op_sel_hi:[1,0]
    v_pk_mul_f16 v147, v147, v78 op_sel:[0,0] op_sel_hi:[1,0]
    v_mfma_f32_16x16x32_bf16 v[116:119], a[96:99], v[64:67], 0
    ds_read_b128 v[108:111], v133 offset:1024
    v_cvt_pk_bf16_f32 v164, v98, v99
    v_mfma_f32_16x16x32_bf16 v[116:119], a[100:103], v[52:55], v[116:119]
    s_nop 0
    ds_read_u16 v166, v131 offset:80
    v_cvt_pk_f16_f32 v78, v112, v113
    v_mfma_f32_16x16x32_bf16 v[116:119], a[104:107], v[40:43], v[116:119]
    ds_read_u16 v162, v131 offset:96
    v_cvt_pk_f16_f32 v79, v114, v115
    v_mfma_f32_16x16x32_bf16 v[116:119], a[108:111], v[48:51], v[116:119]
    ds_read_u16 v158, v131 offset:104
    v_pk_fmac_f16 v36, v78, v78
    v_mfma_f32_16x16x32_bf16 v[116:119], a[112:115], v[32:35], v[116:119]
    ds_read_b128 v[96:99], v137 offset:256
    v_pk_fmac_f16 v36, v79, v79
    v_mfma_f32_16x16x32_bf16 v[116:119], a[116:119], v[44:47], v[116:119]
    s_add_u32 m0, s67, 1024
    v_pk_fmac_f16 v36, v140, v140
    v_pk_fmac_f16 v36, v141, v141
    v_mfma_f32_16x16x32_bf16 v[112:115], v[64:67], a[192:195], 0
    ds_read_b128 v[64:67], v136 offset:0
    v_cvt_pk_bf16_f32 v165, v100, v101
    v_mfma_f32_16x16x32_bf16 v[112:115], v[52:55], a[196:199], v[112:115]
    ds_read_b128 v[52:55], v133 offset:3072
    v_cvt_pk_f16_f32 v58, v116, v117
    v_mfma_f32_16x16x32_bf16 v[112:115], v[40:43], a[200:203], v[112:115]
    ds_read_b128 v[40:43], v137 offset:128
    v_cvt_pk_f16_f32 v59, v118, v119
    v_mfma_f32_16x16x32_bf16 v[112:115], v[48:51], a[204:207], v[112:115]
    s_waitcnt lgkmcnt(7)
    buffer_store_dwordx4 v[104:107], v128, s[28:31], s60 offen sc1
    buffer_load_dwordx4 v127, s[24:27], s56 offen nt lds
    v_pk_fmac_f16 v37, v58, v58
    v_pk_fmac_f16 v37, v59, v59
    v_pk_fmac_f16 v37, v142, v142
    v_mfma_f32_16x16x32_bf16 v[112:115], v[32:35], a[208:211], v[112:115]
    v_pk_fmac_f16 v37, v143, v143
    v_cvt_pk_bf16_f32 v20, v16, v17
    v_mfma_f32_16x16x32_bf16 v[112:115], v[44:47], a[212:215], v[112:115]
    ds_read_b128 v[32:35], v136 offset:256
    v_cvt_pk_bf16_f32 v21, v18, v19
    v_mfma_f32_16x16x32_f16 v[16:19], v[212:215], v[36:39], 0
    s_nop 0
    v_cvt_pk_bf16_f32 v160, v80, v81
    v_cvt_pk_bf16_f32 v161, v82, v83
    v_mfma_f32_16x16x32_f16 v[36:39], v[8:11], v[28:31], v[200:203]
    s_nop 0
    v_cvt_pk_bf16_f32 v156, v112, v113
    v_cvt_pk_bf16_f32 v157, v114, v115
    v_mfma_f32_16x16x32_f16 v[36:39], v[146:149], v[150:153], v[36:39]
    s_add_u32 m0, s67, 2048
    v_or3_b32 v123, v123, v16, v17
    v_mfma_f32_16x16x32_bf16 v[48:51], a[216:219], v[84:87], 0
    s_waitcnt lgkmcnt(2)
    ds_read_b128 v[44:47], v133 offset:4096
    v_mfma_f32_16x16x32_bf16 v[48:51], a[220:223], v[64:67], v[48:51]
    s_waitcnt lgkmcnt(2)
    buffer_store_dwordx4 v[108:111], v127, s[28:31], s60 offen sc1
    buffer_load_dwordx4 v126, s[24:27], s56 offen nt lds
    v_rsq_f32 v16, v16
    v_mfma_f32_16x16x32_bf16 v[48:51], a[224:227], v[40:43], v[48:51]
    v_rsq_f32 v17, v17
    v_mfma_f32_16x16x32_bf16 v[48:51], a[228:231], v[92:95], v[48:51]
    v_exp_f32 v36, v36
    v_mfma_f32_16x16x32_bf16 v[48:51], a[232:235], v[96:99], v[48:51]
    s_waitcnt lgkmcnt(1)
    v_exp_f32 v37, v37
    v_mfma_f32_16x16x32_bf16 v[48:51], a[236:239], v[32:35], v[48:51]
    v_mul_f32 v16, s52, v16
    v_cvt_pk_f16_f32 v16, v16, v17
    v_mfma_f32_16x16x32_bf16 v[80:83], a[240:243], v[84:87], 0
    v_pk_mul_f16 v76, v76, v16 op_sel:[0,0] op_sel_hi:[1,0]
    v_pk_mul_f16 v77, v77, v16 op_sel:[0,0] op_sel_hi:[1,0]
    v_mfma_f32_16x16x32_bf16 v[80:83], a[244:247], v[64:67], v[80:83]
    v_pk_mul_f16 v78, v78, v16 op_sel:[0,0] op_sel_hi:[1,0]
    v_pk_mul_f16 v79, v79, v16 op_sel:[0,0] op_sel_hi:[1,0]
    v_mfma_f32_16x16x32_bf16 v[80:83], a[248:251], v[40:43], v[80:83]
    v_pk_mul_f16 v140, v140, v16 op_sel:[0,0] op_sel_hi:[1,0]
    v_pk_mul_f16 v141, v141, v16 op_sel:[0,0] op_sel_hi:[1,0]
    v_mfma_f32_16x16x32_bf16 v[80:83], a[252:255], v[92:95], v[80:83]
    v_pk_mul_f16 v56, v56, v16 op_sel:[0,1] op_sel_hi:[1,1]
    v_pk_mul_f16 v57, v57, v16 op_sel:[0,1] op_sel_hi:[1,1]
    v_mfma_f32_16x16x32_bf16 v[80:83], v[224:227], v[96:99], v[80:83]
    v_pk_mul_f16 v58, v58, v16 op_sel:[0,1] op_sel_hi:[1,1]
    v_pk_mul_f16 v59, v59, v16 op_sel:[0,1] op_sel_hi:[1,1]
    v_mfma_f32_16x16x32_bf16 v[80:83], v[228:231], v[32:35], v[80:83]
    s_add_u32 m0, s67, 3072
    buffer_store_dwordx4 v[88:91], v126, s[28:31], s60 offen sc1
    v_pk_mul_f16 v142, v142, v16 op_sel:[0,1] op_sel_hi:[1,1]
    v_pk_mul_f16 v143, v143, v16 op_sel:[0,1] op_sel_hi:[1,1]
    v_exp_f32 v38, v38
    v_mfma_f32_16x16x32_f16 v[16:19], v[68:71], v[28:31], v[208:211]
    v_exp_f32 v39, v39
    v_mfma_f32_16x16x32_f16 v[16:19], v[60:63], v[12:15], v[16:19]
    v_cvt_pk_bf16_f32 v36, v36, v37
    v_cvt_pk_bf16_f32 v37, v38, v39
    v_mfma_f32_16x16x32_f16 v[16:19], v[72:75], v[152:155], v[16:19]
    s_nop 0
    buffer_load_dwordx4 v125, s[24:27], s56 offen nt lds
    v_mfma_f32_16x16x32_f16 v[104:107], v[56:59], v[28:31], v[196:199]
    s_add_u32 m0, s67, 4096
    s_nop 1
    v_mfma_f32_16x16x32_f16 v[104:107], v[140:143], v[150:153], v[104:107]
    s_nop 0
    v_exp_f32 v16, v16
    v_mfma_f32_16x16x32_f16 v[88:91], v[12:15], v[28:31], v[204:207]
    s_nop 0
    v_cvt_pk_bf16_f32 v170, v16, 0
    s_nop 0
    v_mfma_f32_16x16x32_f16 v[88:91], v[152:155], v[150:153], v[88:91]
    s_nop 0
    v_exp_f32 v104, v104
    v_mfma_f32_16x16x32_bf16 v[116:119], v[232:235], v[84:87], 0
    s_waitcnt lgkmcnt(0)
    buffer_store_dwordx4 v[52:55], v125, s[28:31], s60 offen sc1
    buffer_load_dwordx4 v124, s[24:27], s56 offen nt lds
    v_exp_f32 v105, v105
    v_mfma_f32_16x16x32_bf16 v[116:119], v[236:239], v[64:67], v[116:119]
    v_exp_f32 v88, v88
    v_mfma_f32_16x16x32_bf16 v[116:119], v[240:243], v[40:43], v[116:119]
    v_exp_f32 v89, v89
    v_mfma_f32_16x16x32_bf16 v[116:119], v[244:247], v[92:95], v[116:119]
    v_exp_f32 v90, v90
    v_mfma_f32_16x16x32_bf16 v[116:119], v[248:251], v[96:99], v[116:119]
    v_exp_f32 v91, v91
    v_mfma_f32_16x16x32_bf16 v[116:119], v[252:255], v[32:35], v[116:119]
    v_cvt_pk_bf16_f32 v34, v88, v89
    v_cvt_pk_bf16_f32 v35, v90, v91
    v_mfma_f32_16x16x32_f16 v[28:31], v[56:59], v[24:27], v[184:187]
    v_exp_f32 v106, v106
    v_mfma_f32_16x16x32_f16 v[28:31], v[140:143], v[144:147], v[28:31]
    v_exp_f32 v107, v107
    v_mfma_f32_16x16x32_f16 v[40:43], v[56:59], v[76:79], v[172:175]
    buffer_store_dwordx4 v[44:47], v124, s[28:31], s60 offen sc1
    v_cvt_pk_bf16_f32 v168, v104, v105
    v_cvt_pk_bf16_f32 v169, v106, v107
    s_nop 0
    v_mfma_f32_16x16x32_f16 v[40:43], v[140:143], v[138:141], v[40:43]
    s_mov_b32 s53, s47
    v_exp_f32 v28, v28
    v_mfma_f32_16x16x32_f16 v[44:47], v[12:15], v[24:27], v[192:195]
    s_mov_b32 s47, s46
    v_exp_f32 v29, v29
    v_mfma_f32_16x16x32_f16 v[44:47], v[152:155], v[144:147], v[44:47]
    s_mov_b32 s46, s45
    v_exp_f32 v30, v30
    v_mfma_f32_16x16x32_f16 v[52:55], v[68:71], v[76:79], v[208:211]
    s_mov_b32 s45, s44
    v_exp_f32 v31, v31
    v_mfma_f32_16x16x32_f16 v[52:55], v[60:63], v[56:59], v[52:55]
    s_mov_b32 s44, s53
    v_exp_f32 v40, v40
    v_mfma_f32_16x16x32_f16 v[52:55], v[72:75], v[140:143], v[52:55]
    s_sub_u32 s48, s44, s46
    v_exp_f32 v44, v44
    v_mfma_f32_16x16x32_f16 v[64:67], v[68:71], v[24:27], v[208:211]
    s_sub_u32 s49, s46, s45
    v_exp_f32 v45, v45
    v_mfma_f32_16x16x32_f16 v[64:67], v[60:63], v[8:11], v[64:67]
    s_cmp_lg_u32 s5, -1
    v_exp_f32 v46, v46
    v_mfma_f32_16x16x32_f16 v[64:67], v[72:75], v[146:149], v[64:67]
    ds_read_b128 v[60:63], v136 offset:1536
    v_cvt_pk_bf16_f32 v16, v44, v45
    v_mfma_f32_16x16x32_bf16 v[98:101], v[220:223], v[34:37], 0
    ds_read_b128 v[68:71], v137 offset:1664
    v_fma_f32 v32, v48, v48, s42
    v_mfma_f32_16x16x32_bf16 v[98:101], v[220:223], v[168:171], v[98:101]
    s_nop 0
    ds_read_b128 v[88:91], v137 offset:1536
    v_mov_b32_dpp v19, v67 quad_perm:[0,1,2,3] row_mask:0x2 bank_mask:0xf
    v_mfma_f32_16x16x32_bf16 v[104:107], v[0:3], v[34:37], 0
    ds_read_b128 v[72:75], v136 offset:1664
    v_mov_b32_dpp v19, v55 quad_perm:[0,1,2,3] row_mask:0x4 bank_mask:0xf
    v_mfma_f32_16x16x32_bf16 v[104:107], v[164:167], v[168:171], v[104:107]
    ds_read_b128 v[84:87], v136 offset:1792
    v_fmac_f32 v32, v49, v49
    v_mfma_f32_16x16x32_bf16 v[92:95], v[20:23], v[34:37], 0
    v_exp_f32 v47, v47
    v_mfma_f32_16x16x32_bf16 v[92:95], v[160:163], v[168:171], v[92:95]
    v_cvt_pk_bf16_f32 v17, v46, v47
    v_fmac_f32 v32, v50, v50
    v_mfma_f32_16x16x32_bf16 v[44:47], v[4:7], v[34:37], 0
    ds_read_b128 v[36:39], v137 offset:1792
    v_fmac_f32 v32, v51, v51
    v_mfma_f32_16x16x32_bf16 v[44:47], v[156:159], v[168:171], v[44:47]
    v_exp_f32 v65, v65
    v_mfma_f32_16x16x32_f16 v[108:111], v[12:15], v[76:79], v[180:183]
    v_exp_f32 v19, v19
    v_mfma_f32_16x16x32_f16 v[108:111], v[152:155], v[138:141], v[108:111]
    v_cvt_pk_bf16_f32 v19, v19, v19
    v_cvt_pk_bf16_f32 v168, v28, v29
    v_mfma_f32_16x16x32_f16 v[152:155], v[8:11], v[76:79], v[176:179]
    ds_write_b16 v131, v19 offset:64
    v_mfma_f32_16x16x32_f16 v[152:155], v[146:149], v[138:141], v[152:155]
    s_waitcnt lgkmcnt(3)
    v_rcp_f32 v98, v98
    v_mfma_f32_16x16x32_bf16 v[140:143], a[216:219], v[88:91], 0
    v_mul_f32 v104, v104, v98
    v_mul_f32 v105, v105, v98
    v_mfma_f32_16x16x32_bf16 v[140:143], a[220:223], v[60:63], v[140:143]
    ds_read_b128 v[12:15], v132 offset:48
    v_cvt_pk_bf16_f32 v104, v104, v105
    v_mfma_f32_16x16x32_bf16 v[140:143], a[224:227], v[68:71], v[140:143]
    ds_read_b128 v[76:79], v132 offset:64
    v_mul_f32 v106, v106, v98
    v_mfma_f32_16x16x32_bf16 v[140:143], a[228:231], v[72:75], v[140:143]
    s_waitcnt lgkmcnt(3)
    v_mul_f32 v107, v107, v98
    v_cvt_pk_bf16_f32 v105, v106, v107
    v_mfma_f32_16x16x32_bf16 v[140:143], a[232:235], v[36:39], v[140:143]
    v_mul_f32 v92, v92, v98
    v_mul_f32 v93, v93, v98
    v_mfma_f32_16x16x32_bf16 v[140:143], a[236:239], v[84:87], v[140:143]
    v_cvt_pk_bf16_f32 v106, v92, v93
    v_mul_f32 v94, v94, v98
    v_mfma_f32_16x16x32_bf16 v[56:59], v[232:235], v[88:91], 0
    ds_write_b64 v135, v[104:105] offset:0
    v_mfma_f32_16x16x32_bf16 v[56:59], v[236:239], v[60:63], v[56:59]
    v_mul_f32 v95, v95, v98
    v_cvt_pk_bf16_f32 v107, v94, v95
    v_mfma_f32_16x16x32_bf16 v[56:59], v[240:243], v[68:71], v[56:59]
    v_mul_f32 v44, v44, v98
    v_mul_f32 v45, v45, v98
    v_mfma_f32_16x16x32_bf16 v[56:59], v[244:247], v[72:75], v[56:59]
    ds_read_b128 v[92:95], v137 offset:3200
    v_cvt_pk_bf16_f32 v18, v44, v45
    v_mfma_f32_16x16x32_bf16 v[56:59], v[248:251], v[36:39], v[56:59]
    v_mul_f32 v46, v46, v98
    v_mul_f32 v47, v47, v98
    v_mfma_f32_16x16x32_bf16 v[56:59], v[252:255], v[84:87], v[56:59]
    s_waitcnt lgkmcnt(2)
    v_cvt_pk_bf16_f32 v19, v46, v47
    v_cvt_pk_bf16_f32 v169, v30, v31
    v_mfma_f32_16x16x32_bf16 v[28:31], v[12:15], v[0:3], 0
    v_cvt_pk_bf16_f32 v170, v65, 0
    v_fmac_f32 v32, v80, v80
    v_mfma_f32_16x16x32_bf16 v[28:31], v[76:79], v[164:167], v[28:31]
    ds_write_b64 v135, v[106:107] offset:8
    v_mfma_f32_16x16x32_bf16 v[44:47], v[12:15], v[20:23], 0
    v_exp_f32 v41, v41
    v_mfma_f32_16x16x32_bf16 v[44:47], v[76:79], v[160:163], v[44:47]
    v_exp_f32 v42, v42
    v_mfma_f32_16x16x32_bf16 v[64:67], v[12:15], v[4:7], 0
    s_nop 0
    ds_read_b128 v[12:15], v137 offset:3072
    v_fmac_f32 v32, v81, v81
    v_mfma_f32_16x16x32_bf16 v[64:67], v[76:79], v[156:159], v[64:67]
    s_nop 0
    ds_read_b128 v[98:101], v136 offset:3072
    v_mov_b32_dpp v31, v47 quad_perm:[0,1,2,3] row_mask:0x2 bank_mask:0xf
    v_mfma_f32_16x16x32_bf16 v[44:47], a[240:243], v[88:91], 0
    ds_read_b128 v[104:107], v136 offset:3200
    v_fmac_f32 v32, v82, v82
    v_mfma_f32_16x16x32_bf16 v[44:47], a[244:247], v[60:63], v[44:47]
    s_nop 0
    ds_read_b128 v[62:65], v137 offset:3328
    v_mov_b32_dpp v31, v67 quad_perm:[0,1,2,3] row_mask:0x4 bank_mask:0xf
    v_mfma_f32_16x16x32_bf16 v[44:47], a[248:251], v[68:71], v[44:47]
    ds_read_b128 v[66:69], v136 offset:3328
    v_cvt_pk_bf16_f32 v31, v31, v31
    v_mfma_f32_16x16x32_bf16 v[44:47], a[252:255], v[72:75], v[44:47]
    v_exp_f32 v43, v43
    v_mfma_f32_16x16x32_bf16 v[44:47], v[224:227], v[36:39], v[44:47]
    v_exp_f32 v54, v54
    v_mfma_f32_16x16x32_bf16 v[44:47], v[228:231], v[84:87], v[44:47]
    v_exp_f32 v152, v152
    v_mfma_f32_16x16x32_f16 v[36:39], v[8:11], v[24:27], v[188:191]
    ds_write_b16 v131, v31
    v_mfma_f32_16x16x32_f16 v[36:39], v[146:149], v[144:147], v[36:39]
    s_waitcnt lgkmcnt(5)
    v_exp_f32 v153, v153
    v_mfma_f32_16x16x32_bf16 v[88:91], a[240:243], v[12:15], 0
    s_waitcnt lgkmcnt(4)
    v_exp_f32 v154, v154
    v_mfma_f32_16x16x32_bf16 v[88:91], a[244:247], v[98:101], v[88:91]
    v_exp_f32 v155, v155
    v_mfma_f32_16x16x32_bf16 v[88:91], a[248:251], v[92:95], v[88:91]
    s_waitcnt lgkmcnt(2)
    ds_write_b32 v134, v18 offset:0
    v_mfma_f32_16x16x32_bf16 v[88:91], a[252:255], v[104:107], v[88:91]
    v_cvt_pk_bf16_f32 v30, v152, v153
    v_cvt_pk_bf16_f32 v31, v154, v155
    v_mfma_f32_16x16x32_bf16 v[88:91], v[224:227], v[62:65], v[88:91]
    s_waitcnt lgkmcnt(2)
    v_exp_f32 v36, v36
    v_mfma_f32_16x16x32_bf16 v[88:91], v[228:231], v[66:69], v[88:91]
    v_exp_f32 v37, v37
    v_mfma_f32_16x16x32_bf16 v[24:27], a[216:219], v[12:15], 0
    ds_write_b32 v134, v19 offset:4
    v_mfma_f32_16x16x32_bf16 v[24:27], a[220:223], v[98:101], v[24:27]
    v_exp_f32 v38, v38
    v_mfma_f32_16x16x32_bf16 v[24:27], a[224:227], v[92:95], v[24:27]
    v_exp_f32 v39, v39
    v_mfma_f32_16x16x32_bf16 v[24:27], a[228:231], v[104:107], v[24:27]
    v_cvt_pk_bf16_f32 v18, v36, v37
    v_cvt_pk_bf16_f32 v19, v38, v39
    v_mfma_f32_16x16x32_bf16 v[24:27], a[232:235], v[62:65], v[24:27]
    v_exp_f32 v108, v108
    v_mfma_f32_16x16x32_bf16 v[24:27], a[236:239], v[66:69], v[24:27]
    v_exp_f32 v109, v109
    v_mfma_f32_16x16x32_bf16 v[152:155], v[220:223], v[16:19], 0
    v_exp_f32 v110, v110
    v_mfma_f32_16x16x32_bf16 v[152:155], v[220:223], v[168:171], v[152:155]
    s_nop 0
    v_exp_f32 v111, v111
    v_mfma_f32_16x16x32_bf16 v[36:39], v[0:3], v[16:19], 0
    s_nop 0
    v_cvt_pk_bf16_f32 v28, v108, v109
    v_cvt_pk_bf16_f32 v29, v110, v111
    v_mfma_f32_16x16x32_bf16 v[36:39], v[164:167], v[168:171], v[36:39]
    s_nop 0
    v_rcp_f32 v152, v152
    v_mfma_f32_16x16x32_bf16 v[146:149], v[20:23], v[16:19], 0
    v_add_u32 v137, s48, v137
    v_add_u32 v136, s48, v136
    v_mfma_f32_16x16x32_bf16 v[146:149], v[160:163], v[168:171], v[146:149]
    s_nop 0
    ds_read_b128 v[84:87], v137 offset:0
    v_mul_f32 v36, v36, v152
    v_mfma_f32_16x16x32_bf16 v[76:79], v[4:7], v[16:19], 0
    ds_read_b128 v[108:111], v136 offset:0
    v_mul_f32 v37, v37, v152
    v_mfma_f32_16x16x32_bf16 v[76:79], v[156:159], v[168:171], v[76:79]
    ds_read_b128 v[8:11], v137 offset:128
    v_cvt_pk_bf16_f32 v168, v40, v41
    v_mfma_f32_16x16x32_bf16 v[72:75], v[232:235], v[12:15], 0
    ds_read_b128 v[112:115], v136 offset:128
    v_cvt_pk_bf16_f32 v169, v42, v43
    v_mfma_f32_16x16x32_bf16 v[72:75], v[236:239], v[98:101], v[72:75]
    ds_read_b128 v[40:43], v137 offset:256
    v_cvt_pk_bf16_f32 v170, v54, 0
    v_mfma_f32_16x16x32_bf16 v[72:75], v[240:243], v[92:95], v[72:75]
    ds_read_b128 v[52:55], v136 offset:256
    v_cvt_pk_bf16_f32 v12, v36, v37
    v_mfma_f32_16x16x32_bf16 v[72:75], v[244:247], v[104:107], v[72:75]
    ds_read_b128 v[104:107], v136 offset:1792
    v_mul_f32 v38, v38, v152
    v_mfma_f32_16x16x32_bf16 v[72:75], v[248:251], v[62:65], v[72:75]
    ds_read_b128 v[60:63], v136 offset:1536
    v_mul_f32 v39, v39, v152
    v_mfma_f32_16x16x32_bf16 v[72:75], v[252:255], v[66:69], v[72:75]
    ds_read_b128 v[98:101], v137 offset:1664
    v_cvt_pk_bf16_f32 v13, v38, v39
    v_mfma_f32_16x16x32_bf16 v[36:39], v[220:223], v[28:31], 0
    ds_read_b128 v[68:71], v137 offset:1536
    v_mul_f32 v146, v146, v152
    v_mfma_f32_16x16x32_bf16 v[36:39], v[220:223], v[168:171], v[36:39]
    v_mul_f32 v147, v147, v152
    v_cvt_pk_bf16_f32 v14, v146, v147
    v_mfma_f32_16x16x32_bf16 v[64:67], v[0:3], v[28:31], 0
    v_mul_f32 v148, v148, v152
    v_mul_f32 v149, v149, v152
    v_mfma_f32_16x16x32_bf16 v[64:67], v[164:167], v[168:171], v[64:67]
    v_cvt_pk_bf16_f32 v15, v148, v149
    v_mul_f32 v76, v76, v152
    v_mfma_f32_16x16x32_bf16 v[0:3], v[20:23], v[28:31], 0
    ds_write_b32 v135, v12 offset:1536
    v_mfma_f32_16x16x32_bf16 v[0:3], v[160:163], v[168:171], v[0:3]
    v_mul_f32 v77, v77, v152
    v_cvt_pk_bf16_f32 v154, v76, v77
    v_mfma_f32_16x16x32_bf16 v[146:149], v[4:7], v[28:31], 0
    v_mul_f32 v78, v78, v152
    v_mul_f32 v79, v79, v152
    v_mfma_f32_16x16x32_bf16 v[146:149], v[156:159], v[168:171], v[146:149]
    s_waitcnt lgkmcnt(3)
    v_cvt_pk_bf16_f32 v155, v78, v79
    v_fmac_f32 v32, v83, v83
    v_mfma_f32_16x16x32_bf16 v[28:31], a[0:3], v[84:87], 0
    s_cbranch_scc1 L_loopF0
L_tailF:
    ds_write_b32 v135, v13 offset:1540
    v_rcp_f32 v36, v36
    s_mov_b32 s30, 100270464
    s_mul_i32 s89, s68, 7168
    ds_write_b64 v135, v[14:15] offset:1544
    v_mul_f32 v64, v64, v36
    v_mul_f32 v65, v65, v36
    v_cvt_pk_bf16_f32 v4, v64, v65
    s_add_u32 s89, s89, 135168
    s_movk_i32 s90, 112
    ds_write_b64 v134, v[154:155] offset:1536
    v_mul_f32 v66, v66, v36
    v_mul_f32 v67, v67, v36
    v_cvt_pk_bf16_f32 v5, v66, v67
    v_mul_f32 v0, v0, v36
    v_mul_f32 v1, v1, v36
    v_cvt_pk_bf16_f32 v6, v0, v1
    v_mul_f32 v2, v2, v36
    v_mul_f32 v3, v3, v36
    v_cvt_pk_bf16_f32 v7, v2, v3
    v_mul_f32 v146, v146, v36
    v_mul_f32 v147, v147, v36
    v_cvt_pk_bf16_f32 v120, v146, v147
    v_mul_f32 v148, v148, v36
    v_mul_f32 v149, v149, v36
    v_cvt_pk_bf16_f32 v121, v148, v149
    s_lshr_b32 s91, s64, 16
    s_lshl_b32 s92, s68, 10
    ds_write_b64 v135, v[4:5] offset:3072
    v_fmac_f32 v32, v116, v116
    s_sub_u32 s84, s45, s44
    s_sub_u32 s85, s46, s45
    ds_write_b64 v135, v[6:7] offset:3080
    v_fmac_f32 v32, v117, v117
    v_fmac_f32 v32, v118, v118
    v_fmac_f32 v32, v119, v119
    s_sub_u32 s86, s44, s45
    s_sub_u32 s93, s44, s47
    ds_write_b32 v134, v120 offset:3072
    ds_write_b32 v134, v121 offset:3076
    v_fma_f32 v120, v140, v140, s42
    v_fmac_f32 v120, v141, v141
    v_fmac_f32 v120, v142, v142
    v_fmac_f32 v120, v143, v143
    v_fmac_f32 v120, v44, v44
    v_fmac_f32 v120, v45, v45
    v_fmac_f32 v120, v46, v46
    v_fmac_f32 v120, v47, v47
    v_fmac_f32 v120, v56, v56
    v_fmac_f32 v120, v57, v57
    v_fmac_f32 v120, v58, v58
    v_fmac_f32 v120, v59, v59
    v_fma_f32 v121, v24, v24, s42
    v_fmac_f32 v121, v25, v25
    v_fmac_f32 v121, v26, v26
    v_fmac_f32 v121, v27, v27
    v_fmac_f32 v121, v88, v88
    v_fmac_f32 v121, v89, v89
    v_fmac_f32 v121, v90, v90
    v_fmac_f32 v121, v91, v91
    v_fmac_f32 v121, v72, v72
    v_fmac_f32 v121, v73, v73
    v_fmac_f32 v121, v74, v74
    v_fmac_f32 v121, v75, v75
    v_cvt_pk_bf16_f32 v120, v32, v120
    v_cvt_pk_bf16_f32 v121, v121, v122
    s_sub_u32 s94, s45, s47
    s_sub_u32 s95, s46, s47
    ds_write_b64 v130, v[120:121]
    v_mbcnt_lo_u32_b32 v131, -1, 0
    v_mbcnt_hi_u32_b32 v131, -1, v131
    v_and_b32 v138, 15, v131
    v_lshrrev_b32 v131, 4, v131
    v_mul_u32_u24 v131, 1792, v131
    v_add_u32 v131, s89, v131
    v_mad_u32_u24 v132, v138, s90, v131
    v_lshrrev_b32 v139, v138, s64
    v_and_b32 v139, 1, v139
    v_cmp_eq_u32 vcc, 1, v139
    v_mad_u32_u24 v16, v138, s90, v131
    v_lshrrev_b32 v138, v138, s91
    v_cndmask_b32 v132, v131, v132, vcc
    v_and_b32 v138, 1, v138
    v_subrev_u32 v16, 28672, v16
    v_cmp_eq_u32 vcc, 1, v138
    ds_read_b128 v[36:39], v132 offset:64
    ds_read_b128 v[32:35], v132 offset:80
    v_cndmask_b32 v16, v131, v16, vcc
    v_add_u32 v131, s92, v129
    s_waitcnt lgkmcnt(2)
    s_barrier
    ds_read_b128 v[4:7], v132
    v_add_u32 v18, s84, v137
    ds_read_b64 v[8:9], v132 offset:16
    ds_read_b128 v[0:3], v131 offset:6144
    v_add_u32 v17, s84, v136
    v_add_u32 v120, s85, v135
    ds_read_b128 v[28:31], v129 offset:0
    v_add_u32 v19, s85, v134
    ds_read_b128 v[20:23], v129 offset:1024
    v_add_u32 v138, s86, v135
    v_add_u32 v132, s86, v134
    v_add_u32 v131, s93, v133
    v_add_u32 v139, s94, v133
    s_waitcnt lgkmcnt(6)
    v_mfma_f32_16x16x32_bf16 v[12:15], v[220:223], v[36:39], 0
    s_waitcnt lgkmcnt(5)
    ds_read_b128 a[24:27], v18 offset:1536
    ds_read_b128 a[28:31], v17 offset:1536
    v_mfma_f32_16x16x32_bf16 v[12:15], v[220:223], v[32:35], v[12:15]
    s_waitcnt lgkmcnt(3)
    ds_read_b128 a[32:35], v18 offset:1664
    v_lshlrev_b32 v122, 16, v4
    v_and_b32 v4, 0xffff0000, v4
    v_lshlrev_b32 v121, 16, v5
    v_and_b32 v5, 0xffff0000, v5
    v_lshlrev_b32 v11, 16, v6
    v_and_b32 v6, 0xffff0000, v6
    v_rcp_f32 v12, v12
    v_lshlrev_b32 v10, 16, v7
    v_mfma_f32_16x16x32_bf16 v[64:67], v[216:219], v[28:31], 0
    s_waitcnt lgkmcnt(3)
    ds_read_b128 a[36:39], v17 offset:1664
    ds_read_b128 a[40:43], v18 offset:1792
    v_mfma_f32_16x16x32_bf16 v[64:67], v[216:219], v[20:23], v[64:67]
    s_waitcnt lgkmcnt(4)
    ds_read_b128 a[44:47], v17 offset:1792
    v_mul_f32 v122, v122, v12
    v_mul_f32 v4, v4, v12
    v_cvt_pk_bf16_f32 v4, v122, v4
    v_mul_f32 v121, v121, v12
    v_mfma_f32_16x16x32_bf16 v[32:35], a[216:219], a[24:27], 0
    s_waitcnt lgkmcnt(4)
    v_mul_f32 v5, v5, v12
    v_cvt_pk_bf16_f32 v5, v121, v5
    v_mfma_f32_16x16x32_bf16 v[32:35], a[220:223], a[28:31], v[32:35]
    s_waitcnt lgkmcnt(3)
    ds_read_b128 a[0:3], v18 offset:0
    ds_read_b128 a[4:7], v17 offset:0
    v_mfma_f32_16x16x32_bf16 v[32:35], a[224:227], a[32:35], v[32:35]
    s_waitcnt lgkmcnt(4)
    ds_read_b128 a[8:11], v18 offset:128
    v_mul_f32 v11, v11, v12
    v_mul_f32 v6, v6, v12
    v_cvt_pk_bf16_f32 v6, v11, v6
    v_and_b32 v7, 0xffff0000, v7
    v_mul_f32 v10, v10, v12
    v_mfma_f32_16x16x32_bf16 v[32:35], a[228:231], a[36:39], v[32:35]
    s_waitcnt lgkmcnt(4)
    ds_read_b128 a[12:15], v17 offset:128
    ds_read_b128 a[16:19], v18 offset:256
    v_mfma_f32_16x16x32_bf16 v[32:35], a[232:235], a[40:43], v[32:35]
    s_waitcnt lgkmcnt(5)
    ds_read_b128 a[20:23], v17 offset:256
    v_mul_f32 v7, v7, v12
    v_mfma_f32_16x16x32_bf16 v[32:35], a[236:239], a[44:47], v[32:35]
    v_cvt_pk_bf16_f32 v7, v10, v7
    v_lshlrev_b32 v67, 16, v8
    v_mfma_f32_16x16x32_bf16 v[40:43], a[240:243], a[24:27], 0
    ds_write_b128 v138, v[4:7] offset:0
    v_mfma_f32_16x16x32_bf16 v[40:43], a[244:247], a[28:31], v[40:43]
    v_and_b32 v8, 0xffff0000, v8
    v_mul_f32 v67, v67, v12
    v_mfma_f32_16x16x32_bf16 v[40:43], a[248:251], a[32:35], v[40:43]
    v_mul_f32 v8, v8, v12
    v_cvt_pk_bf16_f32 v4, v67, v8
    v_mfma_f32_16x16x32_bf16 v[40:43], a[252:255], a[36:39], v[40:43]
    v_lshlrev_b32 v67, 16, v9
    v_and_b32 v9, 0xffff0000, v9
    v_mfma_f32_16x16x32_bf16 v[40:43], v[224:227], a[40:43], v[40:43]
    v_mul_f32 v67, v67, v12
    v_mul_f32 v9, v9, v12
    v_mfma_f32_16x16x32_bf16 v[40:43], v[228:231], a[44:47], v[40:43]
    v_cvt_pk_bf16_f32 v5, v67, v9
    v_lshrrev_b32 v67, 0, v3
    v_mfma_f32_16x16x32_bf16 v[36:39], v[232:235], a[24:27], 0
    ds_write_b64 v132, v[4:5] offset:0
    v_mfma_f32_16x16x32_bf16 v[36:39], v[236:239], a[28:31], v[36:39]
    v_lshrrev_b32 v67, v67, s64
    v_and_b32 v67, 1, v67
    v_mfma_f32_16x16x32_bf16 v[36:39], v[240:243], a[32:35], v[36:39]
    v_cmp_eq_u32 vcc, 1, v67
    v_lshrrev_b32 v67, 8, v3
    v_mfma_f32_16x16x32_bf16 v[36:39], v[244:247], a[36:39], v[36:39]
    v_cndmask_b32 v0, 2.0, v0, vcc
    v_lshrrev_b32 v67, v67, s64
    v_mfma_f32_16x16x32_bf16 v[36:39], v[248:251], a[40:43], v[36:39]
    v_and_b32 v67, 1, v67
    v_cmp_eq_u32 vcc, 1, v67
    v_mfma_f32_16x16x32_bf16 v[36:39], v[252:255], a[44:47], v[36:39]
    s_waitcnt lgkmcnt(1)
    v_cndmask_b32 v1, 2.0, v1, vcc
    v_lshrrev_b32 v3, 16, v3
    v_mfma_f32_16x16x32_bf16 v[52:55], a[216:219], a[0:3], 0
    v_lshrrev_b32 v3, v3, s64
    v_and_b32 v3, 1, v3
    v_mfma_f32_16x16x32_bf16 v[52:55], a[220:223], a[4:7], v[52:55]
    ds_read_b128 a[48:51], v18 offset:3072
    ds_read_b128 a[52:55], v17 offset:3072
    v_mfma_f32_16x16x32_bf16 v[52:55], a[224:227], a[8:11], v[52:55]
    ds_read_b128 a[56:59], v18 offset:3200
    v_cmp_eq_u32 vcc, 1, v3
    v_mfma_f32_16x16x32_bf16 v[52:55], a[228:231], a[12:15], v[52:55]
    ds_read_b128 a[60:63], v17 offset:3200
    v_cndmask_b32 v2, 2.0, v2, vcc
    v_mfma_f32_16x16x32_bf16 v[52:55], a[232:235], a[16:19], v[52:55]
L_pg2:
    s_cbranch_execz L_main
    ds_read_b128 a[64:67], v18 offset:3328
    v_add_u32 v3, s95, v133
    v_mfma_f32_16x16x32_bf16 v[52:55], a[236:239], a[20:23], v[52:55]
    ds_read_b128 a[68:71], v17 offset:3328
    v_fma_f32 v18, v32, v32, s42
    v_mfma_f32_16x16x32_bf16 v[28:31], a[240:243], a[0:3], 0
    v_rsq_f32 v64, v64
    v_mfma_f32_16x16x32_bf16 v[28:31], a[244:247], a[4:7], v[28:31]
    v_mul_f32 v64, s43, v64
    v_mul_f32 v48, v48, v64
    v_mfma_f32_16x16x32_bf16 v[28:31], a[248:251], a[8:11], v[28:31]
    v_mul_f32 v49, v49, v64
    v_cvt_pk_bf16_f32 v4, v48, v49
    v_mfma_f32_16x16x32_bf16 v[28:31], a[252:255], a[12:15], v[28:31]
    v_mul_f32 v50, v50, v64
    v_mul_f32 v51, v51, v64
    v_mfma_f32_16x16x32_bf16 v[28:31], v[224:227], a[16:19], v[28:31]
    v_cvt_pk_bf16_f32 v5, v50, v51
    v_mul_f32 v80, v80, v64
    v_mfma_f32_16x16x32_bf16 v[28:31], v[228:231], a[20:23], v[28:31]
    v_mul_f32 v81, v81, v64
    v_cvt_pk_bf16_f32 v6, v80, v81
    v_mfma_f32_16x16x32_bf16 v[48:51], v[232:235], a[0:3], 0
    v_mul_f32 v82, v82, v64
    v_mul_f32 v83, v83, v64
    v_mfma_f32_16x16x32_bf16 v[48:51], v[236:239], a[4:7], v[48:51]
    v_cvt_pk_bf16_f32 v7, v82, v83
    v_mul_f32 v116, v116, v64
    v_mfma_f32_16x16x32_bf16 v[48:51], v[240:243], a[8:11], v[48:51]
    ds_write_b128 v120, v[4:7] offset:0
    v_mfma_f32_16x16x32_bf16 v[48:51], v[244:247], a[12:15], v[48:51]
    v_mul_f32 v117, v117, v64
    v_cvt_pk_bf16_f32 v116, v116, v117
    v_mfma_f32_16x16x32_bf16 v[48:51], v[248:251], a[16:19], v[48:51]
    v_mul_f32 v118, v118, v64
    v_mul_f32 v119, v119, v64
    v_mfma_f32_16x16x32_bf16 v[48:51], v[252:255], a[20:23], v[48:51]
    s_waitcnt lgkmcnt(1)
    v_cvt_pk_bf16_f32 v117, v118, v119
    v_fma_f32 v133, v52, v52, s42
    v_mfma_f32_16x16x32_bf16 v[4:7], a[216:219], a[48:51], 0
    ds_write_b64 v19, v[116:117] offset:0
    v_mfma_f32_16x16x32_bf16 v[4:7], a[220:223], a[52:55], v[4:7]
    ds_read_b128 v[68:71], v16 offset:64
    v_fmac_f32 v133, v53, v53
    v_mfma_f32_16x16x32_bf16 v[4:7], a[224:227], a[56:59], v[4:7]
    ds_read_b128 v[8:11], v16 offset:80
    v_fmac_f32 v133, v54, v54
    v_mfma_f32_16x16x32_bf16 v[4:7], a[228:231], a[60:63], v[4:7]
    ds_read_b128 v[12:15], v16
    v_fmac_f32 v133, v55, v55
    v_mfma_f32_16x16x32_bf16 v[4:7], a[232:235], a[64:67], v[4:7]
    ds_read_b64 v[16:17], v16 offset:16
    v_fmac_f32 v133, v28, v28
    v_mfma_f32_16x16x32_bf16 v[4:7], a[236:239], a[68:71], v[4:7]
    v_rsq_f32 v65, v65
    v_mfma_f32_16x16x32_bf16 v[60:63], a[240:243], a[48:51], 0
    v_mul_f32 v65, s43, v65
    v_mul_f32 v140, v140, v65
    v_mfma_f32_16x16x32_bf16 v[60:63], a[244:247], a[52:55], v[60:63]
    v_mul_f32 v141, v141, v65
    v_cvt_pk_bf16_f32 v76, v140, v141
    v_mfma_f32_16x16x32_bf16 v[60:63], a[248:251], a[56:59], v[60:63]
    v_mul_f32 v142, v142, v65
    v_mul_f32 v143, v143, v65
    v_mfma_f32_16x16x32_bf16 v[60:63], a[252:255], a[60:63], v[60:63]
    v_cvt_pk_bf16_f32 v77, v142, v143
    v_mul_f32 v44, v44, v65
    v_mfma_f32_16x16x32_bf16 v[60:63], v[224:227], a[64:67], v[60:63]
    v_mul_f32 v45, v45, v65
    v_cvt_pk_bf16_f32 v78, v44, v45
    v_mfma_f32_16x16x32_bf16 v[60:63], v[228:231], a[68:71], v[60:63]
    v_mul_f32 v46, v46, v65
    v_mul_f32 v47, v47, v65
    v_mfma_f32_16x16x32_bf16 v[20:23], v[232:235], a[48:51], 0
    v_cvt_pk_bf16_f32 v79, v46, v47
    v_mul_f32 v56, v56, v65
    v_mfma_f32_16x16x32_bf16 v[20:23], v[236:239], a[52:55], v[20:23]
    ds_write_b128 v120, v[76:79] offset:1536
    v_mfma_f32_16x16x32_bf16 v[20:23], v[240:243], a[56:59], v[20:23]
    v_mul_f32 v57, v57, v65
    v_cvt_pk_bf16_f32 v56, v56, v57
    v_mfma_f32_16x16x32_bf16 v[20:23], v[244:247], a[60:63], v[20:23]
    v_mul_f32 v58, v58, v65
    v_mul_f32 v59, v59, v65
    v_mfma_f32_16x16x32_bf16 v[20:23], v[248:251], a[64:67], v[20:23]
    v_cvt_pk_bf16_f32 v57, v58, v59
    v_fmac_f32 v133, v29, v29
    v_mfma_f32_16x16x32_bf16 v[20:23], v[252:255], a[68:71], v[20:23]
    s_waitcnt lgkmcnt(1)
    ds_write_b64 v19, v[56:57] offset:1536
    v_mfma_f32_16x16x32_bf16 v[44:47], v[220:223], v[68:71], 0
    v_rsq_f32 v66, v66
    v_mfma_f32_16x16x32_bf16 v[44:47], v[220:223], v[8:11], v[44:47]
    v_mul_f32 v66, s43, v66
    v_mul_f32 v24, v24, v66
    v_mul_f32 v25, v25, v66
    v_cvt_pk_bf16_f32 v8, v24, v25
    v_mul_f32 v26, v26, v66
    v_mul_f32 v27, v27, v66
    v_cvt_pk_bf16_f32 v9, v26, v27
    v_mul_f32 v88, v88, v66
    v_mul_f32 v89, v89, v66
    v_cvt_pk_bf16_f32 v10, v88, v89
    v_mul_f32 v90, v90, v66
    v_mul_f32 v91, v91, v66
    v_cvt_pk_bf16_f32 v11, v90, v91
    v_mul_f32 v72, v72, v66
    v_mul_f32 v73, v73, v66
    v_cvt_pk_bf16_f32 v72, v72, v73
    v_mul_f32 v74, v74, v66
    v_mul_f32 v75, v75, v66
    v_cvt_pk_bf16_f32 v73, v74, v75
    ds_write_b128 v120, v[8:11] offset:3072
    v_fmac_f32 v133, v30, v30
    v_fmac_f32 v133, v31, v31
    v_fmac_f32 v133, v48, v48
    v_fmac_f32 v133, v49, v49
    ds_write_b64 v19, v[72:73] offset:3072
    v_fmac_f32 v133, v50, v50
    v_fmac_f32 v133, v51, v51
    v_fmac_f32 v18, v33, v33
    v_fmac_f32 v18, v34, v34
    v_fmac_f32 v18, v35, v35
    v_fmac_f32 v18, v40, v40
    v_fmac_f32 v18, v41, v41
    v_fmac_f32 v18, v42, v42
    v_fmac_f32 v18, v43, v43
    v_fmac_f32 v18, v36, v36
    v_fmac_f32 v18, v37, v37
    v_fmac_f32 v18, v38, v38
    v_fmac_f32 v18, v39, v39
    v_cvt_pk_bf16_f32 v18, v133, v18
    v_fma_f32 v133, v4, v4, s42
    v_fmac_f32 v133, v5, v5
    v_fmac_f32 v133, v6, v6
    v_fmac_f32 v133, v7, v7
    v_fmac_f32 v133, v60, v60
    v_fmac_f32 v133, v61, v61
    v_fmac_f32 v133, v62, v62
    v_fmac_f32 v133, v63, v63
    v_fmac_f32 v133, v20, v20
    v_fmac_f32 v133, v21, v21
    v_fmac_f32 v133, v22, v22
    v_fmac_f32 v133, v23, v23
    v_cvt_pk_bf16_f32 v19, v133, v133
    ds_write_b64 v130, v[18:19] offset:2048
    v_rcp_f32 v44, v44
    v_lshlrev_b32 v133, 16, v12
    v_and_b32 v12, 0xffff0000, v12
    v_mul_f32 v133, v133, v44
    v_mul_f32 v12, v12, v44
    v_cvt_pk_bf16_f32 v12, v133, v12
    v_lshlrev_b32 v133, 16, v13
    v_and_b32 v13, 0xffff0000, v13
    v_mul_f32 v133, v133, v44
    v_mul_f32 v13, v13, v44
    v_cvt_pk_bf16_f32 v13, v133, v13
    v_lshlrev_b32 v133, 16, v14
    v_and_b32 v14, 0xffff0000, v14
    v_mul_f32 v133, v133, v44
    v_mul_f32 v14, v14, v44
    v_cvt_pk_bf16_f32 v14, v133, v14
    v_lshlrev_b32 v133, 16, v15
    v_and_b32 v15, 0xffff0000, v15
    v_mul_f32 v133, v133, v44
    v_mul_f32 v15, v15, v44
    v_cvt_pk_bf16_f32 v15, v133, v15
    v_lshlrev_b32 v133, 16, v16
    v_and_b32 v16, 0xffff0000, v16
    v_mul_f32 v133, v133, v44
    v_mul_f32 v16, v16, v44
    v_cvt_pk_bf16_f32 v8, v133, v16
    v_lshlrev_b32 v133, 16, v17
    v_and_b32 v17, 0xffff0000, v17
    v_mul_f32 v133, v133, v44
    v_mul_f32 v17, v17, v44
    v_cvt_pk_bf16_f32 v9, v133, v17
    s_waitcnt lgkmcnt(0)
    s_barrier
    ds_write_b128 v138, v[12:15] offset:1536
    v_and_b32 v123, 0xb8000000, v123
    v_mov_b32 v121, 0x3f803f80
    v_cmp_ne_u32 vcc, 0, v123
    s_nop 0
    ds_write_b64 v132, v[8:9] offset:1536
    v_cndmask_b32 v121, 0, v121, vcc
    ds_read_b128 a[144:147], v3 offset:0
    ds_read_b128 a[148:151], v3 offset:1024
    ds_read_b128 a[152:155], v3 offset:2048
    ds_read_b128 a[156:159], v3 offset:3072
    ds_read_b128 a[160:163], v3 offset:4096
    s_waitcnt lgkmcnt(5)
    s_barrier
    s_waitcnt lgkmcnt(4)
    buffer_store_dwordx4 a[144:147], v128, s[28:31], s59 offen sc1
    ds_read_b128 v[16:19], v129 offset:2048
    ds_read_b128 v[8:11], v129 offset:3072
    ds_read_b128 a[96:99], v137 offset:1536
    ds_read_b128 a[100:103], v136 offset:1536
    ds_read_b128 a[104:107], v137 offset:1664
    ds_read_b128 a[108:111], v136 offset:1664
    ds_read_b128 a[112:115], v137 offset:1792
    s_waitcnt lgkmcnt(9)
    buffer_store_dwordx4 a[148:151], v127, s[28:31], s59 offen sc1
    ds_read_b128 a[116:119], v136 offset:1792
    s_waitcnt lgkmcnt(7)
    v_mfma_f32_16x16x32_bf16 v[12:15], v[216:219], v[16:19], 0
    s_waitcnt lgkmcnt(6)
    v_mfma_f32_16x16x32_bf16 v[12:15], v[216:219], v[8:11], v[12:15]
    s_waitcnt lgkmcnt(5)
    v_mfma_f32_16x16x32_bf16 v[8:11], a[216:219], a[96:99], 0
    s_waitcnt lgkmcnt(4)
    v_mfma_f32_16x16x32_bf16 v[8:11], a[220:223], a[100:103], v[8:11]
    s_waitcnt lgkmcnt(3)
    ds_read_b128 a[72:75], v137 offset:0
    ds_read_b128 a[76:79], v136 offset:0
    v_mfma_f32_16x16x32_bf16 v[8:11], a[224:227], a[104:107], v[8:11]
    s_waitcnt lgkmcnt(4)
    ds_read_b128 a[80:83], v137 offset:128
    v_mfma_f32_16x16x32_bf16 v[8:11], a[228:231], a[108:111], v[8:11]
    s_waitcnt lgkmcnt(4)
    buffer_store_dwordx4 a[152:155], v126, s[28:31], s59 offen sc1
    ds_read_b128 a[84:87], v136 offset:128
    v_rsq_f32 v12, v12
    v_mfma_f32_16x16x32_bf16 v[8:11], a[232:235], a[112:115], v[8:11]
    s_waitcnt lgkmcnt(4)
    ds_read_b128 a[88:91], v137 offset:256
    ds_read_b128 a[92:95], v136 offset:256
    v_mfma_f32_16x16x32_bf16 v[8:11], a[236:239], a[116:119], v[8:11]
    v_rsq_f32 v13, v13
    v_mfma_f32_16x16x32_bf16 v[16:19], a[240:243], a[96:99], 0
    v_mul_f32 v12, s43, v12
    v_mul_f32 v13, s43, v13
    v_mfma_f32_16x16x32_bf16 v[16:19], a[244:247], a[100:103], v[16:19]
    v_rsq_f32 v14, v14
    v_mfma_f32_16x16x32_bf16 v[16:19], a[248:251], a[104:107], v[16:19]
    v_mul_f32 v14, s43, v14
    v_mul_f32 v4, v4, v14
    v_mfma_f32_16x16x32_bf16 v[16:19], a[252:255], a[108:111], v[16:19]
    buffer_store_dwordx4 a[156:159], v125, s[28:31], s59 offen sc1
    v_mul_f32 v5, v5, v14
    v_cvt_pk_bf16_f32 v24, v4, v5
    v_mul_f32 v6, v6, v14
    v_mul_f32 v7, v7, v14
    v_mfma_f32_16x16x32_bf16 v[16:19], v[224:227], a[112:115], v[16:19]
    v_cvt_pk_bf16_f32 v25, v6, v7
    v_mul_f32 v60, v60, v14
    v_mfma_f32_16x16x32_bf16 v[16:19], v[228:231], a[116:119], v[16:19]
    v_mul_f32 v61, v61, v14
    v_cvt_pk_bf16_f32 v26, v60, v61
    v_mfma_f32_16x16x32_bf16 v[4:7], v[232:235], a[96:99], 0
    v_mul_f32 v62, v62, v14
    v_mul_f32 v63, v63, v14
    v_mfma_f32_16x16x32_bf16 v[4:7], v[236:239], a[100:103], v[4:7]
    v_cvt_pk_bf16_f32 v27, v62, v63
    v_mul_f32 v20, v20, v14
    v_mfma_f32_16x16x32_bf16 v[4:7], v[240:243], a[104:107], v[4:7]
    ds_write_b128 v135, v[24:27] offset:3072
    v_mfma_f32_16x16x32_bf16 v[4:7], v[244:247], a[108:111], v[4:7]
    buffer_store_dwordx4 a[160:163], v124, s[28:31], s59 offen sc1
    v_mul_f32 v21, v21, v14
    v_cvt_pk_bf16_f32 v136, v20, v21
    v_mul_f32 v22, v22, v14
    v_mul_f32 v23, v23, v14
    v_mfma_f32_16x16x32_bf16 v[4:7], v[248:251], a[112:115], v[4:7]
    v_cvt_pk_bf16_f32 v137, v22, v23
    v_mul_f32 v52, v52, v12
    v_mfma_f32_16x16x32_bf16 v[4:7], v[252:255], a[116:119], v[4:7]
    s_waitcnt lgkmcnt(1)
    ds_write_b64 v134, v[136:137] offset:3072
    v_mfma_f32_16x16x32_bf16 v[20:23], a[216:219], a[72:75], 0
    v_mul_f32 v53, v53, v12
    v_cvt_pk_bf16_f32 v24, v52, v53
    v_mfma_f32_16x16x32_bf16 v[20:23], a[220:223], a[76:79], v[20:23]
    v_mul_f32 v54, v54, v12
    v_mul_f32 v55, v55, v12
    v_mfma_f32_16x16x32_bf16 v[20:23], a[224:227], a[80:83], v[20:23]
    v_cvt_pk_bf16_f32 v25, v54, v55
    v_mul_f32 v28, v28, v12
    v_mfma_f32_16x16x32_bf16 v[20:23], a[228:231], a[84:87], v[20:23]
    v_mul_f32 v29, v29, v12
    v_cvt_pk_bf16_f32 v26, v28, v29
    v_mfma_f32_16x16x32_bf16 v[20:23], a[232:235], a[88:91], v[20:23]
    v_mul_f32 v30, v30, v12
    v_mul_f32 v31, v31, v12
    v_mfma_f32_16x16x32_bf16 v[20:23], a[236:239], a[92:95], v[20:23]
    v_cvt_pk_bf16_f32 v27, v30, v31
    v_mul_f32 v48, v48, v12
    v_mfma_f32_16x16x32_bf16 v[28:31], a[240:243], a[72:75], 0
    ds_write_b128 v135, v[24:27] offset:0
    v_mfma_f32_16x16x32_bf16 v[28:31], a[244:247], a[76:79], v[28:31]
    v_mul_f32 v49, v49, v12
    v_cvt_pk_bf16_f32 v14, v48, v49
    v_mfma_f32_16x16x32_bf16 v[28:31], a[248:251], a[80:83], v[28:31]
    v_mul_f32 v50, v50, v12
    v_mul_f32 v51, v51, v12
    v_mfma_f32_16x16x32_bf16 v[28:31], a[252:255], a[84:87], v[28:31]
    v_cvt_pk_bf16_f32 v15, v50, v51
    v_fma_f32 v3, v8, v8, s42
    v_mfma_f32_16x16x32_bf16 v[28:31], v[224:227], a[88:91], v[28:31]
    ds_write_b64 v134, v[14:15] offset:0
    v_mfma_f32_16x16x32_bf16 v[28:31], v[228:231], a[92:95], v[28:31]
    v_fmac_f32 v3, v9, v9
    v_fmac_f32 v3, v10, v10
    v_mfma_f32_16x16x32_bf16 v[24:27], v[232:235], a[72:75], 0
    v_fmac_f32 v3, v11, v11
    v_fmac_f32 v3, v16, v16
    v_mfma_f32_16x16x32_bf16 v[24:27], v[236:239], a[76:79], v[24:27]
    v_fmac_f32 v3, v17, v17
    v_fmac_f32 v3, v18, v18
    v_mfma_f32_16x16x32_bf16 v[24:27], v[240:243], a[80:83], v[24:27]
    v_fmac_f32 v3, v19, v19
    v_fmac_f32 v3, v4, v4
    v_mfma_f32_16x16x32_bf16 v[24:27], v[244:247], a[84:87], v[24:27]
    v_fmac_f32 v3, v5, v5
    v_fmac_f32 v3, v6, v6
    v_mfma_f32_16x16x32_bf16 v[24:27], v[248:251], a[88:91], v[24:27]
    v_fmac_f32 v3, v7, v7
    v_fma_f32 v133, v20, v20, s42
    v_mfma_f32_16x16x32_bf16 v[24:27], v[252:255], a[92:95], v[24:27]
    s_nop 0
    v_fmac_f32 v133, v21, v21
    v_fmac_f32 v133, v22, v22
    v_fmac_f32 v133, v23, v23
    v_fmac_f32 v133, v28, v28
    v_fmac_f32 v133, v29, v29
    v_fmac_f32 v133, v30, v30
    v_fmac_f32 v133, v31, v31
    v_fmac_f32 v133, v24, v24
    v_fmac_f32 v133, v25, v25
    v_fmac_f32 v133, v26, v26
    v_fmac_f32 v133, v27, v27
    v_cvt_pk_bf16_f32 v120, v133, v3
    ds_write_b64 v130, v[120:121] offset:4096
    v_mul_f32 v32, v32, v13
    v_mul_f32 v33, v33, v13
    v_cvt_pk_bf16_f32 v32, v32, v33
    v_mul_f32 v34, v34, v13
    v_mul_f32 v35, v35, v13
    v_cvt_pk_bf16_f32 v33, v34, v35
    v_mul_f32 v40, v40, v13
    v_mul_f32 v41, v41, v13
    v_cvt_pk_bf16_f32 v34, v40, v41
    v_mul_f32 v42, v42, v13
    v_mul_f32 v43, v43, v13
    v_cvt_pk_bf16_f32 v35, v42, v43
    v_mul_f32 v36, v36, v13
    v_mul_f32 v37, v37, v13
    v_cvt_pk_bf16_f32 v136, v36, v37
    v_mul_f32 v38, v38, v13
    v_mul_f32 v39, v39, v13
    v_cvt_pk_bf16_f32 v137, v38, v39
    ds_write_b128 v135, v[32:35] offset:1536
    s_waitcnt lgkmcnt(1)
    s_barrier
    ds_write_b64 v134, v[136:137] offset:1536
    ds_read_b128 v[36:39], v129 offset:4096
    ds_read_b128 v[32:35], v129 offset:5120
    s_waitcnt lgkmcnt(2)
    s_barrier
    s_waitcnt lgkmcnt(1)
    v_mfma_f32_16x16x32_bf16 v[12:15], v[216:219], v[36:39], 0
    s_waitcnt lgkmcnt(0)
    ds_read_b128 a[164:167], v139 offset:0
    ds_read_b128 a[168:171], v139 offset:1024
    v_mfma_f32_16x16x32_bf16 v[12:15], v[216:219], v[32:35], v[12:15]
    s_nop 0
    ds_read_b128 a[172:175], v139 offset:2048
    s_nop 2
    ds_read_b128 a[176:179], v139 offset:3072
    s_nop 1
    v_rsq_f32 v12, v12
    ds_read_b128 a[180:183], v139 offset:4096
    v_mul_f32 v12, s43, v12
    v_mul_f32 v20, v20, v12
    v_mul_f32 v21, v21, v12
    v_cvt_pk_bf16_f32 v20, v20, v21
    v_mul_f32 v22, v22, v12
    v_mul_f32 v23, v23, v12
    v_cvt_pk_bf16_f32 v21, v22, v23
    v_mul_f32 v28, v28, v12
    v_mul_f32 v29, v29, v12
    s_waitcnt lgkmcnt(4)
    buffer_store_dwordx4 a[164:167], v128, s[28:31], s58 offen sc1
    v_cvt_pk_bf16_f32 v22, v28, v29
    v_mul_f32 v30, v30, v12
    v_mul_f32 v31, v31, v12
    v_cvt_pk_bf16_f32 v23, v30, v31
    v_mul_f32 v24, v24, v12
    v_mul_f32 v25, v25, v12
    v_cvt_pk_bf16_f32 v128, v24, v25
    v_mul_f32 v26, v26, v12
    v_mul_f32 v27, v27, v12
    v_cvt_pk_bf16_f32 v129, v26, v27
    ds_write_b128 v138, v[20:23] offset:0
    v_rsq_f32 v13, v13
    v_cmp_neq_f32 vcc, 0, v14
    v_mul_f32 v13, s43, v13
    s_waitcnt lgkmcnt(1)
    buffer_store_dwordx4 a[168:171], v127, s[28:31], s58 offen sc1
    ds_write_b64 v132, v[128:129] offset:0
    v_mul_f32 v8, v8, v13
    v_mul_f32 v9, v9, v13
    v_cvt_pk_bf16_f32 v8, v8, v9
    v_mul_f32 v10, v10, v13
    v_mul_f32 v11, v11, v13
    v_cvt_pk_bf16_f32 v9, v10, v11
    v_mul_f32 v16, v16, v13
    v_mul_f32 v17, v17, v13
    v_cvt_pk_bf16_f32 v10, v16, v17
    v_mul_f32 v18, v18, v13
    v_mul_f32 v19, v19, v13
    v_cvt_pk_bf16_f32 v11, v18, v19
    v_mul_f32 v4, v4, v13
    v_mul_f32 v5, v5, v13
    v_cvt_pk_bf16_f32 v128, v4, v5
    v_mul_f32 v6, v6, v13
    v_mul_f32 v7, v7, v13
    v_cvt_pk_bf16_f32 v129, v6, v7
    buffer_store_dwordx4 a[172:175], v126, s[28:31], s58 offen sc1
    ds_write_b128 v138, v[8:11] offset:1536
    ds_write_b64 v132, v[128:129] offset:1536
    buffer_store_dwordx4 a[176:179], v125, s[28:31], s58 offen sc1
    s_waitcnt lgkmcnt(0)
    s_barrier
    buffer_store_dwordx4 a[180:183], v124, s[28:31], s58 offen sc1
    ds_read_b128 a[184:187], v131 offset:0
    ds_read_b128 a[188:191], v131 offset:1024
    ds_read_b128 a[192:195], v131 offset:2048
    s_waitcnt lgkmcnt(2)
    buffer_store_dwordx4 a[184:187], v0, s[28:31], 0 offen sc1
    s_waitcnt lgkmcnt(0)
    buffer_store_dwordx4 a[188:191], v1, s[28:31], 0 offen sc1
    buffer_store_dwordx4 a[192:195], v2, s[28:31], 0 offen sc1
    s_nop 4
    s_cbranch_vccnz L_slow
L_fin:
    s_cmp_eq_u32 s2, 255
    s_cbranch_scc1 L_again
L_end:
    s_endpgm
L_slow:
    s_waitcnt vmcnt(0) lgkmcnt(0)
    s_nop 15
    s_barrier
    s_lshr_b32 s66, s64, 20
    v_mbcnt_lo_u32_b32 v157, -1, 0
    v_mbcnt_hi_u32_b32 v157, -1, v157
    s_load_dwordx16 s[4:19], s[0:1], 0
    s_load_dwordx4 s[20:23], s[0:1], 64
    s_load_dwordx2 s[38:39], s[0:1], 80
    s_bfe_u32 s88, s2, 0x50003
    s_lshl2_add_u32 s88, s88, s68
    v_lshlrev_b32 v72, 7, v157
    s_mul_i32 s89, s88, 576
    s_mul_i32 s88, s88, 1728
    v_min_u32 v74, 1664, v72
    v_min_u32 v73, 512, v72
    s_mov_b32 s34, 221184
    s_mov_b32 s35, 0x20000
    s_mov_b32 s78, 73728
    s_mov_b32 s79, 0x20000
    v_and_b32 v75, 15, v157
    v_lshrrev_b32 v160, 4, v157
    v_lshrrev_b32 v72, 2, v75
    v_and_b32 v5, 3, v75
    s_mul_i32 s87, s68, 192
    v_mad_u32_u24 v19, v75, 12, s87
    v_lshlrev_b32 v31, 1, v75
    v_lshlrev_b32 v11, 1, v72
    v_lshl_add_u32 v11, v160, 5, v11
    s_movk_i32 s86, 384
    s_mov_b32 s26, 100270464
    s_mov_b32 s27, 0x20000
    s_mov_b32 s30, 0
    s_mov_b32 s31, 0x20000
    s_mul_i32 s96, s68, 288
    s_and_b32 s97, s68, 1
    s_lshl_b32 s97, s97, 2
    s_mov_b32 s98, 193536
    s_waitcnt lgkmcnt(0)
    s_mov_b32 s24, s4
    s_mov_b32 s25, s5
    s_mov_b32 s32, s6
    s_mov_b32 s33, s7
    s_mov_b32 s76, s8
    s_mov_b32 s77, s9
    buffer_load_dword a254, v74, s[32:35], s88 offen
    buffer_load_dword a253, v73, s[76:79], s89 offen
    s_load_dwordx2 s[82:83], s[10:11], 0
    s_movk_i32 s18, 676
    s_mov_b32 s19, 0x20000
    buffer_load_dwordx3 v[28:30], v19, s[16:19], 0 offen
    s_mov_b32 s99, 589824
    v_add_u32 v124, s96, v157
    v_mul_u32_u24 v74, 2731, v124
    v_mul_u32_u24 v73, 6242, v124
    v_lshrrev_b32 v74, 16, v74
    s_lshr_b32 s94, s2, 3
    s_mul_i32 s70, s94, 167
    global_load_ushort v16, v31, s[12:13]
    v_lshrrev_b32 v73, 20, v73
    v_and_or_b32 v8, v74, 3, s97
    v_xor_b32 v8, v124, v8
    v_lshl_add_u32 v128, v8, 4, s99
    v_mad_u32_u24 v128, v73, s98, v128
    s_min_u32 s95, s94, 7
    s_add_u32 s70, s70, s95
    global_load_ushort v17, v31, s[12:13] offset:32
    v_add_u32 v10, 64, v124
    v_mul_u32_u24 v150, 2731, v10
    v_mul_u32_u24 v156, 6242, v10
    v_lshrrev_b32 v150, 16, v150
    v_lshrrev_b32 v156, 20, v156
    s_and_b32 s95, s2, 7
    s_mul_i32 s95, s95, 20
    global_load_ushort v148, v11, s[14:15] offset:0
    v_and_or_b32 v9, v150, 3, s97
    v_xor_b32 v9, v10, v9
    v_lshl_add_u32 v127, v9, 4, s99
    v_mad_u32_u24 v127, v156, s98, v127
    v_add_u32 v18, 128, v124
    s_add_u32 s69, s70, s95
    s_add_u32 s70, s70, 140
    global_load_ushort v158, v11, s[14:15] offset:8
    v_mul_u32_u24 v10, 2731, v18
    v_mul_u32_u24 v4, 6242, v18
    v_lshrrev_b32 v10, 16, v10
    v_lshrrev_b32 v4, 20, v4
    v_and_or_b32 v31, v10, 3, s97
    s_movk_i32 s62, 2688
    s_movk_i32 s71, 20
    global_load_ushort v149, v11, s[14:15] offset:16
    v_xor_b32 v31, v18, v31
    v_lshl_add_u32 v126, v31, 4, s99
    v_mad_u32_u24 v126, v4, s98, v126
    v_add_u32 v125, 192, v124
    v_mul_u32_u24 v159, 2731, v125
    s_cmp_lt_u32 s94, 7
    s_cselect_b32 s73, 28, 27
    global_load_ushort v132, v11, s[14:15] offset:24
    v_mul_u32_u24 v18, 6242, v125
    v_lshrrev_b32 v159, 16, v159
    v_lshrrev_b32 v18, 20, v18
    v_and_or_b32 v11, v159, 3, s97
    v_xor_b32 v11, v125, v11
    v_lshl_add_u32 v125, v11, 4, s99
    v_mad_u32_u24 v125, v18, s98, v125
    v_add_u32 v6, 256, v124
    v_mul_u32_u24 v151, 2731, v6
    v_mul_u32_u24 v11, 6242, v6
    v_lshrrev_b32 v151, 16, v151
    v_lshrrev_b32 v11, 20, v11
    v_and_or_b32 v124, v151, 3, s97
    v_xor_b32 v124, v6, v124
    v_lshl_add_u32 v124, v124, 4, s99
    v_mad_u32_u24 v124, v11, s98, v124
    s_mov_b32 s93, 1769472
    s_mul_i32 s54, s68, 5120
    s_cmp_ge_u32 s2, 248
    s_cbranch_scc1 L_bndS
L_bndrS:
    s_mov_b32 s63, 1180032
    s_mul_i32 s94, s69, 58255
    s_lshr_b32 s94, s94, 22
    s_mul_i32 s94, s94, s63
    s_mul_i32 s72, s69, s62
    s_add_u32 s72, s72, s94
    v_lshl_or_b32 v73, v157, 4, 2.0
    s_sub_u32 s94, s73, 1
    s_max_u32 s94, s94, 20
    s_mul_i32 s95, s68, -44
    s_movk_i32 s99, -24
    s_add_u32 m0, s54, 0
    v_and_b32 v18, -4, v10
    s_mul_i32 s85, s68, 96
    s_sub_u32 s100, s85, 1024
    buffer_load_dwordx4 v128, s[24:27], s72 offen nt lds
    s_add_u32 m0, s54, 1024
    v_mad_u32_u24 v11, v18, 3, v10
    v_add_u32 v11, s95, v11
    v_mad_i32_i24 v10, v10, s99, v31
    v_med3_u32 v18, v11, 20, s94
    v_add_u32 v18, s70, v18
    v_add_u32 v31, s69, v11
    s_sub_u32 s87, s85, 2048
    s_movk_i32 s91, 1152
    buffer_load_dwordx4 v127, s[24:27], s72 offen nt lds
    v_cmp_gt_u32 vcc, s71, v11
    v_lshl_add_u32 v10, v10, 4, s93
    s_add_u32 m0, s54, 43008
    v_cndmask_b32 v31, v18, v31, vcc
    v_mul_u32_u24 v18, 58255, v31
    v_mad_u32_u24 v10, v31, s62, v10
    v_lshrrev_b32 v18, 22, v18
    v_mad_u32_u24 v10, v18, s63, v10
    s_mul_i32 s90, s68, 3072
    s_add_u32 s90, s90, 61440
    buffer_load_dwordx4 v10, s[24:27], 0 offen  lds
    v_lshlrev_b32 v11, 16, v11
    s_add_u32 m0, s54, 2048
    v_and_b32 v31, -4, v150
    v_mad_u32_u24 v18, v31, 3, v150
    v_add_u32 v18, s95, v18
    v_mad_i32_i24 v9, v150, s99, v9
    v_med3_u32 v31, v18, 20, s94
    s_mov_b32 s28, s22
    s_mov_b32 s29, s23
    buffer_load_dwordx4 v126, s[24:27], s72 offen nt lds
    v_add_u32 v31, s70, v31
    v_add_u32 v150, s69, v18
    v_cmp_gt_u32 vcc, s71, v18
    v_lshl_add_u32 v9, v9, 4, s93
    s_add_u32 m0, s54, 41984
    v_cndmask_b32 v150, v31, v150, vcc
    v_mul_u32_u24 v31, 58255, v150
    v_mad_u32_u24 v9, v150, s62, v9
    v_lshrrev_b32 v31, 22, v31
    v_mad_u32_u24 v9, v31, s63, v9
    s_mov_b32 s41, 0x2a8cbccc
    s_mov_b32 s42, 0x38fba882
    buffer_load_dwordx4 v9, s[24:27], 0 offen  lds
    v_lshl_or_b32 v11, v18, 8, v11
    s_add_u32 m0, s54, 3072
    v_cmp_gt_u32 vcc, 32, v157
    v_and_b32 v31, -4, v74
    v_mad_u32_u24 v18, v31, 3, v74
    v_cndmask_b32 v124, v73, v124, vcc
    v_add_u32 v18, s95, v18
    s_mov_b32 s43, 0x415db3d7
    s_mov_b32 s57, s72
    buffer_load_dwordx4 v125, s[24:27], s72 offen nt lds
    s_add_u32 m0, s54, 4096
    v_mad_i32_i24 v8, v74, s99, v8
    v_med3_u32 v31, v18, 20, s94
    v_add_u32 v31, s70, v31
    v_add_u32 v74, s69, v18
    v_cmp_gt_u32 vcc, s71, v18
    v_lshl_add_u32 v8, v8, 4, s93
    s_mul_i32 s93, s68, 6
    s_lshl_b32 s94, s97, 1
    buffer_load_dwordx4 v124, s[24:27], s72 offen nt lds
    v_cndmask_b32 v74, v31, v74, vcc
    v_mul_u32_u24 v31, 58255, v74
    v_mad_u32_u24 v8, v74, s62, v8
    v_lshrrev_b32 v31, 22, v31
    v_mad_u32_u24 v8, v31, s63, v8
    s_add_u32 m0, s54, 40960
    v_lshl_or_b32 v11, v18, 0, v11
    s_mov_b32 s58, 0
    s_mov_b32 s59, 0
    buffer_load_dwordx4 v8, s[24:27], 0 offen nt lds
    v_mul_u32_u24 v6, 10923, v157
    v_lshrrev_b32 v4, 17, v6
    v_lshrrev_b32 v6, 16, v6
    v_mad_i32_i24 v7, v6, -6, v157
    v_bitop3_b32 v4, v4, v6, 4 bitop3:0x28
    v_lshl_add_u32 v7, v7, 4, s85
    v_mul_u32_u24 v4, 3, v4
    v_xor_b32 v6, v6, v4
    v_mad_u32_u24 v4, v6, s91, v7
    v_add_u32 v18, 64, v157
    v_mul_u32_u24 v31, 10923, v18
    v_lshrrev_b32 v156, 17, v31
    v_lshrrev_b32 v31, 16, v31
    v_mad_i32_i24 v159, v31, -6, v18
    v_bitop3_b32 v156, v156, v31, 4 bitop3:0x28
    v_lshl_add_u32 v159, v159, 4, s100
    v_mul_u32_u24 v156, 3, v156
    v_xor_b32 v31, v31, v156
    v_mad_u32_u24 v156, v31, s91, v159
    v_add_u32 v18, 128, v157
    v_mul_u32_u24 v74, 10923, v18
    v_lshrrev_b32 v120, 17, v74
    v_lshrrev_b32 v74, 16, v74
    v_mad_i32_i24 v18, v74, -6, v18
    v_bitop3_b32 v120, v120, v74, 4 bitop3:0x28
    v_lshl_add_u32 v18, v18, 4, s87
    v_mul_u32_u24 v120, 3, v120
    v_xor_b32 v74, v74, v120
    v_mad_u32_u24 v120, v74, s91, v18
    v_mad_u32_u24 v121, v6, s86, v7
    v_mad_u32_u24 v25, v31, s86, v159
    v_mad_u32_u24 v24, v74, s86, v18
    s_add_u32 m0, s90, 0
    s_mov_b32 s92, 0
    buffer_load_dwordx4 v4, s[32:35], s92 offen offset:0 lds
    v_mov_b32 v18, 0x3f803f80
    v_cmp_eq_u32 vcc, 0, v5
    v_and_b32 v31, 1, v157
    v_lshlrev_b32 v31, 4, v31
    v_cndmask_b32 v220, 0, v18, vcc
    v_cndmask_b32 v221, 0, v18, vcc
    v_cndmask_b32 v222, 0, v18, vcc
    v_cndmask_b32 v223, 0, v18, vcc
    v_mov_b32 v18, 0x3f80
    v_lshlrev_b32 v18, v31, v18
    v_cmp_gt_u32 vcc, 2, v5
    v_mov_b32 v171, 0
    v_mov_b32 v167, 0
    v_cndmask_b32 v216, 0, v18, vcc
    v_cndmask_b32 v218, 0, v18, vcc
    v_cmp_le_u32 vcc, 2, v5
    v_mov_b32 v163, 0
    v_mov_b32 v159, 0
    v_cndmask_b32 v217, 0, v18, vcc
    v_cndmask_b32 v219, 0, v18, vcc
    v_cmp_eq_u32 vcc, v160, v72
    v_mov_b32 v150, 0
    v_mov_b32 v151, 0
    v_cndmask_b32 v26, 0, v216, vcc
    v_cndmask_b32 v27, 0, v217, vcc
    v_mov_b32 v144, 0
    v_mov_b32 v145, 0
    v_mov_b32 v138, 0
    v_mov_b32 v139, 0
    v_lshrrev_b32 v6, 1, v160
    v_lshl_add_u32 v7, v160, 2, v72
    v_lshl_add_u32 v7, v6, 3, v7
    v_mul_u32_u24 v7, 96, v7
    v_add_u32 v7, s90, v7
    v_lshl_add_u32 v6, v5, 4, v7
    v_lshl_add_u32 v7, v5, 3, v7
    s_waitcnt lgkmcnt(0)
    s_lshl_b32 s84, s68, 4
    s_lshr_b64 s[82:83], s[82:83], s84
    s_lshl_b32 s82, s82, 16
    v_mov_b32 v74, s82
    v_min_f32 v74, 0x40930000, v74
    v_max_f32 v74, 0xc2c80000, v74
    v_mul_f32 v74, 0x3fb8aa3b, v74
    v_exp_f32 v74, v74
    v_mov_b32 v18, 0
    v_cvt_pk_bf16_f32 v74, v74, v74
    v_lshlrev_b32 v74, 16, v74
    v_mul_f32 v74, 0x4038aa3b, v74
    v_mov_b32 v31, 0
    v_readfirstlane_b32 s55, v74
    v_add_f32 v74, v74, v74
    v_mul_u32_u24 v122, 5120, v160
    v_readfirstlane_b32 s52, v74
    v_add_u32 v122, v19, v122
    s_mov_b32 s84, 0x41b8aa3b
    v_mov_b32 v131, 0xc138aa3b
    v_mul_u32_u24 v74, 5120, v72
    v_mad_u32_u24 v74, v5, s86, v74
    v_and_b32 v19, 7, v75
    s_mov_b32 s44, 61440
    s_mov_b32 s45, 40960
    buffer_load_dwordx4 v156, s[32:35], s92 offen offset:1024 lds
    v_xor_b32 v123, v19, v160
    v_lshl_add_u32 v147, v123, 4, v74
    v_xor_b32 v146, 64, v147
    v_add_u32 v137, 40960, v147
    v_xor_b32 v136, 64, v137
    v_add_u32 v74, 61440, v74
    v_add_u32 v123, s93, v160
    s_mov_b32 s46, 20480
    s_mov_b32 s47, 0
    buffer_load_dwordx4 v120, s[32:35], s92 offen offset:2048 lds
    s_add_u32 m0, s90, 12288
    s_mov_b32 s92, 36864
    v_xor_b32 v123, v19, v123
    v_lshl_add_u32 v135, v123, 4, v74
    v_lshrrev_b32 v123, 1, v160
    v_add3_u32 v123, v123, s93, 4
    v_xor_b32 v123, v19, v123
    s_add_u32 s93, s54, 20480
    s_mov_b32 s60, 0
    buffer_load_dwordx4 v4, s[32:35], s92 offen offset:0 lds
    s_waitcnt vmcnt(16)
    v_lshl_or_b32 v16, v17, 16, v16
    v_cmp_gt_u32 vcc, 16, v157
    v_mov_b32 v17, 0
    v_lshl_add_u32 v123, v123, 4, v74
    v_cndmask_b32 v19, 0, v16, vcc
    v_cndmask_b32 v16, 0, v16, vcc
    v_and_b32 v74, 1, v160
    v_mfma_f32_16x16x16_bf16 v[0:3], v[18:19], v[28:29], 0
    s_waitcnt vmcnt(14)
    s_mov_b32 s65, -1
    v_lshl_or_b32 v148, v158, 16, v148
    v_lshl_add_u32 v134, v74, 3, v123
    v_mfma_f32_16x16x16_bf16 v[12:15], v[16:17], v[28:29], 0
    s_mov_b32 s61, 1
    v_lshlrev_b32 v74, 4, v157
    v_add_u32 v133, s93, v74
    v_mfma_f32_16x16x16_bf16 v[20:23], v[16:17], v[30:31], 0
    s_waitcnt vmcnt(12)
    s_lshr_b32 s93, s68, 1
    buffer_load_dwordx4 v156, s[32:35], s92 offen offset:1024 lds
    v_lshl_or_b32 v149, v132, 16, v149
    v_max_f32 v0, 0, v0
    v_max_f32 v12, 0, v12
    v_max_f32 v13, 0, v13
    v_max_f32 v14, 0, v14
    v_max_f32 v15, 0, v15
    v_cvt_pk_bf16_f32 v12, v12, v13
    v_cvt_pk_bf16_f32 v13, v14, v15
    v_max_f32 v1, 0, v1
    v_max_f32 v2, 0, v2
    v_mfma_f32_16x16x16_bf16 v[16:19], v[148:149], v[12:13], 0
    s_lshl_b32 s93, s93, 10
    v_max_f32 v3, 0, v3
    v_cvt_pk_bf16_f32 v0, v0, v1
    v_cvt_pk_bf16_f32 v1, v2, v3
    v_max_f32 v20, 0, v20
    v_max_f32 v21, 0, v21
    v_mfma_f32_16x16x16_bf16 v[12:15], v[148:149], v[0:1], 0
    s_add_u32 s93, s93, s94
    v_max_f32 v22, 0, v22
    v_max_f32 v23, 0, v23
    v_cvt_pk_bf16_f32 v20, v20, v21
    v_cvt_pk_bf16_f32 v21, v22, v23
    v_cvt_pk_bf16_f32 v16, v16, v16
    v_lshlrev_b32 v16, 16, v16
    v_mfma_f32_16x16x16_bf16 v[0:3], v[148:149], v[20:21], 0
    s_movk_i32 s4, 112
    v_mul_f32 v16, 0xbfb8aa3b, v16
    v_cvt_pk_bf16_f32 v12, v12, v12
    v_exp_f32 v16, v16
    v_lshlrev_b32 v12, 16, v12
    v_add_f32 v16, 1.0, v16
    v_rcp_f32 v16, v16
    v_mul_f32 v12, 0xbfb8aa3b, v12
    v_cvt_pk_bf16_f32 v16, v16, v16
    v_lshlrev_b32 v16, 16, v16
    v_fma_f32 v16, v16, s84, v131
    s_mov_b32 s5, 0
    s_mov_b32 s6, 0
    ds_write_b32 v122, v16 offset:44032
    v_exp_f32 v12, v12
    v_cvt_pk_bf16_f32 v0, v0, v0
    v_add_f32 v12, 1.0, v12
    v_rcp_f32 v12, v12
    v_lshlrev_b32 v0, 16, v0
    v_cvt_pk_bf16_f32 v12, v12, v12
    v_lshlrev_b32 v12, 16, v12
    v_fma_f32 v12, v12, s84, v131
    s_mov_b32 s12, 0
    s_mov_b32 s64, 3
    ds_write_b32 v122, v12 offset:44036
    v_mul_f32 v0, 0xbfb8aa3b, v0
    v_exp_f32 v0, v0
    v_add_u32 v129, 81920, v74
    v_add_f32 v0, 1.0, v0
    v_rcp_f32 v0, v0
    v_add_u32 v130, s93, v129
    v_cvt_pk_bf16_f32 v0, v0, v0
    v_lshlrev_b32 v0, 16, v0
    v_fma_f32 v0, v0, s84, v131
    s_mul_i32 s93, s68, 7168
    s_add_u32 s93, s93, 135168
    ds_write_b32 v122, v0 offset:44040
    v_mul_u32_u24 v74, 1792, v160
    v_add_u32 v123, s93, v74
    v_mul_u32_u24 v74, 112, v75
    v_add_u32 v158, v74, v123
    v_subrev_u32 v158, 28672, v158
    v_cmp_eq_u32 vcc, 0, v72
    v_add_u32 v74, 16, v123
    v_mov_b32 v122, 0
    v_cndmask_b32 v132, v73, v123, vcc
    v_cmp_eq_u32 vcc, 3, v5
    s_mov_b32 s10, 81924
    s_mov_b32 s11, 0x20000
    v_cndmask_b32 v132, v132, v74, vcc
    v_mul_u32_u24 v74, 1792, v72
    v_lshl_add_u32 v74, v160, 3, v74
    v_lshl_add_u32 v74, v5, 1, v74
    v_add_u32 v74, s93, v74
    v_cmp_gt_u32 vcc, 3, v160
    v_mov_b32 v123, v74
    s_add_u32 s93, s69, 1
    v_cndmask_b32 v131, v73, v74, vcc
    s_mul_i32 s94, s93, 58255
    s_lshr_b32 s94, s94, 22
    s_mul_i32 s94, s94, s63
    s_mul_i32 s56, s93, s62
    s_add_u32 s56, s56, s94
    s_sub_u32 s93, s71, 1
    s_cmp_eq_u32 s68, 0
    s_cselect_b32 s13, s93, -1
    s_cmp_gt_u32 s73, 20
    s_cselect_b32 s13, s13, -1
    s_and_b32 s93, s2, -8
    s_sub_u32 s93, 81920, s93
    s_waitcnt lgkmcnt(0)
    s_barrier
    s_sub_u32 s8, s38, s93
    s_subb_u32 s9, s39, 0
    s_mov_b32 s3, 0x00010001
    s_add_u32 s101, s54, 44032
    v_mul_u32_u24 v149, 48, v72
    v_lshl_add_u32 v149, v5, 2, v149
    v_mul_u32_u24 v5, 48, v160
    v_add_u32 v199, 0, v149
    v_mul_u32_u24 v148, 37, v199
    v_lshrrev_b32 v148, 10, v148
    v_mad_u32_u24 v199, v148, 24, v199
    v_add_u32 v199, s101, v199
    v_add_u32 v161, 16, v149
    v_mul_u32_u24 v148, 37, v161
    v_lshrrev_b32 v148, 10, v148
    v_mad_u32_u24 v161, v148, 24, v161
    v_add_u32 v161, s101, v161
    v_add_u32 v148, 32, v149
    v_mul_u32_u24 v162, 37, v148
    v_lshrrev_b32 v162, 10, v162
    v_mad_u32_u24 v148, v162, 24, v148
    v_add_u32 v148, s101, v148
    v_add_u32 v176, 0, v5
    v_mul_u32_u24 v162, 37, v176
    v_lshrrev_b32 v162, 10, v162
    v_mad_u32_u24 v176, v162, 24, v176
    v_add_u32 v169, 4, v5
    v_mul_u32_u24 v162, 37, v169
    v_lshrrev_b32 v162, 10, v162
    v_mad_u32_u24 v169, v162, 24, v169
    v_add_u32 v170, 8, v5
    v_mul_u32_u24 v162, 37, v170
    v_lshrrev_b32 v162, 10, v162
    v_mad_u32_u24 v170, v162, 24, v170
    v_add_u32 v183, 12, v5
    v_mul_u32_u24 v162, 37, v183
    v_lshrrev_b32 v162, 10, v162
    v_mad_u32_u24 v183, v162, 24, v183
    v_add_u32 v168, 16, v5
    v_mul_u32_u24 v162, 37, v168
    v_lshrrev_b32 v162, 10, v162
    v_mad_u32_u24 v168, v162, 24, v168
    v_add_u32 v165, 20, v5
    v_mul_u32_u24 v162, 37, v165
    v_lshrrev_b32 v162, 10, v162
    v_mad_u32_u24 v165, v162, 24, v165
    v_add_u32 v166, 24, v5
    v_mul_u32_u24 v162, 37, v166
    v_lshrrev_b32 v162, 10, v162
    v_mad_u32_u24 v166, v162, 24, v166
    v_add_u32 v179, 28, v5
    v_mul_u32_u24 v162, 37, v179
    v_lshrrev_b32 v162, 10, v162
    v_mad_u32_u24 v179, v162, 24, v179
    v_add_u32 v164, 32, v5
    v_mul_u32_u24 v162, 37, v164
    v_lshrrev_b32 v162, 10, v162
    v_mad_u32_u24 v164, v162, 24, v164
    v_add_u32 v74, 36, v5
    v_mul_u32_u24 v72, 37, v74
    v_lshrrev_b32 v72, 10, v72
    v_mad_u32_u24 v74, v72, 24, v74
    v_add_u32 v162, 40, v5
    v_mul_u32_u24 v72, 37, v162
    v_lshrrev_b32 v72, 10, v72
    s_lshr_b32 s93, s68, 1
    s_mul_i32 s93, s93, 30720
    buffer_load_dwordx4 v120, s[32:35], s92 offen offset:2048 lds
    s_add_u32 m0, s90, 24576
    s_mov_b32 s92, 73728
    ds_read_b32 v208, v199
    v_mad_u32_u24 v162, v72, 24, v162
    v_add_u32 v5, 44, v5
    v_mul_u32_u24 v72, 37, v5
    v_lshrrev_b32 v72, 10, v72
    v_mad_u32_u24 v5, v72, 24, v5
    v_lshl_add_u32 v72, v160, 4, v149
    v_mul_u32_u24 v177, 37, v72
    v_lshrrev_b32 v177, 10, v177
    v_mad_u32_u24 v72, v177, 24, v72
    v_mov_b32 v177, 336
    v_cmp_gt_u32 vcc, 3, v160
    v_sub_u32 v204, v199, v176
    s_and_b32 s94, s68, 1
    v_cndmask_b32 v72, v177, v72, vcc
    v_sub_u32 v72, s101, v72
    s_mul_i32 s94, s94, -2304
    s_add_u32 s93, s93, s94
    ds_read_b32 v204, v204 offset:336
    buffer_load_dwordx4 v4, s[32:35], s92 offen offset:0 lds
    v_sub_u32 v205, v199, v169
    v_sub_u32 v206, v199, v170
    v_sub_u32 v207, v199, v183
    v_sub_u32 v200, v199, v168
    s_lshl_b32 s94, s97, 4
    ds_read_b32 v205, v205 offset:336
    v_sub_u32 v201, v199, v165
    v_sub_u32 v202, v199, v166
    v_sub_u32 v203, v199, v179
    v_sub_u32 v196, v199, v164
    buffer_load_dwordx4 v156, s[32:35], s92 offen offset:1024 lds
    ds_read_b32 v206, v206 offset:336
    v_sub_u32 v197, v199, v74
    v_sub_u32 v198, v199, v162
    v_sub_u32 v199, v199, v5
    v_sub_u32 v192, v161, v176
    v_sub_u32 v193, v161, v169
    ds_read_b32 v207, v207 offset:336
    v_sub_u32 v194, v161, v170
    v_sub_u32 v195, v161, v183
    v_sub_u32 v188, v161, v168
    v_sub_u32 v189, v161, v165
    v_sub_u32 v190, v161, v166
    ds_read_b32 v200, v200 offset:336
    v_sub_u32 v191, v161, v179
    v_sub_u32 v184, v161, v164
    v_sub_u32 v185, v161, v74
    v_sub_u32 v186, v161, v162
    buffer_load_dwordx4 v120, s[32:35], s92 offen offset:2048 lds
    s_add_u32 m0, s90, 36864
    s_mov_b32 s92, 110592
    ds_read_b32 v201, v201 offset:336
    v_sub_u32 v187, v161, v5
    v_sub_u32 v180, v148, v176
    v_sub_u32 v181, v148, v169
    v_sub_u32 v182, v148, v170
    v_sub_u32 v183, v148, v183
    s_waitcnt vmcnt(9)
    s_barrier
    ds_read_b32 v202, v202 offset:336
    v_sub_u32 v176, v148, v168
    v_sub_u32 v177, v148, v165
    v_sub_u32 v178, v148, v166
    v_sub_u32 v179, v148, v179
    v_sub_u32 v172, v148, v164
    ds_read_b32 v203, v203 offset:336
    v_sub_u32 v173, v148, v74
    v_sub_u32 v174, v148, v162
    v_sub_u32 v175, v148, v5
    v_mov_b32 v5, 0xf149f2ca
    v_and_b32 v74, 8, v75
    ds_read_b32 v196, v196 offset:336
    v_add_u32 v74, v74, v75
    v_mul_u32_u24 v74, 96, v74
    buffer_load_dwordx4 v4, s[32:35], s92 offen offset:0 lds
    ds_read_b32 v197, v197 offset:336
    v_add_u32 v74, s90, v74
    v_lshl_add_u32 v19, v160, 4, v74
    v_lshl_add_u32 v18, v160, 3, v74
    v_add_u32 v17, s93, v19
    v_add_u32 v16, s93, v18
    s_lshr_b32 s93, s68, 1
    s_mul_i32 s93, s93, 5120
    ds_read_b32 v198, v198 offset:336
    v_lshlrev_b32 v162, 4, v160
    v_add_u32 v162, 4608, v162
    s_add_u32 s93, s93, s94
    v_add_u32 v74, s93, v162
    v_cmp_eq_u32 vcc, 0, v75
    ds_read_b32 v199, v199 offset:336
    buffer_load_dwordx4 v156, s[32:35], s92 offen offset:1024 lds
    v_cndmask_b32 v74, v73, v74, vcc
    ds_read_b32 v211, v72 offset:672
    ds_read_b32 v192, v192 offset:336
    ds_read_b32 v193, v193 offset:336
    buffer_load_dwordx4 v120, s[32:35], s92 offen offset:2048 lds
    s_add_u32 m0, s90, 49152
    s_mov_b32 s92, 147456
    ds_read_b32 v194, v194 offset:336
    ds_read_b32 v195, v195 offset:336
    ds_read_b32 v188, v188 offset:336
    buffer_load_dwordx4 v4, s[32:35], s92 offen offset:0 lds
    ds_read_b32 v189, v189 offset:336
    ds_read_b32 v190, v190 offset:336
    ds_read_b32 v191, v191 offset:336
    ds_read_b32 v184, v184 offset:336
    buffer_load_dwordx4 v156, s[32:35], s92 offen offset:1024 lds
    ds_read_b32 v185, v185 offset:336
    ds_read_b32 v186, v186 offset:336
    ds_read_b32 v187, v187 offset:336
    buffer_load_dwordx4 v120, s[32:35], s92 offen offset:2048 lds
    s_add_u32 m0, s90, 61440
    s_mov_b32 s92, 184320
    ds_read_b32 v209, v161
    ds_read_b32 v180, v180 offset:336
    ds_read_b32 v181, v181 offset:336
    buffer_load_dwordx4 v4, s[32:35], s92 offen offset:0 lds
    ds_read_b32 v182, v182 offset:336
    ds_read_b32 v183, v183 offset:336
    ds_read_b32 v176, v176 offset:336
    ds_read_b32 v177, v177 offset:336
    buffer_load_dwordx4 v156, s[32:35], s92 offen offset:1024 lds
    ds_read_b32 v178, v178 offset:336
    ds_read_b32 v179, v179 offset:336
    ds_read_b32 v172, v172 offset:336
    buffer_load_dwordx4 v120, s[32:35], s92 offen offset:2048 lds
    ds_read_b32 v173, v173 offset:336
    ds_read_b32 v174, v174 offset:336
    ds_read_b32 v175, v175 offset:336
    ds_read_b32 v210, v148
    s_waitcnt vmcnt(15)
    ds_read_b64_tr_b16 a[0:1], v7 offset:0
    ds_read_b64_tr_b16 a[2:3], v7 offset:768
    ds_read_b64_tr_b16 a[24:25], v7 offset:32
    ds_read_b64_tr_b16 a[26:27], v7 offset:800
    ds_read_b64_tr_b16 a[48:49], v7 offset:64
    ds_read_b64_tr_b16 a[50:51], v7 offset:832
    s_add_u32 m0, s90, 0
    s_mov_b32 s92, 384
    s_waitcnt vmcnt(12)
    ds_read_b64_tr_b16 a[4:5], v7 offset:12288
    ds_read_b64_tr_b16 a[6:7], v7 offset:13056
    ds_read_b64_tr_b16 a[28:29], v7 offset:12320
    ds_read_b64_tr_b16 a[30:31], v7 offset:13088
    ds_read_b64_tr_b16 a[52:53], v7 offset:12352
    ds_read_b64_tr_b16 a[54:55], v7 offset:13120
    s_waitcnt vmcnt(9)
    ds_read_b64_tr_b16 a[8:9], v7 offset:24576
    ds_read_b64_tr_b16 a[10:11], v7 offset:25344
    ds_read_b64_tr_b16 a[32:33], v7 offset:24608
    s_waitcnt lgkmcnt(15)
    s_cmp_ge_u32 s2, 248
    s_cbranch_scc1 L_maskS
L_nomaskS:
    v_cmp_gt_u32 vcc, 16, v157
    v_readlane_b32 s84, v211, 48
    ds_read_b64_tr_b16 a[34:35], v7 offset:25376
    v_cndmask_b32 v208, v5, v208, vcc
    v_cndmask_b32 v209, v5, v209, vcc
    v_cndmask_b32 v210, v5, v210, vcc
    v_cmp_gt_u32 vcc, 49, v157
    ds_read_b64_tr_b16 a[56:57], v7 offset:24640
    s_waitcnt lgkmcnt(10)
    buffer_load_dwordx4 v4, s[32:35], s92 offen offset:0 lds
    ds_read_b64_tr_b16 a[58:59], v7 offset:25408
    v_cndmask_b32 v211, v5, v211, vcc
    s_waitcnt vmcnt(7)
    ds_read_b64_tr_b16 a[12:13], v7 offset:36864
    ds_read_b64_tr_b16 a[14:15], v7 offset:37632
    buffer_load_dwordx4 v156, s[32:35], s92 offen offset:1024 lds
    ds_read_b64_tr_b16 a[36:37], v7 offset:36896
    ds_read_b64_tr_b16 a[38:39], v7 offset:37664
    ds_read_b64_tr_b16 a[60:61], v7 offset:36928
    ds_read_b64_tr_b16 a[62:63], v7 offset:37696
    buffer_load_dwordx4 v120, s[32:35], s92 offen offset:2048 lds
    s_add_u32 m0, s90, 12288
    s_mov_b32 s92, 37248
    ds_read_b128 v[60:63], v147 offset:40960
    ds_read_b128 v[56:59], v146 offset:40960
    s_waitcnt lgkmcnt(10)
    buffer_load_dwordx4 v4, s[32:35], s92 offen offset:0 lds
    ds_read_b128 v[52:55], v147 offset:41088
    ds_read_b128 v[48:51], v146 offset:41088
    buffer_load_dwordx4 v156, s[32:35], s92 offen offset:1024 lds
    ds_read_b128 v[40:43], v147 offset:41216
    ds_read_b128 v[0:3], v146 offset:41216
    buffer_load_dwordx4 v120, s[32:35], s92 offen offset:2048 lds
    s_add_u32 m0, s90, 24576
    s_mov_b32 s92, 74112
    s_waitcnt vmcnt(9)
    ds_read_b64_tr_b16 a[16:17], v7 offset:49152
    ds_read_b64_tr_b16 a[18:19], v7 offset:49920
    ds_read_b64_tr_b16 a[40:41], v7 offset:49184
    ds_read_b64_tr_b16 a[42:43], v7 offset:49952
    ds_read_b64_tr_b16 a[64:65], v7 offset:49216
    ds_read_b64_tr_b16 a[66:67], v7 offset:49984
    s_waitcnt lgkmcnt(7)
    buffer_load_dwordx4 v4, s[32:35], s92 offen offset:0 lds
    buffer_load_dwordx4 v156, s[32:35], s92 offen offset:1024 lds
    buffer_load_dwordx4 v120, s[32:35], s92 offen offset:2048 lds
    s_add_u32 m0, s90, 36864
    s_mov_b32 s92, 110976
    s_waitcnt vmcnt(9)
    ds_read_b64_tr_b16 a[20:21], v7 offset:61440
    ds_read_b64_tr_b16 a[22:23], v7 offset:62208
    v_mfma_f32_16x16x32_bf16 v[68:71], a[0:3], v[60:63], 0
    ds_read_b64_tr_b16 a[44:45], v7 offset:61472
    v_mfma_f32_16x16x32_bf16 v[68:71], a[4:7], v[56:59], v[68:71]
    ds_read_b64_tr_b16 a[46:47], v7 offset:62240
    v_mfma_f32_16x16x32_bf16 v[68:71], a[8:11], v[52:55], v[68:71]
    ds_read_b64_tr_b16 a[68:69], v7 offset:61504
    v_mfma_f32_16x16x32_bf16 v[68:71], a[12:15], v[48:51], v[68:71]
    s_waitcnt lgkmcnt(5)
    ds_read_b64_tr_b16 a[70:71], v7 offset:62272
    v_mfma_f32_16x16x32_bf16 v[68:71], a[16:19], v[40:43], v[68:71]
    ds_read_b128 v[44:47], v147 offset:42496
    ds_read_b128 v[36:39], v146 offset:42496
    ds_read_b128 v[32:35], v147 offset:42624
    ds_read_b128 v[28:31], v146 offset:42624
    s_waitcnt lgkmcnt(7)
    v_mfma_f32_16x16x32_bf16 v[68:71], a[20:23], v[0:3], v[68:71]
    ds_read_b128 v[20:23], v147 offset:42752
    s_nop 0
    v_mfma_f32_16x16x32_bf16 v[92:95], a[24:27], v[60:63], 0
    s_nop 0
    ds_read_b128 v[12:15], v146 offset:42752
    s_nop 0
    v_mfma_f32_16x16x32_bf16 v[92:95], a[28:31], v[56:59], v[92:95]
    s_nop 0
    v_fma_f32 v5, v68, v68, s41
    v_fmac_f32 v5, v69, v69
    v_mfma_f32_16x16x32_bf16 v[92:95], a[32:35], v[52:55], v[92:95]
    v_fmac_f32 v5, v70, v70
    v_fmac_f32 v5, v71, v71
    v_mfma_f32_16x16x32_bf16 v[92:95], a[36:39], v[48:51], v[92:95]
    v_mfma_f32_16x16x32_bf16 v[92:95], a[40:43], v[40:43], v[92:95]
    s_waitcnt lgkmcnt(4)
    v_mfma_f32_16x16x32_bf16 v[92:95], a[44:47], v[0:3], v[92:95]
    s_nop 0
    buffer_load_dwordx4 v4, s[32:35], s92 offen offset:0 lds
    v_mfma_f32_16x16x32_bf16 v[88:91], a[48:51], v[60:63], 0
    s_nop 2
    v_mfma_f32_16x16x32_bf16 v[88:91], a[52:55], v[56:59], v[88:91]
    s_nop 0
    v_fmac_f32 v5, v92, v92
    v_fmac_f32 v5, v93, v93
    v_mfma_f32_16x16x32_bf16 v[88:91], a[56:59], v[52:55], v[88:91]
    v_fmac_f32 v5, v94, v94
    v_fmac_f32 v5, v95, v95
    v_mfma_f32_16x16x32_bf16 v[88:91], a[60:63], v[48:51], v[88:91]
    v_mfma_f32_16x16x32_bf16 v[88:91], a[64:67], v[40:43], v[88:91]
    buffer_load_dwordx4 v156, s[32:35], s92 offen offset:1024 lds
    v_mfma_f32_16x16x32_bf16 v[88:91], a[68:71], v[0:3], v[88:91]
    s_nop 0
    v_mfma_f32_16x16x32_bf16 v[0:3], a[0:3], v[44:47], 0
    s_nop 2
    v_mfma_f32_16x16x32_bf16 v[0:3], a[4:7], v[36:39], v[0:3]
    s_waitcnt lgkmcnt(0)
    s_nop 0
    v_fmac_f32 v5, v88, v88
    v_fmac_f32 v5, v89, v89
    v_mfma_f32_16x16x32_bf16 v[0:3], a[8:11], v[32:35], v[0:3]
    v_fmac_f32 v5, v90, v90
    v_fmac_f32 v5, v91, v91
    v_mfma_f32_16x16x32_bf16 v[0:3], a[12:15], v[28:31], v[0:3]
    ds_read_b128 v[100:103], v147 offset:40960
    buffer_load_dwordx4 v120, s[32:35], s92 offen offset:2048 lds
    v_mfma_f32_16x16x32_bf16 v[0:3], a[16:19], v[20:23], v[0:3]
    s_waitcnt vmcnt(9)
    s_add_u32 m0, s90, 49152
    ds_read_b64_tr_b16 a[72:73], v7 offset:0
    v_mfma_f32_16x16x32_bf16 v[0:3], a[20:23], v[12:15], v[0:3]
    s_mov_b32 s92, 147840
    ds_read_b64_tr_b16 a[74:75], v7 offset:768
    v_mfma_f32_16x16x32_bf16 v[56:59], a[24:27], v[44:47], 0
    ds_read_b64_tr_b16 a[96:97], v7 offset:32
    s_nop 0
    v_mfma_f32_16x16x32_bf16 v[56:59], a[28:31], v[36:39], v[56:59]
    s_nop 0
    ds_read_b64_tr_b16 a[98:99], v7 offset:800
    v_fma_f32 v72, v0, v0, s41
    v_mfma_f32_16x16x32_bf16 v[56:59], a[32:35], v[32:35], v[56:59]
    ds_read_b64_tr_b16 a[120:121], v7 offset:64
    buffer_load_dwordx4 v4, s[32:35], s92 offen offset:0 lds
    v_mfma_f32_16x16x32_bf16 v[56:59], a[36:39], v[28:31], v[56:59]
    ds_read_b64_tr_b16 a[122:123], v7 offset:832
    v_fmac_f32 v72, v1, v1
    v_mfma_f32_16x16x32_bf16 v[56:59], a[40:43], v[20:23], v[56:59]
    ds_read_b128 v[64:67], v146 offset:40960
    v_fmac_f32 v72, v2, v2
    v_mfma_f32_16x16x32_bf16 v[56:59], a[44:47], v[12:15], v[56:59]
    ds_read_b128 v[52:55], v147 offset:41088
    v_fmac_f32 v72, v3, v3
    v_mfma_f32_16x16x32_bf16 v[40:43], a[48:51], v[44:47], 0
    ds_read_b128 v[48:51], v146 offset:41088
    v_mfma_f32_16x16x32_bf16 v[40:43], a[52:55], v[36:39], v[40:43]
    ds_read_b128 v[44:47], v147 offset:41216
    buffer_load_dwordx4 v156, s[32:35], s92 offen offset:1024 lds
    v_mfma_f32_16x16x32_bf16 v[40:43], a[56:59], v[32:35], v[40:43]
    ds_read_b128 v[32:35], v146 offset:41216
    v_fmac_f32 v72, v56, v56
    v_mfma_f32_16x16x32_bf16 v[40:43], a[60:63], v[28:31], v[40:43]
    v_fmac_f32 v72, v57, v57
    v_fmac_f32 v72, v58, v58
    v_mfma_f32_16x16x32_bf16 v[40:43], a[64:67], v[20:23], v[40:43]
    v_fmac_f32 v72, v59, v59
    v_mfma_f32_16x16x32_bf16 v[40:43], a[68:71], v[12:15], v[40:43]
    s_waitcnt vmcnt(8)
    s_nop 2
    buffer_load_dwordx4 v120, s[32:35], s92 offen offset:2048 lds
    s_add_u32 m0, s90, 61440
    s_mov_b32 s92, 184704
    ds_read_b64_tr_b16 a[76:77], v7 offset:12288
    v_fmac_f32 v72, v40, v40
    ds_read_b64_tr_b16 a[78:79], v7 offset:13056
    v_fmac_f32 v72, v41, v41
    ds_read_b64_tr_b16 a[100:101], v7 offset:12320
    v_fmac_f32 v72, v42, v42
    ds_read_b64_tr_b16 a[102:103], v7 offset:13088
    v_fmac_f32 v72, v43, v43
    ds_read_b64_tr_b16 a[124:125], v7 offset:12352
    buffer_load_dwordx4 v4, s[32:35], s92 offen offset:0 lds
    ds_read_b64_tr_b16 a[126:127], v7 offset:13120
    buffer_load_dwordx4 v156, s[32:35], s92 offen offset:1024 lds
    buffer_load_dwordx4 v120, s[32:35], s92 offen offset:2048 lds
    s_add_u32 m0, s90, 0
    s_mov_b32 s92, 768
    s_waitcnt vmcnt(9)
    ds_read_b64_tr_b16 a[80:81], v7 offset:24576
    ds_read_b64_tr_b16 a[82:83], v7 offset:25344
    ds_read_b64_tr_b16 a[104:105], v7 offset:24608
    ds_read_b64_tr_b16 a[106:107], v7 offset:25376
    ds_read_b64_tr_b16 a[128:129], v7 offset:24640
    ds_read_b64_tr_b16 a[130:131], v7 offset:25408
    s_waitcnt lgkmcnt(6)
    buffer_load_dwordx4 v4, s[32:35], s92 offen offset:0 lds
    buffer_load_dwordx4 v156, s[32:35], s92 offen offset:1024 lds
    buffer_load_dwordx4 v120, s[32:35], s92 offen offset:2048 lds
    s_add_u32 m0, s90, 12288
    s_mov_b32 s92, 37632
    s_waitcnt vmcnt(9)
    ds_read_b64_tr_b16 a[84:85], v7 offset:36864
    ds_read_b64_tr_b16 a[86:87], v7 offset:37632
    ds_read_b64_tr_b16 a[108:109], v7 offset:36896
    ds_read_b64_tr_b16 a[110:111], v7 offset:37664
    ds_read_b64_tr_b16 a[132:133], v7 offset:36928
    ds_read_b64_tr_b16 a[134:135], v7 offset:37696
    buffer_load_dwordx4 v4, s[32:35], s92 offen offset:0 lds
    buffer_load_dwordx4 v156, s[32:35], s92 offen offset:1024 lds
    buffer_load_dwordx4 v120, s[32:35], s92 offen offset:2048 lds
    s_add_u32 m0, s90, 24576
    s_mov_b32 s92, 74496
    s_waitcnt vmcnt(9)
    ds_read_b64_tr_b16 a[88:89], v7 offset:49152
    ds_read_b64_tr_b16 a[90:91], v7 offset:49920
    ds_read_b64_tr_b16 a[112:113], v7 offset:49184
    ds_read_b64_tr_b16 a[114:115], v7 offset:49952
    ds_read_b64_tr_b16 a[136:137], v7 offset:49216
    ds_read_b64_tr_b16 a[138:139], v7 offset:49984
    s_waitcnt lgkmcnt(6)
    buffer_load_dwordx4 v4, s[32:35], s92 offen offset:0 lds
    buffer_load_dwordx4 v156, s[32:35], s92 offen offset:1024 lds
    buffer_load_dwordx4 v120, s[32:35], s92 offen offset:2048 lds
    s_add_u32 m0, s90, 36864
    s_mov_b32 s92, 111360
    s_waitcnt vmcnt(9)
    ds_read_b64_tr_b16 a[92:93], v7 offset:61440
    ds_read_b64_tr_b16 a[94:95], v7 offset:62208
    v_mfma_f32_16x16x32_bf16 v[36:39], a[72:75], v[100:103], 0
    ds_read_b64_tr_b16 a[116:117], v7 offset:61472
    v_mfma_f32_16x16x32_bf16 v[36:39], a[76:79], v[64:67], v[36:39]
    ds_read_b64_tr_b16 a[118:119], v7 offset:62240
    v_mfma_f32_16x16x32_bf16 v[36:39], a[80:83], v[52:55], v[36:39]
    ds_read_b64_tr_b16 a[140:141], v7 offset:61504
    v_mfma_f32_16x16x32_bf16 v[36:39], a[84:87], v[48:51], v[36:39]
    s_waitcnt lgkmcnt(5)
    buffer_load_dwordx4 v4, s[32:35], s92 offen offset:0 lds
    ds_read_b64_tr_b16 a[142:143], v7 offset:62272
    v_mfma_f32_16x16x32_bf16 v[36:39], a[88:91], v[44:47], v[36:39]
    ds_read_b128 v[96:99], v147 offset:42496
    ds_read_b128 v[80:83], v146 offset:42496
    ds_read_b128 v[28:31], v147 offset:42624
    ds_read_b128 v[20:23], v146 offset:42624
    s_waitcnt lgkmcnt(7)
    v_mfma_f32_16x16x32_bf16 v[36:39], a[92:95], v[32:35], v[36:39]
    buffer_load_dwordx4 v156, s[32:35], s92 offen offset:1024 lds
    ds_read_b128 v[60:63], v147 offset:42752
    v_mfma_f32_16x16x32_bf16 v[84:87], a[96:99], v[100:103], 0
    s_nop 1
    ds_read_b128 v[12:15], v146 offset:42752
    v_mfma_f32_16x16x32_bf16 v[84:87], a[100:103], v[64:67], v[84:87]
    s_nop 0
    v_fma_f32 v157, v36, v36, s41
    v_fmac_f32 v157, v37, v37
    v_mfma_f32_16x16x32_bf16 v[84:87], a[104:107], v[52:55], v[84:87]
    v_fmac_f32 v157, v38, v38
    v_fmac_f32 v157, v39, v39
    v_mfma_f32_16x16x32_bf16 v[84:87], a[108:111], v[48:51], v[84:87]
    v_mfma_f32_16x16x32_bf16 v[84:87], a[112:115], v[44:47], v[84:87]
    s_waitcnt vmcnt(8) lgkmcnt(4)
    buffer_load_dwordx4 v120, s[32:35], s92 offen offset:2048 lds
    ds_read_b64_tr_b16 a[144:145], v6 offset:0
    v_mfma_f32_16x16x32_bf16 v[84:87], a[116:119], v[32:35], v[84:87]
    s_add_u32 m0, s90, 49152
    ds_read_b64_tr_b16 a[146:147], v6 offset:768
    v_mfma_f32_16x16x32_bf16 v[76:79], a[120:123], v[100:103], 0
    s_mov_b32 s92, 148224
    s_nop 0
    ds_read_b64_tr_b16 a[168:169], v6 offset:8
    v_mfma_f32_16x16x32_bf16 v[76:79], a[124:127], v[64:67], v[76:79]
    s_nop 0
    v_fmac_f32 v157, v84, v84
    v_fmac_f32 v157, v85, v85
    v_mfma_f32_16x16x32_bf16 v[76:79], a[128:131], v[52:55], v[76:79]
    ds_read_b64_tr_b16 a[170:171], v6 offset:776
    v_fmac_f32 v157, v86, v86
    v_mfma_f32_16x16x32_bf16 v[76:79], a[132:135], v[48:51], v[76:79]
    buffer_load_dwordx4 v4, s[32:35], s92 offen offset:0 lds
    ds_read_b64_tr_b16 a[192:193], v7 offset:64
    v_mfma_f32_16x16x32_bf16 v[76:79], a[136:139], v[44:47], v[76:79]
    ds_read_b64_tr_b16 a[194:195], v7 offset:832
    v_fmac_f32 v157, v87, v87
    v_mfma_f32_16x16x32_bf16 v[76:79], a[140:143], v[32:35], v[76:79]
    s_nop 0
    v_mfma_f32_16x16x32_bf16 v[52:55], a[72:75], v[96:99], 0
    s_nop 2
    v_mfma_f32_16x16x32_bf16 v[52:55], a[76:79], v[80:83], v[52:55]
    s_waitcnt lgkmcnt(5)
    s_nop 0
    v_fmac_f32 v157, v76, v76
    v_fmac_f32 v157, v77, v77
    v_mfma_f32_16x16x32_bf16 v[52:55], a[80:83], v[28:31], v[52:55]
    buffer_load_dwordx4 v156, s[32:35], s92 offen offset:1024 lds
    v_fmac_f32 v157, v78, v78
    v_mfma_f32_16x16x32_bf16 v[52:55], a[84:87], v[20:23], v[52:55]
    v_fmac_f32 v157, v79, v79
    v_cvt_pk_bf16_f32 v170, v5, v157
    v_mfma_f32_16x16x32_bf16 v[52:55], a[88:91], v[60:63], v[52:55]
    v_mfma_f32_16x16x32_bf16 v[52:55], a[92:95], v[12:15], v[52:55]
    ds_read_b128 v[64:67], v147 offset:40960
    v_mfma_f32_16x16x32_bf16 v[48:51], a[96:99], v[96:99], 0
    ds_read_b128 v[32:35], v146 offset:40960
    v_mfma_f32_16x16x32_bf16 v[48:51], a[100:103], v[80:83], v[48:51]
    s_waitcnt vmcnt(8)
    buffer_load_dwordx4 v120, s[32:35], s92 offen offset:2048 lds
    ds_read_b64_tr_b16 a[148:149], v6 offset:12288
    v_mfma_f32_16x16x32_bf16 v[48:51], a[104:107], v[28:31], v[48:51]
    s_add_u32 m0, s90, 61440
    v_fma_f32 v157, v52, v52, s41
    v_fmac_f32 v157, v53, v53
    v_mfma_f32_16x16x32_bf16 v[48:51], a[108:111], v[20:23], v[48:51]
    s_mov_b32 s92, 185088
    ds_read_b64_tr_b16 a[150:151], v6 offset:13056
    v_fmac_f32 v157, v54, v54
    v_mfma_f32_16x16x32_bf16 v[48:51], a[112:115], v[60:63], v[48:51]
    ds_read_b64_tr_b16 a[172:173], v6 offset:12296
    v_fmac_f32 v157, v55, v55
    v_mfma_f32_16x16x32_bf16 v[48:51], a[116:119], v[12:15], v[48:51]
    ds_read_b64_tr_b16 a[174:175], v6 offset:13064
    v_mfma_f32_16x16x32_bf16 v[44:47], a[120:123], v[96:99], 0
    s_nop 0
    buffer_load_dwordx4 v4, s[32:35], s92 offen offset:0 lds
    ds_read_b64_tr_b16 a[196:197], v7 offset:12352
    v_mfma_f32_16x16x32_bf16 v[44:47], a[124:127], v[80:83], v[44:47]
    s_nop 0
    ds_read_b64_tr_b16 a[198:199], v7 offset:13120
    v_fmac_f32 v157, v48, v48
    v_mfma_f32_16x16x32_bf16 v[44:47], a[128:131], v[28:31], v[44:47]
    ds_read_b128 v[28:31], v147 offset:41088
    v_fmac_f32 v157, v49, v49
    v_mfma_f32_16x16x32_bf16 v[44:47], a[132:135], v[20:23], v[44:47]
    ds_read_b128 v[20:23], v146 offset:41088
    v_fmac_f32 v157, v50, v50
    v_mfma_f32_16x16x32_bf16 v[44:47], a[136:139], v[60:63], v[44:47]
    ds_read_b128 v[60:63], v147 offset:41216
    v_fmac_f32 v157, v51, v51
    v_mfma_f32_16x16x32_bf16 v[44:47], a[140:143], v[12:15], v[44:47]
    s_nop 0
    buffer_load_dwordx4 v156, s[32:35], s92 offen offset:1024 lds
    ds_read_b128 v[12:15], v146 offset:41216
    v_mfma_f32_16x16x16_bf16 v[80:83], v[216:217], v[170:171], 0
    s_nop 0
    v_mov_b32 v168, 0
    v_mov_b32 v169, 0
    v_mov_b32 v149, 0
    v_fmac_f32 v157, v44, v44
    v_fmac_f32 v157, v45, v45
    v_fmac_f32 v157, v46, v46
    v_fmac_f32 v157, v47, v47
    v_rsq_f32 v80, v80
    v_rsq_f32 v81, v81
    v_mul_f32 v80, s55, v80
    v_mul_f32 v81, 0.5, v81
    v_mul_f32 v68, v68, v80
    buffer_load_dwordx4 v120, s[32:35], s92 offen offset:2048 lds
    s_add_u32 m0, s90, 0
    s_mov_b32 s92, 0
    s_waitcnt vmcnt(9)
    ds_read_b64_tr_b16 a[152:153], v6 offset:24576
    v_mul_f32 v69, v69, v80
    v_cvt_pk_f16_f32 v68, v68, v69
    v_mul_f32 v70, v70, v80
    ds_read_b64_tr_b16 a[154:155], v6 offset:25344
    v_mul_f32 v71, v71, v80
    v_cvt_pk_f16_f32 v69, v70, v71
    v_mul_f32 v92, v92, v80
    ds_read_b64_tr_b16 a[176:177], v6 offset:24584
    v_mul_f32 v93, v93, v80
    v_cvt_pk_f16_f32 v70, v92, v93
    s_waitcnt lgkmcnt(3)
    buffer_load_dwordx4 v121, s[76:79], s92 offen offset:0 lds
    ds_read_b64_tr_b16 a[178:179], v6 offset:25352
    v_mul_f32 v94, v94, v80
    v_mul_f32 v95, v95, v80
    v_cvt_pk_f16_f32 v71, v94, v95
    ds_read_b64_tr_b16 a[200:201], v7 offset:24640
    v_mul_f32 v88, v88, v80
    ds_read_b64_tr_b16 a[202:203], v7 offset:25408
    v_mul_f32 v89, v89, v80
    v_cvt_pk_f16_f32 v160, v88, v89
    v_mul_f32 v90, v90, v80
    v_mul_f32 v91, v91, v80
    v_cvt_pk_f16_f32 v161, v90, v91
    v_mul_f32 v36, v36, v81
    buffer_load_dwordx4 v25, s[76:79], s92 offen offset:1024 lds
    v_mul_f32 v37, v37, v81
    v_cvt_pk_f16_f32 v36, v36, v37
    v_mul_f32 v38, v38, v81
    v_mul_f32 v39, v39, v81
    v_cvt_pk_f16_f32 v37, v38, v39
    v_mul_f32 v84, v84, v81
    v_mul_f32 v85, v85, v81
    v_cvt_pk_f16_f32 v38, v84, v85
    v_mul_f32 v86, v86, v81
    v_mul_f32 v87, v87, v81
    v_cvt_pk_f16_f32 v39, v86, v87
    v_mul_f32 v76, v76, v81
    v_mul_f32 v77, v77, v81
    v_cvt_pk_f16_f32 v4, v76, v77
    v_mul_f32 v78, v78, v81
    v_mul_f32 v79, v79, v81
    v_cvt_pk_f16_f32 v5, v78, v79
    buffer_load_dwordx4 v24, s[76:79], s92 offen offset:2048 lds
    s_add_u32 m0, s90, 12288
    s_mov_b32 s92, 12288
    s_waitcnt vmcnt(9)
    ds_read_b64_tr_b16 a[156:157], v6 offset:36864
    v_fma_mix_f32 v148, v68, v36, 0 op_sel:[0,0,0] op_sel_hi:[1,1,0]
    v_fma_mix_f32 v148, v68, v36, v148 op_sel:[1,1,0] op_sel_hi:[1,1,0]
    v_fma_mix_f32 v148, v69, v37, v148 op_sel:[0,0,0] op_sel_hi:[1,1,0]
    ds_read_b64_tr_b16 a[158:159], v6 offset:37632
    v_fma_mix_f32 v148, v69, v37, v148 op_sel:[1,1,0] op_sel_hi:[1,1,0]
    v_fma_mix_f32 v148, v70, v38, v148 op_sel:[0,0,0] op_sel_hi:[1,1,0]
    v_fma_mix_f32 v148, v70, v38, v148 op_sel:[1,1,0] op_sel_hi:[1,1,0]
    ds_read_b64_tr_b16 a[180:181], v6 offset:36872
    v_fma_mix_f32 v148, v71, v39, v148 op_sel:[0,0,0] op_sel_hi:[1,1,0]
    v_fma_mix_f32 v148, v71, v39, v148 op_sel:[1,1,0] op_sel_hi:[1,1,0]
    buffer_load_dwordx4 v121, s[76:79], s92 offen offset:0 lds
    ds_read_b64_tr_b16 a[182:183], v6 offset:37640
    v_fma_mix_f32 v148, v160, v4, v148 op_sel:[0,0,0] op_sel_hi:[1,1,0]
    v_fma_mix_f32 v148, v160, v4, v148 op_sel:[1,1,0] op_sel_hi:[1,1,0]
    v_fma_mix_f32 v148, v161, v5, v148 op_sel:[0,0,0] op_sel_hi:[1,1,0]
    ds_read_b64_tr_b16 a[204:205], v7 offset:36928
    v_fma_mix_f32 v148, v161, v5, v148 op_sel:[1,1,0] op_sel_hi:[1,1,0]
    ds_read_b64_tr_b16 a[206:207], v7 offset:37696
    v_mov_b32 v120, v148
    v_add_u32 v156, 28672, v158
    ds_write_b128 v156, v[36:39]
    buffer_load_dwordx4 v25, s[76:79], s92 offen offset:1024 lds
    v_permlane32_swap_b32 v120, v148
    v_add_f32 v148, v120, v148
    v_mov_b32 v120, v148
    v_cvt_pk_bf16_f32 v170, v72, v157
    s_nop 0
    v_permlane16_swap_b32 v120, v148
    v_mfma_f32_16x16x16_bf16 v[36:39], v[216:217], v[170:171], 0
    s_waitcnt vmcnt(8)
    ds_write2_b64 v156, v[168:169], v[168:169] offset0:2 offset1:3
    v_add_f32 v148, v120, v148
    buffer_load_dwordx4 v24, s[76:79], s92 offen offset:2048 lds
    s_add_u32 m0, s90, 24576
    s_mov_b32 s92, 24576
    v_and_b32 v120, 0xffff0000, v148
    v_sub_f32 v148, v148, v120
    ds_read_b64_tr_b16 a[160:161], v6 offset:49152
    v_cvt_pk_bf16_f32 v148, v148, v120
    v_rsq_f32 v36, v36
    ds_read_b64_tr_b16 a[162:163], v6 offset:49920
    v_rsq_f32 v37, v37
    v_mul_f32 v36, s55, v36
    s_waitcnt lgkmcnt(3)
    buffer_load_dwordx4 v121, s[76:79], s92 offen offset:0 lds
    ds_read_b64_tr_b16 a[184:185], v6 offset:49160
    v_mul_f32 v37, 0.5, v37
    v_mul_f32 v0, v0, v36
    v_mul_f32 v1, v1, v36
    ds_read_b64_tr_b16 a[186:187], v6 offset:49928
    v_cvt_pk_f16_f32 v0, v0, v1
    v_mul_f32 v2, v2, v36
    v_mul_f32 v3, v3, v36
    ds_read_b64_tr_b16 a[208:209], v7 offset:49216
    v_cvt_pk_f16_f32 v1, v2, v3
    ds_read_b64_tr_b16 a[210:211], v7 offset:49984
    v_mul_f32 v56, v56, v36
    buffer_load_dwordx4 v25, s[76:79], s92 offen offset:1024 lds
    ds_write_b128 v156, v[68:71] offset:32
    v_mul_f32 v57, v57, v36
    v_cvt_pk_f16_f32 v2, v56, v57
    v_mul_f32 v58, v58, v36
    v_mul_f32 v59, v59, v36
    v_cvt_pk_f16_f32 v3, v58, v59
    v_mul_f32 v40, v40, v36
    v_mul_f32 v41, v41, v36
    v_cvt_pk_f16_f32 v254, v40, v41
    ds_write2_b64 v156, v[4:5], v[168:169] offset0:6 offset1:7
    buffer_load_dwordx4 v24, s[76:79], s92 offen offset:2048 lds
    s_add_u32 m0, s90, 36864
    s_mov_b32 s92, 36864
    v_mul_f32 v42, v42, v36
    v_mul_f32 v43, v43, v36
    v_cvt_pk_f16_f32 v255, v42, v43
    v_mul_f32 v52, v52, v37
    v_mul_f32 v53, v53, v37
    s_waitcnt vmcnt(9)
    ds_read_b64_tr_b16 a[164:165], v6 offset:61440
    v_cvt_pk_f16_f32 v4, v52, v53
    v_mul_f32 v54, v54, v37
    v_mul_f32 v55, v55, v37
    ds_read_b64_tr_b16 a[166:167], v6 offset:62208
    v_mfma_f32_16x16x32_bf16 v[40:43], a[144:147], v[64:67], 0
    buffer_load_dwordx4 v121, s[76:79], s92 offen offset:0 lds
    ds_read_b64_tr_b16 a[188:189], v6 offset:61448
    v_mfma_f32_16x16x32_bf16 v[40:43], a[148:151], v[32:35], v[40:43]
    v_cvt_pk_f16_f32 v5, v54, v55
    v_mul_f32 v48, v48, v37
    v_mfma_f32_16x16x32_bf16 v[40:43], a[152:155], v[28:31], v[40:43]
    ds_read_b64_tr_b16 a[190:191], v6 offset:62216
    v_mul_f32 v49, v49, v37
    v_mfma_f32_16x16x32_bf16 v[40:43], a[156:159], v[20:23], v[40:43]
    s_waitcnt lgkmcnt(4)
    ds_read_b64_tr_b16 a[212:213], v7 offset:61504
    v_cvt_pk_f16_f32 v6, v48, v49
    v_mfma_f32_16x16x32_bf16 v[40:43], a[160:163], v[60:63], v[40:43]
    ds_read_b64_tr_b16 a[214:215], v7 offset:62272
    v_mul_f32 v50, v50, v37
    v_mul_f32 v51, v51, v37
    v_cvt_pk_f16_f32 v7, v50, v51
    buffer_load_dwordx4 v25, s[76:79], s92 offen offset:1024 lds
    ds_write2_b64 v156, v[168:169], v[160:161] offset0:8 offset1:9
    v_mul_f32 v44, v44, v37
    v_mul_f32 v45, v45, v37
    v_cvt_pk_f16_f32 v160, v44, v45
    v_mul_f32 v46, v46, v37
    s_waitcnt lgkmcnt(5)
    v_mfma_f32_16x16x32_bf16 v[40:43], a[164:167], v[12:15], v[40:43]
    v_mul_f32 v47, v47, v37
    v_cvt_pk_f16_f32 v161, v46, v47
    v_mfma_f32_16x16x32_bf16 v[52:55], a[168:171], v[64:67], 0
    buffer_load_dwordx4 v24, s[76:79], s92 offen offset:2048 lds
    ds_read_b128 v[48:51], v147 offset:42496
    v_mfma_f32_16x16x32_bf16 v[52:55], a[172:175], v[32:35], v[52:55]
    s_add_u32 m0, s90, 49152
    v_fma_mix_f32 v120, v0, v4, 0 op_sel:[0,0,0] op_sel_hi:[1,1,0]
    v_fma_mix_f32 v120, v0, v4, v120 op_sel:[1,1,0] op_sel_hi:[1,1,0]
    v_mfma_f32_16x16x32_bf16 v[52:55], a[176:179], v[28:31], v[52:55]
    s_mov_b32 s92, 49152
    ds_write_b64 v156, v[148:149] offset:88
    v_mfma_f32_16x16x32_bf16 v[52:55], a[180:183], v[20:23], v[52:55]
    s_lshl_b32 s93, s68, 10
    v_fma_mix_f32 v120, v1, v5, v120 op_sel:[0,0,0] op_sel_hi:[1,1,0]
    v_fma_mix_f32 v120, v1, v5, v120 op_sel:[1,1,0] op_sel_hi:[1,1,0]
    v_mfma_f32_16x16x32_bf16 v[52:55], a[184:187], v[60:63], v[52:55]
    s_waitcnt lgkmcnt(3)
    s_mov_b32 s53, s47
    ds_read_b128 v[44:47], v146 offset:42496
    v_fma_mix_f32 v120, v2, v6, v120 op_sel:[0,0,0] op_sel_hi:[1,1,0]
    v_mfma_f32_16x16x32_bf16 v[52:55], a[188:191], v[12:15], v[52:55]
    s_mov_b32 s47, s46
    buffer_load_dwordx4 v121, s[76:79], s92 offen offset:0 lds
    ds_read_b128 v[36:39], v147 offset:42624
    v_mfma_f32_16x16x32_bf16 v[56:59], a[192:195], v[64:67], 0
    s_mov_b32 s46, s45
    v_fma_mix_f32 v120, v2, v6, v120 op_sel:[1,1,0] op_sel_hi:[1,1,0]
    v_fma_mix_f32 v120, v3, v7, v120 op_sel:[0,0,0] op_sel_hi:[1,1,0]
    v_mfma_f32_16x16x32_bf16 v[56:59], a[196:199], v[32:35], v[56:59]
    s_mov_b32 s45, s44
    ds_read_b128 v[32:35], v146 offset:42624
    v_fma_mix_f32 v120, v3, v7, v120 op_sel:[1,1,0] op_sel_hi:[1,1,0]
    v_mfma_f32_16x16x32_bf16 v[56:59], a[200:203], v[28:31], v[56:59]
    s_mov_b32 s44, s53
    ds_read_b128 v[28:31], v147 offset:42752
    v_fma_mix_f32 v120, v254, v160, v120 op_sel:[0,0,0] op_sel_hi:[1,1,0]
    v_mfma_f32_16x16x32_bf16 v[56:59], a[204:207], v[20:23], v[56:59]
    s_sub_u32 s48, s44, s46
    ds_read_b128 v[20:23], v146 offset:42752
    v_fma_mix_f32 v120, v254, v160, v120 op_sel:[1,1,0] op_sel_hi:[1,1,0]
    v_mfma_f32_16x16x32_bf16 v[56:59], a[208:211], v[60:63], v[56:59]
    s_sub_u32 s49, s46, s45
    buffer_load_dwordx4 v25, s[76:79], s92 offen offset:1024 lds
    v_fma_mix_f32 v120, v255, v161, v120 op_sel:[0,0,0] op_sel_hi:[1,1,0]
    v_mfma_f32_16x16x32_bf16 v[56:59], a[212:215], v[12:15], v[56:59]
    s_waitcnt lgkmcnt(5)
    v_fma_mix_f32 v120, v255, v161, v120 op_sel:[1,1,0] op_sel_hi:[1,1,0]
    v_mov_b32 v146, v120
    v_mfma_f32_16x16x32_bf16 v[12:15], a[144:147], v[48:51], 0
    s_waitcnt lgkmcnt(4)
    v_permlane32_swap_b32 v146, v120
    v_add_f32 v120, v146, v120
    v_mfma_f32_16x16x32_bf16 v[12:15], a[148:151], v[44:47], v[12:15]
    s_waitcnt lgkmcnt(3)
    v_mov_b32 v146, v120
    v_cvt_pk_bf16_f32 v148, v40, v41
    v_cvt_pk_bf16_f32 v149, v42, v43
    v_mfma_f32_16x16x32_bf16 v[12:15], a[152:155], v[36:39], v[12:15]
    s_waitcnt lgkmcnt(2)
    ds_write_b64 v158, v[148:149] offset:28752
    buffer_load_dwordx4 v24, s[76:79], s92 offen offset:2048 lds
    s_add_u32 m0, s90, 61440
    v_mfma_f32_16x16x32_bf16 v[12:15], a[156:159], v[32:35], v[12:15]
    s_waitcnt lgkmcnt(2)
    s_mov_b32 s92, 61440
    v_permlane16_swap_b32 v146, v120
    v_mfma_f32_16x16x32_bf16 v[12:15], a[160:163], v[28:31], v[12:15]
    s_waitcnt lgkmcnt(1)
    v_add_f32 v120, v146, v120
    v_and_b32 v146, 0xffff0000, v120
    v_mfma_f32_16x16x32_bf16 v[12:15], a[164:167], v[20:23], v[12:15]
    v_sub_f32 v120, v120, v146
    v_cvt_pk_bf16_f32 v120, v120, v146
    v_mfma_f32_16x16x32_bf16 v[40:43], a[168:171], v[48:51], 0
    v_cvt_pk_bf16_f32 v52, v52, v53
    v_cvt_pk_bf16_f32 v53, v54, v55
    v_mfma_f32_16x16x32_bf16 v[40:43], a[172:175], v[44:47], v[40:43]
    buffer_load_dwordx4 v121, s[76:79], s92 offen offset:0 lds
    v_cvt_pk_bf16_f32 v54, v56, v57
    v_mfma_f32_16x16x32_bf16 v[40:43], a[176:179], v[36:39], v[40:43]
    v_cvt_pk_bf16_f32 v55, v58, v59
    v_cvt_pk_bf16_f32 v156, v12, v13
    v_mfma_f32_16x16x32_bf16 v[40:43], a[180:183], v[32:35], v[40:43]
    ds_write_b128 v158, v[52:55] offset:28768
    v_mfma_f32_16x16x32_bf16 v[40:43], a[184:187], v[28:31], v[40:43]
    v_cvt_pk_bf16_f32 v157, v14, v15
    v_add_u32 v121, s93, v129
    v_mfma_f32_16x16x32_bf16 v[40:43], a[188:191], v[20:23], v[40:43]
    buffer_load_dwordx4 v25, s[76:79], s92 offen offset:1024 lds
    v_add_u32 v137, s48, v137
    v_mfma_f32_16x16x32_bf16 v[12:15], a[192:195], v[48:51], 0
    s_nop 0
    v_add_u32 v136, s48, v136
    s_nop 0
    v_mfma_f32_16x16x32_bf16 v[12:15], a[196:199], v[44:47], v[12:15]
    s_nop 0
    v_cvt_pk_bf16_f32 v76, v40, v41
    v_cvt_pk_bf16_f32 v77, v42, v43
    v_mfma_f32_16x16x32_bf16 v[12:15], a[200:203], v[36:39], v[12:15]
    v_mfma_f32_16x16x32_bf16 v[12:15], a[204:207], v[32:35], v[12:15]
    v_mfma_f32_16x16x32_bf16 v[12:15], a[208:211], v[28:31], v[12:15]
    buffer_load_dwordx4 v24, s[76:79], s92 offen offset:2048 lds
    v_mfma_f32_16x16x32_bf16 v[12:15], a[212:215], v[20:23], v[12:15]
    s_add_u32 m0, s54, 20480
    s_nop 6
    v_cvt_pk_bf16_f32 v78, v12, v13
    v_cvt_pk_bf16_f32 v79, v14, v15
    buffer_load_dwordx4 v128, s[24:27], s56 offen nt lds
    s_add_u32 m0, s54, 21504
    s_nop 0
    buffer_load_dwordx4 v127, s[24:27], s56 offen nt lds
    s_add_u32 m0, s54, 22528
    s_nop 0
    buffer_load_dwordx4 v126, s[24:27], s56 offen nt lds
    s_add_u32 m0, s54, 23552
    s_nop 0
    buffer_load_dwordx4 v125, s[24:27], s56 offen nt lds
    s_add_u32 m0, s54, 24576
    s_nop 0
    buffer_load_dwordx4 v124, s[24:27], s56 offen nt lds
    s_waitcnt vmcnt(5)
    s_barrier
    ds_read_b128 v[36:39], v17 offset:0
    ds_read_b64 v[12:13], v16 offset:64
    ds_read_b128 v[28:31], v17 offset:3072
    ds_read_b64 v[14:15], v16 offset:3136
    ds_read_b128 v[48:51], v17 offset:6144
    ds_read_b64 v[32:33], v16 offset:6208
    ds_read_b128 v[40:43], v17 offset:9216
    ds_read_b64 v[34:35], v16 offset:9280
    ds_read_b128 v[44:47], v17 offset:12288
    ds_read_b64 v[52:53], v16 offset:12352
    ds_read_b128 v[20:23], v17 offset:15360
    ds_read_b64 v[54:55], v16 offset:15424
    s_waitcnt lgkmcnt(11)
    v_mfma_f32_16x16x32_bf16 v[56:59], v[36:39], v[220:223], 0
    s_waitcnt lgkmcnt(9)
    ds_read_b128 v[36:39], v17 offset:18432
    v_mfma_f32_16x16x32_bf16 v[56:59], v[28:31], v[220:223], v[56:59]
    s_waitcnt lgkmcnt(8)
    ds_read_b64 v[28:29], v16 offset:18496
    ds_read_b128 v[60:63], v17 offset:21504
    v_mfma_f32_16x16x32_bf16 v[56:59], v[48:51], v[220:223], v[56:59]
    s_waitcnt lgkmcnt(8)
    ds_read_b64 v[30:31], v16 offset:21568
    ds_read_b128 v[48:51], v17 offset:24576
    v_mfma_f32_16x16x32_bf16 v[56:59], v[40:43], v[220:223], v[56:59]
    ds_read_b64 v[40:41], v16 offset:24640
    v_mfma_f32_16x16x32_bf16 v[56:59], v[12:15], v[220:223], v[56:59]
    s_waitcnt lgkmcnt(9)
    ds_read_b128 v[12:15], v17 offset:27648
    v_mfma_f32_16x16x32_bf16 v[56:59], v[32:35], v[220:223], v[56:59]
    ds_read_b64 v[42:43], v16 offset:27712
    v_mfma_f32_16x16x32_bf16 v[32:35], v[44:47], v[220:223], 0
    s_waitcnt lgkmcnt(8)
    ds_read_b128 v[44:47], v17 offset:30720
    v_mfma_f32_16x16x32_bf16 v[32:35], v[20:23], v[220:223], v[32:35]
    s_waitcnt lgkmcnt(8)
    s_nop 0
    ds_read_b64 v[20:21], v16 offset:30784
    v_mul_f32 v56, 0xbbaaaaab, v56
    v_mfma_f32_16x16x32_bf16 v[32:35], v[36:39], v[220:223], v[32:35]
    s_waitcnt lgkmcnt(7)
    ds_read_b128 v[36:39], v17 offset:33792
    v_mul_f32 v57, 0xbbaaaaab, v57
    v_mul_f32 v58, 0xbbaaaaab, v58
    v_mul_f32 v59, 0xbbaaaaab, v59
    v_mfma_f32_16x16x32_bf16 v[32:35], v[60:63], v[220:223], v[32:35]
    ds_write_b128 v74, v[56:59] offset:0
    v_mfma_f32_16x16x32_bf16 v[32:35], v[52:55], v[220:223], v[32:35]
    s_waitcnt lgkmcnt(6)
    v_mfma_f32_16x16x32_bf16 v[32:35], v[28:31], v[220:223], v[32:35]
    v_mfma_f32_16x16x32_bf16 v[28:31], v[48:51], v[220:223], 0
    s_waitcnt lgkmcnt(4)
    ds_read_b64 v[22:23], v16 offset:33856
    s_nop 0
    v_mfma_f32_16x16x32_bf16 v[28:31], v[12:15], v[220:223], v[28:31]
    s_waitcnt lgkmcnt(4)
    s_nop 0
    ds_read_b128 v[12:15], v19 offset:0
    v_mul_f32 v32, 0xbbaaaaab, v32
    v_mfma_f32_16x16x32_bf16 v[28:31], v[44:47], v[220:223], v[28:31]
    s_waitcnt lgkmcnt(3)
    ds_read_b64 v[16:17], v18 offset:64
    v_mul_f32 v33, 0xbbaaaaab, v33
    v_mul_f32 v34, 0xbbaaaaab, v34
    v_mul_f32 v35, 0xbbaaaaab, v35
    v_mfma_f32_16x16x32_bf16 v[28:31], v[36:39], v[220:223], v[28:31]
    ds_write_b128 v74, v[32:35] offset:128
    v_mfma_f32_16x16x32_bf16 v[28:31], v[40:43], v[220:223], v[28:31]
    ds_read_b128 v[80:83], v19 offset:768
    ds_read_b64 v[84:85], v18 offset:832
    ds_read_b128 v[68:71], v19 offset:12288
    s_waitcnt lgkmcnt(6)
    v_mfma_f32_16x16x32_bf16 v[28:31], v[20:23], v[220:223], v[28:31]
    s_nop 0
    ds_read_b64 v[72:73], v18 offset:12352
    s_nop 0
    ds_read_b128 v[20:23], v19 offset:13056
    s_nop 2
    ds_read_b64 v[24:25], v18 offset:13120
    v_mul_f32 v28, 0xbbaaaaab, v28
    v_mul_f32 v29, 0xbbaaaaab, v29
    v_mul_f32 v30, 0xbbaaaaab, v30
    v_mul_f32 v31, 0xbbaaaaab, v31
    ds_write_b128 v74, v[28:31] offset:256
    s_waitcnt lgkmcnt(0)
    s_barrier
    ds_read_b128 v[40:43], v162 offset:0
    ds_read_b128 v[28:31], v162 offset:64
    ds_read_b128 v[64:67], v162 offset:128
    ds_read_b128 v[56:59], v162 offset:192
    s_waitcnt lgkmcnt(3)
    v_mfma_f32_16x16x16_bf16 v[32:35], v[12:13], v[26:27], v[40:43]
    v_mfma_f32_16x16x16_bf16 v[36:39], v[14:15], v[26:27], v[40:43]
    s_nop 2
    v_mfma_f32_16x16x16_bf16 v[60:63], v[16:17], v[26:27], v[40:43]
    s_waitcnt lgkmcnt(0)
    s_nop 0
    ds_read_b128 v[12:15], v19 offset:24576
    v_cvt_pk_bf16_f32 v32, v32, v33
    v_mfma_f32_16x16x16_bf16 v[52:55], v[80:81], v[26:27], v[28:31]
    ds_read_b64 v[16:17], v18 offset:24640
    v_accvgpr_write_b32 a216, v32
    v_mfma_f32_16x16x16_bf16 v[48:51], v[82:83], v[26:27], v[28:31]
    ds_read_b128 v[44:47], v162 offset:256
    v_cvt_pk_bf16_f32 v34, v34, v35
    v_mfma_f32_16x16x16_bf16 v[40:43], v[84:85], v[26:27], v[28:31]
    ds_read_b128 v[104:107], v19 offset:25344
    v_accvgpr_write_b32 a217, v34
    v_mfma_f32_16x16x16_bf16 v[84:87], v[68:69], v[26:27], v[64:67]
    ds_read_b64 v[108:109], v18 offset:25408
    v_cvt_pk_bf16_f32 v36, v36, v37
    v_mfma_f32_16x16x16_bf16 v[32:35], v[70:71], v[26:27], v[64:67]
    ds_read_b128 v[100:103], v162 offset:320
    v_accvgpr_write_b32 a240, v36
    v_mfma_f32_16x16x16_bf16 v[28:31], v[72:73], v[26:27], v[64:67]
    ds_read_b128 v[92:95], v19 offset:36864
    v_cvt_pk_bf16_f32 v38, v38, v39
    v_mfma_f32_16x16x16_bf16 v[68:71], v[20:21], v[26:27], v[56:59]
    ds_read_b64 v[96:97], v18 offset:36928
    v_accvgpr_write_b32 a241, v38
    v_mfma_f32_16x16x16_bf16 v[64:67], v[22:23], v[26:27], v[56:59]
    ds_read_b128 v[80:83], v162 offset:5120
    v_cvt_pk_bf16_f32 v232, v60, v61
    v_mfma_f32_16x16x16_bf16 v[36:39], v[24:25], v[26:27], v[56:59]
    s_waitcnt lgkmcnt(6)
    ds_read_b128 v[20:23], v19 offset:37632
    v_cvt_pk_bf16_f32 v233, v62, v63
    v_cvt_pk_bf16_f32 v52, v52, v53
    v_accvgpr_write_b32 a218, v52
    v_cvt_pk_bf16_f32 v54, v54, v55
    v_accvgpr_write_b32 a219, v54
    v_cvt_pk_bf16_f32 v48, v48, v49
    v_mfma_f32_16x16x16_bf16 v[60:63], v[12:13], v[26:27], v[44:47]
    ds_read_b64 v[24:25], v18 offset:37696
    v_accvgpr_write_b32 a242, v48
    v_mfma_f32_16x16x16_bf16 v[56:59], v[14:15], v[26:27], v[44:47]
    ds_read_b128 v[88:91], v162 offset:5184
    v_cvt_pk_bf16_f32 v50, v50, v51
    v_mfma_f32_16x16x16_bf16 v[52:55], v[16:17], v[26:27], v[44:47]
    s_waitcnt lgkmcnt(6)
    ds_read_b128 v[12:15], v19 offset:49152
    v_accvgpr_write_b32 a243, v50
    v_cvt_pk_bf16_f32 v234, v40, v41
    v_cvt_pk_bf16_f32 v235, v42, v43
    v_mfma_f32_16x16x16_bf16 v[72:75], v[104:105], v[26:27], v[100:103]
    ds_read_b64 v[16:17], v18 offset:49216
    v_cvt_pk_bf16_f32 v84, v84, v85
    v_mfma_f32_16x16x16_bf16 v[40:43], v[106:107], v[26:27], v[100:103]
    ds_read_b128 v[48:51], v162 offset:5248
    v_accvgpr_write_b32 a220, v84
    v_mfma_f32_16x16x16_bf16 v[44:47], v[108:109], v[26:27], v[100:103]
    s_waitcnt lgkmcnt(6)
    ds_read_b128 v[104:107], v19 offset:49920
    v_cvt_pk_bf16_f32 v86, v86, v87
    v_accvgpr_write_b32 a221, v86
    v_cvt_pk_bf16_f32 v32, v32, v33
    v_accvgpr_write_b32 a244, v32
    v_cvt_pk_bf16_f32 v34, v34, v35
    v_accvgpr_write_b32 a245, v34
    v_cvt_pk_bf16_f32 v236, v28, v29
    v_cvt_pk_bf16_f32 v237, v30, v31
    v_mfma_f32_16x16x16_bf16 v[84:87], v[92:93], v[26:27], v[80:83]
    ds_read_b64 v[108:109], v18 offset:49984
    v_cvt_pk_bf16_f32 v68, v68, v69
    v_mfma_f32_16x16x16_bf16 v[32:35], v[94:95], v[26:27], v[80:83]
    ds_read_b128 v[100:103], v162 offset:5312
    v_accvgpr_write_b32 a222, v68
    v_mfma_f32_16x16x16_bf16 v[28:31], v[96:97], v[26:27], v[80:83]
    s_waitcnt lgkmcnt(5)
    ds_read_b128 v[92:95], v19 offset:61440
    v_cvt_pk_bf16_f32 v70, v70, v71
    v_accvgpr_write_b32 a223, v70
    v_cvt_pk_bf16_f32 v64, v64, v65
    v_accvgpr_write_b32 a246, v64
    v_cvt_pk_bf16_f32 v66, v66, v67
    v_accvgpr_write_b32 a247, v66
    v_cvt_pk_bf16_f32 v238, v36, v37
    v_cvt_pk_bf16_f32 v239, v38, v39
    v_mfma_f32_16x16x16_bf16 v[36:39], v[20:21], v[26:27], v[88:91]
    ds_read_b64 v[96:97], v18 offset:61504
    v_cvt_pk_bf16_f32 v60, v60, v61
    v_mfma_f32_16x16x16_bf16 v[68:71], v[22:23], v[26:27], v[88:91]
    ds_read_b128 v[80:83], v162 offset:5376
    v_accvgpr_write_b32 a224, v60
    v_mfma_f32_16x16x16_bf16 v[64:67], v[24:25], v[26:27], v[88:91]
    s_waitcnt lgkmcnt(5)
    ds_read_b128 v[20:23], v19 offset:62208
    v_cvt_pk_bf16_f32 v62, v62, v63
    v_accvgpr_write_b32 a225, v62
    v_cvt_pk_bf16_f32 v56, v56, v57
    v_accvgpr_write_b32 a248, v56
    v_cvt_pk_bf16_f32 v58, v58, v59
    v_accvgpr_write_b32 a249, v58
    v_cvt_pk_bf16_f32 v240, v52, v53
    v_cvt_pk_bf16_f32 v241, v54, v55
    v_mfma_f32_16x16x16_bf16 v[60:63], v[12:13], v[26:27], v[48:51]
    ds_read_b64 v[24:25], v18 offset:62272
    v_cvt_pk_bf16_f32 v72, v72, v73
    v_mfma_f32_16x16x16_bf16 v[56:59], v[14:15], v[26:27], v[48:51]
    ds_read_b128 v[12:15], v162 offset:5440
    v_accvgpr_write_b32 a226, v72
    v_mfma_f32_16x16x16_bf16 v[52:55], v[16:17], v[26:27], v[48:51]
    s_waitcnt lgkmcnt(5)
    ds_read_b128 v[16:19], v137 offset:0
    v_cvt_pk_bf16_f32 v74, v74, v75
    v_accvgpr_write_b32 a227, v74
    v_cvt_pk_bf16_f32 v40, v40, v41
    v_accvgpr_write_b32 a250, v40
    v_cvt_pk_bf16_f32 v42, v42, v43
    v_accvgpr_write_b32 a251, v42
    v_cvt_pk_bf16_f32 v242, v44, v45
    v_cvt_pk_bf16_f32 v243, v46, v47
    v_mfma_f32_16x16x16_bf16 v[48:51], v[104:105], v[26:27], v[100:103]
    ds_read_b128 v[146:149], v136 offset:0
    v_cvt_pk_bf16_f32 v84, v84, v85
    v_mfma_f32_16x16x16_bf16 v[44:47], v[106:107], v[26:27], v[100:103]
    ds_read_b128 v[72:75], v137 offset:128
    v_accvgpr_write_b32 a228, v84
    v_mfma_f32_16x16x16_bf16 v[40:43], v[108:109], v[26:27], v[100:103]
    s_waitcnt lgkmcnt(5)
    ds_read_b128 v[88:91], v136 offset:128
    v_cvt_pk_bf16_f32 v86, v86, v87
    v_accvgpr_write_b32 a229, v86
    v_cvt_pk_bf16_f32 v32, v32, v33
    v_accvgpr_write_b32 a252, v32
    v_cvt_pk_bf16_f32 v34, v34, v35
    v_accvgpr_write_b32 a253, v34
    v_cvt_pk_bf16_f32 v244, v28, v29
    v_cvt_pk_bf16_f32 v245, v30, v31
    v_mfma_f32_16x16x16_bf16 v[32:35], v[92:93], v[26:27], v[80:83]
    s_waitcnt vmcnt(0) lgkmcnt(4)
    s_barrier
    ds_write_b128 v121, v[8:11] offset:6144
    v_mfma_f32_16x16x16_bf16 v[28:31], v[94:95], v[26:27], v[80:83]
    v_cvt_pk_bf16_f32 v36, v36, v37
    v_accvgpr_write_b32 a230, v36
    v_mfma_f32_16x16x16_bf16 v[8:11], v[96:97], v[26:27], v[80:83]
    s_waitcnt lgkmcnt(4)
    v_cvt_pk_bf16_f32 v38, v38, v39
    v_accvgpr_write_b32 a231, v38
    v_cvt_pk_bf16_f32 v68, v68, v69
    v_mfma_f32_16x16x32_bf16 v[36:39], a[0:3], v[16:19], 0
    s_waitcnt lgkmcnt(3)
    ds_write_b64 v158, v[156:157] offset:80
    v_mfma_f32_16x16x32_bf16 v[36:39], a[4:7], v[146:149], v[36:39]
    s_waitcnt lgkmcnt(3)
    v_accvgpr_write_b32 a254, v68
    v_cvt_pk_bf16_f32 v70, v70, v71
    v_mfma_f32_16x16x32_bf16 v[36:39], a[8:11], v[72:75], v[36:39]
    s_waitcnt lgkmcnt(2)
    ds_write_b128 v158, v[76:79] offset:96
    v_mfma_f32_16x16x32_bf16 v[36:39], a[12:15], v[88:91], v[36:39]
    v_accvgpr_write_b32 a255, v70
    v_cvt_pk_bf16_f32 v246, v64, v65
    v_cvt_pk_bf16_f32 v247, v66, v67
    v_cvt_pk_bf16_f32 v60, v60, v61
    v_accvgpr_write_b32 a232, v60
    v_cvt_pk_bf16_f32 v62, v62, v63
    v_accvgpr_write_b32 a233, v62
    v_cvt_pk_bf16_f32 v224, v56, v57
    v_cvt_pk_bf16_f32 v225, v58, v59
    v_cvt_pk_bf16_f32 v248, v52, v53
    v_cvt_pk_bf16_f32 v249, v54, v55
    v_cvt_pk_bf16_f32 v48, v48, v49
    v_accvgpr_write_b32 a234, v48
    v_cvt_pk_bf16_f32 v50, v50, v51
    v_accvgpr_write_b32 a235, v50
    v_cvt_pk_bf16_f32 v226, v44, v45
    v_cvt_pk_bf16_f32 v227, v46, v47
    v_cvt_pk_bf16_f32 v250, v40, v41
    v_cvt_pk_bf16_f32 v251, v42, v43
    v_cvt_pk_bf16_f32 v32, v32, v33
    v_accvgpr_write_b32 a236, v32
    v_cvt_pk_bf16_f32 v34, v34, v35
    v_accvgpr_write_b32 a237, v34
    v_cvt_pk_bf16_f32 v228, v28, v29
    v_cvt_pk_bf16_f32 v229, v30, v31
    v_cvt_pk_bf16_f32 v252, v8, v9
    v_cvt_pk_bf16_f32 v253, v10, v11
    v_mov_b32 v156, 0
    v_mov_b32 v157, 0
    v_mov_b32 v121, 0
    v_add_u32 v230, 0, v158
    ds_write_b128 v230, v[4:7]
    v_add_u32 v135, s49, v135
    v_add_u32 v134, s49, v134
    ds_write2_b64 v230, v[156:157], v[156:157] offset0:2 offset1:3
    ds_write_b128 v230, v[0:3] offset:32
    ds_write2_b64 v230, v[160:161], v[156:157] offset0:6 offset1:7
    ds_write2_b64 v230, v[156:157], v[254:255] offset0:8 offset1:9
    ds_write_b64 v230, v[120:121] offset:88
    ds_read_b128 v[76:79], v137 offset:256
    ds_read_b128 v[56:59], v136 offset:256
    s_waitcnt lgkmcnt(1)
    v_mfma_f32_16x16x32_bf16 v[36:39], a[16:19], v[76:79], v[36:39]
    s_waitcnt lgkmcnt(0)
    v_mfma_f32_16x16x32_bf16 v[36:39], a[20:23], v[56:59], v[36:39]
    s_nop 0
    v_mfma_f32_16x16x16_bf16 v[8:11], v[20:21], v[26:27], v[12:15]
    s_nop 3
    v_mfma_f32_16x16x16_bf16 v[4:7], v[22:23], v[26:27], v[12:15]
    s_nop 0
    v_fma_f32 v121, v36, v36, s41
    v_fmac_f32 v121, v37, v37
    v_mfma_f32_16x16x16_bf16 v[0:3], v[24:25], v[26:27], v[12:15]
    v_cvt_pk_bf16_f32 v8, v8, v9
    v_accvgpr_write_b32 a238, v8
    v_cvt_pk_bf16_f32 v10, v10, v11
    v_mfma_f32_16x16x32_bf16 v[48:51], a[24:27], v[16:19], 0
    v_accvgpr_write_b32 a239, v10
    v_cvt_pk_bf16_f32 v230, v4, v5
    v_mfma_f32_16x16x32_bf16 v[48:51], a[28:31], v[146:149], v[48:51]
    v_cvt_pk_bf16_f32 v231, v6, v7
    v_cvt_pk_bf16_f32 v254, v0, v1
    v_mfma_f32_16x16x32_bf16 v[48:51], a[32:35], v[72:75], v[48:51]
    v_cvt_pk_bf16_f32 v255, v2, v3
    v_fmac_f32 v121, v38, v38
    v_mfma_f32_16x16x32_bf16 v[48:51], a[36:39], v[88:91], v[48:51]
    v_fmac_f32 v121, v39, v39
    v_mfma_f32_16x16x32_bf16 v[48:51], a[40:43], v[76:79], v[48:51]
    v_mfma_f32_16x16x32_bf16 v[48:51], a[44:47], v[56:59], v[48:51]
    s_nop 1
    v_mfma_f32_16x16x32_bf16 v[40:43], a[48:51], v[16:19], 0
    s_nop 2
    v_mfma_f32_16x16x32_bf16 v[40:43], a[52:55], v[146:149], v[40:43]
    s_nop 0
    v_fmac_f32 v121, v48, v48
    v_fmac_f32 v121, v49, v49
    v_mfma_f32_16x16x32_bf16 v[40:43], a[56:59], v[72:75], v[40:43]
    v_fmac_f32 v121, v50, v50
    v_fmac_f32 v121, v51, v51
    v_mfma_f32_16x16x32_bf16 v[40:43], a[60:63], v[88:91], v[40:43]
    v_mfma_f32_16x16x32_bf16 v[40:43], a[64:67], v[76:79], v[40:43]
    v_mfma_f32_16x16x32_bf16 v[40:43], a[68:71], v[56:59], v[40:43]
    s_nop 1
    v_mfma_f32_16x16x32_bf16 v[28:31], a[72:75], v[16:19], 0
    s_nop 2
    v_mfma_f32_16x16x32_bf16 v[28:31], a[76:79], v[146:149], v[28:31]
    s_nop 0
    v_fmac_f32 v121, v40, v40
    v_fmac_f32 v121, v41, v41
    v_mfma_f32_16x16x32_bf16 v[28:31], a[80:83], v[72:75], v[28:31]
    v_fmac_f32 v121, v42, v42
    v_fmac_f32 v121, v43, v43
    v_mfma_f32_16x16x32_bf16 v[28:31], a[84:87], v[88:91], v[28:31]
    v_mfma_f32_16x16x32_bf16 v[28:31], a[88:91], v[76:79], v[28:31]
    v_mfma_f32_16x16x32_bf16 v[28:31], a[92:95], v[56:59], v[28:31]
    s_nop 1
    v_mfma_f32_16x16x32_bf16 v[32:35], a[96:99], v[16:19], 0
    s_nop 2
    v_mfma_f32_16x16x32_bf16 v[32:35], a[100:103], v[146:149], v[32:35]
    s_nop 0
    v_fma_f32 v120, v28, v28, s41
    v_fmac_f32 v120, v29, v29
    v_mfma_f32_16x16x32_bf16 v[32:35], a[104:107], v[72:75], v[32:35]
    v_fmac_f32 v120, v30, v30
    v_fmac_f32 v120, v31, v31
    v_mfma_f32_16x16x32_bf16 v[32:35], a[108:111], v[88:91], v[32:35]
    v_mfma_f32_16x16x32_bf16 v[32:35], a[112:115], v[76:79], v[32:35]
    v_mfma_f32_16x16x32_bf16 v[32:35], a[116:119], v[56:59], v[32:35]
    s_nop 1
    v_mfma_f32_16x16x32_bf16 v[20:23], a[120:123], v[16:19], 0
    s_nop 2
    v_mfma_f32_16x16x32_bf16 v[20:23], a[124:127], v[146:149], v[20:23]
    s_nop 0
    v_fmac_f32 v120, v32, v32
    v_fmac_f32 v120, v33, v33
    v_mfma_f32_16x16x32_bf16 v[20:23], a[128:131], v[72:75], v[20:23]
    v_fmac_f32 v120, v34, v34
    v_fmac_f32 v120, v35, v35
    v_mfma_f32_16x16x32_bf16 v[20:23], a[132:135], v[88:91], v[20:23]
    v_mfma_f32_16x16x32_bf16 v[20:23], a[136:139], v[76:79], v[20:23]
    v_mfma_f32_16x16x32_bf16 v[20:23], a[140:143], v[56:59], v[20:23]
    s_nop 1
    v_mfma_f32_16x16x32_bf16 v[8:11], v[16:19], a[144:147], 0
    s_nop 2
    v_mfma_f32_16x16x32_bf16 v[8:11], v[146:149], a[148:151], v[8:11]
    s_nop 0
    v_fmac_f32 v120, v20, v20
    v_fmac_f32 v120, v21, v21
    v_mfma_f32_16x16x32_bf16 v[8:11], v[72:75], a[152:155], v[8:11]
    v_fmac_f32 v120, v22, v22
    v_fmac_f32 v120, v23, v23
    v_mfma_f32_16x16x32_bf16 v[8:11], v[88:91], a[156:159], v[8:11]
    v_cvt_pk_bf16_f32 v170, v121, v120
    v_mfma_f32_16x16x32_bf16 v[8:11], v[76:79], a[160:163], v[8:11]
    ds_read_b128 v[104:107], v137 offset:1536
    v_mfma_f32_16x16x32_bf16 v[8:11], v[56:59], a[164:167], v[8:11]
    s_nop 0
    ds_read_b128 v[100:103], v136 offset:1536
    s_nop 0
    v_mfma_f32_16x16x16_bf16 v[24:27], v[216:217], v[170:171], 0
    s_nop 0
    ds_read_b128 v[44:47], v137 offset:1664
    s_nop 1
    v_cvt_pk_bf16_f32 v0, v8, v9
    v_mfma_f32_16x16x32_bf16 v[4:7], v[16:19], a[168:171], 0
    ds_read_b128 v[84:87], v136 offset:1664
    v_cvt_pk_bf16_f32 v1, v10, v11
    v_mfma_f32_16x16x32_bf16 v[4:7], v[146:149], a[172:175], v[4:7]
    ds_read_b128 v[68:71], v137 offset:1792
    v_mfma_f32_16x16x32_bf16 v[4:7], v[72:75], a[176:179], v[4:7]
    ds_read_b128 v[64:67], v136 offset:1792
    v_mfma_f32_16x16x32_bf16 v[4:7], v[88:91], a[180:183], v[4:7]
    v_rsq_f32 v24, v24
    v_mfma_f32_16x16x32_bf16 v[4:7], v[76:79], a[184:187], v[4:7]
    v_rsq_f32 v25, v25
    v_mfma_f32_16x16x32_bf16 v[4:7], v[56:59], a[188:191], v[4:7]
    v_mul_f32 v24, s55, v24
    v_mul_f32 v25, 0.5, v25
    v_mfma_f32_16x16x32_bf16 v[12:15], v[16:19], a[192:195], 0
    s_nop 0
    v_mul_f32 v36, v36, v24
    v_mul_f32 v37, v37, v24
    v_mfma_f32_16x16x32_bf16 v[12:15], v[146:149], a[196:199], v[12:15]
    s_nop 0
    v_cvt_pk_bf16_f32 v8, v4, v5
    v_cvt_pk_bf16_f32 v9, v6, v7
    v_mfma_f32_16x16x32_bf16 v[12:15], v[72:75], a[200:203], v[12:15]
    v_cvt_pk_f16_f32 v4, v36, v37
    v_mul_f32 v38, v38, v24
    v_mfma_f32_16x16x32_bf16 v[12:15], v[88:91], a[204:207], v[12:15]
    v_mul_f32 v39, v39, v24
    v_cvt_pk_f16_f32 v5, v38, v39
    v_mfma_f32_16x16x32_bf16 v[12:15], v[76:79], a[208:211], v[12:15]
    v_mul_f32 v48, v48, v24
    v_mul_f32 v49, v49, v24
    v_mfma_f32_16x16x32_bf16 v[12:15], v[56:59], a[212:215], v[12:15]
    s_waitcnt lgkmcnt(0)
    v_cvt_pk_f16_f32 v6, v48, v49
    v_mul_f32 v50, v50, v24
    v_mfma_f32_16x16x32_bf16 v[16:19], a[0:3], v[104:107], 0
    v_mul_f32 v51, v51, v24
    v_cvt_pk_f16_f32 v7, v50, v51
    v_mfma_f32_16x16x32_bf16 v[16:19], a[4:7], v[100:103], v[16:19]
    v_mul_f32 v40, v40, v24
    v_mul_f32 v41, v41, v24
    v_mfma_f32_16x16x32_bf16 v[16:19], a[8:11], v[44:47], v[16:19]
    v_cvt_pk_f16_f32 v152, v40, v41
    v_mul_f32 v42, v42, v24
    v_mfma_f32_16x16x32_bf16 v[16:19], a[12:15], v[84:87], v[16:19]
    v_mul_f32 v43, v43, v24
    v_cvt_pk_f16_f32 v153, v42, v43
    v_mfma_f32_16x16x32_bf16 v[16:19], a[16:19], v[68:71], v[16:19]
    v_mul_f32 v28, v28, v25
    v_mul_f32 v29, v29, v25
    v_mfma_f32_16x16x32_bf16 v[16:19], a[20:23], v[64:67], v[16:19]
    v_cvt_pk_f16_f32 v28, v28, v29
    v_mul_f32 v30, v30, v25
    v_mfma_f32_16x16x32_bf16 v[60:63], a[24:27], v[104:107], 0
    v_mul_f32 v31, v31, v25
    v_cvt_pk_f16_f32 v29, v30, v31
    v_mfma_f32_16x16x32_bf16 v[60:63], a[28:31], v[100:103], v[60:63]
    v_mul_f32 v32, v32, v25
    v_mul_f32 v33, v33, v25
    v_mfma_f32_16x16x32_bf16 v[60:63], a[32:35], v[44:47], v[60:63]
    v_cvt_pk_f16_f32 v30, v32, v33
    v_mul_f32 v34, v34, v25
    v_mfma_f32_16x16x32_bf16 v[60:63], a[36:39], v[84:87], v[60:63]
    v_mul_f32 v35, v35, v25
    v_cvt_pk_f16_f32 v31, v34, v35
    v_mfma_f32_16x16x32_bf16 v[60:63], a[40:43], v[68:71], v[60:63]
    v_mul_f32 v20, v20, v25
    v_mul_f32 v21, v21, v25
    v_mfma_f32_16x16x32_bf16 v[60:63], a[44:47], v[64:67], v[60:63]
    v_cvt_pk_f16_f32 v154, v20, v21
    v_mul_f32 v22, v22, v25
    v_mfma_f32_16x16x32_bf16 v[36:39], a[48:51], v[104:107], 0
    v_mul_f32 v23, v23, v25
    v_cvt_pk_f16_f32 v155, v22, v23
    v_mfma_f32_16x16x32_bf16 v[36:39], a[52:55], v[100:103], v[36:39]
    v_cvt_pk_bf16_f32 v20, v12, v13
    v_cvt_pk_bf16_f32 v21, v14, v15
    v_mfma_f32_16x16x32_bf16 v[36:39], a[56:59], v[44:47], v[36:39]
    v_fma_f32 v2, v16, v16, s41
    v_fmac_f32 v2, v17, v17
    v_mfma_f32_16x16x32_bf16 v[36:39], a[60:63], v[84:87], v[36:39]
    v_fmac_f32 v2, v18, v18
    v_fmac_f32 v2, v19, v19
    v_mfma_f32_16x16x32_bf16 v[36:39], a[64:67], v[68:71], v[36:39]
    v_fmac_f32 v2, v60, v60
    v_fmac_f32 v2, v61, v61
    v_mfma_f32_16x16x32_bf16 v[36:39], a[68:71], v[64:67], v[36:39]
    v_fmac_f32 v2, v62, v62
    v_fmac_f32 v2, v63, v63
    v_mfma_f32_16x16x32_bf16 v[52:55], a[72:75], v[104:107], 0
    s_nop 2
    v_mfma_f32_16x16x32_bf16 v[52:55], a[76:79], v[100:103], v[52:55]
    s_nop 0
    v_fmac_f32 v2, v36, v36
    v_fmac_f32 v2, v37, v37
    v_mfma_f32_16x16x32_bf16 v[52:55], a[80:83], v[44:47], v[52:55]
    v_fmac_f32 v2, v38, v38
    v_fmac_f32 v2, v39, v39
    v_mfma_f32_16x16x32_bf16 v[52:55], a[84:87], v[84:87], v[52:55]
    v_mfma_f32_16x16x32_bf16 v[52:55], a[88:91], v[68:71], v[52:55]
    v_mfma_f32_16x16x32_bf16 v[52:55], a[92:95], v[64:67], v[52:55]
    s_nop 1
    v_mfma_f32_16x16x32_bf16 v[12:15], a[96:99], v[104:107], 0
    s_nop 2
    v_mfma_f32_16x16x32_bf16 v[12:15], a[100:103], v[100:103], v[12:15]
    s_nop 0
    v_fma_f32 v3, v52, v52, s41
    v_fmac_f32 v3, v53, v53
    v_mfma_f32_16x16x32_bf16 v[12:15], a[104:107], v[44:47], v[12:15]
    v_fmac_f32 v3, v54, v54
    v_fmac_f32 v3, v55, v55
    v_mfma_f32_16x16x32_bf16 v[12:15], a[108:111], v[84:87], v[12:15]
    v_mfma_f32_16x16x32_bf16 v[12:15], a[112:115], v[68:71], v[12:15]
    v_mfma_f32_16x16x32_bf16 v[12:15], a[116:119], v[64:67], v[12:15]
    s_sub_u32 s50, s45, s44
    v_add_u32 v135, s48, v135
    v_add_u32 v134, s48, v134
    v_mfma_f32_16x16x32_bf16 v[48:51], a[120:123], v[104:107], 0
    s_sub_u32 s51, s46, s47
    v_add_u32 v133, s51, v133
    v_mfma_f32_16x16x32_bf16 v[48:51], a[124:127], v[100:103], v[48:51]
    s_mov_b32 s60, s59
    v_fmac_f32 v3, v12, v12
    v_fmac_f32 v3, v13, v13
    v_mfma_f32_16x16x32_bf16 v[48:51], a[128:131], v[44:47], v[48:51]
    s_mov_b32 s59, s58
    v_fmac_f32 v3, v14, v14
    v_fmac_f32 v3, v15, v15
    v_mfma_f32_16x16x32_bf16 v[48:51], a[132:135], v[84:87], v[48:51]
    s_mov_b32 s58, s57
    v_mfma_f32_16x16x32_bf16 v[48:51], a[136:139], v[68:71], v[48:51]
    s_mov_b32 s57, s56
    v_mfma_f32_16x16x32_bf16 v[48:51], a[140:143], v[64:67], v[48:51]
    s_mov_b32 s7, s6
    s_nop 0
    v_mfma_f32_16x16x32_bf16 v[24:27], v[104:107], a[144:147], 0
    s_mov_b32 s6, s5
    s_nop 1
    v_mfma_f32_16x16x32_bf16 v[24:27], v[100:103], a[148:151], v[24:27]
    s_mov_b32 s5, s4
    v_fmac_f32 v3, v48, v48
    v_fmac_f32 v3, v49, v49
    v_mfma_f32_16x16x32_bf16 v[24:27], v[44:47], a[152:155], v[24:27]
    s_sub_u32 s14, s6, s7
    v_fmac_f32 v3, v50, v50
    v_fmac_f32 v3, v51, v51
    v_mfma_f32_16x16x32_bf16 v[24:27], v[84:87], a[156:159], v[24:27]
    s_add_u32 s61, s61, 1
    v_cvt_pk_bf16_f32 v170, v2, v3
    v_add_u32 v132, s14, v132
    v_mfma_f32_16x16x32_bf16 v[24:27], v[68:71], a[160:163], v[24:27]
    s_ff1_i32_b32 s15, s66
    ds_read_b128 v[96:99], v137 offset:3072
    v_add_u32 v131, s14, v131
    v_mfma_f32_16x16x32_bf16 v[24:27], v[64:67], a[164:167], v[24:27]
    s_cmp_lg_u32 s66, 0
    ds_read_b128 v[92:95], v136 offset:3072
    v_add_u32 v123, s14, v123
    v_mfma_f32_16x16x16_bf16 v[40:43], v[216:217], v[170:171], 0
    s_cselect_b32 s12, s15, s12
    ds_read_b128 v[88:91], v137 offset:3200
    s_nop 1
    v_cvt_pk_bf16_f32 v2, v24, v25
    v_mfma_f32_16x16x32_bf16 v[72:75], v[104:107], a[168:171], 0
    s_cmp_lt_u32 s61, s71
    ds_read_b128 v[80:83], v136 offset:3200
    v_cvt_pk_bf16_f32 v3, v26, v27
    v_mfma_f32_16x16x32_bf16 v[72:75], v[100:103], a[172:175], v[72:75]
    s_cselect_b32 s15, 31, s15
    ds_read_b128 v[56:59], v137 offset:3328
    v_add_u32 v137, s50, v137
    v_mfma_f32_16x16x32_bf16 v[72:75], v[44:47], a[176:179], v[72:75]
    s_bitset0_b32 s66, s15
    ds_read_b128 v[24:27], v136 offset:3328
    v_add_u32 v136, s50, v136
    v_mfma_f32_16x16x32_bf16 v[72:75], v[84:87], a[180:183], v[72:75]
    s_add_u32 s12, s12, 20
    v_rsq_f32 v40, v40
    v_mfma_f32_16x16x32_bf16 v[72:75], v[68:71], a[184:187], v[72:75]
    s_max_u32 s12, s12, s61
    v_rsq_f32 v41, v41
    v_mfma_f32_16x16x32_bf16 v[72:75], v[64:67], a[188:191], v[72:75]
    s_cmp_lt_u32 s61, s71
    v_mul_f32 v40, s55, v40
    v_mul_f32 v41, 0.5, v41
    v_mfma_f32_16x16x32_bf16 v[32:35], v[104:107], a[192:195], 0
    s_cselect_b32 s15, s61, s12
    v_mul_f32 v16, v16, v40
    v_mul_f32 v17, v17, v40
    v_mfma_f32_16x16x32_bf16 v[32:35], v[100:103], a[196:199], v[32:35]
    s_cselect_b32 s56, s69, s70
    v_cvt_pk_bf16_f32 v10, v72, v73
    v_cvt_pk_bf16_f32 v11, v74, v75
    v_mfma_f32_16x16x32_bf16 v[32:35], v[44:47], a[200:203], v[32:35]
    s_add_u32 s56, s56, s15
    v_cvt_pk_f16_f32 v44, v16, v17
    v_mul_f32 v18, v18, v40
    v_mfma_f32_16x16x32_bf16 v[32:35], v[84:87], a[204:207], v[32:35]
    s_mul_i32 s53, s56, 58255
    v_mul_f32 v19, v19, v40
    v_cvt_pk_f16_f32 v45, v18, v19
    v_mfma_f32_16x16x32_bf16 v[32:35], v[68:71], a[208:211], v[32:35]
    s_waitcnt lgkmcnt(0)
    s_lshr_b32 s53, s53, 22
    v_mul_f32 v60, v60, v40
    v_mul_f32 v61, v61, v40
    v_mfma_f32_16x16x32_bf16 v[32:35], v[64:67], a[212:215], v[32:35]
    s_barrier
    v_cvt_pk_f16_f32 v46, v60, v61
    v_mul_f32 v62, v62, v40
    v_mfma_f32_16x16x32_bf16 v[16:19], a[0:3], v[96:99], 0
    s_mul_i32 s53, s53, s63
    v_mul_f32 v63, v63, v40
    v_cvt_pk_f16_f32 v47, v62, v63
    v_mfma_f32_16x16x32_bf16 v[16:19], a[4:7], v[92:95], v[16:19]
    s_mul_i32 s56, s56, s62
    v_mul_f32 v36, v36, v40
    v_mul_f32 v37, v37, v40
    v_mfma_f32_16x16x32_bf16 v[16:19], a[8:11], v[88:91], v[16:19]
    s_add_u32 s56, s56, s53
    v_cvt_pk_f16_f32 v146, v36, v37
    v_mul_f32 v38, v38, v40
    v_mfma_f32_16x16x32_bf16 v[16:19], a[12:15], v[80:83], v[16:19]
    s_mul_i32 s4, s15, 112
    v_mul_f32 v39, v39, v40
    v_cvt_pk_f16_f32 v147, v38, v39
    v_mfma_f32_16x16x32_bf16 v[16:19], a[16:19], v[56:59], v[16:19]
    s_cmp_ge_u32 s15, 16
    v_mul_f32 v52, v52, v41
    v_mul_f32 v53, v53, v41
    v_mfma_f32_16x16x32_bf16 v[16:19], a[20:23], v[24:27], v[16:19]
    s_cselect_b32 s53, -30464, 0
    v_cvt_pk_f16_f32 v72, v52, v53
    v_mul_f32 v54, v54, v41
    v_mfma_f32_16x16x32_bf16 v[36:39], a[24:27], v[96:99], 0
    s_add_u32 s4, s4, s53
    v_mul_f32 v55, v55, v41
    v_cvt_pk_f16_f32 v73, v54, v55
    v_mfma_f32_16x16x32_bf16 v[36:39], a[28:31], v[92:95], v[36:39]
    s_cmp_lt_u32 s15, s73
    v_mul_f32 v12, v12, v41
    v_mul_f32 v13, v13, v41
    v_mfma_f32_16x16x32_bf16 v[36:39], a[32:35], v[88:91], v[36:39]
    s_cselect_b32 s26, 100270464, 0
    v_cvt_pk_f16_f32 v74, v12, v13
    v_mul_f32 v14, v14, v41
    v_mfma_f32_16x16x32_bf16 v[36:39], a[36:39], v[80:83], v[36:39]
    s_cselect_b32 s56, s56, 0
    v_mul_f32 v15, v15, v41
    v_cvt_pk_f16_f32 v75, v14, v15
    v_mfma_f32_16x16x32_bf16 v[36:39], a[40:43], v[56:59], v[36:39]
    s_cselect_b32 s4, s4, -1
    v_mul_f32 v48, v48, v41
    v_mul_f32 v49, v49, v41
    v_mfma_f32_16x16x32_bf16 v[36:39], a[44:47], v[24:27], v[36:39]
    s_cselect_b32 s15, s15, 0
    v_cvt_pk_f16_f32 v148, v48, v49
    v_mul_f32 v50, v50, v41
    v_mfma_f32_16x16x32_bf16 v[12:15], a[48:51], v[96:99], 0
    s_cselect_b32 s13, s13, -1
    v_mul_f32 v51, v51, v41
    v_cvt_pk_f16_f32 v149, v50, v51
    v_mfma_f32_16x16x32_bf16 v[12:15], a[52:55], v[92:95], v[12:15]
    s_bitset1_b32 s64, s15
    v_cvt_pk_bf16_f32 v22, v32, v33
    v_cvt_pk_bf16_f32 v23, v34, v35
    v_mfma_f32_16x16x32_bf16 v[12:15], a[56:59], v[88:91], v[12:15]
    s_add_u32 s65, s65, 1
    v_fma_f32 v156, v16, v16, s41
    v_fmac_f32 v156, v17, v17
    v_mfma_f32_16x16x32_bf16 v[12:15], a[60:63], v[80:83], v[12:15]
    s_cmp_ge_i32 s65, 2
    v_fmac_f32 v156, v18, v18
    v_fmac_f32 v156, v19, v19
    v_mfma_f32_16x16x32_bf16 v[12:15], a[64:67], v[56:59], v[12:15]
    s_cselect_b32 s30, 100270464, 0
    v_fmac_f32 v156, v36, v36
    v_fmac_f32 v156, v37, v37
    v_mfma_f32_16x16x32_bf16 v[12:15], a[68:71], v[24:27], v[12:15]
    s_add_u32 s67, s46, s54
    v_fmac_f32 v156, v38, v38
    v_fmac_f32 v156, v39, v39
    v_mfma_f32_16x16x32_bf16 v[64:67], a[72:75], v[96:99], 0
    s_add_u32 m0, s67, 0
    v_and_b32 v120, -8, v123
    v_mfma_f32_16x16x32_bf16 v[64:67], a[76:79], v[92:95], v[64:67]
    buffer_load_dwordx4 v128, s[24:27], s56 offen nt lds
    v_fmac_f32 v156, v12, v12
    v_mfma_f32_16x16x32_bf16 v[64:67], a[80:83], v[88:91], v[64:67]
    s_add_u32 m0, s67, 1024
    v_fmac_f32 v156, v13, v13
    v_fmac_f32 v156, v14, v14
    v_mfma_f32_16x16x32_bf16 v[64:67], a[84:87], v[80:83], v[64:67]
    v_fmac_f32 v156, v15, v15
    v_mfma_f32_16x16x32_bf16 v[64:67], a[88:91], v[56:59], v[64:67]
    v_mfma_f32_16x16x32_bf16 v[64:67], a[92:95], v[24:27], v[64:67]
    s_nop 1
    v_mfma_f32_16x16x32_bf16 v[32:35], a[96:99], v[96:99], 0
    s_nop 0
    buffer_load_dwordx4 v127, s[24:27], s56 offen nt lds
    s_nop 0
    v_mfma_f32_16x16x32_bf16 v[32:35], a[100:103], v[92:95], v[32:35]
    s_add_u32 m0, s67, 2048
    v_fma_f32 v121, v64, v64, s41
    v_fmac_f32 v121, v65, v65
    v_mfma_f32_16x16x32_bf16 v[32:35], a[104:107], v[88:91], v[32:35]
    v_fmac_f32 v121, v66, v66
    v_fmac_f32 v121, v67, v67
    v_mfma_f32_16x16x32_bf16 v[32:35], a[108:111], v[80:83], v[32:35]
    v_mfma_f32_16x16x32_bf16 v[32:35], a[112:115], v[56:59], v[32:35]
    v_mfma_f32_16x16x32_bf16 v[32:35], a[116:119], v[24:27], v[32:35]
    buffer_load_dwordx4 v126, s[24:27], s56 offen nt lds
    s_nop 0
    v_mfma_f32_16x16x32_bf16 v[40:43], a[120:123], v[96:99], 0
    s_add_u32 m0, s67, 3072
    s_nop 1
    v_mfma_f32_16x16x32_bf16 v[40:43], a[124:127], v[92:95], v[40:43]
    s_mov_b32 s53, s47
    v_fmac_f32 v121, v32, v32
    v_fmac_f32 v121, v33, v33
    v_mfma_f32_16x16x32_bf16 v[40:43], a[128:131], v[88:91], v[40:43]
    s_mov_b32 s47, s46
    v_fmac_f32 v121, v34, v34
    v_fmac_f32 v121, v35, v35
    v_mfma_f32_16x16x32_bf16 v[40:43], a[132:135], v[80:83], v[40:43]
    s_mov_b32 s46, s45
    v_mfma_f32_16x16x32_bf16 v[40:43], a[136:139], v[56:59], v[40:43]
    s_mov_b32 s45, s44
    buffer_load_dwordx4 v125, s[24:27], s56 offen nt lds
    v_mfma_f32_16x16x32_bf16 v[40:43], a[140:143], v[24:27], v[40:43]
    s_add_u32 m0, s67, 4096
    s_nop 0
    v_mfma_f32_16x16x32_bf16 v[68:71], v[96:99], a[144:147], 0
    s_mov_b32 s44, s53
    s_nop 1
    v_mfma_f32_16x16x32_bf16 v[68:71], v[92:95], a[148:151], v[68:71]
    s_sub_u32 s48, s44, s46
    v_fmac_f32 v121, v40, v40
    v_fmac_f32 v121, v41, v41
    v_mfma_f32_16x16x32_bf16 v[68:71], v[88:91], a[152:155], v[68:71]
    s_sub_u32 s49, s46, s45
    v_fmac_f32 v121, v42, v42
    v_fmac_f32 v121, v43, v43
    v_mfma_f32_16x16x32_bf16 v[68:71], v[80:83], a[156:159], v[68:71]
    buffer_load_dwordx4 v124, s[24:27], s56 offen nt lds
    v_cvt_pk_bf16_f32 v170, v156, v121
    v_mfma_f32_16x16x32_bf16 v[68:71], v[56:59], a[160:163], v[68:71]
    ds_read_b128 v[60:63], v132 offset:0
    v_add_u32 v137, s48, v137
    v_mfma_f32_16x16x32_bf16 v[68:71], v[24:27], a[164:167], v[68:71]
    s_nop 0
    ds_read_b128 v[52:55], v132 offset:16
    v_add_u32 v136, s48, v136
    v_mfma_f32_16x16x16_bf16 v[76:79], v[216:217], v[170:171], 0
    s_nop 0
    ds_read_b128 v[48:51], v132 offset:48
    s_nop 1
    v_cvt_pk_bf16_f32 v164, v68, v69
    v_mfma_f32_16x16x32_bf16 v[84:87], v[96:99], a[168:171], 0
    v_cvt_pk_bf16_f32 v165, v70, v71
    v_mfma_f32_16x16x32_bf16 v[84:87], v[92:95], a[172:175], v[84:87]
    v_rsq_f32 v76, v76
    v_mfma_f32_16x16x32_bf16 v[84:87], v[88:91], a[176:179], v[84:87]
    v_rsq_f32 v77, v77
    v_mfma_f32_16x16x32_bf16 v[84:87], v[80:83], a[180:183], v[84:87]
    v_mul_f32 v76, s55, v76
    v_mul_f32 v77, 0.5, v77
    v_mfma_f32_16x16x32_bf16 v[84:87], v[56:59], a[184:187], v[84:87]
    v_mul_f32 v64, v64, v77
    v_mul_f32 v65, v65, v77
    v_mfma_f32_16x16x32_bf16 v[84:87], v[24:27], a[188:191], v[84:87]
    v_cvt_pk_f16_f32 v64, v64, v65
    v_mul_f32 v66, v66, v77
    v_mfma_f32_16x16x32_bf16 v[68:71], v[96:99], a[192:195], 0
    s_nop 0
    v_mul_f32 v67, v67, v77
    v_cvt_pk_f16_f32 v65, v66, v67
    v_mfma_f32_16x16x32_bf16 v[68:71], v[92:95], a[196:199], v[68:71]
    s_nop 0
    v_cvt_pk_bf16_f32 v160, v84, v85
    v_cvt_pk_bf16_f32 v161, v86, v87
    v_mfma_f32_16x16x32_bf16 v[68:71], v[88:91], a[200:203], v[68:71]
    v_mul_f32 v32, v32, v77
    v_mul_f32 v33, v33, v77
    v_mfma_f32_16x16x32_bf16 v[68:71], v[80:83], a[204:207], v[68:71]
    v_cvt_pk_f16_f32 v66, v32, v33
    v_mul_f32 v34, v34, v77
    v_mfma_f32_16x16x32_bf16 v[68:71], v[56:59], a[208:211], v[68:71]
    v_mul_f32 v35, v35, v77
    v_cvt_pk_f16_f32 v67, v34, v35
    v_mfma_f32_16x16x32_bf16 v[68:71], v[24:27], a[212:215], v[68:71]
    v_mul_f32 v40, v40, v77
    v_mul_f32 v41, v41, v77
    v_mfma_f32_16x16x32_f16 v[32:35], v[28:31], v[4:7], v[204:207]
    ds_read_u16 v166, v131 offset:80
    v_cvt_pk_f16_f32 v142, v40, v41
    v_mfma_f32_16x16x32_f16 v[32:35], v[152:155], v[150:153], v[32:35]
    ds_read_u16 v162, v131 offset:96
    v_mul_f32 v42, v42, v77
    v_mfma_f32_16x16x32_f16 v[24:27], v[72:75], v[4:7], v[200:203]
    ds_read_u16 v158, v131 offset:104
    v_mul_f32 v43, v43, v77
    v_mfma_f32_16x16x32_f16 v[24:27], v[146:149], v[150:153], v[24:27]
    s_waitcnt lgkmcnt(3)
    ds_read_b32 v120, v120 offset:64
    v_cvt_pk_f16_f32 v143, v42, v43
    v_mfma_f32_16x16x32_f16 v[56:59], v[60:63], v[4:7], v[208:211]
    v_mul_f32 v16, v16, v76
    v_mul_f32 v17, v17, v76
    v_mfma_f32_16x16x32_f16 v[56:59], v[52:55], v[28:31], v[56:59]
    v_cvt_pk_f16_f32 v16, v16, v17
    v_mul_f32 v18, v18, v76
    v_mfma_f32_16x16x32_f16 v[56:59], v[48:51], v[152:155], v[56:59]
    v_mul_f32 v19, v19, v76
    v_cvt_pk_f16_f32 v17, v18, v19
    v_mfma_f32_16x16x32_f16 v[40:43], v[60:63], v[44:47], v[208:211]
    v_mul_f32 v36, v36, v76
    v_mul_f32 v37, v37, v76
    v_mfma_f32_16x16x32_f16 v[40:43], v[52:55], v[72:75], v[40:43]
    v_cvt_pk_f16_f32 v18, v36, v37
    v_mul_f32 v38, v38, v76
    v_mfma_f32_16x16x32_f16 v[40:43], v[48:51], v[146:149], v[40:43]
    v_mul_f32 v39, v39, v76
    v_cvt_pk_f16_f32 v19, v38, v39
    v_mfma_f32_16x16x32_f16 v[36:39], v[28:31], v[44:47], v[192:195]
    v_mul_f32 v12, v12, v76
    v_mul_f32 v13, v13, v76
    v_mfma_f32_16x16x32_f16 v[36:39], v[152:155], v[144:147], v[36:39]
    v_cvt_pk_f16_f32 v140, v12, v13
    v_mul_f32 v14, v14, v76
    v_mul_f32 v15, v15, v76
    v_cvt_pk_f16_f32 v141, v14, v15
    v_mfma_f32_16x16x32_f16 v[12:15], v[64:67], v[4:7], v[196:199]
    v_cvt_pk_bf16_f32 v156, v68, v69
    v_cvt_pk_bf16_f32 v157, v70, v71
    v_mfma_f32_16x16x32_f16 v[12:15], v[140:143], v[150:153], v[12:15]
    v_max3_f32 v121, v32, v33, v34
    v_max3_f32 v121, v121, v35, v24
    v_mfma_f32_16x16x32_f16 v[4:7], v[60:63], v[16:19], v[208:211]
    s_nop 0
    v_max3_f32 v121, v121, v25, v26
    v_mov_b32_dpp v59, v43 quad_perm:[0,1,2,3] row_mask:0x2 bank_mask:0xf
    v_mfma_f32_16x16x32_f16 v[4:7], v[52:55], v[64:67], v[4:7]
    s_nop 0
    v_max3_f32 v121, v121, v27, v12
    v_max3_f32 v121, v121, v13, v14
    v_mfma_f32_16x16x32_f16 v[4:7], v[48:51], v[140:143], v[4:7]
    v_max3_f32 v121, v121, v15, v56
    v_mov_b32 v57, v121
    v_mfma_f32_16x16x32_f16 v[52:55], v[72:75], v[44:47], v[188:191]
    s_nop 0
    v_permlane32_swap_b32 v57, v121
    v_mfma_f32_16x16x32_f16 v[52:55], v[146:149], v[144:147], v[52:55]
    v_max_f32 v121, v57, v121
    v_mov_b32 v57, v121
    v_mfma_f32_16x16x32_f16 v[48:51], v[64:67], v[44:47], v[184:187]
    s_nop 0
    v_permlane16_swap_b32 v57, v121
    v_mfma_f32_16x16x32_f16 v[48:51], v[140:143], v[144:147], v[48:51]
    v_max_f32 v121, v57, v121
    v_sub_f32 v32, v32, v121
    v_sub_f32 v33, v33, v121
    v_sub_f32 v34, v34, v121
    v_sub_f32 v35, v35, v121
    v_sub_f32 v24, v24, v121
    v_sub_f32 v25, v25, v121
    v_sub_f32 v26, v26, v121
    v_sub_f32 v27, v27, v121
    v_sub_f32 v12, v12, v121
    v_sub_f32 v13, v13, v121
    v_sub_f32 v14, v14, v121
    v_sub_f32 v15, v15, v121
    v_sub_f32 v56, v56, v121
    v_exp_f32 v32, v32
    v_exp_f32 v33, v33
    v_exp_f32 v34, v34
    v_exp_f32 v35, v35
    v_cvt_pk_bf16_f32 v60, v32, v33
    v_cvt_pk_bf16_f32 v61, v34, v35
    v_exp_f32 v24, v24
    v_exp_f32 v25, v25
    v_exp_f32 v26, v26
    v_exp_f32 v27, v27
    v_cvt_pk_bf16_f32 v62, v24, v25
    v_cvt_pk_bf16_f32 v63, v26, v27
    v_exp_f32 v12, v12
    v_exp_f32 v13, v13
    v_exp_f32 v14, v14
    v_exp_f32 v15, v15
    v_cvt_pk_bf16_f32 v168, v12, v13
    v_cvt_pk_bf16_f32 v169, v14, v15
    v_exp_f32 v56, v56
    v_mov_b32_dpp v59, v7 quad_perm:[0,1,2,3] row_mask:0x4 bank_mask:0xf
    v_cvt_pk_bf16_f32 v170, v56, 0
    v_mfma_f32_16x16x32_bf16 v[44:47], v[220:223], v[60:63], 0
    s_waitcnt lgkmcnt(0)
    v_and_b32 v121, 0xffff0000, v120
    v_lshlrev_b32 v120, 16, v120
    v_mfma_f32_16x16x32_bf16 v[44:47], v[220:223], v[168:171], v[44:47]
    v_add_f32 v120, v120, v121
    v_add_f32 v120, v120, v211
    v_mfma_f32_16x16x32_bf16 v[12:15], v[0:3], v[60:63], 0
    s_nop 0
    v_mov_b32_dpp v59, v120 quad_perm:[0,1,2,3] row_mask:0x8 bank_mask:0xf
    v_mov_b32 v4, v59
    v_mfma_f32_16x16x32_bf16 v[12:15], v[164:167], v[168:171], v[12:15]
    s_nop 0
    v_max_f32_dpp v4, v4, v4 row_ror:8 row_mask:0xf bank_mask:0xf
    v_max3_f32 v121, v36, v37, v38
    v_mfma_f32_16x16x32_bf16 v[24:27], v[8:11], v[60:63], 0
    v_max_f32_dpp v4, v4, v4 row_ror:4 row_mask:0xf bank_mask:0xf
    v_max3_f32 v121, v121, v39, v52
    v_mfma_f32_16x16x32_bf16 v[24:27], v[160:163], v[168:171], v[24:27]
    v_max_f32_dpp v4, v4, v4 row_ror:2 row_mask:0xf bank_mask:0xf
    v_max3_f32 v121, v121, v53, v54
    v_mfma_f32_16x16x32_bf16 v[32:35], v[20:23], v[60:63], 0
    v_max_f32_dpp v4, v4, v4 row_ror:1 row_mask:0xf bank_mask:0xf
    v_mov_b32 v120, v4
    v_mfma_f32_16x16x32_bf16 v[32:35], v[156:159], v[168:171], v[32:35]
    s_nop 0
    v_permlane32_swap_b32 v120, v4
    v_max_f32 v4, v120, v4
    v_mov_b32 v120, v4
    v_rcp_f32 v44, v44
    v_max3_f32 v121, v121, v55, v48
    v_permlane16_swap_b32 v120, v4
    v_max_f32 v4, v120, v4
    v_sub_f32 v59, v59, v4
    v_exp_f32 v59, v59
    v_mul_f32 v12, v12, v44
    v_cvt_pk_bf16_f32 v59, v59, v59
    ds_write_b16 v123, v59 offset:64
    v_mul_f32 v13, v13, v44
    v_cvt_pk_bf16_f32 v68, v12, v13
    ds_read_b128 v[60:63], v132 offset:48
    v_mul_f32 v14, v14, v44
    v_mul_f32 v15, v15, v44
    v_cvt_pk_bf16_f32 v69, v14, v15
    ds_read_b128 v[56:59], v132 offset:64
    v_mfma_f32_16x16x32_f16 v[12:15], v[28:31], v[16:19], v[180:183]
    v_mul_f32 v24, v24, v44
    v_mul_f32 v25, v25, v44
    v_mfma_f32_16x16x32_f16 v[12:15], v[152:155], v[138:141], v[12:15]
    ds_write_b64 v135, v[68:69] offset:0
    v_mfma_f32_16x16x32_f16 v[28:31], v[72:75], v[16:19], v[176:179]
    v_cvt_pk_bf16_f32 v70, v24, v25
    v_mul_f32 v26, v26, v44
    v_mfma_f32_16x16x32_f16 v[28:31], v[146:149], v[138:141], v[28:31]
    v_mul_f32 v27, v27, v44
    v_cvt_pk_bf16_f32 v71, v26, v27
    v_mfma_f32_16x16x32_f16 v[24:27], v[64:67], v[16:19], v[172:175]
    ds_write_b64 v135, v[70:71] offset:8
    v_mfma_f32_16x16x32_f16 v[24:27], v[140:143], v[138:141], v[24:27]
    s_waitcnt lgkmcnt(3)
    v_mul_f32 v32, v32, v44
    v_mul_f32 v33, v33, v44
    v_cvt_pk_bf16_f32 v146, v32, v33
    v_mul_f32 v34, v34, v44
    v_mfma_f32_16x16x32_bf16 v[16:19], v[60:63], v[0:3], 0
    s_waitcnt lgkmcnt(2)
    v_mul_f32 v35, v35, v44
    v_cvt_pk_bf16_f32 v147, v34, v35
    v_max3_f32 v121, v121, v49, v50
    v_max3_f32 v121, v121, v51, v41
    v_mfma_f32_16x16x32_bf16 v[16:19], v[56:59], v[164:167], v[16:19]
    ds_write_b64 v134, v[146:147] offset:0
    v_mfma_f32_16x16x32_bf16 v[44:47], v[60:63], v[8:11], 0
    v_mov_b32 v146, v121
    v_max3_f32 v120, v12, v13, v14
    v_mfma_f32_16x16x32_bf16 v[44:47], v[56:59], v[160:163], v[44:47]
    v_permlane32_swap_b32 v146, v121
    v_mfma_f32_16x16x32_bf16 v[32:35], v[60:63], v[20:23], 0
    v_max_f32 v121, v146, v121
    v_mov_b32 v146, v121
    v_mfma_f32_16x16x32_bf16 v[32:35], v[56:59], v[156:159], v[32:35]
    s_nop 0
    v_permlane16_swap_b32 v146, v121
    v_max_f32 v121, v146, v121
    v_sub_f32 v36, v36, v121
    v_sub_f32 v37, v37, v121
    v_sub_f32 v38, v38, v121
    v_sub_f32 v39, v39, v121
    v_sub_f32 v52, v52, v121
    v_sub_f32 v53, v53, v121
    v_sub_f32 v54, v54, v121
    v_sub_f32 v55, v55, v121
    v_sub_f32 v48, v48, v121
    v_sub_f32 v49, v49, v121
    v_sub_f32 v50, v50, v121
    v_sub_f32 v51, v51, v121
    v_sub_f32 v41, v41, v121
    v_exp_f32 v36, v36
    v_exp_f32 v37, v37
    v_exp_f32 v38, v38
    v_exp_f32 v39, v39
    v_cvt_pk_bf16_f32 v36, v36, v37
    v_cvt_pk_bf16_f32 v37, v38, v39
    v_exp_f32 v52, v52
    v_exp_f32 v53, v53
    v_exp_f32 v54, v54
    v_exp_f32 v55, v55
    v_cvt_pk_bf16_f32 v38, v52, v53
    v_cvt_pk_bf16_f32 v39, v54, v55
    v_exp_f32 v48, v48
    v_exp_f32 v49, v49
    v_exp_f32 v50, v50
    v_exp_f32 v51, v51
    v_cvt_pk_bf16_f32 v168, v48, v49
    v_cvt_pk_bf16_f32 v169, v50, v51
    v_exp_f32 v41, v41
    v_mov_b32_dpp v19, v47 quad_perm:[0,1,2,3] row_mask:0x2 bank_mask:0xf
    v_cvt_pk_bf16_f32 v170, v41, 0
    v_mfma_f32_16x16x32_bf16 v[44:47], v[220:223], v[36:39], 0
    v_mov_b32_dpp v19, v35 quad_perm:[0,1,2,3] row_mask:0x4 bank_mask:0xf
    v_cvt_pk_bf16_f32 v19, v19, v19
    v_mfma_f32_16x16x32_bf16 v[44:47], v[220:223], v[168:171], v[44:47]
    ds_write_b16 v131, v19
    v_mfma_f32_16x16x32_bf16 v[32:35], v[0:3], v[36:39], 0
    ds_read_b128 v[16:19], v137 offset:0
    v_max3_f32 v120, v120, v15, v28
    v_mfma_f32_16x16x32_bf16 v[32:35], v[164:167], v[168:171], v[32:35]
    ds_read_b128 v[146:149], v136 offset:0
    v_max3_f32 v120, v120, v29, v30
    v_mfma_f32_16x16x32_bf16 v[48:51], v[8:11], v[36:39], 0
    ds_read_b128 v[72:75], v137 offset:128
    v_max3_f32 v120, v120, v31, v24
    v_mfma_f32_16x16x32_bf16 v[48:51], v[160:163], v[168:171], v[48:51]
    ds_read_b128 v[88:91], v136 offset:128
    v_max3_f32 v120, v120, v25, v26
    v_mfma_f32_16x16x32_bf16 v[40:43], v[20:23], v[36:39], 0
    ds_read_b128 v[76:79], v137 offset:256
    v_max3_f32 v120, v120, v27, v6
    v_mfma_f32_16x16x32_bf16 v[40:43], v[156:159], v[168:171], v[40:43]
    ds_read_b128 v[56:59], v136 offset:256
    v_mov_b32 v121, v120
    v_rcp_f32 v44, v44
    s_nop 0
    v_mul_f32 v32, v32, v44
    v_mul_f32 v33, v33, v44
    v_cvt_pk_bf16_f32 v32, v32, v33
    v_mul_f32 v34, v34, v44
    v_mul_f32 v35, v35, v44
    v_cvt_pk_bf16_f32 v33, v34, v35
    v_mul_f32 v48, v48, v44
    v_mul_f32 v49, v49, v44
    v_cvt_pk_bf16_f32 v34, v48, v49
    v_mul_f32 v50, v50, v44
    s_waitcnt lgkmcnt(5)
    v_mfma_f32_16x16x32_bf16 v[36:39], a[0:3], v[16:19], 0
    ds_write_b64 v135, v[32:33] offset:1536
    v_mul_f32 v51, v51, v44
    v_cvt_pk_bf16_f32 v35, v50, v51
    v_mul_f32 v40, v40, v44
    v_mul_f32 v41, v41, v44
    v_cvt_pk_bf16_f32 v4, v40, v41
    v_mul_f32 v42, v42, v44
    v_mul_f32 v43, v43, v44
    v_cvt_pk_bf16_f32 v5, v42, v43
    ds_write_b64 v135, v[34:35] offset:1544
    v_permlane32_swap_b32 v121, v120
    v_max_f32 v120, v121, v120
    v_mov_b32 v121, v120
    s_nop 0
    ds_write_b64 v134, v[4:5] offset:1536
    v_permlane16_swap_b32 v121, v120
    v_max_f32 v120, v121, v120
    v_sub_f32 v12, v12, v120
    v_sub_f32 v13, v13, v120
    v_sub_f32 v14, v14, v120
    v_sub_f32 v15, v15, v120
    v_sub_f32 v28, v28, v120
    v_sub_f32 v29, v29, v120
    v_sub_f32 v30, v30, v120
    v_sub_f32 v31, v31, v120
    v_sub_f32 v24, v24, v120
    v_sub_f32 v25, v25, v120
    v_sub_f32 v26, v26, v120
    v_sub_f32 v27, v27, v120
    v_sub_f32 v6, v6, v120
    v_exp_f32 v12, v12
    v_exp_f32 v13, v13
    v_exp_f32 v14, v14
    v_exp_f32 v15, v15
    v_cvt_pk_bf16_f32 v12, v12, v13
    v_cvt_pk_bf16_f32 v13, v14, v15
    v_exp_f32 v28, v28
    v_exp_f32 v29, v29
    v_exp_f32 v30, v30
    v_exp_f32 v31, v31
    v_cvt_pk_bf16_f32 v14, v28, v29
    v_cvt_pk_bf16_f32 v15, v30, v31
    v_exp_f32 v24, v24
    v_exp_f32 v25, v25
    v_exp_f32 v26, v26
    v_exp_f32 v27, v27
    v_cvt_pk_bf16_f32 v168, v24, v25
    v_cvt_pk_bf16_f32 v169, v26, v27
    v_exp_f32 v6, v6
    s_nop 0
    v_cvt_pk_bf16_f32 v170, v6, 0
    v_mfma_f32_16x16x32_bf16 v[152:155], v[220:223], v[12:15], 0
    s_nop 0
    v_mfma_f32_16x16x32_bf16 v[152:155], v[220:223], v[168:171], v[152:155]
    s_nop 1
    v_mfma_f32_16x16x32_bf16 v[4:7], v[0:3], v[12:15], 0
    s_nop 2
    v_mfma_f32_16x16x32_bf16 v[4:7], v[164:167], v[168:171], v[4:7]
    s_nop 0
    v_rcp_f32 v152, v152
    v_mfma_f32_16x16x32_bf16 v[0:3], v[8:11], v[12:15], 0
    s_nop 2
    v_mfma_f32_16x16x32_bf16 v[0:3], v[160:163], v[168:171], v[0:3]
    s_nop 0
    v_mul_f32 v4, v4, v152
    v_mul_f32 v5, v5, v152
    v_mfma_f32_16x16x32_bf16 v[8:11], v[20:23], v[12:15], 0
    v_cvt_pk_bf16_f32 v12, v4, v5
    v_mul_f32 v6, v6, v152
    v_mfma_f32_16x16x32_bf16 v[8:11], v[156:159], v[168:171], v[8:11]
    v_mul_f32 v7, v7, v152
    v_cvt_pk_bf16_f32 v13, v6, v7
    s_waitcnt lgkmcnt(0)
.p2align 6
L_loopS0:
    v_mfma_f32_16x16x32_bf16 v[36:39], a[4:7], v[146:149], v[36:39]
    ds_write_b64 v135, v[12:13] offset:3072
    v_mfma_f32_16x16x32_bf16 v[36:39], a[8:11], v[72:75], v[36:39]
    v_mul_f32 v0, v0, v152
    v_mul_f32 v1, v1, v152
    v_mfma_f32_16x16x32_bf16 v[36:39], a[12:15], v[88:91], v[36:39]
    v_cvt_pk_bf16_f32 v14, v0, v1
    v_mul_f32 v2, v2, v152
    v_mfma_f32_16x16x32_bf16 v[36:39], a[16:19], v[76:79], v[36:39]
    v_mul_f32 v3, v3, v152
    v_cvt_pk_bf16_f32 v15, v2, v3
    v_mfma_f32_16x16x32_bf16 v[36:39], a[20:23], v[56:59], v[36:39]
    ds_write_b64 v135, v[14:15] offset:3080
    v_mfma_f32_16x16x32_bf16 v[12:15], a[24:27], v[16:19], 0
    v_mul_f32 v8, v8, v152
    v_mul_f32 v9, v9, v152
    v_mfma_f32_16x16x32_bf16 v[12:15], a[28:31], v[146:149], v[12:15]
    v_cvt_pk_bf16_f32 v8, v8, v9
    v_mul_f32 v10, v10, v152
    v_mfma_f32_16x16x32_bf16 v[12:15], a[32:35], v[72:75], v[12:15]
    v_mul_f32 v11, v11, v152
    v_cvt_pk_bf16_f32 v9, v10, v11
    v_mfma_f32_16x16x32_bf16 v[12:15], a[36:39], v[88:91], v[12:15]
    ds_write_b64 v134, v[8:9] offset:3072
    v_mfma_f32_16x16x32_bf16 v[12:15], a[40:43], v[76:79], v[12:15]
    v_fma_f32 v170, v40, v40, s42
    v_fmac_f32 v170, v41, v41
    v_mfma_f32_16x16x32_bf16 v[12:15], a[44:47], v[56:59], v[12:15]
    v_fmac_f32 v170, v42, v42
    v_fmac_f32 v170, v43, v43
    v_mfma_f32_16x16x32_bf16 v[152:155], a[48:51], v[16:19], 0
    v_fmac_f32 v170, v140, v140
    v_fmac_f32 v170, v141, v141
    v_mfma_f32_16x16x32_bf16 v[152:155], a[52:55], v[146:149], v[152:155]
    v_fmac_f32 v170, v142, v142
    v_fmac_f32 v170, v143, v143
    v_mfma_f32_16x16x32_bf16 v[152:155], a[56:59], v[72:75], v[152:155]
    s_waitcnt vmcnt(10)
    v_fmac_f32 v170, v44, v44
    v_fmac_f32 v170, v45, v45
    v_mfma_f32_16x16x32_bf16 v[152:155], a[60:63], v[88:91], v[152:155]
    v_fmac_f32 v170, v46, v46
    v_fmac_f32 v170, v47, v47
    v_mfma_f32_16x16x32_bf16 v[152:155], a[64:67], v[76:79], v[152:155]
    v_cvt_pk_bf16_f32 v0, v92, v93
    v_cvt_pk_bf16_f32 v1, v170, v122
    v_mfma_f32_16x16x32_bf16 v[152:155], a[68:71], v[56:59], v[152:155]
    ds_write_b64 v130, v[0:1]
    v_mfma_f32_16x16x32_bf16 v[60:63], a[72:75], v[16:19], 0
    v_add_u32 v135, s49, v135
    v_add_u32 v134, s49, v134
    v_mfma_f32_16x16x32_bf16 v[60:63], a[76:79], v[146:149], v[60:63]
    v_fma_f32 v170, v36, v36, s41
    v_fmac_f32 v170, v37, v37
    v_mfma_f32_16x16x32_bf16 v[60:63], a[80:83], v[72:75], v[60:63]
    v_fmac_f32 v170, v38, v38
    v_fmac_f32 v170, v39, v39
    v_mfma_f32_16x16x32_bf16 v[60:63], a[84:87], v[88:91], v[60:63]
    v_fmac_f32 v170, v12, v12
    v_fmac_f32 v170, v13, v13
    v_mfma_f32_16x16x32_bf16 v[60:63], a[88:91], v[76:79], v[60:63]
    v_fmac_f32 v170, v14, v14
    v_fmac_f32 v170, v15, v15
    v_mfma_f32_16x16x32_bf16 v[60:63], a[92:95], v[56:59], v[60:63]
    v_fmac_f32 v170, v152, v152
    v_fmac_f32 v170, v153, v153
    v_mfma_f32_16x16x32_bf16 v[92:95], a[96:99], v[16:19], 0
    v_fmac_f32 v170, v154, v154
    v_fmac_f32 v170, v155, v155
    v_mfma_f32_16x16x32_bf16 v[92:95], a[100:103], v[146:149], v[92:95]
    s_waitcnt lgkmcnt(0)
    s_nop 0
    v_fma_f32 v0, v60, v60, s41
    v_fmac_f32 v0, v61, v61
    v_mfma_f32_16x16x32_bf16 v[92:95], a[104:107], v[72:75], v[92:95]
    s_barrier
    ds_read_b128 v[8:11], v129 offset:0
    v_fmac_f32 v0, v62, v62
    v_mfma_f32_16x16x32_bf16 v[92:95], a[108:111], v[88:91], v[92:95]
    ds_read_b128 v[64:67], v129 offset:1024
    v_fmac_f32 v0, v63, v63
    v_mfma_f32_16x16x32_bf16 v[92:95], a[112:115], v[76:79], v[92:95]
    v_mfma_f32_16x16x32_bf16 v[92:95], a[116:119], v[56:59], v[92:95]
    s_nop 1
    v_mfma_f32_16x16x32_bf16 v[80:83], a[120:123], v[16:19], 0
    s_nop 2
    v_mfma_f32_16x16x32_bf16 v[80:83], a[124:127], v[146:149], v[80:83]
    s_nop 0
    v_fmac_f32 v0, v92, v92
    v_fmac_f32 v0, v93, v93
    v_mfma_f32_16x16x32_bf16 v[80:83], a[128:131], v[72:75], v[80:83]
    v_fmac_f32 v0, v94, v94
    v_fmac_f32 v0, v95, v95
    v_mfma_f32_16x16x32_bf16 v[80:83], a[132:135], v[88:91], v[80:83]
    v_mfma_f32_16x16x32_bf16 v[80:83], a[136:139], v[76:79], v[80:83]
    v_mfma_f32_16x16x32_bf16 v[80:83], a[140:143], v[56:59], v[80:83]
    s_waitcnt lgkmcnt(1)
    v_readfirstlane_b32 s12, v9
    v_mfma_f32_16x16x32_bf16 v[84:87], v[216:219], v[8:11], 0
    s_waitcnt lgkmcnt(0)
    s_nop 1
    v_mfma_f32_16x16x32_bf16 v[84:87], v[216:219], v[64:67], v[84:87]
    s_lshr_b32 s12, s12, 23
    v_fmac_f32 v0, v80, v80
    v_fmac_f32 v0, v81, v81
    v_mfma_f32_16x16x32_bf16 v[8:11], v[16:19], a[144:147], 0
    v_fmac_f32 v0, v82, v82
    v_fmac_f32 v0, v83, v83
    v_mfma_f32_16x16x32_bf16 v[8:11], v[146:149], a[148:151], v[8:11]
    s_nop 0
    v_rsq_f32 v84, v84
    v_mfma_f32_16x16x32_bf16 v[8:11], v[72:75], a[152:155], v[8:11]
    v_rsq_f32 v85, v85
    v_mfma_f32_16x16x32_bf16 v[8:11], v[88:91], a[156:159], v[8:11]
    v_rsq_f32 v86, v86
    v_mfma_f32_16x16x32_bf16 v[8:11], v[76:79], a[160:163], v[8:11]
    ds_read_b128 v[64:67], v137 offset:1536
    v_mul_f32 v84, s43, v84
    v_mfma_f32_16x16x32_bf16 v[8:11], v[56:59], a[164:167], v[8:11]
    ds_read_b128 v[68:71], v136 offset:1536
    v_mul_f32 v85, s43, v85
    v_mfma_f32_16x16x32_bf16 v[48:51], v[16:19], a[168:171], 0
    ds_read_b128 v[52:55], v137 offset:1664
    v_mul_f32 v86, s43, v86
    v_mfma_f32_16x16x32_bf16 v[48:51], v[146:149], a[172:175], v[48:51]
    ds_read_b128 v[96:99], v136 offset:1664
    v_cvt_pk_bf16_f32 v170, v170, v0
    v_mfma_f32_16x16x32_bf16 v[48:51], v[72:75], a[176:179], v[48:51]
    ds_read_b128 v[108:111], v137 offset:1792
    v_cvt_pk_bf16_f32 v0, v8, v9
    v_mfma_f32_16x16x32_bf16 v[48:51], v[88:91], a[180:183], v[48:51]
    ds_read_b128 v[104:107], v136 offset:1792
    v_cvt_pk_bf16_f32 v1, v10, v11
    v_mfma_f32_16x16x32_bf16 v[48:51], v[76:79], a[184:187], v[48:51]
    v_mul_f32 v32, v32, v84
    v_mul_f32 v33, v33, v84
    v_mfma_f32_16x16x32_bf16 v[48:51], v[56:59], a[188:191], v[48:51]
    s_nop 0
    v_cvt_pk_bf16_f32 v2, v32, v33
    v_mul_f32 v34, v34, v84
    v_mfma_f32_16x16x16_bf16 v[118:121], v[216:217], v[170:171], 0
    s_nop 0
    v_mul_f32 v35, v35, v84
    v_cvt_pk_bf16_f32 v3, v34, v35
    v_mul_f32 v4, v4, v84
    v_cvt_pk_bf16_f32 v8, v48, v49
    v_mfma_f32_16x16x32_bf16 v[32:35], v[16:19], a[192:195], 0
    ds_write_b64 v135, v[2:3] offset:0
    v_mfma_f32_16x16x32_bf16 v[32:35], v[146:149], a[196:199], v[32:35]
    v_rsq_f32 v118, v118
    v_mfma_f32_16x16x32_bf16 v[32:35], v[72:75], a[200:203], v[32:35]
    v_rsq_f32 v119, v119
    v_mfma_f32_16x16x32_bf16 v[32:35], v[88:91], a[204:207], v[32:35]
    v_mul_f32 v118, s55, v118
    v_mul_f32 v119, 0.5, v119
    v_mfma_f32_16x16x32_bf16 v[32:35], v[76:79], a[208:211], v[32:35]
    v_cvt_pk_bf16_f32 v9, v50, v51
    v_mul_f32 v36, v36, v118
    v_mfma_f32_16x16x32_bf16 v[32:35], v[56:59], a[212:215], v[32:35]
    s_waitcnt lgkmcnt(1)
    v_mul_f32 v37, v37, v118
    v_cvt_pk_f16_f32 v76, v36, v37
    v_mfma_f32_16x16x32_bf16 v[146:149], a[0:3], v[64:67], 0
    v_mul_f32 v38, v38, v118
    v_mul_f32 v39, v39, v118
    v_mfma_f32_16x16x32_bf16 v[146:149], a[4:7], v[68:71], v[146:149]
    v_cvt_pk_f16_f32 v77, v38, v39
    v_mul_f32 v12, v12, v118
    v_mfma_f32_16x16x32_bf16 v[146:149], a[8:11], v[52:55], v[146:149]
    v_mul_f32 v13, v13, v118
    v_cvt_pk_f16_f32 v78, v12, v13
    v_mfma_f32_16x16x32_bf16 v[146:149], a[12:15], v[96:99], v[146:149]
    v_mul_f32 v14, v14, v118
    v_mul_f32 v15, v15, v118
    v_mfma_f32_16x16x32_bf16 v[146:149], a[16:19], v[108:111], v[146:149]
    v_cvt_pk_f16_f32 v79, v14, v15
    v_mul_f32 v152, v152, v118
    v_mfma_f32_16x16x32_bf16 v[146:149], a[20:23], v[104:107], v[146:149]
    v_mul_f32 v153, v153, v118
    v_cvt_pk_f16_f32 v152, v152, v153
    v_mfma_f32_16x16x32_bf16 v[36:39], a[24:27], v[64:67], 0
    v_mul_f32 v154, v154, v118
    v_mul_f32 v155, v155, v118
    v_mfma_f32_16x16x32_bf16 v[36:39], a[28:31], v[68:71], v[36:39]
    v_cvt_pk_f16_f32 v153, v154, v155
    v_mul_f32 v60, v60, v119
    v_mfma_f32_16x16x32_bf16 v[36:39], a[32:35], v[52:55], v[36:39]
    v_mul_f32 v61, v61, v119
    v_cvt_pk_f16_f32 v16, v60, v61
    v_mfma_f32_16x16x32_bf16 v[36:39], a[36:39], v[96:99], v[36:39]
    v_mul_f32 v62, v62, v119
    v_mul_f32 v63, v63, v119
    v_mfma_f32_16x16x32_bf16 v[36:39], a[40:43], v[108:111], v[36:39]
    v_cvt_pk_f16_f32 v17, v62, v63
    v_mul_f32 v92, v92, v119
    v_mfma_f32_16x16x32_bf16 v[36:39], a[44:47], v[104:107], v[36:39]
    v_mul_f32 v93, v93, v119
    v_cvt_pk_f16_f32 v18, v92, v93
    v_mfma_f32_16x16x32_bf16 v[72:75], a[48:51], v[64:67], 0
    v_mul_f32 v94, v94, v119
    v_mul_f32 v95, v95, v119
    v_mfma_f32_16x16x32_bf16 v[72:75], a[52:55], v[68:71], v[72:75]
    v_cvt_pk_f16_f32 v19, v94, v95
    v_mul_f32 v80, v80, v119
    v_mfma_f32_16x16x32_bf16 v[72:75], a[56:59], v[52:55], v[72:75]
    v_mul_f32 v81, v81, v119
    v_cvt_pk_f16_f32 v154, v80, v81
    v_mfma_f32_16x16x32_bf16 v[72:75], a[60:63], v[96:99], v[72:75]
    v_mul_f32 v82, v82, v119
    v_mul_f32 v83, v83, v119
    v_mfma_f32_16x16x32_bf16 v[72:75], a[64:67], v[108:111], v[72:75]
    v_cvt_pk_f16_f32 v155, v82, v83
    v_cvt_pk_bf16_f32 v12, v32, v33
    v_mfma_f32_16x16x32_bf16 v[72:75], a[68:71], v[104:107], v[72:75]
    v_cvt_pk_bf16_f32 v13, v34, v35
    v_mul_f32 v5, v5, v84
    v_mfma_f32_16x16x32_bf16 v[32:35], a[72:75], v[64:67], 0
    v_cvt_pk_bf16_f32 v4, v4, v5
    v_mul_f32 v6, v6, v84
    v_mfma_f32_16x16x32_bf16 v[32:35], a[76:79], v[68:71], v[32:35]
    v_mul_f32 v7, v7, v84
    v_cvt_pk_bf16_f32 v5, v6, v7
    v_mfma_f32_16x16x32_bf16 v[32:35], a[80:83], v[52:55], v[32:35]
    ds_write_b64 v135, v[4:5] offset:8
    v_mfma_f32_16x16x32_bf16 v[32:35], a[84:87], v[96:99], v[32:35]
    v_mul_f32 v24, v24, v84
    v_mul_f32 v25, v25, v84
    v_mfma_f32_16x16x32_bf16 v[32:35], a[88:91], v[108:111], v[32:35]
    v_cvt_pk_bf16_f32 v2, v24, v25
    v_mul_f32 v26, v26, v84
    v_mfma_f32_16x16x32_bf16 v[32:35], a[92:95], v[104:107], v[32:35]
    v_mul_f32 v27, v27, v84
    v_cvt_pk_bf16_f32 v3, v26, v27
    v_mfma_f32_16x16x32_bf16 v[4:7], a[96:99], v[64:67], 0
    ds_write_b64 v134, v[2:3] offset:0
    v_mfma_f32_16x16x32_bf16 v[4:7], a[100:103], v[68:71], v[4:7]
    v_fma_f32 v2, v146, v146, s41
    v_fmac_f32 v2, v147, v147
    v_mfma_f32_16x16x32_bf16 v[4:7], a[104:107], v[52:55], v[4:7]
    v_fmac_f32 v2, v148, v148
    v_fmac_f32 v2, v149, v149
    v_mfma_f32_16x16x32_bf16 v[4:7], a[108:111], v[96:99], v[4:7]
    v_fmac_f32 v2, v36, v36
    v_fmac_f32 v2, v37, v37
    v_mfma_f32_16x16x32_bf16 v[4:7], a[112:115], v[108:111], v[4:7]
    v_fmac_f32 v2, v38, v38
    v_fmac_f32 v2, v39, v39
    v_mfma_f32_16x16x32_bf16 v[4:7], a[116:119], v[104:107], v[4:7]
    v_fmac_f32 v2, v72, v72
    v_fmac_f32 v2, v73, v73
    v_mfma_f32_16x16x32_bf16 v[24:27], a[120:123], v[64:67], 0
    v_fmac_f32 v2, v74, v74
    v_fmac_f32 v2, v75, v75
    v_mfma_f32_16x16x32_bf16 v[24:27], a[124:127], v[68:71], v[24:27]
    v_mul_f32 v28, v28, v85
    v_mul_f32 v29, v29, v85
    v_mfma_f32_16x16x32_bf16 v[24:27], a[128:131], v[52:55], v[24:27]
    v_cvt_pk_bf16_f32 v88, v28, v29
    v_mul_f32 v30, v30, v85
    v_mfma_f32_16x16x32_bf16 v[24:27], a[132:135], v[96:99], v[24:27]
    v_mul_f32 v31, v31, v85
    v_cvt_pk_bf16_f32 v89, v30, v31
    v_mfma_f32_16x16x32_bf16 v[24:27], a[136:139], v[108:111], v[24:27]
    ds_write_b64 v135, v[88:89] offset:1536
    v_mfma_f32_16x16x32_bf16 v[24:27], a[140:143], v[104:107], v[24:27]
    v_mul_f32 v20, v20, v85
    v_mul_f32 v21, v21, v85
    v_mfma_f32_16x16x32_bf16 v[60:63], v[64:67], a[144:147], 0
    v_cvt_pk_bf16_f32 v90, v20, v21
    v_mul_f32 v22, v22, v85
    v_mfma_f32_16x16x32_bf16 v[60:63], v[68:71], a[148:151], v[60:63]
    v_mul_f32 v23, v23, v85
    v_cvt_pk_bf16_f32 v91, v22, v23
    v_mfma_f32_16x16x32_bf16 v[60:63], v[52:55], a[152:155], v[60:63]
    ds_write_b64 v135, v[90:91] offset:1544
    v_mfma_f32_16x16x32_bf16 v[60:63], v[96:99], a[156:159], v[60:63]
    v_mul_f32 v114, v114, v85
    v_mul_f32 v115, v115, v85
    v_mfma_f32_16x16x32_bf16 v[60:63], v[108:111], a[160:163], v[60:63]
    ds_read_b128 v[88:91], v137 offset:3072
    v_cvt_pk_bf16_f32 v10, v114, v115
    v_mfma_f32_16x16x32_bf16 v[60:63], v[104:107], a[164:167], v[60:63]
    ds_read_b128 v[56:59], v136 offset:3072
    v_mul_f32 v116, v116, v85
    v_mfma_f32_16x16x32_bf16 v[92:95], v[64:67], a[168:171], 0
    ds_read_b128 v[80:83], v137 offset:3200
    v_mul_f32 v117, v117, v85
    v_mfma_f32_16x16x32_bf16 v[92:95], v[68:71], a[172:175], v[92:95]
    ds_read_b128 v[28:31], v136 offset:3200
    v_cvt_pk_bf16_f32 v11, v116, v117
    v_mfma_f32_16x16x32_bf16 v[92:95], v[52:55], a[176:179], v[92:95]
    ds_write_b64 v134, v[10:11] offset:1536
    v_mfma_f32_16x16x32_bf16 v[92:95], v[96:99], a[180:183], v[92:95]
    v_fma_f32 v3, v32, v32, s41
    v_fmac_f32 v3, v33, v33
    v_mfma_f32_16x16x32_bf16 v[92:95], v[108:111], a[184:187], v[92:95]
    ds_read_b128 v[48:51], v137 offset:3328
    v_fmac_f32 v3, v34, v34
    v_mfma_f32_16x16x32_bf16 v[92:95], v[104:107], a[188:191], v[92:95]
    ds_read_b128 v[20:23], v136 offset:3328
    v_fmac_f32 v3, v35, v35
    v_mfma_f32_16x16x32_bf16 v[112:115], v[64:67], a[192:195], 0
    v_fmac_f32 v3, v4, v4
    v_fmac_f32 v3, v5, v5
    v_mfma_f32_16x16x32_bf16 v[112:115], v[68:71], a[196:199], v[112:115]
    s_sub_u32 s50, s45, s44
    v_fmac_f32 v3, v6, v6
    v_fmac_f32 v3, v7, v7
    v_mfma_f32_16x16x32_bf16 v[112:115], v[52:55], a[200:203], v[112:115]
    s_sub_u32 s51, s46, s47
    v_fmac_f32 v3, v24, v24
    v_fmac_f32 v3, v25, v25
    v_mfma_f32_16x16x32_bf16 v[112:115], v[96:99], a[204:207], v[112:115]
    s_mov_b32 s60, s59
    v_fmac_f32 v3, v26, v26
    v_fmac_f32 v3, v27, v27
    v_mfma_f32_16x16x32_bf16 v[112:115], v[108:111], a[208:211], v[112:115]
    s_mov_b32 s59, s58
    v_cvt_pk_bf16_f32 v170, v2, v3
    v_cvt_pk_bf16_f32 v2, v60, v61
    v_mfma_f32_16x16x32_bf16 v[112:115], v[104:107], a[212:215], v[112:115]
    s_mov_b32 s58, s57
    v_cvt_pk_bf16_f32 v3, v62, v63
    v_cvt_pk_bf16_f32 v10, v92, v93
    v_mfma_f32_16x16x16_bf16 v[60:63], v[216:217], v[170:171], 0
    s_waitcnt lgkmcnt(2)
    s_mov_b32 s57, s56
    v_cvt_pk_bf16_f32 v11, v94, v95
    v_mul_f32 v40, v40, v86
    v_mul_f32 v41, v41, v86
    v_cvt_pk_bf16_f32 v14, v112, v113
    v_mfma_f32_16x16x32_bf16 v[92:95], a[0:3], v[88:91], 0
    s_mov_b32 s7, s6
    v_cvt_pk_bf16_f32 v15, v114, v115
    v_cvt_pk_bf16_f32 v40, v40, v41
    v_mfma_f32_16x16x32_bf16 v[92:95], a[4:7], v[56:59], v[92:95]
    s_mov_b32 s6, s5
    v_rsq_f32 v60, v60
    v_mfma_f32_16x16x32_bf16 v[92:95], a[8:11], v[80:83], v[92:95]
    s_mov_b32 s5, s4
    v_rsq_f32 v61, v61
    v_mfma_f32_16x16x32_bf16 v[92:95], a[12:15], v[28:31], v[92:95]
    s_waitcnt lgkmcnt(0)
    s_sub_u32 s14, s6, s7
    v_mul_f32 v60, s55, v60
    v_mul_f32 v61, 0.5, v61
    v_mfma_f32_16x16x32_bf16 v[92:95], a[16:19], v[48:51], v[92:95]
    s_add_u32 s61, s61, 1
    v_mul_f32 v146, v146, v60
    v_mul_f32 v147, v147, v60
    v_mfma_f32_16x16x32_bf16 v[92:95], a[20:23], v[20:23], v[92:95]
    s_ff1_i32_b32 s15, s66
    v_cvt_pk_f16_f32 v96, v146, v147
    v_mul_f32 v148, v148, v60
    v_mfma_f32_16x16x32_bf16 v[64:67], a[24:27], v[88:91], 0
    s_cmp_lg_u32 s66, 0
    v_mul_f32 v149, v149, v60
    v_cvt_pk_f16_f32 v97, v148, v149
    v_mfma_f32_16x16x32_bf16 v[64:67], a[28:31], v[56:59], v[64:67]
    s_cselect_b32 s12, s15, s12
    v_mul_f32 v36, v36, v60
    v_mul_f32 v37, v37, v60
    v_mfma_f32_16x16x32_bf16 v[64:67], a[32:35], v[80:83], v[64:67]
    s_cmp_lt_u32 s61, s71
    v_cvt_pk_f16_f32 v98, v36, v37
    v_mul_f32 v38, v38, v60
    v_mfma_f32_16x16x32_bf16 v[64:67], a[36:39], v[28:31], v[64:67]
    s_cselect_b32 s15, 31, s15
    v_mul_f32 v39, v39, v60
    v_cvt_pk_f16_f32 v99, v38, v39
    v_mfma_f32_16x16x32_bf16 v[64:67], a[40:43], v[48:51], v[64:67]
    s_bitset0_b32 s66, s15
    v_mul_f32 v72, v72, v60
    v_mul_f32 v73, v73, v60
    v_mfma_f32_16x16x32_bf16 v[64:67], a[44:47], v[20:23], v[64:67]
    s_add_u32 s12, s12, 20
    v_cvt_pk_f16_f32 v146, v72, v73
    v_mul_f32 v74, v74, v60
    v_mfma_f32_16x16x32_bf16 v[68:71], a[48:51], v[88:91], 0
    s_max_u32 s12, s12, s61
    v_mul_f32 v75, v75, v60
    v_cvt_pk_f16_f32 v147, v74, v75
    v_mfma_f32_16x16x32_bf16 v[68:71], a[52:55], v[56:59], v[68:71]
    s_cmp_lt_u32 s61, s71
    v_mul_f32 v32, v32, v61
    v_mul_f32 v33, v33, v61
    v_mfma_f32_16x16x32_bf16 v[68:71], a[56:59], v[80:83], v[68:71]
    s_cselect_b32 s15, s61, s12
    v_cvt_pk_f16_f32 v36, v32, v33
    v_mul_f32 v34, v34, v61
    v_mfma_f32_16x16x32_bf16 v[68:71], a[60:63], v[28:31], v[68:71]
    s_cselect_b32 s56, s69, s70
    v_mul_f32 v35, v35, v61
    v_cvt_pk_f16_f32 v37, v34, v35
    v_mfma_f32_16x16x32_bf16 v[68:71], a[64:67], v[48:51], v[68:71]
    s_add_u32 s56, s56, s15
    v_mul_f32 v4, v4, v61
    v_mul_f32 v5, v5, v61
    v_mfma_f32_16x16x32_bf16 v[68:71], a[68:71], v[20:23], v[68:71]
    s_mul_i32 s53, s56, 58255
    v_cvt_pk_f16_f32 v38, v4, v5
    v_mul_f32 v6, v6, v61
    v_mfma_f32_16x16x32_bf16 v[72:75], a[72:75], v[88:91], 0
    s_lshr_b32 s53, s53, 22
    v_mul_f32 v7, v7, v61
    v_cvt_pk_f16_f32 v39, v6, v7
    v_mfma_f32_16x16x32_bf16 v[72:75], a[76:79], v[56:59], v[72:75]
    s_mul_i32 s53, s53, s63
    v_mul_f32 v24, v24, v61
    v_mul_f32 v25, v25, v61
    v_mfma_f32_16x16x32_bf16 v[72:75], a[80:83], v[80:83], v[72:75]
    s_mul_i32 s56, s56, s62
    v_cvt_pk_f16_f32 v148, v24, v25
    v_mul_f32 v26, v26, v61
    v_mfma_f32_16x16x32_bf16 v[72:75], a[84:87], v[28:31], v[72:75]
    s_add_u32 s56, s56, s53
    v_mul_f32 v27, v27, v61
    v_cvt_pk_f16_f32 v149, v26, v27
    v_mfma_f32_16x16x32_bf16 v[72:75], a[88:91], v[48:51], v[72:75]
    s_mul_i32 s4, s15, 112
    v_mul_f32 v42, v42, v86
    v_mul_f32 v43, v43, v86
    v_mfma_f32_16x16x32_bf16 v[72:75], a[92:95], v[20:23], v[72:75]
    s_cmp_ge_u32 s15, 16
    v_cvt_pk_bf16_f32 v41, v42, v43
    v_mul_f32 v140, v140, v86
    v_mfma_f32_16x16x32_bf16 v[4:7], a[96:99], v[88:91], 0
    s_cselect_b32 s53, -30464, 0
    ds_write_b64 v135, v[40:41] offset:3072
    v_mfma_f32_16x16x32_bf16 v[4:7], a[100:103], v[56:59], v[4:7]
    s_add_u32 s4, s4, s53
    v_mul_f32 v141, v141, v86
    v_cvt_pk_bf16_f32 v42, v140, v141
    v_mfma_f32_16x16x32_bf16 v[4:7], a[104:107], v[80:83], v[4:7]
    s_cmp_lt_u32 s15, s73
    v_mul_f32 v142, v142, v86
    v_mul_f32 v143, v143, v86
    v_mfma_f32_16x16x32_bf16 v[4:7], a[108:111], v[28:31], v[4:7]
    s_cselect_b32 s26, 100270464, 0
    v_cvt_pk_bf16_f32 v43, v142, v143
    v_mul_f32 v44, v44, v86
    v_mfma_f32_16x16x32_bf16 v[4:7], a[112:115], v[48:51], v[4:7]
    s_cselect_b32 s56, s56, 0
    ds_write_b64 v135, v[42:43] offset:3080
    v_mfma_f32_16x16x32_bf16 v[4:7], a[116:119], v[20:23], v[4:7]
    s_cselect_b32 s4, s4, -1
    v_mul_f32 v45, v45, v86
    v_cvt_pk_bf16_f32 v44, v44, v45
    v_mul_f32 v46, v46, v86
    v_mul_f32 v47, v47, v86
    v_cvt_pk_bf16_f32 v45, v46, v47
    s_cselect_b32 s15, s15, 0
    s_cselect_b32 s13, s13, -1
    ds_write_b64 v134, v[44:45] offset:3072
    v_fma_f32 v120, v92, v92, s41
    v_fmac_f32 v120, v93, v93
    v_fmac_f32 v120, v94, v94
    v_fmac_f32 v120, v95, v95
    v_mfma_f32_16x16x32_bf16 v[24:27], a[120:123], v[88:91], 0
    s_waitcnt vmcnt(0)
    v_fmac_f32 v120, v64, v64
    v_fmac_f32 v120, v65, v65
    v_mfma_f32_16x16x32_bf16 v[24:27], a[124:127], v[56:59], v[24:27]
    s_bitset1_b32 s64, s15
    v_fmac_f32 v120, v66, v66
    v_fmac_f32 v120, v67, v67
    v_mfma_f32_16x16x32_bf16 v[24:27], a[128:131], v[80:83], v[24:27]
    s_add_u32 s65, s65, 1
    v_fmac_f32 v120, v68, v68
    v_fmac_f32 v120, v69, v69
    v_mfma_f32_16x16x32_bf16 v[24:27], a[132:135], v[28:31], v[24:27]
    s_cmp_ge_i32 s65, 2
    v_fmac_f32 v120, v70, v70
    v_fmac_f32 v120, v71, v71
    v_mfma_f32_16x16x32_bf16 v[24:27], a[136:139], v[48:51], v[24:27]
    s_cselect_b32 s30, 100270464, 0
    v_fma_f32 v121, v72, v72, s41
    v_fmac_f32 v121, v73, v73
    v_mfma_f32_16x16x32_bf16 v[24:27], a[140:143], v[20:23], v[24:27]
    s_add_u32 s67, s46, s54
    v_fmac_f32 v121, v74, v74
    v_fmac_f32 v121, v75, v75
    v_mfma_f32_16x16x32_bf16 v[32:35], v[88:91], a[144:147], 0
    s_waitcnt lgkmcnt(0)
    s_add_u32 m0, s67, 0
    v_fmac_f32 v121, v4, v4
    v_fmac_f32 v121, v5, v5
    v_mfma_f32_16x16x32_bf16 v[32:35], v[56:59], a[148:151], v[32:35]
    s_barrier
    v_fmac_f32 v121, v6, v6
    v_fmac_f32 v121, v7, v7
    v_mfma_f32_16x16x32_bf16 v[32:35], v[80:83], a[152:155], v[32:35]
    s_cmp_ge_u32 s61, s13
    v_fmac_f32 v121, v24, v24
    v_fmac_f32 v121, v25, v25
    v_mfma_f32_16x16x32_bf16 v[32:35], v[28:31], a[156:159], v[32:35]
    s_cbranch_scc1 L_atomS0
L_atomS0r:
    v_mfma_f32_16x16x32_bf16 v[32:35], v[48:51], a[160:163], v[32:35]
    v_fmac_f32 v121, v26, v26
    v_fmac_f32 v121, v27, v27
    v_mfma_f32_16x16x32_bf16 v[32:35], v[20:23], a[164:167], v[32:35]
    v_cvt_pk_bf16_f32 v170, v120, v121
    v_add_u32 v137, s50, v137
    v_mfma_f32_16x16x32_bf16 v[40:43], v[88:91], a[168:171], 0
    ds_read_b128 v[60:63], v137 offset:0
    v_add_u32 v136, s50, v136
    v_mfma_f32_16x16x32_bf16 v[40:43], v[56:59], a[172:175], v[40:43]
    s_nop 0
    ds_read_b128 v[84:87], v136 offset:0
    v_cvt_pk_bf16_f32 v164, v32, v33
    v_mfma_f32_16x16x32_bf16 v[40:43], v[80:83], a[176:179], v[40:43]
    ds_read_b128 v[52:55], v137 offset:128
    v_cvt_pk_bf16_f32 v165, v34, v35
    v_mfma_f32_16x16x32_bf16 v[40:43], v[28:31], a[180:183], v[40:43]
    ds_read_b128 v[112:115], v136 offset:128
    v_add_u32 v135, s48, v135
    v_mfma_f32_16x16x32_bf16 v[40:43], v[48:51], a[184:187], v[40:43]
    ds_read_b128 v[108:111], v137 offset:256
    v_add_u32 v134, s48, v134
    v_mfma_f32_16x16x32_bf16 v[40:43], v[20:23], a[188:191], v[40:43]
    s_nop 0
    ds_read_b128 v[104:107], v136 offset:256
    v_add_u32 v133, s51, v133
    v_mfma_f32_16x16x16_bf16 v[118:121], v[216:217], v[170:171], 0
    s_nop 0
    v_add_u32 v132, s14, v132
    v_add_u32 v131, s14, v131
    v_add_u32 v123, s14, v123
    v_cvt_pk_bf16_f32 v160, v40, v41
    v_mfma_f32_16x16x32_bf16 v[100:103], v[88:91], a[192:195], 0
    v_cvt_pk_bf16_f32 v161, v42, v43
    v_and_b32 v116, -8, v123
    v_mfma_f32_16x16x32_bf16 v[100:103], v[56:59], a[196:199], v[100:103]
    v_rsq_f32 v118, v118
    v_mfma_f32_16x16x32_bf16 v[100:103], v[80:83], a[200:203], v[100:103]
    v_rsq_f32 v119, v119
    v_mfma_f32_16x16x32_bf16 v[100:103], v[28:31], a[204:207], v[100:103]
    ds_read_b128 v[28:31], v132 offset:0
    v_mul_f32 v118, s55, v118
    v_mfma_f32_16x16x32_bf16 v[100:103], v[48:51], a[208:211], v[100:103]
    ds_read_b128 v[48:51], v132 offset:16
    v_mul_f32 v119, 0.5, v119
    v_mfma_f32_16x16x32_bf16 v[100:103], v[20:23], a[212:215], v[100:103]
    s_waitcnt lgkmcnt(3)
    ds_read_b128 v[20:23], v132 offset:48
    v_mul_f32 v72, v72, v119
    v_mfma_f32_16x16x32_bf16 v[32:35], a[216:219], v[60:63], 0
    ds_read_b128 v[88:91], v133 offset:0
    v_mul_f32 v73, v73, v119
    v_mfma_f32_16x16x32_bf16 v[32:35], a[220:223], v[84:87], v[32:35]
    v_cvt_pk_f16_f32 v40, v72, v73
    v_mul_f32 v74, v74, v119
    v_mfma_f32_16x16x32_bf16 v[32:35], a[224:227], v[52:55], v[32:35]
    v_mul_f32 v75, v75, v119
    v_cvt_pk_f16_f32 v41, v74, v75
    v_mfma_f32_16x16x32_bf16 v[32:35], a[228:231], v[112:115], v[32:35]
    v_mul_f32 v4, v4, v119
    v_mul_f32 v5, v5, v119
    v_mfma_f32_16x16x32_bf16 v[32:35], a[232:235], v[108:111], v[32:35]
    s_waitcnt lgkmcnt(4)
    v_cvt_pk_f16_f32 v42, v4, v5
    v_mul_f32 v6, v6, v119
    v_mfma_f32_16x16x32_bf16 v[32:35], a[236:239], v[104:107], v[32:35]
    v_mul_f32 v7, v7, v119
    v_cvt_pk_f16_f32 v43, v6, v7
    v_mfma_f32_16x16x32_bf16 v[4:7], a[240:243], v[60:63], 0
    v_mul_f32 v24, v24, v119
    v_mul_f32 v25, v25, v119
    v_mfma_f32_16x16x32_bf16 v[4:7], a[244:247], v[84:87], v[4:7]
    v_cvt_pk_f16_f32 v142, v24, v25
    v_mul_f32 v26, v26, v119
    v_mfma_f32_16x16x32_bf16 v[4:7], a[248:251], v[52:55], v[4:7]
    v_mul_f32 v27, v27, v119
    v_cvt_pk_f16_f32 v143, v26, v27
    v_mfma_f32_16x16x32_bf16 v[4:7], a[252:255], v[112:115], v[4:7]
    s_waitcnt lgkmcnt(0)
    buffer_load_dwordx4 v128, s[24:27], s56 offen nt lds
    v_mul_f32 v92, v92, v118
    v_mfma_f32_16x16x32_bf16 v[4:7], v[224:227], v[108:111], v[4:7]
    v_mul_f32 v93, v93, v118
    v_cvt_pk_f16_f32 v44, v92, v93
    v_mfma_f32_16x16x32_bf16 v[4:7], v[228:231], v[104:107], v[4:7]
    v_mul_f32 v94, v94, v118
    v_mul_f32 v95, v95, v118
    v_mfma_f32_16x16x32_bf16 v[24:27], v[232:235], v[60:63], 0
    v_cvt_pk_f16_f32 v45, v94, v95
    v_mul_f32 v64, v64, v118
    v_mfma_f32_16x16x32_bf16 v[24:27], v[236:239], v[84:87], v[24:27]
    v_mul_f32 v65, v65, v118
    v_cvt_pk_f16_f32 v46, v64, v65
    v_mfma_f32_16x16x32_bf16 v[24:27], v[240:243], v[52:55], v[24:27]
    v_mul_f32 v66, v66, v118
    v_mul_f32 v67, v67, v118
    v_mfma_f32_16x16x32_bf16 v[24:27], v[244:247], v[112:115], v[24:27]
    v_cvt_pk_f16_f32 v47, v66, v67
    v_mul_f32 v68, v68, v118
    v_mfma_f32_16x16x32_bf16 v[24:27], v[248:251], v[108:111], v[24:27]
    buffer_store_dwordx4 v[88:91], v128, s[28:31], s60 offen sc1
    v_mul_f32 v69, v69, v118
    v_cvt_pk_f16_f32 v140, v68, v69
    v_mul_f32 v70, v70, v118
    v_mul_f32 v71, v71, v118
    v_mfma_f32_16x16x32_bf16 v[24:27], v[252:255], v[104:107], v[24:27]
    s_add_u32 m0, s67, 1024
    v_cvt_pk_f16_f32 v141, v70, v71
    v_cvt_pk_bf16_f32 v156, v100, v101
    v_mfma_f32_16x16x32_f16 v[112:115], v[16:19], v[76:79], v[204:207]
    ds_read_u16 v166, v131 offset:80
    v_cvt_pk_bf16_f32 v157, v102, v103
    v_mfma_f32_16x16x32_f16 v[112:115], v[152:155], v[150:153], v[112:115]
    ds_read_u16 v162, v131 offset:96
    v_mfma_f32_16x16x32_f16 v[108:111], v[36:39], v[76:79], v[200:203]
    s_nop 0
    ds_read_u16 v158, v131 offset:104
    s_nop 0
    v_mfma_f32_16x16x32_f16 v[108:111], v[146:149], v[150:153], v[108:111]
    s_nop 0
    ds_read_b32 v116, v116 offset:64
    v_max3_f32 v120, v112, v113, v114
    v_mfma_f32_16x16x32_f16 v[104:107], v[40:43], v[76:79], v[196:199]
    ds_read_b128 v[68:71], v133 offset:1024
    v_mfma_f32_16x16x32_f16 v[104:107], v[140:143], v[150:153], v[104:107]
    s_nop 0
    ds_read_b128 v[72:75], v137 offset:1536
    v_max3_f32 v120, v120, v115, v108
    v_mfma_f32_16x16x32_f16 v[88:91], v[28:31], v[76:79], v[208:211]
    ds_read_b128 v[76:79], v136 offset:1536
    v_max3_f32 v120, v120, v109, v110
    v_mfma_f32_16x16x32_f16 v[88:91], v[48:51], v[16:19], v[88:91]
    ds_read_b128 v[60:63], v137 offset:1664
    v_max3_f32 v120, v120, v111, v104
    v_mfma_f32_16x16x32_f16 v[88:91], v[20:23], v[152:155], v[88:91]
    ds_read_b128 v[56:59], v136 offset:1664
    v_max3_f32 v120, v120, v105, v106
    v_mfma_f32_16x16x32_f16 v[92:95], v[28:31], v[96:99], v[208:211]
    ds_read_b128 v[64:67], v137 offset:1792
    s_nop 0
    v_mfma_f32_16x16x32_f16 v[92:95], v[48:51], v[36:39], v[92:95]
    s_nop 0
    ds_read_b128 v[80:83], v136 offset:1792
    v_max3_f32 v120, v120, v107, v88
    v_mfma_f32_16x16x32_f16 v[92:95], v[20:23], v[146:149], v[92:95]
    v_mov_b32 v121, v120
    v_mfma_f32_16x16x32_f16 v[84:87], v[28:31], v[44:47], v[208:211]
    s_nop 0
    v_permlane32_swap_b32 v121, v120
    v_mfma_f32_16x16x32_f16 v[84:87], v[48:51], v[40:43], v[84:87]
    s_waitcnt lgkmcnt(6)
    buffer_load_dwordx4 v127, s[24:27], s56 offen nt lds
    v_max_f32 v120, v121, v120
    v_mfma_f32_16x16x32_f16 v[84:87], v[20:23], v[140:143], v[84:87]
    s_waitcnt lgkmcnt(5)
    v_mov_b32 v121, v120
    v_mov_b32_dpp v91, v95 quad_perm:[0,1,2,3] row_mask:0x2 bank_mask:0xf
    v_mfma_f32_16x16x32_bf16 v[28:31], a[216:219], v[72:75], 0
    s_waitcnt lgkmcnt(4)
    v_permlane16_swap_b32 v121, v120
    v_mfma_f32_16x16x32_bf16 v[28:31], a[220:223], v[76:79], v[28:31]
    s_waitcnt lgkmcnt(3)
    v_max_f32 v120, v121, v120
    v_sub_f32 v112, v112, v120
    v_mfma_f32_16x16x32_bf16 v[28:31], a[224:227], v[60:63], v[28:31]
    s_waitcnt lgkmcnt(2)
    v_sub_f32 v113, v113, v120
    v_sub_f32 v114, v114, v120
    v_mfma_f32_16x16x32_bf16 v[28:31], a[228:231], v[56:59], v[28:31]
    s_waitcnt lgkmcnt(1)
    v_sub_f32 v115, v115, v120
    v_sub_f32 v108, v108, v120
    v_mfma_f32_16x16x32_bf16 v[28:31], a[232:235], v[64:67], v[28:31]
    s_waitcnt lgkmcnt(0)
    v_sub_f32 v109, v109, v120
    v_sub_f32 v110, v110, v120
    v_mfma_f32_16x16x32_bf16 v[28:31], a[236:239], v[80:83], v[28:31]
    buffer_store_dwordx4 v[68:71], v127, s[28:31], s60 offen sc1
    ds_read_b128 v[100:103], v133 offset:2048
    v_sub_f32 v111, v111, v120
    v_sub_f32 v104, v104, v120
    v_sub_f32 v105, v105, v120
    v_mfma_f32_16x16x32_f16 v[48:51], v[16:19], v[96:99], v[192:195]
    s_add_u32 m0, s67, 2048
    v_sub_f32 v106, v106, v120
    v_sub_f32 v107, v107, v120
    v_mfma_f32_16x16x32_f16 v[48:51], v[152:155], v[144:147], v[48:51]
    v_sub_f32 v88, v88, v120
    v_mov_b32_dpp v91, v87 quad_perm:[0,1,2,3] row_mask:0x4 bank_mask:0xf
    v_mfma_f32_16x16x32_f16 v[68:71], v[36:39], v[96:99], v[188:191]
    v_exp_f32 v112, v112
    v_mfma_f32_16x16x32_f16 v[68:71], v[146:149], v[144:147], v[68:71]
    v_exp_f32 v113, v113
    v_mfma_f32_16x16x32_f16 v[52:55], v[40:43], v[96:99], v[184:187]
    v_exp_f32 v114, v114
    v_mfma_f32_16x16x32_f16 v[52:55], v[140:143], v[144:147], v[52:55]
    v_exp_f32 v115, v115
    v_mfma_f32_16x16x32_bf16 v[20:23], a[240:243], v[72:75], 0
    v_cvt_pk_bf16_f32 v96, v112, v113
    v_cvt_pk_bf16_f32 v97, v114, v115
    v_mfma_f32_16x16x32_bf16 v[20:23], a[244:247], v[76:79], v[20:23]
    v_exp_f32 v108, v108
    v_mfma_f32_16x16x32_bf16 v[20:23], a[248:251], v[60:63], v[20:23]
    s_waitcnt lgkmcnt(0)
    buffer_load_dwordx4 v126, s[24:27], s56 offen nt lds
    v_and_b32 v120, 0xffff0000, v116
    v_mfma_f32_16x16x32_bf16 v[20:23], a[252:255], v[56:59], v[20:23]
    v_exp_f32 v109, v109
    v_mfma_f32_16x16x32_bf16 v[20:23], v[224:227], v[64:67], v[20:23]
    v_exp_f32 v110, v110
    v_mfma_f32_16x16x32_bf16 v[20:23], v[228:231], v[80:83], v[20:23]
    s_mov_b32 s53, s47
    v_exp_f32 v111, v111
    v_cvt_pk_bf16_f32 v98, v108, v109
    v_cvt_pk_bf16_f32 v99, v110, v111
    v_exp_f32 v104, v104
    v_exp_f32 v105, v105
    v_exp_f32 v106, v106
    v_exp_f32 v107, v107
    v_cvt_pk_bf16_f32 v168, v104, v105
    v_cvt_pk_bf16_f32 v169, v106, v107
    v_exp_f32 v88, v88
    v_lshlrev_b32 v116, 16, v116
    v_cvt_pk_bf16_f32 v170, v88, 0
    v_mfma_f32_16x16x32_bf16 v[112:115], v[220:223], v[96:99], 0
    s_add_u32 m0, s67, 3072
    buffer_store_dwordx4 v[100:103], v126, s[28:31], s60 offen sc1
    v_add_f32 v116, v116, v120
    v_add_f32 v116, v116, v211
    v_max3_f32 v120, v48, v49, v50
    v_max3_f32 v120, v120, v51, v68
    v_mfma_f32_16x16x32_bf16 v[112:115], v[220:223], v[168:171], v[112:115]
    s_mov_b32 s47, s46
    v_mov_b32_dpp v91, v116 quad_perm:[0,1,2,3] row_mask:0x8 bank_mask:0xf
    v_mov_b32 v121, v91
    v_mfma_f32_16x16x32_bf16 v[108:111], v[0:3], v[96:99], 0
    s_mov_b32 s46, s45
    v_max_f32_dpp v121, v121, v121 row_ror:8 row_mask:0xf bank_mask:0xf
    v_max3_f32 v120, v120, v69, v70
    v_mfma_f32_16x16x32_bf16 v[108:111], v[164:167], v[168:171], v[108:111]
    s_mov_b32 s45, s44
    v_max_f32_dpp v121, v121, v121 row_ror:4 row_mask:0xf bank_mask:0xf
    v_max3_f32 v120, v120, v71, v52
    v_mfma_f32_16x16x32_bf16 v[104:107], v[8:11], v[96:99], 0
    s_mov_b32 s44, s53
    v_max_f32_dpp v121, v121, v121 row_ror:2 row_mask:0xf bank_mask:0xf
    v_max3_f32 v120, v120, v53, v54
    v_mfma_f32_16x16x32_bf16 v[104:107], v[160:163], v[168:171], v[104:107]
    s_sub_u32 s48, s44, s46
    v_max_f32_dpp v121, v121, v121 row_ror:1 row_mask:0xf bank_mask:0xf
    v_mov_b32 v84, v121
    v_mfma_f32_16x16x32_bf16 v[100:103], v[12:15], v[96:99], 0
    s_sub_u32 s49, s46, s45
    v_permlane32_swap_b32 v84, v121
    v_mfma_f32_16x16x32_bf16 v[100:103], v[156:159], v[168:171], v[100:103]
    v_max_f32 v121, v84, v121
    v_mov_b32 v84, v121
    v_rcp_f32 v112, v112
    v_max3_f32 v120, v120, v55, v93
    v_permlane16_swap_b32 v84, v121
    v_max_f32 v121, v84, v121
    v_sub_f32 v91, v91, v121
    v_exp_f32 v91, v91
    v_mul_f32 v108, v108, v112
    v_cvt_pk_bf16_f32 v91, v91, v91
    ds_write_b16 v123, v91 offset:64
    v_mul_f32 v109, v109, v112
    v_cvt_pk_bf16_f32 v88, v108, v109
    ds_read_b128 v[94:97], v132 offset:48
    v_mul_f32 v110, v110, v112
    v_mul_f32 v111, v111, v112
    v_cvt_pk_bf16_f32 v89, v110, v111
    ds_read_b128 v[108:111], v132 offset:64
    v_mfma_f32_16x16x32_bf16 v[114:117], v[232:235], v[72:75], 0
    v_mul_f32 v104, v104, v112
    v_mul_f32 v105, v105, v112
    v_mfma_f32_16x16x32_bf16 v[114:117], v[236:239], v[76:79], v[114:117]
    ds_write_b64 v135, v[88:89] offset:0
    v_mfma_f32_16x16x32_bf16 v[114:117], v[240:243], v[60:63], v[114:117]
    v_cvt_pk_bf16_f32 v90, v104, v105
    v_mul_f32 v106, v106, v112
    v_mfma_f32_16x16x32_bf16 v[114:117], v[244:247], v[56:59], v[114:117]
    v_mul_f32 v107, v107, v112
    v_cvt_pk_bf16_f32 v91, v106, v107
    v_mfma_f32_16x16x32_bf16 v[114:117], v[248:251], v[64:67], v[114:117]
    ds_write_b64 v135, v[90:91] offset:8
    v_mfma_f32_16x16x32_bf16 v[114:117], v[252:255], v[80:83], v[114:117]
    s_waitcnt lgkmcnt(3)
    v_mul_f32 v100, v100, v112
    v_mul_f32 v101, v101, v112
    v_cvt_pk_bf16_f32 v168, v100, v101
    v_mul_f32 v102, v102, v112
    v_mfma_f32_16x16x32_bf16 v[72:75], v[94:97], v[0:3], 0
    s_waitcnt lgkmcnt(2)
    v_mul_f32 v103, v103, v112
    v_cvt_pk_bf16_f32 v169, v102, v103
    v_mov_b32 v170, v120
    v_fma_f32 v92, v32, v32, s42
    v_mfma_f32_16x16x32_bf16 v[72:75], v[108:111], v[164:167], v[72:75]
    ds_write_b64 v134, v[168:169] offset:0
    v_mfma_f32_16x16x32_bf16 v[88:91], v[94:97], v[8:11], 0
    v_permlane32_swap_b32 v170, v120
    v_mfma_f32_16x16x32_bf16 v[88:91], v[108:111], v[160:163], v[88:91]
    v_max_f32 v120, v170, v120
    v_mov_b32 v170, v120
    v_mfma_f32_16x16x32_bf16 v[76:79], v[94:97], v[12:15], 0
    s_nop 0
    v_permlane16_swap_b32 v170, v120
    v_mfma_f32_16x16x32_bf16 v[76:79], v[108:111], v[156:159], v[76:79]
    ds_read_b128 v[60:63], v133 offset:3072
    v_max_f32 v120, v170, v120
    v_sub_f32 v48, v48, v120
    v_sub_f32 v49, v49, v120
    v_sub_f32 v50, v50, v120
    v_sub_f32 v51, v51, v120
    v_sub_f32 v68, v68, v120
    v_sub_f32 v69, v69, v120
    v_sub_f32 v70, v70, v120
    v_sub_f32 v71, v71, v120
    v_sub_f32 v52, v52, v120
    v_sub_f32 v53, v53, v120
    v_sub_f32 v54, v54, v120
    v_sub_f32 v55, v55, v120
    v_sub_f32 v93, v93, v120
    v_exp_f32 v48, v48
    v_exp_f32 v49, v49
    v_exp_f32 v50, v50
    v_exp_f32 v51, v51
    v_cvt_pk_bf16_f32 v56, v48, v49
    v_cvt_pk_bf16_f32 v57, v50, v51
    v_exp_f32 v68, v68
    v_exp_f32 v69, v69
    v_exp_f32 v70, v70
    v_exp_f32 v71, v71
    v_cvt_pk_bf16_f32 v58, v68, v69
    v_cvt_pk_bf16_f32 v59, v70, v71
    v_exp_f32 v52, v52
    v_exp_f32 v53, v53
    v_exp_f32 v54, v54
    v_exp_f32 v55, v55
    v_cvt_pk_bf16_f32 v168, v52, v53
    v_cvt_pk_bf16_f32 v169, v54, v55
    v_exp_f32 v93, v93
    v_mov_b32_dpp v75, v91 quad_perm:[0,1,2,3] row_mask:0x2 bank_mask:0xf
    v_cvt_pk_bf16_f32 v170, v93, 0
    v_mfma_f32_16x16x32_bf16 v[88:91], v[220:223], v[56:59], 0
    s_waitcnt lgkmcnt(0)
    buffer_load_dwordx4 v125, s[24:27], s56 offen nt lds
    ds_read_b128 v[64:67], v137 offset:3072
    v_mfma_f32_16x16x32_bf16 v[88:91], v[220:223], v[168:171], v[88:91]
    v_mov_b32_dpp v75, v79 quad_perm:[0,1,2,3] row_mask:0x4 bank_mask:0xf
    v_cvt_pk_bf16_f32 v75, v75, v75
    v_mfma_f32_16x16x32_bf16 v[76:79], v[0:3], v[56:59], 0
    ds_write_b16 v131, v75
    v_mfma_f32_16x16x32_bf16 v[76:79], v[164:167], v[168:171], v[76:79]
    ds_read_b128 v[72:75], v136 offset:3072
    v_fmac_f32 v92, v33, v33
    v_mfma_f32_16x16x32_bf16 v[80:83], v[8:11], v[56:59], 0
    ds_read_b128 v[48:51], v137 offset:3200
    v_fmac_f32 v92, v34, v34
    v_mfma_f32_16x16x32_bf16 v[80:83], v[160:163], v[168:171], v[80:83]
    ds_read_b128 v[68:71], v136 offset:3200
    v_fmac_f32 v92, v35, v35
    v_mfma_f32_16x16x32_bf16 v[52:55], v[12:15], v[56:59], 0
    ds_read_b128 v[56:59], v137 offset:3328
    v_add_u32 v137, s48, v137
    v_mfma_f32_16x16x32_bf16 v[52:55], v[156:159], v[168:171], v[52:55]
    buffer_store_dwordx4 v[60:63], v125, s[28:31], s60 offen sc1
    ds_read_b128 v[94:97], v136 offset:3328
    v_rcp_f32 v88, v88
    v_add_u32 v136, s48, v136
    v_mfma_f32_16x16x32_f16 v[60:63], v[16:19], v[44:47], v[180:183]
    s_add_u32 m0, s67, 4096
    ds_read_b128 v[16:19], v133 offset:4096
    v_mul_f32 v76, v76, v88
    v_mfma_f32_16x16x32_f16 v[60:63], v[152:155], v[138:141], v[60:63]
    s_cmp_lg_u32 s5, -1
    v_mul_f32 v77, v77, v88
    v_cvt_pk_bf16_f32 v76, v76, v77
    v_mfma_f32_16x16x32_f16 v[152:155], v[36:39], v[44:47], v[176:179]
    v_mul_f32 v78, v78, v88
    v_mul_f32 v79, v79, v88
    v_mfma_f32_16x16x32_f16 v[152:155], v[146:149], v[138:141], v[152:155]
    v_cvt_pk_bf16_f32 v77, v78, v79
    v_mul_f32 v80, v80, v88
    v_mfma_f32_16x16x32_f16 v[36:39], v[40:43], v[44:47], v[172:175]
    ds_write_b64 v135, v[76:77] offset:1536
    v_mfma_f32_16x16x32_f16 v[36:39], v[140:143], v[138:141], v[36:39]
    s_waitcnt lgkmcnt(4)
    v_mul_f32 v81, v81, v88
    v_cvt_pk_bf16_f32 v78, v80, v81
    v_mfma_f32_16x16x32_bf16 v[40:43], a[216:219], v[64:67], 0
    v_mul_f32 v82, v82, v88
    v_mul_f32 v83, v83, v88
    v_mfma_f32_16x16x32_bf16 v[40:43], a[220:223], v[72:75], v[40:43]
    v_cvt_pk_bf16_f32 v79, v82, v83
    v_mul_f32 v52, v52, v88
    v_mfma_f32_16x16x32_bf16 v[40:43], a[224:227], v[48:51], v[40:43]
    ds_write_b64 v135, v[78:79] offset:1544
    v_mfma_f32_16x16x32_bf16 v[40:43], a[228:231], v[68:71], v[40:43]
    s_waitcnt lgkmcnt(2)
    buffer_load_dwordx4 v124, s[24:27], s56 offen nt lds
    v_mul_f32 v53, v53, v88
    v_mfma_f32_16x16x32_bf16 v[40:43], a[232:235], v[56:59], v[40:43]
    v_cvt_pk_bf16_f32 v168, v52, v53
    v_mul_f32 v54, v54, v88
    v_mfma_f32_16x16x32_bf16 v[40:43], a[236:239], v[94:97], v[40:43]
    v_mul_f32 v55, v55, v88
    v_cvt_pk_bf16_f32 v169, v54, v55
    v_mfma_f32_16x16x32_bf16 v[140:143], a[240:243], v[64:67], 0
    ds_write_b64 v134, v[168:169] offset:1536
    v_mfma_f32_16x16x32_bf16 v[140:143], a[244:247], v[72:75], v[140:143]
    v_max3_f32 v168, v60, v61, v62
    v_max3_f32 v168, v168, v63, v152
    v_mfma_f32_16x16x32_bf16 v[140:143], a[248:251], v[48:51], v[140:143]
    v_max3_f32 v168, v168, v153, v154
    v_max3_f32 v168, v168, v155, v36
    v_mfma_f32_16x16x32_bf16 v[140:143], a[252:255], v[68:71], v[140:143]
    v_max3_f32 v168, v168, v37, v38
    v_max3_f32 v168, v168, v39, v86
    v_mfma_f32_16x16x32_bf16 v[140:143], v[224:227], v[56:59], v[140:143]
    buffer_store_dwordx4 v[16:19], v124, s[28:31], s60 offen sc1
    v_mov_b32 v169, v168
    v_fmac_f32 v92, v4, v4
    v_fmac_f32 v92, v5, v5
    v_fmac_f32 v92, v6, v6
    v_mfma_f32_16x16x32_bf16 v[140:143], v[228:231], v[94:97], v[140:143]
    ds_read_b128 v[16:19], v137 offset:0
    v_fmac_f32 v92, v7, v7
    v_mfma_f32_16x16x32_bf16 v[44:47], v[232:235], v[64:67], 0
    ds_read_b128 v[146:149], v136 offset:0
    v_fmac_f32 v92, v24, v24
    v_mfma_f32_16x16x32_bf16 v[44:47], v[236:239], v[72:75], v[44:47]
    ds_read_b128 v[72:75], v137 offset:128
    v_fmac_f32 v92, v25, v25
    v_mfma_f32_16x16x32_bf16 v[44:47], v[240:243], v[48:51], v[44:47]
    ds_read_b128 v[88:91], v136 offset:128
    v_fmac_f32 v92, v26, v26
    v_mfma_f32_16x16x32_bf16 v[44:47], v[244:247], v[68:71], v[44:47]
    ds_read_b128 v[76:79], v137 offset:256
    v_fmac_f32 v92, v27, v27
    v_mfma_f32_16x16x32_bf16 v[44:47], v[248:251], v[56:59], v[44:47]
    ds_read_b128 v[56:59], v136 offset:256
    v_fma_f32 v93, v28, v28, s42
    v_mfma_f32_16x16x32_bf16 v[44:47], v[252:255], v[94:97], v[44:47]
    v_permlane32_swap_b32 v169, v168
    v_max_f32 v168, v169, v168
    v_mov_b32 v169, v168
    v_fmac_f32 v93, v29, v29
    v_fmac_f32 v93, v30, v30
    v_permlane16_swap_b32 v169, v168
    v_max_f32 v168, v169, v168
    v_sub_f32 v60, v60, v168
    v_sub_f32 v61, v61, v168
    v_sub_f32 v62, v62, v168
    v_sub_f32 v63, v63, v168
    v_sub_f32 v152, v152, v168
    v_sub_f32 v153, v153, v168
    v_sub_f32 v154, v154, v168
    v_sub_f32 v155, v155, v168
    v_sub_f32 v36, v36, v168
    v_sub_f32 v37, v37, v168
    v_sub_f32 v38, v38, v168
    v_sub_f32 v39, v39, v168
    v_sub_f32 v86, v86, v168
    v_exp_f32 v60, v60
    v_exp_f32 v61, v61
    v_exp_f32 v62, v62
    v_exp_f32 v63, v63
    v_cvt_pk_bf16_f32 v60, v60, v61
    v_cvt_pk_bf16_f32 v61, v62, v63
    v_exp_f32 v152, v152
    v_exp_f32 v153, v153
    v_exp_f32 v154, v154
    v_exp_f32 v155, v155
    v_cvt_pk_bf16_f32 v62, v152, v153
    v_cvt_pk_bf16_f32 v63, v154, v155
    v_exp_f32 v36, v36
    v_exp_f32 v37, v37
    v_exp_f32 v38, v38
    v_exp_f32 v39, v39
    v_cvt_pk_bf16_f32 v168, v36, v37
    v_cvt_pk_bf16_f32 v169, v38, v39
    v_exp_f32 v86, v86
    v_fmac_f32 v93, v31, v31
    v_cvt_pk_bf16_f32 v170, v86, 0
    v_mfma_f32_16x16x32_bf16 v[152:155], v[220:223], v[60:63], 0
    v_fmac_f32 v93, v20, v20
    v_fmac_f32 v93, v21, v21
    v_mfma_f32_16x16x32_bf16 v[152:155], v[220:223], v[168:171], v[152:155]
    v_fmac_f32 v93, v22, v22
    v_fmac_f32 v93, v23, v23
    v_mfma_f32_16x16x32_bf16 v[36:39], v[0:3], v[60:63], 0
    s_nop 0
    v_fmac_f32 v93, v114, v114
    v_fmac_f32 v93, v115, v115
    v_mfma_f32_16x16x32_bf16 v[36:39], v[164:167], v[168:171], v[36:39]
    s_nop 0
    v_rcp_f32 v152, v152
    v_mfma_f32_16x16x32_bf16 v[0:3], v[8:11], v[60:63], 0
    s_nop 0
    v_fmac_f32 v93, v116, v116
    v_fmac_f32 v93, v117, v117
    v_mfma_f32_16x16x32_bf16 v[0:3], v[160:163], v[168:171], v[0:3]
    s_nop 0
    v_mul_f32 v36, v36, v152
    v_mul_f32 v37, v37, v152
    v_mfma_f32_16x16x32_bf16 v[8:11], v[12:15], v[60:63], 0
    v_cvt_pk_bf16_f32 v12, v36, v37
    v_mul_f32 v38, v38, v152
    v_mfma_f32_16x16x32_bf16 v[8:11], v[156:159], v[168:171], v[8:11]
    s_waitcnt lgkmcnt(0)
    v_mul_f32 v39, v39, v152
    v_cvt_pk_bf16_f32 v13, v38, v39
    v_mfma_f32_16x16x32_bf16 v[36:39], a[0:3], v[16:19], 0
    s_cbranch_scc1 L_loopS0
    ds_write_b64 v135, v[12:13] offset:3072
    v_mul_f32 v0, v0, v152
    v_mul_f32 v1, v1, v152
    v_cvt_pk_bf16_f32 v14, v0, v1
    v_mul_f32 v2, v2, v152
    v_mul_f32 v3, v3, v152
    v_cvt_pk_bf16_f32 v15, v2, v3
    v_mul_f32 v8, v8, v152
    v_mul_f32 v9, v9, v152
    v_cvt_pk_bf16_f32 v8, v8, v9
    v_mul_f32 v10, v10, v152
    v_mul_f32 v11, v11, v152
    v_cvt_pk_bf16_f32 v9, v10, v11
    s_mov_b32 s30, 100270464
    s_mul_i32 s89, s68, 7168
    ds_write_b64 v135, v[14:15] offset:3080
    v_fma_f32 v113, v40, v40, s42
    s_add_u32 s89, s89, 135168
    s_movk_i32 s90, 112
    ds_write_b64 v134, v[8:9] offset:3072
    v_fmac_f32 v113, v41, v41
    v_fmac_f32 v113, v42, v42
    v_fmac_f32 v113, v43, v43
    v_fmac_f32 v113, v140, v140
    v_fmac_f32 v113, v141, v141
    v_fmac_f32 v113, v142, v142
    v_fmac_f32 v113, v143, v143
    v_fmac_f32 v113, v44, v44
    v_fmac_f32 v113, v45, v45
    v_fmac_f32 v113, v46, v46
    v_fmac_f32 v113, v47, v47
    v_cvt_pk_bf16_f32 v112, v92, v93
    v_cvt_pk_bf16_f32 v113, v113, v122
    s_lshr_b32 s91, s64, 16
    s_sub_u32 s84, s45, s44
    ds_write_b64 v130, v[112:113]
    v_mbcnt_lo_u32_b32 v131, -1, 0
    v_mbcnt_hi_u32_b32 v131, -1, v131
    v_and_b32 v132, 15, v131
    v_lshrrev_b32 v131, 4, v131
    v_mul_u32_u24 v18, 1792, v131
    v_add_u32 v18, s89, v18
    v_mad_u32_u24 v131, v132, s90, v18
    v_lshrrev_b32 v112, v132, s64
    v_and_b32 v112, 1, v112
    v_cmp_eq_u32 vcc, 1, v112
    v_mad_u32_u24 v48, v132, s90, v18
    v_lshrrev_b32 v19, v132, s91
    v_cndmask_b32 v131, v18, v131, vcc
    s_sub_u32 s85, s46, s45
    s_sub_u32 s86, s44, s45
    ds_read_b128 v[56:59], v131 offset:64
    ds_read_b128 v[36:39], v131 offset:80
    v_and_b32 v19, 1, v19
    v_subrev_u32 v48, 28672, v48
    s_sub_u32 s93, s44, s47
    s_sub_u32 s94, s45, s47
    ds_read_b128 v[12:15], v131
    s_waitcnt lgkmcnt(3)
    s_barrier
    ds_read_b64 v[16:17], v131 offset:16
    ds_read_b128 v[52:55], v129 offset:0
    ds_read_b128 v[8:11], v129 offset:1024
    v_cmp_eq_u32 vcc, 1, v19
    v_add_u32 v132, s84, v137
    v_add_u32 v131, s84, v136
    v_cndmask_b32 v48, v18, v48, vcc
    s_sub_u32 s95, s46, s47
    s_waitcnt lgkmcnt(5)
    v_mfma_f32_16x16x32_bf16 v[0:3], v[220:223], v[56:59], 0
    s_waitcnt lgkmcnt(4)
    s_lshl_b32 s92, s68, 10
    ds_read_b128 a[24:27], v132 offset:1536
    ds_read_b128 a[32:35], v132 offset:1664
    v_mfma_f32_16x16x32_bf16 v[0:3], v[220:223], v[36:39], v[0:3]
    s_waitcnt lgkmcnt(5)
    ds_read_b128 a[40:43], v132 offset:1792
    v_lshlrev_b32 v113, 16, v12
    v_and_b32 v12, 0xffff0000, v12
    v_lshlrev_b32 v112, 16, v13
    v_and_b32 v13, 0xffff0000, v13
    v_lshlrev_b32 v19, 16, v14
    v_and_b32 v14, 0xffff0000, v14
    v_rcp_f32 v0, v0
    v_lshlrev_b32 v18, 16, v15
    v_mul_f32 v113, v113, v0
    s_waitcnt lgkmcnt(4)
    v_mfma_f32_16x16x32_bf16 v[36:39], v[216:219], v[52:55], 0
    s_waitcnt lgkmcnt(3)
    ds_read_b128 a[28:31], v131 offset:1536
    ds_read_b128 a[36:39], v131 offset:1664
    v_mfma_f32_16x16x32_bf16 v[36:39], v[216:219], v[8:11], v[36:39]
    s_waitcnt lgkmcnt(4)
    ds_read_b128 a[44:47], v131 offset:1792
    v_mul_f32 v12, v12, v0
    v_cvt_pk_bf16_f32 v12, v113, v12
    v_mul_f32 v112, v112, v0
    v_mfma_f32_16x16x32_bf16 v[52:55], a[216:219], a[24:27], 0
    v_mul_f32 v13, v13, v0
    v_cvt_pk_bf16_f32 v13, v112, v13
    v_mul_f32 v19, v19, v0
    v_mul_f32 v14, v14, v0
    v_cvt_pk_bf16_f32 v14, v19, v14
    v_and_b32 v15, 0xffff0000, v15
    v_mul_f32 v18, v18, v0
    v_mul_f32 v15, v15, v0
    v_cvt_pk_bf16_f32 v15, v18, v15
    v_lshlrev_b32 v39, 16, v16
    v_and_b32 v16, 0xffff0000, v16
    v_mul_f32 v39, v39, v0
    v_mul_f32 v16, v16, v0
    v_cvt_pk_bf16_f32 v138, v39, v16
    v_lshlrev_b32 v39, 16, v17
    s_waitcnt lgkmcnt(2)
    v_mfma_f32_16x16x32_bf16 v[52:55], a[220:223], a[28:31], v[52:55]
    ds_read_b128 a[0:3], v132 offset:0
    ds_read_b128 a[4:7], v131 offset:0
    v_mfma_f32_16x16x32_bf16 v[52:55], a[224:227], a[32:35], v[52:55]
    s_waitcnt lgkmcnt(3)
    ds_read_b128 a[8:11], v132 offset:128
    v_and_b32 v17, 0xffff0000, v17
    v_mfma_f32_16x16x32_bf16 v[52:55], a[228:231], a[36:39], v[52:55]
    ds_read_b128 a[12:15], v131 offset:128
    v_mul_f32 v39, v39, v0
    v_mfma_f32_16x16x32_bf16 v[52:55], a[232:235], a[40:43], v[52:55]
    s_waitcnt lgkmcnt(4)
    ds_read_b128 a[16:19], v132 offset:256
    v_mul_f32 v17, v17, v0
    v_mfma_f32_16x16x32_bf16 v[52:55], a[236:239], a[44:47], v[52:55]
    ds_read_b128 a[20:23], v131 offset:256
    v_cvt_pk_bf16_f32 v139, v39, v17
    v_mfma_f32_16x16x32_bf16 v[16:19], a[240:243], a[24:27], 0
    v_rsq_f32 v36, v36
    v_mfma_f32_16x16x32_bf16 v[16:19], a[244:247], a[28:31], v[16:19]
    v_mul_f32 v36, s43, v36
    v_mul_f32 v32, v32, v36
    v_mfma_f32_16x16x32_bf16 v[16:19], a[248:251], a[32:35], v[16:19]
    v_mul_f32 v33, v33, v36
    v_cvt_pk_bf16_f32 v0, v32, v33
    v_mfma_f32_16x16x32_bf16 v[16:19], a[252:255], a[36:39], v[16:19]
    v_mul_f32 v34, v34, v36
    v_mul_f32 v35, v35, v36
    v_mfma_f32_16x16x32_bf16 v[16:19], v[224:227], a[40:43], v[16:19]
    v_cvt_pk_bf16_f32 v1, v34, v35
    v_mul_f32 v4, v4, v36
    v_mfma_f32_16x16x32_bf16 v[16:19], v[228:231], a[44:47], v[16:19]
    v_mul_f32 v5, v5, v36
    v_cvt_pk_bf16_f32 v2, v4, v5
    v_mfma_f32_16x16x32_bf16 v[8:11], v[232:235], a[24:27], 0
    v_mul_f32 v6, v6, v36
    v_mul_f32 v7, v7, v36
    v_mfma_f32_16x16x32_bf16 v[8:11], v[236:239], a[28:31], v[8:11]
    v_cvt_pk_bf16_f32 v3, v6, v7
    v_mul_f32 v24, v24, v36
    v_mfma_f32_16x16x32_bf16 v[8:11], v[240:243], a[32:35], v[8:11]
    v_mul_f32 v25, v25, v36
    v_cvt_pk_bf16_f32 v24, v24, v25
    v_mfma_f32_16x16x32_bf16 v[8:11], v[244:247], a[36:39], v[8:11]
    v_mul_f32 v26, v26, v36
    v_mul_f32 v27, v27, v36
    v_mfma_f32_16x16x32_bf16 v[8:11], v[248:251], a[40:43], v[8:11]
    v_cvt_pk_bf16_f32 v25, v26, v27
    v_add_u32 v119, s85, v135
    v_mfma_f32_16x16x32_bf16 v[8:11], v[252:255], a[44:47], v[8:11]
    s_waitcnt lgkmcnt(0)
    ds_write_b128 v119, v[0:3] offset:0
    v_mfma_f32_16x16x32_bf16 v[56:59], a[216:219], a[0:3], 0
    v_rsq_f32 v37, v37
    v_mfma_f32_16x16x32_bf16 v[56:59], a[220:223], a[4:7], v[56:59]
    ds_read_b128 a[48:51], v132 offset:3072
    v_mul_f32 v37, s43, v37
    v_mfma_f32_16x16x32_bf16 v[56:59], a[224:227], a[8:11], v[56:59]
    ds_read_b128 a[52:55], v131 offset:3072
    v_add_u32 v118, s85, v134
    v_mfma_f32_16x16x32_bf16 v[56:59], a[228:231], a[12:15], v[56:59]
    ds_write_b64 v118, v[24:25] offset:0
    v_mfma_f32_16x16x32_bf16 v[56:59], a[232:235], a[16:19], v[56:59]
    v_rsq_f32 v38, v38
    v_mfma_f32_16x16x32_bf16 v[56:59], a[236:239], a[20:23], v[56:59]
    ds_read_b128 a[56:59], v132 offset:3200
    ds_read_b128 a[60:63], v131 offset:3200
    v_mfma_f32_16x16x32_bf16 v[4:7], a[240:243], a[0:3], 0
    v_mul_f32 v38, s43, v38
    v_mul_f32 v40, v40, v38
    v_mfma_f32_16x16x32_bf16 v[4:7], a[244:247], a[4:7], v[4:7]
    ds_read_b128 a[64:67], v132 offset:3328
    ds_read_b128 a[68:71], v131 offset:3328
    v_mfma_f32_16x16x32_bf16 v[4:7], a[248:251], a[8:11], v[4:7]
    v_mul_f32 v41, v41, v38
    v_cvt_pk_bf16_f32 v24, v40, v41
    v_mfma_f32_16x16x32_bf16 v[4:7], a[252:255], a[12:15], v[4:7]
    v_mul_f32 v42, v42, v38
    v_mul_f32 v43, v43, v38
    v_mfma_f32_16x16x32_bf16 v[4:7], v[224:227], a[16:19], v[4:7]
    v_cvt_pk_bf16_f32 v25, v42, v43
    v_mul_f32 v140, v140, v38
    v_mfma_f32_16x16x32_bf16 v[4:7], v[228:231], a[20:23], v[4:7]
    v_mul_f32 v141, v141, v38
    v_cvt_pk_bf16_f32 v26, v140, v141
    v_mfma_f32_16x16x32_bf16 v[0:3], v[232:235], a[0:3], 0
    v_mul_f32 v142, v142, v38
    v_mul_f32 v143, v143, v38
    v_mfma_f32_16x16x32_bf16 v[0:3], v[236:239], a[4:7], v[0:3]
    v_cvt_pk_bf16_f32 v27, v142, v143
    v_mul_f32 v44, v44, v38
    v_mfma_f32_16x16x32_bf16 v[0:3], v[240:243], a[8:11], v[0:3]
    ds_write_b128 v119, v[24:27] offset:3072
    v_mfma_f32_16x16x32_bf16 v[0:3], v[244:247], a[12:15], v[0:3]
    v_mul_f32 v45, v45, v38
    v_cvt_pk_bf16_f32 v44, v44, v45
    v_mfma_f32_16x16x32_bf16 v[0:3], v[248:251], a[16:19], v[0:3]
    v_mul_f32 v46, v46, v38
    v_mul_f32 v47, v47, v38
    v_mfma_f32_16x16x32_bf16 v[0:3], v[252:255], a[20:23], v[0:3]
    s_waitcnt lgkmcnt(1)
    v_cvt_pk_bf16_f32 v45, v46, v47
    v_add_u32 v112, s86, v135
    v_mfma_f32_16x16x32_bf16 v[32:35], a[216:219], a[48:51], 0
    ds_write_b64 v118, v[44:45] offset:3072
    v_mfma_f32_16x16x32_bf16 v[32:35], a[220:223], a[52:55], v[32:35]
    ds_write_b128 v112, v[12:15] offset:0
    v_mfma_f32_16x16x32_bf16 v[32:35], a[224:227], a[56:59], v[32:35]
    v_add_u32 v132, s86, v134
    v_add_u32 v131, s93, v133
    v_mfma_f32_16x16x32_bf16 v[32:35], a[228:231], a[60:63], v[32:35]
    v_add_u32 v113, s94, v133
    v_add_u32 v51, s95, v133
    v_mfma_f32_16x16x32_bf16 v[32:35], a[232:235], a[64:67], v[32:35]
    ds_write_b64 v132, v[138:139] offset:0
    v_mfma_f32_16x16x32_bf16 v[32:35], a[236:239], a[68:71], v[32:35]
    ds_read_b128 v[64:67], v48 offset:64
    v_fma_f32 v50, v56, v56, s42
    v_mfma_f32_16x16x32_bf16 v[40:43], a[240:243], a[48:51], 0
    ds_read_b128 v[60:63], v48 offset:80
    v_fmac_f32 v50, v57, v57
    v_mfma_f32_16x16x32_bf16 v[40:43], a[244:247], a[52:55], v[40:43]
    ds_read_b128 v[44:47], v48
    v_fmac_f32 v50, v58, v58
    v_mfma_f32_16x16x32_bf16 v[40:43], a[248:251], a[56:59], v[40:43]
    ds_read_b64 v[48:49], v48 offset:16
    v_fmac_f32 v50, v59, v59
    v_mfma_f32_16x16x32_bf16 v[40:43], a[252:255], a[60:63], v[40:43]
    v_fmac_f32 v50, v4, v4
    v_fmac_f32 v50, v5, v5
    v_mfma_f32_16x16x32_bf16 v[40:43], v[224:227], a[64:67], v[40:43]
    v_fmac_f32 v50, v6, v6
    v_fmac_f32 v50, v7, v7
    v_mfma_f32_16x16x32_bf16 v[40:43], v[228:231], a[68:71], v[40:43]
    v_fmac_f32 v50, v0, v0
    v_fmac_f32 v50, v1, v1
    v_mfma_f32_16x16x32_bf16 v[12:15], v[232:235], a[48:51], 0
    v_fmac_f32 v50, v2, v2
    v_fmac_f32 v50, v3, v3
    v_mfma_f32_16x16x32_bf16 v[12:15], v[236:239], a[52:55], v[12:15]
    v_mul_f32 v28, v28, v37
    v_mul_f32 v29, v29, v37
    v_mfma_f32_16x16x32_bf16 v[12:15], v[240:243], a[56:59], v[12:15]
    v_cvt_pk_bf16_f32 v28, v28, v29
    v_mul_f32 v30, v30, v37
    v_mfma_f32_16x16x32_bf16 v[12:15], v[244:247], a[60:63], v[12:15]
    v_mul_f32 v31, v31, v37
    v_cvt_pk_bf16_f32 v29, v30, v31
    v_mfma_f32_16x16x32_bf16 v[12:15], v[248:251], a[64:67], v[12:15]
    v_mul_f32 v20, v20, v37
    v_mul_f32 v21, v21, v37
    v_mfma_f32_16x16x32_bf16 v[12:15], v[252:255], a[68:71], v[12:15]
    s_waitcnt lgkmcnt(0)
    v_cvt_pk_bf16_f32 v30, v20, v21
    v_mul_f32 v22, v22, v37
    v_mfma_f32_16x16x32_bf16 v[24:27], v[220:223], v[64:67], 0
    v_mul_f32 v23, v23, v37
    v_cvt_pk_bf16_f32 v31, v22, v23
    v_mfma_f32_16x16x32_bf16 v[24:27], v[220:223], v[60:63], v[24:27]
    ds_write_b128 v119, v[28:31] offset:1536
    v_mul_f32 v114, v114, v37
    v_mul_f32 v115, v115, v37
    v_cvt_pk_bf16_f32 v114, v114, v115
    v_mul_f32 v116, v116, v37
    v_mul_f32 v117, v117, v37
    v_cvt_pk_bf16_f32 v115, v116, v117
    ds_write_b64 v118, v[114:115] offset:1536
    v_fma_f32 v133, v32, v32, s42
    v_fmac_f32 v133, v33, v33
    v_fmac_f32 v133, v34, v34
    v_fmac_f32 v133, v35, v35
    v_fmac_f32 v133, v40, v40
    v_fmac_f32 v133, v41, v41
    v_fmac_f32 v133, v42, v42
    v_fmac_f32 v133, v43, v43
    v_fmac_f32 v133, v12, v12
    v_fmac_f32 v133, v13, v13
    v_fmac_f32 v133, v14, v14
    v_fmac_f32 v133, v15, v15
    v_cvt_pk_bf16_f32 v115, v133, v133
    v_fma_f32 v114, v52, v52, s42
    v_fmac_f32 v114, v53, v53
    v_fmac_f32 v114, v54, v54
    v_fmac_f32 v114, v55, v55
    v_fmac_f32 v114, v16, v16
    v_fmac_f32 v114, v17, v17
    v_fmac_f32 v114, v18, v18
    v_fmac_f32 v114, v19, v19
    v_fmac_f32 v114, v8, v8
    v_fmac_f32 v114, v9, v9
    v_fmac_f32 v114, v10, v10
    v_fmac_f32 v114, v11, v11
    v_cvt_pk_bf16_f32 v114, v50, v114
    ds_write_b64 v130, v[114:115] offset:2048
    v_rcp_f32 v24, v24
    v_lshlrev_b32 v50, 16, v44
    v_and_b32 v44, 0xffff0000, v44
    v_mul_f32 v50, v50, v24
    v_mul_f32 v44, v44, v24
    v_cvt_pk_bf16_f32 v20, v50, v44
    v_lshlrev_b32 v44, 16, v45
    v_and_b32 v45, 0xffff0000, v45
    v_mul_f32 v44, v44, v24
    v_mul_f32 v45, v45, v24
    v_cvt_pk_bf16_f32 v21, v44, v45
    v_lshlrev_b32 v50, 16, v46
    v_and_b32 v46, 0xffff0000, v46
    v_mul_f32 v50, v50, v24
    v_mul_f32 v46, v46, v24
    v_cvt_pk_bf16_f32 v22, v50, v46
    v_lshlrev_b32 v23, 16, v47
    v_and_b32 v47, 0xffff0000, v47
    v_mul_f32 v23, v23, v24
    v_mul_f32 v47, v47, v24
    v_cvt_pk_bf16_f32 v23, v23, v47
    v_lshlrev_b32 v50, 16, v48
    v_and_b32 v48, 0xffff0000, v48
    v_mul_f32 v50, v50, v24
    v_mul_f32 v48, v48, v24
    v_cvt_pk_bf16_f32 v138, v50, v48
    v_lshlrev_b32 v133, 16, v49
    v_and_b32 v49, 0xffff0000, v49
    v_mul_f32 v133, v133, v24
    v_mul_f32 v49, v49, v24
    v_cvt_pk_bf16_f32 v139, v133, v49
    s_waitcnt lgkmcnt(0)
    s_barrier
    ds_write_b128 v112, v[20:23] offset:1536
    v_mov_b32 v115, 0
    v_add_u32 v47, s92, v129
    ds_write_b64 v132, v[138:139] offset:1536
    ds_read_b128 v[24:27], v129 offset:2048
    ds_read_b128 v[20:23], v129 offset:3072
    ds_read_b128 a[144:147], v51 offset:0
    ds_read_b128 a[148:151], v51 offset:1024
    ds_read_b128 a[152:155], v51 offset:2048
    s_waitcnt lgkmcnt(5)
    s_barrier
    s_waitcnt lgkmcnt(4)
    v_mfma_f32_16x16x32_bf16 v[36:39], v[216:219], v[24:27], 0
    s_waitcnt lgkmcnt(3)
    ds_read_b128 a[72:75], v137 offset:0
    ds_read_b128 a[76:79], v136 offset:0
    v_mfma_f32_16x16x32_bf16 v[36:39], v[216:219], v[20:23], v[36:39]
    s_waitcnt lgkmcnt(4)
    ds_read_b128 a[80:83], v137 offset:128
    s_nop 0
    buffer_store_dwordx4 a[144:147], v128, s[28:31], s59 offen sc1
    s_nop 0
    ds_read_b128 a[84:87], v136 offset:128
    s_nop 1
    v_rsq_f32 v36, v36
    ds_read_b128 a[88:91], v137 offset:256
    ds_read_b128 a[92:95], v136 offset:256
    v_mul_f32 v36, s43, v36
    v_mul_f32 v56, v56, v36
    v_mul_f32 v57, v57, v36
    ds_read_b128 a[96:99], v137 offset:1536
    v_cvt_pk_bf16_f32 v48, v56, v57
    s_waitcnt lgkmcnt(6)
    v_mfma_f32_16x16x32_bf16 v[24:27], a[216:219], a[72:75], 0
    s_waitcnt lgkmcnt(5)
    ds_read_b128 a[100:103], v136 offset:1536
    ds_read_b128 a[104:107], v137 offset:1664
    v_mfma_f32_16x16x32_bf16 v[24:27], a[220:223], a[76:79], v[24:27]
    s_waitcnt lgkmcnt(6)
    buffer_store_dwordx4 a[148:151], v127, s[28:31], s59 offen sc1
    ds_read_b128 a[108:111], v136 offset:1664
    v_mul_f32 v58, v58, v36
    v_mul_f32 v59, v59, v36
    v_cvt_pk_bf16_f32 v49, v58, v59
    v_mfma_f32_16x16x32_bf16 v[24:27], a[224:227], a[80:83], v[24:27]
    s_waitcnt lgkmcnt(6)
    ds_read_b128 a[112:115], v137 offset:1792
    v_mul_f32 v4, v4, v36
    v_mfma_f32_16x16x32_bf16 v[24:27], a[228:231], a[84:87], v[24:27]
    s_waitcnt lgkmcnt(6)
    ds_read_b128 a[116:119], v136 offset:1792
    v_mul_f32 v5, v5, v36
    v_mfma_f32_16x16x32_bf16 v[24:27], a[232:235], a[88:91], v[24:27]
    s_waitcnt lgkmcnt(6)
    ds_read_b128 a[156:159], v51 offset:3072
    v_cvt_pk_bf16_f32 v50, v4, v5
    v_mfma_f32_16x16x32_bf16 v[24:27], a[236:239], a[92:95], v[24:27]
    ds_read_b128 a[160:163], v51 offset:4096
    v_mul_f32 v6, v6, v36
    v_mfma_f32_16x16x32_bf16 v[28:31], a[240:243], a[72:75], 0
    v_mul_f32 v7, v7, v36
    v_cvt_pk_bf16_f32 v51, v6, v7
    v_mfma_f32_16x16x32_bf16 v[28:31], a[244:247], a[76:79], v[28:31]
    s_nop 0
    buffer_store_dwordx4 a[152:155], v126, s[28:31], s59 offen sc1
    v_fma_f32 v133, v24, v24, s42
    v_fmac_f32 v133, v25, v25
    v_fmac_f32 v133, v26, v26
    v_fmac_f32 v133, v27, v27
    v_mfma_f32_16x16x32_bf16 v[28:31], a[248:251], a[80:83], v[28:31]
    v_mul_f32 v0, v0, v36
    v_mul_f32 v1, v1, v36
    v_mfma_f32_16x16x32_bf16 v[28:31], a[252:255], a[84:87], v[28:31]
    v_cvt_pk_bf16_f32 v0, v0, v1
    v_mul_f32 v2, v2, v36
    v_mfma_f32_16x16x32_bf16 v[28:31], v[224:227], a[88:91], v[28:31]
    v_rsq_f32 v37, v37
    v_mfma_f32_16x16x32_bf16 v[28:31], v[228:231], a[92:95], v[28:31]
    v_mul_f32 v3, v3, v36
    v_cvt_pk_bf16_f32 v1, v2, v3
    v_mfma_f32_16x16x32_bf16 v[20:23], v[232:235], a[72:75], 0
    v_rsq_f32 v38, v38
    v_mfma_f32_16x16x32_bf16 v[20:23], v[236:239], a[76:79], v[20:23]
    s_waitcnt lgkmcnt(0)
    s_nop 0
    buffer_store_dwordx4 a[156:159], v125, s[28:31], s59 offen sc1
    v_fmac_f32 v133, v28, v28
    v_fmac_f32 v133, v29, v29
    v_fmac_f32 v133, v30, v30
    v_fmac_f32 v133, v31, v31
    v_mfma_f32_16x16x32_bf16 v[20:23], v[240:243], a[80:83], v[20:23]
    v_mul_f32 v37, s43, v37
    v_mul_f32 v52, v52, v37
    v_mfma_f32_16x16x32_bf16 v[20:23], v[244:247], a[84:87], v[20:23]
    v_mul_f32 v53, v53, v37
    v_cvt_pk_bf16_f32 v44, v52, v53
    v_mfma_f32_16x16x32_bf16 v[20:23], v[248:251], a[88:91], v[20:23]
    v_mul_f32 v54, v54, v37
    v_mul_f32 v55, v55, v37
    v_mfma_f32_16x16x32_bf16 v[20:23], v[252:255], a[92:95], v[20:23]
    v_cvt_pk_bf16_f32 v45, v54, v55
    v_mul_f32 v16, v16, v37
    v_mfma_f32_16x16x32_bf16 v[4:7], a[216:219], a[96:99], 0
    v_mul_f32 v17, v17, v37
    v_cvt_pk_bf16_f32 v46, v16, v17
    v_mfma_f32_16x16x32_bf16 v[4:7], a[220:223], a[100:103], v[4:7]
    ds_write_b128 v135, v[48:51] offset:0
    v_mfma_f32_16x16x32_bf16 v[4:7], a[224:227], a[104:107], v[4:7]
    buffer_store_dwordx4 a[160:163], v124, s[28:31], s59 offen sc1
    v_fmac_f32 v133, v20, v20
    v_fmac_f32 v133, v21, v21
    v_fmac_f32 v133, v22, v22
    v_fmac_f32 v133, v23, v23
    v_mfma_f32_16x16x32_bf16 v[4:7], a[228:231], a[108:111], v[4:7]
    ds_write_b64 v134, v[0:1] offset:0
    v_mfma_f32_16x16x32_bf16 v[4:7], a[232:235], a[112:115], v[4:7]
    ds_read_b128 v[0:3], v47 offset:6144
    v_mul_f32 v18, v18, v37
    v_mfma_f32_16x16x32_bf16 v[4:7], a[236:239], a[116:119], v[4:7]
    v_mul_f32 v19, v19, v37
    v_cvt_pk_bf16_f32 v47, v18, v19
    v_mfma_f32_16x16x32_bf16 v[16:19], a[240:243], a[96:99], 0
    ds_write_b128 v135, v[44:47] offset:1536
    v_mfma_f32_16x16x32_bf16 v[16:19], a[244:247], a[100:103], v[16:19]
    v_mul_f32 v8, v8, v37
    v_mul_f32 v9, v9, v37
    v_mfma_f32_16x16x32_bf16 v[16:19], a[248:251], a[104:107], v[16:19]
    v_cvt_pk_bf16_f32 v36, v8, v9
    v_mul_f32 v10, v10, v37
    v_mfma_f32_16x16x32_bf16 v[16:19], a[252:255], a[108:111], v[16:19]
    v_mul_f32 v11, v11, v37
    v_cvt_pk_bf16_f32 v37, v10, v11
    v_mfma_f32_16x16x32_bf16 v[16:19], v[224:227], a[112:115], v[16:19]
    ds_write_b64 v134, v[36:37] offset:1536
    v_mfma_f32_16x16x32_bf16 v[16:19], v[228:231], a[116:119], v[16:19]
    v_mul_f32 v38, s43, v38
    v_mul_f32 v32, v32, v38
    v_mfma_f32_16x16x32_bf16 v[8:11], v[232:235], a[96:99], 0
    v_mul_f32 v33, v33, v38
    v_cvt_pk_bf16_f32 v32, v32, v33
    v_mfma_f32_16x16x32_bf16 v[8:11], v[236:239], a[100:103], v[8:11]
    v_mul_f32 v34, v34, v38
    v_mul_f32 v35, v35, v38
    v_mfma_f32_16x16x32_bf16 v[8:11], v[240:243], a[104:107], v[8:11]
    v_cvt_pk_bf16_f32 v33, v34, v35
    v_mul_f32 v40, v40, v38
    v_mfma_f32_16x16x32_bf16 v[8:11], v[244:247], a[108:111], v[8:11]
    v_mul_f32 v41, v41, v38
    v_cvt_pk_bf16_f32 v34, v40, v41
    v_mfma_f32_16x16x32_bf16 v[8:11], v[248:251], a[112:115], v[8:11]
    v_mul_f32 v42, v42, v38
    v_mul_f32 v43, v43, v38
    v_mfma_f32_16x16x32_bf16 v[8:11], v[252:255], a[116:119], v[8:11]
    v_cvt_pk_bf16_f32 v35, v42, v43
    v_mul_f32 v12, v12, v38
    v_mul_f32 v13, v13, v38
    v_cvt_pk_bf16_f32 v12, v12, v13
    v_mul_f32 v14, v14, v38
    v_mul_f32 v15, v15, v38
    v_cvt_pk_bf16_f32 v13, v14, v15
    ds_write_b128 v135, v[32:35] offset:3072
    v_fma_f32 v114, v4, v4, s42
    v_fmac_f32 v114, v5, v5
    v_fmac_f32 v114, v6, v6
    v_fmac_f32 v114, v7, v7
    ds_write_b64 v134, v[12:13] offset:3072
    v_fmac_f32 v114, v16, v16
    v_fmac_f32 v114, v17, v17
    v_fmac_f32 v114, v18, v18
    v_fmac_f32 v114, v19, v19
    v_fmac_f32 v114, v8, v8
    v_fmac_f32 v114, v9, v9
    v_fmac_f32 v114, v10, v10
    v_fmac_f32 v114, v11, v11
    v_cvt_pk_bf16_f32 v114, v133, v114
    ds_write_b64 v130, v[114:115] offset:4096
    s_waitcnt lgkmcnt(3)
    v_lshrrev_b32 v130, 0, v3
    v_lshrrev_b32 v130, v130, s64
    v_and_b32 v130, 1, v130
    v_cmp_eq_u32 vcc, 1, v130
    v_lshrrev_b32 v130, 8, v3
    v_lshrrev_b32 v130, v130, s64
    v_cndmask_b32 v0, 2.0, v0, vcc
    v_and_b32 v130, 1, v130
    s_waitcnt lgkmcnt(1)
    s_barrier
    ds_read_b128 a[164:167], v113 offset:0
    ds_read_b128 a[168:171], v113 offset:1024
    v_cmp_eq_u32 vcc, 1, v130
    v_lshrrev_b32 v3, 16, v3
    s_waitcnt lgkmcnt(2)
    s_barrier
    ds_read_b128 a[172:175], v113 offset:2048
    v_cndmask_b32 v1, 2.0, v1, vcc
    ds_read_b128 a[176:179], v113 offset:3072
    v_lshrrev_b32 v3, v3, s64
    ds_read_b128 a[180:183], v113 offset:4096
    v_and_b32 v3, 1, v3
    ds_read_b128 v[36:39], v129 offset:4096
    v_cmp_eq_u32 vcc, 1, v3
    ds_read_b128 v[32:35], v129 offset:5120
    s_nop 0
    v_cndmask_b32 v2, 2.0, v2, vcc
    s_waitcnt lgkmcnt(6)
    buffer_store_dwordx4 a[164:167], v128, s[28:31], s58 offen sc1
    s_waitcnt lgkmcnt(1)
    v_mfma_f32_16x16x32_bf16 v[12:15], v[216:219], v[36:39], 0
    s_waitcnt lgkmcnt(0)
    v_mfma_f32_16x16x32_bf16 v[12:15], v[216:219], v[32:35], v[12:15]
    s_nop 2
    buffer_store_dwordx4 a[168:171], v127, s[28:31], s58 offen sc1
    s_nop 3
    v_rsq_f32 v12, v12
    v_rsq_f32 v13, v13
    v_mul_f32 v12, s43, v12
    v_mul_f32 v24, v24, v12
    v_mul_f32 v25, v25, v12
    v_cvt_pk_bf16_f32 v24, v24, v25
    v_mul_f32 v26, v26, v12
    v_mul_f32 v27, v27, v12
    v_cvt_pk_bf16_f32 v25, v26, v27
    v_mul_f32 v28, v28, v12
    v_mul_f32 v29, v29, v12
    v_cvt_pk_bf16_f32 v26, v28, v29
    v_mul_f32 v30, v30, v12
    v_mul_f32 v31, v31, v12
    v_cvt_pk_bf16_f32 v27, v30, v31
    v_mul_f32 v20, v20, v12
    v_mul_f32 v21, v21, v12
    buffer_store_dwordx4 a[172:175], v126, s[28:31], s58 offen sc1
    ds_write_b128 v112, v[24:27] offset:0
    v_cvt_pk_bf16_f32 v14, v20, v21
    v_mul_f32 v22, v22, v12
    v_mul_f32 v23, v23, v12
    v_cvt_pk_bf16_f32 v15, v22, v23
    ds_write_b64 v132, v[14:15] offset:0
    v_mul_f32 v13, s43, v13
    v_mul_f32 v4, v4, v13
    v_mul_f32 v5, v5, v13
    v_cvt_pk_bf16_f32 v4, v4, v5
    v_mul_f32 v6, v6, v13
    v_mul_f32 v7, v7, v13
    v_cvt_pk_bf16_f32 v5, v6, v7
    v_mul_f32 v16, v16, v13
    v_mul_f32 v17, v17, v13
    buffer_store_dwordx4 a[176:179], v125, s[28:31], s58 offen sc1
    v_cvt_pk_bf16_f32 v6, v16, v17
    v_mul_f32 v18, v18, v13
    v_mul_f32 v19, v19, v13
    v_cvt_pk_bf16_f32 v7, v18, v19
    v_mul_f32 v8, v8, v13
    v_mul_f32 v9, v9, v13
    v_cvt_pk_bf16_f32 v126, v8, v9
    v_mul_f32 v10, v10, v13
    v_mul_f32 v11, v11, v13
    v_cvt_pk_bf16_f32 v127, v10, v11
    ds_write_b128 v112, v[4:7] offset:1536
    ds_write_b64 v132, v[126:127] offset:1536
    buffer_store_dwordx4 a[180:183], v124, s[28:31], s58 offen sc1
    s_waitcnt lgkmcnt(0)
    s_barrier
    ds_read_b128 a[184:187], v131 offset:0
    ds_read_b128 a[188:191], v131 offset:1024
    ds_read_b128 a[192:195], v131 offset:2048
    s_waitcnt lgkmcnt(2)
    buffer_store_dwordx4 a[184:187], v0, s[28:31], 0 offen sc1
    s_waitcnt lgkmcnt(0)
    buffer_store_dwordx4 a[188:191], v1, s[28:31], 0 offen sc1
    buffer_store_dwordx4 a[192:195], v2, s[28:31], 0 offen sc1
    s_branch L_fin
L_again:
    s_waitcnt vmcnt(0) lgkmcnt(0)
    s_nop 15
    s_barrier
    s_movk_i32 s2, 256
    s_branch L_top
L_bndS:
    s_movk_i32 s73, 20
    s_movk_i32 s71, 18
    s_movk_i32 s70, -20
    s_mov_b32 s74, 0
    s_bitcmp1_b32 s2, 2
    s_cbranch_scc1 L_bndcS
    s_sub_u32 s94, s2, 248
    s_mul_i32 s69, s94, 18
    s_mov_b32 s74, 2
    s_sub_u32 s93, s93, 1373568
    v_cmp_le_u32 vcc, 4, v73
    v_add_u32 v6, 98896896, v128
    v_subrev_u32 v7, 1373568, v128
    v_cndmask_b32 v128, v6, v7, vcc
    v_cmp_le_u32 vcc, 4, v156
    v_add_u32 v6, 98896896, v127
    v_subrev_u32 v7, 1373568, v127
    v_cndmask_b32 v127, v6, v7, vcc
    v_cmp_le_u32 vcc, 4, v4
    v_add_u32 v6, 98896896, v126
    v_subrev_u32 v7, 1373568, v126
    v_cndmask_b32 v126, v6, v7, vcc
    v_cmp_le_u32 vcc, 4, v18
    v_add_u32 v6, 98896896, v125
    v_subrev_u32 v7, 1373568, v125
    v_cndmask_b32 v125, v6, v7, vcc
    v_cmp_le_u32 vcc, 4, v11
    v_add_u32 v6, 98896896, v124
    v_subrev_u32 v7, 1373568, v124
    v_cndmask_b32 v124, v6, v7, vcc
    s_cmp_lt_u32 s2, 256
    s_cbranch_scc1 L_bndrS
L_bndcS:
    s_sub_u32 s94, s2, 252
    s_mul_i32 s69, s94, 20
    s_lshr_b32 s71, s94, 1
    s_sub_u32 s69, s69, s71
    s_and_b32 s94, s94, 1
    s_sub_u32 s71, 20, s94
    s_cmp_eq_u32 s2, 255
    s_cselect_b32 s71, 13, s71
    s_mov_b32 s62, 1373568
    s_add_u32 s74, s74, 1
    s_sub_u32 s93, s93, 2688
    v_mad_i32_i24 v6, v73, -7, v74
    v_cmp_le_u32 vcc, 4, v6
    v_add_u32 v6, 193536, v128
    v_subrev_u32 v7, 2688, v128
    v_cndmask_b32 v128, v6, v7, vcc
    v_mad_i32_i24 v6, v156, -7, v150
    v_cmp_le_u32 vcc, 4, v6
    v_add_u32 v6, 193536, v127
    v_subrev_u32 v7, 2688, v127
    v_cndmask_b32 v127, v6, v7, vcc
    v_mad_i32_i24 v6, v4, -7, v10
    v_cmp_le_u32 vcc, 4, v6
    v_add_u32 v6, 193536, v126
    v_subrev_u32 v7, 2688, v126
    v_cndmask_b32 v126, v6, v7, vcc
    v_mad_i32_i24 v6, v18, -7, v159
    v_cmp_le_u32 vcc, 4, v6
    v_add_u32 v6, 193536, v125
    v_subrev_u32 v7, 2688, v125
    v_cndmask_b32 v125, v6, v7, vcc
    v_mad_i32_i24 v6, v11, -7, v151
    v_cmp_le_u32 vcc, 4, v6
    v_add_u32 v6, 193536, v124
    v_subrev_u32 v7, 2688, v124
    v_cndmask_b32 v124, v6, v7, vcc
    s_cmp_eq_u32 s2, 256
    s_cselect_b32 s62, 0, s62
    s_cselect_b32 s69, 0, s69
    s_cselect_b32 s71, 2, s71
    s_branch L_bndrS
L_maskS:
    s_and_b32 s20, s74, 2
    s_and_b32 s21, s74, 1
    s_mov_b32 s22, 0xc31044fe
    v_lshrrev_b32 v161, 2, v149
    v_add_u32 v161, 0, v161
    v_mul_u32_u24 v148, 37, v161
    v_lshrrev_b32 v72, 8, v148
    v_mad_i32_i24 v72, v72, -7, v161
    v_lshrrev_b32 v148, 10, v148
    v_lshrrev_b32 v72, 2, v72
    v_mul_u32_u24 v148, s20, v148
    v_mad_u32_u24 v161, v72, s21, v148
    v_cvt_f32_u32 v161, v161
    v_lshrrev_b32 v164, 2, v149
    v_add_u32 v164, 4, v164
    v_mul_u32_u24 v148, 37, v164
    v_lshrrev_b32 v72, 8, v148
    v_mad_i32_i24 v72, v72, -7, v164
    v_lshrrev_b32 v148, 10, v148
    v_lshrrev_b32 v72, 2, v72
    v_mul_u32_u24 v148, s20, v148
    v_mad_u32_u24 v164, v72, s21, v148
    v_cvt_f32_u32 v164, v164
    v_lshrrev_b32 v75, 2, v149
    v_add_u32 v75, 8, v75
    v_mul_u32_u24 v148, 37, v75
    v_lshrrev_b32 v72, 8, v148
    v_mad_i32_i24 v72, v72, -7, v75
    v_lshrrev_b32 v148, 10, v148
    v_lshrrev_b32 v72, 2, v72
    v_mul_u32_u24 v148, s20, v148
    v_mad_u32_u24 v75, v72, s21, v148
    v_cvt_f32_u32 v75, v75
    v_mad_u32_u24 v73, v160, 12, 0
    v_mul_u32_u24 v148, 37, v73
    v_lshrrev_b32 v72, 8, v148
    v_mad_i32_i24 v72, v72, -7, v73
    v_lshrrev_b32 v148, 10, v148
    v_lshrrev_b32 v72, 2, v72
    v_mul_u32_u24 v148, s20, v148
    v_mad_u32_u24 v73, v72, s21, v148
    v_cvt_f32_u32 v73, v73
    v_sub_f32 v148, v161, v73
    v_mul_f32 v148, v148, v148 clamp
    v_fmac_f32 v204, s22, v148
    v_sub_f32 v148, v164, v73
    v_mul_f32 v148, v148, v148 clamp
    v_fmac_f32 v192, s22, v148
    v_sub_f32 v148, v75, v73
    v_mul_f32 v148, v148, v148 clamp
    v_fmac_f32 v180, s22, v148
    v_mad_u32_u24 v73, v160, 12, 1
    v_mul_u32_u24 v148, 37, v73
    v_lshrrev_b32 v72, 8, v148
    v_mad_i32_i24 v72, v72, -7, v73
    v_lshrrev_b32 v148, 10, v148
    v_lshrrev_b32 v72, 2, v72
    v_mul_u32_u24 v148, s20, v148
    v_mad_u32_u24 v73, v72, s21, v148
    v_cvt_f32_u32 v73, v73
    v_sub_f32 v148, v161, v73
    v_mul_f32 v148, v148, v148 clamp
    v_fmac_f32 v205, s22, v148
    v_sub_f32 v148, v164, v73
    v_mul_f32 v148, v148, v148 clamp
    v_fmac_f32 v193, s22, v148
    v_sub_f32 v148, v75, v73
    v_mul_f32 v148, v148, v148 clamp
    v_fmac_f32 v181, s22, v148
    v_mad_u32_u24 v73, v160, 12, 2
    v_mul_u32_u24 v148, 37, v73
    v_lshrrev_b32 v72, 8, v148
    v_mad_i32_i24 v72, v72, -7, v73
    v_lshrrev_b32 v148, 10, v148
    v_lshrrev_b32 v72, 2, v72
    v_mul_u32_u24 v148, s20, v148
    v_mad_u32_u24 v73, v72, s21, v148
    v_cvt_f32_u32 v73, v73
    v_sub_f32 v148, v161, v73
    v_mul_f32 v148, v148, v148 clamp
    v_fmac_f32 v206, s22, v148
    v_sub_f32 v148, v164, v73
    v_mul_f32 v148, v148, v148 clamp
    v_fmac_f32 v194, s22, v148
    v_sub_f32 v148, v75, v73
    v_mul_f32 v148, v148, v148 clamp
    v_fmac_f32 v182, s22, v148
    v_mad_u32_u24 v73, v160, 12, 3
    v_mul_u32_u24 v148, 37, v73
    v_lshrrev_b32 v72, 8, v148
    v_mad_i32_i24 v72, v72, -7, v73
    v_lshrrev_b32 v148, 10, v148
    v_lshrrev_b32 v72, 2, v72
    v_mul_u32_u24 v148, s20, v148
    v_mad_u32_u24 v73, v72, s21, v148
    v_cvt_f32_u32 v73, v73
    v_sub_f32 v148, v161, v73
    v_mul_f32 v148, v148, v148 clamp
    v_fmac_f32 v207, s22, v148
    v_sub_f32 v148, v164, v73
    v_mul_f32 v148, v148, v148 clamp
    v_fmac_f32 v195, s22, v148
    v_sub_f32 v148, v75, v73
    v_mul_f32 v148, v148, v148 clamp
    v_fmac_f32 v183, s22, v148
    v_mad_u32_u24 v73, v160, 12, 4
    v_mul_u32_u24 v148, 37, v73
    v_lshrrev_b32 v72, 8, v148
    v_mad_i32_i24 v72, v72, -7, v73
    v_lshrrev_b32 v148, 10, v148
    v_lshrrev_b32 v72, 2, v72
    v_mul_u32_u24 v148, s20, v148
    v_mad_u32_u24 v73, v72, s21, v148
    v_cvt_f32_u32 v73, v73
    v_sub_f32 v148, v161, v73
    v_mul_f32 v148, v148, v148 clamp
    v_fmac_f32 v200, s22, v148
    v_sub_f32 v148, v164, v73
    v_mul_f32 v148, v148, v148 clamp
    v_fmac_f32 v188, s22, v148
    v_sub_f32 v148, v75, v73
    v_mul_f32 v148, v148, v148 clamp
    v_fmac_f32 v176, s22, v148
    v_mad_u32_u24 v73, v160, 12, 5
    v_mul_u32_u24 v148, 37, v73
    v_lshrrev_b32 v72, 8, v148
    v_mad_i32_i24 v72, v72, -7, v73
    v_lshrrev_b32 v148, 10, v148
    v_lshrrev_b32 v72, 2, v72
    v_mul_u32_u24 v148, s20, v148
    v_mad_u32_u24 v73, v72, s21, v148
    v_cvt_f32_u32 v73, v73
    v_sub_f32 v148, v161, v73
    v_mul_f32 v148, v148, v148 clamp
    v_fmac_f32 v201, s22, v148
    v_sub_f32 v148, v164, v73
    v_mul_f32 v148, v148, v148 clamp
    v_fmac_f32 v189, s22, v148
    v_sub_f32 v148, v75, v73
    v_mul_f32 v148, v148, v148 clamp
    v_fmac_f32 v177, s22, v148
    v_mad_u32_u24 v73, v160, 12, 6
    v_mul_u32_u24 v148, 37, v73
    v_lshrrev_b32 v72, 8, v148
    v_mad_i32_i24 v72, v72, -7, v73
    v_lshrrev_b32 v148, 10, v148
    v_lshrrev_b32 v72, 2, v72
    v_mul_u32_u24 v148, s20, v148
    v_mad_u32_u24 v73, v72, s21, v148
    v_cvt_f32_u32 v73, v73
    v_sub_f32 v148, v161, v73
    v_mul_f32 v148, v148, v148 clamp
    v_fmac_f32 v202, s22, v148
    v_sub_f32 v148, v164, v73
    v_mul_f32 v148, v148, v148 clamp
    v_fmac_f32 v190, s22, v148
    v_sub_f32 v148, v75, v73
    v_mul_f32 v148, v148, v148 clamp
    v_fmac_f32 v178, s22, v148
    v_mad_u32_u24 v73, v160, 12, 7
    v_mul_u32_u24 v148, 37, v73
    v_lshrrev_b32 v72, 8, v148
    v_mad_i32_i24 v72, v72, -7, v73
    v_lshrrev_b32 v148, 10, v148
    v_lshrrev_b32 v72, 2, v72
    v_mul_u32_u24 v148, s20, v148
    v_mad_u32_u24 v73, v72, s21, v148
    v_cvt_f32_u32 v73, v73
    v_sub_f32 v148, v161, v73
    v_mul_f32 v148, v148, v148 clamp
    v_fmac_f32 v203, s22, v148
    v_sub_f32 v148, v164, v73
    v_mul_f32 v148, v148, v148 clamp
    v_fmac_f32 v191, s22, v148
    v_sub_f32 v148, v75, v73
    v_mul_f32 v148, v148, v148 clamp
    v_fmac_f32 v179, s22, v148
    v_mad_u32_u24 v73, v160, 12, 8
    v_mul_u32_u24 v148, 37, v73
    v_lshrrev_b32 v72, 8, v148
    v_mad_i32_i24 v72, v72, -7, v73
    v_lshrrev_b32 v148, 10, v148
    v_lshrrev_b32 v72, 2, v72
    v_mul_u32_u24 v148, s20, v148
    v_mad_u32_u24 v73, v72, s21, v148
    v_cvt_f32_u32 v73, v73
    v_sub_f32 v148, v161, v73
    v_mul_f32 v148, v148, v148 clamp
    v_fmac_f32 v196, s22, v148
    v_sub_f32 v148, v164, v73
    v_mul_f32 v148, v148, v148 clamp
    v_fmac_f32 v184, s22, v148
    v_sub_f32 v148, v75, v73
    v_mul_f32 v148, v148, v148 clamp
    v_fmac_f32 v172, s22, v148
    v_mad_u32_u24 v73, v160, 12, 9
    v_mul_u32_u24 v148, 37, v73
    v_lshrrev_b32 v72, 8, v148
    v_mad_i32_i24 v72, v72, -7, v73
    v_lshrrev_b32 v148, 10, v148
    v_lshrrev_b32 v72, 2, v72
    v_mul_u32_u24 v148, s20, v148
    v_mad_u32_u24 v73, v72, s21, v148
    v_cvt_f32_u32 v73, v73
    v_sub_f32 v148, v161, v73
    v_mul_f32 v148, v148, v148 clamp
    v_fmac_f32 v197, s22, v148
    v_sub_f32 v148, v164, v73
    v_mul_f32 v148, v148, v148 clamp
    v_fmac_f32 v185, s22, v148
    v_sub_f32 v148, v75, v73
    v_mul_f32 v148, v148, v148 clamp
    v_fmac_f32 v173, s22, v148
    v_mad_u32_u24 v73, v160, 12, 10
    v_mul_u32_u24 v148, 37, v73
    v_lshrrev_b32 v72, 8, v148
    v_mad_i32_i24 v72, v72, -7, v73
    v_lshrrev_b32 v148, 10, v148
    v_lshrrev_b32 v72, 2, v72
    v_mul_u32_u24 v148, s20, v148
    v_mad_u32_u24 v73, v72, s21, v148
    v_cvt_f32_u32 v73, v73
    v_sub_f32 v148, v161, v73
    v_mul_f32 v148, v148, v148 clamp
    v_fmac_f32 v198, s22, v148
    v_sub_f32 v148, v164, v73
    v_mul_f32 v148, v148, v148 clamp
    v_fmac_f32 v186, s22, v148
    v_sub_f32 v148, v75, v73
    v_mul_f32 v148, v148, v148 clamp
    v_fmac_f32 v174, s22, v148
    v_mad_u32_u24 v73, v160, 12, 11
    v_mul_u32_u24 v148, 37, v73
    v_lshrrev_b32 v72, 8, v148
    v_mad_i32_i24 v72, v72, -7, v73
    v_lshrrev_b32 v148, 10, v148
    v_lshrrev_b32 v72, 2, v72
    v_mul_u32_u24 v148, s20, v148
    v_mad_u32_u24 v73, v72, s21, v148
    v_cvt_f32_u32 v73, v73
    v_sub_f32 v148, v161, v73
    v_mul_f32 v148, v148, v148 clamp
    v_fmac_f32 v199, s22, v148
    v_sub_f32 v148, v164, v73
    v_mul_f32 v148, v148, v148 clamp
    v_fmac_f32 v187, s22, v148
    v_sub_f32 v148, v75, v73
    v_mul_f32 v148, v148, v148 clamp
    v_fmac_f32 v175, s22, v148
    v_cvt_f32_u32 v73, s74
    v_sub_f32 v148, v161, v73
    v_mul_f32 v148, v148, v148 clamp
    v_fmac_f32 v208, s22, v148
    v_sub_f32 v148, v164, v73
    v_mul_f32 v148, v148, v148 clamp
    v_fmac_f32 v209, s22, v148
    v_sub_f32 v148, v75, v73
    v_mul_f32 v148, v148, v148 clamp
    v_fmac_f32 v210, s22, v148
    v_lshrrev_b32 v161, 2, v149
    v_lshl_add_u32 v161, v160, 2, v161
    v_add_u32 v148, 1, v160
    v_lshrrev_b32 v148, 2, v148
    v_mad_u32_u24 v161, v148, 36, v161
    v_min_u32 v161, 48, v161
    v_mul_u32_u24 v148, 37, v161
    v_lshrrev_b32 v72, 8, v148
    v_mad_i32_i24 v72, v72, -7, v161
    v_lshrrev_b32 v148, 10, v148
    v_lshrrev_b32 v72, 2, v72
    v_mul_u32_u24 v148, s20, v148
    v_mad_u32_u24 v161, v72, s21, v148
    v_cvt_f32_u32 v161, v161
    v_sub_f32 v148, v161, v73
    v_mul_f32 v148, v148, v148 clamp
    v_fmac_f32 v211, s22, v148
    s_branch L_nomaskS
L_atomS0:
    v_mov_b32 v122, 0x800000
    buffer_atomic_add v122, v129, s[8:11], 0 offen sc0 sc1
    s_branch L_atomS0r
.section .rodata,"a"
.p2align 6
.amdhsa_kernel standalone__window_attn_swin_v2__vision_kernel
  .amdhsa_next_free_vgpr 512
  .amdhsa_next_free_sgpr 102
  .amdhsa_accum_offset 256
  .amdhsa_group_segment_fixed_size 0
  .amdhsa_kernarg_size 96
  .amdhsa_user_sgpr_count 2
  .amdhsa_user_sgpr_kernarg_segment_ptr 1
  .amdhsa_system_sgpr_workgroup_id_x 1
.end_amdhsa_kernel
```

```asm
; @launch grid=(256,1,1) block=(256,1,1) lds=163840
.amdgcn_target "amdgcn-amd-amdhsa--gfx950"
.text
.globl standalone__window_attn_swin_v2__vision_kernel
.p2align 8
.type standalone__window_attn_swin_v2__vision_kernel,@function
standalone__window_attn_swin_v2__vision_kernel:
    v_lshrrev_b32 v0, 6, v0
    s_cmp_ge_u32 s2, 256
    s_cbranch_scc1 L_end
    v_readfirstlane_b32 s68, v0
L_top:
    s_mov_b32 s64, 0
    s_nop 0
L_top2:
    v_mbcnt_lo_u32_b32 v97, -1, 0
    v_mbcnt_hi_u32_b32 v97, -1, v97
    s_load_dwordx16 s[4:19], s[0:1], 0
    s_load_dwordx4 s[20:23], s[0:1], 64
    s_load_dwordx2 s[38:39], s[0:1], 80
    s_load_dwordx2 s[76:77], s[0:1], 88
    s_add_u32 s84, s2, s64
    s_sub_u32 s84, s84, 248
    s_cmp_lt_u32 s84, 3
    s_cbranch_scc1 L_prod
    s_bfe_u32 s88, s2, 0x50003
    s_lshl2_add_u32 s88, s88, s68
    v_lshlrev_b32 v98, 7, v97
    s_getpc_b64 s[80:81]
    s_mul_i32 s84, s88, 320
    v_min_u32 v96, 256, v98
    v_add_u32 v96, s84, v96
    v_min_u32 v96, L_slow-standalone__window_attn_swin_v2__vision_kernel-256, v96
    s_mul_i32 s88, s88, 1728
    s_mov_b32 s34, 221184
    global_load_dword a255, v96, s[80:81]
    v_min_u32 v1, 1664, v98
    s_mov_b32 s35, 0x20000
    s_mov_b32 s78, 73728
    s_mov_b32 s79, 0x20000
    v_and_b32 v123, 15, v97
    v_lshrrev_b32 v3, 4, v97
    v_lshrrev_b32 v35, 2, v123
    v_and_b32 v34, 3, v123
    s_mul_i32 s87, s68, 192
    v_mad_u32_u24 v19, v123, 12, s87
    v_lshlrev_b32 v0, 1, v123
    v_lshlrev_b32 v2, 1, v35
    v_lshl_add_u32 v2, v3, 5, v2
    s_movk_i32 s86, 384
    s_mov_b32 s26, 100270464
    s_mov_b32 s27, 0x20000
    s_mov_b32 s30, 0
    s_mov_b32 s31, 0x20000
    s_lshr_b32 s93, s2, 3
    s_mul_i32 s93, s93, 3185912
    s_min_u32 s44, s93, 100270460
    s_add_u32 s93, s93, 2097152
    s_min_u32 s45, s93, 100270460
    s_add_u32 s93, s93, 2097152
    s_min_u32 s46, s93, 100270460
    s_waitcnt lgkmcnt(0)
    s_load_dword s44, s[4:5], s44
    s_load_dword s45, s[4:5], s45
    s_load_dword s46, s[4:5], s46
    s_mov_b32 s24, s4
    s_mov_b32 s25, s5
    s_mov_b32 s32, s6
    s_mov_b32 s33, s7
    buffer_load_dword a254, v1, s[32:35], s88 offen
    s_load_dwordx2 s[82:83], s[10:11], 0
    s_movk_i32 s18, 676
    s_mov_b32 s19, 0x20000
    buffer_load_dwordx3 v[24:26], v19, s[16:19], 0 offen
    s_mul_i32 s96, s68, 288
    s_and_b32 s97, s68, 1
    s_lshl_b32 s97, s97, 2
    s_mov_b32 s98, 193536
    s_mov_b32 s99, 589824
    global_load_ushort v16, v0, s[12:13]
    v_add_u32 v32, s96, v97
    v_mul_u32_u24 v1, 2731, v32
    v_mul_u32_u24 v96, 6242, v32
    v_lshrrev_b32 v1, 16, v1
    v_lshrrev_b32 v96, 20, v96
    s_lshr_b32 s94, s2, 3
    s_mul_i32 s70, s94, 167
    global_load_ushort v17, v0, s[12:13] offset:32
    v_and_or_b32 v27, v1, 3, s97
    v_xor_b32 v27, v32, v27
    v_lshl_add_u32 v128, v27, 4, s99
    v_mad_u32_u24 v128, v96, s98, v128
    v_add_u32 v33, 64, v32
    s_min_u32 s95, s94, 7
    s_add_u32 s70, s70, s95
    global_load_ushort v136, v2, s[14:15] offset:0
    v_mul_u32_u24 v105, 2731, v33
    v_mul_u32_u24 v0, 6242, v33
    v_lshrrev_b32 v105, 16, v105
    v_lshrrev_b32 v0, 20, v0
    v_and_or_b32 v18, v105, 3, s97
    s_and_b32 s95, s2, 7
    s_mul_i32 s95, s95, 20
    global_load_ushort v121, v2, s[14:15] offset:8
    v_xor_b32 v18, v33, v18
    v_lshl_add_u32 v127, v18, 4, s99
    v_mad_u32_u24 v127, v0, s98, v127
    v_add_u32 v122, 128, v32
    v_mul_u32_u24 v120, 2731, v122
    s_add_u32 s69, s70, s95
    s_add_u32 s70, s70, 140
    global_load_ushort v137, v2, s[14:15] offset:16
    v_mul_u32_u24 v104, 6242, v122
    v_lshrrev_b32 v120, 16, v120
    v_lshrrev_b32 v104, 20, v104
    v_and_or_b32 v33, v120, 3, s97
    v_xor_b32 v33, v122, v33
    s_movk_i32 s62, 2688
    s_movk_i32 s71, 20
    global_load_ushort v2, v2, s[14:15] offset:24
    v_lshl_add_u32 v126, v33, 4, s99
    v_mad_u32_u24 v126, v104, s98, v126
    v_add_u32 v106, 192, v32
    v_mul_u32_u24 v99, 2731, v106
    v_mul_u32_u24 v98, 6242, v106
    v_lshrrev_b32 v99, 16, v99
    v_lshrrev_b32 v98, 20, v98
    v_and_or_b32 v122, v99, 3, s97
    v_xor_b32 v122, v106, v122
    v_lshl_add_u32 v125, v122, 4, s99
    v_mad_u32_u24 v125, v98, s98, v125
    v_add_u32 v106, 256, v32
    v_mul_u32_u24 v32, 2731, v106
    v_mul_u32_u24 v122, 6242, v106
    v_lshrrev_b32 v32, 16, v32
    v_lshrrev_b32 v122, 20, v122
    v_and_or_b32 v124, v32, 3, s97
    v_xor_b32 v124, v106, v124
    v_lshl_add_u32 v124, v124, 4, s99
    v_mad_u32_u24 v124, v122, s98, v124
    s_cmp_lt_u32 s94, 7
    s_cselect_b32 s73, 28, 27
    s_mov_b32 s93, 1769472
    s_mul_i32 s54, s68, 5120
    s_cmp_ge_u32 s2, 248
    s_cbranch_scc1 L_bndF
L_bndrF:
    s_mov_b32 s63, 1180032
    s_mul_i32 s94, s69, 58255
    s_lshr_b32 s94, s94, 22
    s_mul_i32 s94, s94, s63
    s_mul_i32 s72, s69, s62
    s_add_u32 s72, s72, s94
    v_lshl_or_b32 v131, v97, 4, 2.0
    s_sub_u32 s94, s73, 1
    s_max_u32 s94, s94, 20
    s_mul_i32 s95, s68, -44
    s_movk_i32 s99, -24
    s_add_u32 m0, s54, 0
    v_and_b32 v32, -4, v120
    s_mul_i32 s85, s68, 96
    s_sub_u32 s100, s85, 1024
    buffer_load_dwordx4 v128, s[24:27], s72 offen nt lds
    s_add_u32 m0, s54, 1024
    v_mad_u32_u24 v0, v32, 3, v120
    v_add_u32 v0, s95, v0
    v_mad_i32_i24 v106, v120, s99, v33
    v_med3_u32 v32, v0, 20, s94
    v_add_u32 v32, s70, v32
    v_add_u32 v33, s69, v0
    s_sub_u32 s87, s85, 2048
    s_movk_i32 s91, 1152
    buffer_load_dwordx4 v127, s[24:27], s72 offen nt lds
    v_cmp_gt_u32 vcc, s71, v0
    v_lshl_add_u32 v106, v106, 4, s93
    s_add_u32 m0, s54, 43008
    v_cndmask_b32 v33, v32, v33, vcc
    v_mul_u32_u24 v32, 58255, v33
    v_mad_u32_u24 v106, v33, s62, v106
    v_lshrrev_b32 v32, 22, v32
    v_mad_u32_u24 v106, v32, s63, v106
    s_mul_i32 s90, s68, 3072
    s_add_u32 s90, s90, 61440
    buffer_load_dwordx4 v106, s[24:27], 0 offen  lds
    v_lshlrev_b32 v107, 16, v0
    s_add_u32 m0, s54, 2048
    v_and_b32 v104, -4, v105
    v_mad_u32_u24 v0, v104, 3, v105
    v_add_u32 v0, s95, v0
    v_mad_i32_i24 v105, v105, s99, v18
    v_med3_u32 v104, v0, 20, s94
    s_mov_b32 s28, s22
    s_mov_b32 s29, s23
    buffer_load_dwordx4 v126, s[24:27], s72 offen nt lds
    v_add_u32 v104, s70, v104
    v_add_u32 v18, s69, v0
    v_cmp_gt_u32 vcc, s71, v0
    v_lshl_add_u32 v105, v105, 4, s93
    s_add_u32 m0, s54, 41984
    v_cndmask_b32 v18, v104, v18, vcc
    v_mul_u32_u24 v104, 58255, v18
    v_mad_u32_u24 v105, v18, s62, v105
    v_lshrrev_b32 v104, 22, v104
    v_mad_u32_u24 v105, v104, s63, v105
    s_mov_b32 s41, 0x2a8cbccc
    s_mov_b32 s42, 0x38fba882
    buffer_load_dwordx4 v105, s[24:27], 0 offen  lds
    v_lshl_or_b32 v107, v0, 8, v107
    s_add_u32 m0, s54, 3072
    v_cmp_gt_u32 vcc, 32, v97
    v_and_b32 v0, -4, v1
    v_mad_u32_u24 v18, v0, 3, v1
    v_cndmask_b32 v124, v131, v124, vcc
    v_add_u32 v18, s95, v18
    s_mov_b32 s43, 0x415db3d7
    s_mov_b32 s30, 100270464
    buffer_load_dwordx4 v125, s[24:27], s72 offen nt lds
    s_add_u32 m0, s54, 4096
    v_mad_i32_i24 v104, v1, s99, v27
    v_med3_u32 v0, v18, 20, s94
    v_add_u32 v0, s70, v0
    v_add_u32 v27, s69, v18
    v_cmp_gt_u32 vcc, s71, v18
    v_lshl_add_u32 v104, v104, 4, s93
    s_add_u32 s101, s54, 44032
    s_mul_i32 s93, s68, 6
    buffer_load_dwordx4 v124, s[24:27], s72 offen nt lds
    v_cndmask_b32 v27, v0, v27, vcc
    v_mul_u32_u24 v0, 58255, v27
    v_mad_u32_u24 v104, v27, s62, v104
    v_lshrrev_b32 v0, 22, v0
    v_mad_u32_u24 v104, v0, s63, v104
    s_add_u32 m0, s54, 40960
    v_lshl_or_b32 v107, v18, 0, v107
    s_lshl_b32 s94, s97, 1
    s_mov_b32 s57, s72
    buffer_load_dwordx4 v104, s[24:27], 0 offen nt lds
    v_mul_u32_u24 v0, 10923, v97
    v_lshrrev_b32 v1, 17, v0
    v_lshrrev_b32 v0, 16, v0
    v_mad_i32_i24 v18, v0, -6, v97
    v_bitop3_b32 v1, v1, v0, 4 bitop3:0x28
    v_lshl_add_u32 v18, v18, 4, s85
    v_mul_u32_u24 v1, 3, v1
    v_xor_b32 v0, v0, v1
    v_mad_u32_u24 v1, v0, s91, v18
    v_add_u32 v27, 64, v97
    v_mul_u32_u24 v18, 10923, v27
    v_lshrrev_b32 v0, 17, v18
    v_lshrrev_b32 v18, 16, v18
    v_mad_i32_i24 v27, v18, -6, v27
    v_bitop3_b32 v0, v0, v18, 4 bitop3:0x28
    v_lshl_add_u32 v27, v27, 4, s100
    v_mul_u32_u24 v0, 3, v0
    v_xor_b32 v18, v18, v0
    v_mad_u32_u24 v0, v18, s91, v27
    v_add_u32 v18, 128, v97
    v_mul_u32_u24 v27, 10923, v18
    v_lshrrev_b32 v33, 17, v27
    v_lshrrev_b32 v27, 16, v27
    v_mad_i32_i24 v18, v27, -6, v18
    v_bitop3_b32 v33, v33, v27, 4 bitop3:0x28
    v_lshl_add_u32 v18, v18, 4, s87
    v_mul_u32_u24 v33, 3, v33
    v_xor_b32 v27, v27, v33
    v_mad_u32_u24 v33, v27, s91, v18
    s_add_u32 m0, s90, 0
    s_mov_b32 s92, 0
    buffer_load_dwordx4 v1, s[32:35], s92 offen offset:0 lds
    v_lshrrev_b32 v27, 1, v3
    v_lshl_add_u32 v18, v3, 2, v35
    v_lshl_add_u32 v18, v27, 3, v18
    v_mul_u32_u24 v18, 96, v18
    v_add_u32 v18, s90, v18
    v_lshl_add_u32 v120, v34, 4, v18
    v_lshl_add_u32 v91, v34, 3, v18
    s_waitcnt lgkmcnt(0)
    s_sext_i32_i16 s84, s82
    s_ashr_i32 s85, s82, 16
    s_max_i32 s84, s84, s85
    s_sext_i32_i16 s85, s83
    s_max_i32 s84, s84, s85
    s_ashr_i32 s85, s83, 16
    s_max_i32 s84, s84, s85
    s_cmp_gt_i32 s84, 16492
    s_cbranch_scc1 L_slow
    s_lshl_b32 s84, s68, 4
    buffer_load_dwordx4 v0, s[32:35], s92 offen offset:1024 lds
    s_lshr_b64 s[82:83], s[82:83], s84
    s_lshl_b32 s82, s82, 16
    v_mov_b32 v32, s82
    v_min_f32 v32, 0x40930000, v32
    v_max_f32 v32, 0xc2c80000, v32
    v_mul_f32 v32, 0x3fb8aa3b, v32
    v_exp_f32 v32, v32
    s_mov_b32 s84, 0x41b8aa3b
    s_mov_b32 s44, 61440
    buffer_load_dwordx4 v33, s[32:35], s92 offen offset:2048 lds
    s_add_u32 m0, s90, 12288
    s_mov_b32 s92, 36864
    v_cvt_pk_bf16_f32 v32, v32, v32
    v_lshlrev_b32 v32, 16, v32
    v_mul_f32 v32, 0x4038aa3b, v32
    v_mov_b32 v18, 0
    v_readfirstlane_b32 s55, v32
    v_add_f32 v32, v32, v32
    v_mov_b32 v27, 0
    v_readfirstlane_b32 s52, v32
    v_mul_u32_u24 v32, 5120, v3
    v_add_u32 v32, v19, v32
    v_mov_b32 v187, 0xc138aa3b
    v_mul_u32_u24 v4, 48, v35
    v_lshl_add_u32 v4, v34, 2, v4
    v_mul_u32_u24 v90, 48, v3
    v_add_u32 v199, 0, v4
    v_mul_u32_u24 v19, 37, v199
    v_lshrrev_b32 v19, 10, v19
    v_mad_u32_u24 v199, v19, 24, v199
    v_add_u32 v199, s101, v199
    v_add_u32 v5, 16, v4
    v_mul_u32_u24 v19, 37, v5
    v_lshrrev_b32 v19, 10, v19
    v_mad_u32_u24 v5, v19, 24, v5
    v_add_u32 v5, s101, v5
    v_add_u32 v175, 32, v4
    v_mul_u32_u24 v19, 37, v175
    v_lshrrev_b32 v19, 10, v19
    v_mad_u32_u24 v175, v19, 24, v175
    v_add_u32 v175, s101, v175
    v_add_u32 v138, 0, v90
    v_mul_u32_u24 v19, 37, v138
    v_lshrrev_b32 v19, 10, v19
    v_mad_u32_u24 v138, v19, 24, v138
    v_add_u32 v139, 4, v90
    v_mul_u32_u24 v19, 37, v139
    v_lshrrev_b32 v19, 10, v19
    v_mad_u32_u24 v139, v19, 24, v139
    v_add_u32 v89, 8, v90
    v_mul_u32_u24 v19, 37, v89
    v_lshrrev_b32 v19, 10, v19
    v_mad_u32_u24 v89, v19, 24, v89
    v_add_u32 v195, 12, v90
    v_mul_u32_u24 v19, 37, v195
    v_lshrrev_b32 v19, 10, v19
    v_mad_u32_u24 v195, v19, 24, v195
    v_add_u32 v88, 16, v90
    v_mul_u32_u24 v19, 37, v88
    v_lshrrev_b32 v19, 10, v19
    v_mad_u32_u24 v88, v19, 24, v88
    v_add_u32 v7, 20, v90
    v_mul_u32_u24 v6, 37, v7
    v_lshrrev_b32 v6, 10, v6
    v_mad_u32_u24 v7, v6, 24, v7
    v_add_u32 v6, 24, v90
    v_mul_u32_u24 v19, 37, v6
    v_lshrrev_b32 v19, 10, v19
    v_mad_u32_u24 v6, v19, 24, v6
    v_add_u32 v184, 28, v90
    s_mov_b32 s45, 40960
    s_mov_b32 s46, 20480
    buffer_load_dwordx4 v1, s[32:35], s92 offen offset:0 lds
    v_mul_u32_u24 v19, 37, v184
    v_lshrrev_b32 v19, 10, v19
    v_mad_u32_u24 v184, v19, 24, v184
    v_add_u32 v209, 32, v90
    v_mul_u32_u24 v19, 37, v209
    v_lshrrev_b32 v19, 10, v19
    v_mad_u32_u24 v209, v19, 24, v209
    s_mov_b32 s47, 0
    s_mov_b32 s58, 0
    buffer_load_dwordx4 v0, s[32:35], s92 offen offset:1024 lds
    s_waitcnt vmcnt(17)
    v_lshl_or_b32 v16, v17, 16, v16
    v_cmp_gt_u32 vcc, 16, v97
    v_mov_b32 v17, 0
    v_add_u32 v185, 36, v90
    v_cndmask_b32 v19, 0, v16, vcc
    v_cndmask_b32 v16, 0, v16, vcc
    v_mul_u32_u24 v186, 37, v185
    v_mfma_f32_16x16x16_bf16 v[8:11], v[18:19], v[24:25], 0
    s_waitcnt vmcnt(15)
    s_mov_b32 s59, 0
    v_lshl_or_b32 v136, v121, 16, v136
    v_lshrrev_b32 v186, 10, v186
    v_mfma_f32_16x16x16_bf16 v[12:15], v[16:17], v[24:25], 0
    s_mov_b32 s60, 0
    v_mad_u32_u24 v185, v186, 24, v185
    v_add_u32 v186, 40, v90
    v_mfma_f32_16x16x16_bf16 v[20:23], v[16:17], v[26:27], 0
    s_waitcnt vmcnt(13)
    s_mov_b32 s65, -1
    buffer_load_dwordx4 v33, s[32:35], s92 offen offset:2048 lds
    v_lshl_or_b32 v137, v2, 16, v137
    v_max_f32 v8, 0, v8
    v_max_f32 v12, 0, v12
    s_add_u32 m0, s90, 24576
    s_mov_b32 s92, 73728
    v_max_f32 v13, 0, v13
    v_max_f32 v14, 0, v14
    v_max_f32 v15, 0, v15
    v_cvt_pk_bf16_f32 v12, v12, v13
    v_cvt_pk_bf16_f32 v13, v14, v15
    v_max_f32 v9, 0, v9
    v_max_f32 v10, 0, v10
    v_mfma_f32_16x16x16_bf16 v[16:19], v[136:137], v[12:13], 0
    s_mov_b32 s61, 1
    v_max_f32 v11, 0, v11
    v_cvt_pk_bf16_f32 v8, v8, v9
    v_cvt_pk_bf16_f32 v9, v10, v11
    v_max_f32 v20, 0, v20
    v_max_f32 v21, 0, v21
    v_mfma_f32_16x16x16_bf16 v[12:15], v[136:137], v[8:9], 0
    s_movk_i32 s4, 112
    v_max_f32 v22, 0, v22
    v_max_f32 v23, 0, v23
    v_cvt_pk_bf16_f32 v20, v20, v21
    v_cvt_pk_bf16_f32 v21, v22, v23
    v_cvt_pk_bf16_f32 v16, v16, v16
    v_lshlrev_b32 v16, 16, v16
    v_mfma_f32_16x16x16_bf16 v[8:11], v[136:137], v[20:21], 0
    s_mov_b32 s5, 0
    v_mul_f32 v16, 0xbfb8aa3b, v16
    v_cvt_pk_bf16_f32 v12, v12, v12
    v_exp_f32 v16, v16
    v_lshlrev_b32 v12, 16, v12
    v_add_f32 v16, 1.0, v16
    v_rcp_f32 v16, v16
    v_mul_f32 v12, 0xbfb8aa3b, v12
    v_cvt_pk_bf16_f32 v16, v16, v16
    v_lshlrev_b32 v16, 16, v16
    v_fma_f32 v16, v16, s84, v187
    s_mov_b32 s6, 0
    s_mov_b32 s12, 0
    ds_write_b32 v32, v16 offset:44032
    v_exp_f32 v12, v12
    v_cvt_pk_bf16_f32 v8, v8, v8
    v_add_f32 v12, 1.0, v12
    v_rcp_f32 v12, v12
    v_lshlrev_b32 v8, 16, v8
    v_cvt_pk_bf16_f32 v12, v12, v12
    v_lshlrev_b32 v12, 16, v12
    v_fma_f32 v12, v12, s84, v187
    s_mov_b32 s64, 3
    s_mov_b32 s10, 81924
    ds_write_b32 v32, v12 offset:44036
    v_mul_f32 v8, 0xbfb8aa3b, v8
    v_exp_f32 v8, v8
    v_mul_u32_u24 v2, 37, v186
    v_add_f32 v8, 1.0, v8
    v_rcp_f32 v8, v8
    v_lshrrev_b32 v2, 10, v2
    v_cvt_pk_bf16_f32 v8, v8, v8
    v_lshlrev_b32 v8, 16, v8
    v_fma_f32 v8, v8, s84, v187
    s_mov_b32 s11, 0x20000
    s_mov_b32 s3, 0x00010001
    ds_write_b32 v32, v8 offset:44040
    v_mad_u32_u24 v186, v2, 24, v186
    v_add_u32 v187, 44, v90
    v_mul_u32_u24 v2, 37, v187
    v_lshrrev_b32 v2, 10, v2
    v_mad_u32_u24 v187, v2, 24, v187
    v_lshl_add_u32 v211, v3, 4, v4
    v_mul_u32_u24 v2, 37, v211
    v_lshrrev_b32 v2, 10, v2
    v_mad_u32_u24 v211, v2, 24, v211
    v_mov_b32 v90, 336
    v_cmp_gt_u32 vcc, 3, v3
    v_mov_b32 v32, 0x3f803f80
    v_and_b32 v2, 1, v97
    v_cndmask_b32 v211, v90, v211, vcc
    v_sub_u32 v211, s101, v211
    v_cmp_eq_u32 vcc, 0, v34
    v_lshlrev_b32 v2, 4, v2
    v_mov_b32 v90, 0x3f80
    v_cndmask_b32 v220, 0, v32, vcc
    v_cndmask_b32 v221, 0, v32, vcc
    v_cndmask_b32 v222, 0, v32, vcc
    v_cndmask_b32 v223, 0, v32, vcc
    v_lshlrev_b32 v90, v2, v90
    v_cmp_gt_u32 vcc, 2, v34
    v_mov_b32 v130, 0x44004400
    v_mov_b32 v2, 0xf149f2ca
    v_cndmask_b32 v216, 0, v90, vcc
    v_cndmask_b32 v218, 0, v90, vcc
    v_cmp_le_u32 vcc, 2, v34
    v_mul_u32_u24 v32, 5120, v35
    v_mad_u32_u24 v32, v34, s86, v32
    v_cndmask_b32 v217, 0, v90, vcc
    v_cndmask_b32 v219, 0, v90, vcc
    s_waitcnt lgkmcnt(0)
    s_barrier
    v_cmp_eq_u32 vcc, 0, v34
    v_and_b32 v129, 7, v123
    v_xor_b32 v122, v129, v3
    v_cndmask_b32 v212, 0, v130, vcc
    v_cmp_eq_u32 vcc, 1, v34
    v_lshl_add_u32 v90, v122, 4, v32
    v_xor_b32 v121, 64, v90
    v_cndmask_b32 v213, 0, v130, vcc
    v_cmp_eq_u32 vcc, 2, v34
    v_add_u32 v137, 40960, v90
    v_xor_b32 v136, 64, v137
    v_cndmask_b32 v214, 0, v130, vcc
    v_cmp_eq_u32 vcc, 3, v34
    v_add_u32 v32, 61440, v32
    v_add_u32 v122, s93, v3
    v_cndmask_b32 v215, 0, v130, vcc
    v_xor_b32 v122, v129, v122
    v_lshl_add_u32 v135, v122, 4, v32
    v_lshrrev_b32 v122, 1, v3
    v_add3_u32 v122, v122, s93, 4
    v_xor_b32 v122, v129, v122
    v_lshl_add_u32 v122, v122, 4, v32
    v_and_b32 v32, 1, v3
    v_lshl_add_u32 v134, v32, 3, v122
    v_lshlrev_b32 v32, 4, v97
    s_add_u32 s93, s54, 20480
    v_add_u32 v133, s93, v32
    v_add_u32 v129, 81920, v32
    s_lshr_b32 s93, s68, 1
    s_lshl_b32 s93, s93, 10
    s_add_u32 s93, s93, s94
    ds_read_b32 v210, v175
    v_add_u32 v130, s93, v129
    s_mul_i32 s93, s68, 7168
    s_add_u32 s93, s93, 135168
    v_mul_u32_u24 v32, 1792, v3
    v_add_u32 v122, s93, v32
    v_mul_u32_u24 v32, 112, v123
    v_add_u32 v38, v32, v122
    v_subrev_u32 v38, 28672, v38
    v_cmp_eq_u32 vcc, 0, v35
    v_add_u32 v32, 16, v122
    v_mov_b32 v123, 0
    buffer_load_dwordx4 v1, s[32:35], s92 offen offset:0 lds
    ds_read_b32 v208, v199
    v_cndmask_b32 v132, v131, v122, vcc
    v_cmp_eq_u32 vcc, 3, v34
    v_mov_b32 v122, 0
    v_sub_u32 v180, v175, v138
    v_cndmask_b32 v132, v132, v32, vcc
    v_mul_u32_u24 v32, 1792, v35
    v_lshl_add_u32 v32, v3, 3, v32
    v_lshl_add_u32 v32, v34, 1, v32
    v_add_u32 v32, s93, v32
    v_cmp_gt_u32 vcc, 3, v3
    s_add_u32 s93, s69, 1
    s_mul_i32 s94, s93, 58255
    ds_read_b32 v180, v180 offset:336
    v_cndmask_b32 v131, v131, v32, vcc
    s_lshr_b32 s94, s94, 22
    s_mul_i32 s94, s94, s63
    s_mul_i32 s56, s93, s62
    s_add_u32 s56, s56, s94
    s_sub_u32 s93, s71, 1
    s_cmp_eq_u32 s68, 0
    buffer_load_dwordx4 v0, s[32:35], s92 offen offset:1024 lds
    s_cselect_b32 s13, s93, -1
    s_cmp_gt_u32 s73, 20
    s_cselect_b32 s13, s13, -1
    s_and_b32 s93, s2, -8
    s_sub_u32 s93, 81920, s93
    s_sub_u32 s8, s38, s93
    s_subb_u32 s9, s39, 0
    ds_read_b32 v211, v211 offset:672
    v_sub_u32 v181, v175, v139
    v_sub_u32 v182, v175, v89
    v_sub_u32 v183, v175, v195
    buffer_load_dwordx4 v33, s[32:35], s92 offen offset:2048 lds
    s_add_u32 m0, s90, 36864
    s_mov_b32 s92, 110592
    ds_read_b32 v181, v181 offset:336
    v_sub_u32 v176, v175, v88
    v_sub_u32 v177, v175, v7
    v_sub_u32 v178, v175, v6
    v_sub_u32 v179, v175, v184
    v_sub_u32 v172, v175, v209
    ds_read_b32 v182, v182 offset:336
    v_sub_u32 v173, v175, v185
    v_sub_u32 v174, v175, v186
    v_sub_u32 v175, v175, v187
    v_sub_u32 v204, v199, v138
    v_sub_u32 v205, v199, v139
    ds_read_b32 v183, v183 offset:336
    v_sub_u32 v206, v199, v89
    v_sub_u32 v207, v199, v195
    buffer_load_dwordx4 v1, s[32:35], s92 offen offset:0 lds
    ds_read_b32 v176, v176 offset:336
    v_sub_u32 v200, v199, v88
    v_sub_u32 v201, v199, v7
    v_sub_u32 v202, v199, v6
    v_sub_u32 v203, v199, v184
    v_sub_u32 v196, v199, v209
    ds_read_b32 v177, v177 offset:336
    s_mov_b64 exec, 0
    s_cmp_eq_u32 s68, 2
    s_cbranch_scc1 L_pga
    s_cmp_eq_u32 s68, 3
    s_cbranch_scc1 L_pg2
    s_cmp_eq_u32 s68, 1
    s_cbranch_scc1 L_pg1
    s_branch L_pg0
L_prod:
    v_mbcnt_lo_u32_b32 v1, -1, 0
    v_mbcnt_hi_u32_b32 v1, -1, v1
    v_and_b32 v2, 15, v1
    v_lshrrev_b32 v3, 4, v1
    v_lshrrev_b32 v4, 2, v2
    v_and_b32 v5, 3, v2
    v_lshl_add_u32 v6, v4, 3, v5
    v_mul_u32_u24 v6, 384, v6
    s_lshr_b32 s85, s68, 1
    s_lshl1_add_u32 s84, s84, s85
    s_mul_i32 s85, s84, 12288
    v_add_u32 v6, s85, v6
    v_lshl_add_u32 v7, v3, 4, v6
    v_lshl_add_u32 v8, v3, 3, v6
    s_and_b32 s85, s68, 1
    s_mul_i32 s86, s85, 192
    s_sub_u32 s87, 192, s86
    s_mul_i32 s85, s85, 36
    s_add_u32 s85, s85, s84
    s_lshl_b32 s85, s85, 10
    v_lshl_add_u32 v18, v1, 4, s85
    v_mov_b32 v10, 0
    s_waitcnt lgkmcnt(0)
    s_mov_b32 s10, 73728
    s_mov_b32 s11, 0x20000
    s_mov_b32 s78, 73728
    s_mov_b32 s79, 0x20000
    buffer_load_dwordx4 v[20:23], v7, s[8:11], s86 offen offset:0
    buffer_load_dwordx2 v[36:37], v8, s[8:11], s86 offen offset:64
    buffer_load_dwordx4 v[24:27], v7, s[8:11], s86 offen offset:96
    buffer_load_dwordx2 v[38:39], v8, s[8:11], s86 offen offset:160
    buffer_load_dwordx4 v[28:31], v7, s[8:11], s87 offen offset:0
    buffer_load_dwordx2 v[40:41], v8, s[8:11], s87 offen offset:64
    buffer_load_dwordx4 v[32:35], v7, s[8:11], s87 offen offset:96
    buffer_load_dwordx2 v[42:43], v8, s[8:11], s87 offen offset:160
    buffer_load_dwordx4 v[44:47], v7, s[8:11], s86 offen offset:1536
    buffer_load_dwordx2 v[60:61], v8, s[8:11], s86 offen offset:1600
    buffer_load_dwordx4 v[48:51], v7, s[8:11], s86 offen offset:1632
    buffer_load_dwordx2 v[62:63], v8, s[8:11], s86 offen offset:1696
    buffer_load_dwordx4 v[52:55], v7, s[8:11], s87 offen offset:1536
    buffer_load_dwordx2 v[64:65], v8, s[8:11], s87 offen offset:1600
    buffer_load_dwordx4 v[56:59], v7, s[8:11], s87 offen offset:1632
    buffer_load_dwordx2 v[66:67], v8, s[8:11], s87 offen offset:1696
    s_add_u32 s88, s76, 0x18000
    s_addc_u32 s89, s77, 0
    global_load_dword v9, v10, s[88:89]
    global_load_dword v19, v10, s[38:39] offset:248 sc1
    v_mov_b32 v12, 0x3f803f80
    v_mov_b32 v13, 0x3f803f80
    v_mov_b32 v14, 0x3f803f80
    v_mov_b32 v15, 0x3f803f80
    v_and_b32 v10, 1, v1
    v_lshlrev_b32 v10, 4, v10
    v_mov_b32 v11, 0x3f80
    v_lshlrev_b32 v10, v10, v11
    v_cmp_eq_u32 vcc, v3, v4
    s_nop 1
    v_cndmask_b32 v10, 0, v10, vcc
    v_cmp_gt_u32 vcc, 2, v5
    s_nop 1
    v_cndmask_b32 v16, 0, v10, vcc
    v_cmp_le_u32 vcc, 2, v5
    s_nop 1
    v_cndmask_b32 v17, 0, v10, vcc
    s_waitcnt vmcnt(2)
    v_mfma_f32_16x16x32_bf16 v[68:71], v[20:23], v[12:15], 0
    v_mfma_f32_16x16x32_bf16 v[68:71], v[24:27], v[12:15], v[68:71]
    v_mfma_f32_16x16x32_bf16 v[68:71], v[28:31], v[12:15], v[68:71]
    v_mfma_f32_16x16x32_bf16 v[68:71], v[32:35], v[12:15], v[68:71]
    v_mfma_f32_16x16x32_bf16 v[68:71], v[36:39], v[12:15], v[68:71]
    v_mfma_f32_16x16x32_bf16 v[68:71], v[40:43], v[12:15], v[68:71]
    v_mfma_f32_16x16x32_bf16 v[72:75], v[44:47], v[12:15], 0
    v_mfma_f32_16x16x32_bf16 v[72:75], v[48:51], v[12:15], v[72:75]
    v_mfma_f32_16x16x32_bf16 v[72:75], v[52:55], v[12:15], v[72:75]
    v_mfma_f32_16x16x32_bf16 v[72:75], v[56:59], v[12:15], v[72:75]
    v_mfma_f32_16x16x32_bf16 v[72:75], v[60:63], v[12:15], v[72:75]
    v_mfma_f32_16x16x32_bf16 v[72:75], v[64:67], v[12:15], v[72:75]
    s_nop 1
    v_mul_f32 v68, 0xbbaaaaab, v68
    v_mul_f32 v69, 0xbbaaaaab, v69
    v_mul_f32 v70, 0xbbaaaaab, v70
    v_mul_f32 v71, 0xbbaaaaab, v71
    s_nop 1
    v_mfma_f32_16x16x16_bf16 v[76:79], v[20:21], v[16:17], v[68:71]
    v_mfma_f32_16x16x16_bf16 v[80:83], v[22:23], v[16:17], v[68:71]
    v_mfma_f32_16x16x16_bf16 v[84:87], v[36:37], v[16:17], v[68:71]
    v_mfma_f32_16x16x16_bf16 v[88:91], v[24:25], v[16:17], v[68:71]
    v_mfma_f32_16x16x16_bf16 v[92:95], v[26:27], v[16:17], v[68:71]
    v_mfma_f32_16x16x16_bf16 v[96:99], v[38:39], v[16:17], v[68:71]
    v_mul_f32 v72, 0xbbaaaaab, v72
    v_mul_f32 v73, 0xbbaaaaab, v73
    v_mul_f32 v74, 0xbbaaaaab, v74
    v_mul_f32 v75, 0xbbaaaaab, v75
    s_nop 1
    v_mfma_f32_16x16x16_bf16 v[100:103], v[44:45], v[16:17], v[72:75]
    v_mfma_f32_16x16x16_bf16 v[104:107], v[46:47], v[16:17], v[72:75]
    v_mfma_f32_16x16x16_bf16 v[108:111], v[60:61], v[16:17], v[72:75]
    v_mfma_f32_16x16x16_bf16 v[112:115], v[48:49], v[16:17], v[72:75]
    v_mfma_f32_16x16x16_bf16 v[116:119], v[50:51], v[16:17], v[72:75]
    v_mfma_f32_16x16x16_bf16 v[120:123], v[62:63], v[16:17], v[72:75]
    v_cvt_pk_bf16_f32 v124, v76, v77
    v_cvt_pk_bf16_f32 v125, v78, v79
    s_nop 0
    v_cvt_pk_bf16_f32 v126, v100, v101
    v_cvt_pk_bf16_f32 v127, v102, v103
    s_movk_i32 s85, 0
    buffer_store_dwordx4 v[124:127], v18, s[76:79], s85 offen sc1
    v_cvt_pk_bf16_f32 v128, v80, v81
    v_cvt_pk_bf16_f32 v129, v82, v83
    v_cvt_pk_bf16_f32 v130, v104, v105
    v_cvt_pk_bf16_f32 v131, v106, v107
    s_movk_i32 s85, 6144
    buffer_store_dwordx4 v[128:131], v18, s[76:79], s85 offen sc1
    v_cvt_pk_bf16_f32 v132, v84, v85
    v_cvt_pk_bf16_f32 v133, v86, v87
    v_cvt_pk_bf16_f32 v134, v108, v109
    v_cvt_pk_bf16_f32 v135, v110, v111
    s_movk_i32 s85, 12288
    buffer_store_dwordx4 v[132:135], v18, s[76:79], s85 offen sc1
    v_cvt_pk_bf16_f32 v136, v88, v89
    v_cvt_pk_bf16_f32 v137, v90, v91
    v_cvt_pk_bf16_f32 v138, v112, v113
    v_cvt_pk_bf16_f32 v139, v114, v115
    s_movk_i32 s85, 18432
    buffer_store_dwordx4 v[136:139], v18, s[76:79], s85 offen sc1
    v_cvt_pk_bf16_f32 v140, v92, v93
    v_cvt_pk_bf16_f32 v141, v94, v95
    v_cvt_pk_bf16_f32 v142, v116, v117
    v_cvt_pk_bf16_f32 v143, v118, v119
    s_movk_i32 s85, 24576
    buffer_store_dwordx4 v[140:143], v18, s[76:79], s85 offen sc1
    v_cvt_pk_bf16_f32 v144, v96, v97
    v_cvt_pk_bf16_f32 v145, v98, v99
    v_cvt_pk_bf16_f32 v146, v120, v121
    v_cvt_pk_bf16_f32 v147, v122, v123
    s_movk_i32 s85, 30720
    buffer_store_dwordx4 v[144:147], v18, s[76:79], s85 offen sc1
    v_mov_b32 v10, 0
    v_mov_b32 v11, 1
    s_mov_b32 s64, 8
    s_waitcnt vmcnt(0)
    s_barrier
    s_cmp_lg_u32 s68, 0
    s_cbranch_scc1 L_top2
    s_mov_b64 exec, 1
    global_atomic_add v10, v11, s[38:39] offset:248 sc1
    s_mov_b64 exec, -1
    s_branch L_top2
.p2alignl 12, 0xbf810000
L_main:
    s_mov_b64 exec, -1
    s_waitcnt vmcnt(10)
    s_barrier
    v_sub_u32 v197, v199, v185
    v_sub_u32 v198, v199, v186
    v_sub_u32 v199, v199, v187
    v_sub_u32 v192, v5, v138
    ds_read_b128 v[12:15], v90 offset:40960
    v_sub_u32 v193, v5, v139
    v_sub_u32 v194, v5, v89
    v_sub_u32 v195, v5, v195
    ds_read_b128 v[8:11], v90 offset:42496
    v_sub_u32 v188, v5, v88
    v_sub_u32 v189, v5, v7
    v_sub_u32 v190, v5, v6
    ds_read_b128 v[24:27], v90 offset:0
    buffer_load_dwordx4 v0, s[32:35], s92 offen offset:1024 lds
    v_sub_u32 v191, v5, v184
    v_sub_u32 v184, v5, v209
    ds_read_b128 v[16:19], v90 offset:1536
    v_sub_u32 v185, v5, v185
    v_sub_u32 v186, v5, v186
    v_sub_u32 v187, v5, v187
    ds_read_b128 v[44:47], v90 offset:3072
    ds_read_b32 v178, v178 offset:336
    buffer_load_dwordx4 v33, s[32:35], s92 offen offset:2048 lds
    s_add_u32 m0, s90, 49152
    s_mov_b32 s92, 147456
    ds_read_b32 v179, v179 offset:336
    ds_read_b32 v172, v172 offset:336
    ds_read_b32 v173, v173 offset:336
    buffer_load_dwordx4 v1, s[32:35], s92 offen offset:0 lds
    s_waitcnt vmcnt(10)
    ds_read_b64_tr_b16 a[0:1], v91 offset:0
    ds_read_b64_tr_b16 a[2:3], v91 offset:768
    ds_read_b64_tr_b16 a[24:25], v91 offset:32
    ds_read_b64_tr_b16 a[26:27], v91 offset:800
    ds_read_b64_tr_b16 a[48:49], v91 offset:64
    ds_read_b64_tr_b16 a[50:51], v91 offset:832
    ds_read_b32 v174, v174 offset:336
    ds_read_b32 v175, v175 offset:336
    buffer_load_dwordx4 v0, s[32:35], s92 offen offset:1024 lds
    ds_read_b32 v204, v204 offset:336
    ds_read_b32 v205, v205 offset:336
    ds_read_b32 v206, v206 offset:336
    s_waitcnt lgkmcnt(8)
    v_mfma_f32_16x16x32_bf16 v[68:71], a[0:3], v[12:15], 0
    s_waitcnt lgkmcnt(7)
    buffer_load_dwordx4 v33, s[32:35], s92 offen offset:2048 lds
    v_mfma_f32_16x16x32_bf16 v[64:67], a[24:27], v[12:15], 0
    s_waitcnt lgkmcnt(5)
    s_add_u32 m0, s90, 61440
    ds_read_b32 v207, v207 offset:336
    v_mfma_f32_16x16x32_bf16 v[56:59], a[48:51], v[12:15], 0
    s_mov_b32 s92, 184320
    v_mfma_f32_16x16x32_bf16 v[40:43], a[0:3], v[8:11], 0
    ds_read_b128 v[48:51], v121 offset:40960
    v_mfma_f32_16x16x32_bf16 v[12:15], a[24:27], v[8:11], 0
    ds_read_b32 v200, v200 offset:336
    v_mfma_f32_16x16x32_bf16 v[28:31], a[48:51], v[8:11], 0
    buffer_load_dwordx4 v1, s[32:35], s92 offen offset:0 lds
    v_mfma_f32_16x16x32_bf16 v[20:23], a[0:3], v[24:27], 0
    s_waitcnt vmcnt(10)
    ds_read_b64_tr_b16 a[4:5], v91 offset:12288
    v_mfma_f32_16x16x32_bf16 v[116:119], a[24:27], v[24:27], 0
    ds_read_b64_tr_b16 a[6:7], v91 offset:13056
    v_mfma_f32_16x16x32_bf16 v[8:11], a[48:51], v[24:27], 0
    ds_read_b64_tr_b16 a[28:29], v91 offset:12320
    v_mfma_f32_16x16x32_bf16 v[108:111], a[0:3], v[16:19], 0
    ds_read_b64_tr_b16 a[30:31], v91 offset:13088
    v_mfma_f32_16x16x32_bf16 v[60:63], a[24:27], v[16:19], 0
    buffer_load_dwordx4 v0, s[32:35], s92 offen offset:1024 lds
    ds_read_b64_tr_b16 a[52:53], v91 offset:12352
    v_mfma_f32_16x16x32_bf16 v[72:75], a[48:51], v[16:19], 0
    ds_read_b64_tr_b16 a[54:55], v91 offset:13120
    v_mfma_f32_16x16x32_bf16 v[92:95], a[0:3], v[44:47], 0
    ds_read_b128 v[24:27], v121 offset:42496
    v_mfma_f32_16x16x32_bf16 v[168:171], a[24:27], v[44:47], 0
    ds_read_b128 v[16:19], v121 offset:0
    v_mfma_f32_16x16x32_bf16 v[140:143], a[48:51], v[44:47], 0
    s_waitcnt lgkmcnt(6)
    ds_read_b128 v[52:55], v121 offset:1536
    buffer_load_dwordx4 v33, s[32:35], s92 offen offset:2048 lds
    s_add_u32 m0, s90, 0
    s_mov_b32 s92, 384
    v_mfma_f32_16x16x32_bf16 v[68:71], a[4:7], v[48:51], v[68:71]
    s_waitcnt lgkmcnt(5)
    ds_read_b128 v[44:47], v121 offset:3072
    ds_read_b32 v201, v201 offset:336
    v_mfma_f32_16x16x32_bf16 v[64:67], a[28:31], v[48:51], v[64:67]
    s_waitcnt lgkmcnt(5)
    ds_read_b32 v202, v202 offset:336
    v_mfma_f32_16x16x32_bf16 v[56:59], a[52:55], v[48:51], v[56:59]
    s_waitcnt vmcnt(9) lgkmcnt(5)
    buffer_load_dwordx4 v1, s[32:35], s92 offen offset:0 lds
    ds_read_b64_tr_b16 a[8:9], v91 offset:24576
    v_mfma_f32_16x16x32_bf16 v[40:43], a[4:7], v[24:27], v[40:43]
    ds_read_b64_tr_b16 a[10:11], v91 offset:25344
    v_mfma_f32_16x16x32_bf16 v[12:15], a[28:31], v[24:27], v[12:15]
    ds_read_b64_tr_b16 a[32:33], v91 offset:24608
    v_mfma_f32_16x16x32_bf16 v[28:31], a[52:55], v[24:27], v[28:31]
    s_waitcnt lgkmcnt(6)
    ds_read_b64_tr_b16 a[34:35], v91 offset:25376
    v_mfma_f32_16x16x32_bf16 v[20:23], a[4:7], v[16:19], v[20:23]
    ds_read_b64_tr_b16 a[56:57], v91 offset:24640
    v_mfma_f32_16x16x32_bf16 v[116:119], a[28:31], v[16:19], v[116:119]
    buffer_load_dwordx4 v0, s[32:35], s92 offen offset:1024 lds
    ds_read_b64_tr_b16 a[58:59], v91 offset:25408
    v_mfma_f32_16x16x32_bf16 v[8:11], a[52:55], v[16:19], v[8:11]
    ds_read_b128 v[48:51], v90 offset:41088
    v_mfma_f32_16x16x32_bf16 v[108:111], a[4:7], v[52:55], v[108:111]
    ds_read_b128 v[24:27], v90 offset:42624
    v_mfma_f32_16x16x32_bf16 v[60:63], a[28:31], v[52:55], v[60:63]
    ds_read_b128 v[16:19], v90 offset:128
    v_mfma_f32_16x16x32_bf16 v[72:75], a[52:55], v[52:55], v[72:75]
    s_waitcnt lgkmcnt(8)
    ds_read_b128 v[52:55], v90 offset:1664
    v_mfma_f32_16x16x32_bf16 v[92:95], a[4:7], v[44:47], v[92:95]
    buffer_load_dwordx4 v33, s[32:35], s92 offen offset:2048 lds
    ds_read_b32 v203, v203 offset:336
    v_mfma_f32_16x16x32_bf16 v[168:171], a[28:31], v[44:47], v[168:171]
    s_add_u32 m0, s90, 12288
    v_mfma_f32_16x16x32_bf16 v[140:143], a[52:55], v[44:47], v[140:143]
    s_mov_b32 s92, 37248
    ds_read_b128 v[44:47], v90 offset:3200
    ds_read_b32 v196, v196 offset:336
    ds_read_b32 v197, v197 offset:336
    s_waitcnt lgkmcnt(7)
    v_mfma_f32_16x16x32_bf16 v[68:71], a[8:11], v[48:51], v[68:71]
    buffer_load_dwordx4 v1, s[32:35], s92 offen offset:0 lds
    v_mfma_f32_16x16x32_bf16 v[64:67], a[32:35], v[48:51], v[64:67]
    s_waitcnt vmcnt(10)
    ds_read_b64_tr_b16 a[12:13], v91 offset:36864
    v_mfma_f32_16x16x32_bf16 v[56:59], a[56:59], v[48:51], v[56:59]
    s_waitcnt lgkmcnt(5)
    ds_read_b64_tr_b16 a[14:15], v91 offset:37632
    v_mfma_f32_16x16x32_bf16 v[40:43], a[8:11], v[24:27], v[40:43]
    ds_read_b64_tr_b16 a[36:37], v91 offset:36896
    v_mfma_f32_16x16x32_bf16 v[12:15], a[32:35], v[24:27], v[12:15]
    ds_read_b64_tr_b16 a[38:39], v91 offset:37664
    v_mfma_f32_16x16x32_bf16 v[28:31], a[56:59], v[24:27], v[28:31]
    buffer_load_dwordx4 v0, s[32:35], s92 offen offset:1024 lds
    ds_read_b64_tr_b16 a[60:61], v91 offset:36928
    v_mfma_f32_16x16x32_bf16 v[20:23], a[8:11], v[16:19], v[20:23]
    ds_read_b64_tr_b16 a[62:63], v91 offset:37696
    v_mfma_f32_16x16x32_bf16 v[116:119], a[32:35], v[16:19], v[116:119]
    ds_read_b128 v[24:27], v121 offset:41088
    v_mfma_f32_16x16x32_bf16 v[8:11], a[56:59], v[16:19], v[8:11]
    ds_read_b128 v[16:19], v121 offset:42624
    v_mfma_f32_16x16x32_bf16 v[108:111], a[8:11], v[52:55], v[108:111]
    ds_read_b128 v[48:51], v121 offset:128
    v_mfma_f32_16x16x32_bf16 v[60:63], a[32:35], v[52:55], v[60:63]
    buffer_load_dwordx4 v33, s[32:35], s92 offen offset:2048 lds
    ds_read_b32 v198, v198 offset:336
    v_mfma_f32_16x16x32_bf16 v[72:75], a[56:59], v[52:55], v[72:75]
    s_waitcnt lgkmcnt(8)
    s_add_u32 m0, s90, 24576
    v_mfma_f32_16x16x32_bf16 v[92:95], a[8:11], v[44:47], v[92:95]
    s_mov_b32 s92, 74112
    ds_read_b128 v[52:55], v121 offset:1664
    v_mfma_f32_16x16x32_bf16 v[168:171], a[32:35], v[44:47], v[168:171]
    ds_read_b32 v199, v199 offset:336
    v_mfma_f32_16x16x32_bf16 v[140:143], a[56:59], v[44:47], v[140:143]
    s_waitcnt vmcnt(9) lgkmcnt(5)
    buffer_load_dwordx4 v1, s[32:35], s92 offen offset:0 lds
    ds_read_b64_tr_b16 a[16:17], v91 offset:49152
    ds_read_b64_tr_b16 a[18:19], v91 offset:49920
    v_mfma_f32_16x16x32_bf16 v[68:71], a[12:15], v[24:27], v[68:71]
    ds_read_b64_tr_b16 a[40:41], v91 offset:49184
    v_mfma_f32_16x16x32_bf16 v[64:67], a[36:39], v[24:27], v[64:67]
    ds_read_b64_tr_b16 a[42:43], v91 offset:49952
    v_mfma_f32_16x16x32_bf16 v[56:59], a[60:63], v[24:27], v[56:59]
    s_waitcnt lgkmcnt(7)
    ds_read_b64_tr_b16 a[64:65], v91 offset:49216
    v_mfma_f32_16x16x32_bf16 v[40:43], a[12:15], v[16:19], v[40:43]
    ds_read_b64_tr_b16 a[66:67], v91 offset:49984
    buffer_load_dwordx4 v0, s[32:35], s92 offen offset:1024 lds
    v_mfma_f32_16x16x32_bf16 v[12:15], a[36:39], v[16:19], v[12:15]
    ds_read_b128 v[44:47], v121 offset:3200
    v_mfma_f32_16x16x32_bf16 v[28:31], a[60:63], v[16:19], v[28:31]
    ds_read_b128 v[24:27], v90 offset:41216
    v_mfma_f32_16x16x32_bf16 v[20:23], a[12:15], v[48:51], v[20:23]
    ds_read_b128 v[16:19], v90 offset:42752
    v_mfma_f32_16x16x32_bf16 v[116:119], a[36:39], v[48:51], v[116:119]
    ds_read_b32 v192, v192 offset:336
    v_mfma_f32_16x16x32_bf16 v[8:11], a[60:63], v[48:51], v[8:11]
    s_waitcnt lgkmcnt(8)
    buffer_load_dwordx4 v33, s[32:35], s92 offen offset:2048 lds
    v_mfma_f32_16x16x32_bf16 v[108:111], a[12:15], v[52:55], v[108:111]
    s_add_u32 m0, s90, 36864
    ds_read_b128 v[48:51], v90 offset:256
    v_mfma_f32_16x16x32_bf16 v[60:63], a[36:39], v[52:55], v[60:63]
    s_mov_b32 s92, 110976
    ds_read_b32 v193, v193 offset:336
    v_mfma_f32_16x16x32_bf16 v[72:75], a[60:63], v[52:55], v[72:75]
    s_waitcnt lgkmcnt(5)
    ds_read_b128 v[52:55], v90 offset:1792
    ds_read_b32 v194, v194 offset:336
    v_mfma_f32_16x16x32_bf16 v[92:95], a[12:15], v[44:47], v[92:95]
    buffer_load_dwordx4 v1, s[32:35], s92 offen offset:0 lds
    v_mfma_f32_16x16x32_bf16 v[168:171], a[36:39], v[44:47], v[168:171]
    s_waitcnt vmcnt(10)
    ds_read_b64_tr_b16 a[20:21], v91 offset:61440
    v_mfma_f32_16x16x32_bf16 v[140:143], a[60:63], v[44:47], v[140:143]
    s_waitcnt lgkmcnt(5)
    ds_read_b64_tr_b16 a[22:23], v91 offset:62208
    v_mfma_f32_16x16x32_bf16 v[68:71], a[16:19], v[24:27], v[68:71]
    ds_read_b64_tr_b16 a[44:45], v91 offset:61472
    v_mfma_f32_16x16x32_bf16 v[64:67], a[40:43], v[24:27], v[64:67]
    ds_read_b64_tr_b16 a[46:47], v91 offset:62240
    v_mfma_f32_16x16x32_bf16 v[56:59], a[64:67], v[24:27], v[56:59]
    buffer_load_dwordx4 v0, s[32:35], s92 offen offset:1024 lds
    ds_read_b64_tr_b16 a[68:69], v91 offset:61504
    v_mfma_f32_16x16x32_bf16 v[40:43], a[16:19], v[16:19], v[40:43]
    ds_read_b64_tr_b16 a[70:71], v91 offset:62272
    v_mfma_f32_16x16x32_bf16 v[12:15], a[40:43], v[16:19], v[12:15]
    ds_read_b128 v[44:47], v90 offset:3328
    v_mfma_f32_16x16x32_bf16 v[28:31], a[64:67], v[16:19], v[28:31]
    s_waitcnt lgkmcnt(7)
    ds_read_b128 v[24:27], v121 offset:41216
    v_mfma_f32_16x16x32_bf16 v[20:23], a[16:19], v[48:51], v[20:23]
    ds_read_b128 v[16:19], v121 offset:42752
    v_mfma_f32_16x16x32_bf16 v[116:119], a[40:43], v[48:51], v[116:119]
    buffer_load_dwordx4 v33, s[32:35], s92 offen offset:2048 lds
    ds_read_b32 v195, v195 offset:336
    v_mfma_f32_16x16x32_bf16 v[8:11], a[64:67], v[48:51], v[8:11]
    s_add_u32 m0, s90, 49152
    v_mfma_f32_16x16x32_bf16 v[108:111], a[16:19], v[52:55], v[108:111]
    s_mov_b32 s92, 147840
    ds_read_b128 v[48:51], v121 offset:256
    v_mfma_f32_16x16x32_bf16 v[60:63], a[40:43], v[52:55], v[60:63]
    ds_read_b32 v188, v188 offset:336
    v_mfma_f32_16x16x32_bf16 v[72:75], a[64:67], v[52:55], v[72:75]
    s_waitcnt vmcnt(9) lgkmcnt(5)
    ds_read_b128 v[52:55], v121 offset:1792
    buffer_load_dwordx4 v1, s[32:35], s92 offen offset:0 lds
    ds_read_b64_tr_b16 a[72:73], v91 offset:0
    v_mfma_f32_16x16x32_bf16 v[92:95], a[16:19], v[44:47], v[92:95]
    ds_read_b64_tr_b16 a[74:75], v91 offset:768
    v_mfma_f32_16x16x32_bf16 v[168:171], a[40:43], v[44:47], v[168:171]
    ds_read_b64_tr_b16 a[96:97], v91 offset:32
    v_mfma_f32_16x16x32_bf16 v[140:143], a[64:67], v[44:47], v[140:143]
    s_waitcnt lgkmcnt(7)
    ds_read_b64_tr_b16 a[98:99], v91 offset:800
    v_mfma_f32_16x16x32_bf16 v[68:71], a[20:23], v[24:27], v[68:71]
    ds_read_b64_tr_b16 a[120:121], v91 offset:64
    v_mfma_f32_16x16x32_bf16 v[64:67], a[44:47], v[24:27], v[64:67]
    s_nop 0
    ds_read_b64_tr_b16 a[122:123], v91 offset:832
    buffer_load_dwordx4 v0, s[32:35], s92 offen offset:1024 lds
    v_mfma_f32_16x16x32_bf16 v[56:59], a[68:71], v[24:27], v[56:59]
    s_nop 0
    ds_read_b128 v[44:47], v121 offset:3328
    v_cvt_pk_f16_f32 v160, v68, v69
    v_mfma_f32_16x16x32_bf16 v[40:43], a[20:23], v[16:19], v[40:43]
    ds_read_b128 v[24:27], v90 offset:40960
    v_cvt_pk_f16_f32 v161, v70, v71
    v_mfma_f32_16x16x32_bf16 v[12:15], a[44:47], v[16:19], v[12:15]
    ds_read_b32 v189, v189 offset:336
    v_pk_fma_f16 v164, v160, v160, s3
    v_mfma_f32_16x16x32_bf16 v[28:31], a[68:71], v[16:19], v[28:31]
    s_waitcnt lgkmcnt(8)
    v_pk_fmac_f16 v164, v161, v161
    v_cvt_pk_f16_f32 v162, v64, v65
    v_mfma_f32_16x16x32_bf16 v[20:23], a[20:23], v[48:51], v[20:23]
    buffer_load_dwordx4 v33, s[32:35], s92 offen offset:2048 lds
    ds_read_b128 v[16:19], v90 offset:42496
    v_mfma_f32_16x16x32_bf16 v[116:119], a[44:47], v[48:51], v[116:119]
    s_add_u32 m0, s90, 61440
    v_cvt_pk_f16_f32 v163, v66, v67
    v_pk_fmac_f16 v164, v162, v162
    v_mfma_f32_16x16x32_bf16 v[8:11], a[68:71], v[48:51], v[8:11]
    s_mov_b32 s92, 184704
    ds_read_b128 v[48:51], v90 offset:0
    v_pk_fmac_f16 v164, v163, v163
    v_mfma_f32_16x16x32_bf16 v[108:111], a[20:23], v[52:55], v[108:111]
    ds_read_b32 v190, v190 offset:336
    v_cvt_pk_f16_f32 v6, v56, v57
    v_mfma_f32_16x16x32_bf16 v[60:63], a[44:47], v[52:55], v[60:63]
    v_cvt_pk_f16_f32 v7, v58, v59
    v_pk_fmac_f16 v164, v6, v6
    v_mfma_f32_16x16x32_bf16 v[72:75], a[68:71], v[52:55], v[72:75]
    s_waitcnt vmcnt(9) lgkmcnt(5)
    ds_read_b64_tr_b16 a[76:77], v91 offset:12288
    buffer_load_dwordx4 v1, s[32:35], s92 offen offset:0 lds
    v_mfma_f32_16x16x32_bf16 v[92:95], a[20:23], v[44:47], v[92:95]
    ds_read_b64_tr_b16 a[78:79], v91 offset:13056
    v_pk_fmac_f16 v164, v7, v7
    v_mfma_f32_16x16x32_bf16 v[168:171], a[44:47], v[44:47], v[168:171]
    ds_read_b64_tr_b16 a[100:101], v91 offset:12320
    v_cvt_pk_f16_f32 v112, v40, v41
    v_mfma_f32_16x16x32_bf16 v[140:143], a[68:71], v[44:47], v[140:143]
    s_waitcnt lgkmcnt(6)
    ds_read_b64_tr_b16 a[102:103], v91 offset:13088
    v_cvt_pk_f16_f32 v113, v42, v43
    v_mfma_f32_16x16x32_bf16 v[156:159], a[72:75], v[24:27], 0
    ds_read_b64_tr_b16 a[124:125], v91 offset:12352
    v_pk_fma_f16 v166, v112, v112, s3
    v_mfma_f32_16x16x32_bf16 v[148:151], a[96:99], v[24:27], 0
    ds_read_b64_tr_b16 a[126:127], v91 offset:13120
    buffer_load_dwordx4 v0, s[32:35], s92 offen offset:1024 lds
    v_mfma_f32_16x16x32_bf16 v[100:103], a[120:123], v[24:27], 0
    s_waitcnt lgkmcnt(7)
    ds_read_b128 v[44:47], v90 offset:1536
    v_pk_fmac_f16 v166, v113, v113
    v_mfma_f32_16x16x32_bf16 v[84:87], a[72:75], v[16:19], 0
    ds_read_b128 v[40:43], v90 offset:3072
    v_cvt_pk_f16_f32 v114, v12, v13
    v_mfma_f32_16x16x32_bf16 v[80:83], a[96:99], v[16:19], 0
    ds_read_b128 v[24:27], v121 offset:40960
    v_cvt_pk_f16_f32 v115, v14, v15
    v_mfma_f32_16x16x32_bf16 v[12:15], a[120:123], v[16:19], 0
    ds_read_b128 v[144:147], v121 offset:42496
    v_pk_fmac_f16 v166, v114, v114
    v_mfma_f32_16x16x32_bf16 v[16:19], a[72:75], v[48:51], 0
    buffer_load_dwordx4 v33, s[32:35], s92 offen offset:2048 lds
    ds_read_b32 v191, v191 offset:336
    v_mfma_f32_16x16x32_bf16 v[228:231], a[96:99], v[48:51], 0
    s_add_u32 m0, s90, 0
    v_pk_fmac_f16 v166, v115, v115
    v_cvt_pk_f16_f32 v88, v28, v29
    v_mfma_f32_16x16x32_bf16 v[224:227], a[120:123], v[48:51], 0
    s_mov_b32 s92, 768
    ds_read_b128 v[64:67], v121 offset:0
    v_cvt_pk_f16_f32 v89, v30, v31
    v_pk_fmac_f16 v166, v88, v88
    v_pk_fmac_f16 v166, v89, v89
    v_cvt_pk_f16_f32 v28, v20, v21
    v_cvt_pk_f16_f32 v29, v22, v23
    v_pk_fma_f16 v248, v28, v28, s3
    v_pk_fmac_f16 v248, v29, v29
    v_cvt_pk_f16_f32 v30, v116, v117
    v_cvt_pk_f16_f32 v31, v118, v119
    v_pk_fmac_f16 v248, v30, v30
    s_waitcnt lgkmcnt(5)
    v_mfma_f32_16x16x32_bf16 v[252:255], a[72:75], v[44:47], 0
    s_waitcnt vmcnt(9)
    ds_read_b64_tr_b16 a[80:81], v91 offset:24576
    buffer_load_dwordx4 v1, s[32:35], s92 offen offset:0 lds
    v_mfma_f32_16x16x32_bf16 v[20:23], a[96:99], v[44:47], 0
    ds_read_b64_tr_b16 a[82:83], v91 offset:25344
    v_pk_fmac_f16 v248, v31, v31
    v_mfma_f32_16x16x32_bf16 v[76:79], a[120:123], v[44:47], 0
    s_waitcnt lgkmcnt(4)
    ds_read_b64_tr_b16 a[104:105], v91 offset:24608
    v_cvt_pk_f16_f32 v152, v8, v9
    v_mfma_f32_16x16x32_bf16 v[56:59], a[72:75], v[40:43], 0
    ds_read_b64_tr_b16 a[106:107], v91 offset:25376
    v_cvt_pk_f16_f32 v153, v10, v11
    v_mfma_f32_16x16x32_bf16 v[156:159], a[76:79], v[24:27], v[156:159]
    ds_read_b64_tr_b16 a[128:129], v91 offset:24640
    v_pk_fmac_f16 v248, v152, v152
    v_mfma_f32_16x16x32_bf16 v[148:151], a[100:103], v[24:27], v[148:151]
    ds_read_b64_tr_b16 a[130:131], v91 offset:25408
    buffer_load_dwordx4 v0, s[32:35], s92 offen offset:1024 lds
    v_mfma_f32_16x16x32_bf16 v[100:103], a[124:127], v[24:27], v[100:103]
    ds_read_b128 v[48:51], v121 offset:1536
    v_pk_fmac_f16 v248, v153, v153
    v_mfma_f32_16x16x32_bf16 v[44:47], a[96:99], v[40:43], 0
    ds_read_b128 v[52:55], v121 offset:3072
    v_cvt_pk_f16_f32 v24, v108, v109
    v_mfma_f32_16x16x32_bf16 v[68:71], a[120:123], v[40:43], 0
    ds_read_b128 v[40:43], v90 offset:41088
    v_cvt_pk_f16_f32 v25, v110, v111
    v_mfma_f32_16x16x32_bf16 v[84:87], a[76:79], v[144:147], v[84:87]
    ds_read_b32 v184, v184 offset:336
    v_pk_fma_f16 v250, v24, v24, s3
    v_mfma_f32_16x16x32_bf16 v[80:83], a[100:103], v[144:147], v[80:83]
    buffer_load_dwordx4 v33, s[32:35], s92 offen offset:2048 lds
    v_pk_fmac_f16 v250, v25, v25
    v_mfma_f32_16x16x32_bf16 v[12:15], a[124:127], v[144:147], v[12:15]
    s_waitcnt lgkmcnt(7)
    s_add_u32 m0, s90, 12288
    ds_read_b128 v[8:11], v90 offset:42624
    v_cvt_pk_f16_f32 v26, v60, v61
    v_mfma_f32_16x16x32_bf16 v[16:19], a[76:79], v[64:67], v[16:19]
    s_mov_b32 s92, 37632
    ds_read_b32 v185, v185 offset:336
    v_cvt_pk_f16_f32 v27, v62, v63
    v_mfma_f32_16x16x32_bf16 v[228:231], a[100:103], v[64:67], v[228:231]
    v_pk_fmac_f16 v250, v26, v26
    v_pk_fmac_f16 v250, v27, v27
    v_mfma_f32_16x16x32_bf16 v[224:227], a[124:127], v[64:67], v[224:227]
    s_waitcnt lgkmcnt(5)
    ds_read_b128 v[64:67], v90 offset:128
    v_cvt_pk_f16_f32 v146, v72, v73
    v_cvt_pk_f16_f32 v147, v74, v75
    v_mfma_f32_16x16x32_bf16 v[252:255], a[76:79], v[48:51], v[252:255]
    s_waitcnt vmcnt(9)
    ds_read_b64_tr_b16 a[84:85], v91 offset:36864
    buffer_load_dwordx4 v1, s[32:35], s92 offen offset:0 lds
    v_mfma_f32_16x16x32_bf16 v[20:23], a[100:103], v[48:51], v[20:23]
    ds_read_b64_tr_b16 a[86:87], v91 offset:37632
    v_pk_fmac_f16 v250, v146, v146
    v_mfma_f32_16x16x32_bf16 v[76:79], a[124:127], v[48:51], v[76:79]
    s_waitcnt lgkmcnt(5)
    ds_read_b64_tr_b16 a[108:109], v91 offset:36896
    v_pk_fmac_f16 v250, v147, v147
    v_mfma_f32_16x16x32_bf16 v[56:59], a[76:79], v[52:55], v[56:59]
    ds_read_b64_tr_b16 a[110:111], v91 offset:37664
    v_cvt_pk_f16_f32 v48, v92, v93
    v_mfma_f32_16x16x32_bf16 v[44:47], a[100:103], v[52:55], v[44:47]
    ds_read_b64_tr_b16 a[132:133], v91 offset:36928
    buffer_load_dwordx4 v0, s[32:35], s92 offen offset:1024 lds
    v_mfma_f32_16x16x32_bf16 v[68:71], a[124:127], v[52:55], v[68:71]
    ds_read_b64_tr_b16 a[134:135], v91 offset:37696
    v_cvt_pk_f16_f32 v49, v94, v95
    v_mfma_f32_16x16x32_bf16 v[156:159], a[80:83], v[40:43], v[156:159]
    ds_read_b128 v[60:63], v90 offset:1664
    v_pk_fma_f16 v32, v48, v48, s3
    v_mfma_f32_16x16x32_bf16 v[148:151], a[104:107], v[40:43], v[148:151]
    ds_read_b128 v[52:55], v90 offset:3200
    v_pk_fmac_f16 v32, v49, v49
    v_mfma_f32_16x16x32_bf16 v[100:103], a[128:131], v[40:43], v[100:103]
    s_waitcnt lgkmcnt(8)
    ds_read_b128 v[40:43], v121 offset:41088
    v_cvt_pk_f16_f32 v50, v168, v169
    v_mfma_f32_16x16x32_bf16 v[84:87], a[80:83], v[8:11], v[84:87]
    ds_read_b32 v186, v186 offset:336
    buffer_load_dwordx4 v33, s[32:35], s92 offen offset:2048 lds
    v_mfma_f32_16x16x32_bf16 v[80:83], a[104:107], v[8:11], v[80:83]
    s_add_u32 m0, s90, 24576
    v_cvt_pk_f16_f32 v51, v170, v171
    v_pk_fmac_f16 v32, v50, v50
    v_mfma_f32_16x16x32_bf16 v[12:15], a[128:131], v[8:11], v[12:15]
    s_mov_b32 s92, 74496
    ds_read_b128 v[8:11], v121 offset:42624
    v_pk_fmac_f16 v32, v51, v51
    v_mfma_f32_16x16x32_bf16 v[16:19], a[80:83], v[64:67], v[16:19]
    ds_read_b32 v187, v187 offset:336
    v_cvt_pk_f16_f32 v140, v140, v141
    v_cvt_pk_f16_f32 v141, v142, v143
    v_pk_fmac_f16 v32, v140, v140
    v_pk_fmac_f16 v32, v141, v141
    v_mfma_f32_16x16x32_bf16 v[228:231], a[104:107], v[64:67], v[228:231]
    ds_read_b32 v209, v5
    v_mov_b32 v34, 0
    v_mfma_f32_16x16x32_bf16 v[224:227], a[128:131], v[64:67], v[224:227]
    s_waitcnt lgkmcnt(6)
    buffer_load_dwordx4 v1, s[32:35], s92 offen offset:0 lds
    v_mov_b32 v35, 0
    v_mfma_f32_16x16x32_bf16 v[252:255], a[80:83], v[60:63], v[252:255]
    s_waitcnt vmcnt(10)
    ds_read_b64_tr_b16 a[88:89], v91 offset:49152
    v_mfma_f32_16x16x32_bf16 v[20:23], a[104:107], v[60:63], v[20:23]
    ds_read_b64_tr_b16 a[90:91], v91 offset:49920
    v_mfma_f32_16x16x32_bf16 v[76:79], a[128:131], v[60:63], v[76:79]
    s_waitcnt lgkmcnt(5)
    ds_read_b64_tr_b16 a[112:113], v91 offset:49184
    v_mfma_f32_16x16x32_bf16 v[56:59], a[80:83], v[52:55], v[56:59]
    ds_read_b64_tr_b16 a[114:115], v91 offset:49952
    v_mfma_f32_16x16x32_bf16 v[44:47], a[104:107], v[52:55], v[44:47]
    ds_read_b64_tr_b16 a[136:137], v91 offset:49216
    buffer_load_dwordx4 v0, s[32:35], s92 offen offset:1024 lds
    v_mfma_f32_16x16x32_bf16 v[68:71], a[128:131], v[52:55], v[68:71]
    ds_read_b64_tr_b16 a[138:139], v91 offset:49984
    v_mfma_f32_16x16x32_bf16 v[156:159], a[84:87], v[40:43], v[156:159]
    ds_read_b128 v[64:67], v121 offset:128
    v_mfma_f32_16x16x32_bf16 v[148:151], a[108:111], v[40:43], v[148:151]
    ds_read_b128 v[52:55], v121 offset:1664
    v_mfma_f32_16x16x32_bf16 v[100:103], a[132:135], v[40:43], v[100:103]
    s_waitcnt lgkmcnt(8)
    ds_read_b128 v[40:43], v121 offset:3200
    v_mfma_f32_16x16x32_bf16 v[84:87], a[84:87], v[8:11], v[84:87]
    buffer_load_dwordx4 v33, s[32:35], s92 offen offset:2048 lds
    ds_read_b128 v[72:75], v121 offset:41216
    v_mfma_f32_16x16x32_bf16 v[80:83], a[108:111], v[8:11], v[80:83]
    s_add_u32 m0, s90, 36864
    s_cmp_ge_u32 s2, 248
    s_cbranch_scc1 L_maskF
L_nomaskF:
    v_mfma_f32_16x16x32_bf16 v[12:15], a[132:135], v[8:11], v[12:15]
    s_waitcnt vmcnt(9)
    s_mov_b32 s92, 111360
    ds_read_b128 v[60:63], v121 offset:42752
    v_readlane_b32 s84, v211, 48
    v_cmp_gt_u32 vcc, 16, v97
    s_nop 0
    ds_read_b128 v[8:11], v121 offset:256
    v_cndmask_b32 v208, v2, v208, vcc
    v_cndmask_b32 v209, v2, v209, vcc
    v_cndmask_b32 v210, v2, v210, vcc
    buffer_load_dwordx4 v1, s[32:35], s92 offen offset:0 lds
    ds_read_b64_tr_b16 a[92:93], v91 offset:61440
    v_cmp_gt_u32 vcc, 49, v97
    s_waitcnt lgkmcnt(6)
    v_mfma_f32_16x16x32_bf16 v[16:19], a[84:87], v[64:67], v[16:19]
    ds_read_b64_tr_b16 a[94:95], v91 offset:62208
    v_cndmask_b32 v211, v2, v211, vcc
    v_mfma_f32_16x16x32_bf16 v[228:231], a[108:111], v[64:67], v[228:231]
    ds_read_b64_tr_b16 a[116:117], v91 offset:61472
    v_mfma_f32_16x16x32_bf16 v[224:227], a[132:135], v[64:67], v[224:227]
    s_waitcnt lgkmcnt(6)
    ds_read_b64_tr_b16 a[118:119], v91 offset:62240
    v_mfma_f32_16x16x32_bf16 v[252:255], a[84:87], v[52:55], v[252:255]
    ds_read_b64_tr_b16 a[140:141], v91 offset:61504
    buffer_load_dwordx4 v0, s[32:35], s92 offen offset:1024 lds
    v_mfma_f32_16x16x32_bf16 v[20:23], a[108:111], v[52:55], v[20:23]
    ds_read_b64_tr_b16 a[142:143], v91 offset:62272
    v_mfma_f32_16x16x32_bf16 v[76:79], a[132:135], v[52:55], v[76:79]
    ds_read_b128 v[64:67], v121 offset:1792
    v_mfma_f32_16x16x32_bf16 v[56:59], a[84:87], v[40:43], v[56:59]
    ds_read_b128 v[52:55], v121 offset:3328
    v_mfma_f32_16x16x32_bf16 v[44:47], a[108:111], v[40:43], v[44:47]
    ds_read_b128 v[108:111], v90 offset:41216
    v_mfma_f32_16x16x32_bf16 v[68:71], a[132:135], v[40:43], v[68:71]
    ds_read_b128 v[92:95], v90 offset:42752
    buffer_load_dwordx4 v33, s[32:35], s92 offen offset:2048 lds
    s_add_u32 m0, s90, 49152
    s_mov_b32 s92, 148224
    ds_read_b128 v[40:43], v90 offset:256
    buffer_load_dwordx4 v1, s[32:35], s92 offen offset:0 lds
    s_waitcnt vmcnt(10)
    ds_read_b64_tr_b16 a[144:145], v120 offset:0
    ds_read_b64_tr_b16 a[146:147], v120 offset:768
    ds_read_b64_tr_b16 a[168:169], v120 offset:8
    s_waitcnt lgkmcnt(5)
    v_mfma_f32_16x16x32_bf16 v[156:159], a[88:91], v[108:111], v[156:159]
    ds_read_b64_tr_b16 a[170:171], v120 offset:776
    v_mfma_f32_16x16x32_bf16 v[156:159], a[92:95], v[72:75], v[156:159]
    s_nop 0
    ds_read_b64_tr_b16 a[192:193], v91 offset:64
    v_mfma_f32_16x16x32_bf16 v[148:151], a[112:115], v[108:111], v[148:151]
    s_nop 0
    buffer_load_dwordx4 v0, s[32:35], s92 offen offset:1024 lds
    ds_read_b64_tr_b16 a[194:195], v91 offset:832
    v_mfma_f32_16x16x32_bf16 v[148:151], a[116:119], v[72:75], v[148:151]
    s_nop 0
    v_cvt_pk_f16_f32 v232, v156, v157
    v_cvt_pk_f16_f32 v233, v158, v159
    v_mfma_f32_16x16x32_bf16 v[100:103], a[136:139], v[108:111], v[100:103]
    v_pk_fma_f16 v165, v232, v232, s3
    v_pk_fmac_f16 v165, v233, v233
    v_mfma_f32_16x16x32_bf16 v[100:103], a[140:143], v[72:75], v[100:103]
    s_waitcnt lgkmcnt(6)
    ds_read_b128 v[72:75], v90 offset:1792
    v_cvt_pk_f16_f32 v234, v148, v149
    v_mfma_f32_16x16x32_bf16 v[84:87], a[88:91], v[92:95], v[84:87]
    v_cvt_pk_f16_f32 v235, v150, v151
    v_pk_fmac_f16 v165, v234, v234
    v_mfma_f32_16x16x32_bf16 v[84:87], a[92:95], v[60:63], v[84:87]
    buffer_load_dwordx4 v33, s[32:35], s92 offen offset:2048 lds
    v_pk_fmac_f16 v165, v235, v235
    v_mfma_f32_16x16x32_bf16 v[80:83], a[112:115], v[92:95], v[80:83]
    s_add_u32 m0, s90, 61440
    v_cvt_pk_f16_f32 v2, v100, v101
    v_cvt_pk_f16_f32 v3, v102, v103
    v_mfma_f32_16x16x32_bf16 v[80:83], a[116:119], v[60:63], v[80:83]
    s_mov_b32 s92, 185088
    v_cvt_pk_f16_f32 v84, v84, v85
    v_cvt_pk_f16_f32 v85, v86, v87
    v_mfma_f32_16x16x32_bf16 v[12:15], a[136:139], v[92:95], v[12:15]
    v_pk_fma_f16 v167, v84, v84, s3
    v_pk_fmac_f16 v167, v85, v85
    v_mfma_f32_16x16x32_bf16 v[12:15], a[140:143], v[60:63], v[12:15]
    ds_read_b128 v[60:63], v90 offset:3328
    v_cvt_pk_f16_f32 v86, v80, v81
    v_mfma_f32_16x16x32_bf16 v[16:19], a[88:91], v[40:43], v[16:19]
    s_waitcnt vmcnt(9)
    buffer_load_dwordx4 v1, s[32:35], s92 offen offset:0 lds
    ds_read_b64_tr_b16 a[148:149], v120 offset:12288
    v_mfma_f32_16x16x32_bf16 v[16:19], a[92:95], v[8:11], v[16:19]
    v_cvt_pk_f16_f32 v87, v82, v83
    v_pk_fmac_f16 v167, v86, v86
    v_mfma_f32_16x16x32_bf16 v[228:231], a[112:115], v[40:43], v[228:231]
    ds_read_b64_tr_b16 a[150:151], v120 offset:13056
    v_pk_fmac_f16 v167, v87, v87
    v_mfma_f32_16x16x32_bf16 v[228:231], a[116:119], v[8:11], v[228:231]
    ds_read_b64_tr_b16 a[172:173], v120 offset:12296
    v_cvt_pk_f16_f32 v102, v12, v13
    v_mfma_f32_16x16x32_bf16 v[224:227], a[136:139], v[40:43], v[224:227]
L_pg0:
    s_cbranch_execz L_main
    ds_read_b64_tr_b16 a[174:175], v120 offset:13064
    v_cvt_pk_f16_f32 v103, v14, v15
    v_mfma_f32_16x16x32_bf16 v[224:227], a[140:143], v[8:11], v[224:227]
    s_waitcnt lgkmcnt(5)
    buffer_load_dwordx4 v0, s[32:35], s92 offen offset:1024 lds
    ds_read_b64_tr_b16 a[196:197], v91 offset:12352
    v_mfma_f32_16x16x32_bf16 v[252:255], a[88:91], v[72:75], v[252:255]
    ds_read_b64_tr_b16 a[198:199], v91 offset:13120
    v_pk_fmac_f16 v167, v102, v102
    v_mfma_f32_16x16x32_bf16 v[252:255], a[92:95], v[64:67], v[252:255]
    ds_read_b128 v[8:11], v90 offset:40960
    v_pk_fmac_f16 v167, v103, v103
    v_mfma_f32_16x16x32_bf16 v[20:23], a[112:115], v[72:75], v[20:23]
    ds_read_b128 v[40:43], v90 offset:0
    v_cvt_pk_f16_f32 v12, v16, v17
    v_mfma_f32_16x16x32_bf16 v[20:23], a[116:119], v[64:67], v[20:23]
    v_cvt_pk_f16_f32 v13, v18, v19
    v_pk_fma_f16 v249, v12, v12, s3
    v_mfma_f32_16x16x32_bf16 v[76:79], a[136:139], v[72:75], v[76:79]
    buffer_load_dwordx4 v33, s[32:35], s92 offen offset:2048 lds
    v_pk_fmac_f16 v249, v13, v13
    v_mfma_f32_16x16x32_bf16 v[76:79], a[140:143], v[64:67], v[76:79]
    s_waitcnt lgkmcnt(6)
    s_add_u32 m0, s54, 20480
    ds_read_b128 v[80:83], v90 offset:1536
    v_cvt_pk_f16_f32 v14, v228, v229
    v_mfma_f32_16x16x32_bf16 v[56:59], a[88:91], v[60:63], v[56:59]
    s_mov_b32 s53, s47
    v_cvt_pk_f16_f32 v15, v230, v231
    v_pk_fmac_f16 v249, v14, v14
    v_mfma_f32_16x16x32_bf16 v[56:59], a[92:95], v[52:55], v[56:59]
    s_mov_b32 s47, s46
    v_pk_fmac_f16 v249, v15, v15
    v_cvt_pk_f16_f32 v154, v224, v225
    v_mfma_f32_16x16x32_bf16 v[44:47], a[112:115], v[60:63], v[44:47]
    s_mov_b32 s46, s45
    ds_read_b128 v[72:75], v90 offset:3072
    v_cvt_pk_f16_f32 v155, v226, v227
    v_mfma_f32_16x16x32_bf16 v[44:47], a[116:119], v[52:55], v[44:47]
    s_waitcnt vmcnt(9)
    s_mov_b32 s45, s44
    ds_read_b64_tr_b16 a[152:153], v120 offset:24576
    buffer_load_dwordx4 v128, s[24:27], s56 offen nt lds
    v_mfma_f32_16x16x32_bf16 v[68:71], a[136:139], v[60:63], v[68:71]
    s_add_u32 m0, s54, 21504
    ds_read_b64_tr_b16 a[154:155], v120 offset:25344
    v_pk_fmac_f16 v249, v154, v154
    v_mfma_f32_16x16x32_bf16 v[68:71], a[140:143], v[52:55], v[68:71]
    s_waitcnt lgkmcnt(4)
    s_mov_b32 s44, s53
    ds_read_b64_tr_b16 a[176:177], v120 offset:24584
    v_pk_fmac_f16 v249, v155, v155
    v_mfma_f32_16x16x32_bf16 v[168:171], a[144:147], v[8:11], 0
    s_sub_u32 s48, s44, s46
    ds_read_b64_tr_b16 a[178:179], v120 offset:25352
    v_cvt_pk_f16_f32 v56, v56, v57
    v_mfma_f32_16x16x32_bf16 v[156:159], a[168:171], v[8:11], 0
    s_sub_u32 s49, s46, s45
    ds_read_b64_tr_b16 a[200:201], v91 offset:24640
    v_cvt_pk_f16_f32 v57, v58, v59
    v_mfma_f32_16x16x32_bf16 v[52:55], a[192:195], v[8:11], 0
    s_sub_u32 s50, s45, s44
    ds_read_b64_tr_b16 a[202:203], v91 offset:25408
    buffer_load_dwordx4 v127, s[24:27], s56 offen nt lds
    ds_read_b128 v[64:67], v121 offset:40960
    v_pk_fma_f16 v33, v56, v56, s3
    s_add_u32 m0, s54, 22528
    v_pk_fmac_f16 v33, v57, v57
    v_mfma_f32_16x16x32_bf16 v[244:247], v[40:43], a[144:147], 0
    s_sub_u32 s51, s46, s47
    ds_read_b128 v[8:11], v121 offset:0
    v_cvt_pk_f16_f32 v58, v44, v45
    v_mfma_f32_16x16x32_bf16 v[16:19], v[40:43], a[168:171], 0
    s_mov_b32 s60, s59
    v_cvt_pk_f16_f32 v59, v46, v47
    v_pk_fmac_f16 v33, v58, v58
    v_pk_fmac_f16 v33, v59, v59
    v_mfma_f32_16x16x32_bf16 v[240:243], v[40:43], a[192:195], 0
    s_waitcnt lgkmcnt(6)
    s_mov_b32 s59, s58
    ds_read_b128 v[44:47], v121 offset:1536
    v_cvt_pk_f16_f32 v142, v68, v69
    v_mfma_f32_16x16x32_bf16 v[60:63], v[80:83], a[144:147], 0
    s_mov_b32 s58, s57
    buffer_load_dwordx4 v126, s[24:27], s56 offen nt lds
    v_cvt_pk_f16_f32 v143, v70, v71
    v_pk_fmac_f16 v33, v142, v142
    v_pk_fmac_f16 v33, v143, v143
    s_add_u32 m0, s54, 23552
    v_pk_fmac_f16 v165, v2, v2
    v_mfma_f32_16x16x32_f16 v[40:43], v[212:215], v[32:35], 0
    s_mov_b32 s57, s56
    v_pk_fmac_f16 v165, v3, v3
    v_add_u32 v137, s48, v137
    v_mfma_f32_16x16x32_bf16 v[68:71], v[80:83], a[168:171], 0
    s_mov_b32 s7, s6
    ds_read_b128 v[32:35], v121 offset:3072
    v_add_u32 v136, s48, v136
    v_mfma_f32_16x16x32_bf16 v[108:111], v[80:83], a[192:195], 0
    s_mov_b32 s6, s5
    v_add_u32 v135, s49, v135
    v_add_u32 v134, s49, v134
    v_mfma_f32_16x16x32_bf16 v[98:101], v[72:75], a[144:147], 0
    s_waitcnt vmcnt(9)
    s_mov_b32 s5, s4
    ds_read_b64_tr_b16 a[156:157], v120 offset:36864
    buffer_load_dwordx4 v125, s[24:27], s56 offen nt lds
    v_mfma_f32_16x16x32_bf16 v[80:83], v[72:75], a[168:171], 0
    s_add_u32 m0, s54, 24576
    ds_read_b64_tr_b16 a[158:159], v120 offset:37632
    v_add_u32 v137, s50, v137
    v_mfma_f32_16x16x32_bf16 v[236:239], v[72:75], a[192:195], 0
    s_waitcnt lgkmcnt(4)
    s_sub_u32 s14, s6, s7
    ds_read_b64_tr_b16 a[180:181], v120 offset:36872
    v_add_u32 v136, s50, v136
    v_mfma_f32_16x16x32_bf16 v[168:171], a[148:151], v[64:67], v[168:171]
    s_add_u32 s61, s61, 1
    ds_read_b64_tr_b16 a[182:183], v120 offset:37640
    v_add_u32 v135, s48, v135
    v_mfma_f32_16x16x32_bf16 v[156:159], a[172:175], v[64:67], v[156:159]
    s_add_u32 s12, s12, 20
    ds_read_b64_tr_b16 a[204:205], v91 offset:36928
    v_add_u32 v134, s48, v134
    v_mfma_f32_16x16x32_bf16 v[52:55], a[196:199], v[64:67], v[52:55]
    s_max_u32 s12, s12, s61
    ds_read_b64_tr_b16 a[206:207], v91 offset:37696
    buffer_load_dwordx4 v124, s[24:27], s56 offen nt lds
    v_mfma_f32_16x16x32_bf16 v[244:247], v[8:11], a[148:151], v[244:247]
    s_cmp_lt_u32 s61, s71
    ds_read_b128 v[72:75], v90 offset:41088
    v_add_u32 v133, s51, v133
    v_mfma_f32_16x16x32_bf16 v[16:19], v[8:11], a[172:175], v[16:19]
    s_cselect_b32 s15, s61, s12
    ds_read_b128 v[64:67], v90 offset:128
    v_add_u32 v132, s14, v132
    v_mfma_f32_16x16x32_bf16 v[240:243], v[8:11], a[196:199], v[240:243]
    s_waitcnt lgkmcnt(8)
    s_cselect_b32 s56, s69, s70
    ds_read_b128 v[92:95], v90 offset:1664
    v_add_u32 v131, s14, v131
    v_mfma_f32_16x16x32_bf16 v[60:63], v[44:47], a[148:151], v[60:63]
    s_add_u32 s56, s56, s15
    v_cvt_pk_f16_f32 v8, v252, v253
    v_cvt_pk_f16_f32 v9, v254, v255
    v_mfma_f32_16x16x32_bf16 v[68:71], v[44:47], a[172:175], v[68:71]
    s_mul_i32 s53, s56, 58255
    buffer_load_dword v96, v126, s[28:31], s72 offen nt
    v_pk_fma_f16 v251, v8, v8, s3
    v_mfma_f32_16x16x32_bf16 v[108:111], v[44:47], a[196:199], v[108:111]
    s_lshr_b32 s53, s53, 22
    ds_read_b128 v[44:47], v90 offset:3200
    v_pk_fmac_f16 v251, v9, v9
    v_mfma_f32_16x16x32_bf16 v[98:101], v[32:35], a[148:151], v[98:101]
    s_mul_i32 s53, s53, s63
    v_cvt_pk_f16_f32 v10, v20, v21
    v_cvt_pk_f16_f32 v11, v22, v23
    v_mfma_f32_16x16x32_bf16 v[80:83], v[32:35], a[172:175], v[80:83]
    s_mul_i32 s56, s56, s62
    v_pk_fmac_f16 v251, v10, v10
    v_pk_fmac_f16 v251, v11, v11
    v_mfma_f32_16x16x32_bf16 v[236:239], v[32:35], a[196:199], v[236:239]
    s_add_u32 s56, s56, s53
    ds_read_b128 v[116:119], v121 offset:41088
    v_cvt_pk_f16_f32 v148, v76, v77
    v_mfma_f32_16x16x32_f16 v[32:35], v[212:215], v[164:167], 0
    s_waitcnt vmcnt(9) lgkmcnt(4)
    s_mul_i32 s4, s15, 112
    ds_read_b64_tr_b16 a[160:161], v120 offset:49152
    v_cvt_pk_f16_f32 v149, v78, v79
    v_mfma_f32_16x16x32_bf16 v[168:171], a[152:155], v[72:75], v[168:171]
    s_cmp_ge_u32 s15, 16
    ds_read_b64_tr_b16 a[162:163], v120 offset:49920
    v_pk_fmac_f16 v251, v148, v148
    v_mfma_f32_16x16x32_bf16 v[156:159], a[176:179], v[72:75], v[156:159]
    s_cselect_b32 s53, -30464, 0
    ds_read_b64_tr_b16 a[184:185], v120 offset:49160
    v_or3_b32 v123, v123, v32, v33
    v_mfma_f32_16x16x32_bf16 v[52:55], a[200:203], v[72:75], v[52:55]
    s_waitcnt lgkmcnt(5)
    s_add_u32 s4, s4, s53
    ds_read_b64_tr_b16 a[186:187], v120 offset:49928
    v_or3_b32 v123, v123, v34, v35
    v_mfma_f32_16x16x32_bf16 v[244:247], v[64:67], a[152:155], v[244:247]
    s_cmp_lt_u32 s15, s73
    ds_read_b64_tr_b16 a[208:209], v91 offset:49216
    v_pk_fmac_f16 v251, v149, v149
    v_mfma_f32_16x16x32_bf16 v[16:19], v[64:67], a[176:179], v[16:19]
    s_cselect_b32 s26, 100270464, 0
    ds_read_b64_tr_b16 a[210:211], v91 offset:49984
    v_mfma_f32_16x16x32_bf16 v[240:243], v[64:67], a[200:203], v[240:243]
    s_cselect_b32 s56, s56, 0
    ds_read_b128 v[72:75], v121 offset:128
    v_mfma_f32_16x16x32_bf16 v[60:63], v[92:95], a[152:155], v[60:63]
    s_cselect_b32 s4, s4, -1
    ds_read_b128 v[64:67], v121 offset:1664
    v_mfma_f32_16x16x32_bf16 v[68:71], v[92:95], a[176:179], v[68:71]
    s_cselect_b32 s15, s15, 0
    ds_read_b128 v[76:79], v121 offset:3200
    v_mfma_f32_16x16x32_bf16 v[108:111], v[92:95], a[200:203], v[108:111]
    s_waitcnt lgkmcnt(8)
    s_cselect_b32 s13, s13, -1
    v_rsq_f32 v32, v32
    v_mfma_f32_16x16x32_bf16 v[98:101], v[44:47], a[152:155], v[98:101]
    s_bitset1_b32 s64, s15
    v_rsq_f32 v33, v33
    v_mfma_f32_16x16x32_bf16 v[80:83], v[44:47], a[176:179], v[80:83]
    s_add_u32 s65, s65, 1
    v_rsq_f32 v34, v34
    v_mfma_f32_16x16x32_bf16 v[236:239], v[44:47], a[200:203], v[236:239]
    s_cmp_ge_i32 s65, 2
    ds_read_b128 v[44:47], v121 offset:41216
    v_mul_f32 v32, s52, v32
    v_mfma_f32_16x16x32_bf16 v[168:171], a[156:159], v[116:119], v[168:171]
    s_cselect_b32 s30, 100270464, 0
    ds_read_b128 v[20:23], v121 offset:256
    v_cvt_pk_f16_f32 v32, v32, v33
    v_mfma_f32_16x16x32_bf16 v[156:159], a[180:183], v[116:119], v[156:159]
    s_add_u32 s67, s46, s54
    ds_read_b128 v[92:95], v121 offset:1792
    v_mul_f32 v34, s52, v34
    v_mfma_f32_16x16x32_bf16 v[52:55], a[204:207], v[116:119], v[52:55]
    s_waitcnt vmcnt(6) lgkmcnt(5)
    ds_read_b64_tr_b16 a[164:165], v120 offset:61440
    v_pk_mul_f16 v160, v160, v32 op_sel:[0,0] op_sel_hi:[1,0]
    v_mfma_f32_16x16x32_bf16 v[244:247], v[72:75], a[156:159], v[244:247]
    ds_read_b64_tr_b16 a[166:167], v120 offset:62208
    v_pk_mul_f16 v161, v161, v32 op_sel:[0,0] op_sel_hi:[1,0]
    v_mfma_f32_16x16x32_bf16 v[16:19], v[72:75], a[180:183], v[16:19]
    ds_read_b64_tr_b16 a[188:189], v120 offset:61448
    v_pk_mul_f16 v162, v162, v32 op_sel:[0,0] op_sel_hi:[1,0]
    v_mfma_f32_16x16x32_bf16 v[240:243], v[72:75], a[204:207], v[240:243]
    s_waitcnt lgkmcnt(6)
    ds_read_b64_tr_b16 a[190:191], v120 offset:62216
    v_pk_mul_f16 v163, v163, v32 op_sel:[0,0] op_sel_hi:[1,0]
    v_mfma_f32_16x16x32_bf16 v[60:63], v[64:67], a[156:159], v[60:63]
    ds_read_b64_tr_b16 a[212:213], v91 offset:61504
    v_pk_mul_f16 v6, v6, v32 op_sel:[0,0] op_sel_hi:[1,0]
    v_mfma_f32_16x16x32_bf16 v[68:71], v[64:67], a[180:183], v[68:71]
    ds_read_b64_tr_b16 a[214:215], v91 offset:62272
    v_pk_mul_f16 v7, v7, v32 op_sel:[0,0] op_sel_hi:[1,0]
    v_mfma_f32_16x16x32_bf16 v[108:111], v[64:67], a[204:207], v[108:111]
    ds_read_b128 v[64:67], v121 offset:3328
    v_pk_mul_f16 v232, v232, v32 op_sel:[0,1] op_sel_hi:[1,1]
    v_mfma_f32_16x16x32_bf16 v[98:101], v[76:79], a[156:159], v[98:101]
    ds_read_b128 v[72:75], v90 offset:41216
    v_pk_mul_f16 v233, v233, v32 op_sel:[0,1] op_sel_hi:[1,1]
    v_mfma_f32_16x16x32_bf16 v[80:83], v[76:79], a[180:183], v[80:83]
    ds_read_b128 v[164:167], v90 offset:256
    v_pk_mul_f16 v234, v234, v32 op_sel:[0,1] op_sel_hi:[1,1]
    v_mfma_f32_16x16x32_bf16 v[236:239], v[76:79], a[204:207], v[236:239]
    ds_read_b128 v[116:119], v90 offset:1792
    v_pk_mul_f16 v235, v235, v32 op_sel:[0,1] op_sel_hi:[1,1]
    v_mfma_f32_16x16x32_f16 v[76:79], v[212:215], v[248:251], 0
    v_rsq_f32 v35, v35
    v_pk_mul_f16 v2, v2, v32 op_sel:[0,1] op_sel_hi:[1,1]
    v_cvt_pk_f16_f32 v34, v34, v35
    v_pk_mul_f16 v3, v3, v32 op_sel:[0,1] op_sel_hi:[1,1]
    v_fma_mix_f32 v138, v160, v232, 0 op_sel:[0,0,0] op_sel_hi:[1,1,0]
    v_fma_mix_f32 v138, v160, v232, v138 op_sel:[1,1,0] op_sel_hi:[1,1,0]
    v_fma_mix_f32 v138, v161, v233, v138 op_sel:[0,0,0] op_sel_hi:[1,1,0]
    v_fma_mix_f32 v138, v161, v233, v138 op_sel:[1,1,0] op_sel_hi:[1,1,0]
    v_fma_mix_f32 v138, v162, v234, v138 op_sel:[0,0,0] op_sel_hi:[1,1,0]
    v_fma_mix_f32 v138, v162, v234, v138 op_sel:[1,1,0] op_sel_hi:[1,1,0]
    v_fma_mix_f32 v138, v163, v235, v138 op_sel:[0,0,0] op_sel_hi:[1,1,0]
    v_fma_mix_f32 v138, v163, v235, v138 op_sel:[1,1,0] op_sel_hi:[1,1,0]
    v_fma_mix_f32 v138, v6, v2, v138 op_sel:[0,0,0] op_sel_hi:[1,1,0]
    v_fma_mix_f32 v138, v6, v2, v138 op_sel:[1,1,0] op_sel_hi:[1,1,0]
    v_fma_mix_f32 v138, v7, v3, v138 op_sel:[0,0,0] op_sel_hi:[1,1,0]
    v_fma_mix_f32 v138, v7, v3, v138 op_sel:[1,1,0] op_sel_hi:[1,1,0]
    v_mov_b32 v91, v138
    v_mov_b32 v144, 0
    v_mov_b32 v145, 0
    v_permlane32_swap_b32 v91, v138
    v_add_f32 v138, v91, v138
    s_waitcnt lgkmcnt(2)
    v_mfma_f32_16x16x32_bf16 v[168:171], a[160:163], v[72:75], v[168:171]
    v_mov_b32 v91, v138
    v_mov_b32 v139, 0
    v_mfma_f32_16x16x32_bf16 v[168:171], a[164:167], v[44:47], v[168:171]
    v_permlane16_swap_b32 v91, v138
    v_mfma_f32_16x16x32_bf16 v[156:159], a[184:187], v[72:75], v[156:159]
    v_add_f32 v138, v91, v138
    v_add_f32 v138, s84, v138
    v_mfma_f32_16x16x32_bf16 v[156:159], a[188:191], v[44:47], v[156:159]
    v_exp_f32 v138, v138
    v_mfma_f32_16x16x32_bf16 v[52:55], a[208:211], v[72:75], v[52:55]
    s_mov_b32 s53, s47
    ds_read_b128 v[72:75], v90 offset:3328
    v_cvt_pk_bf16_f32 v138, v138, 0
    v_mfma_f32_16x16x32_bf16 v[52:55], a[212:215], v[44:47], v[52:55]
    s_waitcnt lgkmcnt(1)
    s_mov_b32 s47, s46
    v_cmp_gt_u32 vcc, 16, v97
    v_add_u32 v47, 28672, v38
    v_mfma_f32_16x16x32_bf16 v[244:247], v[164:167], a[160:163], v[244:247]
    s_mov_b32 s46, s45
    ds_write_b128 v47, v[232:235]
    v_mfma_f32_16x16x32_bf16 v[244:247], v[20:23], a[164:167], v[244:247]
    s_mov_b32 s45, s44
    v_cndmask_b32 v138, 0, v138, vcc
    v_cvt_pk_bf16_f32 v42, v168, v169
    v_mfma_f32_16x16x32_bf16 v[16:19], v[164:167], a[184:187], v[16:19]
    s_sub_u32 s49, s46, s45
    v_cvt_pk_bf16_f32 v43, v170, v171
    v_cvt_pk_bf16_f32 v44, v156, v157
    v_mfma_f32_16x16x32_bf16 v[16:19], v[20:23], a[188:191], v[16:19]
    s_mov_b32 s44, s53
    ds_write2_b64 v47, v[144:145], v[144:145] offset0:2 offset1:3
    v_mfma_f32_16x16x32_bf16 v[240:243], v[164:167], a[208:211], v[240:243]
    s_sub_u32 s48, s44, s46
    v_cvt_pk_bf16_f32 v0, v244, v245
    v_cvt_pk_bf16_f32 v1, v246, v247
    v_mfma_f32_16x16x32_bf16 v[240:243], v[20:23], a[212:215], v[240:243]
    s_mul_i32 s93, s68, 18432
    v_cvt_pk_bf16_f32 v20, v16, v17
    v_cvt_pk_bf16_f32 v21, v18, v19
    v_mfma_f32_16x16x32_bf16 v[60:63], v[116:119], a[160:163], v[60:63]
    s_movk_i32 s92, 0
    ds_write_b128 v47, v[160:163] offset:32
    v_mfma_f32_16x16x32_bf16 v[60:63], v[92:95], a[164:167], v[60:63]
    s_nop 0
    v_cvt_pk_bf16_f32 v4, v240, v241
    v_cvt_pk_bf16_f32 v5, v242, v243
    v_mfma_f32_16x16x32_bf16 v[68:71], v[116:119], a[184:187], v[68:71]
    v_cvt_pk_bf16_f32 v45, v158, v159
    v_cvt_pk_bf16_f32 v46, v52, v53
    v_mfma_f32_16x16x32_bf16 v[68:71], v[92:95], a[188:191], v[68:71]
    ds_write2_b64 v47, v[2:3], v[144:145] offset0:6 offset1:7
    v_mfma_f32_16x16x32_bf16 v[108:111], v[116:119], a[208:211], v[108:111]
    s_nop 0
    v_cvt_pk_bf16_f32 v2, v60, v61
    v_cvt_pk_bf16_f32 v3, v62, v63
    v_mfma_f32_16x16x32_bf16 v[108:111], v[92:95], a[212:215], v[108:111]
    s_waitcnt lgkmcnt(2)
    s_nop 0
    v_cvt_pk_bf16_f32 v22, v68, v69
    v_cvt_pk_bf16_f32 v23, v70, v71
    v_mfma_f32_16x16x32_bf16 v[98:101], v[72:75], a[160:163], v[98:101]
    ds_write2_b64 v47, v[144:145], v[6:7] offset0:8 offset1:9
    v_mfma_f32_16x16x32_bf16 v[98:101], v[64:67], a[164:167], v[98:101]
    s_nop 0
    v_cvt_pk_bf16_f32 v6, v108, v109
    v_cvt_pk_bf16_f32 v7, v110, v111
    v_mfma_f32_16x16x32_bf16 v[80:83], v[72:75], a[184:187], v[80:83]
    v_mov_b32 v171, 0
    v_mov_b32 v167, 0
    v_mfma_f32_16x16x32_bf16 v[80:83], v[64:67], a[188:191], v[80:83]
    ds_write_b64 v47, v[138:139] offset:88
    v_mfma_f32_16x16x32_bf16 v[236:239], v[72:75], a[208:211], v[236:239]
    v_mov_b32 v163, 0
    v_mov_b32 v159, 0
    v_mfma_f32_16x16x32_bf16 v[236:239], v[64:67], a[212:215], v[236:239]
    ds_write_b64 v38, v[42:43] offset:28752
    global_load_dword v120, v122, s[38:39] offset:248 sc1
    v_mov_b32 v150, 0
    v_mov_b32 v151, 0
    v_mov_b32 v144, 0
    v_mov_b32 v145, 0
    v_mov_b32 v138, 0
    v_mov_b32 v139, 0
    v_cvt_pk_bf16_f32 v47, v54, v55
    ds_write_b128 v38, v[44:47] offset:28768
    v_or3_b32 v123, v123, v76, v77
    v_rsq_f32 v76, v76
    v_rsq_f32 v77, v77
    v_mul_f32 v76, s52, v76
    v_cvt_pk_f16_f32 v76, v76, v77
    v_or3_b32 v123, v123, v78, v79
    ds_read_b128 v[68:71], v132 offset:0
    v_or3_b32 v123, v123, v40, v41
    v_rsq_f32 v40, v40
    ds_read_b128 v[60:63], v132 offset:16
    v_rsq_f32 v41, v41
    v_mul_f32 v40, s52, v40
    ds_read_b128 v[16:19], v132 offset:48
    v_cvt_pk_f16_f32 v40, v40, v41
    v_pk_mul_f16 v56, v56, v40 op_sel:[0,1] op_sel_hi:[1,1]
    v_pk_mul_f16 v57, v57, v40 op_sel:[0,1] op_sel_hi:[1,1]
    v_pk_mul_f16 v58, v58, v40 op_sel:[0,1] op_sel_hi:[1,1]
    v_pk_mul_f16 v59, v59, v40 op_sel:[0,1] op_sel_hi:[1,1]
    v_pk_mul_f16 v142, v142, v40 op_sel:[0,1] op_sel_hi:[1,1]
    v_pk_mul_f16 v143, v143, v40 op_sel:[0,1] op_sel_hi:[1,1]
    v_pk_mul_f16 v48, v48, v40 op_sel:[0,0] op_sel_hi:[1,0]
    v_pk_mul_f16 v49, v49, v40 op_sel:[0,0] op_sel_hi:[1,0]
    v_pk_mul_f16 v50, v50, v40 op_sel:[0,0] op_sel_hi:[1,0]
    v_pk_mul_f16 v51, v51, v40 op_sel:[0,0] op_sel_hi:[1,0]
    v_pk_mul_f16 v140, v140, v40 op_sel:[0,0] op_sel_hi:[1,0]
    v_pk_mul_f16 v141, v141, v40 op_sel:[0,0] op_sel_hi:[1,0]
    v_rsq_f32 v78, v78
    v_rsq_f32 v79, v79
    v_mul_f32 v78, s52, v78
    v_cvt_pk_f16_f32 v78, v78, v79
    v_pk_mul_f16 v12, v12, v76 op_sel:[0,1] op_sel_hi:[1,1]
    v_pk_mul_f16 v13, v13, v76 op_sel:[0,1] op_sel_hi:[1,1]
    v_pk_mul_f16 v14, v14, v76 op_sel:[0,1] op_sel_hi:[1,1]
    v_pk_mul_f16 v15, v15, v76 op_sel:[0,1] op_sel_hi:[1,1]
    v_pk_mul_f16 v154, v154, v76 op_sel:[0,1] op_sel_hi:[1,1]
    v_pk_mul_f16 v155, v155, v76 op_sel:[0,1] op_sel_hi:[1,1]
    v_pk_mul_f16 v28, v28, v76 op_sel:[0,0] op_sel_hi:[1,0]
    v_pk_mul_f16 v29, v29, v76 op_sel:[0,0] op_sel_hi:[1,0]
    v_pk_mul_f16 v30, v30, v76 op_sel:[0,0] op_sel_hi:[1,0]
    v_pk_mul_f16 v31, v31, v76 op_sel:[0,0] op_sel_hi:[1,0]
    v_pk_mul_f16 v152, v152, v76 op_sel:[0,0] op_sel_hi:[1,0]
    v_pk_mul_f16 v153, v153, v76 op_sel:[0,0] op_sel_hi:[1,0]
    v_mfma_f32_16x16x32_f16 v[52:55], v[12:15], v[28:31], v[204:207]
    ds_read_b128 v[232:235], v90 offset:42496
    v_pk_mul_f16 v8, v8, v78 op_sel:[0,1] op_sel_hi:[1,1]
    v_mfma_f32_16x16x32_f16 v[52:55], v[152:155], v[150:153], v[52:55]
    ds_read_b128 v[228:231], v121 offset:42496
    v_pk_mul_f16 v9, v9, v78 op_sel:[0,1] op_sel_hi:[1,1]
    v_mfma_f32_16x16x32_f16 v[44:47], v[56:59], v[28:31], v[196:199]
    ds_read_b128 v[224:227], v90 offset:42624
    v_pk_mul_f16 v10, v10, v78 op_sel:[0,1] op_sel_hi:[1,1]
    v_mfma_f32_16x16x32_f16 v[44:47], v[140:143], v[150:153], v[44:47]
    s_waitcnt lgkmcnt(3)
    ds_read_b128 v[116:119], v121 offset:42624
    v_pk_mul_f16 v11, v11, v78 op_sel:[0,1] op_sel_hi:[1,1]
    v_mfma_f32_16x16x32_f16 v[40:43], v[68:71], v[28:31], v[208:211]
    s_add_u32 m0, s67, 0
    ds_read_b128 v[108:111], v90 offset:42752
    v_pk_mul_f16 v148, v148, v78 op_sel:[0,1] op_sel_hi:[1,1]
    v_mfma_f32_16x16x32_f16 v[40:43], v[60:63], v[12:15], v[40:43]
    ds_read_b128 v[92:95], v121 offset:42752
    v_pk_mul_f16 v149, v149, v78 op_sel:[0,1] op_sel_hi:[1,1]
    v_mfma_f32_16x16x32_f16 v[40:43], v[16:19], v[152:155], v[40:43]
    v_pk_mul_f16 v24, v24, v78 op_sel:[0,0] op_sel_hi:[1,0]
    v_pk_mul_f16 v25, v25, v78 op_sel:[0,0] op_sel_hi:[1,0]
    v_pk_mul_f16 v26, v26, v78 op_sel:[0,0] op_sel_hi:[1,0]
    v_pk_mul_f16 v27, v27, v78 op_sel:[0,0] op_sel_hi:[1,0]
    v_pk_mul_f16 v146, v146, v78 op_sel:[0,0] op_sel_hi:[1,0]
    v_pk_mul_f16 v147, v147, v78 op_sel:[0,0] op_sel_hi:[1,0]
    v_mfma_f32_16x16x32_f16 v[64:67], v[8:11], v[28:31], v[200:203]
    v_cvt_pk_bf16_f32 v164, v98, v99
    v_cvt_pk_bf16_f32 v165, v100, v101
    v_mfma_f32_16x16x32_f16 v[64:67], v[146:149], v[150:153], v[64:67]
    s_waitcnt lgkmcnt(5)
    v_cvt_pk_bf16_f32 v160, v80, v81
    v_cvt_pk_bf16_f32 v161, v82, v83
    v_mfma_f32_16x16x32_bf16 v[72:75], a[144:147], v[232:235], 0
    s_waitcnt lgkmcnt(4)
    v_cvt_pk_bf16_f32 v156, v236, v237
    v_cvt_pk_bf16_f32 v157, v238, v239
    v_mfma_f32_16x16x32_bf16 v[72:75], a[148:151], v[228:231], v[72:75]
    s_waitcnt lgkmcnt(3)
    v_exp_f32 v52, v52
    v_mfma_f32_16x16x32_bf16 v[72:75], a[152:155], v[224:227], v[72:75]
    s_waitcnt lgkmcnt(2)
    v_exp_f32 v53, v53
    v_mfma_f32_16x16x32_bf16 v[72:75], a[156:159], v[116:119], v[72:75]
    s_waitcnt vmcnt(1) lgkmcnt(0)
    v_exp_f32 v54, v54
    v_mfma_f32_16x16x32_bf16 v[72:75], a[160:163], v[108:111], v[72:75]
    s_barrier
    buffer_load_dwordx4 v128, s[24:27], s56 offen nt lds
    v_cvt_pk_bf16_f32 v52, v52, v53
    v_mfma_f32_16x16x32_bf16 v[72:75], a[164:167], v[92:95], v[72:75]
    s_add_u32 m0, s67, 1024
    v_exp_f32 v55, v55
    v_mfma_f32_16x16x32_bf16 v[28:31], a[168:171], v[232:235], 0
    s_nop 0
    v_cvt_pk_bf16_f32 v53, v54, v55
    v_add_u32 v137, s48, v137
    v_mfma_f32_16x16x32_bf16 v[28:31], a[172:175], v[228:231], v[28:31]
    s_nop 0
    v_cvt_pk_bf16_f32 v90, v72, v73
    v_cvt_pk_bf16_f32 v91, v74, v75
    v_mfma_f32_16x16x32_bf16 v[28:31], a[176:179], v[224:227], v[28:31]
    v_exp_f32 v64, v64
    v_mfma_f32_16x16x32_bf16 v[28:31], a[180:183], v[116:119], v[28:31]
    buffer_load_dwordx4 v127, s[24:27], s56 offen nt lds
    v_add_u32 v136, s48, v136
    v_mfma_f32_16x16x32_bf16 v[28:31], a[184:187], v[108:111], v[28:31]
    s_add_u32 m0, s67, 2048
    v_exp_f32 v65, v65
    v_mfma_f32_16x16x32_bf16 v[28:31], a[188:191], v[92:95], v[28:31]
    ds_read_u16 v166, v131 offset:80
    v_cvt_pk_bf16_f32 v54, v64, v65
    v_mfma_f32_16x16x32_bf16 v[72:75], a[192:195], v[232:235], 0
    ds_read_u16 v162, v131 offset:96
    v_lshl_add_u32 v121, v97, 4, s93
    v_mfma_f32_16x16x32_bf16 v[72:75], a[196:199], v[228:231], v[72:75]
    s_mov_b32 s93, 0
    ds_read_u16 v158, v131 offset:104
    v_cvt_pk_bf16_f32 v76, v28, v29
    v_mfma_f32_16x16x32_bf16 v[72:75], a[200:203], v[224:227], v[72:75]
    buffer_load_dwordx4 v126, s[24:27], s56 offen nt lds
    v_cvt_pk_bf16_f32 v77, v30, v31
    v_mfma_f32_16x16x32_bf16 v[72:75], a[204:207], v[116:119], v[72:75]
    s_add_u32 m0, s67, 3072
    v_exp_f32 v66, v66
    v_mfma_f32_16x16x32_bf16 v[72:75], a[208:211], v[108:111], v[72:75]
    v_exp_f32 v67, v67
    v_mfma_f32_16x16x32_bf16 v[72:75], a[212:215], v[92:95], v[72:75]
    s_nop 0
    v_exp_f32 v44, v44
    v_mfma_f32_16x16x32_f16 v[28:31], v[68:71], v[24:27], v[208:211]
    s_nop 0
    v_exp_f32 v45, v45
    v_mfma_f32_16x16x32_f16 v[28:31], v[60:63], v[8:11], v[28:31]
    s_nop 0
    buffer_load_dwordx4 v125, s[24:27], s56 offen nt lds
    v_cvt_pk_bf16_f32 v78, v72, v73
    v_mfma_f32_16x16x32_f16 v[28:31], v[16:19], v[146:149], v[28:31]
    s_add_u32 m0, s67, 4096
    v_cvt_pk_bf16_f32 v79, v74, v75
    v_cvt_pk_bf16_f32 v55, v66, v67
    v_mfma_f32_16x16x32_f16 v[228:231], v[68:71], v[48:51], v[208:211]
    s_nop 0
    v_exp_f32 v46, v46
    v_mfma_f32_16x16x32_f16 v[228:231], v[60:63], v[56:59], v[228:231]
    s_nop 0
    v_mov_b32_dpp v43, v31 quad_perm:[0,1,2,3] row_mask:0x2 bank_mask:0xf
    v_cvt_pk_bf16_f32 v168, v44, v45
    v_mfma_f32_16x16x32_f16 v[228:231], v[16:19], v[140:143], v[228:231]
    v_exp_f32 v47, v47
    v_mfma_f32_16x16x32_f16 v[16:19], v[12:15], v[24:27], v[192:195]
    buffer_load_dwordx4 v124, s[24:27], s56 offen nt lds
    v_cvt_pk_bf16_f32 v169, v46, v47
    v_mfma_f32_16x16x32_f16 v[16:19], v[152:155], v[144:147], v[16:19]
    v_exp_f32 v40, v40
    v_mfma_f32_16x16x32_f16 v[92:95], v[8:11], v[24:27], v[188:191]
    ds_read_b128 v[64:67], v137 offset:0
    v_mov_b32_dpp v43, v231 quad_perm:[0,1,2,3] row_mask:0x4 bank_mask:0xf
    v_mfma_f32_16x16x32_f16 v[92:95], v[146:149], v[144:147], v[92:95]
    v_exp_f32 v43, v43
    v_mfma_f32_16x16x32_f16 v[72:75], v[56:59], v[24:27], v[184:187]
    ds_read_b128 v[44:47], v137 offset:256
    v_cvt_pk_bf16_f32 v43, v43, v43
    v_mfma_f32_16x16x32_f16 v[72:75], v[140:143], v[144:147], v[72:75]
    ds_write_b16 v131, v43 offset:64
    v_mfma_f32_16x16x32_f16 v[80:83], v[12:15], v[48:51], v[180:183]
    ds_read_b128 v[236:239], v132 offset:48
    v_cvt_pk_bf16_f32 v170, v40, 0
    v_mfma_f32_16x16x32_f16 v[80:83], v[152:155], v[138:141], v[80:83]
    ds_read_b128 v[60:63], v132 offset:64
    s_nop 0
    v_mfma_f32_16x16x32_bf16 v[12:15], v[220:223], v[52:55], 0
    s_nop 0
    ds_read_b128 v[24:27], v136 offset:0
    s_nop 0
    v_mfma_f32_16x16x32_bf16 v[12:15], v[220:223], v[168:171], v[12:15]
    s_nop 0
    v_exp_f32 v80, v80
    v_mfma_f32_16x16x32_bf16 v[68:71], v[0:3], v[52:55], 0
    s_waitcnt lgkmcnt(6)
    v_exp_f32 v81, v81
    v_mfma_f32_16x16x32_bf16 v[68:71], v[164:167], v[168:171], v[68:71]
    v_exp_f32 v82, v82
    v_mfma_f32_16x16x32_bf16 v[240:243], v[20:23], v[52:55], 0
    v_exp_f32 v83, v83
    v_mfma_f32_16x16x32_bf16 v[240:243], v[160:163], v[168:171], v[240:243]
    ds_read_b128 v[40:43], v136 offset:256
    v_cvt_pk_bf16_f32 v80, v80, v81
    v_mfma_f32_16x16x32_bf16 v[108:111], v[4:7], v[52:55], 0
    v_exp_f32 v230, v230
    v_mfma_f32_16x16x32_bf16 v[108:111], v[156:159], v[168:171], v[108:111]
    v_exp_f32 v16, v16
    v_mfma_f32_16x16x32_f16 v[152:155], v[8:11], v[48:51], v[176:179]
    v_exp_f32 v17, v17
    v_mfma_f32_16x16x32_f16 v[152:155], v[146:149], v[138:141], v[152:155]
    ds_read_b128 v[52:55], v137 offset:128
    v_cvt_pk_bf16_f32 v81, v82, v83
    v_mfma_f32_16x16x32_f16 v[232:235], v[56:59], v[48:51], v[172:175]
    ds_read_b128 v[48:51], v136 offset:128
    v_cvt_pk_bf16_f32 v16, v16, v17
    v_mfma_f32_16x16x32_f16 v[232:235], v[140:143], v[138:141], v[232:235]
    s_waitcnt lgkmcnt(3)
    s_nop 0
    v_exp_f32 v152, v152
    v_mfma_f32_16x16x32_bf16 v[116:119], a[24:27], v[64:67], 0
    v_exp_f32 v153, v153
    v_mfma_f32_16x16x32_bf16 v[116:119], a[28:31], v[24:27], v[116:119]
    v_exp_f32 v154, v154
    v_exp_f32 v155, v155
    v_cvt_pk_bf16_f32 v82, v152, v153
    v_cvt_pk_bf16_f32 v83, v154, v155
    v_exp_f32 v232, v232
    v_exp_f32 v233, v233
    v_exp_f32 v234, v234
    v_exp_f32 v235, v235
    v_exp_f32 v18, v18
    v_exp_f32 v19, v19
    v_exp_f32 v92, v92
    s_waitcnt lgkmcnt(0)
    v_mfma_f32_16x16x32_bf16 v[116:119], a[32:35], v[52:55], v[116:119]
    v_exp_f32 v93, v93
    v_mfma_f32_16x16x32_bf16 v[116:119], a[36:39], v[48:51], v[116:119]
    v_cvt_pk_bf16_f32 v17, v18, v19
    v_cvt_pk_bf16_f32 v18, v92, v93
    v_mfma_f32_16x16x32_bf16 v[116:119], a[40:43], v[44:47], v[116:119]
    v_exp_f32 v94, v94
    v_mfma_f32_16x16x32_bf16 v[116:119], a[44:47], v[40:43], v[116:119]
    v_exp_f32 v95, v95
    v_mfma_f32_16x16x32_bf16 v[8:11], a[48:51], v[64:67], 0
    v_exp_f32 v72, v72
    v_mfma_f32_16x16x32_bf16 v[8:11], a[52:55], v[24:27], v[8:11]
    v_exp_f32 v73, v73
    v_mfma_f32_16x16x32_bf16 v[8:11], a[56:59], v[52:55], v[8:11]
    v_cvt_pk_bf16_f32 v19, v94, v95
    v_cvt_pk_bf16_f32 v168, v72, v73
    v_mfma_f32_16x16x32_bf16 v[8:11], a[60:63], v[48:51], v[8:11]
    v_exp_f32 v74, v74
    v_mfma_f32_16x16x32_bf16 v[8:11], a[64:67], v[44:47], v[8:11]
    v_exp_f32 v75, v75
    v_mfma_f32_16x16x32_bf16 v[8:11], a[68:71], v[40:43], v[8:11]
    v_cvt_pk_bf16_f32 v169, v74, v75
    v_cvt_pk_f16_f32 v30, v116, v117
    v_mfma_f32_16x16x32_bf16 v[224:227], a[120:123], v[64:67], 0
    s_nop 0
    v_exp_f32 v29, v29
    v_mfma_f32_16x16x32_bf16 v[224:227], a[124:127], v[24:27], v[224:227]
L_pg1:
    s_cbranch_execz L_main
    s_nop 0
    v_cvt_pk_bf16_f32 v170, v29, 0
    v_cvt_pk_f16_f32 v152, v8, v9
    v_mfma_f32_16x16x32_bf16 v[224:227], a[128:131], v[52:55], v[224:227]
    s_waitcnt vmcnt(5)
    v_readfirstlane_b32 s94, v120
    s_nop 1
    s_cmp_lt_u32 s94, 3
    s_cbranch_scc1 L_spin
L_spinr:
    v_mfma_f32_16x16x32_bf16 v[224:227], a[132:135], v[48:51], v[224:227]
    buffer_load_dwordx4 a[216:219], v121, s[76:79], s92 offen offset:0 sc1
    v_cvt_pk_f16_f32 v153, v10, v11
    v_mfma_f32_16x16x32_bf16 v[224:227], a[136:139], v[44:47], v[224:227]
    v_rcp_f32 v12, v12
    v_mfma_f32_16x16x32_bf16 v[224:227], a[140:143], v[40:43], v[224:227]
    v_mul_f32 v68, v68, v12
    v_mul_f32 v69, v69, v12
    v_mfma_f32_16x16x32_bf16 v[92:95], v[220:223], v[16:19], 0
    v_cvt_pk_bf16_f32 v68, v68, v69
    v_mul_f32 v70, v70, v12
    v_mfma_f32_16x16x32_bf16 v[92:95], v[220:223], v[168:171], v[92:95]
    v_mul_f32 v71, v71, v12
    v_cvt_pk_bf16_f32 v69, v70, v71
    v_mfma_f32_16x16x32_bf16 v[72:75], v[0:3], v[16:19], 0
    buffer_load_dwordx4 a[220:223], v121, s[76:79], s92 offen offset:1024 sc1
    v_mul_f32 v240, v240, v12
    v_mfma_f32_16x16x32_bf16 v[72:75], v[164:167], v[168:171], v[72:75]
    v_mul_f32 v241, v241, v12
    v_cvt_pk_bf16_f32 v70, v240, v241
    v_mfma_f32_16x16x32_bf16 v[56:59], v[20:23], v[16:19], 0
    v_mul_f32 v242, v242, v12
    v_mul_f32 v243, v243, v12
    v_mfma_f32_16x16x32_bf16 v[56:59], v[160:163], v[168:171], v[56:59]
    v_cvt_pk_bf16_f32 v71, v242, v243
    v_mul_f32 v108, v108, v12
    v_mfma_f32_16x16x32_bf16 v[8:11], v[4:7], v[16:19], 0
    v_mul_f32 v109, v109, v12
    v_cvt_pk_bf16_f32 v14, v108, v109
    v_mfma_f32_16x16x32_bf16 v[8:11], v[156:159], v[168:171], v[8:11]
    buffer_load_dwordx4 a[224:227], v121, s[76:79], s92 offen offset:2048 sc1
    v_cvt_pk_bf16_f32 v168, v232, v233
    v_mfma_f32_16x16x32_bf16 v[16:19], a[72:75], v[64:67], 0
    v_cvt_pk_bf16_f32 v169, v234, v235
    v_cvt_pk_bf16_f32 v170, v230, 0
    v_mfma_f32_16x16x32_bf16 v[16:19], a[76:79], v[24:27], v[16:19]
    v_mul_f32 v110, v110, v12
    v_mul_f32 v111, v111, v12
    v_mfma_f32_16x16x32_bf16 v[16:19], a[80:83], v[52:55], v[16:19]
    v_cvt_pk_bf16_f32 v15, v110, v111
    v_cvt_pk_f16_f32 v154, v224, v225
    v_mfma_f32_16x16x32_bf16 v[16:19], a[84:87], v[48:51], v[16:19]
    v_cvt_pk_f16_f32 v155, v226, v227
    v_cvt_pk_f16_f32 v31, v118, v119
    v_mfma_f32_16x16x32_bf16 v[16:19], a[88:91], v[44:47], v[16:19]
    buffer_load_dwordx4 a[228:231], v121, s[76:79], s92 offen offset:3072 sc1
    v_mfma_f32_16x16x32_bf16 v[16:19], a[92:95], v[40:43], v[16:19]
    s_movk_i32 s92, 4096
    ds_write_b32 v134, v15 offset:4
    v_mfma_f32_16x16x32_bf16 v[244:247], v[64:67], a[144:147], 0
    s_nop 0
    v_rcp_f32 v92, v92
    v_mfma_f32_16x16x32_bf16 v[244:247], v[24:27], a[148:151], v[244:247]
    s_nop 0
    v_mul_f32 v72, v72, v92
    v_cvt_pk_f16_f32 v12, v16, v17
    v_mfma_f32_16x16x32_bf16 v[244:247], v[52:55], a[152:155], v[244:247]
    v_cvt_pk_f16_f32 v13, v18, v19
    v_pk_fma_f16 v37, v12, v12, s3
    v_mfma_f32_16x16x32_bf16 v[244:247], v[48:51], a[156:159], v[244:247]
    buffer_load_dwordx4 a[232:235], v121, s[76:79], s92 offen offset:0 sc1
    v_pk_fmac_f16 v37, v13, v13
    v_mfma_f32_16x16x32_bf16 v[244:247], v[44:47], a[160:163], v[244:247]
    v_mul_f32 v73, v73, v92
    v_cvt_pk_bf16_f32 v248, v72, v73
    v_mfma_f32_16x16x32_bf16 v[244:247], v[40:43], a[164:167], v[244:247]
    v_mul_f32 v74, v74, v92
    v_mul_f32 v75, v75, v92
    v_mfma_f32_16x16x32_bf16 v[16:19], v[64:67], a[168:171], 0
    ds_read_b128 v[98:101], v137 offset:1536
    v_cvt_pk_bf16_f32 v249, v74, v75
    v_mfma_f32_16x16x32_bf16 v[16:19], v[24:27], a[172:175], v[16:19]
    ds_read_b128 v[140:143], v136 offset:1536
    v_mul_f32 v56, v56, v92
    v_mfma_f32_16x16x32_bf16 v[16:19], v[52:55], a[176:179], v[16:19]
    buffer_load_dwordx4 a[236:239], v121, s[76:79], s92 offen offset:1024 sc1
    v_mul_f32 v57, v57, v92
    v_mfma_f32_16x16x32_bf16 v[16:19], v[48:51], a[180:183], v[16:19]
    ds_read_b128 v[116:119], v137 offset:1664
    v_cvt_pk_bf16_f32 v250, v56, v57
    v_mfma_f32_16x16x32_bf16 v[16:19], v[44:47], a[184:187], v[16:19]
    v_mul_f32 v58, v58, v92
    v_mul_f32 v59, v59, v92
    v_mfma_f32_16x16x32_bf16 v[16:19], v[40:43], a[188:191], v[16:19]
    s_lshl_b32 s93, s68, 10
    v_cvt_pk_bf16_f32 v251, v58, v59
    v_mul_f32 v8, v8, v92
    v_mfma_f32_16x16x32_bf16 v[108:111], v[220:223], v[80:83], 0
    v_mul_f32 v9, v9, v92
    v_cvt_pk_bf16_f32 v28, v8, v9
    v_mfma_f32_16x16x32_bf16 v[108:111], v[220:223], v[168:171], v[108:111]
    buffer_load_dwordx4 a[240:243], v121, s[76:79], s92 offen offset:2048 sc1
    ds_read_b128 v[56:59], v136 offset:1792
    v_mfma_f32_16x16x32_bf16 v[72:75], v[0:3], v[80:83], 0
    v_mul_f32 v10, v10, v92
    v_mul_f32 v11, v11, v92
    v_mfma_f32_16x16x32_bf16 v[72:75], v[164:167], v[168:171], v[72:75]
    ds_write_b64 v135, v[68:69] offset:0
    v_mfma_f32_16x16x32_bf16 v[224:227], v[20:23], v[80:83], 0
    v_rcp_f32 v108, v108
    v_mfma_f32_16x16x32_bf16 v[224:227], v[160:163], v[168:171], v[224:227]
    ds_write_b64 v135, v[70:71] offset:8
    v_mfma_f32_16x16x32_bf16 v[68:71], v[4:7], v[80:83], 0
    s_nop 0
    buffer_load_dwordx4 a[244:247], v121, s[76:79], s92 offen offset:3072 sc1
    v_mul_f32 v72, v72, v108
    v_mfma_f32_16x16x32_bf16 v[68:71], v[156:159], v[168:171], v[68:71]
    s_movk_i32 s92, 8192
    ds_write_b32 v134, v14 offset:0
    v_mfma_f32_16x16x32_bf16 v[240:243], v[64:67], a[192:195], 0
    ds_read_b128 v[92:95], v136 offset:1664
    v_mul_f32 v73, v73, v108
    v_mfma_f32_16x16x32_bf16 v[240:243], v[24:27], a[196:199], v[240:243]
    v_cvt_pk_bf16_f32 v72, v72, v73
    v_mul_f32 v74, v74, v108
    v_mfma_f32_16x16x32_bf16 v[240:243], v[52:55], a[200:203], v[240:243]
    v_mul_f32 v75, v75, v108
    v_cvt_pk_bf16_f32 v73, v74, v75
    v_mfma_f32_16x16x32_bf16 v[240:243], v[48:51], a[204:207], v[240:243]
    buffer_load_dwordx4 a[248:251], v121, s[76:79], s92 offen offset:0 sc1
    v_mul_f32 v224, v224, v108
    v_mfma_f32_16x16x32_bf16 v[240:243], v[44:47], a[208:211], v[240:243]
    ds_write_b64 v135, v[72:73] offset:3072
    v_mfma_f32_16x16x32_bf16 v[240:243], v[40:43], a[212:215], v[240:243]
    v_mul_f32 v225, v225, v108
    v_cvt_pk_bf16_f32 v74, v224, v225
    v_mfma_f32_16x16x32_bf16 v[228:231], a[96:99], v[64:67], 0
    v_mul_f32 v226, v226, v108
    v_mul_f32 v227, v227, v108
    v_mfma_f32_16x16x32_bf16 v[228:231], a[100:103], v[24:27], v[228:231]
    ds_read_b128 v[80:83], v137 offset:1792
    v_cvt_pk_bf16_f32 v75, v226, v227
    v_mfma_f32_16x16x32_bf16 v[228:231], a[104:107], v[52:55], v[228:231]
    buffer_load_dwordx4 a[252:255], v121, s[76:79], s92 offen offset:1024 sc1
    v_mul_f32 v68, v68, v108
    v_mfma_f32_16x16x32_bf16 v[228:231], a[108:111], v[48:51], v[228:231]
    ds_write_b64 v135, v[74:75] offset:3080
    v_mfma_f32_16x16x32_bf16 v[228:231], a[112:115], v[44:47], v[228:231]
    v_mul_f32 v69, v69, v108
    v_cvt_pk_bf16_f32 v8, v68, v69
    v_mfma_f32_16x16x32_bf16 v[228:231], a[116:119], v[40:43], v[228:231]
    s_waitcnt lgkmcnt(3)
    ds_write_b32 v134, v8 offset:3072
    v_mfma_f32_16x16x32_bf16 v[72:75], a[48:51], v[98:101], 0
    v_mul_f32 v70, v70, v108
    v_mul_f32 v71, v71, v108
    v_mfma_f32_16x16x32_bf16 v[72:75], a[52:55], v[140:143], v[72:75]
    buffer_load_dwordx4 v[224:227], v121, s[76:79], s92 offen offset:2048 sc1
    v_cvt_pk_bf16_f32 v9, v70, v71
    v_mfma_f32_16x16x32_bf16 v[72:75], a[56:59], v[116:119], v[72:75]
    ds_write_b32 v134, v9 offset:3076
    v_mfma_f32_16x16x32_bf16 v[72:75], a[60:63], v[92:95], v[72:75]
    s_waitcnt lgkmcnt(3)
    v_cvt_pk_f16_f32 v14, v228, v229
    v_cvt_pk_f16_f32 v15, v230, v231
    v_mfma_f32_16x16x32_bf16 v[72:75], a[64:67], v[80:83], v[72:75]
    v_pk_fmac_f16 v37, v14, v14
    v_pk_fmac_f16 v37, v15, v15
    v_mfma_f32_16x16x32_bf16 v[72:75], a[68:71], v[56:59], v[72:75]
    v_pk_fmac_f16 v37, v154, v154
    v_pk_fmac_f16 v37, v155, v155
    v_mfma_f32_16x16x32_bf16 v[252:255], a[72:75], v[98:101], 0
    buffer_load_dwordx4 v[228:231], v121, s[76:79], s92 offen offset:3072 sc1
    v_cvt_pk_bf16_f32 v29, v10, v11
    v_mfma_f32_16x16x32_bf16 v[252:255], a[76:79], v[140:143], v[252:255]
    s_movk_i32 s92, 12288
    ds_write_b32 v135, v249 offset:1540
    v_mfma_f32_16x16x32_bf16 v[252:255], a[80:83], v[116:119], v[252:255]
    v_and_b32 v11, 0xb8000000, v123
    v_cmp_ne_u32 s[94:95], 0, v11
    v_mfma_f32_16x16x32_bf16 v[252:255], a[84:87], v[92:95], v[252:255]
    ds_write_b64 v134, v[28:29] offset:1536
    v_mfma_f32_16x16x32_bf16 v[252:255], a[88:91], v[80:83], v[252:255]
    s_or_b32 s94, s94, s95
    v_mov_b32 v11, s94
    v_add_u32 v147, s93, v129
    v_mfma_f32_16x16x32_bf16 v[252:255], a[92:95], v[56:59], v[252:255]
    s_lshl_b32 s95, s68, 2
    buffer_load_dwordx4 v[232:235], v121, s[76:79], s92 offen offset:0 sc1
    v_mov_b32 v10, s95
    v_mfma_f32_16x16x32_bf16 v[68:71], v[236:239], v[0:3], 0
    s_sub_u32 s50, s45, s44
    ds_write_b32 v135, v248 offset:1536
    v_mfma_f32_16x16x32_bf16 v[68:71], v[60:63], v[164:167], v[68:71]
    s_sub_u32 s51, s46, s47
    v_cvt_pk_f16_f32 v8, v252, v253
    v_cvt_pk_f16_f32 v9, v254, v255
    v_mfma_f32_16x16x32_bf16 v[108:111], v[236:239], v[20:23], 0
    s_mov_b32 s60, s59
    ds_write_b64 v135, v[250:251] offset:1544
    v_mfma_f32_16x16x32_bf16 v[108:111], v[60:63], v[160:163], v[108:111]
    s_mov_b32 s59, s58
    v_pk_fma_f16 v39, v8, v8, s3
    v_pk_fmac_f16 v39, v9, v9
    v_mfma_f32_16x16x32_bf16 v[20:23], v[236:239], v[4:7], 0
    s_mov_b32 s58, s57
    buffer_load_dwordx4 v[236:239], v121, s[76:79], s92 offen offset:1024 sc1
    v_cvt_pk_bf16_f32 v0, v244, v245
    v_mfma_f32_16x16x32_bf16 v[20:23], v[60:63], v[156:159], v[20:23]
    s_mov_b32 s57, s56
    v_cvt_pk_bf16_f32 v1, v246, v247
    v_mov_b32_dpp v71, v111 quad_perm:[0,1,2,3] row_mask:0x2 bank_mask:0xf
    v_mfma_f32_16x16x32_bf16 v[60:63], a[24:27], v[98:101], 0
    s_mov_b32 s7, s6
    v_cvt_pk_bf16_f32 v4, v240, v241
    v_cvt_pk_bf16_f32 v5, v242, v243
    v_mfma_f32_16x16x32_bf16 v[60:63], a[28:31], v[140:143], v[60:63]
    s_mov_b32 s6, s5
    v_mov_b32_dpp v71, v23 quad_perm:[0,1,2,3] row_mask:0x4 bank_mask:0xf
    v_cvt_pk_bf16_f32 v71, v71, v71
    v_mfma_f32_16x16x32_bf16 v[60:63], a[32:35], v[116:119], v[60:63]
    s_mov_b32 s5, s4
    ds_write_b16 v131, v71
    v_mfma_f32_16x16x32_bf16 v[60:63], a[36:39], v[92:95], v[60:63]
    s_sub_u32 s14, s6, s7
    buffer_load_dwordx4 v[240:243], v121, s[76:79], s92 offen offset:2048 sc1
    v_pk_mul_f16 v112, v112, v34 op_sel:[0,0] op_sel_hi:[1,0]
    v_mfma_f32_16x16x32_bf16 v[60:63], a[40:43], v[80:83], v[60:63]
    s_add_u32 s61, s61, 1
    v_pk_mul_f16 v113, v113, v34 op_sel:[0,0] op_sel_hi:[1,0]
    v_pk_mul_f16 v114, v114, v34 op_sel:[0,0] op_sel_hi:[1,0]
    v_mfma_f32_16x16x32_bf16 v[60:63], a[44:47], v[56:59], v[60:63]
    s_add_u32 s12, s12, 20
    v_pk_mul_f16 v115, v115, v34 op_sel:[0,0] op_sel_hi:[1,0]
    v_pk_mul_f16 v88, v88, v34 op_sel:[0,0] op_sel_hi:[1,0]
    v_mfma_f32_16x16x32_bf16 v[20:23], a[0:3], v[64:67], 0
    s_max_u32 s12, s12, s61
    v_add_u32 v135, s49, v135
    v_add_u32 v134, s49, v134
    v_mfma_f32_16x16x32_bf16 v[20:23], a[4:7], v[24:27], v[20:23]
    s_cmp_lt_u32 s61, s71
    v_cvt_pk_f16_f32 v26, v60, v61
    v_cvt_pk_f16_f32 v27, v62, v63
    v_mfma_f32_16x16x32_bf16 v[20:23], a[8:11], v[52:55], v[20:23]
    s_cselect_b32 s15, s61, s12
    buffer_load_dwordx4 v[244:247], v121, s[76:79], s92 offen offset:3072 sc1
    v_pk_mul_f16 v89, v89, v34 op_sel:[0,0] op_sel_hi:[1,0]
    v_mfma_f32_16x16x32_bf16 v[20:23], a[12:15], v[48:51], v[20:23]
    s_movk_i32 s92, 16384
    v_pk_mul_f16 v84, v84, v34 op_sel:[0,1] op_sel_hi:[1,1]
    v_pk_mul_f16 v85, v85, v34 op_sel:[0,1] op_sel_hi:[1,1]
    v_mfma_f32_16x16x32_bf16 v[20:23], a[16:19], v[44:47], v[20:23]
    s_cselect_b32 s56, s69, s70
    v_pk_mul_f16 v86, v86, v34 op_sel:[0,1] op_sel_hi:[1,1]
    v_pk_mul_f16 v87, v87, v34 op_sel:[0,1] op_sel_hi:[1,1]
    v_mfma_f32_16x16x32_bf16 v[20:23], a[20:23], v[40:43], v[20:23]
    s_add_u32 s56, s56, s15
    v_pk_mul_f16 v102, v102, v34 op_sel:[0,1] op_sel_hi:[1,1]
    v_pk_mul_f16 v103, v103, v34 op_sel:[0,1] op_sel_hi:[1,1]
    v_mfma_f32_16x16x32_bf16 v[60:63], v[98:101], a[144:147], 0
    s_mul_i32 s53, s56, 58255
    v_fma_mix_f32 v120, v112, v84, 0 op_sel:[0,0,0] op_sel_hi:[1,1,0]
    v_fma_mix_f32 v120, v112, v84, v120 op_sel:[1,1,0] op_sel_hi:[1,1,0]
    v_mfma_f32_16x16x32_bf16 v[60:63], v[140:143], a[148:151], v[60:63]
    s_lshr_b32 s53, s53, 22
    buffer_load_dwordx4 v[248:251], v121, s[76:79], s92 offen offset:0 sc1
    v_cvt_pk_f16_f32 v28, v20, v21
    v_mfma_f32_16x16x32_bf16 v[60:63], v[116:119], a[152:155], v[60:63]
    s_mul_i32 s53, s53, s63
    ds_read_b128 v[32:35], v137 offset:3328
    v_cvt_pk_f16_f32 v29, v22, v23
    v_mfma_f32_16x16x32_bf16 v[60:63], v[92:95], a[156:159], v[60:63]
    s_mul_i32 s56, s56, s62
    v_pk_fma_f16 v36, v28, v28, s3
    v_pk_fmac_f16 v36, v29, v29
    v_mfma_f32_16x16x32_bf16 v[60:63], v[80:83], a[160:163], v[60:63]
    s_add_u32 s56, s56, s53
    ds_read_b128 v[44:47], v136 offset:3328
    v_pk_fmac_f16 v36, v30, v30
    v_mfma_f32_16x16x32_bf16 v[60:63], v[56:59], a[164:167], v[60:63]
    s_mul_i32 s4, s15, 112
    v_pk_fmac_f16 v36, v31, v31
    v_pk_fmac_f16 v36, v152, v152
    v_mfma_f32_16x16x32_bf16 v[108:111], v[98:101], a[192:195], 0
    s_cmp_ge_u32 s15, 16
    buffer_load_dwordx4 v[252:255], v121, s[76:79], s92 offen offset:1024 sc1
    v_pk_fmac_f16 v36, v153, v153
    v_mfma_f32_16x16x32_bf16 v[108:111], v[140:143], a[196:199], v[108:111]
    s_cselect_b32 s53, -30464, 0
    ds_read_b128 v[40:43], v137 offset:3200
    v_fma_mix_f32 v120, v113, v85, v120 op_sel:[0,0,0] op_sel_hi:[1,1,0]
    v_mfma_f32_16x16x32_bf16 v[108:111], v[116:119], a[200:203], v[108:111]
    s_add_u32 s4, s4, s53
    ds_read_b128 v[48:51], v136 offset:3200
    v_fma_mix_f32 v120, v113, v85, v120 op_sel:[1,1,0] op_sel_hi:[1,1,0]
    v_mfma_f32_16x16x32_bf16 v[108:111], v[92:95], a[204:207], v[108:111]
    s_cmp_lt_u32 s15, s73
    v_fma_mix_f32 v120, v114, v86, v120 op_sel:[0,0,0] op_sel_hi:[1,1,0]
    v_fma_mix_f32 v120, v114, v86, v120 op_sel:[1,1,0] op_sel_hi:[1,1,0]
    v_mfma_f32_16x16x32_bf16 v[108:111], v[80:83], a[208:211], v[108:111]
    s_cselect_b32 s26, 100270464, 0
    v_fma_mix_f32 v120, v115, v87, v120 op_sel:[0,0,0] op_sel_hi:[1,1,0]
    v_fma_mix_f32 v120, v115, v87, v120 op_sel:[1,1,0] op_sel_hi:[1,1,0]
    v_mfma_f32_16x16x32_bf16 v[108:111], v[56:59], a[212:215], v[108:111]
    s_cselect_b32 s56, s56, 0
    ds_read_b128 v[64:67], v137 offset:3072
    v_fma_mix_f32 v120, v88, v102, v120 op_sel:[0,0,0] op_sel_hi:[1,1,0]
    v_mfma_f32_16x16x32_bf16 v[20:23], a[96:99], v[98:101], 0
    s_cselect_b32 s4, s4, -1
    ds_read_b128 v[52:55], v136 offset:3072
    v_fma_mix_f32 v120, v88, v102, v120 op_sel:[1,1,0] op_sel_hi:[1,1,0]
    v_mfma_f32_16x16x32_bf16 v[20:23], a[100:103], v[140:143], v[20:23]
    s_cselect_b32 s15, s15, 0
    v_cvt_pk_bf16_f32 v6, v108, v109
    v_cvt_pk_bf16_f32 v7, v110, v111
    v_mfma_f32_16x16x32_bf16 v[20:23], a[104:107], v[116:119], v[20:23]
    s_cselect_b32 s13, s13, -1
    v_fma_mix_f32 v120, v89, v103, v120 op_sel:[0,0,0] op_sel_hi:[1,1,0]
    v_fma_mix_f32 v120, v89, v103, v120 op_sel:[1,1,0] op_sel_hi:[1,1,0]
    v_mfma_f32_16x16x32_bf16 v[20:23], a[108:111], v[92:95], v[20:23]
    s_bitset1_b32 s64, s15
    v_mov_b32 v121, v120
    v_cvt_pk_f16_f32 v146, v72, v73
    v_mfma_f32_16x16x32_bf16 v[20:23], a[112:115], v[80:83], v[20:23]
    s_add_u32 s65, s65, 1
    v_permlane32_swap_b32 v121, v120
    v_mfma_f32_16x16x32_bf16 v[20:23], a[116:119], v[56:59], v[20:23]
    s_cmp_ge_i32 s65, 2
    ds_write_b32 v10, v11 offset:14848
    v_mfma_f32_16x16x32_bf16 v[68:71], v[98:101], a[168:171], 0
    s_cselect_b32 s30, 100270464, 0
    v_add_f32 v120, v121, v120
    v_mov_b32 v121, v120
    v_mfma_f32_16x16x32_bf16 v[68:71], v[140:143], a[172:175], v[68:71]
    s_add_u32 s67, s46, s54
    v_cvt_pk_f16_f32 v10, v20, v21
    v_cvt_pk_f16_f32 v11, v22, v23
    v_mfma_f32_16x16x32_bf16 v[68:71], v[116:119], a[176:179], v[68:71]
    s_add_u32 m0, s67, 0
    v_pk_fmac_f16 v39, v10, v10
    v_pk_fmac_f16 v39, v11, v11
    v_mfma_f32_16x16x32_bf16 v[68:71], v[92:95], a[180:183], v[68:71]
    ds_write_b128 v147, v[104:107] offset:6144
    v_mfma_f32_16x16x32_bf16 v[68:71], v[80:83], a[184:187], v[68:71]
    v_permlane16_swap_b32 v121, v120
    v_mfma_f32_16x16x32_bf16 v[68:71], v[56:59], a[188:191], v[68:71]
    s_nop 0
    v_add_f32 v120, v121, v120
    v_add_f32 v120, s84, v120
    v_mfma_f32_16x16x32_bf16 v[108:111], a[0:3], v[98:101], 0
    s_nop 0
    ds_write_b64 v38, v[90:91] offset:80
    v_mfma_f32_16x16x32_bf16 v[108:111], a[4:7], v[140:143], v[108:111]
    s_nop 0
    v_cvt_pk_bf16_f32 v22, v68, v69
    v_cvt_pk_bf16_f32 v23, v70, v71
    v_mfma_f32_16x16x32_bf16 v[108:111], a[8:11], v[116:119], v[108:111]
    ds_write_b128 v38, v[76:79] offset:96
    v_mfma_f32_16x16x32_bf16 v[108:111], a[12:15], v[92:95], v[108:111]
    v_mov_b32 v2, 0
    v_mov_b32 v3, 0
    v_mfma_f32_16x16x32_bf16 v[108:111], a[16:19], v[80:83], v[108:111]
    v_mov_b32 v121, 0
    v_add_u32 v20, 0, v38
    v_mfma_f32_16x16x32_bf16 v[108:111], a[20:23], v[56:59], v[108:111]
    s_nop 0
    ds_write2_b64 v20, v[2:3], v[2:3] offset0:2 offset1:3
    v_mfma_f32_16x16x32_bf16 v[76:79], a[120:123], v[98:101], 0
    s_nop 0
    v_exp_f32 v120, v120
    v_mfma_f32_16x16x32_bf16 v[76:79], a[124:127], v[140:143], v[76:79]
    s_nop 0
    v_cvt_pk_bf16_f32 v120, v120, 0
    v_cvt_pk_f16_f32 v24, v108, v109
    v_mfma_f32_16x16x32_bf16 v[76:79], a[128:131], v[116:119], v[76:79]
    ds_write_b128 v20, v[112:115] offset:32
    v_mfma_f32_16x16x32_bf16 v[76:79], a[132:135], v[92:95], v[76:79]
    v_cvt_pk_f16_f32 v25, v110, v111
    v_pk_fma_f16 v38, v24, v24, s3
    v_mfma_f32_16x16x32_bf16 v[76:79], a[136:139], v[80:83], v[76:79]
    v_pk_fmac_f16 v38, v25, v25
    v_pk_fmac_f16 v38, v26, v26
    v_mfma_f32_16x16x32_bf16 v[76:79], a[140:143], v[56:59], v[76:79]
    s_waitcnt lgkmcnt(2)
    ds_write2_b64 v20, v[2:3], v[88:89] offset0:8 offset1:9
    v_mfma_f32_16x16x32_bf16 v[68:71], a[120:123], v[64:67], 0
    v_pk_fmac_f16 v38, v27, v27
    v_cmp_gt_u32 vcc, 16, v97
    v_mfma_f32_16x16x32_bf16 v[68:71], a[124:127], v[52:55], v[68:71]
    s_nop 0
    v_cndmask_b32 v120, 0, v120, vcc
    v_cvt_pk_f16_f32 v148, v76, v77
    v_mfma_f32_16x16x32_bf16 v[68:71], a[128:131], v[40:43], v[68:71]
    ds_write_b128 v20, v[84:87]
    v_mfma_f32_16x16x32_bf16 v[68:71], a[132:135], v[48:51], v[68:71]
    v_cvt_pk_f16_f32 v149, v78, v79
    v_pk_fmac_f16 v39, v148, v148
    v_mfma_f32_16x16x32_bf16 v[68:71], a[136:139], v[32:35], v[68:71]
    v_pk_fmac_f16 v39, v149, v149
    v_cvt_pk_f16_f32 v147, v74, v75
    v_mfma_f32_16x16x32_bf16 v[68:71], a[140:143], v[44:47], v[68:71]
    ds_write2_b64 v20, v[102:103], v[2:3] offset0:6 offset1:7
    v_mfma_f32_16x16x32_bf16 v[56:59], a[72:75], v[64:67], 0
    v_pk_fmac_f16 v38, v146, v146
    v_pk_fmac_f16 v38, v147, v147
    v_mfma_f32_16x16x32_bf16 v[56:59], a[76:79], v[52:55], v[56:59]
    v_cvt_pk_bf16_f32 v2, v60, v61
    v_cvt_pk_bf16_f32 v3, v62, v63
    v_mfma_f32_16x16x32_bf16 v[56:59], a[80:83], v[40:43], v[56:59]
    s_waitcnt vmcnt(0)
    ds_write_b64 v20, v[120:121] offset:88
    v_mfma_f32_16x16x32_bf16 v[56:59], a[84:87], v[48:51], v[56:59]
    s_barrier
    v_add_u32 v137, s50, v137
    v_add_u32 v136, s50, v136
    v_mfma_f32_16x16x32_bf16 v[56:59], a[88:91], v[32:35], v[56:59]
    ds_read_b128 v[60:63], v122 offset:14848
    v_add_u32 v135, s48, v135
    v_mfma_f32_16x16x32_bf16 v[56:59], a[92:95], v[44:47], v[56:59]
    v_add_u32 v133, s51, v133
    v_add_u32 v132, s14, v132
    v_mfma_f32_16x16x32_f16 v[76:79], v[212:215], v[36:39], 0
    s_nop 0
    v_cvt_pk_f16_f32 v142, v68, v69
    v_cvt_pk_f16_f32 v143, v70, v71
    v_mfma_f32_16x16x32_bf16 v[92:95], a[0:3], v[64:67], 0
    s_nop 0
    v_cvt_pk_f16_f32 v56, v56, v57
    v_cvt_pk_f16_f32 v57, v58, v59
    v_mfma_f32_16x16x32_bf16 v[92:95], a[4:7], v[52:55], v[92:95]
    v_or3_b32 v123, v123, v76, v77
    v_or3_b32 v123, v123, v78, v79
    v_mfma_f32_16x16x32_bf16 v[80:83], v[64:67], a[168:171], 0
    v_rsq_f32 v76, v76
    v_mfma_f32_16x16x32_bf16 v[80:83], v[52:55], a[172:175], v[80:83]
    v_rsq_f32 v77, v77
    v_mfma_f32_16x16x32_bf16 v[80:83], v[40:43], a[176:179], v[80:83]
    v_mul_f32 v76, s52, v76
    v_cvt_pk_f16_f32 v76, v76, v77
    v_mfma_f32_16x16x32_bf16 v[80:83], v[48:51], a[180:183], v[80:83]
    v_pk_mul_f16 v12, v12, v76 op_sel:[0,1] op_sel_hi:[1,1]
    v_pk_mul_f16 v13, v13, v76 op_sel:[0,1] op_sel_hi:[1,1]
    v_mfma_f32_16x16x32_bf16 v[80:83], v[32:35], a[184:187], v[80:83]
    v_rsq_f32 v78, v78
    v_mfma_f32_16x16x32_bf16 v[80:83], v[44:47], a[188:191], v[80:83]
    v_rsq_f32 v79, v79
    v_mfma_f32_16x16x32_bf16 v[98:101], v[64:67], a[144:147], 0
    v_mul_f32 v78, s52, v78
    v_cvt_pk_f16_f32 v78, v78, v79
    v_mfma_f32_16x16x32_bf16 v[98:101], v[52:55], a[148:151], v[98:101]
    s_waitcnt lgkmcnt(0)
    v_or3_b32 v60, v60, v61, v62
    v_or_b32 v60, v60, v63
    v_mfma_f32_16x16x32_bf16 v[98:101], v[40:43], a[152:155], v[98:101]
    v_readfirstlane_b32 s75, v60
    v_pk_mul_f16 v8, v8, v78 op_sel:[0,1] op_sel_hi:[1,1]
    v_mfma_f32_16x16x32_bf16 v[98:101], v[48:51], a[156:159], v[98:101]
    v_pk_mul_f16 v9, v9, v78 op_sel:[0,1] op_sel_hi:[1,1]
    v_pk_mul_f16 v10, v10, v78 op_sel:[0,1] op_sel_hi:[1,1]
    v_mfma_f32_16x16x32_bf16 v[98:101], v[32:35], a[160:163], v[98:101]
    v_pk_mul_f16 v11, v11, v78 op_sel:[0,1] op_sel_hi:[1,1]
    v_pk_mul_f16 v148, v148, v78 op_sel:[0,1] op_sel_hi:[1,1]
    v_mfma_f32_16x16x32_bf16 v[98:101], v[44:47], a[164:167], v[98:101]
    v_pk_mul_f16 v149, v149, v78 op_sel:[0,1] op_sel_hi:[1,1]
    v_pk_fma_f16 v37, v56, v56, s3
    v_pk_fmac_f16 v37, v57, v57
    s_waitcnt lgkmcnt(0)
    s_cmp_lg_u32 s75, 0
    s_cbranch_scc0 L_atomF0r
    s_branch L_slow
L_bndF:
    s_movk_i32 s73, 20
    s_movk_i32 s71, 18
    s_movk_i32 s70, -20
    s_mov_b32 s74, 0
    s_bitcmp1_b32 s2, 2
    s_cbranch_scc1 L_bndcF
    s_sub_u32 s94, s2, 248
    s_mul_i32 s69, s94, 18
    s_mov_b32 s74, 2
    s_sub_u32 s93, s93, 1373568
    v_cmp_le_u32 vcc, 4, v96
    v_add_u32 v138, 98896896, v128
    v_subrev_u32 v139, 1373568, v128
    v_cndmask_b32 v128, v138, v139, vcc
    v_cmp_le_u32 vcc, 4, v0
    v_add_u32 v138, 98896896, v127
    v_subrev_u32 v139, 1373568, v127
    v_cndmask_b32 v127, v138, v139, vcc
    v_cmp_le_u32 vcc, 4, v104
    v_add_u32 v138, 98896896, v126
    v_subrev_u32 v139, 1373568, v126
    v_cndmask_b32 v126, v138, v139, vcc
    v_cmp_le_u32 vcc, 4, v98
    v_add_u32 v138, 98896896, v125
    v_subrev_u32 v139, 1373568, v125
    v_cndmask_b32 v125, v138, v139, vcc
    v_cmp_le_u32 vcc, 4, v122
    v_add_u32 v138, 98896896, v124
    v_subrev_u32 v139, 1373568, v124
    v_cndmask_b32 v124, v138, v139, vcc
    s_cmp_lt_u32 s2, 256
    s_cbranch_scc1 L_bndrF
L_bndcF:
    s_sub_u32 s94, s2, 252
    s_mul_i32 s69, s94, 20
    s_lshr_b32 s71, s94, 1
    s_sub_u32 s69, s69, s71
    s_and_b32 s94, s94, 1
    s_sub_u32 s71, 20, s94
    s_cmp_eq_u32 s2, 255
    s_cselect_b32 s71, 13, s71
    s_mov_b32 s62, 1373568
    s_add_u32 s74, s74, 1
    s_sub_u32 s93, s93, 2688
    v_mad_i32_i24 v138, v96, -7, v1
    v_cmp_le_u32 vcc, 4, v138
    v_add_u32 v138, 193536, v128
    v_subrev_u32 v139, 2688, v128
    v_cndmask_b32 v128, v138, v139, vcc
    v_mad_i32_i24 v138, v0, -7, v105
    v_cmp_le_u32 vcc, 4, v138
    v_add_u32 v138, 193536, v127
    v_subrev_u32 v139, 2688, v127
    v_cndmask_b32 v127, v138, v139, vcc
    v_mad_i32_i24 v138, v104, -7, v120
    v_cmp_le_u32 vcc, 4, v138
    v_add_u32 v138, 193536, v126
    v_subrev_u32 v139, 2688, v126
    v_cndmask_b32 v126, v138, v139, vcc
    v_mad_i32_i24 v138, v98, -7, v99
    v_cmp_le_u32 vcc, 4, v138
    v_add_u32 v138, 193536, v125
    v_subrev_u32 v139, 2688, v125
    v_cndmask_b32 v125, v138, v139, vcc
    v_mad_i32_i24 v138, v122, -7, v32
    v_cmp_le_u32 vcc, 4, v138
    v_add_u32 v138, 193536, v124
    v_subrev_u32 v139, 2688, v124
    v_cndmask_b32 v124, v138, v139, vcc
    s_cmp_eq_u32 s2, 256
    s_cselect_b32 s62, 0, s62
    s_cselect_b32 s69, 0, s69
    s_cselect_b32 s71, 2, s71
    s_branch L_bndrF
L_maskF:
    s_and_b32 s20, s74, 2
    s_and_b32 s21, s74, 1
    s_mov_b32 s22, 0xc31044fe
    v_lshrrev_b32 v142, 2, v4
    v_add_u32 v142, 0, v142
    v_mul_u32_u24 v139, 37, v142
    v_lshrrev_b32 v138, 8, v139
    v_mad_i32_i24 v138, v138, -7, v142
    v_lshrrev_b32 v139, 10, v139
    v_lshrrev_b32 v138, 2, v138
    v_mul_u32_u24 v139, s20, v139
    v_mad_u32_u24 v142, v138, s21, v139
    v_cvt_f32_u32 v142, v142
    v_lshrrev_b32 v143, 2, v4
    v_add_u32 v143, 4, v143
    v_mul_u32_u24 v139, 37, v143
    v_lshrrev_b32 v138, 8, v139
    v_mad_i32_i24 v138, v138, -7, v143
    v_lshrrev_b32 v139, 10, v139
    v_lshrrev_b32 v138, 2, v138
    v_mul_u32_u24 v139, s20, v139
    v_mad_u32_u24 v143, v138, s21, v139
    v_cvt_f32_u32 v143, v143
    v_lshrrev_b32 v5, 2, v4
    v_add_u32 v5, 8, v5
    v_mul_u32_u24 v139, 37, v5
    v_lshrrev_b32 v138, 8, v139
    v_mad_i32_i24 v138, v138, -7, v5
    v_lshrrev_b32 v139, 10, v139
    v_lshrrev_b32 v138, 2, v138
    v_mul_u32_u24 v139, s20, v139
    v_mad_u32_u24 v5, v138, s21, v139
    v_cvt_f32_u32 v5, v5
    v_mad_u32_u24 v144, v3, 12, 0
    v_mul_u32_u24 v139, 37, v144
    v_lshrrev_b32 v138, 8, v139
    v_mad_i32_i24 v138, v138, -7, v144
    v_lshrrev_b32 v139, 10, v139
    v_lshrrev_b32 v138, 2, v138
    v_mul_u32_u24 v139, s20, v139
    v_mad_u32_u24 v144, v138, s21, v139
    v_cvt_f32_u32 v144, v144
    v_sub_f32 v139, v142, v144
    v_mul_f32 v139, v139, v139 clamp
    v_fmac_f32 v204, s22, v139
    v_sub_f32 v139, v143, v144
    v_mul_f32 v139, v139, v139 clamp
    v_fmac_f32 v192, s22, v139
    v_sub_f32 v139, v5, v144
    v_mul_f32 v139, v139, v139 clamp
    v_fmac_f32 v180, s22, v139
    v_mad_u32_u24 v144, v3, 12, 1
    v_mul_u32_u24 v139, 37, v144
    v_lshrrev_b32 v138, 8, v139
    v_mad_i32_i24 v138, v138, -7, v144
    v_lshrrev_b32 v139, 10, v139
    v_lshrrev_b32 v138, 2, v138
    v_mul_u32_u24 v139, s20, v139
    v_mad_u32_u24 v144, v138, s21, v139
    v_cvt_f32_u32 v144, v144
    v_sub_f32 v139, v142, v144
    v_mul_f32 v139, v139, v139 clamp
    v_fmac_f32 v205, s22, v139
    v_sub_f32 v139, v143, v144
    v_mul_f32 v139, v139, v139 clamp
    v_fmac_f32 v193, s22, v139
    v_sub_f32 v139, v5, v144
    v_mul_f32 v139, v139, v139 clamp
    v_fmac_f32 v181, s22, v139
    v_mad_u32_u24 v144, v3, 12, 2
    v_mul_u32_u24 v139, 37, v144
    v_lshrrev_b32 v138, 8, v139
    v_mad_i32_i24 v138, v138, -7, v144
    v_lshrrev_b32 v139, 10, v139
    v_lshrrev_b32 v138, 2, v138
    v_mul_u32_u24 v139, s20, v139
    v_mad_u32_u24 v144, v138, s21, v139
    v_cvt_f32_u32 v144, v144
    v_sub_f32 v139, v142, v144
    v_mul_f32 v139, v139, v139 clamp
    v_fmac_f32 v206, s22, v139
    v_sub_f32 v139, v143, v144
    v_mul_f32 v139, v139, v139 clamp
    v_fmac_f32 v194, s22, v139
    v_sub_f32 v139, v5, v144
    v_mul_f32 v139, v139, v139 clamp
    v_fmac_f32 v182, s22, v139
    v_mad_u32_u24 v144, v3, 12, 3
    v_mul_u32_u24 v139, 37, v144
    v_lshrrev_b32 v138, 8, v139
    v_mad_i32_i24 v138, v138, -7, v144
    v_lshrrev_b32 v139, 10, v139
    v_lshrrev_b32 v138, 2, v138
    v_mul_u32_u24 v139, s20, v139
    v_mad_u32_u24 v144, v138, s21, v139
    v_cvt_f32_u32 v144, v144
    v_sub_f32 v139, v142, v144
    v_mul_f32 v139, v139, v139 clamp
    v_fmac_f32 v207, s22, v139
    v_sub_f32 v139, v143, v144
    v_mul_f32 v139, v139, v139 clamp
    v_fmac_f32 v195, s22, v139
    v_sub_f32 v139, v5, v144
    v_mul_f32 v139, v139, v139 clamp
    v_fmac_f32 v183, s22, v139
    v_mad_u32_u24 v144, v3, 12, 4
    v_mul_u32_u24 v139, 37, v144
    v_lshrrev_b32 v138, 8, v139
    v_mad_i32_i24 v138, v138, -7, v144
    v_lshrrev_b32 v139, 10, v139
    v_lshrrev_b32 v138, 2, v138
    v_mul_u32_u24 v139, s20, v139
    v_mad_u32_u24 v144, v138, s21, v139
    v_cvt_f32_u32 v144, v144
    v_sub_f32 v139, v142, v144
    v_mul_f32 v139, v139, v139 clamp
    v_fmac_f32 v200, s22, v139
    v_sub_f32 v139, v143, v144
    v_mul_f32 v139, v139, v139 clamp
    v_fmac_f32 v188, s22, v139
    v_sub_f32 v139, v5, v144
    v_mul_f32 v139, v139, v139 clamp
    v_fmac_f32 v176, s22, v139
    v_mad_u32_u24 v144, v3, 12, 5
    v_mul_u32_u24 v139, 37, v144
    v_lshrrev_b32 v138, 8, v139
    v_mad_i32_i24 v138, v138, -7, v144
    v_lshrrev_b32 v139, 10, v139
    v_lshrrev_b32 v138, 2, v138
    v_mul_u32_u24 v139, s20, v139
    v_mad_u32_u24 v144, v138, s21, v139
    v_cvt_f32_u32 v144, v144
    v_sub_f32 v139, v142, v144
    v_mul_f32 v139, v139, v139 clamp
    v_fmac_f32 v201, s22, v139
    v_sub_f32 v139, v143, v144
    v_mul_f32 v139, v139, v139 clamp
    v_fmac_f32 v189, s22, v139
    v_sub_f32 v139, v5, v144
    v_mul_f32 v139, v139, v139 clamp
    v_fmac_f32 v177, s22, v139
    v_mad_u32_u24 v144, v3, 12, 6
    v_mul_u32_u24 v139, 37, v144
    v_lshrrev_b32 v138, 8, v139
    v_mad_i32_i24 v138, v138, -7, v144
    v_lshrrev_b32 v139, 10, v139
    v_lshrrev_b32 v138, 2, v138
    v_mul_u32_u24 v139, s20, v139
    v_mad_u32_u24 v144, v138, s21, v139
    v_cvt_f32_u32 v144, v144
    v_sub_f32 v139, v142, v144
    v_mul_f32 v139, v139, v139 clamp
    v_fmac_f32 v202, s22, v139
    v_sub_f32 v139, v143, v144
    v_mul_f32 v139, v139, v139 clamp
    v_fmac_f32 v190, s22, v139
    v_sub_f32 v139, v5, v144
    v_mul_f32 v139, v139, v139 clamp
    v_fmac_f32 v178, s22, v139
    v_mad_u32_u24 v144, v3, 12, 7
    v_mul_u32_u24 v139, 37, v144
    v_lshrrev_b32 v138, 8, v139
    v_mad_i32_i24 v138, v138, -7, v144
    v_lshrrev_b32 v139, 10, v139
    v_lshrrev_b32 v138, 2, v138
    v_mul_u32_u24 v139, s20, v139
    v_mad_u32_u24 v144, v138, s21, v139
    v_cvt_f32_u32 v144, v144
    v_sub_f32 v139, v142, v144
    v_mul_f32 v139, v139, v139 clamp
    v_fmac_f32 v203, s22, v139
    v_sub_f32 v139, v143, v144
    v_mul_f32 v139, v139, v139 clamp
    v_fmac_f32 v191, s22, v139
    v_sub_f32 v139, v5, v144
    v_mul_f32 v139, v139, v139 clamp
    v_fmac_f32 v179, s22, v139
    v_mad_u32_u24 v144, v3, 12, 8
    v_mul_u32_u24 v139, 37, v144
    v_lshrrev_b32 v138, 8, v139
    v_mad_i32_i24 v138, v138, -7, v144
    v_lshrrev_b32 v139, 10, v139
    v_lshrrev_b32 v138, 2, v138
    v_mul_u32_u24 v139, s20, v139
    v_mad_u32_u24 v144, v138, s21, v139
    v_cvt_f32_u32 v144, v144
    v_sub_f32 v139, v142, v144
    v_mul_f32 v139, v139, v139 clamp
    v_fmac_f32 v196, s22, v139
    v_sub_f32 v139, v143, v144
    v_mul_f32 v139, v139, v139 clamp
    v_fmac_f32 v184, s22, v139
    v_sub_f32 v139, v5, v144
    v_mul_f32 v139, v139, v139 clamp
    v_fmac_f32 v172, s22, v139
    v_mad_u32_u24 v144, v3, 12, 9
    v_mul_u32_u24 v139, 37, v144
    v_lshrrev_b32 v138, 8, v139
    v_mad_i32_i24 v138, v138, -7, v144
    v_lshrrev_b32 v139, 10, v139
    v_lshrrev_b32 v138, 2, v138
    v_mul_u32_u24 v139, s20, v139
    v_mad_u32_u24 v144, v138, s21, v139
    v_cvt_f32_u32 v144, v144
    v_sub_f32 v139, v142, v144
    v_mul_f32 v139, v139, v139 clamp
    v_fmac_f32 v197, s22, v139
    v_sub_f32 v139, v143, v144
    v_mul_f32 v139, v139, v139 clamp
    v_fmac_f32 v185, s22, v139
    v_sub_f32 v139, v5, v144
    v_mul_f32 v139, v139, v139 clamp
    v_fmac_f32 v173, s22, v139
    v_mad_u32_u24 v144, v3, 12, 10
    v_mul_u32_u24 v139, 37, v144
    v_lshrrev_b32 v138, 8, v139
    v_mad_i32_i24 v138, v138, -7, v144
    v_lshrrev_b32 v139, 10, v139
    v_lshrrev_b32 v138, 2, v138
    v_mul_u32_u24 v139, s20, v139
    v_mad_u32_u24 v144, v138, s21, v139
    v_cvt_f32_u32 v144, v144
    v_sub_f32 v139, v142, v144
    v_mul_f32 v139, v139, v139 clamp
    v_fmac_f32 v198, s22, v139
    v_sub_f32 v139, v143, v144
    v_mul_f32 v139, v139, v139 clamp
    v_fmac_f32 v186, s22, v139
    v_sub_f32 v139, v5, v144
    v_mul_f32 v139, v139, v139 clamp
    v_fmac_f32 v174, s22, v139
    v_mad_u32_u24 v144, v3, 12, 11
    v_mul_u32_u24 v139, 37, v144
    v_lshrrev_b32 v138, 8, v139
    v_mad_i32_i24 v138, v138, -7, v144
    v_lshrrev_b32 v139, 10, v139
    v_lshrrev_b32 v138, 2, v138
    v_mul_u32_u24 v139, s20, v139
    v_mad_u32_u24 v144, v138, s21, v139
    v_cvt_f32_u32 v144, v144
    v_sub_f32 v139, v142, v144
    v_mul_f32 v139, v139, v139 clamp
    v_fmac_f32 v199, s22, v139
    v_sub_f32 v139, v143, v144
    v_mul_f32 v139, v139, v139 clamp
    v_fmac_f32 v187, s22, v139
    v_sub_f32 v139, v5, v144
    v_mul_f32 v139, v139, v139 clamp
    v_fmac_f32 v175, s22, v139
    v_cvt_f32_u32 v144, s74
    v_sub_f32 v139, v142, v144
    v_mul_f32 v139, v139, v139 clamp
    v_fmac_f32 v208, s22, v139
    v_sub_f32 v139, v143, v144
    v_mul_f32 v139, v139, v139 clamp
    v_fmac_f32 v209, s22, v139
    v_sub_f32 v139, v5, v144
    v_mul_f32 v139, v139, v139 clamp
    v_fmac_f32 v210, s22, v139
    v_lshrrev_b32 v142, 2, v4
    v_lshl_add_u32 v142, v3, 2, v142
    v_add_u32 v139, 1, v3
    v_lshrrev_b32 v139, 2, v139
    v_mad_u32_u24 v142, v139, 36, v142
    v_min_u32 v142, 48, v142
    v_mul_u32_u24 v139, 37, v142
    v_lshrrev_b32 v138, 8, v139
    v_mad_i32_i24 v138, v138, -7, v142
    v_lshrrev_b32 v139, 10, v139
    v_lshrrev_b32 v138, 2, v138
    v_mul_u32_u24 v139, s20, v139
    v_mad_u32_u24 v142, v138, s21, v139
    v_cvt_f32_u32 v142, v142
    v_sub_f32 v139, v142, v144
    v_mul_f32 v139, v139, v139 clamp
    v_fmac_f32 v211, s22, v139
    s_branch L_nomaskF
L_spin:
    s_movk_i32 s95, 300
L_spin1:
    global_load_dword v120, v122, s[38:39] offset:248 sc1
    s_waitcnt vmcnt(0)
    v_readfirstlane_b32 s94, v120
    s_nop 1
    s_cmp_ge_u32 s94, 3
    s_cbranch_scc1 L_spinr
    s_sub_u32 s95, s95, 1
    s_cmp_lg_u32 s95, 0
    s_cbranch_scc1 L_spin1
    v_mov_b32 v123, -1
    s_branch L_spinr
.fill 96, 4, 0xbf810000
L_atomF0:
    s_cbranch_execz L_main
    v_mov_b32 v122, 0x800000
    buffer_atomic_add v122, v129, s[8:11], 0 offen sc0 sc1
    s_branch L_atomF0r
.p2alignl 6, 0xbf810000
L_loopF0:
    v_mfma_f32_16x16x32_bf16 v[28:31], a[4:7], v[108:111], v[28:31]
    ds_write_b32 v135, v13 offset:1540
    v_mfma_f32_16x16x32_bf16 v[28:31], a[8:11], v[8:11], v[28:31]
    v_rcp_f32 v36, v36
    v_mfma_f32_16x16x32_bf16 v[28:31], a[12:15], v[112:115], v[28:31]
    v_mul_f32 v64, v64, v36
    v_mul_f32 v65, v65, v36
    v_mfma_f32_16x16x32_bf16 v[28:31], a[16:19], v[40:43], v[28:31]
    ds_read_b128 v[76:79], v136 offset:1664
    v_cvt_pk_bf16_f32 v4, v64, v65
    v_mfma_f32_16x16x32_bf16 v[28:31], a[20:23], v[52:55], v[28:31]
    v_mul_f32 v66, v66, v36
    v_mul_f32 v67, v67, v36
    v_mfma_f32_16x16x32_bf16 v[16:19], v[84:87], a[168:171], 0
    v_cvt_pk_bf16_f32 v5, v66, v67
    v_mul_f32 v0, v0, v36
    v_mfma_f32_16x16x32_bf16 v[16:19], v[108:111], a[172:175], v[16:19]
    v_mul_f32 v1, v1, v36
    v_cvt_pk_bf16_f32 v6, v0, v1
    v_mfma_f32_16x16x32_bf16 v[16:19], v[8:11], a[176:179], v[16:19]
    ds_write_b64 v135, v[14:15] offset:1544
    v_mfma_f32_16x16x32_bf16 v[16:19], v[112:115], a[180:183], v[16:19]
    v_mul_f32 v2, v2, v36
    v_mul_f32 v3, v3, v36
    v_mfma_f32_16x16x32_bf16 v[16:19], v[40:43], a[184:187], v[16:19]
    v_cvt_pk_bf16_f32 v7, v2, v3
    v_mul_f32 v146, v146, v36
    v_mfma_f32_16x16x32_bf16 v[16:19], v[52:55], a[188:191], v[16:19]
    v_mul_f32 v147, v147, v36
    v_cvt_pk_bf16_f32 v152, v146, v147
    v_mfma_f32_16x16x32_bf16 v[12:15], a[120:123], v[84:87], 0
    ds_write_b64 v134, v[154:155] offset:1536
    v_mfma_f32_16x16x32_bf16 v[12:15], a[124:127], v[108:111], v[12:15]
    v_mul_f32 v148, v148, v36
    v_mul_f32 v149, v149, v36
    v_mfma_f32_16x16x32_bf16 v[12:15], a[128:131], v[8:11], v[12:15]
    v_cvt_pk_bf16_f32 v153, v148, v149
    v_fmac_f32 v32, v116, v116
    v_mfma_f32_16x16x32_bf16 v[12:15], a[132:135], v[112:115], v[12:15]
    ds_read_b128 v[92:95], v137 offset:1792
    v_fmac_f32 v32, v117, v117
    v_mfma_f32_16x16x32_bf16 v[12:15], a[136:139], v[40:43], v[12:15]
    v_fmac_f32 v32, v118, v118
    v_fmac_f32 v32, v119, v119
    v_mfma_f32_16x16x32_bf16 v[12:15], a[140:143], v[52:55], v[12:15]
    v_fma_f32 v154, v140, v140, s42
    v_fmac_f32 v154, v141, v141
    v_mfma_f32_16x16x32_bf16 v[0:3], a[48:51], v[84:87], 0
    v_fmac_f32 v154, v142, v142
    v_fmac_f32 v154, v143, v143
    v_mfma_f32_16x16x32_bf16 v[0:3], a[52:55], v[108:111], v[0:3]
    ds_write_b64 v135, v[4:5] offset:3072
    v_mfma_f32_16x16x32_bf16 v[0:3], a[56:59], v[8:11], v[0:3]
    v_fmac_f32 v154, v44, v44
    v_fmac_f32 v154, v45, v45
    v_mfma_f32_16x16x32_bf16 v[0:3], a[60:63], v[112:115], v[0:3]
    v_fmac_f32 v154, v46, v46
    v_fmac_f32 v154, v47, v47
    v_mfma_f32_16x16x32_bf16 v[0:3], a[64:67], v[40:43], v[0:3]
    v_fmac_f32 v154, v56, v56
    v_fmac_f32 v154, v57, v57
    v_mfma_f32_16x16x32_bf16 v[0:3], a[68:71], v[52:55], v[0:3]
    ds_write_b64 v135, v[6:7] offset:3080
    v_mfma_f32_16x16x32_bf16 v[4:7], a[24:27], v[84:87], 0
    v_fmac_f32 v154, v58, v58
    v_fmac_f32 v154, v59, v59
    v_mfma_f32_16x16x32_bf16 v[4:7], a[28:31], v[108:111], v[4:7]
    v_fma_f32 v155, v24, v24, s42
    v_fmac_f32 v155, v25, v25
    v_mfma_f32_16x16x32_bf16 v[4:7], a[32:35], v[8:11], v[4:7]
    v_fmac_f32 v155, v26, v26
    v_fmac_f32 v155, v27, v27
    v_mfma_f32_16x16x32_bf16 v[4:7], a[36:39], v[112:115], v[4:7]
    ds_write_b32 v134, v152 offset:3072
    v_mfma_f32_16x16x32_bf16 v[4:7], a[40:43], v[40:43], v[4:7]
    v_fmac_f32 v155, v88, v88
    v_fmac_f32 v155, v89, v89
    v_mfma_f32_16x16x32_bf16 v[4:7], a[44:47], v[52:55], v[4:7]
    v_fmac_f32 v155, v90, v90
    v_fmac_f32 v155, v91, v91
    v_mfma_f32_16x16x32_bf16 v[146:149], v[84:87], a[192:195], 0
    s_waitcnt vmcnt(10)
    v_fmac_f32 v155, v72, v72
    v_fmac_f32 v155, v73, v73
    v_mfma_f32_16x16x32_bf16 v[146:149], v[108:111], a[196:199], v[146:149]
    ds_write_b32 v134, v153 offset:3076
    v_mfma_f32_16x16x32_bf16 v[146:149], v[8:11], a[200:203], v[146:149]
    v_fmac_f32 v155, v74, v74
    v_fmac_f32 v155, v75, v75
    v_mfma_f32_16x16x32_bf16 v[146:149], v[112:115], a[204:207], v[146:149]
    v_cvt_pk_bf16_f32 v152, v32, v154
    v_cvt_pk_bf16_f32 v153, v155, v122
    v_mfma_f32_16x16x32_bf16 v[146:149], v[40:43], a[208:211], v[146:149]
    v_add_u32 v135, s49, v135
    v_add_u32 v134, s49, v134
    v_mfma_f32_16x16x32_bf16 v[146:149], v[52:55], a[212:215], v[146:149]
    ds_write_b64 v130, v[152:153]
    v_mfma_f32_16x16x32_bf16 v[32:35], a[72:75], v[84:87], 0
    v_cvt_pk_f16_f32 v28, v28, v29
    v_cvt_pk_f16_f32 v29, v30, v31
    v_mfma_f32_16x16x32_bf16 v[32:35], a[76:79], v[108:111], v[32:35]
    v_pk_fma_f16 v36, v28, v28, s3
    v_pk_fmac_f16 v36, v29, v29
    v_mfma_f32_16x16x32_bf16 v[32:35], a[80:83], v[8:11], v[32:35]
    v_cvt_pk_f16_f32 v154, v12, v13
    v_cvt_pk_f16_f32 v155, v14, v15
    v_mfma_f32_16x16x32_bf16 v[32:35], a[84:87], v[112:115], v[32:35]
    v_cvt_pk_f16_f32 v30, v4, v5
    v_cvt_pk_f16_f32 v31, v6, v7
    v_mfma_f32_16x16x32_bf16 v[32:35], a[88:91], v[40:43], v[32:35]
    v_pk_fmac_f16 v36, v30, v30
    v_pk_fmac_f16 v36, v31, v31
    v_mfma_f32_16x16x32_bf16 v[32:35], a[92:95], v[52:55], v[32:35]
    v_cvt_pk_bf16_f32 v4, v146, v147
    v_cvt_pk_bf16_f32 v5, v148, v149
    v_mfma_f32_16x16x32_bf16 v[146:149], a[96:99], v[84:87], 0
    v_cvt_pk_f16_f32 v152, v0, v1
    v_cvt_pk_f16_f32 v153, v2, v3
    v_mfma_f32_16x16x32_bf16 v[146:149], a[100:103], v[108:111], v[146:149]
    s_waitcnt lgkmcnt(0)
    v_pk_fmac_f16 v36, v152, v152
    v_pk_fmac_f16 v36, v153, v153
    v_mfma_f32_16x16x32_bf16 v[146:149], a[104:107], v[8:11], v[146:149]
    s_barrier
    ds_read_b128 v[0:3], v129 offset:0
    v_cvt_pk_f16_f32 v12, v32, v33
    v_mfma_f32_16x16x32_bf16 v[146:149], a[108:111], v[112:115], v[146:149]
    ds_read_b128 v[64:67], v129 offset:1024
    v_cvt_pk_f16_f32 v13, v34, v35
    v_mfma_f32_16x16x32_bf16 v[146:149], a[112:115], v[40:43], v[146:149]
    v_pk_fma_f16 v37, v12, v12, s3
    v_pk_fmac_f16 v37, v13, v13
    v_mfma_f32_16x16x32_bf16 v[146:149], a[116:119], v[52:55], v[146:149]
    s_nop 1
    v_mfma_f32_16x16x32_bf16 v[32:35], v[84:87], a[144:147], 0
    s_nop 2
    v_mfma_f32_16x16x32_bf16 v[32:35], v[108:111], a[148:151], v[32:35]
    s_nop 0
    v_cvt_pk_f16_f32 v14, v146, v147
    v_cvt_pk_f16_f32 v15, v148, v149
    v_mfma_f32_16x16x32_bf16 v[32:35], v[8:11], a[152:155], v[32:35]
    v_pk_fmac_f16 v37, v14, v14
    v_pk_fmac_f16 v37, v15, v15
    v_mfma_f32_16x16x32_bf16 v[32:35], v[112:115], a[156:159], v[32:35]
    v_pk_fmac_f16 v37, v154, v154
    v_pk_fmac_f16 v37, v155, v155
    v_mfma_f32_16x16x32_bf16 v[32:35], v[40:43], a[160:163], v[32:35]
    v_mfma_f32_16x16x32_bf16 v[32:35], v[52:55], a[164:167], v[32:35]
    s_waitcnt lgkmcnt(1)
    v_readfirstlane_b32 s12, v1
    v_mfma_f32_16x16x32_bf16 v[84:87], v[216:219], v[0:3], 0
    s_waitcnt lgkmcnt(0)
    s_nop 1
    v_mfma_f32_16x16x32_bf16 v[84:87], v[216:219], v[64:67], v[84:87]
    s_lshr_b32 s12, s12, 23
    v_cvt_pk_bf16_f32 v0, v32, v33
    v_cvt_pk_bf16_f32 v1, v34, v35
    v_mfma_f32_16x16x32_bf16 v[32:35], a[96:99], v[68:71], 0
    s_nop 1
    v_mfma_f32_16x16x32_bf16 v[32:35], a[100:103], v[60:63], v[32:35]
    s_nop 0
    v_rsq_f32 v84, v84
    v_mfma_f32_16x16x32_bf16 v[32:35], a[104:107], v[98:101], v[32:35]
    v_rsq_f32 v85, v85
    v_mfma_f32_16x16x32_bf16 v[32:35], a[108:111], v[76:79], v[32:35]
    v_rsq_f32 v86, v86
    v_mfma_f32_16x16x32_bf16 v[32:35], a[112:115], v[92:95], v[32:35]
    v_mul_f32 v84, s43, v84
    v_mul_f32 v85, s43, v85
    v_mfma_f32_16x16x32_bf16 v[32:35], a[116:119], v[104:107], v[32:35]
    v_mul_f32 v86, s43, v86
    v_mul_f32 v140, v140, v85
    v_mfma_f32_16x16x32_bf16 v[40:43], v[68:71], a[168:171], 0
    s_nop 0
    v_mul_f32 v141, v141, v85
    v_cvt_pk_bf16_f32 v52, v140, v141
    v_mfma_f32_16x16x32_bf16 v[40:43], v[60:63], a[172:175], v[40:43]
    s_nop 0
    v_cvt_pk_f16_f32 v10, v32, v33
    v_cvt_pk_f16_f32 v11, v34, v35
    v_mfma_f32_16x16x32_bf16 v[40:43], v[98:101], a[176:179], v[40:43]
    v_mul_f32 v142, v142, v85
    v_mul_f32 v143, v143, v85
    v_mfma_f32_16x16x32_bf16 v[40:43], v[76:79], a[180:183], v[40:43]
    v_cvt_pk_bf16_f32 v53, v142, v143
    v_mul_f32 v44, v44, v85
    v_mfma_f32_16x16x32_bf16 v[40:43], v[92:95], a[184:187], v[40:43]
    ds_write_b32 v135, v52 offset:1536
    v_mfma_f32_16x16x32_bf16 v[40:43], v[104:107], a[188:191], v[40:43]
    v_mul_f32 v45, v45, v85
    v_cvt_pk_bf16_f32 v54, v44, v45
    v_mfma_f32_16x16x32_bf16 v[140:143], a[24:27], v[68:71], 0
    s_nop 0
    v_mul_f32 v46, v46, v85
    v_mul_f32 v47, v47, v85
    v_mfma_f32_16x16x32_bf16 v[140:143], a[28:31], v[60:63], v[140:143]
    s_nop 0
    v_cvt_pk_bf16_f32 v22, v40, v41
    v_cvt_pk_bf16_f32 v23, v42, v43
    v_mfma_f32_16x16x32_bf16 v[140:143], a[32:35], v[98:101], v[140:143]
    v_cvt_pk_bf16_f32 v55, v46, v47
    v_mul_f32 v56, v56, v85
    v_mfma_f32_16x16x32_bf16 v[140:143], a[36:39], v[76:79], v[140:143]
    ds_write_b64 v135, v[54:55] offset:1544
    v_mfma_f32_16x16x32_bf16 v[140:143], a[40:43], v[92:95], v[140:143]
    s_sub_u32 s50, s45, s44
    v_mul_f32 v57, v57, v85
    v_cvt_pk_bf16_f32 v38, v56, v57
    v_mfma_f32_16x16x32_bf16 v[140:143], a[44:47], v[104:107], v[140:143]
    s_sub_u32 s51, s46, s47
    v_mul_f32 v58, v58, v85
    v_mul_f32 v59, v59, v85
    v_mfma_f32_16x16x32_bf16 v[32:35], a[72:75], v[68:71], 0
    s_mov_b32 s60, s59
    v_cvt_pk_bf16_f32 v39, v58, v59
    v_mul_f32 v48, v48, v84
    v_mfma_f32_16x16x32_bf16 v[32:35], a[76:79], v[60:63], v[32:35]
    s_mov_b32 s59, s58
    ds_write_b32 v134, v39 offset:1540
    v_mfma_f32_16x16x32_bf16 v[32:35], a[80:83], v[98:101], v[32:35]
    s_mov_b32 s58, s57
    v_mul_f32 v49, v49, v84
    v_cvt_pk_bf16_f32 v64, v48, v49
    v_mfma_f32_16x16x32_bf16 v[32:35], a[84:87], v[76:79], v[32:35]
    s_mov_b32 s57, s56
    v_mul_f32 v50, v50, v84
    v_mul_f32 v51, v51, v84
    v_mfma_f32_16x16x32_bf16 v[32:35], a[88:91], v[92:95], v[32:35]
    s_mov_b32 s7, s6
    v_cvt_pk_bf16_f32 v65, v50, v51
    v_mul_f32 v80, v80, v84
    v_mfma_f32_16x16x32_bf16 v[32:35], a[92:95], v[104:107], v[32:35]
    s_mov_b32 s6, s5
    ds_write_b32 v135, v53 offset:1540
    v_mfma_f32_16x16x32_bf16 v[146:149], a[48:51], v[68:71], 0
    s_mov_b32 s5, s4
    v_mul_f32 v81, v81, v84
    v_cvt_pk_bf16_f32 v66, v80, v81
    v_mfma_f32_16x16x32_bf16 v[146:149], a[52:55], v[60:63], v[146:149]
    s_sub_u32 s14, s6, s7
    v_cvt_pk_f16_f32 v8, v32, v33
    v_cvt_pk_f16_f32 v9, v34, v35
    v_mfma_f32_16x16x32_bf16 v[146:149], a[56:59], v[98:101], v[146:149]
    s_add_u32 s61, s61, 1
    ds_read_b128 v[32:35], v137 offset:3328
    v_pk_fma_f16 v39, v8, v8, s3
    v_mfma_f32_16x16x32_bf16 v[146:149], a[60:63], v[76:79], v[146:149]
    s_add_u32 s12, s12, 20
    ds_read_b128 v[40:43], v137 offset:3200
    v_pk_fmac_f16 v39, v9, v9
    v_mfma_f32_16x16x32_bf16 v[146:149], a[64:67], v[92:95], v[146:149]
    s_max_u32 s12, s12, s61
    ds_read_b128 v[48:51], v136 offset:3200
    v_pk_fmac_f16 v39, v10, v10
    v_mfma_f32_16x16x32_bf16 v[146:149], a[68:71], v[104:107], v[146:149]
    s_cmp_lt_u32 s61, s71
    ds_read_b128 v[44:47], v136 offset:3328
    v_pk_fmac_f16 v39, v11, v11
    v_mfma_f32_16x16x32_bf16 v[108:111], a[120:123], v[68:71], 0
    s_cselect_b32 s15, s61, s12
    ds_read_b128 v[52:55], v136 offset:3072
    v_mul_f32 v82, v82, v84
    v_mfma_f32_16x16x32_bf16 v[108:111], a[124:127], v[60:63], v[108:111]
    s_cselect_b32 s56, s69, s70
    v_cvt_pk_f16_f32 v146, v146, v147
    v_cvt_pk_f16_f32 v147, v148, v149
    v_mfma_f32_16x16x32_bf16 v[108:111], a[128:131], v[98:101], v[108:111]
    s_add_u32 s56, s56, s15
    v_mul_f32 v83, v83, v84
    v_cvt_pk_bf16_f32 v67, v82, v83
    v_mfma_f32_16x16x32_bf16 v[108:111], a[132:135], v[76:79], v[108:111]
    s_mul_i32 s53, s56, 58255
    v_mul_f32 v116, v116, v84
    v_mul_f32 v117, v117, v84
    v_mfma_f32_16x16x32_bf16 v[108:111], a[136:139], v[92:95], v[108:111]
    s_lshr_b32 s53, s53, 22
    ds_write_b32 v134, v38 offset:1536
    v_mfma_f32_16x16x32_bf16 v[108:111], a[140:143], v[104:107], v[108:111]
    s_mul_i32 s53, s53, s63
    v_cvt_pk_bf16_f32 v2, v116, v117
    v_mul_f32 v118, v118, v84
    v_mfma_f32_16x16x32_bf16 v[80:83], a[0:3], v[68:71], 0
    s_mul_i32 s56, s56, s62
    v_mul_f32 v119, v119, v84
    v_cvt_pk_bf16_f32 v3, v118, v119
    v_mfma_f32_16x16x32_bf16 v[80:83], a[4:7], v[60:63], v[80:83]
    s_add_u32 s56, s56, s53
    v_cvt_pk_f16_f32 v148, v108, v109
    v_cvt_pk_f16_f32 v149, v110, v111
    v_mfma_f32_16x16x32_bf16 v[80:83], a[8:11], v[98:101], v[80:83]
    s_mul_i32 s4, s15, 112
    ds_write_b64 v135, v[64:65] offset:0
    v_mfma_f32_16x16x32_bf16 v[80:83], a[12:15], v[76:79], v[80:83]
    s_cmp_ge_u32 s15, 16
    v_pk_fmac_f16 v39, v148, v148
    v_pk_fmac_f16 v39, v149, v149
    v_mfma_f32_16x16x32_bf16 v[80:83], a[16:19], v[92:95], v[80:83]
    s_cselect_b32 s53, -30464, 0
    v_mul_f32 v24, v24, v86
    v_mul_f32 v25, v25, v86
    v_mfma_f32_16x16x32_bf16 v[80:83], a[20:23], v[104:107], v[80:83]
    s_add_u32 s4, s4, s53
    v_cvt_pk_bf16_f32 v116, v24, v25
    v_mul_f32 v26, v26, v86
    v_mfma_f32_16x16x32_bf16 v[108:111], v[68:71], a[144:147], 0
    s_cmp_lt_u32 s15, s73
    ds_write_b64 v135, v[66:67] offset:8
    v_mfma_f32_16x16x32_bf16 v[108:111], v[60:63], a[148:151], v[108:111]
    s_cselect_b32 s26, 100270464, 0
    v_cvt_pk_f16_f32 v24, v80, v81
    v_cvt_pk_f16_f32 v25, v82, v83
    v_mfma_f32_16x16x32_bf16 v[108:111], v[98:101], a[152:155], v[108:111]
    s_cselect_b32 s56, s56, 0
    v_pk_fma_f16 v38, v24, v24, s3
    v_pk_fmac_f16 v38, v25, v25
    v_mfma_f32_16x16x32_bf16 v[108:111], v[76:79], a[156:159], v[108:111]
    s_cselect_b32 s4, s4, -1
    ds_read_b128 v[64:67], v137 offset:3072
    v_mul_f32 v27, v27, v86
    v_mfma_f32_16x16x32_bf16 v[108:111], v[92:95], a[160:163], v[108:111]
    s_cselect_b32 s15, s15, 0
    v_cvt_pk_bf16_f32 v117, v26, v27
    v_mul_f32 v88, v88, v86
    v_mfma_f32_16x16x32_bf16 v[108:111], v[104:107], a[164:167], v[108:111]
    s_cselect_b32 s13, s13, -1
    v_mul_f32 v89, v89, v86
    v_cvt_pk_bf16_f32 v118, v88, v89
    v_mfma_f32_16x16x32_bf16 v[80:83], v[68:71], a[192:195], 0
    s_bitset1_b32 s64, s15
    v_mul_f32 v90, v90, v86
    v_mul_f32 v91, v91, v86
    v_mfma_f32_16x16x32_bf16 v[80:83], v[60:63], a[196:199], v[80:83]
    s_add_u32 s65, s65, 1
    ds_write_b64 v134, v[2:3] offset:0
    v_mfma_f32_16x16x32_bf16 v[80:83], v[98:101], a[200:203], v[80:83]
    s_cmp_ge_i32 s65, 2
    v_cvt_pk_bf16_f32 v119, v90, v91
    v_mul_f32 v72, v72, v86
    v_mfma_f32_16x16x32_bf16 v[80:83], v[76:79], a[204:207], v[80:83]
    s_cselect_b32 s30, 100270464, 0
    v_mul_f32 v73, v73, v86
    v_cvt_pk_bf16_f32 v72, v72, v73
    v_mfma_f32_16x16x32_bf16 v[80:83], v[92:95], a[208:211], v[80:83]
    s_add_u32 s67, s46, s54
    v_mul_f32 v74, v74, v86
    v_mul_f32 v75, v75, v86
    v_mfma_f32_16x16x32_bf16 v[80:83], v[104:107], a[212:215], v[80:83]
    s_waitcnt lgkmcnt(1)
    ds_write_b64 v135, v[116:117] offset:3072
    v_mfma_f32_16x16x32_bf16 v[60:63], a[72:75], v[64:67], 0
    s_add_u32 m0, s67, 0
    v_cvt_pk_bf16_f32 v73, v74, v75
    v_cvt_pk_bf16_f32 v2, v108, v109
    v_mfma_f32_16x16x32_bf16 v[60:63], a[76:79], v[52:55], v[60:63]
    v_cvt_pk_bf16_f32 v3, v110, v111
    v_cvt_pk_f16_f32 v26, v140, v141
    v_mfma_f32_16x16x32_bf16 v[60:63], a[80:83], v[40:43], v[60:63]
    v_cvt_pk_f16_f32 v27, v142, v143
    v_pk_fmac_f16 v38, v26, v26
    v_mfma_f32_16x16x32_bf16 v[60:63], a[84:87], v[48:51], v[60:63]
    ds_write_b32 v135, v118 offset:3080
    v_mfma_f32_16x16x32_bf16 v[60:63], a[88:91], v[32:35], v[60:63]
    v_pk_fmac_f16 v38, v27, v27
    v_pk_fmac_f16 v38, v146, v146
    v_mfma_f32_16x16x32_bf16 v[60:63], a[92:95], v[44:47], v[60:63]
    v_pk_fmac_f16 v38, v147, v147
    v_cvt_pk_bf16_f32 v6, v80, v81
    v_mfma_f32_16x16x32_bf16 v[98:101], a[120:123], v[64:67], 0
    v_cvt_pk_bf16_f32 v7, v82, v83
    v_add_u32 v137, s50, v137
    v_mfma_f32_16x16x32_bf16 v[98:101], a[124:127], v[52:55], v[98:101]
    ds_write_b32 v135, v119 offset:3084
    v_mfma_f32_16x16x32_bf16 v[98:101], a[128:131], v[40:43], v[98:101]
    v_cvt_pk_f16_f32 v56, v60, v61
    v_cvt_pk_f16_f32 v57, v62, v63
    v_mfma_f32_16x16x32_bf16 v[98:101], a[132:135], v[48:51], v[98:101]
    v_add_u32 v136, s50, v136
    v_add_u32 v135, s48, v135
    v_mfma_f32_16x16x32_bf16 v[98:101], a[136:139], v[32:35], v[98:101]
    v_add_u32 v133, s51, v133
    v_add_u32 v132, s14, v132
    v_mfma_f32_16x16x32_bf16 v[98:101], a[140:143], v[44:47], v[98:101]
    s_nop 0
    ds_write_b32 v134, v72 offset:3072
    v_mfma_f32_16x16x32_f16 v[76:79], v[212:215], v[36:39], 0
    s_nop 0
    v_pk_fma_f16 v37, v56, v56, s3
    v_pk_fmac_f16 v37, v57, v57
    v_mfma_f32_16x16x32_bf16 v[80:83], v[64:67], a[168:171], 0
    s_nop 0
    v_cvt_pk_f16_f32 v142, v98, v99
    v_cvt_pk_f16_f32 v143, v100, v101
    v_mfma_f32_16x16x32_bf16 v[80:83], v[52:55], a[172:175], v[80:83]
    v_or3_b32 v123, v123, v76, v77
    v_or3_b32 v123, v123, v78, v79
    v_mfma_f32_16x16x32_bf16 v[80:83], v[40:43], a[176:179], v[80:83]
    ds_write_b32 v134, v73 offset:3076
    v_mfma_f32_16x16x32_bf16 v[80:83], v[48:51], a[180:183], v[80:83]
    s_waitcnt vmcnt(0)
    v_rsq_f32 v76, v76
    v_mfma_f32_16x16x32_bf16 v[80:83], v[32:35], a[184:187], v[80:83]
    v_rsq_f32 v77, v77
    v_mfma_f32_16x16x32_bf16 v[80:83], v[44:47], a[188:191], v[80:83]
    v_mul_f32 v76, s52, v76
    v_cvt_pk_f16_f32 v76, v76, v77
    v_mfma_f32_16x16x32_bf16 v[98:101], v[64:67], a[144:147], 0
    v_rsq_f32 v78, v78
    v_mfma_f32_16x16x32_bf16 v[98:101], v[52:55], a[148:151], v[98:101]
    v_rsq_f32 v79, v79
    v_mfma_f32_16x16x32_bf16 v[98:101], v[40:43], a[152:155], v[98:101]
    v_mul_f32 v78, s52, v78
    v_cvt_pk_f16_f32 v78, v78, v79
    v_mfma_f32_16x16x32_bf16 v[98:101], v[48:51], a[156:159], v[98:101]
    v_pk_mul_f16 v8, v8, v78 op_sel:[0,1] op_sel_hi:[1,1]
    v_pk_mul_f16 v9, v9, v78 op_sel:[0,1] op_sel_hi:[1,1]
    v_mfma_f32_16x16x32_bf16 v[98:101], v[32:35], a[160:163], v[98:101]
    s_waitcnt lgkmcnt(0)
    v_pk_mul_f16 v10, v10, v78 op_sel:[0,1] op_sel_hi:[1,1]
    v_pk_mul_f16 v11, v11, v78 op_sel:[0,1] op_sel_hi:[1,1]
    v_mfma_f32_16x16x32_bf16 v[98:101], v[44:47], a[164:167], v[98:101]
    s_barrier
    v_pk_mul_f16 v148, v148, v78 op_sel:[0,1] op_sel_hi:[1,1]
    v_pk_mul_f16 v149, v149, v78 op_sel:[0,1] op_sel_hi:[1,1]
    v_mfma_f32_16x16x32_bf16 v[92:95], a[0:3], v[64:67], 0
    s_cmp_ge_u32 s61, s13
    v_pk_mul_f16 v12, v12, v76 op_sel:[0,1] op_sel_hi:[1,1]
    v_pk_mul_f16 v13, v13, v76 op_sel:[0,1] op_sel_hi:[1,1]
    v_mfma_f32_16x16x32_bf16 v[92:95], a[4:7], v[52:55], v[92:95]
L_pga:
    s_cbranch_scc1 L_atomF0
L_atomF0r:
    v_mfma_f32_16x16x32_bf16 v[92:95], a[8:11], v[40:43], v[92:95]
    ds_read_b128 v[60:63], v132 offset:16
    v_pk_mul_f16 v14, v14, v76 op_sel:[0,1] op_sel_hi:[1,1]
    v_mfma_f32_16x16x32_bf16 v[92:95], a[12:15], v[48:51], v[92:95]
    ds_read_b128 v[68:71], v132 offset:0
    v_pk_mul_f16 v15, v15, v76 op_sel:[0,1] op_sel_hi:[1,1]
    v_mfma_f32_16x16x32_bf16 v[92:95], a[16:19], v[32:35], v[92:95]
    v_pk_mul_f16 v154, v154, v76 op_sel:[0,1] op_sel_hi:[1,1]
    v_pk_mul_f16 v155, v155, v76 op_sel:[0,1] op_sel_hi:[1,1]
    v_mfma_f32_16x16x32_bf16 v[92:95], a[20:23], v[44:47], v[92:95]
    ds_read_b128 v[104:107], v133 offset:0
    v_pk_mul_f16 v28, v28, v76 op_sel:[0,0] op_sel_hi:[1,0]
    v_mfma_f32_16x16x32_bf16 v[116:119], a[48:51], v[64:67], 0
    v_pk_mul_f16 v29, v29, v76 op_sel:[0,0] op_sel_hi:[1,0]
    v_pk_mul_f16 v30, v30, v76 op_sel:[0,0] op_sel_hi:[1,0]
    v_mfma_f32_16x16x32_bf16 v[116:119], a[52:55], v[52:55], v[116:119]
    ds_read_b128 v[88:91], v133 offset:2048
    v_pk_mul_f16 v31, v31, v76 op_sel:[0,0] op_sel_hi:[1,0]
    v_mfma_f32_16x16x32_bf16 v[116:119], a[56:59], v[40:43], v[116:119]
    v_pk_mul_f16 v152, v152, v76 op_sel:[0,0] op_sel_hi:[1,0]
    v_pk_mul_f16 v153, v153, v76 op_sel:[0,0] op_sel_hi:[1,0]
    v_mfma_f32_16x16x32_bf16 v[116:119], a[60:63], v[48:51], v[116:119]
    ds_read_b128 v[72:75], v132 offset:48
    v_cvt_pk_f16_f32 v76, v92, v93
    v_mfma_f32_16x16x32_bf16 v[116:119], a[64:67], v[32:35], v[116:119]
    ds_read_b128 v[84:87], v137 offset:0
    v_cvt_pk_f16_f32 v77, v94, v95
    v_mfma_f32_16x16x32_bf16 v[116:119], a[68:71], v[44:47], v[116:119]
    v_pk_fma_f16 v36, v76, v76, s3
    v_pk_fmac_f16 v36, v77, v77
    v_mfma_f32_16x16x32_bf16 v[112:115], a[24:27], v[64:67], 0
    s_nop 0
    v_add_u32 v134, s48, v134
    v_add_u32 v131, s14, v131
    v_mfma_f32_16x16x32_bf16 v[112:115], a[28:31], v[52:55], v[112:115]
    s_nop 0
    v_cvt_pk_f16_f32 v140, v116, v117
    v_cvt_pk_f16_f32 v141, v118, v119
    v_mfma_f32_16x16x32_bf16 v[112:115], a[32:35], v[40:43], v[112:115]
    s_waitcnt lgkmcnt(3)
    buffer_load_dwordx4 v128, s[24:27], s56 offen nt lds
    v_pk_mul_f16 v24, v24, v78 op_sel:[0,0] op_sel_hi:[1,0]
    v_mfma_f32_16x16x32_bf16 v[112:115], a[36:39], v[48:51], v[112:115]
    ds_read_b128 v[92:95], v136 offset:128
    v_pk_mul_f16 v25, v25, v78 op_sel:[0,0] op_sel_hi:[1,0]
    v_mfma_f32_16x16x32_bf16 v[112:115], a[40:43], v[32:35], v[112:115]
    v_pk_mul_f16 v26, v26, v78 op_sel:[0,0] op_sel_hi:[1,0]
    v_pk_mul_f16 v27, v27, v78 op_sel:[0,0] op_sel_hi:[1,0]
    v_mfma_f32_16x16x32_bf16 v[112:115], a[44:47], v[44:47], v[112:115]
    v_pk_mul_f16 v146, v146, v78 op_sel:[0,0] op_sel_hi:[1,0]
    v_pk_mul_f16 v147, v147, v78 op_sel:[0,0] op_sel_hi:[1,0]
    v_mfma_f32_16x16x32_bf16 v[116:119], a[96:99], v[64:67], 0
    ds_read_b128 v[108:111], v133 offset:1024
    v_cvt_pk_bf16_f32 v164, v98, v99
    v_mfma_f32_16x16x32_bf16 v[116:119], a[100:103], v[52:55], v[116:119]
    s_nop 0
    ds_read_u16 v166, v131 offset:80
    v_cvt_pk_f16_f32 v78, v112, v113
    v_mfma_f32_16x16x32_bf16 v[116:119], a[104:107], v[40:43], v[116:119]
    ds_read_u16 v162, v131 offset:96
    v_cvt_pk_f16_f32 v79, v114, v115
    v_mfma_f32_16x16x32_bf16 v[116:119], a[108:111], v[48:51], v[116:119]
    ds_read_u16 v158, v131 offset:104
    v_pk_fmac_f16 v36, v78, v78
    v_mfma_f32_16x16x32_bf16 v[116:119], a[112:115], v[32:35], v[116:119]
    ds_read_b128 v[96:99], v137 offset:256
    v_pk_fmac_f16 v36, v79, v79
    v_mfma_f32_16x16x32_bf16 v[116:119], a[116:119], v[44:47], v[116:119]
    s_add_u32 m0, s67, 1024
    v_pk_fmac_f16 v36, v140, v140
    v_pk_fmac_f16 v36, v141, v141
    v_mfma_f32_16x16x32_bf16 v[112:115], v[64:67], a[192:195], 0
    ds_read_b128 v[64:67], v136 offset:0
    v_cvt_pk_bf16_f32 v165, v100, v101
    v_mfma_f32_16x16x32_bf16 v[112:115], v[52:55], a[196:199], v[112:115]
    ds_read_b128 v[52:55], v133 offset:3072
    v_cvt_pk_f16_f32 v58, v116, v117
    v_mfma_f32_16x16x32_bf16 v[112:115], v[40:43], a[200:203], v[112:115]
    ds_read_b128 v[40:43], v137 offset:128
    v_cvt_pk_f16_f32 v59, v118, v119
    v_mfma_f32_16x16x32_bf16 v[112:115], v[48:51], a[204:207], v[112:115]
    s_waitcnt lgkmcnt(7)
    buffer_store_dwordx4 v[104:107], v128, s[28:31], s60 offen sc1
    buffer_load_dwordx4 v127, s[24:27], s56 offen nt lds
    v_pk_fmac_f16 v37, v58, v58
    v_pk_fmac_f16 v37, v59, v59
    v_pk_fmac_f16 v37, v142, v142
    v_mfma_f32_16x16x32_bf16 v[112:115], v[32:35], a[208:211], v[112:115]
    v_pk_fmac_f16 v37, v143, v143
    v_cvt_pk_bf16_f32 v20, v16, v17
    v_mfma_f32_16x16x32_bf16 v[112:115], v[44:47], a[212:215], v[112:115]
    ds_read_b128 v[32:35], v136 offset:256
    v_cvt_pk_bf16_f32 v21, v18, v19
    v_mfma_f32_16x16x32_f16 v[16:19], v[212:215], v[36:39], 0
    s_nop 0
    v_cvt_pk_bf16_f32 v160, v80, v81
    v_cvt_pk_bf16_f32 v161, v82, v83
    v_mfma_f32_16x16x32_f16 v[36:39], v[8:11], v[28:31], v[200:203]
    s_nop 0
    v_cvt_pk_bf16_f32 v156, v112, v113
    v_cvt_pk_bf16_f32 v157, v114, v115
    v_mfma_f32_16x16x32_f16 v[36:39], v[146:149], v[150:153], v[36:39]
    s_add_u32 m0, s67, 2048
    v_or3_b32 v123, v123, v16, v17
    v_mfma_f32_16x16x32_bf16 v[48:51], a[216:219], v[84:87], 0
    s_waitcnt lgkmcnt(2)
    ds_read_b128 v[44:47], v133 offset:4096
    v_mfma_f32_16x16x32_bf16 v[48:51], a[220:223], v[64:67], v[48:51]
    s_waitcnt lgkmcnt(2)
    buffer_store_dwordx4 v[108:111], v127, s[28:31], s60 offen sc1
    buffer_load_dwordx4 v126, s[24:27], s56 offen nt lds
    v_rsq_f32 v16, v16
    v_mfma_f32_16x16x32_bf16 v[48:51], a[224:227], v[40:43], v[48:51]
    v_rsq_f32 v17, v17
    v_mfma_f32_16x16x32_bf16 v[48:51], a[228:231], v[92:95], v[48:51]
    v_exp_f32 v36, v36
    v_mfma_f32_16x16x32_bf16 v[48:51], a[232:235], v[96:99], v[48:51]
    s_waitcnt lgkmcnt(1)
    v_exp_f32 v37, v37
    v_mfma_f32_16x16x32_bf16 v[48:51], a[236:239], v[32:35], v[48:51]
    v_mul_f32 v16, s52, v16
    v_cvt_pk_f16_f32 v16, v16, v17
    v_mfma_f32_16x16x32_bf16 v[80:83], a[240:243], v[84:87], 0
    v_pk_mul_f16 v76, v76, v16 op_sel:[0,0] op_sel_hi:[1,0]
    v_pk_mul_f16 v77, v77, v16 op_sel:[0,0] op_sel_hi:[1,0]
    v_mfma_f32_16x16x32_bf16 v[80:83], a[244:247], v[64:67], v[80:83]
    v_pk_mul_f16 v78, v78, v16 op_sel:[0,0] op_sel_hi:[1,0]
    v_pk_mul_f16 v79, v79, v16 op_sel:[0,0] op_sel_hi:[1,0]
    v_mfma_f32_16x16x32_bf16 v[80:83], a[248:251], v[40:43], v[80:83]
    v_pk_mul_f16 v140, v140, v16 op_sel:[0,0] op_sel_hi:[1,0]
    v_pk_mul_f16 v141, v141, v16 op_sel:[0,0] op_sel_hi:[1,0]
    v_mfma_f32_16x16x32_bf16 v[80:83], a[252:255], v[92:95], v[80:83]
    v_pk_mul_f16 v56, v56, v16 op_sel:[0,1] op_sel_hi:[1,1]
    v_pk_mul_f16 v57, v57, v16 op_sel:[0,1] op_sel_hi:[1,1]
    v_mfma_f32_16x16x32_bf16 v[80:83], v[224:227], v[96:99], v[80:83]
    v_pk_mul_f16 v58, v58, v16 op_sel:[0,1] op_sel_hi:[1,1]
    v_pk_mul_f16 v59, v59, v16 op_sel:[0,1] op_sel_hi:[1,1]
    v_mfma_f32_16x16x32_bf16 v[80:83], v[228:231], v[32:35], v[80:83]
    s_add_u32 m0, s67, 3072
    buffer_store_dwordx4 v[88:91], v126, s[28:31], s60 offen sc1
    v_pk_mul_f16 v142, v142, v16 op_sel:[0,1] op_sel_hi:[1,1]
    v_pk_mul_f16 v143, v143, v16 op_sel:[0,1] op_sel_hi:[1,1]
    v_exp_f32 v38, v38
    v_mfma_f32_16x16x32_f16 v[16:19], v[68:71], v[28:31], v[208:211]
    v_exp_f32 v39, v39
    v_mfma_f32_16x16x32_f16 v[16:19], v[60:63], v[12:15], v[16:19]
    v_cvt_pk_bf16_f32 v36, v36, v37
    v_cvt_pk_bf16_f32 v37, v38, v39
    v_mfma_f32_16x16x32_f16 v[16:19], v[72:75], v[152:155], v[16:19]
    s_nop 0
    buffer_load_dwordx4 v125, s[24:27], s56 offen nt lds
    v_mfma_f32_16x16x32_f16 v[104:107], v[56:59], v[28:31], v[196:199]
    s_add_u32 m0, s67, 4096
    s_nop 1
    v_mfma_f32_16x16x32_f16 v[104:107], v[140:143], v[150:153], v[104:107]
    s_nop 0
    v_exp_f32 v16, v16
    v_mfma_f32_16x16x32_f16 v[88:91], v[12:15], v[28:31], v[204:207]
    s_nop 0
    v_cvt_pk_bf16_f32 v170, v16, 0
    s_nop 0
    v_mfma_f32_16x16x32_f16 v[88:91], v[152:155], v[150:153], v[88:91]
    s_nop 0
    v_exp_f32 v104, v104
    v_mfma_f32_16x16x32_bf16 v[116:119], v[232:235], v[84:87], 0
    s_waitcnt lgkmcnt(0)
    buffer_store_dwordx4 v[52:55], v125, s[28:31], s60 offen sc1
    buffer_load_dwordx4 v124, s[24:27], s56 offen nt lds
    v_exp_f32 v105, v105
    v_mfma_f32_16x16x32_bf16 v[116:119], v[236:239], v[64:67], v[116:119]
    v_exp_f32 v88, v88
    v_mfma_f32_16x16x32_bf16 v[116:119], v[240:243], v[40:43], v[116:119]
    v_exp_f32 v89, v89
    v_mfma_f32_16x16x32_bf16 v[116:119], v[244:247], v[92:95], v[116:119]
    v_exp_f32 v90, v90
    v_mfma_f32_16x16x32_bf16 v[116:119], v[248:251], v[96:99], v[116:119]
    v_exp_f32 v91, v91
    v_mfma_f32_16x16x32_bf16 v[116:119], v[252:255], v[32:35], v[116:119]
    v_cvt_pk_bf16_f32 v34, v88, v89
    v_cvt_pk_bf16_f32 v35, v90, v91
    v_mfma_f32_16x16x32_f16 v[28:31], v[56:59], v[24:27], v[184:187]
    v_exp_f32 v106, v106
    v_mfma_f32_16x16x32_f16 v[28:31], v[140:143], v[144:147], v[28:31]
    v_exp_f32 v107, v107
    v_mfma_f32_16x16x32_f16 v[40:43], v[56:59], v[76:79], v[172:175]
    buffer_store_dwordx4 v[44:47], v124, s[28:31], s60 offen sc1
    v_cvt_pk_bf16_f32 v168, v104, v105
    v_cvt_pk_bf16_f32 v169, v106, v107
    s_nop 0
    v_mfma_f32_16x16x32_f16 v[40:43], v[140:143], v[138:141], v[40:43]
    s_mov_b32 s53, s47
    v_exp_f32 v28, v28
    v_mfma_f32_16x16x32_f16 v[44:47], v[12:15], v[24:27], v[192:195]
    s_mov_b32 s47, s46
    v_exp_f32 v29, v29
    v_mfma_f32_16x16x32_f16 v[44:47], v[152:155], v[144:147], v[44:47]
    s_mov_b32 s46, s45
    v_exp_f32 v30, v30
    v_mfma_f32_16x16x32_f16 v[52:55], v[68:71], v[76:79], v[208:211]
    s_mov_b32 s45, s44
    v_exp_f32 v31, v31
    v_mfma_f32_16x16x32_f16 v[52:55], v[60:63], v[56:59], v[52:55]
    s_mov_b32 s44, s53
    v_exp_f32 v40, v40
    v_mfma_f32_16x16x32_f16 v[52:55], v[72:75], v[140:143], v[52:55]
    s_sub_u32 s48, s44, s46
    v_exp_f32 v44, v44
    v_mfma_f32_16x16x32_f16 v[64:67], v[68:71], v[24:27], v[208:211]
    s_sub_u32 s49, s46, s45
    v_exp_f32 v45, v45
    v_mfma_f32_16x16x32_f16 v[64:67], v[60:63], v[8:11], v[64:67]
    s_cmp_lg_u32 s5, -1
    v_exp_f32 v46, v46
    v_mfma_f32_16x16x32_f16 v[64:67], v[72:75], v[146:149], v[64:67]
    ds_read_b128 v[60:63], v136 offset:1536
    v_cvt_pk_bf16_f32 v16, v44, v45
    v_mfma_f32_16x16x32_bf16 v[98:101], v[220:223], v[34:37], 0
    ds_read_b128 v[68:71], v137 offset:1664
    v_fma_f32 v32, v48, v48, s42
    v_mfma_f32_16x16x32_bf16 v[98:101], v[220:223], v[168:171], v[98:101]
    s_nop 0
    ds_read_b128 v[88:91], v137 offset:1536
    v_mov_b32_dpp v19, v67 quad_perm:[0,1,2,3] row_mask:0x2 bank_mask:0xf
    v_mfma_f32_16x16x32_bf16 v[104:107], v[0:3], v[34:37], 0
    ds_read_b128 v[72:75], v136 offset:1664
    v_mov_b32_dpp v19, v55 quad_perm:[0,1,2,3] row_mask:0x4 bank_mask:0xf
    v_mfma_f32_16x16x32_bf16 v[104:107], v[164:167], v[168:171], v[104:107]
    ds_read_b128 v[84:87], v136 offset:1792
    v_fmac_f32 v32, v49, v49
    v_mfma_f32_16x16x32_bf16 v[92:95], v[20:23], v[34:37], 0
    v_exp_f32 v47, v47
    v_mfma_f32_16x16x32_bf16 v[92:95], v[160:163], v[168:171], v[92:95]
    v_cvt_pk_bf16_f32 v17, v46, v47
    v_fmac_f32 v32, v50, v50
    v_mfma_f32_16x16x32_bf16 v[44:47], v[4:7], v[34:37], 0
    ds_read_b128 v[36:39], v137 offset:1792
    v_fmac_f32 v32, v51, v51
    v_mfma_f32_16x16x32_bf16 v[44:47], v[156:159], v[168:171], v[44:47]
    v_exp_f32 v65, v65
    v_mfma_f32_16x16x32_f16 v[108:111], v[12:15], v[76:79], v[180:183]
    v_exp_f32 v19, v19
    v_mfma_f32_16x16x32_f16 v[108:111], v[152:155], v[138:141], v[108:111]
    v_cvt_pk_bf16_f32 v19, v19, v19
    v_cvt_pk_bf16_f32 v168, v28, v29
    v_mfma_f32_16x16x32_f16 v[152:155], v[8:11], v[76:79], v[176:179]
    ds_write_b16 v131, v19 offset:64
    v_mfma_f32_16x16x32_f16 v[152:155], v[146:149], v[138:141], v[152:155]
    s_waitcnt lgkmcnt(3)
    v_rcp_f32 v98, v98
    v_mfma_f32_16x16x32_bf16 v[140:143], a[216:219], v[88:91], 0
    v_mul_f32 v104, v104, v98
    v_mul_f32 v105, v105, v98
    v_mfma_f32_16x16x32_bf16 v[140:143], a[220:223], v[60:63], v[140:143]
    ds_read_b128 v[12:15], v132 offset:48
    v_cvt_pk_bf16_f32 v104, v104, v105
    v_mfma_f32_16x16x32_bf16 v[140:143], a[224:227], v[68:71], v[140:143]
    ds_read_b128 v[76:79], v132 offset:64
    v_mul_f32 v106, v106, v98
    v_mfma_f32_16x16x32_bf16 v[140:143], a[228:231], v[72:75], v[140:143]
    s_waitcnt lgkmcnt(3)
    v_mul_f32 v107, v107, v98
    v_cvt_pk_bf16_f32 v105, v106, v107
    v_mfma_f32_16x16x32_bf16 v[140:143], a[232:235], v[36:39], v[140:143]
    v_mul_f32 v92, v92, v98
    v_mul_f32 v93, v93, v98
    v_mfma_f32_16x16x32_bf16 v[140:143], a[236:239], v[84:87], v[140:143]
    v_cvt_pk_bf16_f32 v106, v92, v93
    v_mul_f32 v94, v94, v98
    v_mfma_f32_16x16x32_bf16 v[56:59], v[232:235], v[88:91], 0
    ds_write_b64 v135, v[104:105] offset:0
    v_mfma_f32_16x16x32_bf16 v[56:59], v[236:239], v[60:63], v[56:59]
    v_mul_f32 v95, v95, v98
    v_cvt_pk_bf16_f32 v107, v94, v95
    v_mfma_f32_16x16x32_bf16 v[56:59], v[240:243], v[68:71], v[56:59]
    v_mul_f32 v44, v44, v98
    v_mul_f32 v45, v45, v98
    v_mfma_f32_16x16x32_bf16 v[56:59], v[244:247], v[72:75], v[56:59]
    ds_read_b128 v[92:95], v137 offset:3200
    v_cvt_pk_bf16_f32 v18, v44, v45
    v_mfma_f32_16x16x32_bf16 v[56:59], v[248:251], v[36:39], v[56:59]
    v_mul_f32 v46, v46, v98
    v_mul_f32 v47, v47, v98
    v_mfma_f32_16x16x32_bf16 v[56:59], v[252:255], v[84:87], v[56:59]
    s_waitcnt lgkmcnt(2)
    v_cvt_pk_bf16_f32 v19, v46, v47
    v_cvt_pk_bf16_f32 v169, v30, v31
    v_mfma_f32_16x16x32_bf16 v[28:31], v[12:15], v[0:3], 0
    v_cvt_pk_bf16_f32 v170, v65, 0
    v_fmac_f32 v32, v80, v80
    v_mfma_f32_16x16x32_bf16 v[28:31], v[76:79], v[164:167], v[28:31]
    ds_write_b64 v135, v[106:107] offset:8
    v_mfma_f32_16x16x32_bf16 v[44:47], v[12:15], v[20:23], 0
    v_exp_f32 v41, v41
    v_mfma_f32_16x16x32_bf16 v[44:47], v[76:79], v[160:163], v[44:47]
    v_exp_f32 v42, v42
    v_mfma_f32_16x16x32_bf16 v[64:67], v[12:15], v[4:7], 0
    s_nop 0
    ds_read_b128 v[12:15], v137 offset:3072
    v_fmac_f32 v32, v81, v81
    v_mfma_f32_16x16x32_bf16 v[64:67], v[76:79], v[156:159], v[64:67]
    s_nop 0
    ds_read_b128 v[98:101], v136 offset:3072
    v_mov_b32_dpp v31, v47 quad_perm:[0,1,2,3] row_mask:0x2 bank_mask:0xf
    v_mfma_f32_16x16x32_bf16 v[44:47], a[240:243], v[88:91], 0
    ds_read_b128 v[104:107], v136 offset:3200
    v_fmac_f32 v32, v82, v82
    v_mfma_f32_16x16x32_bf16 v[44:47], a[244:247], v[60:63], v[44:47]
    s_nop 0
    ds_read_b128 v[62:65], v137 offset:3328
    v_mov_b32_dpp v31, v67 quad_perm:[0,1,2,3] row_mask:0x4 bank_mask:0xf
    v_mfma_f32_16x16x32_bf16 v[44:47], a[248:251], v[68:71], v[44:47]
    ds_read_b128 v[66:69], v136 offset:3328
    v_cvt_pk_bf16_f32 v31, v31, v31
    v_mfma_f32_16x16x32_bf16 v[44:47], a[252:255], v[72:75], v[44:47]
    v_exp_f32 v43, v43
    v_mfma_f32_16x16x32_bf16 v[44:47], v[224:227], v[36:39], v[44:47]
    v_exp_f32 v54, v54
    v_mfma_f32_16x16x32_bf16 v[44:47], v[228:231], v[84:87], v[44:47]
    v_exp_f32 v152, v152
    v_mfma_f32_16x16x32_f16 v[36:39], v[8:11], v[24:27], v[188:191]
    ds_write_b16 v131, v31
    v_mfma_f32_16x16x32_f16 v[36:39], v[146:149], v[144:147], v[36:39]
    s_waitcnt lgkmcnt(5)
    v_exp_f32 v153, v153
    v_mfma_f32_16x16x32_bf16 v[88:91], a[240:243], v[12:15], 0
    s_waitcnt lgkmcnt(4)
    v_exp_f32 v154, v154
    v_mfma_f32_16x16x32_bf16 v[88:91], a[244:247], v[98:101], v[88:91]
    v_exp_f32 v155, v155
    v_mfma_f32_16x16x32_bf16 v[88:91], a[248:251], v[92:95], v[88:91]
    s_waitcnt lgkmcnt(2)
    ds_write_b32 v134, v18 offset:0
    v_mfma_f32_16x16x32_bf16 v[88:91], a[252:255], v[104:107], v[88:91]
    v_cvt_pk_bf16_f32 v30, v152, v153
    v_cvt_pk_bf16_f32 v31, v154, v155
    v_mfma_f32_16x16x32_bf16 v[88:91], v[224:227], v[62:65], v[88:91]
    s_waitcnt lgkmcnt(2)
    v_exp_f32 v36, v36
    v_mfma_f32_16x16x32_bf16 v[88:91], v[228:231], v[66:69], v[88:91]
    v_exp_f32 v37, v37
    v_mfma_f32_16x16x32_bf16 v[24:27], a[216:219], v[12:15], 0
    ds_write_b32 v134, v19 offset:4
    v_mfma_f32_16x16x32_bf16 v[24:27], a[220:223], v[98:101], v[24:27]
    v_exp_f32 v38, v38
    v_mfma_f32_16x16x32_bf16 v[24:27], a[224:227], v[92:95], v[24:27]
    v_exp_f32 v39, v39
    v_mfma_f32_16x16x32_bf16 v[24:27], a[228:231], v[104:107], v[24:27]
    v_cvt_pk_bf16_f32 v18, v36, v37
    v_cvt_pk_bf16_f32 v19, v38, v39
    v_mfma_f32_16x16x32_bf16 v[24:27], a[232:235], v[62:65], v[24:27]
    v_exp_f32 v108, v108
    v_mfma_f32_16x16x32_bf16 v[24:27], a[236:239], v[66:69], v[24:27]
    v_exp_f32 v109, v109
    v_mfma_f32_16x16x32_bf16 v[152:155], v[220:223], v[16:19], 0
    v_exp_f32 v110, v110
    v_mfma_f32_16x16x32_bf16 v[152:155], v[220:223], v[168:171], v[152:155]
    s_nop 0
    v_exp_f32 v111, v111
    v_mfma_f32_16x16x32_bf16 v[36:39], v[0:3], v[16:19], 0
    s_nop 0
    v_cvt_pk_bf16_f32 v28, v108, v109
    v_cvt_pk_bf16_f32 v29, v110, v111
    v_mfma_f32_16x16x32_bf16 v[36:39], v[164:167], v[168:171], v[36:39]
    s_nop 0
    v_rcp_f32 v152, v152
    v_mfma_f32_16x16x32_bf16 v[146:149], v[20:23], v[16:19], 0
    v_add_u32 v137, s48, v137
    v_add_u32 v136, s48, v136
    v_mfma_f32_16x16x32_bf16 v[146:149], v[160:163], v[168:171], v[146:149]
    s_nop 0
    ds_read_b128 v[84:87], v137 offset:0
    v_mul_f32 v36, v36, v152
    v_mfma_f32_16x16x32_bf16 v[76:79], v[4:7], v[16:19], 0
    ds_read_b128 v[108:111], v136 offset:0
    v_mul_f32 v37, v37, v152
    v_mfma_f32_16x16x32_bf16 v[76:79], v[156:159], v[168:171], v[76:79]
    ds_read_b128 v[8:11], v137 offset:128
    v_cvt_pk_bf16_f32 v168, v40, v41
    v_mfma_f32_16x16x32_bf16 v[72:75], v[232:235], v[12:15], 0
    ds_read_b128 v[112:115], v136 offset:128
    v_cvt_pk_bf16_f32 v169, v42, v43
    v_mfma_f32_16x16x32_bf16 v[72:75], v[236:239], v[98:101], v[72:75]
    ds_read_b128 v[40:43], v137 offset:256
    v_cvt_pk_bf16_f32 v170, v54, 0
    v_mfma_f32_16x16x32_bf16 v[72:75], v[240:243], v[92:95], v[72:75]
    ds_read_b128 v[52:55], v136 offset:256
    v_cvt_pk_bf16_f32 v12, v36, v37
    v_mfma_f32_16x16x32_bf16 v[72:75], v[244:247], v[104:107], v[72:75]
    ds_read_b128 v[104:107], v136 offset:1792
    v_mul_f32 v38, v38, v152
    v_mfma_f32_16x16x32_bf16 v[72:75], v[248:251], v[62:65], v[72:75]
    ds_read_b128 v[60:63], v136 offset:1536
    v_mul_f32 v39, v39, v152
    v_mfma_f32_16x16x32_bf16 v[72:75], v[252:255], v[66:69], v[72:75]
    ds_read_b128 v[98:101], v137 offset:1664
    v_cvt_pk_bf16_f32 v13, v38, v39
    v_mfma_f32_16x16x32_bf16 v[36:39], v[220:223], v[28:31], 0
    ds_read_b128 v[68:71], v137 offset:1536
    v_mul_f32 v146, v146, v152
    v_mfma_f32_16x16x32_bf16 v[36:39], v[220:223], v[168:171], v[36:39]
    v_mul_f32 v147, v147, v152
    v_cvt_pk_bf16_f32 v14, v146, v147
    v_mfma_f32_16x16x32_bf16 v[64:67], v[0:3], v[28:31], 0
    v_mul_f32 v148, v148, v152
    v_mul_f32 v149, v149, v152
    v_mfma_f32_16x16x32_bf16 v[64:67], v[164:167], v[168:171], v[64:67]
    v_cvt_pk_bf16_f32 v15, v148, v149
    v_mul_f32 v76, v76, v152
    v_mfma_f32_16x16x32_bf16 v[0:3], v[20:23], v[28:31], 0
    ds_write_b32 v135, v12 offset:1536
    v_mfma_f32_16x16x32_bf16 v[0:3], v[160:163], v[168:171], v[0:3]
    v_mul_f32 v77, v77, v152
    v_cvt_pk_bf16_f32 v154, v76, v77
    v_mfma_f32_16x16x32_bf16 v[146:149], v[4:7], v[28:31], 0
    v_mul_f32 v78, v78, v152
    v_mul_f32 v79, v79, v152
    v_mfma_f32_16x16x32_bf16 v[146:149], v[156:159], v[168:171], v[146:149]
    s_waitcnt lgkmcnt(3)
    v_cvt_pk_bf16_f32 v155, v78, v79
    v_fmac_f32 v32, v83, v83
    v_mfma_f32_16x16x32_bf16 v[28:31], a[0:3], v[84:87], 0
    s_cbranch_scc1 L_loopF0
L_tailF:
    ds_write_b32 v135, v13 offset:1540
    v_rcp_f32 v36, v36
    s_mov_b32 s30, 100270464
    s_mul_i32 s89, s68, 7168
    ds_write_b64 v135, v[14:15] offset:1544
    v_mul_f32 v64, v64, v36
    v_mul_f32 v65, v65, v36
    v_cvt_pk_bf16_f32 v4, v64, v65
    s_add_u32 s89, s89, 135168
    s_movk_i32 s90, 112
    ds_write_b64 v134, v[154:155] offset:1536
    v_mul_f32 v66, v66, v36
    v_mul_f32 v67, v67, v36
    v_cvt_pk_bf16_f32 v5, v66, v67
    v_mul_f32 v0, v0, v36
    v_mul_f32 v1, v1, v36
    v_cvt_pk_bf16_f32 v6, v0, v1
    v_mul_f32 v2, v2, v36
    v_mul_f32 v3, v3, v36
    v_cvt_pk_bf16_f32 v7, v2, v3
    v_mul_f32 v146, v146, v36
    v_mul_f32 v147, v147, v36
    v_cvt_pk_bf16_f32 v120, v146, v147
    v_mul_f32 v148, v148, v36
    v_mul_f32 v149, v149, v36
    v_cvt_pk_bf16_f32 v121, v148, v149
    s_lshr_b32 s91, s64, 16
    s_lshl_b32 s92, s68, 10
    ds_write_b64 v135, v[4:5] offset:3072
    v_fmac_f32 v32, v116, v116
    s_sub_u32 s84, s45, s44
    s_sub_u32 s85, s46, s45
    ds_write_b64 v135, v[6:7] offset:3080
    v_fmac_f32 v32, v117, v117
    v_fmac_f32 v32, v118, v118
    v_fmac_f32 v32, v119, v119
    s_sub_u32 s86, s44, s45
    s_sub_u32 s93, s44, s47
    ds_write_b32 v134, v120 offset:3072
    ds_write_b32 v134, v121 offset:3076
    v_fma_f32 v120, v140, v140, s42
    v_fmac_f32 v120, v141, v141
    v_fmac_f32 v120, v142, v142
    v_fmac_f32 v120, v143, v143
    v_fmac_f32 v120, v44, v44
    v_fmac_f32 v120, v45, v45
    v_fmac_f32 v120, v46, v46
    v_fmac_f32 v120, v47, v47
    v_fmac_f32 v120, v56, v56
    v_fmac_f32 v120, v57, v57
    v_fmac_f32 v120, v58, v58
    v_fmac_f32 v120, v59, v59
    v_fma_f32 v121, v24, v24, s42
    v_fmac_f32 v121, v25, v25
    v_fmac_f32 v121, v26, v26
    v_fmac_f32 v121, v27, v27
    v_fmac_f32 v121, v88, v88
    v_fmac_f32 v121, v89, v89
    v_fmac_f32 v121, v90, v90
    v_fmac_f32 v121, v91, v91
    v_fmac_f32 v121, v72, v72
    v_fmac_f32 v121, v73, v73
    v_fmac_f32 v121, v74, v74
    v_fmac_f32 v121, v75, v75
    v_cvt_pk_bf16_f32 v120, v32, v120
    v_cvt_pk_bf16_f32 v121, v121, v122
    s_sub_u32 s94, s45, s47
    s_sub_u32 s95, s46, s47
    ds_write_b64 v130, v[120:121]
    v_mbcnt_lo_u32_b32 v131, -1, 0
    v_mbcnt_hi_u32_b32 v131, -1, v131
    v_and_b32 v138, 15, v131
    v_lshrrev_b32 v131, 4, v131
    v_mul_u32_u24 v131, 1792, v131
    v_add_u32 v131, s89, v131
    v_mad_u32_u24 v132, v138, s90, v131
    v_lshrrev_b32 v139, v138, s64
    v_and_b32 v139, 1, v139
    v_cmp_eq_u32 vcc, 1, v139
    v_mad_u32_u24 v16, v138, s90, v131
    v_lshrrev_b32 v138, v138, s91
    v_cndmask_b32 v132, v131, v132, vcc
    v_and_b32 v138, 1, v138
    v_subrev_u32 v16, 28672, v16
    v_cmp_eq_u32 vcc, 1, v138
    ds_read_b128 v[36:39], v132 offset:64
    ds_read_b128 v[32:35], v132 offset:80
    v_cndmask_b32 v16, v131, v16, vcc
    v_add_u32 v131, s92, v129
    s_waitcnt lgkmcnt(2)
    s_barrier
    ds_read_b128 v[4:7], v132
    v_add_u32 v18, s84, v137
    ds_read_b64 v[8:9], v132 offset:16
    ds_read_b128 v[0:3], v131 offset:6144
    v_add_u32 v17, s84, v136
    v_add_u32 v120, s85, v135
    ds_read_b128 v[28:31], v129 offset:0
    v_add_u32 v19, s85, v134
    ds_read_b128 v[20:23], v129 offset:1024
    v_add_u32 v138, s86, v135
    v_add_u32 v132, s86, v134
    v_add_u32 v131, s93, v133
    v_add_u32 v139, s94, v133
    s_waitcnt lgkmcnt(6)
    v_mfma_f32_16x16x32_bf16 v[12:15], v[220:223], v[36:39], 0
    s_waitcnt lgkmcnt(5)
    ds_read_b128 a[24:27], v18 offset:1536
    ds_read_b128 a[28:31], v17 offset:1536
    v_mfma_f32_16x16x32_bf16 v[12:15], v[220:223], v[32:35], v[12:15]
    s_waitcnt lgkmcnt(3)
    ds_read_b128 a[32:35], v18 offset:1664
    v_lshlrev_b32 v122, 16, v4
    v_and_b32 v4, 0xffff0000, v4
    v_lshlrev_b32 v121, 16, v5
    v_and_b32 v5, 0xffff0000, v5
    v_lshlrev_b32 v11, 16, v6
    v_and_b32 v6, 0xffff0000, v6
    v_rcp_f32 v12, v12
    v_lshlrev_b32 v10, 16, v7
    v_mfma_f32_16x16x32_bf16 v[64:67], v[216:219], v[28:31], 0
    s_waitcnt lgkmcnt(3)
    ds_read_b128 a[36:39], v17 offset:1664
    ds_read_b128 a[40:43], v18 offset:1792
    v_mfma_f32_16x16x32_bf16 v[64:67], v[216:219], v[20:23], v[64:67]
    s_waitcnt lgkmcnt(4)
    ds_read_b128 a[44:47], v17 offset:1792
    v_mul_f32 v122, v122, v12
    v_mul_f32 v4, v4, v12
    v_cvt_pk_bf16_f32 v4, v122, v4
    v_mul_f32 v121, v121, v12
    v_mfma_f32_16x16x32_bf16 v[32:35], a[216:219], a[24:27], 0
    s_waitcnt lgkmcnt(4)
    v_mul_f32 v5, v5, v12
    v_cvt_pk_bf16_f32 v5, v121, v5
    v_mfma_f32_16x16x32_bf16 v[32:35], a[220:223], a[28:31], v[32:35]
    s_waitcnt lgkmcnt(3)
    ds_read_b128 a[0:3], v18 offset:0
    ds_read_b128 a[4:7], v17 offset:0
    v_mfma_f32_16x16x32_bf16 v[32:35], a[224:227], a[32:35], v[32:35]
    s_waitcnt lgkmcnt(4)
    ds_read_b128 a[8:11], v18 offset:128
    v_mul_f32 v11, v11, v12
    v_mul_f32 v6, v6, v12
    v_cvt_pk_bf16_f32 v6, v11, v6
    v_and_b32 v7, 0xffff0000, v7
    v_mul_f32 v10, v10, v12
    v_mfma_f32_16x16x32_bf16 v[32:35], a[228:231], a[36:39], v[32:35]
    s_waitcnt lgkmcnt(4)
    ds_read_b128 a[12:15], v17 offset:128
    ds_read_b128 a[16:19], v18 offset:256
    v_mfma_f32_16x16x32_bf16 v[32:35], a[232:235], a[40:43], v[32:35]
    s_waitcnt lgkmcnt(5)
    ds_read_b128 a[20:23], v17 offset:256
    v_mul_f32 v7, v7, v12
    v_mfma_f32_16x16x32_bf16 v[32:35], a[236:239], a[44:47], v[32:35]
    v_cvt_pk_bf16_f32 v7, v10, v7
    v_lshlrev_b32 v67, 16, v8
    v_mfma_f32_16x16x32_bf16 v[40:43], a[240:243], a[24:27], 0
    ds_write_b128 v138, v[4:7] offset:0
    v_mfma_f32_16x16x32_bf16 v[40:43], a[244:247], a[28:31], v[40:43]
    v_and_b32 v8, 0xffff0000, v8
    v_mul_f32 v67, v67, v12
    v_mfma_f32_16x16x32_bf16 v[40:43], a[248:251], a[32:35], v[40:43]
    v_mul_f32 v8, v8, v12
    v_cvt_pk_bf16_f32 v4, v67, v8
    v_mfma_f32_16x16x32_bf16 v[40:43], a[252:255], a[36:39], v[40:43]
    v_lshlrev_b32 v67, 16, v9
    v_and_b32 v9, 0xffff0000, v9
    v_mfma_f32_16x16x32_bf16 v[40:43], v[224:227], a[40:43], v[40:43]
    v_mul_f32 v67, v67, v12
    v_mul_f32 v9, v9, v12
    v_mfma_f32_16x16x32_bf16 v[40:43], v[228:231], a[44:47], v[40:43]
    v_cvt_pk_bf16_f32 v5, v67, v9
    v_lshrrev_b32 v67, 0, v3
    v_mfma_f32_16x16x32_bf16 v[36:39], v[232:235], a[24:27], 0
    ds_write_b64 v132, v[4:5] offset:0
    v_mfma_f32_16x16x32_bf16 v[36:39], v[236:239], a[28:31], v[36:39]
    v_lshrrev_b32 v67, v67, s64
    v_and_b32 v67, 1, v67
    v_mfma_f32_16x16x32_bf16 v[36:39], v[240:243], a[32:35], v[36:39]
    v_cmp_eq_u32 vcc, 1, v67
    v_lshrrev_b32 v67, 8, v3
    v_mfma_f32_16x16x32_bf16 v[36:39], v[244:247], a[36:39], v[36:39]
    v_cndmask_b32 v0, 2.0, v0, vcc
    v_lshrrev_b32 v67, v67, s64
    v_mfma_f32_16x16x32_bf16 v[36:39], v[248:251], a[40:43], v[36:39]
    v_and_b32 v67, 1, v67
    v_cmp_eq_u32 vcc, 1, v67
    v_mfma_f32_16x16x32_bf16 v[36:39], v[252:255], a[44:47], v[36:39]
    s_waitcnt lgkmcnt(1)
    v_cndmask_b32 v1, 2.0, v1, vcc
    v_lshrrev_b32 v3, 16, v3
    v_mfma_f32_16x16x32_bf16 v[52:55], a[216:219], a[0:3], 0
    v_lshrrev_b32 v3, v3, s64
    v_and_b32 v3, 1, v3
    v_mfma_f32_16x16x32_bf16 v[52:55], a[220:223], a[4:7], v[52:55]
    ds_read_b128 a[48:51], v18 offset:3072
    ds_read_b128 a[52:55], v17 offset:3072
    v_mfma_f32_16x16x32_bf16 v[52:55], a[224:227], a[8:11], v[52:55]
    ds_read_b128 a[56:59], v18 offset:3200
    v_cmp_eq_u32 vcc, 1, v3
    v_mfma_f32_16x16x32_bf16 v[52:55], a[228:231], a[12:15], v[52:55]
    ds_read_b128 a[60:63], v17 offset:3200
    v_cndmask_b32 v2, 2.0, v2, vcc
    v_mfma_f32_16x16x32_bf16 v[52:55], a[232:235], a[16:19], v[52:55]
L_pg2:
    s_cbranch_execz L_main
    ds_read_b128 a[64:67], v18 offset:3328
    v_add_u32 v3, s95, v133
    v_mfma_f32_16x16x32_bf16 v[52:55], a[236:239], a[20:23], v[52:55]
    ds_read_b128 a[68:71], v17 offset:3328
    v_fma_f32 v18, v32, v32, s42
    v_mfma_f32_16x16x32_bf16 v[28:31], a[240:243], a[0:3], 0
    v_rsq_f32 v64, v64
    v_mfma_f32_16x16x32_bf16 v[28:31], a[244:247], a[4:7], v[28:31]
    v_mul_f32 v64, s43, v64
    v_mul_f32 v48, v48, v64
    v_mfma_f32_16x16x32_bf16 v[28:31], a[248:251], a[8:11], v[28:31]
    v_mul_f32 v49, v49, v64
    v_cvt_pk_bf16_f32 v4, v48, v49
    v_mfma_f32_16x16x32_bf16 v[28:31], a[252:255], a[12:15], v[28:31]
    v_mul_f32 v50, v50, v64
    v_mul_f32 v51, v51, v64
    v_mfma_f32_16x16x32_bf16 v[28:31], v[224:227], a[16:19], v[28:31]
    v_cvt_pk_bf16_f32 v5, v50, v51
    v_mul_f32 v80, v80, v64
    v_mfma_f32_16x16x32_bf16 v[28:31], v[228:231], a[20:23], v[28:31]
    v_mul_f32 v81, v81, v64
    v_cvt_pk_bf16_f32 v6, v80, v81
    v_mfma_f32_16x16x32_bf16 v[48:51], v[232:235], a[0:3], 0
    v_mul_f32 v82, v82, v64
    v_mul_f32 v83, v83, v64
    v_mfma_f32_16x16x32_bf16 v[48:51], v[236:239], a[4:7], v[48:51]
    v_cvt_pk_bf16_f32 v7, v82, v83
    v_mul_f32 v116, v116, v64
    v_mfma_f32_16x16x32_bf16 v[48:51], v[240:243], a[8:11], v[48:51]
    ds_write_b128 v120, v[4:7] offset:0
    v_mfma_f32_16x16x32_bf16 v[48:51], v[244:247], a[12:15], v[48:51]
    v_mul_f32 v117, v117, v64
    v_cvt_pk_bf16_f32 v116, v116, v117
    v_mfma_f32_16x16x32_bf16 v[48:51], v[248:251], a[16:19], v[48:51]
    v_mul_f32 v118, v118, v64
    v_mul_f32 v119, v119, v64
    v_mfma_f32_16x16x32_bf16 v[48:51], v[252:255], a[20:23], v[48:51]
    s_waitcnt lgkmcnt(1)
    v_cvt_pk_bf16_f32 v117, v118, v119
    v_fma_f32 v133, v52, v52, s42
    v_mfma_f32_16x16x32_bf16 v[4:7], a[216:219], a[48:51], 0
    ds_write_b64 v19, v[116:117] offset:0
    v_mfma_f32_16x16x32_bf16 v[4:7], a[220:223], a[52:55], v[4:7]
    ds_read_b128 v[68:71], v16 offset:64
    v_fmac_f32 v133, v53, v53
    v_mfma_f32_16x16x32_bf16 v[4:7], a[224:227], a[56:59], v[4:7]
    ds_read_b128 v[8:11], v16 offset:80
    v_fmac_f32 v133, v54, v54
    v_mfma_f32_16x16x32_bf16 v[4:7], a[228:231], a[60:63], v[4:7]
    ds_read_b128 v[12:15], v16
    v_fmac_f32 v133, v55, v55
    v_mfma_f32_16x16x32_bf16 v[4:7], a[232:235], a[64:67], v[4:7]
    ds_read_b64 v[16:17], v16 offset:16
    v_fmac_f32 v133, v28, v28
    v_mfma_f32_16x16x32_bf16 v[4:7], a[236:239], a[68:71], v[4:7]
    v_rsq_f32 v65, v65
    v_mfma_f32_16x16x32_bf16 v[60:63], a[240:243], a[48:51], 0
    v_mul_f32 v65, s43, v65
    v_mul_f32 v140, v140, v65
    v_mfma_f32_16x16x32_bf16 v[60:63], a[244:247], a[52:55], v[60:63]
    v_mul_f32 v141, v141, v65
    v_cvt_pk_bf16_f32 v76, v140, v141
    v_mfma_f32_16x16x32_bf16 v[60:63], a[248:251], a[56:59], v[60:63]
    v_mul_f32 v142, v142, v65
    v_mul_f32 v143, v143, v65
    v_mfma_f32_16x16x32_bf16 v[60:63], a[252:255], a[60:63], v[60:63]
    v_cvt_pk_bf16_f32 v77, v142, v143
    v_mul_f32 v44, v44, v65
    v_mfma_f32_16x16x32_bf16 v[60:63], v[224:227], a[64:67], v[60:63]
    v_mul_f32 v45, v45, v65
    v_cvt_pk_bf16_f32 v78, v44, v45
    v_mfma_f32_16x16x32_bf16 v[60:63], v[228:231], a[68:71], v[60:63]
    v_mul_f32 v46, v46, v65
    v_mul_f32 v47, v47, v65
    v_mfma_f32_16x16x32_bf16 v[20:23], v[232:235], a[48:51], 0
    v_cvt_pk_bf16_f32 v79, v46, v47
    v_mul_f32 v56, v56, v65
    v_mfma_f32_16x16x32_bf16 v[20:23], v[236:239], a[52:55], v[20:23]
    ds_write_b128 v120, v[76:79] offset:1536
    v_mfma_f32_16x16x32_bf16 v[20:23], v[240:243], a[56:59], v[20:23]
    v_mul_f32 v57, v57, v65
    v_cvt_pk_bf16_f32 v56, v56, v57
    v_mfma_f32_16x16x32_bf16 v[20:23], v[244:247], a[60:63], v[20:23]
    v_mul_f32 v58, v58, v65
    v_mul_f32 v59, v59, v65
    v_mfma_f32_16x16x32_bf16 v[20:23], v[248:251], a[64:67], v[20:23]
    v_cvt_pk_bf16_f32 v57, v58, v59
    v_fmac_f32 v133, v29, v29
    v_mfma_f32_16x16x32_bf16 v[20:23], v[252:255], a[68:71], v[20:23]
    s_waitcnt lgkmcnt(1)
    ds_write_b64 v19, v[56:57] offset:1536
    v_mfma_f32_16x16x32_bf16 v[44:47], v[220:223], v[68:71], 0
    v_rsq_f32 v66, v66
    v_mfma_f32_16x16x32_bf16 v[44:47], v[220:223], v[8:11], v[44:47]
    v_mul_f32 v66, s43, v66
    v_mul_f32 v24, v24, v66
    v_mul_f32 v25, v25, v66
    v_cvt_pk_bf16_f32 v8, v24, v25
    v_mul_f32 v26, v26, v66
    v_mul_f32 v27, v27, v66
    v_cvt_pk_bf16_f32 v9, v26, v27
    v_mul_f32 v88, v88, v66
    v_mul_f32 v89, v89, v66
    v_cvt_pk_bf16_f32 v10, v88, v89
    v_mul_f32 v90, v90, v66
    v_mul_f32 v91, v91, v66
    v_cvt_pk_bf16_f32 v11, v90, v91
    v_mul_f32 v72, v72, v66
    v_mul_f32 v73, v73, v66
    v_cvt_pk_bf16_f32 v72, v72, v73
    v_mul_f32 v74, v74, v66
    v_mul_f32 v75, v75, v66
    v_cvt_pk_bf16_f32 v73, v74, v75
    ds_write_b128 v120, v[8:11] offset:3072
    v_fmac_f32 v133, v30, v30
    v_fmac_f32 v133, v31, v31
    v_fmac_f32 v133, v48, v48
    v_fmac_f32 v133, v49, v49
    ds_write_b64 v19, v[72:73] offset:3072
    v_fmac_f32 v133, v50, v50
    v_fmac_f32 v133, v51, v51
    v_fmac_f32 v18, v33, v33
    v_fmac_f32 v18, v34, v34
    v_fmac_f32 v18, v35, v35
    v_fmac_f32 v18, v40, v40
    v_fmac_f32 v18, v41, v41
    v_fmac_f32 v18, v42, v42
    v_fmac_f32 v18, v43, v43
    v_fmac_f32 v18, v36, v36
    v_fmac_f32 v18, v37, v37
    v_fmac_f32 v18, v38, v38
    v_fmac_f32 v18, v39, v39
    v_cvt_pk_bf16_f32 v18, v133, v18
    v_fma_f32 v133, v4, v4, s42
    v_fmac_f32 v133, v5, v5
    v_fmac_f32 v133, v6, v6
    v_fmac_f32 v133, v7, v7
    v_fmac_f32 v133, v60, v60
    v_fmac_f32 v133, v61, v61
    v_fmac_f32 v133, v62, v62
    v_fmac_f32 v133, v63, v63
    v_fmac_f32 v133, v20, v20
    v_fmac_f32 v133, v21, v21
    v_fmac_f32 v133, v22, v22
    v_fmac_f32 v133, v23, v23
    v_cvt_pk_bf16_f32 v19, v133, v133
    ds_write_b64 v130, v[18:19] offset:2048
    v_rcp_f32 v44, v44
    v_lshlrev_b32 v133, 16, v12
    v_and_b32 v12, 0xffff0000, v12
    v_mul_f32 v133, v133, v44
    v_mul_f32 v12, v12, v44
    v_cvt_pk_bf16_f32 v12, v133, v12
    v_lshlrev_b32 v133, 16, v13
    v_and_b32 v13, 0xffff0000, v13
    v_mul_f32 v133, v133, v44
    v_mul_f32 v13, v13, v44
    v_cvt_pk_bf16_f32 v13, v133, v13
    v_lshlrev_b32 v133, 16, v14
    v_and_b32 v14, 0xffff0000, v14
    v_mul_f32 v133, v133, v44
    v_mul_f32 v14, v14, v44
    v_cvt_pk_bf16_f32 v14, v133, v14
    v_lshlrev_b32 v133, 16, v15
    v_and_b32 v15, 0xffff0000, v15
    v_mul_f32 v133, v133, v44
    v_mul_f32 v15, v15, v44
    v_cvt_pk_bf16_f32 v15, v133, v15
    v_lshlrev_b32 v133, 16, v16
    v_and_b32 v16, 0xffff0000, v16
    v_mul_f32 v133, v133, v44
    v_mul_f32 v16, v16, v44
    v_cvt_pk_bf16_f32 v8, v133, v16
    v_lshlrev_b32 v133, 16, v17
    v_and_b32 v17, 0xffff0000, v17
    v_mul_f32 v133, v133, v44
    v_mul_f32 v17, v17, v44
    v_cvt_pk_bf16_f32 v9, v133, v17
    s_waitcnt lgkmcnt(0)
    s_barrier
    ds_write_b128 v138, v[12:15] offset:1536
    v_and_b32 v123, 0xb8000000, v123
    v_mov_b32 v121, 0x3f803f80
    v_cmp_ne_u32 vcc, 0, v123
    s_nop 0
    ds_write_b64 v132, v[8:9] offset:1536
    v_cndmask_b32 v121, 0, v121, vcc
    ds_read_b128 a[144:147], v3 offset:0
    ds_read_b128 a[148:151], v3 offset:1024
    ds_read_b128 a[152:155], v3 offset:2048
    ds_read_b128 a[156:159], v3 offset:3072
    ds_read_b128 a[160:163], v3 offset:4096
    s_waitcnt lgkmcnt(5)
    s_barrier
    s_waitcnt lgkmcnt(4)
    buffer_store_dwordx4 a[144:147], v128, s[28:31], s59 offen sc1
    ds_read_b128 v[16:19], v129 offset:2048
    ds_read_b128 v[8:11], v129 offset:3072
    ds_read_b128 a[96:99], v137 offset:1536
    ds_read_b128 a[100:103], v136 offset:1536
    ds_read_b128 a[104:107], v137 offset:1664
    ds_read_b128 a[108:111], v136 offset:1664
    ds_read_b128 a[112:115], v137 offset:1792
    s_waitcnt lgkmcnt(9)
    buffer_store_dwordx4 a[148:151], v127, s[28:31], s59 offen sc1
    ds_read_b128 a[116:119], v136 offset:1792
    s_waitcnt lgkmcnt(7)
    v_mfma_f32_16x16x32_bf16 v[12:15], v[216:219], v[16:19], 0
    s_waitcnt lgkmcnt(6)
    v_mfma_f32_16x16x32_bf16 v[12:15], v[216:219], v[8:11], v[12:15]
    s_waitcnt lgkmcnt(5)
    v_mfma_f32_16x16x32_bf16 v[8:11], a[216:219], a[96:99], 0
    s_waitcnt lgkmcnt(4)
    v_mfma_f32_16x16x32_bf16 v[8:11], a[220:223], a[100:103], v[8:11]
    s_waitcnt lgkmcnt(3)
    ds_read_b128 a[72:75], v137 offset:0
    ds_read_b128 a[76:79], v136 offset:0
    v_mfma_f32_16x16x32_bf16 v[8:11], a[224:227], a[104:107], v[8:11]
    s_waitcnt lgkmcnt(4)
    ds_read_b128 a[80:83], v137 offset:128
    v_mfma_f32_16x16x32_bf16 v[8:11], a[228:231], a[108:111], v[8:11]
    s_waitcnt lgkmcnt(4)
    buffer_store_dwordx4 a[152:155], v126, s[28:31], s59 offen sc1
    ds_read_b128 a[84:87], v136 offset:128
    v_rsq_f32 v12, v12
    v_mfma_f32_16x16x32_bf16 v[8:11], a[232:235], a[112:115], v[8:11]
    s_waitcnt lgkmcnt(4)
    ds_read_b128 a[88:91], v137 offset:256
    ds_read_b128 a[92:95], v136 offset:256
    v_mfma_f32_16x16x32_bf16 v[8:11], a[236:239], a[116:119], v[8:11]
    v_rsq_f32 v13, v13
    v_mfma_f32_16x16x32_bf16 v[16:19], a[240:243], a[96:99], 0
    v_mul_f32 v12, s43, v12
    v_mul_f32 v13, s43, v13
    v_mfma_f32_16x16x32_bf16 v[16:19], a[244:247], a[100:103], v[16:19]
    v_rsq_f32 v14, v14
    v_mfma_f32_16x16x32_bf16 v[16:19], a[248:251], a[104:107], v[16:19]
    v_mul_f32 v14, s43, v14
    v_mul_f32 v4, v4, v14
    v_mfma_f32_16x16x32_bf16 v[16:19], a[252:255], a[108:111], v[16:19]
    buffer_store_dwordx4 a[156:159], v125, s[28:31], s59 offen sc1
    v_mul_f32 v5, v5, v14
    v_cvt_pk_bf16_f32 v24, v4, v5
    v_mul_f32 v6, v6, v14
    v_mul_f32 v7, v7, v14
    v_mfma_f32_16x16x32_bf16 v[16:19], v[224:227], a[112:115], v[16:19]
    v_cvt_pk_bf16_f32 v25, v6, v7
    v_mul_f32 v60, v60, v14
    v_mfma_f32_16x16x32_bf16 v[16:19], v[228:231], a[116:119], v[16:19]
    v_mul_f32 v61, v61, v14
    v_cvt_pk_bf16_f32 v26, v60, v61
    v_mfma_f32_16x16x32_bf16 v[4:7], v[232:235], a[96:99], 0
    v_mul_f32 v62, v62, v14
    v_mul_f32 v63, v63, v14
    v_mfma_f32_16x16x32_bf16 v[4:7], v[236:239], a[100:103], v[4:7]
    v_cvt_pk_bf16_f32 v27, v62, v63
    v_mul_f32 v20, v20, v14
    v_mfma_f32_16x16x32_bf16 v[4:7], v[240:243], a[104:107], v[4:7]
    ds_write_b128 v135, v[24:27] offset:3072
    v_mfma_f32_16x16x32_bf16 v[4:7], v[244:247], a[108:111], v[4:7]
    buffer_store_dwordx4 a[160:163], v124, s[28:31], s59 offen sc1
    v_mul_f32 v21, v21, v14
    v_cvt_pk_bf16_f32 v136, v20, v21
    v_mul_f32 v22, v22, v14
    v_mul_f32 v23, v23, v14
    v_mfma_f32_16x16x32_bf16 v[4:7], v[248:251], a[112:115], v[4:7]
    v_cvt_pk_bf16_f32 v137, v22, v23
    v_mul_f32 v52, v52, v12
    v_mfma_f32_16x16x32_bf16 v[4:7], v[252:255], a[116:119], v[4:7]
    s_waitcnt lgkmcnt(1)
    ds_write_b64 v134, v[136:137] offset:3072
    v_mfma_f32_16x16x32_bf16 v[20:23], a[216:219], a[72:75], 0
    v_mul_f32 v53, v53, v12
    v_cvt_pk_bf16_f32 v24, v52, v53
    v_mfma_f32_16x16x32_bf16 v[20:23], a[220:223], a[76:79], v[20:23]
    v_mul_f32 v54, v54, v12
    v_mul_f32 v55, v55, v12
    v_mfma_f32_16x16x32_bf16 v[20:23], a[224:227], a[80:83], v[20:23]
    v_cvt_pk_bf16_f32 v25, v54, v55
    v_mul_f32 v28, v28, v12
    v_mfma_f32_16x16x32_bf16 v[20:23], a[228:231], a[84:87], v[20:23]
    v_mul_f32 v29, v29, v12
    v_cvt_pk_bf16_f32 v26, v28, v29
    v_mfma_f32_16x16x32_bf16 v[20:23], a[232:235], a[88:91], v[20:23]
    v_mul_f32 v30, v30, v12
    v_mul_f32 v31, v31, v12
    v_mfma_f32_16x16x32_bf16 v[20:23], a[236:239], a[92:95], v[20:23]
    v_cvt_pk_bf16_f32 v27, v30, v31
    v_mul_f32 v48, v48, v12
    v_mfma_f32_16x16x32_bf16 v[28:31], a[240:243], a[72:75], 0
    ds_write_b128 v135, v[24:27] offset:0
    v_mfma_f32_16x16x32_bf16 v[28:31], a[244:247], a[76:79], v[28:31]
    v_mul_f32 v49, v49, v12
    v_cvt_pk_bf16_f32 v14, v48, v49
    v_mfma_f32_16x16x32_bf16 v[28:31], a[248:251], a[80:83], v[28:31]
    v_mul_f32 v50, v50, v12
    v_mul_f32 v51, v51, v12
    v_mfma_f32_16x16x32_bf16 v[28:31], a[252:255], a[84:87], v[28:31]
    v_cvt_pk_bf16_f32 v15, v50, v51
    v_fma_f32 v3, v8, v8, s42
    v_mfma_f32_16x16x32_bf16 v[28:31], v[224:227], a[88:91], v[28:31]
    ds_write_b64 v134, v[14:15] offset:0
    v_mfma_f32_16x16x32_bf16 v[28:31], v[228:231], a[92:95], v[28:31]
    v_fmac_f32 v3, v9, v9
    v_fmac_f32 v3, v10, v10
    v_mfma_f32_16x16x32_bf16 v[24:27], v[232:235], a[72:75], 0
    v_fmac_f32 v3, v11, v11
    v_fmac_f32 v3, v16, v16
    v_mfma_f32_16x16x32_bf16 v[24:27], v[236:239], a[76:79], v[24:27]
    v_fmac_f32 v3, v17, v17
    v_fmac_f32 v3, v18, v18
    v_mfma_f32_16x16x32_bf16 v[24:27], v[240:243], a[80:83], v[24:27]
    v_fmac_f32 v3, v19, v19
    v_fmac_f32 v3, v4, v4
    v_mfma_f32_16x16x32_bf16 v[24:27], v[244:247], a[84:87], v[24:27]
    v_fmac_f32 v3, v5, v5
    v_fmac_f32 v3, v6, v6
    v_mfma_f32_16x16x32_bf16 v[24:27], v[248:251], a[88:91], v[24:27]
    v_fmac_f32 v3, v7, v7
    v_fma_f32 v133, v20, v20, s42
    v_mfma_f32_16x16x32_bf16 v[24:27], v[252:255], a[92:95], v[24:27]
    s_nop 0
    v_fmac_f32 v133, v21, v21
    v_fmac_f32 v133, v22, v22
    v_fmac_f32 v133, v23, v23
    v_fmac_f32 v133, v28, v28
    v_fmac_f32 v133, v29, v29
    v_fmac_f32 v133, v30, v30
    v_fmac_f32 v133, v31, v31
    v_fmac_f32 v133, v24, v24
    v_fmac_f32 v133, v25, v25
    v_fmac_f32 v133, v26, v26
    v_fmac_f32 v133, v27, v27
    v_cvt_pk_bf16_f32 v120, v133, v3
    ds_write_b64 v130, v[120:121] offset:4096
    v_mul_f32 v32, v32, v13
    v_mul_f32 v33, v33, v13
    v_cvt_pk_bf16_f32 v32, v32, v33
    v_mul_f32 v34, v34, v13
    v_mul_f32 v35, v35, v13
    v_cvt_pk_bf16_f32 v33, v34, v35
    v_mul_f32 v40, v40, v13
    v_mul_f32 v41, v41, v13
    v_cvt_pk_bf16_f32 v34, v40, v41
    v_mul_f32 v42, v42, v13
    v_mul_f32 v43, v43, v13
    v_cvt_pk_bf16_f32 v35, v42, v43
    v_mul_f32 v36, v36, v13
    v_mul_f32 v37, v37, v13
    v_cvt_pk_bf16_f32 v136, v36, v37
    v_mul_f32 v38, v38, v13
    v_mul_f32 v39, v39, v13
    v_cvt_pk_bf16_f32 v137, v38, v39
    ds_write_b128 v135, v[32:35] offset:1536
    s_waitcnt lgkmcnt(1)
    s_barrier
    ds_write_b64 v134, v[136:137] offset:1536
    ds_read_b128 v[36:39], v129 offset:4096
    ds_read_b128 v[32:35], v129 offset:5120
    s_waitcnt lgkmcnt(2)
    s_barrier
    s_waitcnt lgkmcnt(1)
    v_mfma_f32_16x16x32_bf16 v[12:15], v[216:219], v[36:39], 0
    s_waitcnt lgkmcnt(0)
    ds_read_b128 a[164:167], v139 offset:0
    ds_read_b128 a[168:171], v139 offset:1024
    v_mfma_f32_16x16x32_bf16 v[12:15], v[216:219], v[32:35], v[12:15]
    s_nop 0
    ds_read_b128 a[172:175], v139 offset:2048
    s_nop 2
    ds_read_b128 a[176:179], v139 offset:3072
    s_nop 1
    v_rsq_f32 v12, v12
    ds_read_b128 a[180:183], v139 offset:4096
    v_mul_f32 v12, s43, v12
    v_mul_f32 v20, v20, v12
    v_mul_f32 v21, v21, v12
    v_cvt_pk_bf16_f32 v20, v20, v21
    v_mul_f32 v22, v22, v12
    v_mul_f32 v23, v23, v12
    v_cvt_pk_bf16_f32 v21, v22, v23
    v_mul_f32 v28, v28, v12
    v_mul_f32 v29, v29, v12
    s_waitcnt lgkmcnt(4)
    buffer_store_dwordx4 a[164:167], v128, s[28:31], s58 offen sc1
    v_cvt_pk_bf16_f32 v22, v28, v29
    v_mul_f32 v30, v30, v12
    v_mul_f32 v31, v31, v12
    v_cvt_pk_bf16_f32 v23, v30, v31
    v_mul_f32 v24, v24, v12
    v_mul_f32 v25, v25, v12
    v_cvt_pk_bf16_f32 v128, v24, v25
    v_mul_f32 v26, v26, v12
    v_mul_f32 v27, v27, v12
    v_cvt_pk_bf16_f32 v129, v26, v27
    ds_write_b128 v138, v[20:23] offset:0
    v_rsq_f32 v13, v13
    v_cmp_neq_f32 vcc, 0, v14
    v_mul_f32 v13, s43, v13
    s_waitcnt lgkmcnt(1)
    buffer_store_dwordx4 a[168:171], v127, s[28:31], s58 offen sc1
    ds_write_b64 v132, v[128:129] offset:0
    v_mul_f32 v8, v8, v13
    v_mul_f32 v9, v9, v13
    v_cvt_pk_bf16_f32 v8, v8, v9
    v_mul_f32 v10, v10, v13
    v_mul_f32 v11, v11, v13
    v_cvt_pk_bf16_f32 v9, v10, v11
    v_mul_f32 v16, v16, v13
    v_mul_f32 v17, v17, v13
    v_cvt_pk_bf16_f32 v10, v16, v17
    v_mul_f32 v18, v18, v13
    v_mul_f32 v19, v19, v13
    v_cvt_pk_bf16_f32 v11, v18, v19
    v_mul_f32 v4, v4, v13
    v_mul_f32 v5, v5, v13
    v_cvt_pk_bf16_f32 v128, v4, v5
    v_mul_f32 v6, v6, v13
    v_mul_f32 v7, v7, v13
    v_cvt_pk_bf16_f32 v129, v6, v7
    buffer_store_dwordx4 a[172:175], v126, s[28:31], s58 offen sc1
    ds_write_b128 v138, v[8:11] offset:1536
    ds_write_b64 v132, v[128:129] offset:1536
    buffer_store_dwordx4 a[176:179], v125, s[28:31], s58 offen sc1
    s_waitcnt lgkmcnt(0)
    s_barrier
    buffer_store_dwordx4 a[180:183], v124, s[28:31], s58 offen sc1
    ds_read_b128 a[184:187], v131 offset:0
    ds_read_b128 a[188:191], v131 offset:1024
    ds_read_b128 a[192:195], v131 offset:2048
    s_waitcnt lgkmcnt(2)
    buffer_store_dwordx4 a[184:187], v0, s[28:31], 0 offen sc1
    s_waitcnt lgkmcnt(0)
    buffer_store_dwordx4 a[188:191], v1, s[28:31], 0 offen sc1
    buffer_store_dwordx4 a[192:195], v2, s[28:31], 0 offen sc1
    s_nop 4
    s_cbranch_vccnz L_slow
L_fin:
    s_cmp_eq_u32 s2, 255
    s_cbranch_scc1 L_again
L_end:
    s_endpgm
L_slow:
    s_waitcnt vmcnt(0) lgkmcnt(0)
    s_nop 15
    s_barrier
    s_lshr_b32 s66, s64, 20
    v_mbcnt_lo_u32_b32 v157, -1, 0
    v_mbcnt_hi_u32_b32 v157, -1, v157
    s_load_dwordx16 s[4:19], s[0:1], 0
    s_load_dwordx4 s[20:23], s[0:1], 64
    s_load_dwordx2 s[38:39], s[0:1], 80
    s_bfe_u32 s88, s2, 0x50003
    s_lshl2_add_u32 s88, s88, s68
    v_lshlrev_b32 v72, 7, v157
    s_mul_i32 s89, s88, 576
    s_mul_i32 s88, s88, 1728
    v_min_u32 v74, 1664, v72
    v_min_u32 v73, 512, v72
    s_mov_b32 s34, 221184
    s_mov_b32 s35, 0x20000
    s_mov_b32 s78, 73728
    s_mov_b32 s79, 0x20000
    v_and_b32 v75, 15, v157
    v_lshrrev_b32 v160, 4, v157
    v_lshrrev_b32 v72, 2, v75
    v_and_b32 v5, 3, v75
    s_mul_i32 s87, s68, 192
    v_mad_u32_u24 v19, v75, 12, s87
    v_lshlrev_b32 v31, 1, v75
    v_lshlrev_b32 v11, 1, v72
    v_lshl_add_u32 v11, v160, 5, v11
    s_movk_i32 s86, 384
    s_mov_b32 s26, 100270464
    s_mov_b32 s27, 0x20000
    s_mov_b32 s30, 0
    s_mov_b32 s31, 0x20000
    s_mul_i32 s96, s68, 288
    s_and_b32 s97, s68, 1
    s_lshl_b32 s97, s97, 2
    s_mov_b32 s98, 193536
    s_waitcnt lgkmcnt(0)
    s_mov_b32 s24, s4
    s_mov_b32 s25, s5
    s_mov_b32 s32, s6
    s_mov_b32 s33, s7
    s_mov_b32 s76, s8
    s_mov_b32 s77, s9
    buffer_load_dword a254, v74, s[32:35], s88 offen
    buffer_load_dword a253, v73, s[76:79], s89 offen
    s_load_dwordx2 s[82:83], s[10:11], 0
    s_movk_i32 s18, 676
    s_mov_b32 s19, 0x20000
    buffer_load_dwordx3 v[28:30], v19, s[16:19], 0 offen
    s_mov_b32 s99, 589824
    v_add_u32 v124, s96, v157
    v_mul_u32_u24 v74, 2731, v124
    v_mul_u32_u24 v73, 6242, v124
    v_lshrrev_b32 v74, 16, v74
    s_lshr_b32 s94, s2, 3
    s_mul_i32 s70, s94, 167
    global_load_ushort v16, v31, s[12:13]
    v_lshrrev_b32 v73, 20, v73
    v_and_or_b32 v8, v74, 3, s97
    v_xor_b32 v8, v124, v8
    v_lshl_add_u32 v128, v8, 4, s99
    v_mad_u32_u24 v128, v73, s98, v128
    s_min_u32 s95, s94, 7
    s_add_u32 s70, s70, s95
    global_load_ushort v17, v31, s[12:13] offset:32
    v_add_u32 v10, 64, v124
    v_mul_u32_u24 v150, 2731, v10
    v_mul_u32_u24 v156, 6242, v10
    v_lshrrev_b32 v150, 16, v150
    v_lshrrev_b32 v156, 20, v156
    s_and_b32 s95, s2, 7
    s_mul_i32 s95, s95, 20
    global_load_ushort v148, v11, s[14:15] offset:0
    v_and_or_b32 v9, v150, 3, s97
    v_xor_b32 v9, v10, v9
    v_lshl_add_u32 v127, v9, 4, s99
    v_mad_u32_u24 v127, v156, s98, v127
    v_add_u32 v18, 128, v124
    s_add_u32 s69, s70, s95
    s_add_u32 s70, s70, 140
    global_load_ushort v158, v11, s[14:15] offset:8
    v_mul_u32_u24 v10, 2731, v18
    v_mul_u32_u24 v4, 6242, v18
    v_lshrrev_b32 v10, 16, v10
    v_lshrrev_b32 v4, 20, v4
    v_and_or_b32 v31, v10, 3, s97
    s_movk_i32 s62, 2688
    s_movk_i32 s71, 20
    global_load_ushort v149, v11, s[14:15] offset:16
    v_xor_b32 v31, v18, v31
    v_lshl_add_u32 v126, v31, 4, s99
    v_mad_u32_u24 v126, v4, s98, v126
    v_add_u32 v125, 192, v124
    v_mul_u32_u24 v159, 2731, v125
    s_cmp_lt_u32 s94, 7
    s_cselect_b32 s73, 28, 27
    global_load_ushort v132, v11, s[14:15] offset:24
    v_mul_u32_u24 v18, 6242, v125
    v_lshrrev_b32 v159, 16, v159
    v_lshrrev_b32 v18, 20, v18
    v_and_or_b32 v11, v159, 3, s97
    v_xor_b32 v11, v125, v11
    v_lshl_add_u32 v125, v11, 4, s99
    v_mad_u32_u24 v125, v18, s98, v125
    v_add_u32 v6, 256, v124
    v_mul_u32_u24 v151, 2731, v6
    v_mul_u32_u24 v11, 6242, v6
    v_lshrrev_b32 v151, 16, v151
    v_lshrrev_b32 v11, 20, v11
    v_and_or_b32 v124, v151, 3, s97
    v_xor_b32 v124, v6, v124
    v_lshl_add_u32 v124, v124, 4, s99
    v_mad_u32_u24 v124, v11, s98, v124
    s_mov_b32 s93, 1769472
    s_mul_i32 s54, s68, 5120
    s_cmp_ge_u32 s2, 248
    s_cbranch_scc1 L_bndS
L_bndrS:
    s_mov_b32 s63, 1180032
    s_mul_i32 s94, s69, 58255
    s_lshr_b32 s94, s94, 22
    s_mul_i32 s94, s94, s63
    s_mul_i32 s72, s69, s62
    s_add_u32 s72, s72, s94
    v_lshl_or_b32 v73, v157, 4, 2.0
    s_sub_u32 s94, s73, 1
    s_max_u32 s94, s94, 20
    s_mul_i32 s95, s68, -44
    s_movk_i32 s99, -24
    s_add_u32 m0, s54, 0
    v_and_b32 v18, -4, v10
    s_mul_i32 s85, s68, 96
    s_sub_u32 s100, s85, 1024
    buffer_load_dwordx4 v128, s[24:27], s72 offen nt lds
    s_add_u32 m0, s54, 1024
    v_mad_u32_u24 v11, v18, 3, v10
    v_add_u32 v11, s95, v11
    v_mad_i32_i24 v10, v10, s99, v31
    v_med3_u32 v18, v11, 20, s94
    v_add_u32 v18, s70, v18
    v_add_u32 v31, s69, v11
    s_sub_u32 s87, s85, 2048
    s_movk_i32 s91, 1152
    buffer_load_dwordx4 v127, s[24:27], s72 offen nt lds
    v_cmp_gt_u32 vcc, s71, v11
    v_lshl_add_u32 v10, v10, 4, s93
    s_add_u32 m0, s54, 43008
    v_cndmask_b32 v31, v18, v31, vcc
    v_mul_u32_u24 v18, 58255, v31
    v_mad_u32_u24 v10, v31, s62, v10
    v_lshrrev_b32 v18, 22, v18
    v_mad_u32_u24 v10, v18, s63, v10
    s_mul_i32 s90, s68, 3072
    s_add_u32 s90, s90, 61440
    buffer_load_dwordx4 v10, s[24:27], 0 offen  lds
    v_lshlrev_b32 v11, 16, v11
    s_add_u32 m0, s54, 2048
    v_and_b32 v31, -4, v150
    v_mad_u32_u24 v18, v31, 3, v150
    v_add_u32 v18, s95, v18
    v_mad_i32_i24 v9, v150, s99, v9
    v_med3_u32 v31, v18, 20, s94
    s_mov_b32 s28, s22
    s_mov_b32 s29, s23
    buffer_load_dwordx4 v126, s[24:27], s72 offen nt lds
    v_add_u32 v31, s70, v31
    v_add_u32 v150, s69, v18
    v_cmp_gt_u32 vcc, s71, v18
    v_lshl_add_u32 v9, v9, 4, s93
    s_add_u32 m0, s54, 41984
    v_cndmask_b32 v150, v31, v150, vcc
    v_mul_u32_u24 v31, 58255, v150
    v_mad_u32_u24 v9, v150, s62, v9
    v_lshrrev_b32 v31, 22, v31
    v_mad_u32_u24 v9, v31, s63, v9
    s_mov_b32 s41, 0x2a8cbccc
    s_mov_b32 s42, 0x38fba882
    buffer_load_dwordx4 v9, s[24:27], 0 offen  lds
    v_lshl_or_b32 v11, v18, 8, v11
    s_add_u32 m0, s54, 3072
    v_cmp_gt_u32 vcc, 32, v157
    v_and_b32 v31, -4, v74
    v_mad_u32_u24 v18, v31, 3, v74
    v_cndmask_b32 v124, v73, v124, vcc
    v_add_u32 v18, s95, v18
    s_mov_b32 s43, 0x415db3d7
    s_mov_b32 s57, s72
    buffer_load_dwordx4 v125, s[24:27], s72 offen nt lds
    s_add_u32 m0, s54, 4096
    v_mad_i32_i24 v8, v74, s99, v8
    v_med3_u32 v31, v18, 20, s94
    v_add_u32 v31, s70, v31
    v_add_u32 v74, s69, v18
    v_cmp_gt_u32 vcc, s71, v18
    v_lshl_add_u32 v8, v8, 4, s93
    s_mul_i32 s93, s68, 6
    s_lshl_b32 s94, s97, 1
    buffer_load_dwordx4 v124, s[24:27], s72 offen nt lds
    v_cndmask_b32 v74, v31, v74, vcc
    v_mul_u32_u24 v31, 58255, v74
    v_mad_u32_u24 v8, v74, s62, v8
    v_lshrrev_b32 v31, 22, v31
    v_mad_u32_u24 v8, v31, s63, v8
    s_add_u32 m0, s54, 40960
    v_lshl_or_b32 v11, v18, 0, v11
    s_mov_b32 s58, 0
    s_mov_b32 s59, 0
    buffer_load_dwordx4 v8, s[24:27], 0 offen nt lds
    v_mul_u32_u24 v6, 10923, v157
    v_lshrrev_b32 v4, 17, v6
    v_lshrrev_b32 v6, 16, v6
    v_mad_i32_i24 v7, v6, -6, v157
    v_bitop3_b32 v4, v4, v6, 4 bitop3:0x28
    v_lshl_add_u32 v7, v7, 4, s85
    v_mul_u32_u24 v4, 3, v4
    v_xor_b32 v6, v6, v4
    v_mad_u32_u24 v4, v6, s91, v7
    v_add_u32 v18, 64, v157
    v_mul_u32_u24 v31, 10923, v18
    v_lshrrev_b32 v156, 17, v31
    v_lshrrev_b32 v31, 16, v31
    v_mad_i32_i24 v159, v31, -6, v18
    v_bitop3_b32 v156, v156, v31, 4 bitop3:0x28
    v_lshl_add_u32 v159, v159, 4, s100
    v_mul_u32_u24 v156, 3, v156
    v_xor_b32 v31, v31, v156
    v_mad_u32_u24 v156, v31, s91, v159
    v_add_u32 v18, 128, v157
    v_mul_u32_u24 v74, 10923, v18
    v_lshrrev_b32 v120, 17, v74
    v_lshrrev_b32 v74, 16, v74
    v_mad_i32_i24 v18, v74, -6, v18
    v_bitop3_b32 v120, v120, v74, 4 bitop3:0x28
    v_lshl_add_u32 v18, v18, 4, s87
    v_mul_u32_u24 v120, 3, v120
    v_xor_b32 v74, v74, v120
    v_mad_u32_u24 v120, v74, s91, v18
    v_mad_u32_u24 v121, v6, s86, v7
    v_mad_u32_u24 v25, v31, s86, v159
    v_mad_u32_u24 v24, v74, s86, v18
    s_add_u32 m0, s90, 0
    s_mov_b32 s92, 0
    buffer_load_dwordx4 v4, s[32:35], s92 offen offset:0 lds
    v_mov_b32 v18, 0x3f803f80
    v_cmp_eq_u32 vcc, 0, v5
    v_and_b32 v31, 1, v157
    v_lshlrev_b32 v31, 4, v31
    v_cndmask_b32 v220, 0, v18, vcc
    v_cndmask_b32 v221, 0, v18, vcc
    v_cndmask_b32 v222, 0, v18, vcc
    v_cndmask_b32 v223, 0, v18, vcc
    v_mov_b32 v18, 0x3f80
    v_lshlrev_b32 v18, v31, v18
    v_cmp_gt_u32 vcc, 2, v5
    v_mov_b32 v171, 0
    v_mov_b32 v167, 0
    v_cndmask_b32 v216, 0, v18, vcc
    v_cndmask_b32 v218, 0, v18, vcc
    v_cmp_le_u32 vcc, 2, v5
    v_mov_b32 v163, 0
    v_mov_b32 v159, 0
    v_cndmask_b32 v217, 0, v18, vcc
    v_cndmask_b32 v219, 0, v18, vcc
    v_cmp_eq_u32 vcc, v160, v72
    v_mov_b32 v150, 0
    v_mov_b32 v151, 0
    v_cndmask_b32 v26, 0, v216, vcc
    v_cndmask_b32 v27, 0, v217, vcc
    v_mov_b32 v144, 0
    v_mov_b32 v145, 0
    v_mov_b32 v138, 0
    v_mov_b32 v139, 0
    v_lshrrev_b32 v6, 1, v160
    v_lshl_add_u32 v7, v160, 2, v72
    v_lshl_add_u32 v7, v6, 3, v7
    v_mul_u32_u24 v7, 96, v7
    v_add_u32 v7, s90, v7
    v_lshl_add_u32 v6, v5, 4, v7
    v_lshl_add_u32 v7, v5, 3, v7
    s_waitcnt lgkmcnt(0)
    s_lshl_b32 s84, s68, 4
    s_lshr_b64 s[82:83], s[82:83], s84
    s_lshl_b32 s82, s82, 16
    v_mov_b32 v74, s82
    v_min_f32 v74, 0x40930000, v74
    v_max_f32 v74, 0xc2c80000, v74
    v_mul_f32 v74, 0x3fb8aa3b, v74
    v_exp_f32 v74, v74
    v_mov_b32 v18, 0
    v_cvt_pk_bf16_f32 v74, v74, v74
    v_lshlrev_b32 v74, 16, v74
    v_mul_f32 v74, 0x4038aa3b, v74
    v_mov_b32 v31, 0
    v_readfirstlane_b32 s55, v74
    v_add_f32 v74, v74, v74
    v_mul_u32_u24 v122, 5120, v160
    v_readfirstlane_b32 s52, v74
    v_add_u32 v122, v19, v122
    s_mov_b32 s84, 0x41b8aa3b
    v_mov_b32 v131, 0xc138aa3b
    v_mul_u32_u24 v74, 5120, v72
    v_mad_u32_u24 v74, v5, s86, v74
    v_and_b32 v19, 7, v75
    s_mov_b32 s44, 61440
    s_mov_b32 s45, 40960
    buffer_load_dwordx4 v156, s[32:35], s92 offen offset:1024 lds
    v_xor_b32 v123, v19, v160
    v_lshl_add_u32 v147, v123, 4, v74
    v_xor_b32 v146, 64, v147
    v_add_u32 v137, 40960, v147
    v_xor_b32 v136, 64, v137
    v_add_u32 v74, 61440, v74
    v_add_u32 v123, s93, v160
    s_mov_b32 s46, 20480
    s_mov_b32 s47, 0
    buffer_load_dwordx4 v120, s[32:35], s92 offen offset:2048 lds
    s_add_u32 m0, s90, 12288
    s_mov_b32 s92, 36864
    v_xor_b32 v123, v19, v123
    v_lshl_add_u32 v135, v123, 4, v74
    v_lshrrev_b32 v123, 1, v160
    v_add3_u32 v123, v123, s93, 4
    v_xor_b32 v123, v19, v123
    s_add_u32 s93, s54, 20480
    s_mov_b32 s60, 0
    buffer_load_dwordx4 v4, s[32:35], s92 offen offset:0 lds
    s_waitcnt vmcnt(16)
    v_lshl_or_b32 v16, v17, 16, v16
    v_cmp_gt_u32 vcc, 16, v157
    v_mov_b32 v17, 0
    v_lshl_add_u32 v123, v123, 4, v74
    v_cndmask_b32 v19, 0, v16, vcc
    v_cndmask_b32 v16, 0, v16, vcc
    v_and_b32 v74, 1, v160
    v_mfma_f32_16x16x16_bf16 v[0:3], v[18:19], v[28:29], 0
    s_waitcnt vmcnt(14)
    s_mov_b32 s65, -1
    v_lshl_or_b32 v148, v158, 16, v148
    v_lshl_add_u32 v134, v74, 3, v123
    v_mfma_f32_16x16x16_bf16 v[12:15], v[16:17], v[28:29], 0
    s_mov_b32 s61, 1
    v_lshlrev_b32 v74, 4, v157
    v_add_u32 v133, s93, v74
    v_mfma_f32_16x16x16_bf16 v[20:23], v[16:17], v[30:31], 0
    s_waitcnt vmcnt(12)
    s_lshr_b32 s93, s68, 1
    buffer_load_dwordx4 v156, s[32:35], s92 offen offset:1024 lds
    v_lshl_or_b32 v149, v132, 16, v149
    v_max_f32 v0, 0, v0
    v_max_f32 v12, 0, v12
    v_max_f32 v13, 0, v13
    v_max_f32 v14, 0, v14
    v_max_f32 v15, 0, v15
    v_cvt_pk_bf16_f32 v12, v12, v13
    v_cvt_pk_bf16_f32 v13, v14, v15
    v_max_f32 v1, 0, v1
    v_max_f32 v2, 0, v2
    v_mfma_f32_16x16x16_bf16 v[16:19], v[148:149], v[12:13], 0
    s_lshl_b32 s93, s93, 10
    v_max_f32 v3, 0, v3
    v_cvt_pk_bf16_f32 v0, v0, v1
    v_cvt_pk_bf16_f32 v1, v2, v3
    v_max_f32 v20, 0, v20
    v_max_f32 v21, 0, v21
    v_mfma_f32_16x16x16_bf16 v[12:15], v[148:149], v[0:1], 0
    s_add_u32 s93, s93, s94
    v_max_f32 v22, 0, v22
    v_max_f32 v23, 0, v23
    v_cvt_pk_bf16_f32 v20, v20, v21
    v_cvt_pk_bf16_f32 v21, v22, v23
    v_cvt_pk_bf16_f32 v16, v16, v16
    v_lshlrev_b32 v16, 16, v16
    v_mfma_f32_16x16x16_bf16 v[0:3], v[148:149], v[20:21], 0
    s_movk_i32 s4, 112
    v_mul_f32 v16, 0xbfb8aa3b, v16
    v_cvt_pk_bf16_f32 v12, v12, v12
    v_exp_f32 v16, v16
    v_lshlrev_b32 v12, 16, v12
    v_add_f32 v16, 1.0, v16
    v_rcp_f32 v16, v16
    v_mul_f32 v12, 0xbfb8aa3b, v12
    v_cvt_pk_bf16_f32 v16, v16, v16
    v_lshlrev_b32 v16, 16, v16
    v_fma_f32 v16, v16, s84, v131
    s_mov_b32 s5, 0
    s_mov_b32 s6, 0
    ds_write_b32 v122, v16 offset:44032
    v_exp_f32 v12, v12
    v_cvt_pk_bf16_f32 v0, v0, v0
    v_add_f32 v12, 1.0, v12
    v_rcp_f32 v12, v12
    v_lshlrev_b32 v0, 16, v0
    v_cvt_pk_bf16_f32 v12, v12, v12
    v_lshlrev_b32 v12, 16, v12
    v_fma_f32 v12, v12, s84, v131
    s_mov_b32 s12, 0
    s_mov_b32 s64, 3
    ds_write_b32 v122, v12 offset:44036
    v_mul_f32 v0, 0xbfb8aa3b, v0
    v_exp_f32 v0, v0
    v_add_u32 v129, 81920, v74
    v_add_f32 v0, 1.0, v0
    v_rcp_f32 v0, v0
    v_add_u32 v130, s93, v129
    v_cvt_pk_bf16_f32 v0, v0, v0
    v_lshlrev_b32 v0, 16, v0
    v_fma_f32 v0, v0, s84, v131
    s_mul_i32 s93, s68, 7168
    s_add_u32 s93, s93, 135168
    ds_write_b32 v122, v0 offset:44040
    v_mul_u32_u24 v74, 1792, v160
    v_add_u32 v123, s93, v74
    v_mul_u32_u24 v74, 112, v75
    v_add_u32 v158, v74, v123
    v_subrev_u32 v158, 28672, v158
    v_cmp_eq_u32 vcc, 0, v72
    v_add_u32 v74, 16, v123
    v_mov_b32 v122, 0
    v_cndmask_b32 v132, v73, v123, vcc
    v_cmp_eq_u32 vcc, 3, v5
    s_mov_b32 s10, 81924
    s_mov_b32 s11, 0x20000
    v_cndmask_b32 v132, v132, v74, vcc
    v_mul_u32_u24 v74, 1792, v72
    v_lshl_add_u32 v74, v160, 3, v74
    v_lshl_add_u32 v74, v5, 1, v74
    v_add_u32 v74, s93, v74
    v_cmp_gt_u32 vcc, 3, v160
    v_mov_b32 v123, v74
    s_add_u32 s93, s69, 1
    v_cndmask_b32 v131, v73, v74, vcc
    s_mul_i32 s94, s93, 58255
    s_lshr_b32 s94, s94, 22
    s_mul_i32 s94, s94, s63
    s_mul_i32 s56, s93, s62
    s_add_u32 s56, s56, s94
    s_sub_u32 s93, s71, 1
    s_cmp_eq_u32 s68, 0
    s_cselect_b32 s13, s93, -1
    s_cmp_gt_u32 s73, 20
    s_cselect_b32 s13, s13, -1
    s_and_b32 s93, s2, -8
    s_sub_u32 s93, 81920, s93
    s_waitcnt lgkmcnt(0)
    s_barrier
    s_sub_u32 s8, s38, s93
    s_subb_u32 s9, s39, 0
    s_mov_b32 s3, 0x00010001
    s_add_u32 s101, s54, 44032
    v_mul_u32_u24 v149, 48, v72
    v_lshl_add_u32 v149, v5, 2, v149
    v_mul_u32_u24 v5, 48, v160
    v_add_u32 v199, 0, v149
    v_mul_u32_u24 v148, 37, v199
    v_lshrrev_b32 v148, 10, v148
    v_mad_u32_u24 v199, v148, 24, v199
    v_add_u32 v199, s101, v199
    v_add_u32 v161, 16, v149
    v_mul_u32_u24 v148, 37, v161
    v_lshrrev_b32 v148, 10, v148
    v_mad_u32_u24 v161, v148, 24, v161
    v_add_u32 v161, s101, v161
    v_add_u32 v148, 32, v149
    v_mul_u32_u24 v162, 37, v148
    v_lshrrev_b32 v162, 10, v162
    v_mad_u32_u24 v148, v162, 24, v148
    v_add_u32 v148, s101, v148
    v_add_u32 v176, 0, v5
    v_mul_u32_u24 v162, 37, v176
    v_lshrrev_b32 v162, 10, v162
    v_mad_u32_u24 v176, v162, 24, v176
    v_add_u32 v169, 4, v5
    v_mul_u32_u24 v162, 37, v169
    v_lshrrev_b32 v162, 10, v162
    v_mad_u32_u24 v169, v162, 24, v169
    v_add_u32 v170, 8, v5
    v_mul_u32_u24 v162, 37, v170
    v_lshrrev_b32 v162, 10, v162
    v_mad_u32_u24 v170, v162, 24, v170
    v_add_u32 v183, 12, v5
    v_mul_u32_u24 v162, 37, v183
    v_lshrrev_b32 v162, 10, v162
    v_mad_u32_u24 v183, v162, 24, v183
    v_add_u32 v168, 16, v5
    v_mul_u32_u24 v162, 37, v168
    v_lshrrev_b32 v162, 10, v162
    v_mad_u32_u24 v168, v162, 24, v168
    v_add_u32 v165, 20, v5
    v_mul_u32_u24 v162, 37, v165
    v_lshrrev_b32 v162, 10, v162
    v_mad_u32_u24 v165, v162, 24, v165
    v_add_u32 v166, 24, v5
    v_mul_u32_u24 v162, 37, v166
    v_lshrrev_b32 v162, 10, v162
    v_mad_u32_u24 v166, v162, 24, v166
    v_add_u32 v179, 28, v5
    v_mul_u32_u24 v162, 37, v179
    v_lshrrev_b32 v162, 10, v162
    v_mad_u32_u24 v179, v162, 24, v179
    v_add_u32 v164, 32, v5
    v_mul_u32_u24 v162, 37, v164
    v_lshrrev_b32 v162, 10, v162
    v_mad_u32_u24 v164, v162, 24, v164
    v_add_u32 v74, 36, v5
    v_mul_u32_u24 v72, 37, v74
    v_lshrrev_b32 v72, 10, v72
    v_mad_u32_u24 v74, v72, 24, v74
    v_add_u32 v162, 40, v5
    v_mul_u32_u24 v72, 37, v162
    v_lshrrev_b32 v72, 10, v72
    s_lshr_b32 s93, s68, 1
    s_mul_i32 s93, s93, 30720
    buffer_load_dwordx4 v120, s[32:35], s92 offen offset:2048 lds
    s_add_u32 m0, s90, 24576
    s_mov_b32 s92, 73728
    ds_read_b32 v208, v199
    v_mad_u32_u24 v162, v72, 24, v162
    v_add_u32 v5, 44, v5
    v_mul_u32_u24 v72, 37, v5
    v_lshrrev_b32 v72, 10, v72
    v_mad_u32_u24 v5, v72, 24, v5
    v_lshl_add_u32 v72, v160, 4, v149
    v_mul_u32_u24 v177, 37, v72
    v_lshrrev_b32 v177, 10, v177
    v_mad_u32_u24 v72, v177, 24, v72
    v_mov_b32 v177, 336
    v_cmp_gt_u32 vcc, 3, v160
    v_sub_u32 v204, v199, v176
    s_and_b32 s94, s68, 1
    v_cndmask_b32 v72, v177, v72, vcc
    v_sub_u32 v72, s101, v72
    s_mul_i32 s94, s94, -2304
    s_add_u32 s93, s93, s94
    ds_read_b32 v204, v204 offset:336
    buffer_load_dwordx4 v4, s[32:35], s92 offen offset:0 lds
    v_sub_u32 v205, v199, v169
    v_sub_u32 v206, v199, v170
    v_sub_u32 v207, v199, v183
    v_sub_u32 v200, v199, v168
    s_lshl_b32 s94, s97, 4
    ds_read_b32 v205, v205 offset:336
    v_sub_u32 v201, v199, v165
    v_sub_u32 v202, v199, v166
    v_sub_u32 v203, v199, v179
    v_sub_u32 v196, v199, v164
    buffer_load_dwordx4 v156, s[32:35], s92 offen offset:1024 lds
    ds_read_b32 v206, v206 offset:336
    v_sub_u32 v197, v199, v74
    v_sub_u32 v198, v199, v162
    v_sub_u32 v199, v199, v5
    v_sub_u32 v192, v161, v176
    v_sub_u32 v193, v161, v169
    ds_read_b32 v207, v207 offset:336
    v_sub_u32 v194, v161, v170
    v_sub_u32 v195, v161, v183
    v_sub_u32 v188, v161, v168
    v_sub_u32 v189, v161, v165
    v_sub_u32 v190, v161, v166
    ds_read_b32 v200, v200 offset:336
    v_sub_u32 v191, v161, v179
    v_sub_u32 v184, v161, v164
    v_sub_u32 v185, v161, v74
    v_sub_u32 v186, v161, v162
    buffer_load_dwordx4 v120, s[32:35], s92 offen offset:2048 lds
    s_add_u32 m0, s90, 36864
    s_mov_b32 s92, 110592
    ds_read_b32 v201, v201 offset:336
    v_sub_u32 v187, v161, v5
    v_sub_u32 v180, v148, v176
    v_sub_u32 v181, v148, v169
    v_sub_u32 v182, v148, v170
    v_sub_u32 v183, v148, v183
    s_waitcnt vmcnt(9)
    s_barrier
    ds_read_b32 v202, v202 offset:336
    v_sub_u32 v176, v148, v168
    v_sub_u32 v177, v148, v165
    v_sub_u32 v178, v148, v166
    v_sub_u32 v179, v148, v179
    v_sub_u32 v172, v148, v164
    ds_read_b32 v203, v203 offset:336
    v_sub_u32 v173, v148, v74
    v_sub_u32 v174, v148, v162
    v_sub_u32 v175, v148, v5
    v_mov_b32 v5, 0xf149f2ca
    v_and_b32 v74, 8, v75
    ds_read_b32 v196, v196 offset:336
    v_add_u32 v74, v74, v75
    v_mul_u32_u24 v74, 96, v74
    buffer_load_dwordx4 v4, s[32:35], s92 offen offset:0 lds
    ds_read_b32 v197, v197 offset:336
    v_add_u32 v74, s90, v74
    v_lshl_add_u32 v19, v160, 4, v74
    v_lshl_add_u32 v18, v160, 3, v74
    v_add_u32 v17, s93, v19
    v_add_u32 v16, s93, v18
    s_lshr_b32 s93, s68, 1
    s_mul_i32 s93, s93, 5120
    ds_read_b32 v198, v198 offset:336
    v_lshlrev_b32 v162, 4, v160
    v_add_u32 v162, 4608, v162
    s_add_u32 s93, s93, s94
    v_add_u32 v74, s93, v162
    v_cmp_eq_u32 vcc, 0, v75
    ds_read_b32 v199, v199 offset:336
    buffer_load_dwordx4 v156, s[32:35], s92 offen offset:1024 lds
    v_cndmask_b32 v74, v73, v74, vcc
    ds_read_b32 v211, v72 offset:672
    ds_read_b32 v192, v192 offset:336
    ds_read_b32 v193, v193 offset:336
    buffer_load_dwordx4 v120, s[32:35], s92 offen offset:2048 lds
    s_add_u32 m0, s90, 49152
    s_mov_b32 s92, 147456
    ds_read_b32 v194, v194 offset:336
    ds_read_b32 v195, v195 offset:336
    ds_read_b32 v188, v188 offset:336
    buffer_load_dwordx4 v4, s[32:35], s92 offen offset:0 lds
    ds_read_b32 v189, v189 offset:336
    ds_read_b32 v190, v190 offset:336
    ds_read_b32 v191, v191 offset:336
    ds_read_b32 v184, v184 offset:336
    buffer_load_dwordx4 v156, s[32:35], s92 offen offset:1024 lds
    ds_read_b32 v185, v185 offset:336
    ds_read_b32 v186, v186 offset:336
    ds_read_b32 v187, v187 offset:336
    buffer_load_dwordx4 v120, s[32:35], s92 offen offset:2048 lds
    s_add_u32 m0, s90, 61440
    s_mov_b32 s92, 184320
    ds_read_b32 v209, v161
    ds_read_b32 v180, v180 offset:336
    ds_read_b32 v181, v181 offset:336
    buffer_load_dwordx4 v4, s[32:35], s92 offen offset:0 lds
    ds_read_b32 v182, v182 offset:336
    ds_read_b32 v183, v183 offset:336
    ds_read_b32 v176, v176 offset:336
    ds_read_b32 v177, v177 offset:336
    buffer_load_dwordx4 v156, s[32:35], s92 offen offset:1024 lds
    ds_read_b32 v178, v178 offset:336
    ds_read_b32 v179, v179 offset:336
    ds_read_b32 v172, v172 offset:336
    buffer_load_dwordx4 v120, s[32:35], s92 offen offset:2048 lds
    ds_read_b32 v173, v173 offset:336
    ds_read_b32 v174, v174 offset:336
    ds_read_b32 v175, v175 offset:336
    ds_read_b32 v210, v148
    s_waitcnt vmcnt(15)
    ds_read_b64_tr_b16 a[0:1], v7 offset:0
    ds_read_b64_tr_b16 a[2:3], v7 offset:768
    ds_read_b64_tr_b16 a[24:25], v7 offset:32
    ds_read_b64_tr_b16 a[26:27], v7 offset:800
    ds_read_b64_tr_b16 a[48:49], v7 offset:64
    ds_read_b64_tr_b16 a[50:51], v7 offset:832
    s_add_u32 m0, s90, 0
    s_mov_b32 s92, 384
    s_waitcnt vmcnt(12)
    ds_read_b64_tr_b16 a[4:5], v7 offset:12288
    ds_read_b64_tr_b16 a[6:7], v7 offset:13056
    ds_read_b64_tr_b16 a[28:29], v7 offset:12320
    ds_read_b64_tr_b16 a[30:31], v7 offset:13088
    ds_read_b64_tr_b16 a[52:53], v7 offset:12352
    ds_read_b64_tr_b16 a[54:55], v7 offset:13120
    s_waitcnt vmcnt(9)
    ds_read_b64_tr_b16 a[8:9], v7 offset:24576
    ds_read_b64_tr_b16 a[10:11], v7 offset:25344
    ds_read_b64_tr_b16 a[32:33], v7 offset:24608
    s_waitcnt lgkmcnt(15)
    s_cmp_ge_u32 s2, 248
    s_cbranch_scc1 L_maskS
L_nomaskS:
    v_cmp_gt_u32 vcc, 16, v157
    v_readlane_b32 s84, v211, 48
    ds_read_b64_tr_b16 a[34:35], v7 offset:25376
    v_cndmask_b32 v208, v5, v208, vcc
    v_cndmask_b32 v209, v5, v209, vcc
    v_cndmask_b32 v210, v5, v210, vcc
    v_cmp_gt_u32 vcc, 49, v157
    ds_read_b64_tr_b16 a[56:57], v7 offset:24640
    s_waitcnt lgkmcnt(10)
    buffer_load_dwordx4 v4, s[32:35], s92 offen offset:0 lds
    ds_read_b64_tr_b16 a[58:59], v7 offset:25408
    v_cndmask_b32 v211, v5, v211, vcc
    s_waitcnt vmcnt(7)
    ds_read_b64_tr_b16 a[12:13], v7 offset:36864
    ds_read_b64_tr_b16 a[14:15], v7 offset:37632
    buffer_load_dwordx4 v156, s[32:35], s92 offen offset:1024 lds
    ds_read_b64_tr_b16 a[36:37], v7 offset:36896
    ds_read_b64_tr_b16 a[38:39], v7 offset:37664
    ds_read_b64_tr_b16 a[60:61], v7 offset:36928
    ds_read_b64_tr_b16 a[62:63], v7 offset:37696
    buffer_load_dwordx4 v120, s[32:35], s92 offen offset:2048 lds
    s_add_u32 m0, s90, 12288
    s_mov_b32 s92, 37248
    ds_read_b128 v[60:63], v147 offset:40960
    ds_read_b128 v[56:59], v146 offset:40960
    s_waitcnt lgkmcnt(10)
    buffer_load_dwordx4 v4, s[32:35], s92 offen offset:0 lds
    ds_read_b128 v[52:55], v147 offset:41088
    ds_read_b128 v[48:51], v146 offset:41088
    buffer_load_dwordx4 v156, s[32:35], s92 offen offset:1024 lds
    ds_read_b128 v[40:43], v147 offset:41216
    ds_read_b128 v[0:3], v146 offset:41216
    buffer_load_dwordx4 v120, s[32:35], s92 offen offset:2048 lds
    s_add_u32 m0, s90, 24576
    s_mov_b32 s92, 74112
    s_waitcnt vmcnt(9)
    ds_read_b64_tr_b16 a[16:17], v7 offset:49152
    ds_read_b64_tr_b16 a[18:19], v7 offset:49920
    ds_read_b64_tr_b16 a[40:41], v7 offset:49184
    ds_read_b64_tr_b16 a[42:43], v7 offset:49952
    ds_read_b64_tr_b16 a[64:65], v7 offset:49216
    ds_read_b64_tr_b16 a[66:67], v7 offset:49984
    s_waitcnt lgkmcnt(7)
    buffer_load_dwordx4 v4, s[32:35], s92 offen offset:0 lds
    buffer_load_dwordx4 v156, s[32:35], s92 offen offset:1024 lds
    buffer_load_dwordx4 v120, s[32:35], s92 offen offset:2048 lds
    s_add_u32 m0, s90, 36864
    s_mov_b32 s92, 110976
    s_waitcnt vmcnt(9)
    ds_read_b64_tr_b16 a[20:21], v7 offset:61440
    ds_read_b64_tr_b16 a[22:23], v7 offset:62208
    v_mfma_f32_16x16x32_bf16 v[68:71], a[0:3], v[60:63], 0
    ds_read_b64_tr_b16 a[44:45], v7 offset:61472
    v_mfma_f32_16x16x32_bf16 v[68:71], a[4:7], v[56:59], v[68:71]
    ds_read_b64_tr_b16 a[46:47], v7 offset:62240
    v_mfma_f32_16x16x32_bf16 v[68:71], a[8:11], v[52:55], v[68:71]
    ds_read_b64_tr_b16 a[68:69], v7 offset:61504
    v_mfma_f32_16x16x32_bf16 v[68:71], a[12:15], v[48:51], v[68:71]
    s_waitcnt lgkmcnt(5)
    ds_read_b64_tr_b16 a[70:71], v7 offset:62272
    v_mfma_f32_16x16x32_bf16 v[68:71], a[16:19], v[40:43], v[68:71]
    ds_read_b128 v[44:47], v147 offset:42496
    ds_read_b128 v[36:39], v146 offset:42496
    ds_read_b128 v[32:35], v147 offset:42624
    ds_read_b128 v[28:31], v146 offset:42624
    s_waitcnt lgkmcnt(7)
    v_mfma_f32_16x16x32_bf16 v[68:71], a[20:23], v[0:3], v[68:71]
    ds_read_b128 v[20:23], v147 offset:42752
    s_nop 0
    v_mfma_f32_16x16x32_bf16 v[92:95], a[24:27], v[60:63], 0
    s_nop 0
    ds_read_b128 v[12:15], v146 offset:42752
    s_nop 0
    v_mfma_f32_16x16x32_bf16 v[92:95], a[28:31], v[56:59], v[92:95]
    s_nop 0
    v_fma_f32 v5, v68, v68, s41
    v_fmac_f32 v5, v69, v69
    v_mfma_f32_16x16x32_bf16 v[92:95], a[32:35], v[52:55], v[92:95]
    v_fmac_f32 v5, v70, v70
    v_fmac_f32 v5, v71, v71
    v_mfma_f32_16x16x32_bf16 v[92:95], a[36:39], v[48:51], v[92:95]
    v_mfma_f32_16x16x32_bf16 v[92:95], a[40:43], v[40:43], v[92:95]
    s_waitcnt lgkmcnt(4)
    v_mfma_f32_16x16x32_bf16 v[92:95], a[44:47], v[0:3], v[92:95]
    s_nop 0
    buffer_load_dwordx4 v4, s[32:35], s92 offen offset:0 lds
    v_mfma_f32_16x16x32_bf16 v[88:91], a[48:51], v[60:63], 0
    s_nop 2
    v_mfma_f32_16x16x32_bf16 v[88:91], a[52:55], v[56:59], v[88:91]
    s_nop 0
    v_fmac_f32 v5, v92, v92
    v_fmac_f32 v5, v93, v93
    v_mfma_f32_16x16x32_bf16 v[88:91], a[56:59], v[52:55], v[88:91]
    v_fmac_f32 v5, v94, v94
    v_fmac_f32 v5, v95, v95
    v_mfma_f32_16x16x32_bf16 v[88:91], a[60:63], v[48:51], v[88:91]
    v_mfma_f32_16x16x32_bf16 v[88:91], a[64:67], v[40:43], v[88:91]
    buffer_load_dwordx4 v156, s[32:35], s92 offen offset:1024 lds
    v_mfma_f32_16x16x32_bf16 v[88:91], a[68:71], v[0:3], v[88:91]
    s_nop 0
    v_mfma_f32_16x16x32_bf16 v[0:3], a[0:3], v[44:47], 0
    s_nop 2
    v_mfma_f32_16x16x32_bf16 v[0:3], a[4:7], v[36:39], v[0:3]
    s_waitcnt lgkmcnt(0)
    s_nop 0
    v_fmac_f32 v5, v88, v88
    v_fmac_f32 v5, v89, v89
    v_mfma_f32_16x16x32_bf16 v[0:3], a[8:11], v[32:35], v[0:3]
    v_fmac_f32 v5, v90, v90
    v_fmac_f32 v5, v91, v91
    v_mfma_f32_16x16x32_bf16 v[0:3], a[12:15], v[28:31], v[0:3]
    ds_read_b128 v[100:103], v147 offset:40960
    buffer_load_dwordx4 v120, s[32:35], s92 offen offset:2048 lds
    v_mfma_f32_16x16x32_bf16 v[0:3], a[16:19], v[20:23], v[0:3]
    s_waitcnt vmcnt(9)
    s_add_u32 m0, s90, 49152
    ds_read_b64_tr_b16 a[72:73], v7 offset:0
    v_mfma_f32_16x16x32_bf16 v[0:3], a[20:23], v[12:15], v[0:3]
    s_mov_b32 s92, 147840
    ds_read_b64_tr_b16 a[74:75], v7 offset:768
    v_mfma_f32_16x16x32_bf16 v[56:59], a[24:27], v[44:47], 0
    ds_read_b64_tr_b16 a[96:97], v7 offset:32
    s_nop 0
    v_mfma_f32_16x16x32_bf16 v[56:59], a[28:31], v[36:39], v[56:59]
    s_nop 0
    ds_read_b64_tr_b16 a[98:99], v7 offset:800
    v_fma_f32 v72, v0, v0, s41
    v_mfma_f32_16x16x32_bf16 v[56:59], a[32:35], v[32:35], v[56:59]
    ds_read_b64_tr_b16 a[120:121], v7 offset:64
    buffer_load_dwordx4 v4, s[32:35], s92 offen offset:0 lds
    v_mfma_f32_16x16x32_bf16 v[56:59], a[36:39], v[28:31], v[56:59]
    ds_read_b64_tr_b16 a[122:123], v7 offset:832
    v_fmac_f32 v72, v1, v1
    v_mfma_f32_16x16x32_bf16 v[56:59], a[40:43], v[20:23], v[56:59]
    ds_read_b128 v[64:67], v146 offset:40960
    v_fmac_f32 v72, v2, v2
    v_mfma_f32_16x16x32_bf16 v[56:59], a[44:47], v[12:15], v[56:59]
    ds_read_b128 v[52:55], v147 offset:41088
    v_fmac_f32 v72, v3, v3
    v_mfma_f32_16x16x32_bf16 v[40:43], a[48:51], v[44:47], 0
    ds_read_b128 v[48:51], v146 offset:41088
    v_mfma_f32_16x16x32_bf16 v[40:43], a[52:55], v[36:39], v[40:43]
    ds_read_b128 v[44:47], v147 offset:41216
    buffer_load_dwordx4 v156, s[32:35], s92 offen offset:1024 lds
    v_mfma_f32_16x16x32_bf16 v[40:43], a[56:59], v[32:35], v[40:43]
    ds_read_b128 v[32:35], v146 offset:41216
    v_fmac_f32 v72, v56, v56
    v_mfma_f32_16x16x32_bf16 v[40:43], a[60:63], v[28:31], v[40:43]
    v_fmac_f32 v72, v57, v57
    v_fmac_f32 v72, v58, v58
    v_mfma_f32_16x16x32_bf16 v[40:43], a[64:67], v[20:23], v[40:43]
    v_fmac_f32 v72, v59, v59
    v_mfma_f32_16x16x32_bf16 v[40:43], a[68:71], v[12:15], v[40:43]
    s_waitcnt vmcnt(8)
    s_nop 2
    buffer_load_dwordx4 v120, s[32:35], s92 offen offset:2048 lds
    s_add_u32 m0, s90, 61440
    s_mov_b32 s92, 184704
    ds_read_b64_tr_b16 a[76:77], v7 offset:12288
    v_fmac_f32 v72, v40, v40
    ds_read_b64_tr_b16 a[78:79], v7 offset:13056
    v_fmac_f32 v72, v41, v41
    ds_read_b64_tr_b16 a[100:101], v7 offset:12320
    v_fmac_f32 v72, v42, v42
    ds_read_b64_tr_b16 a[102:103], v7 offset:13088
    v_fmac_f32 v72, v43, v43
    ds_read_b64_tr_b16 a[124:125], v7 offset:12352
    buffer_load_dwordx4 v4, s[32:35], s92 offen offset:0 lds
    ds_read_b64_tr_b16 a[126:127], v7 offset:13120
    buffer_load_dwordx4 v156, s[32:35], s92 offen offset:1024 lds
    buffer_load_dwordx4 v120, s[32:35], s92 offen offset:2048 lds
    s_add_u32 m0, s90, 0
    s_mov_b32 s92, 768
    s_waitcnt vmcnt(9)
    ds_read_b64_tr_b16 a[80:81], v7 offset:24576
    ds_read_b64_tr_b16 a[82:83], v7 offset:25344
    ds_read_b64_tr_b16 a[104:105], v7 offset:24608
    ds_read_b64_tr_b16 a[106:107], v7 offset:25376
    ds_read_b64_tr_b16 a[128:129], v7 offset:24640
    ds_read_b64_tr_b16 a[130:131], v7 offset:25408
    s_waitcnt lgkmcnt(6)
    buffer_load_dwordx4 v4, s[32:35], s92 offen offset:0 lds
    buffer_load_dwordx4 v156, s[32:35], s92 offen offset:1024 lds
    buffer_load_dwordx4 v120, s[32:35], s92 offen offset:2048 lds
    s_add_u32 m0, s90, 12288
    s_mov_b32 s92, 37632
    s_waitcnt vmcnt(9)
    ds_read_b64_tr_b16 a[84:85], v7 offset:36864
    ds_read_b64_tr_b16 a[86:87], v7 offset:37632
    ds_read_b64_tr_b16 a[108:109], v7 offset:36896
    ds_read_b64_tr_b16 a[110:111], v7 offset:37664
    ds_read_b64_tr_b16 a[132:133], v7 offset:36928
    ds_read_b64_tr_b16 a[134:135], v7 offset:37696
    buffer_load_dwordx4 v4, s[32:35], s92 offen offset:0 lds
    buffer_load_dwordx4 v156, s[32:35], s92 offen offset:1024 lds
    buffer_load_dwordx4 v120, s[32:35], s92 offen offset:2048 lds
    s_add_u32 m0, s90, 24576
    s_mov_b32 s92, 74496
    s_waitcnt vmcnt(9)
    ds_read_b64_tr_b16 a[88:89], v7 offset:49152
    ds_read_b64_tr_b16 a[90:91], v7 offset:49920
    ds_read_b64_tr_b16 a[112:113], v7 offset:49184
    ds_read_b64_tr_b16 a[114:115], v7 offset:49952
    ds_read_b64_tr_b16 a[136:137], v7 offset:49216
    ds_read_b64_tr_b16 a[138:139], v7 offset:49984
    s_waitcnt lgkmcnt(6)
    buffer_load_dwordx4 v4, s[32:35], s92 offen offset:0 lds
    buffer_load_dwordx4 v156, s[32:35], s92 offen offset:1024 lds
    buffer_load_dwordx4 v120, s[32:35], s92 offen offset:2048 lds
    s_add_u32 m0, s90, 36864
    s_mov_b32 s92, 111360
    s_waitcnt vmcnt(9)
    ds_read_b64_tr_b16 a[92:93], v7 offset:61440
    ds_read_b64_tr_b16 a[94:95], v7 offset:62208
    v_mfma_f32_16x16x32_bf16 v[36:39], a[72:75], v[100:103], 0
    ds_read_b64_tr_b16 a[116:117], v7 offset:61472
    v_mfma_f32_16x16x32_bf16 v[36:39], a[76:79], v[64:67], v[36:39]
    ds_read_b64_tr_b16 a[118:119], v7 offset:62240
    v_mfma_f32_16x16x32_bf16 v[36:39], a[80:83], v[52:55], v[36:39]
    ds_read_b64_tr_b16 a[140:141], v7 offset:61504
    v_mfma_f32_16x16x32_bf16 v[36:39], a[84:87], v[48:51], v[36:39]
    s_waitcnt lgkmcnt(5)
    buffer_load_dwordx4 v4, s[32:35], s92 offen offset:0 lds
    ds_read_b64_tr_b16 a[142:143], v7 offset:62272
    v_mfma_f32_16x16x32_bf16 v[36:39], a[88:91], v[44:47], v[36:39]
    ds_read_b128 v[96:99], v147 offset:42496
    ds_read_b128 v[80:83], v146 offset:42496
    ds_read_b128 v[28:31], v147 offset:42624
    ds_read_b128 v[20:23], v146 offset:42624
    s_waitcnt lgkmcnt(7)
    v_mfma_f32_16x16x32_bf16 v[36:39], a[92:95], v[32:35], v[36:39]
    buffer_load_dwordx4 v156, s[32:35], s92 offen offset:1024 lds
    ds_read_b128 v[60:63], v147 offset:42752
    v_mfma_f32_16x16x32_bf16 v[84:87], a[96:99], v[100:103], 0
    s_nop 1
    ds_read_b128 v[12:15], v146 offset:42752
    v_mfma_f32_16x16x32_bf16 v[84:87], a[100:103], v[64:67], v[84:87]
    s_nop 0
    v_fma_f32 v157, v36, v36, s41
    v_fmac_f32 v157, v37, v37
    v_mfma_f32_16x16x32_bf16 v[84:87], a[104:107], v[52:55], v[84:87]
    v_fmac_f32 v157, v38, v38
    v_fmac_f32 v157, v39, v39
    v_mfma_f32_16x16x32_bf16 v[84:87], a[108:111], v[48:51], v[84:87]
    v_mfma_f32_16x16x32_bf16 v[84:87], a[112:115], v[44:47], v[84:87]
    s_waitcnt vmcnt(8) lgkmcnt(4)
    buffer_load_dwordx4 v120, s[32:35], s92 offen offset:2048 lds
    ds_read_b64_tr_b16 a[144:145], v6 offset:0
    v_mfma_f32_16x16x32_bf16 v[84:87], a[116:119], v[32:35], v[84:87]
    s_add_u32 m0, s90, 49152
    ds_read_b64_tr_b16 a[146:147], v6 offset:768
    v_mfma_f32_16x16x32_bf16 v[76:79], a[120:123], v[100:103], 0
    s_mov_b32 s92, 148224
    s_nop 0
    ds_read_b64_tr_b16 a[168:169], v6 offset:8
    v_mfma_f32_16x16x32_bf16 v[76:79], a[124:127], v[64:67], v[76:79]
    s_nop 0
    v_fmac_f32 v157, v84, v84
    v_fmac_f32 v157, v85, v85
    v_mfma_f32_16x16x32_bf16 v[76:79], a[128:131], v[52:55], v[76:79]
    ds_read_b64_tr_b16 a[170:171], v6 offset:776
    v_fmac_f32 v157, v86, v86
    v_mfma_f32_16x16x32_bf16 v[76:79], a[132:135], v[48:51], v[76:79]
    buffer_load_dwordx4 v4, s[32:35], s92 offen offset:0 lds
    ds_read_b64_tr_b16 a[192:193], v7 offset:64
    v_mfma_f32_16x16x32_bf16 v[76:79], a[136:139], v[44:47], v[76:79]
    ds_read_b64_tr_b16 a[194:195], v7 offset:832
    v_fmac_f32 v157, v87, v87
    v_mfma_f32_16x16x32_bf16 v[76:79], a[140:143], v[32:35], v[76:79]
    s_nop 0
    v_mfma_f32_16x16x32_bf16 v[52:55], a[72:75], v[96:99], 0
    s_nop 2
    v_mfma_f32_16x16x32_bf16 v[52:55], a[76:79], v[80:83], v[52:55]
    s_waitcnt lgkmcnt(5)
    s_nop 0
    v_fmac_f32 v157, v76, v76
    v_fmac_f32 v157, v77, v77
    v_mfma_f32_16x16x32_bf16 v[52:55], a[80:83], v[28:31], v[52:55]
    buffer_load_dwordx4 v156, s[32:35], s92 offen offset:1024 lds
    v_fmac_f32 v157, v78, v78
    v_mfma_f32_16x16x32_bf16 v[52:55], a[84:87], v[20:23], v[52:55]
    v_fmac_f32 v157, v79, v79
    v_cvt_pk_bf16_f32 v170, v5, v157
    v_mfma_f32_16x16x32_bf16 v[52:55], a[88:91], v[60:63], v[52:55]
    v_mfma_f32_16x16x32_bf16 v[52:55], a[92:95], v[12:15], v[52:55]
    ds_read_b128 v[64:67], v147 offset:40960
    v_mfma_f32_16x16x32_bf16 v[48:51], a[96:99], v[96:99], 0
    ds_read_b128 v[32:35], v146 offset:40960
    v_mfma_f32_16x16x32_bf16 v[48:51], a[100:103], v[80:83], v[48:51]
    s_waitcnt vmcnt(8)
    buffer_load_dwordx4 v120, s[32:35], s92 offen offset:2048 lds
    ds_read_b64_tr_b16 a[148:149], v6 offset:12288
    v_mfma_f32_16x16x32_bf16 v[48:51], a[104:107], v[28:31], v[48:51]
    s_add_u32 m0, s90, 61440
    v_fma_f32 v157, v52, v52, s41
    v_fmac_f32 v157, v53, v53
    v_mfma_f32_16x16x32_bf16 v[48:51], a[108:111], v[20:23], v[48:51]
    s_mov_b32 s92, 185088
    ds_read_b64_tr_b16 a[150:151], v6 offset:13056
    v_fmac_f32 v157, v54, v54
    v_mfma_f32_16x16x32_bf16 v[48:51], a[112:115], v[60:63], v[48:51]
    ds_read_b64_tr_b16 a[172:173], v6 offset:12296
    v_fmac_f32 v157, v55, v55
    v_mfma_f32_16x16x32_bf16 v[48:51], a[116:119], v[12:15], v[48:51]
    ds_read_b64_tr_b16 a[174:175], v6 offset:13064
    v_mfma_f32_16x16x32_bf16 v[44:47], a[120:123], v[96:99], 0
    s_nop 0
    buffer_load_dwordx4 v4, s[32:35], s92 offen offset:0 lds
    ds_read_b64_tr_b16 a[196:197], v7 offset:12352
    v_mfma_f32_16x16x32_bf16 v[44:47], a[124:127], v[80:83], v[44:47]
    s_nop 0
    ds_read_b64_tr_b16 a[198:199], v7 offset:13120
    v_fmac_f32 v157, v48, v48
    v_mfma_f32_16x16x32_bf16 v[44:47], a[128:131], v[28:31], v[44:47]
    ds_read_b128 v[28:31], v147 offset:41088
    v_fmac_f32 v157, v49, v49
    v_mfma_f32_16x16x32_bf16 v[44:47], a[132:135], v[20:23], v[44:47]
    ds_read_b128 v[20:23], v146 offset:41088
    v_fmac_f32 v157, v50, v50
    v_mfma_f32_16x16x32_bf16 v[44:47], a[136:139], v[60:63], v[44:47]
    ds_read_b128 v[60:63], v147 offset:41216
    v_fmac_f32 v157, v51, v51
    v_mfma_f32_16x16x32_bf16 v[44:47], a[140:143], v[12:15], v[44:47]
    s_nop 0
    buffer_load_dwordx4 v156, s[32:35], s92 offen offset:1024 lds
    ds_read_b128 v[12:15], v146 offset:41216
    v_mfma_f32_16x16x16_bf16 v[80:83], v[216:217], v[170:171], 0
    s_nop 0
    v_mov_b32 v168, 0
    v_mov_b32 v169, 0
    v_mov_b32 v149, 0
    v_fmac_f32 v157, v44, v44
    v_fmac_f32 v157, v45, v45
    v_fmac_f32 v157, v46, v46
    v_fmac_f32 v157, v47, v47
    v_rsq_f32 v80, v80
    v_rsq_f32 v81, v81
    v_mul_f32 v80, s55, v80
    v_mul_f32 v81, 0.5, v81
    v_mul_f32 v68, v68, v80
    buffer_load_dwordx4 v120, s[32:35], s92 offen offset:2048 lds
    s_add_u32 m0, s90, 0
    s_mov_b32 s92, 0
    s_waitcnt vmcnt(9)
    ds_read_b64_tr_b16 a[152:153], v6 offset:24576
    v_mul_f32 v69, v69, v80
    v_cvt_pk_f16_f32 v68, v68, v69
    v_mul_f32 v70, v70, v80
    ds_read_b64_tr_b16 a[154:155], v6 offset:25344
    v_mul_f32 v71, v71, v80
    v_cvt_pk_f16_f32 v69, v70, v71
    v_mul_f32 v92, v92, v80
    ds_read_b64_tr_b16 a[176:177], v6 offset:24584
    v_mul_f32 v93, v93, v80
    v_cvt_pk_f16_f32 v70, v92, v93
    s_waitcnt lgkmcnt(3)
    buffer_load_dwordx4 v121, s[76:79], s92 offen offset:0 lds
    ds_read_b64_tr_b16 a[178:179], v6 offset:25352
    v_mul_f32 v94, v94, v80
    v_mul_f32 v95, v95, v80
    v_cvt_pk_f16_f32 v71, v94, v95
    ds_read_b64_tr_b16 a[200:201], v7 offset:24640
    v_mul_f32 v88, v88, v80
    ds_read_b64_tr_b16 a[202:203], v7 offset:25408
    v_mul_f32 v89, v89, v80
    v_cvt_pk_f16_f32 v160, v88, v89
    v_mul_f32 v90, v90, v80
    v_mul_f32 v91, v91, v80
    v_cvt_pk_f16_f32 v161, v90, v91
    v_mul_f32 v36, v36, v81
    buffer_load_dwordx4 v25, s[76:79], s92 offen offset:1024 lds
    v_mul_f32 v37, v37, v81
    v_cvt_pk_f16_f32 v36, v36, v37
    v_mul_f32 v38, v38, v81
    v_mul_f32 v39, v39, v81
    v_cvt_pk_f16_f32 v37, v38, v39
    v_mul_f32 v84, v84, v81
    v_mul_f32 v85, v85, v81
    v_cvt_pk_f16_f32 v38, v84, v85
    v_mul_f32 v86, v86, v81
    v_mul_f32 v87, v87, v81
    v_cvt_pk_f16_f32 v39, v86, v87
    v_mul_f32 v76, v76, v81
    v_mul_f32 v77, v77, v81
    v_cvt_pk_f16_f32 v4, v76, v77
    v_mul_f32 v78, v78, v81
    v_mul_f32 v79, v79, v81
    v_cvt_pk_f16_f32 v5, v78, v79
    buffer_load_dwordx4 v24, s[76:79], s92 offen offset:2048 lds
    s_add_u32 m0, s90, 12288
    s_mov_b32 s92, 12288
    s_waitcnt vmcnt(9)
    ds_read_b64_tr_b16 a[156:157], v6 offset:36864
    v_fma_mix_f32 v148, v68, v36, 0 op_sel:[0,0,0] op_sel_hi:[1,1,0]
    v_fma_mix_f32 v148, v68, v36, v148 op_sel:[1,1,0] op_sel_hi:[1,1,0]
    v_fma_mix_f32 v148, v69, v37, v148 op_sel:[0,0,0] op_sel_hi:[1,1,0]
    ds_read_b64_tr_b16 a[158:159], v6 offset:37632
    v_fma_mix_f32 v148, v69, v37, v148 op_sel:[1,1,0] op_sel_hi:[1,1,0]
    v_fma_mix_f32 v148, v70, v38, v148 op_sel:[0,0,0] op_sel_hi:[1,1,0]
    v_fma_mix_f32 v148, v70, v38, v148 op_sel:[1,1,0] op_sel_hi:[1,1,0]
    ds_read_b64_tr_b16 a[180:181], v6 offset:36872
    v_fma_mix_f32 v148, v71, v39, v148 op_sel:[0,0,0] op_sel_hi:[1,1,0]
    v_fma_mix_f32 v148, v71, v39, v148 op_sel:[1,1,0] op_sel_hi:[1,1,0]
    buffer_load_dwordx4 v121, s[76:79], s92 offen offset:0 lds
    ds_read_b64_tr_b16 a[182:183], v6 offset:37640
    v_fma_mix_f32 v148, v160, v4, v148 op_sel:[0,0,0] op_sel_hi:[1,1,0]
    v_fma_mix_f32 v148, v160, v4, v148 op_sel:[1,1,0] op_sel_hi:[1,1,0]
    v_fma_mix_f32 v148, v161, v5, v148 op_sel:[0,0,0] op_sel_hi:[1,1,0]
    ds_read_b64_tr_b16 a[204:205], v7 offset:36928
    v_fma_mix_f32 v148, v161, v5, v148 op_sel:[1,1,0] op_sel_hi:[1,1,0]
    ds_read_b64_tr_b16 a[206:207], v7 offset:37696
    v_mov_b32 v120, v148
    v_add_u32 v156, 28672, v158
    ds_write_b128 v156, v[36:39]
    buffer_load_dwordx4 v25, s[76:79], s92 offen offset:1024 lds
    v_permlane32_swap_b32 v120, v148
    v_add_f32 v148, v120, v148
    v_mov_b32 v120, v148
    v_cvt_pk_bf16_f32 v170, v72, v157
    s_nop 0
    v_permlane16_swap_b32 v120, v148
    v_mfma_f32_16x16x16_bf16 v[36:39], v[216:217], v[170:171], 0
    s_waitcnt vmcnt(8)
    ds_write2_b64 v156, v[168:169], v[168:169] offset0:2 offset1:3
    v_add_f32 v148, v120, v148
    buffer_load_dwordx4 v24, s[76:79], s92 offen offset:2048 lds
    s_add_u32 m0, s90, 24576
    s_mov_b32 s92, 24576
    v_and_b32 v120, 0xffff0000, v148
    v_sub_f32 v148, v148, v120
    ds_read_b64_tr_b16 a[160:161], v6 offset:49152
    v_cvt_pk_bf16_f32 v148, v148, v120
    v_rsq_f32 v36, v36
    ds_read_b64_tr_b16 a[162:163], v6 offset:49920
    v_rsq_f32 v37, v37
    v_mul_f32 v36, s55, v36
    s_waitcnt lgkmcnt(3)
    buffer_load_dwordx4 v121, s[76:79], s92 offen offset:0 lds
    ds_read_b64_tr_b16 a[184:185], v6 offset:49160
    v_mul_f32 v37, 0.5, v37
    v_mul_f32 v0, v0, v36
    v_mul_f32 v1, v1, v36
    ds_read_b64_tr_b16 a[186:187], v6 offset:49928
    v_cvt_pk_f16_f32 v0, v0, v1
    v_mul_f32 v2, v2, v36
    v_mul_f32 v3, v3, v36
    ds_read_b64_tr_b16 a[208:209], v7 offset:49216
    v_cvt_pk_f16_f32 v1, v2, v3
    ds_read_b64_tr_b16 a[210:211], v7 offset:49984
    v_mul_f32 v56, v56, v36
    buffer_load_dwordx4 v25, s[76:79], s92 offen offset:1024 lds
    ds_write_b128 v156, v[68:71] offset:32
    v_mul_f32 v57, v57, v36
    v_cvt_pk_f16_f32 v2, v56, v57
    v_mul_f32 v58, v58, v36
    v_mul_f32 v59, v59, v36
    v_cvt_pk_f16_f32 v3, v58, v59
    v_mul_f32 v40, v40, v36
    v_mul_f32 v41, v41, v36
    v_cvt_pk_f16_f32 v254, v40, v41
    ds_write2_b64 v156, v[4:5], v[168:169] offset0:6 offset1:7
    buffer_load_dwordx4 v24, s[76:79], s92 offen offset:2048 lds
    s_add_u32 m0, s90, 36864
    s_mov_b32 s92, 36864
    v_mul_f32 v42, v42, v36
    v_mul_f32 v43, v43, v36
    v_cvt_pk_f16_f32 v255, v42, v43
    v_mul_f32 v52, v52, v37
    v_mul_f32 v53, v53, v37
    s_waitcnt vmcnt(9)
    ds_read_b64_tr_b16 a[164:165], v6 offset:61440
    v_cvt_pk_f16_f32 v4, v52, v53
    v_mul_f32 v54, v54, v37
    v_mul_f32 v55, v55, v37
    ds_read_b64_tr_b16 a[166:167], v6 offset:62208
    v_mfma_f32_16x16x32_bf16 v[40:43], a[144:147], v[64:67], 0
    buffer_load_dwordx4 v121, s[76:79], s92 offen offset:0 lds
    ds_read_b64_tr_b16 a[188:189], v6 offset:61448
    v_mfma_f32_16x16x32_bf16 v[40:43], a[148:151], v[32:35], v[40:43]
    v_cvt_pk_f16_f32 v5, v54, v55
    v_mul_f32 v48, v48, v37
    v_mfma_f32_16x16x32_bf16 v[40:43], a[152:155], v[28:31], v[40:43]
    ds_read_b64_tr_b16 a[190:191], v6 offset:62216
    v_mul_f32 v49, v49, v37
    v_mfma_f32_16x16x32_bf16 v[40:43], a[156:159], v[20:23], v[40:43]
    s_waitcnt lgkmcnt(4)
    ds_read_b64_tr_b16 a[212:213], v7 offset:61504
    v_cvt_pk_f16_f32 v6, v48, v49
    v_mfma_f32_16x16x32_bf16 v[40:43], a[160:163], v[60:63], v[40:43]
    ds_read_b64_tr_b16 a[214:215], v7 offset:62272
    v_mul_f32 v50, v50, v37
    v_mul_f32 v51, v51, v37
    v_cvt_pk_f16_f32 v7, v50, v51
    buffer_load_dwordx4 v25, s[76:79], s92 offen offset:1024 lds
    ds_write2_b64 v156, v[168:169], v[160:161] offset0:8 offset1:9
    v_mul_f32 v44, v44, v37
    v_mul_f32 v45, v45, v37
    v_cvt_pk_f16_f32 v160, v44, v45
    v_mul_f32 v46, v46, v37
    s_waitcnt lgkmcnt(5)
    v_mfma_f32_16x16x32_bf16 v[40:43], a[164:167], v[12:15], v[40:43]
    v_mul_f32 v47, v47, v37
    v_cvt_pk_f16_f32 v161, v46, v47
    v_mfma_f32_16x16x32_bf16 v[52:55], a[168:171], v[64:67], 0
    buffer_load_dwordx4 v24, s[76:79], s92 offen offset:2048 lds
    ds_read_b128 v[48:51], v147 offset:42496
    v_mfma_f32_16x16x32_bf16 v[52:55], a[172:175], v[32:35], v[52:55]
    s_add_u32 m0, s90, 49152
    v_fma_mix_f32 v120, v0, v4, 0 op_sel:[0,0,0] op_sel_hi:[1,1,0]
    v_fma_mix_f32 v120, v0, v4, v120 op_sel:[1,1,0] op_sel_hi:[1,1,0]
    v_mfma_f32_16x16x32_bf16 v[52:55], a[176:179], v[28:31], v[52:55]
    s_mov_b32 s92, 49152
    ds_write_b64 v156, v[148:149] offset:88
    v_mfma_f32_16x16x32_bf16 v[52:55], a[180:183], v[20:23], v[52:55]
    s_lshl_b32 s93, s68, 10
    v_fma_mix_f32 v120, v1, v5, v120 op_sel:[0,0,0] op_sel_hi:[1,1,0]
    v_fma_mix_f32 v120, v1, v5, v120 op_sel:[1,1,0] op_sel_hi:[1,1,0]
    v_mfma_f32_16x16x32_bf16 v[52:55], a[184:187], v[60:63], v[52:55]
    s_waitcnt lgkmcnt(3)
    s_mov_b32 s53, s47
    ds_read_b128 v[44:47], v146 offset:42496
    v_fma_mix_f32 v120, v2, v6, v120 op_sel:[0,0,0] op_sel_hi:[1,1,0]
    v_mfma_f32_16x16x32_bf16 v[52:55], a[188:191], v[12:15], v[52:55]
    s_mov_b32 s47, s46
    buffer_load_dwordx4 v121, s[76:79], s92 offen offset:0 lds
    ds_read_b128 v[36:39], v147 offset:42624
    v_mfma_f32_16x16x32_bf16 v[56:59], a[192:195], v[64:67], 0
    s_mov_b32 s46, s45
    v_fma_mix_f32 v120, v2, v6, v120 op_sel:[1,1,0] op_sel_hi:[1,1,0]
    v_fma_mix_f32 v120, v3, v7, v120 op_sel:[0,0,0] op_sel_hi:[1,1,0]
    v_mfma_f32_16x16x32_bf16 v[56:59], a[196:199], v[32:35], v[56:59]
    s_mov_b32 s45, s44
    ds_read_b128 v[32:35], v146 offset:42624
    v_fma_mix_f32 v120, v3, v7, v120 op_sel:[1,1,0] op_sel_hi:[1,1,0]
    v_mfma_f32_16x16x32_bf16 v[56:59], a[200:203], v[28:31], v[56:59]
    s_mov_b32 s44, s53
    ds_read_b128 v[28:31], v147 offset:42752
    v_fma_mix_f32 v120, v254, v160, v120 op_sel:[0,0,0] op_sel_hi:[1,1,0]
    v_mfma_f32_16x16x32_bf16 v[56:59], a[204:207], v[20:23], v[56:59]
    s_sub_u32 s48, s44, s46
    ds_read_b128 v[20:23], v146 offset:42752
    v_fma_mix_f32 v120, v254, v160, v120 op_sel:[1,1,0] op_sel_hi:[1,1,0]
    v_mfma_f32_16x16x32_bf16 v[56:59], a[208:211], v[60:63], v[56:59]
    s_sub_u32 s49, s46, s45
    buffer_load_dwordx4 v25, s[76:79], s92 offen offset:1024 lds
    v_fma_mix_f32 v120, v255, v161, v120 op_sel:[0,0,0] op_sel_hi:[1,1,0]
    v_mfma_f32_16x16x32_bf16 v[56:59], a[212:215], v[12:15], v[56:59]
    s_waitcnt lgkmcnt(5)
    v_fma_mix_f32 v120, v255, v161, v120 op_sel:[1,1,0] op_sel_hi:[1,1,0]
    v_mov_b32 v146, v120
    v_mfma_f32_16x16x32_bf16 v[12:15], a[144:147], v[48:51], 0
    s_waitcnt lgkmcnt(4)
    v_permlane32_swap_b32 v146, v120
    v_add_f32 v120, v146, v120
    v_mfma_f32_16x16x32_bf16 v[12:15], a[148:151], v[44:47], v[12:15]
    s_waitcnt lgkmcnt(3)
    v_mov_b32 v146, v120
    v_cvt_pk_bf16_f32 v148, v40, v41
    v_cvt_pk_bf16_f32 v149, v42, v43
    v_mfma_f32_16x16x32_bf16 v[12:15], a[152:155], v[36:39], v[12:15]
    s_waitcnt lgkmcnt(2)
    ds_write_b64 v158, v[148:149] offset:28752
    buffer_load_dwordx4 v24, s[76:79], s92 offen offset:2048 lds
    s_add_u32 m0, s90, 61440
    v_mfma_f32_16x16x32_bf16 v[12:15], a[156:159], v[32:35], v[12:15]
    s_waitcnt lgkmcnt(2)
    s_mov_b32 s92, 61440
    v_permlane16_swap_b32 v146, v120
    v_mfma_f32_16x16x32_bf16 v[12:15], a[160:163], v[28:31], v[12:15]
    s_waitcnt lgkmcnt(1)
    v_add_f32 v120, v146, v120
    v_and_b32 v146, 0xffff0000, v120
    v_mfma_f32_16x16x32_bf16 v[12:15], a[164:167], v[20:23], v[12:15]
    v_sub_f32 v120, v120, v146
    v_cvt_pk_bf16_f32 v120, v120, v146
    v_mfma_f32_16x16x32_bf16 v[40:43], a[168:171], v[48:51], 0
    v_cvt_pk_bf16_f32 v52, v52, v53
    v_cvt_pk_bf16_f32 v53, v54, v55
    v_mfma_f32_16x16x32_bf16 v[40:43], a[172:175], v[44:47], v[40:43]
    buffer_load_dwordx4 v121, s[76:79], s92 offen offset:0 lds
    v_cvt_pk_bf16_f32 v54, v56, v57
    v_mfma_f32_16x16x32_bf16 v[40:43], a[176:179], v[36:39], v[40:43]
    v_cvt_pk_bf16_f32 v55, v58, v59
    v_cvt_pk_bf16_f32 v156, v12, v13
    v_mfma_f32_16x16x32_bf16 v[40:43], a[180:183], v[32:35], v[40:43]
    ds_write_b128 v158, v[52:55] offset:28768
    v_mfma_f32_16x16x32_bf16 v[40:43], a[184:187], v[28:31], v[40:43]
    v_cvt_pk_bf16_f32 v157, v14, v15
    v_add_u32 v121, s93, v129
    v_mfma_f32_16x16x32_bf16 v[40:43], a[188:191], v[20:23], v[40:43]
    buffer_load_dwordx4 v25, s[76:79], s92 offen offset:1024 lds
    v_add_u32 v137, s48, v137
    v_mfma_f32_16x16x32_bf16 v[12:15], a[192:195], v[48:51], 0
    s_nop 0
    v_add_u32 v136, s48, v136
    s_nop 0
    v_mfma_f32_16x16x32_bf16 v[12:15], a[196:199], v[44:47], v[12:15]
    s_nop 0
    v_cvt_pk_bf16_f32 v76, v40, v41
    v_cvt_pk_bf16_f32 v77, v42, v43
    v_mfma_f32_16x16x32_bf16 v[12:15], a[200:203], v[36:39], v[12:15]
    v_mfma_f32_16x16x32_bf16 v[12:15], a[204:207], v[32:35], v[12:15]
    v_mfma_f32_16x16x32_bf16 v[12:15], a[208:211], v[28:31], v[12:15]
    buffer_load_dwordx4 v24, s[76:79], s92 offen offset:2048 lds
    v_mfma_f32_16x16x32_bf16 v[12:15], a[212:215], v[20:23], v[12:15]
    s_add_u32 m0, s54, 20480
    s_nop 6
    v_cvt_pk_bf16_f32 v78, v12, v13
    v_cvt_pk_bf16_f32 v79, v14, v15
    buffer_load_dwordx4 v128, s[24:27], s56 offen nt lds
    s_add_u32 m0, s54, 21504
    s_nop 0
    buffer_load_dwordx4 v127, s[24:27], s56 offen nt lds
    s_add_u32 m0, s54, 22528
    s_nop 0
    buffer_load_dwordx4 v126, s[24:27], s56 offen nt lds
    s_add_u32 m0, s54, 23552
    s_nop 0
    buffer_load_dwordx4 v125, s[24:27], s56 offen nt lds
    s_add_u32 m0, s54, 24576
    s_nop 0
    buffer_load_dwordx4 v124, s[24:27], s56 offen nt lds
    s_waitcnt vmcnt(5)
    s_barrier
    ds_read_b128 v[36:39], v17 offset:0
    ds_read_b64 v[12:13], v16 offset:64
    ds_read_b128 v[28:31], v17 offset:3072
    ds_read_b64 v[14:15], v16 offset:3136
    ds_read_b128 v[48:51], v17 offset:6144
    ds_read_b64 v[32:33], v16 offset:6208
    ds_read_b128 v[40:43], v17 offset:9216
    ds_read_b64 v[34:35], v16 offset:9280
    ds_read_b128 v[44:47], v17 offset:12288
    ds_read_b64 v[52:53], v16 offset:12352
    ds_read_b128 v[20:23], v17 offset:15360
    ds_read_b64 v[54:55], v16 offset:15424
    s_waitcnt lgkmcnt(11)
    v_mfma_f32_16x16x32_bf16 v[56:59], v[36:39], v[220:223], 0
    s_waitcnt lgkmcnt(9)
    ds_read_b128 v[36:39], v17 offset:18432
    v_mfma_f32_16x16x32_bf16 v[56:59], v[28:31], v[220:223], v[56:59]
    s_waitcnt lgkmcnt(8)
    ds_read_b64 v[28:29], v16 offset:18496
    ds_read_b128 v[60:63], v17 offset:21504
    v_mfma_f32_16x16x32_bf16 v[56:59], v[48:51], v[220:223], v[56:59]
    s_waitcnt lgkmcnt(8)
    ds_read_b64 v[30:31], v16 offset:21568
    ds_read_b128 v[48:51], v17 offset:24576
    v_mfma_f32_16x16x32_bf16 v[56:59], v[40:43], v[220:223], v[56:59]
    ds_read_b64 v[40:41], v16 offset:24640
    v_mfma_f32_16x16x32_bf16 v[56:59], v[12:15], v[220:223], v[56:59]
    s_waitcnt lgkmcnt(9)
    ds_read_b128 v[12:15], v17 offset:27648
    v_mfma_f32_16x16x32_bf16 v[56:59], v[32:35], v[220:223], v[56:59]
    ds_read_b64 v[42:43], v16 offset:27712
    v_mfma_f32_16x16x32_bf16 v[32:35], v[44:47], v[220:223], 0
    s_waitcnt lgkmcnt(8)
    ds_read_b128 v[44:47], v17 offset:30720
    v_mfma_f32_16x16x32_bf16 v[32:35], v[20:23], v[220:223], v[32:35]
    s_waitcnt lgkmcnt(8)
    s_nop 0
    ds_read_b64 v[20:21], v16 offset:30784
    v_mul_f32 v56, 0xbbaaaaab, v56
    v_mfma_f32_16x16x32_bf16 v[32:35], v[36:39], v[220:223], v[32:35]
    s_waitcnt lgkmcnt(7)
    ds_read_b128 v[36:39], v17 offset:33792
    v_mul_f32 v57, 0xbbaaaaab, v57
    v_mul_f32 v58, 0xbbaaaaab, v58
    v_mul_f32 v59, 0xbbaaaaab, v59
    v_mfma_f32_16x16x32_bf16 v[32:35], v[60:63], v[220:223], v[32:35]
    ds_write_b128 v74, v[56:59] offset:0
    v_mfma_f32_16x16x32_bf16 v[32:35], v[52:55], v[220:223], v[32:35]
    s_waitcnt lgkmcnt(6)
    v_mfma_f32_16x16x32_bf16 v[32:35], v[28:31], v[220:223], v[32:35]
    v_mfma_f32_16x16x32_bf16 v[28:31], v[48:51], v[220:223], 0
    s_waitcnt lgkmcnt(4)
    ds_read_b64 v[22:23], v16 offset:33856
    s_nop 0
    v_mfma_f32_16x16x32_bf16 v[28:31], v[12:15], v[220:223], v[28:31]
    s_waitcnt lgkmcnt(4)
    s_nop 0
    ds_read_b128 v[12:15], v19 offset:0
    v_mul_f32 v32, 0xbbaaaaab, v32
    v_mfma_f32_16x16x32_bf16 v[28:31], v[44:47], v[220:223], v[28:31]
    s_waitcnt lgkmcnt(3)
    ds_read_b64 v[16:17], v18 offset:64
    v_mul_f32 v33, 0xbbaaaaab, v33
    v_mul_f32 v34, 0xbbaaaaab, v34
    v_mul_f32 v35, 0xbbaaaaab, v35
    v_mfma_f32_16x16x32_bf16 v[28:31], v[36:39], v[220:223], v[28:31]
    ds_write_b128 v74, v[32:35] offset:128
    v_mfma_f32_16x16x32_bf16 v[28:31], v[40:43], v[220:223], v[28:31]
    ds_read_b128 v[80:83], v19 offset:768
    ds_read_b64 v[84:85], v18 offset:832
    ds_read_b128 v[68:71], v19 offset:12288
    s_waitcnt lgkmcnt(6)
    v_mfma_f32_16x16x32_bf16 v[28:31], v[20:23], v[220:223], v[28:31]
    s_nop 0
    ds_read_b64 v[72:73], v18 offset:12352
    s_nop 0
    ds_read_b128 v[20:23], v19 offset:13056
    s_nop 2
    ds_read_b64 v[24:25], v18 offset:13120
    v_mul_f32 v28, 0xbbaaaaab, v28
    v_mul_f32 v29, 0xbbaaaaab, v29
    v_mul_f32 v30, 0xbbaaaaab, v30
    v_mul_f32 v31, 0xbbaaaaab, v31
    ds_write_b128 v74, v[28:31] offset:256
    s_waitcnt lgkmcnt(0)
    s_barrier
    ds_read_b128 v[40:43], v162 offset:0
    ds_read_b128 v[28:31], v162 offset:64
    ds_read_b128 v[64:67], v162 offset:128
    ds_read_b128 v[56:59], v162 offset:192
    s_waitcnt lgkmcnt(3)
    v_mfma_f32_16x16x16_bf16 v[32:35], v[12:13], v[26:27], v[40:43]
    v_mfma_f32_16x16x16_bf16 v[36:39], v[14:15], v[26:27], v[40:43]
    s_nop 2
    v_mfma_f32_16x16x16_bf16 v[60:63], v[16:17], v[26:27], v[40:43]
    s_waitcnt lgkmcnt(0)
    s_nop 0
    ds_read_b128 v[12:15], v19 offset:24576
    v_cvt_pk_bf16_f32 v32, v32, v33
    v_mfma_f32_16x16x16_bf16 v[52:55], v[80:81], v[26:27], v[28:31]
    ds_read_b64 v[16:17], v18 offset:24640
    v_accvgpr_write_b32 a216, v32
    v_mfma_f32_16x16x16_bf16 v[48:51], v[82:83], v[26:27], v[28:31]
    ds_read_b128 v[44:47], v162 offset:256
    v_cvt_pk_bf16_f32 v34, v34, v35
    v_mfma_f32_16x16x16_bf16 v[40:43], v[84:85], v[26:27], v[28:31]
    ds_read_b128 v[104:107], v19 offset:25344
    v_accvgpr_write_b32 a217, v34
    v_mfma_f32_16x16x16_bf16 v[84:87], v[68:69], v[26:27], v[64:67]
    ds_read_b64 v[108:109], v18 offset:25408
    v_cvt_pk_bf16_f32 v36, v36, v37
    v_mfma_f32_16x16x16_bf16 v[32:35], v[70:71], v[26:27], v[64:67]
    ds_read_b128 v[100:103], v162 offset:320
    v_accvgpr_write_b32 a240, v36
    v_mfma_f32_16x16x16_bf16 v[28:31], v[72:73], v[26:27], v[64:67]
    ds_read_b128 v[92:95], v19 offset:36864
    v_cvt_pk_bf16_f32 v38, v38, v39
    v_mfma_f32_16x16x16_bf16 v[68:71], v[20:21], v[26:27], v[56:59]
    ds_read_b64 v[96:97], v18 offset:36928
    v_accvgpr_write_b32 a241, v38
    v_mfma_f32_16x16x16_bf16 v[64:67], v[22:23], v[26:27], v[56:59]
    ds_read_b128 v[80:83], v162 offset:5120
    v_cvt_pk_bf16_f32 v232, v60, v61
    v_mfma_f32_16x16x16_bf16 v[36:39], v[24:25], v[26:27], v[56:59]
    s_waitcnt lgkmcnt(6)
    ds_read_b128 v[20:23], v19 offset:37632
    v_cvt_pk_bf16_f32 v233, v62, v63
    v_cvt_pk_bf16_f32 v52, v52, v53
    v_accvgpr_write_b32 a218, v52
    v_cvt_pk_bf16_f32 v54, v54, v55
    v_accvgpr_write_b32 a219, v54
    v_cvt_pk_bf16_f32 v48, v48, v49
    v_mfma_f32_16x16x16_bf16 v[60:63], v[12:13], v[26:27], v[44:47]
    ds_read_b64 v[24:25], v18 offset:37696
    v_accvgpr_write_b32 a242, v48
    v_mfma_f32_16x16x16_bf16 v[56:59], v[14:15], v[26:27], v[44:47]
    ds_read_b128 v[88:91], v162 offset:5184
    v_cvt_pk_bf16_f32 v50, v50, v51
    v_mfma_f32_16x16x16_bf16 v[52:55], v[16:17], v[26:27], v[44:47]
    s_waitcnt lgkmcnt(6)
    ds_read_b128 v[12:15], v19 offset:49152
    v_accvgpr_write_b32 a243, v50
    v_cvt_pk_bf16_f32 v234, v40, v41
    v_cvt_pk_bf16_f32 v235, v42, v43
    v_mfma_f32_16x16x16_bf16 v[72:75], v[104:105], v[26:27], v[100:103]
    ds_read_b64 v[16:17], v18 offset:49216
    v_cvt_pk_bf16_f32 v84, v84, v85
    v_mfma_f32_16x16x16_bf16 v[40:43], v[106:107], v[26:27], v[100:103]
    ds_read_b128 v[48:51], v162 offset:5248
    v_accvgpr_write_b32 a220, v84
    v_mfma_f32_16x16x16_bf16 v[44:47], v[108:109], v[26:27], v[100:103]
    s_waitcnt lgkmcnt(6)
    ds_read_b128 v[104:107], v19 offset:49920
    v_cvt_pk_bf16_f32 v86, v86, v87
    v_accvgpr_write_b32 a221, v86
    v_cvt_pk_bf16_f32 v32, v32, v33
    v_accvgpr_write_b32 a244, v32
    v_cvt_pk_bf16_f32 v34, v34, v35
    v_accvgpr_write_b32 a245, v34
    v_cvt_pk_bf16_f32 v236, v28, v29
    v_cvt_pk_bf16_f32 v237, v30, v31
    v_mfma_f32_16x16x16_bf16 v[84:87], v[92:93], v[26:27], v[80:83]
    ds_read_b64 v[108:109], v18 offset:49984
    v_cvt_pk_bf16_f32 v68, v68, v69
    v_mfma_f32_16x16x16_bf16 v[32:35], v[94:95], v[26:27], v[80:83]
    ds_read_b128 v[100:103], v162 offset:5312
    v_accvgpr_write_b32 a222, v68
    v_mfma_f32_16x16x16_bf16 v[28:31], v[96:97], v[26:27], v[80:83]
    s_waitcnt lgkmcnt(5)
    ds_read_b128 v[92:95], v19 offset:61440
    v_cvt_pk_bf16_f32 v70, v70, v71
    v_accvgpr_write_b32 a223, v70
    v_cvt_pk_bf16_f32 v64, v64, v65
    v_accvgpr_write_b32 a246, v64
    v_cvt_pk_bf16_f32 v66, v66, v67
    v_accvgpr_write_b32 a247, v66
    v_cvt_pk_bf16_f32 v238, v36, v37
    v_cvt_pk_bf16_f32 v239, v38, v39
    v_mfma_f32_16x16x16_bf16 v[36:39], v[20:21], v[26:27], v[88:91]
    ds_read_b64 v[96:97], v18 offset:61504
    v_cvt_pk_bf16_f32 v60, v60, v61
    v_mfma_f32_16x16x16_bf16 v[68:71], v[22:23], v[26:27], v[88:91]
    ds_read_b128 v[80:83], v162 offset:5376
    v_accvgpr_write_b32 a224, v60
    v_mfma_f32_16x16x16_bf16 v[64:67], v[24:25], v[26:27], v[88:91]
    s_waitcnt lgkmcnt(5)
    ds_read_b128 v[20:23], v19 offset:62208
    v_cvt_pk_bf16_f32 v62, v62, v63
    v_accvgpr_write_b32 a225, v62
    v_cvt_pk_bf16_f32 v56, v56, v57
    v_accvgpr_write_b32 a248, v56
    v_cvt_pk_bf16_f32 v58, v58, v59
    v_accvgpr_write_b32 a249, v58
    v_cvt_pk_bf16_f32 v240, v52, v53
    v_cvt_pk_bf16_f32 v241, v54, v55
    v_mfma_f32_16x16x16_bf16 v[60:63], v[12:13], v[26:27], v[48:51]
    ds_read_b64 v[24:25], v18 offset:62272
    v_cvt_pk_bf16_f32 v72, v72, v73
    v_mfma_f32_16x16x16_bf16 v[56:59], v[14:15], v[26:27], v[48:51]
    ds_read_b128 v[12:15], v162 offset:5440
    v_accvgpr_write_b32 a226, v72
    v_mfma_f32_16x16x16_bf16 v[52:55], v[16:17], v[26:27], v[48:51]
    s_waitcnt lgkmcnt(5)
    ds_read_b128 v[16:19], v137 offset:0
    v_cvt_pk_bf16_f32 v74, v74, v75
    v_accvgpr_write_b32 a227, v74
    v_cvt_pk_bf16_f32 v40, v40, v41
    v_accvgpr_write_b32 a250, v40
    v_cvt_pk_bf16_f32 v42, v42, v43
    v_accvgpr_write_b32 a251, v42
    v_cvt_pk_bf16_f32 v242, v44, v45
    v_cvt_pk_bf16_f32 v243, v46, v47
    v_mfma_f32_16x16x16_bf16 v[48:51], v[104:105], v[26:27], v[100:103]
    ds_read_b128 v[146:149], v136 offset:0
    v_cvt_pk_bf16_f32 v84, v84, v85
    v_mfma_f32_16x16x16_bf16 v[44:47], v[106:107], v[26:27], v[100:103]
    ds_read_b128 v[72:75], v137 offset:128
    v_accvgpr_write_b32 a228, v84
    v_mfma_f32_16x16x16_bf16 v[40:43], v[108:109], v[26:27], v[100:103]
    s_waitcnt lgkmcnt(5)
    ds_read_b128 v[88:91], v136 offset:128
    v_cvt_pk_bf16_f32 v86, v86, v87
    v_accvgpr_write_b32 a229, v86
    v_cvt_pk_bf16_f32 v32, v32, v33
    v_accvgpr_write_b32 a252, v32
    v_cvt_pk_bf16_f32 v34, v34, v35
    v_accvgpr_write_b32 a253, v34
    v_cvt_pk_bf16_f32 v244, v28, v29
    v_cvt_pk_bf16_f32 v245, v30, v31
    v_mfma_f32_16x16x16_bf16 v[32:35], v[92:93], v[26:27], v[80:83]
    s_waitcnt vmcnt(0) lgkmcnt(4)
    s_barrier
    ds_write_b128 v121, v[8:11] offset:6144
    v_mfma_f32_16x16x16_bf16 v[28:31], v[94:95], v[26:27], v[80:83]
    v_cvt_pk_bf16_f32 v36, v36, v37
    v_accvgpr_write_b32 a230, v36
    v_mfma_f32_16x16x16_bf16 v[8:11], v[96:97], v[26:27], v[80:83]
    s_waitcnt lgkmcnt(4)
    v_cvt_pk_bf16_f32 v38, v38, v39
    v_accvgpr_write_b32 a231, v38
    v_cvt_pk_bf16_f32 v68, v68, v69
    v_mfma_f32_16x16x32_bf16 v[36:39], a[0:3], v[16:19], 0
    s_waitcnt lgkmcnt(3)
    ds_write_b64 v158, v[156:157] offset:80
    v_mfma_f32_16x16x32_bf16 v[36:39], a[4:7], v[146:149], v[36:39]
    s_waitcnt lgkmcnt(3)
    v_accvgpr_write_b32 a254, v68
    v_cvt_pk_bf16_f32 v70, v70, v71
    v_mfma_f32_16x16x32_bf16 v[36:39], a[8:11], v[72:75], v[36:39]
    s_waitcnt lgkmcnt(2)
    ds_write_b128 v158, v[76:79] offset:96
    v_mfma_f32_16x16x32_bf16 v[36:39], a[12:15], v[88:91], v[36:39]
    v_accvgpr_write_b32 a255, v70
    v_cvt_pk_bf16_f32 v246, v64, v65
    v_cvt_pk_bf16_f32 v247, v66, v67
    v_cvt_pk_bf16_f32 v60, v60, v61
    v_accvgpr_write_b32 a232, v60
    v_cvt_pk_bf16_f32 v62, v62, v63
    v_accvgpr_write_b32 a233, v62
    v_cvt_pk_bf16_f32 v224, v56, v57
    v_cvt_pk_bf16_f32 v225, v58, v59
    v_cvt_pk_bf16_f32 v248, v52, v53
    v_cvt_pk_bf16_f32 v249, v54, v55
    v_cvt_pk_bf16_f32 v48, v48, v49
    v_accvgpr_write_b32 a234, v48
    v_cvt_pk_bf16_f32 v50, v50, v51
    v_accvgpr_write_b32 a235, v50
    v_cvt_pk_bf16_f32 v226, v44, v45
    v_cvt_pk_bf16_f32 v227, v46, v47
    v_cvt_pk_bf16_f32 v250, v40, v41
    v_cvt_pk_bf16_f32 v251, v42, v43
    v_cvt_pk_bf16_f32 v32, v32, v33
    v_accvgpr_write_b32 a236, v32
    v_cvt_pk_bf16_f32 v34, v34, v35
    v_accvgpr_write_b32 a237, v34
    v_cvt_pk_bf16_f32 v228, v28, v29
    v_cvt_pk_bf16_f32 v229, v30, v31
    v_cvt_pk_bf16_f32 v252, v8, v9
    v_cvt_pk_bf16_f32 v253, v10, v11
    v_mov_b32 v156, 0
    v_mov_b32 v157, 0
    v_mov_b32 v121, 0
    v_add_u32 v230, 0, v158
    ds_write_b128 v230, v[4:7]
    v_add_u32 v135, s49, v135
    v_add_u32 v134, s49, v134
    ds_write2_b64 v230, v[156:157], v[156:157] offset0:2 offset1:3
    ds_write_b128 v230, v[0:3] offset:32
    ds_write2_b64 v230, v[160:161], v[156:157] offset0:6 offset1:7
    ds_write2_b64 v230, v[156:157], v[254:255] offset0:8 offset1:9
    ds_write_b64 v230, v[120:121] offset:88
    ds_read_b128 v[76:79], v137 offset:256
    ds_read_b128 v[56:59], v136 offset:256
    s_waitcnt lgkmcnt(1)
    v_mfma_f32_16x16x32_bf16 v[36:39], a[16:19], v[76:79], v[36:39]
    s_waitcnt lgkmcnt(0)
    v_mfma_f32_16x16x32_bf16 v[36:39], a[20:23], v[56:59], v[36:39]
    s_nop 0
    v_mfma_f32_16x16x16_bf16 v[8:11], v[20:21], v[26:27], v[12:15]
    s_nop 3
    v_mfma_f32_16x16x16_bf16 v[4:7], v[22:23], v[26:27], v[12:15]
    s_nop 0
    v_fma_f32 v121, v36, v36, s41
    v_fmac_f32 v121, v37, v37
    v_mfma_f32_16x16x16_bf16 v[0:3], v[24:25], v[26:27], v[12:15]
    v_cvt_pk_bf16_f32 v8, v8, v9
    v_accvgpr_write_b32 a238, v8
    v_cvt_pk_bf16_f32 v10, v10, v11
    v_mfma_f32_16x16x32_bf16 v[48:51], a[24:27], v[16:19], 0
    v_accvgpr_write_b32 a239, v10
    v_cvt_pk_bf16_f32 v230, v4, v5
    v_mfma_f32_16x16x32_bf16 v[48:51], a[28:31], v[146:149], v[48:51]
    v_cvt_pk_bf16_f32 v231, v6, v7
    v_cvt_pk_bf16_f32 v254, v0, v1
    v_mfma_f32_16x16x32_bf16 v[48:51], a[32:35], v[72:75], v[48:51]
    v_cvt_pk_bf16_f32 v255, v2, v3
    v_fmac_f32 v121, v38, v38
    v_mfma_f32_16x16x32_bf16 v[48:51], a[36:39], v[88:91], v[48:51]
    v_fmac_f32 v121, v39, v39
    v_mfma_f32_16x16x32_bf16 v[48:51], a[40:43], v[76:79], v[48:51]
    v_mfma_f32_16x16x32_bf16 v[48:51], a[44:47], v[56:59], v[48:51]
    s_nop 1
    v_mfma_f32_16x16x32_bf16 v[40:43], a[48:51], v[16:19], 0
    s_nop 2
    v_mfma_f32_16x16x32_bf16 v[40:43], a[52:55], v[146:149], v[40:43]
    s_nop 0
    v_fmac_f32 v121, v48, v48
    v_fmac_f32 v121, v49, v49
    v_mfma_f32_16x16x32_bf16 v[40:43], a[56:59], v[72:75], v[40:43]
    v_fmac_f32 v121, v50, v50
    v_fmac_f32 v121, v51, v51
    v_mfma_f32_16x16x32_bf16 v[40:43], a[60:63], v[88:91], v[40:43]
    v_mfma_f32_16x16x32_bf16 v[40:43], a[64:67], v[76:79], v[40:43]
    v_mfma_f32_16x16x32_bf16 v[40:43], a[68:71], v[56:59], v[40:43]
    s_nop 1
    v_mfma_f32_16x16x32_bf16 v[28:31], a[72:75], v[16:19], 0
    s_nop 2
    v_mfma_f32_16x16x32_bf16 v[28:31], a[76:79], v[146:149], v[28:31]
    s_nop 0
    v_fmac_f32 v121, v40, v40
    v_fmac_f32 v121, v41, v41
    v_mfma_f32_16x16x32_bf16 v[28:31], a[80:83], v[72:75], v[28:31]
    v_fmac_f32 v121, v42, v42
    v_fmac_f32 v121, v43, v43
    v_mfma_f32_16x16x32_bf16 v[28:31], a[84:87], v[88:91], v[28:31]
    v_mfma_f32_16x16x32_bf16 v[28:31], a[88:91], v[76:79], v[28:31]
    v_mfma_f32_16x16x32_bf16 v[28:31], a[92:95], v[56:59], v[28:31]
    s_nop 1
    v_mfma_f32_16x16x32_bf16 v[32:35], a[96:99], v[16:19], 0
    s_nop 2
    v_mfma_f32_16x16x32_bf16 v[32:35], a[100:103], v[146:149], v[32:35]
    s_nop 0
    v_fma_f32 v120, v28, v28, s41
    v_fmac_f32 v120, v29, v29
    v_mfma_f32_16x16x32_bf16 v[32:35], a[104:107], v[72:75], v[32:35]
    v_fmac_f32 v120, v30, v30
    v_fmac_f32 v120, v31, v31
    v_mfma_f32_16x16x32_bf16 v[32:35], a[108:111], v[88:91], v[32:35]
    v_mfma_f32_16x16x32_bf16 v[32:35], a[112:115], v[76:79], v[32:35]
    v_mfma_f32_16x16x32_bf16 v[32:35], a[116:119], v[56:59], v[32:35]
    s_nop 1
    v_mfma_f32_16x16x32_bf16 v[20:23], a[120:123], v[16:19], 0
    s_nop 2
    v_mfma_f32_16x16x32_bf16 v[20:23], a[124:127], v[146:149], v[20:23]
    s_nop 0
    v_fmac_f32 v120, v32, v32
    v_fmac_f32 v120, v33, v33
    v_mfma_f32_16x16x32_bf16 v[20:23], a[128:131], v[72:75], v[20:23]
    v_fmac_f32 v120, v34, v34
    v_fmac_f32 v120, v35, v35
    v_mfma_f32_16x16x32_bf16 v[20:23], a[132:135], v[88:91], v[20:23]
    v_mfma_f32_16x16x32_bf16 v[20:23], a[136:139], v[76:79], v[20:23]
    v_mfma_f32_16x16x32_bf16 v[20:23], a[140:143], v[56:59], v[20:23]
    s_nop 1
    v_mfma_f32_16x16x32_bf16 v[8:11], v[16:19], a[144:147], 0
    s_nop 2
    v_mfma_f32_16x16x32_bf16 v[8:11], v[146:149], a[148:151], v[8:11]
    s_nop 0
    v_fmac_f32 v120, v20, v20
    v_fmac_f32 v120, v21, v21
    v_mfma_f32_16x16x32_bf16 v[8:11], v[72:75], a[152:155], v[8:11]
    v_fmac_f32 v120, v22, v22
    v_fmac_f32 v120, v23, v23
    v_mfma_f32_16x16x32_bf16 v[8:11], v[88:91], a[156:159], v[8:11]
    v_cvt_pk_bf16_f32 v170, v121, v120
    v_mfma_f32_16x16x32_bf16 v[8:11], v[76:79], a[160:163], v[8:11]
    ds_read_b128 v[104:107], v137 offset:1536
    v_mfma_f32_16x16x32_bf16 v[8:11], v[56:59], a[164:167], v[8:11]
    s_nop 0
    ds_read_b128 v[100:103], v136 offset:1536
    s_nop 0
    v_mfma_f32_16x16x16_bf16 v[24:27], v[216:217], v[170:171], 0
    s_nop 0
    ds_read_b128 v[44:47], v137 offset:1664
    s_nop 1
    v_cvt_pk_bf16_f32 v0, v8, v9
    v_mfma_f32_16x16x32_bf16 v[4:7], v[16:19], a[168:171], 0
    ds_read_b128 v[84:87], v136 offset:1664
    v_cvt_pk_bf16_f32 v1, v10, v11
    v_mfma_f32_16x16x32_bf16 v[4:7], v[146:149], a[172:175], v[4:7]
    ds_read_b128 v[68:71], v137 offset:1792
    v_mfma_f32_16x16x32_bf16 v[4:7], v[72:75], a[176:179], v[4:7]
    ds_read_b128 v[64:67], v136 offset:1792
    v_mfma_f32_16x16x32_bf16 v[4:7], v[88:91], a[180:183], v[4:7]
    v_rsq_f32 v24, v24
    v_mfma_f32_16x16x32_bf16 v[4:7], v[76:79], a[184:187], v[4:7]
    v_rsq_f32 v25, v25
    v_mfma_f32_16x16x32_bf16 v[4:7], v[56:59], a[188:191], v[4:7]
    v_mul_f32 v24, s55, v24
    v_mul_f32 v25, 0.5, v25
    v_mfma_f32_16x16x32_bf16 v[12:15], v[16:19], a[192:195], 0
    s_nop 0
    v_mul_f32 v36, v36, v24
    v_mul_f32 v37, v37, v24
    v_mfma_f32_16x16x32_bf16 v[12:15], v[146:149], a[196:199], v[12:15]
    s_nop 0
    v_cvt_pk_bf16_f32 v8, v4, v5
    v_cvt_pk_bf16_f32 v9, v6, v7
    v_mfma_f32_16x16x32_bf16 v[12:15], v[72:75], a[200:203], v[12:15]
    v_cvt_pk_f16_f32 v4, v36, v37
    v_mul_f32 v38, v38, v24
    v_mfma_f32_16x16x32_bf16 v[12:15], v[88:91], a[204:207], v[12:15]
    v_mul_f32 v39, v39, v24
    v_cvt_pk_f16_f32 v5, v38, v39
    v_mfma_f32_16x16x32_bf16 v[12:15], v[76:79], a[208:211], v[12:15]
    v_mul_f32 v48, v48, v24
    v_mul_f32 v49, v49, v24
    v_mfma_f32_16x16x32_bf16 v[12:15], v[56:59], a[212:215], v[12:15]
    s_waitcnt lgkmcnt(0)
    v_cvt_pk_f16_f32 v6, v48, v49
    v_mul_f32 v50, v50, v24
    v_mfma_f32_16x16x32_bf16 v[16:19], a[0:3], v[104:107], 0
    v_mul_f32 v51, v51, v24
    v_cvt_pk_f16_f32 v7, v50, v51
    v_mfma_f32_16x16x32_bf16 v[16:19], a[4:7], v[100:103], v[16:19]
    v_mul_f32 v40, v40, v24
    v_mul_f32 v41, v41, v24
    v_mfma_f32_16x16x32_bf16 v[16:19], a[8:11], v[44:47], v[16:19]
    v_cvt_pk_f16_f32 v152, v40, v41
    v_mul_f32 v42, v42, v24
    v_mfma_f32_16x16x32_bf16 v[16:19], a[12:15], v[84:87], v[16:19]
    v_mul_f32 v43, v43, v24
    v_cvt_pk_f16_f32 v153, v42, v43
    v_mfma_f32_16x16x32_bf16 v[16:19], a[16:19], v[68:71], v[16:19]
    v_mul_f32 v28, v28, v25
    v_mul_f32 v29, v29, v25
    v_mfma_f32_16x16x32_bf16 v[16:19], a[20:23], v[64:67], v[16:19]
    v_cvt_pk_f16_f32 v28, v28, v29
    v_mul_f32 v30, v30, v25
    v_mfma_f32_16x16x32_bf16 v[60:63], a[24:27], v[104:107], 0
    v_mul_f32 v31, v31, v25
    v_cvt_pk_f16_f32 v29, v30, v31
    v_mfma_f32_16x16x32_bf16 v[60:63], a[28:31], v[100:103], v[60:63]
    v_mul_f32 v32, v32, v25
    v_mul_f32 v33, v33, v25
    v_mfma_f32_16x16x32_bf16 v[60:63], a[32:35], v[44:47], v[60:63]
    v_cvt_pk_f16_f32 v30, v32, v33
    v_mul_f32 v34, v34, v25
    v_mfma_f32_16x16x32_bf16 v[60:63], a[36:39], v[84:87], v[60:63]
    v_mul_f32 v35, v35, v25
    v_cvt_pk_f16_f32 v31, v34, v35
    v_mfma_f32_16x16x32_bf16 v[60:63], a[40:43], v[68:71], v[60:63]
    v_mul_f32 v20, v20, v25
    v_mul_f32 v21, v21, v25
    v_mfma_f32_16x16x32_bf16 v[60:63], a[44:47], v[64:67], v[60:63]
    v_cvt_pk_f16_f32 v154, v20, v21
    v_mul_f32 v22, v22, v25
    v_mfma_f32_16x16x32_bf16 v[36:39], a[48:51], v[104:107], 0
    v_mul_f32 v23, v23, v25
    v_cvt_pk_f16_f32 v155, v22, v23
    v_mfma_f32_16x16x32_bf16 v[36:39], a[52:55], v[100:103], v[36:39]
    v_cvt_pk_bf16_f32 v20, v12, v13
    v_cvt_pk_bf16_f32 v21, v14, v15
    v_mfma_f32_16x16x32_bf16 v[36:39], a[56:59], v[44:47], v[36:39]
    v_fma_f32 v2, v16, v16, s41
    v_fmac_f32 v2, v17, v17
    v_mfma_f32_16x16x32_bf16 v[36:39], a[60:63], v[84:87], v[36:39]
    v_fmac_f32 v2, v18, v18
    v_fmac_f32 v2, v19, v19
    v_mfma_f32_16x16x32_bf16 v[36:39], a[64:67], v[68:71], v[36:39]
    v_fmac_f32 v2, v60, v60
    v_fmac_f32 v2, v61, v61
    v_mfma_f32_16x16x32_bf16 v[36:39], a[68:71], v[64:67], v[36:39]
    v_fmac_f32 v2, v62, v62
    v_fmac_f32 v2, v63, v63
    v_mfma_f32_16x16x32_bf16 v[52:55], a[72:75], v[104:107], 0
    s_nop 2
    v_mfma_f32_16x16x32_bf16 v[52:55], a[76:79], v[100:103], v[52:55]
    s_nop 0
    v_fmac_f32 v2, v36, v36
    v_fmac_f32 v2, v37, v37
    v_mfma_f32_16x16x32_bf16 v[52:55], a[80:83], v[44:47], v[52:55]
    v_fmac_f32 v2, v38, v38
    v_fmac_f32 v2, v39, v39
    v_mfma_f32_16x16x32_bf16 v[52:55], a[84:87], v[84:87], v[52:55]
    v_mfma_f32_16x16x32_bf16 v[52:55], a[88:91], v[68:71], v[52:55]
    v_mfma_f32_16x16x32_bf16 v[52:55], a[92:95], v[64:67], v[52:55]
    s_nop 1
    v_mfma_f32_16x16x32_bf16 v[12:15], a[96:99], v[104:107], 0
    s_nop 2
    v_mfma_f32_16x16x32_bf16 v[12:15], a[100:103], v[100:103], v[12:15]
    s_nop 0
    v_fma_f32 v3, v52, v52, s41
    v_fmac_f32 v3, v53, v53
    v_mfma_f32_16x16x32_bf16 v[12:15], a[104:107], v[44:47], v[12:15]
    v_fmac_f32 v3, v54, v54
    v_fmac_f32 v3, v55, v55
    v_mfma_f32_16x16x32_bf16 v[12:15], a[108:111], v[84:87], v[12:15]
    v_mfma_f32_16x16x32_bf16 v[12:15], a[112:115], v[68:71], v[12:15]
    v_mfma_f32_16x16x32_bf16 v[12:15], a[116:119], v[64:67], v[12:15]
    s_sub_u32 s50, s45, s44
    v_add_u32 v135, s48, v135
    v_add_u32 v134, s48, v134
    v_mfma_f32_16x16x32_bf16 v[48:51], a[120:123], v[104:107], 0
    s_sub_u32 s51, s46, s47
    v_add_u32 v133, s51, v133
    v_mfma_f32_16x16x32_bf16 v[48:51], a[124:127], v[100:103], v[48:51]
    s_mov_b32 s60, s59
    v_fmac_f32 v3, v12, v12
    v_fmac_f32 v3, v13, v13
    v_mfma_f32_16x16x32_bf16 v[48:51], a[128:131], v[44:47], v[48:51]
    s_mov_b32 s59, s58
    v_fmac_f32 v3, v14, v14
    v_fmac_f32 v3, v15, v15
    v_mfma_f32_16x16x32_bf16 v[48:51], a[132:135], v[84:87], v[48:51]
    s_mov_b32 s58, s57
    v_mfma_f32_16x16x32_bf16 v[48:51], a[136:139], v[68:71], v[48:51]
    s_mov_b32 s57, s56
    v_mfma_f32_16x16x32_bf16 v[48:51], a[140:143], v[64:67], v[48:51]
    s_mov_b32 s7, s6
    s_nop 0
    v_mfma_f32_16x16x32_bf16 v[24:27], v[104:107], a[144:147], 0
    s_mov_b32 s6, s5
    s_nop 1
    v_mfma_f32_16x16x32_bf16 v[24:27], v[100:103], a[148:151], v[24:27]
    s_mov_b32 s5, s4
    v_fmac_f32 v3, v48, v48
    v_fmac_f32 v3, v49, v49
    v_mfma_f32_16x16x32_bf16 v[24:27], v[44:47], a[152:155], v[24:27]
    s_sub_u32 s14, s6, s7
    v_fmac_f32 v3, v50, v50
    v_fmac_f32 v3, v51, v51
    v_mfma_f32_16x16x32_bf16 v[24:27], v[84:87], a[156:159], v[24:27]
    s_add_u32 s61, s61, 1
    v_cvt_pk_bf16_f32 v170, v2, v3
    v_add_u32 v132, s14, v132
    v_mfma_f32_16x16x32_bf16 v[24:27], v[68:71], a[160:163], v[24:27]
    s_ff1_i32_b32 s15, s66
    ds_read_b128 v[96:99], v137 offset:3072
    v_add_u32 v131, s14, v131
    v_mfma_f32_16x16x32_bf16 v[24:27], v[64:67], a[164:167], v[24:27]
    s_cmp_lg_u32 s66, 0
    ds_read_b128 v[92:95], v136 offset:3072
    v_add_u32 v123, s14, v123
    v_mfma_f32_16x16x16_bf16 v[40:43], v[216:217], v[170:171], 0
    s_cselect_b32 s12, s15, s12
    ds_read_b128 v[88:91], v137 offset:3200
    s_nop 1
    v_cvt_pk_bf16_f32 v2, v24, v25
    v_mfma_f32_16x16x32_bf16 v[72:75], v[104:107], a[168:171], 0
    s_cmp_lt_u32 s61, s71
    ds_read_b128 v[80:83], v136 offset:3200
    v_cvt_pk_bf16_f32 v3, v26, v27
    v_mfma_f32_16x16x32_bf16 v[72:75], v[100:103], a[172:175], v[72:75]
    s_cselect_b32 s15, 31, s15
    ds_read_b128 v[56:59], v137 offset:3328
    v_add_u32 v137, s50, v137
    v_mfma_f32_16x16x32_bf16 v[72:75], v[44:47], a[176:179], v[72:75]
    s_bitset0_b32 s66, s15
    ds_read_b128 v[24:27], v136 offset:3328
    v_add_u32 v136, s50, v136
    v_mfma_f32_16x16x32_bf16 v[72:75], v[84:87], a[180:183], v[72:75]
    s_add_u32 s12, s12, 20
    v_rsq_f32 v40, v40
    v_mfma_f32_16x16x32_bf16 v[72:75], v[68:71], a[184:187], v[72:75]
    s_max_u32 s12, s12, s61
    v_rsq_f32 v41, v41
    v_mfma_f32_16x16x32_bf16 v[72:75], v[64:67], a[188:191], v[72:75]
    s_cmp_lt_u32 s61, s71
    v_mul_f32 v40, s55, v40
    v_mul_f32 v41, 0.5, v41
    v_mfma_f32_16x16x32_bf16 v[32:35], v[104:107], a[192:195], 0
    s_cselect_b32 s15, s61, s12
    v_mul_f32 v16, v16, v40
    v_mul_f32 v17, v17, v40
    v_mfma_f32_16x16x32_bf16 v[32:35], v[100:103], a[196:199], v[32:35]
    s_cselect_b32 s56, s69, s70
    v_cvt_pk_bf16_f32 v10, v72, v73
    v_cvt_pk_bf16_f32 v11, v74, v75
    v_mfma_f32_16x16x32_bf16 v[32:35], v[44:47], a[200:203], v[32:35]
    s_add_u32 s56, s56, s15
    v_cvt_pk_f16_f32 v44, v16, v17
    v_mul_f32 v18, v18, v40
    v_mfma_f32_16x16x32_bf16 v[32:35], v[84:87], a[204:207], v[32:35]
    s_mul_i32 s53, s56, 58255
    v_mul_f32 v19, v19, v40
    v_cvt_pk_f16_f32 v45, v18, v19
    v_mfma_f32_16x16x32_bf16 v[32:35], v[68:71], a[208:211], v[32:35]
    s_waitcnt lgkmcnt(0)
    s_lshr_b32 s53, s53, 22
    v_mul_f32 v60, v60, v40
    v_mul_f32 v61, v61, v40
    v_mfma_f32_16x16x32_bf16 v[32:35], v[64:67], a[212:215], v[32:35]
    s_barrier
    v_cvt_pk_f16_f32 v46, v60, v61
    v_mul_f32 v62, v62, v40
    v_mfma_f32_16x16x32_bf16 v[16:19], a[0:3], v[96:99], 0
    s_mul_i32 s53, s53, s63
    v_mul_f32 v63, v63, v40
    v_cvt_pk_f16_f32 v47, v62, v63
    v_mfma_f32_16x16x32_bf16 v[16:19], a[4:7], v[92:95], v[16:19]
    s_mul_i32 s56, s56, s62
    v_mul_f32 v36, v36, v40
    v_mul_f32 v37, v37, v40
    v_mfma_f32_16x16x32_bf16 v[16:19], a[8:11], v[88:91], v[16:19]
    s_add_u32 s56, s56, s53
    v_cvt_pk_f16_f32 v146, v36, v37
    v_mul_f32 v38, v38, v40
    v_mfma_f32_16x16x32_bf16 v[16:19], a[12:15], v[80:83], v[16:19]
    s_mul_i32 s4, s15, 112
    v_mul_f32 v39, v39, v40
    v_cvt_pk_f16_f32 v147, v38, v39
    v_mfma_f32_16x16x32_bf16 v[16:19], a[16:19], v[56:59], v[16:19]
    s_cmp_ge_u32 s15, 16
    v_mul_f32 v52, v52, v41
    v_mul_f32 v53, v53, v41
    v_mfma_f32_16x16x32_bf16 v[16:19], a[20:23], v[24:27], v[16:19]
    s_cselect_b32 s53, -30464, 0
    v_cvt_pk_f16_f32 v72, v52, v53
    v_mul_f32 v54, v54, v41
    v_mfma_f32_16x16x32_bf16 v[36:39], a[24:27], v[96:99], 0
    s_add_u32 s4, s4, s53
    v_mul_f32 v55, v55, v41
    v_cvt_pk_f16_f32 v73, v54, v55
    v_mfma_f32_16x16x32_bf16 v[36:39], a[28:31], v[92:95], v[36:39]
    s_cmp_lt_u32 s15, s73
    v_mul_f32 v12, v12, v41
    v_mul_f32 v13, v13, v41
    v_mfma_f32_16x16x32_bf16 v[36:39], a[32:35], v[88:91], v[36:39]
    s_cselect_b32 s26, 100270464, 0
    v_cvt_pk_f16_f32 v74, v12, v13
    v_mul_f32 v14, v14, v41
    v_mfma_f32_16x16x32_bf16 v[36:39], a[36:39], v[80:83], v[36:39]
    s_cselect_b32 s56, s56, 0
    v_mul_f32 v15, v15, v41
    v_cvt_pk_f16_f32 v75, v14, v15
    v_mfma_f32_16x16x32_bf16 v[36:39], a[40:43], v[56:59], v[36:39]
    s_cselect_b32 s4, s4, -1
    v_mul_f32 v48, v48, v41
    v_mul_f32 v49, v49, v41
    v_mfma_f32_16x16x32_bf16 v[36:39], a[44:47], v[24:27], v[36:39]
    s_cselect_b32 s15, s15, 0
    v_cvt_pk_f16_f32 v148, v48, v49
    v_mul_f32 v50, v50, v41
    v_mfma_f32_16x16x32_bf16 v[12:15], a[48:51], v[96:99], 0
    s_cselect_b32 s13, s13, -1
    v_mul_f32 v51, v51, v41
    v_cvt_pk_f16_f32 v149, v50, v51
    v_mfma_f32_16x16x32_bf16 v[12:15], a[52:55], v[92:95], v[12:15]
    s_bitset1_b32 s64, s15
    v_cvt_pk_bf16_f32 v22, v32, v33
    v_cvt_pk_bf16_f32 v23, v34, v35
    v_mfma_f32_16x16x32_bf16 v[12:15], a[56:59], v[88:91], v[12:15]
    s_add_u32 s65, s65, 1
    v_fma_f32 v156, v16, v16, s41
    v_fmac_f32 v156, v17, v17
    v_mfma_f32_16x16x32_bf16 v[12:15], a[60:63], v[80:83], v[12:15]
    s_cmp_ge_i32 s65, 2
    v_fmac_f32 v156, v18, v18
    v_fmac_f32 v156, v19, v19
    v_mfma_f32_16x16x32_bf16 v[12:15], a[64:67], v[56:59], v[12:15]
    s_cselect_b32 s30, 100270464, 0
    v_fmac_f32 v156, v36, v36
    v_fmac_f32 v156, v37, v37
    v_mfma_f32_16x16x32_bf16 v[12:15], a[68:71], v[24:27], v[12:15]
    s_add_u32 s67, s46, s54
    v_fmac_f32 v156, v38, v38
    v_fmac_f32 v156, v39, v39
    v_mfma_f32_16x16x32_bf16 v[64:67], a[72:75], v[96:99], 0
    s_add_u32 m0, s67, 0
    v_and_b32 v120, -8, v123
    v_mfma_f32_16x16x32_bf16 v[64:67], a[76:79], v[92:95], v[64:67]
    buffer_load_dwordx4 v128, s[24:27], s56 offen nt lds
    v_fmac_f32 v156, v12, v12
    v_mfma_f32_16x16x32_bf16 v[64:67], a[80:83], v[88:91], v[64:67]
    s_add_u32 m0, s67, 1024
    v_fmac_f32 v156, v13, v13
    v_fmac_f32 v156, v14, v14
    v_mfma_f32_16x16x32_bf16 v[64:67], a[84:87], v[80:83], v[64:67]
    v_fmac_f32 v156, v15, v15
    v_mfma_f32_16x16x32_bf16 v[64:67], a[88:91], v[56:59], v[64:67]
    v_mfma_f32_16x16x32_bf16 v[64:67], a[92:95], v[24:27], v[64:67]
    s_nop 1
    v_mfma_f32_16x16x32_bf16 v[32:35], a[96:99], v[96:99], 0
    s_nop 0
    buffer_load_dwordx4 v127, s[24:27], s56 offen nt lds
    s_nop 0
    v_mfma_f32_16x16x32_bf16 v[32:35], a[100:103], v[92:95], v[32:35]
    s_add_u32 m0, s67, 2048
    v_fma_f32 v121, v64, v64, s41
    v_fmac_f32 v121, v65, v65
    v_mfma_f32_16x16x32_bf16 v[32:35], a[104:107], v[88:91], v[32:35]
    v_fmac_f32 v121, v66, v66
    v_fmac_f32 v121, v67, v67
    v_mfma_f32_16x16x32_bf16 v[32:35], a[108:111], v[80:83], v[32:35]
    v_mfma_f32_16x16x32_bf16 v[32:35], a[112:115], v[56:59], v[32:35]
    v_mfma_f32_16x16x32_bf16 v[32:35], a[116:119], v[24:27], v[32:35]
    buffer_load_dwordx4 v126, s[24:27], s56 offen nt lds
    s_nop 0
    v_mfma_f32_16x16x32_bf16 v[40:43], a[120:123], v[96:99], 0
    s_add_u32 m0, s67, 3072
    s_nop 1
    v_mfma_f32_16x16x32_bf16 v[40:43], a[124:127], v[92:95], v[40:43]
    s_mov_b32 s53, s47
    v_fmac_f32 v121, v32, v32
    v_fmac_f32 v121, v33, v33
    v_mfma_f32_16x16x32_bf16 v[40:43], a[128:131], v[88:91], v[40:43]
    s_mov_b32 s47, s46
    v_fmac_f32 v121, v34, v34
    v_fmac_f32 v121, v35, v35
    v_mfma_f32_16x16x32_bf16 v[40:43], a[132:135], v[80:83], v[40:43]
    s_mov_b32 s46, s45
    v_mfma_f32_16x16x32_bf16 v[40:43], a[136:139], v[56:59], v[40:43]
    s_mov_b32 s45, s44
    buffer_load_dwordx4 v125, s[24:27], s56 offen nt lds
    v_mfma_f32_16x16x32_bf16 v[40:43], a[140:143], v[24:27], v[40:43]
    s_add_u32 m0, s67, 4096
    s_nop 0
    v_mfma_f32_16x16x32_bf16 v[68:71], v[96:99], a[144:147], 0
    s_mov_b32 s44, s53
    s_nop 1
    v_mfma_f32_16x16x32_bf16 v[68:71], v[92:95], a[148:151], v[68:71]
    s_sub_u32 s48, s44, s46
    v_fmac_f32 v121, v40, v40
    v_fmac_f32 v121, v41, v41
    v_mfma_f32_16x16x32_bf16 v[68:71], v[88:91], a[152:155], v[68:71]
    s_sub_u32 s49, s46, s45
    v_fmac_f32 v121, v42, v42
    v_fmac_f32 v121, v43, v43
    v_mfma_f32_16x16x32_bf16 v[68:71], v[80:83], a[156:159], v[68:71]
    buffer_load_dwordx4 v124, s[24:27], s56 offen nt lds
    v_cvt_pk_bf16_f32 v170, v156, v121
    v_mfma_f32_16x16x32_bf16 v[68:71], v[56:59], a[160:163], v[68:71]
    ds_read_b128 v[60:63], v132 offset:0
    v_add_u32 v137, s48, v137
    v_mfma_f32_16x16x32_bf16 v[68:71], v[24:27], a[164:167], v[68:71]
    s_nop 0
    ds_read_b128 v[52:55], v132 offset:16
    v_add_u32 v136, s48, v136
    v_mfma_f32_16x16x16_bf16 v[76:79], v[216:217], v[170:171], 0
    s_nop 0
    ds_read_b128 v[48:51], v132 offset:48
    s_nop 1
    v_cvt_pk_bf16_f32 v164, v68, v69
    v_mfma_f32_16x16x32_bf16 v[84:87], v[96:99], a[168:171], 0
    v_cvt_pk_bf16_f32 v165, v70, v71
    v_mfma_f32_16x16x32_bf16 v[84:87], v[92:95], a[172:175], v[84:87]
    v_rsq_f32 v76, v76
    v_mfma_f32_16x16x32_bf16 v[84:87], v[88:91], a[176:179], v[84:87]
    v_rsq_f32 v77, v77
    v_mfma_f32_16x16x32_bf16 v[84:87], v[80:83], a[180:183], v[84:87]
    v_mul_f32 v76, s55, v76
    v_mul_f32 v77, 0.5, v77
    v_mfma_f32_16x16x32_bf16 v[84:87], v[56:59], a[184:187], v[84:87]
    v_mul_f32 v64, v64, v77
    v_mul_f32 v65, v65, v77
    v_mfma_f32_16x16x32_bf16 v[84:87], v[24:27], a[188:191], v[84:87]
    v_cvt_pk_f16_f32 v64, v64, v65
    v_mul_f32 v66, v66, v77
    v_mfma_f32_16x16x32_bf16 v[68:71], v[96:99], a[192:195], 0
    s_nop 0
    v_mul_f32 v67, v67, v77
    v_cvt_pk_f16_f32 v65, v66, v67
    v_mfma_f32_16x16x32_bf16 v[68:71], v[92:95], a[196:199], v[68:71]
    s_nop 0
    v_cvt_pk_bf16_f32 v160, v84, v85
    v_cvt_pk_bf16_f32 v161, v86, v87
    v_mfma_f32_16x16x32_bf16 v[68:71], v[88:91], a[200:203], v[68:71]
    v_mul_f32 v32, v32, v77
    v_mul_f32 v33, v33, v77
    v_mfma_f32_16x16x32_bf16 v[68:71], v[80:83], a[204:207], v[68:71]
    v_cvt_pk_f16_f32 v66, v32, v33
    v_mul_f32 v34, v34, v77
    v_mfma_f32_16x16x32_bf16 v[68:71], v[56:59], a[208:211], v[68:71]
    v_mul_f32 v35, v35, v77
    v_cvt_pk_f16_f32 v67, v34, v35
    v_mfma_f32_16x16x32_bf16 v[68:71], v[24:27], a[212:215], v[68:71]
    v_mul_f32 v40, v40, v77
    v_mul_f32 v41, v41, v77
    v_mfma_f32_16x16x32_f16 v[32:35], v[28:31], v[4:7], v[204:207]
    ds_read_u16 v166, v131 offset:80
    v_cvt_pk_f16_f32 v142, v40, v41
    v_mfma_f32_16x16x32_f16 v[32:35], v[152:155], v[150:153], v[32:35]
    ds_read_u16 v162, v131 offset:96
    v_mul_f32 v42, v42, v77
    v_mfma_f32_16x16x32_f16 v[24:27], v[72:75], v[4:7], v[200:203]
    ds_read_u16 v158, v131 offset:104
    v_mul_f32 v43, v43, v77
    v_mfma_f32_16x16x32_f16 v[24:27], v[146:149], v[150:153], v[24:27]
    s_waitcnt lgkmcnt(3)
    ds_read_b32 v120, v120 offset:64
    v_cvt_pk_f16_f32 v143, v42, v43
    v_mfma_f32_16x16x32_f16 v[56:59], v[60:63], v[4:7], v[208:211]
    v_mul_f32 v16, v16, v76
    v_mul_f32 v17, v17, v76
    v_mfma_f32_16x16x32_f16 v[56:59], v[52:55], v[28:31], v[56:59]
    v_cvt_pk_f16_f32 v16, v16, v17
    v_mul_f32 v18, v18, v76
    v_mfma_f32_16x16x32_f16 v[56:59], v[48:51], v[152:155], v[56:59]
    v_mul_f32 v19, v19, v76
    v_cvt_pk_f16_f32 v17, v18, v19
    v_mfma_f32_16x16x32_f16 v[40:43], v[60:63], v[44:47], v[208:211]
    v_mul_f32 v36, v36, v76
    v_mul_f32 v37, v37, v76
    v_mfma_f32_16x16x32_f16 v[40:43], v[52:55], v[72:75], v[40:43]
    v_cvt_pk_f16_f32 v18, v36, v37
    v_mul_f32 v38, v38, v76
    v_mfma_f32_16x16x32_f16 v[40:43], v[48:51], v[146:149], v[40:43]
    v_mul_f32 v39, v39, v76
    v_cvt_pk_f16_f32 v19, v38, v39
    v_mfma_f32_16x16x32_f16 v[36:39], v[28:31], v[44:47], v[192:195]
    v_mul_f32 v12, v12, v76
    v_mul_f32 v13, v13, v76
    v_mfma_f32_16x16x32_f16 v[36:39], v[152:155], v[144:147], v[36:39]
    v_cvt_pk_f16_f32 v140, v12, v13
    v_mul_f32 v14, v14, v76
    v_mul_f32 v15, v15, v76
    v_cvt_pk_f16_f32 v141, v14, v15
    v_mfma_f32_16x16x32_f16 v[12:15], v[64:67], v[4:7], v[196:199]
    v_cvt_pk_bf16_f32 v156, v68, v69
    v_cvt_pk_bf16_f32 v157, v70, v71
    v_mfma_f32_16x16x32_f16 v[12:15], v[140:143], v[150:153], v[12:15]
    v_max3_f32 v121, v32, v33, v34
    v_max3_f32 v121, v121, v35, v24
    v_mfma_f32_16x16x32_f16 v[4:7], v[60:63], v[16:19], v[208:211]
    s_nop 0
    v_max3_f32 v121, v121, v25, v26
    v_mov_b32_dpp v59, v43 quad_perm:[0,1,2,3] row_mask:0x2 bank_mask:0xf
    v_mfma_f32_16x16x32_f16 v[4:7], v[52:55], v[64:67], v[4:7]
    s_nop 0
    v_max3_f32 v121, v121, v27, v12
    v_max3_f32 v121, v121, v13, v14
    v_mfma_f32_16x16x32_f16 v[4:7], v[48:51], v[140:143], v[4:7]
    v_max3_f32 v121, v121, v15, v56
    v_mov_b32 v57, v121
    v_mfma_f32_16x16x32_f16 v[52:55], v[72:75], v[44:47], v[188:191]
    s_nop 0
    v_permlane32_swap_b32 v57, v121
    v_mfma_f32_16x16x32_f16 v[52:55], v[146:149], v[144:147], v[52:55]
    v_max_f32 v121, v57, v121
    v_mov_b32 v57, v121
    v_mfma_f32_16x16x32_f16 v[48:51], v[64:67], v[44:47], v[184:187]
    s_nop 0
    v_permlane16_swap_b32 v57, v121
    v_mfma_f32_16x16x32_f16 v[48:51], v[140:143], v[144:147], v[48:51]
    v_max_f32 v121, v57, v121
    v_sub_f32 v32, v32, v121
    v_sub_f32 v33, v33, v121
    v_sub_f32 v34, v34, v121
    v_sub_f32 v35, v35, v121
    v_sub_f32 v24, v24, v121
    v_sub_f32 v25, v25, v121
    v_sub_f32 v26, v26, v121
    v_sub_f32 v27, v27, v121
    v_sub_f32 v12, v12, v121
    v_sub_f32 v13, v13, v121
    v_sub_f32 v14, v14, v121
    v_sub_f32 v15, v15, v121
    v_sub_f32 v56, v56, v121
    v_exp_f32 v32, v32
    v_exp_f32 v33, v33
    v_exp_f32 v34, v34
    v_exp_f32 v35, v35
    v_cvt_pk_bf16_f32 v60, v32, v33
    v_cvt_pk_bf16_f32 v61, v34, v35
    v_exp_f32 v24, v24
    v_exp_f32 v25, v25
    v_exp_f32 v26, v26
    v_exp_f32 v27, v27
    v_cvt_pk_bf16_f32 v62, v24, v25
    v_cvt_pk_bf16_f32 v63, v26, v27
    v_exp_f32 v12, v12
    v_exp_f32 v13, v13
    v_exp_f32 v14, v14
    v_exp_f32 v15, v15
    v_cvt_pk_bf16_f32 v168, v12, v13
    v_cvt_pk_bf16_f32 v169, v14, v15
    v_exp_f32 v56, v56
    v_mov_b32_dpp v59, v7 quad_perm:[0,1,2,3] row_mask:0x4 bank_mask:0xf
    v_cvt_pk_bf16_f32 v170, v56, 0
    v_mfma_f32_16x16x32_bf16 v[44:47], v[220:223], v[60:63], 0
    s_waitcnt lgkmcnt(0)
    v_and_b32 v121, 0xffff0000, v120
    v_lshlrev_b32 v120, 16, v120
    v_mfma_f32_16x16x32_bf16 v[44:47], v[220:223], v[168:171], v[44:47]
    v_add_f32 v120, v120, v121
    v_add_f32 v120, v120, v211
    v_mfma_f32_16x16x32_bf16 v[12:15], v[0:3], v[60:63], 0
    s_nop 0
    v_mov_b32_dpp v59, v120 quad_perm:[0,1,2,3] row_mask:0x8 bank_mask:0xf
    v_mov_b32 v4, v59
    v_mfma_f32_16x16x32_bf16 v[12:15], v[164:167], v[168:171], v[12:15]
    s_nop 0
    v_max_f32_dpp v4, v4, v4 row_ror:8 row_mask:0xf bank_mask:0xf
    v_max3_f32 v121, v36, v37, v38
    v_mfma_f32_16x16x32_bf16 v[24:27], v[8:11], v[60:63], 0
    v_max_f32_dpp v4, v4, v4 row_ror:4 row_mask:0xf bank_mask:0xf
    v_max3_f32 v121, v121, v39, v52
    v_mfma_f32_16x16x32_bf16 v[24:27], v[160:163], v[168:171], v[24:27]
    v_max_f32_dpp v4, v4, v4 row_ror:2 row_mask:0xf bank_mask:0xf
    v_max3_f32 v121, v121, v53, v54
    v_mfma_f32_16x16x32_bf16 v[32:35], v[20:23], v[60:63], 0
    v_max_f32_dpp v4, v4, v4 row_ror:1 row_mask:0xf bank_mask:0xf
    v_mov_b32 v120, v4
    v_mfma_f32_16x16x32_bf16 v[32:35], v[156:159], v[168:171], v[32:35]
    s_nop 0
    v_permlane32_swap_b32 v120, v4
    v_max_f32 v4, v120, v4
    v_mov_b32 v120, v4
    v_rcp_f32 v44, v44
    v_max3_f32 v121, v121, v55, v48
    v_permlane16_swap_b32 v120, v4
    v_max_f32 v4, v120, v4
    v_sub_f32 v59, v59, v4
    v_exp_f32 v59, v59
    v_mul_f32 v12, v12, v44
    v_cvt_pk_bf16_f32 v59, v59, v59
    ds_write_b16 v123, v59 offset:64
    v_mul_f32 v13, v13, v44
    v_cvt_pk_bf16_f32 v68, v12, v13
    ds_read_b128 v[60:63], v132 offset:48
    v_mul_f32 v14, v14, v44
    v_mul_f32 v15, v15, v44
    v_cvt_pk_bf16_f32 v69, v14, v15
    ds_read_b128 v[56:59], v132 offset:64
    v_mfma_f32_16x16x32_f16 v[12:15], v[28:31], v[16:19], v[180:183]
    v_mul_f32 v24, v24, v44
    v_mul_f32 v25, v25, v44
    v_mfma_f32_16x16x32_f16 v[12:15], v[152:155], v[138:141], v[12:15]
    ds_write_b64 v135, v[68:69] offset:0
    v_mfma_f32_16x16x32_f16 v[28:31], v[72:75], v[16:19], v[176:179]
    v_cvt_pk_bf16_f32 v70, v24, v25
    v_mul_f32 v26, v26, v44
    v_mfma_f32_16x16x32_f16 v[28:31], v[146:149], v[138:141], v[28:31]
    v_mul_f32 v27, v27, v44
    v_cvt_pk_bf16_f32 v71, v26, v27
    v_mfma_f32_16x16x32_f16 v[24:27], v[64:67], v[16:19], v[172:175]
    ds_write_b64 v135, v[70:71] offset:8
    v_mfma_f32_16x16x32_f16 v[24:27], v[140:143], v[138:141], v[24:27]
    s_waitcnt lgkmcnt(3)
    v_mul_f32 v32, v32, v44
    v_mul_f32 v33, v33, v44
    v_cvt_pk_bf16_f32 v146, v32, v33
    v_mul_f32 v34, v34, v44
    v_mfma_f32_16x16x32_bf16 v[16:19], v[60:63], v[0:3], 0
    s_waitcnt lgkmcnt(2)
    v_mul_f32 v35, v35, v44
    v_cvt_pk_bf16_f32 v147, v34, v35
    v_max3_f32 v121, v121, v49, v50
    v_max3_f32 v121, v121, v51, v41
    v_mfma_f32_16x16x32_bf16 v[16:19], v[56:59], v[164:167], v[16:19]
    ds_write_b64 v134, v[146:147] offset:0
    v_mfma_f32_16x16x32_bf16 v[44:47], v[60:63], v[8:11], 0
    v_mov_b32 v146, v121
    v_max3_f32 v120, v12, v13, v14
    v_mfma_f32_16x16x32_bf16 v[44:47], v[56:59], v[160:163], v[44:47]
    v_permlane32_swap_b32 v146, v121
    v_mfma_f32_16x16x32_bf16 v[32:35], v[60:63], v[20:23], 0
    v_max_f32 v121, v146, v121
    v_mov_b32 v146, v121
    v_mfma_f32_16x16x32_bf16 v[32:35], v[56:59], v[156:159], v[32:35]
    s_nop 0
    v_permlane16_swap_b32 v146, v121
    v_max_f32 v121, v146, v121
    v_sub_f32 v36, v36, v121
    v_sub_f32 v37, v37, v121
    v_sub_f32 v38, v38, v121
    v_sub_f32 v39, v39, v121
    v_sub_f32 v52, v52, v121
    v_sub_f32 v53, v53, v121
    v_sub_f32 v54, v54, v121
    v_sub_f32 v55, v55, v121
    v_sub_f32 v48, v48, v121
    v_sub_f32 v49, v49, v121
    v_sub_f32 v50, v50, v121
    v_sub_f32 v51, v51, v121
    v_sub_f32 v41, v41, v121
    v_exp_f32 v36, v36
    v_exp_f32 v37, v37
    v_exp_f32 v38, v38
    v_exp_f32 v39, v39
    v_cvt_pk_bf16_f32 v36, v36, v37
    v_cvt_pk_bf16_f32 v37, v38, v39
    v_exp_f32 v52, v52
    v_exp_f32 v53, v53
    v_exp_f32 v54, v54
    v_exp_f32 v55, v55
    v_cvt_pk_bf16_f32 v38, v52, v53
    v_cvt_pk_bf16_f32 v39, v54, v55
    v_exp_f32 v48, v48
    v_exp_f32 v49, v49
    v_exp_f32 v50, v50
    v_exp_f32 v51, v51
    v_cvt_pk_bf16_f32 v168, v48, v49
    v_cvt_pk_bf16_f32 v169, v50, v51
    v_exp_f32 v41, v41
    v_mov_b32_dpp v19, v47 quad_perm:[0,1,2,3] row_mask:0x2 bank_mask:0xf
    v_cvt_pk_bf16_f32 v170, v41, 0
    v_mfma_f32_16x16x32_bf16 v[44:47], v[220:223], v[36:39], 0
    v_mov_b32_dpp v19, v35 quad_perm:[0,1,2,3] row_mask:0x4 bank_mask:0xf
    v_cvt_pk_bf16_f32 v19, v19, v19
    v_mfma_f32_16x16x32_bf16 v[44:47], v[220:223], v[168:171], v[44:47]
    ds_write_b16 v131, v19
    v_mfma_f32_16x16x32_bf16 v[32:35], v[0:3], v[36:39], 0
    ds_read_b128 v[16:19], v137 offset:0
    v_max3_f32 v120, v120, v15, v28
    v_mfma_f32_16x16x32_bf16 v[32:35], v[164:167], v[168:171], v[32:35]
    ds_read_b128 v[146:149], v136 offset:0
    v_max3_f32 v120, v120, v29, v30
    v_mfma_f32_16x16x32_bf16 v[48:51], v[8:11], v[36:39], 0
    ds_read_b128 v[72:75], v137 offset:128
    v_max3_f32 v120, v120, v31, v24
    v_mfma_f32_16x16x32_bf16 v[48:51], v[160:163], v[168:171], v[48:51]
    ds_read_b128 v[88:91], v136 offset:128
    v_max3_f32 v120, v120, v25, v26
    v_mfma_f32_16x16x32_bf16 v[40:43], v[20:23], v[36:39], 0
    ds_read_b128 v[76:79], v137 offset:256
    v_max3_f32 v120, v120, v27, v6
    v_mfma_f32_16x16x32_bf16 v[40:43], v[156:159], v[168:171], v[40:43]
    ds_read_b128 v[56:59], v136 offset:256
    v_mov_b32 v121, v120
    v_rcp_f32 v44, v44
    s_nop 0
    v_mul_f32 v32, v32, v44
    v_mul_f32 v33, v33, v44
    v_cvt_pk_bf16_f32 v32, v32, v33
    v_mul_f32 v34, v34, v44
    v_mul_f32 v35, v35, v44
    v_cvt_pk_bf16_f32 v33, v34, v35
    v_mul_f32 v48, v48, v44
    v_mul_f32 v49, v49, v44
    v_cvt_pk_bf16_f32 v34, v48, v49
    v_mul_f32 v50, v50, v44
    s_waitcnt lgkmcnt(5)
    v_mfma_f32_16x16x32_bf16 v[36:39], a[0:3], v[16:19], 0
    ds_write_b64 v135, v[32:33] offset:1536
    v_mul_f32 v51, v51, v44
    v_cvt_pk_bf16_f32 v35, v50, v51
    v_mul_f32 v40, v40, v44
    v_mul_f32 v41, v41, v44
    v_cvt_pk_bf16_f32 v4, v40, v41
    v_mul_f32 v42, v42, v44
    v_mul_f32 v43, v43, v44
    v_cvt_pk_bf16_f32 v5, v42, v43
    ds_write_b64 v135, v[34:35] offset:1544
    v_permlane32_swap_b32 v121, v120
    v_max_f32 v120, v121, v120
    v_mov_b32 v121, v120
    s_nop 0
    ds_write_b64 v134, v[4:5] offset:1536
    v_permlane16_swap_b32 v121, v120
    v_max_f32 v120, v121, v120
    v_sub_f32 v12, v12, v120
    v_sub_f32 v13, v13, v120
    v_sub_f32 v14, v14, v120
    v_sub_f32 v15, v15, v120
    v_sub_f32 v28, v28, v120
    v_sub_f32 v29, v29, v120
    v_sub_f32 v30, v30, v120
    v_sub_f32 v31, v31, v120
    v_sub_f32 v24, v24, v120
    v_sub_f32 v25, v25, v120
    v_sub_f32 v26, v26, v120
    v_sub_f32 v27, v27, v120
    v_sub_f32 v6, v6, v120
    v_exp_f32 v12, v12
    v_exp_f32 v13, v13
    v_exp_f32 v14, v14
    v_exp_f32 v15, v15
    v_cvt_pk_bf16_f32 v12, v12, v13
    v_cvt_pk_bf16_f32 v13, v14, v15
    v_exp_f32 v28, v28
    v_exp_f32 v29, v29
    v_exp_f32 v30, v30
    v_exp_f32 v31, v31
    v_cvt_pk_bf16_f32 v14, v28, v29
    v_cvt_pk_bf16_f32 v15, v30, v31
    v_exp_f32 v24, v24
    v_exp_f32 v25, v25
    v_exp_f32 v26, v26
    v_exp_f32 v27, v27
    v_cvt_pk_bf16_f32 v168, v24, v25
    v_cvt_pk_bf16_f32 v169, v26, v27
    v_exp_f32 v6, v6
    s_nop 0
    v_cvt_pk_bf16_f32 v170, v6, 0
    v_mfma_f32_16x16x32_bf16 v[152:155], v[220:223], v[12:15], 0
    s_nop 0
    v_mfma_f32_16x16x32_bf16 v[152:155], v[220:223], v[168:171], v[152:155]
    s_nop 1
    v_mfma_f32_16x16x32_bf16 v[4:7], v[0:3], v[12:15], 0
    s_nop 2
    v_mfma_f32_16x16x32_bf16 v[4:7], v[164:167], v[168:171], v[4:7]
    s_nop 0
    v_rcp_f32 v152, v152
    v_mfma_f32_16x16x32_bf16 v[0:3], v[8:11], v[12:15], 0
    s_nop 2
    v_mfma_f32_16x16x32_bf16 v[0:3], v[160:163], v[168:171], v[0:3]
    s_nop 0
    v_mul_f32 v4, v4, v152
    v_mul_f32 v5, v5, v152
    v_mfma_f32_16x16x32_bf16 v[8:11], v[20:23], v[12:15], 0
    v_cvt_pk_bf16_f32 v12, v4, v5
    v_mul_f32 v6, v6, v152
    v_mfma_f32_16x16x32_bf16 v[8:11], v[156:159], v[168:171], v[8:11]
    v_mul_f32 v7, v7, v152
    v_cvt_pk_bf16_f32 v13, v6, v7
    s_waitcnt lgkmcnt(0)
.p2align 6
L_loopS0:
    v_mfma_f32_16x16x32_bf16 v[36:39], a[4:7], v[146:149], v[36:39]
    ds_write_b64 v135, v[12:13] offset:3072
    v_mfma_f32_16x16x32_bf16 v[36:39], a[8:11], v[72:75], v[36:39]
    v_mul_f32 v0, v0, v152
    v_mul_f32 v1, v1, v152
    v_mfma_f32_16x16x32_bf16 v[36:39], a[12:15], v[88:91], v[36:39]
    v_cvt_pk_bf16_f32 v14, v0, v1
    v_mul_f32 v2, v2, v152
    v_mfma_f32_16x16x32_bf16 v[36:39], a[16:19], v[76:79], v[36:39]
    v_mul_f32 v3, v3, v152
    v_cvt_pk_bf16_f32 v15, v2, v3
    v_mfma_f32_16x16x32_bf16 v[36:39], a[20:23], v[56:59], v[36:39]
    ds_write_b64 v135, v[14:15] offset:3080
    v_mfma_f32_16x16x32_bf16 v[12:15], a[24:27], v[16:19], 0
    v_mul_f32 v8, v8, v152
    v_mul_f32 v9, v9, v152
    v_mfma_f32_16x16x32_bf16 v[12:15], a[28:31], v[146:149], v[12:15]
    v_cvt_pk_bf16_f32 v8, v8, v9
    v_mul_f32 v10, v10, v152
    v_mfma_f32_16x16x32_bf16 v[12:15], a[32:35], v[72:75], v[12:15]
    v_mul_f32 v11, v11, v152
    v_cvt_pk_bf16_f32 v9, v10, v11
    v_mfma_f32_16x16x32_bf16 v[12:15], a[36:39], v[88:91], v[12:15]
    ds_write_b64 v134, v[8:9] offset:3072
    v_mfma_f32_16x16x32_bf16 v[12:15], a[40:43], v[76:79], v[12:15]
    v_fma_f32 v170, v40, v40, s42
    v_fmac_f32 v170, v41, v41
    v_mfma_f32_16x16x32_bf16 v[12:15], a[44:47], v[56:59], v[12:15]
    v_fmac_f32 v170, v42, v42
    v_fmac_f32 v170, v43, v43
    v_mfma_f32_16x16x32_bf16 v[152:155], a[48:51], v[16:19], 0
    v_fmac_f32 v170, v140, v140
    v_fmac_f32 v170, v141, v141
    v_mfma_f32_16x16x32_bf16 v[152:155], a[52:55], v[146:149], v[152:155]
    v_fmac_f32 v170, v142, v142
    v_fmac_f32 v170, v143, v143
    v_mfma_f32_16x16x32_bf16 v[152:155], a[56:59], v[72:75], v[152:155]
    s_waitcnt vmcnt(10)
    v_fmac_f32 v170, v44, v44
    v_fmac_f32 v170, v45, v45
    v_mfma_f32_16x16x32_bf16 v[152:155], a[60:63], v[88:91], v[152:155]
    v_fmac_f32 v170, v46, v46
    v_fmac_f32 v170, v47, v47
    v_mfma_f32_16x16x32_bf16 v[152:155], a[64:67], v[76:79], v[152:155]
    v_cvt_pk_bf16_f32 v0, v92, v93
    v_cvt_pk_bf16_f32 v1, v170, v122
    v_mfma_f32_16x16x32_bf16 v[152:155], a[68:71], v[56:59], v[152:155]
    ds_write_b64 v130, v[0:1]
    v_mfma_f32_16x16x32_bf16 v[60:63], a[72:75], v[16:19], 0
    v_add_u32 v135, s49, v135
    v_add_u32 v134, s49, v134
    v_mfma_f32_16x16x32_bf16 v[60:63], a[76:79], v[146:149], v[60:63]
    v_fma_f32 v170, v36, v36, s41
    v_fmac_f32 v170, v37, v37
    v_mfma_f32_16x16x32_bf16 v[60:63], a[80:83], v[72:75], v[60:63]
    v_fmac_f32 v170, v38, v38
    v_fmac_f32 v170, v39, v39
    v_mfma_f32_16x16x32_bf16 v[60:63], a[84:87], v[88:91], v[60:63]
    v_fmac_f32 v170, v12, v12
    v_fmac_f32 v170, v13, v13
    v_mfma_f32_16x16x32_bf16 v[60:63], a[88:91], v[76:79], v[60:63]
    v_fmac_f32 v170, v14, v14
    v_fmac_f32 v170, v15, v15
    v_mfma_f32_16x16x32_bf16 v[60:63], a[92:95], v[56:59], v[60:63]
    v_fmac_f32 v170, v152, v152
    v_fmac_f32 v170, v153, v153
    v_mfma_f32_16x16x32_bf16 v[92:95], a[96:99], v[16:19], 0
    v_fmac_f32 v170, v154, v154
    v_fmac_f32 v170, v155, v155
    v_mfma_f32_16x16x32_bf16 v[92:95], a[100:103], v[146:149], v[92:95]
    s_waitcnt lgkmcnt(0)
    s_nop 0
    v_fma_f32 v0, v60, v60, s41
    v_fmac_f32 v0, v61, v61
    v_mfma_f32_16x16x32_bf16 v[92:95], a[104:107], v[72:75], v[92:95]
    s_barrier
    ds_read_b128 v[8:11], v129 offset:0
    v_fmac_f32 v0, v62, v62
    v_mfma_f32_16x16x32_bf16 v[92:95], a[108:111], v[88:91], v[92:95]
    ds_read_b128 v[64:67], v129 offset:1024
    v_fmac_f32 v0, v63, v63
    v_mfma_f32_16x16x32_bf16 v[92:95], a[112:115], v[76:79], v[92:95]
    v_mfma_f32_16x16x32_bf16 v[92:95], a[116:119], v[56:59], v[92:95]
    s_nop 1
    v_mfma_f32_16x16x32_bf16 v[80:83], a[120:123], v[16:19], 0
    s_nop 2
    v_mfma_f32_16x16x32_bf16 v[80:83], a[124:127], v[146:149], v[80:83]
    s_nop 0
    v_fmac_f32 v0, v92, v92
    v_fmac_f32 v0, v93, v93
    v_mfma_f32_16x16x32_bf16 v[80:83], a[128:131], v[72:75], v[80:83]
    v_fmac_f32 v0, v94, v94
    v_fmac_f32 v0, v95, v95
    v_mfma_f32_16x16x32_bf16 v[80:83], a[132:135], v[88:91], v[80:83]
    v_mfma_f32_16x16x32_bf16 v[80:83], a[136:139], v[76:79], v[80:83]
    v_mfma_f32_16x16x32_bf16 v[80:83], a[140:143], v[56:59], v[80:83]
    s_waitcnt lgkmcnt(1)
    v_readfirstlane_b32 s12, v9
    v_mfma_f32_16x16x32_bf16 v[84:87], v[216:219], v[8:11], 0
    s_waitcnt lgkmcnt(0)
    s_nop 1
    v_mfma_f32_16x16x32_bf16 v[84:87], v[216:219], v[64:67], v[84:87]
    s_lshr_b32 s12, s12, 23
    v_fmac_f32 v0, v80, v80
    v_fmac_f32 v0, v81, v81
    v_mfma_f32_16x16x32_bf16 v[8:11], v[16:19], a[144:147], 0
    v_fmac_f32 v0, v82, v82
    v_fmac_f32 v0, v83, v83
    v_mfma_f32_16x16x32_bf16 v[8:11], v[146:149], a[148:151], v[8:11]
    s_nop 0
    v_rsq_f32 v84, v84
    v_mfma_f32_16x16x32_bf16 v[8:11], v[72:75], a[152:155], v[8:11]
    v_rsq_f32 v85, v85
    v_mfma_f32_16x16x32_bf16 v[8:11], v[88:91], a[156:159], v[8:11]
    v_rsq_f32 v86, v86
    v_mfma_f32_16x16x32_bf16 v[8:11], v[76:79], a[160:163], v[8:11]
    ds_read_b128 v[64:67], v137 offset:1536
    v_mul_f32 v84, s43, v84
    v_mfma_f32_16x16x32_bf16 v[8:11], v[56:59], a[164:167], v[8:11]
    ds_read_b128 v[68:71], v136 offset:1536
    v_mul_f32 v85, s43, v85
    v_mfma_f32_16x16x32_bf16 v[48:51], v[16:19], a[168:171], 0
    ds_read_b128 v[52:55], v137 offset:1664
    v_mul_f32 v86, s43, v86
    v_mfma_f32_16x16x32_bf16 v[48:51], v[146:149], a[172:175], v[48:51]
    ds_read_b128 v[96:99], v136 offset:1664
    v_cvt_pk_bf16_f32 v170, v170, v0
    v_mfma_f32_16x16x32_bf16 v[48:51], v[72:75], a[176:179], v[48:51]
    ds_read_b128 v[108:111], v137 offset:1792
    v_cvt_pk_bf16_f32 v0, v8, v9
    v_mfma_f32_16x16x32_bf16 v[48:51], v[88:91], a[180:183], v[48:51]
    ds_read_b128 v[104:107], v136 offset:1792
    v_cvt_pk_bf16_f32 v1, v10, v11
    v_mfma_f32_16x16x32_bf16 v[48:51], v[76:79], a[184:187], v[48:51]
    v_mul_f32 v32, v32, v84
    v_mul_f32 v33, v33, v84
    v_mfma_f32_16x16x32_bf16 v[48:51], v[56:59], a[188:191], v[48:51]
    s_nop 0
    v_cvt_pk_bf16_f32 v2, v32, v33
    v_mul_f32 v34, v34, v84
    v_mfma_f32_16x16x16_bf16 v[118:121], v[216:217], v[170:171], 0
    s_nop 0
    v_mul_f32 v35, v35, v84
    v_cvt_pk_bf16_f32 v3, v34, v35
    v_mul_f32 v4, v4, v84
    v_cvt_pk_bf16_f32 v8, v48, v49
    v_mfma_f32_16x16x32_bf16 v[32:35], v[16:19], a[192:195], 0
    ds_write_b64 v135, v[2:3] offset:0
    v_mfma_f32_16x16x32_bf16 v[32:35], v[146:149], a[196:199], v[32:35]
    v_rsq_f32 v118, v118
    v_mfma_f32_16x16x32_bf16 v[32:35], v[72:75], a[200:203], v[32:35]
    v_rsq_f32 v119, v119
    v_mfma_f32_16x16x32_bf16 v[32:35], v[88:91], a[204:207], v[32:35]
    v_mul_f32 v118, s55, v118
    v_mul_f32 v119, 0.5, v119
    v_mfma_f32_16x16x32_bf16 v[32:35], v[76:79], a[208:211], v[32:35]
    v_cvt_pk_bf16_f32 v9, v50, v51
    v_mul_f32 v36, v36, v118
    v_mfma_f32_16x16x32_bf16 v[32:35], v[56:59], a[212:215], v[32:35]
    s_waitcnt lgkmcnt(1)
    v_mul_f32 v37, v37, v118
    v_cvt_pk_f16_f32 v76, v36, v37
    v_mfma_f32_16x16x32_bf16 v[146:149], a[0:3], v[64:67], 0
    v_mul_f32 v38, v38, v118
    v_mul_f32 v39, v39, v118
    v_mfma_f32_16x16x32_bf16 v[146:149], a[4:7], v[68:71], v[146:149]
    v_cvt_pk_f16_f32 v77, v38, v39
    v_mul_f32 v12, v12, v118
    v_mfma_f32_16x16x32_bf16 v[146:149], a[8:11], v[52:55], v[146:149]
    v_mul_f32 v13, v13, v118
    v_cvt_pk_f16_f32 v78, v12, v13
    v_mfma_f32_16x16x32_bf16 v[146:149], a[12:15], v[96:99], v[146:149]
    v_mul_f32 v14, v14, v118
    v_mul_f32 v15, v15, v118
    v_mfma_f32_16x16x32_bf16 v[146:149], a[16:19], v[108:111], v[146:149]
    v_cvt_pk_f16_f32 v79, v14, v15
    v_mul_f32 v152, v152, v118
    v_mfma_f32_16x16x32_bf16 v[146:149], a[20:23], v[104:107], v[146:149]
    v_mul_f32 v153, v153, v118
    v_cvt_pk_f16_f32 v152, v152, v153
    v_mfma_f32_16x16x32_bf16 v[36:39], a[24:27], v[64:67], 0
    v_mul_f32 v154, v154, v118
    v_mul_f32 v155, v155, v118
    v_mfma_f32_16x16x32_bf16 v[36:39], a[28:31], v[68:71], v[36:39]
    v_cvt_pk_f16_f32 v153, v154, v155
    v_mul_f32 v60, v60, v119
    v_mfma_f32_16x16x32_bf16 v[36:39], a[32:35], v[52:55], v[36:39]
    v_mul_f32 v61, v61, v119
    v_cvt_pk_f16_f32 v16, v60, v61
    v_mfma_f32_16x16x32_bf16 v[36:39], a[36:39], v[96:99], v[36:39]
    v_mul_f32 v62, v62, v119
    v_mul_f32 v63, v63, v119
    v_mfma_f32_16x16x32_bf16 v[36:39], a[40:43], v[108:111], v[36:39]
    v_cvt_pk_f16_f32 v17, v62, v63
    v_mul_f32 v92, v92, v119
    v_mfma_f32_16x16x32_bf16 v[36:39], a[44:47], v[104:107], v[36:39]
    v_mul_f32 v93, v93, v119
    v_cvt_pk_f16_f32 v18, v92, v93
    v_mfma_f32_16x16x32_bf16 v[72:75], a[48:51], v[64:67], 0
    v_mul_f32 v94, v94, v119
    v_mul_f32 v95, v95, v119
    v_mfma_f32_16x16x32_bf16 v[72:75], a[52:55], v[68:71], v[72:75]
    v_cvt_pk_f16_f32 v19, v94, v95
    v_mul_f32 v80, v80, v119
    v_mfma_f32_16x16x32_bf16 v[72:75], a[56:59], v[52:55], v[72:75]
    v_mul_f32 v81, v81, v119
    v_cvt_pk_f16_f32 v154, v80, v81
    v_mfma_f32_16x16x32_bf16 v[72:75], a[60:63], v[96:99], v[72:75]
    v_mul_f32 v82, v82, v119
    v_mul_f32 v83, v83, v119
    v_mfma_f32_16x16x32_bf16 v[72:75], a[64:67], v[108:111], v[72:75]
    v_cvt_pk_f16_f32 v155, v82, v83
    v_cvt_pk_bf16_f32 v12, v32, v33
    v_mfma_f32_16x16x32_bf16 v[72:75], a[68:71], v[104:107], v[72:75]
    v_cvt_pk_bf16_f32 v13, v34, v35
    v_mul_f32 v5, v5, v84
    v_mfma_f32_16x16x32_bf16 v[32:35], a[72:75], v[64:67], 0
    v_cvt_pk_bf16_f32 v4, v4, v5
    v_mul_f32 v6, v6, v84
    v_mfma_f32_16x16x32_bf16 v[32:35], a[76:79], v[68:71], v[32:35]
    v_mul_f32 v7, v7, v84
    v_cvt_pk_bf16_f32 v5, v6, v7
    v_mfma_f32_16x16x32_bf16 v[32:35], a[80:83], v[52:55], v[32:35]
    ds_write_b64 v135, v[4:5] offset:8
    v_mfma_f32_16x16x32_bf16 v[32:35], a[84:87], v[96:99], v[32:35]
    v_mul_f32 v24, v24, v84
    v_mul_f32 v25, v25, v84
    v_mfma_f32_16x16x32_bf16 v[32:35], a[88:91], v[108:111], v[32:35]
    v_cvt_pk_bf16_f32 v2, v24, v25
    v_mul_f32 v26, v26, v84
    v_mfma_f32_16x16x32_bf16 v[32:35], a[92:95], v[104:107], v[32:35]
    v_mul_f32 v27, v27, v84
    v_cvt_pk_bf16_f32 v3, v26, v27
    v_mfma_f32_16x16x32_bf16 v[4:7], a[96:99], v[64:67], 0
    ds_write_b64 v134, v[2:3] offset:0
    v_mfma_f32_16x16x32_bf16 v[4:7], a[100:103], v[68:71], v[4:7]
    v_fma_f32 v2, v146, v146, s41
    v_fmac_f32 v2, v147, v147
    v_mfma_f32_16x16x32_bf16 v[4:7], a[104:107], v[52:55], v[4:7]
    v_fmac_f32 v2, v148, v148
    v_fmac_f32 v2, v149, v149
    v_mfma_f32_16x16x32_bf16 v[4:7], a[108:111], v[96:99], v[4:7]
    v_fmac_f32 v2, v36, v36
    v_fmac_f32 v2, v37, v37
    v_mfma_f32_16x16x32_bf16 v[4:7], a[112:115], v[108:111], v[4:7]
    v_fmac_f32 v2, v38, v38
    v_fmac_f32 v2, v39, v39
    v_mfma_f32_16x16x32_bf16 v[4:7], a[116:119], v[104:107], v[4:7]
    v_fmac_f32 v2, v72, v72
    v_fmac_f32 v2, v73, v73
    v_mfma_f32_16x16x32_bf16 v[24:27], a[120:123], v[64:67], 0
    v_fmac_f32 v2, v74, v74
    v_fmac_f32 v2, v75, v75
    v_mfma_f32_16x16x32_bf16 v[24:27], a[124:127], v[68:71], v[24:27]
    v_mul_f32 v28, v28, v85
    v_mul_f32 v29, v29, v85
    v_mfma_f32_16x16x32_bf16 v[24:27], a[128:131], v[52:55], v[24:27]
    v_cvt_pk_bf16_f32 v88, v28, v29
    v_mul_f32 v30, v30, v85
    v_mfma_f32_16x16x32_bf16 v[24:27], a[132:135], v[96:99], v[24:27]
    v_mul_f32 v31, v31, v85
    v_cvt_pk_bf16_f32 v89, v30, v31
    v_mfma_f32_16x16x32_bf16 v[24:27], a[136:139], v[108:111], v[24:27]
    ds_write_b64 v135, v[88:89] offset:1536
    v_mfma_f32_16x16x32_bf16 v[24:27], a[140:143], v[104:107], v[24:27]
    v_mul_f32 v20, v20, v85
    v_mul_f32 v21, v21, v85
    v_mfma_f32_16x16x32_bf16 v[60:63], v[64:67], a[144:147], 0
    v_cvt_pk_bf16_f32 v90, v20, v21
    v_mul_f32 v22, v22, v85
    v_mfma_f32_16x16x32_bf16 v[60:63], v[68:71], a[148:151], v[60:63]
    v_mul_f32 v23, v23, v85
    v_cvt_pk_bf16_f32 v91, v22, v23
    v_mfma_f32_16x16x32_bf16 v[60:63], v[52:55], a[152:155], v[60:63]
    ds_write_b64 v135, v[90:91] offset:1544
    v_mfma_f32_16x16x32_bf16 v[60:63], v[96:99], a[156:159], v[60:63]
    v_mul_f32 v114, v114, v85
    v_mul_f32 v115, v115, v85
    v_mfma_f32_16x16x32_bf16 v[60:63], v[108:111], a[160:163], v[60:63]
    ds_read_b128 v[88:91], v137 offset:3072
    v_cvt_pk_bf16_f32 v10, v114, v115
    v_mfma_f32_16x16x32_bf16 v[60:63], v[104:107], a[164:167], v[60:63]
    ds_read_b128 v[56:59], v136 offset:3072
    v_mul_f32 v116, v116, v85
    v_mfma_f32_16x16x32_bf16 v[92:95], v[64:67], a[168:171], 0
    ds_read_b128 v[80:83], v137 offset:3200
    v_mul_f32 v117, v117, v85
    v_mfma_f32_16x16x32_bf16 v[92:95], v[68:71], a[172:175], v[92:95]
    ds_read_b128 v[28:31], v136 offset:3200
    v_cvt_pk_bf16_f32 v11, v116, v117
    v_mfma_f32_16x16x32_bf16 v[92:95], v[52:55], a[176:179], v[92:95]
    ds_write_b64 v134, v[10:11] offset:1536
    v_mfma_f32_16x16x32_bf16 v[92:95], v[96:99], a[180:183], v[92:95]
    v_fma_f32 v3, v32, v32, s41
    v_fmac_f32 v3, v33, v33
    v_mfma_f32_16x16x32_bf16 v[92:95], v[108:111], a[184:187], v[92:95]
    ds_read_b128 v[48:51], v137 offset:3328
    v_fmac_f32 v3, v34, v34
    v_mfma_f32_16x16x32_bf16 v[92:95], v[104:107], a[188:191], v[92:95]
    ds_read_b128 v[20:23], v136 offset:3328
    v_fmac_f32 v3, v35, v35
    v_mfma_f32_16x16x32_bf16 v[112:115], v[64:67], a[192:195], 0
    v_fmac_f32 v3, v4, v4
    v_fmac_f32 v3, v5, v5
    v_mfma_f32_16x16x32_bf16 v[112:115], v[68:71], a[196:199], v[112:115]
    s_sub_u32 s50, s45, s44
    v_fmac_f32 v3, v6, v6
    v_fmac_f32 v3, v7, v7
    v_mfma_f32_16x16x32_bf16 v[112:115], v[52:55], a[200:203], v[112:115]
    s_sub_u32 s51, s46, s47
    v_fmac_f32 v3, v24, v24
    v_fmac_f32 v3, v25, v25
    v_mfma_f32_16x16x32_bf16 v[112:115], v[96:99], a[204:207], v[112:115]
    s_mov_b32 s60, s59
    v_fmac_f32 v3, v26, v26
    v_fmac_f32 v3, v27, v27
    v_mfma_f32_16x16x32_bf16 v[112:115], v[108:111], a[208:211], v[112:115]
    s_mov_b32 s59, s58
    v_cvt_pk_bf16_f32 v170, v2, v3
    v_cvt_pk_bf16_f32 v2, v60, v61
    v_mfma_f32_16x16x32_bf16 v[112:115], v[104:107], a[212:215], v[112:115]
    s_mov_b32 s58, s57
    v_cvt_pk_bf16_f32 v3, v62, v63
    v_cvt_pk_bf16_f32 v10, v92, v93
    v_mfma_f32_16x16x16_bf16 v[60:63], v[216:217], v[170:171], 0
    s_waitcnt lgkmcnt(2)
    s_mov_b32 s57, s56
    v_cvt_pk_bf16_f32 v11, v94, v95
    v_mul_f32 v40, v40, v86
    v_mul_f32 v41, v41, v86
    v_cvt_pk_bf16_f32 v14, v112, v113
    v_mfma_f32_16x16x32_bf16 v[92:95], a[0:3], v[88:91], 0
    s_mov_b32 s7, s6
    v_cvt_pk_bf16_f32 v15, v114, v115
    v_cvt_pk_bf16_f32 v40, v40, v41
    v_mfma_f32_16x16x32_bf16 v[92:95], a[4:7], v[56:59], v[92:95]
    s_mov_b32 s6, s5
    v_rsq_f32 v60, v60
    v_mfma_f32_16x16x32_bf16 v[92:95], a[8:11], v[80:83], v[92:95]
    s_mov_b32 s5, s4
    v_rsq_f32 v61, v61
    v_mfma_f32_16x16x32_bf16 v[92:95], a[12:15], v[28:31], v[92:95]
    s_waitcnt lgkmcnt(0)
    s_sub_u32 s14, s6, s7
    v_mul_f32 v60, s55, v60
    v_mul_f32 v61, 0.5, v61
    v_mfma_f32_16x16x32_bf16 v[92:95], a[16:19], v[48:51], v[92:95]
    s_add_u32 s61, s61, 1
    v_mul_f32 v146, v146, v60
    v_mul_f32 v147, v147, v60
    v_mfma_f32_16x16x32_bf16 v[92:95], a[20:23], v[20:23], v[92:95]
    s_ff1_i32_b32 s15, s66
    v_cvt_pk_f16_f32 v96, v146, v147
    v_mul_f32 v148, v148, v60
    v_mfma_f32_16x16x32_bf16 v[64:67], a[24:27], v[88:91], 0
    s_cmp_lg_u32 s66, 0
    v_mul_f32 v149, v149, v60
    v_cvt_pk_f16_f32 v97, v148, v149
    v_mfma_f32_16x16x32_bf16 v[64:67], a[28:31], v[56:59], v[64:67]
    s_cselect_b32 s12, s15, s12
    v_mul_f32 v36, v36, v60
    v_mul_f32 v37, v37, v60
    v_mfma_f32_16x16x32_bf16 v[64:67], a[32:35], v[80:83], v[64:67]
    s_cmp_lt_u32 s61, s71
    v_cvt_pk_f16_f32 v98, v36, v37
    v_mul_f32 v38, v38, v60
    v_mfma_f32_16x16x32_bf16 v[64:67], a[36:39], v[28:31], v[64:67]
    s_cselect_b32 s15, 31, s15
    v_mul_f32 v39, v39, v60
    v_cvt_pk_f16_f32 v99, v38, v39
    v_mfma_f32_16x16x32_bf16 v[64:67], a[40:43], v[48:51], v[64:67]
    s_bitset0_b32 s66, s15
    v_mul_f32 v72, v72, v60
    v_mul_f32 v73, v73, v60
    v_mfma_f32_16x16x32_bf16 v[64:67], a[44:47], v[20:23], v[64:67]
    s_add_u32 s12, s12, 20
    v_cvt_pk_f16_f32 v146, v72, v73
    v_mul_f32 v74, v74, v60
    v_mfma_f32_16x16x32_bf16 v[68:71], a[48:51], v[88:91], 0
    s_max_u32 s12, s12, s61
    v_mul_f32 v75, v75, v60
    v_cvt_pk_f16_f32 v147, v74, v75
    v_mfma_f32_16x16x32_bf16 v[68:71], a[52:55], v[56:59], v[68:71]
    s_cmp_lt_u32 s61, s71
    v_mul_f32 v32, v32, v61
    v_mul_f32 v33, v33, v61
    v_mfma_f32_16x16x32_bf16 v[68:71], a[56:59], v[80:83], v[68:71]
    s_cselect_b32 s15, s61, s12
    v_cvt_pk_f16_f32 v36, v32, v33
    v_mul_f32 v34, v34, v61
    v_mfma_f32_16x16x32_bf16 v[68:71], a[60:63], v[28:31], v[68:71]
    s_cselect_b32 s56, s69, s70
    v_mul_f32 v35, v35, v61
    v_cvt_pk_f16_f32 v37, v34, v35
    v_mfma_f32_16x16x32_bf16 v[68:71], a[64:67], v[48:51], v[68:71]
    s_add_u32 s56, s56, s15
    v_mul_f32 v4, v4, v61
    v_mul_f32 v5, v5, v61
    v_mfma_f32_16x16x32_bf16 v[68:71], a[68:71], v[20:23], v[68:71]
    s_mul_i32 s53, s56, 58255
    v_cvt_pk_f16_f32 v38, v4, v5
    v_mul_f32 v6, v6, v61
    v_mfma_f32_16x16x32_bf16 v[72:75], a[72:75], v[88:91], 0
    s_lshr_b32 s53, s53, 22
    v_mul_f32 v7, v7, v61
    v_cvt_pk_f16_f32 v39, v6, v7
    v_mfma_f32_16x16x32_bf16 v[72:75], a[76:79], v[56:59], v[72:75]
    s_mul_i32 s53, s53, s63
    v_mul_f32 v24, v24, v61
    v_mul_f32 v25, v25, v61
    v_mfma_f32_16x16x32_bf16 v[72:75], a[80:83], v[80:83], v[72:75]
    s_mul_i32 s56, s56, s62
    v_cvt_pk_f16_f32 v148, v24, v25
    v_mul_f32 v26, v26, v61
    v_mfma_f32_16x16x32_bf16 v[72:75], a[84:87], v[28:31], v[72:75]
    s_add_u32 s56, s56, s53
    v_mul_f32 v27, v27, v61
    v_cvt_pk_f16_f32 v149, v26, v27
    v_mfma_f32_16x16x32_bf16 v[72:75], a[88:91], v[48:51], v[72:75]
    s_mul_i32 s4, s15, 112
    v_mul_f32 v42, v42, v86
    v_mul_f32 v43, v43, v86
    v_mfma_f32_16x16x32_bf16 v[72:75], a[92:95], v[20:23], v[72:75]
    s_cmp_ge_u32 s15, 16
    v_cvt_pk_bf16_f32 v41, v42, v43
    v_mul_f32 v140, v140, v86
    v_mfma_f32_16x16x32_bf16 v[4:7], a[96:99], v[88:91], 0
    s_cselect_b32 s53, -30464, 0
    ds_write_b64 v135, v[40:41] offset:3072
    v_mfma_f32_16x16x32_bf16 v[4:7], a[100:103], v[56:59], v[4:7]
    s_add_u32 s4, s4, s53
    v_mul_f32 v141, v141, v86
    v_cvt_pk_bf16_f32 v42, v140, v141
    v_mfma_f32_16x16x32_bf16 v[4:7], a[104:107], v[80:83], v[4:7]
    s_cmp_lt_u32 s15, s73
    v_mul_f32 v142, v142, v86
    v_mul_f32 v143, v143, v86
    v_mfma_f32_16x16x32_bf16 v[4:7], a[108:111], v[28:31], v[4:7]
    s_cselect_b32 s26, 100270464, 0
    v_cvt_pk_bf16_f32 v43, v142, v143
    v_mul_f32 v44, v44, v86
    v_mfma_f32_16x16x32_bf16 v[4:7], a[112:115], v[48:51], v[4:7]
    s_cselect_b32 s56, s56, 0
    ds_write_b64 v135, v[42:43] offset:3080
    v_mfma_f32_16x16x32_bf16 v[4:7], a[116:119], v[20:23], v[4:7]
    s_cselect_b32 s4, s4, -1
    v_mul_f32 v45, v45, v86
    v_cvt_pk_bf16_f32 v44, v44, v45
    v_mul_f32 v46, v46, v86
    v_mul_f32 v47, v47, v86
    v_cvt_pk_bf16_f32 v45, v46, v47
    s_cselect_b32 s15, s15, 0
    s_cselect_b32 s13, s13, -1
    ds_write_b64 v134, v[44:45] offset:3072
    v_fma_f32 v120, v92, v92, s41
    v_fmac_f32 v120, v93, v93
    v_fmac_f32 v120, v94, v94
    v_fmac_f32 v120, v95, v95
    v_mfma_f32_16x16x32_bf16 v[24:27], a[120:123], v[88:91], 0
    s_waitcnt vmcnt(0)
    v_fmac_f32 v120, v64, v64
    v_fmac_f32 v120, v65, v65
    v_mfma_f32_16x16x32_bf16 v[24:27], a[124:127], v[56:59], v[24:27]
    s_bitset1_b32 s64, s15
    v_fmac_f32 v120, v66, v66
    v_fmac_f32 v120, v67, v67
    v_mfma_f32_16x16x32_bf16 v[24:27], a[128:131], v[80:83], v[24:27]
    s_add_u32 s65, s65, 1
    v_fmac_f32 v120, v68, v68
    v_fmac_f32 v120, v69, v69
    v_mfma_f32_16x16x32_bf16 v[24:27], a[132:135], v[28:31], v[24:27]
    s_cmp_ge_i32 s65, 2
    v_fmac_f32 v120, v70, v70
    v_fmac_f32 v120, v71, v71
    v_mfma_f32_16x16x32_bf16 v[24:27], a[136:139], v[48:51], v[24:27]
    s_cselect_b32 s30, 100270464, 0
    v_fma_f32 v121, v72, v72, s41
    v_fmac_f32 v121, v73, v73
    v_mfma_f32_16x16x32_bf16 v[24:27], a[140:143], v[20:23], v[24:27]
    s_add_u32 s67, s46, s54
    v_fmac_f32 v121, v74, v74
    v_fmac_f32 v121, v75, v75
    v_mfma_f32_16x16x32_bf16 v[32:35], v[88:91], a[144:147], 0
    s_waitcnt lgkmcnt(0)
    s_add_u32 m0, s67, 0
    v_fmac_f32 v121, v4, v4
    v_fmac_f32 v121, v5, v5
    v_mfma_f32_16x16x32_bf16 v[32:35], v[56:59], a[148:151], v[32:35]
    s_barrier
    v_fmac_f32 v121, v6, v6
    v_fmac_f32 v121, v7, v7
    v_mfma_f32_16x16x32_bf16 v[32:35], v[80:83], a[152:155], v[32:35]
    s_cmp_ge_u32 s61, s13
    v_fmac_f32 v121, v24, v24
    v_fmac_f32 v121, v25, v25
    v_mfma_f32_16x16x32_bf16 v[32:35], v[28:31], a[156:159], v[32:35]
    s_cbranch_scc1 L_atomS0
L_atomS0r:
    v_mfma_f32_16x16x32_bf16 v[32:35], v[48:51], a[160:163], v[32:35]
    v_fmac_f32 v121, v26, v26
    v_fmac_f32 v121, v27, v27
    v_mfma_f32_16x16x32_bf16 v[32:35], v[20:23], a[164:167], v[32:35]
    v_cvt_pk_bf16_f32 v170, v120, v121
    v_add_u32 v137, s50, v137
    v_mfma_f32_16x16x32_bf16 v[40:43], v[88:91], a[168:171], 0
    ds_read_b128 v[60:63], v137 offset:0
    v_add_u32 v136, s50, v136
    v_mfma_f32_16x16x32_bf16 v[40:43], v[56:59], a[172:175], v[40:43]
    s_nop 0
    ds_read_b128 v[84:87], v136 offset:0
    v_cvt_pk_bf16_f32 v164, v32, v33
    v_mfma_f32_16x16x32_bf16 v[40:43], v[80:83], a[176:179], v[40:43]
    ds_read_b128 v[52:55], v137 offset:128
    v_cvt_pk_bf16_f32 v165, v34, v35
    v_mfma_f32_16x16x32_bf16 v[40:43], v[28:31], a[180:183], v[40:43]
    ds_read_b128 v[112:115], v136 offset:128
    v_add_u32 v135, s48, v135
    v_mfma_f32_16x16x32_bf16 v[40:43], v[48:51], a[184:187], v[40:43]
    ds_read_b128 v[108:111], v137 offset:256
    v_add_u32 v134, s48, v134
    v_mfma_f32_16x16x32_bf16 v[40:43], v[20:23], a[188:191], v[40:43]
    s_nop 0
    ds_read_b128 v[104:107], v136 offset:256
    v_add_u32 v133, s51, v133
    v_mfma_f32_16x16x16_bf16 v[118:121], v[216:217], v[170:171], 0
    s_nop 0
    v_add_u32 v132, s14, v132
    v_add_u32 v131, s14, v131
    v_add_u32 v123, s14, v123
    v_cvt_pk_bf16_f32 v160, v40, v41
    v_mfma_f32_16x16x32_bf16 v[100:103], v[88:91], a[192:195], 0
    v_cvt_pk_bf16_f32 v161, v42, v43
    v_and_b32 v116, -8, v123
    v_mfma_f32_16x16x32_bf16 v[100:103], v[56:59], a[196:199], v[100:103]
    v_rsq_f32 v118, v118
    v_mfma_f32_16x16x32_bf16 v[100:103], v[80:83], a[200:203], v[100:103]
    v_rsq_f32 v119, v119
    v_mfma_f32_16x16x32_bf16 v[100:103], v[28:31], a[204:207], v[100:103]
    ds_read_b128 v[28:31], v132 offset:0
    v_mul_f32 v118, s55, v118
    v_mfma_f32_16x16x32_bf16 v[100:103], v[48:51], a[208:211], v[100:103]
    ds_read_b128 v[48:51], v132 offset:16
    v_mul_f32 v119, 0.5, v119
    v_mfma_f32_16x16x32_bf16 v[100:103], v[20:23], a[212:215], v[100:103]
    s_waitcnt lgkmcnt(3)
    ds_read_b128 v[20:23], v132 offset:48
    v_mul_f32 v72, v72, v119
    v_mfma_f32_16x16x32_bf16 v[32:35], a[216:219], v[60:63], 0
    ds_read_b128 v[88:91], v133 offset:0
    v_mul_f32 v73, v73, v119
    v_mfma_f32_16x16x32_bf16 v[32:35], a[220:223], v[84:87], v[32:35]
    v_cvt_pk_f16_f32 v40, v72, v73
    v_mul_f32 v74, v74, v119
    v_mfma_f32_16x16x32_bf16 v[32:35], a[224:227], v[52:55], v[32:35]
    v_mul_f32 v75, v75, v119
    v_cvt_pk_f16_f32 v41, v74, v75
    v_mfma_f32_16x16x32_bf16 v[32:35], a[228:231], v[112:115], v[32:35]
    v_mul_f32 v4, v4, v119
    v_mul_f32 v5, v5, v119
    v_mfma_f32_16x16x32_bf16 v[32:35], a[232:235], v[108:111], v[32:35]
    s_waitcnt lgkmcnt(4)
    v_cvt_pk_f16_f32 v42, v4, v5
    v_mul_f32 v6, v6, v119
    v_mfma_f32_16x16x32_bf16 v[32:35], a[236:239], v[104:107], v[32:35]
    v_mul_f32 v7, v7, v119
    v_cvt_pk_f16_f32 v43, v6, v7
    v_mfma_f32_16x16x32_bf16 v[4:7], a[240:243], v[60:63], 0
    v_mul_f32 v24, v24, v119
    v_mul_f32 v25, v25, v119
    v_mfma_f32_16x16x32_bf16 v[4:7], a[244:247], v[84:87], v[4:7]
    v_cvt_pk_f16_f32 v142, v24, v25
    v_mul_f32 v26, v26, v119
    v_mfma_f32_16x16x32_bf16 v[4:7], a[248:251], v[52:55], v[4:7]
    v_mul_f32 v27, v27, v119
    v_cvt_pk_f16_f32 v143, v26, v27
    v_mfma_f32_16x16x32_bf16 v[4:7], a[252:255], v[112:115], v[4:7]
    s_waitcnt lgkmcnt(0)
    buffer_load_dwordx4 v128, s[24:27], s56 offen nt lds
    v_mul_f32 v92, v92, v118
    v_mfma_f32_16x16x32_bf16 v[4:7], v[224:227], v[108:111], v[4:7]
    v_mul_f32 v93, v93, v118
    v_cvt_pk_f16_f32 v44, v92, v93
    v_mfma_f32_16x16x32_bf16 v[4:7], v[228:231], v[104:107], v[4:7]
    v_mul_f32 v94, v94, v118
    v_mul_f32 v95, v95, v118
    v_mfma_f32_16x16x32_bf16 v[24:27], v[232:235], v[60:63], 0
    v_cvt_pk_f16_f32 v45, v94, v95
    v_mul_f32 v64, v64, v118
    v_mfma_f32_16x16x32_bf16 v[24:27], v[236:239], v[84:87], v[24:27]
    v_mul_f32 v65, v65, v118
    v_cvt_pk_f16_f32 v46, v64, v65
    v_mfma_f32_16x16x32_bf16 v[24:27], v[240:243], v[52:55], v[24:27]
    v_mul_f32 v66, v66, v118
    v_mul_f32 v67, v67, v118
    v_mfma_f32_16x16x32_bf16 v[24:27], v[244:247], v[112:115], v[24:27]
    v_cvt_pk_f16_f32 v47, v66, v67
    v_mul_f32 v68, v68, v118
    v_mfma_f32_16x16x32_bf16 v[24:27], v[248:251], v[108:111], v[24:27]
    buffer_store_dwordx4 v[88:91], v128, s[28:31], s60 offen sc1
    v_mul_f32 v69, v69, v118
    v_cvt_pk_f16_f32 v140, v68, v69
    v_mul_f32 v70, v70, v118
    v_mul_f32 v71, v71, v118
    v_mfma_f32_16x16x32_bf16 v[24:27], v[252:255], v[104:107], v[24:27]
    s_add_u32 m0, s67, 1024
    v_cvt_pk_f16_f32 v141, v70, v71
    v_cvt_pk_bf16_f32 v156, v100, v101
    v_mfma_f32_16x16x32_f16 v[112:115], v[16:19], v[76:79], v[204:207]
    ds_read_u16 v166, v131 offset:80
    v_cvt_pk_bf16_f32 v157, v102, v103
    v_mfma_f32_16x16x32_f16 v[112:115], v[152:155], v[150:153], v[112:115]
    ds_read_u16 v162, v131 offset:96
    v_mfma_f32_16x16x32_f16 v[108:111], v[36:39], v[76:79], v[200:203]
    s_nop 0
    ds_read_u16 v158, v131 offset:104
    s_nop 0
    v_mfma_f32_16x16x32_f16 v[108:111], v[146:149], v[150:153], v[108:111]
    s_nop 0
    ds_read_b32 v116, v116 offset:64
    v_max3_f32 v120, v112, v113, v114
    v_mfma_f32_16x16x32_f16 v[104:107], v[40:43], v[76:79], v[196:199]
    ds_read_b128 v[68:71], v133 offset:1024
    v_mfma_f32_16x16x32_f16 v[104:107], v[140:143], v[150:153], v[104:107]
    s_nop 0
    ds_read_b128 v[72:75], v137 offset:1536
    v_max3_f32 v120, v120, v115, v108
    v_mfma_f32_16x16x32_f16 v[88:91], v[28:31], v[76:79], v[208:211]
    ds_read_b128 v[76:79], v136 offset:1536
    v_max3_f32 v120, v120, v109, v110
    v_mfma_f32_16x16x32_f16 v[88:91], v[48:51], v[16:19], v[88:91]
    ds_read_b128 v[60:63], v137 offset:1664
    v_max3_f32 v120, v120, v111, v104
    v_mfma_f32_16x16x32_f16 v[88:91], v[20:23], v[152:155], v[88:91]
    ds_read_b128 v[56:59], v136 offset:1664
    v_max3_f32 v120, v120, v105, v106
    v_mfma_f32_16x16x32_f16 v[92:95], v[28:31], v[96:99], v[208:211]
    ds_read_b128 v[64:67], v137 offset:1792
    s_nop 0
    v_mfma_f32_16x16x32_f16 v[92:95], v[48:51], v[36:39], v[92:95]
    s_nop 0
    ds_read_b128 v[80:83], v136 offset:1792
    v_max3_f32 v120, v120, v107, v88
    v_mfma_f32_16x16x32_f16 v[92:95], v[20:23], v[146:149], v[92:95]
    v_mov_b32 v121, v120
    v_mfma_f32_16x16x32_f16 v[84:87], v[28:31], v[44:47], v[208:211]
    s_nop 0
    v_permlane32_swap_b32 v121, v120
    v_mfma_f32_16x16x32_f16 v[84:87], v[48:51], v[40:43], v[84:87]
    s_waitcnt lgkmcnt(6)
    buffer_load_dwordx4 v127, s[24:27], s56 offen nt lds
    v_max_f32 v120, v121, v120
    v_mfma_f32_16x16x32_f16 v[84:87], v[20:23], v[140:143], v[84:87]
    s_waitcnt lgkmcnt(5)
    v_mov_b32 v121, v120
    v_mov_b32_dpp v91, v95 quad_perm:[0,1,2,3] row_mask:0x2 bank_mask:0xf
    v_mfma_f32_16x16x32_bf16 v[28:31], a[216:219], v[72:75], 0
    s_waitcnt lgkmcnt(4)
    v_permlane16_swap_b32 v121, v120
    v_mfma_f32_16x16x32_bf16 v[28:31], a[220:223], v[76:79], v[28:31]
    s_waitcnt lgkmcnt(3)
    v_max_f32 v120, v121, v120
    v_sub_f32 v112, v112, v120
    v_mfma_f32_16x16x32_bf16 v[28:31], a[224:227], v[60:63], v[28:31]
    s_waitcnt lgkmcnt(2)
    v_sub_f32 v113, v113, v120
    v_sub_f32 v114, v114, v120
    v_mfma_f32_16x16x32_bf16 v[28:31], a[228:231], v[56:59], v[28:31]
    s_waitcnt lgkmcnt(1)
    v_sub_f32 v115, v115, v120
    v_sub_f32 v108, v108, v120
    v_mfma_f32_16x16x32_bf16 v[28:31], a[232:235], v[64:67], v[28:31]
    s_waitcnt lgkmcnt(0)
    v_sub_f32 v109, v109, v120
    v_sub_f32 v110, v110, v120
    v_mfma_f32_16x16x32_bf16 v[28:31], a[236:239], v[80:83], v[28:31]
    buffer_store_dwordx4 v[68:71], v127, s[28:31], s60 offen sc1
    ds_read_b128 v[100:103], v133 offset:2048
    v_sub_f32 v111, v111, v120
    v_sub_f32 v104, v104, v120
    v_sub_f32 v105, v105, v120
    v_mfma_f32_16x16x32_f16 v[48:51], v[16:19], v[96:99], v[192:195]
    s_add_u32 m0, s67, 2048
    v_sub_f32 v106, v106, v120
    v_sub_f32 v107, v107, v120
    v_mfma_f32_16x16x32_f16 v[48:51], v[152:155], v[144:147], v[48:51]
    v_sub_f32 v88, v88, v120
    v_mov_b32_dpp v91, v87 quad_perm:[0,1,2,3] row_mask:0x4 bank_mask:0xf
    v_mfma_f32_16x16x32_f16 v[68:71], v[36:39], v[96:99], v[188:191]
    v_exp_f32 v112, v112
    v_mfma_f32_16x16x32_f16 v[68:71], v[146:149], v[144:147], v[68:71]
    v_exp_f32 v113, v113
    v_mfma_f32_16x16x32_f16 v[52:55], v[40:43], v[96:99], v[184:187]
    v_exp_f32 v114, v114
    v_mfma_f32_16x16x32_f16 v[52:55], v[140:143], v[144:147], v[52:55]
    v_exp_f32 v115, v115
    v_mfma_f32_16x16x32_bf16 v[20:23], a[240:243], v[72:75], 0
    v_cvt_pk_bf16_f32 v96, v112, v113
    v_cvt_pk_bf16_f32 v97, v114, v115
    v_mfma_f32_16x16x32_bf16 v[20:23], a[244:247], v[76:79], v[20:23]
    v_exp_f32 v108, v108
    v_mfma_f32_16x16x32_bf16 v[20:23], a[248:251], v[60:63], v[20:23]
    s_waitcnt lgkmcnt(0)
    buffer_load_dwordx4 v126, s[24:27], s56 offen nt lds
    v_and_b32 v120, 0xffff0000, v116
    v_mfma_f32_16x16x32_bf16 v[20:23], a[252:255], v[56:59], v[20:23]
    v_exp_f32 v109, v109
    v_mfma_f32_16x16x32_bf16 v[20:23], v[224:227], v[64:67], v[20:23]
    v_exp_f32 v110, v110
    v_mfma_f32_16x16x32_bf16 v[20:23], v[228:231], v[80:83], v[20:23]
    s_mov_b32 s53, s47
    v_exp_f32 v111, v111
    v_cvt_pk_bf16_f32 v98, v108, v109
    v_cvt_pk_bf16_f32 v99, v110, v111
    v_exp_f32 v104, v104
    v_exp_f32 v105, v105
    v_exp_f32 v106, v106
    v_exp_f32 v107, v107
    v_cvt_pk_bf16_f32 v168, v104, v105
    v_cvt_pk_bf16_f32 v169, v106, v107
    v_exp_f32 v88, v88
    v_lshlrev_b32 v116, 16, v116
    v_cvt_pk_bf16_f32 v170, v88, 0
    v_mfma_f32_16x16x32_bf16 v[112:115], v[220:223], v[96:99], 0
    s_add_u32 m0, s67, 3072
    buffer_store_dwordx4 v[100:103], v126, s[28:31], s60 offen sc1
    v_add_f32 v116, v116, v120
    v_add_f32 v116, v116, v211
    v_max3_f32 v120, v48, v49, v50
    v_max3_f32 v120, v120, v51, v68
    v_mfma_f32_16x16x32_bf16 v[112:115], v[220:223], v[168:171], v[112:115]
    s_mov_b32 s47, s46
    v_mov_b32_dpp v91, v116 quad_perm:[0,1,2,3] row_mask:0x8 bank_mask:0xf
    v_mov_b32 v121, v91
    v_mfma_f32_16x16x32_bf16 v[108:111], v[0:3], v[96:99], 0
    s_mov_b32 s46, s45
    v_max_f32_dpp v121, v121, v121 row_ror:8 row_mask:0xf bank_mask:0xf
    v_max3_f32 v120, v120, v69, v70
    v_mfma_f32_16x16x32_bf16 v[108:111], v[164:167], v[168:171], v[108:111]
    s_mov_b32 s45, s44
    v_max_f32_dpp v121, v121, v121 row_ror:4 row_mask:0xf bank_mask:0xf
    v_max3_f32 v120, v120, v71, v52
    v_mfma_f32_16x16x32_bf16 v[104:107], v[8:11], v[96:99], 0
    s_mov_b32 s44, s53
    v_max_f32_dpp v121, v121, v121 row_ror:2 row_mask:0xf bank_mask:0xf
    v_max3_f32 v120, v120, v53, v54
    v_mfma_f32_16x16x32_bf16 v[104:107], v[160:163], v[168:171], v[104:107]
    s_sub_u32 s48, s44, s46
    v_max_f32_dpp v121, v121, v121 row_ror:1 row_mask:0xf bank_mask:0xf
    v_mov_b32 v84, v121
    v_mfma_f32_16x16x32_bf16 v[100:103], v[12:15], v[96:99], 0
    s_sub_u32 s49, s46, s45
    v_permlane32_swap_b32 v84, v121
    v_mfma_f32_16x16x32_bf16 v[100:103], v[156:159], v[168:171], v[100:103]
    v_max_f32 v121, v84, v121
    v_mov_b32 v84, v121
    v_rcp_f32 v112, v112
    v_max3_f32 v120, v120, v55, v93
    v_permlane16_swap_b32 v84, v121
    v_max_f32 v121, v84, v121
    v_sub_f32 v91, v91, v121
    v_exp_f32 v91, v91
    v_mul_f32 v108, v108, v112
    v_cvt_pk_bf16_f32 v91, v91, v91
    ds_write_b16 v123, v91 offset:64
    v_mul_f32 v109, v109, v112
    v_cvt_pk_bf16_f32 v88, v108, v109
    ds_read_b128 v[94:97], v132 offset:48
    v_mul_f32 v110, v110, v112
    v_mul_f32 v111, v111, v112
    v_cvt_pk_bf16_f32 v89, v110, v111
    ds_read_b128 v[108:111], v132 offset:64
    v_mfma_f32_16x16x32_bf16 v[114:117], v[232:235], v[72:75], 0
    v_mul_f32 v104, v104, v112
    v_mul_f32 v105, v105, v112
    v_mfma_f32_16x16x32_bf16 v[114:117], v[236:239], v[76:79], v[114:117]
    ds_write_b64 v135, v[88:89] offset:0
    v_mfma_f32_16x16x32_bf16 v[114:117], v[240:243], v[60:63], v[114:117]
    v_cvt_pk_bf16_f32 v90, v104, v105
    v_mul_f32 v106, v106, v112
    v_mfma_f32_16x16x32_bf16 v[114:117], v[244:247], v[56:59], v[114:117]
    v_mul_f32 v107, v107, v112
    v_cvt_pk_bf16_f32 v91, v106, v107
    v_mfma_f32_16x16x32_bf16 v[114:117], v[248:251], v[64:67], v[114:117]
    ds_write_b64 v135, v[90:91] offset:8
    v_mfma_f32_16x16x32_bf16 v[114:117], v[252:255], v[80:83], v[114:117]
    s_waitcnt lgkmcnt(3)
    v_mul_f32 v100, v100, v112
    v_mul_f32 v101, v101, v112
    v_cvt_pk_bf16_f32 v168, v100, v101
    v_mul_f32 v102, v102, v112
    v_mfma_f32_16x16x32_bf16 v[72:75], v[94:97], v[0:3], 0
    s_waitcnt lgkmcnt(2)
    v_mul_f32 v103, v103, v112
    v_cvt_pk_bf16_f32 v169, v102, v103
    v_mov_b32 v170, v120
    v_fma_f32 v92, v32, v32, s42
    v_mfma_f32_16x16x32_bf16 v[72:75], v[108:111], v[164:167], v[72:75]
    ds_write_b64 v134, v[168:169] offset:0
    v_mfma_f32_16x16x32_bf16 v[88:91], v[94:97], v[8:11], 0
    v_permlane32_swap_b32 v170, v120
    v_mfma_f32_16x16x32_bf16 v[88:91], v[108:111], v[160:163], v[88:91]
    v_max_f32 v120, v170, v120
    v_mov_b32 v170, v120
    v_mfma_f32_16x16x32_bf16 v[76:79], v[94:97], v[12:15], 0
    s_nop 0
    v_permlane16_swap_b32 v170, v120
    v_mfma_f32_16x16x32_bf16 v[76:79], v[108:111], v[156:159], v[76:79]
    ds_read_b128 v[60:63], v133 offset:3072
    v_max_f32 v120, v170, v120
    v_sub_f32 v48, v48, v120
    v_sub_f32 v49, v49, v120
    v_sub_f32 v50, v50, v120
    v_sub_f32 v51, v51, v120
    v_sub_f32 v68, v68, v120
    v_sub_f32 v69, v69, v120
    v_sub_f32 v70, v70, v120
    v_sub_f32 v71, v71, v120
    v_sub_f32 v52, v52, v120
    v_sub_f32 v53, v53, v120
    v_sub_f32 v54, v54, v120
    v_sub_f32 v55, v55, v120
    v_sub_f32 v93, v93, v120
    v_exp_f32 v48, v48
    v_exp_f32 v49, v49
    v_exp_f32 v50, v50
    v_exp_f32 v51, v51
    v_cvt_pk_bf16_f32 v56, v48, v49
    v_cvt_pk_bf16_f32 v57, v50, v51
    v_exp_f32 v68, v68
    v_exp_f32 v69, v69
    v_exp_f32 v70, v70
    v_exp_f32 v71, v71
    v_cvt_pk_bf16_f32 v58, v68, v69
    v_cvt_pk_bf16_f32 v59, v70, v71
    v_exp_f32 v52, v52
    v_exp_f32 v53, v53
    v_exp_f32 v54, v54
    v_exp_f32 v55, v55
    v_cvt_pk_bf16_f32 v168, v52, v53
    v_cvt_pk_bf16_f32 v169, v54, v55
    v_exp_f32 v93, v93
    v_mov_b32_dpp v75, v91 quad_perm:[0,1,2,3] row_mask:0x2 bank_mask:0xf
    v_cvt_pk_bf16_f32 v170, v93, 0
    v_mfma_f32_16x16x32_bf16 v[88:91], v[220:223], v[56:59], 0
    s_waitcnt lgkmcnt(0)
    buffer_load_dwordx4 v125, s[24:27], s56 offen nt lds
    ds_read_b128 v[64:67], v137 offset:3072
    v_mfma_f32_16x16x32_bf16 v[88:91], v[220:223], v[168:171], v[88:91]
    v_mov_b32_dpp v75, v79 quad_perm:[0,1,2,3] row_mask:0x4 bank_mask:0xf
    v_cvt_pk_bf16_f32 v75, v75, v75
    v_mfma_f32_16x16x32_bf16 v[76:79], v[0:3], v[56:59], 0
    ds_write_b16 v131, v75
    v_mfma_f32_16x16x32_bf16 v[76:79], v[164:167], v[168:171], v[76:79]
    ds_read_b128 v[72:75], v136 offset:3072
    v_fmac_f32 v92, v33, v33
    v_mfma_f32_16x16x32_bf16 v[80:83], v[8:11], v[56:59], 0
    ds_read_b128 v[48:51], v137 offset:3200
    v_fmac_f32 v92, v34, v34
    v_mfma_f32_16x16x32_bf16 v[80:83], v[160:163], v[168:171], v[80:83]
    ds_read_b128 v[68:71], v136 offset:3200
    v_fmac_f32 v92, v35, v35
    v_mfma_f32_16x16x32_bf16 v[52:55], v[12:15], v[56:59], 0
    ds_read_b128 v[56:59], v137 offset:3328
    v_add_u32 v137, s48, v137
    v_mfma_f32_16x16x32_bf16 v[52:55], v[156:159], v[168:171], v[52:55]
    buffer_store_dwordx4 v[60:63], v125, s[28:31], s60 offen sc1
    ds_read_b128 v[94:97], v136 offset:3328
    v_rcp_f32 v88, v88
    v_add_u32 v136, s48, v136
    v_mfma_f32_16x16x32_f16 v[60:63], v[16:19], v[44:47], v[180:183]
    s_add_u32 m0, s67, 4096
    ds_read_b128 v[16:19], v133 offset:4096
    v_mul_f32 v76, v76, v88
    v_mfma_f32_16x16x32_f16 v[60:63], v[152:155], v[138:141], v[60:63]
    s_cmp_lg_u32 s5, -1
    v_mul_f32 v77, v77, v88
    v_cvt_pk_bf16_f32 v76, v76, v77
    v_mfma_f32_16x16x32_f16 v[152:155], v[36:39], v[44:47], v[176:179]
    v_mul_f32 v78, v78, v88
    v_mul_f32 v79, v79, v88
    v_mfma_f32_16x16x32_f16 v[152:155], v[146:149], v[138:141], v[152:155]
    v_cvt_pk_bf16_f32 v77, v78, v79
    v_mul_f32 v80, v80, v88
    v_mfma_f32_16x16x32_f16 v[36:39], v[40:43], v[44:47], v[172:175]
    ds_write_b64 v135, v[76:77] offset:1536
    v_mfma_f32_16x16x32_f16 v[36:39], v[140:143], v[138:141], v[36:39]
    s_waitcnt lgkmcnt(4)
    v_mul_f32 v81, v81, v88
    v_cvt_pk_bf16_f32 v78, v80, v81
    v_mfma_f32_16x16x32_bf16 v[40:43], a[216:219], v[64:67], 0
    v_mul_f32 v82, v82, v88
    v_mul_f32 v83, v83, v88
    v_mfma_f32_16x16x32_bf16 v[40:43], a[220:223], v[72:75], v[40:43]
    v_cvt_pk_bf16_f32 v79, v82, v83
    v_mul_f32 v52, v52, v88
    v_mfma_f32_16x16x32_bf16 v[40:43], a[224:227], v[48:51], v[40:43]
    ds_write_b64 v135, v[78:79] offset:1544
    v_mfma_f32_16x16x32_bf16 v[40:43], a[228:231], v[68:71], v[40:43]
    s_waitcnt lgkmcnt(2)
    buffer_load_dwordx4 v124, s[24:27], s56 offen nt lds
    v_mul_f32 v53, v53, v88
    v_mfma_f32_16x16x32_bf16 v[40:43], a[232:235], v[56:59], v[40:43]
    v_cvt_pk_bf16_f32 v168, v52, v53
    v_mul_f32 v54, v54, v88
    v_mfma_f32_16x16x32_bf16 v[40:43], a[236:239], v[94:97], v[40:43]
    v_mul_f32 v55, v55, v88
    v_cvt_pk_bf16_f32 v169, v54, v55
    v_mfma_f32_16x16x32_bf16 v[140:143], a[240:243], v[64:67], 0
    ds_write_b64 v134, v[168:169] offset:1536
    v_mfma_f32_16x16x32_bf16 v[140:143], a[244:247], v[72:75], v[140:143]
    v_max3_f32 v168, v60, v61, v62
    v_max3_f32 v168, v168, v63, v152
    v_mfma_f32_16x16x32_bf16 v[140:143], a[248:251], v[48:51], v[140:143]
    v_max3_f32 v168, v168, v153, v154
    v_max3_f32 v168, v168, v155, v36
    v_mfma_f32_16x16x32_bf16 v[140:143], a[252:255], v[68:71], v[140:143]
    v_max3_f32 v168, v168, v37, v38
    v_max3_f32 v168, v168, v39, v86
    v_mfma_f32_16x16x32_bf16 v[140:143], v[224:227], v[56:59], v[140:143]
    buffer_store_dwordx4 v[16:19], v124, s[28:31], s60 offen sc1
    v_mov_b32 v169, v168
    v_fmac_f32 v92, v4, v4
    v_fmac_f32 v92, v5, v5
    v_fmac_f32 v92, v6, v6
    v_mfma_f32_16x16x32_bf16 v[140:143], v[228:231], v[94:97], v[140:143]
    ds_read_b128 v[16:19], v137 offset:0
    v_fmac_f32 v92, v7, v7
    v_mfma_f32_16x16x32_bf16 v[44:47], v[232:235], v[64:67], 0
    ds_read_b128 v[146:149], v136 offset:0
    v_fmac_f32 v92, v24, v24
    v_mfma_f32_16x16x32_bf16 v[44:47], v[236:239], v[72:75], v[44:47]
    ds_read_b128 v[72:75], v137 offset:128
    v_fmac_f32 v92, v25, v25
    v_mfma_f32_16x16x32_bf16 v[44:47], v[240:243], v[48:51], v[44:47]
    ds_read_b128 v[88:91], v136 offset:128
    v_fmac_f32 v92, v26, v26
    v_mfma_f32_16x16x32_bf16 v[44:47], v[244:247], v[68:71], v[44:47]
    ds_read_b128 v[76:79], v137 offset:256
    v_fmac_f32 v92, v27, v27
    v_mfma_f32_16x16x32_bf16 v[44:47], v[248:251], v[56:59], v[44:47]
    ds_read_b128 v[56:59], v136 offset:256
    v_fma_f32 v93, v28, v28, s42
    v_mfma_f32_16x16x32_bf16 v[44:47], v[252:255], v[94:97], v[44:47]
    v_permlane32_swap_b32 v169, v168
    v_max_f32 v168, v169, v168
    v_mov_b32 v169, v168
    v_fmac_f32 v93, v29, v29
    v_fmac_f32 v93, v30, v30
    v_permlane16_swap_b32 v169, v168
    v_max_f32 v168, v169, v168
    v_sub_f32 v60, v60, v168
    v_sub_f32 v61, v61, v168
    v_sub_f32 v62, v62, v168
    v_sub_f32 v63, v63, v168
    v_sub_f32 v152, v152, v168
    v_sub_f32 v153, v153, v168
    v_sub_f32 v154, v154, v168
    v_sub_f32 v155, v155, v168
    v_sub_f32 v36, v36, v168
    v_sub_f32 v37, v37, v168
    v_sub_f32 v38, v38, v168
    v_sub_f32 v39, v39, v168
    v_sub_f32 v86, v86, v168
    v_exp_f32 v60, v60
    v_exp_f32 v61, v61
    v_exp_f32 v62, v62
    v_exp_f32 v63, v63
    v_cvt_pk_bf16_f32 v60, v60, v61
    v_cvt_pk_bf16_f32 v61, v62, v63
    v_exp_f32 v152, v152
    v_exp_f32 v153, v153
    v_exp_f32 v154, v154
    v_exp_f32 v155, v155
    v_cvt_pk_bf16_f32 v62, v152, v153
    v_cvt_pk_bf16_f32 v63, v154, v155
    v_exp_f32 v36, v36
    v_exp_f32 v37, v37
    v_exp_f32 v38, v38
    v_exp_f32 v39, v39
    v_cvt_pk_bf16_f32 v168, v36, v37
    v_cvt_pk_bf16_f32 v169, v38, v39
    v_exp_f32 v86, v86
    v_fmac_f32 v93, v31, v31
    v_cvt_pk_bf16_f32 v170, v86, 0
    v_mfma_f32_16x16x32_bf16 v[152:155], v[220:223], v[60:63], 0
    v_fmac_f32 v93, v20, v20
    v_fmac_f32 v93, v21, v21
    v_mfma_f32_16x16x32_bf16 v[152:155], v[220:223], v[168:171], v[152:155]
    v_fmac_f32 v93, v22, v22
    v_fmac_f32 v93, v23, v23
    v_mfma_f32_16x16x32_bf16 v[36:39], v[0:3], v[60:63], 0
    s_nop 0
    v_fmac_f32 v93, v114, v114
    v_fmac_f32 v93, v115, v115
    v_mfma_f32_16x16x32_bf16 v[36:39], v[164:167], v[168:171], v[36:39]
    s_nop 0
    v_rcp_f32 v152, v152
    v_mfma_f32_16x16x32_bf16 v[0:3], v[8:11], v[60:63], 0
    s_nop 0
    v_fmac_f32 v93, v116, v116
    v_fmac_f32 v93, v117, v117
    v_mfma_f32_16x16x32_bf16 v[0:3], v[160:163], v[168:171], v[0:3]
    s_nop 0
    v_mul_f32 v36, v36, v152
    v_mul_f32 v37, v37, v152
    v_mfma_f32_16x16x32_bf16 v[8:11], v[12:15], v[60:63], 0
    v_cvt_pk_bf16_f32 v12, v36, v37
    v_mul_f32 v38, v38, v152
    v_mfma_f32_16x16x32_bf16 v[8:11], v[156:159], v[168:171], v[8:11]
    s_waitcnt lgkmcnt(0)
    v_mul_f32 v39, v39, v152
    v_cvt_pk_bf16_f32 v13, v38, v39
    v_mfma_f32_16x16x32_bf16 v[36:39], a[0:3], v[16:19], 0
    s_cbranch_scc1 L_loopS0
    ds_write_b64 v135, v[12:13] offset:3072
    v_mul_f32 v0, v0, v152
    v_mul_f32 v1, v1, v152
    v_cvt_pk_bf16_f32 v14, v0, v1
    v_mul_f32 v2, v2, v152
    v_mul_f32 v3, v3, v152
    v_cvt_pk_bf16_f32 v15, v2, v3
    v_mul_f32 v8, v8, v152
    v_mul_f32 v9, v9, v152
    v_cvt_pk_bf16_f32 v8, v8, v9
    v_mul_f32 v10, v10, v152
    v_mul_f32 v11, v11, v152
    v_cvt_pk_bf16_f32 v9, v10, v11
    s_mov_b32 s30, 100270464
    s_mul_i32 s89, s68, 7168
    ds_write_b64 v135, v[14:15] offset:3080
    v_fma_f32 v113, v40, v40, s42
    s_add_u32 s89, s89, 135168
    s_movk_i32 s90, 112
    ds_write_b64 v134, v[8:9] offset:3072
    v_fmac_f32 v113, v41, v41
    v_fmac_f32 v113, v42, v42
    v_fmac_f32 v113, v43, v43
    v_fmac_f32 v113, v140, v140
    v_fmac_f32 v113, v141, v141
    v_fmac_f32 v113, v142, v142
    v_fmac_f32 v113, v143, v143
    v_fmac_f32 v113, v44, v44
    v_fmac_f32 v113, v45, v45
    v_fmac_f32 v113, v46, v46
    v_fmac_f32 v113, v47, v47
    v_cvt_pk_bf16_f32 v112, v92, v93
    v_cvt_pk_bf16_f32 v113, v113, v122
    s_lshr_b32 s91, s64, 16
    s_sub_u32 s84, s45, s44
    ds_write_b64 v130, v[112:113]
    v_mbcnt_lo_u32_b32 v131, -1, 0
    v_mbcnt_hi_u32_b32 v131, -1, v131
    v_and_b32 v132, 15, v131
    v_lshrrev_b32 v131, 4, v131
    v_mul_u32_u24 v18, 1792, v131
    v_add_u32 v18, s89, v18
    v_mad_u32_u24 v131, v132, s90, v18
    v_lshrrev_b32 v112, v132, s64
    v_and_b32 v112, 1, v112
    v_cmp_eq_u32 vcc, 1, v112
    v_mad_u32_u24 v48, v132, s90, v18
    v_lshrrev_b32 v19, v132, s91
    v_cndmask_b32 v131, v18, v131, vcc
    s_sub_u32 s85, s46, s45
    s_sub_u32 s86, s44, s45
    ds_read_b128 v[56:59], v131 offset:64
    ds_read_b128 v[36:39], v131 offset:80
    v_and_b32 v19, 1, v19
    v_subrev_u32 v48, 28672, v48
    s_sub_u32 s93, s44, s47
    s_sub_u32 s94, s45, s47
    ds_read_b128 v[12:15], v131
    s_waitcnt lgkmcnt(3)
    s_barrier
    ds_read_b64 v[16:17], v131 offset:16
    ds_read_b128 v[52:55], v129 offset:0
    ds_read_b128 v[8:11], v129 offset:1024
    v_cmp_eq_u32 vcc, 1, v19
    v_add_u32 v132, s84, v137
    v_add_u32 v131, s84, v136
    v_cndmask_b32 v48, v18, v48, vcc
    s_sub_u32 s95, s46, s47
    s_waitcnt lgkmcnt(5)
    v_mfma_f32_16x16x32_bf16 v[0:3], v[220:223], v[56:59], 0
    s_waitcnt lgkmcnt(4)
    s_lshl_b32 s92, s68, 10
    ds_read_b128 a[24:27], v132 offset:1536
    ds_read_b128 a[32:35], v132 offset:1664
    v_mfma_f32_16x16x32_bf16 v[0:3], v[220:223], v[36:39], v[0:3]
    s_waitcnt lgkmcnt(5)
    ds_read_b128 a[40:43], v132 offset:1792
    v_lshlrev_b32 v113, 16, v12
    v_and_b32 v12, 0xffff0000, v12
    v_lshlrev_b32 v112, 16, v13
    v_and_b32 v13, 0xffff0000, v13
    v_lshlrev_b32 v19, 16, v14
    v_and_b32 v14, 0xffff0000, v14
    v_rcp_f32 v0, v0
    v_lshlrev_b32 v18, 16, v15
    v_mul_f32 v113, v113, v0
    s_waitcnt lgkmcnt(4)
    v_mfma_f32_16x16x32_bf16 v[36:39], v[216:219], v[52:55], 0
    s_waitcnt lgkmcnt(3)
    ds_read_b128 a[28:31], v131 offset:1536
    ds_read_b128 a[36:39], v131 offset:1664
    v_mfma_f32_16x16x32_bf16 v[36:39], v[216:219], v[8:11], v[36:39]
    s_waitcnt lgkmcnt(4)
    ds_read_b128 a[44:47], v131 offset:1792
    v_mul_f32 v12, v12, v0
    v_cvt_pk_bf16_f32 v12, v113, v12
    v_mul_f32 v112, v112, v0
    v_mfma_f32_16x16x32_bf16 v[52:55], a[216:219], a[24:27], 0
    v_mul_f32 v13, v13, v0
    v_cvt_pk_bf16_f32 v13, v112, v13
    v_mul_f32 v19, v19, v0
    v_mul_f32 v14, v14, v0
    v_cvt_pk_bf16_f32 v14, v19, v14
    v_and_b32 v15, 0xffff0000, v15
    v_mul_f32 v18, v18, v0
    v_mul_f32 v15, v15, v0
    v_cvt_pk_bf16_f32 v15, v18, v15
    v_lshlrev_b32 v39, 16, v16
    v_and_b32 v16, 0xffff0000, v16
    v_mul_f32 v39, v39, v0
    v_mul_f32 v16, v16, v0
    v_cvt_pk_bf16_f32 v138, v39, v16
    v_lshlrev_b32 v39, 16, v17
    s_waitcnt lgkmcnt(2)
    v_mfma_f32_16x16x32_bf16 v[52:55], a[220:223], a[28:31], v[52:55]
    ds_read_b128 a[0:3], v132 offset:0
    ds_read_b128 a[4:7], v131 offset:0
    v_mfma_f32_16x16x32_bf16 v[52:55], a[224:227], a[32:35], v[52:55]
    s_waitcnt lgkmcnt(3)
    ds_read_b128 a[8:11], v132 offset:128
    v_and_b32 v17, 0xffff0000, v17
    v_mfma_f32_16x16x32_bf16 v[52:55], a[228:231], a[36:39], v[52:55]
    ds_read_b128 a[12:15], v131 offset:128
    v_mul_f32 v39, v39, v0
    v_mfma_f32_16x16x32_bf16 v[52:55], a[232:235], a[40:43], v[52:55]
    s_waitcnt lgkmcnt(4)
    ds_read_b128 a[16:19], v132 offset:256
    v_mul_f32 v17, v17, v0
    v_mfma_f32_16x16x32_bf16 v[52:55], a[236:239], a[44:47], v[52:55]
    ds_read_b128 a[20:23], v131 offset:256
    v_cvt_pk_bf16_f32 v139, v39, v17
    v_mfma_f32_16x16x32_bf16 v[16:19], a[240:243], a[24:27], 0
    v_rsq_f32 v36, v36
    v_mfma_f32_16x16x32_bf16 v[16:19], a[244:247], a[28:31], v[16:19]
    v_mul_f32 v36, s43, v36
    v_mul_f32 v32, v32, v36
    v_mfma_f32_16x16x32_bf16 v[16:19], a[248:251], a[32:35], v[16:19]
    v_mul_f32 v33, v33, v36
    v_cvt_pk_bf16_f32 v0, v32, v33
    v_mfma_f32_16x16x32_bf16 v[16:19], a[252:255], a[36:39], v[16:19]
    v_mul_f32 v34, v34, v36
    v_mul_f32 v35, v35, v36
    v_mfma_f32_16x16x32_bf16 v[16:19], v[224:227], a[40:43], v[16:19]
    v_cvt_pk_bf16_f32 v1, v34, v35
    v_mul_f32 v4, v4, v36
    v_mfma_f32_16x16x32_bf16 v[16:19], v[228:231], a[44:47], v[16:19]
    v_mul_f32 v5, v5, v36
    v_cvt_pk_bf16_f32 v2, v4, v5
    v_mfma_f32_16x16x32_bf16 v[8:11], v[232:235], a[24:27], 0
    v_mul_f32 v6, v6, v36
    v_mul_f32 v7, v7, v36
    v_mfma_f32_16x16x32_bf16 v[8:11], v[236:239], a[28:31], v[8:11]
    v_cvt_pk_bf16_f32 v3, v6, v7
    v_mul_f32 v24, v24, v36
    v_mfma_f32_16x16x32_bf16 v[8:11], v[240:243], a[32:35], v[8:11]
    v_mul_f32 v25, v25, v36
    v_cvt_pk_bf16_f32 v24, v24, v25
    v_mfma_f32_16x16x32_bf16 v[8:11], v[244:247], a[36:39], v[8:11]
    v_mul_f32 v26, v26, v36
    v_mul_f32 v27, v27, v36
    v_mfma_f32_16x16x32_bf16 v[8:11], v[248:251], a[40:43], v[8:11]
    v_cvt_pk_bf16_f32 v25, v26, v27
    v_add_u32 v119, s85, v135
    v_mfma_f32_16x16x32_bf16 v[8:11], v[252:255], a[44:47], v[8:11]
    s_waitcnt lgkmcnt(0)
    ds_write_b128 v119, v[0:3] offset:0
    v_mfma_f32_16x16x32_bf16 v[56:59], a[216:219], a[0:3], 0
    v_rsq_f32 v37, v37
    v_mfma_f32_16x16x32_bf16 v[56:59], a[220:223], a[4:7], v[56:59]
    ds_read_b128 a[48:51], v132 offset:3072
    v_mul_f32 v37, s43, v37
    v_mfma_f32_16x16x32_bf16 v[56:59], a[224:227], a[8:11], v[56:59]
    ds_read_b128 a[52:55], v131 offset:3072
    v_add_u32 v118, s85, v134
    v_mfma_f32_16x16x32_bf16 v[56:59], a[228:231], a[12:15], v[56:59]
    ds_write_b64 v118, v[24:25] offset:0
    v_mfma_f32_16x16x32_bf16 v[56:59], a[232:235], a[16:19], v[56:59]
    v_rsq_f32 v38, v38
    v_mfma_f32_16x16x32_bf16 v[56:59], a[236:239], a[20:23], v[56:59]
    ds_read_b128 a[56:59], v132 offset:3200
    ds_read_b128 a[60:63], v131 offset:3200
    v_mfma_f32_16x16x32_bf16 v[4:7], a[240:243], a[0:3], 0
    v_mul_f32 v38, s43, v38
    v_mul_f32 v40, v40, v38
    v_mfma_f32_16x16x32_bf16 v[4:7], a[244:247], a[4:7], v[4:7]
    ds_read_b128 a[64:67], v132 offset:3328
    ds_read_b128 a[68:71], v131 offset:3328
    v_mfma_f32_16x16x32_bf16 v[4:7], a[248:251], a[8:11], v[4:7]
    v_mul_f32 v41, v41, v38
    v_cvt_pk_bf16_f32 v24, v40, v41
    v_mfma_f32_16x16x32_bf16 v[4:7], a[252:255], a[12:15], v[4:7]
    v_mul_f32 v42, v42, v38
    v_mul_f32 v43, v43, v38
    v_mfma_f32_16x16x32_bf16 v[4:7], v[224:227], a[16:19], v[4:7]
    v_cvt_pk_bf16_f32 v25, v42, v43
    v_mul_f32 v140, v140, v38
    v_mfma_f32_16x16x32_bf16 v[4:7], v[228:231], a[20:23], v[4:7]
    v_mul_f32 v141, v141, v38
    v_cvt_pk_bf16_f32 v26, v140, v141
    v_mfma_f32_16x16x32_bf16 v[0:3], v[232:235], a[0:3], 0
    v_mul_f32 v142, v142, v38
    v_mul_f32 v143, v143, v38
    v_mfma_f32_16x16x32_bf16 v[0:3], v[236:239], a[4:7], v[0:3]
    v_cvt_pk_bf16_f32 v27, v142, v143
    v_mul_f32 v44, v44, v38
    v_mfma_f32_16x16x32_bf16 v[0:3], v[240:243], a[8:11], v[0:3]
    ds_write_b128 v119, v[24:27] offset:3072
    v_mfma_f32_16x16x32_bf16 v[0:3], v[244:247], a[12:15], v[0:3]
    v_mul_f32 v45, v45, v38
    v_cvt_pk_bf16_f32 v44, v44, v45
    v_mfma_f32_16x16x32_bf16 v[0:3], v[248:251], a[16:19], v[0:3]
    v_mul_f32 v46, v46, v38
    v_mul_f32 v47, v47, v38
    v_mfma_f32_16x16x32_bf16 v[0:3], v[252:255], a[20:23], v[0:3]
    s_waitcnt lgkmcnt(1)
    v_cvt_pk_bf16_f32 v45, v46, v47
    v_add_u32 v112, s86, v135
    v_mfma_f32_16x16x32_bf16 v[32:35], a[216:219], a[48:51], 0
    ds_write_b64 v118, v[44:45] offset:3072
    v_mfma_f32_16x16x32_bf16 v[32:35], a[220:223], a[52:55], v[32:35]
    ds_write_b128 v112, v[12:15] offset:0
    v_mfma_f32_16x16x32_bf16 v[32:35], a[224:227], a[56:59], v[32:35]
    v_add_u32 v132, s86, v134
    v_add_u32 v131, s93, v133
    v_mfma_f32_16x16x32_bf16 v[32:35], a[228:231], a[60:63], v[32:35]
    v_add_u32 v113, s94, v133
    v_add_u32 v51, s95, v133
    v_mfma_f32_16x16x32_bf16 v[32:35], a[232:235], a[64:67], v[32:35]
    ds_write_b64 v132, v[138:139] offset:0
    v_mfma_f32_16x16x32_bf16 v[32:35], a[236:239], a[68:71], v[32:35]
    ds_read_b128 v[64:67], v48 offset:64
    v_fma_f32 v50, v56, v56, s42
    v_mfma_f32_16x16x32_bf16 v[40:43], a[240:243], a[48:51], 0
    ds_read_b128 v[60:63], v48 offset:80
    v_fmac_f32 v50, v57, v57
    v_mfma_f32_16x16x32_bf16 v[40:43], a[244:247], a[52:55], v[40:43]
    ds_read_b128 v[44:47], v48
    v_fmac_f32 v50, v58, v58
    v_mfma_f32_16x16x32_bf16 v[40:43], a[248:251], a[56:59], v[40:43]
    ds_read_b64 v[48:49], v48 offset:16
    v_fmac_f32 v50, v59, v59
    v_mfma_f32_16x16x32_bf16 v[40:43], a[252:255], a[60:63], v[40:43]
    v_fmac_f32 v50, v4, v4
    v_fmac_f32 v50, v5, v5
    v_mfma_f32_16x16x32_bf16 v[40:43], v[224:227], a[64:67], v[40:43]
    v_fmac_f32 v50, v6, v6
    v_fmac_f32 v50, v7, v7
    v_mfma_f32_16x16x32_bf16 v[40:43], v[228:231], a[68:71], v[40:43]
    v_fmac_f32 v50, v0, v0
    v_fmac_f32 v50, v1, v1
    v_mfma_f32_16x16x32_bf16 v[12:15], v[232:235], a[48:51], 0
    v_fmac_f32 v50, v2, v2
    v_fmac_f32 v50, v3, v3
    v_mfma_f32_16x16x32_bf16 v[12:15], v[236:239], a[52:55], v[12:15]
    v_mul_f32 v28, v28, v37
    v_mul_f32 v29, v29, v37
    v_mfma_f32_16x16x32_bf16 v[12:15], v[240:243], a[56:59], v[12:15]
    v_cvt_pk_bf16_f32 v28, v28, v29
    v_mul_f32 v30, v30, v37
    v_mfma_f32_16x16x32_bf16 v[12:15], v[244:247], a[60:63], v[12:15]
    v_mul_f32 v31, v31, v37
    v_cvt_pk_bf16_f32 v29, v30, v31
    v_mfma_f32_16x16x32_bf16 v[12:15], v[248:251], a[64:67], v[12:15]
    v_mul_f32 v20, v20, v37
    v_mul_f32 v21, v21, v37
    v_mfma_f32_16x16x32_bf16 v[12:15], v[252:255], a[68:71], v[12:15]
    s_waitcnt lgkmcnt(0)
    v_cvt_pk_bf16_f32 v30, v20, v21
    v_mul_f32 v22, v22, v37
    v_mfma_f32_16x16x32_bf16 v[24:27], v[220:223], v[64:67], 0
    v_mul_f32 v23, v23, v37
    v_cvt_pk_bf16_f32 v31, v22, v23
    v_mfma_f32_16x16x32_bf16 v[24:27], v[220:223], v[60:63], v[24:27]
    ds_write_b128 v119, v[28:31] offset:1536
    v_mul_f32 v114, v114, v37
    v_mul_f32 v115, v115, v37
    v_cvt_pk_bf16_f32 v114, v114, v115
    v_mul_f32 v116, v116, v37
    v_mul_f32 v117, v117, v37
    v_cvt_pk_bf16_f32 v115, v116, v117
    ds_write_b64 v118, v[114:115] offset:1536
    v_fma_f32 v133, v32, v32, s42
    v_fmac_f32 v133, v33, v33
    v_fmac_f32 v133, v34, v34
    v_fmac_f32 v133, v35, v35
    v_fmac_f32 v133, v40, v40
    v_fmac_f32 v133, v41, v41
    v_fmac_f32 v133, v42, v42
    v_fmac_f32 v133, v43, v43
    v_fmac_f32 v133, v12, v12
    v_fmac_f32 v133, v13, v13
    v_fmac_f32 v133, v14, v14
    v_fmac_f32 v133, v15, v15
    v_cvt_pk_bf16_f32 v115, v133, v133
    v_fma_f32 v114, v52, v52, s42
    v_fmac_f32 v114, v53, v53
    v_fmac_f32 v114, v54, v54
    v_fmac_f32 v114, v55, v55
    v_fmac_f32 v114, v16, v16
    v_fmac_f32 v114, v17, v17
    v_fmac_f32 v114, v18, v18
    v_fmac_f32 v114, v19, v19
    v_fmac_f32 v114, v8, v8
    v_fmac_f32 v114, v9, v9
    v_fmac_f32 v114, v10, v10
    v_fmac_f32 v114, v11, v11
    v_cvt_pk_bf16_f32 v114, v50, v114
    ds_write_b64 v130, v[114:115] offset:2048
    v_rcp_f32 v24, v24
    v_lshlrev_b32 v50, 16, v44
    v_and_b32 v44, 0xffff0000, v44
    v_mul_f32 v50, v50, v24
    v_mul_f32 v44, v44, v24
    v_cvt_pk_bf16_f32 v20, v50, v44
    v_lshlrev_b32 v44, 16, v45
    v_and_b32 v45, 0xffff0000, v45
    v_mul_f32 v44, v44, v24
    v_mul_f32 v45, v45, v24
    v_cvt_pk_bf16_f32 v21, v44, v45
    v_lshlrev_b32 v50, 16, v46
    v_and_b32 v46, 0xffff0000, v46
    v_mul_f32 v50, v50, v24
    v_mul_f32 v46, v46, v24
    v_cvt_pk_bf16_f32 v22, v50, v46
    v_lshlrev_b32 v23, 16, v47
    v_and_b32 v47, 0xffff0000, v47
    v_mul_f32 v23, v23, v24
    v_mul_f32 v47, v47, v24
    v_cvt_pk_bf16_f32 v23, v23, v47
    v_lshlrev_b32 v50, 16, v48
    v_and_b32 v48, 0xffff0000, v48
    v_mul_f32 v50, v50, v24
    v_mul_f32 v48, v48, v24
    v_cvt_pk_bf16_f32 v138, v50, v48
    v_lshlrev_b32 v133, 16, v49
    v_and_b32 v49, 0xffff0000, v49
    v_mul_f32 v133, v133, v24
    v_mul_f32 v49, v49, v24
    v_cvt_pk_bf16_f32 v139, v133, v49
    s_waitcnt lgkmcnt(0)
    s_barrier
    ds_write_b128 v112, v[20:23] offset:1536
    v_mov_b32 v115, 0
    v_add_u32 v47, s92, v129
    ds_write_b64 v132, v[138:139] offset:1536
    ds_read_b128 v[24:27], v129 offset:2048
    ds_read_b128 v[20:23], v129 offset:3072
    ds_read_b128 a[144:147], v51 offset:0
    ds_read_b128 a[148:151], v51 offset:1024
    ds_read_b128 a[152:155], v51 offset:2048
    s_waitcnt lgkmcnt(5)
    s_barrier
    s_waitcnt lgkmcnt(4)
    v_mfma_f32_16x16x32_bf16 v[36:39], v[216:219], v[24:27], 0
    s_waitcnt lgkmcnt(3)
    ds_read_b128 a[72:75], v137 offset:0
    ds_read_b128 a[76:79], v136 offset:0
    v_mfma_f32_16x16x32_bf16 v[36:39], v[216:219], v[20:23], v[36:39]
    s_waitcnt lgkmcnt(4)
    ds_read_b128 a[80:83], v137 offset:128
    s_nop 0
    buffer_store_dwordx4 a[144:147], v128, s[28:31], s59 offen sc1
    s_nop 0
    ds_read_b128 a[84:87], v136 offset:128
    s_nop 1
    v_rsq_f32 v36, v36
    ds_read_b128 a[88:91], v137 offset:256
    ds_read_b128 a[92:95], v136 offset:256
    v_mul_f32 v36, s43, v36
    v_mul_f32 v56, v56, v36
    v_mul_f32 v57, v57, v36
    ds_read_b128 a[96:99], v137 offset:1536
    v_cvt_pk_bf16_f32 v48, v56, v57
    s_waitcnt lgkmcnt(6)
    v_mfma_f32_16x16x32_bf16 v[24:27], a[216:219], a[72:75], 0
    s_waitcnt lgkmcnt(5)
    ds_read_b128 a[100:103], v136 offset:1536
    ds_read_b128 a[104:107], v137 offset:1664
    v_mfma_f32_16x16x32_bf16 v[24:27], a[220:223], a[76:79], v[24:27]
    s_waitcnt lgkmcnt(6)
    buffer_store_dwordx4 a[148:151], v127, s[28:31], s59 offen sc1
    ds_read_b128 a[108:111], v136 offset:1664
    v_mul_f32 v58, v58, v36
    v_mul_f32 v59, v59, v36
    v_cvt_pk_bf16_f32 v49, v58, v59
    v_mfma_f32_16x16x32_bf16 v[24:27], a[224:227], a[80:83], v[24:27]
    s_waitcnt lgkmcnt(6)
    ds_read_b128 a[112:115], v137 offset:1792
    v_mul_f32 v4, v4, v36
    v_mfma_f32_16x16x32_bf16 v[24:27], a[228:231], a[84:87], v[24:27]
    s_waitcnt lgkmcnt(6)
    ds_read_b128 a[116:119], v136 offset:1792
    v_mul_f32 v5, v5, v36
    v_mfma_f32_16x16x32_bf16 v[24:27], a[232:235], a[88:91], v[24:27]
    s_waitcnt lgkmcnt(6)
    ds_read_b128 a[156:159], v51 offset:3072
    v_cvt_pk_bf16_f32 v50, v4, v5
    v_mfma_f32_16x16x32_bf16 v[24:27], a[236:239], a[92:95], v[24:27]
    ds_read_b128 a[160:163], v51 offset:4096
    v_mul_f32 v6, v6, v36
    v_mfma_f32_16x16x32_bf16 v[28:31], a[240:243], a[72:75], 0
    v_mul_f32 v7, v7, v36
    v_cvt_pk_bf16_f32 v51, v6, v7
    v_mfma_f32_16x16x32_bf16 v[28:31], a[244:247], a[76:79], v[28:31]
    s_nop 0
    buffer_store_dwordx4 a[152:155], v126, s[28:31], s59 offen sc1
    v_fma_f32 v133, v24, v24, s42
    v_fmac_f32 v133, v25, v25
    v_fmac_f32 v133, v26, v26
    v_fmac_f32 v133, v27, v27
    v_mfma_f32_16x16x32_bf16 v[28:31], a[248:251], a[80:83], v[28:31]
    v_mul_f32 v0, v0, v36
    v_mul_f32 v1, v1, v36
    v_mfma_f32_16x16x32_bf16 v[28:31], a[252:255], a[84:87], v[28:31]
    v_cvt_pk_bf16_f32 v0, v0, v1
    v_mul_f32 v2, v2, v36
    v_mfma_f32_16x16x32_bf16 v[28:31], v[224:227], a[88:91], v[28:31]
    v_rsq_f32 v37, v37
    v_mfma_f32_16x16x32_bf16 v[28:31], v[228:231], a[92:95], v[28:31]
    v_mul_f32 v3, v3, v36
    v_cvt_pk_bf16_f32 v1, v2, v3
    v_mfma_f32_16x16x32_bf16 v[20:23], v[232:235], a[72:75], 0
    v_rsq_f32 v38, v38
    v_mfma_f32_16x16x32_bf16 v[20:23], v[236:239], a[76:79], v[20:23]
    s_waitcnt lgkmcnt(0)
    s_nop 0
    buffer_store_dwordx4 a[156:159], v125, s[28:31], s59 offen sc1
    v_fmac_f32 v133, v28, v28
    v_fmac_f32 v133, v29, v29
    v_fmac_f32 v133, v30, v30
    v_fmac_f32 v133, v31, v31
    v_mfma_f32_16x16x32_bf16 v[20:23], v[240:243], a[80:83], v[20:23]
    v_mul_f32 v37, s43, v37
    v_mul_f32 v52, v52, v37
    v_mfma_f32_16x16x32_bf16 v[20:23], v[244:247], a[84:87], v[20:23]
    v_mul_f32 v53, v53, v37
    v_cvt_pk_bf16_f32 v44, v52, v53
    v_mfma_f32_16x16x32_bf16 v[20:23], v[248:251], a[88:91], v[20:23]
    v_mul_f32 v54, v54, v37
    v_mul_f32 v55, v55, v37
    v_mfma_f32_16x16x32_bf16 v[20:23], v[252:255], a[92:95], v[20:23]
    v_cvt_pk_bf16_f32 v45, v54, v55
    v_mul_f32 v16, v16, v37
    v_mfma_f32_16x16x32_bf16 v[4:7], a[216:219], a[96:99], 0
    v_mul_f32 v17, v17, v37
    v_cvt_pk_bf16_f32 v46, v16, v17
    v_mfma_f32_16x16x32_bf16 v[4:7], a[220:223], a[100:103], v[4:7]
    ds_write_b128 v135, v[48:51] offset:0
    v_mfma_f32_16x16x32_bf16 v[4:7], a[224:227], a[104:107], v[4:7]
    buffer_store_dwordx4 a[160:163], v124, s[28:31], s59 offen sc1
    v_fmac_f32 v133, v20, v20
    v_fmac_f32 v133, v21, v21
    v_fmac_f32 v133, v22, v22
    v_fmac_f32 v133, v23, v23
    v_mfma_f32_16x16x32_bf16 v[4:7], a[228:231], a[108:111], v[4:7]
    ds_write_b64 v134, v[0:1] offset:0
    v_mfma_f32_16x16x32_bf16 v[4:7], a[232:235], a[112:115], v[4:7]
    ds_read_b128 v[0:3], v47 offset:6144
    v_mul_f32 v18, v18, v37
    v_mfma_f32_16x16x32_bf16 v[4:7], a[236:239], a[116:119], v[4:7]
    v_mul_f32 v19, v19, v37
    v_cvt_pk_bf16_f32 v47, v18, v19
    v_mfma_f32_16x16x32_bf16 v[16:19], a[240:243], a[96:99], 0
    ds_write_b128 v135, v[44:47] offset:1536
    v_mfma_f32_16x16x32_bf16 v[16:19], a[244:247], a[100:103], v[16:19]
    v_mul_f32 v8, v8, v37
    v_mul_f32 v9, v9, v37
    v_mfma_f32_16x16x32_bf16 v[16:19], a[248:251], a[104:107], v[16:19]
    v_cvt_pk_bf16_f32 v36, v8, v9
    v_mul_f32 v10, v10, v37
    v_mfma_f32_16x16x32_bf16 v[16:19], a[252:255], a[108:111], v[16:19]
    v_mul_f32 v11, v11, v37
    v_cvt_pk_bf16_f32 v37, v10, v11
    v_mfma_f32_16x16x32_bf16 v[16:19], v[224:227], a[112:115], v[16:19]
    ds_write_b64 v134, v[36:37] offset:1536
    v_mfma_f32_16x16x32_bf16 v[16:19], v[228:231], a[116:119], v[16:19]
    v_mul_f32 v38, s43, v38
    v_mul_f32 v32, v32, v38
    v_mfma_f32_16x16x32_bf16 v[8:11], v[232:235], a[96:99], 0
    v_mul_f32 v33, v33, v38
    v_cvt_pk_bf16_f32 v32, v32, v33
    v_mfma_f32_16x16x32_bf16 v[8:11], v[236:239], a[100:103], v[8:11]
    v_mul_f32 v34, v34, v38
    v_mul_f32 v35, v35, v38
    v_mfma_f32_16x16x32_bf16 v[8:11], v[240:243], a[104:107], v[8:11]
    v_cvt_pk_bf16_f32 v33, v34, v35
    v_mul_f32 v40, v40, v38
    v_mfma_f32_16x16x32_bf16 v[8:11], v[244:247], a[108:111], v[8:11]
    v_mul_f32 v41, v41, v38
    v_cvt_pk_bf16_f32 v34, v40, v41
    v_mfma_f32_16x16x32_bf16 v[8:11], v[248:251], a[112:115], v[8:11]
    v_mul_f32 v42, v42, v38
    v_mul_f32 v43, v43, v38
    v_mfma_f32_16x16x32_bf16 v[8:11], v[252:255], a[116:119], v[8:11]
    v_cvt_pk_bf16_f32 v35, v42, v43
    v_mul_f32 v12, v12, v38
    v_mul_f32 v13, v13, v38
    v_cvt_pk_bf16_f32 v12, v12, v13
    v_mul_f32 v14, v14, v38
    v_mul_f32 v15, v15, v38
    v_cvt_pk_bf16_f32 v13, v14, v15
    ds_write_b128 v135, v[32:35] offset:3072
    v_fma_f32 v114, v4, v4, s42
    v_fmac_f32 v114, v5, v5
    v_fmac_f32 v114, v6, v6
    v_fmac_f32 v114, v7, v7
    ds_write_b64 v134, v[12:13] offset:3072
    v_fmac_f32 v114, v16, v16
    v_fmac_f32 v114, v17, v17
    v_fmac_f32 v114, v18, v18
    v_fmac_f32 v114, v19, v19
    v_fmac_f32 v114, v8, v8
    v_fmac_f32 v114, v9, v9
    v_fmac_f32 v114, v10, v10
    v_fmac_f32 v114, v11, v11
    v_cvt_pk_bf16_f32 v114, v133, v114
    ds_write_b64 v130, v[114:115] offset:4096
    s_waitcnt lgkmcnt(3)
    v_lshrrev_b32 v130, 0, v3
    v_lshrrev_b32 v130, v130, s64
    v_and_b32 v130, 1, v130
    v_cmp_eq_u32 vcc, 1, v130
    v_lshrrev_b32 v130, 8, v3
    v_lshrrev_b32 v130, v130, s64
    v_cndmask_b32 v0, 2.0, v0, vcc
    v_and_b32 v130, 1, v130
    s_waitcnt lgkmcnt(1)
    s_barrier
    ds_read_b128 a[164:167], v113 offset:0
    ds_read_b128 a[168:171], v113 offset:1024
    v_cmp_eq_u32 vcc, 1, v130
    v_lshrrev_b32 v3, 16, v3
    s_waitcnt lgkmcnt(2)
    s_barrier
    ds_read_b128 a[172:175], v113 offset:2048
    v_cndmask_b32 v1, 2.0, v1, vcc
    ds_read_b128 a[176:179], v113 offset:3072
    v_lshrrev_b32 v3, v3, s64
    ds_read_b128 a[180:183], v113 offset:4096
    v_and_b32 v3, 1, v3
    ds_read_b128 v[36:39], v129 offset:4096
    v_cmp_eq_u32 vcc, 1, v3
    ds_read_b128 v[32:35], v129 offset:5120
    s_nop 0
    v_cndmask_b32 v2, 2.0, v2, vcc
    s_waitcnt lgkmcnt(6)
    buffer_store_dwordx4 a[164:167], v128, s[28:31], s58 offen sc1
    s_waitcnt lgkmcnt(1)
    v_mfma_f32_16x16x32_bf16 v[12:15], v[216:219], v[36:39], 0
    s_waitcnt lgkmcnt(0)
    v_mfma_f32_16x16x32_bf16 v[12:15], v[216:219], v[32:35], v[12:15]
    s_nop 2
    buffer_store_dwordx4 a[168:171], v127, s[28:31], s58 offen sc1
    s_nop 3
    v_rsq_f32 v12, v12
    v_rsq_f32 v13, v13
    v_mul_f32 v12, s43, v12
    v_mul_f32 v24, v24, v12
    v_mul_f32 v25, v25, v12
    v_cvt_pk_bf16_f32 v24, v24, v25
    v_mul_f32 v26, v26, v12
    v_mul_f32 v27, v27, v12
    v_cvt_pk_bf16_f32 v25, v26, v27
    v_mul_f32 v28, v28, v12
    v_mul_f32 v29, v29, v12
    v_cvt_pk_bf16_f32 v26, v28, v29
    v_mul_f32 v30, v30, v12
    v_mul_f32 v31, v31, v12
    v_cvt_pk_bf16_f32 v27, v30, v31
    v_mul_f32 v20, v20, v12
    v_mul_f32 v21, v21, v12
    buffer_store_dwordx4 a[172:175], v126, s[28:31], s58 offen sc1
    ds_write_b128 v112, v[24:27] offset:0
    v_cvt_pk_bf16_f32 v14, v20, v21
    v_mul_f32 v22, v22, v12
    v_mul_f32 v23, v23, v12
    v_cvt_pk_bf16_f32 v15, v22, v23
    ds_write_b64 v132, v[14:15] offset:0
    v_mul_f32 v13, s43, v13
    v_mul_f32 v4, v4, v13
    v_mul_f32 v5, v5, v13
    v_cvt_pk_bf16_f32 v4, v4, v5
    v_mul_f32 v6, v6, v13
    v_mul_f32 v7, v7, v13
    v_cvt_pk_bf16_f32 v5, v6, v7
    v_mul_f32 v16, v16, v13
    v_mul_f32 v17, v17, v13
    buffer_store_dwordx4 a[176:179], v125, s[28:31], s58 offen sc1
    v_cvt_pk_bf16_f32 v6, v16, v17
    v_mul_f32 v18, v18, v13
    v_mul_f32 v19, v19, v13
    v_cvt_pk_bf16_f32 v7, v18, v19
    v_mul_f32 v8, v8, v13
    v_mul_f32 v9, v9, v13
    v_cvt_pk_bf16_f32 v126, v8, v9
    v_mul_f32 v10, v10, v13
    v_mul_f32 v11, v11, v13
    v_cvt_pk_bf16_f32 v127, v10, v11
    ds_write_b128 v112, v[4:7] offset:1536
    ds_write_b64 v132, v[126:127] offset:1536
    buffer_store_dwordx4 a[180:183], v124, s[28:31], s58 offen sc1
    s_waitcnt lgkmcnt(0)
    s_barrier
    ds_read_b128 a[184:187], v131 offset:0
    ds_read_b128 a[188:191], v131 offset:1024
    ds_read_b128 a[192:195], v131 offset:2048
    s_waitcnt lgkmcnt(2)
    buffer_store_dwordx4 a[184:187], v0, s[28:31], 0 offen sc1
    s_waitcnt lgkmcnt(0)
    buffer_store_dwordx4 a[188:191], v1, s[28:31], 0 offen sc1
    buffer_store_dwordx4 a[192:195], v2, s[28:31], 0 offen sc1
    s_branch L_fin
L_again:
    s_waitcnt vmcnt(0) lgkmcnt(0)
    s_nop 15
    s_barrier
    s_movk_i32 s2, 256
    s_branch L_top
L_bndS:
    s_movk_i32 s73, 20
    s_movk_i32 s71, 18
    s_movk_i32 s70, -20
    s_mov_b32 s74, 0
    s_bitcmp1_b32 s2, 2
    s_cbranch_scc1 L_bndcS
    s_sub_u32 s94, s2, 248
    s_mul_i32 s69, s94, 18
    s_mov_b32 s74, 2
    s_sub_u32 s93, s93, 1373568
    v_cmp_le_u32 vcc, 4, v73
    v_add_u32 v6, 98896896, v128
    v_subrev_u32 v7, 1373568, v128
    v_cndmask_b32 v128, v6, v7, vcc
    v_cmp_le_u32 vcc, 4, v156
    v_add_u32 v6, 98896896, v127
    v_subrev_u32 v7, 1373568, v127
    v_cndmask_b32 v127, v6, v7, vcc
    v_cmp_le_u32 vcc, 4, v4
    v_add_u32 v6, 98896896, v126
    v_subrev_u32 v7, 1373568, v126
    v_cndmask_b32 v126, v6, v7, vcc
    v_cmp_le_u32 vcc, 4, v18
    v_add_u32 v6, 98896896, v125
    v_subrev_u32 v7, 1373568, v125
    v_cndmask_b32 v125, v6, v7, vcc
    v_cmp_le_u32 vcc, 4, v11
    v_add_u32 v6, 98896896, v124
    v_subrev_u32 v7, 1373568, v124
    v_cndmask_b32 v124, v6, v7, vcc
    s_cmp_lt_u32 s2, 256
    s_cbranch_scc1 L_bndrS
L_bndcS:
    s_sub_u32 s94, s2, 252
    s_mul_i32 s69, s94, 20
    s_lshr_b32 s71, s94, 1
    s_sub_u32 s69, s69, s71
    s_and_b32 s94, s94, 1
    s_sub_u32 s71, 20, s94
    s_cmp_eq_u32 s2, 255
    s_cselect_b32 s71, 13, s71
    s_mov_b32 s62, 1373568
    s_add_u32 s74, s74, 1
    s_sub_u32 s93, s93, 2688
    v_mad_i32_i24 v6, v73, -7, v74
    v_cmp_le_u32 vcc, 4, v6
    v_add_u32 v6, 193536, v128
    v_subrev_u32 v7, 2688, v128
    v_cndmask_b32 v128, v6, v7, vcc
    v_mad_i32_i24 v6, v156, -7, v150
    v_cmp_le_u32 vcc, 4, v6
    v_add_u32 v6, 193536, v127
    v_subrev_u32 v7, 2688, v127
    v_cndmask_b32 v127, v6, v7, vcc
    v_mad_i32_i24 v6, v4, -7, v10
    v_cmp_le_u32 vcc, 4, v6
    v_add_u32 v6, 193536, v126
    v_subrev_u32 v7, 2688, v126
    v_cndmask_b32 v126, v6, v7, vcc
    v_mad_i32_i24 v6, v18, -7, v159
    v_cmp_le_u32 vcc, 4, v6
    v_add_u32 v6, 193536, v125
    v_subrev_u32 v7, 2688, v125
    v_cndmask_b32 v125, v6, v7, vcc
    v_mad_i32_i24 v6, v11, -7, v151
    v_cmp_le_u32 vcc, 4, v6
    v_add_u32 v6, 193536, v124
    v_subrev_u32 v7, 2688, v124
    v_cndmask_b32 v124, v6, v7, vcc
    s_cmp_eq_u32 s2, 256
    s_cselect_b32 s62, 0, s62
    s_cselect_b32 s69, 0, s69
    s_cselect_b32 s71, 2, s71
    s_branch L_bndrS
L_maskS:
    s_and_b32 s20, s74, 2
    s_and_b32 s21, s74, 1
    s_mov_b32 s22, 0xc31044fe
    v_lshrrev_b32 v161, 2, v149
    v_add_u32 v161, 0, v161
    v_mul_u32_u24 v148, 37, v161
    v_lshrrev_b32 v72, 8, v148
    v_mad_i32_i24 v72, v72, -7, v161
    v_lshrrev_b32 v148, 10, v148
    v_lshrrev_b32 v72, 2, v72
    v_mul_u32_u24 v148, s20, v148
    v_mad_u32_u24 v161, v72, s21, v148
    v_cvt_f32_u32 v161, v161
    v_lshrrev_b32 v164, 2, v149
    v_add_u32 v164, 4, v164
    v_mul_u32_u24 v148, 37, v164
    v_lshrrev_b32 v72, 8, v148
    v_mad_i32_i24 v72, v72, -7, v164
    v_lshrrev_b32 v148, 10, v148
    v_lshrrev_b32 v72, 2, v72
    v_mul_u32_u24 v148, s20, v148
    v_mad_u32_u24 v164, v72, s21, v148
    v_cvt_f32_u32 v164, v164
    v_lshrrev_b32 v75, 2, v149
    v_add_u32 v75, 8, v75
    v_mul_u32_u24 v148, 37, v75
    v_lshrrev_b32 v72, 8, v148
    v_mad_i32_i24 v72, v72, -7, v75
    v_lshrrev_b32 v148, 10, v148
    v_lshrrev_b32 v72, 2, v72
    v_mul_u32_u24 v148, s20, v148
    v_mad_u32_u24 v75, v72, s21, v148
    v_cvt_f32_u32 v75, v75
    v_mad_u32_u24 v73, v160, 12, 0
    v_mul_u32_u24 v148, 37, v73
    v_lshrrev_b32 v72, 8, v148
    v_mad_i32_i24 v72, v72, -7, v73
    v_lshrrev_b32 v148, 10, v148
    v_lshrrev_b32 v72, 2, v72
    v_mul_u32_u24 v148, s20, v148
    v_mad_u32_u24 v73, v72, s21, v148
    v_cvt_f32_u32 v73, v73
    v_sub_f32 v148, v161, v73
    v_mul_f32 v148, v148, v148 clamp
    v_fmac_f32 v204, s22, v148
    v_sub_f32 v148, v164, v73
    v_mul_f32 v148, v148, v148 clamp
    v_fmac_f32 v192, s22, v148
    v_sub_f32 v148, v75, v73
    v_mul_f32 v148, v148, v148 clamp
    v_fmac_f32 v180, s22, v148
    v_mad_u32_u24 v73, v160, 12, 1
    v_mul_u32_u24 v148, 37, v73
    v_lshrrev_b32 v72, 8, v148
    v_mad_i32_i24 v72, v72, -7, v73
    v_lshrrev_b32 v148, 10, v148
    v_lshrrev_b32 v72, 2, v72
    v_mul_u32_u24 v148, s20, v148
    v_mad_u32_u24 v73, v72, s21, v148
    v_cvt_f32_u32 v73, v73
    v_sub_f32 v148, v161, v73
    v_mul_f32 v148, v148, v148 clamp
    v_fmac_f32 v205, s22, v148
    v_sub_f32 v148, v164, v73
    v_mul_f32 v148, v148, v148 clamp
    v_fmac_f32 v193, s22, v148
    v_sub_f32 v148, v75, v73
    v_mul_f32 v148, v148, v148 clamp
    v_fmac_f32 v181, s22, v148
    v_mad_u32_u24 v73, v160, 12, 2
    v_mul_u32_u24 v148, 37, v73
    v_lshrrev_b32 v72, 8, v148
    v_mad_i32_i24 v72, v72, -7, v73
    v_lshrrev_b32 v148, 10, v148
    v_lshrrev_b32 v72, 2, v72
    v_mul_u32_u24 v148, s20, v148
    v_mad_u32_u24 v73, v72, s21, v148
    v_cvt_f32_u32 v73, v73
    v_sub_f32 v148, v161, v73
    v_mul_f32 v148, v148, v148 clamp
    v_fmac_f32 v206, s22, v148
    v_sub_f32 v148, v164, v73
    v_mul_f32 v148, v148, v148 clamp
    v_fmac_f32 v194, s22, v148
    v_sub_f32 v148, v75, v73
    v_mul_f32 v148, v148, v148 clamp
    v_fmac_f32 v182, s22, v148
    v_mad_u32_u24 v73, v160, 12, 3
    v_mul_u32_u24 v148, 37, v73
    v_lshrrev_b32 v72, 8, v148
    v_mad_i32_i24 v72, v72, -7, v73
    v_lshrrev_b32 v148, 10, v148
    v_lshrrev_b32 v72, 2, v72
    v_mul_u32_u24 v148, s20, v148
    v_mad_u32_u24 v73, v72, s21, v148
    v_cvt_f32_u32 v73, v73
    v_sub_f32 v148, v161, v73
    v_mul_f32 v148, v148, v148 clamp
    v_fmac_f32 v207, s22, v148
    v_sub_f32 v148, v164, v73
    v_mul_f32 v148, v148, v148 clamp
    v_fmac_f32 v195, s22, v148
    v_sub_f32 v148, v75, v73
    v_mul_f32 v148, v148, v148 clamp
    v_fmac_f32 v183, s22, v148
    v_mad_u32_u24 v73, v160, 12, 4
    v_mul_u32_u24 v148, 37, v73
    v_lshrrev_b32 v72, 8, v148
    v_mad_i32_i24 v72, v72, -7, v73
    v_lshrrev_b32 v148, 10, v148
    v_lshrrev_b32 v72, 2, v72
    v_mul_u32_u24 v148, s20, v148
    v_mad_u32_u24 v73, v72, s21, v148
    v_cvt_f32_u32 v73, v73
    v_sub_f32 v148, v161, v73
    v_mul_f32 v148, v148, v148 clamp
    v_fmac_f32 v200, s22, v148
    v_sub_f32 v148, v164, v73
    v_mul_f32 v148, v148, v148 clamp
    v_fmac_f32 v188, s22, v148
    v_sub_f32 v148, v75, v73
    v_mul_f32 v148, v148, v148 clamp
    v_fmac_f32 v176, s22, v148
    v_mad_u32_u24 v73, v160, 12, 5
    v_mul_u32_u24 v148, 37, v73
    v_lshrrev_b32 v72, 8, v148
    v_mad_i32_i24 v72, v72, -7, v73
    v_lshrrev_b32 v148, 10, v148
    v_lshrrev_b32 v72, 2, v72
    v_mul_u32_u24 v148, s20, v148
    v_mad_u32_u24 v73, v72, s21, v148
    v_cvt_f32_u32 v73, v73
    v_sub_f32 v148, v161, v73
    v_mul_f32 v148, v148, v148 clamp
    v_fmac_f32 v201, s22, v148
    v_sub_f32 v148, v164, v73
    v_mul_f32 v148, v148, v148 clamp
    v_fmac_f32 v189, s22, v148
    v_sub_f32 v148, v75, v73
    v_mul_f32 v148, v148, v148 clamp
    v_fmac_f32 v177, s22, v148
    v_mad_u32_u24 v73, v160, 12, 6
    v_mul_u32_u24 v148, 37, v73
    v_lshrrev_b32 v72, 8, v148
    v_mad_i32_i24 v72, v72, -7, v73
    v_lshrrev_b32 v148, 10, v148
    v_lshrrev_b32 v72, 2, v72
    v_mul_u32_u24 v148, s20, v148
    v_mad_u32_u24 v73, v72, s21, v148
    v_cvt_f32_u32 v73, v73
    v_sub_f32 v148, v161, v73
    v_mul_f32 v148, v148, v148 clamp
    v_fmac_f32 v202, s22, v148
    v_sub_f32 v148, v164, v73
    v_mul_f32 v148, v148, v148 clamp
    v_fmac_f32 v190, s22, v148
    v_sub_f32 v148, v75, v73
    v_mul_f32 v148, v148, v148 clamp
    v_fmac_f32 v178, s22, v148
    v_mad_u32_u24 v73, v160, 12, 7
    v_mul_u32_u24 v148, 37, v73
    v_lshrrev_b32 v72, 8, v148
    v_mad_i32_i24 v72, v72, -7, v73
    v_lshrrev_b32 v148, 10, v148
    v_lshrrev_b32 v72, 2, v72
    v_mul_u32_u24 v148, s20, v148
    v_mad_u32_u24 v73, v72, s21, v148
    v_cvt_f32_u32 v73, v73
    v_sub_f32 v148, v161, v73
    v_mul_f32 v148, v148, v148 clamp
    v_fmac_f32 v203, s22, v148
    v_sub_f32 v148, v164, v73
    v_mul_f32 v148, v148, v148 clamp
    v_fmac_f32 v191, s22, v148
    v_sub_f32 v148, v75, v73
    v_mul_f32 v148, v148, v148 clamp
    v_fmac_f32 v179, s22, v148
    v_mad_u32_u24 v73, v160, 12, 8
    v_mul_u32_u24 v148, 37, v73
    v_lshrrev_b32 v72, 8, v148
    v_mad_i32_i24 v72, v72, -7, v73
    v_lshrrev_b32 v148, 10, v148
    v_lshrrev_b32 v72, 2, v72
    v_mul_u32_u24 v148, s20, v148
    v_mad_u32_u24 v73, v72, s21, v148
    v_cvt_f32_u32 v73, v73
    v_sub_f32 v148, v161, v73
    v_mul_f32 v148, v148, v148 clamp
    v_fmac_f32 v196, s22, v148
    v_sub_f32 v148, v164, v73
    v_mul_f32 v148, v148, v148 clamp
    v_fmac_f32 v184, s22, v148
    v_sub_f32 v148, v75, v73
    v_mul_f32 v148, v148, v148 clamp
    v_fmac_f32 v172, s22, v148
    v_mad_u32_u24 v73, v160, 12, 9
    v_mul_u32_u24 v148, 37, v73
    v_lshrrev_b32 v72, 8, v148
    v_mad_i32_i24 v72, v72, -7, v73
    v_lshrrev_b32 v148, 10, v148
    v_lshrrev_b32 v72, 2, v72
    v_mul_u32_u24 v148, s20, v148
    v_mad_u32_u24 v73, v72, s21, v148
    v_cvt_f32_u32 v73, v73
    v_sub_f32 v148, v161, v73
    v_mul_f32 v148, v148, v148 clamp
    v_fmac_f32 v197, s22, v148
    v_sub_f32 v148, v164, v73
    v_mul_f32 v148, v148, v148 clamp
    v_fmac_f32 v185, s22, v148
    v_sub_f32 v148, v75, v73
    v_mul_f32 v148, v148, v148 clamp
    v_fmac_f32 v173, s22, v148
    v_mad_u32_u24 v73, v160, 12, 10
    v_mul_u32_u24 v148, 37, v73
    v_lshrrev_b32 v72, 8, v148
    v_mad_i32_i24 v72, v72, -7, v73
    v_lshrrev_b32 v148, 10, v148
    v_lshrrev_b32 v72, 2, v72
    v_mul_u32_u24 v148, s20, v148
    v_mad_u32_u24 v73, v72, s21, v148
    v_cvt_f32_u32 v73, v73
    v_sub_f32 v148, v161, v73
    v_mul_f32 v148, v148, v148 clamp
    v_fmac_f32 v198, s22, v148
    v_sub_f32 v148, v164, v73
    v_mul_f32 v148, v148, v148 clamp
    v_fmac_f32 v186, s22, v148
    v_sub_f32 v148, v75, v73
    v_mul_f32 v148, v148, v148 clamp
    v_fmac_f32 v174, s22, v148
    v_mad_u32_u24 v73, v160, 12, 11
    v_mul_u32_u24 v148, 37, v73
    v_lshrrev_b32 v72, 8, v148
    v_mad_i32_i24 v72, v72, -7, v73
    v_lshrrev_b32 v148, 10, v148
    v_lshrrev_b32 v72, 2, v72
    v_mul_u32_u24 v148, s20, v148
    v_mad_u32_u24 v73, v72, s21, v148
    v_cvt_f32_u32 v73, v73
    v_sub_f32 v148, v161, v73
    v_mul_f32 v148, v148, v148 clamp
    v_fmac_f32 v199, s22, v148
    v_sub_f32 v148, v164, v73
    v_mul_f32 v148, v148, v148 clamp
    v_fmac_f32 v187, s22, v148
    v_sub_f32 v148, v75, v73
    v_mul_f32 v148, v148, v148 clamp
    v_fmac_f32 v175, s22, v148
    v_cvt_f32_u32 v73, s74
    v_sub_f32 v148, v161, v73
    v_mul_f32 v148, v148, v148 clamp
    v_fmac_f32 v208, s22, v148
    v_sub_f32 v148, v164, v73
    v_mul_f32 v148, v148, v148 clamp
    v_fmac_f32 v209, s22, v148
    v_sub_f32 v148, v75, v73
    v_mul_f32 v148, v148, v148 clamp
    v_fmac_f32 v210, s22, v148
    v_lshrrev_b32 v161, 2, v149
    v_lshl_add_u32 v161, v160, 2, v161
    v_add_u32 v148, 1, v160
    v_lshrrev_b32 v148, 2, v148
    v_mad_u32_u24 v161, v148, 36, v161
    v_min_u32 v161, 48, v161
    v_mul_u32_u24 v148, 37, v161
    v_lshrrev_b32 v72, 8, v148
    v_mad_i32_i24 v72, v72, -7, v161
    v_lshrrev_b32 v148, 10, v148
    v_lshrrev_b32 v72, 2, v72
    v_mul_u32_u24 v148, s20, v148
    v_mad_u32_u24 v161, v72, s21, v148
    v_cvt_f32_u32 v161, v161
    v_sub_f32 v148, v161, v73
    v_mul_f32 v148, v148, v148 clamp
    v_fmac_f32 v211, s22, v148
    s_branch L_nomaskS
L_atomS0:
    v_mov_b32 v122, 0x800000
    buffer_atomic_add v122, v129, s[8:11], 0 offen sc0 sc1
    s_branch L_atomS0r

.section .rodata,"a"
.p2align 6
.amdhsa_kernel standalone__window_attn_swin_v2__vision_kernel
  .amdhsa_next_free_vgpr 512
  .amdhsa_next_free_sgpr 102
  .amdhsa_accum_offset 256
  .amdhsa_group_segment_fixed_size 0
  .amdhsa_kernarg_size 96
  .amdhsa_user_sgpr_count 2
  .amdhsa_user_sgpr_kernarg_segment_ptr 1
  .amdhsa_system_sgpr_workgroup_id_x 1
.end_amdhsa_kernel
```

```asm
; @launch grid=(256,1,1) block=(256,1,1) lds=163840
.amdgcn_target "amdgcn-amd-amdhsa--gfx950"
.text
.globl standalone__window_attn_swin_v2__vision_kernel
.p2align 8
.type standalone__window_attn_swin_v2__vision_kernel,@function
standalone__window_attn_swin_v2__vision_kernel:
    v_lshrrev_b32 v0, 6, v0
    s_cmp_ge_u32 s2, 256
    s_cbranch_scc1 L_end
    v_readfirstlane_b32 s68, v0
L_top:
    s_mov_b32 s64, 0
    s_nop 0
L_top2:
    v_mbcnt_lo_u32_b32 v85, -1, 0
    v_mbcnt_hi_u32_b32 v85, -1, v85
    s_load_dwordx16 s[4:19], s[0:1], 0
    s_load_dwordx4 s[20:23], s[0:1], 64
    s_load_dwordx2 s[38:39], s[0:1], 80
    s_load_dwordx2 s[76:77], s[0:1], 88
    s_add_u32 s84, s2, s64
    s_sub_u32 s84, s84, 248
    s_cmp_lt_u32 s84, 3
    s_cbranch_scc1 L_prod
    s_bfe_u32 s88, s2, 0x50003
    s_lshl2_add_u32 s88, s88, s68
    v_lshlrev_b32 v84, 7, v85
    s_getpc_b64 s[80:81]
    s_mul_i32 s84, s88, 320
    v_min_u32 v86, 256, v84
    v_add_u32 v86, s84, v86
    v_min_u32 v86, L_slow-standalone__window_attn_swin_v2__vision_kernel-256, v86
    s_mul_i32 s88, s88, 1728
    s_mov_b32 s34, 221184
    global_load_dword a255, v86, s[80:81]
    v_min_u32 v10, 1664, v84
    s_mov_b32 s35, 0x20000
    s_mov_b32 s78, 73728
    s_mov_b32 s79, 0x20000
    v_and_b32 v50, 15, v85
    v_lshrrev_b32 v143, 4, v85
    v_lshrrev_b32 v8, 2, v50
    v_and_b32 v211, 3, v50
    s_mul_i32 s87, s68, 192
    v_mad_u32_u24 v23, v50, 12, s87
    v_lshlrev_b32 v9, 1, v50
    v_lshlrev_b32 v11, 1, v8
    v_lshl_add_u32 v11, v143, 5, v11
    s_movk_i32 s86, 384
    s_mov_b32 s26, 100270464
    s_mov_b32 s27, 0x20000
    s_mov_b32 s30, 0
    s_mov_b32 s31, 0x20000
    s_lshr_b32 s93, s2, 3
    s_mul_i32 s93, s93, 3185912
    s_min_u32 s44, s93, 100270460
    s_add_u32 s93, s93, 2097152
    s_min_u32 s45, s93, 100270460
    s_add_u32 s93, s93, 2097152
    s_min_u32 s46, s93, 100270460
    s_waitcnt lgkmcnt(0)
    s_load_dword s44, s[4:5], s44
    s_load_dword s45, s[4:5], s45
    s_load_dword s46, s[4:5], s46
    s_mov_b32 s24, s4
    s_mov_b32 s25, s5
    s_mov_b32 s32, s6
    s_mov_b32 s33, s7
    buffer_load_dword a254, v10, s[32:35], s88 offen
    s_load_dwordx2 s[82:83], s[10:11], 0
    s_movk_i32 s18, 676
    s_mov_b32 s19, 0x20000
    buffer_load_dwordx3 v[12:14], v23, s[16:19], 0 offen
    s_mul_i32 s96, s68, 288
    s_and_b32 s97, s68, 1
    s_lshl_b32 s97, s97, 2
    s_mov_b32 s98, 193536
    s_mov_b32 s99, 589824
    global_load_ushort v20, v9, s[12:13]
    v_add_u32 v10, s96, v85
    v_mul_u32_u24 v51, 2731, v10
    v_mul_u32_u24 v124, 6242, v10
    v_lshrrev_b32 v51, 16, v51
    v_lshrrev_b32 v124, 20, v124
    s_lshr_b32 s94, s2, 3
    s_mul_i32 s70, s94, 167
    global_load_ushort v21, v9, s[12:13] offset:32
    v_and_or_b32 v112, v51, 3, s97
    v_xor_b32 v112, v10, v112
    v_lshl_add_u32 v130, v112, 4, s99
    v_mad_u32_u24 v130, v124, s98, v130
    v_add_u32 v15, 64, v10
    s_min_u32 s95, s94, 7
    s_add_u32 s70, s70, s95
    global_load_ushort v48, v11, s[14:15] offset:0
    v_mul_u32_u24 v125, 2731, v15
    v_mul_u32_u24 v9, 6242, v15
    v_lshrrev_b32 v125, 16, v125
    v_lshrrev_b32 v9, 20, v9
    v_and_or_b32 v113, v125, 3, s97
    s_and_b32 s95, s2, 7
    s_mul_i32 s95, s95, 20
    global_load_ushort v186, v11, s[14:15] offset:8
    v_xor_b32 v113, v15, v113
    v_lshl_add_u32 v129, v113, 4, s99
    v_mad_u32_u24 v129, v9, s98, v129
    v_add_u32 v22, 128, v10
    v_mul_u32_u24 v131, 2731, v22
    s_add_u32 s69, s70, s95
    s_add_u32 s70, s70, 140
    global_load_ushort v49, v11, s[14:15] offset:16
    v_mul_u32_u24 v15, 6242, v22
    v_lshrrev_b32 v131, 16, v131
    v_lshrrev_b32 v15, 20, v15
    v_and_or_b32 v114, v131, 3, s97
    v_xor_b32 v114, v22, v114
    s_movk_i32 s62, 2688
    s_movk_i32 s71, 20
    global_load_ushort v159, v11, s[14:15] offset:24
    v_lshl_add_u32 v128, v114, 4, s99
    v_mad_u32_u24 v128, v15, s98, v128
    v_add_u32 v126, 192, v10
    v_mul_u32_u24 v11, 2731, v126
    v_mul_u32_u24 v115, 6242, v126
    v_lshrrev_b32 v11, 16, v11
    v_lshrrev_b32 v115, 20, v115
    v_and_or_b32 v22, v11, 3, s97
    v_xor_b32 v22, v126, v22
    v_lshl_add_u32 v127, v22, 4, s99
    v_mad_u32_u24 v127, v115, s98, v127
    v_add_u32 v126, 256, v10
    v_mul_u32_u24 v22, 2731, v126
    v_mul_u32_u24 v10, 6242, v126
    v_lshrrev_b32 v22, 16, v22
    v_lshrrev_b32 v10, 20, v10
    v_and_or_b32 v84, v22, 3, s97
    v_xor_b32 v84, v126, v84
    v_lshl_add_u32 v126, v84, 4, s99
    v_mad_u32_u24 v126, v10, s98, v126
    s_cmp_lt_u32 s94, 7
    s_cselect_b32 s73, 28, 27
    s_mov_b32 s93, 1769472
    s_mul_i32 s54, s68, 5120
    s_cmp_ge_u32 s2, 248
    s_cbranch_scc1 L_bndF
L_bndrF:
    s_mov_b32 s63, 1180032
    s_mul_i32 s94, s69, 58255
    s_lshr_b32 s94, s94, 22
    s_mul_i32 s94, s94, s63
    s_mul_i32 s72, s69, s62
    s_add_u32 s72, s72, s94
    v_lshl_or_b32 v124, v85, 4, 2.0
    s_sub_u32 s94, s73, 1
    s_max_u32 s94, s94, 20
    s_mul_i32 s95, s68, -44
    s_movk_i32 s99, -24
    s_add_u32 m0, s54, 0
    v_and_b32 v22, -4, v131
    s_mul_i32 s85, s68, 96
    s_sub_u32 s100, s85, 1024
    buffer_load_dwordx4 v130, s[24:27], s72 offen nt lds
    s_add_u32 m0, s54, 1024
    v_mad_u32_u24 v15, v22, 3, v131
    v_add_u32 v15, s95, v15
    v_mad_i32_i24 v114, v131, s99, v114
    v_med3_u32 v22, v15, 20, s94
    v_add_u32 v22, s70, v22
    v_add_u32 v115, s69, v15
    s_sub_u32 s87, s85, 2048
    s_movk_i32 s91, 1152
    buffer_load_dwordx4 v129, s[24:27], s72 offen nt lds
    v_cmp_gt_u32 vcc, s71, v15
    v_lshl_add_u32 v114, v114, 4, s93
    s_add_u32 m0, s54, 43008
    v_cndmask_b32 v115, v22, v115, vcc
    v_mul_u32_u24 v22, 58255, v115
    v_mad_u32_u24 v114, v115, s62, v114
    v_lshrrev_b32 v22, 22, v22
    v_mad_u32_u24 v114, v22, s63, v114
    s_mul_i32 s90, s68, 3072
    s_add_u32 s90, s90, 61440
    buffer_load_dwordx4 v114, s[24:27], 0 offen  lds
    v_lshlrev_b32 v115, 16, v15
    s_add_u32 m0, s54, 2048
    v_and_b32 v22, -4, v125
    v_mad_u32_u24 v15, v22, 3, v125
    v_add_u32 v15, s95, v15
    v_mad_i32_i24 v113, v125, s99, v113
    v_med3_u32 v22, v15, 20, s94
    s_mov_b32 s30, 100270464
    s_mov_b32 s28, s22
    buffer_load_dwordx4 v128, s[24:27], s72 offen nt lds
    v_add_u32 v22, s70, v22
    v_add_u32 v125, s69, v15
    v_cmp_gt_u32 vcc, s71, v15
    v_lshl_add_u32 v113, v113, 4, s93
    s_add_u32 m0, s54, 41984
    v_cndmask_b32 v125, v22, v125, vcc
    v_mul_u32_u24 v22, 58255, v125
    v_mad_u32_u24 v113, v125, s62, v113
    v_lshrrev_b32 v22, 22, v22
    v_mad_u32_u24 v113, v22, s63, v113
    s_mov_b32 s29, s23
    s_mov_b32 s41, 0x2a8cbccc
    buffer_load_dwordx4 v113, s[24:27], 0 offen  lds
    v_lshl_or_b32 v115, v15, 8, v115
    s_add_u32 m0, s54, 3072
    v_cmp_gt_u32 vcc, 32, v85
    v_and_b32 v15, -4, v51
    v_mad_u32_u24 v22, v15, 3, v51
    v_cndmask_b32 v126, v124, v126, vcc
    v_add_u32 v22, s95, v22
    s_mov_b32 s42, 0x38fba882
    s_mov_b32 s43, 0x415db3d7
    buffer_load_dwordx4 v127, s[24:27], s72 offen nt lds
    s_add_u32 m0, s54, 4096
    v_mad_i32_i24 v112, v51, s99, v112
    v_med3_u32 v15, v22, 20, s94
    v_add_u32 v15, s70, v15
    v_add_u32 v51, s69, v22
    v_cmp_gt_u32 vcc, s71, v22
    v_lshl_add_u32 v112, v112, 4, s93
    s_add_u32 s101, s54, 44032
    s_mul_i32 s93, s68, 6
    buffer_load_dwordx4 v126, s[24:27], s72 offen nt lds
    v_cndmask_b32 v51, v15, v51, vcc
    v_mul_u32_u24 v15, 58255, v51
    v_mad_u32_u24 v112, v51, s62, v112
    v_lshrrev_b32 v15, 22, v15
    v_mad_u32_u24 v112, v15, s63, v112
    s_add_u32 m0, s54, 40960
    v_lshl_or_b32 v115, v22, 0, v115
    s_lshl_b32 s94, s97, 1
    s_mov_b32 s57, s72
    buffer_load_dwordx4 v112, s[24:27], 0 offen nt lds
    v_mul_u32_u24 v15, 10923, v85
    v_lshrrev_b32 v84, 17, v15
    v_lshrrev_b32 v15, 16, v15
    v_mad_i32_i24 v22, v15, -6, v85
    v_bitop3_b32 v84, v84, v15, 4 bitop3:0x28
    v_lshl_add_u32 v22, v22, 4, s85
    v_mul_u32_u24 v84, 3, v84
    v_xor_b32 v15, v15, v84
    v_mad_u32_u24 v84, v15, s91, v22
    v_add_u32 v15, 64, v85
    v_mul_u32_u24 v22, 10923, v15
    v_lshrrev_b32 v37, 17, v22
    v_lshrrev_b32 v22, 16, v22
    v_mad_i32_i24 v15, v22, -6, v15
    v_bitop3_b32 v37, v37, v22, 4 bitop3:0x28
    v_lshl_add_u32 v15, v15, 4, s100
    v_mul_u32_u24 v37, 3, v37
    v_xor_b32 v22, v22, v37
    v_mad_u32_u24 v37, v22, s91, v15
    v_add_u32 v22, 128, v85
    v_mul_u32_u24 v15, 10923, v22
    v_lshrrev_b32 v11, 17, v15
    v_lshrrev_b32 v15, 16, v15
    v_mad_i32_i24 v22, v15, -6, v22
    v_bitop3_b32 v11, v11, v15, 4 bitop3:0x28
    v_lshl_add_u32 v22, v22, 4, s87
    v_mul_u32_u24 v11, 3, v11
    v_xor_b32 v15, v15, v11
    v_mad_u32_u24 v11, v15, s91, v22
    s_add_u32 m0, s90, 0
    s_mov_b32 s92, 0
    buffer_load_dwordx4 v84, s[32:35], s92 offen offset:0 lds
    v_lshrrev_b32 v22, 1, v143
    v_lshl_add_u32 v15, v143, 2, v8
    v_lshl_add_u32 v15, v22, 3, v15
    v_mul_u32_u24 v15, 96, v15
    v_add_u32 v15, s90, v15
    v_lshl_add_u32 v158, v211, 4, v15
    v_lshl_add_u32 v51, v211, 3, v15
    s_waitcnt lgkmcnt(0)
    s_lshl_b32 s85, s68, 4
    buffer_load_dwordx4 v37, s[32:35], s92 offen offset:1024 lds
    v_lshlrev_b32 v15, 4, v143
    v_lshrrev_b64 v[86:87], v15, s[82:83]
    v_lshlrev_b32 v15, 16, v86
    v_min_f32 v15, 0x40930000, v15
    v_max_f32 v15, 0xc2c80000, v15
    v_mul_f32 v15, 0x3fb8aa3b, v15
    v_exp_f32 v15, v15
    s_mov_b32 s84, 0x41b8aa3b
    s_mov_b32 s44, 61440
    buffer_load_dwordx4 v11, s[32:35], s92 offen offset:2048 lds
    s_add_u32 m0, s90, 12288
    s_mov_b32 s92, 36864
    v_cvt_pk_bf16_f32 v15, v15, v15
    v_lshlrev_b32 v15, 16, v15
    v_mul_f32 v15, 0x4038aa3b, v15
    v_mov_b32 v187, 0xc138aa3b
    v_readlane_b32 s55, v15, s85
    v_fmac_f32 v187, 0xbe333333, v15
    v_add_f32 v15, v15, v15
    v_mov_b32 v22, 0
    v_readlane_b32 s52, v15, s85
    v_mov_b32 v15, 0
    v_mul_u32_u24 v131, 5120, v143
    v_add_u32 v131, v23, v131
    v_mul_u32_u24 v139, 48, v8
    v_lshl_add_u32 v139, v211, 2, v139
    v_mul_u32_u24 v125, 48, v143
    v_add_u32 v199, 0, v139
    v_mul_u32_u24 v23, 37, v199
    v_lshrrev_b32 v23, 10, v23
    v_mad_u32_u24 v199, v23, 24, v199
    v_add_u32 v199, s101, v199
    v_add_u32 v138, 16, v139
    v_mul_u32_u24 v23, 37, v138
    v_lshrrev_b32 v23, 10, v23
    v_mad_u32_u24 v138, v23, 24, v138
    v_add_u32 v138, s101, v138
    v_add_u32 v175, 32, v139
    v_mul_u32_u24 v23, 37, v175
    v_lshrrev_b32 v23, 10, v23
    v_mad_u32_u24 v175, v23, 24, v175
    v_add_u32 v175, s101, v175
    v_add_u32 v184, 0, v125
    v_mul_u32_u24 v23, 37, v184
    v_lshrrev_b32 v23, 10, v23
    v_mad_u32_u24 v184, v23, 24, v184
    v_add_u32 v185, 4, v125
    v_mul_u32_u24 v23, 37, v185
    v_lshrrev_b32 v23, 10, v23
    v_mad_u32_u24 v185, v23, 24, v185
    v_add_u32 v156, 8, v125
    v_mul_u32_u24 v23, 37, v156
    v_lshrrev_b32 v23, 10, v23
    v_mad_u32_u24 v156, v23, 24, v156
    v_add_u32 v157, 12, v125
    v_mul_u32_u24 v23, 37, v157
    v_lshrrev_b32 v23, 10, v23
    v_mad_u32_u24 v157, v23, 24, v157
    v_add_u32 v188, 16, v125
    v_mul_u32_u24 v23, 37, v188
    v_lshrrev_b32 v23, 10, v23
    v_mad_u32_u24 v188, v23, 24, v188
    v_add_u32 v189, 20, v125
    v_mul_u32_u24 v23, 37, v189
    v_lshrrev_b32 v23, 10, v23
    v_mad_u32_u24 v189, v23, 24, v189
    v_add_u32 v190, 24, v125
    v_mul_u32_u24 v23, 37, v190
    v_lshrrev_b32 v23, 10, v23
    v_mad_u32_u24 v190, v23, 24, v190
    s_mov_b32 s45, 40960
    s_mov_b32 s46, 20480
    buffer_load_dwordx4 v84, s[32:35], s92 offen offset:0 lds
    v_add_u32 v191, 28, v125
    v_mul_u32_u24 v23, 37, v191
    v_lshrrev_b32 v23, 10, v23
    v_mad_u32_u24 v191, v23, 24, v191
    v_add_u32 v86, 32, v125
    v_mul_u32_u24 v23, 37, v86
    v_lshrrev_b32 v23, 10, v23
    s_mov_b32 s47, 0
    s_mov_b32 s58, 0
    buffer_load_dwordx4 v37, s[32:35], s92 offen offset:1024 lds
    s_waitcnt vmcnt(17)
    v_lshl_or_b32 v20, v21, 16, v20
    v_cmp_gt_u32 vcc, 16, v85
    v_mov_b32 v21, 0
    v_mad_u32_u24 v86, v23, 24, v86
    v_cndmask_b32 v23, 0, v20, vcc
    v_cndmask_b32 v20, 0, v20, vcc
    v_add_u32 v87, 36, v125
    v_mfma_f32_16x16x16_bf16 v[0:3], v[22:23], v[12:13], 0
    s_waitcnt vmcnt(15)
    s_mov_b32 s59, 0
    v_lshl_or_b32 v48, v186, 16, v48
    v_mul_u32_u24 v186, 37, v87
    v_mfma_f32_16x16x16_bf16 v[4:7], v[20:21], v[12:13], 0
    s_mov_b32 s60, 0
    v_lshrrev_b32 v186, 10, v186
    v_mad_u32_u24 v87, v186, 24, v87
    v_mfma_f32_16x16x16_bf16 v[16:19], v[20:21], v[14:15], 0
    s_waitcnt vmcnt(13)
    s_mov_b32 s65, -1
    buffer_load_dwordx4 v11, s[32:35], s92 offen offset:2048 lds
    v_lshl_or_b32 v49, v159, 16, v49
    v_max_f32 v0, 0, v0
    v_max_f32 v4, 0, v4
    s_add_u32 m0, s90, 24576
    s_mov_b32 s92, 73728
    v_max_f32 v5, 0, v5
    v_max_f32 v6, 0, v6
    v_max_f32 v7, 0, v7
    v_cvt_pk_bf16_f32 v4, v4, v5
    v_cvt_pk_bf16_f32 v5, v6, v7
    v_max_f32 v1, 0, v1
    v_max_f32 v2, 0, v2
    v_mfma_f32_16x16x16_bf16 v[12:15], v[48:49], v[4:5], 0
    s_mov_b32 s61, 1
    v_max_f32 v3, 0, v3
    v_cvt_pk_bf16_f32 v0, v0, v1
    v_cvt_pk_bf16_f32 v1, v2, v3
    v_max_f32 v16, 0, v16
    v_max_f32 v17, 0, v17
    v_mfma_f32_16x16x16_bf16 v[4:7], v[48:49], v[0:1], 0
    s_movk_i32 s4, 112
    v_max_f32 v18, 0, v18
    v_max_f32 v19, 0, v19
    v_cvt_pk_bf16_f32 v16, v16, v17
    v_cvt_pk_bf16_f32 v17, v18, v19
    v_cvt_pk_bf16_f32 v12, v12, v12
    v_lshlrev_b32 v12, 16, v12
    v_mfma_f32_16x16x16_bf16 v[0:3], v[48:49], v[16:17], 0
    s_mov_b32 s5, 0
    v_mul_f32 v12, 0xbfb8aa3b, v12
    v_cvt_pk_bf16_f32 v4, v4, v4
    v_exp_f32 v12, v12
    v_lshlrev_b32 v4, 16, v4
    v_add_f32 v12, 1.0, v12
    v_rcp_f32 v12, v12
    v_mul_f32 v4, 0xbfb8aa3b, v4
    v_cvt_pk_bf16_f32 v12, v12, v12
    v_lshlrev_b32 v12, 16, v12
    v_fma_f32 v12, v12, s84, v187
    s_mov_b32 s6, 0
    s_mov_b32 s12, 0
    ds_write_b32 v131, v12 offset:44032
    v_exp_f32 v4, v4
    v_cvt_pk_bf16_f32 v0, v0, v0
    v_add_f32 v4, 1.0, v4
    v_rcp_f32 v4, v4
    v_lshlrev_b32 v0, 16, v0
    v_cvt_pk_bf16_f32 v4, v4, v4
    v_lshlrev_b32 v4, 16, v4
    v_fma_f32 v4, v4, s84, v187
    s_mov_b32 s64, 3
    s_mov_b32 s10, 81924
    ds_write_b32 v131, v4 offset:44036
    v_mul_f32 v0, 0xbfb8aa3b, v0
    v_exp_f32 v0, v0
    v_add_u32 v186, 40, v125
    v_add_f32 v0, 1.0, v0
    v_rcp_f32 v0, v0
    v_mul_u32_u24 v159, 37, v186
    v_cvt_pk_bf16_f32 v0, v0, v0
    v_lshlrev_b32 v0, 16, v0
    v_fma_f32 v0, v0, s84, v187
    s_mov_b32 s11, 0x20000
    s_mov_b32 s3, 0x00010001
    ds_write_b32 v131, v0 offset:44040
    v_lshrrev_b32 v159, 10, v159
    v_mad_u32_u24 v186, v159, 24, v186
    v_add_u32 v187, 44, v125
    v_mul_u32_u24 v125, 37, v187
    v_lshrrev_b32 v125, 10, v125
    v_mad_u32_u24 v187, v125, 24, v187
    v_lshl_add_u32 v131, v143, 4, v139
    v_mul_u32_u24 v125, 37, v131
    v_lshrrev_b32 v125, 10, v125
    v_mad_u32_u24 v131, v125, 24, v131
    v_mov_b32 v10, 336
    v_cmp_gt_u32 vcc, 3, v143
    v_mov_b32 v125, 0x3f803f80
    v_and_b32 v9, 1, v85
    v_cndmask_b32 v131, v10, v131, vcc
    v_sub_u32 v131, s101, v131
    v_cmp_eq_u32 vcc, 0, v211
    v_lshlrev_b32 v9, 4, v9
    v_mov_b32 v159, 0x3f80
    v_cndmask_b32 v220, 0, v125, vcc
    v_cndmask_b32 v221, 0, v125, vcc
    v_cndmask_b32 v222, 0, v125, vcc
    v_cndmask_b32 v223, 0, v125, vcc
    v_lshlrev_b32 v125, v9, v159
    v_cmp_gt_u32 vcc, 2, v211
    v_mov_b32 v215, 0x44004400
    v_mov_b32 v89, 0xf149f2ca
    v_cndmask_b32 v216, 0, v125, vcc
    v_cndmask_b32 v218, 0, v125, vcc
    v_cmp_le_u32 vcc, 2, v211
    v_mul_u32_u24 v209, 5120, v8
    v_mad_u32_u24 v209, v211, s86, v209
    v_cndmask_b32 v217, 0, v125, vcc
    s_waitcnt lgkmcnt(0)
    s_barrier
    v_cndmask_b32 v219, 0, v125, vcc
    v_cmp_eq_u32 vcc, 0, v211
    v_and_b32 v159, 7, v50
    v_xor_b32 v125, v159, v143
    v_cndmask_b32 v212, 0, v215, vcc
    v_cmp_eq_u32 vcc, 1, v211
    v_lshl_add_u32 v49, v125, 4, v209
    v_xor_b32 v48, 64, v49
    v_cndmask_b32 v213, 0, v215, vcc
    v_cmp_eq_u32 vcc, 2, v211
    v_add_u32 v137, 40960, v49
    v_xor_b32 v136, 64, v137
    v_cndmask_b32 v214, 0, v215, vcc
    v_cmp_eq_u32 vcc, 3, v211
    v_add_u32 v209, 61440, v209
    v_add_u32 v125, s93, v143
    v_cndmask_b32 v215, 0, v215, vcc
    v_xor_b32 v125, v159, v125
    v_lshl_add_u32 v135, v125, 4, v209
    v_lshrrev_b32 v125, 1, v143
    v_add3_u32 v125, v125, s93, 4
    v_xor_b32 v125, v159, v125
    v_lshl_add_u32 v125, v125, 4, v209
    v_and_b32 v209, 1, v143
    v_lshl_add_u32 v134, v209, 3, v125
    v_lshlrev_b32 v125, 4, v85
    s_add_u32 s93, s54, 20480
    v_add_u32 v133, s93, v125
    v_add_u32 v163, 81920, v125
    s_lshr_b32 s93, s68, 1
    s_lshl_b32 s93, s93, 10
    s_add_u32 s93, s93, s94
    ds_read_b32 v210, v175
    v_add_u32 v159, s93, v163
    s_mul_i32 s93, s68, 7168
    s_add_u32 s93, s93, 135168
    v_mul_u32_u24 v209, 1792, v143
    v_add_u32 v125, s93, v209
    v_mul_u32_u24 v209, 112, v50
    v_add_u32 v50, v209, v125
    v_subrev_u32 v50, 28672, v50
    v_cmp_eq_u32 vcc, 0, v8
    v_add_u32 v209, 16, v125
    buffer_load_dwordx4 v84, s[32:35], s92 offen offset:0 lds
    ds_read_b32 v208, v199
    v_cndmask_b32 v132, v124, v125, vcc
    v_cmp_eq_u32 vcc, 3, v211
    v_mov_b32 v125, 0
    v_mov_b32 v167, 0
    v_cndmask_b32 v132, v132, v209, vcc
    v_mul_u32_u24 v209, 1792, v8
    v_lshl_add_u32 v209, v143, 3, v209
    v_lshl_add_u32 v209, v211, 1, v209
    v_add_u32 v209, s93, v209
    v_cmp_gt_u32 vcc, 3, v143
    s_add_u32 s93, s69, 1
    s_mul_i32 s94, s93, 58255
    ds_read_b32 v211, v131 offset:672
    v_cndmask_b32 v131, v124, v209, vcc
    s_lshr_b32 s94, s94, 22
    s_mul_i32 s94, s94, s63
    s_mul_i32 s56, s93, s62
    s_add_u32 s56, s56, s94
    ds_read_b32 v209, v138
    v_mov_b32 v124, 0
    s_sub_u32 s93, s71, 1
    s_cmp_eq_u32 s68, 0
    buffer_load_dwordx4 v37, s[32:35], s92 offen offset:1024 lds
    s_cselect_b32 s13, s93, -1
    s_cmp_gt_u32 s73, 20
    s_cselect_b32 s13, s13, -1
    s_and_b32 s93, s2, -8
    s_sub_u32 s93, 81920, s93
    s_sub_u32 s8, s38, s93
    s_subb_u32 s9, s39, 0
    v_sub_u32 v180, v175, v184
    buffer_load_dwordx4 v11, s[32:35], s92 offen offset:2048 lds
    s_add_u32 m0, s90, 36864
    s_mov_b32 s92, 110592
    ds_read_b32 v180, v180 offset:336
    v_sub_u32 v181, v175, v185
    v_sub_u32 v182, v175, v156
    v_sub_u32 v183, v175, v157
    v_sub_u32 v176, v175, v188
    v_sub_u32 v177, v175, v189
    ds_read_b32 v181, v181 offset:336
    v_sub_u32 v178, v175, v190
    v_sub_u32 v179, v175, v191
    v_sub_u32 v172, v175, v86
    v_sub_u32 v173, v175, v87
    v_sub_u32 v174, v175, v186
    ds_read_b32 v182, v182 offset:336
    v_sub_u32 v175, v175, v187
    v_sub_u32 v204, v199, v184
    v_sub_u32 v205, v199, v185
    buffer_load_dwordx4 v84, s[32:35], s92 offen offset:0 lds
    ds_read_b32 v183, v183 offset:336
    v_sub_u32 v206, v199, v156
    v_sub_u32 v207, v199, v157
    v_sub_u32 v200, v199, v188
    v_sub_u32 v201, v199, v189
    v_sub_u32 v202, v199, v190
    ds_read_b32 v176, v176 offset:336
    s_mov_b64 exec, 0
    s_cmp_eq_u32 s68, 2
    s_cbranch_scc1 L_pga
    s_cmp_eq_u32 s68, 3
    s_cbranch_scc1 L_pg2
    s_cmp_eq_u32 s68, 1
    s_cbranch_scc1 L_pg1
    s_branch L_pg0
L_prod:
    v_mbcnt_lo_u32_b32 v1, -1, 0
    v_mbcnt_hi_u32_b32 v1, -1, v1
    v_and_b32 v2, 15, v1
    v_lshrrev_b32 v3, 4, v1
    v_lshrrev_b32 v4, 2, v2
    v_and_b32 v5, 3, v2
    v_lshl_add_u32 v6, v4, 3, v5
    v_mul_u32_u24 v6, 384, v6
    s_lshr_b32 s85, s68, 1
    s_lshl1_add_u32 s84, s84, s85
    s_mul_i32 s85, s84, 12288
    v_add_u32 v6, s85, v6
    v_lshl_add_u32 v7, v3, 4, v6
    v_lshl_add_u32 v8, v3, 3, v6
    s_and_b32 s85, s68, 1
    s_mul_i32 s86, s85, 192
    s_sub_u32 s87, 192, s86
    s_mul_i32 s85, s85, 36
    s_add_u32 s85, s85, s84
    s_lshl_b32 s85, s85, 10
    v_lshl_add_u32 v18, v1, 4, s85
    v_mov_b32 v10, 0
    s_waitcnt lgkmcnt(0)
    s_mov_b32 s10, 73728
    s_mov_b32 s11, 0x20000
    s_mov_b32 s78, 73728
    s_mov_b32 s79, 0x20000
    buffer_load_dwordx4 v[20:23], v7, s[8:11], s86 offen offset:0
    buffer_load_dwordx2 v[36:37], v8, s[8:11], s86 offen offset:64
    buffer_load_dwordx4 v[24:27], v7, s[8:11], s86 offen offset:96
    buffer_load_dwordx2 v[38:39], v8, s[8:11], s86 offen offset:160
    buffer_load_dwordx4 v[28:31], v7, s[8:11], s87 offen offset:0
    buffer_load_dwordx2 v[40:41], v8, s[8:11], s87 offen offset:64
    buffer_load_dwordx4 v[32:35], v7, s[8:11], s87 offen offset:96
    buffer_load_dwordx2 v[42:43], v8, s[8:11], s87 offen offset:160
    buffer_load_dwordx4 v[44:47], v7, s[8:11], s86 offen offset:1536
    buffer_load_dwordx2 v[60:61], v8, s[8:11], s86 offen offset:1600
    buffer_load_dwordx4 v[48:51], v7, s[8:11], s86 offen offset:1632
    buffer_load_dwordx2 v[62:63], v8, s[8:11], s86 offen offset:1696
    buffer_load_dwordx4 v[52:55], v7, s[8:11], s87 offen offset:1536
    buffer_load_dwordx2 v[64:65], v8, s[8:11], s87 offen offset:1600
    buffer_load_dwordx4 v[56:59], v7, s[8:11], s87 offen offset:1632
    buffer_load_dwordx2 v[66:67], v8, s[8:11], s87 offen offset:1696
    s_add_u32 s88, s76, 0x18000
    s_addc_u32 s89, s77, 0
    global_load_dword v9, v10, s[88:89]
    global_load_dword v19, v10, s[38:39] offset:248 sc1
    v_mov_b32 v12, 0x3f803f80
    v_mov_b32 v13, 0x3f803f80
    v_mov_b32 v14, 0x3f803f80
    v_mov_b32 v15, 0x3f803f80
    v_and_b32 v10, 1, v1
    v_lshlrev_b32 v10, 4, v10
    v_mov_b32 v11, 0x3f80
    v_lshlrev_b32 v10, v10, v11
    v_cmp_eq_u32 vcc, v3, v4
    s_nop 1
    v_cndmask_b32 v10, 0, v10, vcc
    v_cmp_gt_u32 vcc, 2, v5
    s_nop 1
    v_cndmask_b32 v16, 0, v10, vcc
    v_cmp_le_u32 vcc, 2, v5
    s_nop 1
    v_cndmask_b32 v17, 0, v10, vcc
    s_waitcnt vmcnt(2)
    v_mfma_f32_16x16x32_bf16 v[68:71], v[20:23], v[12:15], 0
    v_mfma_f32_16x16x32_bf16 v[68:71], v[24:27], v[12:15], v[68:71]
    v_mfma_f32_16x16x32_bf16 v[68:71], v[28:31], v[12:15], v[68:71]
    v_mfma_f32_16x16x32_bf16 v[68:71], v[32:35], v[12:15], v[68:71]
    v_mfma_f32_16x16x32_bf16 v[68:71], v[36:39], v[12:15], v[68:71]
    v_mfma_f32_16x16x32_bf16 v[68:71], v[40:43], v[12:15], v[68:71]
    v_mfma_f32_16x16x32_bf16 v[72:75], v[44:47], v[12:15], 0
    v_mfma_f32_16x16x32_bf16 v[72:75], v[48:51], v[12:15], v[72:75]
    v_mfma_f32_16x16x32_bf16 v[72:75], v[52:55], v[12:15], v[72:75]
    v_mfma_f32_16x16x32_bf16 v[72:75], v[56:59], v[12:15], v[72:75]
    v_mfma_f32_16x16x32_bf16 v[72:75], v[60:63], v[12:15], v[72:75]
    v_mfma_f32_16x16x32_bf16 v[72:75], v[64:67], v[12:15], v[72:75]
    s_nop 1
    v_mul_f32 v68, 0xbbaaaaab, v68
    v_mul_f32 v69, 0xbbaaaaab, v69
    v_mul_f32 v70, 0xbbaaaaab, v70
    v_mul_f32 v71, 0xbbaaaaab, v71
    s_nop 1
    v_mfma_f32_16x16x16_bf16 v[76:79], v[20:21], v[16:17], v[68:71]
    v_mfma_f32_16x16x16_bf16 v[80:83], v[22:23], v[16:17], v[68:71]
    v_mfma_f32_16x16x16_bf16 v[84:87], v[36:37], v[16:17], v[68:71]
    v_mfma_f32_16x16x16_bf16 v[88:91], v[24:25], v[16:17], v[68:71]
    v_mfma_f32_16x16x16_bf16 v[92:95], v[26:27], v[16:17], v[68:71]
    v_mfma_f32_16x16x16_bf16 v[96:99], v[38:39], v[16:17], v[68:71]
    v_mul_f32 v72, 0xbbaaaaab, v72
    v_mul_f32 v73, 0xbbaaaaab, v73
    v_mul_f32 v74, 0xbbaaaaab, v74
    v_mul_f32 v75, 0xbbaaaaab, v75
    s_nop 1
    v_mfma_f32_16x16x16_bf16 v[100:103], v[44:45], v[16:17], v[72:75]
    v_mfma_f32_16x16x16_bf16 v[104:107], v[46:47], v[16:17], v[72:75]
    v_mfma_f32_16x16x16_bf16 v[108:111], v[60:61], v[16:17], v[72:75]
    v_mfma_f32_16x16x16_bf16 v[112:115], v[48:49], v[16:17], v[72:75]
    v_mfma_f32_16x16x16_bf16 v[116:119], v[50:51], v[16:17], v[72:75]
    v_mfma_f32_16x16x16_bf16 v[120:123], v[62:63], v[16:17], v[72:75]
    v_cvt_pk_bf16_f32 v124, v76, v77
    v_cvt_pk_bf16_f32 v125, v78, v79
    s_nop 0
    v_cvt_pk_bf16_f32 v126, v100, v101
    v_cvt_pk_bf16_f32 v127, v102, v103
    s_movk_i32 s85, 0
    buffer_store_dwordx4 v[124:127], v18, s[76:79], s85 offen sc1
    v_cvt_pk_bf16_f32 v128, v80, v81
    v_cvt_pk_bf16_f32 v129, v82, v83
    v_cvt_pk_bf16_f32 v130, v104, v105
    v_cvt_pk_bf16_f32 v131, v106, v107
    s_movk_i32 s85, 6144
    buffer_store_dwordx4 v[128:131], v18, s[76:79], s85 offen sc1
    v_cvt_pk_bf16_f32 v132, v84, v85
    v_cvt_pk_bf16_f32 v133, v86, v87
    v_cvt_pk_bf16_f32 v134, v108, v109
    v_cvt_pk_bf16_f32 v135, v110, v111
    s_movk_i32 s85, 12288
    buffer_store_dwordx4 v[132:135], v18, s[76:79], s85 offen sc1
    v_cvt_pk_bf16_f32 v136, v88, v89
    v_cvt_pk_bf16_f32 v137, v90, v91
    v_cvt_pk_bf16_f32 v138, v112, v113
    v_cvt_pk_bf16_f32 v139, v114, v115
    s_movk_i32 s85, 18432
    buffer_store_dwordx4 v[136:139], v18, s[76:79], s85 offen sc1
    v_cvt_pk_bf16_f32 v140, v92, v93
    v_cvt_pk_bf16_f32 v141, v94, v95
    v_cvt_pk_bf16_f32 v142, v116, v117
    v_cvt_pk_bf16_f32 v143, v118, v119
    s_movk_i32 s85, 24576
    buffer_store_dwordx4 v[140:143], v18, s[76:79], s85 offen sc1
    v_cvt_pk_bf16_f32 v144, v96, v97
    v_cvt_pk_bf16_f32 v145, v98, v99
    v_cvt_pk_bf16_f32 v146, v120, v121
    v_cvt_pk_bf16_f32 v147, v122, v123
    s_movk_i32 s85, 30720
    buffer_store_dwordx4 v[144:147], v18, s[76:79], s85 offen sc1
    v_mov_b32 v10, 0
    v_mov_b32 v11, 1
    s_mov_b32 s64, 8
    s_waitcnt vmcnt(0)
    s_barrier
    s_cmp_lg_u32 s68, 0
    s_cbranch_scc1 L_top2
    s_mov_b64 exec, 1
    global_atomic_add v10, v11, s[38:39] offset:248 sc1
    s_mov_b64 exec, -1
    s_branch L_top2
L_bndF:
    s_movk_i32 s73, 20
    s_movk_i32 s71, 18
    s_movk_i32 s70, -20
    s_mov_b32 s74, 0
    s_bitcmp1_b32 s2, 2
    s_cbranch_scc1 L_bndcF
    s_sub_u32 s94, s2, 248
    s_mul_i32 s69, s94, 18
    s_mov_b32 s74, 2
    s_sub_u32 s93, s93, 1373568
    v_cmp_le_u32 vcc, 4, v124
    v_add_u32 v86, 98896896, v130
    v_subrev_u32 v87, 1373568, v130
    v_cndmask_b32 v130, v86, v87, vcc
    v_cmp_le_u32 vcc, 4, v9
    v_add_u32 v86, 98896896, v129
    v_subrev_u32 v87, 1373568, v129
    v_cndmask_b32 v129, v86, v87, vcc
    v_cmp_le_u32 vcc, 4, v15
    v_add_u32 v86, 98896896, v128
    v_subrev_u32 v87, 1373568, v128
    v_cndmask_b32 v128, v86, v87, vcc
    v_cmp_le_u32 vcc, 4, v115
    v_add_u32 v86, 98896896, v127
    v_subrev_u32 v87, 1373568, v127
    v_cndmask_b32 v127, v86, v87, vcc
    v_cmp_le_u32 vcc, 4, v10
    v_add_u32 v86, 98896896, v126
    v_subrev_u32 v87, 1373568, v126
    v_cndmask_b32 v126, v86, v87, vcc
    s_cmp_lt_u32 s2, 256
    s_cbranch_scc1 L_bndrF
L_bndcF:
    s_sub_u32 s94, s2, 252
    s_mul_i32 s69, s94, 20
    s_lshr_b32 s71, s94, 1
    s_sub_u32 s69, s69, s71
    s_and_b32 s94, s94, 1
    s_sub_u32 s71, 20, s94
    s_cmp_eq_u32 s2, 255
    s_cselect_b32 s71, 13, s71
    s_mov_b32 s62, 1373568
    s_add_u32 s74, s74, 1
    s_sub_u32 s93, s93, 2688
    v_mad_i32_i24 v86, v124, -7, v51
    v_cmp_le_u32 vcc, 4, v86
    v_add_u32 v86, 193536, v130
    v_subrev_u32 v87, 2688, v130
    v_cndmask_b32 v130, v86, v87, vcc
    v_mad_i32_i24 v86, v9, -7, v125
    v_cmp_le_u32 vcc, 4, v86
    v_add_u32 v86, 193536, v129
    v_subrev_u32 v87, 2688, v129
    v_cndmask_b32 v129, v86, v87, vcc
    v_mad_i32_i24 v86, v15, -7, v131
    v_cmp_le_u32 vcc, 4, v86
    v_add_u32 v86, 193536, v128
    v_subrev_u32 v87, 2688, v128
    v_cndmask_b32 v128, v86, v87, vcc
    v_mad_i32_i24 v86, v115, -7, v11
    v_cmp_le_u32 vcc, 4, v86
    v_add_u32 v86, 193536, v127
    v_subrev_u32 v87, 2688, v127
    v_cndmask_b32 v127, v86, v87, vcc
    v_mad_i32_i24 v86, v10, -7, v22
    v_cmp_le_u32 vcc, 4, v86
    v_add_u32 v86, 193536, v126
    v_subrev_u32 v87, 2688, v126
    v_cndmask_b32 v126, v86, v87, vcc
    s_cmp_eq_u32 s2, 256
    s_cselect_b32 s62, 0, s62
    s_cselect_b32 s69, 0, s69
    s_cselect_b32 s71, 2, s71
    s_branch L_bndrF
L_maskF:
    s_and_b32 s20, s74, 2
    s_and_b32 s21, s74, 1
    s_mov_b32 s22, 0xc31044fe
    v_lshrrev_b32 v138, 2, v139
    v_add_u32 v138, 0, v138
    v_mul_u32_u24 v145, 37, v138
    v_lshrrev_b32 v144, 8, v145
    v_mad_i32_i24 v144, v144, -7, v138
    v_lshrrev_b32 v145, 10, v145
    v_lshrrev_b32 v144, 2, v144
    v_mul_u32_u24 v145, s20, v145
    v_mad_u32_u24 v138, v144, s21, v145
    v_cvt_f32_u32 v138, v138
    v_lshrrev_b32 v154, 2, v139
    v_add_u32 v154, 4, v154
    v_mul_u32_u24 v145, 37, v154
    v_lshrrev_b32 v144, 8, v145
    v_mad_i32_i24 v144, v144, -7, v154
    v_lshrrev_b32 v145, 10, v145
    v_lshrrev_b32 v144, 2, v144
    v_mul_u32_u24 v145, s20, v145
    v_mad_u32_u24 v154, v144, s21, v145
    v_cvt_f32_u32 v154, v154
    v_lshrrev_b32 v91, 2, v139
    v_add_u32 v91, 8, v91
    v_mul_u32_u24 v145, 37, v91
    v_lshrrev_b32 v144, 8, v145
    v_mad_i32_i24 v144, v144, -7, v91
    v_lshrrev_b32 v145, 10, v145
    v_lshrrev_b32 v144, 2, v144
    v_mul_u32_u24 v145, s20, v145
    v_mad_u32_u24 v91, v144, s21, v145
    v_cvt_f32_u32 v91, v91
    v_mad_u32_u24 v142, v143, 12, 0
    v_mul_u32_u24 v145, 37, v142
    v_lshrrev_b32 v144, 8, v145
    v_mad_i32_i24 v144, v144, -7, v142
    v_lshrrev_b32 v145, 10, v145
    v_lshrrev_b32 v144, 2, v144
    v_mul_u32_u24 v145, s20, v145
    v_mad_u32_u24 v142, v144, s21, v145
    v_cvt_f32_u32 v142, v142
    v_sub_f32 v145, v138, v142
    v_mul_f32 v145, v145, v145 clamp
    v_fmac_f32 v204, s22, v145
    v_sub_f32 v145, v154, v142
    v_mul_f32 v145, v145, v145 clamp
    v_fmac_f32 v192, s22, v145
    v_sub_f32 v145, v91, v142
    v_mul_f32 v145, v145, v145 clamp
    v_fmac_f32 v180, s22, v145
    v_mad_u32_u24 v142, v143, 12, 1
    v_mul_u32_u24 v145, 37, v142
    v_lshrrev_b32 v144, 8, v145
    v_mad_i32_i24 v144, v144, -7, v142
    v_lshrrev_b32 v145, 10, v145
    v_lshrrev_b32 v144, 2, v144
    v_mul_u32_u24 v145, s20, v145
    v_mad_u32_u24 v142, v144, s21, v145
    v_cvt_f32_u32 v142, v142
    v_sub_f32 v145, v138, v142
    v_mul_f32 v145, v145, v145 clamp
    v_fmac_f32 v205, s22, v145
    v_sub_f32 v145, v154, v142
    v_mul_f32 v145, v145, v145 clamp
    v_fmac_f32 v193, s22, v145
    v_sub_f32 v145, v91, v142
    v_mul_f32 v145, v145, v145 clamp
    v_fmac_f32 v181, s22, v145
    v_mad_u32_u24 v142, v143, 12, 2
    v_mul_u32_u24 v145, 37, v142
    v_lshrrev_b32 v144, 8, v145
    v_mad_i32_i24 v144, v144, -7, v142
    v_lshrrev_b32 v145, 10, v145
    v_lshrrev_b32 v144, 2, v144
    v_mul_u32_u24 v145, s20, v145
    v_mad_u32_u24 v142, v144, s21, v145
    v_cvt_f32_u32 v142, v142
    v_sub_f32 v145, v138, v142
    v_mul_f32 v145, v145, v145 clamp
    v_fmac_f32 v206, s22, v145
    v_sub_f32 v145, v154, v142
    v_mul_f32 v145, v145, v145 clamp
    v_fmac_f32 v194, s22, v145
    v_sub_f32 v145, v91, v142
    v_mul_f32 v145, v145, v145 clamp
    v_fmac_f32 v182, s22, v145
    v_mad_u32_u24 v142, v143, 12, 3
    v_mul_u32_u24 v145, 37, v142
    v_lshrrev_b32 v144, 8, v145
    v_mad_i32_i24 v144, v144, -7, v142
    v_lshrrev_b32 v145, 10, v145
    v_lshrrev_b32 v144, 2, v144
    v_mul_u32_u24 v145, s20, v145
    v_mad_u32_u24 v142, v144, s21, v145
    v_cvt_f32_u32 v142, v142
    v_sub_f32 v145, v138, v142
    v_mul_f32 v145, v145, v145 clamp
    v_fmac_f32 v207, s22, v145
    v_sub_f32 v145, v154, v142
    v_mul_f32 v145, v145, v145 clamp
    v_fmac_f32 v195, s22, v145
    v_sub_f32 v145, v91, v142
    v_mul_f32 v145, v145, v145 clamp
    v_fmac_f32 v183, s22, v145
    v_mad_u32_u24 v142, v143, 12, 4
    v_mul_u32_u24 v145, 37, v142
    v_lshrrev_b32 v144, 8, v145
    v_mad_i32_i24 v144, v144, -7, v142
    v_lshrrev_b32 v145, 10, v145
    v_lshrrev_b32 v144, 2, v144
    v_mul_u32_u24 v145, s20, v145
    v_mad_u32_u24 v142, v144, s21, v145
    v_cvt_f32_u32 v142, v142
    v_sub_f32 v145, v138, v142
    v_mul_f32 v145, v145, v145 clamp
    v_fmac_f32 v200, s22, v145
    v_sub_f32 v145, v154, v142
    v_mul_f32 v145, v145, v145 clamp
    v_fmac_f32 v188, s22, v145
    v_sub_f32 v145, v91, v142
    v_mul_f32 v145, v145, v145 clamp
    v_fmac_f32 v176, s22, v145
    v_mad_u32_u24 v142, v143, 12, 5
    v_mul_u32_u24 v145, 37, v142
    v_lshrrev_b32 v144, 8, v145
    v_mad_i32_i24 v144, v144, -7, v142
    v_lshrrev_b32 v145, 10, v145
    v_lshrrev_b32 v144, 2, v144
    v_mul_u32_u24 v145, s20, v145
    v_mad_u32_u24 v142, v144, s21, v145
    v_cvt_f32_u32 v142, v142
    v_sub_f32 v145, v138, v142
    v_mul_f32 v145, v145, v145 clamp
    v_fmac_f32 v201, s22, v145
    v_sub_f32 v145, v154, v142
    v_mul_f32 v145, v145, v145 clamp
    v_fmac_f32 v189, s22, v145
    v_sub_f32 v145, v91, v142
    v_mul_f32 v145, v145, v145 clamp
    v_fmac_f32 v177, s22, v145
    v_mad_u32_u24 v142, v143, 12, 6
    v_mul_u32_u24 v145, 37, v142
    v_lshrrev_b32 v144, 8, v145
    v_mad_i32_i24 v144, v144, -7, v142
    v_lshrrev_b32 v145, 10, v145
    v_lshrrev_b32 v144, 2, v144
    v_mul_u32_u24 v145, s20, v145
    v_mad_u32_u24 v142, v144, s21, v145
    v_cvt_f32_u32 v142, v142
    v_sub_f32 v145, v138, v142
    v_mul_f32 v145, v145, v145 clamp
    v_fmac_f32 v202, s22, v145
    v_sub_f32 v145, v154, v142
    v_mul_f32 v145, v145, v145 clamp
    v_fmac_f32 v190, s22, v145
    v_sub_f32 v145, v91, v142
    v_mul_f32 v145, v145, v145 clamp
    v_fmac_f32 v178, s22, v145
    v_mad_u32_u24 v142, v143, 12, 7
    v_mul_u32_u24 v145, 37, v142
    v_lshrrev_b32 v144, 8, v145
    v_mad_i32_i24 v144, v144, -7, v142
    v_lshrrev_b32 v145, 10, v145
    v_lshrrev_b32 v144, 2, v144
    v_mul_u32_u24 v145, s20, v145
    v_mad_u32_u24 v142, v144, s21, v145
    v_cvt_f32_u32 v142, v142
    v_sub_f32 v145, v138, v142
    v_mul_f32 v145, v145, v145 clamp
    v_fmac_f32 v203, s22, v145
    v_sub_f32 v145, v154, v142
    v_mul_f32 v145, v145, v145 clamp
    v_fmac_f32 v191, s22, v145
    v_sub_f32 v145, v91, v142
    v_mul_f32 v145, v145, v145 clamp
    v_fmac_f32 v179, s22, v145
    v_mad_u32_u24 v142, v143, 12, 8
    v_mul_u32_u24 v145, 37, v142
    v_lshrrev_b32 v144, 8, v145
    v_mad_i32_i24 v144, v144, -7, v142
    v_lshrrev_b32 v145, 10, v145
    v_lshrrev_b32 v144, 2, v144
    v_mul_u32_u24 v145, s20, v145
    v_mad_u32_u24 v142, v144, s21, v145
    v_cvt_f32_u32 v142, v142
    v_sub_f32 v145, v138, v142
    v_mul_f32 v145, v145, v145 clamp
    v_fmac_f32 v196, s22, v145
    v_sub_f32 v145, v154, v142
    v_mul_f32 v145, v145, v145 clamp
    v_fmac_f32 v184, s22, v145
    v_sub_f32 v145, v91, v142
    v_mul_f32 v145, v145, v145 clamp
    v_fmac_f32 v172, s22, v145
    v_mad_u32_u24 v142, v143, 12, 9
    v_mul_u32_u24 v145, 37, v142
    v_lshrrev_b32 v144, 8, v145
    v_mad_i32_i24 v144, v144, -7, v142
    v_lshrrev_b32 v145, 10, v145
    v_lshrrev_b32 v144, 2, v144
    v_mul_u32_u24 v145, s20, v145
    v_mad_u32_u24 v142, v144, s21, v145
    v_cvt_f32_u32 v142, v142
    v_sub_f32 v145, v138, v142
    v_mul_f32 v145, v145, v145 clamp
    v_fmac_f32 v197, s22, v145
    v_sub_f32 v145, v154, v142
    v_mul_f32 v145, v145, v145 clamp
    v_fmac_f32 v185, s22, v145
    v_sub_f32 v145, v91, v142
    v_mul_f32 v145, v145, v145 clamp
    v_fmac_f32 v173, s22, v145
    v_mad_u32_u24 v142, v143, 12, 10
    v_mul_u32_u24 v145, 37, v142
    v_lshrrev_b32 v144, 8, v145
    v_mad_i32_i24 v144, v144, -7, v142
    v_lshrrev_b32 v145, 10, v145
    v_lshrrev_b32 v144, 2, v144
    v_mul_u32_u24 v145, s20, v145
    v_mad_u32_u24 v142, v144, s21, v145
    v_cvt_f32_u32 v142, v142
    v_sub_f32 v145, v138, v142
    v_mul_f32 v145, v145, v145 clamp
    v_fmac_f32 v198, s22, v145
    v_sub_f32 v145, v154, v142
    v_mul_f32 v145, v145, v145 clamp
    v_fmac_f32 v186, s22, v145
    v_sub_f32 v145, v91, v142
    v_mul_f32 v145, v145, v145 clamp
    v_fmac_f32 v174, s22, v145
    v_mad_u32_u24 v142, v143, 12, 11
    v_mul_u32_u24 v145, 37, v142
    v_lshrrev_b32 v144, 8, v145
    v_mad_i32_i24 v144, v144, -7, v142
    v_lshrrev_b32 v145, 10, v145
    v_lshrrev_b32 v144, 2, v144
    v_mul_u32_u24 v145, s20, v145
    v_mad_u32_u24 v142, v144, s21, v145
    v_cvt_f32_u32 v142, v142
    v_sub_f32 v145, v138, v142
    v_mul_f32 v145, v145, v145 clamp
    v_fmac_f32 v199, s22, v145
    v_sub_f32 v145, v154, v142
    v_mul_f32 v145, v145, v145 clamp
    v_fmac_f32 v187, s22, v145
    v_sub_f32 v145, v91, v142
    v_mul_f32 v145, v145, v145 clamp
    v_fmac_f32 v175, s22, v145
    v_cvt_f32_u32 v142, s74
    v_sub_f32 v145, v138, v142
    v_mul_f32 v145, v145, v145 clamp
    v_fmac_f32 v208, s22, v145
    v_sub_f32 v145, v154, v142
    v_mul_f32 v145, v145, v145 clamp
    v_fmac_f32 v209, s22, v145
    v_sub_f32 v145, v91, v142
    v_mul_f32 v145, v145, v145 clamp
    v_fmac_f32 v210, s22, v145
    v_lshrrev_b32 v138, 2, v139
    v_lshl_add_u32 v138, v143, 2, v138
    v_add_u32 v145, 1, v143
    v_lshrrev_b32 v145, 2, v145
    v_mad_u32_u24 v138, v145, 36, v138
    v_min_u32 v138, 48, v138
    v_mul_u32_u24 v145, 37, v138
    v_lshrrev_b32 v144, 8, v145
    v_mad_i32_i24 v144, v144, -7, v138
    v_lshrrev_b32 v145, 10, v145
    v_lshrrev_b32 v144, 2, v144
    v_mul_u32_u24 v145, s20, v145
    v_mad_u32_u24 v138, v144, s21, v145
    v_cvt_f32_u32 v138, v138
    v_sub_f32 v145, v138, v142
    v_mul_f32 v145, v145, v145 clamp
    v_fmac_f32 v211, s22, v145
    s_branch L_nomaskF
L_spin:
    s_movk_i32 s95, 300
L_spin1:
    global_load_dword v101, v167, s[38:39] offset:248 sc1
    s_waitcnt vmcnt(0)
    v_readfirstlane_b32 s94, v101
    s_nop 1
    s_cmp_ge_u32 s94, 3
    s_cbranch_scc1 L_spinr
    s_sub_u32 s95, s95, 1
    s_cmp_lg_u32 s95, 0
    s_cbranch_scc1 L_spin1
    v_mov_b32 v125, -1
    s_branch L_spinr
.p2alignl 12, 0xbf810000
L_main:
    s_mov_b64 exec, -1
    s_waitcnt vmcnt(10)
    s_barrier
    v_sub_u32 v203, v199, v191
    v_sub_u32 v196, v199, v86
    v_sub_u32 v197, v199, v87
    v_sub_u32 v198, v199, v186
    ds_read_b128 v[20:23], v49 offset:40960
    v_sub_u32 v199, v199, v187
    v_sub_u32 v192, v138, v184
    v_sub_u32 v193, v138, v185
    ds_read_b128 v[16:19], v49 offset:42496
    v_sub_u32 v194, v138, v156
    v_sub_u32 v195, v138, v157
    v_sub_u32 v188, v138, v188
    ds_read_b128 v[4:7], v49 offset:0
    buffer_load_dwordx4 v37, s[32:35], s92 offen offset:1024 lds
    v_sub_u32 v189, v138, v189
    v_sub_u32 v190, v138, v190
    ds_read_b128 v[0:3], v49 offset:1536
    v_sub_u32 v191, v138, v191
    v_sub_u32 v184, v138, v86
    v_sub_u32 v185, v138, v87
    ds_read_b128 v[28:31], v49 offset:3072
    v_sub_u32 v186, v138, v186
    v_sub_u32 v187, v138, v187
    ds_read_b32 v177, v177 offset:336
    buffer_load_dwordx4 v11, s[32:35], s92 offen offset:2048 lds
    s_add_u32 m0, s90, 49152
    s_mov_b32 s92, 147456
    ds_read_b32 v178, v178 offset:336
    ds_read_b32 v179, v179 offset:336
    ds_read_b32 v172, v172 offset:336
    buffer_load_dwordx4 v84, s[32:35], s92 offen offset:0 lds
    s_waitcnt vmcnt(10)
    ds_read_b64_tr_b16 a[0:1], v51 offset:0
    ds_read_b64_tr_b16 a[2:3], v51 offset:768
    ds_read_b64_tr_b16 a[24:25], v51 offset:32
    ds_read_b64_tr_b16 a[26:27], v51 offset:800
    ds_read_b64_tr_b16 a[48:49], v51 offset:64
    ds_read_b64_tr_b16 a[50:51], v51 offset:832
    ds_read_b32 v173, v173 offset:336
    ds_read_b32 v174, v174 offset:336
    buffer_load_dwordx4 v37, s[32:35], s92 offen offset:1024 lds
    ds_read_b32 v175, v175 offset:336
    ds_read_b32 v204, v204 offset:336
    ds_read_b32 v205, v205 offset:336
    s_waitcnt lgkmcnt(8)
    v_mfma_f32_16x16x32_bf16 v[64:67], a[0:3], v[20:23], 0
    s_waitcnt lgkmcnt(7)
    buffer_load_dwordx4 v11, s[32:35], s92 offen offset:2048 lds
    v_mfma_f32_16x16x32_bf16 v[60:63], a[24:27], v[20:23], 0
    s_waitcnt lgkmcnt(5)
    s_add_u32 m0, s90, 61440
    ds_read_b32 v206, v206 offset:336
    v_mfma_f32_16x16x32_bf16 v[12:15], a[48:51], v[20:23], 0
    s_mov_b32 s92, 184320
    v_mfma_f32_16x16x32_bf16 v[56:59], a[0:3], v[16:19], 0
    ds_read_b128 v[24:27], v48 offset:40960
    v_mfma_f32_16x16x32_bf16 v[44:47], a[24:27], v[16:19], 0
    ds_read_b32 v207, v207 offset:336
    v_mfma_f32_16x16x32_bf16 v[32:35], a[48:51], v[16:19], 0
    buffer_load_dwordx4 v84, s[32:35], s92 offen offset:0 lds
    v_mfma_f32_16x16x32_bf16 v[16:19], a[0:3], v[4:7], 0
    s_waitcnt vmcnt(10)
    ds_read_b64_tr_b16 a[4:5], v51 offset:12288
    v_mfma_f32_16x16x32_bf16 v[228:231], a[24:27], v[4:7], 0
    ds_read_b64_tr_b16 a[6:7], v51 offset:13056
    v_mfma_f32_16x16x32_bf16 v[20:23], a[48:51], v[4:7], 0
    ds_read_b64_tr_b16 a[28:29], v51 offset:12320
    v_mfma_f32_16x16x32_bf16 v[76:79], a[0:3], v[0:3], 0
    ds_read_b64_tr_b16 a[30:31], v51 offset:13088
    v_mfma_f32_16x16x32_bf16 v[72:75], a[24:27], v[0:3], 0
    buffer_load_dwordx4 v37, s[32:35], s92 offen offset:1024 lds
    ds_read_b64_tr_b16 a[52:53], v51 offset:12352
    v_mfma_f32_16x16x32_bf16 v[240:243], a[48:51], v[0:3], 0
    ds_read_b64_tr_b16 a[54:55], v51 offset:13120
    v_mfma_f32_16x16x32_bf16 v[40:43], a[0:3], v[28:31], 0
    ds_read_b128 v[4:7], v48 offset:42496
    v_mfma_f32_16x16x32_bf16 v[96:99], a[24:27], v[28:31], 0
    ds_read_b128 v[0:3], v48 offset:0
    v_mfma_f32_16x16x32_bf16 v[80:83], a[48:51], v[28:31], 0
    s_waitcnt lgkmcnt(6)
    ds_read_b128 v[52:55], v48 offset:1536
    buffer_load_dwordx4 v11, s[32:35], s92 offen offset:2048 lds
    s_add_u32 m0, s90, 0
    s_mov_b32 s92, 384
    v_mfma_f32_16x16x32_bf16 v[64:67], a[4:7], v[24:27], v[64:67]
    s_waitcnt lgkmcnt(5)
    ds_read_b128 v[28:31], v48 offset:3072
    ds_read_b32 v200, v200 offset:336
    v_mfma_f32_16x16x32_bf16 v[60:63], a[28:31], v[24:27], v[60:63]
    s_waitcnt lgkmcnt(5)
    ds_read_b32 v201, v201 offset:336
    v_mfma_f32_16x16x32_bf16 v[12:15], a[52:55], v[24:27], v[12:15]
    s_waitcnt vmcnt(9) lgkmcnt(5)
    buffer_load_dwordx4 v84, s[32:35], s92 offen offset:0 lds
    ds_read_b64_tr_b16 a[8:9], v51 offset:24576
    v_mfma_f32_16x16x32_bf16 v[56:59], a[4:7], v[4:7], v[56:59]
    ds_read_b64_tr_b16 a[10:11], v51 offset:25344
    v_mfma_f32_16x16x32_bf16 v[44:47], a[28:31], v[4:7], v[44:47]
    ds_read_b64_tr_b16 a[32:33], v51 offset:24608
    v_mfma_f32_16x16x32_bf16 v[32:35], a[52:55], v[4:7], v[32:35]
    s_waitcnt lgkmcnt(6)
    ds_read_b64_tr_b16 a[34:35], v51 offset:25376
    v_mfma_f32_16x16x32_bf16 v[16:19], a[4:7], v[0:3], v[16:19]
    ds_read_b64_tr_b16 a[56:57], v51 offset:24640
    v_mfma_f32_16x16x32_bf16 v[228:231], a[28:31], v[0:3], v[228:231]
    buffer_load_dwordx4 v37, s[32:35], s92 offen offset:1024 lds
    ds_read_b64_tr_b16 a[58:59], v51 offset:25408
    v_mfma_f32_16x16x32_bf16 v[20:23], a[52:55], v[0:3], v[20:23]
    ds_read_b128 v[24:27], v49 offset:41088
    v_mfma_f32_16x16x32_bf16 v[76:79], a[4:7], v[52:55], v[76:79]
    ds_read_b128 v[4:7], v49 offset:42624
    v_mfma_f32_16x16x32_bf16 v[72:75], a[28:31], v[52:55], v[72:75]
    ds_read_b128 v[0:3], v49 offset:128
    v_mfma_f32_16x16x32_bf16 v[240:243], a[52:55], v[52:55], v[240:243]
    s_waitcnt lgkmcnt(8)
    ds_read_b128 v[52:55], v49 offset:1664
    v_mfma_f32_16x16x32_bf16 v[40:43], a[4:7], v[28:31], v[40:43]
    buffer_load_dwordx4 v11, s[32:35], s92 offen offset:2048 lds
    ds_read_b32 v202, v202 offset:336
    v_mfma_f32_16x16x32_bf16 v[96:99], a[28:31], v[28:31], v[96:99]
    s_add_u32 m0, s90, 12288
    v_mfma_f32_16x16x32_bf16 v[80:83], a[52:55], v[28:31], v[80:83]
    s_mov_b32 s92, 37248
    ds_read_b128 v[28:31], v49 offset:3200
    ds_read_b32 v203, v203 offset:336
    ds_read_b32 v196, v196 offset:336
    s_waitcnt lgkmcnt(7)
    v_mfma_f32_16x16x32_bf16 v[64:67], a[8:11], v[24:27], v[64:67]
    buffer_load_dwordx4 v84, s[32:35], s92 offen offset:0 lds
    v_mfma_f32_16x16x32_bf16 v[60:63], a[32:35], v[24:27], v[60:63]
    s_waitcnt vmcnt(10)
    ds_read_b64_tr_b16 a[12:13], v51 offset:36864
    v_mfma_f32_16x16x32_bf16 v[12:15], a[56:59], v[24:27], v[12:15]
    s_waitcnt lgkmcnt(5)
    ds_read_b64_tr_b16 a[14:15], v51 offset:37632
    v_mfma_f32_16x16x32_bf16 v[56:59], a[8:11], v[4:7], v[56:59]
    ds_read_b64_tr_b16 a[36:37], v51 offset:36896
    v_mfma_f32_16x16x32_bf16 v[44:47], a[32:35], v[4:7], v[44:47]
    ds_read_b64_tr_b16 a[38:39], v51 offset:37664
    v_mfma_f32_16x16x32_bf16 v[32:35], a[56:59], v[4:7], v[32:35]
    buffer_load_dwordx4 v37, s[32:35], s92 offen offset:1024 lds
    ds_read_b64_tr_b16 a[60:61], v51 offset:36928
    v_mfma_f32_16x16x32_bf16 v[16:19], a[8:11], v[0:3], v[16:19]
    ds_read_b64_tr_b16 a[62:63], v51 offset:37696
    v_mfma_f32_16x16x32_bf16 v[228:231], a[32:35], v[0:3], v[228:231]
    ds_read_b128 v[24:27], v48 offset:41088
    v_mfma_f32_16x16x32_bf16 v[20:23], a[56:59], v[0:3], v[20:23]
    ds_read_b128 v[0:3], v48 offset:42624
    v_mfma_f32_16x16x32_bf16 v[76:79], a[8:11], v[52:55], v[76:79]
    ds_read_b128 v[4:7], v48 offset:128
    v_mfma_f32_16x16x32_bf16 v[72:75], a[32:35], v[52:55], v[72:75]
    buffer_load_dwordx4 v11, s[32:35], s92 offen offset:2048 lds
    ds_read_b32 v197, v197 offset:336
    v_mfma_f32_16x16x32_bf16 v[240:243], a[56:59], v[52:55], v[240:243]
    s_waitcnt lgkmcnt(8)
    s_add_u32 m0, s90, 24576
    v_mfma_f32_16x16x32_bf16 v[40:43], a[8:11], v[28:31], v[40:43]
    s_mov_b32 s92, 74112
    ds_read_b128 v[92:95], v48 offset:1664
    v_mfma_f32_16x16x32_bf16 v[96:99], a[32:35], v[28:31], v[96:99]
    ds_read_b32 v198, v198 offset:336
    v_mfma_f32_16x16x32_bf16 v[80:83], a[56:59], v[28:31], v[80:83]
    s_waitcnt vmcnt(9) lgkmcnt(5)
    buffer_load_dwordx4 v84, s[32:35], s92 offen offset:0 lds
    ds_read_b64_tr_b16 a[16:17], v51 offset:49152
    ds_read_b64_tr_b16 a[18:19], v51 offset:49920
    v_mfma_f32_16x16x32_bf16 v[64:67], a[12:15], v[24:27], v[64:67]
    ds_read_b64_tr_b16 a[40:41], v51 offset:49184
    v_mfma_f32_16x16x32_bf16 v[60:63], a[36:39], v[24:27], v[60:63]
    ds_read_b64_tr_b16 a[42:43], v51 offset:49952
    v_mfma_f32_16x16x32_bf16 v[12:15], a[60:63], v[24:27], v[12:15]
    s_waitcnt lgkmcnt(7)
    ds_read_b64_tr_b16 a[64:65], v51 offset:49216
    v_mfma_f32_16x16x32_bf16 v[56:59], a[12:15], v[0:3], v[56:59]
    ds_read_b64_tr_b16 a[66:67], v51 offset:49984
    buffer_load_dwordx4 v37, s[32:35], s92 offen offset:1024 lds
    v_mfma_f32_16x16x32_bf16 v[44:47], a[36:39], v[0:3], v[44:47]
    ds_read_b128 v[24:27], v48 offset:3200
    v_mfma_f32_16x16x32_bf16 v[32:35], a[60:63], v[0:3], v[32:35]
    ds_read_b128 v[100:103], v48 offset:41216
    v_mfma_f32_16x16x32_bf16 v[16:19], a[12:15], v[4:7], v[16:19]
    ds_read_b128 v[68:71], v48 offset:42752
    v_mfma_f32_16x16x32_bf16 v[228:231], a[36:39], v[4:7], v[228:231]
    ds_read_b128 v[0:3], v48 offset:256
    v_mfma_f32_16x16x32_bf16 v[20:23], a[60:63], v[4:7], v[20:23]
    s_waitcnt lgkmcnt(8)
    ds_read_b128 v[28:31], v48 offset:1792
    buffer_load_dwordx4 v11, s[32:35], s92 offen offset:2048 lds
    v_mfma_f32_16x16x32_bf16 v[76:79], a[12:15], v[92:95], v[76:79]
    s_add_u32 m0, s90, 36864
    ds_read_b128 v[4:7], v48 offset:3328
    v_mfma_f32_16x16x32_bf16 v[72:75], a[36:39], v[92:95], v[72:75]
    s_mov_b32 s92, 110976
    ds_read_b128 v[52:55], v49 offset:41216
    v_mfma_f32_16x16x32_bf16 v[240:243], a[60:63], v[92:95], v[240:243]
    s_waitcnt lgkmcnt(6)
    ds_read_b128 v[92:95], v49 offset:42752
    ds_read_b32 v199, v199 offset:336
    v_mfma_f32_16x16x32_bf16 v[40:43], a[12:15], v[24:27], v[40:43]
    s_waitcnt vmcnt(9)
    buffer_load_dwordx4 v84, s[32:35], s92 offen offset:0 lds
    ds_read_b64_tr_b16 a[20:21], v51 offset:61440
    v_mfma_f32_16x16x32_bf16 v[96:99], a[36:39], v[24:27], v[96:99]
    ds_read_b64_tr_b16 a[22:23], v51 offset:62208
    v_mfma_f32_16x16x32_bf16 v[80:83], a[60:63], v[24:27], v[80:83]
    ds_read_b64_tr_b16 a[44:45], v51 offset:61472
    ds_read_b64_tr_b16 a[46:47], v51 offset:62240
    ds_read_b64_tr_b16 a[68:69], v51 offset:61504
    ds_read_b64_tr_b16 a[70:71], v51 offset:62272
    ds_read_b128 v[24:27], v49 offset:256
    buffer_load_dwordx4 v37, s[32:35], s92 offen offset:1024 lds
    ds_read_b32 v192, v192 offset:336
    s_waitcnt lgkmcnt(10)
    v_mfma_f32_16x16x32_bf16 v[64:67], a[16:19], v[52:55], v[64:67]
    v_mfma_f32_16x16x32_bf16 v[60:63], a[40:43], v[52:55], v[60:63]
    ds_read_b32 v193, v193 offset:336
    v_mfma_f32_16x16x32_bf16 v[12:15], a[64:67], v[52:55], v[12:15]
    s_waitcnt lgkmcnt(9)
    v_mfma_f32_16x16x32_bf16 v[56:59], a[16:19], v[92:95], v[56:59]
    ds_read_b32 v194, v194 offset:336
    v_mfma_f32_16x16x32_bf16 v[44:47], a[40:43], v[92:95], v[44:47]
    s_waitcnt lgkmcnt(8)
    buffer_load_dwordx4 v11, s[32:35], s92 offen offset:2048 lds
    v_mfma_f32_16x16x32_bf16 v[64:67], a[20:23], v[100:103], v[64:67]
    s_waitcnt lgkmcnt(6)
    s_add_u32 m0, s90, 49152
    ds_read_b128 v[52:55], v49 offset:1792
    v_mfma_f32_16x16x32_bf16 v[60:63], a[44:47], v[100:103], v[60:63]
    s_waitcnt lgkmcnt(5)
    s_mov_b32 s92, 147840
    ds_read_b32 v195, v195 offset:336
    v_mfma_f32_16x16x32_bf16 v[12:15], a[68:71], v[100:103], v[12:15]
    v_cvt_pk_f16_f32 v64, v64, v65
    v_cvt_pk_f16_f32 v65, v66, v67
    v_mfma_f32_16x16x32_bf16 v[56:59], a[20:23], v[68:71], v[56:59]
    ds_read_b32 v188, v188 offset:336
    v_pk_fma_f16 v88, v64, v64, s3
    v_mfma_f32_16x16x32_bf16 v[44:47], a[44:47], v[68:71], v[44:47]
    buffer_load_dwordx4 v84, s[32:35], s92 offen offset:0 lds
    v_pk_fmac_f16 v88, v65, v65
    v_mfma_f32_16x16x32_bf16 v[32:35], a[64:67], v[92:95], v[32:35]
    s_waitcnt vmcnt(10)
    ds_read_b64_tr_b16 a[72:73], v51 offset:0
    v_cvt_pk_f16_f32 v66, v60, v61
    v_mfma_f32_16x16x32_bf16 v[32:35], a[68:71], v[68:71], v[32:35]
    s_waitcnt lgkmcnt(5)
    ds_read_b64_tr_b16 a[74:75], v51 offset:768
    v_cvt_pk_f16_f32 v67, v62, v63
    v_mfma_f32_16x16x32_bf16 v[16:19], a[16:19], v[24:27], v[16:19]
    ds_read_b64_tr_b16 a[96:97], v51 offset:32
    v_pk_fmac_f16 v88, v66, v66
    v_mfma_f32_16x16x32_bf16 v[16:19], a[20:23], v[0:3], v[16:19]
    ds_read_b64_tr_b16 a[98:99], v51 offset:800
    v_pk_fmac_f16 v88, v67, v67
    v_mfma_f32_16x16x32_bf16 v[228:231], a[40:43], v[24:27], v[228:231]
    ds_read_b64_tr_b16 a[120:121], v51 offset:64
    buffer_load_dwordx4 v37, s[32:35], s92 offen offset:1024 lds
    v_mfma_f32_16x16x32_bf16 v[228:231], a[44:47], v[0:3], v[228:231]
    ds_read_b64_tr_b16 a[122:123], v51 offset:832
    v_cvt_pk_f16_f32 v156, v12, v13
    v_mfma_f32_16x16x32_bf16 v[20:23], a[64:67], v[24:27], v[20:23]
    ds_read_b128 v[24:27], v49 offset:3328
    v_cvt_pk_f16_f32 v157, v14, v15
    v_mfma_f32_16x16x32_bf16 v[20:23], a[68:71], v[0:3], v[20:23]
    s_waitcnt lgkmcnt(7)
    ds_read_b128 v[0:3], v49 offset:40960
    v_pk_fmac_f16 v88, v156, v156
    v_mfma_f32_16x16x32_bf16 v[76:79], a[16:19], v[52:55], v[76:79]
    ds_read_b32 v189, v189 offset:336
    v_pk_fmac_f16 v88, v157, v157
    v_mfma_f32_16x16x32_bf16 v[76:79], a[20:23], v[28:31], v[76:79]
    buffer_load_dwordx4 v11, s[32:35], s92 offen offset:2048 lds
    v_cvt_pk_f16_f32 v108, v56, v57
    v_mfma_f32_16x16x32_bf16 v[72:75], a[40:43], v[52:55], v[72:75]
    s_add_u32 m0, s90, 61440
    ds_read_b128 v[12:15], v49 offset:42496
    v_cvt_pk_f16_f32 v109, v58, v59
    v_mfma_f32_16x16x32_bf16 v[72:75], a[44:47], v[28:31], v[72:75]
    s_mov_b32 s92, 184704
    ds_read_b32 v190, v190 offset:336
    v_pk_fma_f16 v90, v108, v108, s3
    v_mfma_f32_16x16x32_bf16 v[240:243], a[64:67], v[52:55], v[240:243]
    v_pk_fmac_f16 v90, v109, v109
    v_cvt_pk_f16_f32 v110, v44, v45
    v_mfma_f32_16x16x32_bf16 v[240:243], a[68:71], v[28:31], v[240:243]
    s_waitcnt vmcnt(9) lgkmcnt(4)
    ds_read_b128 v[28:31], v49 offset:0
    v_cvt_pk_f16_f32 v111, v46, v47
    v_pk_fmac_f16 v90, v110, v110
    v_pk_fmac_f16 v90, v111, v111
    ds_read_b64_tr_b16 a[76:77], v51 offset:12288
    v_mfma_f32_16x16x32_bf16 v[40:43], a[16:19], v[24:27], v[40:43]
    ds_read_b64_tr_b16 a[78:79], v51 offset:13056
    buffer_load_dwordx4 v84, s[32:35], s92 offen offset:0 lds
    v_mfma_f32_16x16x32_bf16 v[40:43], a[20:23], v[4:7], v[40:43]
    ds_read_b64_tr_b16 a[100:101], v51 offset:12320
    v_cvt_pk_f16_f32 v86, v32, v33
    v_mfma_f32_16x16x32_bf16 v[96:99], a[40:43], v[24:27], v[96:99]
    ds_read_b64_tr_b16 a[102:103], v51 offset:13088
    v_cvt_pk_f16_f32 v87, v34, v35
    v_mfma_f32_16x16x32_bf16 v[96:99], a[44:47], v[4:7], v[96:99]
    ds_read_b64_tr_b16 a[124:125], v51 offset:12352
    v_pk_fmac_f16 v90, v86, v86
    v_mfma_f32_16x16x32_bf16 v[80:83], a[64:67], v[24:27], v[80:83]
    ds_read_b64_tr_b16 a[126:127], v51 offset:13120
    buffer_load_dwordx4 v37, s[32:35], s92 offen offset:1024 lds
    v_mfma_f32_16x16x32_bf16 v[80:83], a[68:71], v[4:7], v[80:83]
    s_waitcnt lgkmcnt(7)
    ds_read_b128 v[4:7], v49 offset:1536
    v_pk_fmac_f16 v90, v87, v87
    v_mfma_f32_16x16x32_bf16 v[120:123], a[72:75], v[0:3], 0
    ds_read_b128 v[52:55], v49 offset:3072
    v_cvt_pk_f16_f32 v24, v16, v17
    v_mfma_f32_16x16x32_bf16 v[148:151], a[96:99], v[0:3], 0
    ds_read_b32 v191, v191 offset:336
    v_cvt_pk_f16_f32 v25, v18, v19
    v_mfma_f32_16x16x32_bf16 v[56:59], a[120:123], v[0:3], 0
    v_pk_fma_f16 v224, v24, v24, s3
    v_pk_fmac_f16 v224, v25, v25
    v_mfma_f32_16x16x32_bf16 v[116:119], a[72:75], v[12:15], 0
    buffer_load_dwordx4 v11, s[32:35], s92 offen offset:2048 lds
    ds_read_b128 v[0:3], v48 offset:40960
    v_mfma_f32_16x16x32_bf16 v[104:107], a[96:99], v[12:15], 0
    s_add_u32 m0, s90, 0
    v_cvt_pk_f16_f32 v26, v228, v229
    v_cvt_pk_f16_f32 v27, v230, v231
    v_mfma_f32_16x16x32_bf16 v[92:95], a[120:123], v[12:15], 0
    s_waitcnt lgkmcnt(6)
    s_mov_b32 s92, 768
    ds_read_b128 v[32:35], v48 offset:42496
    v_pk_fmac_f16 v224, v26, v26
    v_mfma_f32_16x16x32_bf16 v[248:251], a[72:75], v[28:31], 0
    ds_read_b32 v184, v184 offset:336
    v_pk_fmac_f16 v224, v27, v27
    v_mfma_f32_16x16x32_bf16 v[44:47], a[96:99], v[28:31], 0
    v_cvt_pk_f16_f32 v152, v20, v21
    v_cvt_pk_f16_f32 v153, v22, v23
    v_mfma_f32_16x16x32_bf16 v[12:15], a[120:123], v[28:31], 0
    s_waitcnt vmcnt(9) lgkmcnt(5)
    ds_read_b64_tr_b16 a[80:81], v51 offset:24576
    buffer_load_dwordx4 v84, s[32:35], s92 offen offset:0 lds
    v_mfma_f32_16x16x32_bf16 v[228:231], a[72:75], v[4:7], 0
    ds_read_b64_tr_b16 a[82:83], v51 offset:25344
    v_pk_fmac_f16 v224, v152, v152
    v_mfma_f32_16x16x32_bf16 v[16:19], a[96:99], v[4:7], 0
    ds_read_b64_tr_b16 a[104:105], v51 offset:24608
    v_pk_fmac_f16 v224, v153, v153
    v_mfma_f32_16x16x32_bf16 v[68:71], a[120:123], v[4:7], 0
    s_waitcnt lgkmcnt(6)
    ds_read_b64_tr_b16 a[106:107], v51 offset:25376
    v_cvt_pk_f16_f32 v28, v76, v77
    v_mfma_f32_16x16x32_bf16 v[60:63], a[72:75], v[52:55], 0
    ds_read_b64_tr_b16 a[128:129], v51 offset:24640
    v_cvt_pk_f16_f32 v29, v78, v79
    v_mfma_f32_16x16x32_bf16 v[4:7], a[96:99], v[52:55], 0
    ds_read_b64_tr_b16 a[130:131], v51 offset:25408
    buffer_load_dwordx4 v37, s[32:35], s92 offen offset:1024 lds
    v_mfma_f32_16x16x32_bf16 v[100:103], a[120:123], v[52:55], 0
    s_waitcnt lgkmcnt(7)
    ds_read_b128 v[76:79], v48 offset:0
    v_pk_fma_f16 v226, v28, v28, s3
    v_mfma_f32_16x16x32_bf16 v[120:123], a[76:79], v[0:3], v[120:123]
    ds_read_b128 v[52:55], v48 offset:1536
    v_pk_fmac_f16 v226, v29, v29
    v_mfma_f32_16x16x32_bf16 v[148:151], a[100:103], v[0:3], v[148:151]
    ds_read_b128 v[20:23], v48 offset:3072
    v_cvt_pk_f16_f32 v30, v72, v73
    v_mfma_f32_16x16x32_bf16 v[56:59], a[124:127], v[0:3], v[56:59]
    ds_read_b128 v[0:3], v49 offset:41088
    v_cvt_pk_f16_f32 v31, v74, v75
    v_mfma_f32_16x16x32_bf16 v[116:119], a[76:79], v[32:35], v[116:119]
    buffer_load_dwordx4 v11, s[32:35], s92 offen offset:2048 lds
    ds_read_b32 v185, v185 offset:336
    v_mfma_f32_16x16x32_bf16 v[104:107], a[100:103], v[32:35], v[104:107]
    s_add_u32 m0, s90, 12288
    v_pk_fmac_f16 v226, v30, v30
    v_pk_fmac_f16 v226, v31, v31
    v_mfma_f32_16x16x32_bf16 v[92:95], a[124:127], v[32:35], v[92:95]
    s_mov_b32 s92, 37632
    ds_read_b128 v[32:35], v49 offset:42624
    v_cvt_pk_f16_f32 v146, v240, v241
    v_cvt_pk_f16_f32 v147, v242, v243
    v_pk_fmac_f16 v226, v146, v146
    v_pk_fmac_f16 v226, v147, v147
    v_cvt_pk_f16_f32 v40, v40, v41
    v_cvt_pk_f16_f32 v41, v42, v43
    v_pk_fma_f16 v36, v40, v40, s3
    v_pk_fmac_f16 v36, v41, v41
    v_cvt_pk_f16_f32 v42, v96, v97
    v_cvt_pk_f16_f32 v43, v98, v99
    s_waitcnt lgkmcnt(5)
    v_mfma_f32_16x16x32_bf16 v[248:251], a[76:79], v[76:79], v[248:251]
    s_waitcnt vmcnt(9)
    ds_read_b64_tr_b16 a[84:85], v51 offset:36864
    buffer_load_dwordx4 v84, s[32:35], s92 offen offset:0 lds
    v_mfma_f32_16x16x32_bf16 v[44:47], a[100:103], v[76:79], v[44:47]
    ds_read_b64_tr_b16 a[86:87], v51 offset:37632
    v_pk_fmac_f16 v36, v42, v42
    v_mfma_f32_16x16x32_bf16 v[12:15], a[124:127], v[76:79], v[12:15]
    s_waitcnt lgkmcnt(4)
    ds_read_b64_tr_b16 a[108:109], v51 offset:36896
    v_pk_fmac_f16 v36, v43, v43
    v_mfma_f32_16x16x32_bf16 v[228:231], a[76:79], v[52:55], v[228:231]
    ds_read_b64_tr_b16 a[110:111], v51 offset:37664
    v_cvt_pk_f16_f32 v140, v80, v81
    v_mfma_f32_16x16x32_bf16 v[16:19], a[100:103], v[52:55], v[16:19]
    ds_read_b64_tr_b16 a[132:133], v51 offset:36928
    v_cvt_pk_f16_f32 v141, v82, v83
    v_mfma_f32_16x16x32_bf16 v[68:71], a[124:127], v[52:55], v[68:71]
    ds_read_b64_tr_b16 a[134:135], v51 offset:37696
    buffer_load_dwordx4 v37, s[32:35], s92 offen offset:1024 lds
    v_mfma_f32_16x16x32_bf16 v[60:63], a[76:79], v[20:23], v[60:63]
    ds_read_b128 v[72:75], v49 offset:128
    v_pk_fmac_f16 v36, v140, v140
    v_mfma_f32_16x16x32_bf16 v[4:7], a[100:103], v[20:23], v[4:7]
    ds_read_b128 v[52:55], v49 offset:1664
    v_pk_fmac_f16 v36, v141, v141
    v_mfma_f32_16x16x32_bf16 v[100:103], a[124:127], v[20:23], v[100:103]
    ds_read_b128 v[20:23], v49 offset:3200
    v_mfma_f32_16x16x32_bf16 v[120:123], a[80:83], v[0:3], v[120:123]
    ds_read_b32 v186, v186 offset:336
    v_mfma_f32_16x16x32_bf16 v[148:151], a[104:107], v[0:3], v[148:151]
    buffer_load_dwordx4 v11, s[32:35], s92 offen offset:2048 lds
    v_mfma_f32_16x16x32_bf16 v[56:59], a[128:131], v[0:3], v[56:59]
    s_waitcnt lgkmcnt(7)
    s_add_u32 m0, s90, 24576
    ds_read_b128 v[0:3], v48 offset:41088
    v_mfma_f32_16x16x32_bf16 v[116:119], a[80:83], v[32:35], v[116:119]
    s_mov_b32 s92, 74496
    ds_read_b32 v187, v187 offset:336
    v_mov_b32 v38, 0
    v_mfma_f32_16x16x32_bf16 v[104:107], a[104:107], v[32:35], v[104:107]
    v_mov_b32 v39, 0
    v_mfma_f32_16x16x32_bf16 v[92:95], a[128:131], v[32:35], v[92:95]
    s_waitcnt lgkmcnt(5)
    ds_read_b128 v[32:35], v48 offset:42624
    buffer_load_dwordx4 v84, s[32:35], s92 offen offset:0 lds
    v_mfma_f32_16x16x32_bf16 v[248:251], a[80:83], v[72:75], v[248:251]
    s_waitcnt vmcnt(10)
    ds_read_b64_tr_b16 a[88:89], v51 offset:49152
    v_mfma_f32_16x16x32_bf16 v[44:47], a[104:107], v[72:75], v[44:47]
    ds_read_b64_tr_b16 a[90:91], v51 offset:49920
    v_mfma_f32_16x16x32_bf16 v[12:15], a[128:131], v[72:75], v[12:15]
    s_waitcnt lgkmcnt(5)
    ds_read_b64_tr_b16 a[112:113], v51 offset:49184
    v_mfma_f32_16x16x32_bf16 v[228:231], a[80:83], v[52:55], v[228:231]
    ds_read_b64_tr_b16 a[114:115], v51 offset:49952
    v_mfma_f32_16x16x32_bf16 v[16:19], a[104:107], v[52:55], v[16:19]
    ds_read_b64_tr_b16 a[136:137], v51 offset:49216
    buffer_load_dwordx4 v37, s[32:35], s92 offen offset:1024 lds
    v_mfma_f32_16x16x32_bf16 v[68:71], a[128:131], v[52:55], v[68:71]
    ds_read_b64_tr_b16 a[138:139], v51 offset:49984
    v_mfma_f32_16x16x32_bf16 v[60:63], a[80:83], v[20:23], v[60:63]
    ds_read_b128 v[80:83], v48 offset:128
    v_mfma_f32_16x16x32_bf16 v[4:7], a[104:107], v[20:23], v[4:7]
    ds_read_b128 v[72:75], v48 offset:1664
    v_mfma_f32_16x16x32_bf16 v[100:103], a[128:131], v[20:23], v[100:103]
    s_waitcnt lgkmcnt(8)
    ds_read_b128 v[20:23], v48 offset:3200
    v_mfma_f32_16x16x32_bf16 v[120:123], a[84:87], v[0:3], v[120:123]
    buffer_load_dwordx4 v11, s[32:35], s92 offen offset:2048 lds
    v_mfma_f32_16x16x32_bf16 v[148:151], a[108:111], v[0:3], v[148:151]
    s_add_u32 m0, s90, 36864
    s_cmp_ge_u32 s2, 248
    s_cbranch_scc1 L_maskF
L_nomaskF:
    v_mfma_f32_16x16x32_bf16 v[56:59], a[132:135], v[0:3], v[56:59]
    s_mov_b32 s92, 111360
    ds_read_b128 v[52:55], v48 offset:41216
    v_readlane_b32 s84, v211, 48
    v_mfma_f32_16x16x32_bf16 v[116:119], a[84:87], v[32:35], v[116:119]
    ds_read_b128 v[76:79], v48 offset:42752
    v_cmp_gt_u32 vcc, 16, v85
    v_mfma_f32_16x16x32_bf16 v[104:107], a[108:111], v[32:35], v[104:107]
    ds_read_b128 v[0:3], v48 offset:256
    v_cndmask_b32 v208, v89, v208, vcc
    v_mfma_f32_16x16x32_bf16 v[92:95], a[132:135], v[32:35], v[92:95]
    s_waitcnt lgkmcnt(5)
    ds_read_b128 v[32:35], v48 offset:1792
    buffer_load_dwordx4 v84, s[32:35], s92 offen offset:0 lds
    v_cndmask_b32 v209, v89, v209, vcc
    v_mfma_f32_16x16x32_bf16 v[248:251], a[84:87], v[80:83], v[248:251]
    s_waitcnt vmcnt(10)
    ds_read_b64_tr_b16 a[92:93], v51 offset:61440
    v_cndmask_b32 v210, v89, v210, vcc
    v_mfma_f32_16x16x32_bf16 v[44:47], a[108:111], v[80:83], v[44:47]
    ds_read_b64_tr_b16 a[94:95], v51 offset:62208
    v_cmp_gt_u32 vcc, 49, v85
    v_mfma_f32_16x16x32_bf16 v[12:15], a[132:135], v[80:83], v[12:15]
    s_waitcnt lgkmcnt(6)
    ds_read_b64_tr_b16 a[116:117], v51 offset:61472
    v_cndmask_b32 v211, v89, v211, vcc
    v_mfma_f32_16x16x32_bf16 v[228:231], a[84:87], v[72:75], v[228:231]
    ds_read_b64_tr_b16 a[118:119], v51 offset:62240
    v_mfma_f32_16x16x32_bf16 v[16:19], a[108:111], v[72:75], v[16:19]
    buffer_load_dwordx4 v37, s[32:35], s92 offen offset:1024 lds
    ds_read_b64_tr_b16 a[140:141], v51 offset:61504
    v_mfma_f32_16x16x32_bf16 v[68:71], a[132:135], v[72:75], v[68:71]
    ds_read_b64_tr_b16 a[142:143], v51 offset:62272
    v_mfma_f32_16x16x32_bf16 v[60:63], a[84:87], v[20:23], v[60:63]
    ds_read_b128 v[72:75], v48 offset:3328
    v_mfma_f32_16x16x32_bf16 v[4:7], a[108:111], v[20:23], v[4:7]
    ds_read_b128 v[96:99], v49 offset:41216
    v_mfma_f32_16x16x32_bf16 v[100:103], a[132:135], v[20:23], v[100:103]
    ds_read_b128 v[80:83], v49 offset:42752
    buffer_load_dwordx4 v11, s[32:35], s92 offen offset:2048 lds
    s_add_u32 m0, s90, 49152
    s_mov_b32 s92, 148224
    ds_read_b128 v[20:23], v49 offset:256
    buffer_load_dwordx4 v84, s[32:35], s92 offen offset:0 lds
    s_waitcnt vmcnt(10)
    ds_read_b64_tr_b16 a[144:145], v158 offset:0
    ds_read_b64_tr_b16 a[146:147], v158 offset:768
    s_waitcnt lgkmcnt(4)
    v_mfma_f32_16x16x32_bf16 v[120:123], a[88:91], v[96:99], v[120:123]
    ds_read_b64_tr_b16 a[168:169], v158 offset:8
    v_mfma_f32_16x16x32_bf16 v[120:123], a[92:95], v[52:55], v[120:123]
    ds_read_b64_tr_b16 a[170:171], v158 offset:776
    v_mfma_f32_16x16x32_bf16 v[148:151], a[112:115], v[96:99], v[148:151]
    ds_read_b64_tr_b16 a[192:193], v51 offset:64
    v_mfma_f32_16x16x32_bf16 v[148:151], a[116:119], v[52:55], v[148:151]
    buffer_load_dwordx4 v37, s[32:35], s92 offen offset:1024 lds
    ds_read_b64_tr_b16 a[194:195], v51 offset:832
    v_mfma_f32_16x16x32_bf16 v[56:59], a[136:139], v[96:99], v[56:59]
    s_nop 0
    v_cvt_pk_f16_f32 v120, v120, v121
    v_cvt_pk_f16_f32 v121, v122, v123
    v_mfma_f32_16x16x32_bf16 v[56:59], a[140:143], v[52:55], v[56:59]
    s_waitcnt lgkmcnt(6)
    ds_read_b128 v[52:55], v49 offset:1792
    v_pk_fma_f16 v89, v120, v120, s3
    v_mfma_f32_16x16x32_bf16 v[116:119], a[88:91], v[80:83], v[116:119]
    v_pk_fmac_f16 v89, v121, v121
    v_cvt_pk_f16_f32 v122, v148, v149
    v_mfma_f32_16x16x32_bf16 v[116:119], a[92:95], v[76:79], v[116:119]
    v_cvt_pk_f16_f32 v123, v150, v151
    v_pk_fmac_f16 v89, v122, v122
    v_mfma_f32_16x16x32_bf16 v[104:107], a[112:115], v[80:83], v[104:107]
    s_nop 0
    buffer_load_dwordx4 v11, s[32:35], s92 offen offset:2048 lds
    v_pk_fmac_f16 v89, v123, v123
    v_mfma_f32_16x16x32_bf16 v[104:107], a[116:119], v[76:79], v[104:107]
    s_add_u32 m0, s90, 61440
    v_cvt_pk_f16_f32 v116, v116, v117
    v_cvt_pk_f16_f32 v117, v118, v119
    v_mfma_f32_16x16x32_bf16 v[92:95], a[136:139], v[80:83], v[92:95]
    s_mov_b32 s92, 185088
    v_pk_fma_f16 v91, v116, v116, s3
    v_pk_fmac_f16 v91, v117, v117
    v_mfma_f32_16x16x32_bf16 v[92:95], a[140:143], v[76:79], v[92:95]
    ds_read_b128 v[76:79], v49 offset:3328
    v_cvt_pk_f16_f32 v118, v104, v105
    v_mfma_f32_16x16x32_bf16 v[248:251], a[88:91], v[20:23], v[248:251]
    v_cvt_pk_f16_f32 v119, v106, v107
    v_pk_fmac_f16 v91, v118, v118
    v_mfma_f32_16x16x32_bf16 v[248:251], a[92:95], v[0:3], v[248:251]
    s_waitcnt vmcnt(9)
    buffer_load_dwordx4 v84, s[32:35], s92 offen offset:0 lds
    ds_read_b64_tr_b16 a[148:149], v158 offset:12288
    v_mfma_f32_16x16x32_bf16 v[44:47], a[112:115], v[20:23], v[44:47]
    v_pk_fmac_f16 v91, v119, v119
    v_cvt_pk_f16_f32 v80, v92, v93
    v_mfma_f32_16x16x32_bf16 v[44:47], a[116:119], v[0:3], v[44:47]
    ds_read_b64_tr_b16 a[150:151], v158 offset:13056
    v_cvt_pk_f16_f32 v81, v94, v95
    v_mfma_f32_16x16x32_bf16 v[12:15], a[136:139], v[20:23], v[12:15]
    ds_read_b64_tr_b16 a[172:173], v158 offset:12296
    v_pk_fmac_f16 v91, v80, v80
    v_mfma_f32_16x16x32_bf16 v[12:15], a[140:143], v[0:3], v[12:15]
L_pg0:
    s_cbranch_execz L_main
    s_waitcnt lgkmcnt(4)
    ds_read_b64_tr_b16 a[174:175], v158 offset:13064
    v_pk_fmac_f16 v91, v81, v81
    v_mfma_f32_16x16x32_bf16 v[228:231], a[88:91], v[52:55], v[228:231]
    buffer_load_dwordx4 v37, s[32:35], s92 offen offset:1024 lds
    ds_read_b64_tr_b16 a[196:197], v51 offset:12352
    v_mfma_f32_16x16x32_bf16 v[228:231], a[92:95], v[32:35], v[228:231]
    ds_read_b64_tr_b16 a[198:199], v51 offset:13120
    v_cvt_pk_f16_f32 v8, v248, v249
    v_mfma_f32_16x16x32_bf16 v[16:19], a[112:115], v[52:55], v[16:19]
    ds_read_b128 v[20:23], v49 offset:40960
    v_cvt_pk_f16_f32 v9, v250, v251
    v_mfma_f32_16x16x32_bf16 v[16:19], a[116:119], v[32:35], v[16:19]
    ds_read_b128 v[0:3], v49 offset:0
    v_pk_fma_f16 v225, v8, v8, s3
    v_mfma_f32_16x16x32_bf16 v[68:71], a[136:139], v[52:55], v[68:71]
    v_pk_fmac_f16 v225, v9, v9
    v_cvt_pk_f16_f32 v10, v44, v45
    v_mfma_f32_16x16x32_bf16 v[68:71], a[140:143], v[32:35], v[68:71]
    s_waitcnt lgkmcnt(7)
    s_mov_b32 s53, s47
    buffer_load_dwordx4 v11, s[32:35], s92 offen offset:2048 lds
    ds_read_b128 v[32:35], v49 offset:1536
    v_mfma_f32_16x16x32_bf16 v[60:63], a[88:91], v[76:79], v[60:63]
    s_add_u32 m0, s54, 20480
    v_cvt_pk_f16_f32 v11, v46, v47
    v_pk_fmac_f16 v225, v10, v10
    v_mfma_f32_16x16x32_bf16 v[60:63], a[92:95], v[72:75], v[60:63]
    s_mov_b32 s47, s46
    v_pk_fmac_f16 v225, v11, v11
    v_cvt_pk_f16_f32 v154, v12, v13
    v_mfma_f32_16x16x32_bf16 v[4:7], a[112:115], v[76:79], v[4:7]
    s_mov_b32 s46, s45
    ds_read_b128 v[52:55], v49 offset:3072
    v_cvt_pk_f16_f32 v155, v14, v15
    v_mfma_f32_16x16x32_bf16 v[4:7], a[116:119], v[72:75], v[4:7]
    s_mov_b32 s45, s44
    v_pk_fmac_f16 v225, v154, v154
    v_pk_fmac_f16 v225, v155, v155
    v_mfma_f32_16x16x32_bf16 v[100:103], a[136:139], v[76:79], v[100:103]
    s_waitcnt vmcnt(9)
    s_mov_b32 s44, s53
    ds_read_b64_tr_b16 a[152:153], v158 offset:24576
    buffer_load_dwordx4 v130, s[24:27], s56 offen nt lds
    v_mfma_f32_16x16x32_bf16 v[100:103], a[140:143], v[72:75], v[100:103]
    s_waitcnt lgkmcnt(4)
    s_add_u32 m0, s54, 21504
    ds_read_b64_tr_b16 a[154:155], v158 offset:25344
    v_cvt_pk_f16_f32 v60, v60, v61
    v_mfma_f32_16x16x32_bf16 v[252:255], a[144:147], v[20:23], 0
    s_sub_u32 s48, s44, s46
    ds_read_b64_tr_b16 a[176:177], v158 offset:24584
    v_cvt_pk_f16_f32 v61, v62, v63
    v_mfma_f32_16x16x32_bf16 v[248:251], a[168:171], v[20:23], 0
    s_sub_u32 s49, s46, s45
    ds_read_b64_tr_b16 a[178:179], v158 offset:25352
    v_pk_fma_f16 v37, v60, v60, s3
    v_mfma_f32_16x16x32_bf16 v[244:247], a[192:195], v[20:23], 0
    s_waitcnt lgkmcnt(5)
    s_sub_u32 s50, s45, s44
    ds_read_b64_tr_b16 a[200:201], v51 offset:24640
    v_pk_fmac_f16 v37, v61, v61
    v_mfma_f32_16x16x32_bf16 v[236:239], v[0:3], a[144:147], 0
    s_sub_u32 s51, s46, s47
    ds_read_b64_tr_b16 a[202:203], v51 offset:25408
    buffer_load_dwordx4 v129, s[24:27], s56 offen nt lds
    v_mfma_f32_16x16x32_bf16 v[20:23], v[0:3], a[168:171], 0
    s_add_u32 m0, s54, 22528
    ds_read_b128 v[44:47], v48 offset:40960
    v_cvt_pk_f16_f32 v62, v4, v5
    v_cvt_pk_f16_f32 v63, v6, v7
    v_pk_fmac_f16 v37, v62, v62
    v_pk_fmac_f16 v37, v63, v63
    v_mfma_f32_16x16x32_bf16 v[240:243], v[0:3], a[192:195], 0
    s_mov_b32 s60, s59
    ds_read_b128 v[12:15], v48 offset:0
    v_cvt_pk_f16_f32 v142, v100, v101
    v_mfma_f32_16x16x32_bf16 v[104:107], v[32:35], a[144:147], 0
    s_mov_b32 s59, s58
    ds_read_b128 v[0:3], v48 offset:1536
    v_cvt_pk_f16_f32 v143, v102, v103
    v_pk_fmac_f16 v37, v142, v142
    v_pk_fmac_f16 v37, v143, v143
    v_mfma_f32_16x16x32_bf16 v[72:75], v[32:35], a[168:171], 0
    s_mov_b32 s58, s57
    buffer_load_dwordx4 v128, s[24:27], s56 offen nt lds
    v_cvt_pk_f16_f32 v6, v56, v57
    v_mfma_f32_16x16x32_bf16 v[96:99], v[32:35], a[192:195], 0
    s_waitcnt lgkmcnt(5)
    s_add_u32 m0, s54, 23552
    ds_read_b128 v[32:35], v48 offset:3072
    v_cvt_pk_f16_f32 v7, v58, v59
    v_mfma_f32_16x16x32_bf16 v[92:95], v[52:55], a[144:147], 0
    s_mov_b32 s57, s56
    v_pk_fmac_f16 v89, v6, v6
    v_pk_fmac_f16 v89, v7, v7
    v_mfma_f32_16x16x32_bf16 v[76:79], v[52:55], a[168:171], 0
    s_mov_b32 s7, s6
    v_add_u32 v137, s48, v137
    v_add_u32 v136, s48, v136
    v_mfma_f32_16x16x32_bf16 v[232:235], v[52:55], a[192:195], 0
    s_waitcnt lgkmcnt(3)
    s_mov_b32 s6, s5
    v_add_u32 v135, s49, v135
    v_add_u32 v134, s49, v134
    v_mfma_f32_16x16x32_bf16 v[252:255], a[148:151], v[44:47], v[252:255]
    s_waitcnt vmcnt(9)
    s_mov_b32 s5, s4
    ds_read_b64_tr_b16 a[156:157], v158 offset:36864
    buffer_load_dwordx4 v127, s[24:27], s56 offen nt lds
    v_mfma_f32_16x16x32_bf16 v[248:251], a[172:175], v[44:47], v[248:251]
    s_add_u32 m0, s54, 24576
    ds_read_b64_tr_b16 a[158:159], v158 offset:37632
    v_add_u32 v137, s50, v137
    v_mfma_f32_16x16x32_bf16 v[244:247], a[196:199], v[44:47], v[244:247]
    s_waitcnt lgkmcnt(3)
    s_sub_u32 s14, s6, s7
    ds_read_b64_tr_b16 a[180:181], v158 offset:36872
    v_add_u32 v136, s50, v136
    v_mfma_f32_16x16x32_bf16 v[236:239], v[12:15], a[148:151], v[236:239]
    s_add_u32 s61, s61, 1
    ds_read_b64_tr_b16 a[182:183], v158 offset:37640
    v_add_u32 v135, s48, v135
    v_mfma_f32_16x16x32_bf16 v[20:23], v[12:15], a[172:175], v[20:23]
    s_add_u32 s12, s12, 20
    ds_read_b64_tr_b16 a[204:205], v51 offset:36928
    v_add_u32 v134, s48, v134
    v_mfma_f32_16x16x32_bf16 v[240:243], v[12:15], a[196:199], v[240:243]
    s_max_u32 s12, s12, s61
    ds_read_b64_tr_b16 a[206:207], v51 offset:37696
    buffer_load_dwordx4 v126, s[24:27], s56 offen nt lds
    v_mfma_f32_16x16x32_bf16 v[104:107], v[0:3], a[148:151], v[104:107]
    s_cmp_lt_u32 s61, s71
    ds_read_b128 v[56:59], v49 offset:41088
    v_add_u32 v133, s51, v133
    v_mfma_f32_16x16x32_bf16 v[72:75], v[0:3], a[172:175], v[72:75]
    s_cselect_b32 s15, s61, s12
    ds_read_b128 v[44:47], v49 offset:128
    v_add_u32 v132, s14, v132
    v_mfma_f32_16x16x32_bf16 v[96:99], v[0:3], a[196:199], v[96:99]
    s_waitcnt lgkmcnt(8)
    s_cselect_b32 s56, s69, s70
    ds_read_b128 v[52:55], v49 offset:1664
    v_add_u32 v131, s14, v131
    v_mfma_f32_16x16x32_bf16 v[92:95], v[32:35], a[148:151], v[92:95]
    s_add_u32 s56, s56, s15
    ds_read_b128 v[0:3], v49 offset:3200
    v_cvt_pk_f16_f32 v12, v228, v229
    v_mfma_f32_16x16x32_bf16 v[76:79], v[32:35], a[172:175], v[76:79]
    s_mul_i32 s53, s56, 58255
    buffer_load_dword v84, v128, s[28:31], s72 offen nt
    v_cvt_pk_f16_f32 v13, v230, v231
    v_mfma_f32_16x16x32_bf16 v[232:235], v[32:35], a[196:199], v[232:235]
    s_lshr_b32 s53, s53, 22
    v_pk_fma_f16 v227, v12, v12, s3
    v_pk_fmac_f16 v227, v13, v13
    v_mfma_f32_16x16x32_f16 v[32:35], v[212:215], v[36:39], 0
    s_mul_i32 s53, s53, s63
    ds_read_b128 v[36:39], v48 offset:41088
    v_cvt_pk_f16_f32 v14, v16, v17
    v_mfma_f32_16x16x32_f16 v[100:103], v[212:215], v[88:91], 0
    s_waitcnt vmcnt(9) lgkmcnt(4)
    s_mul_i32 s56, s56, s62
    v_cvt_pk_f16_f32 v15, v18, v19
    v_pk_fmac_f16 v227, v14, v14
    v_pk_fmac_f16 v227, v15, v15
    v_cvt_pk_f16_f32 v148, v68, v69
    s_add_u32 s56, s56, s53
    s_mul_i32 s4, s15, 112
    ds_read_b64_tr_b16 a[160:161], v158 offset:49152
    v_mfma_f32_16x16x32_bf16 v[252:255], a[152:155], v[56:59], v[252:255]
    s_cmp_ge_u32 s15, 16
    v_or3_b32 v125, v125, v100, v101
    v_or3_b32 v125, v125, v102, v103
    v_mfma_f32_16x16x32_bf16 v[248:251], a[176:179], v[56:59], v[248:251]
    s_cselect_b32 s53, -30464, 0
    ds_read_b64_tr_b16 a[162:163], v158 offset:49920
    v_cvt_pk_f16_f32 v149, v70, v71
    v_mfma_f32_16x16x32_bf16 v[244:247], a[200:203], v[56:59], v[244:247]
    s_waitcnt lgkmcnt(3)
    s_add_u32 s4, s4, s53
    ds_read_b64_tr_b16 a[184:185], v158 offset:49160
    v_pk_fmac_f16 v227, v148, v148
    v_mfma_f32_16x16x32_bf16 v[236:239], v[44:47], a[152:155], v[236:239]
    s_cmp_lt_u32 s15, s73
    ds_read_b64_tr_b16 a[186:187], v158 offset:49928
    v_pk_fmac_f16 v227, v149, v149
    v_mfma_f32_16x16x32_bf16 v[20:23], v[44:47], a[176:179], v[20:23]
    s_cselect_b32 s26, 100270464, 0
    ds_read_b64_tr_b16 a[208:209], v51 offset:49216
    v_mfma_f32_16x16x32_bf16 v[240:243], v[44:47], a[200:203], v[240:243]
    s_cselect_b32 s56, s56, 0
    ds_read_b64_tr_b16 a[210:211], v51 offset:49984
    v_mfma_f32_16x16x32_bf16 v[104:107], v[52:55], a[152:155], v[104:107]
    s_cselect_b32 s4, s4, -1
    ds_read_b128 v[44:47], v48 offset:128
    v_mfma_f32_16x16x32_bf16 v[72:75], v[52:55], a[176:179], v[72:75]
    s_cselect_b32 s15, s15, 0
    ds_read_b128 v[16:19], v48 offset:1664
    v_mfma_f32_16x16x32_bf16 v[96:99], v[52:55], a[200:203], v[96:99]
    s_cselect_b32 s13, s13, -1
    ds_read_b128 v[56:59], v48 offset:3200
    v_mfma_f32_16x16x32_bf16 v[92:95], v[0:3], a[152:155], v[92:95]
    s_bitset1_b32 s64, s15
    v_rsq_f32 v100, v100
    v_mfma_f32_16x16x32_bf16 v[76:79], v[0:3], a[176:179], v[76:79]
    s_add_u32 s65, s65, 1
    v_rsq_f32 v101, v101
    v_mfma_f32_16x16x32_bf16 v[232:235], v[0:3], a[200:203], v[232:235]
    s_waitcnt lgkmcnt(6)
    s_cmp_ge_i32 s65, 2
    ds_read_b128 v[68:71], v48 offset:41216
    v_mul_f32 v100, s52, v100
    v_mfma_f32_16x16x32_bf16 v[252:255], a[156:159], v[36:39], v[252:255]
    s_cselect_b32 s30, 100270464, 0
    ds_read_b128 v[0:3], v48 offset:256
    v_cvt_pk_f16_f32 v100, v100, v101
    v_mfma_f32_16x16x32_bf16 v[248:251], a[180:183], v[36:39], v[248:251]
    s_add_u32 s67, s46, s54
    ds_read_b128 v[52:55], v48 offset:1792
    v_pk_mul_f16 v64, v64, v100 op_sel:[0,0] op_sel_hi:[1,0]
    v_mfma_f32_16x16x32_bf16 v[244:247], a[204:207], v[36:39], v[244:247]
    s_waitcnt lgkmcnt(5)
    ds_read_b128 v[36:39], v48 offset:3328
    v_pk_mul_f16 v65, v65, v100 op_sel:[0,0] op_sel_hi:[1,0]
    v_rsq_f32 v102, v102
    v_mfma_f32_16x16x32_bf16 v[236:239], v[44:47], a[156:159], v[236:239]
    s_waitcnt vmcnt(6)
    s_mov_b32 s53, s47
    ds_read_b64_tr_b16 a[164:165], v158 offset:61440
    v_mul_f32 v102, s52, v102
    v_mfma_f32_16x16x32_bf16 v[20:23], v[44:47], a[180:183], v[20:23]
    s_mov_b32 s47, s46
    ds_read_b64_tr_b16 a[166:167], v158 offset:62208
    v_pk_mul_f16 v66, v66, v100 op_sel:[0,0] op_sel_hi:[1,0]
    v_mfma_f32_16x16x32_bf16 v[240:243], v[44:47], a[204:207], v[240:243]
    s_waitcnt lgkmcnt(6)
    s_mov_b32 s46, s45
    ds_read_b64_tr_b16 a[188:189], v158 offset:61448
    v_pk_mul_f16 v67, v67, v100 op_sel:[0,0] op_sel_hi:[1,0]
    v_mfma_f32_16x16x32_bf16 v[104:107], v[16:19], a[156:159], v[104:107]
    s_mov_b32 s45, s44
    ds_read_b64_tr_b16 a[190:191], v158 offset:62216
    v_mov_b32 v171, 0
    v_mfma_f32_16x16x32_bf16 v[72:75], v[16:19], a[180:183], v[72:75]
    s_sub_u32 s49, s46, s45
    ds_read_b64_tr_b16 a[212:213], v51 offset:61504
    v_mov_b32 v150, 0
    v_mfma_f32_16x16x32_bf16 v[96:99], v[16:19], a[204:207], v[96:99]
    s_mov_b32 s44, s53
    ds_read_b64_tr_b16 a[214:215], v51 offset:62272
    v_mov_b32 v151, 0
    v_mfma_f32_16x16x32_bf16 v[92:95], v[56:59], a[156:159], v[92:95]
    s_sub_u32 s48, s44, s46
    ds_read_b128 v[44:47], v49 offset:41216
    v_mov_b32 v144, 0
    v_mfma_f32_16x16x32_bf16 v[76:79], v[56:59], a[180:183], v[76:79]
    s_mul_i32 s93, s68, 18432
    ds_read_b128 v[16:19], v49 offset:256
    v_mov_b32 v145, 0
    v_mfma_f32_16x16x32_bf16 v[232:235], v[56:59], a[204:207], v[232:235]
    ds_read_b128 v[56:59], v49 offset:1792
    v_mov_b32 v138, 0
    v_mov_b32 v139, 0
    v_mfma_f32_16x16x32_f16 v[88:91], v[212:215], v[224:227], 0
    v_rsq_f32 v103, v103
    v_pk_mul_f16 v156, v156, v100 op_sel:[0,0] op_sel_hi:[1,0]
    v_cvt_pk_f16_f32 v102, v102, v103
    v_pk_mul_f16 v157, v157, v100 op_sel:[0,0] op_sel_hi:[1,0]
    v_pk_mul_f16 v120, v120, v100 op_sel:[0,1] op_sel_hi:[1,1]
    v_pk_mul_f16 v121, v121, v100 op_sel:[0,1] op_sel_hi:[1,1]
    v_pk_mul_f16 v122, v122, v100 op_sel:[0,1] op_sel_hi:[1,1]
    v_pk_mul_f16 v123, v123, v100 op_sel:[0,1] op_sel_hi:[1,1]
    v_pk_mul_f16 v6, v6, v100 op_sel:[0,1] op_sel_hi:[1,1]
    v_pk_mul_f16 v7, v7, v100 op_sel:[0,1] op_sel_hi:[1,1]
    v_fma_mix_f32 v34, v64, v120, 0 op_sel:[0,0,0] op_sel_hi:[1,1,0]
    v_fma_mix_f32 v34, v64, v120, v34 op_sel:[1,1,0] op_sel_hi:[1,1,0]
    v_fma_mix_f32 v34, v65, v121, v34 op_sel:[0,0,0] op_sel_hi:[1,1,0]
    v_fma_mix_f32 v34, v65, v121, v34 op_sel:[1,1,0] op_sel_hi:[1,1,0]
    v_fma_mix_f32 v34, v66, v122, v34 op_sel:[0,0,0] op_sel_hi:[1,1,0]
    v_fma_mix_f32 v34, v66, v122, v34 op_sel:[1,1,0] op_sel_hi:[1,1,0]
    v_fma_mix_f32 v34, v67, v123, v34 op_sel:[0,0,0] op_sel_hi:[1,1,0]
    v_fma_mix_f32 v34, v67, v123, v34 op_sel:[1,1,0] op_sel_hi:[1,1,0]
    v_fma_mix_f32 v34, v156, v6, v34 op_sel:[0,0,0] op_sel_hi:[1,1,0]
    v_fma_mix_f32 v34, v156, v6, v34 op_sel:[1,1,0] op_sel_hi:[1,1,0]
    v_fma_mix_f32 v34, v157, v7, v34 op_sel:[0,0,0] op_sel_hi:[1,1,0]
    s_waitcnt lgkmcnt(2)
    v_mfma_f32_16x16x32_bf16 v[252:255], a[160:163], v[44:47], v[252:255]
    v_fma_mix_f32 v34, v157, v7, v34 op_sel:[1,1,0] op_sel_hi:[1,1,0]
    v_mov_b32 v35, v34
    v_mfma_f32_16x16x32_bf16 v[252:255], a[164:167], v[68:71], v[252:255]
    s_nop 0
    v_permlane32_swap_b32 v35, v34
    v_mfma_f32_16x16x32_bf16 v[248:251], a[184:187], v[44:47], v[248:251]
    s_movk_i32 s92, 0
    v_add_f32 v34, v35, v34
    v_mov_b32 v35, v34
    v_mfma_f32_16x16x32_bf16 v[248:251], a[188:191], v[68:71], v[248:251]
    s_nop 0
    v_permlane16_swap_b32 v35, v34
    v_mfma_f32_16x16x32_bf16 v[244:247], a[208:211], v[44:47], v[244:247]
    ds_read_b128 v[44:47], v49 offset:3328
    v_add_f32 v34, v35, v34
    v_mfma_f32_16x16x32_bf16 v[244:247], a[212:215], v[68:71], v[244:247]
    s_waitcnt lgkmcnt(1)
    v_add_f32 v34, s84, v34
    v_mov_b32 v82, 0
    v_mfma_f32_16x16x32_bf16 v[236:239], v[16:19], a[160:163], v[236:239]
    v_exp_f32 v34, v34
    v_mfma_f32_16x16x32_bf16 v[236:239], v[0:3], a[164:167], v[236:239]
    v_cvt_pk_bf16_f32 v34, v34, 0
    v_cmp_gt_u32 vcc, 16, v85
    v_mfma_f32_16x16x32_bf16 v[20:23], v[16:19], a[184:187], v[20:23]
    s_nop 0
    v_cndmask_b32 v34, 0, v34, vcc
    v_mov_b32 v83, 0
    v_mfma_f32_16x16x32_bf16 v[20:23], v[0:3], a[188:191], v[20:23]
    v_mov_b32 v35, 0
    v_add_u32 v51, 28672, v50
    v_mfma_f32_16x16x32_bf16 v[240:243], v[16:19], a[208:211], v[240:243]
    ds_write_b128 v51, v[120:123]
    v_mfma_f32_16x16x32_bf16 v[240:243], v[0:3], a[212:215], v[240:243]
    v_cvt_pk_bf16_f32 v0, v236, v237
    v_cvt_pk_bf16_f32 v1, v238, v239
    v_mfma_f32_16x16x32_bf16 v[104:107], v[56:59], a[160:163], v[104:107]
    v_cvt_pk_bf16_f32 v16, v20, v21
    v_cvt_pk_bf16_f32 v17, v22, v23
    v_mfma_f32_16x16x32_bf16 v[104:107], v[52:55], a[164:167], v[104:107]
    s_nop 0
    ds_write2_b64 v51, v[82:83], v[82:83] offset0:2 offset1:3
    v_mfma_f32_16x16x32_bf16 v[72:75], v[56:59], a[184:187], v[72:75]
    s_nop 0
    v_cvt_pk_bf16_f32 v4, v240, v241
    v_cvt_pk_bf16_f32 v5, v242, v243
    v_mfma_f32_16x16x32_bf16 v[72:75], v[52:55], a[188:191], v[72:75]
    s_nop 0
    v_cvt_pk_bf16_f32 v2, v104, v105
    v_cvt_pk_bf16_f32 v3, v106, v107
    v_mfma_f32_16x16x32_bf16 v[96:99], v[56:59], a[208:211], v[96:99]
    s_add_u32 m0, s67, 0
    ds_write_b128 v51, v[64:67] offset:32
    v_mfma_f32_16x16x32_bf16 v[96:99], v[52:55], a[212:215], v[96:99]
    s_waitcnt lgkmcnt(2)
    v_cvt_pk_bf16_f32 v18, v72, v73
    v_cvt_pk_bf16_f32 v19, v74, v75
    v_mfma_f32_16x16x32_bf16 v[92:95], v[44:47], a[160:163], v[92:95]
    v_or3_b32 v125, v125, v88, v89
    v_or3_b32 v125, v125, v90, v91
    v_mfma_f32_16x16x32_bf16 v[92:95], v[36:39], a[164:167], v[92:95]
    ds_write2_b64 v51, v[6:7], v[82:83] offset0:6 offset1:7
    v_mfma_f32_16x16x32_bf16 v[76:79], v[44:47], a[184:187], v[76:79]
    v_cvt_pk_bf16_f32 v6, v96, v97
    v_cvt_pk_bf16_f32 v7, v98, v99
    v_mfma_f32_16x16x32_bf16 v[76:79], v[36:39], a[188:191], v[76:79]
    v_rsq_f32 v88, v88
    v_mfma_f32_16x16x32_bf16 v[232:235], v[44:47], a[208:211], v[232:235]
    ds_write2_b64 v51, v[82:83], v[156:157] offset0:8 offset1:9
    v_mfma_f32_16x16x32_bf16 v[232:235], v[36:39], a[212:215], v[232:235]
    global_load_dword v101, v167, s[38:39] offset:248 sc1
    v_mul_f32 v88, s52, v88
    v_rsq_f32 v89, v89
    v_or3_b32 v125, v125, v32, v33
    v_cvt_pk_f16_f32 v88, v88, v89
    ds_write_b64 v51, v[34:35] offset:88
    v_rsq_f32 v32, v32
    v_rsq_f32 v33, v33
    v_mul_f32 v32, s52, v32
    ds_read_b128 v[68:71], v132 offset:0
    v_cvt_pk_f16_f32 v32, v32, v33
    v_pk_mul_f16 v60, v60, v32 op_sel:[0,1] op_sel_hi:[1,1]
    v_pk_mul_f16 v61, v61, v32 op_sel:[0,1] op_sel_hi:[1,1]
    ds_read_b128 v[72:75], v132 offset:16
    v_pk_mul_f16 v62, v62, v32 op_sel:[0,1] op_sel_hi:[1,1]
    v_pk_mul_f16 v63, v63, v32 op_sel:[0,1] op_sel_hi:[1,1]
    v_pk_mul_f16 v142, v142, v32 op_sel:[0,1] op_sel_hi:[1,1]
    ds_read_b128 v[56:59], v132 offset:48
    v_pk_mul_f16 v143, v143, v32 op_sel:[0,1] op_sel_hi:[1,1]
    v_pk_mul_f16 v40, v40, v32 op_sel:[0,0] op_sel_hi:[1,0]
    v_pk_mul_f16 v41, v41, v32 op_sel:[0,0] op_sel_hi:[1,0]
    v_pk_mul_f16 v42, v42, v32 op_sel:[0,0] op_sel_hi:[1,0]
    v_pk_mul_f16 v43, v43, v32 op_sel:[0,0] op_sel_hi:[1,0]
    v_pk_mul_f16 v140, v140, v32 op_sel:[0,0] op_sel_hi:[1,0]
    v_pk_mul_f16 v141, v141, v32 op_sel:[0,0] op_sel_hi:[1,0]
    v_rsq_f32 v90, v90
    v_rsq_f32 v91, v91
    v_mul_f32 v90, s52, v90
    v_cvt_pk_f16_f32 v90, v90, v91
    v_pk_mul_f16 v8, v8, v88 op_sel:[0,1] op_sel_hi:[1,1]
    v_pk_mul_f16 v9, v9, v88 op_sel:[0,1] op_sel_hi:[1,1]
    v_pk_mul_f16 v10, v10, v88 op_sel:[0,1] op_sel_hi:[1,1]
    v_pk_mul_f16 v11, v11, v88 op_sel:[0,1] op_sel_hi:[1,1]
    v_pk_mul_f16 v154, v154, v88 op_sel:[0,1] op_sel_hi:[1,1]
    v_pk_mul_f16 v155, v155, v88 op_sel:[0,1] op_sel_hi:[1,1]
    v_pk_mul_f16 v24, v24, v88 op_sel:[0,0] op_sel_hi:[1,0]
    v_pk_mul_f16 v25, v25, v88 op_sel:[0,0] op_sel_hi:[1,0]
    v_pk_mul_f16 v26, v26, v88 op_sel:[0,0] op_sel_hi:[1,0]
    v_pk_mul_f16 v27, v27, v88 op_sel:[0,0] op_sel_hi:[1,0]
    v_pk_mul_f16 v152, v152, v88 op_sel:[0,0] op_sel_hi:[1,0]
    v_pk_mul_f16 v153, v153, v88 op_sel:[0,0] op_sel_hi:[1,0]
    v_mfma_f32_16x16x32_f16 v[32:35], v[8:11], v[24:27], v[204:207]
    ds_read_b128 v[224:227], v49 offset:42496
    v_pk_mul_f16 v12, v12, v90 op_sel:[0,1] op_sel_hi:[1,1]
    v_mfma_f32_16x16x32_f16 v[32:35], v[152:155], v[150:153], v[32:35]
    ds_read_b128 v[120:123], v48 offset:42496
    v_pk_mul_f16 v13, v13, v90 op_sel:[0,1] op_sel_hi:[1,1]
    v_mfma_f32_16x16x32_f16 v[36:39], v[60:63], v[24:27], v[196:199]
    ds_read_b128 v[104:107], v49 offset:42624
    v_pk_mul_f16 v14, v14, v90 op_sel:[0,1] op_sel_hi:[1,1]
    v_mfma_f32_16x16x32_f16 v[36:39], v[140:143], v[150:153], v[36:39]
    s_waitcnt lgkmcnt(3)
    ds_read_b128 v[64:67], v48 offset:42624
    v_pk_mul_f16 v15, v15, v90 op_sel:[0,1] op_sel_hi:[1,1]
    v_mfma_f32_16x16x32_f16 v[96:99], v[68:71], v[24:27], v[208:211]
    ds_read_b128 v[52:55], v49 offset:42752
    v_pk_mul_f16 v148, v148, v90 op_sel:[0,1] op_sel_hi:[1,1]
    v_mfma_f32_16x16x32_f16 v[96:99], v[72:75], v[8:11], v[96:99]
    ds_read_b128 v[44:47], v48 offset:42752
    v_pk_mul_f16 v149, v149, v90 op_sel:[0,1] op_sel_hi:[1,1]
    v_mfma_f32_16x16x32_f16 v[96:99], v[56:59], v[152:155], v[96:99]
    v_pk_mul_f16 v28, v28, v90 op_sel:[0,0] op_sel_hi:[1,0]
    v_pk_mul_f16 v29, v29, v90 op_sel:[0,0] op_sel_hi:[1,0]
    v_pk_mul_f16 v30, v30, v90 op_sel:[0,0] op_sel_hi:[1,0]
    v_pk_mul_f16 v31, v31, v90 op_sel:[0,0] op_sel_hi:[1,0]
    v_pk_mul_f16 v146, v146, v90 op_sel:[0,0] op_sel_hi:[1,0]
    v_pk_mul_f16 v147, v147, v90 op_sel:[0,0] op_sel_hi:[1,0]
    v_mfma_f32_16x16x32_f16 v[20:23], v[12:15], v[24:27], v[200:203]
    v_cvt_pk_bf16_f32 v82, v252, v253
    v_cvt_pk_bf16_f32 v83, v254, v255
    v_mfma_f32_16x16x32_f16 v[20:23], v[146:149], v[150:153], v[20:23]
    s_waitcnt lgkmcnt(5)
    v_cvt_pk_bf16_f32 v88, v248, v249
    v_cvt_pk_bf16_f32 v89, v250, v251
    v_mfma_f32_16x16x32_bf16 v[24:27], a[144:147], v[224:227], 0
    s_waitcnt lgkmcnt(4)
    v_cvt_pk_bf16_f32 v90, v244, v245
    v_cvt_pk_bf16_f32 v91, v246, v247
    v_mfma_f32_16x16x32_bf16 v[24:27], a[148:151], v[120:123], v[24:27]
    s_waitcnt lgkmcnt(3)
    v_cvt_pk_bf16_f32 v164, v92, v93
    v_cvt_pk_bf16_f32 v165, v94, v95
    v_mfma_f32_16x16x32_bf16 v[24:27], a[152:155], v[104:107], v[24:27]
    s_waitcnt lgkmcnt(2)
    ds_write_b64 v50, v[82:83] offset:28752
    v_mfma_f32_16x16x32_bf16 v[24:27], a[156:159], v[64:67], v[24:27]
    s_waitcnt vmcnt(1) lgkmcnt(1)
    v_cvt_pk_bf16_f32 v160, v76, v77
    v_cvt_pk_bf16_f32 v161, v78, v79
    v_mfma_f32_16x16x32_bf16 v[24:27], a[160:163], v[52:55], v[24:27]
    s_barrier
    ds_write_b128 v50, v[88:91] offset:28768
    v_mfma_f32_16x16x32_bf16 v[24:27], a[164:167], v[44:47], v[24:27]
    buffer_load_dwordx4 v130, s[24:27], s56 offen nt lds
    v_cvt_pk_bf16_f32 v156, v232, v233
    v_mfma_f32_16x16x32_bf16 v[76:79], a[168:171], v[224:227], 0
    s_add_u32 m0, s67, 1024
    v_cvt_pk_bf16_f32 v157, v234, v235
    v_add_u32 v137, s48, v137
    v_mfma_f32_16x16x32_bf16 v[76:79], a[172:175], v[120:123], v[76:79]
    ds_read_u16 v166, v131 offset:80
    v_cvt_pk_bf16_f32 v82, v24, v25
    v_mfma_f32_16x16x32_bf16 v[76:79], a[176:179], v[104:107], v[76:79]
    ds_read_u16 v162, v131 offset:96
    v_cvt_pk_bf16_f32 v83, v26, v27
    v_mfma_f32_16x16x32_bf16 v[76:79], a[180:183], v[64:67], v[76:79]
    ds_read_u16 v158, v131 offset:104
    v_add_u32 v136, s48, v136
    v_mfma_f32_16x16x32_bf16 v[76:79], a[184:187], v[52:55], v[76:79]
    buffer_load_dwordx4 v129, s[24:27], s56 offen nt lds
    v_lshl_add_u32 v100, v85, 4, s93
    v_mfma_f32_16x16x32_bf16 v[76:79], a[188:191], v[44:47], v[76:79]
    s_mov_b32 s93, 0
    v_exp_f32 v32, v32
    v_mfma_f32_16x16x32_bf16 v[24:27], a[192:195], v[224:227], 0
    s_add_u32 m0, s67, 2048
    v_exp_f32 v33, v33
    v_mfma_f32_16x16x32_bf16 v[24:27], a[196:199], v[120:123], v[24:27]
    v_exp_f32 v34, v34
    v_mfma_f32_16x16x32_bf16 v[24:27], a[200:203], v[104:107], v[24:27]
    v_cvt_pk_bf16_f32 v76, v76, v77
    v_cvt_pk_bf16_f32 v77, v78, v79
    v_mfma_f32_16x16x32_bf16 v[24:27], a[204:207], v[64:67], v[24:27]
    buffer_load_dwordx4 v128, s[24:27], s56 offen nt lds
    v_cvt_pk_bf16_f32 v88, v32, v33
    v_mfma_f32_16x16x32_bf16 v[24:27], a[208:211], v[52:55], v[24:27]
    s_add_u32 m0, s67, 3072
    v_exp_f32 v35, v35
    v_mfma_f32_16x16x32_bf16 v[24:27], a[212:215], v[44:47], v[24:27]
    v_exp_f32 v20, v20
    v_mfma_f32_16x16x32_f16 v[252:255], v[68:71], v[28:31], v[208:211]
    s_nop 0
    ds_read_b128 v[64:67], v137 offset:0
    v_cvt_pk_bf16_f32 v89, v34, v35
    v_mfma_f32_16x16x32_f16 v[252:255], v[72:75], v[12:15], v[252:255]
    s_nop 0
    ds_read_b128 v[52:55], v136 offset:0
    v_cvt_pk_bf16_f32 v78, v24, v25
    v_mfma_f32_16x16x32_f16 v[252:255], v[56:59], v[146:149], v[252:255]
    ds_read_b128 v[32:35], v137 offset:256
    buffer_load_dwordx4 v127, s[24:27], s56 offen nt lds
    v_mfma_f32_16x16x32_f16 v[44:47], v[68:71], v[40:43], v[208:211]
    s_add_u32 m0, s67, 4096
    v_exp_f32 v21, v21
    v_mfma_f32_16x16x32_f16 v[44:47], v[72:75], v[60:63], v[44:47]
    v_cvt_pk_bf16_f32 v79, v26, v27
    v_cvt_pk_bf16_f32 v90, v20, v21
    v_mfma_f32_16x16x32_f16 v[44:47], v[56:59], v[140:143], v[44:47]
    v_exp_f32 v22, v22
    v_mfma_f32_16x16x32_f16 v[240:243], v[8:11], v[28:31], v[192:195]
    v_exp_f32 v23, v23
    v_mfma_f32_16x16x32_f16 v[240:243], v[152:155], v[144:147], v[240:243]
    v_cvt_pk_bf16_f32 v91, v22, v23
    v_mov_b32_dpp v99, v255 quad_perm:[0,1,2,3] row_mask:0x2 bank_mask:0xf
    v_mfma_f32_16x16x32_f16 v[72:75], v[12:15], v[28:31], v[188:191]
    ds_read_b128 v[56:59], v136 offset:128
    buffer_load_dwordx4 v126, s[24:27], s56 offen nt lds
    v_mfma_f32_16x16x32_f16 v[72:75], v[146:149], v[144:147], v[72:75]
    v_exp_f32 v36, v36
    v_mfma_f32_16x16x32_f16 v[68:71], v[60:63], v[28:31], v[184:187]
    v_exp_f32 v37, v37
    v_mfma_f32_16x16x32_f16 v[68:71], v[140:143], v[144:147], v[68:71]
    v_exp_f32 v38, v38
    v_mfma_f32_16x16x32_f16 v[20:23], v[8:11], v[40:43], v[180:183]
    ds_read_b128 v[28:31], v136 offset:256
    v_cvt_pk_bf16_f32 v168, v36, v37
    v_mfma_f32_16x16x32_f16 v[20:23], v[152:155], v[138:141], v[20:23]
    v_exp_f32 v39, v39
    v_exp_f32 v96, v96
    v_cvt_pk_bf16_f32 v169, v38, v39
    v_mfma_f32_16x16x32_f16 v[8:11], v[12:15], v[40:43], v[176:179]
    v_cvt_pk_bf16_f32 v170, v96, 0
    v_mov_b32_dpp v99, v47 quad_perm:[0,1,2,3] row_mask:0x4 bank_mask:0xf
    v_mfma_f32_16x16x32_f16 v[8:11], v[146:149], v[138:141], v[8:11]
    ds_read_b128 v[36:39], v137 offset:128
    v_mfma_f32_16x16x32_bf16 v[24:27], v[220:223], v[88:91], 0
    v_exp_f32 v99, v99
    v_mfma_f32_16x16x32_bf16 v[24:27], v[220:223], v[168:171], v[24:27]
    v_exp_f32 v46, v46
    v_mfma_f32_16x16x32_bf16 v[248:251], v[0:3], v[88:91], 0
    s_waitcnt lgkmcnt(2)
    v_exp_f32 v20, v20
    v_mfma_f32_16x16x32_bf16 v[248:251], v[164:167], v[168:171], v[248:251]
    v_exp_f32 v21, v21
    v_mfma_f32_16x16x32_bf16 v[232:235], v[16:19], v[88:91], 0
    v_cvt_pk_bf16_f32 v99, v99, v99
    v_cvt_pk_bf16_f32 v224, v20, v21
    v_mfma_f32_16x16x32_bf16 v[232:235], v[160:163], v[168:171], v[232:235]
    ds_write_b16 v131, v99 offset:64
    v_mfma_f32_16x16x32_bf16 v[96:99], v[4:7], v[88:91], 0
    ds_read_b128 v[244:247], v132 offset:48
    v_mfma_f32_16x16x32_bf16 v[96:99], v[156:159], v[168:171], v[96:99]
    ds_read_b128 v[104:107], v132 offset:64
    v_mfma_f32_16x16x32_f16 v[236:239], v[60:63], v[40:43], v[172:175]
    v_exp_f32 v22, v22
    v_mfma_f32_16x16x32_f16 v[236:239], v[140:143], v[138:141], v[236:239]
    v_exp_f32 v23, v23
    v_mfma_f32_16x16x32_bf16 v[228:231], a[24:27], v[64:67], 0
    v_exp_f32 v8, v8
    v_mfma_f32_16x16x32_bf16 v[228:231], a[28:31], v[52:55], v[228:231]
    s_waitcnt lgkmcnt(3)
    ds_read_b128 v[92:95], v137 offset:1664
    v_cvt_pk_bf16_f32 v225, v22, v23
    v_mfma_f32_16x16x32_bf16 v[228:231], a[32:35], v[36:39], v[228:231]
    ds_read_b128 v[40:43], v136 offset:1792
    v_mfma_f32_16x16x32_bf16 v[228:231], a[36:39], v[56:59], v[228:231]
    v_exp_f32 v9, v9
    v_mfma_f32_16x16x32_bf16 v[228:231], a[40:43], v[32:35], v[228:231]
    v_exp_f32 v10, v10
    v_mfma_f32_16x16x32_bf16 v[228:231], a[44:47], v[28:31], v[228:231]
    v_exp_f32 v11, v11
    v_mfma_f32_16x16x32_bf16 v[12:15], a[120:123], v[64:67], 0
    ds_read_b128 v[120:123], v136 offset:1536
    v_cvt_pk_bf16_f32 v226, v8, v9
    v_mfma_f32_16x16x32_bf16 v[12:15], a[124:127], v[52:55], v[12:15]
    ds_read_b128 v[140:143], v137 offset:1536
    v_cvt_pk_bf16_f32 v227, v10, v11
    v_mfma_f32_16x16x32_bf16 v[12:15], a[128:131], v[36:39], v[12:15]
    v_exp_f32 v236, v236
    v_mfma_f32_16x16x32_bf16 v[12:15], a[132:135], v[56:59], v[12:15]
    v_exp_f32 v237, v237
    v_mfma_f32_16x16x32_bf16 v[12:15], a[136:139], v[32:35], v[12:15]
    v_exp_f32 v238, v238
    v_mfma_f32_16x16x32_bf16 v[12:15], a[140:143], v[28:31], v[12:15]
    v_exp_f32 v239, v239
    v_mfma_f32_16x16x32_bf16 v[20:23], a[48:51], v[64:67], 0
    v_exp_f32 v240, v240
    v_mfma_f32_16x16x32_bf16 v[20:23], a[52:55], v[52:55], v[20:23]
    v_exp_f32 v241, v241
    v_mfma_f32_16x16x32_bf16 v[20:23], a[56:59], v[36:39], v[20:23]
    v_exp_f32 v242, v242
    v_mfma_f32_16x16x32_bf16 v[20:23], a[60:63], v[56:59], v[20:23]
    v_exp_f32 v243, v243
    v_mfma_f32_16x16x32_bf16 v[20:23], a[64:67], v[32:35], v[20:23]
    ds_read_b128 v[88:91], v136 offset:1664
    v_cvt_pk_bf16_f32 v240, v240, v241
    v_mfma_f32_16x16x32_bf16 v[20:23], a[68:71], v[28:31], v[20:23]
    ds_read_b128 v[60:63], v137 offset:1792
    v_cvt_pk_bf16_f32 v241, v242, v243
    v_exp_f32 v72, v72
    v_exp_f32 v73, v73
    v_exp_f32 v74, v74
    v_exp_f32 v75, v75
    v_cvt_pk_bf16_f32 v242, v72, v73
    v_cvt_pk_bf16_f32 v243, v74, v75
L_pg1:
    s_cbranch_execz L_main
    v_exp_f32 v68, v68
    v_exp_f32 v69, v69
    v_exp_f32 v70, v70
    v_exp_f32 v71, v71
    v_cvt_pk_bf16_f32 v168, v68, v69
    v_cvt_pk_bf16_f32 v169, v70, v71
    v_exp_f32 v253, v253
    s_waitcnt vmcnt(5)
    v_readfirstlane_b32 s94, v101
    s_nop 1
    s_cmp_lt_u32 s94, 3
    s_cbranch_scc1 L_spin
L_spinr:
    v_cvt_pk_bf16_f32 v170, v253, 0
    v_mfma_f32_16x16x32_bf16 v[8:11], v[220:223], v[240:243], 0
    buffer_load_dwordx4 a[216:219], v100, s[76:79], s92 offen offset:0 sc1
    v_cvt_pk_f16_f32 v152, v20, v21
    v_mfma_f32_16x16x32_bf16 v[8:11], v[220:223], v[168:171], v[8:11]
    v_cvt_pk_f16_f32 v153, v22, v23
    v_cvt_pk_f16_f32 v26, v228, v229
    v_mfma_f32_16x16x32_bf16 v[72:75], v[0:3], v[240:243], 0
    v_rcp_f32 v25, v24
    v_mfma_f32_16x16x32_bf16 v[72:75], v[164:167], v[168:171], v[72:75]
    v_max3_u32 v124, v124, v24, v25
    v_mul_f32 v248, v248, v25
    v_mfma_f32_16x16x32_bf16 v[20:23], v[16:19], v[240:243], 0
    v_mul_f32 v249, v249, v25
    v_cvt_pk_bf16_f32 v44, v248, v249
    v_mfma_f32_16x16x32_bf16 v[20:23], v[160:163], v[168:171], v[20:23]
    buffer_load_dwordx4 a[220:223], v100, s[76:79], s92 offen offset:1024 sc1
    v_mul_f32 v250, v250, v25
    v_mfma_f32_16x16x32_bf16 v[68:71], v[4:7], v[240:243], 0
    v_mul_f32 v251, v251, v25
    v_cvt_pk_bf16_f32 v45, v250, v251
    v_mfma_f32_16x16x32_bf16 v[68:71], v[156:159], v[168:171], v[68:71]
    s_waitcnt lgkmcnt(0)
    v_cvt_pk_bf16_f32 v168, v236, v237
    v_cvt_pk_bf16_f32 v169, v238, v239
    v_mfma_f32_16x16x32_bf16 v[240:243], a[48:51], v[140:143], 0
    v_cvt_pk_bf16_f32 v170, v46, 0
    v_mul_f32 v232, v232, v25
    v_mfma_f32_16x16x32_bf16 v[240:243], a[52:55], v[120:123], v[240:243]
    v_mul_f32 v233, v233, v25
    v_cvt_pk_bf16_f32 v46, v232, v233
    v_mfma_f32_16x16x32_bf16 v[240:243], a[56:59], v[92:95], v[240:243]
    buffer_load_dwordx4 a[224:227], v100, s[76:79], s92 offen offset:2048 sc1
    v_mul_f32 v234, v234, v25
    v_mfma_f32_16x16x32_bf16 v[240:243], a[60:63], v[88:91], v[240:243]
    v_mul_f32 v235, v235, v25
    v_cvt_pk_bf16_f32 v47, v234, v235
    v_mfma_f32_16x16x32_bf16 v[240:243], a[64:67], v[60:63], v[240:243]
    v_mul_f32 v96, v96, v25
    v_mul_f32 v97, v97, v25
    v_mfma_f32_16x16x32_bf16 v[240:243], a[68:71], v[40:43], v[240:243]
    v_cvt_pk_bf16_f32 v24, v96, v97
    v_mul_f32 v98, v98, v25
    v_mfma_f32_16x16x32_bf16 v[236:239], v[64:67], a[144:147], 0
    v_mul_f32 v99, v99, v25
    v_cvt_pk_bf16_f32 v25, v98, v99
    v_mfma_f32_16x16x32_bf16 v[236:239], v[52:55], a[148:151], v[236:239]
    buffer_load_dwordx4 a[228:231], v100, s[76:79], s92 offen offset:3072 sc1
    v_cvt_pk_f16_f32 v27, v230, v231
    v_mfma_f32_16x16x32_bf16 v[236:239], v[36:39], a[152:155], v[236:239]
    s_movk_i32 s92, 4096
    v_rcp_f32 v9, v8
    v_mfma_f32_16x16x32_bf16 v[236:239], v[56:59], a[156:159], v[236:239]
    v_max3_u32 v124, v124, v8, v9
    v_mul_f32 v72, v72, v9
    v_mfma_f32_16x16x32_bf16 v[236:239], v[32:35], a[160:163], v[236:239]
    v_mul_f32 v73, v73, v9
    v_cvt_pk_bf16_f32 v232, v72, v73
    v_mfma_f32_16x16x32_bf16 v[236:239], v[28:31], a[164:167], v[236:239]
    s_lshl_b32 s93, s68, 10
    v_mul_f32 v74, v74, v9
    v_mul_f32 v75, v75, v9
    v_mfma_f32_16x16x32_bf16 v[248:251], a[72:75], v[64:67], 0
    buffer_load_dwordx4 a[232:235], v100, s[76:79], s92 offen offset:0 sc1
    v_cvt_pk_bf16_f32 v233, v74, v75
    v_mfma_f32_16x16x32_bf16 v[248:251], a[76:79], v[52:55], v[248:251]
    v_mul_f32 v20, v20, v9
    v_mul_f32 v21, v21, v9
    v_mfma_f32_16x16x32_bf16 v[248:251], a[80:83], v[36:39], v[248:251]
    v_cvt_pk_bf16_f32 v234, v20, v21
    v_mul_f32 v22, v22, v9
    v_mfma_f32_16x16x32_bf16 v[248:251], a[84:87], v[56:59], v[248:251]
    v_mul_f32 v23, v23, v9
    v_cvt_pk_bf16_f32 v235, v22, v23
    v_mfma_f32_16x16x32_bf16 v[248:251], a[88:91], v[32:35], v[248:251]
    v_mul_f32 v68, v68, v9
    v_mul_f32 v69, v69, v9
    v_mfma_f32_16x16x32_bf16 v[248:251], a[92:95], v[28:31], v[248:251]
    buffer_load_dwordx4 a[236:239], v100, s[76:79], s92 offen offset:1024 sc1
    v_cvt_pk_bf16_f32 v10, v68, v69
    v_mfma_f32_16x16x32_bf16 v[20:23], v[64:67], a[168:171], 0
    s_nop 0
    v_mul_f32 v70, v70, v9
    v_mul_f32 v71, v71, v9
    v_mfma_f32_16x16x32_bf16 v[20:23], v[52:55], a[172:175], v[20:23]
    s_nop 0
    v_cvt_pk_f16_f32 v8, v248, v249
    v_cvt_pk_f16_f32 v9, v250, v251
    v_mfma_f32_16x16x32_bf16 v[20:23], v[36:39], a[176:179], v[20:23]
    v_pk_fma_f16 v49, v8, v8, s3
    v_pk_fmac_f16 v49, v9, v9
    v_mfma_f32_16x16x32_bf16 v[20:23], v[56:59], a[180:183], v[20:23]
    v_cvt_pk_bf16_f32 v11, v70, v71
    v_cvt_pk_f16_f32 v154, v12, v13
    v_mfma_f32_16x16x32_bf16 v[20:23], v[32:35], a[184:187], v[20:23]
    buffer_load_dwordx4 a[240:243], v100, s[76:79], s92 offen offset:2048 sc1
    v_cvt_pk_f16_f32 v155, v14, v15
    v_mfma_f32_16x16x32_bf16 v[20:23], v[28:31], a[188:191], v[20:23]
    v_add_u32 v14, s93, v163
    v_cvt_pk_f16_f32 v146, v240, v241
    v_mfma_f32_16x16x32_bf16 v[228:231], a[72:75], v[140:143], 0
    v_cvt_pk_f16_f32 v147, v242, v243
    v_pk_mul_f16 v108, v108, v102 op_sel:[0,0] op_sel_hi:[1,0]
    v_mfma_f32_16x16x32_bf16 v[228:231], a[76:79], v[120:123], v[228:231]
    ds_write_b32 v135, v44 offset:0
    v_mfma_f32_16x16x32_bf16 v[228:231], a[80:83], v[92:95], v[228:231]
    v_pk_mul_f16 v109, v109, v102 op_sel:[0,0] op_sel_hi:[1,0]
    v_pk_mul_f16 v110, v110, v102 op_sel:[0,0] op_sel_hi:[1,0]
    v_mfma_f32_16x16x32_bf16 v[228:231], a[84:87], v[88:91], v[228:231]
    buffer_load_dwordx4 a[244:247], v100, s[76:79], s92 offen offset:3072 sc1
    v_pk_mul_f16 v111, v111, v102 op_sel:[0,0] op_sel_hi:[1,0]
    v_mfma_f32_16x16x32_bf16 v[228:231], a[88:91], v[60:63], v[228:231]
    s_movk_i32 s92, 8192
    ds_write_b32 v135, v45 offset:4
    v_mfma_f32_16x16x32_bf16 v[228:231], a[92:95], v[40:43], v[228:231]
    s_nop 0
    v_pk_mul_f16 v86, v86, v102 op_sel:[0,0] op_sel_hi:[1,0]
    v_pk_mul_f16 v87, v87, v102 op_sel:[0,0] op_sel_hi:[1,0]
    v_mfma_f32_16x16x32_bf16 v[72:75], v[220:223], v[224:227], 0
    s_nop 0
    ds_write_b64 v135, v[46:47] offset:8
    v_mfma_f32_16x16x32_bf16 v[72:75], v[220:223], v[168:171], v[72:75]
    s_nop 0
    v_cvt_pk_f16_f32 v12, v228, v229
    v_cvt_pk_f16_f32 v13, v230, v231
    v_mfma_f32_16x16x32_bf16 v[96:99], v[0:3], v[224:227], 0
    buffer_load_dwordx4 a[248:251], v100, s[76:79], s92 offen offset:0 sc1
    v_pk_fma_f16 v51, v12, v12, s3
    v_mfma_f32_16x16x32_bf16 v[96:99], v[164:167], v[168:171], v[96:99]
    ds_write_b32 v134, v24 offset:0
    v_mfma_f32_16x16x32_bf16 v[68:71], v[16:19], v[224:227], 0
    ds_write_b32 v134, v25 offset:4
    v_mfma_f32_16x16x32_bf16 v[68:71], v[160:163], v[168:171], v[68:71]
    s_nop 0
    v_rcp_f32 v73, v72
    v_mfma_f32_16x16x32_bf16 v[44:47], v[4:7], v[224:227], 0
    s_nop 0
    v_mul_f32 v96, v96, v73
    v_mul_f32 v97, v97, v73
    v_mfma_f32_16x16x32_bf16 v[44:47], v[156:159], v[168:171], v[44:47]
    buffer_load_dwordx4 a[252:255], v100, s[76:79], s92 offen offset:1024 sc1
    v_cvt_pk_bf16_f32 v96, v96, v97
    v_mfma_f32_16x16x32_bf16 v[240:243], v[64:67], a[192:195], 0
    v_mul_f32 v98, v98, v73
    v_mul_f32 v99, v99, v73
    v_mfma_f32_16x16x32_bf16 v[240:243], v[52:55], a[196:199], v[240:243]
    v_cvt_pk_bf16_f32 v97, v98, v99
    v_mul_f32 v68, v68, v73
    v_mfma_f32_16x16x32_bf16 v[240:243], v[36:39], a[200:203], v[240:243]
    ds_write_b64 v135, v[96:97] offset:3072
    v_mfma_f32_16x16x32_bf16 v[240:243], v[56:59], a[204:207], v[240:243]
    v_mul_f32 v69, v69, v73
    v_cvt_pk_bf16_f32 v98, v68, v69
    v_mfma_f32_16x16x32_bf16 v[240:243], v[32:35], a[208:211], v[240:243]
    buffer_load_dwordx4 v[224:227], v100, s[76:79], s92 offen offset:2048 sc1
    v_mul_f32 v70, v70, v73
    v_mfma_f32_16x16x32_bf16 v[240:243], v[28:31], a[212:215], v[240:243]
    v_mul_f32 v71, v71, v73
    v_cvt_pk_bf16_f32 v99, v70, v71
    v_mfma_f32_16x16x32_bf16 v[68:71], v[244:247], v[0:3], 0
    ds_write_b64 v135, v[98:99] offset:3080
    v_mfma_f32_16x16x32_bf16 v[68:71], v[104:107], v[164:167], v[68:71]
    v_mul_f32 v44, v44, v73
    v_mul_f32 v45, v45, v73
    v_mfma_f32_16x16x32_bf16 v[96:99], v[244:247], v[16:19], 0
    ds_write_b32 v135, v232 offset:1536
    v_mfma_f32_16x16x32_bf16 v[96:99], v[104:107], v[160:163], v[96:99]
    buffer_load_dwordx4 v[228:231], v100, s[76:79], s92 offen offset:3072 sc1
    v_cvt_pk_bf16_f32 v24, v44, v45
    v_mfma_f32_16x16x32_bf16 v[0:3], v[244:247], v[4:7], 0
    s_movk_i32 s92, 12288
    ds_write_b32 v134, v24 offset:3072
    v_mfma_f32_16x16x32_bf16 v[0:3], v[104:107], v[156:159], v[0:3]
    s_sub_u32 s50, s45, s44
    ds_write_b32 v135, v233 offset:1540
    v_mfma_f32_16x16x32_bf16 v[104:107], v[140:143], a[144:147], 0
    s_sub_u32 s51, s46, s47
    v_mul_f32 v46, v46, v73
    v_mul_f32 v47, v47, v73
    v_mfma_f32_16x16x32_bf16 v[104:107], v[120:123], a[148:151], v[104:107]
    s_mov_b32 s60, s59
    ds_write_b64 v135, v[234:235] offset:1544
    v_mfma_f32_16x16x32_bf16 v[104:107], v[92:95], a[152:155], v[104:107]
    s_mov_b32 s59, s58
    buffer_load_dwordx4 v[232:235], v100, s[76:79], s92 offen offset:0 sc1
    v_cvt_pk_bf16_f32 v25, v46, v47
    v_mfma_f32_16x16x32_bf16 v[104:107], v[88:91], a[156:159], v[104:107]
    s_mov_b32 s58, s57
    ds_write_b32 v134, v25 offset:3076
    v_mfma_f32_16x16x32_bf16 v[104:107], v[60:63], a[160:163], v[104:107]
    s_mov_b32 s57, s56
    ds_write_b64 v134, v[10:11] offset:1536
    v_mfma_f32_16x16x32_bf16 v[104:107], v[40:43], a[164:167], v[104:107]
    s_mov_b32 s7, s6
    v_pk_fmac_f16 v51, v13, v13
    v_cvt_pk_bf16_f32 v0, v236, v237
    v_mfma_f32_16x16x32_bf16 v[44:47], a[96:99], v[64:67], 0
    s_mov_b32 s6, s5
    v_cvt_pk_bf16_f32 v1, v238, v239
    v_mov_b32_dpp v71, v99 quad_perm:[0,1,2,3] row_mask:0x2 bank_mask:0xf
    v_mfma_f32_16x16x32_bf16 v[44:47], a[100:103], v[52:55], v[44:47]
    s_mov_b32 s5, s4
    buffer_load_dwordx4 v[236:239], v100, s[76:79], s92 offen offset:1024 sc1
    v_cvt_pk_bf16_f32 v4, v240, v241
    v_mfma_f32_16x16x32_bf16 v[44:47], a[104:107], v[36:39], v[44:47]
    s_sub_u32 s14, s6, s7
    v_cvt_pk_bf16_f32 v5, v242, v243
    v_mov_b32_dpp v71, v3 quad_perm:[0,1,2,3] row_mask:0x4 bank_mask:0xf
    v_mfma_f32_16x16x32_bf16 v[44:47], a[108:111], v[56:59], v[44:47]
    s_add_u32 s61, s61, 1
    v_cvt_pk_bf16_f32 v71, v71, v71
    v_max3_u32 v124, v124, v72, v73
    v_mfma_f32_16x16x32_bf16 v[44:47], a[112:115], v[32:35], v[44:47]
    s_add_u32 s12, s12, 20
    ds_write_b16 v131, v71
    v_mfma_f32_16x16x32_bf16 v[44:47], a[116:119], v[28:31], v[44:47]
    s_max_u32 s12, s12, s61
    v_pk_mul_f16 v116, v116, v102 op_sel:[0,1] op_sel_hi:[1,1]
    v_pk_mul_f16 v117, v117, v102 op_sel:[0,1] op_sel_hi:[1,1]
    v_mfma_f32_16x16x32_bf16 v[16:19], a[0:3], v[64:67], 0
    s_cmp_lt_u32 s61, s71
    buffer_load_dwordx4 v[240:243], v100, s[76:79], s92 offen offset:2048 sc1
    v_add_u32 v135, s49, v135
    v_mfma_f32_16x16x32_bf16 v[16:19], a[4:7], v[52:55], v[16:19]
    s_cselect_b32 s15, s61, s12
    ds_read_b128 v[52:55], v137 offset:3200
    v_add_u32 v134, s49, v134
    v_mfma_f32_16x16x32_bf16 v[16:19], a[8:11], v[36:39], v[16:19]
    s_cselect_b32 s56, s69, s70
    ds_read_b128 v[36:39], v137 offset:3328
    v_cvt_pk_f16_f32 v10, v44, v45
    v_mfma_f32_16x16x32_bf16 v[16:19], a[12:15], v[56:59], v[16:19]
    s_add_u32 s56, s56, s15
    v_cvt_pk_f16_f32 v11, v46, v47
    v_pk_fmac_f16 v49, v10, v10
    v_mfma_f32_16x16x32_bf16 v[16:19], a[16:19], v[32:35], v[16:19]
    s_mul_i32 s53, s56, 58255
    ds_read_b128 v[32:35], v136 offset:3328
    v_pk_fmac_f16 v49, v11, v11
    v_mfma_f32_16x16x32_bf16 v[16:19], a[20:23], v[28:31], v[16:19]
    s_lshr_b32 s53, s53, 22
    buffer_load_dwordx4 v[244:247], v100, s[76:79], s92 offen offset:3072 sc1
    v_pk_fmac_f16 v49, v154, v154
    v_mfma_f32_16x16x32_bf16 v[72:75], a[24:27], v[140:143], 0
    s_movk_i32 s92, 16384
    v_pk_fmac_f16 v49, v155, v155
    v_pk_mul_f16 v118, v118, v102 op_sel:[0,1] op_sel_hi:[1,1]
    v_mfma_f32_16x16x32_bf16 v[72:75], a[28:31], v[120:123], v[72:75]
    s_mul_i32 s53, s53, s63
    ds_read_b128 v[44:47], v136 offset:3200
    v_cvt_pk_f16_f32 v24, v16, v17
    v_mfma_f32_16x16x32_bf16 v[72:75], a[32:35], v[92:95], v[72:75]
    s_mul_i32 s56, s56, s62
    v_cvt_pk_f16_f32 v25, v18, v19
    v_pk_fma_f16 v48, v24, v24, s3
    v_mfma_f32_16x16x32_bf16 v[72:75], a[36:39], v[88:91], v[72:75]
    s_add_u32 s56, s56, s53
    v_pk_fmac_f16 v48, v25, v25
    v_pk_fmac_f16 v48, v26, v26
    v_mfma_f32_16x16x32_bf16 v[72:75], a[40:43], v[60:63], v[72:75]
    s_mul_i32 s4, s15, 112
    buffer_load_dwordx4 v[248:251], v100, s[76:79], s92 offen offset:0 sc1
    v_pk_fmac_f16 v48, v27, v27
    v_mfma_f32_16x16x32_bf16 v[72:75], a[44:47], v[40:43], v[72:75]
    s_cmp_ge_u32 s15, 16
    ds_read_b128 v[64:67], v137 offset:3072
    v_pk_fmac_f16 v48, v152, v152
    v_mfma_f32_16x16x32_bf16 v[16:19], a[96:99], v[140:143], 0
    s_cselect_b32 s53, -30464, 0
    ds_read_b128 v[56:59], v136 offset:3072
    v_pk_fmac_f16 v48, v153, v153
    v_mfma_f32_16x16x32_bf16 v[16:19], a[100:103], v[120:123], v[16:19]
    s_add_u32 s4, s4, s53
    v_cvt_pk_f16_f32 v30, v72, v73
    v_cvt_pk_f16_f32 v31, v74, v75
    v_mfma_f32_16x16x32_bf16 v[16:19], a[104:107], v[92:95], v[16:19]
    s_cmp_lt_u32 s15, s73
    v_pk_mul_f16 v119, v119, v102 op_sel:[0,1] op_sel_hi:[1,1]
    v_pk_mul_f16 v80, v80, v102 op_sel:[0,1] op_sel_hi:[1,1]
    v_mfma_f32_16x16x32_bf16 v[16:19], a[108:111], v[88:91], v[16:19]
    s_cselect_b32 s26, 100270464, 0
    buffer_load_dwordx4 v[252:255], v100, s[76:79], s92 offen offset:1024 sc1
    v_pk_mul_f16 v81, v81, v102 op_sel:[0,1] op_sel_hi:[1,1]
    v_mfma_f32_16x16x32_bf16 v[16:19], a[112:115], v[60:63], v[16:19]
    s_cselect_b32 s56, s56, 0
    v_fma_mix_f32 v6, v108, v116, 0 op_sel:[0,0,0] op_sel_hi:[1,1,0]
    v_fma_mix_f32 v6, v108, v116, v6 op_sel:[1,1,0] op_sel_hi:[1,1,0]
    v_mfma_f32_16x16x32_bf16 v[16:19], a[116:119], v[40:43], v[16:19]
    s_cselect_b32 s4, s4, -1
    ds_write_b128 v14, v[112:115] offset:6144
    v_mfma_f32_16x16x32_bf16 v[96:99], v[140:143], a[192:195], 0
    s_cselect_b32 s15, s15, 0
    v_fma_mix_f32 v6, v109, v117, v6 op_sel:[0,0,0] op_sel_hi:[1,1,0]
    v_fma_mix_f32 v6, v109, v117, v6 op_sel:[1,1,0] op_sel_hi:[1,1,0]
    v_mfma_f32_16x16x32_bf16 v[96:99], v[120:123], a[196:199], v[96:99]
    s_cselect_b32 s13, s13, -1
    v_cvt_pk_f16_f32 v14, v16, v17
    v_cvt_pk_f16_f32 v15, v18, v19
    v_mfma_f32_16x16x32_bf16 v[96:99], v[92:95], a[200:203], v[96:99]
    s_bitset1_b32 s64, s15
    ds_write_b64 v50, v[82:83] offset:80
    v_mfma_f32_16x16x32_bf16 v[96:99], v[88:91], a[204:207], v[96:99]
    s_add_u32 s65, s65, 1
    v_pk_fmac_f16 v51, v14, v14
    v_pk_fmac_f16 v51, v15, v15
    v_mfma_f32_16x16x32_bf16 v[96:99], v[60:63], a[208:211], v[96:99]
    s_cmp_ge_i32 s65, 2
    ds_write_b128 v50, v[76:79] offset:96
    v_mfma_f32_16x16x32_bf16 v[96:99], v[40:43], a[212:215], v[96:99]
    s_cselect_b32 s30, 100270464, 0
    v_fma_mix_f32 v6, v110, v118, v6 op_sel:[0,0,0] op_sel_hi:[1,1,0]
    v_fma_mix_f32 v6, v110, v118, v6 op_sel:[1,1,0] op_sel_hi:[1,1,0]
    v_mfma_f32_16x16x32_bf16 v[72:75], v[140:143], a[168:171], 0
    s_add_u32 s67, s46, s54
    v_fma_mix_f32 v6, v111, v119, v6 op_sel:[0,0,0] op_sel_hi:[1,1,0]
    v_fma_mix_f32 v6, v111, v119, v6 op_sel:[1,1,0] op_sel_hi:[1,1,0]
    v_mfma_f32_16x16x32_bf16 v[72:75], v[120:123], a[172:175], v[72:75]
    s_add_u32 m0, s67, 0
    v_fma_mix_f32 v6, v86, v80, v6 op_sel:[0,0,0] op_sel_hi:[1,1,0]
    v_fma_mix_f32 v6, v86, v80, v6 op_sel:[1,1,0] op_sel_hi:[1,1,0]
    v_mfma_f32_16x16x32_bf16 v[72:75], v[92:95], a[176:179], v[72:75]
    v_fma_mix_f32 v6, v87, v81, v6 op_sel:[0,0,0] op_sel_hi:[1,1,0]
    v_fma_mix_f32 v6, v87, v81, v6 op_sel:[1,1,0] op_sel_hi:[1,1,0]
    v_mfma_f32_16x16x32_bf16 v[72:75], v[88:91], a[180:183], v[72:75]
    v_mov_b32 v16, 0
    v_mov_b32 v17, 0
    v_mfma_f32_16x16x32_bf16 v[72:75], v[60:63], a[184:187], v[72:75]
    v_mov_b32 v7, 0
    v_add_u32 v2, 0, v50
    v_mfma_f32_16x16x32_bf16 v[72:75], v[40:43], a[188:191], v[72:75]
    s_nop 0
    ds_write2_b64 v2, v[16:17], v[16:17] offset0:2 offset1:3
    v_mfma_f32_16x16x32_bf16 v[76:79], a[0:3], v[140:143], 0
    s_nop 0
    v_mov_b32 v3, v6
    v_cmp_gt_u32 vcc, 1820327936, v124
    v_mfma_f32_16x16x32_bf16 v[76:79], a[4:7], v[120:123], v[76:79]
    s_nop 0
    v_cvt_pk_bf16_f32 v18, v72, v73
    v_cvt_pk_bf16_f32 v19, v74, v75
    v_mfma_f32_16x16x32_bf16 v[76:79], a[8:11], v[92:95], v[76:79]
    ds_write_b128 v2, v[108:111] offset:32
    v_mfma_f32_16x16x32_bf16 v[76:79], a[12:15], v[88:91], v[76:79]
    v_permlane32_swap_b32 v3, v6
    v_mfma_f32_16x16x32_bf16 v[76:79], a[16:19], v[60:63], v[76:79]
    v_add_f32 v6, v3, v6
    v_mov_b32 v3, v6
    v_mfma_f32_16x16x32_bf16 v[76:79], a[20:23], v[40:43], v[76:79]
    s_nop 0
    ds_write2_b64 v2, v[16:17], v[86:87] offset0:8 offset1:9
    v_mfma_f32_16x16x32_bf16 v[68:71], a[120:123], v[140:143], 0
    s_nop 0
    v_permlane16_swap_b32 v3, v6
    v_mfma_f32_16x16x32_bf16 v[68:71], a[124:127], v[120:123], v[68:71]
    s_nop 0
    v_add_f32 v6, v3, v6
    v_cvt_pk_f16_f32 v28, v76, v77
    v_mfma_f32_16x16x32_bf16 v[68:71], a[128:131], v[92:95], v[68:71]
    ds_write_b128 v2, v[116:119]
    v_mfma_f32_16x16x32_bf16 v[68:71], a[132:135], v[88:91], v[68:71]
    v_cvt_pk_f16_f32 v29, v78, v79
    v_pk_fma_f16 v50, v28, v28, s3
    v_mfma_f32_16x16x32_bf16 v[68:71], a[136:139], v[60:63], v[68:71]
    v_pk_fmac_f16 v50, v29, v29
    v_pk_fmac_f16 v50, v30, v30
    v_mfma_f32_16x16x32_bf16 v[68:71], a[140:143], v[40:43], v[68:71]
    s_waitcnt lgkmcnt(2)
    ds_write2_b64 v2, v[80:81], v[16:17] offset0:6 offset1:7
    v_mfma_f32_16x16x32_bf16 v[100:103], a[120:123], v[64:67], 0
    v_pk_fmac_f16 v50, v31, v31
    v_pk_fmac_f16 v50, v146, v146
    v_mfma_f32_16x16x32_bf16 v[100:103], a[124:127], v[56:59], v[100:103]
    v_pk_fmac_f16 v50, v147, v147
    v_add_f32 v6, s84, v6
    v_mfma_f32_16x16x32_bf16 v[100:103], a[128:131], v[52:55], v[100:103]
    v_exp_f32 v6, v6
    v_mfma_f32_16x16x32_bf16 v[100:103], a[132:135], v[44:47], v[100:103]
    v_cvt_pk_bf16_f32 v6, v6, 0
    v_cndmask_b32 v3, -1, v125, vcc
    v_mfma_f32_16x16x32_bf16 v[100:103], a[136:139], v[36:39], v[100:103]
    v_cmp_gt_u32 vcc, 16, v85
    v_and_b32 v3, 0xb8000000, v3
    v_mfma_f32_16x16x32_bf16 v[100:103], a[140:143], v[32:35], v[100:103]
    v_cndmask_b32 v6, 0, v6, vcc
    v_cmp_ne_u32 s[94:95], 0, v3
    v_mfma_f32_16x16x32_bf16 v[80:83], a[48:51], v[64:67], 0
    ds_write_b64 v2, v[6:7] offset:88
    v_mfma_f32_16x16x32_bf16 v[80:83], a[52:55], v[56:59], v[80:83]
    s_or_b32 s94, s94, s95
    v_mov_b32 v3, s94
    v_cvt_pk_f16_f32 v148, v68, v69
    v_mfma_f32_16x16x32_bf16 v[80:83], a[56:59], v[52:55], v[80:83]
    s_lshl_b32 s95, s68, 2
    v_mov_b32 v2, s95
    v_cvt_pk_f16_f32 v149, v70, v71
    v_mfma_f32_16x16x32_bf16 v[80:83], a[60:63], v[44:47], v[80:83]
    ds_write_b32 v2, v3 offset:14848
    v_mfma_f32_16x16x32_bf16 v[80:83], a[64:67], v[36:39], v[80:83]
    v_pk_fmac_f16 v51, v148, v148
    v_pk_fmac_f16 v51, v149, v149
    v_mfma_f32_16x16x32_bf16 v[80:83], a[68:71], v[32:35], v[80:83]
    v_add_u32 v137, s50, v137
    v_add_u32 v136, s50, v136
    v_mfma_f32_16x16x32_f16 v[88:91], v[212:215], v[48:51], 0
    v_add_u32 v135, s48, v135
    v_add_u32 v134, s48, v134
    v_mfma_f32_16x16x32_bf16 v[60:63], a[72:75], v[64:67], 0
    v_add_u32 v133, s51, v133
    v_add_u32 v132, s14, v132
    v_mfma_f32_16x16x32_bf16 v[60:63], a[76:79], v[56:59], v[60:63]
    s_nop 0
    ds_read_b128 v[72:75], v132 offset:16
    v_or3_b32 v125, v125, v88, v89
    v_mfma_f32_16x16x32_bf16 v[60:63], a[80:83], v[52:55], v[60:63]
    v_rsq_f32 v88, v88
    v_mfma_f32_16x16x32_bf16 v[60:63], a[84:87], v[44:47], v[60:63]
    v_rsq_f32 v89, v89
    v_mfma_f32_16x16x32_bf16 v[60:63], a[88:91], v[36:39], v[60:63]
    s_waitcnt vmcnt(0) lgkmcnt(1)
    v_mul_f32 v88, s52, v88
    v_cvt_pk_f16_f32 v88, v88, v89
    v_mfma_f32_16x16x32_bf16 v[60:63], a[92:95], v[32:35], v[60:63]
    s_barrier
    ds_read_b128 v[92:95], v167 offset:14848
    v_pk_mul_f16 v8, v8, v88 op_sel:[0,1] op_sel_hi:[1,1]
    v_mfma_f32_16x16x32_bf16 v[40:43], a[0:3], v[64:67], 0
    v_pk_mul_f16 v9, v9, v88 op_sel:[0,1] op_sel_hi:[1,1]
    v_pk_mul_f16 v10, v10, v88 op_sel:[0,1] op_sel_hi:[1,1]
    v_mfma_f32_16x16x32_bf16 v[40:43], a[4:7], v[56:59], v[40:43]
    v_pk_mul_f16 v11, v11, v88 op_sel:[0,1] op_sel_hi:[1,1]
    v_pk_mul_f16 v154, v154, v88 op_sel:[0,1] op_sel_hi:[1,1]
    v_mfma_f32_16x16x32_bf16 v[40:43], a[8:11], v[52:55], v[40:43]
    v_pk_mul_f16 v155, v155, v88 op_sel:[0,1] op_sel_hi:[1,1]
    v_or3_b32 v125, v125, v90, v91
    v_mfma_f32_16x16x32_bf16 v[40:43], a[12:15], v[44:47], v[40:43]
    v_rsq_f32 v90, v90
    v_mfma_f32_16x16x32_bf16 v[40:43], a[16:19], v[36:39], v[40:43]
    v_rsq_f32 v91, v91
    v_mfma_f32_16x16x32_bf16 v[40:43], a[20:23], v[32:35], v[40:43]
    v_mul_f32 v90, s52, v90
    v_cvt_pk_f16_f32 v90, v90, v91
    v_mfma_f32_16x16x32_bf16 v[76:79], v[64:67], a[168:171], 0
    v_cvt_pk_f16_f32 v60, v60, v61
    v_cvt_pk_f16_f32 v61, v62, v63
    v_mfma_f32_16x16x32_bf16 v[76:79], v[56:59], a[172:175], v[76:79]
    ds_read_b128 v[68:71], v132 offset:0
    v_pk_fma_f16 v49, v60, v60, s3
    v_mfma_f32_16x16x32_bf16 v[76:79], v[52:55], a[176:179], v[76:79]
    s_waitcnt lgkmcnt(1)
    v_pk_fmac_f16 v49, v61, v61
    v_or3_b32 v92, v92, v93, v94
    v_mfma_f32_16x16x32_bf16 v[76:79], v[44:47], a[180:183], v[76:79]
    v_or_b32 v92, v92, v95
    v_add_u32 v131, s14, v131
    v_mfma_f32_16x16x32_bf16 v[76:79], v[36:39], a[184:187], v[76:79]
    ds_read_u16 v162, v131 offset:96
    v_readfirstlane_b32 s75, v92
    v_mfma_f32_16x16x32_bf16 v[76:79], v[32:35], a[188:191], v[76:79]
    v_cvt_pk_bf16_f32 v2, v104, v105
    v_cvt_pk_bf16_f32 v3, v106, v107
    v_mfma_f32_16x16x32_bf16 v[92:95], v[64:67], a[144:147], 0
    v_cvt_pk_bf16_f32 v6, v96, v97
    v_cvt_pk_bf16_f32 v7, v98, v99
    v_mfma_f32_16x16x32_bf16 v[92:95], v[56:59], a[148:151], v[92:95]
    v_cvt_pk_f16_f32 v142, v100, v101
    v_cvt_pk_f16_f32 v143, v102, v103
    v_mfma_f32_16x16x32_bf16 v[92:95], v[52:55], a[152:155], v[92:95]
    v_pk_mul_f16 v24, v24, v88 op_sel:[0,0] op_sel_hi:[1,0]
    v_pk_mul_f16 v25, v25, v88 op_sel:[0,0] op_sel_hi:[1,0]
    v_mfma_f32_16x16x32_bf16 v[92:95], v[44:47], a[156:159], v[92:95]
    v_pk_mul_f16 v26, v26, v88 op_sel:[0,0] op_sel_hi:[1,0]
    v_pk_mul_f16 v27, v27, v88 op_sel:[0,0] op_sel_hi:[1,0]
    v_mfma_f32_16x16x32_bf16 v[92:95], v[36:39], a[160:163], v[92:95]
    v_pk_mul_f16 v152, v152, v88 op_sel:[0,0] op_sel_hi:[1,0]
    v_pk_mul_f16 v153, v153, v88 op_sel:[0,0] op_sel_hi:[1,0]
    v_mfma_f32_16x16x32_bf16 v[92:95], v[32:35], a[164:167], v[92:95]
    v_pk_mul_f16 v12, v12, v90 op_sel:[0,1] op_sel_hi:[1,1]
    v_pk_mul_f16 v13, v13, v90 op_sel:[0,1] op_sel_hi:[1,1]
    v_mfma_f32_16x16x32_bf16 v[96:99], a[24:27], v[64:67], 0
    v_pk_mul_f16 v14, v14, v90 op_sel:[0,1] op_sel_hi:[1,1]
    v_pk_mul_f16 v15, v15, v90 op_sel:[0,1] op_sel_hi:[1,1]
    v_mfma_f32_16x16x32_bf16 v[96:99], a[28:31], v[56:59], v[96:99]
    v_pk_mul_f16 v148, v148, v90 op_sel:[0,1] op_sel_hi:[1,1]
    v_pk_mul_f16 v149, v149, v90 op_sel:[0,1] op_sel_hi:[1,1]
    v_mfma_f32_16x16x32_bf16 v[96:99], a[32:35], v[52:55], v[96:99]
    v_cvt_pk_bf16_f32 v164, v92, v93
    v_cvt_pk_bf16_f32 v165, v94, v95
    v_mfma_f32_16x16x32_bf16 v[96:99], a[36:39], v[44:47], v[96:99]
    v_cvt_pk_f16_f32 v40, v40, v41
    v_cvt_pk_f16_f32 v41, v42, v43
    v_pk_mul_f16 v28, v28, v90 op_sel:[0,0] op_sel_hi:[1,0]
    v_pk_mul_f16 v29, v29, v90 op_sel:[0,0] op_sel_hi:[1,0]
    v_pk_mul_f16 v30, v30, v90 op_sel:[0,0] op_sel_hi:[1,0]
    v_pk_mul_f16 v31, v31, v90 op_sel:[0,0] op_sel_hi:[1,0]
    v_pk_mul_f16 v146, v146, v90 op_sel:[0,0] op_sel_hi:[1,0]
    v_pk_mul_f16 v147, v147, v90 op_sel:[0,0] op_sel_hi:[1,0]
    s_waitcnt lgkmcnt(0)
    s_cmp_lg_u32 s75, 0
    s_cbranch_scc0 L_atomF0r
    s_branch L_slow
.fill 422, 4, 0xbf810000
L_atomF0:
    s_cbranch_execz L_main
    v_mov_b32 v167, 0x800000
    buffer_atomic_add v167, v163, s[8:11], 0 offen sc0 sc1
    s_branch L_atomF0r
.p2alignl 6, 0xbf810000
L_loopF0:
    v_mfma_f32_16x16x32_bf16 v[46:49], a[4:7], v[12:15], v[46:49]
    v_mul_f32 v154, v154, v69
    v_mul_f32 v155, v155, v69
    v_mfma_f32_16x16x32_bf16 v[46:49], a[8:11], v[36:39], v[46:49]
    v_cvt_pk_bf16_f32 v153, v154, v155
    v_mul_f32 v20, v20, v69
    v_mfma_f32_16x16x32_bf16 v[46:49], a[12:15], v[96:99], v[46:49]
    ds_write_b64 v135, v[152:153] offset:3072
    v_mfma_f32_16x16x32_bf16 v[46:49], a[16:19], v[40:43], v[46:49]
    v_mul_f32 v21, v21, v69
    v_cvt_pk_bf16_f32 v154, v20, v21
    v_mfma_f32_16x16x32_bf16 v[46:49], a[20:23], v[52:55], v[46:49]
    v_mul_f32 v22, v22, v69
    v_mul_f32 v23, v23, v69
    v_mfma_f32_16x16x32_bf16 v[4:7], a[120:123], v[146:149], 0
    v_cvt_pk_bf16_f32 v155, v22, v23
    v_mul_f32 v0, v0, v69
    v_mfma_f32_16x16x32_bf16 v[4:7], a[124:127], v[12:15], v[4:7]
    ds_write_b64 v135, v[154:155] offset:3080
    v_mfma_f32_16x16x32_bf16 v[4:7], a[128:131], v[36:39], v[4:7]
    v_mul_f32 v1, v1, v69
    v_cvt_pk_bf16_f32 v0, v0, v1
    v_mfma_f32_16x16x32_bf16 v[4:7], a[132:135], v[96:99], v[4:7]
    v_mul_f32 v2, v2, v69
    v_mul_f32 v3, v3, v69
    v_mfma_f32_16x16x32_bf16 v[4:7], a[136:139], v[40:43], v[4:7]
    ds_read_b128 v[68:71], v137 offset:1792
    v_cvt_pk_bf16_f32 v1, v2, v3
    v_mfma_f32_16x16x32_bf16 v[4:7], a[140:143], v[52:55], v[4:7]
    ds_read_b128 v[120:123], v136 offset:1664
    v_mul_f32 v80, v80, v11
    v_mfma_f32_16x16x32_bf16 v[20:23], v[146:149], a[168:171], 0
    v_mul_f32 v81, v81, v11
    v_cvt_pk_bf16_f32 v8, v80, v81
    v_mfma_f32_16x16x32_bf16 v[20:23], v[12:15], a[172:175], v[20:23]
    v_mul_f32 v82, v82, v11
    v_mul_f32 v83, v83, v11
    v_mfma_f32_16x16x32_bf16 v[20:23], v[36:39], a[176:179], v[20:23]
    v_cvt_pk_bf16_f32 v9, v82, v83
    v_fmac_f32 v51, v117, v117
    v_mfma_f32_16x16x32_bf16 v[20:23], v[96:99], a[180:183], v[20:23]
    ds_write_b32 v134, v0 offset:3072
    v_mfma_f32_16x16x32_bf16 v[20:23], v[40:43], a[184:187], v[20:23]
    v_fmac_f32 v51, v118, v118
    v_fmac_f32 v51, v119, v119
    v_mfma_f32_16x16x32_bf16 v[20:23], v[52:55], a[188:191], v[20:23]
    v_fma_f32 v24, v92, v92, s42
    v_fmac_f32 v24, v93, v93
    v_mfma_f32_16x16x32_bf16 v[32:35], a[24:27], v[146:149], 0
    v_fmac_f32 v24, v94, v94
    v_fmac_f32 v24, v95, v95
    v_mfma_f32_16x16x32_bf16 v[32:35], a[28:31], v[12:15], v[32:35]
    ds_write_b32 v134, v1 offset:3076
    v_mfma_f32_16x16x32_bf16 v[32:35], a[32:35], v[36:39], v[32:35]
    v_fmac_f32 v24, v84, v84
    v_fmac_f32 v24, v85, v85
    v_mfma_f32_16x16x32_bf16 v[32:35], a[36:39], v[96:99], v[32:35]
    v_fmac_f32 v24, v86, v86
    v_fmac_f32 v24, v87, v87
    v_mfma_f32_16x16x32_bf16 v[32:35], a[40:43], v[40:43], v[32:35]
    v_fmac_f32 v24, v28, v28
    v_fmac_f32 v24, v29, v29
    v_mfma_f32_16x16x32_bf16 v[32:35], a[44:47], v[52:55], v[32:35]
    ds_write_b32 v135, v25 offset:1540
    v_mfma_f32_16x16x32_bf16 v[0:3], a[48:51], v[146:149], 0
    v_fmac_f32 v24, v30, v30
    v_fmac_f32 v24, v31, v31
    v_mfma_f32_16x16x32_bf16 v[0:3], a[52:55], v[12:15], v[0:3]
    v_fma_f32 v25, v108, v108, s42
    v_fmac_f32 v25, v109, v109
    v_mfma_f32_16x16x32_bf16 v[0:3], a[56:59], v[36:39], v[0:3]
    v_fmac_f32 v25, v110, v110
    v_fmac_f32 v25, v111, v111
    v_mfma_f32_16x16x32_bf16 v[0:3], a[60:63], v[96:99], v[0:3]
    ds_write_b64 v135, v[26:27] offset:1544
    v_mfma_f32_16x16x32_bf16 v[0:3], a[64:67], v[40:43], v[0:3]
    v_fmac_f32 v25, v140, v140
    v_fmac_f32 v25, v141, v141
    v_mfma_f32_16x16x32_bf16 v[0:3], a[68:71], v[52:55], v[0:3]
    v_fmac_f32 v25, v142, v142
    v_fmac_f32 v25, v143, v143
    v_mfma_f32_16x16x32_bf16 v[56:59], v[146:149], a[192:195], 0
    s_waitcnt vmcnt(10)
    v_fmac_f32 v25, v88, v88
    v_fmac_f32 v25, v89, v89
    v_mfma_f32_16x16x32_bf16 v[56:59], v[12:15], a[196:199], v[56:59]
    ds_write_b64 v134, v[8:9] offset:1536
    v_mfma_f32_16x16x32_bf16 v[56:59], v[36:39], a[200:203], v[56:59]
    v_fmac_f32 v25, v90, v90
    v_fmac_f32 v25, v91, v91
    v_mfma_f32_16x16x32_bf16 v[56:59], v[96:99], a[204:207], v[56:59]
    v_cvt_pk_bf16_f32 v26, v51, v24
    v_cvt_pk_bf16_f32 v27, v25, v167
    v_mfma_f32_16x16x32_bf16 v[56:59], v[40:43], a[208:211], v[56:59]
    v_add_u32 v135, s49, v135
    v_add_u32 v134, s49, v134
    v_mfma_f32_16x16x32_bf16 v[56:59], v[52:55], a[212:215], v[56:59]
    ds_write_b64 v159, v[26:27]
    v_mfma_f32_16x16x32_bf16 v[8:11], a[72:75], v[146:149], 0
    v_cvt_pk_f16_f32 v24, v46, v47
    v_cvt_pk_f16_f32 v25, v48, v49
    v_mfma_f32_16x16x32_bf16 v[8:11], a[76:79], v[12:15], v[8:11]
    v_pk_fma_f16 v48, v24, v24, s3
    v_pk_fmac_f16 v48, v25, v25
    v_mfma_f32_16x16x32_bf16 v[8:11], a[80:83], v[36:39], v[8:11]
    v_cvt_pk_f16_f32 v154, v4, v5
    v_cvt_pk_f16_f32 v155, v6, v7
    v_mfma_f32_16x16x32_bf16 v[8:11], a[84:87], v[96:99], v[8:11]
    v_cvt_pk_f16_f32 v26, v32, v33
    v_cvt_pk_f16_f32 v27, v34, v35
    v_mfma_f32_16x16x32_bf16 v[8:11], a[88:91], v[40:43], v[8:11]
    v_pk_fmac_f16 v48, v26, v26
    v_pk_fmac_f16 v48, v27, v27
    v_mfma_f32_16x16x32_bf16 v[8:11], a[92:95], v[52:55], v[8:11]
    v_cvt_pk_bf16_f32 v4, v56, v57
    v_cvt_pk_bf16_f32 v5, v58, v59
    v_mfma_f32_16x16x32_bf16 v[32:35], a[96:99], v[146:149], 0
    v_cvt_pk_f16_f32 v152, v0, v1
    v_cvt_pk_f16_f32 v153, v2, v3
    v_mfma_f32_16x16x32_bf16 v[32:35], a[100:103], v[12:15], v[32:35]
    s_waitcnt lgkmcnt(0)
    v_pk_fmac_f16 v48, v152, v152
    v_pk_fmac_f16 v48, v153, v153
    v_mfma_f32_16x16x32_bf16 v[32:35], a[104:107], v[36:39], v[32:35]
    s_barrier
    ds_read_b128 v[0:3], v163 offset:0
    v_mfma_f32_16x16x32_bf16 v[32:35], a[108:111], v[96:99], v[32:35]
    ds_read_b128 v[44:47], v163 offset:1024
    v_mfma_f32_16x16x32_bf16 v[32:35], a[112:115], v[40:43], v[32:35]
    v_mfma_f32_16x16x32_bf16 v[32:35], a[116:119], v[52:55], v[32:35]
    v_cvt_pk_f16_f32 v8, v8, v9
    v_cvt_pk_f16_f32 v9, v10, v11
    v_mfma_f32_16x16x32_bf16 v[56:59], v[146:149], a[144:147], 0
    s_nop 0
    v_pk_fma_f16 v49, v8, v8, s3
    v_pk_fmac_f16 v49, v9, v9
    v_mfma_f32_16x16x32_bf16 v[56:59], v[12:15], a[148:151], v[56:59]
    s_nop 0
    v_cvt_pk_f16_f32 v10, v32, v33
    v_cvt_pk_f16_f32 v11, v34, v35
    v_mfma_f32_16x16x32_bf16 v[56:59], v[36:39], a[152:155], v[56:59]
    v_pk_fmac_f16 v49, v10, v10
    v_pk_fmac_f16 v49, v11, v11
    v_mfma_f32_16x16x32_bf16 v[56:59], v[96:99], a[156:159], v[56:59]
    v_pk_fmac_f16 v49, v154, v154
    v_pk_fmac_f16 v49, v155, v155
    v_mfma_f32_16x16x32_bf16 v[56:59], v[40:43], a[160:163], v[56:59]
    v_mfma_f32_16x16x32_bf16 v[56:59], v[52:55], a[164:167], v[56:59]
    s_waitcnt lgkmcnt(1)
    v_readfirstlane_b32 s12, v1
    v_mfma_f32_16x16x32_bf16 v[40:43], v[216:219], v[0:3], 0
    s_waitcnt lgkmcnt(0)
    s_nop 1
    v_mfma_f32_16x16x32_bf16 v[40:43], v[216:219], v[44:47], v[40:43]
    s_lshr_b32 s12, s12, 23
    v_cvt_pk_bf16_f32 v0, v56, v57
    v_cvt_pk_bf16_f32 v1, v58, v59
    v_mfma_f32_16x16x32_bf16 v[52:55], a[96:99], v[60:63], 0
    s_nop 1
    v_mfma_f32_16x16x32_bf16 v[52:55], a[100:103], v[112:115], v[52:55]
    s_nop 0
    v_rsq_f32 v40, v40
    v_mfma_f32_16x16x32_bf16 v[52:55], a[104:107], v[100:103], v[52:55]
    v_rsq_f32 v41, v41
    v_mfma_f32_16x16x32_bf16 v[52:55], a[108:111], v[120:123], v[52:55]
    v_rsq_f32 v42, v42
    v_mfma_f32_16x16x32_bf16 v[52:55], a[112:115], v[68:71], v[52:55]
    v_mul_f32 v40, s43, v40
    v_mul_f32 v41, s43, v41
    v_mfma_f32_16x16x32_bf16 v[52:55], a[116:119], v[72:75], v[52:55]
    v_mul_f32 v42, s43, v42
    v_mul_f32 v92, v92, v41
    v_mfma_f32_16x16x32_bf16 v[36:39], v[60:63], a[168:171], 0
    v_mul_f32 v93, v93, v41
    v_cvt_pk_bf16_f32 v12, v92, v93
    v_mfma_f32_16x16x32_bf16 v[36:39], v[112:115], a[172:175], v[36:39]
    ds_write_b32 v135, v12 offset:1536
    v_mfma_f32_16x16x32_bf16 v[36:39], v[100:103], a[176:179], v[36:39]
    v_mul_f32 v94, v94, v41
    v_mul_f32 v95, v95, v41
    v_mfma_f32_16x16x32_bf16 v[36:39], v[120:123], a[180:183], v[36:39]
    v_cvt_pk_bf16_f32 v13, v94, v95
    v_mul_f32 v84, v84, v41
    v_mfma_f32_16x16x32_bf16 v[36:39], v[68:71], a[184:187], v[36:39]
    v_mul_f32 v85, v85, v41
    v_cvt_pk_bf16_f32 v14, v84, v85
    v_mfma_f32_16x16x32_bf16 v[36:39], v[72:75], a[188:191], v[36:39]
    ds_write_b32 v135, v13 offset:1540
    v_mfma_f32_16x16x32_bf16 v[64:67], a[24:27], v[60:63], 0
    v_mul_f32 v86, v86, v41
    v_mul_f32 v87, v87, v41
    v_mfma_f32_16x16x32_bf16 v[64:67], a[28:31], v[112:115], v[64:67]
    v_cvt_pk_bf16_f32 v15, v86, v87
    v_mul_f32 v28, v28, v41
    v_mfma_f32_16x16x32_bf16 v[64:67], a[32:35], v[100:103], v[64:67]
    v_mul_f32 v29, v29, v41
    v_cvt_pk_bf16_f32 v148, v28, v29
    v_mfma_f32_16x16x32_bf16 v[64:67], a[36:39], v[120:123], v[64:67]
    ds_write_b64 v135, v[14:15] offset:1544
    v_mfma_f32_16x16x32_bf16 v[64:67], a[40:43], v[68:71], v[64:67]
    s_sub_u32 s50, s45, s44
    v_mul_f32 v30, v30, v41
    v_mul_f32 v31, v31, v41
    v_mfma_f32_16x16x32_bf16 v[64:67], a[44:47], v[72:75], v[64:67]
    s_sub_u32 s51, s46, s47
    v_cvt_pk_bf16_f32 v149, v30, v31
    v_cvt_pk_f16_f32 v14, v52, v53
    v_mfma_f32_16x16x32_bf16 v[32:35], a[48:51], v[60:63], 0
    s_mov_b32 s60, s59
    v_cvt_pk_f16_f32 v15, v54, v55
    v_cvt_pk_bf16_f32 v18, v36, v37
    v_mfma_f32_16x16x32_bf16 v[32:35], a[52:55], v[112:115], v[32:35]
    s_mov_b32 s59, s58
    ds_write_b32 v134, v148 offset:1536
    v_mfma_f32_16x16x32_bf16 v[32:35], a[56:59], v[100:103], v[32:35]
    s_mov_b32 s58, s57
    v_cvt_pk_bf16_f32 v19, v38, v39
    v_mul_f32 v108, v108, v42
    v_mfma_f32_16x16x32_bf16 v[32:35], a[60:63], v[120:123], v[32:35]
    s_mov_b32 s57, s56
    v_mul_f32 v109, v109, v42
    v_cvt_pk_bf16_f32 v84, v108, v109
    v_mfma_f32_16x16x32_bf16 v[32:35], a[64:67], v[68:71], v[32:35]
    s_mov_b32 s7, s6
    ds_read_b128 v[52:55], v137 offset:3200
    v_mul_f32 v110, v110, v42
    v_mfma_f32_16x16x32_bf16 v[32:35], a[68:71], v[72:75], v[32:35]
    s_mov_b32 s6, s5
    v_mul_f32 v111, v111, v42
    v_cvt_pk_bf16_f32 v85, v110, v111
    v_mfma_f32_16x16x32_bf16 v[28:31], a[72:75], v[60:63], 0
    s_mov_b32 s5, s4
    ds_read_b128 v[36:39], v137 offset:3328
    v_mul_f32 v140, v140, v42
    v_mfma_f32_16x16x32_bf16 v[28:31], a[76:79], v[112:115], v[28:31]
    s_sub_u32 s14, s6, s7
    v_cvt_pk_f16_f32 v146, v32, v33
    v_cvt_pk_f16_f32 v147, v34, v35
    v_mfma_f32_16x16x32_bf16 v[28:31], a[80:83], v[100:103], v[28:31]
    s_add_u32 s61, s61, 1
    v_mul_f32 v141, v141, v42
    v_cvt_pk_bf16_f32 v86, v140, v141
    v_mfma_f32_16x16x32_bf16 v[28:31], a[84:87], v[120:123], v[28:31]
    s_add_u32 s12, s12, 20
    ds_read_b128 v[32:35], v136 offset:3328
    v_mul_f32 v142, v142, v42
    v_mfma_f32_16x16x32_bf16 v[28:31], a[88:91], v[68:71], v[28:31]
    s_max_u32 s12, s12, s61
    ds_read_b128 v[44:47], v136 offset:3200
    v_mul_f32 v143, v143, v42
    v_mfma_f32_16x16x32_bf16 v[28:31], a[92:95], v[72:75], v[28:31]
    s_cmp_lt_u32 s61, s71
    v_cvt_pk_bf16_f32 v87, v142, v143
    v_mul_f32 v88, v88, v42
    v_mfma_f32_16x16x32_bf16 v[140:143], a[120:123], v[60:63], 0
    s_cselect_b32 s15, s61, s12
    ds_read_b128 v[56:59], v136 offset:3072
    v_mul_f32 v89, v89, v42
    v_mfma_f32_16x16x32_bf16 v[140:143], a[124:127], v[112:115], v[140:143]
    s_cselect_b32 s56, s69, s70
    v_cvt_pk_f16_f32 v12, v28, v29
    v_cvt_pk_f16_f32 v13, v30, v31
    v_mfma_f32_16x16x32_bf16 v[140:143], a[128:131], v[100:103], v[140:143]
    s_add_u32 s56, s56, s15
    v_pk_fma_f16 v51, v12, v12, s3
    v_pk_fmac_f16 v51, v13, v13
    v_mfma_f32_16x16x32_bf16 v[140:143], a[132:135], v[120:123], v[140:143]
    s_mul_i32 s53, s56, 58255
    v_pk_fmac_f16 v51, v14, v14
    v_pk_fmac_f16 v51, v15, v15
    v_mfma_f32_16x16x32_bf16 v[140:143], a[136:139], v[68:71], v[140:143]
    s_lshr_b32 s53, s53, 22
    ds_write_b32 v134, v149 offset:1540
    v_mfma_f32_16x16x32_bf16 v[140:143], a[140:143], v[72:75], v[140:143]
    s_mul_i32 s53, s53, s63
    v_cvt_pk_bf16_f32 v88, v88, v89
    v_mul_f32 v90, v90, v42
    v_mfma_f32_16x16x32_bf16 v[80:83], a[0:3], v[60:63], 0
    s_mul_i32 s56, s56, s62
    v_mul_f32 v91, v91, v42
    v_cvt_pk_bf16_f32 v89, v90, v91
    v_mfma_f32_16x16x32_bf16 v[80:83], a[4:7], v[112:115], v[80:83]
    s_add_u32 s56, s56, s53
    v_cvt_pk_f16_f32 v148, v140, v141
    v_cvt_pk_f16_f32 v149, v142, v143
    v_mfma_f32_16x16x32_bf16 v[80:83], a[8:11], v[100:103], v[80:83]
    s_mul_i32 s4, s15, 112
    ds_write_b64 v135, v[84:85] offset:3072
    v_mfma_f32_16x16x32_bf16 v[80:83], a[12:15], v[120:123], v[80:83]
    s_cmp_ge_u32 s15, 16
    v_pk_fmac_f16 v51, v148, v148
    v_pk_fmac_f16 v51, v149, v149
    v_mfma_f32_16x16x32_bf16 v[80:83], a[16:19], v[68:71], v[80:83]
    s_cselect_b32 s53, -30464, 0
    v_cvt_pk_f16_f32 v30, v64, v65
    v_cvt_pk_f16_f32 v31, v66, v67
    v_mfma_f32_16x16x32_bf16 v[80:83], a[20:23], v[72:75], v[80:83]
    s_add_u32 s4, s4, s53
    v_mul_f32 v76, v76, v40
    v_mul_f32 v77, v77, v40
    v_mfma_f32_16x16x32_bf16 v[140:143], v[60:63], a[144:147], 0
    s_cmp_lt_u32 s15, s73
    ds_write_b32 v135, v86 offset:3080
    v_mfma_f32_16x16x32_bf16 v[140:143], v[112:115], a[148:151], v[140:143]
    s_cselect_b32 s26, 100270464, 0
    v_cvt_pk_f16_f32 v28, v80, v81
    v_cvt_pk_f16_f32 v29, v82, v83
    v_mfma_f32_16x16x32_bf16 v[140:143], v[100:103], a[152:155], v[140:143]
    s_cselect_b32 s56, s56, 0
    v_pk_fma_f16 v50, v28, v28, s3
    v_pk_fmac_f16 v50, v29, v29
    v_mfma_f32_16x16x32_bf16 v[140:143], v[120:123], a[156:159], v[140:143]
    s_cselect_b32 s4, s4, -1
    ds_read_b128 v[64:67], v137 offset:3072
    v_pk_fmac_f16 v50, v30, v30
    v_mfma_f32_16x16x32_bf16 v[140:143], v[68:71], a[160:163], v[140:143]
    s_cselect_b32 s15, s15, 0
    v_pk_fmac_f16 v50, v31, v31
    v_pk_fmac_f16 v50, v146, v146
    v_mfma_f32_16x16x32_bf16 v[140:143], v[72:75], a[164:167], v[140:143]
    s_cselect_b32 s13, s13, -1
    v_pk_fmac_f16 v50, v147, v147
    v_cvt_pk_bf16_f32 v84, v76, v77
    v_mfma_f32_16x16x32_bf16 v[80:83], v[60:63], a[192:195], 0
    s_bitset1_b32 s64, s15
    v_mul_f32 v78, v78, v40
    v_mul_f32 v79, v79, v40
    v_mfma_f32_16x16x32_bf16 v[80:83], v[112:115], a[196:199], v[80:83]
    s_add_u32 s65, s65, 1
    ds_write_b32 v135, v87 offset:3084
    v_mfma_f32_16x16x32_bf16 v[80:83], v[100:103], a[200:203], v[80:83]
    s_cmp_ge_i32 s65, 2
    v_cvt_pk_bf16_f32 v2, v140, v141
    v_cvt_pk_bf16_f32 v3, v142, v143
    v_mfma_f32_16x16x32_bf16 v[80:83], v[120:123], a[204:207], v[80:83]
    s_cselect_b32 s30, 100270464, 0
    v_cvt_pk_bf16_f32 v85, v78, v79
    v_mul_f32 v104, v104, v40
    v_mfma_f32_16x16x32_bf16 v[80:83], v[68:71], a[208:211], v[80:83]
    s_add_u32 s67, s46, s54
    v_mul_f32 v105, v105, v40
    v_cvt_pk_bf16_f32 v86, v104, v105
    v_mfma_f32_16x16x32_bf16 v[80:83], v[72:75], a[212:215], v[80:83]
    s_add_u32 m0, s67, 0
    ds_write_b32 v134, v88 offset:3072
    v_mfma_f32_16x16x32_f16 v[68:71], v[212:215], v[48:51], 0
    s_waitcnt lgkmcnt(2)
    v_mul_f32 v106, v106, v40
    v_mul_f32 v107, v107, v40
    v_mfma_f32_16x16x32_bf16 v[76:79], v[64:67], a[168:171], 0
    s_nop 0
    v_cvt_pk_bf16_f32 v6, v80, v81
    v_cvt_pk_bf16_f32 v7, v82, v83
    v_mfma_f32_16x16x32_bf16 v[76:79], v[56:59], a[172:175], v[76:79]
    v_or3_b32 v125, v125, v68, v69
    v_or3_b32 v125, v125, v70, v71
    v_mfma_f32_16x16x32_bf16 v[76:79], v[52:55], a[176:179], v[76:79]
    ds_write_b32 v134, v89 offset:3076
    v_mfma_f32_16x16x32_bf16 v[76:79], v[44:47], a[180:183], v[76:79]
    v_rsq_f32 v68, v68
    v_mfma_f32_16x16x32_bf16 v[76:79], v[36:39], a[184:187], v[76:79]
    v_rsq_f32 v69, v69
    v_mfma_f32_16x16x32_bf16 v[76:79], v[32:35], a[188:191], v[76:79]
    v_mul_f32 v68, s52, v68
    v_cvt_pk_f16_f32 v68, v68, v69
    v_mfma_f32_16x16x32_bf16 v[140:143], a[72:75], v[64:67], 0
    ds_write_b32 v135, v85 offset:4
    v_mfma_f32_16x16x32_bf16 v[140:143], a[76:79], v[56:59], v[140:143]
    v_rsq_f32 v70, v70
    v_mfma_f32_16x16x32_bf16 v[140:143], a[80:83], v[52:55], v[140:143]
    v_rsq_f32 v71, v71
    v_mfma_f32_16x16x32_bf16 v[140:143], a[84:87], v[44:47], v[140:143]
    v_mul_f32 v70, s52, v70
    v_cvt_pk_f16_f32 v70, v70, v71
    v_mfma_f32_16x16x32_bf16 v[140:143], a[88:91], v[36:39], v[140:143]
    v_pk_mul_f16 v12, v12, v70 op_sel:[0,1] op_sel_hi:[1,1]
    v_pk_mul_f16 v13, v13, v70 op_sel:[0,1] op_sel_hi:[1,1]
    v_mfma_f32_16x16x32_bf16 v[140:143], a[92:95], v[32:35], v[140:143]
    v_pk_mul_f16 v14, v14, v70 op_sel:[0,1] op_sel_hi:[1,1]
    v_pk_mul_f16 v15, v15, v70 op_sel:[0,1] op_sel_hi:[1,1]
    v_mfma_f32_16x16x32_bf16 v[72:75], a[120:123], v[64:67], 0
    s_nop 0
    v_pk_mul_f16 v148, v148, v70 op_sel:[0,1] op_sel_hi:[1,1]
    v_pk_mul_f16 v149, v149, v70 op_sel:[0,1] op_sel_hi:[1,1]
    v_mfma_f32_16x16x32_bf16 v[72:75], a[124:127], v[56:59], v[72:75]
    s_nop 0
    v_cvt_pk_f16_f32 v60, v140, v141
    v_cvt_pk_f16_f32 v61, v142, v143
    v_mfma_f32_16x16x32_bf16 v[72:75], a[128:131], v[52:55], v[72:75]
    v_pk_mul_f16 v8, v8, v68 op_sel:[0,1] op_sel_hi:[1,1]
    v_pk_mul_f16 v9, v9, v68 op_sel:[0,1] op_sel_hi:[1,1]
    v_mfma_f32_16x16x32_bf16 v[72:75], a[132:135], v[44:47], v[72:75]
    v_pk_mul_f16 v10, v10, v68 op_sel:[0,1] op_sel_hi:[1,1]
    v_pk_mul_f16 v11, v11, v68 op_sel:[0,1] op_sel_hi:[1,1]
    v_mfma_f32_16x16x32_bf16 v[72:75], a[136:139], v[36:39], v[72:75]
    v_pk_mul_f16 v154, v154, v68 op_sel:[0,1] op_sel_hi:[1,1]
    v_pk_mul_f16 v155, v155, v68 op_sel:[0,1] op_sel_hi:[1,1]
    v_mfma_f32_16x16x32_bf16 v[72:75], a[140:143], v[32:35], v[72:75]
    v_pk_mul_f16 v24, v24, v68 op_sel:[0,0] op_sel_hi:[1,0]
    v_pk_mul_f16 v25, v25, v68 op_sel:[0,0] op_sel_hi:[1,0]
    v_mfma_f32_16x16x32_bf16 v[100:103], v[64:67], a[144:147], 0
    v_pk_mul_f16 v26, v26, v68 op_sel:[0,0] op_sel_hi:[1,0]
    v_pk_mul_f16 v27, v27, v68 op_sel:[0,0] op_sel_hi:[1,0]
    v_mfma_f32_16x16x32_bf16 v[100:103], v[56:59], a[148:151], v[100:103]
    v_pk_mul_f16 v152, v152, v68 op_sel:[0,0] op_sel_hi:[1,0]
    v_pk_mul_f16 v153, v153, v68 op_sel:[0,0] op_sel_hi:[1,0]
    v_mfma_f32_16x16x32_bf16 v[100:103], v[52:55], a[152:155], v[100:103]
    ds_write_b32 v135, v84 offset:0
    v_mfma_f32_16x16x32_bf16 v[100:103], v[44:47], a[156:159], v[100:103]
    v_pk_fma_f16 v49, v60, v60, s3
    v_pk_fmac_f16 v49, v61, v61
    v_mfma_f32_16x16x32_bf16 v[100:103], v[36:39], a[160:163], v[100:103]
    v_cvt_pk_bf16_f32 v87, v106, v107
    v_mul_f32 v116, v116, v40
    v_mfma_f32_16x16x32_bf16 v[100:103], v[32:35], a[164:167], v[100:103]
    v_mul_f32 v117, v117, v40
    v_cvt_pk_bf16_f32 v84, v116, v117
    v_mfma_f32_16x16x32_bf16 v[80:83], a[48:51], v[64:67], 0
    ds_write_b64 v135, v[86:87] offset:8
    v_mfma_f32_16x16x32_bf16 v[80:83], a[52:55], v[56:59], v[80:83]
    v_mul_f32 v118, v118, v40
    v_mul_f32 v119, v119, v40
    v_mfma_f32_16x16x32_bf16 v[80:83], a[56:59], v[52:55], v[80:83]
    v_cvt_pk_bf16_f32 v85, v118, v119
    v_cvt_pk_f16_f32 v142, v72, v73
    v_mfma_f32_16x16x32_bf16 v[80:83], a[60:63], v[44:47], v[80:83]
    v_cvt_pk_f16_f32 v143, v74, v75
    v_pk_mul_f16 v28, v28, v70 op_sel:[0,0] op_sel_hi:[1,0]
    v_mfma_f32_16x16x32_bf16 v[80:83], a[64:67], v[36:39], v[80:83]
    ds_write_b64 v134, v[84:85] offset:0
    v_mfma_f32_16x16x32_bf16 v[80:83], a[68:71], v[32:35], v[80:83]
    s_waitcnt vmcnt(0)
    v_pk_mul_f16 v29, v29, v70 op_sel:[0,0] op_sel_hi:[1,0]
    v_pk_mul_f16 v30, v30, v70 op_sel:[0,0] op_sel_hi:[1,0]
    v_mfma_f32_16x16x32_bf16 v[40:43], a[0:3], v[64:67], 0
    v_pk_mul_f16 v31, v31, v70 op_sel:[0,0] op_sel_hi:[1,0]
    v_pk_mul_f16 v146, v146, v70 op_sel:[0,0] op_sel_hi:[1,0]
    v_mfma_f32_16x16x32_bf16 v[40:43], a[4:7], v[56:59], v[40:43]
    v_pk_mul_f16 v147, v147, v70 op_sel:[0,0] op_sel_hi:[1,0]
    v_add_u32 v137, s50, v137
    v_mfma_f32_16x16x32_bf16 v[40:43], a[8:11], v[52:55], v[40:43]
    v_add_u32 v136, s50, v136
    v_add_u32 v135, s48, v135
    v_mfma_f32_16x16x32_bf16 v[40:43], a[12:15], v[44:47], v[40:43]
    v_add_u32 v134, s48, v134
    v_add_u32 v133, s51, v133
    v_mfma_f32_16x16x32_bf16 v[40:43], a[16:19], v[36:39], v[40:43]
    v_add_u32 v132, s14, v132
    v_add_u32 v131, s14, v131
    v_mfma_f32_16x16x32_bf16 v[40:43], a[20:23], v[32:35], v[40:43]
    ds_read_b128 v[68:71], v132 offset:0
    v_cvt_pk_bf16_f32 v164, v100, v101
    v_mfma_f32_16x16x32_bf16 v[96:99], a[24:27], v[64:67], 0
    s_waitcnt lgkmcnt(1)
    ds_read_b128 v[72:75], v132 offset:16
    v_cvt_pk_bf16_f32 v165, v102, v103
    v_mfma_f32_16x16x32_bf16 v[96:99], a[28:31], v[56:59], v[96:99]
    s_barrier
    ds_read_b128 v[104:107], v133 offset:0
    v_cvt_pk_f16_f32 v40, v40, v41
    v_mfma_f32_16x16x32_bf16 v[96:99], a[32:35], v[52:55], v[96:99]
    s_cmp_ge_u32 s61, s13
    ds_read_u16 v162, v131 offset:96
    v_cvt_pk_f16_f32 v41, v42, v43
    v_mfma_f32_16x16x32_bf16 v[96:99], a[36:39], v[44:47], v[96:99]
L_pga:
    s_cbranch_scc1 L_atomF0
L_atomF0r:
    v_mfma_f32_16x16x32_bf16 v[96:99], a[40:43], v[36:39], v[96:99]
    ds_read_u16 v158, v131 offset:104
    v_pk_fma_f16 v48, v40, v40, s3
    v_mfma_f32_16x16x32_bf16 v[96:99], a[44:47], v[32:35], v[96:99]
    ds_read_b128 v[84:87], v137 offset:0
    v_pk_fmac_f16 v48, v41, v41
    v_mfma_f32_16x16x32_f16 v[100:103], v[8:11], v[24:27], v[204:207]
    v_cvt_pk_f16_f32 v140, v80, v81
    v_cvt_pk_f16_f32 v141, v82, v83
    v_mfma_f32_16x16x32_f16 v[100:103], v[152:155], v[150:153], v[100:103]
    s_nop 0
    ds_read_u16 v166, v131 offset:80
    v_cvt_pk_f16_f32 v42, v96, v97
    v_mfma_f32_16x16x32_bf16 v[116:119], a[96:99], v[64:67], 0
    v_cvt_pk_f16_f32 v43, v98, v99
    v_pk_fmac_f16 v48, v42, v42
    v_mfma_f32_16x16x32_bf16 v[116:119], a[100:103], v[56:59], v[116:119]
    ds_read_b128 v[80:83], v132 offset:48
    v_pk_fmac_f16 v48, v43, v43
    v_mfma_f32_16x16x32_bf16 v[116:119], a[104:107], v[52:55], v[116:119]
    s_waitcnt lgkmcnt(5)
    ds_read_b128 v[96:99], v133 offset:2048
    buffer_load_dwordx4 v130, s[24:27], s56 offen nt lds
    v_mfma_f32_16x16x32_bf16 v[116:119], a[108:111], v[44:47], v[116:119]
    ds_read_b128 v[108:111], v133 offset:1024
    v_pk_fmac_f16 v48, v140, v140
    v_mfma_f32_16x16x32_bf16 v[116:119], a[112:115], v[36:39], v[116:119]
    ds_read_b128 v[88:91], v136 offset:128
    v_pk_fmac_f16 v48, v141, v141
    v_mfma_f32_16x16x32_bf16 v[116:119], a[116:119], v[32:35], v[116:119]
    ds_read_b128 v[92:95], v137 offset:256
    v_cvt_pk_bf16_f32 v16, v20, v21
    v_mfma_f32_16x16x32_bf16 v[112:115], v[64:67], a[192:195], 0
    ds_read_b128 v[64:67], v136 offset:0
    v_cvt_pk_bf16_f32 v17, v22, v23
    v_mfma_f32_16x16x32_bf16 v[112:115], v[56:59], a[196:199], v[112:115]
    s_nop 0
    ds_read_b128 v[20:23], v137 offset:128
    v_cvt_pk_f16_f32 v62, v116, v117
    v_mfma_f32_16x16x32_bf16 v[112:115], v[52:55], a[200:203], v[112:115]
    v_cvt_pk_f16_f32 v63, v118, v119
    v_pk_fmac_f16 v49, v62, v62
    v_mfma_f32_16x16x32_bf16 v[112:115], v[44:47], a[204:207], v[112:115]
    v_pk_fmac_f16 v49, v63, v63
    v_pk_fmac_f16 v49, v142, v142
    v_mfma_f32_16x16x32_bf16 v[112:115], v[36:39], a[208:211], v[112:115]
    v_pk_fmac_f16 v49, v143, v143
    v_cvt_pk_bf16_f32 v160, v76, v77
    v_mfma_f32_16x16x32_bf16 v[112:115], v[32:35], a[212:215], v[112:115]
    s_add_u32 m0, s67, 1024
    ds_read_b128 v[52:55], v136 offset:256
    v_cvt_pk_bf16_f32 v161, v78, v79
    v_mfma_f32_16x16x32_f16 v[36:39], v[212:215], v[48:51], 0
    s_waitcnt lgkmcnt(5)
    buffer_store_dwordx4 v[104:107], v130, s[28:31], s60 offen sc1
    buffer_load_dwordx4 v129, s[24:27], s56 offen nt lds
    v_exp_f32 v100, v100
    v_cvt_pk_bf16_f32 v156, v112, v113
    v_mfma_f32_16x16x32_f16 v[48:51], v[12:15], v[24:27], v[200:203]
    ds_read_b128 v[32:35], v133 offset:4096
    v_cvt_pk_bf16_f32 v157, v114, v115
    v_mfma_f32_16x16x32_f16 v[48:51], v[146:149], v[150:153], v[48:51]
    v_exp_f32 v101, v101
    v_mfma_f32_16x16x32_bf16 v[76:79], a[216:219], v[84:87], 0
    s_waitcnt lgkmcnt(2)
    v_or3_b32 v125, v125, v36, v37
    v_cvt_pk_bf16_f32 v46, v100, v101
    v_mfma_f32_16x16x32_bf16 v[76:79], a[220:223], v[64:67], v[76:79]
    v_rsq_f32 v36, v36
    v_mfma_f32_16x16x32_bf16 v[76:79], a[224:227], v[20:23], v[76:79]
    v_rsq_f32 v37, v37
    v_mfma_f32_16x16x32_bf16 v[76:79], a[228:231], v[88:91], v[76:79]
    ds_read_b128 v[56:59], v133 offset:3072
    v_mul_f32 v36, s52, v36
    v_mfma_f32_16x16x32_bf16 v[76:79], a[232:235], v[92:95], v[76:79]
    s_waitcnt lgkmcnt(2)
    v_exp_f32 v102, v102
    v_mfma_f32_16x16x32_bf16 v[76:79], a[236:239], v[52:55], v[76:79]
    s_add_u32 m0, s67, 2048
    buffer_store_dwordx4 v[108:111], v129, s[28:31], s60 offen sc1
    v_cvt_pk_f16_f32 v36, v36, v37
    v_pk_mul_f16 v40, v40, v36 op_sel:[0,0] op_sel_hi:[1,0]
    v_pk_mul_f16 v41, v41, v36 op_sel:[0,0] op_sel_hi:[1,0]
    v_pk_mul_f16 v42, v42, v36 op_sel:[0,0] op_sel_hi:[1,0]
    v_mfma_f32_16x16x32_bf16 v[104:107], a[240:243], v[84:87], 0
    v_pk_mul_f16 v43, v43, v36 op_sel:[0,0] op_sel_hi:[1,0]
    v_pk_mul_f16 v140, v140, v36 op_sel:[0,0] op_sel_hi:[1,0]
    v_mfma_f32_16x16x32_bf16 v[104:107], a[244:247], v[64:67], v[104:107]
    v_pk_mul_f16 v141, v141, v36 op_sel:[0,0] op_sel_hi:[1,0]
    v_pk_mul_f16 v60, v60, v36 op_sel:[0,1] op_sel_hi:[1,1]
    v_mfma_f32_16x16x32_bf16 v[104:107], a[248:251], v[20:23], v[104:107]
    v_exp_f32 v103, v103
    v_mfma_f32_16x16x32_bf16 v[104:107], a[252:255], v[88:91], v[104:107]
    buffer_load_dwordx4 v128, s[24:27], s56 offen nt lds
    v_cvt_pk_bf16_f32 v47, v102, v103
    v_mfma_f32_16x16x32_bf16 v[104:107], v[224:227], v[92:95], v[104:107]
    v_pk_mul_f16 v61, v61, v36 op_sel:[0,1] op_sel_hi:[1,1]
    v_pk_mul_f16 v62, v62, v36 op_sel:[0,1] op_sel_hi:[1,1]
    v_mfma_f32_16x16x32_bf16 v[104:107], v[228:231], v[52:55], v[104:107]
    v_pk_mul_f16 v63, v63, v36 op_sel:[0,1] op_sel_hi:[1,1]
    v_pk_mul_f16 v142, v142, v36 op_sel:[0,1] op_sel_hi:[1,1]
    v_mfma_f32_16x16x32_f16 v[100:103], v[68:71], v[24:27], v[208:211]
    s_add_u32 m0, s67, 3072
    v_exp_f32 v48, v48
    v_mfma_f32_16x16x32_f16 v[100:103], v[72:75], v[8:11], v[100:103]
    buffer_store_dwordx4 v[96:99], v128, s[28:31], s60 offen sc1
    v_pk_mul_f16 v143, v143, v36 op_sel:[0,1] op_sel_hi:[1,1]
    v_exp_f32 v49, v49
    v_mfma_f32_16x16x32_f16 v[100:103], v[80:83], v[152:155], v[100:103]
    v_exp_f32 v50, v50
    v_mfma_f32_16x16x32_f16 v[36:39], v[68:71], v[28:31], v[208:211]
    v_exp_f32 v51, v51
    v_mfma_f32_16x16x32_f16 v[36:39], v[72:75], v[12:15], v[36:39]
    v_cvt_pk_bf16_f32 v48, v48, v49
    v_cvt_pk_bf16_f32 v49, v50, v51
    v_mfma_f32_16x16x32_f16 v[36:39], v[80:83], v[146:149], v[36:39]
    s_waitcnt lgkmcnt(0)
    buffer_load_dwordx4 v127, s[24:27], s56 offen nt lds
    v_mfma_f32_16x16x32_f16 v[116:119], v[8:11], v[28:31], v[192:195]
    s_nop 0
    v_exp_f32 v100, v100
    v_mfma_f32_16x16x32_f16 v[116:119], v[152:155], v[144:147], v[116:119]
    s_nop 0
    v_cvt_pk_bf16_f32 v170, v100, 0
    v_mov_b32_dpp v103, v39 quad_perm:[0,1,2,3] row_mask:0x2 bank_mask:0xf
    v_mfma_f32_16x16x32_f16 v[96:99], v[60:63], v[28:31], v[184:187]
    s_add_u32 m0, s67, 4096
    v_exp_f32 v37, v37
    v_mfma_f32_16x16x32_f16 v[96:99], v[140:143], v[144:147], v[96:99]
    buffer_store_dwordx4 v[56:59], v127, s[28:31], s60 offen sc1
    buffer_load_dwordx4 v126, s[24:27], s56 offen nt lds
    v_exp_f32 v116, v116
    v_mfma_f32_16x16x32_f16 v[56:59], v[60:63], v[24:27], v[196:199]
    v_exp_f32 v117, v117
    v_mfma_f32_16x16x32_f16 v[56:59], v[140:143], v[150:153], v[56:59]
    v_exp_f32 v118, v118
    v_mfma_f32_16x16x32_f16 v[24:27], v[60:63], v[40:43], v[172:175]
    v_exp_f32 v119, v119
    v_mfma_f32_16x16x32_f16 v[24:27], v[140:143], v[138:141], v[24:27]
    s_nop 0
    buffer_store_dwordx4 v[32:35], v126, s[28:31], s60 offen sc1
    v_cvt_pk_bf16_f32 v44, v116, v117
    v_cvt_pk_bf16_f32 v45, v118, v119
    v_exp_f32 v56, v56
    v_mfma_f32_16x16x32_bf16 v[116:119], v[232:235], v[84:87], 0
    s_mov_b32 s53, s47
    v_exp_f32 v57, v57
    v_mfma_f32_16x16x32_bf16 v[116:119], v[236:239], v[64:67], v[116:119]
    s_mov_b32 s47, s46
    v_exp_f32 v58, v58
    v_mfma_f32_16x16x32_bf16 v[116:119], v[240:243], v[20:23], v[116:119]
    s_mov_b32 s46, s45
    ds_read_b128 v[20:23], v136 offset:1664
    v_cvt_pk_bf16_f32 v168, v56, v57
    v_mfma_f32_16x16x32_bf16 v[116:119], v[244:247], v[88:91], v[116:119]
    s_mov_b32 s45, s44
    v_exp_f32 v59, v59
    v_mfma_f32_16x16x32_bf16 v[116:119], v[248:251], v[92:95], v[116:119]
    s_mov_b32 s44, s53
    v_exp_f32 v96, v96
    v_mfma_f32_16x16x32_bf16 v[116:119], v[252:255], v[52:55], v[116:119]
    s_sub_u32 s48, s44, s46
    ds_read_b128 v[32:35], v136 offset:1792
    v_cvt_pk_bf16_f32 v169, v58, v59
    v_mfma_f32_16x16x32_f16 v[52:55], v[68:71], v[40:43], v[208:211]
    s_sub_u32 s49, s46, s45
    v_exp_f32 v97, v97
    v_mfma_f32_16x16x32_f16 v[52:55], v[72:75], v[60:63], v[52:55]
    s_cmp_lg_u32 s5, -1
    ds_read_b128 v[56:59], v136 offset:1536
    v_fma_f32 v51, v76, v76, s42
    v_mfma_f32_16x16x32_f16 v[52:55], v[80:83], v[140:143], v[52:55]
    ds_read_b128 v[68:71], v137 offset:1664
    v_fmac_f32 v51, v77, v77
    v_mfma_f32_16x16x32_bf16 v[64:67], v[220:223], v[46:49], 0
    ds_read_b128 v[72:75], v137 offset:1536
    v_fmac_f32 v51, v78, v78
    v_mfma_f32_16x16x32_bf16 v[64:67], v[220:223], v[168:171], v[64:67]
    v_exp_f32 v98, v98
    v_mfma_f32_16x16x32_bf16 v[84:87], v[0:3], v[46:49], 0
    ds_read_b128 v[80:83], v137 offset:1792
    v_mov_b32_dpp v103, v55 quad_perm:[0,1,2,3] row_mask:0x4 bank_mask:0xf
    v_mfma_f32_16x16x32_bf16 v[84:87], v[164:167], v[168:171], v[84:87]
    v_exp_f32 v99, v99
    v_mfma_f32_16x16x32_bf16 v[108:111], v[16:19], v[46:49], 0
    v_exp_f32 v103, v103
    v_mfma_f32_16x16x32_bf16 v[108:111], v[160:163], v[168:171], v[108:111]
    v_cvt_pk_bf16_f32 v103, v103, v103
    v_fmac_f32 v51, v79, v79
    v_mfma_f32_16x16x32_bf16 v[88:91], v[4:7], v[46:49], 0
    ds_write_b16 v131, v103 offset:64
    v_mfma_f32_16x16x32_bf16 v[88:91], v[156:159], v[168:171], v[88:91]
    v_rcp_f32 v65, v64
    v_mfma_f32_16x16x32_f16 v[100:103], v[8:11], v[40:43], v[180:183]
    v_max3_u32 v124, v124, v64, v65
    v_mul_f32 v84, v84, v65
    v_mfma_f32_16x16x32_f16 v[100:103], v[152:155], v[138:141], v[100:103]
    s_waitcnt lgkmcnt(2)
    ds_read_b128 v[46:49], v132 offset:48
    v_mul_f32 v85, v85, v65
    v_mfma_f32_16x16x32_bf16 v[92:95], a[216:219], v[72:75], 0
    ds_read_b128 v[152:155], v132 offset:64
    v_cvt_pk_bf16_f32 v8, v84, v85
    v_mfma_f32_16x16x32_bf16 v[92:95], a[220:223], v[56:59], v[92:95]
    v_mul_f32 v86, v86, v65
    v_mul_f32 v87, v87, v65
    v_mfma_f32_16x16x32_bf16 v[92:95], a[224:227], v[68:71], v[92:95]
    v_cvt_pk_bf16_f32 v9, v86, v87
    v_mul_f32 v108, v108, v65
    v_mfma_f32_16x16x32_bf16 v[92:95], a[228:231], v[20:23], v[92:95]
    s_waitcnt lgkmcnt(3)
    v_mul_f32 v109, v109, v65
    v_cvt_pk_bf16_f32 v10, v108, v109
    v_mfma_f32_16x16x32_bf16 v[92:95], a[232:235], v[80:83], v[92:95]
    ds_write_b32 v135, v8 offset:0
    v_mfma_f32_16x16x32_bf16 v[92:95], a[236:239], v[32:35], v[92:95]
    v_mul_f32 v110, v110, v65
    v_mul_f32 v111, v111, v65
    v_mfma_f32_16x16x32_bf16 v[84:87], a[240:243], v[72:75], 0
    v_cvt_pk_bf16_f32 v11, v110, v111
    v_mul_f32 v88, v88, v65
    v_mfma_f32_16x16x32_bf16 v[84:87], a[244:247], v[56:59], v[84:87]
    v_mul_f32 v89, v89, v65
    v_cvt_pk_bf16_f32 v8, v88, v89
    v_mfma_f32_16x16x32_bf16 v[84:87], a[248:251], v[68:71], v[84:87]
    ds_write_b32 v135, v9 offset:4
    v_mfma_f32_16x16x32_bf16 v[84:87], a[252:255], v[20:23], v[84:87]
    v_mul_f32 v90, v90, v65
    v_mul_f32 v91, v91, v65
    v_mfma_f32_16x16x32_bf16 v[84:87], v[224:227], v[80:83], v[84:87]
    v_cvt_pk_bf16_f32 v9, v90, v91
    v_cvt_pk_bf16_f32 v168, v96, v97
    v_mfma_f32_16x16x32_bf16 v[84:87], v[228:231], v[32:35], v[84:87]
    s_waitcnt lgkmcnt(2)
    ds_read_b128 v[64:67], v137 offset:3200
    v_cvt_pk_bf16_f32 v169, v98, v99
    v_mfma_f32_16x16x32_bf16 v[96:99], v[46:49], v[0:3], 0
    v_cvt_pk_bf16_f32 v170, v37, 0
    v_fmac_f32 v51, v104, v104
    v_mfma_f32_16x16x32_bf16 v[96:99], v[152:155], v[164:167], v[96:99]
    v_exp_f32 v24, v24
    v_mfma_f32_16x16x32_bf16 v[36:39], v[46:49], v[16:19], 0
    v_exp_f32 v25, v25
    v_mfma_f32_16x16x32_bf16 v[36:39], v[152:155], v[160:163], v[36:39]
    ds_write_b64 v135, v[10:11] offset:8
    v_mfma_f32_16x16x32_bf16 v[108:111], v[46:49], v[4:7], 0
    v_exp_f32 v26, v26
    v_mfma_f32_16x16x32_bf16 v[108:111], v[152:155], v[156:159], v[108:111]
    v_exp_f32 v27, v27
    v_mfma_f32_16x16x32_f16 v[46:49], v[12:15], v[28:31], v[188:191]
    s_nop 0
    ds_read_b128 v[152:155], v137 offset:3072
    v_mov_b32_dpp v99, v39 quad_perm:[0,1,2,3] row_mask:0x2 bank_mask:0xf
    v_mfma_f32_16x16x32_f16 v[46:49], v[146:149], v[144:147], v[46:49]
    s_nop 0
    ds_read_b128 v[36:39], v136 offset:3072
    v_mov_b32_dpp v99, v111 quad_perm:[0,1,2,3] row_mask:0x4 bank_mask:0xf
    v_mfma_f32_16x16x32_bf16 v[28:31], v[232:235], v[72:75], 0
    ds_read_b128 v[72:75], v136 offset:3200
    v_cvt_pk_bf16_f32 v99, v99, v99
    v_mfma_f32_16x16x32_bf16 v[28:31], v[236:239], v[56:59], v[28:31]
    ds_read_b128 v[56:59], v137 offset:3328
    v_add_u32 v137, s48, v137
    v_mfma_f32_16x16x32_bf16 v[28:31], v[240:243], v[68:71], v[28:31]
    ds_read_b128 v[68:71], v136 offset:3328
    v_add_u32 v136, s48, v136
    v_mfma_f32_16x16x32_bf16 v[28:31], v[244:247], v[20:23], v[28:31]
    v_exp_f32 v46, v46
    v_mfma_f32_16x16x32_bf16 v[28:31], v[248:251], v[80:83], v[28:31]
    v_exp_f32 v47, v47
    v_mfma_f32_16x16x32_bf16 v[28:31], v[252:255], v[32:35], v[28:31]
    v_exp_f32 v48, v48
    v_mfma_f32_16x16x32_f16 v[20:23], v[12:15], v[40:43], v[176:179]
    ds_write_b16 v131, v99
    v_mfma_f32_16x16x32_f16 v[20:23], v[146:149], v[138:141], v[20:23]
    s_waitcnt lgkmcnt(5)
    v_exp_f32 v49, v49
    v_mfma_f32_16x16x32_bf16 v[140:143], a[240:243], v[152:155], 0
    s_waitcnt lgkmcnt(4)
    v_cvt_pk_bf16_f32 v46, v46, v47
    v_cvt_pk_bf16_f32 v47, v48, v49
    v_mfma_f32_16x16x32_bf16 v[140:143], a[244:247], v[36:39], v[140:143]
    v_exp_f32 v54, v54
    v_mfma_f32_16x16x32_bf16 v[140:143], a[248:251], v[64:67], v[140:143]
    s_waitcnt lgkmcnt(2)
    ds_write_b32 v134, v8 offset:0
    v_mfma_f32_16x16x32_bf16 v[140:143], a[252:255], v[72:75], v[140:143]
    v_exp_f32 v20, v20
    v_mfma_f32_16x16x32_bf16 v[140:143], v[224:227], v[56:59], v[140:143]
    s_waitcnt lgkmcnt(2)
    v_exp_f32 v21, v21
    v_mfma_f32_16x16x32_bf16 v[140:143], v[228:231], v[68:71], v[140:143]
    v_exp_f32 v22, v22
    v_mfma_f32_16x16x32_bf16 v[10:13], v[220:223], v[44:47], 0
    ds_write_b32 v134, v9 offset:4
    v_mfma_f32_16x16x32_bf16 v[10:13], v[220:223], v[168:171], v[10:13]
    v_exp_f32 v23, v23
    v_mfma_f32_16x16x32_bf16 v[32:35], v[0:3], v[44:47], 0
    v_cvt_pk_bf16_f32 v48, v20, v21
    v_cvt_pk_bf16_f32 v49, v22, v23
    v_mfma_f32_16x16x32_bf16 v[32:35], v[164:167], v[168:171], v[32:35]
    ds_read_b128 v[146:149], v137 offset:0
    v_fmac_f32 v51, v105, v105
    v_mfma_f32_16x16x32_bf16 v[20:23], v[16:19], v[44:47], 0
    ds_read_b128 v[12:15], v136 offset:0
    v_fmac_f32 v51, v106, v106
    v_mfma_f32_16x16x32_bf16 v[20:23], v[160:163], v[168:171], v[20:23]
    ds_read_b128 v[40:43], v137 offset:256
    v_fmac_f32 v51, v107, v107
    v_mfma_f32_16x16x32_bf16 v[80:83], v[4:7], v[44:47], 0
    v_exp_f32 v100, v100
    v_mfma_f32_16x16x32_bf16 v[80:83], v[156:159], v[168:171], v[80:83]
    ds_read_b128 v[96:99], v136 offset:128
    v_cvt_pk_bf16_f32 v168, v24, v25
    v_mfma_f32_16x16x32_bf16 v[108:111], a[216:219], v[152:155], 0
    v_cvt_pk_bf16_f32 v169, v26, v27
    v_cvt_pk_bf16_f32 v170, v54, 0
    v_mfma_f32_16x16x32_bf16 v[108:111], a[220:223], v[36:39], v[108:111]
    ds_read_b128 v[52:55], v136 offset:256
    v_fmac_f32 v51, v116, v116
    v_mfma_f32_16x16x32_bf16 v[108:111], a[224:227], v[64:67], v[108:111]
    v_exp_f32 v101, v101
    v_mfma_f32_16x16x32_bf16 v[108:111], a[228:231], v[72:75], v[108:111]
    v_exp_f32 v102, v102
    v_mfma_f32_16x16x32_bf16 v[108:111], a[232:235], v[56:59], v[108:111]
    v_exp_f32 v103, v103
    v_mfma_f32_16x16x32_bf16 v[108:111], a[236:239], v[68:71], v[108:111]
    v_cvt_pk_bf16_f32 v46, v100, v101
    v_cvt_pk_bf16_f32 v47, v102, v103
    v_mfma_f32_16x16x32_bf16 v[88:91], v[232:235], v[152:155], 0
    v_rcp_f32 v11, v10
    v_mfma_f32_16x16x32_bf16 v[88:91], v[236:239], v[36:39], v[88:91]
    v_max3_u32 v124, v124, v10, v11
    v_mul_f32 v32, v32, v11
    v_mfma_f32_16x16x32_bf16 v[88:91], v[240:243], v[64:67], v[88:91]
    ds_read_b128 v[36:39], v137 offset:128
    v_mul_f32 v33, v33, v11
    v_mfma_f32_16x16x32_bf16 v[88:91], v[244:247], v[72:75], v[88:91]
    ds_read_b128 v[72:75], v136 offset:1792
    v_cvt_pk_bf16_f32 v24, v32, v33
    v_mfma_f32_16x16x32_bf16 v[88:91], v[248:251], v[56:59], v[88:91]
    v_mul_f32 v34, v34, v11
    v_mul_f32 v35, v35, v11
    v_mfma_f32_16x16x32_bf16 v[88:91], v[252:255], v[68:71], v[88:91]
    ds_read_b128 v[100:103], v137 offset:1664
    v_cvt_pk_bf16_f32 v25, v34, v35
    v_mfma_f32_16x16x32_bf16 v[68:71], v[220:223], v[46:49], 0
    v_mul_f32 v20, v20, v11
    v_mul_f32 v21, v21, v11
    v_mfma_f32_16x16x32_bf16 v[68:71], v[220:223], v[168:171], v[68:71]
    v_cvt_pk_bf16_f32 v26, v20, v21
    v_mul_f32 v22, v22, v11
    v_mfma_f32_16x16x32_bf16 v[152:155], v[0:3], v[46:49], 0
    v_mul_f32 v23, v23, v11
    v_cvt_pk_bf16_f32 v27, v22, v23
    v_mfma_f32_16x16x32_bf16 v[152:155], v[164:167], v[168:171], v[152:155]
    s_nop 0
    ds_write_b32 v135, v24 offset:1536
    v_mfma_f32_16x16x32_bf16 v[20:23], v[16:19], v[46:49], 0
    s_nop 0
    v_rcp_f32 v69, v68
    v_mfma_f32_16x16x32_bf16 v[20:23], v[160:163], v[168:171], v[20:23]
    s_nop 0
    v_max3_u32 v124, v124, v68, v69
    v_mul_f32 v152, v152, v69
    v_mfma_f32_16x16x32_bf16 v[0:3], v[4:7], v[46:49], 0
    ds_read_b128 v[112:115], v136 offset:1536
    v_mul_f32 v153, v153, v69
    v_mfma_f32_16x16x32_bf16 v[0:3], v[156:159], v[168:171], v[0:3]
    s_waitcnt lgkmcnt(3)
    ds_read_b128 v[60:63], v137 offset:1536
    v_cvt_pk_bf16_f32 v152, v152, v153
    v_mfma_f32_16x16x32_bf16 v[46:49], a[0:3], v[146:149], 0
    s_cbranch_scc1 L_loopF0
L_tailF:
    ds_write_b32 v135, v25 offset:1540
    v_mul_f32 v80, v80, v11
    v_mul_f32 v81, v81, v11
    v_cvt_pk_bf16_f32 v24, v80, v81
    v_mul_f32 v82, v82, v11
    v_mul_f32 v83, v83, v11
    v_cvt_pk_bf16_f32 v25, v82, v83
    s_mov_b32 s30, 100270464
    s_mul_i32 s89, s68, 7168
    ds_write_b64 v135, v[26:27] offset:1544
    v_mul_f32 v154, v154, v69
    s_add_u32 s89, s89, 135168
    s_movk_i32 s90, 112
    ds_write_b64 v134, v[24:25] offset:1536
    v_mul_f32 v155, v155, v69
    v_cvt_pk_bf16_f32 v153, v154, v155
    v_mul_f32 v20, v20, v69
    v_mul_f32 v21, v21, v69
    v_cvt_pk_bf16_f32 v154, v20, v21
    v_mul_f32 v22, v22, v69
    v_mul_f32 v23, v23, v69
    v_cvt_pk_bf16_f32 v155, v22, v23
    v_mul_f32 v0, v0, v69
    v_mul_f32 v1, v1, v69
    v_cvt_pk_bf16_f32 v0, v0, v1
    v_mul_f32 v2, v2, v69
    v_mul_f32 v3, v3, v69
    v_cvt_pk_bf16_f32 v1, v2, v3
    s_lshr_b32 s91, s64, 16
    s_lshl_b32 s92, s68, 10
    ds_write_b64 v135, v[152:153] offset:3072
    v_fmac_f32 v51, v117, v117
    s_sub_u32 s84, s45, s44
    s_sub_u32 s85, s46, s45
    ds_write_b64 v135, v[154:155] offset:3080
    v_fmac_f32 v51, v118, v118
    v_fmac_f32 v51, v119, v119
    v_fma_f32 v132, v92, v92, s42
    s_sub_u32 s86, s44, s45
    s_sub_u32 s93, s44, s47
    ds_write_b32 v134, v0 offset:3072
    ds_write_b32 v134, v1 offset:3076
    v_fmac_f32 v132, v93, v93
    v_fmac_f32 v132, v94, v94
    v_fmac_f32 v132, v95, v95
    v_fmac_f32 v132, v84, v84
    v_fmac_f32 v132, v85, v85
    v_fmac_f32 v132, v86, v86
    v_fmac_f32 v132, v87, v87
    v_fmac_f32 v132, v28, v28
    v_fmac_f32 v132, v29, v29
    v_fmac_f32 v132, v30, v30
    v_fmac_f32 v132, v31, v31
    v_fma_f32 v131, v108, v108, s42
    v_fmac_f32 v131, v109, v109
    v_fmac_f32 v131, v110, v110
    v_fmac_f32 v131, v111, v111
    v_fmac_f32 v131, v140, v140
    v_fmac_f32 v131, v141, v141
    v_fmac_f32 v131, v142, v142
    v_fmac_f32 v131, v143, v143
    v_fmac_f32 v131, v88, v88
    v_fmac_f32 v131, v89, v89
    v_fmac_f32 v131, v90, v90
    v_fmac_f32 v131, v91, v91
    v_cvt_pk_bf16_f32 v138, v51, v132
    v_cvt_pk_bf16_f32 v139, v131, v167
    s_sub_u32 s94, s45, s47
    s_sub_u32 s95, s46, s47
    ds_write_b64 v159, v[138:139]
    v_mbcnt_lo_u32_b32 v131, -1, 0
    v_mbcnt_hi_u32_b32 v131, -1, v131
    v_and_b32 v132, 15, v131
    v_lshrrev_b32 v131, 4, v131
    v_mul_u32_u24 v138, 1792, v131
    v_add_u32 v138, s89, v138
    v_mad_u32_u24 v131, v132, s90, v138
    v_lshrrev_b32 v139, v132, s64
    v_and_b32 v139, 1, v139
    v_cmp_eq_u32 vcc, 1, v139
    s_waitcnt lgkmcnt(1)
    v_mad_u32_u24 v60, v132, s90, v138
    v_lshrrev_b32 v132, v132, s91
    v_cndmask_b32 v131, v138, v131, vcc
    v_and_b32 v132, 1, v132
    v_subrev_u32 v60, 28672, v60
    v_cmp_eq_u32 vcc, 1, v132
    ds_read_b128 v[32:35], v131 offset:64
    ds_read_b128 v[24:27], v131 offset:80
    v_cndmask_b32 v60, v138, v60, vcc
    v_add_u32 v132, s92, v163
    s_waitcnt lgkmcnt(2)
    s_barrier
    ds_read_b128 v[4:7], v131
    v_add_u32 v62, s84, v137
    ds_read_b64 v[8:9], v131 offset:16
    ds_read_b128 v[0:3], v132 offset:6144
    v_add_u32 v61, s84, v136
    v_add_u32 v156, s85, v135
    ds_read_b128 v[20:23], v163 offset:0
    v_add_u32 v63, s85, v134
    ds_read_b128 v[12:15], v163 offset:1024
    v_add_u32 v138, s86, v135
    v_add_u32 v132, s86, v134
    v_add_u32 v131, s93, v133
    v_add_u32 v139, s94, v133
    s_waitcnt lgkmcnt(6)
    v_mfma_f32_16x16x32_bf16 v[16:19], v[220:223], v[32:35], 0
    s_waitcnt lgkmcnt(5)
    ds_read_b128 a[24:27], v62 offset:1536
    ds_read_b128 a[28:31], v61 offset:1536
    v_mfma_f32_16x16x32_bf16 v[16:19], v[220:223], v[24:27], v[16:19]
    s_waitcnt lgkmcnt(3)
    ds_read_b128 a[32:35], v62 offset:1664
    v_lshlrev_b32 v158, 16, v4
    v_and_b32 v4, 0xffff0000, v4
    v_lshlrev_b32 v157, 16, v5
    v_and_b32 v5, 0xffff0000, v5
    v_lshlrev_b32 v11, 16, v6
    v_and_b32 v6, 0xffff0000, v6
    v_rcp_f32 v17, v16
    v_lshlrev_b32 v10, 16, v7
    v_mfma_f32_16x16x32_bf16 v[36:39], v[216:219], v[20:23], 0
    s_waitcnt lgkmcnt(3)
    ds_read_b128 a[36:39], v61 offset:1664
    ds_read_b128 a[40:43], v62 offset:1792
    v_mfma_f32_16x16x32_bf16 v[36:39], v[216:219], v[12:15], v[36:39]
    s_waitcnt lgkmcnt(4)
    ds_read_b128 a[44:47], v61 offset:1792
    v_max3_u32 v124, v124, v16, v17
    v_mul_f32 v158, v158, v17
    v_mul_f32 v4, v4, v17
    v_cvt_pk_bf16_f32 v4, v158, v4
    v_mfma_f32_16x16x32_bf16 v[12:15], a[216:219], a[24:27], 0
    s_waitcnt lgkmcnt(4)
    v_mul_f32 v157, v157, v17
    v_mul_f32 v5, v5, v17
    v_mfma_f32_16x16x32_bf16 v[12:15], a[220:223], a[28:31], v[12:15]
    s_waitcnt lgkmcnt(3)
    ds_read_b128 a[0:3], v62 offset:0
    ds_read_b128 a[4:7], v61 offset:0
    v_mfma_f32_16x16x32_bf16 v[12:15], a[224:227], a[32:35], v[12:15]
    s_waitcnt lgkmcnt(4)
    ds_read_b128 a[8:11], v62 offset:128
    v_cvt_pk_bf16_f32 v5, v157, v5
    v_mul_f32 v11, v11, v17
    v_mul_f32 v6, v6, v17
    v_cvt_pk_bf16_f32 v6, v11, v6
    v_and_b32 v7, 0xffff0000, v7
    v_mfma_f32_16x16x32_bf16 v[12:15], a[228:231], a[36:39], v[12:15]
    s_waitcnt lgkmcnt(4)
    ds_read_b128 a[12:15], v61 offset:128
    ds_read_b128 a[16:19], v62 offset:256
    v_mfma_f32_16x16x32_bf16 v[12:15], a[232:235], a[40:43], v[12:15]
    s_waitcnt lgkmcnt(5)
    ds_read_b128 a[20:23], v61 offset:256
    v_mul_f32 v10, v10, v17
    v_mfma_f32_16x16x32_bf16 v[12:15], a[236:239], a[44:47], v[12:15]
    v_mul_f32 v7, v7, v17
    v_cvt_pk_bf16_f32 v7, v10, v7
    v_mfma_f32_16x16x32_bf16 v[40:43], a[240:243], a[24:27], 0
    ds_write_b128 v138, v[4:7] offset:0
    v_mfma_f32_16x16x32_bf16 v[40:43], a[244:247], a[28:31], v[40:43]
    v_lshlrev_b32 v39, 16, v8
    v_and_b32 v8, 0xffff0000, v8
    v_mfma_f32_16x16x32_bf16 v[40:43], a[248:251], a[32:35], v[40:43]
    v_mul_f32 v39, v39, v17
    v_mul_f32 v8, v8, v17
    v_mfma_f32_16x16x32_bf16 v[40:43], a[252:255], a[36:39], v[40:43]
    v_cvt_pk_bf16_f32 v160, v39, v8
    v_lshlrev_b32 v39, 16, v9
    v_mfma_f32_16x16x32_bf16 v[40:43], v[224:227], a[40:43], v[40:43]
    v_and_b32 v9, 0xffff0000, v9
    v_mul_f32 v39, v39, v17
    v_mfma_f32_16x16x32_bf16 v[40:43], v[228:231], a[44:47], v[40:43]
    v_mul_f32 v9, v9, v17
    v_cvt_pk_bf16_f32 v161, v39, v9
    v_mfma_f32_16x16x32_bf16 v[32:35], v[232:235], a[24:27], 0
    ds_write_b64 v132, v[160:161] offset:0
    v_mfma_f32_16x16x32_bf16 v[32:35], v[236:239], a[28:31], v[32:35]
    v_lshrrev_b32 v39, 0, v3
    v_lshrrev_b32 v39, v39, s64
    v_mfma_f32_16x16x32_bf16 v[32:35], v[240:243], a[32:35], v[32:35]
    v_and_b32 v39, 1, v39
    v_cmp_eq_u32 vcc, 1, v39
    v_mfma_f32_16x16x32_bf16 v[32:35], v[244:247], a[36:39], v[32:35]
    s_nop 0
    v_cndmask_b32 v0, 2.0, v0, vcc
    v_lshrrev_b32 v39, 8, v3
    v_mfma_f32_16x16x32_bf16 v[32:35], v[248:251], a[40:43], v[32:35]
    v_lshrrev_b32 v39, v39, s64
    v_and_b32 v39, 1, v39
    v_mfma_f32_16x16x32_bf16 v[32:35], v[252:255], a[44:47], v[32:35]
    s_waitcnt lgkmcnt(1)
    v_cmp_eq_u32 vcc, 1, v39
    v_lshrrev_b32 v3, 16, v3
    v_mfma_f32_16x16x32_bf16 v[44:47], a[216:219], a[0:3], 0
    v_cndmask_b32 v1, 2.0, v1, vcc
    v_lshrrev_b32 v3, v3, s64
    v_mfma_f32_16x16x32_bf16 v[44:47], a[220:223], a[4:7], v[44:47]
    ds_read_b128 a[48:51], v62 offset:3072
    ds_read_b128 a[52:55], v61 offset:3072
    v_mfma_f32_16x16x32_bf16 v[44:47], a[224:227], a[8:11], v[44:47]
    ds_read_b128 a[56:59], v62 offset:3200
    v_and_b32 v3, 1, v3
    v_mfma_f32_16x16x32_bf16 v[44:47], a[228:231], a[12:15], v[44:47]
    ds_read_b128 a[60:63], v61 offset:3200
    v_cmp_eq_u32 vcc, 1, v3
    v_mfma_f32_16x16x32_bf16 v[44:47], a[232:235], a[16:19], v[44:47]
    ds_read_b128 a[64:67], v62 offset:3328
    v_cndmask_b32 v2, 2.0, v2, vcc
    v_mfma_f32_16x16x32_bf16 v[44:47], a[236:239], a[20:23], v[44:47]
    ds_read_b128 a[68:71], v61 offset:3328
    v_add_u32 v3, s95, v133
    v_mfma_f32_16x16x32_bf16 v[48:51], a[240:243], a[0:3], 0
    v_rsq_f32 v36, v36
    v_mfma_f32_16x16x32_bf16 v[48:51], a[244:247], a[4:7], v[48:51]
    v_mul_f32 v36, s43, v36
    v_mul_f32 v76, v76, v36
    v_mfma_f32_16x16x32_bf16 v[48:51], a[248:251], a[8:11], v[48:51]
    v_mul_f32 v77, v77, v36
    v_cvt_pk_bf16_f32 v4, v76, v77
    v_mfma_f32_16x16x32_bf16 v[48:51], a[252:255], a[12:15], v[48:51]
    v_mul_f32 v78, v78, v36
    v_mul_f32 v79, v79, v36
    v_mfma_f32_16x16x32_bf16 v[48:51], v[224:227], a[16:19], v[48:51]
    v_cvt_pk_bf16_f32 v5, v78, v79
    v_mul_f32 v104, v104, v36
    v_mfma_f32_16x16x32_bf16 v[48:51], v[228:231], a[20:23], v[48:51]
    v_mul_f32 v105, v105, v36
    v_cvt_pk_bf16_f32 v6, v104, v105
    v_mfma_f32_16x16x32_bf16 v[24:27], v[232:235], a[0:3], 0
    v_mul_f32 v106, v106, v36
    v_mul_f32 v107, v107, v36
    v_mfma_f32_16x16x32_bf16 v[24:27], v[236:239], a[4:7], v[24:27]
    v_cvt_pk_bf16_f32 v7, v106, v107
    v_mul_f32 v116, v116, v36
    v_mfma_f32_16x16x32_bf16 v[24:27], v[240:243], a[8:11], v[24:27]
    ds_write_b128 v156, v[4:7] offset:0
    v_mfma_f32_16x16x32_bf16 v[24:27], v[244:247], a[12:15], v[24:27]
    v_mul_f32 v117, v117, v36
    v_cvt_pk_bf16_f32 v116, v116, v117
    v_mfma_f32_16x16x32_bf16 v[24:27], v[248:251], a[16:19], v[24:27]
    v_mul_f32 v118, v118, v36
    v_mul_f32 v119, v119, v36
    v_mfma_f32_16x16x32_bf16 v[24:27], v[252:255], a[20:23], v[24:27]
    s_waitcnt lgkmcnt(1)
    v_cvt_pk_bf16_f32 v117, v118, v119
    v_fma_f32 v62, v44, v44, s42
    v_mfma_f32_16x16x32_bf16 v[8:11], a[216:219], a[48:51], 0
    ds_write_b64 v63, v[116:117] offset:0
    v_mfma_f32_16x16x32_bf16 v[8:11], a[220:223], a[52:55], v[8:11]
    ds_read_b128 v[64:67], v60 offset:64
    v_fmac_f32 v62, v45, v45
    v_mfma_f32_16x16x32_bf16 v[8:11], a[224:227], a[56:59], v[8:11]
    ds_read_b128 v[4:7], v60 offset:80
    v_fmac_f32 v62, v46, v46
    v_mfma_f32_16x16x32_bf16 v[8:11], a[228:231], a[60:63], v[8:11]
    ds_read_b128 v[56:59], v60
    v_fmac_f32 v62, v47, v47
    v_mfma_f32_16x16x32_bf16 v[8:11], a[232:235], a[64:67], v[8:11]
L_pg2:
    s_cbranch_execz L_main
    ds_read_b64 v[60:61], v60 offset:16
    v_fmac_f32 v62, v48, v48
    v_mfma_f32_16x16x32_bf16 v[8:11], a[236:239], a[68:71], v[8:11]
    v_rsq_f32 v37, v37
    v_mfma_f32_16x16x32_bf16 v[52:55], a[240:243], a[48:51], 0
    v_mul_f32 v37, s43, v37
    v_mul_f32 v92, v92, v37
    v_mfma_f32_16x16x32_bf16 v[52:55], a[244:247], a[52:55], v[52:55]
    v_mul_f32 v93, v93, v37
    v_cvt_pk_bf16_f32 v16, v92, v93
    v_mfma_f32_16x16x32_bf16 v[52:55], a[248:251], a[56:59], v[52:55]
    v_mul_f32 v94, v94, v37
    v_mul_f32 v95, v95, v37
    v_mfma_f32_16x16x32_bf16 v[52:55], a[252:255], a[60:63], v[52:55]
    v_cvt_pk_bf16_f32 v17, v94, v95
    v_mul_f32 v84, v84, v37
    v_mfma_f32_16x16x32_bf16 v[52:55], v[224:227], a[64:67], v[52:55]
    v_mul_f32 v85, v85, v37
    v_cvt_pk_bf16_f32 v18, v84, v85
    v_mfma_f32_16x16x32_bf16 v[52:55], v[228:231], a[68:71], v[52:55]
    v_mul_f32 v86, v86, v37
    v_mul_f32 v87, v87, v37
    v_mfma_f32_16x16x32_bf16 v[20:23], v[232:235], a[48:51], 0
    v_cvt_pk_bf16_f32 v19, v86, v87
    v_mul_f32 v28, v28, v37
    v_mfma_f32_16x16x32_bf16 v[20:23], v[236:239], a[52:55], v[20:23]
    ds_write_b128 v156, v[16:19] offset:1536
    v_mfma_f32_16x16x32_bf16 v[20:23], v[240:243], a[56:59], v[20:23]
    v_mul_f32 v29, v29, v37
    v_cvt_pk_bf16_f32 v28, v28, v29
    v_mfma_f32_16x16x32_bf16 v[20:23], v[244:247], a[60:63], v[20:23]
    v_mul_f32 v30, v30, v37
    v_mul_f32 v31, v31, v37
    v_mfma_f32_16x16x32_bf16 v[20:23], v[248:251], a[64:67], v[20:23]
    v_cvt_pk_bf16_f32 v29, v30, v31
    v_fmac_f32 v62, v49, v49
    v_mfma_f32_16x16x32_bf16 v[20:23], v[252:255], a[68:71], v[20:23]
    s_waitcnt lgkmcnt(1)
    ds_write_b64 v63, v[28:29] offset:1536
    v_mfma_f32_16x16x32_bf16 v[16:19], v[220:223], v[64:67], 0
    v_rsq_f32 v38, v38
    v_mfma_f32_16x16x32_bf16 v[16:19], v[220:223], v[4:7], v[16:19]
    v_mul_f32 v38, s43, v38
    v_mul_f32 v108, v108, v38
    v_mul_f32 v109, v109, v38
    v_cvt_pk_bf16_f32 v4, v108, v109
    v_mul_f32 v110, v110, v38
    v_mul_f32 v111, v111, v38
    v_cvt_pk_bf16_f32 v5, v110, v111
    v_mul_f32 v140, v140, v38
    v_mul_f32 v141, v141, v38
    v_cvt_pk_bf16_f32 v6, v140, v141
    v_mul_f32 v142, v142, v38
    v_mul_f32 v143, v143, v38
    v_cvt_pk_bf16_f32 v7, v142, v143
    v_mul_f32 v88, v88, v38
    v_mul_f32 v89, v89, v38
    v_cvt_pk_bf16_f32 v88, v88, v89
    v_mul_f32 v90, v90, v38
    v_mul_f32 v91, v91, v38
    v_cvt_pk_bf16_f32 v89, v90, v91
    ds_write_b128 v156, v[4:7] offset:3072
    v_fmac_f32 v62, v50, v50
    v_fmac_f32 v62, v51, v51
    v_fmac_f32 v62, v24, v24
    v_fmac_f32 v62, v25, v25
    ds_write_b64 v63, v[88:89] offset:3072
    v_fmac_f32 v62, v26, v26
    v_fmac_f32 v62, v27, v27
    v_fma_f32 v133, v12, v12, s42
    v_fmac_f32 v133, v13, v13
    v_fmac_f32 v133, v14, v14
    v_fmac_f32 v133, v15, v15
    v_fmac_f32 v133, v40, v40
    v_fmac_f32 v133, v41, v41
    v_fmac_f32 v133, v42, v42
    v_fmac_f32 v133, v43, v43
    v_fmac_f32 v133, v32, v32
    v_fmac_f32 v133, v33, v33
    v_fmac_f32 v133, v34, v34
    v_fmac_f32 v133, v35, v35
    v_cvt_pk_bf16_f32 v62, v62, v133
    v_fma_f32 v133, v8, v8, s42
    v_fmac_f32 v133, v9, v9
    v_fmac_f32 v133, v10, v10
    v_fmac_f32 v133, v11, v11
    v_fmac_f32 v133, v52, v52
    v_fmac_f32 v133, v53, v53
    v_fmac_f32 v133, v54, v54
    v_fmac_f32 v133, v55, v55
    v_fmac_f32 v133, v20, v20
    v_fmac_f32 v133, v21, v21
    v_fmac_f32 v133, v22, v22
    v_fmac_f32 v133, v23, v23
    v_cvt_pk_bf16_f32 v63, v133, v133
    ds_write_b64 v159, v[62:63] offset:2048
    v_rcp_f32 v17, v16
    v_lshlrev_b32 v133, 16, v56
    v_max3_u32 v124, v124, v16, v17
    v_and_b32 v56, 0xffff0000, v56
    v_mul_f32 v133, v133, v17
    v_mul_f32 v56, v56, v17
    v_cvt_pk_bf16_f32 v4, v133, v56
    v_lshlrev_b32 v56, 16, v57
    v_and_b32 v57, 0xffff0000, v57
    v_mul_f32 v56, v56, v17
    v_mul_f32 v57, v57, v17
    v_cvt_pk_bf16_f32 v5, v56, v57
    v_lshlrev_b32 v133, 16, v58
    v_and_b32 v58, 0xffff0000, v58
    v_mul_f32 v133, v133, v17
    v_mul_f32 v58, v58, v17
    v_cvt_pk_bf16_f32 v6, v133, v58
    v_lshlrev_b32 v7, 16, v59
    v_and_b32 v59, 0xffff0000, v59
    v_mul_f32 v7, v7, v17
    v_mul_f32 v59, v59, v17
    v_cvt_pk_bf16_f32 v7, v7, v59
    v_lshlrev_b32 v133, 16, v60
    v_and_b32 v60, 0xffff0000, v60
    v_mul_f32 v133, v133, v17
    v_mul_f32 v60, v60, v17
    v_cvt_pk_bf16_f32 v160, v133, v60
    v_lshlrev_b32 v133, 16, v61
    v_and_b32 v61, 0xffff0000, v61
    v_mul_f32 v133, v133, v17
    v_mul_f32 v61, v61, v17
    v_cvt_pk_bf16_f32 v161, v133, v61
    s_waitcnt lgkmcnt(0)
    s_barrier
    ds_write_b128 v138, v[4:7] offset:1536
    v_cmp_gt_u32 vcc, 1820327936, v124
    v_mov_b32 v157, 0x3f803f80
    s_nop 0
    v_cndmask_b32 v125, -1, v125, vcc
    ds_write_b64 v132, v[160:161] offset:1536
    v_and_b32 v125, 0xb8000000, v125
    v_cmp_ne_u32 vcc, 0, v125
    s_nop 0
    ds_read_b128 a[144:147], v3 offset:0
    v_cndmask_b32 v157, 0, v157, vcc
    ds_read_b128 a[148:151], v3 offset:1024
    ds_read_b128 a[152:155], v3 offset:2048
    ds_read_b128 a[156:159], v3 offset:3072
    ds_read_b128 a[160:163], v3 offset:4096
    s_waitcnt lgkmcnt(5)
    s_barrier
    s_waitcnt lgkmcnt(4)
    buffer_store_dwordx4 a[144:147], v130, s[28:31], s59 offen sc1
    ds_read_b128 v[16:19], v163 offset:2048
    ds_read_b128 v[4:7], v163 offset:3072
    ds_read_b128 a[96:99], v137 offset:1536
    ds_read_b128 a[100:103], v136 offset:1536
    ds_read_b128 a[104:107], v137 offset:1664
    ds_read_b128 a[108:111], v136 offset:1664
    ds_read_b128 a[112:115], v137 offset:1792
    s_waitcnt lgkmcnt(8)
    buffer_store_dwordx4 a[148:151], v129, s[28:31], s59 offen sc1
    ds_read_b128 a[116:119], v136 offset:1792
    s_waitcnt lgkmcnt(7)
    v_mfma_f32_16x16x32_bf16 v[36:39], v[216:219], v[16:19], 0
    s_waitcnt lgkmcnt(6)
    v_mfma_f32_16x16x32_bf16 v[36:39], v[216:219], v[4:7], v[36:39]
    s_waitcnt lgkmcnt(5)
    v_mfma_f32_16x16x32_bf16 v[4:7], a[216:219], a[96:99], 0
    s_waitcnt lgkmcnt(4)
    v_mfma_f32_16x16x32_bf16 v[4:7], a[220:223], a[100:103], v[4:7]
    s_waitcnt lgkmcnt(3)
    ds_read_b128 a[72:75], v137 offset:0
    ds_read_b128 a[76:79], v136 offset:0
    v_mfma_f32_16x16x32_bf16 v[4:7], a[224:227], a[104:107], v[4:7]
    s_waitcnt lgkmcnt(4)
    ds_read_b128 a[80:83], v137 offset:128
    v_mfma_f32_16x16x32_bf16 v[4:7], a[228:231], a[108:111], v[4:7]
    s_waitcnt lgkmcnt(4)
    buffer_store_dwordx4 a[152:155], v128, s[28:31], s59 offen sc1
    ds_read_b128 a[84:87], v136 offset:128
    v_rsq_f32 v36, v36
    v_mfma_f32_16x16x32_bf16 v[4:7], a[232:235], a[112:115], v[4:7]
    s_waitcnt lgkmcnt(4)
    ds_read_b128 a[88:91], v137 offset:256
    ds_read_b128 a[92:95], v136 offset:256
    v_mfma_f32_16x16x32_bf16 v[4:7], a[236:239], a[116:119], v[4:7]
    v_rsq_f32 v37, v37
    v_mfma_f32_16x16x32_bf16 v[16:19], a[240:243], a[96:99], 0
    v_mul_f32 v36, s43, v36
    v_mul_f32 v37, s43, v37
    v_mfma_f32_16x16x32_bf16 v[16:19], a[244:247], a[100:103], v[16:19]
    v_rsq_f32 v38, v38
    v_mfma_f32_16x16x32_bf16 v[16:19], a[248:251], a[104:107], v[16:19]
    v_mul_f32 v38, s43, v38
    v_mul_f32 v8, v8, v38
    v_mfma_f32_16x16x32_bf16 v[16:19], a[252:255], a[108:111], v[16:19]
    buffer_store_dwordx4 a[156:159], v127, s[28:31], s59 offen sc1
    v_mul_f32 v9, v9, v38
    v_cvt_pk_bf16_f32 v28, v8, v9
    v_mul_f32 v10, v10, v38
    v_mul_f32 v11, v11, v38
    v_mfma_f32_16x16x32_bf16 v[16:19], v[224:227], a[112:115], v[16:19]
    v_cvt_pk_bf16_f32 v29, v10, v11
    v_mul_f32 v52, v52, v38
    v_mfma_f32_16x16x32_bf16 v[16:19], v[228:231], a[116:119], v[16:19]
    v_mul_f32 v53, v53, v38
    v_cvt_pk_bf16_f32 v30, v52, v53
    v_mfma_f32_16x16x32_bf16 v[8:11], v[232:235], a[96:99], 0
    v_mul_f32 v54, v54, v38
    v_mul_f32 v55, v55, v38
    v_mfma_f32_16x16x32_bf16 v[8:11], v[236:239], a[100:103], v[8:11]
    v_cvt_pk_bf16_f32 v31, v54, v55
    v_mul_f32 v20, v20, v38
    v_mfma_f32_16x16x32_bf16 v[8:11], v[240:243], a[104:107], v[8:11]
    ds_write_b128 v135, v[28:31] offset:3072
    v_mfma_f32_16x16x32_bf16 v[8:11], v[244:247], a[108:111], v[8:11]
    buffer_store_dwordx4 a[160:163], v126, s[28:31], s59 offen sc1
    v_mul_f32 v21, v21, v38
    v_cvt_pk_bf16_f32 v124, v20, v21
    v_mul_f32 v22, v22, v38
    v_mul_f32 v23, v23, v38
    v_mfma_f32_16x16x32_bf16 v[8:11], v[248:251], a[112:115], v[8:11]
    v_cvt_pk_bf16_f32 v125, v22, v23
    v_mul_f32 v44, v44, v36
    v_mfma_f32_16x16x32_bf16 v[8:11], v[252:255], a[116:119], v[8:11]
    s_waitcnt lgkmcnt(1)
    ds_write_b64 v134, v[124:125] offset:3072
    v_mfma_f32_16x16x32_bf16 v[20:23], a[216:219], a[72:75], 0
    v_mul_f32 v45, v45, v36
    v_cvt_pk_bf16_f32 v44, v44, v45
    v_mfma_f32_16x16x32_bf16 v[20:23], a[220:223], a[76:79], v[20:23]
    v_mul_f32 v46, v46, v36
    v_mul_f32 v47, v47, v36
    v_mfma_f32_16x16x32_bf16 v[20:23], a[224:227], a[80:83], v[20:23]
    v_cvt_pk_bf16_f32 v45, v46, v47
    v_mul_f32 v48, v48, v36
    v_mfma_f32_16x16x32_bf16 v[20:23], a[228:231], a[84:87], v[20:23]
    v_mul_f32 v49, v49, v36
    v_cvt_pk_bf16_f32 v46, v48, v49
    v_mfma_f32_16x16x32_bf16 v[20:23], a[232:235], a[88:91], v[20:23]
    v_mul_f32 v50, v50, v36
    v_mul_f32 v51, v51, v36
    v_mfma_f32_16x16x32_bf16 v[20:23], a[236:239], a[92:95], v[20:23]
    v_cvt_pk_bf16_f32 v47, v50, v51
    v_mul_f32 v24, v24, v36
    v_mfma_f32_16x16x32_bf16 v[28:31], a[240:243], a[72:75], 0
    ds_write_b128 v135, v[44:47] offset:0
    v_mfma_f32_16x16x32_bf16 v[28:31], a[244:247], a[76:79], v[28:31]
    v_mul_f32 v25, v25, v36
    v_cvt_pk_bf16_f32 v38, v24, v25
    v_mfma_f32_16x16x32_bf16 v[28:31], a[248:251], a[80:83], v[28:31]
    v_mul_f32 v26, v26, v36
    v_mul_f32 v27, v27, v36
    v_mfma_f32_16x16x32_bf16 v[28:31], a[252:255], a[84:87], v[28:31]
    v_cvt_pk_bf16_f32 v39, v26, v27
    v_fma_f32 v133, v4, v4, s42
    v_mfma_f32_16x16x32_bf16 v[28:31], v[224:227], a[88:91], v[28:31]
    ds_write_b64 v134, v[38:39] offset:0
    v_mfma_f32_16x16x32_bf16 v[28:31], v[228:231], a[92:95], v[28:31]
    v_fmac_f32 v133, v5, v5
    v_fmac_f32 v133, v6, v6
    v_mfma_f32_16x16x32_bf16 v[24:27], v[232:235], a[72:75], 0
    v_fmac_f32 v133, v7, v7
    v_fmac_f32 v133, v16, v16
    v_mfma_f32_16x16x32_bf16 v[24:27], v[236:239], a[76:79], v[24:27]
    v_fmac_f32 v133, v17, v17
    v_fmac_f32 v133, v18, v18
    v_mfma_f32_16x16x32_bf16 v[24:27], v[240:243], a[80:83], v[24:27]
    v_fmac_f32 v133, v19, v19
    v_fmac_f32 v133, v8, v8
    v_mfma_f32_16x16x32_bf16 v[24:27], v[244:247], a[84:87], v[24:27]
    v_fmac_f32 v133, v9, v9
    v_fmac_f32 v133, v10, v10
    v_mfma_f32_16x16x32_bf16 v[24:27], v[248:251], a[88:91], v[24:27]
    v_fmac_f32 v133, v11, v11
    v_fma_f32 v3, v20, v20, s42
    v_mfma_f32_16x16x32_bf16 v[24:27], v[252:255], a[92:95], v[24:27]
    s_nop 0
    v_fmac_f32 v3, v21, v21
    v_fmac_f32 v3, v22, v22
    v_fmac_f32 v3, v23, v23
    v_fmac_f32 v3, v28, v28
    v_fmac_f32 v3, v29, v29
    v_fmac_f32 v3, v30, v30
    v_fmac_f32 v3, v31, v31
    v_fmac_f32 v3, v24, v24
    v_fmac_f32 v3, v25, v25
    v_fmac_f32 v3, v26, v26
    v_fmac_f32 v3, v27, v27
    v_cvt_pk_bf16_f32 v156, v3, v133
    ds_write_b64 v159, v[156:157] offset:4096
    v_mul_f32 v12, v12, v37
    v_mul_f32 v13, v13, v37
    v_cvt_pk_bf16_f32 v12, v12, v13
    v_mul_f32 v14, v14, v37
    v_mul_f32 v15, v15, v37
    v_cvt_pk_bf16_f32 v13, v14, v15
    v_mul_f32 v40, v40, v37
    v_mul_f32 v41, v41, v37
    v_cvt_pk_bf16_f32 v14, v40, v41
    v_mul_f32 v42, v42, v37
    v_mul_f32 v43, v43, v37
    v_cvt_pk_bf16_f32 v15, v42, v43
    v_mul_f32 v32, v32, v37
    v_mul_f32 v33, v33, v37
    v_cvt_pk_bf16_f32 v124, v32, v33
    v_mul_f32 v34, v34, v37
    v_mul_f32 v35, v35, v37
    v_cvt_pk_bf16_f32 v125, v34, v35
    ds_write_b128 v135, v[12:15] offset:1536
    s_waitcnt lgkmcnt(1)
    s_barrier
    ds_write_b64 v134, v[124:125] offset:1536
    ds_read_b128 v[36:39], v163 offset:4096
    ds_read_b128 v[32:35], v163 offset:5120
    s_waitcnt lgkmcnt(2)
    s_barrier
    s_waitcnt lgkmcnt(1)
    v_mfma_f32_16x16x32_bf16 v[12:15], v[216:219], v[36:39], 0
    s_waitcnt lgkmcnt(0)
    ds_read_b128 a[164:167], v139 offset:0
    ds_read_b128 a[168:171], v139 offset:1024
    v_mfma_f32_16x16x32_bf16 v[12:15], v[216:219], v[32:35], v[12:15]
    s_nop 0
    ds_read_b128 a[172:175], v139 offset:2048
    s_nop 2
    ds_read_b128 a[176:179], v139 offset:3072
    s_nop 1
    v_rsq_f32 v12, v12
    ds_read_b128 a[180:183], v139 offset:4096
    v_mul_f32 v12, s43, v12
    v_mul_f32 v20, v20, v12
    v_mul_f32 v21, v21, v12
    v_cvt_pk_bf16_f32 v20, v20, v21
    v_mul_f32 v22, v22, v12
    v_mul_f32 v23, v23, v12
    v_cvt_pk_bf16_f32 v21, v22, v23
    v_mul_f32 v28, v28, v12
    v_mul_f32 v29, v29, v12
    s_waitcnt lgkmcnt(4)
    buffer_store_dwordx4 a[164:167], v130, s[28:31], s58 offen sc1
    v_cvt_pk_bf16_f32 v22, v28, v29
    v_mul_f32 v30, v30, v12
    v_mul_f32 v31, v31, v12
    v_cvt_pk_bf16_f32 v23, v30, v31
    v_mul_f32 v24, v24, v12
    v_mul_f32 v25, v25, v12
    v_cvt_pk_bf16_f32 v124, v24, v25
    v_mul_f32 v26, v26, v12
    v_mul_f32 v27, v27, v12
    v_cvt_pk_bf16_f32 v125, v26, v27
    ds_write_b128 v138, v[20:23] offset:0
    v_rsq_f32 v13, v13
    v_cmp_neq_f32 vcc, 0, v14
    v_mul_f32 v13, s43, v13
    s_waitcnt lgkmcnt(1)
    buffer_store_dwordx4 a[168:171], v129, s[28:31], s58 offen sc1
    ds_write_b64 v132, v[124:125] offset:0
    v_mul_f32 v4, v4, v13
    v_mul_f32 v5, v5, v13
    v_cvt_pk_bf16_f32 v4, v4, v5
    v_mul_f32 v6, v6, v13
    v_mul_f32 v7, v7, v13
    v_cvt_pk_bf16_f32 v5, v6, v7
    v_mul_f32 v16, v16, v13
    v_mul_f32 v17, v17, v13
    v_cvt_pk_bf16_f32 v6, v16, v17
    v_mul_f32 v18, v18, v13
    v_mul_f32 v19, v19, v13
    v_cvt_pk_bf16_f32 v7, v18, v19
    v_mul_f32 v8, v8, v13
    v_mul_f32 v9, v9, v13
    v_cvt_pk_bf16_f32 v124, v8, v9
    v_mul_f32 v10, v10, v13
    v_mul_f32 v11, v11, v13
    v_cvt_pk_bf16_f32 v125, v10, v11
    buffer_store_dwordx4 a[172:175], v128, s[28:31], s58 offen sc1
    ds_write_b128 v138, v[4:7] offset:1536
    ds_write_b64 v132, v[124:125] offset:1536
    buffer_store_dwordx4 a[176:179], v127, s[28:31], s58 offen sc1
    s_waitcnt lgkmcnt(0)
    s_barrier
    buffer_store_dwordx4 a[180:183], v126, s[28:31], s58 offen sc1
    ds_read_b128 a[184:187], v131 offset:0
    ds_read_b128 a[188:191], v131 offset:1024
    ds_read_b128 a[192:195], v131 offset:2048
    s_waitcnt lgkmcnt(2)
    buffer_store_dwordx4 a[184:187], v0, s[28:31], 0 offen sc1
    s_waitcnt lgkmcnt(0)
    buffer_store_dwordx4 a[188:191], v1, s[28:31], 0 offen sc1
    buffer_store_dwordx4 a[192:195], v2, s[28:31], 0 offen sc1
    s_nop 4
    s_cbranch_vccnz L_slow
L_fin:
    s_cmp_eq_u32 s2, 255
    s_cbranch_scc1 L_again
L_end:
    s_endpgm
L_slow:
    s_waitcnt vmcnt(0) lgkmcnt(0)
    s_nop 15
    s_barrier
    s_lshr_b32 s66, s64, 20
    v_mbcnt_lo_u32_b32 v4, -1, 0
    v_mbcnt_hi_u32_b32 v4, -1, v4
    s_load_dwordx16 s[4:19], s[0:1], 0
    s_load_dwordx4 s[20:23], s[0:1], 64
    s_load_dwordx2 s[38:39], s[0:1], 80
    s_bfe_u32 s88, s2, 0x50003
    s_lshl2_add_u32 s88, s88, s68
    v_lshlrev_b32 v5, 7, v4
    s_mul_i32 s89, s88, 576
    s_mul_i32 s88, s88, 1728
    v_min_u32 v17, 1664, v5
    v_min_u32 v7, 512, v5
    s_mov_b32 s34, 221184
    s_mov_b32 s35, 0x20000
    s_mov_b32 s78, 73728
    s_mov_b32 s79, 0x20000
    v_and_b32 v161, 15, v4
    v_lshrrev_b32 v44, 4, v4
    v_lshrrev_b32 v148, 2, v161
    v_and_b32 v5, 3, v161
    s_mul_i32 s87, s68, 192
    v_mad_u32_u24 v23, v161, 12, s87
    v_lshlrev_b32 v6, 1, v161
    v_lshlrev_b32 v16, 1, v148
    v_lshl_add_u32 v16, v44, 5, v16
    s_movk_i32 s86, 384
    s_mov_b32 s26, 100270464
    s_mov_b32 s27, 0x20000
    s_mov_b32 s30, 0
    s_mov_b32 s31, 0x20000
    s_mul_i32 s96, s68, 288
    s_and_b32 s97, s68, 1
    s_lshl_b32 s97, s97, 2
    s_mov_b32 s98, 193536
    s_waitcnt lgkmcnt(0)
    s_mov_b32 s24, s4
    s_mov_b32 s25, s5
    s_mov_b32 s32, s6
    s_mov_b32 s33, s7
    s_mov_b32 s76, s8
    s_mov_b32 s77, s9
    buffer_load_dword a254, v17, s[32:35], s88 offen
    buffer_load_dword a253, v7, s[76:79], s89 offen
    s_load_dwordx2 s[82:83], s[10:11], 0
    s_movk_i32 s18, 676
    s_mov_b32 s19, 0x20000
    buffer_load_dwordx3 v[32:34], v23, s[16:19], 0 offen
    s_mov_b32 s99, 589824
    v_add_u32 v7, s96, v4
    v_mul_u32_u24 v131, 2731, v7
    v_mul_u32_u24 v35, 6242, v7
    v_lshrrev_b32 v131, 16, v131
    s_lshr_b32 s94, s2, 3
    s_mul_i32 s70, s94, 167
    global_load_ushort v20, v6, s[12:13]
    v_lshrrev_b32 v35, 20, v35
    v_and_or_b32 v8, v131, 3, s97
    v_xor_b32 v8, v7, v8
    v_lshl_add_u32 v130, v8, 4, s99
    v_mad_u32_u24 v130, v35, s98, v130
    s_min_u32 s95, s94, 7
    s_add_u32 s70, s70, s95
    global_load_ushort v21, v6, s[12:13] offset:32
    v_add_u32 v22, 64, v7
    v_mul_u32_u24 v6, 2731, v22
    v_mul_u32_u24 v25, 6242, v22
    v_lshrrev_b32 v6, 16, v6
    v_lshrrev_b32 v25, 20, v25
    s_and_b32 s95, s2, 7
    s_mul_i32 s95, s95, 20
    global_load_ushort v18, v16, s[14:15] offset:0
    v_and_or_b32 v9, v6, 3, s97
    v_xor_b32 v9, v22, v9
    v_lshl_add_u32 v129, v9, 4, s99
    v_mad_u32_u24 v129, v25, s98, v129
    v_add_u32 v17, 128, v7
    s_add_u32 s69, s70, s95
    s_add_u32 s70, s70, 140
    global_load_ushort v133, v16, s[14:15] offset:8
    v_mul_u32_u24 v22, 2731, v17
    v_mul_u32_u24 v11, 6242, v17
    v_lshrrev_b32 v22, 16, v22
    v_lshrrev_b32 v11, 20, v11
    v_and_or_b32 v10, v22, 3, s97
    s_movk_i32 s62, 2688
    s_movk_i32 s71, 20
    global_load_ushort v19, v16, s[14:15] offset:16
    v_xor_b32 v10, v17, v10
    v_lshl_add_u32 v128, v10, 4, s99
    v_mad_u32_u24 v128, v11, s98, v128
    v_add_u32 v17, 192, v7
    v_mul_u32_u24 v124, 2731, v17
    s_cmp_lt_u32 s94, 7
    s_cselect_b32 s73, 28, 27
    global_load_ushort v24, v16, s[14:15] offset:24
    v_mul_u32_u24 v125, 6242, v17
    v_lshrrev_b32 v124, 16, v124
    v_lshrrev_b32 v125, 20, v125
    v_and_or_b32 v16, v124, 3, s97
    v_xor_b32 v16, v17, v16
    v_lshl_add_u32 v127, v16, 4, s99
    v_mad_u32_u24 v127, v125, s98, v127
    v_add_u32 v126, 256, v7
    v_mul_u32_u24 v26, 2731, v126
    v_mul_u32_u24 v7, 6242, v126
    v_lshrrev_b32 v26, 16, v26
    v_lshrrev_b32 v7, 20, v7
    v_and_or_b32 v27, v26, 3, s97
    v_xor_b32 v27, v126, v27
    v_lshl_add_u32 v126, v27, 4, s99
    v_mad_u32_u24 v126, v7, s98, v126
    s_mov_b32 s93, 1769472
    s_mul_i32 s54, s68, 5120
    s_cmp_ge_u32 s2, 248
    s_cbranch_scc1 L_bndS
L_bndrS:
    s_mov_b32 s63, 1180032
    s_mul_i32 s94, s69, 58255
    s_lshr_b32 s94, s94, 22
    s_mul_i32 s94, s94, s63
    s_mul_i32 s72, s69, s62
    s_add_u32 s72, s72, s94
    v_lshl_or_b32 v149, v4, 4, 2.0
    s_sub_u32 s94, s73, 1
    s_max_u32 s94, s94, 20
    s_mul_i32 s95, s68, -44
    s_movk_i32 s99, -24
    s_add_u32 m0, s54, 0
    v_and_b32 v11, -4, v22
    s_mul_i32 s85, s68, 96
    s_sub_u32 s100, s85, 1024
    buffer_load_dwordx4 v130, s[24:27], s72 offen nt lds
    s_add_u32 m0, s54, 1024
    v_mad_u32_u24 v7, v11, 3, v22
    v_add_u32 v7, s95, v7
    v_mad_i32_i24 v10, v22, s99, v10
    v_med3_u32 v11, v7, 20, s94
    v_add_u32 v11, s70, v11
    v_add_u32 v22, s69, v7
    s_sub_u32 s87, s85, 2048
    s_movk_i32 s91, 1152
    buffer_load_dwordx4 v129, s[24:27], s72 offen nt lds
    v_cmp_gt_u32 vcc, s71, v7
    v_lshl_add_u32 v10, v10, 4, s93
    s_add_u32 m0, s54, 43008
    v_cndmask_b32 v22, v11, v22, vcc
    v_mul_u32_u24 v11, 58255, v22
    v_mad_u32_u24 v10, v22, s62, v10
    v_lshrrev_b32 v11, 22, v11
    v_mad_u32_u24 v10, v11, s63, v10
    s_mul_i32 s90, s68, 3072
    s_add_u32 s90, s90, 61440
    buffer_load_dwordx4 v10, s[24:27], 0 offen  lds
    v_lshlrev_b32 v11, 16, v7
    s_add_u32 m0, s54, 2048
    v_and_b32 v35, -4, v6
    v_mad_u32_u24 v22, v35, 3, v6
    v_add_u32 v22, s95, v22
    v_mad_i32_i24 v9, v6, s99, v9
    v_med3_u32 v35, v22, 20, s94
    s_mov_b32 s28, s22
    s_mov_b32 s29, s23
    buffer_load_dwordx4 v128, s[24:27], s72 offen nt lds
    v_add_u32 v35, s70, v35
    v_add_u32 v6, s69, v22
    v_cmp_gt_u32 vcc, s71, v22
    v_lshl_add_u32 v9, v9, 4, s93
    s_add_u32 m0, s54, 41984
    v_cndmask_b32 v6, v35, v6, vcc
    v_mul_u32_u24 v35, 58255, v6
    v_mad_u32_u24 v9, v6, s62, v9
    v_lshrrev_b32 v35, 22, v35
    v_mad_u32_u24 v9, v35, s63, v9
    s_mov_b32 s41, 0x2a8cbccc
    s_mov_b32 s42, 0x38fba882
    buffer_load_dwordx4 v9, s[24:27], 0 offen  lds
    v_lshl_or_b32 v11, v22, 8, v11
    s_add_u32 m0, s54, 3072
    v_cmp_gt_u32 vcc, 32, v4
    v_and_b32 v35, -4, v131
    v_mad_u32_u24 v22, v35, 3, v131
    v_cndmask_b32 v126, v149, v126, vcc
    v_add_u32 v22, s95, v22
    s_mov_b32 s43, 0x415db3d7
    s_mov_b32 s57, s72
    buffer_load_dwordx4 v127, s[24:27], s72 offen nt lds
    s_add_u32 m0, s54, 4096
    v_mad_i32_i24 v8, v131, s99, v8
    v_med3_u32 v35, v22, 20, s94
    v_add_u32 v35, s70, v35
    v_add_u32 v131, s69, v22
    v_cmp_gt_u32 vcc, s71, v22
    v_lshl_add_u32 v8, v8, 4, s93
    s_mul_i32 s93, s68, 6
    s_lshl_b32 s94, s97, 1
    buffer_load_dwordx4 v126, s[24:27], s72 offen nt lds
    v_cndmask_b32 v131, v35, v131, vcc
    v_mul_u32_u24 v35, 58255, v131
    v_mad_u32_u24 v8, v131, s62, v8
    v_lshrrev_b32 v35, 22, v35
    v_mad_u32_u24 v8, v35, s63, v8
    s_add_u32 m0, s54, 40960
    v_lshl_or_b32 v11, v22, 0, v11
    s_mov_b32 s58, 0
    s_mov_b32 s59, 0
    buffer_load_dwordx4 v8, s[24:27], 0 offen nt lds
    v_mul_u32_u24 v131, 10923, v4
    v_lshrrev_b32 v168, 17, v131
    v_lshrrev_b32 v131, 16, v131
    v_mad_i32_i24 v6, v131, -6, v4
    v_bitop3_b32 v168, v168, v131, 4 bitop3:0x28
    v_lshl_add_u32 v6, v6, 4, s85
    v_mul_u32_u24 v168, 3, v168
    v_xor_b32 v131, v131, v168
    v_mad_u32_u24 v168, v131, s91, v6
    v_add_u32 v7, 64, v4
    v_mul_u32_u24 v17, 10923, v7
    v_lshrrev_b32 v157, 17, v17
    v_lshrrev_b32 v17, 16, v17
    v_mad_i32_i24 v22, v17, -6, v7
    v_bitop3_b32 v157, v157, v17, 4 bitop3:0x28
    v_lshl_add_u32 v22, v22, 4, s100
    v_mul_u32_u24 v157, 3, v157
    v_xor_b32 v17, v17, v157
    v_mad_u32_u24 v157, v17, s91, v22
    v_add_u32 v7, 128, v4
    v_mul_u32_u24 v35, 10923, v7
    v_lshrrev_b32 v47, 17, v35
    v_lshrrev_b32 v35, 16, v35
    v_mad_i32_i24 v16, v35, -6, v7
    v_bitop3_b32 v47, v47, v35, 4 bitop3:0x28
    v_lshl_add_u32 v16, v16, 4, s87
    v_mul_u32_u24 v47, 3, v47
    v_xor_b32 v35, v35, v47
    v_mad_u32_u24 v47, v35, s91, v16
    v_mad_u32_u24 v158, v131, s86, v6
    v_mad_u32_u24 v17, v17, s86, v22
    v_mad_u32_u24 v16, v35, s86, v16
    s_add_u32 m0, s90, 0
    s_mov_b32 s92, 0
    buffer_load_dwordx4 v168, s[32:35], s92 offen offset:0 lds
    v_mov_b32 v35, 0x3f803f80
    v_cmp_eq_u32 vcc, 0, v5
    v_and_b32 v22, 1, v4
    v_lshlrev_b32 v22, 4, v22
    v_cndmask_b32 v220, 0, v35, vcc
    v_cndmask_b32 v221, 0, v35, vcc
    v_cndmask_b32 v222, 0, v35, vcc
    v_cndmask_b32 v223, 0, v35, vcc
    v_mov_b32 v35, 0x3f80
    v_lshlrev_b32 v22, v22, v35
    v_cmp_gt_u32 vcc, 2, v5
    v_mov_b32 v171, 0
    v_mov_b32 v150, 0
    v_cndmask_b32 v216, 0, v22, vcc
    v_cndmask_b32 v218, 0, v22, vcc
    v_cmp_le_u32 vcc, 2, v5
    v_mov_b32 v151, 0
    v_mov_b32 v144, 0
    v_cndmask_b32 v217, 0, v22, vcc
    v_cndmask_b32 v219, 0, v22, vcc
    v_cmp_eq_u32 vcc, v44, v148
    v_mov_b32 v145, 0
    v_mov_b32 v138, 0
    v_cndmask_b32 v26, 0, v216, vcc
    v_cndmask_b32 v27, 0, v217, vcc
    v_mov_b32 v139, 0
    v_lshrrev_b32 v6, 1, v44
    v_lshl_add_u32 v7, v44, 2, v148
    v_lshl_add_u32 v7, v6, 3, v7
    v_mul_u32_u24 v7, 96, v7
    v_add_u32 v7, s90, v7
    v_lshl_add_u32 v6, v5, 4, v7
    v_lshl_add_u32 v7, v5, 3, v7
    s_waitcnt lgkmcnt(0)
    s_lshl_b32 s85, s68, 4
    v_lshlrev_b32 v25, 4, v44
    v_lshrrev_b64 v[124:125], v25, s[82:83]
    v_lshlrev_b32 v25, 16, v124
    v_min_f32 v25, 0x40930000, v25
    v_max_f32 v25, 0xc2c80000, v25
    v_mul_f32 v25, 0x3fb8aa3b, v25
    v_exp_f32 v25, v25
    v_mov_b32 v132, 0xc138aa3b
    v_cvt_pk_bf16_f32 v25, v25, v25
    v_lshlrev_b32 v25, 16, v25
    v_mul_f32 v25, 0x4038aa3b, v25
    v_fmac_f32 v132, 0xbe333333, v25
    v_readlane_b32 s55, v25, s85
    v_add_f32 v25, v25, v25
    v_mov_b32 v22, 0
    v_readlane_b32 s52, v25, s85
    v_mov_b32 v35, 0
    v_mul_u32_u24 v124, 5120, v44
    v_add_u32 v124, v23, v124
    s_mov_b32 s84, 0x41b8aa3b
    v_mul_u32_u24 v131, 5120, v148
    v_mad_u32_u24 v131, v5, s86, v131
    v_and_b32 v23, 7, v161
    v_xor_b32 v125, v23, v44
    v_lshl_add_u32 v147, v125, 4, v131
    s_mov_b32 s44, 61440
    s_mov_b32 s45, 40960
    buffer_load_dwordx4 v157, s[32:35], s92 offen offset:1024 lds
    v_xor_b32 v146, 64, v147
    v_add_u32 v137, 40960, v147
    v_xor_b32 v136, 64, v137
    v_add_u32 v131, 61440, v131
    v_add_u32 v125, s93, v44
    v_xor_b32 v125, v23, v125
    v_lshl_add_u32 v135, v125, 4, v131
    s_mov_b32 s46, 20480
    s_mov_b32 s47, 0
    buffer_load_dwordx4 v47, s[32:35], s92 offen offset:2048 lds
    s_add_u32 m0, s90, 12288
    s_mov_b32 s92, 36864
    v_lshrrev_b32 v125, 1, v44
    v_add3_u32 v125, v125, s93, 4
    v_xor_b32 v125, v23, v125
    v_lshl_add_u32 v125, v125, 4, v131
    v_and_b32 v131, 1, v44
    s_add_u32 s93, s54, 20480
    s_mov_b32 s60, 0
    buffer_load_dwordx4 v168, s[32:35], s92 offen offset:0 lds
    s_waitcnt vmcnt(16)
    v_lshl_or_b32 v20, v21, 16, v20
    v_cmp_gt_u32 vcc, 16, v4
    v_mov_b32 v21, 0
    v_lshl_add_u32 v134, v131, 3, v125
    v_cndmask_b32 v23, 0, v20, vcc
    v_cndmask_b32 v20, 0, v20, vcc
    v_lshlrev_b32 v25, 4, v4
    v_mfma_f32_16x16x16_bf16 v[0:3], v[22:23], v[32:33], 0
    s_waitcnt vmcnt(14)
    s_mov_b32 s65, -1
    v_lshl_or_b32 v18, v133, 16, v18
    v_add_u32 v133, s93, v25
    v_mfma_f32_16x16x16_bf16 v[12:15], v[20:21], v[32:33], 0
    s_lshr_b32 s93, s68, 1
    v_add_u32 v163, 81920, v25
    v_mul_u32_u24 v131, 1792, v44
    v_mfma_f32_16x16x16_bf16 v[28:31], v[20:21], v[34:35], 0
    s_waitcnt vmcnt(12)
    s_lshl_b32 s93, s93, 10
    buffer_load_dwordx4 v157, s[32:35], s92 offen offset:1024 lds
    v_lshl_or_b32 v19, v24, 16, v19
    v_max_f32 v0, 0, v0
    v_max_f32 v12, 0, v12
    v_max_f32 v13, 0, v13
    v_max_f32 v14, 0, v14
    v_max_f32 v15, 0, v15
    v_cvt_pk_bf16_f32 v12, v12, v13
    v_cvt_pk_bf16_f32 v13, v14, v15
    v_max_f32 v1, 0, v1
    v_max_f32 v2, 0, v2
    v_mfma_f32_16x16x16_bf16 v[20:23], v[18:19], v[12:13], 0
    s_add_u32 s93, s93, s94
    v_max_f32 v3, 0, v3
    v_cvt_pk_bf16_f32 v0, v0, v1
    v_cvt_pk_bf16_f32 v1, v2, v3
    v_max_f32 v28, 0, v28
    v_max_f32 v29, 0, v29
    v_mfma_f32_16x16x16_bf16 v[12:15], v[18:19], v[0:1], 0
    s_mov_b32 s61, 1
    v_max_f32 v30, 0, v30
    v_max_f32 v31, 0, v31
    v_cvt_pk_bf16_f32 v28, v28, v29
    v_cvt_pk_bf16_f32 v29, v30, v31
    v_cvt_pk_bf16_f32 v20, v20, v20
    v_lshlrev_b32 v20, 16, v20
    v_mfma_f32_16x16x16_bf16 v[0:3], v[18:19], v[28:29], 0
    s_movk_i32 s4, 112
    v_mul_f32 v20, 0xbfb8aa3b, v20
    v_cvt_pk_bf16_f32 v12, v12, v12
    v_exp_f32 v20, v20
    v_lshlrev_b32 v12, 16, v12
    v_add_f32 v20, 1.0, v20
    v_rcp_f32 v20, v20
    v_mul_f32 v12, 0xbfb8aa3b, v12
    v_cvt_pk_bf16_f32 v20, v20, v20
    v_lshlrev_b32 v20, 16, v20
    v_fma_f32 v20, v20, s84, v132
    s_mov_b32 s5, 0
    s_mov_b32 s6, 0
    ds_write_b32 v124, v20 offset:44032
    v_exp_f32 v12, v12
    v_cvt_pk_bf16_f32 v0, v0, v0
    v_add_f32 v12, 1.0, v12
    v_rcp_f32 v12, v12
    v_lshlrev_b32 v0, 16, v0
    v_cvt_pk_bf16_f32 v12, v12, v12
    v_lshlrev_b32 v12, 16, v12
    v_fma_f32 v12, v12, s84, v132
    s_mov_b32 s12, 0
    s_mov_b32 s64, 3
    ds_write_b32 v124, v12 offset:44036
    v_mul_f32 v0, 0xbfb8aa3b, v0
    v_exp_f32 v0, v0
    v_add_u32 v159, s93, v163
    v_add_f32 v0, 1.0, v0
    v_rcp_f32 v0, v0
    s_mul_i32 s93, s68, 7168
    v_cvt_pk_bf16_f32 v0, v0, v0
    v_lshlrev_b32 v0, 16, v0
    v_fma_f32 v0, v0, s84, v132
    s_add_u32 s93, s93, 135168
    s_mov_b32 s10, 81924
    ds_write_b32 v124, v0 offset:44040
    v_add_u32 v125, s93, v131
    v_mul_u32_u24 v131, 112, v161
    v_add_u32 v124, v131, v125
    v_subrev_u32 v124, 28672, v124
    v_cmp_eq_u32 vcc, 0, v148
    v_add_u32 v131, 16, v125
    v_mov_b32 v167, 0
    v_cndmask_b32 v132, v149, v125, vcc
    v_cmp_eq_u32 vcc, 3, v5
    s_mov_b32 s11, 0x20000
    s_mov_b32 s3, 0x00010001
    v_cndmask_b32 v132, v132, v131, vcc
    v_mul_u32_u24 v131, 1792, v148
    v_lshl_add_u32 v131, v44, 3, v131
    v_lshl_add_u32 v131, v5, 1, v131
    v_add_u32 v131, s93, v131
    v_cmp_gt_u32 vcc, 3, v44
    v_mov_b32 v125, v131
    s_add_u32 s93, s69, 1
    v_cndmask_b32 v131, v149, v131, vcc
    s_mul_i32 s94, s93, 58255
    s_lshr_b32 s94, s94, 22
    s_mul_i32 s94, s94, s63
    s_mul_i32 s56, s93, s62
    s_add_u32 s56, s56, s94
    s_sub_u32 s93, s71, 1
    s_cmp_eq_u32 s68, 0
    s_cselect_b32 s13, s93, -1
    s_cmp_gt_u32 s73, 20
    s_cselect_b32 s13, s13, -1
    s_and_b32 s93, s2, -8
    s_sub_u32 s93, 81920, s93
    s_sub_u32 s8, s38, s93
    s_waitcnt lgkmcnt(0)
    s_barrier
    s_subb_u32 s9, s39, 0
    s_add_u32 s101, s54, 44032
    v_mul_u32_u24 v45, 48, v148
    v_lshl_add_u32 v45, v5, 2, v45
    v_mul_u32_u24 v46, 48, v44
    v_add_u32 v199, 0, v45
    v_mul_u32_u24 v5, 37, v199
    v_lshrrev_b32 v5, 10, v5
    v_mad_u32_u24 v199, v5, 24, v199
    v_add_u32 v199, s101, v199
    v_add_u32 v148, 16, v45
    v_mul_u32_u24 v5, 37, v148
    v_lshrrev_b32 v5, 10, v5
    v_mad_u32_u24 v148, v5, 24, v148
    v_add_u32 v148, s101, v148
    v_add_u32 v5, 32, v45
    v_mul_u32_u24 v156, 37, v5
    v_lshrrev_b32 v156, 10, v156
    v_mad_u32_u24 v5, v156, 24, v5
    v_add_u32 v5, s101, v5
    v_add_u32 v164, 0, v46
    v_mul_u32_u24 v156, 37, v164
    v_lshrrev_b32 v156, 10, v156
    v_mad_u32_u24 v164, v156, 24, v164
    v_add_u32 v169, 4, v46
    v_mul_u32_u24 v156, 37, v169
    v_lshrrev_b32 v156, 10, v156
    v_mad_u32_u24 v169, v156, 24, v169
    v_add_u32 v182, 8, v46
    v_mul_u32_u24 v156, 37, v182
    v_lshrrev_b32 v156, 10, v156
    v_mad_u32_u24 v182, v156, 24, v182
    v_add_u32 v25, 12, v46
    v_mul_u32_u24 v24, 37, v25
    v_lshrrev_b32 v24, 10, v24
    v_mad_u32_u24 v25, v24, 24, v25
    v_add_u32 v170, 16, v46
    v_mul_u32_u24 v24, 37, v170
    v_lshrrev_b32 v24, 10, v24
    v_mad_u32_u24 v170, v24, 24, v170
    v_add_u32 v24, 20, v46
    v_mul_u32_u24 v156, 37, v24
    v_lshrrev_b32 v156, 10, v156
    v_mad_u32_u24 v24, v156, 24, v24
    v_add_u32 v19, 24, v46
    v_mul_u32_u24 v18, 37, v19
    v_lshrrev_b32 v18, 10, v18
    v_mad_u32_u24 v19, v18, 24, v19
    v_add_u32 v179, 28, v46
    v_mul_u32_u24 v18, 37, v179
    v_lshrrev_b32 v18, 10, v18
    v_mad_u32_u24 v179, v18, 24, v179
    v_add_u32 v18, 32, v46
    v_mul_u32_u24 v156, 37, v18
    v_lshrrev_b32 v156, 10, v156
    v_mad_u32_u24 v18, v156, 24, v18
    v_add_u32 v162, 36, v46
    v_mul_u32_u24 v156, 37, v162
    v_lshrrev_b32 v156, 10, v156
    v_mad_u32_u24 v162, v156, 24, v162
    v_add_u32 v156, 40, v46
    v_mul_u32_u24 v160, 37, v156
    v_lshrrev_b32 v160, 10, v160
    v_mad_u32_u24 v156, v160, 24, v156
    v_add_u32 v46, 44, v46
    s_lshr_b32 s93, s68, 1
    s_mul_i32 s93, s93, 30720
    buffer_load_dwordx4 v47, s[32:35], s92 offen offset:2048 lds
    s_add_u32 m0, s90, 24576
    s_mov_b32 s92, 73728
    ds_read_b32 v208, v199
    v_mul_u32_u24 v160, 37, v46
    v_lshrrev_b32 v160, 10, v160
    v_mad_u32_u24 v46, v160, 24, v46
    v_lshl_add_u32 v160, v44, 4, v45
    v_mul_u32_u24 v165, 37, v160
    v_lshrrev_b32 v165, 10, v165
    v_mad_u32_u24 v160, v165, 24, v160
    v_mov_b32 v165, 336
    v_cmp_gt_u32 vcc, 3, v44
    v_sub_u32 v204, v199, v164
    s_and_b32 s94, s68, 1
    v_cndmask_b32 v160, v165, v160, vcc
    v_sub_u32 v160, s101, v160
    s_mul_i32 s94, s94, -2304
    s_add_u32 s93, s93, s94
    ds_read_b32 v204, v204 offset:336
    v_sub_u32 v205, v199, v169
    v_sub_u32 v206, v199, v182
    s_lshl_b32 s94, s97, 4
    buffer_load_dwordx4 v168, s[32:35], s92 offen offset:0 lds
    ds_read_b32 v205, v205 offset:336
    v_sub_u32 v207, v199, v25
    v_sub_u32 v200, v199, v170
    v_sub_u32 v201, v199, v24
    v_sub_u32 v202, v199, v19
    v_sub_u32 v203, v199, v179
    ds_read_b32 v206, v206 offset:336
    buffer_load_dwordx4 v157, s[32:35], s92 offen offset:1024 lds
    v_sub_u32 v196, v199, v18
    v_sub_u32 v197, v199, v162
    v_sub_u32 v198, v199, v156
    v_sub_u32 v199, v199, v46
    ds_read_b32 v207, v207 offset:336
    v_sub_u32 v192, v148, v164
    v_sub_u32 v193, v148, v169
    v_sub_u32 v194, v148, v182
    v_sub_u32 v195, v148, v25
    v_sub_u32 v188, v148, v170
    ds_read_b32 v200, v200 offset:336
    v_sub_u32 v189, v148, v24
    v_sub_u32 v190, v148, v19
    v_sub_u32 v191, v148, v179
    v_sub_u32 v184, v148, v18
    v_sub_u32 v185, v148, v162
    ds_read_b32 v201, v201 offset:336
    buffer_load_dwordx4 v47, s[32:35], s92 offen offset:2048 lds
    s_add_u32 m0, s90, 36864
    s_mov_b32 s92, 110592
    v_sub_u32 v186, v148, v156
    v_sub_u32 v187, v148, v46
    ds_read_b32 v202, v202 offset:336
    v_sub_u32 v180, v5, v164
    v_sub_u32 v181, v5, v169
    v_sub_u32 v182, v5, v182
    v_sub_u32 v183, v5, v25
    v_sub_u32 v176, v5, v170
    s_waitcnt vmcnt(9)
    s_barrier
    ds_read_b32 v203, v203 offset:336
    v_sub_u32 v177, v5, v24
    v_sub_u32 v178, v5, v19
    v_sub_u32 v179, v5, v179
    v_sub_u32 v172, v5, v18
    v_sub_u32 v173, v5, v162
    ds_read_b32 v196, v196 offset:336
    v_sub_u32 v174, v5, v156
    v_sub_u32 v175, v5, v46
    v_mov_b32 v156, 0xf149f2ca
    v_and_b32 v24, 8, v161
    v_add_u32 v24, v24, v161
    ds_read_b32 v197, v197 offset:336
    buffer_load_dwordx4 v168, s[32:35], s92 offen offset:0 lds
    v_mul_u32_u24 v24, 96, v24
    v_add_u32 v24, s90, v24
    v_lshl_add_u32 v25, v44, 4, v24
    v_lshl_add_u32 v24, v44, 3, v24
    ds_read_b32 v198, v198 offset:336
    v_add_u32 v19, s93, v25
    v_add_u32 v18, s93, v24
    v_lshlrev_b32 v162, 4, v44
    v_add_u32 v162, 4608, v162
    s_lshr_b32 s93, s68, 1
    s_mul_i32 s93, s93, 5120
    ds_read_b32 v199, v199 offset:336
    s_add_u32 s93, s93, s94
    v_add_u32 v46, s93, v162
    v_cmp_eq_u32 vcc, 0, v161
    buffer_load_dwordx4 v157, s[32:35], s92 offen offset:1024 lds
    ds_read_b32 v211, v160 offset:672
    v_cndmask_b32 v46, v149, v46, vcc
    ds_read_b32 v192, v192 offset:336
    ds_read_b32 v193, v193 offset:336
    ds_read_b32 v194, v194 offset:336
    buffer_load_dwordx4 v47, s[32:35], s92 offen offset:2048 lds
    s_add_u32 m0, s90, 49152
    s_mov_b32 s92, 147456
    ds_read_b32 v195, v195 offset:336
    ds_read_b32 v188, v188 offset:336
    ds_read_b32 v189, v189 offset:336
    buffer_load_dwordx4 v168, s[32:35], s92 offen offset:0 lds
    ds_read_b32 v190, v190 offset:336
    ds_read_b32 v191, v191 offset:336
    ds_read_b32 v184, v184 offset:336
    buffer_load_dwordx4 v157, s[32:35], s92 offen offset:1024 lds
    ds_read_b32 v185, v185 offset:336
    ds_read_b32 v186, v186 offset:336
    ds_read_b32 v187, v187 offset:336
    ds_read_b32 v209, v148
    buffer_load_dwordx4 v47, s[32:35], s92 offen offset:2048 lds
    s_add_u32 m0, s90, 61440
    s_mov_b32 s92, 184320
    ds_read_b32 v180, v180 offset:336
    ds_read_b32 v181, v181 offset:336
    ds_read_b32 v182, v182 offset:336
    buffer_load_dwordx4 v168, s[32:35], s92 offen offset:0 lds
    ds_read_b32 v183, v183 offset:336
    ds_read_b32 v176, v176 offset:336
    ds_read_b32 v177, v177 offset:336
    buffer_load_dwordx4 v157, s[32:35], s92 offen offset:1024 lds
    ds_read_b32 v178, v178 offset:336
    ds_read_b32 v179, v179 offset:336
    ds_read_b32 v172, v172 offset:336
    ds_read_b32 v173, v173 offset:336
    buffer_load_dwordx4 v47, s[32:35], s92 offen offset:2048 lds
    ds_read_b32 v174, v174 offset:336
    ds_read_b32 v175, v175 offset:336
    ds_read_b32 v210, v5
    s_waitcnt vmcnt(15)
    ds_read_b64_tr_b16 a[0:1], v7 offset:0
    ds_read_b64_tr_b16 a[2:3], v7 offset:768
    ds_read_b64_tr_b16 a[24:25], v7 offset:32
    ds_read_b64_tr_b16 a[26:27], v7 offset:800
    ds_read_b64_tr_b16 a[48:49], v7 offset:64
    ds_read_b64_tr_b16 a[50:51], v7 offset:832
    s_add_u32 m0, s90, 0
    s_mov_b32 s92, 384
    s_waitcnt vmcnt(12)
    ds_read_b64_tr_b16 a[4:5], v7 offset:12288
    ds_read_b64_tr_b16 a[6:7], v7 offset:13056
    ds_read_b64_tr_b16 a[28:29], v7 offset:12320
    ds_read_b64_tr_b16 a[30:31], v7 offset:13088
    ds_read_b64_tr_b16 a[52:53], v7 offset:12352
    ds_read_b64_tr_b16 a[54:55], v7 offset:13120
    s_waitcnt vmcnt(9)
    ds_read_b64_tr_b16 a[8:9], v7 offset:24576
    ds_read_b64_tr_b16 a[10:11], v7 offset:25344
    ds_read_b64_tr_b16 a[32:33], v7 offset:24608
    s_waitcnt lgkmcnt(15)
    s_cmp_ge_u32 s2, 248
    s_cbranch_scc1 L_maskS
L_nomaskS:
    v_cmp_gt_u32 vcc, 16, v4
    v_readlane_b32 s84, v211, 48
    ds_read_b64_tr_b16 a[34:35], v7 offset:25376
    v_cndmask_b32 v208, v156, v208, vcc
    v_cndmask_b32 v209, v156, v209, vcc
    v_cndmask_b32 v210, v156, v210, vcc
    v_cmp_gt_u32 vcc, 49, v4
    ds_read_b64_tr_b16 a[56:57], v7 offset:24640
    s_waitcnt lgkmcnt(10)
    buffer_load_dwordx4 v168, s[32:35], s92 offen offset:0 lds
    ds_read_b64_tr_b16 a[58:59], v7 offset:25408
    v_cndmask_b32 v211, v156, v211, vcc
    s_waitcnt vmcnt(7)
    ds_read_b64_tr_b16 a[12:13], v7 offset:36864
    ds_read_b64_tr_b16 a[14:15], v7 offset:37632
    buffer_load_dwordx4 v157, s[32:35], s92 offen offset:1024 lds
    ds_read_b64_tr_b16 a[36:37], v7 offset:36896
    ds_read_b64_tr_b16 a[38:39], v7 offset:37664
    ds_read_b64_tr_b16 a[60:61], v7 offset:36928
    ds_read_b64_tr_b16 a[62:63], v7 offset:37696
    buffer_load_dwordx4 v47, s[32:35], s92 offen offset:2048 lds
    s_add_u32 m0, s90, 12288
    s_mov_b32 s92, 37248
    ds_read_b128 v[64:67], v147 offset:40960
    ds_read_b128 v[60:63], v146 offset:40960
    s_waitcnt lgkmcnt(10)
    buffer_load_dwordx4 v168, s[32:35], s92 offen offset:0 lds
    ds_read_b128 v[56:59], v147 offset:41088
    ds_read_b128 v[52:55], v146 offset:41088
    buffer_load_dwordx4 v157, s[32:35], s92 offen offset:1024 lds
    ds_read_b128 v[40:43], v147 offset:41216
    ds_read_b128 v[0:3], v146 offset:41216
    buffer_load_dwordx4 v47, s[32:35], s92 offen offset:2048 lds
    s_add_u32 m0, s90, 24576
    s_mov_b32 s92, 74112
    s_waitcnt vmcnt(9)
    ds_read_b64_tr_b16 a[16:17], v7 offset:49152
    ds_read_b64_tr_b16 a[18:19], v7 offset:49920
    ds_read_b64_tr_b16 a[40:41], v7 offset:49184
    ds_read_b64_tr_b16 a[42:43], v7 offset:49952
    ds_read_b64_tr_b16 a[64:65], v7 offset:49216
    ds_read_b64_tr_b16 a[66:67], v7 offset:49984
    s_waitcnt lgkmcnt(6)
    buffer_load_dwordx4 v168, s[32:35], s92 offen offset:0 lds
    buffer_load_dwordx4 v157, s[32:35], s92 offen offset:1024 lds
    buffer_load_dwordx4 v47, s[32:35], s92 offen offset:2048 lds
    s_add_u32 m0, s90, 36864
    s_mov_b32 s92, 110976
    s_waitcnt vmcnt(9)
    ds_read_b64_tr_b16 a[20:21], v7 offset:61440
    ds_read_b64_tr_b16 a[22:23], v7 offset:62208
    v_mfma_f32_16x16x32_bf16 v[72:75], a[0:3], v[64:67], 0
    ds_read_b64_tr_b16 a[44:45], v7 offset:61472
    v_mfma_f32_16x16x32_bf16 v[72:75], a[4:7], v[60:63], v[72:75]
    ds_read_b64_tr_b16 a[46:47], v7 offset:62240
    v_mfma_f32_16x16x32_bf16 v[72:75], a[8:11], v[56:59], v[72:75]
    ds_read_b64_tr_b16 a[68:69], v7 offset:61504
    v_mfma_f32_16x16x32_bf16 v[72:75], a[12:15], v[52:55], v[72:75]
    s_waitcnt lgkmcnt(5)
    ds_read_b64_tr_b16 a[70:71], v7 offset:62272
    v_mfma_f32_16x16x32_bf16 v[72:75], a[16:19], v[40:43], v[72:75]
    ds_read_b128 v[48:51], v147 offset:42496
    ds_read_b128 v[36:39], v146 offset:42496
    ds_read_b128 v[32:35], v147 offset:42624
    ds_read_b128 v[28:31], v146 offset:42624
    s_waitcnt lgkmcnt(7)
    v_mfma_f32_16x16x32_bf16 v[72:75], a[20:23], v[0:3], v[72:75]
    ds_read_b128 v[20:23], v147 offset:42752
    s_nop 0
    v_mfma_f32_16x16x32_bf16 v[92:95], a[24:27], v[64:67], 0
    s_nop 0
    ds_read_b128 v[12:15], v146 offset:42752
    s_nop 0
    v_mfma_f32_16x16x32_bf16 v[92:95], a[28:31], v[60:63], v[92:95]
    s_nop 0
    v_fma_f32 v170, v72, v72, s41
    v_fmac_f32 v170, v73, v73
    v_mfma_f32_16x16x32_bf16 v[92:95], a[32:35], v[56:59], v[92:95]
    v_fmac_f32 v170, v74, v74
    v_fmac_f32 v170, v75, v75
    v_mfma_f32_16x16x32_bf16 v[92:95], a[36:39], v[52:55], v[92:95]
    v_mfma_f32_16x16x32_bf16 v[92:95], a[40:43], v[40:43], v[92:95]
    s_waitcnt lgkmcnt(4)
    buffer_load_dwordx4 v168, s[32:35], s92 offen offset:0 lds
    v_mfma_f32_16x16x32_bf16 v[92:95], a[44:47], v[0:3], v[92:95]
    s_nop 1
    v_mfma_f32_16x16x32_bf16 v[88:91], a[48:51], v[64:67], 0
    s_nop 2
    v_mfma_f32_16x16x32_bf16 v[88:91], a[52:55], v[60:63], v[88:91]
    s_nop 0
    v_fmac_f32 v170, v92, v92
    v_fmac_f32 v170, v93, v93
    v_mfma_f32_16x16x32_bf16 v[88:91], a[56:59], v[56:59], v[88:91]
    v_fmac_f32 v170, v94, v94
    v_fmac_f32 v170, v95, v95
    v_mfma_f32_16x16x32_bf16 v[88:91], a[60:63], v[52:55], v[88:91]
    buffer_load_dwordx4 v157, s[32:35], s92 offen offset:1024 lds
    v_mfma_f32_16x16x32_bf16 v[88:91], a[64:67], v[40:43], v[88:91]
    v_mfma_f32_16x16x32_bf16 v[88:91], a[68:71], v[0:3], v[88:91]
    s_nop 0
    v_mfma_f32_16x16x32_bf16 v[0:3], a[0:3], v[48:51], 0
    s_nop 2
    v_mfma_f32_16x16x32_bf16 v[0:3], a[4:7], v[36:39], v[0:3]
    s_waitcnt lgkmcnt(0)
    s_nop 0
    v_fmac_f32 v170, v88, v88
    v_fmac_f32 v170, v89, v89
    v_mfma_f32_16x16x32_bf16 v[0:3], a[8:11], v[32:35], v[0:3]
    v_fmac_f32 v170, v90, v90
    v_fmac_f32 v170, v91, v91
    v_mfma_f32_16x16x32_bf16 v[0:3], a[12:15], v[28:31], v[0:3]
    s_waitcnt vmcnt(8)
    buffer_load_dwordx4 v47, s[32:35], s92 offen offset:2048 lds
    ds_read_b64_tr_b16 a[72:73], v7 offset:0
    v_mfma_f32_16x16x32_bf16 v[0:3], a[16:19], v[20:23], v[0:3]
    s_add_u32 m0, s90, 49152
    ds_read_b64_tr_b16 a[74:75], v7 offset:768
    v_mfma_f32_16x16x32_bf16 v[0:3], a[20:23], v[12:15], v[0:3]
    s_mov_b32 s92, 147840
    ds_read_b64_tr_b16 a[96:97], v7 offset:32
    v_mfma_f32_16x16x32_bf16 v[60:63], a[24:27], v[48:51], 0
    ds_read_b64_tr_b16 a[98:99], v7 offset:800
    v_mfma_f32_16x16x32_bf16 v[60:63], a[28:31], v[36:39], v[60:63]
    ds_read_b64_tr_b16 a[120:121], v7 offset:64
    buffer_load_dwordx4 v168, s[32:35], s92 offen offset:0 lds
    v_mfma_f32_16x16x32_bf16 v[60:63], a[32:35], v[32:35], v[60:63]
    ds_read_b64_tr_b16 a[122:123], v7 offset:832
    v_fma_f32 v169, v0, v0, s41
    v_mfma_f32_16x16x32_bf16 v[60:63], a[36:39], v[28:31], v[60:63]
    ds_read_b128 v[100:103], v147 offset:40960
    v_fmac_f32 v169, v1, v1
    v_mfma_f32_16x16x32_bf16 v[60:63], a[40:43], v[20:23], v[60:63]
    ds_read_b128 v[68:71], v146 offset:40960
    v_fmac_f32 v169, v2, v2
    v_mfma_f32_16x16x32_bf16 v[60:63], a[44:47], v[12:15], v[60:63]
    ds_read_b128 v[56:59], v147 offset:41088
    v_fmac_f32 v169, v3, v3
    v_mfma_f32_16x16x32_bf16 v[40:43], a[48:51], v[48:51], 0
    ds_read_b128 v[52:55], v146 offset:41088
    buffer_load_dwordx4 v157, s[32:35], s92 offen offset:1024 lds
    v_mfma_f32_16x16x32_bf16 v[40:43], a[52:55], v[36:39], v[40:43]
    s_nop 0
    ds_read_b128 v[48:51], v147 offset:41216
    v_fmac_f32 v169, v60, v60
    v_mfma_f32_16x16x32_bf16 v[40:43], a[56:59], v[32:35], v[40:43]
    ds_read_b128 v[32:35], v146 offset:41216
    v_fmac_f32 v169, v61, v61
    v_mfma_f32_16x16x32_bf16 v[40:43], a[60:63], v[28:31], v[40:43]
    v_fmac_f32 v169, v62, v62
    v_fmac_f32 v169, v63, v63
    v_mfma_f32_16x16x32_bf16 v[40:43], a[64:67], v[20:23], v[40:43]
    v_mfma_f32_16x16x32_bf16 v[40:43], a[68:71], v[12:15], v[40:43]
    s_waitcnt vmcnt(8)
    buffer_load_dwordx4 v47, s[32:35], s92 offen offset:2048 lds
    ds_read_b64_tr_b16 a[76:77], v7 offset:12288
    s_add_u32 m0, s90, 61440
    s_mov_b32 s92, 184704
    ds_read_b64_tr_b16 a[78:79], v7 offset:13056
    s_nop 0
    ds_read_b64_tr_b16 a[100:101], v7 offset:12320
    v_fmac_f32 v169, v40, v40
    ds_read_b64_tr_b16 a[102:103], v7 offset:13088
    v_fmac_f32 v169, v41, v41
    ds_read_b64_tr_b16 a[124:125], v7 offset:12352
    v_fmac_f32 v169, v42, v42
    ds_read_b64_tr_b16 a[126:127], v7 offset:13120
    v_fmac_f32 v169, v43, v43
    buffer_load_dwordx4 v168, s[32:35], s92 offen offset:0 lds
    buffer_load_dwordx4 v157, s[32:35], s92 offen offset:1024 lds
    buffer_load_dwordx4 v47, s[32:35], s92 offen offset:2048 lds
    s_add_u32 m0, s90, 0
    s_mov_b32 s92, 768
    s_waitcnt vmcnt(9)
    ds_read_b64_tr_b16 a[80:81], v7 offset:24576
    ds_read_b64_tr_b16 a[82:83], v7 offset:25344
    ds_read_b64_tr_b16 a[104:105], v7 offset:24608
    ds_read_b64_tr_b16 a[106:107], v7 offset:25376
    ds_read_b64_tr_b16 a[128:129], v7 offset:24640
    ds_read_b64_tr_b16 a[130:131], v7 offset:25408
    s_waitcnt lgkmcnt(6)
    buffer_load_dwordx4 v168, s[32:35], s92 offen offset:0 lds
    buffer_load_dwordx4 v157, s[32:35], s92 offen offset:1024 lds
    buffer_load_dwordx4 v47, s[32:35], s92 offen offset:2048 lds
    s_add_u32 m0, s90, 12288
    s_mov_b32 s92, 37632
    s_waitcnt vmcnt(9)
    ds_read_b64_tr_b16 a[84:85], v7 offset:36864
    ds_read_b64_tr_b16 a[86:87], v7 offset:37632
    ds_read_b64_tr_b16 a[108:109], v7 offset:36896
    ds_read_b64_tr_b16 a[110:111], v7 offset:37664
    ds_read_b64_tr_b16 a[132:133], v7 offset:36928
    ds_read_b64_tr_b16 a[134:135], v7 offset:37696
    buffer_load_dwordx4 v168, s[32:35], s92 offen offset:0 lds
    buffer_load_dwordx4 v157, s[32:35], s92 offen offset:1024 lds
    buffer_load_dwordx4 v47, s[32:35], s92 offen offset:2048 lds
    s_add_u32 m0, s90, 24576
    s_mov_b32 s92, 74496
    s_waitcnt vmcnt(9)
    ds_read_b64_tr_b16 a[88:89], v7 offset:49152
    ds_read_b64_tr_b16 a[90:91], v7 offset:49920
    ds_read_b64_tr_b16 a[112:113], v7 offset:49184
    ds_read_b64_tr_b16 a[114:115], v7 offset:49952
    ds_read_b64_tr_b16 a[136:137], v7 offset:49216
    ds_read_b64_tr_b16 a[138:139], v7 offset:49984
    s_waitcnt lgkmcnt(6)
    buffer_load_dwordx4 v168, s[32:35], s92 offen offset:0 lds
    buffer_load_dwordx4 v157, s[32:35], s92 offen offset:1024 lds
    buffer_load_dwordx4 v47, s[32:35], s92 offen offset:2048 lds
    s_add_u32 m0, s90, 36864
    s_mov_b32 s92, 111360
    s_waitcnt vmcnt(9)
    ds_read_b64_tr_b16 a[92:93], v7 offset:61440
    ds_read_b64_tr_b16 a[94:95], v7 offset:62208
    v_mfma_f32_16x16x32_bf16 v[36:39], a[72:75], v[100:103], 0
    ds_read_b64_tr_b16 a[116:117], v7 offset:61472
    v_mfma_f32_16x16x32_bf16 v[36:39], a[76:79], v[68:71], v[36:39]
    ds_read_b64_tr_b16 a[118:119], v7 offset:62240
    v_mfma_f32_16x16x32_bf16 v[36:39], a[80:83], v[56:59], v[36:39]
    ds_read_b64_tr_b16 a[140:141], v7 offset:61504
    v_mfma_f32_16x16x32_bf16 v[36:39], a[84:87], v[52:55], v[36:39]
    s_waitcnt lgkmcnt(5)
    buffer_load_dwordx4 v168, s[32:35], s92 offen offset:0 lds
    ds_read_b64_tr_b16 a[142:143], v7 offset:62272
    v_mfma_f32_16x16x32_bf16 v[36:39], a[88:91], v[48:51], v[36:39]
    ds_read_b128 v[96:99], v147 offset:42496
    ds_read_b128 v[80:83], v146 offset:42496
    ds_read_b128 v[28:31], v147 offset:42624
    ds_read_b128 v[20:23], v146 offset:42624
    s_waitcnt lgkmcnt(7)
    v_mfma_f32_16x16x32_bf16 v[36:39], a[92:95], v[32:35], v[36:39]
    buffer_load_dwordx4 v157, s[32:35], s92 offen offset:1024 lds
    ds_read_b128 v[64:67], v147 offset:42752
    v_mfma_f32_16x16x32_bf16 v[84:87], a[96:99], v[100:103], 0
    s_nop 1
    ds_read_b128 v[12:15], v146 offset:42752
    v_mfma_f32_16x16x32_bf16 v[84:87], a[100:103], v[68:71], v[84:87]
    s_nop 0
    v_fma_f32 v156, v36, v36, s41
    v_fmac_f32 v156, v37, v37
    v_mfma_f32_16x16x32_bf16 v[84:87], a[104:107], v[56:59], v[84:87]
    v_fmac_f32 v156, v38, v38
    v_fmac_f32 v156, v39, v39
    v_mfma_f32_16x16x32_bf16 v[84:87], a[108:111], v[52:55], v[84:87]
    v_mfma_f32_16x16x32_bf16 v[84:87], a[112:115], v[48:51], v[84:87]
    s_waitcnt vmcnt(8) lgkmcnt(4)
    buffer_load_dwordx4 v47, s[32:35], s92 offen offset:2048 lds
    ds_read_b64_tr_b16 a[144:145], v6 offset:0
    v_mfma_f32_16x16x32_bf16 v[84:87], a[116:119], v[32:35], v[84:87]
    s_add_u32 m0, s90, 49152
    ds_read_b64_tr_b16 a[146:147], v6 offset:768
    v_mfma_f32_16x16x32_bf16 v[76:79], a[120:123], v[100:103], 0
    s_mov_b32 s92, 148224
    s_nop 0
    ds_read_b64_tr_b16 a[168:169], v6 offset:8
    v_mfma_f32_16x16x32_bf16 v[76:79], a[124:127], v[68:71], v[76:79]
    s_nop 0
    v_fmac_f32 v156, v84, v84
    v_fmac_f32 v156, v85, v85
    v_mfma_f32_16x16x32_bf16 v[76:79], a[128:131], v[56:59], v[76:79]
    ds_read_b64_tr_b16 a[170:171], v6 offset:776
    v_fmac_f32 v156, v86, v86
    v_mfma_f32_16x16x32_bf16 v[76:79], a[132:135], v[52:55], v[76:79]
    buffer_load_dwordx4 v168, s[32:35], s92 offen offset:0 lds
    ds_read_b64_tr_b16 a[192:193], v7 offset:64
    v_mfma_f32_16x16x32_bf16 v[76:79], a[136:139], v[48:51], v[76:79]
    ds_read_b64_tr_b16 a[194:195], v7 offset:832
    v_fmac_f32 v156, v87, v87
    v_mfma_f32_16x16x32_bf16 v[76:79], a[140:143], v[32:35], v[76:79]
    s_nop 0
    v_mfma_f32_16x16x32_bf16 v[56:59], a[72:75], v[96:99], 0
    s_nop 2
    v_mfma_f32_16x16x32_bf16 v[56:59], a[76:79], v[80:83], v[56:59]
    s_waitcnt lgkmcnt(5)
    s_nop 0
    v_fmac_f32 v156, v76, v76
    v_fmac_f32 v156, v77, v77
    v_mfma_f32_16x16x32_bf16 v[56:59], a[80:83], v[28:31], v[56:59]
    buffer_load_dwordx4 v157, s[32:35], s92 offen offset:1024 lds
    v_fmac_f32 v156, v78, v78
    v_mfma_f32_16x16x32_bf16 v[56:59], a[84:87], v[20:23], v[56:59]
    v_fmac_f32 v156, v79, v79
    v_cvt_pk_bf16_f32 v170, v170, v156
    v_mfma_f32_16x16x32_bf16 v[56:59], a[88:91], v[64:67], v[56:59]
    v_mfma_f32_16x16x32_bf16 v[56:59], a[92:95], v[12:15], v[56:59]
    ds_read_b128 v[68:71], v147 offset:40960
    v_mfma_f32_16x16x32_bf16 v[52:55], a[96:99], v[96:99], 0
    ds_read_b128 v[32:35], v146 offset:40960
    v_mfma_f32_16x16x32_bf16 v[52:55], a[100:103], v[80:83], v[52:55]
    s_waitcnt vmcnt(8)
    buffer_load_dwordx4 v47, s[32:35], s92 offen offset:2048 lds
    ds_read_b64_tr_b16 a[148:149], v6 offset:12288
    v_mfma_f32_16x16x32_bf16 v[52:55], a[104:107], v[28:31], v[52:55]
    s_add_u32 m0, s90, 61440
    v_fma_f32 v156, v56, v56, s41
    v_fmac_f32 v156, v57, v57
    v_mfma_f32_16x16x32_bf16 v[52:55], a[108:111], v[20:23], v[52:55]
    s_mov_b32 s92, 185088
    ds_read_b64_tr_b16 a[150:151], v6 offset:13056
    v_fmac_f32 v156, v58, v58
    v_mfma_f32_16x16x32_bf16 v[52:55], a[112:115], v[64:67], v[52:55]
    ds_read_b64_tr_b16 a[172:173], v6 offset:12296
    v_fmac_f32 v156, v59, v59
    v_mfma_f32_16x16x32_bf16 v[52:55], a[116:119], v[12:15], v[52:55]
    ds_read_b64_tr_b16 a[174:175], v6 offset:13064
    v_mfma_f32_16x16x32_bf16 v[48:51], a[120:123], v[96:99], 0
    s_nop 0
    buffer_load_dwordx4 v168, s[32:35], s92 offen offset:0 lds
    ds_read_b64_tr_b16 a[196:197], v7 offset:12352
    v_mfma_f32_16x16x32_bf16 v[48:51], a[124:127], v[80:83], v[48:51]
    s_nop 0
    ds_read_b64_tr_b16 a[198:199], v7 offset:13120
    v_fmac_f32 v156, v52, v52
    v_mfma_f32_16x16x32_bf16 v[48:51], a[128:131], v[28:31], v[48:51]
    ds_read_b128 v[28:31], v147 offset:41088
    v_fmac_f32 v156, v53, v53
    v_mfma_f32_16x16x32_bf16 v[48:51], a[132:135], v[20:23], v[48:51]
    ds_read_b128 v[20:23], v146 offset:41088
    v_fmac_f32 v156, v54, v54
    v_mfma_f32_16x16x32_bf16 v[48:51], a[136:139], v[64:67], v[48:51]
    ds_read_b128 v[64:67], v147 offset:41216
    v_fmac_f32 v156, v55, v55
    v_mfma_f32_16x16x32_bf16 v[48:51], a[140:143], v[12:15], v[48:51]
    s_nop 0
    buffer_load_dwordx4 v157, s[32:35], s92 offen offset:1024 lds
    ds_read_b128 v[12:15], v146 offset:41216
    v_mfma_f32_16x16x16_bf16 v[80:83], v[216:217], v[170:171], 0
    s_nop 0
    v_mov_b32 v44, 0
    v_mov_b32 v45, 0
    v_mov_b32 v149, 0
    v_fmac_f32 v156, v48, v48
    v_fmac_f32 v156, v49, v49
    v_fmac_f32 v156, v50, v50
    v_fmac_f32 v156, v51, v51
    v_rsq_f32 v80, v80
    v_rsq_f32 v81, v81
    v_mul_f32 v80, s55, v80
    v_mul_f32 v81, 0.5, v81
    v_mul_f32 v72, v72, v80
    buffer_load_dwordx4 v47, s[32:35], s92 offen offset:2048 lds
    s_add_u32 m0, s90, 0
    s_mov_b32 s92, 0
    s_waitcnt vmcnt(9)
    ds_read_b64_tr_b16 a[152:153], v6 offset:24576
    v_mul_f32 v73, v73, v80
    v_cvt_pk_f16_f32 v72, v72, v73
    v_mul_f32 v74, v74, v80
    ds_read_b64_tr_b16 a[154:155], v6 offset:25344
    v_mul_f32 v75, v75, v80
    v_cvt_pk_f16_f32 v73, v74, v75
    v_mul_f32 v92, v92, v80
    ds_read_b64_tr_b16 a[176:177], v6 offset:24584
    v_mul_f32 v93, v93, v80
    v_cvt_pk_f16_f32 v74, v92, v93
    s_waitcnt lgkmcnt(3)
    buffer_load_dwordx4 v158, s[76:79], s92 offen offset:0 lds
    ds_read_b64_tr_b16 a[178:179], v6 offset:25352
    v_mul_f32 v94, v94, v80
    v_mul_f32 v95, v95, v80
    v_cvt_pk_f16_f32 v75, v94, v95
    ds_read_b64_tr_b16 a[200:201], v7 offset:24640
    v_mul_f32 v88, v88, v80
    ds_read_b64_tr_b16 a[202:203], v7 offset:25408
    v_mul_f32 v89, v89, v80
    v_cvt_pk_f16_f32 v160, v88, v89
    v_mul_f32 v90, v90, v80
    v_mul_f32 v91, v91, v80
    v_cvt_pk_f16_f32 v161, v90, v91
    v_mul_f32 v36, v36, v81
    buffer_load_dwordx4 v17, s[76:79], s92 offen offset:1024 lds
    v_mul_f32 v37, v37, v81
    v_cvt_pk_f16_f32 v36, v36, v37
    v_mul_f32 v38, v38, v81
    v_mul_f32 v39, v39, v81
    v_cvt_pk_f16_f32 v37, v38, v39
    v_mul_f32 v84, v84, v81
    v_mul_f32 v85, v85, v81
    v_cvt_pk_f16_f32 v38, v84, v85
    v_mul_f32 v86, v86, v81
    v_mul_f32 v87, v87, v81
    v_cvt_pk_f16_f32 v39, v86, v87
    v_mul_f32 v76, v76, v81
    v_mul_f32 v77, v77, v81
    v_cvt_pk_f16_f32 v4, v76, v77
    v_mul_f32 v78, v78, v81
    v_mul_f32 v79, v79, v81
    v_cvt_pk_f16_f32 v5, v78, v79
    buffer_load_dwordx4 v16, s[76:79], s92 offen offset:2048 lds
    s_add_u32 m0, s90, 12288
    s_mov_b32 s92, 12288
    s_waitcnt vmcnt(9)
    ds_read_b64_tr_b16 a[156:157], v6 offset:36864
    v_fma_mix_f32 v148, v72, v36, 0 op_sel:[0,0,0] op_sel_hi:[1,1,0]
    v_fma_mix_f32 v148, v72, v36, v148 op_sel:[1,1,0] op_sel_hi:[1,1,0]
    v_fma_mix_f32 v148, v73, v37, v148 op_sel:[0,0,0] op_sel_hi:[1,1,0]
    ds_read_b64_tr_b16 a[158:159], v6 offset:37632
    v_fma_mix_f32 v148, v73, v37, v148 op_sel:[1,1,0] op_sel_hi:[1,1,0]
    v_fma_mix_f32 v148, v74, v38, v148 op_sel:[0,0,0] op_sel_hi:[1,1,0]
    v_fma_mix_f32 v148, v74, v38, v148 op_sel:[1,1,0] op_sel_hi:[1,1,0]
    ds_read_b64_tr_b16 a[180:181], v6 offset:36872
    v_fma_mix_f32 v148, v75, v39, v148 op_sel:[0,0,0] op_sel_hi:[1,1,0]
    v_fma_mix_f32 v148, v75, v39, v148 op_sel:[1,1,0] op_sel_hi:[1,1,0]
    buffer_load_dwordx4 v158, s[76:79], s92 offen offset:0 lds
    ds_read_b64_tr_b16 a[182:183], v6 offset:37640
    v_fma_mix_f32 v148, v160, v4, v148 op_sel:[0,0,0] op_sel_hi:[1,1,0]
    v_fma_mix_f32 v148, v160, v4, v148 op_sel:[1,1,0] op_sel_hi:[1,1,0]
    v_fma_mix_f32 v148, v161, v5, v148 op_sel:[0,0,0] op_sel_hi:[1,1,0]
    ds_read_b64_tr_b16 a[204:205], v7 offset:36928
    v_fma_mix_f32 v148, v161, v5, v148 op_sel:[1,1,0] op_sel_hi:[1,1,0]
    ds_read_b64_tr_b16 a[206:207], v7 offset:37696
    v_mov_b32 v47, v148
    v_add_u32 v168, 28672, v124
    ds_write_b128 v168, v[36:39]
    buffer_load_dwordx4 v17, s[76:79], s92 offen offset:1024 lds
    v_permlane32_swap_b32 v47, v148
    v_add_f32 v148, v47, v148
    v_mov_b32 v47, v148
    v_cvt_pk_bf16_f32 v170, v169, v156
    s_nop 0
    v_permlane16_swap_b32 v47, v148
    v_mfma_f32_16x16x16_bf16 v[36:39], v[216:217], v[170:171], 0
    s_waitcnt vmcnt(8)
    ds_write2_b64 v168, v[44:45], v[44:45] offset0:2 offset1:3
    v_add_f32 v148, v47, v148
    buffer_load_dwordx4 v16, s[76:79], s92 offen offset:2048 lds
    s_add_u32 m0, s90, 24576
    s_mov_b32 s92, 24576
    v_and_b32 v47, 0xffff0000, v148
    v_sub_f32 v148, v148, v47
    ds_read_b64_tr_b16 a[160:161], v6 offset:49152
    v_cvt_pk_bf16_f32 v148, v148, v47
    v_rsq_f32 v36, v36
    ds_read_b64_tr_b16 a[162:163], v6 offset:49920
    v_rsq_f32 v37, v37
    v_mul_f32 v36, s55, v36
    s_waitcnt lgkmcnt(3)
    buffer_load_dwordx4 v158, s[76:79], s92 offen offset:0 lds
    ds_read_b64_tr_b16 a[184:185], v6 offset:49160
    v_mul_f32 v37, 0.5, v37
    v_mul_f32 v0, v0, v36
    v_mul_f32 v1, v1, v36
    ds_read_b64_tr_b16 a[186:187], v6 offset:49928
    v_cvt_pk_f16_f32 v0, v0, v1
    v_mul_f32 v2, v2, v36
    v_mul_f32 v3, v3, v36
    ds_read_b64_tr_b16 a[208:209], v7 offset:49216
    v_cvt_pk_f16_f32 v1, v2, v3
    ds_read_b64_tr_b16 a[210:211], v7 offset:49984
    v_mul_f32 v60, v60, v36
    buffer_load_dwordx4 v17, s[76:79], s92 offen offset:1024 lds
    ds_write_b128 v168, v[72:75] offset:32
    v_mul_f32 v61, v61, v36
    v_cvt_pk_f16_f32 v2, v60, v61
    v_mul_f32 v62, v62, v36
    v_mul_f32 v63, v63, v36
    v_cvt_pk_f16_f32 v3, v62, v63
    v_mul_f32 v40, v40, v36
    v_mul_f32 v41, v41, v36
    v_cvt_pk_f16_f32 v156, v40, v41
    ds_write2_b64 v168, v[4:5], v[44:45] offset0:6 offset1:7
    buffer_load_dwordx4 v16, s[76:79], s92 offen offset:2048 lds
    s_add_u32 m0, s90, 36864
    s_mov_b32 s92, 36864
    v_mul_f32 v42, v42, v36
    v_mul_f32 v43, v43, v36
    v_cvt_pk_f16_f32 v157, v42, v43
    v_mul_f32 v56, v56, v37
    v_mul_f32 v57, v57, v37
    s_waitcnt vmcnt(9)
    ds_read_b64_tr_b16 a[164:165], v6 offset:61440
    v_cvt_pk_f16_f32 v4, v56, v57
    v_mul_f32 v58, v58, v37
    v_mul_f32 v59, v59, v37
    ds_read_b64_tr_b16 a[166:167], v6 offset:62208
    v_mfma_f32_16x16x32_bf16 v[40:43], a[144:147], v[68:71], 0
    buffer_load_dwordx4 v158, s[76:79], s92 offen offset:0 lds
    ds_read_b64_tr_b16 a[188:189], v6 offset:61448
    v_mfma_f32_16x16x32_bf16 v[40:43], a[148:151], v[32:35], v[40:43]
    v_cvt_pk_f16_f32 v5, v58, v59
    v_mul_f32 v52, v52, v37
    v_mfma_f32_16x16x32_bf16 v[40:43], a[152:155], v[28:31], v[40:43]
    ds_read_b64_tr_b16 a[190:191], v6 offset:62216
    v_mul_f32 v53, v53, v37
    v_mfma_f32_16x16x32_bf16 v[40:43], a[156:159], v[20:23], v[40:43]
    s_waitcnt lgkmcnt(4)
    ds_read_b64_tr_b16 a[212:213], v7 offset:61504
    v_cvt_pk_f16_f32 v6, v52, v53
    v_mfma_f32_16x16x32_bf16 v[40:43], a[160:163], v[64:67], v[40:43]
    ds_read_b64_tr_b16 a[214:215], v7 offset:62272
    v_mul_f32 v54, v54, v37
    v_mul_f32 v55, v55, v37
    v_cvt_pk_f16_f32 v7, v54, v55
    buffer_load_dwordx4 v17, s[76:79], s92 offen offset:1024 lds
    ds_write2_b64 v168, v[44:45], v[160:161] offset0:8 offset1:9
    v_mul_f32 v48, v48, v37
    v_mul_f32 v49, v49, v37
    v_cvt_pk_f16_f32 v160, v48, v49
    v_mul_f32 v50, v50, v37
    s_waitcnt lgkmcnt(5)
    v_mfma_f32_16x16x32_bf16 v[40:43], a[164:167], v[12:15], v[40:43]
    v_mul_f32 v51, v51, v37
    v_cvt_pk_f16_f32 v161, v50, v51
    v_mfma_f32_16x16x32_bf16 v[56:59], a[168:171], v[68:71], 0
    buffer_load_dwordx4 v16, s[76:79], s92 offen offset:2048 lds
    ds_read_b128 v[52:55], v147 offset:42496
    v_mfma_f32_16x16x32_bf16 v[56:59], a[172:175], v[32:35], v[56:59]
    s_add_u32 m0, s90, 49152
    v_fma_mix_f32 v230, v0, v4, 0 op_sel:[0,0,0] op_sel_hi:[1,1,0]
    v_fma_mix_f32 v230, v0, v4, v230 op_sel:[1,1,0] op_sel_hi:[1,1,0]
    v_mfma_f32_16x16x32_bf16 v[56:59], a[176:179], v[28:31], v[56:59]
    s_mov_b32 s92, 49152
    ds_write_b64 v168, v[148:149] offset:88
    v_mfma_f32_16x16x32_bf16 v[56:59], a[180:183], v[20:23], v[56:59]
    s_lshl_b32 s93, s68, 10
    v_fma_mix_f32 v230, v1, v5, v230 op_sel:[0,0,0] op_sel_hi:[1,1,0]
    v_fma_mix_f32 v230, v1, v5, v230 op_sel:[1,1,0] op_sel_hi:[1,1,0]
    v_mfma_f32_16x16x32_bf16 v[56:59], a[184:187], v[64:67], v[56:59]
    s_waitcnt lgkmcnt(3)
    s_mov_b32 s53, s47
    ds_read_b128 v[48:51], v146 offset:42496
    v_fma_mix_f32 v230, v2, v6, v230 op_sel:[0,0,0] op_sel_hi:[1,1,0]
    v_mfma_f32_16x16x32_bf16 v[56:59], a[188:191], v[12:15], v[56:59]
    s_mov_b32 s47, s46
    buffer_load_dwordx4 v158, s[76:79], s92 offen offset:0 lds
    ds_read_b128 v[36:39], v147 offset:42624
    v_mfma_f32_16x16x32_bf16 v[60:63], a[192:195], v[68:71], 0
    s_mov_b32 s46, s45
    v_fma_mix_f32 v230, v2, v6, v230 op_sel:[1,1,0] op_sel_hi:[1,1,0]
    v_fma_mix_f32 v230, v3, v7, v230 op_sel:[0,0,0] op_sel_hi:[1,1,0]
    v_mfma_f32_16x16x32_bf16 v[60:63], a[196:199], v[32:35], v[60:63]
    s_mov_b32 s45, s44
    ds_read_b128 v[32:35], v146 offset:42624
    v_fma_mix_f32 v230, v3, v7, v230 op_sel:[1,1,0] op_sel_hi:[1,1,0]
    v_mfma_f32_16x16x32_bf16 v[60:63], a[200:203], v[28:31], v[60:63]
    s_mov_b32 s44, s53
    ds_read_b128 v[28:31], v147 offset:42752
    v_fma_mix_f32 v230, v156, v160, v230 op_sel:[0,0,0] op_sel_hi:[1,1,0]
    v_mfma_f32_16x16x32_bf16 v[60:63], a[204:207], v[20:23], v[60:63]
    s_sub_u32 s48, s44, s46
    ds_read_b128 v[20:23], v146 offset:42752
    v_fma_mix_f32 v230, v156, v160, v230 op_sel:[1,1,0] op_sel_hi:[1,1,0]
    v_mfma_f32_16x16x32_bf16 v[60:63], a[208:211], v[64:67], v[60:63]
    s_sub_u32 s49, s46, s45
    buffer_load_dwordx4 v17, s[76:79], s92 offen offset:1024 lds
    v_fma_mix_f32 v230, v157, v161, v230 op_sel:[0,0,0] op_sel_hi:[1,1,0]
    v_mfma_f32_16x16x32_bf16 v[60:63], a[212:215], v[12:15], v[60:63]
    s_waitcnt lgkmcnt(5)
    v_fma_mix_f32 v230, v157, v161, v230 op_sel:[1,1,0] op_sel_hi:[1,1,0]
    v_mov_b32 v146, v230
    v_mfma_f32_16x16x32_bf16 v[12:15], a[144:147], v[52:55], 0
    s_waitcnt lgkmcnt(4)
    v_permlane32_swap_b32 v146, v230
    v_add_f32 v230, v146, v230
    v_mfma_f32_16x16x32_bf16 v[12:15], a[148:151], v[48:51], v[12:15]
    s_waitcnt lgkmcnt(3)
    v_mov_b32 v146, v230
    v_cvt_pk_bf16_f32 v148, v40, v41
    v_cvt_pk_bf16_f32 v149, v42, v43
    v_mfma_f32_16x16x32_bf16 v[12:15], a[152:155], v[36:39], v[12:15]
    s_waitcnt lgkmcnt(2)
    ds_write_b64 v124, v[148:149] offset:28752
    buffer_load_dwordx4 v16, s[76:79], s92 offen offset:2048 lds
    s_add_u32 m0, s90, 61440
    v_mfma_f32_16x16x32_bf16 v[12:15], a[156:159], v[32:35], v[12:15]
    s_waitcnt lgkmcnt(2)
    s_mov_b32 s92, 61440
    v_permlane16_swap_b32 v146, v230
    v_mfma_f32_16x16x32_bf16 v[12:15], a[160:163], v[28:31], v[12:15]
    s_waitcnt lgkmcnt(1)
    v_add_f32 v230, v146, v230
    v_and_b32 v146, 0xffff0000, v230
    v_mfma_f32_16x16x32_bf16 v[12:15], a[164:167], v[20:23], v[12:15]
    v_sub_f32 v230, v230, v146
    v_cvt_pk_bf16_f32 v230, v230, v146
    v_mfma_f32_16x16x32_bf16 v[40:43], a[168:171], v[52:55], 0
    v_cvt_pk_bf16_f32 v56, v56, v57
    v_cvt_pk_bf16_f32 v57, v58, v59
    v_mfma_f32_16x16x32_bf16 v[40:43], a[172:175], v[48:51], v[40:43]
    buffer_load_dwordx4 v158, s[76:79], s92 offen offset:0 lds
    v_cvt_pk_bf16_f32 v58, v60, v61
    v_mfma_f32_16x16x32_bf16 v[40:43], a[176:179], v[36:39], v[40:43]
    v_cvt_pk_bf16_f32 v59, v62, v63
    v_cvt_pk_bf16_f32 v246, v12, v13
    v_mfma_f32_16x16x32_bf16 v[40:43], a[180:183], v[32:35], v[40:43]
    ds_write_b128 v124, v[56:59] offset:28768
    v_mfma_f32_16x16x32_bf16 v[40:43], a[184:187], v[28:31], v[40:43]
    v_cvt_pk_bf16_f32 v247, v14, v15
    v_add_u32 v158, s93, v163
    v_mfma_f32_16x16x32_bf16 v[40:43], a[188:191], v[20:23], v[40:43]
    buffer_load_dwordx4 v17, s[76:79], s92 offen offset:1024 lds
    v_add_u32 v137, s48, v137
    v_mfma_f32_16x16x32_bf16 v[12:15], a[192:195], v[52:55], 0
    s_nop 0
    v_add_u32 v136, s48, v136
    s_nop 0
    v_mfma_f32_16x16x32_bf16 v[12:15], a[196:199], v[48:51], v[12:15]
    s_nop 0
    v_cvt_pk_bf16_f32 v76, v40, v41
    v_cvt_pk_bf16_f32 v77, v42, v43
    v_mfma_f32_16x16x32_bf16 v[12:15], a[200:203], v[36:39], v[12:15]
    v_mfma_f32_16x16x32_bf16 v[12:15], a[204:207], v[32:35], v[12:15]
    v_mfma_f32_16x16x32_bf16 v[12:15], a[208:211], v[28:31], v[12:15]
    buffer_load_dwordx4 v16, s[76:79], s92 offen offset:2048 lds
    v_mfma_f32_16x16x32_bf16 v[12:15], a[212:215], v[20:23], v[12:15]
    s_add_u32 m0, s54, 20480
    s_nop 6
    v_cvt_pk_bf16_f32 v78, v12, v13
    v_cvt_pk_bf16_f32 v79, v14, v15
    buffer_load_dwordx4 v130, s[24:27], s56 offen nt lds
    s_add_u32 m0, s54, 21504
    s_nop 0
    buffer_load_dwordx4 v129, s[24:27], s56 offen nt lds
    s_add_u32 m0, s54, 22528
    s_nop 0
    buffer_load_dwordx4 v128, s[24:27], s56 offen nt lds
    s_add_u32 m0, s54, 23552
    s_nop 0
    buffer_load_dwordx4 v127, s[24:27], s56 offen nt lds
    s_add_u32 m0, s54, 24576
    s_nop 0
    buffer_load_dwordx4 v126, s[24:27], s56 offen nt lds
    s_waitcnt vmcnt(5)
    s_barrier
    ds_read_b128 v[32:35], v19 offset:0
    ds_read_b64 v[40:41], v18 offset:64
    ds_read_b128 v[12:15], v19 offset:3072
    ds_read_b64 v[42:43], v18 offset:3136
    ds_read_b128 v[48:51], v19 offset:6144
    ds_read_b64 v[28:29], v18 offset:6208
    ds_read_b128 v[20:23], v19 offset:9216
    ds_read_b64 v[30:31], v18 offset:9280
    ds_read_b128 v[36:39], v19 offset:12288
    ds_read_b64 v[52:53], v18 offset:12352
    ds_read_b128 v[64:67], v19 offset:15360
    ds_read_b64 v[54:55], v18 offset:15424
    s_waitcnt lgkmcnt(11)
    v_mfma_f32_16x16x32_bf16 v[60:63], v[32:35], v[220:223], 0
    s_waitcnt lgkmcnt(9)
    ds_read_b128 v[32:35], v19 offset:18432
    v_mfma_f32_16x16x32_bf16 v[60:63], v[12:15], v[220:223], v[60:63]
    s_waitcnt lgkmcnt(8)
    ds_read_b64 v[12:13], v18 offset:18496
    ds_read_b128 v[56:59], v19 offset:21504
    v_mfma_f32_16x16x32_bf16 v[60:63], v[48:51], v[220:223], v[60:63]
    s_waitcnt lgkmcnt(8)
    ds_read_b64 v[14:15], v18 offset:21568
    ds_read_b128 v[48:51], v19 offset:24576
    v_mfma_f32_16x16x32_bf16 v[60:63], v[20:23], v[220:223], v[60:63]
    ds_read_b64 v[20:21], v18 offset:24640
    v_mfma_f32_16x16x32_bf16 v[60:63], v[40:43], v[220:223], v[60:63]
    s_waitcnt lgkmcnt(9)
    ds_read_b128 v[40:43], v19 offset:27648
    v_mfma_f32_16x16x32_bf16 v[60:63], v[28:31], v[220:223], v[60:63]
    ds_read_b64 v[22:23], v18 offset:27712
    v_mfma_f32_16x16x32_bf16 v[28:31], v[36:39], v[220:223], 0
    s_waitcnt lgkmcnt(8)
    ds_read_b128 v[36:39], v19 offset:30720
    v_mfma_f32_16x16x32_bf16 v[28:31], v[64:67], v[220:223], v[28:31]
    s_waitcnt lgkmcnt(8)
    s_nop 0
    ds_read_b64 v[16:17], v18 offset:30784
    v_mul_f32 v60, 0xbbaaaaab, v60
    v_mfma_f32_16x16x32_bf16 v[28:31], v[32:35], v[220:223], v[28:31]
    s_waitcnt lgkmcnt(7)
    ds_read_b128 v[32:35], v19 offset:33792
    v_mul_f32 v61, 0xbbaaaaab, v61
    v_mul_f32 v62, 0xbbaaaaab, v62
    v_mul_f32 v63, 0xbbaaaaab, v63
    v_mfma_f32_16x16x32_bf16 v[28:31], v[56:59], v[220:223], v[28:31]
    ds_write_b128 v46, v[60:63] offset:0
    v_mfma_f32_16x16x32_bf16 v[28:31], v[52:55], v[220:223], v[28:31]
    s_waitcnt lgkmcnt(6)
    v_mfma_f32_16x16x32_bf16 v[28:31], v[12:15], v[220:223], v[28:31]
    v_mfma_f32_16x16x32_bf16 v[12:15], v[48:51], v[220:223], 0
    s_waitcnt lgkmcnt(4)
    ds_read_b64 v[18:19], v18 offset:33856
    s_nop 0
    v_mfma_f32_16x16x32_bf16 v[12:15], v[40:43], v[220:223], v[12:15]
    s_waitcnt lgkmcnt(4)
    s_nop 0
    ds_read_b128 v[40:43], v25 offset:0
    v_mul_f32 v28, 0xbbaaaaab, v28
    v_mfma_f32_16x16x32_bf16 v[12:15], v[36:39], v[220:223], v[12:15]
    s_waitcnt lgkmcnt(3)
    ds_read_b64 v[44:45], v24 offset:64
    v_mul_f32 v29, 0xbbaaaaab, v29
    v_mul_f32 v30, 0xbbaaaaab, v30
    v_mul_f32 v31, 0xbbaaaaab, v31
    v_mfma_f32_16x16x32_bf16 v[12:15], v[32:35], v[220:223], v[12:15]
    ds_write_b128 v46, v[28:31] offset:128
    v_mfma_f32_16x16x32_bf16 v[12:15], v[20:23], v[220:223], v[12:15]
    ds_read_b128 v[62:65], v25 offset:768
    ds_read_b64 v[66:67], v24 offset:832
    ds_read_b128 v[56:59], v25 offset:12288
    s_waitcnt lgkmcnt(6)
    v_mfma_f32_16x16x32_bf16 v[12:15], v[16:19], v[220:223], v[12:15]
    s_nop 0
    ds_read_b64 v[60:61], v24 offset:12352
    s_nop 0
    ds_read_b128 v[102:105], v25 offset:13056
    s_nop 2
    ds_read_b64 v[106:107], v24 offset:13120
    v_mul_f32 v12, 0xbbaaaaab, v12
    v_mul_f32 v13, 0xbbaaaaab, v13
    v_mul_f32 v14, 0xbbaaaaab, v14
    v_mul_f32 v15, 0xbbaaaaab, v15
    ds_write_b128 v46, v[12:15] offset:256
    s_waitcnt lgkmcnt(0)
    s_barrier
    ds_read_b128 v[12:15], v162 offset:0
    ds_read_b128 v[28:31], v162 offset:64
    ds_read_b128 v[36:39], v162 offset:128
    ds_read_b128 v[16:19], v162 offset:192
    s_waitcnt lgkmcnt(3)
    v_mfma_f32_16x16x16_bf16 v[32:35], v[40:41], v[26:27], v[12:15]
    v_mfma_f32_16x16x16_bf16 v[20:23], v[42:43], v[26:27], v[12:15]
    s_nop 2
    v_mfma_f32_16x16x16_bf16 v[52:55], v[44:45], v[26:27], v[12:15]
    s_waitcnt lgkmcnt(0)
    s_nop 0
    ds_read_b128 v[96:99], v25 offset:24576
    v_cvt_pk_bf16_f32 v32, v32, v33
    v_mfma_f32_16x16x16_bf16 v[12:15], v[62:63], v[26:27], v[28:31]
    ds_read_b64 v[100:101], v24 offset:24640
    v_accvgpr_write_b32 a216, v32
    v_mfma_f32_16x16x16_bf16 v[48:51], v[64:65], v[26:27], v[28:31]
    ds_read_b128 v[40:43], v162 offset:256
    v_cvt_pk_bf16_f32 v34, v34, v35
    v_mfma_f32_16x16x16_bf16 v[44:47], v[66:67], v[26:27], v[28:31]
    ds_read_b128 v[90:93], v25 offset:25344
    v_accvgpr_write_b32 a217, v34
    v_mfma_f32_16x16x16_bf16 v[80:83], v[56:57], v[26:27], v[36:39]
    ds_read_b64 v[94:95], v24 offset:25408
    v_cvt_pk_bf16_f32 v20, v20, v21
    v_mfma_f32_16x16x16_bf16 v[32:35], v[58:59], v[26:27], v[36:39]
    ds_read_b128 v[68:71], v162 offset:320
    v_accvgpr_write_b32 a240, v20
    v_mfma_f32_16x16x16_bf16 v[28:31], v[60:61], v[26:27], v[36:39]
    ds_read_b128 v[84:87], v25 offset:36864
    v_cvt_pk_bf16_f32 v22, v22, v23
    v_mfma_f32_16x16x16_bf16 v[60:63], v[102:103], v[26:27], v[16:19]
    ds_read_b64 v[88:89], v24 offset:36928
    v_accvgpr_write_b32 a241, v22
    v_mfma_f32_16x16x16_bf16 v[36:39], v[104:105], v[26:27], v[16:19]
    ds_read_b128 v[64:67], v162 offset:5120
    v_cvt_pk_bf16_f32 v232, v52, v53
    v_mfma_f32_16x16x16_bf16 v[20:23], v[106:107], v[26:27], v[16:19]
    s_waitcnt lgkmcnt(6)
    ds_read_b128 v[116:119], v25 offset:37632
    v_cvt_pk_bf16_f32 v233, v54, v55
    v_cvt_pk_bf16_f32 v12, v12, v13
    v_accvgpr_write_b32 a218, v12
    v_cvt_pk_bf16_f32 v14, v14, v15
    v_accvgpr_write_b32 a219, v14
    v_cvt_pk_bf16_f32 v48, v48, v49
    v_mfma_f32_16x16x16_bf16 v[56:59], v[96:97], v[26:27], v[40:43]
    ds_read_b64 v[120:121], v24 offset:37696
    v_accvgpr_write_b32 a242, v48
    v_mfma_f32_16x16x16_bf16 v[16:19], v[98:99], v[26:27], v[40:43]
    ds_read_b128 v[52:55], v162 offset:5184
    v_cvt_pk_bf16_f32 v50, v50, v51
    v_mfma_f32_16x16x16_bf16 v[12:15], v[100:101], v[26:27], v[40:43]
    s_waitcnt lgkmcnt(6)
    ds_read_b128 v[110:113], v25 offset:49152
    v_accvgpr_write_b32 a243, v50
    v_cvt_pk_bf16_f32 v234, v44, v45
    v_cvt_pk_bf16_f32 v235, v46, v47
    v_mfma_f32_16x16x16_bf16 v[72:75], v[90:91], v[26:27], v[68:71]
    ds_read_b64 v[114:115], v24 offset:49216
    v_cvt_pk_bf16_f32 v80, v80, v81
    v_mfma_f32_16x16x16_bf16 v[44:47], v[92:93], v[26:27], v[68:71]
    ds_read_b128 v[48:51], v162 offset:5248
    v_accvgpr_write_b32 a220, v80
    v_mfma_f32_16x16x16_bf16 v[40:43], v[94:95], v[26:27], v[68:71]
    s_waitcnt lgkmcnt(6)
    ds_read_b128 v[104:107], v25 offset:49920
    v_cvt_pk_bf16_f32 v82, v82, v83
    v_accvgpr_write_b32 a221, v82
    v_cvt_pk_bf16_f32 v32, v32, v33
    v_accvgpr_write_b32 a244, v32
    v_cvt_pk_bf16_f32 v34, v34, v35
    v_accvgpr_write_b32 a245, v34
    v_cvt_pk_bf16_f32 v236, v28, v29
    v_cvt_pk_bf16_f32 v237, v30, v31
    v_mfma_f32_16x16x16_bf16 v[100:103], v[84:85], v[26:27], v[64:67]
    ds_read_b64 v[108:109], v24 offset:49984
    v_cvt_pk_bf16_f32 v60, v60, v61
    v_mfma_f32_16x16x16_bf16 v[32:35], v[86:87], v[26:27], v[64:67]
    ds_read_b128 v[84:87], v162 offset:5312
    v_accvgpr_write_b32 a222, v60
    v_mfma_f32_16x16x16_bf16 v[28:31], v[88:89], v[26:27], v[64:67]
    s_waitcnt lgkmcnt(5)
    ds_read_b128 v[92:95], v25 offset:61440
    v_cvt_pk_bf16_f32 v62, v62, v63
    v_accvgpr_write_b32 a223, v62
    v_cvt_pk_bf16_f32 v36, v36, v37
    v_accvgpr_write_b32 a246, v36
    v_cvt_pk_bf16_f32 v38, v38, v39
    v_accvgpr_write_b32 a247, v38
    v_cvt_pk_bf16_f32 v238, v20, v21
    v_cvt_pk_bf16_f32 v239, v22, v23
    v_mfma_f32_16x16x16_bf16 v[36:39], v[116:117], v[26:27], v[52:55]
    ds_read_b64 v[96:97], v24 offset:61504
    v_cvt_pk_bf16_f32 v56, v56, v57
    v_mfma_f32_16x16x16_bf16 v[68:71], v[118:119], v[26:27], v[52:55]
    ds_read_b128 v[80:83], v162 offset:5376
    v_accvgpr_write_b32 a224, v56
    v_mfma_f32_16x16x16_bf16 v[64:67], v[120:121], v[26:27], v[52:55]
    s_waitcnt lgkmcnt(5)
    ds_read_b128 v[20:23], v25 offset:62208
    v_cvt_pk_bf16_f32 v58, v58, v59
    v_accvgpr_write_b32 a225, v58
    v_cvt_pk_bf16_f32 v16, v16, v17
    v_accvgpr_write_b32 a248, v16
    v_cvt_pk_bf16_f32 v18, v18, v19
    v_accvgpr_write_b32 a249, v18
    v_cvt_pk_bf16_f32 v240, v12, v13
    v_cvt_pk_bf16_f32 v241, v14, v15
    v_mfma_f32_16x16x16_bf16 v[60:63], v[110:111], v[26:27], v[48:51]
    ds_read_b64 v[24:25], v24 offset:62272
    v_cvt_pk_bf16_f32 v72, v72, v73
    v_mfma_f32_16x16x16_bf16 v[52:55], v[112:113], v[26:27], v[48:51]
    ds_read_b128 v[16:19], v162 offset:5440
    v_accvgpr_write_b32 a226, v72
    v_mfma_f32_16x16x16_bf16 v[56:59], v[114:115], v[26:27], v[48:51]
    s_waitcnt lgkmcnt(5)
    ds_read_b128 v[12:15], v137 offset:0
    v_cvt_pk_bf16_f32 v74, v74, v75
    v_accvgpr_write_b32 a227, v74
    v_cvt_pk_bf16_f32 v44, v44, v45
    v_accvgpr_write_b32 a250, v44
    v_cvt_pk_bf16_f32 v46, v46, v47
    v_accvgpr_write_b32 a251, v46
    v_cvt_pk_bf16_f32 v242, v40, v41
    v_cvt_pk_bf16_f32 v243, v42, v43
    v_mfma_f32_16x16x16_bf16 v[48:51], v[104:105], v[26:27], v[84:87]
    ds_read_b128 v[146:149], v136 offset:0
    v_cvt_pk_bf16_f32 v100, v100, v101
    v_mfma_f32_16x16x16_bf16 v[44:47], v[106:107], v[26:27], v[84:87]
    ds_read_b128 v[72:75], v137 offset:128
    v_accvgpr_write_b32 a228, v100
    v_mfma_f32_16x16x16_bf16 v[40:43], v[108:109], v[26:27], v[84:87]
    s_waitcnt lgkmcnt(5)
    ds_read_b128 v[88:91], v136 offset:128
    v_cvt_pk_bf16_f32 v102, v102, v103
    v_accvgpr_write_b32 a229, v102
    v_cvt_pk_bf16_f32 v32, v32, v33
    v_accvgpr_write_b32 a252, v32
    v_cvt_pk_bf16_f32 v34, v34, v35
    v_accvgpr_write_b32 a253, v34
    v_cvt_pk_bf16_f32 v244, v28, v29
    v_cvt_pk_bf16_f32 v245, v30, v31
    v_mfma_f32_16x16x16_bf16 v[32:35], v[92:93], v[26:27], v[80:83]
    s_waitcnt vmcnt(0) lgkmcnt(4)
    s_barrier
    ds_write_b128 v158, v[8:11] offset:6144
    v_mfma_f32_16x16x16_bf16 v[28:31], v[94:95], v[26:27], v[80:83]
    v_cvt_pk_bf16_f32 v36, v36, v37
    v_accvgpr_write_b32 a230, v36
    v_mfma_f32_16x16x16_bf16 v[8:11], v[96:97], v[26:27], v[80:83]
    s_waitcnt lgkmcnt(4)
    v_cvt_pk_bf16_f32 v38, v38, v39
    v_accvgpr_write_b32 a231, v38
    v_cvt_pk_bf16_f32 v68, v68, v69
    v_mfma_f32_16x16x32_bf16 v[36:39], a[0:3], v[12:15], 0
    s_waitcnt lgkmcnt(3)
    ds_write_b64 v124, v[246:247] offset:80
    v_mfma_f32_16x16x32_bf16 v[36:39], a[4:7], v[146:149], v[36:39]
    s_waitcnt lgkmcnt(3)
    v_accvgpr_write_b32 a254, v68
    v_cvt_pk_bf16_f32 v70, v70, v71
    v_mfma_f32_16x16x32_bf16 v[36:39], a[8:11], v[72:75], v[36:39]
    s_waitcnt lgkmcnt(2)
    ds_write_b128 v124, v[76:79] offset:96
    v_mfma_f32_16x16x32_bf16 v[36:39], a[12:15], v[88:91], v[36:39]
    v_accvgpr_write_b32 a255, v70
    v_cvt_pk_bf16_f32 v246, v64, v65
    v_cvt_pk_bf16_f32 v247, v66, v67
    v_cvt_pk_bf16_f32 v60, v60, v61
    v_accvgpr_write_b32 a232, v60
    v_cvt_pk_bf16_f32 v62, v62, v63
    v_accvgpr_write_b32 a233, v62
    v_cvt_pk_bf16_f32 v224, v52, v53
    v_cvt_pk_bf16_f32 v225, v54, v55
    v_cvt_pk_bf16_f32 v248, v56, v57
    v_cvt_pk_bf16_f32 v249, v58, v59
    v_cvt_pk_bf16_f32 v48, v48, v49
    v_accvgpr_write_b32 a234, v48
    v_cvt_pk_bf16_f32 v50, v50, v51
    v_accvgpr_write_b32 a235, v50
    v_cvt_pk_bf16_f32 v226, v44, v45
    v_cvt_pk_bf16_f32 v227, v46, v47
    v_cvt_pk_bf16_f32 v250, v40, v41
    v_cvt_pk_bf16_f32 v251, v42, v43
    v_cvt_pk_bf16_f32 v32, v32, v33
    v_accvgpr_write_b32 a236, v32
    v_cvt_pk_bf16_f32 v34, v34, v35
    v_accvgpr_write_b32 a237, v34
    v_cvt_pk_bf16_f32 v228, v28, v29
    v_cvt_pk_bf16_f32 v229, v30, v31
    v_cvt_pk_bf16_f32 v252, v8, v9
    v_cvt_pk_bf16_f32 v253, v10, v11
    v_mov_b32 v254, 0
    v_mov_b32 v255, 0
    v_mov_b32 v231, 0
    v_add_u32 v124, 0, v124
    ds_write_b128 v124, v[4:7]
    v_add_u32 v135, s49, v135
    v_add_u32 v134, s49, v134
    ds_write2_b64 v124, v[254:255], v[254:255] offset0:2 offset1:3
    ds_write_b128 v124, v[0:3] offset:32
    ds_write2_b64 v124, v[160:161], v[254:255] offset0:6 offset1:7
    ds_write2_b64 v124, v[254:255], v[156:157] offset0:8 offset1:9
    ds_write_b64 v124, v[230:231] offset:88
    ds_read_b128 v[76:79], v137 offset:256
    ds_read_b128 v[56:59], v136 offset:256
    s_waitcnt lgkmcnt(1)
    v_mfma_f32_16x16x32_bf16 v[36:39], a[16:19], v[76:79], v[36:39]
    s_waitcnt lgkmcnt(0)
    v_mfma_f32_16x16x32_bf16 v[36:39], a[20:23], v[56:59], v[36:39]
    s_nop 0
    v_mfma_f32_16x16x16_bf16 v[8:11], v[20:21], v[26:27], v[16:19]
    s_nop 3
    v_mfma_f32_16x16x16_bf16 v[4:7], v[22:23], v[26:27], v[16:19]
    s_nop 0
    v_fma_f32 v124, v36, v36, s41
    v_fmac_f32 v124, v37, v37
    v_mfma_f32_16x16x16_bf16 v[0:3], v[24:25], v[26:27], v[16:19]
    v_cvt_pk_bf16_f32 v8, v8, v9
    v_accvgpr_write_b32 a238, v8
    v_cvt_pk_bf16_f32 v10, v10, v11
    v_mfma_f32_16x16x32_bf16 v[48:51], a[24:27], v[12:15], 0
    v_accvgpr_write_b32 a239, v10
    v_cvt_pk_bf16_f32 v230, v4, v5
    v_mfma_f32_16x16x32_bf16 v[48:51], a[28:31], v[146:149], v[48:51]
    v_cvt_pk_bf16_f32 v231, v6, v7
    v_cvt_pk_bf16_f32 v254, v0, v1
    v_mfma_f32_16x16x32_bf16 v[48:51], a[32:35], v[72:75], v[48:51]
    v_cvt_pk_bf16_f32 v255, v2, v3
    v_fmac_f32 v124, v38, v38
    v_mfma_f32_16x16x32_bf16 v[48:51], a[36:39], v[88:91], v[48:51]
    v_fmac_f32 v124, v39, v39
    v_mfma_f32_16x16x32_bf16 v[48:51], a[40:43], v[76:79], v[48:51]
    v_mfma_f32_16x16x32_bf16 v[48:51], a[44:47], v[56:59], v[48:51]
    s_nop 1
    v_mfma_f32_16x16x32_bf16 v[40:43], a[48:51], v[12:15], 0
    s_nop 2
    v_mfma_f32_16x16x32_bf16 v[40:43], a[52:55], v[146:149], v[40:43]
    s_nop 0
    v_fmac_f32 v124, v48, v48
    v_fmac_f32 v124, v49, v49
    v_mfma_f32_16x16x32_bf16 v[40:43], a[56:59], v[72:75], v[40:43]
    v_fmac_f32 v124, v50, v50
    v_fmac_f32 v124, v51, v51
    v_mfma_f32_16x16x32_bf16 v[40:43], a[60:63], v[88:91], v[40:43]
    v_mfma_f32_16x16x32_bf16 v[40:43], a[64:67], v[76:79], v[40:43]
    v_mfma_f32_16x16x32_bf16 v[40:43], a[68:71], v[56:59], v[40:43]
    s_nop 1
    v_mfma_f32_16x16x32_bf16 v[28:31], a[72:75], v[12:15], 0
    s_nop 2
    v_mfma_f32_16x16x32_bf16 v[28:31], a[76:79], v[146:149], v[28:31]
    s_nop 0
    v_fmac_f32 v124, v40, v40
    v_fmac_f32 v124, v41, v41
    v_mfma_f32_16x16x32_bf16 v[28:31], a[80:83], v[72:75], v[28:31]
    v_fmac_f32 v124, v42, v42
    v_fmac_f32 v124, v43, v43
    v_mfma_f32_16x16x32_bf16 v[28:31], a[84:87], v[88:91], v[28:31]
    v_mfma_f32_16x16x32_bf16 v[28:31], a[88:91], v[76:79], v[28:31]
    v_mfma_f32_16x16x32_bf16 v[28:31], a[92:95], v[56:59], v[28:31]
    s_nop 1
    v_mfma_f32_16x16x32_bf16 v[32:35], a[96:99], v[12:15], 0
    s_nop 2
    v_mfma_f32_16x16x32_bf16 v[32:35], a[100:103], v[146:149], v[32:35]
    s_nop 0
    v_fma_f32 v156, v28, v28, s41
    v_fmac_f32 v156, v29, v29
    v_mfma_f32_16x16x32_bf16 v[32:35], a[104:107], v[72:75], v[32:35]
    v_fmac_f32 v156, v30, v30
    v_fmac_f32 v156, v31, v31
    v_mfma_f32_16x16x32_bf16 v[32:35], a[108:111], v[88:91], v[32:35]
    v_mfma_f32_16x16x32_bf16 v[32:35], a[112:115], v[76:79], v[32:35]
    v_mfma_f32_16x16x32_bf16 v[32:35], a[116:119], v[56:59], v[32:35]
    s_nop 1
    v_mfma_f32_16x16x32_bf16 v[20:23], a[120:123], v[12:15], 0
    s_nop 2
    v_mfma_f32_16x16x32_bf16 v[20:23], a[124:127], v[146:149], v[20:23]
    s_nop 0
    v_fmac_f32 v156, v32, v32
    v_fmac_f32 v156, v33, v33
    v_mfma_f32_16x16x32_bf16 v[20:23], a[128:131], v[72:75], v[20:23]
    v_fmac_f32 v156, v34, v34
    v_fmac_f32 v156, v35, v35
    v_mfma_f32_16x16x32_bf16 v[20:23], a[132:135], v[88:91], v[20:23]
    v_mfma_f32_16x16x32_bf16 v[20:23], a[136:139], v[76:79], v[20:23]
    v_mfma_f32_16x16x32_bf16 v[20:23], a[140:143], v[56:59], v[20:23]
    s_nop 1
    v_mfma_f32_16x16x32_bf16 v[4:7], v[12:15], a[144:147], 0
    s_nop 2
    v_mfma_f32_16x16x32_bf16 v[4:7], v[146:149], a[148:151], v[4:7]
    s_nop 0
    v_fmac_f32 v156, v20, v20
    v_fmac_f32 v156, v21, v21
    v_mfma_f32_16x16x32_bf16 v[4:7], v[72:75], a[152:155], v[4:7]
    v_fmac_f32 v156, v22, v22
    v_fmac_f32 v156, v23, v23
    v_mfma_f32_16x16x32_bf16 v[4:7], v[88:91], a[156:159], v[4:7]
    v_cvt_pk_bf16_f32 v170, v124, v156
    v_mfma_f32_16x16x32_bf16 v[4:7], v[76:79], a[160:163], v[4:7]
    ds_read_b128 v[108:111], v137 offset:1536
    v_mfma_f32_16x16x32_bf16 v[4:7], v[56:59], a[164:167], v[4:7]
    s_nop 0
    ds_read_b128 v[104:107], v136 offset:1536
    s_nop 0
    v_mfma_f32_16x16x16_bf16 v[24:27], v[216:217], v[170:171], 0
    s_nop 0
    ds_read_b128 v[44:47], v137 offset:1664
    s_nop 1
    v_cvt_pk_bf16_f32 v16, v4, v5
    v_mfma_f32_16x16x32_bf16 v[0:3], v[12:15], a[168:171], 0
    ds_read_b128 v[100:103], v136 offset:1664
    v_cvt_pk_bf16_f32 v17, v6, v7
    v_mfma_f32_16x16x32_bf16 v[0:3], v[146:149], a[172:175], v[0:3]
    ds_read_b128 v[68:71], v137 offset:1792
    v_mfma_f32_16x16x32_bf16 v[0:3], v[72:75], a[176:179], v[0:3]
    ds_read_b128 v[64:67], v136 offset:1792
    v_mfma_f32_16x16x32_bf16 v[0:3], v[88:91], a[180:183], v[0:3]
    v_rsq_f32 v24, v24
    v_mfma_f32_16x16x32_bf16 v[0:3], v[76:79], a[184:187], v[0:3]
    v_rsq_f32 v25, v25
    v_mfma_f32_16x16x32_bf16 v[0:3], v[56:59], a[188:191], v[0:3]
    v_mul_f32 v24, s55, v24
    v_mul_f32 v25, 0.5, v25
    v_mfma_f32_16x16x32_bf16 v[8:11], v[12:15], a[192:195], 0
    s_nop 0
    v_mul_f32 v36, v36, v24
    v_mul_f32 v37, v37, v24
    v_mfma_f32_16x16x32_bf16 v[8:11], v[146:149], a[196:199], v[8:11]
    s_nop 0
    v_cvt_pk_bf16_f32 v0, v0, v1
    v_cvt_pk_bf16_f32 v1, v2, v3
    v_mfma_f32_16x16x32_bf16 v[8:11], v[72:75], a[200:203], v[8:11]
    v_cvt_pk_f16_f32 v4, v36, v37
    v_mul_f32 v38, v38, v24
    v_mfma_f32_16x16x32_bf16 v[8:11], v[88:91], a[204:207], v[8:11]
    v_mul_f32 v39, v39, v24
    v_cvt_pk_f16_f32 v5, v38, v39
    v_mfma_f32_16x16x32_bf16 v[8:11], v[76:79], a[208:211], v[8:11]
    v_mul_f32 v48, v48, v24
    v_mul_f32 v49, v49, v24
    v_mfma_f32_16x16x32_bf16 v[8:11], v[56:59], a[212:215], v[8:11]
    s_waitcnt lgkmcnt(0)
    v_cvt_pk_f16_f32 v6, v48, v49
    v_mul_f32 v50, v50, v24
    v_mfma_f32_16x16x32_bf16 v[12:15], a[0:3], v[108:111], 0
    v_mul_f32 v51, v51, v24
    v_cvt_pk_f16_f32 v7, v50, v51
    v_mfma_f32_16x16x32_bf16 v[12:15], a[4:7], v[104:107], v[12:15]
    v_mul_f32 v40, v40, v24
    v_mul_f32 v41, v41, v24
    v_mfma_f32_16x16x32_bf16 v[12:15], a[8:11], v[44:47], v[12:15]
    v_cvt_pk_f16_f32 v152, v40, v41
    v_mul_f32 v42, v42, v24
    v_mfma_f32_16x16x32_bf16 v[12:15], a[12:15], v[100:103], v[12:15]
    v_mul_f32 v43, v43, v24
    v_cvt_pk_f16_f32 v153, v42, v43
    v_mfma_f32_16x16x32_bf16 v[12:15], a[16:19], v[68:71], v[12:15]
    v_mul_f32 v28, v28, v25
    v_mul_f32 v29, v29, v25
    v_mfma_f32_16x16x32_bf16 v[12:15], a[20:23], v[64:67], v[12:15]
    v_cvt_pk_f16_f32 v28, v28, v29
    v_mul_f32 v30, v30, v25
    v_mfma_f32_16x16x32_bf16 v[60:63], a[24:27], v[108:111], 0
    v_mul_f32 v31, v31, v25
    v_cvt_pk_f16_f32 v29, v30, v31
    v_mfma_f32_16x16x32_bf16 v[60:63], a[28:31], v[104:107], v[60:63]
    v_mul_f32 v32, v32, v25
    v_mul_f32 v33, v33, v25
    v_mfma_f32_16x16x32_bf16 v[60:63], a[32:35], v[44:47], v[60:63]
    v_cvt_pk_f16_f32 v30, v32, v33
    v_mul_f32 v34, v34, v25
    v_mfma_f32_16x16x32_bf16 v[60:63], a[36:39], v[100:103], v[60:63]
    v_mul_f32 v35, v35, v25
    v_cvt_pk_f16_f32 v31, v34, v35
    v_mfma_f32_16x16x32_bf16 v[60:63], a[40:43], v[68:71], v[60:63]
    v_mul_f32 v20, v20, v25
    v_mul_f32 v21, v21, v25
    v_mfma_f32_16x16x32_bf16 v[60:63], a[44:47], v[64:67], v[60:63]
    v_cvt_pk_f16_f32 v154, v20, v21
    v_mul_f32 v22, v22, v25
    v_mfma_f32_16x16x32_bf16 v[36:39], a[48:51], v[108:111], 0
    v_mul_f32 v23, v23, v25
    v_cvt_pk_f16_f32 v155, v22, v23
    v_mfma_f32_16x16x32_bf16 v[36:39], a[52:55], v[104:107], v[36:39]
    v_cvt_pk_bf16_f32 v20, v8, v9
    v_cvt_pk_bf16_f32 v21, v10, v11
    v_mfma_f32_16x16x32_bf16 v[36:39], a[56:59], v[44:47], v[36:39]
    v_fma_f32 v124, v12, v12, s41
    v_fmac_f32 v124, v13, v13
    v_mfma_f32_16x16x32_bf16 v[36:39], a[60:63], v[100:103], v[36:39]
    v_fmac_f32 v124, v14, v14
    v_fmac_f32 v124, v15, v15
    v_mfma_f32_16x16x32_bf16 v[36:39], a[64:67], v[68:71], v[36:39]
    v_fmac_f32 v124, v60, v60
    v_fmac_f32 v124, v61, v61
    v_mfma_f32_16x16x32_bf16 v[36:39], a[68:71], v[64:67], v[36:39]
    v_fmac_f32 v124, v62, v62
    v_fmac_f32 v124, v63, v63
    v_mfma_f32_16x16x32_bf16 v[52:55], a[72:75], v[108:111], 0
    s_nop 2
    v_mfma_f32_16x16x32_bf16 v[52:55], a[76:79], v[104:107], v[52:55]
    s_nop 0
    v_fmac_f32 v124, v36, v36
    v_fmac_f32 v124, v37, v37
    v_mfma_f32_16x16x32_bf16 v[52:55], a[80:83], v[44:47], v[52:55]
    v_fmac_f32 v124, v38, v38
    v_fmac_f32 v124, v39, v39
    v_mfma_f32_16x16x32_bf16 v[52:55], a[84:87], v[100:103], v[52:55]
    v_mfma_f32_16x16x32_bf16 v[52:55], a[88:91], v[68:71], v[52:55]
    v_mfma_f32_16x16x32_bf16 v[52:55], a[92:95], v[64:67], v[52:55]
    s_nop 1
    v_mfma_f32_16x16x32_bf16 v[8:11], a[96:99], v[108:111], 0
    s_nop 2
    v_mfma_f32_16x16x32_bf16 v[8:11], a[100:103], v[104:107], v[8:11]
    s_nop 0
    v_fma_f32 v2, v52, v52, s41
    v_fmac_f32 v2, v53, v53
    v_mfma_f32_16x16x32_bf16 v[8:11], a[104:107], v[44:47], v[8:11]
    v_fmac_f32 v2, v54, v54
    v_fmac_f32 v2, v55, v55
    v_mfma_f32_16x16x32_bf16 v[8:11], a[108:111], v[100:103], v[8:11]
    v_mfma_f32_16x16x32_bf16 v[8:11], a[112:115], v[68:71], v[8:11]
    v_mfma_f32_16x16x32_bf16 v[8:11], a[116:119], v[64:67], v[8:11]
    s_sub_u32 s50, s45, s44
    v_add_u32 v135, s48, v135
    v_add_u32 v134, s48, v134
    v_mfma_f32_16x16x32_bf16 v[48:51], a[120:123], v[108:111], 0
    s_sub_u32 s51, s46, s47
    v_add_u32 v133, s51, v133
    v_mfma_f32_16x16x32_bf16 v[48:51], a[124:127], v[104:107], v[48:51]
    s_mov_b32 s60, s59
    v_fmac_f32 v2, v8, v8
    v_fmac_f32 v2, v9, v9
    v_mfma_f32_16x16x32_bf16 v[48:51], a[128:131], v[44:47], v[48:51]
    s_mov_b32 s59, s58
    v_fmac_f32 v2, v10, v10
    v_fmac_f32 v2, v11, v11
    v_mfma_f32_16x16x32_bf16 v[48:51], a[132:135], v[100:103], v[48:51]
    s_mov_b32 s58, s57
    v_mfma_f32_16x16x32_bf16 v[48:51], a[136:139], v[68:71], v[48:51]
    s_mov_b32 s57, s56
    v_mfma_f32_16x16x32_bf16 v[48:51], a[140:143], v[64:67], v[48:51]
    s_mov_b32 s7, s6
    s_nop 0
    v_mfma_f32_16x16x32_bf16 v[24:27], v[108:111], a[144:147], 0
    s_mov_b32 s6, s5
    s_nop 1
    v_mfma_f32_16x16x32_bf16 v[24:27], v[104:107], a[148:151], v[24:27]
    s_mov_b32 s5, s4
    v_fmac_f32 v2, v48, v48
    v_fmac_f32 v2, v49, v49
    v_mfma_f32_16x16x32_bf16 v[24:27], v[44:47], a[152:155], v[24:27]
    s_sub_u32 s14, s6, s7
    v_fmac_f32 v2, v50, v50
    v_fmac_f32 v2, v51, v51
    v_mfma_f32_16x16x32_bf16 v[24:27], v[100:103], a[156:159], v[24:27]
    s_add_u32 s61, s61, 1
    v_cvt_pk_bf16_f32 v170, v124, v2
    v_add_u32 v132, s14, v132
    v_mfma_f32_16x16x32_bf16 v[24:27], v[68:71], a[160:163], v[24:27]
    s_ff1_i32_b32 s15, s66
    ds_read_b128 v[96:99], v137 offset:3072
    v_add_u32 v131, s14, v131
    v_mfma_f32_16x16x32_bf16 v[24:27], v[64:67], a[164:167], v[24:27]
    s_cmp_lg_u32 s66, 0
    ds_read_b128 v[92:95], v136 offset:3072
    v_add_u32 v125, s14, v125
    v_mfma_f32_16x16x16_bf16 v[40:43], v[216:217], v[170:171], 0
    s_cselect_b32 s12, s15, s12
    ds_read_b128 v[84:87], v137 offset:3200
    s_nop 1
    v_cvt_pk_bf16_f32 v18, v24, v25
    v_mfma_f32_16x16x32_bf16 v[72:75], v[108:111], a[168:171], 0
    s_cmp_lt_u32 s61, s71
    ds_read_b128 v[80:83], v136 offset:3200
    v_cvt_pk_bf16_f32 v19, v26, v27
    v_mfma_f32_16x16x32_bf16 v[72:75], v[104:107], a[172:175], v[72:75]
    s_cselect_b32 s15, 31, s15
    ds_read_b128 v[56:59], v137 offset:3328
    v_add_u32 v137, s50, v137
    v_mfma_f32_16x16x32_bf16 v[72:75], v[44:47], a[176:179], v[72:75]
    s_bitset0_b32 s66, s15
    ds_read_b128 v[24:27], v136 offset:3328
    v_add_u32 v136, s50, v136
    v_mfma_f32_16x16x32_bf16 v[72:75], v[100:103], a[180:183], v[72:75]
    s_add_u32 s12, s12, 20
    v_rsq_f32 v40, v40
    v_mfma_f32_16x16x32_bf16 v[72:75], v[68:71], a[184:187], v[72:75]
    s_max_u32 s12, s12, s61
    v_rsq_f32 v41, v41
    v_mfma_f32_16x16x32_bf16 v[72:75], v[64:67], a[188:191], v[72:75]
    s_cmp_lt_u32 s61, s71
    v_mul_f32 v40, s55, v40
    v_mul_f32 v41, 0.5, v41
    v_mfma_f32_16x16x32_bf16 v[32:35], v[108:111], a[192:195], 0
    s_cselect_b32 s15, s61, s12
    v_mul_f32 v12, v12, v40
    v_mul_f32 v13, v13, v40
    v_mfma_f32_16x16x32_bf16 v[32:35], v[104:107], a[196:199], v[32:35]
    s_cselect_b32 s56, s69, s70
    v_cvt_pk_bf16_f32 v2, v72, v73
    v_cvt_pk_bf16_f32 v3, v74, v75
    v_mfma_f32_16x16x32_bf16 v[32:35], v[44:47], a[200:203], v[32:35]
    s_add_u32 s56, s56, s15
    v_cvt_pk_f16_f32 v44, v12, v13
    v_mul_f32 v14, v14, v40
    v_mfma_f32_16x16x32_bf16 v[32:35], v[100:103], a[204:207], v[32:35]
    s_mul_i32 s53, s56, 58255
    v_mul_f32 v15, v15, v40
    v_cvt_pk_f16_f32 v45, v14, v15
    v_mfma_f32_16x16x32_bf16 v[32:35], v[68:71], a[208:211], v[32:35]
    s_waitcnt lgkmcnt(0)
    s_lshr_b32 s53, s53, 22
    v_mul_f32 v60, v60, v40
    v_mul_f32 v61, v61, v40
    v_mfma_f32_16x16x32_bf16 v[32:35], v[64:67], a[212:215], v[32:35]
    s_barrier
    v_cvt_pk_f16_f32 v46, v60, v61
    v_mul_f32 v62, v62, v40
    v_mfma_f32_16x16x32_bf16 v[12:15], a[0:3], v[96:99], 0
    s_mul_i32 s53, s53, s63
    v_mul_f32 v63, v63, v40
    v_cvt_pk_f16_f32 v47, v62, v63
    v_mfma_f32_16x16x32_bf16 v[12:15], a[4:7], v[92:95], v[12:15]
    s_mul_i32 s56, s56, s62
    v_mul_f32 v36, v36, v40
    v_mul_f32 v37, v37, v40
    v_mfma_f32_16x16x32_bf16 v[12:15], a[8:11], v[84:87], v[12:15]
    s_add_u32 s56, s56, s53
    v_cvt_pk_f16_f32 v146, v36, v37
    v_mul_f32 v38, v38, v40
    v_mfma_f32_16x16x32_bf16 v[12:15], a[12:15], v[80:83], v[12:15]
    s_mul_i32 s4, s15, 112
    v_mul_f32 v39, v39, v40
    v_cvt_pk_f16_f32 v147, v38, v39
    v_mfma_f32_16x16x32_bf16 v[12:15], a[16:19], v[56:59], v[12:15]
    s_cmp_ge_u32 s15, 16
    v_mul_f32 v52, v52, v41
    v_mul_f32 v53, v53, v41
    v_mfma_f32_16x16x32_bf16 v[12:15], a[20:23], v[24:27], v[12:15]
    s_cselect_b32 s53, -30464, 0
    v_cvt_pk_f16_f32 v72, v52, v53
    v_mul_f32 v54, v54, v41
    v_mfma_f32_16x16x32_bf16 v[36:39], a[24:27], v[96:99], 0
    s_add_u32 s4, s4, s53
    v_mul_f32 v55, v55, v41
    v_cvt_pk_f16_f32 v73, v54, v55
    v_mfma_f32_16x16x32_bf16 v[36:39], a[28:31], v[92:95], v[36:39]
    s_cmp_lt_u32 s15, s73
    v_mul_f32 v8, v8, v41
    v_mul_f32 v9, v9, v41
    v_mfma_f32_16x16x32_bf16 v[36:39], a[32:35], v[84:87], v[36:39]
    s_cselect_b32 s26, 100270464, 0
    v_cvt_pk_f16_f32 v74, v8, v9
    v_mul_f32 v10, v10, v41
    v_mfma_f32_16x16x32_bf16 v[36:39], a[36:39], v[80:83], v[36:39]
    s_cselect_b32 s56, s56, 0
    v_mul_f32 v11, v11, v41
    v_cvt_pk_f16_f32 v75, v10, v11
    v_mfma_f32_16x16x32_bf16 v[36:39], a[40:43], v[56:59], v[36:39]
    s_cselect_b32 s4, s4, -1
    v_mul_f32 v48, v48, v41
    v_mul_f32 v49, v49, v41
    v_mfma_f32_16x16x32_bf16 v[36:39], a[44:47], v[24:27], v[36:39]
    s_cselect_b32 s15, s15, 0
    v_cvt_pk_f16_f32 v148, v48, v49
    v_mul_f32 v50, v50, v41
    v_mfma_f32_16x16x32_bf16 v[8:11], a[48:51], v[96:99], 0
    s_cselect_b32 s13, s13, -1
    v_mul_f32 v51, v51, v41
    v_cvt_pk_f16_f32 v149, v50, v51
    v_mfma_f32_16x16x32_bf16 v[8:11], a[52:55], v[92:95], v[8:11]
    s_bitset1_b32 s64, s15
    v_cvt_pk_bf16_f32 v22, v32, v33
    v_cvt_pk_bf16_f32 v23, v34, v35
    v_mfma_f32_16x16x32_bf16 v[8:11], a[56:59], v[84:87], v[8:11]
    s_add_u32 s65, s65, 1
    v_fma_f32 v156, v12, v12, s41
    v_fmac_f32 v156, v13, v13
    v_mfma_f32_16x16x32_bf16 v[8:11], a[60:63], v[80:83], v[8:11]
    s_cmp_ge_i32 s65, 2
    v_fmac_f32 v156, v14, v14
    v_fmac_f32 v156, v15, v15
    v_mfma_f32_16x16x32_bf16 v[8:11], a[64:67], v[56:59], v[8:11]
    s_cselect_b32 s30, 100270464, 0
    v_fmac_f32 v156, v36, v36
    v_fmac_f32 v156, v37, v37
    v_mfma_f32_16x16x32_bf16 v[8:11], a[68:71], v[24:27], v[8:11]
    s_add_u32 s67, s46, s54
    v_fmac_f32 v156, v38, v38
    v_fmac_f32 v156, v39, v39
    v_mfma_f32_16x16x32_bf16 v[64:67], a[72:75], v[96:99], 0
    s_add_u32 m0, s67, 0
    v_and_b32 v124, -8, v125
    v_mfma_f32_16x16x32_bf16 v[64:67], a[76:79], v[92:95], v[64:67]
    buffer_load_dwordx4 v130, s[24:27], s56 offen nt lds
    v_fmac_f32 v156, v8, v8
    v_mfma_f32_16x16x32_bf16 v[64:67], a[80:83], v[84:87], v[64:67]
    s_add_u32 m0, s67, 1024
    v_fmac_f32 v156, v9, v9
    v_fmac_f32 v156, v10, v10
    v_mfma_f32_16x16x32_bf16 v[64:67], a[84:87], v[80:83], v[64:67]
    v_fmac_f32 v156, v11, v11
    v_mfma_f32_16x16x32_bf16 v[64:67], a[88:91], v[56:59], v[64:67]
    v_mfma_f32_16x16x32_bf16 v[64:67], a[92:95], v[24:27], v[64:67]
    s_nop 1
    v_mfma_f32_16x16x32_bf16 v[32:35], a[96:99], v[96:99], 0
    s_nop 0
    buffer_load_dwordx4 v129, s[24:27], s56 offen nt lds
    s_nop 0
    v_mfma_f32_16x16x32_bf16 v[32:35], a[100:103], v[92:95], v[32:35]
    s_add_u32 m0, s67, 2048
    v_fma_f32 v157, v64, v64, s41
    v_fmac_f32 v157, v65, v65
    v_mfma_f32_16x16x32_bf16 v[32:35], a[104:107], v[84:87], v[32:35]
    v_fmac_f32 v157, v66, v66
    v_fmac_f32 v157, v67, v67
    v_mfma_f32_16x16x32_bf16 v[32:35], a[108:111], v[80:83], v[32:35]
    v_mfma_f32_16x16x32_bf16 v[32:35], a[112:115], v[56:59], v[32:35]
    v_mfma_f32_16x16x32_bf16 v[32:35], a[116:119], v[24:27], v[32:35]
    buffer_load_dwordx4 v128, s[24:27], s56 offen nt lds
    s_nop 0
    v_mfma_f32_16x16x32_bf16 v[40:43], a[120:123], v[96:99], 0
    s_add_u32 m0, s67, 3072
    s_nop 1
    v_mfma_f32_16x16x32_bf16 v[40:43], a[124:127], v[92:95], v[40:43]
    s_mov_b32 s53, s47
    v_fmac_f32 v157, v32, v32
    v_fmac_f32 v157, v33, v33
    v_mfma_f32_16x16x32_bf16 v[40:43], a[128:131], v[84:87], v[40:43]
    s_mov_b32 s47, s46
    v_fmac_f32 v157, v34, v34
    v_fmac_f32 v157, v35, v35
    v_mfma_f32_16x16x32_bf16 v[40:43], a[132:135], v[80:83], v[40:43]
    s_mov_b32 s46, s45
    v_mfma_f32_16x16x32_bf16 v[40:43], a[136:139], v[56:59], v[40:43]
    s_mov_b32 s45, s44
    buffer_load_dwordx4 v127, s[24:27], s56 offen nt lds
    v_mfma_f32_16x16x32_bf16 v[40:43], a[140:143], v[24:27], v[40:43]
    s_add_u32 m0, s67, 4096
    s_nop 0
    v_mfma_f32_16x16x32_bf16 v[68:71], v[96:99], a[144:147], 0
    s_mov_b32 s44, s53
    s_nop 1
    v_mfma_f32_16x16x32_bf16 v[68:71], v[92:95], a[148:151], v[68:71]
    s_sub_u32 s48, s44, s46
    v_fmac_f32 v157, v40, v40
    v_fmac_f32 v157, v41, v41
    v_mfma_f32_16x16x32_bf16 v[68:71], v[84:87], a[152:155], v[68:71]
    s_sub_u32 s49, s46, s45
    v_fmac_f32 v157, v42, v42
    v_fmac_f32 v157, v43, v43
    v_mfma_f32_16x16x32_bf16 v[68:71], v[80:83], a[156:159], v[68:71]
    buffer_load_dwordx4 v126, s[24:27], s56 offen nt lds
    v_cvt_pk_bf16_f32 v170, v156, v157
    v_mfma_f32_16x16x32_bf16 v[68:71], v[56:59], a[160:163], v[68:71]
    ds_read_b128 v[60:63], v132 offset:0
    v_add_u32 v137, s48, v137
    v_mfma_f32_16x16x32_bf16 v[68:71], v[24:27], a[164:167], v[68:71]
    s_nop 0
    ds_read_b128 v[52:55], v132 offset:16
    v_add_u32 v136, s48, v136
    v_mfma_f32_16x16x16_bf16 v[76:79], v[216:217], v[170:171], 0
    s_nop 0
    ds_read_b128 v[48:51], v132 offset:48
    s_nop 1
    v_cvt_pk_bf16_f32 v164, v68, v69
    v_mfma_f32_16x16x32_bf16 v[88:91], v[96:99], a[168:171], 0
    v_cvt_pk_bf16_f32 v165, v70, v71
    v_mfma_f32_16x16x32_bf16 v[88:91], v[92:95], a[172:175], v[88:91]
    v_rsq_f32 v76, v76
    v_mfma_f32_16x16x32_bf16 v[88:91], v[84:87], a[176:179], v[88:91]
    v_rsq_f32 v77, v77
    v_mfma_f32_16x16x32_bf16 v[88:91], v[80:83], a[180:183], v[88:91]
    v_mul_f32 v76, s55, v76
    v_mul_f32 v77, 0.5, v77
    v_mfma_f32_16x16x32_bf16 v[88:91], v[56:59], a[184:187], v[88:91]
    v_mul_f32 v64, v64, v77
    v_mul_f32 v65, v65, v77
    v_mfma_f32_16x16x32_bf16 v[88:91], v[24:27], a[188:191], v[88:91]
    v_cvt_pk_f16_f32 v64, v64, v65
    v_mul_f32 v66, v66, v77
    v_mfma_f32_16x16x32_bf16 v[68:71], v[96:99], a[192:195], 0
    s_nop 0
    v_mul_f32 v67, v67, v77
    v_cvt_pk_f16_f32 v65, v66, v67
    v_mfma_f32_16x16x32_bf16 v[68:71], v[92:95], a[196:199], v[68:71]
    s_nop 0
    v_cvt_pk_bf16_f32 v160, v88, v89
    v_cvt_pk_bf16_f32 v161, v90, v91
    v_mfma_f32_16x16x32_bf16 v[68:71], v[84:87], a[200:203], v[68:71]
    v_mul_f32 v32, v32, v77
    v_mul_f32 v33, v33, v77
    v_mfma_f32_16x16x32_bf16 v[68:71], v[80:83], a[204:207], v[68:71]
    v_cvt_pk_f16_f32 v66, v32, v33
    v_mul_f32 v34, v34, v77
    v_mfma_f32_16x16x32_bf16 v[68:71], v[56:59], a[208:211], v[68:71]
    v_mul_f32 v35, v35, v77
    v_cvt_pk_f16_f32 v67, v34, v35
    v_mfma_f32_16x16x32_bf16 v[68:71], v[24:27], a[212:215], v[68:71]
    v_mul_f32 v40, v40, v77
    v_mul_f32 v41, v41, v77
    v_mfma_f32_16x16x32_f16 v[32:35], v[28:31], v[4:7], v[204:207]
    ds_read_u16 v166, v131 offset:80
    v_cvt_pk_f16_f32 v142, v40, v41
    v_mfma_f32_16x16x32_f16 v[32:35], v[152:155], v[150:153], v[32:35]
    ds_read_u16 v162, v131 offset:96
    v_mul_f32 v42, v42, v77
    v_mfma_f32_16x16x32_f16 v[24:27], v[72:75], v[4:7], v[200:203]
    ds_read_u16 v158, v131 offset:104
    v_mul_f32 v43, v43, v77
    v_mfma_f32_16x16x32_f16 v[24:27], v[146:149], v[150:153], v[24:27]
    s_waitcnt lgkmcnt(3)
    ds_read_b32 v124, v124 offset:64
    v_cvt_pk_f16_f32 v143, v42, v43
    v_mfma_f32_16x16x32_f16 v[56:59], v[60:63], v[4:7], v[208:211]
    v_mul_f32 v12, v12, v76
    v_mul_f32 v13, v13, v76
    v_mfma_f32_16x16x32_f16 v[56:59], v[52:55], v[28:31], v[56:59]
    v_cvt_pk_f16_f32 v12, v12, v13
    v_mul_f32 v14, v14, v76
    v_mfma_f32_16x16x32_f16 v[56:59], v[48:51], v[152:155], v[56:59]
    v_mul_f32 v15, v15, v76
    v_cvt_pk_f16_f32 v13, v14, v15
    v_mfma_f32_16x16x32_f16 v[40:43], v[60:63], v[44:47], v[208:211]
    v_mul_f32 v36, v36, v76
    v_mul_f32 v37, v37, v76
    v_mfma_f32_16x16x32_f16 v[40:43], v[52:55], v[72:75], v[40:43]
    v_cvt_pk_f16_f32 v14, v36, v37
    v_mul_f32 v38, v38, v76
    v_mfma_f32_16x16x32_f16 v[40:43], v[48:51], v[146:149], v[40:43]
    v_mul_f32 v39, v39, v76
    v_cvt_pk_f16_f32 v15, v38, v39
    v_mfma_f32_16x16x32_f16 v[36:39], v[28:31], v[44:47], v[192:195]
    v_mul_f32 v8, v8, v76
    v_mul_f32 v9, v9, v76
    v_mfma_f32_16x16x32_f16 v[36:39], v[152:155], v[144:147], v[36:39]
    v_cvt_pk_f16_f32 v140, v8, v9
    v_mul_f32 v10, v10, v76
    v_mul_f32 v11, v11, v76
    v_cvt_pk_f16_f32 v141, v10, v11
    v_mfma_f32_16x16x32_f16 v[8:11], v[64:67], v[4:7], v[196:199]
    v_cvt_pk_bf16_f32 v156, v68, v69
    v_cvt_pk_bf16_f32 v157, v70, v71
    v_mfma_f32_16x16x32_f16 v[8:11], v[140:143], v[150:153], v[8:11]
    v_max3_f32 v40, v32, v33, v34
    v_max3_f32 v40, v40, v35, v24
    v_mfma_f32_16x16x32_f16 v[4:7], v[60:63], v[12:15], v[208:211]
    s_nop 0
    v_max3_f32 v40, v40, v25, v26
    v_mov_b32_dpp v59, v43 quad_perm:[0,1,2,3] row_mask:0x2 bank_mask:0xf
    v_mfma_f32_16x16x32_f16 v[4:7], v[52:55], v[64:67], v[4:7]
    s_nop 0
    v_max3_f32 v40, v40, v27, v8
    v_max3_f32 v40, v40, v9, v10
    v_mfma_f32_16x16x32_f16 v[4:7], v[48:51], v[140:143], v[4:7]
    v_max3_f32 v40, v40, v11, v56
    v_mov_b32 v42, v40
    v_mfma_f32_16x16x32_f16 v[52:55], v[72:75], v[44:47], v[188:191]
    s_nop 0
    v_permlane32_swap_b32 v42, v40
    v_mfma_f32_16x16x32_f16 v[52:55], v[146:149], v[144:147], v[52:55]
    v_max_f32 v40, v42, v40
    v_mov_b32 v42, v40
    v_mfma_f32_16x16x32_f16 v[48:51], v[64:67], v[44:47], v[184:187]
    s_nop 0
    v_permlane16_swap_b32 v42, v40
    v_mfma_f32_16x16x32_f16 v[48:51], v[140:143], v[144:147], v[48:51]
    v_max_f32 v40, v42, v40
    v_sub_f32 v32, v32, v40
    v_sub_f32 v33, v33, v40
    v_sub_f32 v34, v34, v40
    v_sub_f32 v35, v35, v40
    v_sub_f32 v24, v24, v40
    v_sub_f32 v25, v25, v40
    v_sub_f32 v26, v26, v40
    v_sub_f32 v27, v27, v40
    v_sub_f32 v8, v8, v40
    v_sub_f32 v9, v9, v40
    v_sub_f32 v10, v10, v40
    v_sub_f32 v11, v11, v40
    v_sub_f32 v56, v56, v40
    v_exp_f32 v32, v32
    v_exp_f32 v33, v33
    v_exp_f32 v34, v34
    v_exp_f32 v35, v35
    v_cvt_pk_bf16_f32 v60, v32, v33
    v_cvt_pk_bf16_f32 v61, v34, v35
    v_exp_f32 v24, v24
    v_exp_f32 v25, v25
    v_exp_f32 v26, v26
    v_exp_f32 v27, v27
    v_cvt_pk_bf16_f32 v62, v24, v25
    v_cvt_pk_bf16_f32 v63, v26, v27
    v_exp_f32 v8, v8
    v_exp_f32 v9, v9
    v_exp_f32 v10, v10
    v_exp_f32 v11, v11
    v_cvt_pk_bf16_f32 v168, v8, v9
    v_cvt_pk_bf16_f32 v169, v10, v11
    v_exp_f32 v56, v56
    v_mov_b32_dpp v59, v7 quad_perm:[0,1,2,3] row_mask:0x4 bank_mask:0xf
    v_cvt_pk_bf16_f32 v170, v56, 0
    v_mfma_f32_16x16x32_bf16 v[44:47], v[220:223], v[60:63], 0
    s_waitcnt lgkmcnt(0)
    v_and_b32 v4, 0xffff0000, v124
    v_lshlrev_b32 v124, 16, v124
    v_mfma_f32_16x16x32_bf16 v[44:47], v[220:223], v[168:171], v[44:47]
    v_add_f32 v124, v124, v4
    v_add_f32 v124, v124, v211
    v_mfma_f32_16x16x32_bf16 v[8:11], v[16:19], v[60:63], 0
    s_nop 0
    v_mov_b32_dpp v59, v124 quad_perm:[0,1,2,3] row_mask:0x8 bank_mask:0xf
    v_mov_b32 v124, v59
    v_mfma_f32_16x16x32_bf16 v[8:11], v[164:167], v[168:171], v[8:11]
    s_nop 0
    v_max_f32_dpp v124, v124, v124 row_ror:8 row_mask:0xf bank_mask:0xf
    v_max3_f32 v4, v36, v37, v38
    v_mfma_f32_16x16x32_bf16 v[24:27], v[0:3], v[60:63], 0
    v_max_f32_dpp v124, v124, v124 row_ror:4 row_mask:0xf bank_mask:0xf
    v_max3_f32 v4, v4, v39, v52
    v_mfma_f32_16x16x32_bf16 v[24:27], v[160:163], v[168:171], v[24:27]
    v_max_f32_dpp v124, v124, v124 row_ror:2 row_mask:0xf bank_mask:0xf
    v_max3_f32 v4, v4, v53, v54
    v_mfma_f32_16x16x32_bf16 v[32:35], v[20:23], v[60:63], 0
    v_max_f32_dpp v124, v124, v124 row_ror:1 row_mask:0xf bank_mask:0xf
    v_mov_b32 v5, v124
    v_mfma_f32_16x16x32_bf16 v[32:35], v[156:159], v[168:171], v[32:35]
    s_nop 0
    v_permlane32_swap_b32 v5, v124
    v_max_f32 v124, v5, v124
    v_mov_b32 v5, v124
    v_rcp_f32 v45, v44
    v_max3_f32 v4, v4, v55, v48
    v_permlane16_swap_b32 v5, v124
    v_max_f32 v124, v5, v124
    v_sub_f32 v59, v59, v124
    v_exp_f32 v59, v59
    v_mul_f32 v8, v8, v45
    v_cvt_pk_bf16_f32 v59, v59, v59
    ds_write_b16 v125, v59 offset:64
    v_mul_f32 v9, v9, v45
    v_cvt_pk_bf16_f32 v68, v8, v9
    ds_read_b128 v[60:63], v132 offset:48
    v_mul_f32 v10, v10, v45
    v_mul_f32 v11, v11, v45
    v_cvt_pk_bf16_f32 v69, v10, v11
    ds_read_b128 v[56:59], v132 offset:64
    v_mfma_f32_16x16x32_f16 v[8:11], v[28:31], v[12:15], v[180:183]
    v_mul_f32 v24, v24, v45
    v_mul_f32 v25, v25, v45
    v_mfma_f32_16x16x32_f16 v[8:11], v[152:155], v[138:141], v[8:11]
    ds_write_b64 v135, v[68:69] offset:0
    v_mfma_f32_16x16x32_f16 v[28:31], v[72:75], v[12:15], v[176:179]
    v_cvt_pk_bf16_f32 v70, v24, v25
    v_mul_f32 v26, v26, v45
    v_mfma_f32_16x16x32_f16 v[28:31], v[146:149], v[138:141], v[28:31]
    v_mul_f32 v27, v27, v45
    v_cvt_pk_bf16_f32 v71, v26, v27
    v_mfma_f32_16x16x32_f16 v[24:27], v[64:67], v[12:15], v[172:175]
    ds_write_b64 v135, v[70:71] offset:8
    v_mfma_f32_16x16x32_f16 v[24:27], v[140:143], v[138:141], v[24:27]
    s_waitcnt lgkmcnt(3)
    v_mul_f32 v32, v32, v45
    v_mul_f32 v33, v33, v45
    v_cvt_pk_bf16_f32 v146, v32, v33
    v_mul_f32 v34, v34, v45
    v_mfma_f32_16x16x32_bf16 v[12:15], v[60:63], v[16:19], 0
    s_waitcnt lgkmcnt(2)
    v_mul_f32 v35, v35, v45
    v_cvt_pk_bf16_f32 v147, v34, v35
    v_max3_f32 v4, v4, v49, v50
    v_max3_f32 v4, v4, v51, v41
    v_mfma_f32_16x16x32_bf16 v[12:15], v[56:59], v[164:167], v[12:15]
    ds_write_b64 v134, v[146:147] offset:0
    v_mfma_f32_16x16x32_bf16 v[44:47], v[60:63], v[0:3], 0
    v_mov_b32 v5, v4
    v_max3_f32 v124, v8, v9, v10
    v_mfma_f32_16x16x32_bf16 v[44:47], v[56:59], v[160:163], v[44:47]
    v_permlane32_swap_b32 v5, v4
    v_mfma_f32_16x16x32_bf16 v[32:35], v[60:63], v[20:23], 0
    v_max_f32 v4, v5, v4
    v_mov_b32 v5, v4
    v_mfma_f32_16x16x32_bf16 v[32:35], v[56:59], v[156:159], v[32:35]
    s_nop 0
    v_permlane16_swap_b32 v5, v4
    v_max_f32 v4, v5, v4
    v_sub_f32 v36, v36, v4
    v_sub_f32 v37, v37, v4
    v_sub_f32 v38, v38, v4
    v_sub_f32 v39, v39, v4
    v_sub_f32 v52, v52, v4
    v_sub_f32 v53, v53, v4
    v_sub_f32 v54, v54, v4
    v_sub_f32 v55, v55, v4
    v_sub_f32 v48, v48, v4
    v_sub_f32 v49, v49, v4
    v_sub_f32 v50, v50, v4
    v_sub_f32 v51, v51, v4
    v_sub_f32 v41, v41, v4
    v_exp_f32 v36, v36
    v_exp_f32 v37, v37
    v_exp_f32 v38, v38
    v_exp_f32 v39, v39
    v_cvt_pk_bf16_f32 v36, v36, v37
    v_cvt_pk_bf16_f32 v37, v38, v39
    v_exp_f32 v52, v52
    v_exp_f32 v53, v53
    v_exp_f32 v54, v54
    v_exp_f32 v55, v55
    v_cvt_pk_bf16_f32 v38, v52, v53
    v_cvt_pk_bf16_f32 v39, v54, v55
    v_exp_f32 v48, v48
    v_exp_f32 v49, v49
    v_exp_f32 v50, v50
    v_exp_f32 v51, v51
    v_cvt_pk_bf16_f32 v168, v48, v49
    v_cvt_pk_bf16_f32 v169, v50, v51
    v_exp_f32 v41, v41
    v_mov_b32_dpp v15, v47 quad_perm:[0,1,2,3] row_mask:0x2 bank_mask:0xf
    v_cvt_pk_bf16_f32 v170, v41, 0
    v_mfma_f32_16x16x32_bf16 v[44:47], v[220:223], v[36:39], 0
    v_mov_b32_dpp v15, v35 quad_perm:[0,1,2,3] row_mask:0x4 bank_mask:0xf
    v_cvt_pk_bf16_f32 v15, v15, v15
    v_mfma_f32_16x16x32_bf16 v[44:47], v[220:223], v[168:171], v[44:47]
    ds_write_b16 v131, v15
    v_mfma_f32_16x16x32_bf16 v[32:35], v[16:19], v[36:39], 0
    ds_read_b128 v[12:15], v137 offset:0
    v_max3_f32 v124, v124, v11, v28
    v_mfma_f32_16x16x32_bf16 v[32:35], v[164:167], v[168:171], v[32:35]
    ds_read_b128 v[146:149], v136 offset:0
    v_max3_f32 v124, v124, v29, v30
    v_mfma_f32_16x16x32_bf16 v[48:51], v[0:3], v[36:39], 0
    ds_read_b128 v[72:75], v137 offset:128
    v_max3_f32 v124, v124, v31, v24
    v_mfma_f32_16x16x32_bf16 v[48:51], v[160:163], v[168:171], v[48:51]
    ds_read_b128 v[88:91], v136 offset:128
    v_max3_f32 v124, v124, v25, v26
    v_mfma_f32_16x16x32_bf16 v[40:43], v[20:23], v[36:39], 0
    ds_read_b128 v[76:79], v137 offset:256
    v_max3_f32 v124, v124, v27, v6
    v_mfma_f32_16x16x32_bf16 v[40:43], v[156:159], v[168:171], v[40:43]
    ds_read_b128 v[56:59], v136 offset:256
    v_mov_b32 v4, v124
    v_rcp_f32 v45, v44
    s_nop 0
    v_mul_f32 v32, v32, v45
    v_mul_f32 v33, v33, v45
    v_cvt_pk_bf16_f32 v32, v32, v33
    v_mul_f32 v34, v34, v45
    v_mul_f32 v35, v35, v45
    v_cvt_pk_bf16_f32 v33, v34, v35
    v_mul_f32 v48, v48, v45
    v_mul_f32 v49, v49, v45
    v_cvt_pk_bf16_f32 v34, v48, v49
    v_mul_f32 v50, v50, v45
    s_waitcnt lgkmcnt(5)
    v_mfma_f32_16x16x32_bf16 v[36:39], a[0:3], v[12:15], 0
    ds_write_b64 v135, v[32:33] offset:1536
    v_mul_f32 v51, v51, v45
    v_cvt_pk_bf16_f32 v35, v50, v51
    v_mul_f32 v40, v40, v45
    v_mul_f32 v41, v41, v45
    v_cvt_pk_bf16_f32 v168, v40, v41
    v_mul_f32 v42, v42, v45
    v_mul_f32 v43, v43, v45
    v_cvt_pk_bf16_f32 v169, v42, v43
    ds_write_b64 v135, v[34:35] offset:1544
    v_permlane32_swap_b32 v4, v124
    v_max_f32 v124, v4, v124
    v_mov_b32 v4, v124
    s_nop 0
    ds_write_b64 v134, v[168:169] offset:1536
    v_permlane16_swap_b32 v4, v124
    v_max_f32 v124, v4, v124
    v_sub_f32 v8, v8, v124
    v_sub_f32 v9, v9, v124
    v_sub_f32 v10, v10, v124
    v_sub_f32 v11, v11, v124
    v_sub_f32 v28, v28, v124
    v_sub_f32 v29, v29, v124
    v_sub_f32 v30, v30, v124
    v_sub_f32 v31, v31, v124
    v_sub_f32 v24, v24, v124
    v_sub_f32 v25, v25, v124
    v_sub_f32 v26, v26, v124
    v_sub_f32 v27, v27, v124
    v_sub_f32 v6, v6, v124
    v_exp_f32 v8, v8
    v_exp_f32 v9, v9
    v_exp_f32 v10, v10
    v_exp_f32 v11, v11
    v_cvt_pk_bf16_f32 v8, v8, v9
    v_cvt_pk_bf16_f32 v9, v10, v11
    v_exp_f32 v28, v28
    v_exp_f32 v29, v29
    v_exp_f32 v30, v30
    v_exp_f32 v31, v31
    v_cvt_pk_bf16_f32 v10, v28, v29
    v_cvt_pk_bf16_f32 v11, v30, v31
    v_exp_f32 v24, v24
    v_exp_f32 v25, v25
    v_exp_f32 v26, v26
    v_exp_f32 v27, v27
    v_cvt_pk_bf16_f32 v168, v24, v25
    v_cvt_pk_bf16_f32 v169, v26, v27
    v_exp_f32 v6, v6
    s_nop 0
    v_cvt_pk_bf16_f32 v170, v6, 0
    v_mfma_f32_16x16x32_bf16 v[152:155], v[220:223], v[8:11], 0
    s_nop 0
    v_mfma_f32_16x16x32_bf16 v[152:155], v[220:223], v[168:171], v[152:155]
    s_nop 1
    v_mfma_f32_16x16x32_bf16 v[4:7], v[16:19], v[8:11], 0
    s_nop 2
    v_mfma_f32_16x16x32_bf16 v[4:7], v[164:167], v[168:171], v[4:7]
    s_nop 0
    v_rcp_f32 v153, v152
    v_mfma_f32_16x16x32_bf16 v[16:19], v[0:3], v[8:11], 0
    s_nop 2
    v_mfma_f32_16x16x32_bf16 v[16:19], v[160:163], v[168:171], v[16:19]
    s_nop 0
    v_mul_f32 v4, v4, v153
    v_mul_f32 v5, v5, v153
    v_mfma_f32_16x16x32_bf16 v[0:3], v[20:23], v[8:11], 0
    v_cvt_pk_bf16_f32 v8, v4, v5
    v_mul_f32 v6, v6, v153
    v_mfma_f32_16x16x32_bf16 v[0:3], v[156:159], v[168:171], v[0:3]
    v_mul_f32 v7, v7, v153
    v_cvt_pk_bf16_f32 v9, v6, v7
    s_waitcnt lgkmcnt(0)
.p2align 6
L_loopS0:
    v_mfma_f32_16x16x32_bf16 v[36:39], a[4:7], v[146:149], v[36:39]
    ds_write_b64 v135, v[8:9] offset:3072
    v_mfma_f32_16x16x32_bf16 v[36:39], a[8:11], v[72:75], v[36:39]
    v_mul_f32 v16, v16, v153
    v_mul_f32 v17, v17, v153
    v_mfma_f32_16x16x32_bf16 v[36:39], a[12:15], v[88:91], v[36:39]
    v_cvt_pk_bf16_f32 v10, v16, v17
    v_mul_f32 v18, v18, v153
    v_mfma_f32_16x16x32_bf16 v[36:39], a[16:19], v[76:79], v[36:39]
    v_mul_f32 v19, v19, v153
    v_cvt_pk_bf16_f32 v11, v18, v19
    v_mfma_f32_16x16x32_bf16 v[36:39], a[20:23], v[56:59], v[36:39]
    ds_write_b64 v135, v[10:11] offset:3080
    v_mfma_f32_16x16x32_bf16 v[8:11], a[24:27], v[12:15], 0
    v_mul_f32 v0, v0, v153
    v_mul_f32 v1, v1, v153
    v_mfma_f32_16x16x32_bf16 v[8:11], a[28:31], v[146:149], v[8:11]
    v_cvt_pk_bf16_f32 v0, v0, v1
    v_mul_f32 v2, v2, v153
    v_mfma_f32_16x16x32_bf16 v[8:11], a[32:35], v[72:75], v[8:11]
    v_mul_f32 v3, v3, v153
    v_cvt_pk_bf16_f32 v1, v2, v3
    v_mfma_f32_16x16x32_bf16 v[8:11], a[36:39], v[88:91], v[8:11]
    ds_write_b64 v134, v[0:1] offset:3072
    v_mfma_f32_16x16x32_bf16 v[8:11], a[40:43], v[76:79], v[8:11]
    v_fma_f32 v170, v40, v40, s42
    v_fmac_f32 v170, v41, v41
    v_mfma_f32_16x16x32_bf16 v[8:11], a[44:47], v[56:59], v[8:11]
    v_fmac_f32 v170, v42, v42
    v_fmac_f32 v170, v43, v43
    v_mfma_f32_16x16x32_bf16 v[152:155], a[48:51], v[12:15], 0
    v_fmac_f32 v170, v140, v140
    v_fmac_f32 v170, v141, v141
    v_mfma_f32_16x16x32_bf16 v[152:155], a[52:55], v[146:149], v[152:155]
    v_fmac_f32 v170, v142, v142
    v_fmac_f32 v170, v143, v143
    v_mfma_f32_16x16x32_bf16 v[152:155], a[56:59], v[72:75], v[152:155]
    s_waitcnt vmcnt(10)
    v_fmac_f32 v170, v44, v44
    v_fmac_f32 v170, v45, v45
    v_mfma_f32_16x16x32_bf16 v[152:155], a[60:63], v[88:91], v[152:155]
    v_fmac_f32 v170, v46, v46
    v_fmac_f32 v170, v47, v47
    v_mfma_f32_16x16x32_bf16 v[152:155], a[64:67], v[76:79], v[152:155]
    v_cvt_pk_bf16_f32 v16, v92, v93
    v_cvt_pk_bf16_f32 v17, v170, v167
    v_mfma_f32_16x16x32_bf16 v[152:155], a[68:71], v[56:59], v[152:155]
    ds_write_b64 v159, v[16:17]
    v_mfma_f32_16x16x32_bf16 v[60:63], a[72:75], v[12:15], 0
    v_add_u32 v135, s49, v135
    v_add_u32 v134, s49, v134
    v_mfma_f32_16x16x32_bf16 v[60:63], a[76:79], v[146:149], v[60:63]
    v_fma_f32 v170, v36, v36, s41
    v_fmac_f32 v170, v37, v37
    v_mfma_f32_16x16x32_bf16 v[60:63], a[80:83], v[72:75], v[60:63]
    v_fmac_f32 v170, v38, v38
    v_fmac_f32 v170, v39, v39
    v_mfma_f32_16x16x32_bf16 v[60:63], a[84:87], v[88:91], v[60:63]
    v_fmac_f32 v170, v8, v8
    v_fmac_f32 v170, v9, v9
    v_mfma_f32_16x16x32_bf16 v[60:63], a[88:91], v[76:79], v[60:63]
    v_fmac_f32 v170, v10, v10
    v_fmac_f32 v170, v11, v11
    v_mfma_f32_16x16x32_bf16 v[60:63], a[92:95], v[56:59], v[60:63]
    v_fmac_f32 v170, v152, v152
    v_fmac_f32 v170, v153, v153
    v_mfma_f32_16x16x32_bf16 v[92:95], a[96:99], v[12:15], 0
    v_fmac_f32 v170, v154, v154
    v_fmac_f32 v170, v155, v155
    v_mfma_f32_16x16x32_bf16 v[92:95], a[100:103], v[146:149], v[92:95]
    s_waitcnt lgkmcnt(0)
    s_nop 0
    v_fma_f32 v124, v60, v60, s41
    v_fmac_f32 v124, v61, v61
    v_mfma_f32_16x16x32_bf16 v[92:95], a[104:107], v[72:75], v[92:95]
    s_barrier
    ds_read_b128 v[16:19], v163 offset:0
    v_fmac_f32 v124, v62, v62
    v_mfma_f32_16x16x32_bf16 v[92:95], a[108:111], v[88:91], v[92:95]
    ds_read_b128 v[0:3], v163 offset:1024
    v_fmac_f32 v124, v63, v63
    v_mfma_f32_16x16x32_bf16 v[92:95], a[112:115], v[76:79], v[92:95]
    v_mfma_f32_16x16x32_bf16 v[92:95], a[116:119], v[56:59], v[92:95]
    s_nop 1
    v_mfma_f32_16x16x32_bf16 v[64:67], a[120:123], v[12:15], 0
    s_nop 2
    v_mfma_f32_16x16x32_bf16 v[64:67], a[124:127], v[146:149], v[64:67]
    s_nop 0
    v_fmac_f32 v124, v92, v92
    v_fmac_f32 v124, v93, v93
    v_mfma_f32_16x16x32_bf16 v[64:67], a[128:131], v[72:75], v[64:67]
    v_fmac_f32 v124, v94, v94
    v_fmac_f32 v124, v95, v95
    v_mfma_f32_16x16x32_bf16 v[64:67], a[132:135], v[88:91], v[64:67]
    v_mfma_f32_16x16x32_bf16 v[64:67], a[136:139], v[76:79], v[64:67]
    v_mfma_f32_16x16x32_bf16 v[64:67], a[140:143], v[56:59], v[64:67]
    s_waitcnt lgkmcnt(1)
    v_readfirstlane_b32 s12, v17
    v_mfma_f32_16x16x32_bf16 v[80:83], v[216:219], v[16:19], 0
    s_waitcnt lgkmcnt(0)
    s_nop 1
    v_mfma_f32_16x16x32_bf16 v[80:83], v[216:219], v[0:3], v[80:83]
    s_lshr_b32 s12, s12, 23
    v_fmac_f32 v124, v64, v64
    v_fmac_f32 v124, v65, v65
    v_mfma_f32_16x16x32_bf16 v[16:19], v[12:15], a[144:147], 0
    v_fmac_f32 v124, v66, v66
    v_fmac_f32 v124, v67, v67
    v_mfma_f32_16x16x32_bf16 v[16:19], v[146:149], a[148:151], v[16:19]
    s_nop 0
    v_rsq_f32 v80, v80
    v_mfma_f32_16x16x32_bf16 v[16:19], v[72:75], a[152:155], v[16:19]
    v_rsq_f32 v81, v81
    v_mfma_f32_16x16x32_bf16 v[16:19], v[88:91], a[156:159], v[16:19]
    v_rsq_f32 v82, v82
    v_mfma_f32_16x16x32_bf16 v[16:19], v[76:79], a[160:163], v[16:19]
    ds_read_b128 v[84:87], v137 offset:1536
    v_mul_f32 v80, s43, v80
    v_mfma_f32_16x16x32_bf16 v[16:19], v[56:59], a[164:167], v[16:19]
    ds_read_b128 v[48:51], v136 offset:1536
    v_mul_f32 v81, s43, v81
    v_mfma_f32_16x16x32_bf16 v[68:71], v[12:15], a[168:171], 0
    ds_read_b128 v[52:55], v137 offset:1664
    v_mul_f32 v82, s43, v82
    v_mfma_f32_16x16x32_bf16 v[68:71], v[146:149], a[172:175], v[68:71]
    ds_read_b128 v[96:99], v136 offset:1664
    v_cvt_pk_bf16_f32 v170, v170, v124
    v_mfma_f32_16x16x32_bf16 v[68:71], v[72:75], a[176:179], v[68:71]
    ds_read_b128 v[112:115], v137 offset:1792
    v_cvt_pk_bf16_f32 v16, v16, v17
    v_mfma_f32_16x16x32_bf16 v[68:71], v[88:91], a[180:183], v[68:71]
    ds_read_b128 v[104:107], v136 offset:1792
    v_cvt_pk_bf16_f32 v17, v18, v19
    v_mfma_f32_16x16x32_bf16 v[68:71], v[76:79], a[184:187], v[68:71]
    v_mul_f32 v32, v32, v80
    v_mul_f32 v33, v33, v80
    v_mfma_f32_16x16x32_bf16 v[68:71], v[56:59], a[188:191], v[68:71]
    s_nop 0
    v_cvt_pk_bf16_f32 v18, v32, v33
    v_mul_f32 v34, v34, v80
    v_mfma_f32_16x16x16_bf16 v[100:103], v[216:217], v[170:171], 0
    s_nop 0
    v_mul_f32 v35, v35, v80
    v_cvt_pk_bf16_f32 v19, v34, v35
    v_mul_f32 v20, v20, v80
    v_cvt_pk_bf16_f32 v0, v68, v69
    v_mfma_f32_16x16x32_bf16 v[32:35], v[12:15], a[192:195], 0
    ds_write_b64 v135, v[18:19] offset:0
    v_mfma_f32_16x16x32_bf16 v[32:35], v[146:149], a[196:199], v[32:35]
    v_rsq_f32 v100, v100
    v_mfma_f32_16x16x32_bf16 v[32:35], v[72:75], a[200:203], v[32:35]
    v_rsq_f32 v101, v101
    v_mfma_f32_16x16x32_bf16 v[32:35], v[88:91], a[204:207], v[32:35]
    v_mul_f32 v100, s55, v100
    v_mul_f32 v101, 0.5, v101
    v_mfma_f32_16x16x32_bf16 v[32:35], v[76:79], a[208:211], v[32:35]
    v_cvt_pk_bf16_f32 v1, v70, v71
    v_mul_f32 v36, v36, v100
    v_mfma_f32_16x16x32_bf16 v[32:35], v[56:59], a[212:215], v[32:35]
    s_waitcnt lgkmcnt(1)
    v_mul_f32 v37, v37, v100
    v_cvt_pk_f16_f32 v76, v36, v37
    v_mfma_f32_16x16x32_bf16 v[146:149], a[0:3], v[84:87], 0
    v_mul_f32 v38, v38, v100
    v_mul_f32 v39, v39, v100
    v_mfma_f32_16x16x32_bf16 v[146:149], a[4:7], v[48:51], v[146:149]
    v_cvt_pk_f16_f32 v77, v38, v39
    v_mul_f32 v8, v8, v100
    v_mfma_f32_16x16x32_bf16 v[146:149], a[8:11], v[52:55], v[146:149]
    v_mul_f32 v9, v9, v100
    v_cvt_pk_f16_f32 v78, v8, v9
    v_mfma_f32_16x16x32_bf16 v[146:149], a[12:15], v[96:99], v[146:149]
    v_mul_f32 v10, v10, v100
    v_mul_f32 v11, v11, v100
    v_mfma_f32_16x16x32_bf16 v[146:149], a[16:19], v[112:115], v[146:149]
    v_cvt_pk_f16_f32 v79, v10, v11
    v_mul_f32 v152, v152, v100
    v_mfma_f32_16x16x32_bf16 v[146:149], a[20:23], v[104:107], v[146:149]
    v_mul_f32 v153, v153, v100
    v_cvt_pk_f16_f32 v152, v152, v153
    v_mfma_f32_16x16x32_bf16 v[36:39], a[24:27], v[84:87], 0
    v_mul_f32 v154, v154, v100
    v_mul_f32 v155, v155, v100
    v_mfma_f32_16x16x32_bf16 v[36:39], a[28:31], v[48:51], v[36:39]
    v_cvt_pk_f16_f32 v153, v154, v155
    v_mul_f32 v60, v60, v101
    v_mfma_f32_16x16x32_bf16 v[36:39], a[32:35], v[52:55], v[36:39]
    v_mul_f32 v61, v61, v101
    v_cvt_pk_f16_f32 v12, v60, v61
    v_mfma_f32_16x16x32_bf16 v[36:39], a[36:39], v[96:99], v[36:39]
    v_mul_f32 v62, v62, v101
    v_mul_f32 v63, v63, v101
    v_mfma_f32_16x16x32_bf16 v[36:39], a[40:43], v[112:115], v[36:39]
    v_cvt_pk_f16_f32 v13, v62, v63
    v_mul_f32 v92, v92, v101
    v_mfma_f32_16x16x32_bf16 v[36:39], a[44:47], v[104:107], v[36:39]
    v_mul_f32 v93, v93, v101
    v_cvt_pk_f16_f32 v14, v92, v93
    v_mfma_f32_16x16x32_bf16 v[72:75], a[48:51], v[84:87], 0
    v_mul_f32 v94, v94, v101
    v_mul_f32 v95, v95, v101
    v_mfma_f32_16x16x32_bf16 v[72:75], a[52:55], v[48:51], v[72:75]
    v_cvt_pk_f16_f32 v15, v94, v95
    v_mul_f32 v64, v64, v101
    v_mfma_f32_16x16x32_bf16 v[72:75], a[56:59], v[52:55], v[72:75]
    v_mul_f32 v65, v65, v101
    v_cvt_pk_f16_f32 v154, v64, v65
    v_mfma_f32_16x16x32_bf16 v[72:75], a[60:63], v[96:99], v[72:75]
    v_mul_f32 v66, v66, v101
    v_mul_f32 v67, v67, v101
    v_mfma_f32_16x16x32_bf16 v[72:75], a[64:67], v[112:115], v[72:75]
    v_cvt_pk_f16_f32 v155, v66, v67
    v_cvt_pk_bf16_f32 v8, v32, v33
    v_mfma_f32_16x16x32_bf16 v[72:75], a[68:71], v[104:107], v[72:75]
    v_cvt_pk_bf16_f32 v9, v34, v35
    v_mul_f32 v21, v21, v80
    v_mfma_f32_16x16x32_bf16 v[32:35], a[72:75], v[84:87], 0
    v_cvt_pk_bf16_f32 v20, v20, v21
    v_mul_f32 v22, v22, v80
    v_mfma_f32_16x16x32_bf16 v[32:35], a[76:79], v[48:51], v[32:35]
    v_mul_f32 v23, v23, v80
    v_cvt_pk_bf16_f32 v21, v22, v23
    v_mfma_f32_16x16x32_bf16 v[32:35], a[80:83], v[52:55], v[32:35]
    ds_write_b64 v135, v[20:21] offset:8
    v_mfma_f32_16x16x32_bf16 v[32:35], a[84:87], v[96:99], v[32:35]
    v_mul_f32 v4, v4, v80
    v_mul_f32 v5, v5, v80
    v_mfma_f32_16x16x32_bf16 v[32:35], a[88:91], v[112:115], v[32:35]
    v_cvt_pk_bf16_f32 v18, v4, v5
    v_mul_f32 v6, v6, v80
    v_mfma_f32_16x16x32_bf16 v[32:35], a[92:95], v[104:107], v[32:35]
    v_mul_f32 v7, v7, v80
    v_cvt_pk_bf16_f32 v19, v6, v7
    v_mfma_f32_16x16x32_bf16 v[20:23], a[96:99], v[84:87], 0
    ds_write_b64 v134, v[18:19] offset:0
    v_mfma_f32_16x16x32_bf16 v[20:23], a[100:103], v[48:51], v[20:23]
    v_fma_f32 v18, v146, v146, s41
    v_fmac_f32 v18, v147, v147
    v_mfma_f32_16x16x32_bf16 v[20:23], a[104:107], v[52:55], v[20:23]
    v_fmac_f32 v18, v148, v148
    v_fmac_f32 v18, v149, v149
    v_mfma_f32_16x16x32_bf16 v[20:23], a[108:111], v[96:99], v[20:23]
    v_fmac_f32 v18, v36, v36
    v_fmac_f32 v18, v37, v37
    v_mfma_f32_16x16x32_bf16 v[20:23], a[112:115], v[112:115], v[20:23]
    v_fmac_f32 v18, v38, v38
    v_fmac_f32 v18, v39, v39
    v_mfma_f32_16x16x32_bf16 v[20:23], a[116:119], v[104:107], v[20:23]
    v_fmac_f32 v18, v72, v72
    v_fmac_f32 v18, v73, v73
    v_mfma_f32_16x16x32_bf16 v[4:7], a[120:123], v[84:87], 0
    v_fmac_f32 v18, v74, v74
    v_fmac_f32 v18, v75, v75
    v_mfma_f32_16x16x32_bf16 v[4:7], a[124:127], v[48:51], v[4:7]
    v_mul_f32 v24, v24, v81
    v_mul_f32 v25, v25, v81
    v_mfma_f32_16x16x32_bf16 v[4:7], a[128:131], v[52:55], v[4:7]
    v_cvt_pk_bf16_f32 v88, v24, v25
    v_mul_f32 v26, v26, v81
    v_mfma_f32_16x16x32_bf16 v[4:7], a[132:135], v[96:99], v[4:7]
    v_mul_f32 v27, v27, v81
    v_cvt_pk_bf16_f32 v89, v26, v27
    v_mfma_f32_16x16x32_bf16 v[4:7], a[136:139], v[112:115], v[4:7]
    ds_write_b64 v135, v[88:89] offset:1536
    v_mfma_f32_16x16x32_bf16 v[4:7], a[140:143], v[104:107], v[4:7]
    v_mul_f32 v28, v28, v81
    v_mul_f32 v29, v29, v81
    v_mfma_f32_16x16x32_bf16 v[60:63], v[84:87], a[144:147], 0
    v_cvt_pk_bf16_f32 v90, v28, v29
    v_mul_f32 v30, v30, v81
    v_mfma_f32_16x16x32_bf16 v[60:63], v[48:51], a[148:151], v[60:63]
    v_mul_f32 v31, v31, v81
    v_cvt_pk_bf16_f32 v91, v30, v31
    v_mfma_f32_16x16x32_bf16 v[60:63], v[52:55], a[152:155], v[60:63]
    ds_write_b64 v135, v[90:91] offset:1544
    v_mfma_f32_16x16x32_bf16 v[60:63], v[96:99], a[156:159], v[60:63]
    v_mul_f32 v108, v108, v81
    v_mul_f32 v109, v109, v81
    v_mfma_f32_16x16x32_bf16 v[60:63], v[112:115], a[160:163], v[60:63]
    ds_read_b128 v[88:91], v137 offset:3072
    v_cvt_pk_bf16_f32 v2, v108, v109
    v_mfma_f32_16x16x32_bf16 v[60:63], v[104:107], a[164:167], v[60:63]
    ds_read_b128 v[56:59], v136 offset:3072
    v_mul_f32 v110, v110, v81
    v_mfma_f32_16x16x32_bf16 v[92:95], v[84:87], a[168:171], 0
    ds_read_b128 v[64:67], v137 offset:3200
    v_mul_f32 v111, v111, v81
    v_mfma_f32_16x16x32_bf16 v[92:95], v[48:51], a[172:175], v[92:95]
    ds_read_b128 v[24:27], v136 offset:3200
    v_cvt_pk_bf16_f32 v3, v110, v111
    v_mfma_f32_16x16x32_bf16 v[92:95], v[52:55], a[176:179], v[92:95]
    ds_write_b64 v134, v[2:3] offset:1536
    v_mfma_f32_16x16x32_bf16 v[92:95], v[96:99], a[180:183], v[92:95]
    v_fma_f32 v19, v32, v32, s41
    v_fmac_f32 v19, v33, v33
    v_mfma_f32_16x16x32_bf16 v[92:95], v[112:115], a[184:187], v[92:95]
    ds_read_b128 v[68:71], v137 offset:3328
    v_fmac_f32 v19, v34, v34
    v_mfma_f32_16x16x32_bf16 v[92:95], v[104:107], a[188:191], v[92:95]
    ds_read_b128 v[28:31], v136 offset:3328
    v_fmac_f32 v19, v35, v35
    v_mfma_f32_16x16x32_bf16 v[108:111], v[84:87], a[192:195], 0
    v_fmac_f32 v19, v20, v20
    v_fmac_f32 v19, v21, v21
    v_mfma_f32_16x16x32_bf16 v[108:111], v[48:51], a[196:199], v[108:111]
    s_sub_u32 s50, s45, s44
    v_fmac_f32 v19, v22, v22
    v_fmac_f32 v19, v23, v23
    v_mfma_f32_16x16x32_bf16 v[108:111], v[52:55], a[200:203], v[108:111]
    s_sub_u32 s51, s46, s47
    v_fmac_f32 v19, v4, v4
    v_fmac_f32 v19, v5, v5
    v_mfma_f32_16x16x32_bf16 v[108:111], v[96:99], a[204:207], v[108:111]
    s_mov_b32 s60, s59
    v_fmac_f32 v19, v6, v6
    v_fmac_f32 v19, v7, v7
    v_mfma_f32_16x16x32_bf16 v[108:111], v[112:115], a[208:211], v[108:111]
    s_mov_b32 s59, s58
    v_cvt_pk_bf16_f32 v170, v18, v19
    v_cvt_pk_bf16_f32 v18, v60, v61
    v_mfma_f32_16x16x32_bf16 v[108:111], v[104:107], a[212:215], v[108:111]
    s_mov_b32 s58, s57
    v_cvt_pk_bf16_f32 v19, v62, v63
    v_cvt_pk_bf16_f32 v2, v92, v93
    v_mfma_f32_16x16x16_bf16 v[60:63], v[216:217], v[170:171], 0
    s_waitcnt lgkmcnt(2)
    s_mov_b32 s57, s56
    v_cvt_pk_bf16_f32 v3, v94, v95
    v_mul_f32 v40, v40, v82
    v_mul_f32 v41, v41, v82
    v_cvt_pk_bf16_f32 v10, v108, v109
    v_mfma_f32_16x16x32_bf16 v[92:95], a[0:3], v[88:91], 0
    s_mov_b32 s7, s6
    v_cvt_pk_bf16_f32 v11, v110, v111
    v_cvt_pk_bf16_f32 v40, v40, v41
    v_mfma_f32_16x16x32_bf16 v[92:95], a[4:7], v[56:59], v[92:95]
    s_mov_b32 s6, s5
    v_rsq_f32 v60, v60
    v_mfma_f32_16x16x32_bf16 v[92:95], a[8:11], v[64:67], v[92:95]
    s_mov_b32 s5, s4
    v_rsq_f32 v61, v61
    v_mfma_f32_16x16x32_bf16 v[92:95], a[12:15], v[24:27], v[92:95]
    s_waitcnt lgkmcnt(0)
    s_sub_u32 s14, s6, s7
    v_mul_f32 v60, s55, v60
    v_mul_f32 v61, 0.5, v61
    v_mfma_f32_16x16x32_bf16 v[92:95], a[16:19], v[68:71], v[92:95]
    s_add_u32 s61, s61, 1
    v_mul_f32 v146, v146, v60
    v_mul_f32 v147, v147, v60
    v_mfma_f32_16x16x32_bf16 v[92:95], a[20:23], v[28:31], v[92:95]
    s_ff1_i32_b32 s15, s66
    v_cvt_pk_f16_f32 v96, v146, v147
    v_mul_f32 v148, v148, v60
    v_mfma_f32_16x16x32_bf16 v[84:87], a[24:27], v[88:91], 0
    s_cmp_lg_u32 s66, 0
    v_mul_f32 v149, v149, v60
    v_cvt_pk_f16_f32 v97, v148, v149
    v_mfma_f32_16x16x32_bf16 v[84:87], a[28:31], v[56:59], v[84:87]
    s_cselect_b32 s12, s15, s12
    v_mul_f32 v36, v36, v60
    v_mul_f32 v37, v37, v60
    v_mfma_f32_16x16x32_bf16 v[84:87], a[32:35], v[64:67], v[84:87]
    s_cmp_lt_u32 s61, s71
    v_cvt_pk_f16_f32 v98, v36, v37
    v_mul_f32 v38, v38, v60
    v_mfma_f32_16x16x32_bf16 v[84:87], a[36:39], v[24:27], v[84:87]
    s_cselect_b32 s15, 31, s15
    v_mul_f32 v39, v39, v60
    v_cvt_pk_f16_f32 v99, v38, v39
    v_mfma_f32_16x16x32_bf16 v[84:87], a[40:43], v[68:71], v[84:87]
    s_bitset0_b32 s66, s15
    v_mul_f32 v72, v72, v60
    v_mul_f32 v73, v73, v60
    v_mfma_f32_16x16x32_bf16 v[84:87], a[44:47], v[28:31], v[84:87]
    s_add_u32 s12, s12, 20
    v_cvt_pk_f16_f32 v146, v72, v73
    v_mul_f32 v74, v74, v60
    v_mfma_f32_16x16x32_bf16 v[48:51], a[48:51], v[88:91], 0
    s_max_u32 s12, s12, s61
    v_mul_f32 v75, v75, v60
    v_cvt_pk_f16_f32 v147, v74, v75
    v_mfma_f32_16x16x32_bf16 v[48:51], a[52:55], v[56:59], v[48:51]
    s_cmp_lt_u32 s61, s71
    v_mul_f32 v32, v32, v61
    v_mul_f32 v33, v33, v61
    v_mfma_f32_16x16x32_bf16 v[48:51], a[56:59], v[64:67], v[48:51]
    s_cselect_b32 s15, s61, s12
    v_cvt_pk_f16_f32 v36, v32, v33
    v_mul_f32 v34, v34, v61
    v_mfma_f32_16x16x32_bf16 v[48:51], a[60:63], v[24:27], v[48:51]
    s_cselect_b32 s56, s69, s70
    v_mul_f32 v35, v35, v61
    v_cvt_pk_f16_f32 v37, v34, v35
    v_mfma_f32_16x16x32_bf16 v[48:51], a[64:67], v[68:71], v[48:51]
    s_add_u32 s56, s56, s15
    v_mul_f32 v20, v20, v61
    v_mul_f32 v21, v21, v61
    v_mfma_f32_16x16x32_bf16 v[48:51], a[68:71], v[28:31], v[48:51]
    s_mul_i32 s53, s56, 58255
    v_cvt_pk_f16_f32 v38, v20, v21
    v_mul_f32 v22, v22, v61
    v_mfma_f32_16x16x32_bf16 v[72:75], a[72:75], v[88:91], 0
    s_lshr_b32 s53, s53, 22
    v_mul_f32 v23, v23, v61
    v_cvt_pk_f16_f32 v39, v22, v23
    v_mfma_f32_16x16x32_bf16 v[72:75], a[76:79], v[56:59], v[72:75]
    s_mul_i32 s53, s53, s63
    v_mul_f32 v4, v4, v61
    v_mul_f32 v5, v5, v61
    v_mfma_f32_16x16x32_bf16 v[72:75], a[80:83], v[64:67], v[72:75]
    s_mul_i32 s56, s56, s62
    v_cvt_pk_f16_f32 v148, v4, v5
    v_mul_f32 v6, v6, v61
    v_mfma_f32_16x16x32_bf16 v[72:75], a[84:87], v[24:27], v[72:75]
    s_add_u32 s56, s56, s53
    v_mul_f32 v7, v7, v61
    v_cvt_pk_f16_f32 v149, v6, v7
    v_mfma_f32_16x16x32_bf16 v[72:75], a[88:91], v[68:71], v[72:75]
    s_mul_i32 s4, s15, 112
    v_mul_f32 v42, v42, v82
    v_mul_f32 v43, v43, v82
    v_mfma_f32_16x16x32_bf16 v[72:75], a[92:95], v[28:31], v[72:75]
    s_cmp_ge_u32 s15, 16
    v_cvt_pk_bf16_f32 v41, v42, v43
    v_mul_f32 v140, v140, v82
    v_mfma_f32_16x16x32_bf16 v[20:23], a[96:99], v[88:91], 0
    s_cselect_b32 s53, -30464, 0
    ds_write_b64 v135, v[40:41] offset:3072
    v_mfma_f32_16x16x32_bf16 v[20:23], a[100:103], v[56:59], v[20:23]
    s_add_u32 s4, s4, s53
    v_mul_f32 v141, v141, v82
    v_cvt_pk_bf16_f32 v42, v140, v141
    v_mfma_f32_16x16x32_bf16 v[20:23], a[104:107], v[64:67], v[20:23]
    s_cmp_lt_u32 s15, s73
    v_mul_f32 v142, v142, v82
    v_mul_f32 v143, v143, v82
    v_mfma_f32_16x16x32_bf16 v[20:23], a[108:111], v[24:27], v[20:23]
    s_cselect_b32 s26, 100270464, 0
    v_cvt_pk_bf16_f32 v43, v142, v143
    v_mul_f32 v44, v44, v82
    v_mfma_f32_16x16x32_bf16 v[20:23], a[112:115], v[68:71], v[20:23]
    s_cselect_b32 s56, s56, 0
    ds_write_b64 v135, v[42:43] offset:3080
    v_mfma_f32_16x16x32_bf16 v[20:23], a[116:119], v[28:31], v[20:23]
    s_cselect_b32 s4, s4, -1
    v_mul_f32 v45, v45, v82
    v_cvt_pk_bf16_f32 v44, v44, v45
    v_mul_f32 v46, v46, v82
    v_mul_f32 v47, v47, v82
    v_cvt_pk_bf16_f32 v45, v46, v47
    s_cselect_b32 s15, s15, 0
    s_cselect_b32 s13, s13, -1
    ds_write_b64 v134, v[44:45] offset:3072
    v_fma_f32 v124, v92, v92, s41
    v_fmac_f32 v124, v93, v93
    v_fmac_f32 v124, v94, v94
    v_fmac_f32 v124, v95, v95
    v_mfma_f32_16x16x32_bf16 v[4:7], a[120:123], v[88:91], 0
    s_waitcnt vmcnt(0)
    v_fmac_f32 v124, v84, v84
    v_fmac_f32 v124, v85, v85
    v_mfma_f32_16x16x32_bf16 v[4:7], a[124:127], v[56:59], v[4:7]
    s_bitset1_b32 s64, s15
    v_fmac_f32 v124, v86, v86
    v_fmac_f32 v124, v87, v87
    v_mfma_f32_16x16x32_bf16 v[4:7], a[128:131], v[64:67], v[4:7]
    s_add_u32 s65, s65, 1
    v_fmac_f32 v124, v48, v48
    v_fmac_f32 v124, v49, v49
    v_mfma_f32_16x16x32_bf16 v[4:7], a[132:135], v[24:27], v[4:7]
    s_cmp_ge_i32 s65, 2
    v_fmac_f32 v124, v50, v50
    v_fmac_f32 v124, v51, v51
    v_mfma_f32_16x16x32_bf16 v[4:7], a[136:139], v[68:71], v[4:7]
    s_cselect_b32 s30, 100270464, 0
    v_fma_f32 v170, v72, v72, s41
    v_fmac_f32 v170, v73, v73
    v_mfma_f32_16x16x32_bf16 v[4:7], a[140:143], v[28:31], v[4:7]
    s_add_u32 s67, s46, s54
    v_fmac_f32 v170, v74, v74
    v_fmac_f32 v170, v75, v75
    v_mfma_f32_16x16x32_bf16 v[32:35], v[88:91], a[144:147], 0
    s_waitcnt lgkmcnt(0)
    s_add_u32 m0, s67, 0
    v_fmac_f32 v170, v20, v20
    v_fmac_f32 v170, v21, v21
    v_mfma_f32_16x16x32_bf16 v[32:35], v[56:59], a[148:151], v[32:35]
    s_barrier
    v_fmac_f32 v170, v22, v22
    v_fmac_f32 v170, v23, v23
    v_mfma_f32_16x16x32_bf16 v[32:35], v[64:67], a[152:155], v[32:35]
    s_cmp_ge_u32 s61, s13
    v_fmac_f32 v170, v4, v4
    v_fmac_f32 v170, v5, v5
    v_mfma_f32_16x16x32_bf16 v[32:35], v[24:27], a[156:159], v[32:35]
    s_cbranch_scc1 L_atomS0
L_atomS0r:
    v_mfma_f32_16x16x32_bf16 v[32:35], v[68:71], a[160:163], v[32:35]
    v_fmac_f32 v170, v6, v6
    v_fmac_f32 v170, v7, v7
    v_mfma_f32_16x16x32_bf16 v[32:35], v[28:31], a[164:167], v[32:35]
    v_cvt_pk_bf16_f32 v170, v124, v170
    v_add_u32 v137, s50, v137
    v_mfma_f32_16x16x32_bf16 v[40:43], v[88:91], a[168:171], 0
    ds_read_b128 v[60:63], v137 offset:0
    v_add_u32 v136, s50, v136
    v_mfma_f32_16x16x32_bf16 v[40:43], v[56:59], a[172:175], v[40:43]
    s_nop 0
    ds_read_b128 v[80:83], v136 offset:0
    v_cvt_pk_bf16_f32 v164, v32, v33
    v_mfma_f32_16x16x32_bf16 v[40:43], v[64:67], a[176:179], v[40:43]
    ds_read_b128 v[52:55], v137 offset:128
    v_cvt_pk_bf16_f32 v165, v34, v35
    v_mfma_f32_16x16x32_bf16 v[40:43], v[24:27], a[180:183], v[40:43]
    ds_read_b128 v[112:115], v136 offset:128
    v_add_u32 v135, s48, v135
    v_mfma_f32_16x16x32_bf16 v[40:43], v[68:71], a[184:187], v[40:43]
    ds_read_b128 v[108:111], v137 offset:256
    v_add_u32 v134, s48, v134
    v_mfma_f32_16x16x32_bf16 v[40:43], v[28:31], a[188:191], v[40:43]
    s_nop 0
    ds_read_b128 v[104:107], v136 offset:256
    v_add_u32 v133, s51, v133
    v_mfma_f32_16x16x16_bf16 v[100:103], v[216:217], v[170:171], 0
    s_nop 0
    v_add_u32 v132, s14, v132
    v_add_u32 v131, s14, v131
    v_add_u32 v125, s14, v125
    v_cvt_pk_bf16_f32 v160, v40, v41
    v_mfma_f32_16x16x32_bf16 v[116:119], v[88:91], a[192:195], 0
    v_cvt_pk_bf16_f32 v161, v42, v43
    v_and_b32 v120, -8, v125
    v_mfma_f32_16x16x32_bf16 v[116:119], v[56:59], a[196:199], v[116:119]
    v_rsq_f32 v100, v100
    v_mfma_f32_16x16x32_bf16 v[116:119], v[64:67], a[200:203], v[116:119]
    v_rsq_f32 v101, v101
    v_mfma_f32_16x16x32_bf16 v[116:119], v[24:27], a[204:207], v[116:119]
    ds_read_b128 v[24:27], v132 offset:0
    v_mul_f32 v100, s55, v100
    v_mfma_f32_16x16x32_bf16 v[116:119], v[68:71], a[208:211], v[116:119]
    ds_read_b128 v[68:71], v132 offset:16
    v_mul_f32 v101, 0.5, v101
    v_mfma_f32_16x16x32_bf16 v[116:119], v[28:31], a[212:215], v[116:119]
    s_waitcnt lgkmcnt(3)
    ds_read_b128 v[28:31], v132 offset:48
    v_mul_f32 v72, v72, v101
    v_mfma_f32_16x16x32_bf16 v[32:35], a[216:219], v[60:63], 0
    ds_read_b128 v[88:91], v133 offset:0
    v_mul_f32 v73, v73, v101
    v_mfma_f32_16x16x32_bf16 v[32:35], a[220:223], v[80:83], v[32:35]
    v_cvt_pk_f16_f32 v40, v72, v73
    v_mul_f32 v74, v74, v101
    v_mfma_f32_16x16x32_bf16 v[32:35], a[224:227], v[52:55], v[32:35]
    v_mul_f32 v75, v75, v101
    v_cvt_pk_f16_f32 v41, v74, v75
    v_mfma_f32_16x16x32_bf16 v[32:35], a[228:231], v[112:115], v[32:35]
    v_mul_f32 v20, v20, v101
    v_mul_f32 v21, v21, v101
    v_mfma_f32_16x16x32_bf16 v[32:35], a[232:235], v[108:111], v[32:35]
    s_waitcnt lgkmcnt(4)
    v_cvt_pk_f16_f32 v42, v20, v21
    v_mul_f32 v22, v22, v101
    v_mfma_f32_16x16x32_bf16 v[32:35], a[236:239], v[104:107], v[32:35]
    v_mul_f32 v23, v23, v101
    v_cvt_pk_f16_f32 v43, v22, v23
    v_mfma_f32_16x16x32_bf16 v[20:23], a[240:243], v[60:63], 0
    v_mul_f32 v4, v4, v101
    v_mul_f32 v5, v5, v101
    v_mfma_f32_16x16x32_bf16 v[20:23], a[244:247], v[80:83], v[20:23]
    v_cvt_pk_f16_f32 v142, v4, v5
    v_mul_f32 v6, v6, v101
    v_mfma_f32_16x16x32_bf16 v[20:23], a[248:251], v[52:55], v[20:23]
    v_mul_f32 v7, v7, v101
    v_cvt_pk_f16_f32 v143, v6, v7
    v_mfma_f32_16x16x32_bf16 v[20:23], a[252:255], v[112:115], v[20:23]
    s_waitcnt lgkmcnt(0)
    buffer_load_dwordx4 v130, s[24:27], s56 offen nt lds
    v_mul_f32 v92, v92, v100
    v_mfma_f32_16x16x32_bf16 v[20:23], v[224:227], v[108:111], v[20:23]
    v_mul_f32 v93, v93, v100
    v_cvt_pk_f16_f32 v44, v92, v93
    v_mfma_f32_16x16x32_bf16 v[20:23], v[228:231], v[104:107], v[20:23]
    v_mul_f32 v94, v94, v100
    v_mul_f32 v95, v95, v100
    v_mfma_f32_16x16x32_bf16 v[4:7], v[232:235], v[60:63], 0
    v_cvt_pk_f16_f32 v45, v94, v95
    v_mul_f32 v84, v84, v100
    v_mfma_f32_16x16x32_bf16 v[4:7], v[236:239], v[80:83], v[4:7]
    v_mul_f32 v85, v85, v100
    v_cvt_pk_f16_f32 v46, v84, v85
    v_mfma_f32_16x16x32_bf16 v[4:7], v[240:243], v[52:55], v[4:7]
    v_mul_f32 v86, v86, v100
    v_mul_f32 v87, v87, v100
    v_mfma_f32_16x16x32_bf16 v[4:7], v[244:247], v[112:115], v[4:7]
    v_cvt_pk_f16_f32 v47, v86, v87
    v_mul_f32 v48, v48, v100
    v_mfma_f32_16x16x32_bf16 v[4:7], v[248:251], v[108:111], v[4:7]
    buffer_store_dwordx4 v[88:91], v130, s[28:31], s60 offen sc1
    v_mul_f32 v49, v49, v100
    v_cvt_pk_f16_f32 v140, v48, v49
    v_mul_f32 v50, v50, v100
    v_mul_f32 v51, v51, v100
    v_mfma_f32_16x16x32_bf16 v[4:7], v[252:255], v[104:107], v[4:7]
    s_add_u32 m0, s67, 1024
    v_cvt_pk_f16_f32 v141, v50, v51
    v_cvt_pk_bf16_f32 v156, v116, v117
    v_mfma_f32_16x16x32_f16 v[112:115], v[12:15], v[76:79], v[204:207]
    ds_read_u16 v166, v131 offset:80
    v_cvt_pk_bf16_f32 v157, v118, v119
    v_mfma_f32_16x16x32_f16 v[112:115], v[152:155], v[150:153], v[112:115]
    ds_read_u16 v162, v131 offset:96
    v_mfma_f32_16x16x32_f16 v[108:111], v[36:39], v[76:79], v[200:203]
    s_nop 0
    ds_read_u16 v158, v131 offset:104
    s_nop 0
    v_mfma_f32_16x16x32_f16 v[108:111], v[146:149], v[150:153], v[108:111]
    s_nop 0
    ds_read_b32 v120, v120 offset:64
    v_max3_f32 v124, v112, v113, v114
    v_mfma_f32_16x16x32_f16 v[104:107], v[40:43], v[76:79], v[196:199]
    ds_read_b128 v[48:51], v133 offset:1024
    v_mfma_f32_16x16x32_f16 v[104:107], v[140:143], v[150:153], v[104:107]
    s_nop 0
    ds_read_b128 v[72:75], v137 offset:1536
    v_max3_f32 v124, v124, v115, v108
    v_mfma_f32_16x16x32_f16 v[88:91], v[24:27], v[76:79], v[208:211]
    ds_read_b128 v[76:79], v136 offset:1536
    v_max3_f32 v124, v124, v109, v110
    v_mfma_f32_16x16x32_f16 v[88:91], v[68:71], v[12:15], v[88:91]
    ds_read_b128 v[60:63], v137 offset:1664
    v_max3_f32 v124, v124, v111, v104
    v_mfma_f32_16x16x32_f16 v[88:91], v[28:31], v[152:155], v[88:91]
    ds_read_b128 v[56:59], v136 offset:1664
    v_max3_f32 v124, v124, v105, v106
    v_mfma_f32_16x16x32_f16 v[92:95], v[24:27], v[96:99], v[208:211]
    ds_read_b128 v[64:67], v137 offset:1792
    s_nop 0
    v_mfma_f32_16x16x32_f16 v[92:95], v[68:71], v[36:39], v[92:95]
    s_nop 0
    ds_read_b128 v[80:83], v136 offset:1792
    v_max3_f32 v124, v124, v107, v88
    v_mfma_f32_16x16x32_f16 v[92:95], v[28:31], v[146:149], v[92:95]
    v_mov_b32 v168, v124
    v_mfma_f32_16x16x32_f16 v[84:87], v[24:27], v[44:47], v[208:211]
    s_nop 0
    v_permlane32_swap_b32 v168, v124
    v_mfma_f32_16x16x32_f16 v[84:87], v[68:71], v[40:43], v[84:87]
    s_waitcnt lgkmcnt(6)
    buffer_load_dwordx4 v129, s[24:27], s56 offen nt lds
    v_max_f32 v124, v168, v124
    v_mfma_f32_16x16x32_f16 v[84:87], v[28:31], v[140:143], v[84:87]
    s_waitcnt lgkmcnt(5)
    v_mov_b32 v168, v124
    v_mov_b32_dpp v91, v95 quad_perm:[0,1,2,3] row_mask:0x2 bank_mask:0xf
    v_mfma_f32_16x16x32_bf16 v[24:27], a[216:219], v[72:75], 0
    s_waitcnt lgkmcnt(4)
    v_permlane16_swap_b32 v168, v124
    v_mfma_f32_16x16x32_bf16 v[24:27], a[220:223], v[76:79], v[24:27]
    s_waitcnt lgkmcnt(3)
    v_max_f32 v124, v168, v124
    v_sub_f32 v112, v112, v124
    v_mfma_f32_16x16x32_bf16 v[24:27], a[224:227], v[60:63], v[24:27]
    s_waitcnt lgkmcnt(2)
    v_sub_f32 v113, v113, v124
    v_sub_f32 v114, v114, v124
    v_mfma_f32_16x16x32_bf16 v[24:27], a[228:231], v[56:59], v[24:27]
    s_waitcnt lgkmcnt(1)
    v_sub_f32 v115, v115, v124
    v_sub_f32 v108, v108, v124
    v_mfma_f32_16x16x32_bf16 v[24:27], a[232:235], v[64:67], v[24:27]
    s_waitcnt lgkmcnt(0)
    v_sub_f32 v109, v109, v124
    v_sub_f32 v110, v110, v124
    v_mfma_f32_16x16x32_bf16 v[24:27], a[236:239], v[80:83], v[24:27]
    buffer_store_dwordx4 v[48:51], v129, s[28:31], s60 offen sc1
    ds_read_b128 v[100:103], v133 offset:2048
    v_sub_f32 v111, v111, v124
    v_sub_f32 v104, v104, v124
    v_sub_f32 v105, v105, v124
    v_mfma_f32_16x16x32_f16 v[48:51], v[12:15], v[96:99], v[192:195]
    s_add_u32 m0, s67, 2048
    v_sub_f32 v106, v106, v124
    v_sub_f32 v107, v107, v124
    v_mfma_f32_16x16x32_f16 v[48:51], v[152:155], v[144:147], v[48:51]
    v_sub_f32 v88, v88, v124
    v_mov_b32_dpp v91, v87 quad_perm:[0,1,2,3] row_mask:0x4 bank_mask:0xf
    v_mfma_f32_16x16x32_f16 v[68:71], v[36:39], v[96:99], v[188:191]
    v_exp_f32 v112, v112
    v_mfma_f32_16x16x32_f16 v[68:71], v[146:149], v[144:147], v[68:71]
    v_exp_f32 v113, v113
    v_mfma_f32_16x16x32_f16 v[52:55], v[40:43], v[96:99], v[184:187]
    v_exp_f32 v114, v114
    v_mfma_f32_16x16x32_f16 v[52:55], v[140:143], v[144:147], v[52:55]
    v_exp_f32 v115, v115
    v_mfma_f32_16x16x32_bf16 v[28:31], a[240:243], v[72:75], 0
    v_cvt_pk_bf16_f32 v96, v112, v113
    v_cvt_pk_bf16_f32 v97, v114, v115
    v_mfma_f32_16x16x32_bf16 v[28:31], a[244:247], v[76:79], v[28:31]
    v_exp_f32 v108, v108
    v_mfma_f32_16x16x32_bf16 v[28:31], a[248:251], v[60:63], v[28:31]
    s_waitcnt lgkmcnt(0)
    buffer_load_dwordx4 v128, s[24:27], s56 offen nt lds
    v_and_b32 v124, 0xffff0000, v120
    v_mfma_f32_16x16x32_bf16 v[28:31], a[252:255], v[56:59], v[28:31]
    v_exp_f32 v109, v109
    v_mfma_f32_16x16x32_bf16 v[28:31], v[224:227], v[64:67], v[28:31]
    v_exp_f32 v110, v110
    v_mfma_f32_16x16x32_bf16 v[28:31], v[228:231], v[80:83], v[28:31]
    s_mov_b32 s53, s47
    v_exp_f32 v111, v111
    v_cvt_pk_bf16_f32 v98, v108, v109
    v_cvt_pk_bf16_f32 v99, v110, v111
    v_exp_f32 v104, v104
    v_exp_f32 v105, v105
    v_exp_f32 v106, v106
    v_exp_f32 v107, v107
    v_cvt_pk_bf16_f32 v168, v104, v105
    v_cvt_pk_bf16_f32 v169, v106, v107
    v_exp_f32 v88, v88
    v_lshlrev_b32 v120, 16, v120
    v_cvt_pk_bf16_f32 v170, v88, 0
    v_mfma_f32_16x16x32_bf16 v[112:115], v[220:223], v[96:99], 0
    s_add_u32 m0, s67, 3072
    buffer_store_dwordx4 v[100:103], v128, s[28:31], s60 offen sc1
    v_add_f32 v120, v120, v124
    v_add_f32 v120, v120, v211
    v_max3_f32 v124, v48, v49, v50
    v_max3_f32 v124, v124, v51, v68
    v_mfma_f32_16x16x32_bf16 v[112:115], v[220:223], v[168:171], v[112:115]
    s_mov_b32 s47, s46
    v_mov_b32_dpp v91, v120 quad_perm:[0,1,2,3] row_mask:0x8 bank_mask:0xf
    v_mov_b32 v84, v91
    v_mfma_f32_16x16x32_bf16 v[108:111], v[16:19], v[96:99], 0
    s_mov_b32 s46, s45
    v_max_f32_dpp v84, v84, v84 row_ror:8 row_mask:0xf bank_mask:0xf
    v_max3_f32 v124, v124, v69, v70
    v_mfma_f32_16x16x32_bf16 v[108:111], v[164:167], v[168:171], v[108:111]
    s_mov_b32 s45, s44
    v_max_f32_dpp v84, v84, v84 row_ror:4 row_mask:0xf bank_mask:0xf
    v_max3_f32 v124, v124, v71, v52
    v_mfma_f32_16x16x32_bf16 v[104:107], v[0:3], v[96:99], 0
    s_mov_b32 s44, s53
    v_max_f32_dpp v84, v84, v84 row_ror:2 row_mask:0xf bank_mask:0xf
    v_max3_f32 v124, v124, v53, v54
    v_mfma_f32_16x16x32_bf16 v[104:107], v[160:163], v[168:171], v[104:107]
    s_sub_u32 s48, s44, s46
    v_max_f32_dpp v84, v84, v84 row_ror:1 row_mask:0xf bank_mask:0xf
    v_mov_b32 v85, v84
    v_mfma_f32_16x16x32_bf16 v[100:103], v[8:11], v[96:99], 0
    s_sub_u32 s49, s46, s45
    v_permlane32_swap_b32 v85, v84
    v_mfma_f32_16x16x32_bf16 v[100:103], v[156:159], v[168:171], v[100:103]
    v_max_f32 v84, v85, v84
    v_mov_b32 v85, v84
    v_rcp_f32 v113, v112
    v_max3_f32 v124, v124, v55, v93
    v_permlane16_swap_b32 v85, v84
    v_max_f32 v84, v85, v84
    v_sub_f32 v91, v91, v84
    v_exp_f32 v91, v91
    v_mul_f32 v108, v108, v113
    v_cvt_pk_bf16_f32 v91, v91, v91
    ds_write_b16 v125, v91 offset:64
    v_mul_f32 v109, v109, v113
    v_cvt_pk_bf16_f32 v88, v108, v109
    ds_read_b128 v[94:97], v132 offset:48
    v_mul_f32 v110, v110, v113
    v_mul_f32 v111, v111, v113
    v_cvt_pk_bf16_f32 v89, v110, v111
    ds_read_b128 v[114:117], v132 offset:64
    v_mfma_f32_16x16x32_bf16 v[108:111], v[232:235], v[72:75], 0
    v_mul_f32 v104, v104, v113
    v_mul_f32 v105, v105, v113
    v_mfma_f32_16x16x32_bf16 v[108:111], v[236:239], v[76:79], v[108:111]
    ds_write_b64 v135, v[88:89] offset:0
    v_mfma_f32_16x16x32_bf16 v[108:111], v[240:243], v[60:63], v[108:111]
    v_cvt_pk_bf16_f32 v90, v104, v105
    v_mul_f32 v106, v106, v113
    v_mfma_f32_16x16x32_bf16 v[108:111], v[244:247], v[56:59], v[108:111]
    v_mul_f32 v107, v107, v113
    v_cvt_pk_bf16_f32 v91, v106, v107
    v_mfma_f32_16x16x32_bf16 v[108:111], v[248:251], v[64:67], v[108:111]
    ds_write_b64 v135, v[90:91] offset:8
    v_mfma_f32_16x16x32_bf16 v[108:111], v[252:255], v[80:83], v[108:111]
    s_waitcnt lgkmcnt(3)
    v_mul_f32 v100, v100, v113
    v_mul_f32 v101, v101, v113
    v_cvt_pk_bf16_f32 v168, v100, v101
    v_mul_f32 v102, v102, v113
    v_mfma_f32_16x16x32_bf16 v[72:75], v[94:97], v[16:19], 0
    s_waitcnt lgkmcnt(2)
    v_mul_f32 v103, v103, v113
    v_cvt_pk_bf16_f32 v169, v102, v103
    v_mov_b32 v170, v124
    v_fma_f32 v92, v32, v32, s42
    v_mfma_f32_16x16x32_bf16 v[72:75], v[114:117], v[164:167], v[72:75]
    ds_write_b64 v134, v[168:169] offset:0
    v_mfma_f32_16x16x32_bf16 v[88:91], v[94:97], v[0:3], 0
    v_permlane32_swap_b32 v170, v124
    v_mfma_f32_16x16x32_bf16 v[88:91], v[114:117], v[160:163], v[88:91]
    v_max_f32 v124, v170, v124
    v_mov_b32 v170, v124
    v_mfma_f32_16x16x32_bf16 v[76:79], v[94:97], v[8:11], 0
    s_nop 0
    v_permlane16_swap_b32 v170, v124
    v_mfma_f32_16x16x32_bf16 v[76:79], v[114:117], v[156:159], v[76:79]
    ds_read_b128 v[60:63], v133 offset:3072
    v_max_f32 v124, v170, v124
    v_sub_f32 v48, v48, v124
    v_sub_f32 v49, v49, v124
    v_sub_f32 v50, v50, v124
    v_sub_f32 v51, v51, v124
    v_sub_f32 v68, v68, v124
    v_sub_f32 v69, v69, v124
    v_sub_f32 v70, v70, v124
    v_sub_f32 v71, v71, v124
    v_sub_f32 v52, v52, v124
    v_sub_f32 v53, v53, v124
    v_sub_f32 v54, v54, v124
    v_sub_f32 v55, v55, v124
    v_sub_f32 v93, v93, v124
    v_exp_f32 v48, v48
    v_exp_f32 v49, v49
    v_exp_f32 v50, v50
    v_exp_f32 v51, v51
    v_cvt_pk_bf16_f32 v56, v48, v49
    v_cvt_pk_bf16_f32 v57, v50, v51
    v_exp_f32 v68, v68
    v_exp_f32 v69, v69
    v_exp_f32 v70, v70
    v_exp_f32 v71, v71
    v_cvt_pk_bf16_f32 v58, v68, v69
    v_cvt_pk_bf16_f32 v59, v70, v71
    v_exp_f32 v52, v52
    v_exp_f32 v53, v53
    v_exp_f32 v54, v54
    v_exp_f32 v55, v55
    v_cvt_pk_bf16_f32 v168, v52, v53
    v_cvt_pk_bf16_f32 v169, v54, v55
    v_exp_f32 v93, v93
    v_mov_b32_dpp v75, v91 quad_perm:[0,1,2,3] row_mask:0x2 bank_mask:0xf
    v_cvt_pk_bf16_f32 v170, v93, 0
    v_mfma_f32_16x16x32_bf16 v[88:91], v[220:223], v[56:59], 0
    s_waitcnt lgkmcnt(0)
    buffer_load_dwordx4 v127, s[24:27], s56 offen nt lds
    ds_read_b128 v[64:67], v137 offset:3072
    v_mfma_f32_16x16x32_bf16 v[88:91], v[220:223], v[168:171], v[88:91]
    v_mov_b32_dpp v75, v79 quad_perm:[0,1,2,3] row_mask:0x4 bank_mask:0xf
    v_cvt_pk_bf16_f32 v75, v75, v75
    v_mfma_f32_16x16x32_bf16 v[76:79], v[16:19], v[56:59], 0
    ds_write_b16 v131, v75
    v_mfma_f32_16x16x32_bf16 v[76:79], v[164:167], v[168:171], v[76:79]
    ds_read_b128 v[72:75], v136 offset:3072
    v_fmac_f32 v92, v33, v33
    v_mfma_f32_16x16x32_bf16 v[80:83], v[0:3], v[56:59], 0
    ds_read_b128 v[48:51], v137 offset:3200
    v_fmac_f32 v92, v34, v34
    v_mfma_f32_16x16x32_bf16 v[80:83], v[160:163], v[168:171], v[80:83]
    ds_read_b128 v[68:71], v136 offset:3200
    v_fmac_f32 v92, v35, v35
    v_mfma_f32_16x16x32_bf16 v[52:55], v[8:11], v[56:59], 0
    ds_read_b128 v[56:59], v137 offset:3328
    v_add_u32 v137, s48, v137
    v_mfma_f32_16x16x32_bf16 v[52:55], v[156:159], v[168:171], v[52:55]
    buffer_store_dwordx4 v[60:63], v127, s[28:31], s60 offen sc1
    ds_read_b128 v[94:97], v136 offset:3328
    v_rcp_f32 v89, v88
    v_add_u32 v136, s48, v136
    v_mfma_f32_16x16x32_f16 v[60:63], v[12:15], v[44:47], v[180:183]
    s_add_u32 m0, s67, 4096
    ds_read_b128 v[12:15], v133 offset:4096
    v_mul_f32 v76, v76, v89
    v_mfma_f32_16x16x32_f16 v[60:63], v[152:155], v[138:141], v[60:63]
    s_cmp_lg_u32 s5, -1
    v_mul_f32 v77, v77, v89
    v_cvt_pk_bf16_f32 v76, v76, v77
    v_mfma_f32_16x16x32_f16 v[152:155], v[36:39], v[44:47], v[176:179]
    v_mul_f32 v78, v78, v89
    v_mul_f32 v79, v79, v89
    v_mfma_f32_16x16x32_f16 v[152:155], v[146:149], v[138:141], v[152:155]
    v_cvt_pk_bf16_f32 v77, v78, v79
    v_mul_f32 v80, v80, v89
    v_mfma_f32_16x16x32_f16 v[36:39], v[40:43], v[44:47], v[172:175]
    ds_write_b64 v135, v[76:77] offset:1536
    v_mfma_f32_16x16x32_f16 v[36:39], v[140:143], v[138:141], v[36:39]
    s_waitcnt lgkmcnt(4)
    v_mul_f32 v81, v81, v89
    v_cvt_pk_bf16_f32 v78, v80, v81
    v_mfma_f32_16x16x32_bf16 v[40:43], a[216:219], v[64:67], 0
    v_mul_f32 v82, v82, v89
    v_mul_f32 v83, v83, v89
    v_mfma_f32_16x16x32_bf16 v[40:43], a[220:223], v[72:75], v[40:43]
    v_cvt_pk_bf16_f32 v79, v82, v83
    v_mul_f32 v52, v52, v89
    v_mfma_f32_16x16x32_bf16 v[40:43], a[224:227], v[48:51], v[40:43]
    ds_write_b64 v135, v[78:79] offset:1544
    v_mfma_f32_16x16x32_bf16 v[40:43], a[228:231], v[68:71], v[40:43]
    s_waitcnt lgkmcnt(2)
    buffer_load_dwordx4 v126, s[24:27], s56 offen nt lds
    v_mul_f32 v53, v53, v89
    v_mfma_f32_16x16x32_bf16 v[40:43], a[232:235], v[56:59], v[40:43]
    v_cvt_pk_bf16_f32 v168, v52, v53
    v_mul_f32 v54, v54, v89
    v_mfma_f32_16x16x32_bf16 v[40:43], a[236:239], v[94:97], v[40:43]
    v_mul_f32 v55, v55, v89
    v_cvt_pk_bf16_f32 v169, v54, v55
    v_mfma_f32_16x16x32_bf16 v[140:143], a[240:243], v[64:67], 0
    ds_write_b64 v134, v[168:169] offset:1536
    v_mfma_f32_16x16x32_bf16 v[140:143], a[244:247], v[72:75], v[140:143]
    v_max3_f32 v168, v60, v61, v62
    v_max3_f32 v168, v168, v63, v152
    v_mfma_f32_16x16x32_bf16 v[140:143], a[248:251], v[48:51], v[140:143]
    v_max3_f32 v168, v168, v153, v154
    v_max3_f32 v168, v168, v155, v36
    v_mfma_f32_16x16x32_bf16 v[140:143], a[252:255], v[68:71], v[140:143]
    v_max3_f32 v168, v168, v37, v38
    v_max3_f32 v168, v168, v39, v86
    v_mfma_f32_16x16x32_bf16 v[140:143], v[224:227], v[56:59], v[140:143]
    buffer_store_dwordx4 v[12:15], v126, s[28:31], s60 offen sc1
    v_mov_b32 v169, v168
    v_fmac_f32 v92, v20, v20
    v_fmac_f32 v92, v21, v21
    v_fmac_f32 v92, v22, v22
    v_mfma_f32_16x16x32_bf16 v[140:143], v[228:231], v[94:97], v[140:143]
    ds_read_b128 v[12:15], v137 offset:0
    v_fmac_f32 v92, v23, v23
    v_mfma_f32_16x16x32_bf16 v[44:47], v[232:235], v[64:67], 0
    ds_read_b128 v[146:149], v136 offset:0
    v_fmac_f32 v92, v4, v4
    v_mfma_f32_16x16x32_bf16 v[44:47], v[236:239], v[72:75], v[44:47]
    ds_read_b128 v[72:75], v137 offset:128
    v_fmac_f32 v92, v5, v5
    v_mfma_f32_16x16x32_bf16 v[44:47], v[240:243], v[48:51], v[44:47]
    ds_read_b128 v[88:91], v136 offset:128
    v_fmac_f32 v92, v6, v6
    v_mfma_f32_16x16x32_bf16 v[44:47], v[244:247], v[68:71], v[44:47]
    ds_read_b128 v[76:79], v137 offset:256
    v_fmac_f32 v92, v7, v7
    v_mfma_f32_16x16x32_bf16 v[44:47], v[248:251], v[56:59], v[44:47]
    ds_read_b128 v[56:59], v136 offset:256
    v_fma_f32 v93, v24, v24, s42
    v_mfma_f32_16x16x32_bf16 v[44:47], v[252:255], v[94:97], v[44:47]
    v_permlane32_swap_b32 v169, v168
    v_max_f32 v168, v169, v168
    v_mov_b32 v169, v168
    v_fmac_f32 v93, v25, v25
    v_fmac_f32 v93, v26, v26
    v_permlane16_swap_b32 v169, v168
    v_max_f32 v168, v169, v168
    v_sub_f32 v60, v60, v168
    v_sub_f32 v61, v61, v168
    v_sub_f32 v62, v62, v168
    v_sub_f32 v63, v63, v168
    v_sub_f32 v152, v152, v168
    v_sub_f32 v153, v153, v168
    v_sub_f32 v154, v154, v168
    v_sub_f32 v155, v155, v168
    v_sub_f32 v36, v36, v168
    v_sub_f32 v37, v37, v168
    v_sub_f32 v38, v38, v168
    v_sub_f32 v39, v39, v168
    v_sub_f32 v86, v86, v168
    v_exp_f32 v60, v60
    v_exp_f32 v61, v61
    v_exp_f32 v62, v62
    v_exp_f32 v63, v63
    v_cvt_pk_bf16_f32 v60, v60, v61
    v_cvt_pk_bf16_f32 v61, v62, v63
    v_exp_f32 v152, v152
    v_exp_f32 v153, v153
    v_exp_f32 v154, v154
    v_exp_f32 v155, v155
    v_cvt_pk_bf16_f32 v62, v152, v153
    v_cvt_pk_bf16_f32 v63, v154, v155
    v_exp_f32 v36, v36
    v_exp_f32 v37, v37
    v_exp_f32 v38, v38
    v_exp_f32 v39, v39
    v_cvt_pk_bf16_f32 v168, v36, v37
    v_cvt_pk_bf16_f32 v169, v38, v39
    v_exp_f32 v86, v86
    v_fmac_f32 v93, v27, v27
    v_cvt_pk_bf16_f32 v170, v86, 0
    v_mfma_f32_16x16x32_bf16 v[152:155], v[220:223], v[60:63], 0
    v_fmac_f32 v93, v28, v28
    v_fmac_f32 v93, v29, v29
    v_mfma_f32_16x16x32_bf16 v[152:155], v[220:223], v[168:171], v[152:155]
    v_fmac_f32 v93, v30, v30
    v_fmac_f32 v93, v31, v31
    v_mfma_f32_16x16x32_bf16 v[36:39], v[16:19], v[60:63], 0
    s_nop 0
    v_fmac_f32 v93, v108, v108
    v_fmac_f32 v93, v109, v109
    v_mfma_f32_16x16x32_bf16 v[36:39], v[164:167], v[168:171], v[36:39]
    s_nop 0
    v_rcp_f32 v153, v152
    v_mfma_f32_16x16x32_bf16 v[16:19], v[0:3], v[60:63], 0
    s_nop 0
    v_fmac_f32 v93, v110, v110
    v_fmac_f32 v93, v111, v111
    v_mfma_f32_16x16x32_bf16 v[16:19], v[160:163], v[168:171], v[16:19]
    s_nop 0
    v_mul_f32 v36, v36, v153
    v_mul_f32 v37, v37, v153
    v_mfma_f32_16x16x32_bf16 v[0:3], v[8:11], v[60:63], 0
    v_cvt_pk_bf16_f32 v8, v36, v37
    v_mul_f32 v38, v38, v153
    v_mfma_f32_16x16x32_bf16 v[0:3], v[156:159], v[168:171], v[0:3]
    s_waitcnt lgkmcnt(0)
    v_mul_f32 v39, v39, v153
    v_cvt_pk_bf16_f32 v9, v38, v39
    v_mfma_f32_16x16x32_bf16 v[36:39], a[0:3], v[12:15], 0
    s_cbranch_scc1 L_loopS0
    ds_write_b64 v135, v[8:9] offset:3072
    v_mul_f32 v16, v16, v153
    v_mul_f32 v17, v17, v153
    v_cvt_pk_bf16_f32 v10, v16, v17
    v_mul_f32 v18, v18, v153
    v_mul_f32 v19, v19, v153
    v_cvt_pk_bf16_f32 v11, v18, v19
    v_mul_f32 v0, v0, v153
    v_mul_f32 v1, v1, v153
    v_cvt_pk_bf16_f32 v0, v0, v1
    v_mul_f32 v2, v2, v153
    v_mul_f32 v3, v3, v153
    v_cvt_pk_bf16_f32 v1, v2, v3
    s_mov_b32 s30, 100270464
    s_mul_i32 s89, s68, 7168
    ds_write_b64 v135, v[10:11] offset:3080
    v_fma_f32 v125, v40, v40, s42
    s_add_u32 s89, s89, 135168
    s_movk_i32 s90, 112
    ds_write_b64 v134, v[0:1] offset:3072
    v_fmac_f32 v125, v41, v41
    v_fmac_f32 v125, v42, v42
    v_fmac_f32 v125, v43, v43
    v_fmac_f32 v125, v140, v140
    v_fmac_f32 v125, v141, v141
    v_fmac_f32 v125, v142, v142
    v_fmac_f32 v125, v143, v143
    v_fmac_f32 v125, v44, v44
    v_fmac_f32 v125, v45, v45
    v_fmac_f32 v125, v46, v46
    v_fmac_f32 v125, v47, v47
    v_cvt_pk_bf16_f32 v124, v92, v93
    v_cvt_pk_bf16_f32 v125, v125, v167
    s_lshr_b32 s91, s64, 16
    s_sub_u32 s84, s45, s44
    ds_write_b64 v159, v[124:125]
    v_mbcnt_lo_u32_b32 v131, -1, 0
    v_mbcnt_hi_u32_b32 v131, -1, v131
    v_and_b32 v132, 15, v131
    v_lshrrev_b32 v131, 4, v131
    v_mul_u32_u24 v18, 1792, v131
    v_add_u32 v18, s89, v18
    v_mad_u32_u24 v131, v132, s90, v18
    v_lshrrev_b32 v124, v132, s64
    v_and_b32 v124, 1, v124
    v_cmp_eq_u32 vcc, 1, v124
    v_mad_u32_u24 v60, v132, s90, v18
    v_lshrrev_b32 v19, v132, s91
    v_cndmask_b32 v131, v18, v131, vcc
    s_sub_u32 s85, s46, s45
    s_sub_u32 s86, s44, s45
    ds_read_b128 v[52:55], v131 offset:64
    ds_read_b128 v[0:3], v131 offset:80
    v_and_b32 v19, 1, v19
    v_subrev_u32 v60, 28672, v60
    s_sub_u32 s93, s44, s47
    s_sub_u32 s94, s45, s47
    ds_read_b128 v[12:15], v131
    s_waitcnt lgkmcnt(3)
    s_barrier
    ds_read_b64 v[16:17], v131 offset:16
    ds_read_b128 v[48:51], v163 offset:0
    ds_read_b128 v[36:39], v163 offset:1024
    v_cmp_eq_u32 vcc, 1, v19
    v_add_u32 v131, s84, v137
    v_add_u32 v132, s84, v136
    v_cndmask_b32 v60, v18, v60, vcc
    s_sub_u32 s95, s46, s47
    s_waitcnt lgkmcnt(5)
    v_mfma_f32_16x16x32_bf16 v[8:11], v[220:223], v[52:55], 0
    s_waitcnt lgkmcnt(4)
    s_lshl_b32 s92, s68, 10
    ds_read_b128 a[24:27], v131 offset:1536
    ds_read_b128 a[32:35], v131 offset:1664
    v_mfma_f32_16x16x32_bf16 v[8:11], v[220:223], v[0:3], v[8:11]
    s_waitcnt lgkmcnt(5)
    ds_read_b128 a[40:43], v131 offset:1792
    v_lshlrev_b32 v125, 16, v12
    v_and_b32 v12, 0xffff0000, v12
    v_lshlrev_b32 v124, 16, v13
    v_and_b32 v13, 0xffff0000, v13
    v_lshlrev_b32 v19, 16, v14
    v_and_b32 v14, 0xffff0000, v14
    v_rcp_f32 v9, v8
    v_lshlrev_b32 v18, 16, v15
    v_mul_f32 v125, v125, v9
    s_waitcnt lgkmcnt(4)
    v_mfma_f32_16x16x32_bf16 v[0:3], v[216:219], v[48:51], 0
    s_waitcnt lgkmcnt(3)
    ds_read_b128 a[28:31], v132 offset:1536
    ds_read_b128 a[36:39], v132 offset:1664
    v_mfma_f32_16x16x32_bf16 v[0:3], v[216:219], v[36:39], v[0:3]
    s_waitcnt lgkmcnt(4)
    ds_read_b128 a[44:47], v132 offset:1792
    v_mul_f32 v12, v12, v9
    v_cvt_pk_bf16_f32 v12, v125, v12
    v_mul_f32 v124, v124, v9
    v_mfma_f32_16x16x32_bf16 v[48:51], a[216:219], a[24:27], 0
    v_mul_f32 v13, v13, v9
    v_cvt_pk_bf16_f32 v13, v124, v13
    v_mul_f32 v19, v19, v9
    v_mul_f32 v14, v14, v9
    v_cvt_pk_bf16_f32 v14, v19, v14
    v_and_b32 v15, 0xffff0000, v15
    v_mul_f32 v18, v18, v9
    v_mul_f32 v15, v15, v9
    v_cvt_pk_bf16_f32 v15, v18, v15
    v_lshlrev_b32 v3, 16, v16
    v_and_b32 v16, 0xffff0000, v16
    v_mul_f32 v3, v3, v9
    v_mul_f32 v16, v16, v9
    v_cvt_pk_bf16_f32 v124, v3, v16
    v_lshlrev_b32 v3, 16, v17
    s_waitcnt lgkmcnt(2)
    v_mfma_f32_16x16x32_bf16 v[48:51], a[220:223], a[28:31], v[48:51]
    ds_read_b128 a[0:3], v131 offset:0
    ds_read_b128 a[4:7], v132 offset:0
    v_mfma_f32_16x16x32_bf16 v[48:51], a[224:227], a[32:35], v[48:51]
    s_waitcnt lgkmcnt(3)
    ds_read_b128 a[8:11], v131 offset:128
    v_and_b32 v17, 0xffff0000, v17
    v_mfma_f32_16x16x32_bf16 v[48:51], a[228:231], a[36:39], v[48:51]
    ds_read_b128 a[12:15], v132 offset:128
    v_mul_f32 v3, v3, v9
    v_mfma_f32_16x16x32_bf16 v[48:51], a[232:235], a[40:43], v[48:51]
    s_waitcnt lgkmcnt(4)
    ds_read_b128 a[16:19], v131 offset:256
    v_mul_f32 v17, v17, v9
    v_mfma_f32_16x16x32_bf16 v[48:51], a[236:239], a[44:47], v[48:51]
    ds_read_b128 a[20:23], v132 offset:256
    v_cvt_pk_bf16_f32 v125, v3, v17
    v_mfma_f32_16x16x32_bf16 v[16:19], a[240:243], a[24:27], 0
    v_rsq_f32 v0, v0
    v_mfma_f32_16x16x32_bf16 v[16:19], a[244:247], a[28:31], v[16:19]
    v_mul_f32 v0, s43, v0
    v_mul_f32 v32, v32, v0
    v_mfma_f32_16x16x32_bf16 v[16:19], a[248:251], a[32:35], v[16:19]
    v_mul_f32 v33, v33, v0
    v_cvt_pk_bf16_f32 v32, v32, v33
    v_mfma_f32_16x16x32_bf16 v[16:19], a[252:255], a[36:39], v[16:19]
    v_mul_f32 v34, v34, v0
    v_mul_f32 v35, v35, v0
    v_mfma_f32_16x16x32_bf16 v[16:19], v[224:227], a[40:43], v[16:19]
    v_cvt_pk_bf16_f32 v33, v34, v35
    v_mul_f32 v20, v20, v0
    v_mfma_f32_16x16x32_bf16 v[16:19], v[228:231], a[44:47], v[16:19]
    v_mul_f32 v21, v21, v0
    v_cvt_pk_bf16_f32 v34, v20, v21
    v_mfma_f32_16x16x32_bf16 v[8:11], v[232:235], a[24:27], 0
    v_mul_f32 v22, v22, v0
    v_mul_f32 v23, v23, v0
    v_mfma_f32_16x16x32_bf16 v[8:11], v[236:239], a[28:31], v[8:11]
    v_cvt_pk_bf16_f32 v35, v22, v23
    v_mul_f32 v4, v4, v0
    v_mfma_f32_16x16x32_bf16 v[8:11], v[240:243], a[32:35], v[8:11]
    v_mul_f32 v5, v5, v0
    v_cvt_pk_bf16_f32 v4, v4, v5
    v_mfma_f32_16x16x32_bf16 v[8:11], v[244:247], a[36:39], v[8:11]
    v_mul_f32 v6, v6, v0
    v_mul_f32 v7, v7, v0
    v_mfma_f32_16x16x32_bf16 v[8:11], v[248:251], a[40:43], v[8:11]
    v_cvt_pk_bf16_f32 v5, v6, v7
    v_add_u32 v0, s85, v135
    v_mfma_f32_16x16x32_bf16 v[8:11], v[252:255], a[44:47], v[8:11]
    s_waitcnt lgkmcnt(0)
    ds_write_b128 v0, v[32:35] offset:0
    v_mfma_f32_16x16x32_bf16 v[52:55], a[216:219], a[0:3], 0
    v_rsq_f32 v1, v1
    v_mfma_f32_16x16x32_bf16 v[52:55], a[220:223], a[4:7], v[52:55]
    ds_read_b128 a[48:51], v131 offset:3072
    v_mul_f32 v1, s43, v1
    v_mfma_f32_16x16x32_bf16 v[52:55], a[224:227], a[8:11], v[52:55]
    ds_read_b128 a[52:55], v132 offset:3072
    v_add_u32 v63, s85, v134
    v_mfma_f32_16x16x32_bf16 v[52:55], a[228:231], a[12:15], v[52:55]
    ds_write_b64 v63, v[4:5] offset:0
    v_mfma_f32_16x16x32_bf16 v[52:55], a[232:235], a[16:19], v[52:55]
    v_rsq_f32 v2, v2
    v_mfma_f32_16x16x32_bf16 v[52:55], a[236:239], a[20:23], v[52:55]
    ds_read_b128 a[56:59], v131 offset:3200
    ds_read_b128 a[60:63], v132 offset:3200
    v_mfma_f32_16x16x32_bf16 v[20:23], a[240:243], a[0:3], 0
    v_mul_f32 v2, s43, v2
    v_mul_f32 v40, v40, v2
    v_mfma_f32_16x16x32_bf16 v[20:23], a[244:247], a[4:7], v[20:23]
    ds_read_b128 a[64:67], v131 offset:3328
    ds_read_b128 a[68:71], v132 offset:3328
    v_mfma_f32_16x16x32_bf16 v[20:23], a[248:251], a[8:11], v[20:23]
    v_mul_f32 v41, v41, v2
    v_cvt_pk_bf16_f32 v32, v40, v41
    v_mfma_f32_16x16x32_bf16 v[20:23], a[252:255], a[12:15], v[20:23]
    v_mul_f32 v42, v42, v2
    v_mul_f32 v43, v43, v2
    v_mfma_f32_16x16x32_bf16 v[20:23], v[224:227], a[16:19], v[20:23]
    v_cvt_pk_bf16_f32 v33, v42, v43
    v_mul_f32 v140, v140, v2
    v_mfma_f32_16x16x32_bf16 v[20:23], v[228:231], a[20:23], v[20:23]
    v_mul_f32 v141, v141, v2
    v_cvt_pk_bf16_f32 v34, v140, v141
    v_mfma_f32_16x16x32_bf16 v[4:7], v[232:235], a[0:3], 0
    v_mul_f32 v142, v142, v2
    v_mul_f32 v143, v143, v2
    v_mfma_f32_16x16x32_bf16 v[4:7], v[236:239], a[4:7], v[4:7]
    v_cvt_pk_bf16_f32 v35, v142, v143
    v_mul_f32 v44, v44, v2
    v_mfma_f32_16x16x32_bf16 v[4:7], v[240:243], a[8:11], v[4:7]
    ds_write_b128 v0, v[32:35] offset:3072
    v_mfma_f32_16x16x32_bf16 v[4:7], v[244:247], a[12:15], v[4:7]
    v_mul_f32 v45, v45, v2
    v_cvt_pk_bf16_f32 v44, v44, v45
    v_mfma_f32_16x16x32_bf16 v[4:7], v[248:251], a[16:19], v[4:7]
    v_mul_f32 v46, v46, v2
    v_mul_f32 v47, v47, v2
    v_mfma_f32_16x16x32_bf16 v[4:7], v[252:255], a[20:23], v[4:7]
    s_waitcnt lgkmcnt(1)
    v_cvt_pk_bf16_f32 v45, v46, v47
    v_add_u32 v138, s86, v135
    v_mfma_f32_16x16x32_bf16 v[32:35], a[216:219], a[48:51], 0
    ds_write_b64 v63, v[44:45] offset:3072
    v_mfma_f32_16x16x32_bf16 v[32:35], a[220:223], a[52:55], v[32:35]
    ds_write_b128 v138, v[12:15] offset:0
    v_mfma_f32_16x16x32_bf16 v[32:35], a[224:227], a[56:59], v[32:35]
    v_add_u32 v132, s86, v134
    v_add_u32 v131, s93, v133
    v_mfma_f32_16x16x32_bf16 v[32:35], a[228:231], a[60:63], v[32:35]
    v_add_u32 v139, s94, v133
    v_add_u32 v3, s95, v133
    v_mfma_f32_16x16x32_bf16 v[32:35], a[232:235], a[64:67], v[32:35]
    ds_write_b64 v132, v[124:125] offset:0
    v_mfma_f32_16x16x32_bf16 v[32:35], a[236:239], a[68:71], v[32:35]
    ds_read_b128 v[64:67], v60 offset:64
    v_fma_f32 v62, v52, v52, s42
    v_mfma_f32_16x16x32_bf16 v[40:43], a[240:243], a[48:51], 0
    ds_read_b128 v[44:47], v60 offset:80
    v_fmac_f32 v62, v53, v53
    v_mfma_f32_16x16x32_bf16 v[40:43], a[244:247], a[52:55], v[40:43]
    ds_read_b128 v[56:59], v60
    v_fmac_f32 v62, v54, v54
    v_mfma_f32_16x16x32_bf16 v[40:43], a[248:251], a[56:59], v[40:43]
    ds_read_b64 v[60:61], v60 offset:16
    v_fmac_f32 v62, v55, v55
    v_mfma_f32_16x16x32_bf16 v[40:43], a[252:255], a[60:63], v[40:43]
    v_fmac_f32 v62, v20, v20
    v_fmac_f32 v62, v21, v21
    v_mfma_f32_16x16x32_bf16 v[40:43], v[224:227], a[64:67], v[40:43]
    v_fmac_f32 v62, v22, v22
    v_fmac_f32 v62, v23, v23
    v_mfma_f32_16x16x32_bf16 v[40:43], v[228:231], a[68:71], v[40:43]
    v_fmac_f32 v62, v4, v4
    v_fmac_f32 v62, v5, v5
    v_mfma_f32_16x16x32_bf16 v[12:15], v[232:235], a[48:51], 0
    v_fmac_f32 v62, v6, v6
    v_fmac_f32 v62, v7, v7
    v_mfma_f32_16x16x32_bf16 v[12:15], v[236:239], a[52:55], v[12:15]
    v_mul_f32 v24, v24, v1
    v_mul_f32 v25, v25, v1
    v_mfma_f32_16x16x32_bf16 v[12:15], v[240:243], a[56:59], v[12:15]
    v_cvt_pk_bf16_f32 v24, v24, v25
    v_mul_f32 v26, v26, v1
    v_mfma_f32_16x16x32_bf16 v[12:15], v[244:247], a[60:63], v[12:15]
    v_mul_f32 v27, v27, v1
    v_cvt_pk_bf16_f32 v25, v26, v27
    v_mfma_f32_16x16x32_bf16 v[12:15], v[248:251], a[64:67], v[12:15]
    v_mul_f32 v28, v28, v1
    v_mul_f32 v29, v29, v1
    v_mfma_f32_16x16x32_bf16 v[12:15], v[252:255], a[68:71], v[12:15]
    s_waitcnt lgkmcnt(0)
    v_cvt_pk_bf16_f32 v26, v28, v29
    v_mul_f32 v30, v30, v1
    v_mfma_f32_16x16x32_bf16 v[36:39], v[220:223], v[64:67], 0
    v_mul_f32 v31, v31, v1
    v_cvt_pk_bf16_f32 v27, v30, v31
    v_mfma_f32_16x16x32_bf16 v[36:39], v[220:223], v[44:47], v[36:39]
    ds_write_b128 v0, v[24:27] offset:1536
    v_mul_f32 v108, v108, v1
    v_mul_f32 v109, v109, v1
    v_cvt_pk_bf16_f32 v108, v108, v109
    v_mul_f32 v110, v110, v1
    v_mul_f32 v111, v111, v1
    v_cvt_pk_bf16_f32 v109, v110, v111
    ds_write_b64 v63, v[108:109] offset:1536
    v_fma_f32 v63, v32, v32, s42
    v_fmac_f32 v63, v33, v33
    v_fmac_f32 v63, v34, v34
    v_fmac_f32 v63, v35, v35
    v_fmac_f32 v63, v40, v40
    v_fmac_f32 v63, v41, v41
    v_fmac_f32 v63, v42, v42
    v_fmac_f32 v63, v43, v43
    v_fmac_f32 v63, v12, v12
    v_fmac_f32 v63, v13, v13
    v_fmac_f32 v63, v14, v14
    v_fmac_f32 v63, v15, v15
    v_cvt_pk_bf16_f32 v63, v63, v63
    v_fma_f32 v133, v48, v48, s42
    v_fmac_f32 v133, v49, v49
    v_fmac_f32 v133, v50, v50
    v_fmac_f32 v133, v51, v51
    v_fmac_f32 v133, v16, v16
    v_fmac_f32 v133, v17, v17
    v_fmac_f32 v133, v18, v18
    v_fmac_f32 v133, v19, v19
    v_fmac_f32 v133, v8, v8
    v_fmac_f32 v133, v9, v9
    v_fmac_f32 v133, v10, v10
    v_fmac_f32 v133, v11, v11
    v_cvt_pk_bf16_f32 v62, v62, v133
    ds_write_b64 v159, v[62:63] offset:2048
    v_rcp_f32 v37, v36
    v_lshlrev_b32 v133, 16, v56
    v_and_b32 v56, 0xffff0000, v56
    v_mul_f32 v133, v133, v37
    v_mul_f32 v56, v56, v37
    v_cvt_pk_bf16_f32 v24, v133, v56
    v_lshlrev_b32 v56, 16, v57
    v_and_b32 v57, 0xffff0000, v57
    v_mul_f32 v56, v56, v37
    v_mul_f32 v57, v57, v37
    v_cvt_pk_bf16_f32 v25, v56, v57
    v_lshlrev_b32 v133, 16, v58
    v_and_b32 v58, 0xffff0000, v58
    v_mul_f32 v133, v133, v37
    v_mul_f32 v58, v58, v37
    v_cvt_pk_bf16_f32 v26, v133, v58
    v_lshlrev_b32 v27, 16, v59
    v_and_b32 v59, 0xffff0000, v59
    v_mul_f32 v27, v27, v37
    v_mul_f32 v59, v59, v37
    v_cvt_pk_bf16_f32 v27, v27, v59
    v_lshlrev_b32 v133, 16, v60
    v_and_b32 v60, 0xffff0000, v60
    v_mul_f32 v133, v133, v37
    v_mul_f32 v60, v60, v37
    v_cvt_pk_bf16_f32 v0, v133, v60
    v_lshlrev_b32 v133, 16, v61
    v_and_b32 v61, 0xffff0000, v61
    v_mul_f32 v133, v133, v37
    v_mul_f32 v61, v61, v37
    v_cvt_pk_bf16_f32 v1, v133, v61
    s_waitcnt lgkmcnt(0)
    s_barrier
    ds_write_b128 v138, v[24:27] offset:1536
    v_mov_b32 v125, 0
    v_add_u32 v47, s92, v163
    ds_write_b64 v132, v[0:1] offset:1536
    ds_read_b128 v[28:31], v163 offset:2048
    ds_read_b128 v[24:27], v163 offset:3072
    ds_read_b128 a[144:147], v3 offset:0
    ds_read_b128 a[148:151], v3 offset:1024
    ds_read_b128 a[152:155], v3 offset:2048
    s_waitcnt lgkmcnt(5)
    s_barrier
    s_waitcnt lgkmcnt(4)
    v_mfma_f32_16x16x32_bf16 v[36:39], v[216:219], v[28:31], 0
    s_waitcnt lgkmcnt(3)
    ds_read_b128 a[72:75], v137 offset:0
    ds_read_b128 a[76:79], v136 offset:0
    v_mfma_f32_16x16x32_bf16 v[36:39], v[216:219], v[24:27], v[36:39]
    s_waitcnt lgkmcnt(4)
    ds_read_b128 a[80:83], v137 offset:128
    s_nop 0
    buffer_store_dwordx4 a[144:147], v130, s[28:31], s59 offen sc1
    s_nop 0
    ds_read_b128 a[84:87], v136 offset:128
    s_nop 1
    v_rsq_f32 v36, v36
    ds_read_b128 a[88:91], v137 offset:256
    ds_read_b128 a[92:95], v136 offset:256
    v_mul_f32 v36, s43, v36
    v_mul_f32 v52, v52, v36
    v_mul_f32 v53, v53, v36
    ds_read_b128 a[96:99], v137 offset:1536
    v_cvt_pk_bf16_f32 v0, v52, v53
    s_waitcnt lgkmcnt(6)
    v_mfma_f32_16x16x32_bf16 v[24:27], a[216:219], a[72:75], 0
    s_waitcnt lgkmcnt(5)
    ds_read_b128 a[100:103], v136 offset:1536
    ds_read_b128 a[104:107], v137 offset:1664
    v_mfma_f32_16x16x32_bf16 v[24:27], a[220:223], a[76:79], v[24:27]
    s_waitcnt lgkmcnt(6)
    buffer_store_dwordx4 a[148:151], v129, s[28:31], s59 offen sc1
    ds_read_b128 a[108:111], v136 offset:1664
    v_mul_f32 v54, v54, v36
    v_mul_f32 v55, v55, v36
    v_cvt_pk_bf16_f32 v1, v54, v55
    v_mfma_f32_16x16x32_bf16 v[24:27], a[224:227], a[80:83], v[24:27]
    s_waitcnt lgkmcnt(6)
    ds_read_b128 a[112:115], v137 offset:1792
    v_mul_f32 v20, v20, v36
    v_mfma_f32_16x16x32_bf16 v[24:27], a[228:231], a[84:87], v[24:27]
    s_waitcnt lgkmcnt(6)
    ds_read_b128 a[116:119], v136 offset:1792
    v_mul_f32 v21, v21, v36
    v_mfma_f32_16x16x32_bf16 v[24:27], a[232:235], a[88:91], v[24:27]
    s_waitcnt lgkmcnt(6)
    ds_read_b128 a[156:159], v3 offset:3072
    v_cvt_pk_bf16_f32 v2, v20, v21
    v_mfma_f32_16x16x32_bf16 v[24:27], a[236:239], a[92:95], v[24:27]
    ds_read_b128 a[160:163], v3 offset:4096
    v_mul_f32 v22, v22, v36
    v_mfma_f32_16x16x32_bf16 v[28:31], a[240:243], a[72:75], 0
    v_mul_f32 v23, v23, v36
    v_cvt_pk_bf16_f32 v3, v22, v23
    v_mfma_f32_16x16x32_bf16 v[28:31], a[244:247], a[76:79], v[28:31]
    s_nop 0
    buffer_store_dwordx4 a[152:155], v128, s[28:31], s59 offen sc1
    v_fma_f32 v133, v24, v24, s42
    v_fmac_f32 v133, v25, v25
    v_fmac_f32 v133, v26, v26
    v_fmac_f32 v133, v27, v27
    v_mfma_f32_16x16x32_bf16 v[28:31], a[248:251], a[80:83], v[28:31]
    v_mul_f32 v4, v4, v36
    v_mul_f32 v5, v5, v36
    v_mfma_f32_16x16x32_bf16 v[28:31], a[252:255], a[84:87], v[28:31]
    v_cvt_pk_bf16_f32 v136, v4, v5
    v_mul_f32 v6, v6, v36
    v_mfma_f32_16x16x32_bf16 v[28:31], v[224:227], a[88:91], v[28:31]
    v_rsq_f32 v37, v37
    v_mfma_f32_16x16x32_bf16 v[28:31], v[228:231], a[92:95], v[28:31]
    v_mul_f32 v7, v7, v36
    v_cvt_pk_bf16_f32 v137, v6, v7
    v_mfma_f32_16x16x32_bf16 v[20:23], v[232:235], a[72:75], 0
    v_rsq_f32 v38, v38
    v_mfma_f32_16x16x32_bf16 v[20:23], v[236:239], a[76:79], v[20:23]
    s_waitcnt lgkmcnt(0)
    s_nop 0
    buffer_store_dwordx4 a[156:159], v127, s[28:31], s59 offen sc1
    v_fmac_f32 v133, v28, v28
    v_fmac_f32 v133, v29, v29
    v_fmac_f32 v133, v30, v30
    v_fmac_f32 v133, v31, v31
    v_mfma_f32_16x16x32_bf16 v[20:23], v[240:243], a[80:83], v[20:23]
    v_mul_f32 v37, s43, v37
    v_mul_f32 v48, v48, v37
    v_mfma_f32_16x16x32_bf16 v[20:23], v[244:247], a[84:87], v[20:23]
    v_mul_f32 v49, v49, v37
    v_cvt_pk_bf16_f32 v44, v48, v49
    v_mfma_f32_16x16x32_bf16 v[20:23], v[248:251], a[88:91], v[20:23]
    v_mul_f32 v50, v50, v37
    v_mul_f32 v51, v51, v37
    v_mfma_f32_16x16x32_bf16 v[20:23], v[252:255], a[92:95], v[20:23]
    v_cvt_pk_bf16_f32 v45, v50, v51
    v_mul_f32 v16, v16, v37
    v_mfma_f32_16x16x32_bf16 v[4:7], a[216:219], a[96:99], 0
    v_mul_f32 v17, v17, v37
    v_cvt_pk_bf16_f32 v46, v16, v17
    v_mfma_f32_16x16x32_bf16 v[4:7], a[220:223], a[100:103], v[4:7]
    ds_write_b128 v135, v[0:3] offset:0
    v_mfma_f32_16x16x32_bf16 v[4:7], a[224:227], a[104:107], v[4:7]
    buffer_store_dwordx4 a[160:163], v126, s[28:31], s59 offen sc1
    v_fmac_f32 v133, v20, v20
    v_fmac_f32 v133, v21, v21
    v_fmac_f32 v133, v22, v22
    v_fmac_f32 v133, v23, v23
    v_mfma_f32_16x16x32_bf16 v[4:7], a[228:231], a[108:111], v[4:7]
    ds_write_b64 v134, v[136:137] offset:0
    v_mfma_f32_16x16x32_bf16 v[4:7], a[232:235], a[112:115], v[4:7]
    ds_read_b128 v[0:3], v47 offset:6144
    v_mul_f32 v18, v18, v37
    v_mfma_f32_16x16x32_bf16 v[4:7], a[236:239], a[116:119], v[4:7]
    v_mul_f32 v19, v19, v37
    v_cvt_pk_bf16_f32 v47, v18, v19
    v_mfma_f32_16x16x32_bf16 v[16:19], a[240:243], a[96:99], 0
    ds_write_b128 v135, v[44:47] offset:1536
    v_mfma_f32_16x16x32_bf16 v[16:19], a[244:247], a[100:103], v[16:19]
    v_mul_f32 v8, v8, v37
    v_mul_f32 v9, v9, v37
    v_mfma_f32_16x16x32_bf16 v[16:19], a[248:251], a[104:107], v[16:19]
    v_cvt_pk_bf16_f32 v136, v8, v9
    v_mul_f32 v10, v10, v37
    v_mfma_f32_16x16x32_bf16 v[16:19], a[252:255], a[108:111], v[16:19]
    v_mul_f32 v11, v11, v37
    v_cvt_pk_bf16_f32 v137, v10, v11
    v_mfma_f32_16x16x32_bf16 v[16:19], v[224:227], a[112:115], v[16:19]
    ds_write_b64 v134, v[136:137] offset:1536
    v_mfma_f32_16x16x32_bf16 v[16:19], v[228:231], a[116:119], v[16:19]
    v_mul_f32 v38, s43, v38
    v_mul_f32 v32, v32, v38
    v_mfma_f32_16x16x32_bf16 v[8:11], v[232:235], a[96:99], 0
    v_mul_f32 v33, v33, v38
    v_cvt_pk_bf16_f32 v32, v32, v33
    v_mfma_f32_16x16x32_bf16 v[8:11], v[236:239], a[100:103], v[8:11]
    v_mul_f32 v34, v34, v38
    v_mul_f32 v35, v35, v38
    v_mfma_f32_16x16x32_bf16 v[8:11], v[240:243], a[104:107], v[8:11]
    v_cvt_pk_bf16_f32 v33, v34, v35
    v_mul_f32 v40, v40, v38
    v_mfma_f32_16x16x32_bf16 v[8:11], v[244:247], a[108:111], v[8:11]
    v_mul_f32 v41, v41, v38
    v_cvt_pk_bf16_f32 v34, v40, v41
    v_mfma_f32_16x16x32_bf16 v[8:11], v[248:251], a[112:115], v[8:11]
    v_mul_f32 v42, v42, v38
    v_mul_f32 v43, v43, v38
    v_mfma_f32_16x16x32_bf16 v[8:11], v[252:255], a[116:119], v[8:11]
    v_cvt_pk_bf16_f32 v35, v42, v43
    v_mul_f32 v12, v12, v38
    v_mul_f32 v13, v13, v38
    v_cvt_pk_bf16_f32 v136, v12, v13
    v_mul_f32 v14, v14, v38
    v_mul_f32 v15, v15, v38
    v_cvt_pk_bf16_f32 v137, v14, v15
    ds_write_b128 v135, v[32:35] offset:3072
    v_fma_f32 v124, v4, v4, s42
    v_fmac_f32 v124, v5, v5
    v_fmac_f32 v124, v6, v6
    v_fmac_f32 v124, v7, v7
    ds_write_b64 v134, v[136:137] offset:3072
    v_fmac_f32 v124, v16, v16
    v_fmac_f32 v124, v17, v17
    v_fmac_f32 v124, v18, v18
    v_fmac_f32 v124, v19, v19
    v_fmac_f32 v124, v8, v8
    v_fmac_f32 v124, v9, v9
    v_fmac_f32 v124, v10, v10
    v_fmac_f32 v124, v11, v11
    v_cvt_pk_bf16_f32 v124, v133, v124
    ds_write_b64 v159, v[124:125] offset:4096
    s_waitcnt lgkmcnt(3)
    v_lshrrev_b32 v124, 0, v3
    v_lshrrev_b32 v124, v124, s64
    v_and_b32 v124, 1, v124
    v_cmp_eq_u32 vcc, 1, v124
    v_lshrrev_b32 v124, 8, v3
    v_lshrrev_b32 v124, v124, s64
    v_cndmask_b32 v0, 2.0, v0, vcc
    v_and_b32 v124, 1, v124
    s_waitcnt lgkmcnt(1)
    s_barrier
    ds_read_b128 a[164:167], v139 offset:0
    ds_read_b128 a[168:171], v139 offset:1024
    v_cmp_eq_u32 vcc, 1, v124
    v_lshrrev_b32 v3, 16, v3
    s_waitcnt lgkmcnt(2)
    s_barrier
    ds_read_b128 a[172:175], v139 offset:2048
    v_cndmask_b32 v1, 2.0, v1, vcc
    ds_read_b128 a[176:179], v139 offset:3072
    v_lshrrev_b32 v3, v3, s64
    ds_read_b128 a[180:183], v139 offset:4096
    v_and_b32 v3, 1, v3
    ds_read_b128 v[36:39], v163 offset:4096
    v_cmp_eq_u32 vcc, 1, v3
    ds_read_b128 v[32:35], v163 offset:5120
    s_nop 0
    v_cndmask_b32 v2, 2.0, v2, vcc
    s_waitcnt lgkmcnt(6)
    buffer_store_dwordx4 a[164:167], v130, s[28:31], s58 offen sc1
    s_waitcnt lgkmcnt(1)
    v_mfma_f32_16x16x32_bf16 v[12:15], v[216:219], v[36:39], 0
    s_waitcnt lgkmcnt(0)
    v_mfma_f32_16x16x32_bf16 v[12:15], v[216:219], v[32:35], v[12:15]
    s_nop 2
    buffer_store_dwordx4 a[168:171], v129, s[28:31], s58 offen sc1
    s_nop 3
    v_rsq_f32 v12, v12
    v_rsq_f32 v13, v13
    v_mul_f32 v12, s43, v12
    v_mul_f32 v24, v24, v12
    v_mul_f32 v25, v25, v12
    v_cvt_pk_bf16_f32 v24, v24, v25
    v_mul_f32 v26, v26, v12
    v_mul_f32 v27, v27, v12
    v_cvt_pk_bf16_f32 v25, v26, v27
    v_mul_f32 v28, v28, v12
    v_mul_f32 v29, v29, v12
    v_cvt_pk_bf16_f32 v26, v28, v29
    v_mul_f32 v30, v30, v12
    v_mul_f32 v31, v31, v12
    v_cvt_pk_bf16_f32 v27, v30, v31
    v_mul_f32 v20, v20, v12
    v_mul_f32 v21, v21, v12
    buffer_store_dwordx4 a[172:175], v128, s[28:31], s58 offen sc1
    ds_write_b128 v138, v[24:27] offset:0
    v_cvt_pk_bf16_f32 v14, v20, v21
    v_mul_f32 v22, v22, v12
    v_mul_f32 v23, v23, v12
    v_cvt_pk_bf16_f32 v15, v22, v23
    ds_write_b64 v132, v[14:15] offset:0
    v_mul_f32 v13, s43, v13
    v_mul_f32 v4, v4, v13
    v_mul_f32 v5, v5, v13
    v_cvt_pk_bf16_f32 v4, v4, v5
    v_mul_f32 v6, v6, v13
    v_mul_f32 v7, v7, v13
    v_cvt_pk_bf16_f32 v5, v6, v7
    v_mul_f32 v16, v16, v13
    v_mul_f32 v17, v17, v13
    buffer_store_dwordx4 a[176:179], v127, s[28:31], s58 offen sc1
    v_cvt_pk_bf16_f32 v6, v16, v17
    v_mul_f32 v18, v18, v13
    v_mul_f32 v19, v19, v13
    v_cvt_pk_bf16_f32 v7, v18, v19
    v_mul_f32 v8, v8, v13
    v_mul_f32 v9, v9, v13
    v_cvt_pk_bf16_f32 v124, v8, v9
    v_mul_f32 v10, v10, v13
    v_mul_f32 v11, v11, v13
    v_cvt_pk_bf16_f32 v125, v10, v11
    ds_write_b128 v138, v[4:7] offset:1536
    ds_write_b64 v132, v[124:125] offset:1536
    buffer_store_dwordx4 a[180:183], v126, s[28:31], s58 offen sc1
    s_waitcnt lgkmcnt(0)
    s_barrier
    ds_read_b128 a[184:187], v131 offset:0
    ds_read_b128 a[188:191], v131 offset:1024
    ds_read_b128 a[192:195], v131 offset:2048
    s_waitcnt lgkmcnt(2)
    buffer_store_dwordx4 a[184:187], v0, s[28:31], 0 offen sc1
    s_waitcnt lgkmcnt(0)
    buffer_store_dwordx4 a[188:191], v1, s[28:31], 0 offen sc1
    buffer_store_dwordx4 a[192:195], v2, s[28:31], 0 offen sc1
    s_branch L_fin
L_again:
    s_waitcnt vmcnt(0) lgkmcnt(0)
    s_nop 15
    s_barrier
    s_movk_i32 s2, 256
    s_branch L_top
L_bndS:
    s_movk_i32 s73, 20
    s_movk_i32 s71, 18
    s_movk_i32 s70, -20
    s_mov_b32 s74, 0
    s_bitcmp1_b32 s2, 2
    s_cbranch_scc1 L_bndcS
    s_sub_u32 s94, s2, 248
    s_mul_i32 s69, s94, 18
    s_mov_b32 s74, 2
    s_sub_u32 s93, s93, 1373568
    v_cmp_le_u32 vcc, 4, v35
    v_add_u32 v16, 98896896, v130
    v_subrev_u32 v17, 1373568, v130
    v_cndmask_b32 v130, v16, v17, vcc
    v_cmp_le_u32 vcc, 4, v25
    v_add_u32 v16, 98896896, v129
    v_subrev_u32 v17, 1373568, v129
    v_cndmask_b32 v129, v16, v17, vcc
    v_cmp_le_u32 vcc, 4, v11
    v_add_u32 v16, 98896896, v128
    v_subrev_u32 v17, 1373568, v128
    v_cndmask_b32 v128, v16, v17, vcc
    v_cmp_le_u32 vcc, 4, v125
    v_add_u32 v16, 98896896, v127
    v_subrev_u32 v17, 1373568, v127
    v_cndmask_b32 v127, v16, v17, vcc
    v_cmp_le_u32 vcc, 4, v7
    v_add_u32 v16, 98896896, v126
    v_subrev_u32 v17, 1373568, v126
    v_cndmask_b32 v126, v16, v17, vcc
    s_cmp_lt_u32 s2, 256
    s_cbranch_scc1 L_bndrS
L_bndcS:
    s_sub_u32 s94, s2, 252
    s_mul_i32 s69, s94, 20
    s_lshr_b32 s71, s94, 1
    s_sub_u32 s69, s69, s71
    s_and_b32 s94, s94, 1
    s_sub_u32 s71, 20, s94
    s_cmp_eq_u32 s2, 255
    s_cselect_b32 s71, 13, s71
    s_mov_b32 s62, 1373568
    s_add_u32 s74, s74, 1
    s_sub_u32 s93, s93, 2688
    v_mad_i32_i24 v16, v35, -7, v131
    v_cmp_le_u32 vcc, 4, v16
    v_add_u32 v16, 193536, v130
    v_subrev_u32 v17, 2688, v130
    v_cndmask_b32 v130, v16, v17, vcc
    v_mad_i32_i24 v16, v25, -7, v6
    v_cmp_le_u32 vcc, 4, v16
    v_add_u32 v16, 193536, v129
    v_subrev_u32 v17, 2688, v129
    v_cndmask_b32 v129, v16, v17, vcc
    v_mad_i32_i24 v16, v11, -7, v22
    v_cmp_le_u32 vcc, 4, v16
    v_add_u32 v16, 193536, v128
    v_subrev_u32 v17, 2688, v128
    v_cndmask_b32 v128, v16, v17, vcc
    v_mad_i32_i24 v16, v125, -7, v124
    v_cmp_le_u32 vcc, 4, v16
    v_add_u32 v16, 193536, v127
    v_subrev_u32 v17, 2688, v127
    v_cndmask_b32 v127, v16, v17, vcc
    v_mad_i32_i24 v16, v7, -7, v26
    v_cmp_le_u32 vcc, 4, v16
    v_add_u32 v16, 193536, v126
    v_subrev_u32 v17, 2688, v126
    v_cndmask_b32 v126, v16, v17, vcc
    s_cmp_eq_u32 s2, 256
    s_cselect_b32 s62, 0, s62
    s_cselect_b32 s69, 0, s69
    s_cselect_b32 s71, 2, s71
    s_branch L_bndrS
L_maskS:
    s_and_b32 s20, s74, 2
    s_and_b32 s21, s74, 1
    s_mov_b32 s22, 0xc31044fe
    v_lshrrev_b32 v5, 2, v45
    v_add_u32 v5, 0, v5
    v_mul_u32_u24 v161, 37, v5
    v_lshrrev_b32 v160, 8, v161
    v_mad_i32_i24 v160, v160, -7, v5
    v_lshrrev_b32 v161, 10, v161
    v_lshrrev_b32 v160, 2, v160
    v_mul_u32_u24 v161, s20, v161
    v_mad_u32_u24 v5, v160, s21, v161
    v_cvt_f32_u32 v5, v5
    v_lshrrev_b32 v149, 2, v45
    v_add_u32 v149, 4, v149
    v_mul_u32_u24 v161, 37, v149
    v_lshrrev_b32 v160, 8, v161
    v_mad_i32_i24 v160, v160, -7, v149
    v_lshrrev_b32 v161, 10, v161
    v_lshrrev_b32 v160, 2, v160
    v_mul_u32_u24 v161, s20, v161
    v_mad_u32_u24 v149, v160, s21, v161
    v_cvt_f32_u32 v149, v149
    v_lshrrev_b32 v148, 2, v45
    v_add_u32 v148, 8, v148
    v_mul_u32_u24 v161, 37, v148
    v_lshrrev_b32 v160, 8, v161
    v_mad_i32_i24 v160, v160, -7, v148
    v_lshrrev_b32 v161, 10, v161
    v_lshrrev_b32 v160, 2, v160
    v_mul_u32_u24 v161, s20, v161
    v_mad_u32_u24 v148, v160, s21, v161
    v_cvt_f32_u32 v148, v148
    v_mad_u32_u24 v169, v44, 12, 0
    v_mul_u32_u24 v161, 37, v169
    v_lshrrev_b32 v160, 8, v161
    v_mad_i32_i24 v160, v160, -7, v169
    v_lshrrev_b32 v161, 10, v161
    v_lshrrev_b32 v160, 2, v160
    v_mul_u32_u24 v161, s20, v161
    v_mad_u32_u24 v169, v160, s21, v161
    v_cvt_f32_u32 v169, v169
    v_sub_f32 v161, v5, v169
    v_mul_f32 v161, v161, v161 clamp
    v_fmac_f32 v204, s22, v161
    v_sub_f32 v161, v149, v169
    v_mul_f32 v161, v161, v161 clamp
    v_fmac_f32 v192, s22, v161
    v_sub_f32 v161, v148, v169
    v_mul_f32 v161, v161, v161 clamp
    v_fmac_f32 v180, s22, v161
    v_mad_u32_u24 v169, v44, 12, 1
    v_mul_u32_u24 v161, 37, v169
    v_lshrrev_b32 v160, 8, v161
    v_mad_i32_i24 v160, v160, -7, v169
    v_lshrrev_b32 v161, 10, v161
    v_lshrrev_b32 v160, 2, v160
    v_mul_u32_u24 v161, s20, v161
    v_mad_u32_u24 v169, v160, s21, v161
    v_cvt_f32_u32 v169, v169
    v_sub_f32 v161, v5, v169
    v_mul_f32 v161, v161, v161 clamp
    v_fmac_f32 v205, s22, v161
    v_sub_f32 v161, v149, v169
    v_mul_f32 v161, v161, v161 clamp
    v_fmac_f32 v193, s22, v161
    v_sub_f32 v161, v148, v169
    v_mul_f32 v161, v161, v161 clamp
    v_fmac_f32 v181, s22, v161
    v_mad_u32_u24 v169, v44, 12, 2
    v_mul_u32_u24 v161, 37, v169
    v_lshrrev_b32 v160, 8, v161
    v_mad_i32_i24 v160, v160, -7, v169
    v_lshrrev_b32 v161, 10, v161
    v_lshrrev_b32 v160, 2, v160
    v_mul_u32_u24 v161, s20, v161
    v_mad_u32_u24 v169, v160, s21, v161
    v_cvt_f32_u32 v169, v169
    v_sub_f32 v161, v5, v169
    v_mul_f32 v161, v161, v161 clamp
    v_fmac_f32 v206, s22, v161
    v_sub_f32 v161, v149, v169
    v_mul_f32 v161, v161, v161 clamp
    v_fmac_f32 v194, s22, v161
    v_sub_f32 v161, v148, v169
    v_mul_f32 v161, v161, v161 clamp
    v_fmac_f32 v182, s22, v161
    v_mad_u32_u24 v169, v44, 12, 3
    v_mul_u32_u24 v161, 37, v169
    v_lshrrev_b32 v160, 8, v161
    v_mad_i32_i24 v160, v160, -7, v169
    v_lshrrev_b32 v161, 10, v161
    v_lshrrev_b32 v160, 2, v160
    v_mul_u32_u24 v161, s20, v161
    v_mad_u32_u24 v169, v160, s21, v161
    v_cvt_f32_u32 v169, v169
    v_sub_f32 v161, v5, v169
    v_mul_f32 v161, v161, v161 clamp
    v_fmac_f32 v207, s22, v161
    v_sub_f32 v161, v149, v169
    v_mul_f32 v161, v161, v161 clamp
    v_fmac_f32 v195, s22, v161
    v_sub_f32 v161, v148, v169
    v_mul_f32 v161, v161, v161 clamp
    v_fmac_f32 v183, s22, v161
    v_mad_u32_u24 v169, v44, 12, 4
    v_mul_u32_u24 v161, 37, v169
    v_lshrrev_b32 v160, 8, v161
    v_mad_i32_i24 v160, v160, -7, v169
    v_lshrrev_b32 v161, 10, v161
    v_lshrrev_b32 v160, 2, v160
    v_mul_u32_u24 v161, s20, v161
    v_mad_u32_u24 v169, v160, s21, v161
    v_cvt_f32_u32 v169, v169
    v_sub_f32 v161, v5, v169
    v_mul_f32 v161, v161, v161 clamp
    v_fmac_f32 v200, s22, v161
    v_sub_f32 v161, v149, v169
    v_mul_f32 v161, v161, v161 clamp
    v_fmac_f32 v188, s22, v161
    v_sub_f32 v161, v148, v169
    v_mul_f32 v161, v161, v161 clamp
    v_fmac_f32 v176, s22, v161
    v_mad_u32_u24 v169, v44, 12, 5
    v_mul_u32_u24 v161, 37, v169
    v_lshrrev_b32 v160, 8, v161
    v_mad_i32_i24 v160, v160, -7, v169
    v_lshrrev_b32 v161, 10, v161
    v_lshrrev_b32 v160, 2, v160
    v_mul_u32_u24 v161, s20, v161
    v_mad_u32_u24 v169, v160, s21, v161
    v_cvt_f32_u32 v169, v169
    v_sub_f32 v161, v5, v169
    v_mul_f32 v161, v161, v161 clamp
    v_fmac_f32 v201, s22, v161
    v_sub_f32 v161, v149, v169
    v_mul_f32 v161, v161, v161 clamp
    v_fmac_f32 v189, s22, v161
    v_sub_f32 v161, v148, v169
    v_mul_f32 v161, v161, v161 clamp
    v_fmac_f32 v177, s22, v161
    v_mad_u32_u24 v169, v44, 12, 6
    v_mul_u32_u24 v161, 37, v169
    v_lshrrev_b32 v160, 8, v161
    v_mad_i32_i24 v160, v160, -7, v169
    v_lshrrev_b32 v161, 10, v161
    v_lshrrev_b32 v160, 2, v160
    v_mul_u32_u24 v161, s20, v161
    v_mad_u32_u24 v169, v160, s21, v161
    v_cvt_f32_u32 v169, v169
    v_sub_f32 v161, v5, v169
    v_mul_f32 v161, v161, v161 clamp
    v_fmac_f32 v202, s22, v161
    v_sub_f32 v161, v149, v169
    v_mul_f32 v161, v161, v161 clamp
    v_fmac_f32 v190, s22, v161
    v_sub_f32 v161, v148, v169
    v_mul_f32 v161, v161, v161 clamp
    v_fmac_f32 v178, s22, v161
    v_mad_u32_u24 v169, v44, 12, 7
    v_mul_u32_u24 v161, 37, v169
    v_lshrrev_b32 v160, 8, v161
    v_mad_i32_i24 v160, v160, -7, v169
    v_lshrrev_b32 v161, 10, v161
    v_lshrrev_b32 v160, 2, v160
    v_mul_u32_u24 v161, s20, v161
    v_mad_u32_u24 v169, v160, s21, v161
    v_cvt_f32_u32 v169, v169
    v_sub_f32 v161, v5, v169
    v_mul_f32 v161, v161, v161 clamp
    v_fmac_f32 v203, s22, v161
    v_sub_f32 v161, v149, v169
    v_mul_f32 v161, v161, v161 clamp
    v_fmac_f32 v191, s22, v161
    v_sub_f32 v161, v148, v169
    v_mul_f32 v161, v161, v161 clamp
    v_fmac_f32 v179, s22, v161
    v_mad_u32_u24 v169, v44, 12, 8
    v_mul_u32_u24 v161, 37, v169
    v_lshrrev_b32 v160, 8, v161
    v_mad_i32_i24 v160, v160, -7, v169
    v_lshrrev_b32 v161, 10, v161
    v_lshrrev_b32 v160, 2, v160
    v_mul_u32_u24 v161, s20, v161
    v_mad_u32_u24 v169, v160, s21, v161
    v_cvt_f32_u32 v169, v169
    v_sub_f32 v161, v5, v169
    v_mul_f32 v161, v161, v161 clamp
    v_fmac_f32 v196, s22, v161
    v_sub_f32 v161, v149, v169
    v_mul_f32 v161, v161, v161 clamp
    v_fmac_f32 v184, s22, v161
    v_sub_f32 v161, v148, v169
    v_mul_f32 v161, v161, v161 clamp
    v_fmac_f32 v172, s22, v161
    v_mad_u32_u24 v169, v44, 12, 9
    v_mul_u32_u24 v161, 37, v169
    v_lshrrev_b32 v160, 8, v161
    v_mad_i32_i24 v160, v160, -7, v169
    v_lshrrev_b32 v161, 10, v161
    v_lshrrev_b32 v160, 2, v160
    v_mul_u32_u24 v161, s20, v161
    v_mad_u32_u24 v169, v160, s21, v161
    v_cvt_f32_u32 v169, v169
    v_sub_f32 v161, v5, v169
    v_mul_f32 v161, v161, v161 clamp
    v_fmac_f32 v197, s22, v161
    v_sub_f32 v161, v149, v169
    v_mul_f32 v161, v161, v161 clamp
    v_fmac_f32 v185, s22, v161
    v_sub_f32 v161, v148, v169
    v_mul_f32 v161, v161, v161 clamp
    v_fmac_f32 v173, s22, v161
    v_mad_u32_u24 v169, v44, 12, 10
    v_mul_u32_u24 v161, 37, v169
    v_lshrrev_b32 v160, 8, v161
    v_mad_i32_i24 v160, v160, -7, v169
    v_lshrrev_b32 v161, 10, v161
    v_lshrrev_b32 v160, 2, v160
    v_mul_u32_u24 v161, s20, v161
    v_mad_u32_u24 v169, v160, s21, v161
    v_cvt_f32_u32 v169, v169
    v_sub_f32 v161, v5, v169
    v_mul_f32 v161, v161, v161 clamp
    v_fmac_f32 v198, s22, v161
    v_sub_f32 v161, v149, v169
    v_mul_f32 v161, v161, v161 clamp
    v_fmac_f32 v186, s22, v161
    v_sub_f32 v161, v148, v169
    v_mul_f32 v161, v161, v161 clamp
    v_fmac_f32 v174, s22, v161
    v_mad_u32_u24 v169, v44, 12, 11
    v_mul_u32_u24 v161, 37, v169
    v_lshrrev_b32 v160, 8, v161
    v_mad_i32_i24 v160, v160, -7, v169
    v_lshrrev_b32 v161, 10, v161
    v_lshrrev_b32 v160, 2, v160
    v_mul_u32_u24 v161, s20, v161
    v_mad_u32_u24 v169, v160, s21, v161
    v_cvt_f32_u32 v169, v169
    v_sub_f32 v161, v5, v169
    v_mul_f32 v161, v161, v161 clamp
    v_fmac_f32 v199, s22, v161
    v_sub_f32 v161, v149, v169
    v_mul_f32 v161, v161, v161 clamp
    v_fmac_f32 v187, s22, v161
    v_sub_f32 v161, v148, v169
    v_mul_f32 v161, v161, v161 clamp
    v_fmac_f32 v175, s22, v161
    v_cvt_f32_u32 v169, s74
    v_sub_f32 v161, v5, v169
    v_mul_f32 v161, v161, v161 clamp
    v_fmac_f32 v208, s22, v161
    v_sub_f32 v161, v149, v169
    v_mul_f32 v161, v161, v161 clamp
    v_fmac_f32 v209, s22, v161
    v_sub_f32 v161, v148, v169
    v_mul_f32 v161, v161, v161 clamp
    v_fmac_f32 v210, s22, v161
    v_lshrrev_b32 v5, 2, v45
    v_lshl_add_u32 v5, v44, 2, v5
    v_add_u32 v161, 1, v44
    v_lshrrev_b32 v161, 2, v161
    v_mad_u32_u24 v5, v161, 36, v5
    v_min_u32 v5, 48, v5
    v_mul_u32_u24 v161, 37, v5
    v_lshrrev_b32 v160, 8, v161
    v_mad_i32_i24 v160, v160, -7, v5
    v_lshrrev_b32 v161, 10, v161
    v_lshrrev_b32 v160, 2, v160
    v_mul_u32_u24 v161, s20, v161
    v_mad_u32_u24 v5, v160, s21, v161
    v_cvt_f32_u32 v5, v5
    v_sub_f32 v161, v5, v169
    v_mul_f32 v161, v161, v161 clamp
    v_fmac_f32 v211, s22, v161
    s_branch L_nomaskS
L_atomS0:
    v_mov_b32 v167, 0x800000
    buffer_atomic_add v167, v163, s[8:11], 0 offen sc0 sc1
    s_branch L_atomS0r

.section .rodata,"a"
.p2align 6
.amdhsa_kernel standalone__window_attn_swin_v2__vision_kernel
  .amdhsa_next_free_vgpr 512
  .amdhsa_next_free_sgpr 102
  .amdhsa_accum_offset 256
  .amdhsa_group_segment_fixed_size 0
  .amdhsa_kernarg_size 96
  .amdhsa_user_sgpr_count 2
  .amdhsa_user_sgpr_kernarg_segment_ptr 1
  .amdhsa_system_sgpr_workgroup_id_x 1
.end_amdhsa_kernel
```

```asm
; @launch grid=(256,1,1) block=(256,1,1) lds=163840
.amdgcn_target "amdgcn-amd-amdhsa--gfx950"
.text
.globl standalone__window_attn_swin_v2__vision_kernel
.p2align 8
.type standalone__window_attn_swin_v2__vision_kernel,@function
standalone__window_attn_swin_v2__vision_kernel:
    v_lshrrev_b32 v0, 6, v0
    s_cmp_ge_u32 s2, 256
    s_cbranch_scc1 L_end
    v_readfirstlane_b32 s68, v0
L_top:
    s_mov_b32 s64, 0
    s_nop 0
L_top2:
    v_mbcnt_lo_u32_b32 v85, -1, 0
    v_mbcnt_hi_u32_b32 v85, -1, v85
    s_load_dwordx16 s[4:19], s[0:1], 0
    s_load_dwordx4 s[20:23], s[0:1], 64
    s_load_dwordx2 s[38:39], s[0:1], 80
    s_load_dwordx2 s[76:77], s[0:1], 88
    s_add_u32 s84, s2, s64
    s_sub_u32 s84, s84, 248
    s_cmp_lt_u32 s84, 3
    s_cbranch_scc1 L_prod
    s_bfe_u32 s88, s2, 0x50003
    s_lshl2_add_u32 s88, s88, s68
    v_lshlrev_b32 v84, 7, v85
    s_getpc_b64 s[80:81]
    s_mul_i32 s84, s88, 320
    v_min_u32 v86, 256, v84
    v_add_u32 v86, s84, v86
    v_min_u32 v86, L_slow-standalone__window_attn_swin_v2__vision_kernel-256, v86
    s_mul_i32 s88, s88, 1728
    s_mov_b32 s34, 221184
    global_load_dword a255, v86, s[80:81]
    v_min_u32 v10, 1664, v84
    s_mov_b32 s35, 0x20000
    s_mov_b32 s78, 73728
    s_mov_b32 s79, 0x20000
    v_and_b32 v50, 15, v85
    v_lshrrev_b32 v143, 4, v85
    v_lshrrev_b32 v8, 2, v50
    v_and_b32 v211, 3, v50
    s_mul_i32 s87, s68, 192
    v_mad_u32_u24 v23, v50, 12, s87
    v_lshlrev_b32 v9, 1, v50
    v_lshlrev_b32 v11, 1, v8
    v_lshl_add_u32 v11, v143, 5, v11
    s_movk_i32 s86, 384
    s_mov_b32 s26, 100270464
    s_mov_b32 s27, 0x20000
    s_mov_b32 s30, 0
    s_mov_b32 s31, 0x20000
    s_lshr_b32 s93, s2, 3
    s_mul_i32 s93, s93, 3185912
    s_min_u32 s44, s93, 100270460
    s_add_u32 s93, s93, 2097152
    s_min_u32 s45, s93, 100270460
    s_add_u32 s93, s93, 2097152
    s_min_u32 s46, s93, 100270460
    s_waitcnt lgkmcnt(0)
    s_load_dword s44, s[4:5], s44
    s_load_dword s45, s[4:5], s45
    s_load_dword s46, s[4:5], s46
    s_mov_b32 s24, s4
    s_mov_b32 s25, s5
    s_mov_b32 s32, s6
    s_mov_b32 s33, s7
    buffer_load_dword a254, v10, s[32:35], s88 offen
    s_load_dwordx2 s[82:83], s[10:11], 0
    s_movk_i32 s18, 676
    s_mov_b32 s19, 0x20000
    buffer_load_dwordx3 v[12:14], v23, s[16:19], 0 offen
    s_mul_i32 s96, s68, 288
    s_and_b32 s97, s68, 1
    s_lshl_b32 s97, s97, 2
    s_mov_b32 s98, 193536
    s_mov_b32 s99, 589824
    global_load_ushort v20, v9, s[12:13]
    v_add_u32 v10, s96, v85
    v_mul_u32_u24 v51, 2731, v10
    v_mul_u32_u24 v124, 6242, v10
    v_lshrrev_b32 v51, 16, v51
    v_lshrrev_b32 v124, 20, v124
    s_lshr_b32 s94, s2, 3
    s_mul_i32 s70, s94, 167
    global_load_ushort v21, v9, s[12:13] offset:32
    v_and_or_b32 v112, v51, 3, s97
    v_xor_b32 v112, v10, v112
    v_lshl_add_u32 v130, v112, 4, s99
    v_mad_u32_u24 v130, v124, s98, v130
    v_add_u32 v15, 64, v10
    s_min_u32 s95, s94, 7
    s_add_u32 s70, s70, s95
    global_load_ushort v48, v11, s[14:15] offset:0
    v_mul_u32_u24 v125, 2731, v15
    v_mul_u32_u24 v9, 6242, v15
    v_lshrrev_b32 v125, 16, v125
    v_lshrrev_b32 v9, 20, v9
    v_and_or_b32 v113, v125, 3, s97
    s_and_b32 s95, s2, 7
    s_mul_i32 s95, s95, 20
    global_load_ushort v186, v11, s[14:15] offset:8
    v_xor_b32 v113, v15, v113
    v_lshl_add_u32 v129, v113, 4, s99
    v_mad_u32_u24 v129, v9, s98, v129
    v_add_u32 v22, 128, v10
    v_mul_u32_u24 v131, 2731, v22
    s_add_u32 s69, s70, s95
    s_add_u32 s70, s70, 140
    global_load_ushort v49, v11, s[14:15] offset:16
    v_mul_u32_u24 v15, 6242, v22
    v_lshrrev_b32 v131, 16, v131
    v_lshrrev_b32 v15, 20, v15
    v_and_or_b32 v114, v131, 3, s97
    v_xor_b32 v114, v22, v114
    s_movk_i32 s62, 2688
    s_movk_i32 s71, 20
    global_load_ushort v159, v11, s[14:15] offset:24
    v_lshl_add_u32 v128, v114, 4, s99
    v_mad_u32_u24 v128, v15, s98, v128
    v_add_u32 v126, 192, v10
    v_mul_u32_u24 v11, 2731, v126
    v_mul_u32_u24 v115, 6242, v126
    v_lshrrev_b32 v11, 16, v11
    v_lshrrev_b32 v115, 20, v115
    v_and_or_b32 v22, v11, 3, s97
    v_xor_b32 v22, v126, v22
    v_lshl_add_u32 v127, v22, 4, s99
    v_mad_u32_u24 v127, v115, s98, v127
    v_add_u32 v126, 256, v10
    v_mul_u32_u24 v22, 2731, v126
    v_mul_u32_u24 v10, 6242, v126
    v_lshrrev_b32 v22, 16, v22
    v_lshrrev_b32 v10, 20, v10
    v_and_or_b32 v84, v22, 3, s97
    v_xor_b32 v84, v126, v84
    v_lshl_add_u32 v126, v84, 4, s99
    v_mad_u32_u24 v126, v10, s98, v126
    s_cmp_lt_u32 s94, 7
    s_cselect_b32 s73, 28, 27
    s_mov_b32 s93, 1769472
    s_mul_i32 s54, s68, 5120
    s_cmp_ge_u32 s2, 248
    s_cbranch_scc1 L_bndF
L_bndrF:
    s_mov_b32 s63, 1180032
    s_mul_i32 s94, s69, 58255
    s_lshr_b32 s94, s94, 22
    s_mul_i32 s94, s94, s63
    s_mul_i32 s72, s69, s62
    s_add_u32 s72, s72, s94
    v_lshl_or_b32 v124, v85, 4, 2.0
    s_sub_u32 s94, s73, 1
    s_max_u32 s94, s94, 20
    s_mul_i32 s95, s68, -44
    s_movk_i32 s99, -24
    s_add_u32 m0, s54, 0
    v_and_b32 v22, -4, v131
    s_mul_i32 s85, s68, 96
    s_sub_u32 s100, s85, 1024
    buffer_load_dwordx4 v130, s[24:27], s72 offen nt lds
    s_add_u32 m0, s54, 1024
    v_mad_u32_u24 v15, v22, 3, v131
    v_add_u32 v15, s95, v15
    v_mad_i32_i24 v114, v131, s99, v114
    v_med3_u32 v22, v15, 20, s94
    v_add_u32 v22, s70, v22
    v_add_u32 v115, s69, v15
    s_sub_u32 s87, s85, 2048
    s_movk_i32 s91, 1152
    buffer_load_dwordx4 v129, s[24:27], s72 offen nt lds
    v_cmp_gt_u32 vcc, s71, v15
    v_lshl_add_u32 v114, v114, 4, s93
    s_add_u32 m0, s54, 43008
    v_cndmask_b32 v115, v22, v115, vcc
    v_mul_u32_u24 v22, 58255, v115
    v_mad_u32_u24 v114, v115, s62, v114
    v_lshrrev_b32 v22, 22, v22
    v_mad_u32_u24 v114, v22, s63, v114
    s_mul_i32 s90, s68, 3072
    s_add_u32 s90, s90, 61440
    buffer_load_dwordx4 v114, s[24:27], 0 offen  lds
    v_lshlrev_b32 v115, 16, v15
    s_add_u32 m0, s54, 2048
    v_and_b32 v22, -4, v125
    v_mad_u32_u24 v15, v22, 3, v125
    v_add_u32 v15, s95, v15
    v_mad_i32_i24 v113, v125, s99, v113
    v_med3_u32 v22, v15, 20, s94
    s_mov_b32 s30, 100270464
    s_mov_b32 s28, s22
    buffer_load_dwordx4 v128, s[24:27], s72 offen nt lds
    v_add_u32 v22, s70, v22
    v_add_u32 v125, s69, v15
    v_cmp_gt_u32 vcc, s71, v15
    v_lshl_add_u32 v113, v113, 4, s93
    s_add_u32 m0, s54, 41984
    v_cndmask_b32 v125, v22, v125, vcc
    v_mul_u32_u24 v22, 58255, v125
    v_mad_u32_u24 v113, v125, s62, v113
    v_lshrrev_b32 v22, 22, v22
    v_mad_u32_u24 v113, v22, s63, v113
    s_mov_b32 s29, s23
    s_mov_b32 s41, 0x2a8cbccc
    buffer_load_dwordx4 v113, s[24:27], 0 offen  lds
    v_lshl_or_b32 v115, v15, 8, v115
    s_add_u32 m0, s54, 3072
    v_cmp_gt_u32 vcc, 32, v85
    v_and_b32 v15, -4, v51
    v_mad_u32_u24 v22, v15, 3, v51
    v_cndmask_b32 v126, v124, v126, vcc
    v_add_u32 v22, s95, v22
    s_mov_b32 s42, 0x38fba882
    s_mov_b32 s43, 0x415db3d7
    buffer_load_dwordx4 v127, s[24:27], s72 offen nt lds
    s_add_u32 m0, s54, 4096
    v_mad_i32_i24 v112, v51, s99, v112
    v_med3_u32 v15, v22, 20, s94
    v_add_u32 v15, s70, v15
    v_add_u32 v51, s69, v22
    v_cmp_gt_u32 vcc, s71, v22
    v_lshl_add_u32 v112, v112, 4, s93
    s_add_u32 s101, s54, 44032
    s_mul_i32 s93, s68, 6
    buffer_load_dwordx4 v126, s[24:27], s72 offen nt lds
    v_cndmask_b32 v51, v15, v51, vcc
    v_mul_u32_u24 v15, 58255, v51
    v_mad_u32_u24 v112, v51, s62, v112
    v_lshrrev_b32 v15, 22, v15
    v_mad_u32_u24 v112, v15, s63, v112
    s_add_u32 m0, s54, 40960
    v_lshl_or_b32 v115, v22, 0, v115
    s_lshl_b32 s94, s97, 1
    s_mov_b32 s57, s72
    buffer_load_dwordx4 v112, s[24:27], 0 offen nt lds
    v_mul_u32_u24 v15, 10923, v85
    v_lshrrev_b32 v84, 17, v15
    v_lshrrev_b32 v15, 16, v15
    v_mad_i32_i24 v22, v15, -6, v85
    v_bitop3_b32 v84, v84, v15, 4 bitop3:0x28
    v_lshl_add_u32 v22, v22, 4, s85
    v_mul_u32_u24 v84, 3, v84
    v_xor_b32 v15, v15, v84
    v_mad_u32_u24 v84, v15, s91, v22
    v_add_u32 v15, 64, v85
    v_mul_u32_u24 v22, 10923, v15
    v_lshrrev_b32 v37, 17, v22
    v_lshrrev_b32 v22, 16, v22
    v_mad_i32_i24 v15, v22, -6, v15
    v_bitop3_b32 v37, v37, v22, 4 bitop3:0x28
    v_lshl_add_u32 v15, v15, 4, s100
    v_mul_u32_u24 v37, 3, v37
    v_xor_b32 v22, v22, v37
    v_mad_u32_u24 v37, v22, s91, v15
    v_add_u32 v22, 128, v85
    v_mul_u32_u24 v15, 10923, v22
    v_lshrrev_b32 v11, 17, v15
    v_lshrrev_b32 v15, 16, v15
    v_mad_i32_i24 v22, v15, -6, v22
    v_bitop3_b32 v11, v11, v15, 4 bitop3:0x28
    v_lshl_add_u32 v22, v22, 4, s87
    v_mul_u32_u24 v11, 3, v11
    v_xor_b32 v15, v15, v11
    v_mad_u32_u24 v11, v15, s91, v22
    s_add_u32 m0, s90, 0
    s_mov_b32 s92, 0
    buffer_load_dwordx4 v84, s[32:35], s92 offen offset:0 lds
    v_lshrrev_b32 v22, 1, v143
    v_lshl_add_u32 v15, v143, 2, v8
    v_lshl_add_u32 v15, v22, 3, v15
    v_mul_u32_u24 v15, 96, v15
    v_add_u32 v15, s90, v15
    v_lshl_add_u32 v158, v211, 4, v15
    v_lshl_add_u32 v51, v211, 3, v15
    s_waitcnt lgkmcnt(0)
    s_lshl_b32 s85, s68, 4
    buffer_load_dwordx4 v37, s[32:35], s92 offen offset:1024 lds
    v_lshlrev_b32 v15, 4, v143
    v_lshrrev_b64 v[86:87], v15, s[82:83]
    v_lshlrev_b32 v15, 16, v86
    v_min_f32 v15, 0x40930000, v15
    v_max_f32 v15, 0xc2c80000, v15
    v_mul_f32 v15, 0x3fb8aa3b, v15
    v_exp_f32 v15, v15
    s_mov_b32 s84, 0x41b8aa3b
    s_mov_b32 s44, 61440
    buffer_load_dwordx4 v11, s[32:35], s92 offen offset:2048 lds
    s_add_u32 m0, s90, 12288
    s_mov_b32 s92, 36864
    v_cvt_pk_bf16_f32 v15, v15, v15
    v_lshlrev_b32 v15, 16, v15
    v_mul_f32 v15, 0x4038aa3b, v15
    v_mov_b32 v187, 0xc138aa3b
    v_readlane_b32 s55, v15, s85
    v_fmac_f32 v187, 0xbe333333, v15
    v_mul_f32 v15, 0x43000000, v15
    v_mov_b32 v22, 0
    v_readlane_b32 s52, v15, s85
    v_mov_b32 v15, 0
    v_mul_u32_u24 v131, 5120, v143
    v_add_u32 v131, v23, v131
    v_mul_u32_u24 v139, 48, v8
    v_lshl_add_u32 v139, v211, 2, v139
    v_mul_u32_u24 v125, 48, v143
    v_add_u32 v199, 0, v139
    v_mul_u32_u24 v23, 37, v199
    v_lshrrev_b32 v23, 10, v23
    v_mad_u32_u24 v199, v23, 24, v199
    v_add_u32 v199, s101, v199
    v_add_u32 v138, 16, v139
    v_mul_u32_u24 v23, 37, v138
    v_lshrrev_b32 v23, 10, v23
    v_mad_u32_u24 v138, v23, 24, v138
    v_add_u32 v138, s101, v138
    v_add_u32 v175, 32, v139
    v_mul_u32_u24 v23, 37, v175
    v_lshrrev_b32 v23, 10, v23
    v_mad_u32_u24 v175, v23, 24, v175
    v_add_u32 v175, s101, v175
    v_add_u32 v184, 0, v125
    v_mul_u32_u24 v23, 37, v184
    v_lshrrev_b32 v23, 10, v23
    v_mad_u32_u24 v184, v23, 24, v184
    v_add_u32 v185, 4, v125
    v_mul_u32_u24 v23, 37, v185
    v_lshrrev_b32 v23, 10, v23
    v_mad_u32_u24 v185, v23, 24, v185
    v_add_u32 v156, 8, v125
    v_mul_u32_u24 v23, 37, v156
    v_lshrrev_b32 v23, 10, v23
    v_mad_u32_u24 v156, v23, 24, v156
    v_add_u32 v157, 12, v125
    v_mul_u32_u24 v23, 37, v157
    v_lshrrev_b32 v23, 10, v23
    v_mad_u32_u24 v157, v23, 24, v157
    v_add_u32 v188, 16, v125
    v_mul_u32_u24 v23, 37, v188
    v_lshrrev_b32 v23, 10, v23
    v_mad_u32_u24 v188, v23, 24, v188
    v_add_u32 v189, 20, v125
    v_mul_u32_u24 v23, 37, v189
    v_lshrrev_b32 v23, 10, v23
    v_mad_u32_u24 v189, v23, 24, v189
    v_add_u32 v190, 24, v125
    v_mul_u32_u24 v23, 37, v190
    v_lshrrev_b32 v23, 10, v23
    v_mad_u32_u24 v190, v23, 24, v190
    s_mov_b32 s45, 40960
    s_mov_b32 s46, 20480
    buffer_load_dwordx4 v84, s[32:35], s92 offen offset:0 lds
    v_add_u32 v191, 28, v125
    v_mul_u32_u24 v23, 37, v191
    v_lshrrev_b32 v23, 10, v23
    v_mad_u32_u24 v191, v23, 24, v191
    v_add_u32 v86, 32, v125
    v_mul_u32_u24 v23, 37, v86
    v_lshrrev_b32 v23, 10, v23
    s_mov_b32 s47, 0
    s_mov_b32 s58, 0
    buffer_load_dwordx4 v37, s[32:35], s92 offen offset:1024 lds
    s_waitcnt vmcnt(17)
    v_lshl_or_b32 v20, v21, 16, v20
    v_cmp_gt_u32 vcc, 16, v85
    v_mov_b32 v21, 0
    v_mad_u32_u24 v86, v23, 24, v86
    v_cndmask_b32 v23, 0, v20, vcc
    v_cndmask_b32 v20, 0, v20, vcc
    v_add_u32 v87, 36, v125
    v_mfma_f32_16x16x16_bf16 v[0:3], v[22:23], v[12:13], 0
    s_waitcnt vmcnt(15)
    s_mov_b32 s59, 0
    v_lshl_or_b32 v48, v186, 16, v48
    v_mul_u32_u24 v186, 37, v87
    v_mfma_f32_16x16x16_bf16 v[4:7], v[20:21], v[12:13], 0
    s_mov_b32 s60, 0
    v_lshrrev_b32 v186, 10, v186
    v_mad_u32_u24 v87, v186, 24, v87
    v_mfma_f32_16x16x16_bf16 v[16:19], v[20:21], v[14:15], 0
    s_waitcnt vmcnt(13)
    s_mov_b32 s65, -1
    buffer_load_dwordx4 v11, s[32:35], s92 offen offset:2048 lds
    v_lshl_or_b32 v49, v159, 16, v49
    v_max_f32 v0, 0, v0
    v_max_f32 v4, 0, v4
    s_add_u32 m0, s90, 24576
    s_mov_b32 s92, 73728
    v_max_f32 v5, 0, v5
    v_max_f32 v6, 0, v6
    v_max_f32 v7, 0, v7
    v_cvt_pk_bf16_f32 v4, v4, v5
    v_cvt_pk_bf16_f32 v5, v6, v7
    v_max_f32 v1, 0, v1
    v_max_f32 v2, 0, v2
    v_mfma_f32_16x16x16_bf16 v[12:15], v[48:49], v[4:5], 0
    s_mov_b32 s61, 1
    v_max_f32 v3, 0, v3
    v_cvt_pk_bf16_f32 v0, v0, v1
    v_cvt_pk_bf16_f32 v1, v2, v3
    v_max_f32 v16, 0, v16
    v_max_f32 v17, 0, v17
    v_mfma_f32_16x16x16_bf16 v[4:7], v[48:49], v[0:1], 0
    s_movk_i32 s4, 112
    v_max_f32 v18, 0, v18
    v_max_f32 v19, 0, v19
    v_cvt_pk_bf16_f32 v16, v16, v17
    v_cvt_pk_bf16_f32 v17, v18, v19
    v_cvt_pk_bf16_f32 v12, v12, v12
    v_lshlrev_b32 v12, 16, v12
    v_mfma_f32_16x16x16_bf16 v[0:3], v[48:49], v[16:17], 0
    s_mov_b32 s5, 0
    v_mul_f32 v12, 0xbfb8aa3b, v12
    v_cvt_pk_bf16_f32 v4, v4, v4
    v_exp_f32 v12, v12
    v_lshlrev_b32 v4, 16, v4
    v_add_f32 v12, 1.0, v12
    v_rcp_f32 v12, v12
    v_mul_f32 v4, 0xbfb8aa3b, v4
    v_cvt_pk_bf16_f32 v12, v12, v12
    v_lshlrev_b32 v12, 16, v12
    v_fma_f32 v12, v12, s84, v187
    s_mov_b32 s6, 0
    s_mov_b32 s12, 0
    ds_write_b32 v131, v12 offset:44032
    v_exp_f32 v4, v4
    v_cvt_pk_bf16_f32 v0, v0, v0
    v_add_f32 v4, 1.0, v4
    v_rcp_f32 v4, v4
    v_lshlrev_b32 v0, 16, v0
    v_cvt_pk_bf16_f32 v4, v4, v4
    v_lshlrev_b32 v4, 16, v4
    v_fma_f32 v4, v4, s84, v187
    s_mov_b32 s64, 3
    s_mov_b32 s10, 81924
    ds_write_b32 v131, v4 offset:44036
    v_mul_f32 v0, 0xbfb8aa3b, v0
    v_exp_f32 v0, v0
    v_add_u32 v186, 40, v125
    v_add_f32 v0, 1.0, v0
    v_rcp_f32 v0, v0
    v_mul_u32_u24 v159, 37, v186
    v_cvt_pk_bf16_f32 v0, v0, v0
    v_lshlrev_b32 v0, 16, v0
    v_fma_f32 v0, v0, s84, v187
    s_mov_b32 s11, 0x20000
    s_mov_b32 s3, 0x00010001
    ds_write_b32 v131, v0 offset:44040
    v_lshrrev_b32 v159, 10, v159
    v_mad_u32_u24 v186, v159, 24, v186
    v_add_u32 v187, 44, v125
    v_mul_u32_u24 v125, 37, v187
    v_lshrrev_b32 v125, 10, v125
    v_mad_u32_u24 v187, v125, 24, v187
    v_lshl_add_u32 v131, v143, 4, v139
    v_mul_u32_u24 v125, 37, v131
    v_lshrrev_b32 v125, 10, v125
    v_mad_u32_u24 v131, v125, 24, v131
    v_mov_b32 v10, 336
    v_cmp_gt_u32 vcc, 3, v143
    v_mov_b32 v125, 0x3f803f80
    v_and_b32 v9, 1, v85
    v_cndmask_b32 v131, v10, v131, vcc
    v_sub_u32 v131, s101, v131
    v_cmp_eq_u32 vcc, 0, v211
    v_lshlrev_b32 v9, 4, v9
    v_mov_b32 v159, 0x3f80
    v_cndmask_b32 v220, 0, v125, vcc
    v_cndmask_b32 v221, 0, v125, vcc
    v_cndmask_b32 v222, 0, v125, vcc
    v_cndmask_b32 v223, 0, v125, vcc
    v_lshlrev_b32 v125, v9, v159
    v_cmp_gt_u32 vcc, 2, v211
    v_mov_b32 v215, 0x5c005c00
    v_mov_b32 v89, 0xf149f2ca
    v_cndmask_b32 v216, 0, v125, vcc
    v_cndmask_b32 v218, 0, v125, vcc
    v_cmp_le_u32 vcc, 2, v211
    v_mul_u32_u24 v209, 5120, v8
    v_mad_u32_u24 v209, v211, s86, v209
    v_cndmask_b32 v217, 0, v125, vcc
    s_waitcnt lgkmcnt(0)
    s_barrier
    v_cndmask_b32 v219, 0, v125, vcc
    v_cmp_eq_u32 vcc, 0, v211
    v_and_b32 v159, 7, v50
    v_xor_b32 v125, v159, v143
    v_cndmask_b32 v212, 0, v215, vcc
    v_cmp_eq_u32 vcc, 1, v211
    v_lshl_add_u32 v49, v125, 4, v209
    v_xor_b32 v48, 64, v49
    v_cndmask_b32 v213, 0, v215, vcc
    v_cmp_eq_u32 vcc, 2, v211
    v_add_u32 v137, 40960, v49
    v_xor_b32 v136, 64, v137
    v_cndmask_b32 v214, 0, v215, vcc
    v_cmp_eq_u32 vcc, 3, v211
    v_add_u32 v209, 61440, v209
    v_add_u32 v125, s93, v143
    v_cndmask_b32 v215, 0, v215, vcc
    v_xor_b32 v125, v159, v125
    v_lshl_add_u32 v135, v125, 4, v209
    v_lshrrev_b32 v125, 1, v143
    v_add3_u32 v125, v125, s93, 4
    v_xor_b32 v125, v159, v125
    v_lshl_add_u32 v125, v125, 4, v209
    v_and_b32 v209, 1, v143
    v_lshl_add_u32 v134, v209, 3, v125
    v_lshlrev_b32 v125, 4, v85
    s_add_u32 s93, s54, 20480
    v_add_u32 v133, s93, v125
    v_add_u32 v163, 81920, v125
    s_lshr_b32 s93, s68, 1
    s_lshl_b32 s93, s93, 10
    s_add_u32 s93, s93, s94
    ds_read_b32 v210, v175
    v_add_u32 v159, s93, v163
    s_mul_i32 s93, s68, 7168
    s_add_u32 s93, s93, 135168
    v_mul_u32_u24 v209, 1792, v143
    v_add_u32 v125, s93, v209
    v_mul_u32_u24 v209, 112, v50
    v_add_u32 v50, v209, v125
    v_subrev_u32 v50, 28672, v50
    v_cmp_eq_u32 vcc, 0, v8
    v_add_u32 v209, 16, v125
    buffer_load_dwordx4 v84, s[32:35], s92 offen offset:0 lds
    ds_read_b32 v208, v199
    v_cndmask_b32 v132, v124, v125, vcc
    v_cmp_eq_u32 vcc, 3, v211
    v_mov_b32 v125, 0
    v_mov_b32 v167, 0
    v_cndmask_b32 v132, v132, v209, vcc
    v_mul_u32_u24 v209, 1792, v8
    v_lshl_add_u32 v209, v143, 3, v209
    v_lshl_add_u32 v209, v211, 1, v209
    v_add_u32 v209, s93, v209
    v_cmp_gt_u32 vcc, 3, v143
    s_add_u32 s93, s69, 1
    s_mul_i32 s94, s93, 58255
    ds_read_b32 v211, v131 offset:672
    v_cndmask_b32 v131, v124, v209, vcc
    s_lshr_b32 s94, s94, 22
    s_mul_i32 s94, s94, s63
    s_mul_i32 s56, s93, s62
    s_add_u32 s56, s56, s94
    ds_read_b32 v209, v138
    v_mov_b32 v124, 0
    s_sub_u32 s93, s71, 1
    s_cmp_eq_u32 s68, 0
    buffer_load_dwordx4 v37, s[32:35], s92 offen offset:1024 lds
    s_cselect_b32 s13, s93, -1
    s_cmp_gt_u32 s73, 20
    s_cselect_b32 s13, s13, -1
    s_and_b32 s93, s2, -8
    s_sub_u32 s93, 81920, s93
    s_sub_u32 s8, s38, s93
    s_subb_u32 s9, s39, 0
    v_sub_u32 v180, v175, v184
    buffer_load_dwordx4 v11, s[32:35], s92 offen offset:2048 lds
    s_add_u32 m0, s90, 36864
    s_mov_b32 s92, 110592
    ds_read_b32 v180, v180 offset:336
    v_sub_u32 v181, v175, v185
    v_sub_u32 v182, v175, v156
    v_sub_u32 v183, v175, v157
    v_sub_u32 v176, v175, v188
    v_sub_u32 v177, v175, v189
    ds_read_b32 v181, v181 offset:336
    v_sub_u32 v178, v175, v190
    v_sub_u32 v179, v175, v191
    v_sub_u32 v172, v175, v86
    v_sub_u32 v173, v175, v87
    v_sub_u32 v174, v175, v186
    ds_read_b32 v182, v182 offset:336
    v_sub_u32 v175, v175, v187
    v_sub_u32 v204, v199, v184
    v_sub_u32 v205, v199, v185
    buffer_load_dwordx4 v84, s[32:35], s92 offen offset:0 lds
    ds_read_b32 v183, v183 offset:336
    v_sub_u32 v206, v199, v156
    v_sub_u32 v207, v199, v157
    v_sub_u32 v200, v199, v188
    v_sub_u32 v201, v199, v189
    v_sub_u32 v202, v199, v190
    ds_read_b32 v176, v176 offset:336
    s_mov_b64 exec, 0
    s_cmp_eq_u32 s68, 2
    s_cbranch_scc1 L_pga
    s_cmp_eq_u32 s68, 3
    s_cbranch_scc1 L_pg2
    s_cmp_eq_u32 s68, 1
    s_cbranch_scc1 L_pg1
    s_branch L_pg0
L_prod:
    v_mbcnt_lo_u32_b32 v1, -1, 0
    v_mbcnt_hi_u32_b32 v1, -1, v1
    v_and_b32 v2, 15, v1
    v_lshrrev_b32 v3, 4, v1
    v_lshrrev_b32 v4, 2, v2
    v_and_b32 v5, 3, v2
    v_lshl_add_u32 v6, v4, 3, v5
    v_mul_u32_u24 v6, 384, v6
    s_lshr_b32 s85, s68, 1
    s_lshl1_add_u32 s84, s84, s85
    s_mul_i32 s85, s84, 12288
    v_add_u32 v6, s85, v6
    v_lshl_add_u32 v7, v3, 4, v6
    v_lshl_add_u32 v8, v3, 3, v6
    s_and_b32 s85, s68, 1
    s_mul_i32 s86, s85, 192
    s_sub_u32 s87, 192, s86
    s_mul_i32 s85, s85, 36
    s_add_u32 s85, s85, s84
    s_lshl_b32 s85, s85, 10
    v_lshl_add_u32 v18, v1, 4, s85
    v_mov_b32 v10, 0
    s_waitcnt lgkmcnt(0)
    s_mov_b32 s10, 73728
    s_mov_b32 s11, 0x20000
    s_mov_b32 s78, 73728
    s_mov_b32 s79, 0x20000
    buffer_load_dwordx4 v[20:23], v7, s[8:11], s86 offen offset:0
    buffer_load_dwordx2 v[36:37], v8, s[8:11], s86 offen offset:64
    buffer_load_dwordx4 v[24:27], v7, s[8:11], s86 offen offset:96
    buffer_load_dwordx2 v[38:39], v8, s[8:11], s86 offen offset:160
    buffer_load_dwordx4 v[28:31], v7, s[8:11], s87 offen offset:0
    buffer_load_dwordx2 v[40:41], v8, s[8:11], s87 offen offset:64
    buffer_load_dwordx4 v[32:35], v7, s[8:11], s87 offen offset:96
    buffer_load_dwordx2 v[42:43], v8, s[8:11], s87 offen offset:160
    buffer_load_dwordx4 v[44:47], v7, s[8:11], s86 offen offset:1536
    buffer_load_dwordx2 v[60:61], v8, s[8:11], s86 offen offset:1600
    buffer_load_dwordx4 v[48:51], v7, s[8:11], s86 offen offset:1632
    buffer_load_dwordx2 v[62:63], v8, s[8:11], s86 offen offset:1696
    buffer_load_dwordx4 v[52:55], v7, s[8:11], s87 offen offset:1536
    buffer_load_dwordx2 v[64:65], v8, s[8:11], s87 offen offset:1600
    buffer_load_dwordx4 v[56:59], v7, s[8:11], s87 offen offset:1632
    buffer_load_dwordx2 v[66:67], v8, s[8:11], s87 offen offset:1696
    s_add_u32 s88, s76, 0x18000
    s_addc_u32 s89, s77, 0
    global_load_dword v9, v10, s[88:89]
    global_load_dword v19, v10, s[38:39] offset:248 sc1
    v_mov_b32 v12, 0x3f803f80
    v_mov_b32 v13, 0x3f803f80
    v_mov_b32 v14, 0x3f803f80
    v_mov_b32 v15, 0x3f803f80
    v_and_b32 v10, 1, v1
    v_lshlrev_b32 v10, 4, v10
    v_mov_b32 v11, 0x3f80
    v_lshlrev_b32 v10, v10, v11
    v_cmp_eq_u32 vcc, v3, v4
    s_nop 1
    v_cndmask_b32 v10, 0, v10, vcc
    v_cmp_gt_u32 vcc, 2, v5
    s_nop 1
    v_cndmask_b32 v16, 0, v10, vcc
    v_cmp_le_u32 vcc, 2, v5
    s_nop 1
    v_cndmask_b32 v17, 0, v10, vcc
    s_waitcnt vmcnt(2)
    v_mfma_f32_16x16x32_bf16 v[68:71], v[20:23], v[12:15], 0
    v_mfma_f32_16x16x32_bf16 v[68:71], v[24:27], v[12:15], v[68:71]
    v_mfma_f32_16x16x32_bf16 v[68:71], v[28:31], v[12:15], v[68:71]
    v_mfma_f32_16x16x32_bf16 v[68:71], v[32:35], v[12:15], v[68:71]
    v_mfma_f32_16x16x32_bf16 v[68:71], v[36:39], v[12:15], v[68:71]
    v_mfma_f32_16x16x32_bf16 v[68:71], v[40:43], v[12:15], v[68:71]
    v_mfma_f32_16x16x32_bf16 v[72:75], v[44:47], v[12:15], 0
    v_mfma_f32_16x16x32_bf16 v[72:75], v[48:51], v[12:15], v[72:75]
    v_mfma_f32_16x16x32_bf16 v[72:75], v[52:55], v[12:15], v[72:75]
    v_mfma_f32_16x16x32_bf16 v[72:75], v[56:59], v[12:15], v[72:75]
    v_mfma_f32_16x16x32_bf16 v[72:75], v[60:63], v[12:15], v[72:75]
    v_mfma_f32_16x16x32_bf16 v[72:75], v[64:67], v[12:15], v[72:75]
    s_nop 1
    v_mul_f32 v68, 0xbbaaaaab, v68
    v_mul_f32 v69, 0xbbaaaaab, v69
    v_mul_f32 v70, 0xbbaaaaab, v70
    v_mul_f32 v71, 0xbbaaaaab, v71
    s_nop 1
    v_mfma_f32_16x16x16_bf16 v[76:79], v[20:21], v[16:17], v[68:71]
    v_mfma_f32_16x16x16_bf16 v[80:83], v[22:23], v[16:17], v[68:71]
    v_mfma_f32_16x16x16_bf16 v[84:87], v[36:37], v[16:17], v[68:71]
    v_mfma_f32_16x16x16_bf16 v[88:91], v[24:25], v[16:17], v[68:71]
    v_mfma_f32_16x16x16_bf16 v[92:95], v[26:27], v[16:17], v[68:71]
    v_mfma_f32_16x16x16_bf16 v[96:99], v[38:39], v[16:17], v[68:71]
    v_mul_f32 v72, 0xbbaaaaab, v72
    v_mul_f32 v73, 0xbbaaaaab, v73
    v_mul_f32 v74, 0xbbaaaaab, v74
    v_mul_f32 v75, 0xbbaaaaab, v75
    s_nop 1
    v_mfma_f32_16x16x16_bf16 v[100:103], v[44:45], v[16:17], v[72:75]
    v_mfma_f32_16x16x16_bf16 v[104:107], v[46:47], v[16:17], v[72:75]
    v_mfma_f32_16x16x16_bf16 v[108:111], v[60:61], v[16:17], v[72:75]
    v_mfma_f32_16x16x16_bf16 v[112:115], v[48:49], v[16:17], v[72:75]
    v_mfma_f32_16x16x16_bf16 v[116:119], v[50:51], v[16:17], v[72:75]
    v_mfma_f32_16x16x16_bf16 v[120:123], v[62:63], v[16:17], v[72:75]
    v_cvt_pk_bf16_f32 v124, v76, v77
    v_cvt_pk_bf16_f32 v125, v78, v79
    s_nop 0
    v_cvt_pk_bf16_f32 v126, v100, v101
    v_cvt_pk_bf16_f32 v127, v102, v103
    s_movk_i32 s85, 0
    buffer_store_dwordx4 v[124:127], v18, s[76:79], s85 offen sc1
    v_cvt_pk_bf16_f32 v128, v80, v81
    v_cvt_pk_bf16_f32 v129, v82, v83
    v_cvt_pk_bf16_f32 v130, v104, v105
    v_cvt_pk_bf16_f32 v131, v106, v107
    s_movk_i32 s85, 6144
    buffer_store_dwordx4 v[128:131], v18, s[76:79], s85 offen sc1
    v_cvt_pk_bf16_f32 v132, v84, v85
    v_cvt_pk_bf16_f32 v133, v86, v87
    v_cvt_pk_bf16_f32 v134, v108, v109
    v_cvt_pk_bf16_f32 v135, v110, v111
    s_movk_i32 s85, 12288
    buffer_store_dwordx4 v[132:135], v18, s[76:79], s85 offen sc1
    v_cvt_pk_bf16_f32 v136, v88, v89
    v_cvt_pk_bf16_f32 v137, v90, v91
    v_cvt_pk_bf16_f32 v138, v112, v113
    v_cvt_pk_bf16_f32 v139, v114, v115
    s_movk_i32 s85, 18432
    buffer_store_dwordx4 v[136:139], v18, s[76:79], s85 offen sc1
    v_cvt_pk_bf16_f32 v140, v92, v93
    v_cvt_pk_bf16_f32 v141, v94, v95
    v_cvt_pk_bf16_f32 v142, v116, v117
    v_cvt_pk_bf16_f32 v143, v118, v119
    s_movk_i32 s85, 24576
    buffer_store_dwordx4 v[140:143], v18, s[76:79], s85 offen sc1
    v_cvt_pk_bf16_f32 v144, v96, v97
    v_cvt_pk_bf16_f32 v145, v98, v99
    v_cvt_pk_bf16_f32 v146, v120, v121
    v_cvt_pk_bf16_f32 v147, v122, v123
    s_movk_i32 s85, 30720
    buffer_store_dwordx4 v[144:147], v18, s[76:79], s85 offen sc1
    v_mov_b32 v10, 0
    v_mov_b32 v11, 1
    s_mov_b32 s64, 8
    s_waitcnt vmcnt(0)
    s_barrier
    s_cmp_lg_u32 s68, 0
    s_cbranch_scc1 L_top2
    s_mov_b64 exec, 1
    global_atomic_add v10, v11, s[38:39] offset:248 sc1
    s_mov_b64 exec, -1
    s_branch L_top2
L_bndF:
    s_movk_i32 s73, 20
    s_movk_i32 s71, 18
    s_movk_i32 s70, -20
    s_mov_b32 s74, 0
    s_bitcmp1_b32 s2, 2
    s_cbranch_scc1 L_bndcF
    s_sub_u32 s94, s2, 248
    s_mul_i32 s69, s94, 18
    s_mov_b32 s74, 2
    s_sub_u32 s93, s93, 1373568
    v_cmp_le_u32 vcc, 4, v124
    v_add_u32 v86, 98896896, v130
    v_subrev_u32 v87, 1373568, v130
    v_cndmask_b32 v130, v86, v87, vcc
    v_cmp_le_u32 vcc, 4, v9
    v_add_u32 v86, 98896896, v129
    v_subrev_u32 v87, 1373568, v129
    v_cndmask_b32 v129, v86, v87, vcc
    v_cmp_le_u32 vcc, 4, v15
    v_add_u32 v86, 98896896, v128
    v_subrev_u32 v87, 1373568, v128
    v_cndmask_b32 v128, v86, v87, vcc
    v_cmp_le_u32 vcc, 4, v115
    v_add_u32 v86, 98896896, v127
    v_subrev_u32 v87, 1373568, v127
    v_cndmask_b32 v127, v86, v87, vcc
    v_cmp_le_u32 vcc, 4, v10
    v_add_u32 v86, 98896896, v126
    v_subrev_u32 v87, 1373568, v126
    v_cndmask_b32 v126, v86, v87, vcc
    s_cmp_lt_u32 s2, 256
    s_cbranch_scc1 L_bndrF
L_bndcF:
    s_sub_u32 s94, s2, 252
    s_mul_i32 s69, s94, 20
    s_lshr_b32 s71, s94, 1
    s_sub_u32 s69, s69, s71
    s_and_b32 s94, s94, 1
    s_sub_u32 s71, 20, s94
    s_cmp_eq_u32 s2, 255
    s_cselect_b32 s71, 13, s71
    s_mov_b32 s62, 1373568
    s_add_u32 s74, s74, 1
    s_sub_u32 s93, s93, 2688
    v_mad_i32_i24 v86, v124, -7, v51
    v_cmp_le_u32 vcc, 4, v86
    v_add_u32 v86, 193536, v130
    v_subrev_u32 v87, 2688, v130
    v_cndmask_b32 v130, v86, v87, vcc
    v_mad_i32_i24 v86, v9, -7, v125
    v_cmp_le_u32 vcc, 4, v86
    v_add_u32 v86, 193536, v129
    v_subrev_u32 v87, 2688, v129
    v_cndmask_b32 v129, v86, v87, vcc
    v_mad_i32_i24 v86, v15, -7, v131
    v_cmp_le_u32 vcc, 4, v86
    v_add_u32 v86, 193536, v128
    v_subrev_u32 v87, 2688, v128
    v_cndmask_b32 v128, v86, v87, vcc
    v_mad_i32_i24 v86, v115, -7, v11
    v_cmp_le_u32 vcc, 4, v86
    v_add_u32 v86, 193536, v127
    v_subrev_u32 v87, 2688, v127
    v_cndmask_b32 v127, v86, v87, vcc
    v_mad_i32_i24 v86, v10, -7, v22
    v_cmp_le_u32 vcc, 4, v86
    v_add_u32 v86, 193536, v126
    v_subrev_u32 v87, 2688, v126
    v_cndmask_b32 v126, v86, v87, vcc
    s_cmp_eq_u32 s2, 256
    s_cselect_b32 s62, 0, s62
    s_cselect_b32 s69, 0, s69
    s_cselect_b32 s71, 2, s71
    s_branch L_bndrF
L_maskF:
    s_and_b32 s20, s74, 2
    s_and_b32 s21, s74, 1
    s_mov_b32 s22, 0xc31044fe
    v_lshrrev_b32 v138, 2, v139
    v_add_u32 v138, 0, v138
    v_mul_u32_u24 v145, 37, v138
    v_lshrrev_b32 v144, 8, v145
    v_mad_i32_i24 v144, v144, -7, v138
    v_lshrrev_b32 v145, 10, v145
    v_lshrrev_b32 v144, 2, v144
    v_mul_u32_u24 v145, s20, v145
    v_mad_u32_u24 v138, v144, s21, v145
    v_cvt_f32_u32 v138, v138
    v_lshrrev_b32 v154, 2, v139
    v_add_u32 v154, 4, v154
    v_mul_u32_u24 v145, 37, v154
    v_lshrrev_b32 v144, 8, v145
    v_mad_i32_i24 v144, v144, -7, v154
    v_lshrrev_b32 v145, 10, v145
    v_lshrrev_b32 v144, 2, v144
    v_mul_u32_u24 v145, s20, v145
    v_mad_u32_u24 v154, v144, s21, v145
    v_cvt_f32_u32 v154, v154
    v_lshrrev_b32 v91, 2, v139
    v_add_u32 v91, 8, v91
    v_mul_u32_u24 v145, 37, v91
    v_lshrrev_b32 v144, 8, v145
    v_mad_i32_i24 v144, v144, -7, v91
    v_lshrrev_b32 v145, 10, v145
    v_lshrrev_b32 v144, 2, v144
    v_mul_u32_u24 v145, s20, v145
    v_mad_u32_u24 v91, v144, s21, v145
    v_cvt_f32_u32 v91, v91
    v_mad_u32_u24 v142, v143, 12, 0
    v_mul_u32_u24 v145, 37, v142
    v_lshrrev_b32 v144, 8, v145
    v_mad_i32_i24 v144, v144, -7, v142
    v_lshrrev_b32 v145, 10, v145
    v_lshrrev_b32 v144, 2, v144
    v_mul_u32_u24 v145, s20, v145
    v_mad_u32_u24 v142, v144, s21, v145
    v_cvt_f32_u32 v142, v142
    v_sub_f32 v145, v138, v142
    v_mul_f32 v145, v145, v145 clamp
    v_fmac_f32 v204, s22, v145
    v_sub_f32 v145, v154, v142
    v_mul_f32 v145, v145, v145 clamp
    v_fmac_f32 v192, s22, v145
    v_sub_f32 v145, v91, v142
    v_mul_f32 v145, v145, v145 clamp
    v_fmac_f32 v180, s22, v145
    v_mad_u32_u24 v142, v143, 12, 1
    v_mul_u32_u24 v145, 37, v142
    v_lshrrev_b32 v144, 8, v145
    v_mad_i32_i24 v144, v144, -7, v142
    v_lshrrev_b32 v145, 10, v145
    v_lshrrev_b32 v144, 2, v144
    v_mul_u32_u24 v145, s20, v145
    v_mad_u32_u24 v142, v144, s21, v145
    v_cvt_f32_u32 v142, v142
    v_sub_f32 v145, v138, v142
    v_mul_f32 v145, v145, v145 clamp
    v_fmac_f32 v205, s22, v145
    v_sub_f32 v145, v154, v142
    v_mul_f32 v145, v145, v145 clamp
    v_fmac_f32 v193, s22, v145
    v_sub_f32 v145, v91, v142
    v_mul_f32 v145, v145, v145 clamp
    v_fmac_f32 v181, s22, v145
    v_mad_u32_u24 v142, v143, 12, 2
    v_mul_u32_u24 v145, 37, v142
    v_lshrrev_b32 v144, 8, v145
    v_mad_i32_i24 v144, v144, -7, v142
    v_lshrrev_b32 v145, 10, v145
    v_lshrrev_b32 v144, 2, v144
    v_mul_u32_u24 v145, s20, v145
    v_mad_u32_u24 v142, v144, s21, v145
    v_cvt_f32_u32 v142, v142
    v_sub_f32 v145, v138, v142
    v_mul_f32 v145, v145, v145 clamp
    v_fmac_f32 v206, s22, v145
    v_sub_f32 v145, v154, v142
    v_mul_f32 v145, v145, v145 clamp
    v_fmac_f32 v194, s22, v145
    v_sub_f32 v145, v91, v142
    v_mul_f32 v145, v145, v145 clamp
    v_fmac_f32 v182, s22, v145
    v_mad_u32_u24 v142, v143, 12, 3
    v_mul_u32_u24 v145, 37, v142
    v_lshrrev_b32 v144, 8, v145
    v_mad_i32_i24 v144, v144, -7, v142
    v_lshrrev_b32 v145, 10, v145
    v_lshrrev_b32 v144, 2, v144
    v_mul_u32_u24 v145, s20, v145
    v_mad_u32_u24 v142, v144, s21, v145
    v_cvt_f32_u32 v142, v142
    v_sub_f32 v145, v138, v142
    v_mul_f32 v145, v145, v145 clamp
    v_fmac_f32 v207, s22, v145
    v_sub_f32 v145, v154, v142
    v_mul_f32 v145, v145, v145 clamp
    v_fmac_f32 v195, s22, v145
    v_sub_f32 v145, v91, v142
    v_mul_f32 v145, v145, v145 clamp
    v_fmac_f32 v183, s22, v145
    v_mad_u32_u24 v142, v143, 12, 4
    v_mul_u32_u24 v145, 37, v142
    v_lshrrev_b32 v144, 8, v145
    v_mad_i32_i24 v144, v144, -7, v142
    v_lshrrev_b32 v145, 10, v145
    v_lshrrev_b32 v144, 2, v144
    v_mul_u32_u24 v145, s20, v145
    v_mad_u32_u24 v142, v144, s21, v145
    v_cvt_f32_u32 v142, v142
    v_sub_f32 v145, v138, v142
    v_mul_f32 v145, v145, v145 clamp
    v_fmac_f32 v200, s22, v145
    v_sub_f32 v145, v154, v142
    v_mul_f32 v145, v145, v145 clamp
    v_fmac_f32 v188, s22, v145
    v_sub_f32 v145, v91, v142
    v_mul_f32 v145, v145, v145 clamp
    v_fmac_f32 v176, s22, v145
    v_mad_u32_u24 v142, v143, 12, 5
    v_mul_u32_u24 v145, 37, v142
    v_lshrrev_b32 v144, 8, v145
    v_mad_i32_i24 v144, v144, -7, v142
    v_lshrrev_b32 v145, 10, v145
    v_lshrrev_b32 v144, 2, v144
    v_mul_u32_u24 v145, s20, v145
    v_mad_u32_u24 v142, v144, s21, v145
    v_cvt_f32_u32 v142, v142
    v_sub_f32 v145, v138, v142
    v_mul_f32 v145, v145, v145 clamp
    v_fmac_f32 v201, s22, v145
    v_sub_f32 v145, v154, v142
    v_mul_f32 v145, v145, v145 clamp
    v_fmac_f32 v189, s22, v145
    v_sub_f32 v145, v91, v142
    v_mul_f32 v145, v145, v145 clamp
    v_fmac_f32 v177, s22, v145
    v_mad_u32_u24 v142, v143, 12, 6
    v_mul_u32_u24 v145, 37, v142
    v_lshrrev_b32 v144, 8, v145
    v_mad_i32_i24 v144, v144, -7, v142
    v_lshrrev_b32 v145, 10, v145
    v_lshrrev_b32 v144, 2, v144
    v_mul_u32_u24 v145, s20, v145
    v_mad_u32_u24 v142, v144, s21, v145
    v_cvt_f32_u32 v142, v142
    v_sub_f32 v145, v138, v142
    v_mul_f32 v145, v145, v145 clamp
    v_fmac_f32 v202, s22, v145
    v_sub_f32 v145, v154, v142
    v_mul_f32 v145, v145, v145 clamp
    v_fmac_f32 v190, s22, v145
    v_sub_f32 v145, v91, v142
    v_mul_f32 v145, v145, v145 clamp
    v_fmac_f32 v178, s22, v145
    v_mad_u32_u24 v142, v143, 12, 7
    v_mul_u32_u24 v145, 37, v142
    v_lshrrev_b32 v144, 8, v145
    v_mad_i32_i24 v144, v144, -7, v142
    v_lshrrev_b32 v145, 10, v145
    v_lshrrev_b32 v144, 2, v144
    v_mul_u32_u24 v145, s20, v145
    v_mad_u32_u24 v142, v144, s21, v145
    v_cvt_f32_u32 v142, v142
    v_sub_f32 v145, v138, v142
    v_mul_f32 v145, v145, v145 clamp
    v_fmac_f32 v203, s22, v145
    v_sub_f32 v145, v154, v142
    v_mul_f32 v145, v145, v145 clamp
    v_fmac_f32 v191, s22, v145
    v_sub_f32 v145, v91, v142
    v_mul_f32 v145, v145, v145 clamp
    v_fmac_f32 v179, s22, v145
    v_mad_u32_u24 v142, v143, 12, 8
    v_mul_u32_u24 v145, 37, v142
    v_lshrrev_b32 v144, 8, v145
    v_mad_i32_i24 v144, v144, -7, v142
    v_lshrrev_b32 v145, 10, v145
    v_lshrrev_b32 v144, 2, v144
    v_mul_u32_u24 v145, s20, v145
    v_mad_u32_u24 v142, v144, s21, v145
    v_cvt_f32_u32 v142, v142
    v_sub_f32 v145, v138, v142
    v_mul_f32 v145, v145, v145 clamp
    v_fmac_f32 v196, s22, v145
    v_sub_f32 v145, v154, v142
    v_mul_f32 v145, v145, v145 clamp
    v_fmac_f32 v184, s22, v145
    v_sub_f32 v145, v91, v142
    v_mul_f32 v145, v145, v145 clamp
    v_fmac_f32 v172, s22, v145
    v_mad_u32_u24 v142, v143, 12, 9
    v_mul_u32_u24 v145, 37, v142
    v_lshrrev_b32 v144, 8, v145
    v_mad_i32_i24 v144, v144, -7, v142
    v_lshrrev_b32 v145, 10, v145
    v_lshrrev_b32 v144, 2, v144
    v_mul_u32_u24 v145, s20, v145
    v_mad_u32_u24 v142, v144, s21, v145
    v_cvt_f32_u32 v142, v142
    v_sub_f32 v145, v138, v142
    v_mul_f32 v145, v145, v145 clamp
    v_fmac_f32 v197, s22, v145
    v_sub_f32 v145, v154, v142
    v_mul_f32 v145, v145, v145 clamp
    v_fmac_f32 v185, s22, v145
    v_sub_f32 v145, v91, v142
    v_mul_f32 v145, v145, v145 clamp
    v_fmac_f32 v173, s22, v145
    v_mad_u32_u24 v142, v143, 12, 10
    v_mul_u32_u24 v145, 37, v142
    v_lshrrev_b32 v144, 8, v145
    v_mad_i32_i24 v144, v144, -7, v142
    v_lshrrev_b32 v145, 10, v145
    v_lshrrev_b32 v144, 2, v144
    v_mul_u32_u24 v145, s20, v145
    v_mad_u32_u24 v142, v144, s21, v145
    v_cvt_f32_u32 v142, v142
    v_sub_f32 v145, v138, v142
    v_mul_f32 v145, v145, v145 clamp
    v_fmac_f32 v198, s22, v145
    v_sub_f32 v145, v154, v142
    v_mul_f32 v145, v145, v145 clamp
    v_fmac_f32 v186, s22, v145
    v_sub_f32 v145, v91, v142
    v_mul_f32 v145, v145, v145 clamp
    v_fmac_f32 v174, s22, v145
    v_mad_u32_u24 v142, v143, 12, 11
    v_mul_u32_u24 v145, 37, v142
    v_lshrrev_b32 v144, 8, v145
    v_mad_i32_i24 v144, v144, -7, v142
    v_lshrrev_b32 v145, 10, v145
    v_lshrrev_b32 v144, 2, v144
    v_mul_u32_u24 v145, s20, v145
    v_mad_u32_u24 v142, v144, s21, v145
    v_cvt_f32_u32 v142, v142
    v_sub_f32 v145, v138, v142
    v_mul_f32 v145, v145, v145 clamp
    v_fmac_f32 v199, s22, v145
    v_sub_f32 v145, v154, v142
    v_mul_f32 v145, v145, v145 clamp
    v_fmac_f32 v187, s22, v145
    v_sub_f32 v145, v91, v142
    v_mul_f32 v145, v145, v145 clamp
    v_fmac_f32 v175, s22, v145
    v_cvt_f32_u32 v142, s74
    v_sub_f32 v145, v138, v142
    v_mul_f32 v145, v145, v145 clamp
    v_fmac_f32 v208, s22, v145
    v_sub_f32 v145, v154, v142
    v_mul_f32 v145, v145, v145 clamp
    v_fmac_f32 v209, s22, v145
    v_sub_f32 v145, v91, v142
    v_mul_f32 v145, v145, v145 clamp
    v_fmac_f32 v210, s22, v145
    v_lshrrev_b32 v138, 2, v139
    v_lshl_add_u32 v138, v143, 2, v138
    v_add_u32 v145, 1, v143
    v_lshrrev_b32 v145, 2, v145
    v_mad_u32_u24 v138, v145, 36, v138
    v_min_u32 v138, 48, v138
    v_mul_u32_u24 v145, 37, v138
    v_lshrrev_b32 v144, 8, v145
    v_mad_i32_i24 v144, v144, -7, v138
    v_lshrrev_b32 v145, 10, v145
    v_lshrrev_b32 v144, 2, v144
    v_mul_u32_u24 v145, s20, v145
    v_mad_u32_u24 v138, v144, s21, v145
    v_cvt_f32_u32 v138, v138
    v_sub_f32 v145, v138, v142
    v_mul_f32 v145, v145, v145 clamp
    v_fmac_f32 v211, s22, v145
    s_branch L_nomaskF
L_spin:
    s_movk_i32 s95, 300
L_spin1:
    global_load_dword v101, v167, s[38:39] offset:248 sc1
    s_waitcnt vmcnt(0)
    v_readfirstlane_b32 s94, v101
    s_nop 1
    s_cmp_ge_u32 s94, 3
    s_cbranch_scc1 L_spinr
    s_sub_u32 s95, s95, 1
    s_cmp_lg_u32 s95, 0
    s_cbranch_scc1 L_spin1
    v_mov_b32 v125, -1
    s_branch L_spinr
.p2alignl 12, 0xbf810000
L_main:
    s_mov_b64 exec, -1
    s_waitcnt vmcnt(10)
    s_barrier
    v_sub_u32 v203, v199, v191
    v_sub_u32 v196, v199, v86
    v_sub_u32 v197, v199, v87
    v_sub_u32 v198, v199, v186
    ds_read_b128 v[20:23], v49 offset:40960
    v_sub_u32 v199, v199, v187
    v_sub_u32 v192, v138, v184
    v_sub_u32 v193, v138, v185
    ds_read_b128 v[16:19], v49 offset:42496
    v_sub_u32 v194, v138, v156
    v_sub_u32 v195, v138, v157
    v_sub_u32 v188, v138, v188
    ds_read_b128 v[4:7], v49 offset:0
    buffer_load_dwordx4 v37, s[32:35], s92 offen offset:1024 lds
    v_sub_u32 v189, v138, v189
    v_sub_u32 v190, v138, v190
    ds_read_b128 v[0:3], v49 offset:1536
    v_sub_u32 v191, v138, v191
    v_sub_u32 v184, v138, v86
    v_sub_u32 v185, v138, v87
    ds_read_b128 v[28:31], v49 offset:3072
    v_sub_u32 v186, v138, v186
    v_sub_u32 v187, v138, v187
    ds_read_b32 v177, v177 offset:336
    buffer_load_dwordx4 v11, s[32:35], s92 offen offset:2048 lds
    s_add_u32 m0, s90, 49152
    s_mov_b32 s92, 147456
    ds_read_b32 v178, v178 offset:336
    ds_read_b32 v179, v179 offset:336
    ds_read_b32 v172, v172 offset:336
    buffer_load_dwordx4 v84, s[32:35], s92 offen offset:0 lds
    s_waitcnt vmcnt(10)
    ds_read_b64_tr_b16 a[0:1], v51 offset:0
    ds_read_b64_tr_b16 a[2:3], v51 offset:768
    ds_read_b64_tr_b16 a[24:25], v51 offset:32
    ds_read_b64_tr_b16 a[26:27], v51 offset:800
    ds_read_b64_tr_b16 a[48:49], v51 offset:64
    ds_read_b64_tr_b16 a[50:51], v51 offset:832
    ds_read_b32 v173, v173 offset:336
    ds_read_b32 v174, v174 offset:336
    buffer_load_dwordx4 v37, s[32:35], s92 offen offset:1024 lds
    ds_read_b32 v175, v175 offset:336
    ds_read_b32 v204, v204 offset:336
    ds_read_b32 v205, v205 offset:336
    s_waitcnt lgkmcnt(8)
    v_mfma_f32_16x16x32_bf16 v[64:67], a[0:3], v[20:23], 0
    s_waitcnt lgkmcnt(7)
    buffer_load_dwordx4 v11, s[32:35], s92 offen offset:2048 lds
    v_mfma_f32_16x16x32_bf16 v[60:63], a[24:27], v[20:23], 0
    s_waitcnt lgkmcnt(5)
    s_add_u32 m0, s90, 61440
    ds_read_b32 v206, v206 offset:336
    v_mfma_f32_16x16x32_bf16 v[12:15], a[48:51], v[20:23], 0
    s_mov_b32 s92, 184320
    v_mfma_f32_16x16x32_bf16 v[56:59], a[0:3], v[16:19], 0
    ds_read_b128 v[24:27], v48 offset:40960
    v_mfma_f32_16x16x32_bf16 v[44:47], a[24:27], v[16:19], 0
    ds_read_b32 v207, v207 offset:336
    v_mfma_f32_16x16x32_bf16 v[32:35], a[48:51], v[16:19], 0
    buffer_load_dwordx4 v84, s[32:35], s92 offen offset:0 lds
    v_mfma_f32_16x16x32_bf16 v[16:19], a[0:3], v[4:7], 0
    s_waitcnt vmcnt(10)
    ds_read_b64_tr_b16 a[4:5], v51 offset:12288
    v_mfma_f32_16x16x32_bf16 v[228:231], a[24:27], v[4:7], 0
    ds_read_b64_tr_b16 a[6:7], v51 offset:13056
    v_mfma_f32_16x16x32_bf16 v[20:23], a[48:51], v[4:7], 0
    ds_read_b64_tr_b16 a[28:29], v51 offset:12320
    v_mfma_f32_16x16x32_bf16 v[76:79], a[0:3], v[0:3], 0
    ds_read_b64_tr_b16 a[30:31], v51 offset:13088
    v_mfma_f32_16x16x32_bf16 v[72:75], a[24:27], v[0:3], 0
    buffer_load_dwordx4 v37, s[32:35], s92 offen offset:1024 lds
    ds_read_b64_tr_b16 a[52:53], v51 offset:12352
    v_mfma_f32_16x16x32_bf16 v[240:243], a[48:51], v[0:3], 0
    ds_read_b64_tr_b16 a[54:55], v51 offset:13120
    v_mfma_f32_16x16x32_bf16 v[40:43], a[0:3], v[28:31], 0
    ds_read_b128 v[4:7], v48 offset:42496
    v_mfma_f32_16x16x32_bf16 v[96:99], a[24:27], v[28:31], 0
    ds_read_b128 v[0:3], v48 offset:0
    v_mfma_f32_16x16x32_bf16 v[80:83], a[48:51], v[28:31], 0
    s_waitcnt lgkmcnt(6)
    ds_read_b128 v[52:55], v48 offset:1536
    buffer_load_dwordx4 v11, s[32:35], s92 offen offset:2048 lds
    s_add_u32 m0, s90, 0
    s_mov_b32 s92, 384
    v_mfma_f32_16x16x32_bf16 v[64:67], a[4:7], v[24:27], v[64:67]
    s_waitcnt lgkmcnt(5)
    ds_read_b128 v[28:31], v48 offset:3072
    ds_read_b32 v200, v200 offset:336
    v_mfma_f32_16x16x32_bf16 v[60:63], a[28:31], v[24:27], v[60:63]
    s_waitcnt lgkmcnt(5)
    ds_read_b32 v201, v201 offset:336
    v_mfma_f32_16x16x32_bf16 v[12:15], a[52:55], v[24:27], v[12:15]
    s_waitcnt vmcnt(9) lgkmcnt(5)
    buffer_load_dwordx4 v84, s[32:35], s92 offen offset:0 lds
    ds_read_b64_tr_b16 a[8:9], v51 offset:24576
    v_mfma_f32_16x16x32_bf16 v[56:59], a[4:7], v[4:7], v[56:59]
    ds_read_b64_tr_b16 a[10:11], v51 offset:25344
    v_mfma_f32_16x16x32_bf16 v[44:47], a[28:31], v[4:7], v[44:47]
    ds_read_b64_tr_b16 a[32:33], v51 offset:24608
    v_mfma_f32_16x16x32_bf16 v[32:35], a[52:55], v[4:7], v[32:35]
    s_waitcnt lgkmcnt(6)
    ds_read_b64_tr_b16 a[34:35], v51 offset:25376
    v_mfma_f32_16x16x32_bf16 v[16:19], a[4:7], v[0:3], v[16:19]
    ds_read_b64_tr_b16 a[56:57], v51 offset:24640
    v_mfma_f32_16x16x32_bf16 v[228:231], a[28:31], v[0:3], v[228:231]
    buffer_load_dwordx4 v37, s[32:35], s92 offen offset:1024 lds
    ds_read_b64_tr_b16 a[58:59], v51 offset:25408
    v_mfma_f32_16x16x32_bf16 v[20:23], a[52:55], v[0:3], v[20:23]
    ds_read_b128 v[24:27], v49 offset:41088
    v_mfma_f32_16x16x32_bf16 v[76:79], a[4:7], v[52:55], v[76:79]
    ds_read_b128 v[4:7], v49 offset:42624
    v_mfma_f32_16x16x32_bf16 v[72:75], a[28:31], v[52:55], v[72:75]
    ds_read_b128 v[0:3], v49 offset:128
    v_mfma_f32_16x16x32_bf16 v[240:243], a[52:55], v[52:55], v[240:243]
    s_waitcnt lgkmcnt(8)
    ds_read_b128 v[52:55], v49 offset:1664
    v_mfma_f32_16x16x32_bf16 v[40:43], a[4:7], v[28:31], v[40:43]
    buffer_load_dwordx4 v11, s[32:35], s92 offen offset:2048 lds
    ds_read_b32 v202, v202 offset:336
    v_mfma_f32_16x16x32_bf16 v[96:99], a[28:31], v[28:31], v[96:99]
    s_add_u32 m0, s90, 12288
    v_mfma_f32_16x16x32_bf16 v[80:83], a[52:55], v[28:31], v[80:83]
    s_mov_b32 s92, 37248
    ds_read_b128 v[28:31], v49 offset:3200
    ds_read_b32 v203, v203 offset:336
    ds_read_b32 v196, v196 offset:336
    s_waitcnt lgkmcnt(7)
    v_mfma_f32_16x16x32_bf16 v[64:67], a[8:11], v[24:27], v[64:67]
    buffer_load_dwordx4 v84, s[32:35], s92 offen offset:0 lds
    v_mfma_f32_16x16x32_bf16 v[60:63], a[32:35], v[24:27], v[60:63]
    s_waitcnt vmcnt(10)
    ds_read_b64_tr_b16 a[12:13], v51 offset:36864
    v_mfma_f32_16x16x32_bf16 v[12:15], a[56:59], v[24:27], v[12:15]
    s_waitcnt lgkmcnt(5)
    ds_read_b64_tr_b16 a[14:15], v51 offset:37632
    v_mfma_f32_16x16x32_bf16 v[56:59], a[8:11], v[4:7], v[56:59]
    ds_read_b64_tr_b16 a[36:37], v51 offset:36896
    v_mfma_f32_16x16x32_bf16 v[44:47], a[32:35], v[4:7], v[44:47]
    ds_read_b64_tr_b16 a[38:39], v51 offset:37664
    v_mfma_f32_16x16x32_bf16 v[32:35], a[56:59], v[4:7], v[32:35]
    buffer_load_dwordx4 v37, s[32:35], s92 offen offset:1024 lds
    ds_read_b64_tr_b16 a[60:61], v51 offset:36928
    v_mfma_f32_16x16x32_bf16 v[16:19], a[8:11], v[0:3], v[16:19]
    ds_read_b64_tr_b16 a[62:63], v51 offset:37696
    v_mfma_f32_16x16x32_bf16 v[228:231], a[32:35], v[0:3], v[228:231]
    ds_read_b128 v[24:27], v48 offset:41088
    v_mfma_f32_16x16x32_bf16 v[20:23], a[56:59], v[0:3], v[20:23]
    ds_read_b128 v[0:3], v48 offset:42624
    v_mfma_f32_16x16x32_bf16 v[76:79], a[8:11], v[52:55], v[76:79]
    ds_read_b128 v[4:7], v48 offset:128
    v_mfma_f32_16x16x32_bf16 v[72:75], a[32:35], v[52:55], v[72:75]
    buffer_load_dwordx4 v11, s[32:35], s92 offen offset:2048 lds
    ds_read_b32 v197, v197 offset:336
    v_mfma_f32_16x16x32_bf16 v[240:243], a[56:59], v[52:55], v[240:243]
    s_waitcnt lgkmcnt(8)
    s_add_u32 m0, s90, 24576
    v_mfma_f32_16x16x32_bf16 v[40:43], a[8:11], v[28:31], v[40:43]
    s_mov_b32 s92, 74112
    ds_read_b128 v[92:95], v48 offset:1664
    v_mfma_f32_16x16x32_bf16 v[96:99], a[32:35], v[28:31], v[96:99]
    ds_read_b32 v198, v198 offset:336
    v_mfma_f32_16x16x32_bf16 v[80:83], a[56:59], v[28:31], v[80:83]
    s_waitcnt vmcnt(9) lgkmcnt(5)
    buffer_load_dwordx4 v84, s[32:35], s92 offen offset:0 lds
    ds_read_b64_tr_b16 a[16:17], v51 offset:49152
    ds_read_b64_tr_b16 a[18:19], v51 offset:49920
    v_mfma_f32_16x16x32_bf16 v[64:67], a[12:15], v[24:27], v[64:67]
    ds_read_b64_tr_b16 a[40:41], v51 offset:49184
    v_mfma_f32_16x16x32_bf16 v[60:63], a[36:39], v[24:27], v[60:63]
    ds_read_b64_tr_b16 a[42:43], v51 offset:49952
    v_mfma_f32_16x16x32_bf16 v[12:15], a[60:63], v[24:27], v[12:15]
    s_waitcnt lgkmcnt(7)
    ds_read_b64_tr_b16 a[64:65], v51 offset:49216
    v_mfma_f32_16x16x32_bf16 v[56:59], a[12:15], v[0:3], v[56:59]
    ds_read_b64_tr_b16 a[66:67], v51 offset:49984
    buffer_load_dwordx4 v37, s[32:35], s92 offen offset:1024 lds
    v_mfma_f32_16x16x32_bf16 v[44:47], a[36:39], v[0:3], v[44:47]
    ds_read_b128 v[24:27], v48 offset:3200
    v_mfma_f32_16x16x32_bf16 v[32:35], a[60:63], v[0:3], v[32:35]
    ds_read_b128 v[100:103], v48 offset:41216
    v_mfma_f32_16x16x32_bf16 v[16:19], a[12:15], v[4:7], v[16:19]
    ds_read_b128 v[68:71], v48 offset:42752
    v_mfma_f32_16x16x32_bf16 v[228:231], a[36:39], v[4:7], v[228:231]
    ds_read_b128 v[0:3], v48 offset:256
    v_mfma_f32_16x16x32_bf16 v[20:23], a[60:63], v[4:7], v[20:23]
    s_waitcnt lgkmcnt(8)
    ds_read_b128 v[28:31], v48 offset:1792
    buffer_load_dwordx4 v11, s[32:35], s92 offen offset:2048 lds
    v_mfma_f32_16x16x32_bf16 v[76:79], a[12:15], v[92:95], v[76:79]
    s_add_u32 m0, s90, 36864
    ds_read_b128 v[4:7], v48 offset:3328
    v_mfma_f32_16x16x32_bf16 v[72:75], a[36:39], v[92:95], v[72:75]
    s_mov_b32 s92, 110976
    ds_read_b128 v[52:55], v49 offset:41216
    v_mfma_f32_16x16x32_bf16 v[240:243], a[60:63], v[92:95], v[240:243]
    s_waitcnt lgkmcnt(6)
    ds_read_b128 v[92:95], v49 offset:42752
    ds_read_b32 v199, v199 offset:336
    v_mfma_f32_16x16x32_bf16 v[40:43], a[12:15], v[24:27], v[40:43]
    s_waitcnt vmcnt(9)
    buffer_load_dwordx4 v84, s[32:35], s92 offen offset:0 lds
    ds_read_b64_tr_b16 a[20:21], v51 offset:61440
    v_mfma_f32_16x16x32_bf16 v[96:99], a[36:39], v[24:27], v[96:99]
    ds_read_b64_tr_b16 a[22:23], v51 offset:62208
    v_mfma_f32_16x16x32_bf16 v[80:83], a[60:63], v[24:27], v[80:83]
    ds_read_b64_tr_b16 a[44:45], v51 offset:61472
    ds_read_b64_tr_b16 a[46:47], v51 offset:62240
    ds_read_b64_tr_b16 a[68:69], v51 offset:61504
    ds_read_b64_tr_b16 a[70:71], v51 offset:62272
    ds_read_b128 v[24:27], v49 offset:256
    buffer_load_dwordx4 v37, s[32:35], s92 offen offset:1024 lds
    ds_read_b32 v192, v192 offset:336
    s_waitcnt lgkmcnt(10)
    v_mfma_f32_16x16x32_bf16 v[64:67], a[16:19], v[52:55], v[64:67]
    v_mfma_f32_16x16x32_bf16 v[60:63], a[40:43], v[52:55], v[60:63]
    ds_read_b32 v193, v193 offset:336
    v_mfma_f32_16x16x32_bf16 v[12:15], a[64:67], v[52:55], v[12:15]
    s_waitcnt lgkmcnt(9)
    v_mfma_f32_16x16x32_bf16 v[56:59], a[16:19], v[92:95], v[56:59]
    ds_read_b32 v194, v194 offset:336
    v_mfma_f32_16x16x32_bf16 v[44:47], a[40:43], v[92:95], v[44:47]
    s_waitcnt lgkmcnt(8)
    buffer_load_dwordx4 v11, s[32:35], s92 offen offset:2048 lds
    v_mfma_f32_16x16x32_bf16 v[64:67], a[20:23], v[100:103], v[64:67]
    s_waitcnt lgkmcnt(6)
    s_add_u32 m0, s90, 49152
    ds_read_b128 v[52:55], v49 offset:1792
    v_mfma_f32_16x16x32_bf16 v[60:63], a[44:47], v[100:103], v[60:63]
    s_waitcnt lgkmcnt(5)
    s_mov_b32 s92, 147840
    ds_read_b32 v195, v195 offset:336
    v_mfma_f32_16x16x32_bf16 v[12:15], a[68:71], v[100:103], v[12:15]
    v_cvt_pk_f16_f32 v64, v64, v65
    v_cvt_pk_f16_f32 v65, v66, v67
    v_mfma_f32_16x16x32_bf16 v[56:59], a[20:23], v[68:71], v[56:59]
    ds_read_b32 v188, v188 offset:336
    v_pk_fma_f16 v88, v64, v64, s3
    v_mfma_f32_16x16x32_bf16 v[44:47], a[44:47], v[68:71], v[44:47]
    buffer_load_dwordx4 v84, s[32:35], s92 offen offset:0 lds
    v_pk_fmac_f16 v88, v65, v65
    v_mfma_f32_16x16x32_bf16 v[32:35], a[64:67], v[92:95], v[32:35]
    s_waitcnt vmcnt(10)
    ds_read_b64_tr_b16 a[72:73], v51 offset:0
    v_cvt_pk_f16_f32 v66, v60, v61
    v_mfma_f32_16x16x32_bf16 v[32:35], a[68:71], v[68:71], v[32:35]
    s_waitcnt lgkmcnt(5)
    ds_read_b64_tr_b16 a[74:75], v51 offset:768
    v_cvt_pk_f16_f32 v67, v62, v63
    v_mfma_f32_16x16x32_bf16 v[16:19], a[16:19], v[24:27], v[16:19]
    ds_read_b64_tr_b16 a[96:97], v51 offset:32
    v_pk_fmac_f16 v88, v66, v66
    v_mfma_f32_16x16x32_bf16 v[16:19], a[20:23], v[0:3], v[16:19]
    ds_read_b64_tr_b16 a[98:99], v51 offset:800
    v_pk_fmac_f16 v88, v67, v67
    v_mfma_f32_16x16x32_bf16 v[228:231], a[40:43], v[24:27], v[228:231]
    ds_read_b64_tr_b16 a[120:121], v51 offset:64
    buffer_load_dwordx4 v37, s[32:35], s92 offen offset:1024 lds
    v_mfma_f32_16x16x32_bf16 v[228:231], a[44:47], v[0:3], v[228:231]
    ds_read_b64_tr_b16 a[122:123], v51 offset:832
    v_cvt_pk_f16_f32 v156, v12, v13
    v_mfma_f32_16x16x32_bf16 v[20:23], a[64:67], v[24:27], v[20:23]
    ds_read_b128 v[24:27], v49 offset:3328
    v_cvt_pk_f16_f32 v157, v14, v15
    v_mfma_f32_16x16x32_bf16 v[20:23], a[68:71], v[0:3], v[20:23]
    s_waitcnt lgkmcnt(7)
    ds_read_b128 v[0:3], v49 offset:40960
    v_pk_fmac_f16 v88, v156, v156
    v_mfma_f32_16x16x32_bf16 v[76:79], a[16:19], v[52:55], v[76:79]
    ds_read_b32 v189, v189 offset:336
    v_pk_fmac_f16 v88, v157, v157
    v_mfma_f32_16x16x32_bf16 v[76:79], a[20:23], v[28:31], v[76:79]
    buffer_load_dwordx4 v11, s[32:35], s92 offen offset:2048 lds
    v_cvt_pk_f16_f32 v108, v56, v57
    v_mfma_f32_16x16x32_bf16 v[72:75], a[40:43], v[52:55], v[72:75]
    s_add_u32 m0, s90, 61440
    ds_read_b128 v[12:15], v49 offset:42496
    v_cvt_pk_f16_f32 v109, v58, v59
    v_mfma_f32_16x16x32_bf16 v[72:75], a[44:47], v[28:31], v[72:75]
    s_mov_b32 s92, 184704
    ds_read_b32 v190, v190 offset:336
    v_pk_fma_f16 v90, v108, v108, s3
    v_mfma_f32_16x16x32_bf16 v[240:243], a[64:67], v[52:55], v[240:243]
    v_pk_fmac_f16 v90, v109, v109
    v_cvt_pk_f16_f32 v110, v44, v45
    v_mfma_f32_16x16x32_bf16 v[240:243], a[68:71], v[28:31], v[240:243]
    s_waitcnt vmcnt(9) lgkmcnt(4)
    ds_read_b128 v[28:31], v49 offset:0
    v_cvt_pk_f16_f32 v111, v46, v47
    v_pk_fmac_f16 v90, v110, v110
    v_pk_fmac_f16 v90, v111, v111
    ds_read_b64_tr_b16 a[76:77], v51 offset:12288
    v_mfma_f32_16x16x32_bf16 v[40:43], a[16:19], v[24:27], v[40:43]
    ds_read_b64_tr_b16 a[78:79], v51 offset:13056
    buffer_load_dwordx4 v84, s[32:35], s92 offen offset:0 lds
    v_mfma_f32_16x16x32_bf16 v[40:43], a[20:23], v[4:7], v[40:43]
    ds_read_b64_tr_b16 a[100:101], v51 offset:12320
    v_cvt_pk_f16_f32 v86, v32, v33
    v_mfma_f32_16x16x32_bf16 v[96:99], a[40:43], v[24:27], v[96:99]
    ds_read_b64_tr_b16 a[102:103], v51 offset:13088
    v_cvt_pk_f16_f32 v87, v34, v35
    v_mfma_f32_16x16x32_bf16 v[96:99], a[44:47], v[4:7], v[96:99]
    ds_read_b64_tr_b16 a[124:125], v51 offset:12352
    v_pk_fmac_f16 v90, v86, v86
    v_mfma_f32_16x16x32_bf16 v[80:83], a[64:67], v[24:27], v[80:83]
    ds_read_b64_tr_b16 a[126:127], v51 offset:13120
    buffer_load_dwordx4 v37, s[32:35], s92 offen offset:1024 lds
    v_mfma_f32_16x16x32_bf16 v[80:83], a[68:71], v[4:7], v[80:83]
    s_waitcnt lgkmcnt(7)
    ds_read_b128 v[4:7], v49 offset:1536
    v_pk_fmac_f16 v90, v87, v87
    v_mfma_f32_16x16x32_bf16 v[120:123], a[72:75], v[0:3], 0
    ds_read_b128 v[52:55], v49 offset:3072
    v_cvt_pk_f16_f32 v24, v16, v17
    v_mfma_f32_16x16x32_bf16 v[148:151], a[96:99], v[0:3], 0
    ds_read_b32 v191, v191 offset:336
    v_cvt_pk_f16_f32 v25, v18, v19
    v_mfma_f32_16x16x32_bf16 v[56:59], a[120:123], v[0:3], 0
    v_pk_fma_f16 v224, v24, v24, s3
    v_pk_fmac_f16 v224, v25, v25
    v_mfma_f32_16x16x32_bf16 v[116:119], a[72:75], v[12:15], 0
    buffer_load_dwordx4 v11, s[32:35], s92 offen offset:2048 lds
    ds_read_b128 v[0:3], v48 offset:40960
    v_mfma_f32_16x16x32_bf16 v[104:107], a[96:99], v[12:15], 0
    s_add_u32 m0, s90, 0
    v_cvt_pk_f16_f32 v26, v228, v229
    v_cvt_pk_f16_f32 v27, v230, v231
    v_mfma_f32_16x16x32_bf16 v[92:95], a[120:123], v[12:15], 0
    s_waitcnt lgkmcnt(6)
    s_mov_b32 s92, 768
    ds_read_b128 v[32:35], v48 offset:42496
    v_pk_fmac_f16 v224, v26, v26
    v_mfma_f32_16x16x32_bf16 v[248:251], a[72:75], v[28:31], 0
    ds_read_b32 v184, v184 offset:336
    v_pk_fmac_f16 v224, v27, v27
    v_mfma_f32_16x16x32_bf16 v[44:47], a[96:99], v[28:31], 0
    v_cvt_pk_f16_f32 v152, v20, v21
    v_cvt_pk_f16_f32 v153, v22, v23
    v_mfma_f32_16x16x32_bf16 v[12:15], a[120:123], v[28:31], 0
    s_waitcnt vmcnt(9) lgkmcnt(5)
    ds_read_b64_tr_b16 a[80:81], v51 offset:24576
    buffer_load_dwordx4 v84, s[32:35], s92 offen offset:0 lds
    v_mfma_f32_16x16x32_bf16 v[228:231], a[72:75], v[4:7], 0
    ds_read_b64_tr_b16 a[82:83], v51 offset:25344
    v_pk_fmac_f16 v224, v152, v152
    v_mfma_f32_16x16x32_bf16 v[16:19], a[96:99], v[4:7], 0
    ds_read_b64_tr_b16 a[104:105], v51 offset:24608
    v_pk_fmac_f16 v224, v153, v153
    v_mfma_f32_16x16x32_bf16 v[68:71], a[120:123], v[4:7], 0
    s_waitcnt lgkmcnt(6)
    ds_read_b64_tr_b16 a[106:107], v51 offset:25376
    v_cvt_pk_f16_f32 v28, v76, v77
    v_mfma_f32_16x16x32_bf16 v[60:63], a[72:75], v[52:55], 0
    ds_read_b64_tr_b16 a[128:129], v51 offset:24640
    v_cvt_pk_f16_f32 v29, v78, v79
    v_mfma_f32_16x16x32_bf16 v[4:7], a[96:99], v[52:55], 0
    ds_read_b64_tr_b16 a[130:131], v51 offset:25408
    buffer_load_dwordx4 v37, s[32:35], s92 offen offset:1024 lds
    v_mfma_f32_16x16x32_bf16 v[100:103], a[120:123], v[52:55], 0
    s_waitcnt lgkmcnt(7)
    ds_read_b128 v[76:79], v48 offset:0
    v_pk_fma_f16 v226, v28, v28, s3
    v_mfma_f32_16x16x32_bf16 v[120:123], a[76:79], v[0:3], v[120:123]
    ds_read_b128 v[52:55], v48 offset:1536
    v_pk_fmac_f16 v226, v29, v29
    v_mfma_f32_16x16x32_bf16 v[148:151], a[100:103], v[0:3], v[148:151]
    ds_read_b128 v[20:23], v48 offset:3072
    v_cvt_pk_f16_f32 v30, v72, v73
    v_mfma_f32_16x16x32_bf16 v[56:59], a[124:127], v[0:3], v[56:59]
    ds_read_b128 v[0:3], v49 offset:41088
    v_cvt_pk_f16_f32 v31, v74, v75
    v_mfma_f32_16x16x32_bf16 v[116:119], a[76:79], v[32:35], v[116:119]
    buffer_load_dwordx4 v11, s[32:35], s92 offen offset:2048 lds
    ds_read_b32 v185, v185 offset:336
    v_mfma_f32_16x16x32_bf16 v[104:107], a[100:103], v[32:35], v[104:107]
    s_add_u32 m0, s90, 12288
    v_pk_fmac_f16 v226, v30, v30
    v_pk_fmac_f16 v226, v31, v31
    v_mfma_f32_16x16x32_bf16 v[92:95], a[124:127], v[32:35], v[92:95]
    s_mov_b32 s92, 37632
    ds_read_b128 v[32:35], v49 offset:42624
    v_cvt_pk_f16_f32 v146, v240, v241
    v_cvt_pk_f16_f32 v147, v242, v243
    v_pk_fmac_f16 v226, v146, v146
    v_pk_fmac_f16 v226, v147, v147
    v_cvt_pk_f16_f32 v40, v40, v41
    v_cvt_pk_f16_f32 v41, v42, v43
    v_pk_fma_f16 v36, v40, v40, s3
    v_pk_fmac_f16 v36, v41, v41
    v_cvt_pk_f16_f32 v42, v96, v97
    v_cvt_pk_f16_f32 v43, v98, v99
    s_waitcnt lgkmcnt(5)
    v_mfma_f32_16x16x32_bf16 v[248:251], a[76:79], v[76:79], v[248:251]
    s_waitcnt vmcnt(9)
    ds_read_b64_tr_b16 a[84:85], v51 offset:36864
    buffer_load_dwordx4 v84, s[32:35], s92 offen offset:0 lds
    v_mfma_f32_16x16x32_bf16 v[44:47], a[100:103], v[76:79], v[44:47]
    ds_read_b64_tr_b16 a[86:87], v51 offset:37632
    v_pk_fmac_f16 v36, v42, v42
    v_mfma_f32_16x16x32_bf16 v[12:15], a[124:127], v[76:79], v[12:15]
    s_waitcnt lgkmcnt(4)
    ds_read_b64_tr_b16 a[108:109], v51 offset:36896
    v_pk_fmac_f16 v36, v43, v43
    v_mfma_f32_16x16x32_bf16 v[228:231], a[76:79], v[52:55], v[228:231]
    ds_read_b64_tr_b16 a[110:111], v51 offset:37664
    v_cvt_pk_f16_f32 v140, v80, v81
    v_mfma_f32_16x16x32_bf16 v[16:19], a[100:103], v[52:55], v[16:19]
    ds_read_b64_tr_b16 a[132:133], v51 offset:36928
    v_cvt_pk_f16_f32 v141, v82, v83
    v_mfma_f32_16x16x32_bf16 v[68:71], a[124:127], v[52:55], v[68:71]
    ds_read_b64_tr_b16 a[134:135], v51 offset:37696
    buffer_load_dwordx4 v37, s[32:35], s92 offen offset:1024 lds
    v_mfma_f32_16x16x32_bf16 v[60:63], a[76:79], v[20:23], v[60:63]
    ds_read_b128 v[72:75], v49 offset:128
    v_pk_fmac_f16 v36, v140, v140
    v_mfma_f32_16x16x32_bf16 v[4:7], a[100:103], v[20:23], v[4:7]
    ds_read_b128 v[52:55], v49 offset:1664
    v_pk_fmac_f16 v36, v141, v141
    v_mfma_f32_16x16x32_bf16 v[100:103], a[124:127], v[20:23], v[100:103]
    ds_read_b128 v[20:23], v49 offset:3200
    v_mfma_f32_16x16x32_bf16 v[120:123], a[80:83], v[0:3], v[120:123]
    ds_read_b32 v186, v186 offset:336
    v_mfma_f32_16x16x32_bf16 v[148:151], a[104:107], v[0:3], v[148:151]
    buffer_load_dwordx4 v11, s[32:35], s92 offen offset:2048 lds
    v_mfma_f32_16x16x32_bf16 v[56:59], a[128:131], v[0:3], v[56:59]
    s_waitcnt lgkmcnt(7)
    s_add_u32 m0, s90, 24576
    ds_read_b128 v[0:3], v48 offset:41088
    v_mfma_f32_16x16x32_bf16 v[116:119], a[80:83], v[32:35], v[116:119]
    s_mov_b32 s92, 74496
    ds_read_b32 v187, v187 offset:336
    v_mov_b32 v38, 0
    v_mfma_f32_16x16x32_bf16 v[104:107], a[104:107], v[32:35], v[104:107]
    v_mov_b32 v39, 0
    v_mfma_f32_16x16x32_bf16 v[92:95], a[128:131], v[32:35], v[92:95]
    s_waitcnt lgkmcnt(5)
    ds_read_b128 v[32:35], v48 offset:42624
    buffer_load_dwordx4 v84, s[32:35], s92 offen offset:0 lds
    v_mfma_f32_16x16x32_bf16 v[248:251], a[80:83], v[72:75], v[248:251]
    s_waitcnt vmcnt(10)
    ds_read_b64_tr_b16 a[88:89], v51 offset:49152
    v_mfma_f32_16x16x32_bf16 v[44:47], a[104:107], v[72:75], v[44:47]
    ds_read_b64_tr_b16 a[90:91], v51 offset:49920
    v_mfma_f32_16x16x32_bf16 v[12:15], a[128:131], v[72:75], v[12:15]
    s_waitcnt lgkmcnt(5)
    ds_read_b64_tr_b16 a[112:113], v51 offset:49184
    v_mfma_f32_16x16x32_bf16 v[228:231], a[80:83], v[52:55], v[228:231]
    ds_read_b64_tr_b16 a[114:115], v51 offset:49952
    v_mfma_f32_16x16x32_bf16 v[16:19], a[104:107], v[52:55], v[16:19]
    ds_read_b64_tr_b16 a[136:137], v51 offset:49216
    buffer_load_dwordx4 v37, s[32:35], s92 offen offset:1024 lds
    v_mfma_f32_16x16x32_bf16 v[68:71], a[128:131], v[52:55], v[68:71]
    ds_read_b64_tr_b16 a[138:139], v51 offset:49984
    v_mfma_f32_16x16x32_bf16 v[60:63], a[80:83], v[20:23], v[60:63]
    ds_read_b128 v[80:83], v48 offset:128
    v_mfma_f32_16x16x32_bf16 v[4:7], a[104:107], v[20:23], v[4:7]
    ds_read_b128 v[72:75], v48 offset:1664
    v_mfma_f32_16x16x32_bf16 v[100:103], a[128:131], v[20:23], v[100:103]
    s_waitcnt lgkmcnt(8)
    ds_read_b128 v[20:23], v48 offset:3200
    v_mfma_f32_16x16x32_bf16 v[120:123], a[84:87], v[0:3], v[120:123]
    buffer_load_dwordx4 v11, s[32:35], s92 offen offset:2048 lds
    v_mfma_f32_16x16x32_bf16 v[148:151], a[108:111], v[0:3], v[148:151]
    s_add_u32 m0, s90, 36864
    s_cmp_ge_u32 s2, 248
    s_cbranch_scc1 L_maskF
L_nomaskF:
    v_mfma_f32_16x16x32_bf16 v[56:59], a[132:135], v[0:3], v[56:59]
    s_mov_b32 s92, 111360
    ds_read_b128 v[52:55], v48 offset:41216
    v_readlane_b32 s84, v211, 48
    v_mfma_f32_16x16x32_bf16 v[116:119], a[84:87], v[32:35], v[116:119]
    ds_read_b128 v[76:79], v48 offset:42752
    v_cmp_gt_u32 vcc, 16, v85
    v_mfma_f32_16x16x32_bf16 v[104:107], a[108:111], v[32:35], v[104:107]
    ds_read_b128 v[0:3], v48 offset:256
    v_cndmask_b32 v208, v89, v208, vcc
    v_mfma_f32_16x16x32_bf16 v[92:95], a[132:135], v[32:35], v[92:95]
    s_waitcnt lgkmcnt(5)
    ds_read_b128 v[32:35], v48 offset:1792
    buffer_load_dwordx4 v84, s[32:35], s92 offen offset:0 lds
    v_cndmask_b32 v209, v89, v209, vcc
    v_mfma_f32_16x16x32_bf16 v[248:251], a[84:87], v[80:83], v[248:251]
    s_waitcnt vmcnt(10)
    ds_read_b64_tr_b16 a[92:93], v51 offset:61440
    v_cndmask_b32 v210, v89, v210, vcc
    v_mfma_f32_16x16x32_bf16 v[44:47], a[108:111], v[80:83], v[44:47]
    ds_read_b64_tr_b16 a[94:95], v51 offset:62208
    v_cmp_gt_u32 vcc, 49, v85
    v_mfma_f32_16x16x32_bf16 v[12:15], a[132:135], v[80:83], v[12:15]
    s_waitcnt lgkmcnt(6)
    ds_read_b64_tr_b16 a[116:117], v51 offset:61472
    v_cndmask_b32 v211, v89, v211, vcc
    v_mfma_f32_16x16x32_bf16 v[228:231], a[84:87], v[72:75], v[228:231]
    ds_read_b64_tr_b16 a[118:119], v51 offset:62240
    v_mfma_f32_16x16x32_bf16 v[16:19], a[108:111], v[72:75], v[16:19]
    buffer_load_dwordx4 v37, s[32:35], s92 offen offset:1024 lds
    ds_read_b64_tr_b16 a[140:141], v51 offset:61504
    v_mfma_f32_16x16x32_bf16 v[68:71], a[132:135], v[72:75], v[68:71]
    ds_read_b64_tr_b16 a[142:143], v51 offset:62272
    v_mfma_f32_16x16x32_bf16 v[60:63], a[84:87], v[20:23], v[60:63]
    ds_read_b128 v[72:75], v48 offset:3328
    v_mfma_f32_16x16x32_bf16 v[4:7], a[108:111], v[20:23], v[4:7]
    ds_read_b128 v[96:99], v49 offset:41216
    v_mfma_f32_16x16x32_bf16 v[100:103], a[132:135], v[20:23], v[100:103]
    ds_read_b128 v[80:83], v49 offset:42752
    buffer_load_dwordx4 v11, s[32:35], s92 offen offset:2048 lds
    s_add_u32 m0, s90, 49152
    s_mov_b32 s92, 148224
    ds_read_b128 v[20:23], v49 offset:256
    buffer_load_dwordx4 v84, s[32:35], s92 offen offset:0 lds
    s_waitcnt vmcnt(10)
    ds_read_b64_tr_b16 a[144:145], v158 offset:0
    ds_read_b64_tr_b16 a[146:147], v158 offset:768
    s_waitcnt lgkmcnt(4)
    v_mfma_f32_16x16x32_bf16 v[120:123], a[88:91], v[96:99], v[120:123]
    ds_read_b64_tr_b16 a[168:169], v158 offset:8
    v_mfma_f32_16x16x32_bf16 v[120:123], a[92:95], v[52:55], v[120:123]
    ds_read_b64_tr_b16 a[170:171], v158 offset:776
    v_mfma_f32_16x16x32_bf16 v[148:151], a[112:115], v[96:99], v[148:151]
    ds_read_b64_tr_b16 a[192:193], v51 offset:64
    v_mfma_f32_16x16x32_bf16 v[148:151], a[116:119], v[52:55], v[148:151]
    buffer_load_dwordx4 v37, s[32:35], s92 offen offset:1024 lds
    ds_read_b64_tr_b16 a[194:195], v51 offset:832
    v_mfma_f32_16x16x32_bf16 v[56:59], a[136:139], v[96:99], v[56:59]
    s_nop 0
    v_cvt_pk_f16_f32 v120, v120, v121
    v_cvt_pk_f16_f32 v121, v122, v123
    v_mfma_f32_16x16x32_bf16 v[56:59], a[140:143], v[52:55], v[56:59]
    s_waitcnt lgkmcnt(6)
    ds_read_b128 v[52:55], v49 offset:1792
    v_pk_fma_f16 v89, v120, v120, s3
    v_mfma_f32_16x16x32_bf16 v[116:119], a[88:91], v[80:83], v[116:119]
    v_pk_fmac_f16 v89, v121, v121
    v_cvt_pk_f16_f32 v122, v148, v149
    v_mfma_f32_16x16x32_bf16 v[116:119], a[92:95], v[76:79], v[116:119]
    v_cvt_pk_f16_f32 v123, v150, v151
    v_pk_fmac_f16 v89, v122, v122
    v_mfma_f32_16x16x32_bf16 v[104:107], a[112:115], v[80:83], v[104:107]
    s_nop 0
    buffer_load_dwordx4 v11, s[32:35], s92 offen offset:2048 lds
    v_pk_fmac_f16 v89, v123, v123
    v_mfma_f32_16x16x32_bf16 v[104:107], a[116:119], v[76:79], v[104:107]
    s_add_u32 m0, s90, 61440
    v_cvt_pk_f16_f32 v116, v116, v117
    v_cvt_pk_f16_f32 v117, v118, v119
    v_mfma_f32_16x16x32_bf16 v[92:95], a[136:139], v[80:83], v[92:95]
    s_mov_b32 s92, 185088
    v_pk_fma_f16 v91, v116, v116, s3
    v_pk_fmac_f16 v91, v117, v117
    v_mfma_f32_16x16x32_bf16 v[92:95], a[140:143], v[76:79], v[92:95]
    ds_read_b128 v[76:79], v49 offset:3328
    v_cvt_pk_f16_f32 v118, v104, v105
    v_mfma_f32_16x16x32_bf16 v[248:251], a[88:91], v[20:23], v[248:251]
    v_cvt_pk_f16_f32 v119, v106, v107
    v_pk_fmac_f16 v91, v118, v118
    v_mfma_f32_16x16x32_bf16 v[248:251], a[92:95], v[0:3], v[248:251]
    s_waitcnt vmcnt(9)
    buffer_load_dwordx4 v84, s[32:35], s92 offen offset:0 lds
    ds_read_b64_tr_b16 a[148:149], v158 offset:12288
    v_mfma_f32_16x16x32_bf16 v[44:47], a[112:115], v[20:23], v[44:47]
    v_pk_fmac_f16 v91, v119, v119
    v_cvt_pk_f16_f32 v80, v92, v93
    v_mfma_f32_16x16x32_bf16 v[44:47], a[116:119], v[0:3], v[44:47]
    ds_read_b64_tr_b16 a[150:151], v158 offset:13056
    v_cvt_pk_f16_f32 v81, v94, v95
    v_mfma_f32_16x16x32_bf16 v[12:15], a[136:139], v[20:23], v[12:15]
    ds_read_b64_tr_b16 a[172:173], v158 offset:12296
    v_pk_fmac_f16 v91, v80, v80
    v_mfma_f32_16x16x32_bf16 v[12:15], a[140:143], v[0:3], v[12:15]
L_pg0:
    s_cbranch_execz L_main
    s_waitcnt lgkmcnt(4)
    ds_read_b64_tr_b16 a[174:175], v158 offset:13064
    v_pk_fmac_f16 v91, v81, v81
    v_mfma_f32_16x16x32_bf16 v[228:231], a[88:91], v[52:55], v[228:231]
    buffer_load_dwordx4 v37, s[32:35], s92 offen offset:1024 lds
    ds_read_b64_tr_b16 a[196:197], v51 offset:12352
    v_mfma_f32_16x16x32_bf16 v[228:231], a[92:95], v[32:35], v[228:231]
    ds_read_b64_tr_b16 a[198:199], v51 offset:13120
    v_cvt_pk_f16_f32 v8, v248, v249
    v_mfma_f32_16x16x32_bf16 v[16:19], a[112:115], v[52:55], v[16:19]
    ds_read_b128 v[20:23], v49 offset:40960
    v_cvt_pk_f16_f32 v9, v250, v251
    v_mfma_f32_16x16x32_bf16 v[16:19], a[116:119], v[32:35], v[16:19]
    ds_read_b128 v[0:3], v49 offset:0
    v_pk_fma_f16 v225, v8, v8, s3
    v_mfma_f32_16x16x32_bf16 v[68:71], a[136:139], v[52:55], v[68:71]
    v_pk_fmac_f16 v225, v9, v9
    v_cvt_pk_f16_f32 v10, v44, v45
    v_mfma_f32_16x16x32_bf16 v[68:71], a[140:143], v[32:35], v[68:71]
    s_waitcnt lgkmcnt(7)
    s_mov_b32 s53, s47
    buffer_load_dwordx4 v11, s[32:35], s92 offen offset:2048 lds
    ds_read_b128 v[32:35], v49 offset:1536
    v_mfma_f32_16x16x32_bf16 v[60:63], a[88:91], v[76:79], v[60:63]
    s_add_u32 m0, s54, 20480
    v_cvt_pk_f16_f32 v11, v46, v47
    v_pk_fmac_f16 v225, v10, v10
    v_mfma_f32_16x16x32_bf16 v[60:63], a[92:95], v[72:75], v[60:63]
    s_mov_b32 s47, s46
    v_pk_fmac_f16 v225, v11, v11
    v_cvt_pk_f16_f32 v154, v12, v13
    v_mfma_f32_16x16x32_bf16 v[4:7], a[112:115], v[76:79], v[4:7]
    s_mov_b32 s46, s45
    ds_read_b128 v[52:55], v49 offset:3072
    v_cvt_pk_f16_f32 v155, v14, v15
    v_mfma_f32_16x16x32_bf16 v[4:7], a[116:119], v[72:75], v[4:7]
    s_mov_b32 s45, s44
    v_pk_fmac_f16 v225, v154, v154
    v_pk_fmac_f16 v225, v155, v155
    v_mfma_f32_16x16x32_bf16 v[100:103], a[136:139], v[76:79], v[100:103]
    s_waitcnt vmcnt(9)
    s_mov_b32 s44, s53
    ds_read_b64_tr_b16 a[152:153], v158 offset:24576
    buffer_load_dwordx4 v130, s[24:27], s56 offen nt lds
    v_mfma_f32_16x16x32_bf16 v[100:103], a[140:143], v[72:75], v[100:103]
    s_waitcnt lgkmcnt(4)
    s_add_u32 m0, s54, 21504
    ds_read_b64_tr_b16 a[154:155], v158 offset:25344
    v_cvt_pk_f16_f32 v60, v60, v61
    v_mfma_f32_16x16x32_bf16 v[252:255], a[144:147], v[20:23], 0
    s_sub_u32 s48, s44, s46
    ds_read_b64_tr_b16 a[176:177], v158 offset:24584
    v_cvt_pk_f16_f32 v61, v62, v63
    v_mfma_f32_16x16x32_bf16 v[248:251], a[168:171], v[20:23], 0
    s_sub_u32 s49, s46, s45
    ds_read_b64_tr_b16 a[178:179], v158 offset:25352
    v_pk_fma_f16 v37, v60, v60, s3
    v_mfma_f32_16x16x32_bf16 v[244:247], a[192:195], v[20:23], 0
    s_waitcnt lgkmcnt(5)
    s_sub_u32 s50, s45, s44
    ds_read_b64_tr_b16 a[200:201], v51 offset:24640
    v_pk_fmac_f16 v37, v61, v61
    v_mfma_f32_16x16x32_bf16 v[236:239], v[0:3], a[144:147], 0
    s_sub_u32 s51, s46, s47
    ds_read_b64_tr_b16 a[202:203], v51 offset:25408
    buffer_load_dwordx4 v129, s[24:27], s56 offen nt lds
    v_mfma_f32_16x16x32_bf16 v[20:23], v[0:3], a[168:171], 0
    s_add_u32 m0, s54, 22528
    ds_read_b128 v[44:47], v48 offset:40960
    v_cvt_pk_f16_f32 v62, v4, v5
    v_cvt_pk_f16_f32 v63, v6, v7
    v_pk_fmac_f16 v37, v62, v62
    v_pk_fmac_f16 v37, v63, v63
    v_mfma_f32_16x16x32_bf16 v[240:243], v[0:3], a[192:195], 0
    s_mov_b32 s60, s59
    ds_read_b128 v[12:15], v48 offset:0
    v_cvt_pk_f16_f32 v142, v100, v101
    v_mfma_f32_16x16x32_bf16 v[104:107], v[32:35], a[144:147], 0
    s_mov_b32 s59, s58
    ds_read_b128 v[0:3], v48 offset:1536
    v_cvt_pk_f16_f32 v143, v102, v103
    v_pk_fmac_f16 v37, v142, v142
    v_pk_fmac_f16 v37, v143, v143
    v_mfma_f32_16x16x32_bf16 v[72:75], v[32:35], a[168:171], 0
    s_mov_b32 s58, s57
    buffer_load_dwordx4 v128, s[24:27], s56 offen nt lds
    v_cvt_pk_f16_f32 v6, v56, v57
    v_mfma_f32_16x16x32_bf16 v[96:99], v[32:35], a[192:195], 0
    s_waitcnt lgkmcnt(5)
    s_add_u32 m0, s54, 23552
    ds_read_b128 v[32:35], v48 offset:3072
    v_cvt_pk_f16_f32 v7, v58, v59
    v_mfma_f32_16x16x32_bf16 v[92:95], v[52:55], a[144:147], 0
    s_mov_b32 s57, s56
    v_pk_fmac_f16 v89, v6, v6
    v_pk_fmac_f16 v89, v7, v7
    v_mfma_f32_16x16x32_bf16 v[76:79], v[52:55], a[168:171], 0
    s_mov_b32 s7, s6
    v_add_u32 v137, s48, v137
    v_add_u32 v136, s48, v136
    v_mfma_f32_16x16x32_bf16 v[232:235], v[52:55], a[192:195], 0
    s_waitcnt lgkmcnt(3)
    s_mov_b32 s6, s5
    v_add_u32 v135, s49, v135
    v_add_u32 v134, s49, v134
    v_mfma_f32_16x16x32_bf16 v[252:255], a[148:151], v[44:47], v[252:255]
    s_waitcnt vmcnt(9)
    s_mov_b32 s5, s4
    ds_read_b64_tr_b16 a[156:157], v158 offset:36864
    buffer_load_dwordx4 v127, s[24:27], s56 offen nt lds
    v_mfma_f32_16x16x32_bf16 v[248:251], a[172:175], v[44:47], v[248:251]
    s_add_u32 m0, s54, 24576
    ds_read_b64_tr_b16 a[158:159], v158 offset:37632
    v_add_u32 v137, s50, v137
    v_mfma_f32_16x16x32_bf16 v[244:247], a[196:199], v[44:47], v[244:247]
    s_waitcnt lgkmcnt(3)
    s_sub_u32 s14, s6, s7
    ds_read_b64_tr_b16 a[180:181], v158 offset:36872
    v_add_u32 v136, s50, v136
    v_mfma_f32_16x16x32_bf16 v[236:239], v[12:15], a[148:151], v[236:239]
    s_add_u32 s61, s61, 1
    ds_read_b64_tr_b16 a[182:183], v158 offset:37640
    v_add_u32 v135, s48, v135
    v_mfma_f32_16x16x32_bf16 v[20:23], v[12:15], a[172:175], v[20:23]
    s_add_u32 s12, s12, 20
    ds_read_b64_tr_b16 a[204:205], v51 offset:36928
    v_add_u32 v134, s48, v134
    v_mfma_f32_16x16x32_bf16 v[240:243], v[12:15], a[196:199], v[240:243]
    s_max_u32 s12, s12, s61
    ds_read_b64_tr_b16 a[206:207], v51 offset:37696
    buffer_load_dwordx4 v126, s[24:27], s56 offen nt lds
    v_mfma_f32_16x16x32_bf16 v[104:107], v[0:3], a[148:151], v[104:107]
    s_cmp_lt_u32 s61, s71
    ds_read_b128 v[56:59], v49 offset:41088
    v_add_u32 v133, s51, v133
    v_mfma_f32_16x16x32_bf16 v[72:75], v[0:3], a[172:175], v[72:75]
    s_cselect_b32 s15, s61, s12
    ds_read_b128 v[44:47], v49 offset:128
    v_add_u32 v132, s14, v132
    v_mfma_f32_16x16x32_bf16 v[96:99], v[0:3], a[196:199], v[96:99]
    s_waitcnt lgkmcnt(8)
    s_cselect_b32 s56, s69, s70
    ds_read_b128 v[52:55], v49 offset:1664
    v_add_u32 v131, s14, v131
    v_mfma_f32_16x16x32_bf16 v[92:95], v[32:35], a[148:151], v[92:95]
    s_add_u32 s56, s56, s15
    ds_read_b128 v[0:3], v49 offset:3200
    v_cvt_pk_f16_f32 v12, v228, v229
    v_mfma_f32_16x16x32_bf16 v[76:79], v[32:35], a[172:175], v[76:79]
    s_mul_i32 s53, s56, 58255
    buffer_load_dword v84, v128, s[28:31], s72 offen nt
    v_cvt_pk_f16_f32 v13, v230, v231
    v_mfma_f32_16x16x32_bf16 v[232:235], v[32:35], a[196:199], v[232:235]
    s_lshr_b32 s53, s53, 22
    v_pk_fma_f16 v227, v12, v12, s3
    v_pk_fmac_f16 v227, v13, v13
    v_mfma_f32_16x16x32_f16 v[32:35], v[212:215], v[36:39], 0
    s_mul_i32 s53, s53, s63
    ds_read_b128 v[36:39], v48 offset:41088
    v_cvt_pk_f16_f32 v14, v16, v17
    v_mfma_f32_16x16x32_f16 v[100:103], v[212:215], v[88:91], 0
    s_waitcnt vmcnt(9) lgkmcnt(4)
    s_mul_i32 s56, s56, s62
    v_cvt_pk_f16_f32 v15, v18, v19
    v_pk_fmac_f16 v227, v14, v14
    v_pk_fmac_f16 v227, v15, v15
    v_cvt_pk_f16_f32 v148, v68, v69
    s_add_u32 s56, s56, s53
    s_mul_i32 s4, s15, 112
    ds_read_b64_tr_b16 a[160:161], v158 offset:49152
    v_mfma_f32_16x16x32_bf16 v[252:255], a[152:155], v[56:59], v[252:255]
    s_cmp_ge_u32 s15, 16
    v_or3_b32 v125, v125, v100, v101
    v_or3_b32 v125, v125, v102, v103
    v_mfma_f32_16x16x32_bf16 v[248:251], a[176:179], v[56:59], v[248:251]
    s_cselect_b32 s53, -30464, 0
    ds_read_b64_tr_b16 a[162:163], v158 offset:49920
    v_cvt_pk_f16_f32 v149, v70, v71
    v_mfma_f32_16x16x32_bf16 v[244:247], a[200:203], v[56:59], v[244:247]
    s_waitcnt lgkmcnt(3)
    s_add_u32 s4, s4, s53
    ds_read_b64_tr_b16 a[184:185], v158 offset:49160
    v_pk_fmac_f16 v227, v148, v148
    v_mfma_f32_16x16x32_bf16 v[236:239], v[44:47], a[152:155], v[236:239]
    s_cmp_lt_u32 s15, s73
    ds_read_b64_tr_b16 a[186:187], v158 offset:49928
    v_pk_fmac_f16 v227, v149, v149
    v_mfma_f32_16x16x32_bf16 v[20:23], v[44:47], a[176:179], v[20:23]
    s_cselect_b32 s26, 100270464, 0
    ds_read_b64_tr_b16 a[208:209], v51 offset:49216
    v_mfma_f32_16x16x32_bf16 v[240:243], v[44:47], a[200:203], v[240:243]
    s_cselect_b32 s56, s56, 0
    ds_read_b64_tr_b16 a[210:211], v51 offset:49984
    v_mfma_f32_16x16x32_bf16 v[104:107], v[52:55], a[152:155], v[104:107]
    s_cselect_b32 s4, s4, -1
    ds_read_b128 v[44:47], v48 offset:128
    v_mfma_f32_16x16x32_bf16 v[72:75], v[52:55], a[176:179], v[72:75]
    s_cselect_b32 s15, s15, 0
    ds_read_b128 v[16:19], v48 offset:1664
    v_mfma_f32_16x16x32_bf16 v[96:99], v[52:55], a[200:203], v[96:99]
    s_cselect_b32 s13, s13, -1
    ds_read_b128 v[56:59], v48 offset:3200
    v_mfma_f32_16x16x32_bf16 v[92:95], v[0:3], a[152:155], v[92:95]
    s_bitset1_b32 s64, s15
    v_rsq_f32 v100, v100
    v_mfma_f32_16x16x32_bf16 v[76:79], v[0:3], a[176:179], v[76:79]
    s_add_u32 s65, s65, 1
    v_rsq_f32 v101, v101
    v_mfma_f32_16x16x32_bf16 v[232:235], v[0:3], a[200:203], v[232:235]
    s_waitcnt lgkmcnt(6)
    s_cmp_ge_i32 s65, 2
    ds_read_b128 v[68:71], v48 offset:41216
    v_mul_f32 v100, s52, v100
    v_mfma_f32_16x16x32_bf16 v[252:255], a[156:159], v[36:39], v[252:255]
    s_cselect_b32 s30, 100270464, 0
    ds_read_b128 v[0:3], v48 offset:256
    v_cvt_pk_f16_f32 v100, v100, v101
    v_mfma_f32_16x16x32_bf16 v[248:251], a[180:183], v[36:39], v[248:251]
    s_add_u32 s67, s46, s54
    ds_read_b128 v[52:55], v48 offset:1792
    v_pk_mul_f16 v64, v64, v100 op_sel:[0,0] op_sel_hi:[1,0]
    v_mfma_f32_16x16x32_bf16 v[244:247], a[204:207], v[36:39], v[244:247]
    s_waitcnt lgkmcnt(5)
    ds_read_b128 v[36:39], v48 offset:3328
    v_pk_mul_f16 v65, v65, v100 op_sel:[0,0] op_sel_hi:[1,0]
    v_rsq_f32 v102, v102
    v_mfma_f32_16x16x32_bf16 v[236:239], v[44:47], a[156:159], v[236:239]
    s_waitcnt vmcnt(6)
    s_mov_b32 s53, s47
    ds_read_b64_tr_b16 a[164:165], v158 offset:61440
    v_mul_f32 v102, s52, v102
    v_mfma_f32_16x16x32_bf16 v[20:23], v[44:47], a[180:183], v[20:23]
    s_mov_b32 s47, s46
    ds_read_b64_tr_b16 a[166:167], v158 offset:62208
    v_pk_mul_f16 v66, v66, v100 op_sel:[0,0] op_sel_hi:[1,0]
    v_mfma_f32_16x16x32_bf16 v[240:243], v[44:47], a[204:207], v[240:243]
    s_waitcnt lgkmcnt(6)
    s_mov_b32 s46, s45
    ds_read_b64_tr_b16 a[188:189], v158 offset:61448
    v_pk_mul_f16 v67, v67, v100 op_sel:[0,0] op_sel_hi:[1,0]
    v_mfma_f32_16x16x32_bf16 v[104:107], v[16:19], a[156:159], v[104:107]
    s_mov_b32 s45, s44
    ds_read_b64_tr_b16 a[190:191], v158 offset:62216
    v_mov_b32 v171, 0
    v_mfma_f32_16x16x32_bf16 v[72:75], v[16:19], a[180:183], v[72:75]
    s_sub_u32 s49, s46, s45
    ds_read_b64_tr_b16 a[212:213], v51 offset:61504
    v_mov_b32 v150, 0
    v_mfma_f32_16x16x32_bf16 v[96:99], v[16:19], a[204:207], v[96:99]
    s_mov_b32 s44, s53
    ds_read_b64_tr_b16 a[214:215], v51 offset:62272
    v_mov_b32 v151, 0
    v_mfma_f32_16x16x32_bf16 v[92:95], v[56:59], a[156:159], v[92:95]
    s_sub_u32 s48, s44, s46
    ds_read_b128 v[44:47], v49 offset:41216
    v_mov_b32 v144, 0
    v_mfma_f32_16x16x32_bf16 v[76:79], v[56:59], a[180:183], v[76:79]
    s_mul_i32 s93, s68, 18432
    ds_read_b128 v[16:19], v49 offset:256
    v_mov_b32 v145, 0
    v_mfma_f32_16x16x32_bf16 v[232:235], v[56:59], a[204:207], v[232:235]
    ds_read_b128 v[56:59], v49 offset:1792
    v_mov_b32 v138, 0
    v_mov_b32 v139, 0
    v_mfma_f32_16x16x32_f16 v[88:91], v[212:215], v[224:227], 0
    v_rsq_f32 v103, v103
    v_pk_mul_f16 v156, v156, v100 op_sel:[0,0] op_sel_hi:[1,0]
    v_cvt_pk_f16_f32 v102, v102, v103
    v_pk_mul_f16 v157, v157, v100 op_sel:[0,0] op_sel_hi:[1,0]
    v_pk_mul_f16 v120, v120, v100 op_sel:[0,1] op_sel_hi:[1,1]
    v_pk_mul_f16 v121, v121, v100 op_sel:[0,1] op_sel_hi:[1,1]
    v_pk_mul_f16 v122, v122, v100 op_sel:[0,1] op_sel_hi:[1,1]
    v_pk_mul_f16 v123, v123, v100 op_sel:[0,1] op_sel_hi:[1,1]
    v_pk_mul_f16 v6, v6, v100 op_sel:[0,1] op_sel_hi:[1,1]
    v_pk_mul_f16 v7, v7, v100 op_sel:[0,1] op_sel_hi:[1,1]
    v_fma_mix_f32 v34, v64, v120, 0 op_sel:[0,0,0] op_sel_hi:[1,1,0]
    v_fma_mix_f32 v34, v64, v120, v34 op_sel:[1,1,0] op_sel_hi:[1,1,0]
    v_fma_mix_f32 v34, v65, v121, v34 op_sel:[0,0,0] op_sel_hi:[1,1,0]
    v_fma_mix_f32 v34, v65, v121, v34 op_sel:[1,1,0] op_sel_hi:[1,1,0]
    v_fma_mix_f32 v34, v66, v122, v34 op_sel:[0,0,0] op_sel_hi:[1,1,0]
    v_fma_mix_f32 v34, v66, v122, v34 op_sel:[1,1,0] op_sel_hi:[1,1,0]
    v_fma_mix_f32 v34, v67, v123, v34 op_sel:[0,0,0] op_sel_hi:[1,1,0]
    v_fma_mix_f32 v34, v67, v123, v34 op_sel:[1,1,0] op_sel_hi:[1,1,0]
    v_fma_mix_f32 v34, v156, v6, v34 op_sel:[0,0,0] op_sel_hi:[1,1,0]
    v_fma_mix_f32 v34, v156, v6, v34 op_sel:[1,1,0] op_sel_hi:[1,1,0]
    v_fma_mix_f32 v34, v157, v7, v34 op_sel:[0,0,0] op_sel_hi:[1,1,0]
    s_waitcnt lgkmcnt(2)
    v_mfma_f32_16x16x32_bf16 v[252:255], a[160:163], v[44:47], v[252:255]
    v_fma_mix_f32 v34, v157, v7, v34 op_sel:[1,1,0] op_sel_hi:[1,1,0]
    v_mov_b32 v35, v34
    v_mfma_f32_16x16x32_bf16 v[252:255], a[164:167], v[68:71], v[252:255]
    s_nop 0
    v_permlane32_swap_b32 v35, v34
    v_mfma_f32_16x16x32_bf16 v[248:251], a[184:187], v[44:47], v[248:251]
    s_movk_i32 s92, 0
    v_add_f32 v34, v35, v34
    v_mov_b32 v35, v34
    v_mfma_f32_16x16x32_bf16 v[248:251], a[188:191], v[68:71], v[248:251]
    s_nop 0
    v_permlane16_swap_b32 v35, v34
    v_mfma_f32_16x16x32_bf16 v[244:247], a[208:211], v[44:47], v[244:247]
    ds_read_b128 v[44:47], v49 offset:3328
    v_add_f32 v34, v35, v34
    v_mfma_f32_16x16x32_bf16 v[244:247], a[212:215], v[68:71], v[244:247]
    s_waitcnt lgkmcnt(1)
    v_add_f32 v34, s84, v34
    v_mov_b32 v82, 0
    v_mfma_f32_16x16x32_bf16 v[236:239], v[16:19], a[160:163], v[236:239]
    v_exp_f32 v34, v34
    v_mfma_f32_16x16x32_bf16 v[236:239], v[0:3], a[164:167], v[236:239]
    v_cvt_pk_bf16_f32 v34, v34, 0
    v_cmp_gt_u32 vcc, 16, v85
    v_mfma_f32_16x16x32_bf16 v[20:23], v[16:19], a[184:187], v[20:23]
    s_nop 0
    v_cndmask_b32 v34, 0, v34, vcc
    v_mov_b32 v83, 0
    v_mfma_f32_16x16x32_bf16 v[20:23], v[0:3], a[188:191], v[20:23]
    v_mov_b32 v35, 0
    v_add_u32 v51, 28672, v50
    v_mfma_f32_16x16x32_bf16 v[240:243], v[16:19], a[208:211], v[240:243]
    ds_write_b128 v51, v[120:123]
    v_mfma_f32_16x16x32_bf16 v[240:243], v[0:3], a[212:215], v[240:243]
    v_cvt_pk_bf16_f32 v0, v236, v237
    v_cvt_pk_bf16_f32 v1, v238, v239
    v_mfma_f32_16x16x32_bf16 v[104:107], v[56:59], a[160:163], v[104:107]
    v_cvt_pk_bf16_f32 v16, v20, v21
    v_cvt_pk_bf16_f32 v17, v22, v23
    v_mfma_f32_16x16x32_bf16 v[104:107], v[52:55], a[164:167], v[104:107]
    s_nop 0
    ds_write2_b64 v51, v[82:83], v[82:83] offset0:2 offset1:3
    v_mfma_f32_16x16x32_bf16 v[72:75], v[56:59], a[184:187], v[72:75]
    s_nop 0
    v_cvt_pk_bf16_f32 v4, v240, v241
    v_cvt_pk_bf16_f32 v5, v242, v243
    v_mfma_f32_16x16x32_bf16 v[72:75], v[52:55], a[188:191], v[72:75]
    s_nop 0
    v_cvt_pk_bf16_f32 v2, v104, v105
    v_cvt_pk_bf16_f32 v3, v106, v107
    v_mfma_f32_16x16x32_bf16 v[96:99], v[56:59], a[208:211], v[96:99]
    s_add_u32 m0, s67, 0
    ds_write_b128 v51, v[64:67] offset:32
    v_mfma_f32_16x16x32_bf16 v[96:99], v[52:55], a[212:215], v[96:99]
    s_waitcnt lgkmcnt(2)
    v_cvt_pk_bf16_f32 v18, v72, v73
    v_cvt_pk_bf16_f32 v19, v74, v75
    v_mfma_f32_16x16x32_bf16 v[92:95], v[44:47], a[160:163], v[92:95]
    v_or3_b32 v125, v125, v88, v89
    v_or3_b32 v125, v125, v90, v91
    v_mfma_f32_16x16x32_bf16 v[92:95], v[36:39], a[164:167], v[92:95]
    ds_write2_b64 v51, v[6:7], v[82:83] offset0:6 offset1:7
    v_mfma_f32_16x16x32_bf16 v[76:79], v[44:47], a[184:187], v[76:79]
    v_cvt_pk_bf16_f32 v6, v96, v97
    v_cvt_pk_bf16_f32 v7, v98, v99
    v_mfma_f32_16x16x32_bf16 v[76:79], v[36:39], a[188:191], v[76:79]
    v_rsq_f32 v88, v88
    v_mfma_f32_16x16x32_bf16 v[232:235], v[44:47], a[208:211], v[232:235]
    ds_write2_b64 v51, v[82:83], v[156:157] offset0:8 offset1:9
    v_mfma_f32_16x16x32_bf16 v[232:235], v[36:39], a[212:215], v[232:235]
    global_load_dword v101, v167, s[38:39] offset:248 sc1
    v_mul_f32 v88, s52, v88
    v_rsq_f32 v89, v89
    v_or3_b32 v125, v125, v32, v33
    v_cvt_pk_f16_f32 v88, v88, v89
    ds_write_b64 v51, v[34:35] offset:88
    v_rsq_f32 v32, v32
    v_rsq_f32 v33, v33
    v_mul_f32 v32, s52, v32
    ds_read_b128 v[68:71], v132 offset:0
    v_cvt_pk_f16_f32 v32, v32, v33
    v_pk_mul_f16 v60, v60, v32 op_sel:[0,1] op_sel_hi:[1,1]
    v_pk_mul_f16 v61, v61, v32 op_sel:[0,1] op_sel_hi:[1,1]
    ds_read_b128 v[72:75], v132 offset:16
    v_pk_mul_f16 v62, v62, v32 op_sel:[0,1] op_sel_hi:[1,1]
    v_pk_mul_f16 v63, v63, v32 op_sel:[0,1] op_sel_hi:[1,1]
    v_pk_mul_f16 v142, v142, v32 op_sel:[0,1] op_sel_hi:[1,1]
    ds_read_b128 v[56:59], v132 offset:48
    v_pk_mul_f16 v143, v143, v32 op_sel:[0,1] op_sel_hi:[1,1]
    v_pk_mul_f16 v40, v40, v32 op_sel:[0,0] op_sel_hi:[1,0]
    v_pk_mul_f16 v41, v41, v32 op_sel:[0,0] op_sel_hi:[1,0]
    v_pk_mul_f16 v42, v42, v32 op_sel:[0,0] op_sel_hi:[1,0]
    v_pk_mul_f16 v43, v43, v32 op_sel:[0,0] op_sel_hi:[1,0]
    v_pk_mul_f16 v140, v140, v32 op_sel:[0,0] op_sel_hi:[1,0]
    v_pk_mul_f16 v141, v141, v32 op_sel:[0,0] op_sel_hi:[1,0]
    v_rsq_f32 v90, v90
    v_rsq_f32 v91, v91
    v_mul_f32 v90, s52, v90
    v_cvt_pk_f16_f32 v90, v90, v91
    v_pk_mul_f16 v8, v8, v88 op_sel:[0,1] op_sel_hi:[1,1]
    v_pk_mul_f16 v9, v9, v88 op_sel:[0,1] op_sel_hi:[1,1]
    v_pk_mul_f16 v10, v10, v88 op_sel:[0,1] op_sel_hi:[1,1]
    v_pk_mul_f16 v11, v11, v88 op_sel:[0,1] op_sel_hi:[1,1]
    v_pk_mul_f16 v154, v154, v88 op_sel:[0,1] op_sel_hi:[1,1]
    v_pk_mul_f16 v155, v155, v88 op_sel:[0,1] op_sel_hi:[1,1]
    v_pk_mul_f16 v24, v24, v88 op_sel:[0,0] op_sel_hi:[1,0]
    v_pk_mul_f16 v25, v25, v88 op_sel:[0,0] op_sel_hi:[1,0]
    v_pk_mul_f16 v26, v26, v88 op_sel:[0,0] op_sel_hi:[1,0]
    v_pk_mul_f16 v27, v27, v88 op_sel:[0,0] op_sel_hi:[1,0]
    v_pk_mul_f16 v152, v152, v88 op_sel:[0,0] op_sel_hi:[1,0]
    v_pk_mul_f16 v153, v153, v88 op_sel:[0,0] op_sel_hi:[1,0]
    v_mfma_f32_16x16x32_f16 v[32:35], v[8:11], v[24:27], v[204:207]
    ds_read_b128 v[224:227], v49 offset:42496
    v_pk_mul_f16 v12, v12, v90 op_sel:[0,1] op_sel_hi:[1,1]
    v_mfma_f32_16x16x32_f16 v[32:35], v[152:155], v[150:153], v[32:35]
    ds_read_b128 v[120:123], v48 offset:42496
    v_pk_mul_f16 v13, v13, v90 op_sel:[0,1] op_sel_hi:[1,1]
    v_mfma_f32_16x16x32_f16 v[36:39], v[60:63], v[24:27], v[196:199]
    ds_read_b128 v[104:107], v49 offset:42624
    v_pk_mul_f16 v14, v14, v90 op_sel:[0,1] op_sel_hi:[1,1]
    v_mfma_f32_16x16x32_f16 v[36:39], v[140:143], v[150:153], v[36:39]
    s_waitcnt lgkmcnt(3)
    ds_read_b128 v[64:67], v48 offset:42624
    v_pk_mul_f16 v15, v15, v90 op_sel:[0,1] op_sel_hi:[1,1]
    v_mfma_f32_16x16x32_f16 v[96:99], v[68:71], v[24:27], v[208:211]
    ds_read_b128 v[52:55], v49 offset:42752
    v_pk_mul_f16 v148, v148, v90 op_sel:[0,1] op_sel_hi:[1,1]
    v_mfma_f32_16x16x32_f16 v[96:99], v[72:75], v[8:11], v[96:99]
    ds_read_b128 v[44:47], v48 offset:42752
    v_pk_mul_f16 v149, v149, v90 op_sel:[0,1] op_sel_hi:[1,1]
    v_mfma_f32_16x16x32_f16 v[96:99], v[56:59], v[152:155], v[96:99]
    v_pk_mul_f16 v28, v28, v90 op_sel:[0,0] op_sel_hi:[1,0]
    v_pk_mul_f16 v29, v29, v90 op_sel:[0,0] op_sel_hi:[1,0]
    v_pk_mul_f16 v30, v30, v90 op_sel:[0,0] op_sel_hi:[1,0]
    v_pk_mul_f16 v31, v31, v90 op_sel:[0,0] op_sel_hi:[1,0]
    v_pk_mul_f16 v146, v146, v90 op_sel:[0,0] op_sel_hi:[1,0]
    v_pk_mul_f16 v147, v147, v90 op_sel:[0,0] op_sel_hi:[1,0]
    v_mfma_f32_16x16x32_f16 v[20:23], v[12:15], v[24:27], v[200:203]
    v_cvt_pk_bf16_f32 v82, v252, v253
    v_cvt_pk_bf16_f32 v83, v254, v255
    v_mfma_f32_16x16x32_f16 v[20:23], v[146:149], v[150:153], v[20:23]
    s_waitcnt lgkmcnt(5)
    v_cvt_pk_bf16_f32 v88, v248, v249
    v_cvt_pk_bf16_f32 v89, v250, v251
    v_mfma_f32_16x16x32_bf16 v[24:27], a[144:147], v[224:227], 0
    s_waitcnt lgkmcnt(4)
    v_cvt_pk_bf16_f32 v90, v244, v245
    v_cvt_pk_bf16_f32 v91, v246, v247
    v_mfma_f32_16x16x32_bf16 v[24:27], a[148:151], v[120:123], v[24:27]
    s_waitcnt lgkmcnt(3)
    v_cvt_pk_bf16_f32 v164, v92, v93
    v_cvt_pk_bf16_f32 v165, v94, v95
    v_mfma_f32_16x16x32_bf16 v[24:27], a[152:155], v[104:107], v[24:27]
    s_waitcnt lgkmcnt(2)
    ds_write_b64 v50, v[82:83] offset:28752
    v_mfma_f32_16x16x32_bf16 v[24:27], a[156:159], v[64:67], v[24:27]
    s_waitcnt vmcnt(1) lgkmcnt(1)
    v_cvt_pk_bf16_f32 v160, v76, v77
    v_cvt_pk_bf16_f32 v161, v78, v79
    v_mfma_f32_16x16x32_bf16 v[24:27], a[160:163], v[52:55], v[24:27]
    s_barrier
    ds_write_b128 v50, v[88:91] offset:28768
    v_mfma_f32_16x16x32_bf16 v[24:27], a[164:167], v[44:47], v[24:27]
    buffer_load_dwordx4 v130, s[24:27], s56 offen nt lds
    v_cvt_pk_bf16_f32 v156, v232, v233
    v_mfma_f32_16x16x32_bf16 v[76:79], a[168:171], v[224:227], 0
    s_add_u32 m0, s67, 1024
    v_cvt_pk_bf16_f32 v157, v234, v235
    v_add_u32 v137, s48, v137
    v_mfma_f32_16x16x32_bf16 v[76:79], a[172:175], v[120:123], v[76:79]
    ds_read_u16 v166, v131 offset:80
    v_cvt_pk_bf16_f32 v82, v24, v25
    v_mfma_f32_16x16x32_bf16 v[76:79], a[176:179], v[104:107], v[76:79]
    ds_read_u16 v162, v131 offset:96
    v_cvt_pk_bf16_f32 v83, v26, v27
    v_mfma_f32_16x16x32_bf16 v[76:79], a[180:183], v[64:67], v[76:79]
    ds_read_u16 v158, v131 offset:104
    v_add_u32 v136, s48, v136
    v_mfma_f32_16x16x32_bf16 v[76:79], a[184:187], v[52:55], v[76:79]
    buffer_load_dwordx4 v129, s[24:27], s56 offen nt lds
    v_lshl_add_u32 v100, v85, 4, s93
    v_mfma_f32_16x16x32_bf16 v[76:79], a[188:191], v[44:47], v[76:79]
    s_mov_b32 s93, 0
    v_exp_f32 v32, v32
    v_mfma_f32_16x16x32_bf16 v[24:27], a[192:195], v[224:227], 0
    s_add_u32 m0, s67, 2048
    v_exp_f32 v33, v33
    v_mfma_f32_16x16x32_bf16 v[24:27], a[196:199], v[120:123], v[24:27]
    v_exp_f32 v34, v34
    v_mfma_f32_16x16x32_bf16 v[24:27], a[200:203], v[104:107], v[24:27]
    v_cvt_pk_bf16_f32 v76, v76, v77
    v_cvt_pk_bf16_f32 v77, v78, v79
    v_mfma_f32_16x16x32_bf16 v[24:27], a[204:207], v[64:67], v[24:27]
    buffer_load_dwordx4 v128, s[24:27], s56 offen nt lds
    v_cvt_pk_bf16_f32 v88, v32, v33
    v_mfma_f32_16x16x32_bf16 v[24:27], a[208:211], v[52:55], v[24:27]
    s_add_u32 m0, s67, 3072
    v_exp_f32 v35, v35
    v_mfma_f32_16x16x32_bf16 v[24:27], a[212:215], v[44:47], v[24:27]
    v_exp_f32 v20, v20
    v_mfma_f32_16x16x32_f16 v[252:255], v[68:71], v[28:31], v[208:211]
    s_nop 0
    ds_read_b128 v[64:67], v137 offset:0
    v_cvt_pk_bf16_f32 v89, v34, v35
    v_mfma_f32_16x16x32_f16 v[252:255], v[72:75], v[12:15], v[252:255]
    s_nop 0
    ds_read_b128 v[52:55], v136 offset:0
    v_cvt_pk_bf16_f32 v78, v24, v25
    v_mfma_f32_16x16x32_f16 v[252:255], v[56:59], v[146:149], v[252:255]
    ds_read_b128 v[32:35], v137 offset:256
    buffer_load_dwordx4 v127, s[24:27], s56 offen nt lds
    v_mfma_f32_16x16x32_f16 v[44:47], v[68:71], v[40:43], v[208:211]
    s_add_u32 m0, s67, 4096
    v_exp_f32 v21, v21
    v_mfma_f32_16x16x32_f16 v[44:47], v[72:75], v[60:63], v[44:47]
    v_cvt_pk_bf16_f32 v79, v26, v27
    v_cvt_pk_bf16_f32 v90, v20, v21
    v_mfma_f32_16x16x32_f16 v[44:47], v[56:59], v[140:143], v[44:47]
    v_exp_f32 v22, v22
    v_mfma_f32_16x16x32_f16 v[240:243], v[8:11], v[28:31], v[192:195]
    v_exp_f32 v23, v23
    v_mfma_f32_16x16x32_f16 v[240:243], v[152:155], v[144:147], v[240:243]
    v_cvt_pk_bf16_f32 v91, v22, v23
    v_mov_b32_dpp v99, v255 quad_perm:[0,1,2,3] row_mask:0x2 bank_mask:0xf
    v_mfma_f32_16x16x32_f16 v[72:75], v[12:15], v[28:31], v[188:191]
    ds_read_b128 v[56:59], v136 offset:128
    buffer_load_dwordx4 v126, s[24:27], s56 offen nt lds
    v_mfma_f32_16x16x32_f16 v[72:75], v[146:149], v[144:147], v[72:75]
    v_exp_f32 v36, v36
    v_mfma_f32_16x16x32_f16 v[68:71], v[60:63], v[28:31], v[184:187]
    v_exp_f32 v37, v37
    v_mfma_f32_16x16x32_f16 v[68:71], v[140:143], v[144:147], v[68:71]
    v_exp_f32 v38, v38
    v_mfma_f32_16x16x32_f16 v[20:23], v[8:11], v[40:43], v[180:183]
    ds_read_b128 v[28:31], v136 offset:256
    v_cvt_pk_bf16_f32 v168, v36, v37
    v_mfma_f32_16x16x32_f16 v[20:23], v[152:155], v[138:141], v[20:23]
    v_exp_f32 v39, v39
    v_exp_f32 v96, v96
    v_cvt_pk_bf16_f32 v169, v38, v39
    v_mfma_f32_16x16x32_f16 v[8:11], v[12:15], v[40:43], v[176:179]
    v_cvt_pk_bf16_f32 v170, v96, 0
    v_mov_b32_dpp v99, v47 quad_perm:[0,1,2,3] row_mask:0x4 bank_mask:0xf
    v_mfma_f32_16x16x32_f16 v[8:11], v[146:149], v[138:141], v[8:11]
    ds_read_b128 v[36:39], v137 offset:128
    v_mfma_f32_16x16x32_bf16 v[24:27], v[220:223], v[88:91], 0
    v_exp_f32 v99, v99
    v_mfma_f32_16x16x32_bf16 v[24:27], v[220:223], v[168:171], v[24:27]
    v_exp_f32 v46, v46
    v_mfma_f32_16x16x32_bf16 v[248:251], v[0:3], v[88:91], 0
    s_waitcnt lgkmcnt(2)
    v_exp_f32 v20, v20
    v_mfma_f32_16x16x32_bf16 v[248:251], v[164:167], v[168:171], v[248:251]
    v_exp_f32 v21, v21
    v_mfma_f32_16x16x32_bf16 v[232:235], v[16:19], v[88:91], 0
    v_cvt_pk_bf16_f32 v99, v99, v99
    v_cvt_pk_bf16_f32 v224, v20, v21
    v_mfma_f32_16x16x32_bf16 v[232:235], v[160:163], v[168:171], v[232:235]
    ds_write_b16 v131, v99 offset:64
    v_mfma_f32_16x16x32_bf16 v[96:99], v[4:7], v[88:91], 0
    ds_read_b128 v[244:247], v132 offset:48
    v_mfma_f32_16x16x32_bf16 v[96:99], v[156:159], v[168:171], v[96:99]
    ds_read_b128 v[104:107], v132 offset:64
    v_mfma_f32_16x16x32_f16 v[236:239], v[60:63], v[40:43], v[172:175]
    v_exp_f32 v22, v22
    v_mfma_f32_16x16x32_f16 v[236:239], v[140:143], v[138:141], v[236:239]
    v_exp_f32 v23, v23
    v_mfma_f32_16x16x32_bf16 v[228:231], a[24:27], v[64:67], 0
    v_exp_f32 v8, v8
    v_mfma_f32_16x16x32_bf16 v[228:231], a[28:31], v[52:55], v[228:231]
    s_waitcnt lgkmcnt(3)
    ds_read_b128 v[92:95], v137 offset:1664
    v_cvt_pk_bf16_f32 v225, v22, v23
    v_mfma_f32_16x16x32_bf16 v[228:231], a[32:35], v[36:39], v[228:231]
    ds_read_b128 v[40:43], v136 offset:1792
    v_mfma_f32_16x16x32_bf16 v[228:231], a[36:39], v[56:59], v[228:231]
    v_exp_f32 v9, v9
    v_mfma_f32_16x16x32_bf16 v[228:231], a[40:43], v[32:35], v[228:231]
    v_exp_f32 v10, v10
    v_mfma_f32_16x16x32_bf16 v[228:231], a[44:47], v[28:31], v[228:231]
    v_exp_f32 v11, v11
    v_mfma_f32_16x16x32_bf16 v[12:15], a[120:123], v[64:67], 0
    ds_read_b128 v[120:123], v136 offset:1536
    v_cvt_pk_bf16_f32 v226, v8, v9
    v_mfma_f32_16x16x32_bf16 v[12:15], a[124:127], v[52:55], v[12:15]
    ds_read_b128 v[140:143], v137 offset:1536
    v_cvt_pk_bf16_f32 v227, v10, v11
    v_mfma_f32_16x16x32_bf16 v[12:15], a[128:131], v[36:39], v[12:15]
    v_exp_f32 v236, v236
    v_mfma_f32_16x16x32_bf16 v[12:15], a[132:135], v[56:59], v[12:15]
    v_exp_f32 v237, v237
    v_mfma_f32_16x16x32_bf16 v[12:15], a[136:139], v[32:35], v[12:15]
    v_exp_f32 v238, v238
    v_mfma_f32_16x16x32_bf16 v[12:15], a[140:143], v[28:31], v[12:15]
    v_exp_f32 v239, v239
    v_mfma_f32_16x16x32_bf16 v[20:23], a[48:51], v[64:67], 0
    v_exp_f32 v240, v240
    v_mfma_f32_16x16x32_bf16 v[20:23], a[52:55], v[52:55], v[20:23]
    v_exp_f32 v241, v241
    v_mfma_f32_16x16x32_bf16 v[20:23], a[56:59], v[36:39], v[20:23]
    v_exp_f32 v242, v242
    v_mfma_f32_16x16x32_bf16 v[20:23], a[60:63], v[56:59], v[20:23]
    v_exp_f32 v243, v243
    v_mfma_f32_16x16x32_bf16 v[20:23], a[64:67], v[32:35], v[20:23]
    ds_read_b128 v[88:91], v136 offset:1664
    v_cvt_pk_bf16_f32 v240, v240, v241
    v_mfma_f32_16x16x32_bf16 v[20:23], a[68:71], v[28:31], v[20:23]
    ds_read_b128 v[60:63], v137 offset:1792
    v_cvt_pk_bf16_f32 v241, v242, v243
    v_exp_f32 v72, v72
    v_exp_f32 v73, v73
    v_exp_f32 v74, v74
    v_exp_f32 v75, v75
    v_cvt_pk_bf16_f32 v242, v72, v73
    v_cvt_pk_bf16_f32 v243, v74, v75
L_pg1:
    s_cbranch_execz L_main
    v_exp_f32 v68, v68
    v_exp_f32 v69, v69
    v_exp_f32 v70, v70
    v_exp_f32 v71, v71
    v_cvt_pk_bf16_f32 v168, v68, v69
    v_cvt_pk_bf16_f32 v169, v70, v71
    v_exp_f32 v253, v253
    s_waitcnt vmcnt(5)
    v_readfirstlane_b32 s94, v101
    s_nop 1
    s_cmp_lt_u32 s94, 3
    s_cbranch_scc1 L_spin
L_spinr:
    v_cvt_pk_bf16_f32 v170, v253, 0
    v_mfma_f32_16x16x32_bf16 v[8:11], v[220:223], v[240:243], 0
    buffer_load_dwordx4 a[216:219], v100, s[76:79], s92 offen offset:0 sc1
    v_cvt_pk_f16_f32 v152, v20, v21
    v_mfma_f32_16x16x32_bf16 v[8:11], v[220:223], v[168:171], v[8:11]
    v_cvt_pk_f16_f32 v153, v22, v23
    v_cvt_pk_f16_f32 v26, v228, v229
    v_mfma_f32_16x16x32_bf16 v[72:75], v[0:3], v[240:243], 0
    v_rcp_f32 v25, v24
    v_mfma_f32_16x16x32_bf16 v[72:75], v[164:167], v[168:171], v[72:75]
    v_max3_u32 v124, v124, v24, v25
    v_mul_f32 v248, v248, v25
    v_mfma_f32_16x16x32_bf16 v[20:23], v[16:19], v[240:243], 0
    v_mul_f32 v249, v249, v25
    v_cvt_pk_bf16_f32 v44, v248, v249
    v_mfma_f32_16x16x32_bf16 v[20:23], v[160:163], v[168:171], v[20:23]
    buffer_load_dwordx4 a[220:223], v100, s[76:79], s92 offen offset:1024 sc1
    v_mul_f32 v250, v250, v25
    v_mfma_f32_16x16x32_bf16 v[68:71], v[4:7], v[240:243], 0
    v_mul_f32 v251, v251, v25
    v_cvt_pk_bf16_f32 v45, v250, v251
    v_mfma_f32_16x16x32_bf16 v[68:71], v[156:159], v[168:171], v[68:71]
    s_waitcnt lgkmcnt(0)
    v_cvt_pk_bf16_f32 v168, v236, v237
    v_cvt_pk_bf16_f32 v169, v238, v239
    v_mfma_f32_16x16x32_bf16 v[240:243], a[48:51], v[140:143], 0
    v_cvt_pk_bf16_f32 v170, v46, 0
    v_mul_f32 v232, v232, v25
    v_mfma_f32_16x16x32_bf16 v[240:243], a[52:55], v[120:123], v[240:243]
    v_mul_f32 v233, v233, v25
    v_cvt_pk_bf16_f32 v46, v232, v233
    v_mfma_f32_16x16x32_bf16 v[240:243], a[56:59], v[92:95], v[240:243]
    buffer_load_dwordx4 a[224:227], v100, s[76:79], s92 offen offset:2048 sc1
    v_mul_f32 v234, v234, v25
    v_mfma_f32_16x16x32_bf16 v[240:243], a[60:63], v[88:91], v[240:243]
    v_mul_f32 v235, v235, v25
    v_cvt_pk_bf16_f32 v47, v234, v235
    v_mfma_f32_16x16x32_bf16 v[240:243], a[64:67], v[60:63], v[240:243]
    v_mul_f32 v96, v96, v25
    v_mul_f32 v97, v97, v25
    v_mfma_f32_16x16x32_bf16 v[240:243], a[68:71], v[40:43], v[240:243]
    v_cvt_pk_bf16_f32 v24, v96, v97
    v_mul_f32 v98, v98, v25
    v_mfma_f32_16x16x32_bf16 v[236:239], v[64:67], a[144:147], 0
    v_mul_f32 v99, v99, v25
    v_cvt_pk_bf16_f32 v25, v98, v99
    v_mfma_f32_16x16x32_bf16 v[236:239], v[52:55], a[148:151], v[236:239]
    buffer_load_dwordx4 a[228:231], v100, s[76:79], s92 offen offset:3072 sc1
    v_cvt_pk_f16_f32 v27, v230, v231
    v_mfma_f32_16x16x32_bf16 v[236:239], v[36:39], a[152:155], v[236:239]
    s_movk_i32 s92, 4096
    v_rcp_f32 v9, v8
    v_mfma_f32_16x16x32_bf16 v[236:239], v[56:59], a[156:159], v[236:239]
    v_max3_u32 v124, v124, v8, v9
    v_mul_f32 v72, v72, v9
    v_mfma_f32_16x16x32_bf16 v[236:239], v[32:35], a[160:163], v[236:239]
    v_mul_f32 v73, v73, v9
    v_cvt_pk_bf16_f32 v232, v72, v73
    v_mfma_f32_16x16x32_bf16 v[236:239], v[28:31], a[164:167], v[236:239]
    s_lshl_b32 s93, s68, 10
    v_mul_f32 v74, v74, v9
    v_mul_f32 v75, v75, v9
    v_mfma_f32_16x16x32_bf16 v[248:251], a[72:75], v[64:67], 0
    buffer_load_dwordx4 a[232:235], v100, s[76:79], s92 offen offset:0 sc1
    v_cvt_pk_bf16_f32 v233, v74, v75
    v_mfma_f32_16x16x32_bf16 v[248:251], a[76:79], v[52:55], v[248:251]
    v_mul_f32 v20, v20, v9
    v_mul_f32 v21, v21, v9
    v_mfma_f32_16x16x32_bf16 v[248:251], a[80:83], v[36:39], v[248:251]
    v_cvt_pk_bf16_f32 v234, v20, v21
    v_mul_f32 v22, v22, v9
    v_mfma_f32_16x16x32_bf16 v[248:251], a[84:87], v[56:59], v[248:251]
    v_mul_f32 v23, v23, v9
    v_cvt_pk_bf16_f32 v235, v22, v23
    v_mfma_f32_16x16x32_bf16 v[248:251], a[88:91], v[32:35], v[248:251]
    v_mul_f32 v68, v68, v9
    v_mul_f32 v69, v69, v9
    v_mfma_f32_16x16x32_bf16 v[248:251], a[92:95], v[28:31], v[248:251]
    buffer_load_dwordx4 a[236:239], v100, s[76:79], s92 offen offset:1024 sc1
    v_cvt_pk_bf16_f32 v10, v68, v69
    v_mfma_f32_16x16x32_bf16 v[20:23], v[64:67], a[168:171], 0
    s_nop 0
    v_mul_f32 v70, v70, v9
    v_mul_f32 v71, v71, v9
    v_mfma_f32_16x16x32_bf16 v[20:23], v[52:55], a[172:175], v[20:23]
    s_nop 0
    v_cvt_pk_f16_f32 v8, v248, v249
    v_cvt_pk_f16_f32 v9, v250, v251
    v_mfma_f32_16x16x32_bf16 v[20:23], v[36:39], a[176:179], v[20:23]
    v_pk_fma_f16 v49, v8, v8, s3
    v_pk_fmac_f16 v49, v9, v9
    v_mfma_f32_16x16x32_bf16 v[20:23], v[56:59], a[180:183], v[20:23]
    v_cvt_pk_bf16_f32 v11, v70, v71
    v_cvt_pk_f16_f32 v154, v12, v13
    v_mfma_f32_16x16x32_bf16 v[20:23], v[32:35], a[184:187], v[20:23]
    buffer_load_dwordx4 a[240:243], v100, s[76:79], s92 offen offset:2048 sc1
    v_cvt_pk_f16_f32 v155, v14, v15
    v_mfma_f32_16x16x32_bf16 v[20:23], v[28:31], a[188:191], v[20:23]
    v_add_u32 v14, s93, v163
    v_cvt_pk_f16_f32 v146, v240, v241
    v_mfma_f32_16x16x32_bf16 v[228:231], a[72:75], v[140:143], 0
    v_cvt_pk_f16_f32 v147, v242, v243
    v_pk_mul_f16 v108, v108, v102 op_sel:[0,0] op_sel_hi:[1,0]
    v_mfma_f32_16x16x32_bf16 v[228:231], a[76:79], v[120:123], v[228:231]
    ds_write_b32 v135, v44 offset:0
    v_mfma_f32_16x16x32_bf16 v[228:231], a[80:83], v[92:95], v[228:231]
    v_pk_mul_f16 v109, v109, v102 op_sel:[0,0] op_sel_hi:[1,0]
    v_pk_mul_f16 v110, v110, v102 op_sel:[0,0] op_sel_hi:[1,0]
    v_mfma_f32_16x16x32_bf16 v[228:231], a[84:87], v[88:91], v[228:231]
    buffer_load_dwordx4 a[244:247], v100, s[76:79], s92 offen offset:3072 sc1
    v_pk_mul_f16 v111, v111, v102 op_sel:[0,0] op_sel_hi:[1,0]
    v_mfma_f32_16x16x32_bf16 v[228:231], a[88:91], v[60:63], v[228:231]
    s_movk_i32 s92, 8192
    ds_write_b32 v135, v45 offset:4
    v_mfma_f32_16x16x32_bf16 v[228:231], a[92:95], v[40:43], v[228:231]
    s_nop 0
    v_pk_mul_f16 v86, v86, v102 op_sel:[0,0] op_sel_hi:[1,0]
    v_pk_mul_f16 v87, v87, v102 op_sel:[0,0] op_sel_hi:[1,0]
    v_mfma_f32_16x16x32_bf16 v[72:75], v[220:223], v[224:227], 0
    s_nop 0
    ds_write_b64 v135, v[46:47] offset:8
    v_mfma_f32_16x16x32_bf16 v[72:75], v[220:223], v[168:171], v[72:75]
    s_nop 0
    v_cvt_pk_f16_f32 v12, v228, v229
    v_cvt_pk_f16_f32 v13, v230, v231
    v_mfma_f32_16x16x32_bf16 v[96:99], v[0:3], v[224:227], 0
    buffer_load_dwordx4 a[248:251], v100, s[76:79], s92 offen offset:0 sc1
    v_pk_fma_f16 v51, v12, v12, s3
    v_mfma_f32_16x16x32_bf16 v[96:99], v[164:167], v[168:171], v[96:99]
    ds_write_b32 v134, v24 offset:0
    v_mfma_f32_16x16x32_bf16 v[68:71], v[16:19], v[224:227], 0
    ds_write_b32 v134, v25 offset:4
    v_mfma_f32_16x16x32_bf16 v[68:71], v[160:163], v[168:171], v[68:71]
    s_nop 0
    v_rcp_f32 v73, v72
    v_mfma_f32_16x16x32_bf16 v[44:47], v[4:7], v[224:227], 0
    s_nop 0
    v_mul_f32 v96, v96, v73
    v_mul_f32 v97, v97, v73
    v_mfma_f32_16x16x32_bf16 v[44:47], v[156:159], v[168:171], v[44:47]
    buffer_load_dwordx4 a[252:255], v100, s[76:79], s92 offen offset:1024 sc1
    v_cvt_pk_bf16_f32 v96, v96, v97
    v_mfma_f32_16x16x32_bf16 v[240:243], v[64:67], a[192:195], 0
    v_mul_f32 v98, v98, v73
    v_mul_f32 v99, v99, v73
    v_mfma_f32_16x16x32_bf16 v[240:243], v[52:55], a[196:199], v[240:243]
    v_cvt_pk_bf16_f32 v97, v98, v99
    v_mul_f32 v68, v68, v73
    v_mfma_f32_16x16x32_bf16 v[240:243], v[36:39], a[200:203], v[240:243]
    ds_write_b64 v135, v[96:97] offset:3072
    v_mfma_f32_16x16x32_bf16 v[240:243], v[56:59], a[204:207], v[240:243]
    v_mul_f32 v69, v69, v73
    v_cvt_pk_bf16_f32 v98, v68, v69
    v_mfma_f32_16x16x32_bf16 v[240:243], v[32:35], a[208:211], v[240:243]
    buffer_load_dwordx4 v[224:227], v100, s[76:79], s92 offen offset:2048 sc1
    v_mul_f32 v70, v70, v73
    v_mfma_f32_16x16x32_bf16 v[240:243], v[28:31], a[212:215], v[240:243]
    v_mul_f32 v71, v71, v73
    v_cvt_pk_bf16_f32 v99, v70, v71
    v_mfma_f32_16x16x32_bf16 v[68:71], v[244:247], v[0:3], 0
    ds_write_b64 v135, v[98:99] offset:3080
    v_mfma_f32_16x16x32_bf16 v[68:71], v[104:107], v[164:167], v[68:71]
    v_mul_f32 v44, v44, v73
    v_mul_f32 v45, v45, v73
    v_mfma_f32_16x16x32_bf16 v[96:99], v[244:247], v[16:19], 0
    ds_write_b32 v135, v232 offset:1536
    v_mfma_f32_16x16x32_bf16 v[96:99], v[104:107], v[160:163], v[96:99]
    buffer_load_dwordx4 v[228:231], v100, s[76:79], s92 offen offset:3072 sc1
    v_cvt_pk_bf16_f32 v24, v44, v45
    v_mfma_f32_16x16x32_bf16 v[0:3], v[244:247], v[4:7], 0
    s_movk_i32 s92, 12288
    ds_write_b32 v134, v24 offset:3072
    v_mfma_f32_16x16x32_bf16 v[0:3], v[104:107], v[156:159], v[0:3]
    s_sub_u32 s50, s45, s44
    ds_write_b32 v135, v233 offset:1540
    v_mfma_f32_16x16x32_bf16 v[104:107], v[140:143], a[144:147], 0
    s_sub_u32 s51, s46, s47
    v_mul_f32 v46, v46, v73
    v_mul_f32 v47, v47, v73
    v_mfma_f32_16x16x32_bf16 v[104:107], v[120:123], a[148:151], v[104:107]
    s_mov_b32 s60, s59
    ds_write_b64 v135, v[234:235] offset:1544
    v_mfma_f32_16x16x32_bf16 v[104:107], v[92:95], a[152:155], v[104:107]
    s_mov_b32 s59, s58
    buffer_load_dwordx4 v[232:235], v100, s[76:79], s92 offen offset:0 sc1
    v_cvt_pk_bf16_f32 v25, v46, v47
    v_mfma_f32_16x16x32_bf16 v[104:107], v[88:91], a[156:159], v[104:107]
    s_mov_b32 s58, s57
    ds_write_b32 v134, v25 offset:3076
    v_mfma_f32_16x16x32_bf16 v[104:107], v[60:63], a[160:163], v[104:107]
    s_mov_b32 s57, s56
    ds_write_b64 v134, v[10:11] offset:1536
    v_mfma_f32_16x16x32_bf16 v[104:107], v[40:43], a[164:167], v[104:107]
    s_mov_b32 s7, s6
    v_pk_fmac_f16 v51, v13, v13
    v_cvt_pk_bf16_f32 v0, v236, v237
    v_mfma_f32_16x16x32_bf16 v[44:47], a[96:99], v[64:67], 0
    s_mov_b32 s6, s5
    v_cvt_pk_bf16_f32 v1, v238, v239
    v_mov_b32_dpp v71, v99 quad_perm:[0,1,2,3] row_mask:0x2 bank_mask:0xf
    v_mfma_f32_16x16x32_bf16 v[44:47], a[100:103], v[52:55], v[44:47]
    s_mov_b32 s5, s4
    buffer_load_dwordx4 v[236:239], v100, s[76:79], s92 offen offset:1024 sc1
    v_cvt_pk_bf16_f32 v4, v240, v241
    v_mfma_f32_16x16x32_bf16 v[44:47], a[104:107], v[36:39], v[44:47]
    s_sub_u32 s14, s6, s7
    v_cvt_pk_bf16_f32 v5, v242, v243
    v_mov_b32_dpp v71, v3 quad_perm:[0,1,2,3] row_mask:0x4 bank_mask:0xf
    v_mfma_f32_16x16x32_bf16 v[44:47], a[108:111], v[56:59], v[44:47]
    s_add_u32 s61, s61, 1
    v_cvt_pk_bf16_f32 v71, v71, v71
    v_max3_u32 v124, v124, v72, v73
    v_mfma_f32_16x16x32_bf16 v[44:47], a[112:115], v[32:35], v[44:47]
    s_add_u32 s12, s12, 20
    ds_write_b16 v131, v71
    v_mfma_f32_16x16x32_bf16 v[44:47], a[116:119], v[28:31], v[44:47]
    s_max_u32 s12, s12, s61
    v_pk_mul_f16 v116, v116, v102 op_sel:[0,1] op_sel_hi:[1,1]
    v_pk_mul_f16 v117, v117, v102 op_sel:[0,1] op_sel_hi:[1,1]
    v_mfma_f32_16x16x32_bf16 v[16:19], a[0:3], v[64:67], 0
    s_cmp_lt_u32 s61, s71
    buffer_load_dwordx4 v[240:243], v100, s[76:79], s92 offen offset:2048 sc1
    v_add_u32 v135, s49, v135
    v_mfma_f32_16x16x32_bf16 v[16:19], a[4:7], v[52:55], v[16:19]
    s_cselect_b32 s15, s61, s12
    ds_read_b128 v[52:55], v137 offset:3200
    v_add_u32 v134, s49, v134
    v_mfma_f32_16x16x32_bf16 v[16:19], a[8:11], v[36:39], v[16:19]
    s_cselect_b32 s56, s69, s70
    ds_read_b128 v[36:39], v137 offset:3328
    v_cvt_pk_f16_f32 v10, v44, v45
    v_mfma_f32_16x16x32_bf16 v[16:19], a[12:15], v[56:59], v[16:19]
    s_add_u32 s56, s56, s15
    v_cvt_pk_f16_f32 v11, v46, v47
    v_pk_fmac_f16 v49, v10, v10
    v_mfma_f32_16x16x32_bf16 v[16:19], a[16:19], v[32:35], v[16:19]
    s_mul_i32 s53, s56, 58255
    ds_read_b128 v[32:35], v136 offset:3328
    v_pk_fmac_f16 v49, v11, v11
    v_mfma_f32_16x16x32_bf16 v[16:19], a[20:23], v[28:31], v[16:19]
    s_lshr_b32 s53, s53, 22
    buffer_load_dwordx4 v[244:247], v100, s[76:79], s92 offen offset:3072 sc1
    v_pk_fmac_f16 v49, v154, v154
    v_mfma_f32_16x16x32_bf16 v[72:75], a[24:27], v[140:143], 0
    s_movk_i32 s92, 16384
    v_pk_fmac_f16 v49, v155, v155
    v_pk_mul_f16 v118, v118, v102 op_sel:[0,1] op_sel_hi:[1,1]
    v_mfma_f32_16x16x32_bf16 v[72:75], a[28:31], v[120:123], v[72:75]
    s_mul_i32 s53, s53, s63
    ds_read_b128 v[44:47], v136 offset:3200
    v_cvt_pk_f16_f32 v24, v16, v17
    v_mfma_f32_16x16x32_bf16 v[72:75], a[32:35], v[92:95], v[72:75]
    s_mul_i32 s56, s56, s62
    v_cvt_pk_f16_f32 v25, v18, v19
    v_pk_fma_f16 v48, v24, v24, s3
    v_mfma_f32_16x16x32_bf16 v[72:75], a[36:39], v[88:91], v[72:75]
    s_add_u32 s56, s56, s53
    v_pk_fmac_f16 v48, v25, v25
    v_pk_fmac_f16 v48, v26, v26
    v_mfma_f32_16x16x32_bf16 v[72:75], a[40:43], v[60:63], v[72:75]
    s_mul_i32 s4, s15, 112
    buffer_load_dwordx4 v[248:251], v100, s[76:79], s92 offen offset:0 sc1
    v_pk_fmac_f16 v48, v27, v27
    v_mfma_f32_16x16x32_bf16 v[72:75], a[44:47], v[40:43], v[72:75]
    s_cmp_ge_u32 s15, 16
    ds_read_b128 v[64:67], v137 offset:3072
    v_pk_fmac_f16 v48, v152, v152
    v_mfma_f32_16x16x32_bf16 v[16:19], a[96:99], v[140:143], 0
    s_cselect_b32 s53, -30464, 0
    ds_read_b128 v[56:59], v136 offset:3072
    v_pk_fmac_f16 v48, v153, v153
    v_mfma_f32_16x16x32_bf16 v[16:19], a[100:103], v[120:123], v[16:19]
    s_add_u32 s4, s4, s53
    v_cvt_pk_f16_f32 v30, v72, v73
    v_cvt_pk_f16_f32 v31, v74, v75
    v_mfma_f32_16x16x32_bf16 v[16:19], a[104:107], v[92:95], v[16:19]
    s_cmp_lt_u32 s15, s73
    v_pk_mul_f16 v119, v119, v102 op_sel:[0,1] op_sel_hi:[1,1]
    v_pk_mul_f16 v80, v80, v102 op_sel:[0,1] op_sel_hi:[1,1]
    v_mfma_f32_16x16x32_bf16 v[16:19], a[108:111], v[88:91], v[16:19]
    s_cselect_b32 s26, 100270464, 0
    buffer_load_dwordx4 v[252:255], v100, s[76:79], s92 offen offset:1024 sc1
    v_pk_mul_f16 v81, v81, v102 op_sel:[0,1] op_sel_hi:[1,1]
    v_mfma_f32_16x16x32_bf16 v[16:19], a[112:115], v[60:63], v[16:19]
    s_cselect_b32 s56, s56, 0
    v_fma_mix_f32 v6, v108, v116, 0 op_sel:[0,0,0] op_sel_hi:[1,1,0]
    v_fma_mix_f32 v6, v108, v116, v6 op_sel:[1,1,0] op_sel_hi:[1,1,0]
    v_mfma_f32_16x16x32_bf16 v[16:19], a[116:119], v[40:43], v[16:19]
    s_cselect_b32 s4, s4, -1
    ds_write_b128 v14, v[112:115] offset:6144
    v_mfma_f32_16x16x32_bf16 v[96:99], v[140:143], a[192:195], 0
    s_cselect_b32 s15, s15, 0
    v_fma_mix_f32 v6, v109, v117, v6 op_sel:[0,0,0] op_sel_hi:[1,1,0]
    v_fma_mix_f32 v6, v109, v117, v6 op_sel:[1,1,0] op_sel_hi:[1,1,0]
    v_mfma_f32_16x16x32_bf16 v[96:99], v[120:123], a[196:199], v[96:99]
    s_cselect_b32 s13, s13, -1
    v_cvt_pk_f16_f32 v14, v16, v17
    v_cvt_pk_f16_f32 v15, v18, v19
    v_mfma_f32_16x16x32_bf16 v[96:99], v[92:95], a[200:203], v[96:99]
    s_bitset1_b32 s64, s15
    ds_write_b64 v50, v[82:83] offset:80
    v_mfma_f32_16x16x32_bf16 v[96:99], v[88:91], a[204:207], v[96:99]
    s_add_u32 s65, s65, 1
    v_pk_fmac_f16 v51, v14, v14
    v_pk_fmac_f16 v51, v15, v15
    v_mfma_f32_16x16x32_bf16 v[96:99], v[60:63], a[208:211], v[96:99]
    s_cmp_ge_i32 s65, 2
    ds_write_b128 v50, v[76:79] offset:96
    v_mfma_f32_16x16x32_bf16 v[96:99], v[40:43], a[212:215], v[96:99]
    s_cselect_b32 s30, 100270464, 0
    v_fma_mix_f32 v6, v110, v118, v6 op_sel:[0,0,0] op_sel_hi:[1,1,0]
    v_fma_mix_f32 v6, v110, v118, v6 op_sel:[1,1,0] op_sel_hi:[1,1,0]
    v_mfma_f32_16x16x32_bf16 v[72:75], v[140:143], a[168:171], 0
    s_add_u32 s67, s46, s54
    v_fma_mix_f32 v6, v111, v119, v6 op_sel:[0,0,0] op_sel_hi:[1,1,0]
    v_fma_mix_f32 v6, v111, v119, v6 op_sel:[1,1,0] op_sel_hi:[1,1,0]
    v_mfma_f32_16x16x32_bf16 v[72:75], v[120:123], a[172:175], v[72:75]
    s_add_u32 m0, s67, 0
    v_fma_mix_f32 v6, v86, v80, v6 op_sel:[0,0,0] op_sel_hi:[1,1,0]
    v_fma_mix_f32 v6, v86, v80, v6 op_sel:[1,1,0] op_sel_hi:[1,1,0]
    v_mfma_f32_16x16x32_bf16 v[72:75], v[92:95], a[176:179], v[72:75]
    v_fma_mix_f32 v6, v87, v81, v6 op_sel:[0,0,0] op_sel_hi:[1,1,0]
    v_fma_mix_f32 v6, v87, v81, v6 op_sel:[1,1,0] op_sel_hi:[1,1,0]
    v_mfma_f32_16x16x32_bf16 v[72:75], v[88:91], a[180:183], v[72:75]
    v_mov_b32 v16, 0
    v_mov_b32 v17, 0
    v_mfma_f32_16x16x32_bf16 v[72:75], v[60:63], a[184:187], v[72:75]
    v_mov_b32 v7, 0
    v_add_u32 v2, 0, v50
    v_mfma_f32_16x16x32_bf16 v[72:75], v[40:43], a[188:191], v[72:75]
    s_nop 0
    ds_write2_b64 v2, v[16:17], v[16:17] offset0:2 offset1:3
    v_mfma_f32_16x16x32_bf16 v[76:79], a[0:3], v[140:143], 0
    s_nop 0
    v_mov_b32 v3, v6
    v_cmp_gt_u32 vcc, 1820327936, v124
    v_mfma_f32_16x16x32_bf16 v[76:79], a[4:7], v[120:123], v[76:79]
    s_nop 0
    v_cvt_pk_bf16_f32 v18, v72, v73
    v_cvt_pk_bf16_f32 v19, v74, v75
    v_mfma_f32_16x16x32_bf16 v[76:79], a[8:11], v[92:95], v[76:79]
    ds_write_b128 v2, v[108:111] offset:32
    v_mfma_f32_16x16x32_bf16 v[76:79], a[12:15], v[88:91], v[76:79]
    v_permlane32_swap_b32 v3, v6
    v_mfma_f32_16x16x32_bf16 v[76:79], a[16:19], v[60:63], v[76:79]
    v_add_f32 v6, v3, v6
    v_mov_b32 v3, v6
    v_mfma_f32_16x16x32_bf16 v[76:79], a[20:23], v[40:43], v[76:79]
    s_nop 0
    ds_write2_b64 v2, v[16:17], v[86:87] offset0:8 offset1:9
    v_mfma_f32_16x16x32_bf16 v[68:71], a[120:123], v[140:143], 0
    s_nop 0
    v_permlane16_swap_b32 v3, v6
    v_mfma_f32_16x16x32_bf16 v[68:71], a[124:127], v[120:123], v[68:71]
    s_nop 0
    v_add_f32 v6, v3, v6
    v_cvt_pk_f16_f32 v28, v76, v77
    v_mfma_f32_16x16x32_bf16 v[68:71], a[128:131], v[92:95], v[68:71]
    ds_write_b128 v2, v[116:119]
    v_mfma_f32_16x16x32_bf16 v[68:71], a[132:135], v[88:91], v[68:71]
    v_cvt_pk_f16_f32 v29, v78, v79
    v_pk_fma_f16 v50, v28, v28, s3
    v_mfma_f32_16x16x32_bf16 v[68:71], a[136:139], v[60:63], v[68:71]
    v_pk_fmac_f16 v50, v29, v29
    v_pk_fmac_f16 v50, v30, v30
    v_mfma_f32_16x16x32_bf16 v[68:71], a[140:143], v[40:43], v[68:71]
    s_waitcnt lgkmcnt(2)
    ds_write2_b64 v2, v[80:81], v[16:17] offset0:6 offset1:7
    v_mfma_f32_16x16x32_bf16 v[100:103], a[120:123], v[64:67], 0
    v_pk_fmac_f16 v50, v31, v31
    v_pk_fmac_f16 v50, v146, v146
    v_mfma_f32_16x16x32_bf16 v[100:103], a[124:127], v[56:59], v[100:103]
    v_pk_fmac_f16 v50, v147, v147
    v_add_f32 v6, s84, v6
    v_mfma_f32_16x16x32_bf16 v[100:103], a[128:131], v[52:55], v[100:103]
    v_exp_f32 v6, v6
    v_mfma_f32_16x16x32_bf16 v[100:103], a[132:135], v[44:47], v[100:103]
    v_cvt_pk_bf16_f32 v6, v6, 0
    v_cndmask_b32 v3, -1, v125, vcc
    v_mfma_f32_16x16x32_bf16 v[100:103], a[136:139], v[36:39], v[100:103]
    v_cmp_gt_u32 vcc, 16, v85
    v_and_b32 v3, 0xb0000000, v3
    v_mfma_f32_16x16x32_bf16 v[100:103], a[140:143], v[32:35], v[100:103]
    v_cndmask_b32 v6, 0, v6, vcc
    v_cmp_ne_u32 s[94:95], 0, v3
    v_mfma_f32_16x16x32_bf16 v[80:83], a[48:51], v[64:67], 0
    ds_write_b64 v2, v[6:7] offset:88
    v_mfma_f32_16x16x32_bf16 v[80:83], a[52:55], v[56:59], v[80:83]
    s_or_b32 s94, s94, s95
    v_mov_b32 v3, s94
    v_cvt_pk_f16_f32 v148, v68, v69
    v_mfma_f32_16x16x32_bf16 v[80:83], a[56:59], v[52:55], v[80:83]
    s_lshl_b32 s95, s68, 2
    v_mov_b32 v2, s95
    v_cvt_pk_f16_f32 v149, v70, v71
    v_mfma_f32_16x16x32_bf16 v[80:83], a[60:63], v[44:47], v[80:83]
    ds_write_b32 v2, v3 offset:14848
    v_mfma_f32_16x16x32_bf16 v[80:83], a[64:67], v[36:39], v[80:83]
    v_pk_fmac_f16 v51, v148, v148
    v_pk_fmac_f16 v51, v149, v149
    v_mfma_f32_16x16x32_bf16 v[80:83], a[68:71], v[32:35], v[80:83]
    v_add_u32 v137, s50, v137
    v_add_u32 v136, s50, v136
    v_mfma_f32_16x16x32_f16 v[88:91], v[212:215], v[48:51], 0
    v_add_u32 v135, s48, v135
    v_add_u32 v134, s48, v134
    v_mfma_f32_16x16x32_bf16 v[60:63], a[72:75], v[64:67], 0
    v_add_u32 v133, s51, v133
    v_add_u32 v132, s14, v132
    v_mfma_f32_16x16x32_bf16 v[60:63], a[76:79], v[56:59], v[60:63]
    s_nop 0
    ds_read_b128 v[72:75], v132 offset:16
    v_or3_b32 v125, v125, v88, v89
    v_mfma_f32_16x16x32_bf16 v[60:63], a[80:83], v[52:55], v[60:63]
    v_rsq_f32 v88, v88
    v_mfma_f32_16x16x32_bf16 v[60:63], a[84:87], v[44:47], v[60:63]
    v_rsq_f32 v89, v89
    v_mfma_f32_16x16x32_bf16 v[60:63], a[88:91], v[36:39], v[60:63]
    s_waitcnt vmcnt(0) lgkmcnt(1)
    v_mul_f32 v88, s52, v88
    v_cvt_pk_f16_f32 v88, v88, v89
    v_mfma_f32_16x16x32_bf16 v[60:63], a[92:95], v[32:35], v[60:63]
    s_barrier
    ds_read_b128 v[92:95], v167 offset:14848
    v_pk_mul_f16 v8, v8, v88 op_sel:[0,1] op_sel_hi:[1,1]
    v_mfma_f32_16x16x32_bf16 v[40:43], a[0:3], v[64:67], 0
    v_pk_mul_f16 v9, v9, v88 op_sel:[0,1] op_sel_hi:[1,1]
    v_pk_mul_f16 v10, v10, v88 op_sel:[0,1] op_sel_hi:[1,1]
    v_mfma_f32_16x16x32_bf16 v[40:43], a[4:7], v[56:59], v[40:43]
    v_pk_mul_f16 v11, v11, v88 op_sel:[0,1] op_sel_hi:[1,1]
    v_pk_mul_f16 v154, v154, v88 op_sel:[0,1] op_sel_hi:[1,1]
    v_mfma_f32_16x16x32_bf16 v[40:43], a[8:11], v[52:55], v[40:43]
    v_pk_mul_f16 v155, v155, v88 op_sel:[0,1] op_sel_hi:[1,1]
    v_or3_b32 v125, v125, v90, v91
    v_mfma_f32_16x16x32_bf16 v[40:43], a[12:15], v[44:47], v[40:43]
    v_rsq_f32 v90, v90
    v_mfma_f32_16x16x32_bf16 v[40:43], a[16:19], v[36:39], v[40:43]
    v_rsq_f32 v91, v91
    v_mfma_f32_16x16x32_bf16 v[40:43], a[20:23], v[32:35], v[40:43]
    v_mul_f32 v90, s52, v90
    v_cvt_pk_f16_f32 v90, v90, v91
    v_mfma_f32_16x16x32_bf16 v[76:79], v[64:67], a[168:171], 0
    v_cvt_pk_f16_f32 v60, v60, v61
    v_cvt_pk_f16_f32 v61, v62, v63
    v_mfma_f32_16x16x32_bf16 v[76:79], v[56:59], a[172:175], v[76:79]
    ds_read_b128 v[68:71], v132 offset:0
    v_pk_fma_f16 v49, v60, v60, s3
    v_mfma_f32_16x16x32_bf16 v[76:79], v[52:55], a[176:179], v[76:79]
    s_waitcnt lgkmcnt(1)
    v_pk_fmac_f16 v49, v61, v61
    v_or3_b32 v92, v92, v93, v94
    v_mfma_f32_16x16x32_bf16 v[76:79], v[44:47], a[180:183], v[76:79]
    v_or_b32 v92, v92, v95
    v_add_u32 v131, s14, v131
    v_mfma_f32_16x16x32_bf16 v[76:79], v[36:39], a[184:187], v[76:79]
    ds_read_u16 v162, v131 offset:96
    v_readfirstlane_b32 s75, v92
    v_mfma_f32_16x16x32_bf16 v[76:79], v[32:35], a[188:191], v[76:79]
    v_cvt_pk_bf16_f32 v2, v104, v105
    v_cvt_pk_bf16_f32 v3, v106, v107
    v_mfma_f32_16x16x32_bf16 v[92:95], v[64:67], a[144:147], 0
    v_cvt_pk_bf16_f32 v6, v96, v97
    v_cvt_pk_bf16_f32 v7, v98, v99
    v_mfma_f32_16x16x32_bf16 v[92:95], v[56:59], a[148:151], v[92:95]
    v_cvt_pk_f16_f32 v142, v100, v101
    v_cvt_pk_f16_f32 v143, v102, v103
    v_mfma_f32_16x16x32_bf16 v[92:95], v[52:55], a[152:155], v[92:95]
    v_pk_mul_f16 v24, v24, v88 op_sel:[0,0] op_sel_hi:[1,0]
    v_pk_mul_f16 v25, v25, v88 op_sel:[0,0] op_sel_hi:[1,0]
    v_mfma_f32_16x16x32_bf16 v[92:95], v[44:47], a[156:159], v[92:95]
    v_pk_mul_f16 v26, v26, v88 op_sel:[0,0] op_sel_hi:[1,0]
    v_pk_mul_f16 v27, v27, v88 op_sel:[0,0] op_sel_hi:[1,0]
    v_mfma_f32_16x16x32_bf16 v[92:95], v[36:39], a[160:163], v[92:95]
    v_pk_mul_f16 v152, v152, v88 op_sel:[0,0] op_sel_hi:[1,0]
    v_pk_mul_f16 v153, v153, v88 op_sel:[0,0] op_sel_hi:[1,0]
    v_mfma_f32_16x16x32_bf16 v[92:95], v[32:35], a[164:167], v[92:95]
    v_pk_mul_f16 v12, v12, v90 op_sel:[0,1] op_sel_hi:[1,1]
    v_pk_mul_f16 v13, v13, v90 op_sel:[0,1] op_sel_hi:[1,1]
    v_mfma_f32_16x16x32_bf16 v[96:99], a[24:27], v[64:67], 0
    v_pk_mul_f16 v14, v14, v90 op_sel:[0,1] op_sel_hi:[1,1]
    v_pk_mul_f16 v15, v15, v90 op_sel:[0,1] op_sel_hi:[1,1]
    v_mfma_f32_16x16x32_bf16 v[96:99], a[28:31], v[56:59], v[96:99]
    v_pk_mul_f16 v148, v148, v90 op_sel:[0,1] op_sel_hi:[1,1]
    v_pk_mul_f16 v149, v149, v90 op_sel:[0,1] op_sel_hi:[1,1]
    v_mfma_f32_16x16x32_bf16 v[96:99], a[32:35], v[52:55], v[96:99]
    v_cvt_pk_bf16_f32 v164, v92, v93
    v_cvt_pk_bf16_f32 v165, v94, v95
    v_mfma_f32_16x16x32_bf16 v[96:99], a[36:39], v[44:47], v[96:99]
    v_cvt_pk_f16_f32 v40, v40, v41
    v_cvt_pk_f16_f32 v41, v42, v43
    v_pk_mul_f16 v28, v28, v90 op_sel:[0,0] op_sel_hi:[1,0]
    v_pk_mul_f16 v29, v29, v90 op_sel:[0,0] op_sel_hi:[1,0]
    v_pk_mul_f16 v30, v30, v90 op_sel:[0,0] op_sel_hi:[1,0]
    v_pk_mul_f16 v31, v31, v90 op_sel:[0,0] op_sel_hi:[1,0]
    v_pk_mul_f16 v146, v146, v90 op_sel:[0,0] op_sel_hi:[1,0]
    v_pk_mul_f16 v147, v147, v90 op_sel:[0,0] op_sel_hi:[1,0]
    s_waitcnt lgkmcnt(0)
    s_cmp_lg_u32 s75, 0
    s_cbranch_scc0 L_atomF0r
    s_branch L_slow
.fill 422, 4, 0xbf810000
L_atomF0:
    s_cbranch_execz L_main
    v_mov_b32 v167, 0x800000
    buffer_atomic_add v167, v163, s[8:11], 0 offen sc0 sc1
    s_branch L_atomF0r
.p2alignl 6, 0xbf810000
L_loopF0:
    v_mfma_f32_16x16x32_bf16 v[46:49], a[4:7], v[12:15], v[46:49]
    v_mul_f32 v154, v154, v69
    v_mul_f32 v155, v155, v69
    v_mfma_f32_16x16x32_bf16 v[46:49], a[8:11], v[36:39], v[46:49]
    v_cvt_pk_bf16_f32 v153, v154, v155
    v_mul_f32 v20, v20, v69
    v_mfma_f32_16x16x32_bf16 v[46:49], a[12:15], v[96:99], v[46:49]
    ds_write_b64 v135, v[152:153] offset:3072
    v_mfma_f32_16x16x32_bf16 v[46:49], a[16:19], v[40:43], v[46:49]
    v_mul_f32 v21, v21, v69
    v_cvt_pk_bf16_f32 v154, v20, v21
    v_mfma_f32_16x16x32_bf16 v[46:49], a[20:23], v[52:55], v[46:49]
    v_mul_f32 v22, v22, v69
    v_mul_f32 v23, v23, v69
    v_mfma_f32_16x16x32_bf16 v[4:7], a[120:123], v[146:149], 0
    v_cvt_pk_bf16_f32 v155, v22, v23
    v_mul_f32 v0, v0, v69
    v_mfma_f32_16x16x32_bf16 v[4:7], a[124:127], v[12:15], v[4:7]
    ds_write_b64 v135, v[154:155] offset:3080
    v_mfma_f32_16x16x32_bf16 v[4:7], a[128:131], v[36:39], v[4:7]
    v_mul_f32 v1, v1, v69
    v_cvt_pk_bf16_f32 v0, v0, v1
    v_mfma_f32_16x16x32_bf16 v[4:7], a[132:135], v[96:99], v[4:7]
    v_mul_f32 v2, v2, v69
    v_mul_f32 v3, v3, v69
    v_mfma_f32_16x16x32_bf16 v[4:7], a[136:139], v[40:43], v[4:7]
    ds_read_b128 v[68:71], v137 offset:1792
    v_cvt_pk_bf16_f32 v1, v2, v3
    v_mfma_f32_16x16x32_bf16 v[4:7], a[140:143], v[52:55], v[4:7]
    ds_read_b128 v[120:123], v136 offset:1664
    v_mul_f32 v80, v80, v11
    v_mfma_f32_16x16x32_bf16 v[20:23], v[146:149], a[168:171], 0
    v_mul_f32 v81, v81, v11
    v_cvt_pk_bf16_f32 v8, v80, v81
    v_mfma_f32_16x16x32_bf16 v[20:23], v[12:15], a[172:175], v[20:23]
    v_mul_f32 v82, v82, v11
    v_mul_f32 v83, v83, v11
    v_mfma_f32_16x16x32_bf16 v[20:23], v[36:39], a[176:179], v[20:23]
    v_cvt_pk_bf16_f32 v9, v82, v83
    v_fmac_f32 v51, v117, v117
    v_mfma_f32_16x16x32_bf16 v[20:23], v[96:99], a[180:183], v[20:23]
    ds_write_b32 v134, v0 offset:3072
    v_mfma_f32_16x16x32_bf16 v[20:23], v[40:43], a[184:187], v[20:23]
    v_fmac_f32 v51, v118, v118
    v_fmac_f32 v51, v119, v119
    v_mfma_f32_16x16x32_bf16 v[20:23], v[52:55], a[188:191], v[20:23]
    v_fma_f32 v24, v92, v92, s42
    v_fmac_f32 v24, v93, v93
    v_mfma_f32_16x16x32_bf16 v[32:35], a[24:27], v[146:149], 0
    v_fmac_f32 v24, v94, v94
    v_fmac_f32 v24, v95, v95
    v_mfma_f32_16x16x32_bf16 v[32:35], a[28:31], v[12:15], v[32:35]
    ds_write_b32 v134, v1 offset:3076
    v_mfma_f32_16x16x32_bf16 v[32:35], a[32:35], v[36:39], v[32:35]
    v_fmac_f32 v24, v84, v84
    v_fmac_f32 v24, v85, v85
    v_mfma_f32_16x16x32_bf16 v[32:35], a[36:39], v[96:99], v[32:35]
    v_fmac_f32 v24, v86, v86
    v_fmac_f32 v24, v87, v87
    v_mfma_f32_16x16x32_bf16 v[32:35], a[40:43], v[40:43], v[32:35]
    v_fmac_f32 v24, v28, v28
    v_fmac_f32 v24, v29, v29
    v_mfma_f32_16x16x32_bf16 v[32:35], a[44:47], v[52:55], v[32:35]
    ds_write_b32 v135, v25 offset:1540
    v_mfma_f32_16x16x32_bf16 v[0:3], a[48:51], v[146:149], 0
    v_fmac_f32 v24, v30, v30
    v_fmac_f32 v24, v31, v31
    v_mfma_f32_16x16x32_bf16 v[0:3], a[52:55], v[12:15], v[0:3]
    v_fma_f32 v25, v108, v108, s42
    v_fmac_f32 v25, v109, v109
    v_mfma_f32_16x16x32_bf16 v[0:3], a[56:59], v[36:39], v[0:3]
    v_fmac_f32 v25, v110, v110
    v_fmac_f32 v25, v111, v111
    v_mfma_f32_16x16x32_bf16 v[0:3], a[60:63], v[96:99], v[0:3]
    ds_write_b64 v135, v[26:27] offset:1544
    v_mfma_f32_16x16x32_bf16 v[0:3], a[64:67], v[40:43], v[0:3]
    v_fmac_f32 v25, v140, v140
    v_fmac_f32 v25, v141, v141
    v_mfma_f32_16x16x32_bf16 v[0:3], a[68:71], v[52:55], v[0:3]
    v_fmac_f32 v25, v142, v142
    v_fmac_f32 v25, v143, v143
    v_mfma_f32_16x16x32_bf16 v[56:59], v[146:149], a[192:195], 0
    s_waitcnt vmcnt(10)
    v_fmac_f32 v25, v88, v88
    v_fmac_f32 v25, v89, v89
    v_mfma_f32_16x16x32_bf16 v[56:59], v[12:15], a[196:199], v[56:59]
    ds_write_b64 v134, v[8:9] offset:1536
    v_mfma_f32_16x16x32_bf16 v[56:59], v[36:39], a[200:203], v[56:59]
    v_fmac_f32 v25, v90, v90
    v_fmac_f32 v25, v91, v91
    v_mfma_f32_16x16x32_bf16 v[56:59], v[96:99], a[204:207], v[56:59]
    v_cvt_pk_bf16_f32 v26, v51, v24
    v_cvt_pk_bf16_f32 v27, v25, v167
    v_mfma_f32_16x16x32_bf16 v[56:59], v[40:43], a[208:211], v[56:59]
    v_add_u32 v135, s49, v135
    v_add_u32 v134, s49, v134
    v_mfma_f32_16x16x32_bf16 v[56:59], v[52:55], a[212:215], v[56:59]
    ds_write_b64 v159, v[26:27]
    v_mfma_f32_16x16x32_bf16 v[8:11], a[72:75], v[146:149], 0
    v_cvt_pk_f16_f32 v24, v46, v47
    v_cvt_pk_f16_f32 v25, v48, v49
    v_mfma_f32_16x16x32_bf16 v[8:11], a[76:79], v[12:15], v[8:11]
    v_pk_fma_f16 v48, v24, v24, s3
    v_pk_fmac_f16 v48, v25, v25
    v_mfma_f32_16x16x32_bf16 v[8:11], a[80:83], v[36:39], v[8:11]
    v_cvt_pk_f16_f32 v154, v4, v5
    v_cvt_pk_f16_f32 v155, v6, v7
    v_mfma_f32_16x16x32_bf16 v[8:11], a[84:87], v[96:99], v[8:11]
    v_cvt_pk_f16_f32 v26, v32, v33
    v_cvt_pk_f16_f32 v27, v34, v35
    v_mfma_f32_16x16x32_bf16 v[8:11], a[88:91], v[40:43], v[8:11]
    v_pk_fmac_f16 v48, v26, v26
    v_pk_fmac_f16 v48, v27, v27
    v_mfma_f32_16x16x32_bf16 v[8:11], a[92:95], v[52:55], v[8:11]
    v_cvt_pk_bf16_f32 v4, v56, v57
    v_cvt_pk_bf16_f32 v5, v58, v59
    v_mfma_f32_16x16x32_bf16 v[32:35], a[96:99], v[146:149], 0
    v_cvt_pk_f16_f32 v152, v0, v1
    v_cvt_pk_f16_f32 v153, v2, v3
    v_mfma_f32_16x16x32_bf16 v[32:35], a[100:103], v[12:15], v[32:35]
    s_waitcnt lgkmcnt(0)
    v_pk_fmac_f16 v48, v152, v152
    v_pk_fmac_f16 v48, v153, v153
    v_mfma_f32_16x16x32_bf16 v[32:35], a[104:107], v[36:39], v[32:35]
    s_barrier
    ds_read_b128 v[0:3], v163 offset:0
    v_mfma_f32_16x16x32_bf16 v[32:35], a[108:111], v[96:99], v[32:35]
    ds_read_b128 v[44:47], v163 offset:1024
    v_mfma_f32_16x16x32_bf16 v[32:35], a[112:115], v[40:43], v[32:35]
    v_mfma_f32_16x16x32_bf16 v[32:35], a[116:119], v[52:55], v[32:35]
    v_cvt_pk_f16_f32 v8, v8, v9
    v_cvt_pk_f16_f32 v9, v10, v11
    v_mfma_f32_16x16x32_bf16 v[56:59], v[146:149], a[144:147], 0
    s_nop 0
    v_pk_fma_f16 v49, v8, v8, s3
    v_pk_fmac_f16 v49, v9, v9
    v_mfma_f32_16x16x32_bf16 v[56:59], v[12:15], a[148:151], v[56:59]
    s_nop 0
    v_cvt_pk_f16_f32 v10, v32, v33
    v_cvt_pk_f16_f32 v11, v34, v35
    v_mfma_f32_16x16x32_bf16 v[56:59], v[36:39], a[152:155], v[56:59]
    v_pk_fmac_f16 v49, v10, v10
    v_pk_fmac_f16 v49, v11, v11
    v_mfma_f32_16x16x32_bf16 v[56:59], v[96:99], a[156:159], v[56:59]
    v_pk_fmac_f16 v49, v154, v154
    v_pk_fmac_f16 v49, v155, v155
    v_mfma_f32_16x16x32_bf16 v[56:59], v[40:43], a[160:163], v[56:59]
    v_mfma_f32_16x16x32_bf16 v[56:59], v[52:55], a[164:167], v[56:59]
    s_waitcnt lgkmcnt(1)
    v_readfirstlane_b32 s12, v1
    v_mfma_f32_16x16x32_bf16 v[40:43], v[216:219], v[0:3], 0
    s_waitcnt lgkmcnt(0)
    s_nop 1
    v_mfma_f32_16x16x32_bf16 v[40:43], v[216:219], v[44:47], v[40:43]
    s_lshr_b32 s12, s12, 23
    v_cvt_pk_bf16_f32 v0, v56, v57
    v_cvt_pk_bf16_f32 v1, v58, v59
    v_mfma_f32_16x16x32_bf16 v[52:55], a[96:99], v[60:63], 0
    s_nop 1
    v_mfma_f32_16x16x32_bf16 v[52:55], a[100:103], v[112:115], v[52:55]
    s_nop 0
    v_rsq_f32 v40, v40
    v_mfma_f32_16x16x32_bf16 v[52:55], a[104:107], v[100:103], v[52:55]
    v_rsq_f32 v41, v41
    v_mfma_f32_16x16x32_bf16 v[52:55], a[108:111], v[120:123], v[52:55]
    v_rsq_f32 v42, v42
    v_mfma_f32_16x16x32_bf16 v[52:55], a[112:115], v[68:71], v[52:55]
    v_mul_f32 v40, s43, v40
    v_mul_f32 v41, s43, v41
    v_mfma_f32_16x16x32_bf16 v[52:55], a[116:119], v[72:75], v[52:55]
    v_mul_f32 v42, s43, v42
    v_mul_f32 v92, v92, v41
    v_mfma_f32_16x16x32_bf16 v[36:39], v[60:63], a[168:171], 0
    v_mul_f32 v93, v93, v41
    v_cvt_pk_bf16_f32 v12, v92, v93
    v_mfma_f32_16x16x32_bf16 v[36:39], v[112:115], a[172:175], v[36:39]
    ds_write_b32 v135, v12 offset:1536
    v_mfma_f32_16x16x32_bf16 v[36:39], v[100:103], a[176:179], v[36:39]
    v_mul_f32 v94, v94, v41
    v_mul_f32 v95, v95, v41
    v_mfma_f32_16x16x32_bf16 v[36:39], v[120:123], a[180:183], v[36:39]
    v_cvt_pk_bf16_f32 v13, v94, v95
    v_mul_f32 v84, v84, v41
    v_mfma_f32_16x16x32_bf16 v[36:39], v[68:71], a[184:187], v[36:39]
    v_mul_f32 v85, v85, v41
    v_cvt_pk_bf16_f32 v14, v84, v85
    v_mfma_f32_16x16x32_bf16 v[36:39], v[72:75], a[188:191], v[36:39]
    ds_write_b32 v135, v13 offset:1540
    v_mfma_f32_16x16x32_bf16 v[64:67], a[24:27], v[60:63], 0
    v_mul_f32 v86, v86, v41
    v_mul_f32 v87, v87, v41
    v_mfma_f32_16x16x32_bf16 v[64:67], a[28:31], v[112:115], v[64:67]
    v_cvt_pk_bf16_f32 v15, v86, v87
    v_mul_f32 v28, v28, v41
    v_mfma_f32_16x16x32_bf16 v[64:67], a[32:35], v[100:103], v[64:67]
    v_mul_f32 v29, v29, v41
    v_cvt_pk_bf16_f32 v148, v28, v29
    v_mfma_f32_16x16x32_bf16 v[64:67], a[36:39], v[120:123], v[64:67]
    ds_write_b64 v135, v[14:15] offset:1544
    v_mfma_f32_16x16x32_bf16 v[64:67], a[40:43], v[68:71], v[64:67]
    s_sub_u32 s50, s45, s44
    v_mul_f32 v30, v30, v41
    v_mul_f32 v31, v31, v41
    v_mfma_f32_16x16x32_bf16 v[64:67], a[44:47], v[72:75], v[64:67]
    s_sub_u32 s51, s46, s47
    v_cvt_pk_bf16_f32 v149, v30, v31
    v_cvt_pk_f16_f32 v14, v52, v53
    v_mfma_f32_16x16x32_bf16 v[32:35], a[48:51], v[60:63], 0
    s_mov_b32 s60, s59
    v_cvt_pk_f16_f32 v15, v54, v55
    v_cvt_pk_bf16_f32 v18, v36, v37
    v_mfma_f32_16x16x32_bf16 v[32:35], a[52:55], v[112:115], v[32:35]
    s_mov_b32 s59, s58
    ds_write_b32 v134, v148 offset:1536
    v_mfma_f32_16x16x32_bf16 v[32:35], a[56:59], v[100:103], v[32:35]
    s_mov_b32 s58, s57
    v_cvt_pk_bf16_f32 v19, v38, v39
    v_mul_f32 v108, v108, v42
    v_mfma_f32_16x16x32_bf16 v[32:35], a[60:63], v[120:123], v[32:35]
    s_mov_b32 s57, s56
    v_mul_f32 v109, v109, v42
    v_cvt_pk_bf16_f32 v84, v108, v109
    v_mfma_f32_16x16x32_bf16 v[32:35], a[64:67], v[68:71], v[32:35]
    s_mov_b32 s7, s6
    ds_read_b128 v[52:55], v137 offset:3200
    v_mul_f32 v110, v110, v42
    v_mfma_f32_16x16x32_bf16 v[32:35], a[68:71], v[72:75], v[32:35]
    s_mov_b32 s6, s5
    v_mul_f32 v111, v111, v42
    v_cvt_pk_bf16_f32 v85, v110, v111
    v_mfma_f32_16x16x32_bf16 v[28:31], a[72:75], v[60:63], 0
    s_mov_b32 s5, s4
    ds_read_b128 v[36:39], v137 offset:3328
    v_mul_f32 v140, v140, v42
    v_mfma_f32_16x16x32_bf16 v[28:31], a[76:79], v[112:115], v[28:31]
    s_sub_u32 s14, s6, s7
    v_cvt_pk_f16_f32 v146, v32, v33
    v_cvt_pk_f16_f32 v147, v34, v35
    v_mfma_f32_16x16x32_bf16 v[28:31], a[80:83], v[100:103], v[28:31]
    s_add_u32 s61, s61, 1
    v_mul_f32 v141, v141, v42
    v_cvt_pk_bf16_f32 v86, v140, v141
    v_mfma_f32_16x16x32_bf16 v[28:31], a[84:87], v[120:123], v[28:31]
    s_add_u32 s12, s12, 20
    ds_read_b128 v[32:35], v136 offset:3328
    v_mul_f32 v142, v142, v42
    v_mfma_f32_16x16x32_bf16 v[28:31], a[88:91], v[68:71], v[28:31]
    s_max_u32 s12, s12, s61
    ds_read_b128 v[44:47], v136 offset:3200
    v_mul_f32 v143, v143, v42
    v_mfma_f32_16x16x32_bf16 v[28:31], a[92:95], v[72:75], v[28:31]
    s_cmp_lt_u32 s61, s71
    v_cvt_pk_bf16_f32 v87, v142, v143
    v_mul_f32 v88, v88, v42
    v_mfma_f32_16x16x32_bf16 v[140:143], a[120:123], v[60:63], 0
    s_cselect_b32 s15, s61, s12
    ds_read_b128 v[56:59], v136 offset:3072
    v_mul_f32 v89, v89, v42
    v_mfma_f32_16x16x32_bf16 v[140:143], a[124:127], v[112:115], v[140:143]
    s_cselect_b32 s56, s69, s70
    v_cvt_pk_f16_f32 v12, v28, v29
    v_cvt_pk_f16_f32 v13, v30, v31
    v_mfma_f32_16x16x32_bf16 v[140:143], a[128:131], v[100:103], v[140:143]
    s_add_u32 s56, s56, s15
    v_pk_fma_f16 v51, v12, v12, s3
    v_pk_fmac_f16 v51, v13, v13
    v_mfma_f32_16x16x32_bf16 v[140:143], a[132:135], v[120:123], v[140:143]
    s_mul_i32 s53, s56, 58255
    v_pk_fmac_f16 v51, v14, v14
    v_pk_fmac_f16 v51, v15, v15
    v_mfma_f32_16x16x32_bf16 v[140:143], a[136:139], v[68:71], v[140:143]
    s_lshr_b32 s53, s53, 22
    ds_write_b32 v134, v149 offset:1540
    v_mfma_f32_16x16x32_bf16 v[140:143], a[140:143], v[72:75], v[140:143]
    s_mul_i32 s53, s53, s63
    v_cvt_pk_bf16_f32 v88, v88, v89
    v_mul_f32 v90, v90, v42
    v_mfma_f32_16x16x32_bf16 v[80:83], a[0:3], v[60:63], 0
    s_mul_i32 s56, s56, s62
    v_mul_f32 v91, v91, v42
    v_cvt_pk_bf16_f32 v89, v90, v91
    v_mfma_f32_16x16x32_bf16 v[80:83], a[4:7], v[112:115], v[80:83]
    s_add_u32 s56, s56, s53
    v_cvt_pk_f16_f32 v148, v140, v141
    v_cvt_pk_f16_f32 v149, v142, v143
    v_mfma_f32_16x16x32_bf16 v[80:83], a[8:11], v[100:103], v[80:83]
    s_mul_i32 s4, s15, 112
    ds_write_b64 v135, v[84:85] offset:3072
    v_mfma_f32_16x16x32_bf16 v[80:83], a[12:15], v[120:123], v[80:83]
    s_cmp_ge_u32 s15, 16
    v_pk_fmac_f16 v51, v148, v148
    v_pk_fmac_f16 v51, v149, v149
    v_mfma_f32_16x16x32_bf16 v[80:83], a[16:19], v[68:71], v[80:83]
    s_cselect_b32 s53, -30464, 0
    v_cvt_pk_f16_f32 v30, v64, v65
    v_cvt_pk_f16_f32 v31, v66, v67
    v_mfma_f32_16x16x32_bf16 v[80:83], a[20:23], v[72:75], v[80:83]
    s_add_u32 s4, s4, s53
    v_mul_f32 v76, v76, v40
    v_mul_f32 v77, v77, v40
    v_mfma_f32_16x16x32_bf16 v[140:143], v[60:63], a[144:147], 0
    s_cmp_lt_u32 s15, s73
    ds_write_b32 v135, v86 offset:3080
    v_mfma_f32_16x16x32_bf16 v[140:143], v[112:115], a[148:151], v[140:143]
    s_cselect_b32 s26, 100270464, 0
    v_cvt_pk_f16_f32 v28, v80, v81
    v_cvt_pk_f16_f32 v29, v82, v83
    v_mfma_f32_16x16x32_bf16 v[140:143], v[100:103], a[152:155], v[140:143]
    s_cselect_b32 s56, s56, 0
    v_pk_fma_f16 v50, v28, v28, s3
    v_pk_fmac_f16 v50, v29, v29
    v_mfma_f32_16x16x32_bf16 v[140:143], v[120:123], a[156:159], v[140:143]
    s_cselect_b32 s4, s4, -1
    ds_read_b128 v[64:67], v137 offset:3072
    v_pk_fmac_f16 v50, v30, v30
    v_mfma_f32_16x16x32_bf16 v[140:143], v[68:71], a[160:163], v[140:143]
    s_cselect_b32 s15, s15, 0
    v_pk_fmac_f16 v50, v31, v31
    v_pk_fmac_f16 v50, v146, v146
    v_mfma_f32_16x16x32_bf16 v[140:143], v[72:75], a[164:167], v[140:143]
    s_cselect_b32 s13, s13, -1
    v_pk_fmac_f16 v50, v147, v147
    v_cvt_pk_bf16_f32 v84, v76, v77
    v_mfma_f32_16x16x32_bf16 v[80:83], v[60:63], a[192:195], 0
    s_bitset1_b32 s64, s15
    v_mul_f32 v78, v78, v40
    v_mul_f32 v79, v79, v40
    v_mfma_f32_16x16x32_bf16 v[80:83], v[112:115], a[196:199], v[80:83]
    s_add_u32 s65, s65, 1
    ds_write_b32 v135, v87 offset:3084
    v_mfma_f32_16x16x32_bf16 v[80:83], v[100:103], a[200:203], v[80:83]
    s_cmp_ge_i32 s65, 2
    v_cvt_pk_bf16_f32 v2, v140, v141
    v_cvt_pk_bf16_f32 v3, v142, v143
    v_mfma_f32_16x16x32_bf16 v[80:83], v[120:123], a[204:207], v[80:83]
    s_cselect_b32 s30, 100270464, 0
    v_cvt_pk_bf16_f32 v85, v78, v79
    v_mul_f32 v104, v104, v40
    v_mfma_f32_16x16x32_bf16 v[80:83], v[68:71], a[208:211], v[80:83]
    s_add_u32 s67, s46, s54
    v_mul_f32 v105, v105, v40
    v_cvt_pk_bf16_f32 v86, v104, v105
    v_mfma_f32_16x16x32_bf16 v[80:83], v[72:75], a[212:215], v[80:83]
    s_add_u32 m0, s67, 0
    ds_write_b32 v134, v88 offset:3072
    v_mfma_f32_16x16x32_f16 v[68:71], v[212:215], v[48:51], 0
    s_waitcnt lgkmcnt(2)
    v_mul_f32 v106, v106, v40
    v_mul_f32 v107, v107, v40
    v_mfma_f32_16x16x32_bf16 v[76:79], v[64:67], a[168:171], 0
    s_nop 0
    v_cvt_pk_bf16_f32 v6, v80, v81
    v_cvt_pk_bf16_f32 v7, v82, v83
    v_mfma_f32_16x16x32_bf16 v[76:79], v[56:59], a[172:175], v[76:79]
    v_or3_b32 v125, v125, v68, v69
    v_or3_b32 v125, v125, v70, v71
    v_mfma_f32_16x16x32_bf16 v[76:79], v[52:55], a[176:179], v[76:79]
    ds_write_b32 v134, v89 offset:3076
    v_mfma_f32_16x16x32_bf16 v[76:79], v[44:47], a[180:183], v[76:79]
    v_rsq_f32 v68, v68
    v_mfma_f32_16x16x32_bf16 v[76:79], v[36:39], a[184:187], v[76:79]
    v_rsq_f32 v69, v69
    v_mfma_f32_16x16x32_bf16 v[76:79], v[32:35], a[188:191], v[76:79]
    v_mul_f32 v68, s52, v68
    v_cvt_pk_f16_f32 v68, v68, v69
    v_mfma_f32_16x16x32_bf16 v[140:143], a[72:75], v[64:67], 0
    ds_write_b32 v135, v85 offset:4
    v_mfma_f32_16x16x32_bf16 v[140:143], a[76:79], v[56:59], v[140:143]
    v_rsq_f32 v70, v70
    v_mfma_f32_16x16x32_bf16 v[140:143], a[80:83], v[52:55], v[140:143]
    v_rsq_f32 v71, v71
    v_mfma_f32_16x16x32_bf16 v[140:143], a[84:87], v[44:47], v[140:143]
    v_mul_f32 v70, s52, v70
    v_cvt_pk_f16_f32 v70, v70, v71
    v_mfma_f32_16x16x32_bf16 v[140:143], a[88:91], v[36:39], v[140:143]
    v_pk_mul_f16 v12, v12, v70 op_sel:[0,1] op_sel_hi:[1,1]
    v_pk_mul_f16 v13, v13, v70 op_sel:[0,1] op_sel_hi:[1,1]
    v_mfma_f32_16x16x32_bf16 v[140:143], a[92:95], v[32:35], v[140:143]
    v_pk_mul_f16 v14, v14, v70 op_sel:[0,1] op_sel_hi:[1,1]
    v_pk_mul_f16 v15, v15, v70 op_sel:[0,1] op_sel_hi:[1,1]
    v_mfma_f32_16x16x32_bf16 v[72:75], a[120:123], v[64:67], 0
    s_nop 0
    v_pk_mul_f16 v148, v148, v70 op_sel:[0,1] op_sel_hi:[1,1]
    v_pk_mul_f16 v149, v149, v70 op_sel:[0,1] op_sel_hi:[1,1]
    v_mfma_f32_16x16x32_bf16 v[72:75], a[124:127], v[56:59], v[72:75]
    s_nop 0
    v_cvt_pk_f16_f32 v60, v140, v141
    v_cvt_pk_f16_f32 v61, v142, v143
    v_mfma_f32_16x16x32_bf16 v[72:75], a[128:131], v[52:55], v[72:75]
    v_pk_mul_f16 v8, v8, v68 op_sel:[0,1] op_sel_hi:[1,1]
    v_pk_mul_f16 v9, v9, v68 op_sel:[0,1] op_sel_hi:[1,1]
    v_mfma_f32_16x16x32_bf16 v[72:75], a[132:135], v[44:47], v[72:75]
    v_pk_mul_f16 v10, v10, v68 op_sel:[0,1] op_sel_hi:[1,1]
    v_pk_mul_f16 v11, v11, v68 op_sel:[0,1] op_sel_hi:[1,1]
    v_mfma_f32_16x16x32_bf16 v[72:75], a[136:139], v[36:39], v[72:75]
    v_pk_mul_f16 v154, v154, v68 op_sel:[0,1] op_sel_hi:[1,1]
    v_pk_mul_f16 v155, v155, v68 op_sel:[0,1] op_sel_hi:[1,1]
    v_mfma_f32_16x16x32_bf16 v[72:75], a[140:143], v[32:35], v[72:75]
    v_pk_mul_f16 v24, v24, v68 op_sel:[0,0] op_sel_hi:[1,0]
    v_pk_mul_f16 v25, v25, v68 op_sel:[0,0] op_sel_hi:[1,0]
    v_mfma_f32_16x16x32_bf16 v[100:103], v[64:67], a[144:147], 0
    v_pk_mul_f16 v26, v26, v68 op_sel:[0,0] op_sel_hi:[1,0]
    v_pk_mul_f16 v27, v27, v68 op_sel:[0,0] op_sel_hi:[1,0]
    v_mfma_f32_16x16x32_bf16 v[100:103], v[56:59], a[148:151], v[100:103]
    v_pk_mul_f16 v152, v152, v68 op_sel:[0,0] op_sel_hi:[1,0]
    v_pk_mul_f16 v153, v153, v68 op_sel:[0,0] op_sel_hi:[1,0]
    v_mfma_f32_16x16x32_bf16 v[100:103], v[52:55], a[152:155], v[100:103]
    ds_write_b32 v135, v84 offset:0
    v_mfma_f32_16x16x32_bf16 v[100:103], v[44:47], a[156:159], v[100:103]
    v_pk_fma_f16 v49, v60, v60, s3
    v_pk_fmac_f16 v49, v61, v61
    v_mfma_f32_16x16x32_bf16 v[100:103], v[36:39], a[160:163], v[100:103]
    v_cvt_pk_bf16_f32 v87, v106, v107
    v_mul_f32 v116, v116, v40
    v_mfma_f32_16x16x32_bf16 v[100:103], v[32:35], a[164:167], v[100:103]
    v_mul_f32 v117, v117, v40
    v_cvt_pk_bf16_f32 v84, v116, v117
    v_mfma_f32_16x16x32_bf16 v[80:83], a[48:51], v[64:67], 0
    ds_write_b64 v135, v[86:87] offset:8
    v_mfma_f32_16x16x32_bf16 v[80:83], a[52:55], v[56:59], v[80:83]
    v_mul_f32 v118, v118, v40
    v_mul_f32 v119, v119, v40
    v_mfma_f32_16x16x32_bf16 v[80:83], a[56:59], v[52:55], v[80:83]
    v_cvt_pk_bf16_f32 v85, v118, v119
    v_cvt_pk_f16_f32 v142, v72, v73
    v_mfma_f32_16x16x32_bf16 v[80:83], a[60:63], v[44:47], v[80:83]
    v_cvt_pk_f16_f32 v143, v74, v75
    v_pk_mul_f16 v28, v28, v70 op_sel:[0,0] op_sel_hi:[1,0]
    v_mfma_f32_16x16x32_bf16 v[80:83], a[64:67], v[36:39], v[80:83]
    ds_write_b64 v134, v[84:85] offset:0
    v_mfma_f32_16x16x32_bf16 v[80:83], a[68:71], v[32:35], v[80:83]
    s_waitcnt vmcnt(0)
    v_pk_mul_f16 v29, v29, v70 op_sel:[0,0] op_sel_hi:[1,0]
    v_pk_mul_f16 v30, v30, v70 op_sel:[0,0] op_sel_hi:[1,0]
    v_mfma_f32_16x16x32_bf16 v[40:43], a[0:3], v[64:67], 0
    v_pk_mul_f16 v31, v31, v70 op_sel:[0,0] op_sel_hi:[1,0]
    v_pk_mul_f16 v146, v146, v70 op_sel:[0,0] op_sel_hi:[1,0]
    v_mfma_f32_16x16x32_bf16 v[40:43], a[4:7], v[56:59], v[40:43]
    v_pk_mul_f16 v147, v147, v70 op_sel:[0,0] op_sel_hi:[1,0]
    v_add_u32 v137, s50, v137
    v_mfma_f32_16x16x32_bf16 v[40:43], a[8:11], v[52:55], v[40:43]
    v_add_u32 v136, s50, v136
    v_add_u32 v135, s48, v135
    v_mfma_f32_16x16x32_bf16 v[40:43], a[12:15], v[44:47], v[40:43]
    v_add_u32 v134, s48, v134
    v_add_u32 v133, s51, v133
    v_mfma_f32_16x16x32_bf16 v[40:43], a[16:19], v[36:39], v[40:43]
    v_add_u32 v132, s14, v132
    v_add_u32 v131, s14, v131
    v_mfma_f32_16x16x32_bf16 v[40:43], a[20:23], v[32:35], v[40:43]
    ds_read_b128 v[68:71], v132 offset:0
    v_cvt_pk_bf16_f32 v164, v100, v101
    v_mfma_f32_16x16x32_bf16 v[96:99], a[24:27], v[64:67], 0
    s_waitcnt lgkmcnt(1)
    ds_read_b128 v[72:75], v132 offset:16
    v_cvt_pk_bf16_f32 v165, v102, v103
    v_mfma_f32_16x16x32_bf16 v[96:99], a[28:31], v[56:59], v[96:99]
    s_barrier
    ds_read_b128 v[104:107], v133 offset:0
    v_cvt_pk_f16_f32 v40, v40, v41
    v_mfma_f32_16x16x32_bf16 v[96:99], a[32:35], v[52:55], v[96:99]
    s_cmp_ge_u32 s61, s13
    ds_read_u16 v162, v131 offset:96
    v_cvt_pk_f16_f32 v41, v42, v43
    v_mfma_f32_16x16x32_bf16 v[96:99], a[36:39], v[44:47], v[96:99]
L_pga:
    s_cbranch_scc1 L_atomF0
L_atomF0r:
    v_mfma_f32_16x16x32_bf16 v[96:99], a[40:43], v[36:39], v[96:99]
    ds_read_u16 v158, v131 offset:104
    v_pk_fma_f16 v48, v40, v40, s3
    v_mfma_f32_16x16x32_bf16 v[96:99], a[44:47], v[32:35], v[96:99]
    ds_read_b128 v[84:87], v137 offset:0
    v_pk_fmac_f16 v48, v41, v41
    v_mfma_f32_16x16x32_f16 v[100:103], v[8:11], v[24:27], v[204:207]
    v_cvt_pk_f16_f32 v140, v80, v81
    v_cvt_pk_f16_f32 v141, v82, v83
    v_mfma_f32_16x16x32_f16 v[100:103], v[152:155], v[150:153], v[100:103]
    s_nop 0
    ds_read_u16 v166, v131 offset:80
    v_cvt_pk_f16_f32 v42, v96, v97
    v_mfma_f32_16x16x32_bf16 v[116:119], a[96:99], v[64:67], 0
    v_cvt_pk_f16_f32 v43, v98, v99
    v_pk_fmac_f16 v48, v42, v42
    v_mfma_f32_16x16x32_bf16 v[116:119], a[100:103], v[56:59], v[116:119]
    ds_read_b128 v[80:83], v132 offset:48
    v_pk_fmac_f16 v48, v43, v43
    v_mfma_f32_16x16x32_bf16 v[116:119], a[104:107], v[52:55], v[116:119]
    s_waitcnt lgkmcnt(5)
    ds_read_b128 v[96:99], v133 offset:2048
    buffer_load_dwordx4 v130, s[24:27], s56 offen nt lds
    v_mfma_f32_16x16x32_bf16 v[116:119], a[108:111], v[44:47], v[116:119]
    ds_read_b128 v[108:111], v133 offset:1024
    v_pk_fmac_f16 v48, v140, v140
    v_mfma_f32_16x16x32_bf16 v[116:119], a[112:115], v[36:39], v[116:119]
    ds_read_b128 v[88:91], v136 offset:128
    v_pk_fmac_f16 v48, v141, v141
    v_mfma_f32_16x16x32_bf16 v[116:119], a[116:119], v[32:35], v[116:119]
    ds_read_b128 v[92:95], v137 offset:256
    v_cvt_pk_bf16_f32 v16, v20, v21
    v_mfma_f32_16x16x32_bf16 v[112:115], v[64:67], a[192:195], 0
    ds_read_b128 v[64:67], v136 offset:0
    v_cvt_pk_bf16_f32 v17, v22, v23
    v_mfma_f32_16x16x32_bf16 v[112:115], v[56:59], a[196:199], v[112:115]
    s_nop 0
    ds_read_b128 v[20:23], v137 offset:128
    v_cvt_pk_f16_f32 v62, v116, v117
    v_mfma_f32_16x16x32_bf16 v[112:115], v[52:55], a[200:203], v[112:115]
    v_cvt_pk_f16_f32 v63, v118, v119
    v_pk_fmac_f16 v49, v62, v62
    v_mfma_f32_16x16x32_bf16 v[112:115], v[44:47], a[204:207], v[112:115]
    v_pk_fmac_f16 v49, v63, v63
    v_pk_fmac_f16 v49, v142, v142
    v_mfma_f32_16x16x32_bf16 v[112:115], v[36:39], a[208:211], v[112:115]
    v_pk_fmac_f16 v49, v143, v143
    v_cvt_pk_bf16_f32 v160, v76, v77
    v_mfma_f32_16x16x32_bf16 v[112:115], v[32:35], a[212:215], v[112:115]
    s_add_u32 m0, s67, 1024
    ds_read_b128 v[52:55], v136 offset:256
    v_cvt_pk_bf16_f32 v161, v78, v79
    v_mfma_f32_16x16x32_f16 v[36:39], v[212:215], v[48:51], 0
    s_waitcnt lgkmcnt(5)
    buffer_store_dwordx4 v[104:107], v130, s[28:31], s60 offen sc1
    buffer_load_dwordx4 v129, s[24:27], s56 offen nt lds
    v_exp_f32 v100, v100
    v_cvt_pk_bf16_f32 v156, v112, v113
    v_mfma_f32_16x16x32_f16 v[48:51], v[12:15], v[24:27], v[200:203]
    ds_read_b128 v[32:35], v133 offset:4096
    v_cvt_pk_bf16_f32 v157, v114, v115
    v_mfma_f32_16x16x32_f16 v[48:51], v[146:149], v[150:153], v[48:51]
    v_exp_f32 v101, v101
    v_mfma_f32_16x16x32_bf16 v[76:79], a[216:219], v[84:87], 0
    s_waitcnt lgkmcnt(2)
    v_or3_b32 v125, v125, v36, v37
    v_cvt_pk_bf16_f32 v46, v100, v101
    v_mfma_f32_16x16x32_bf16 v[76:79], a[220:223], v[64:67], v[76:79]
    v_rsq_f32 v36, v36
    v_mfma_f32_16x16x32_bf16 v[76:79], a[224:227], v[20:23], v[76:79]
    v_rsq_f32 v37, v37
    v_mfma_f32_16x16x32_bf16 v[76:79], a[228:231], v[88:91], v[76:79]
    ds_read_b128 v[56:59], v133 offset:3072
    v_mul_f32 v36, s52, v36
    v_mfma_f32_16x16x32_bf16 v[76:79], a[232:235], v[92:95], v[76:79]
    s_waitcnt lgkmcnt(2)
    v_exp_f32 v102, v102
    v_mfma_f32_16x16x32_bf16 v[76:79], a[236:239], v[52:55], v[76:79]
    s_add_u32 m0, s67, 2048
    buffer_store_dwordx4 v[108:111], v129, s[28:31], s60 offen sc1
    v_cvt_pk_f16_f32 v36, v36, v37
    v_pk_mul_f16 v40, v40, v36 op_sel:[0,0] op_sel_hi:[1,0]
    v_pk_mul_f16 v41, v41, v36 op_sel:[0,0] op_sel_hi:[1,0]
    v_pk_mul_f16 v42, v42, v36 op_sel:[0,0] op_sel_hi:[1,0]
    v_mfma_f32_16x16x32_bf16 v[104:107], a[240:243], v[84:87], 0
    v_pk_mul_f16 v43, v43, v36 op_sel:[0,0] op_sel_hi:[1,0]
    v_pk_mul_f16 v140, v140, v36 op_sel:[0,0] op_sel_hi:[1,0]
    v_mfma_f32_16x16x32_bf16 v[104:107], a[244:247], v[64:67], v[104:107]
    v_pk_mul_f16 v141, v141, v36 op_sel:[0,0] op_sel_hi:[1,0]
    v_pk_mul_f16 v60, v60, v36 op_sel:[0,1] op_sel_hi:[1,1]
    v_mfma_f32_16x16x32_bf16 v[104:107], a[248:251], v[20:23], v[104:107]
    v_exp_f32 v103, v103
    v_mfma_f32_16x16x32_bf16 v[104:107], a[252:255], v[88:91], v[104:107]
    buffer_load_dwordx4 v128, s[24:27], s56 offen nt lds
    v_cvt_pk_bf16_f32 v47, v102, v103
    v_mfma_f32_16x16x32_bf16 v[104:107], v[224:227], v[92:95], v[104:107]
    v_pk_mul_f16 v61, v61, v36 op_sel:[0,1] op_sel_hi:[1,1]
    v_pk_mul_f16 v62, v62, v36 op_sel:[0,1] op_sel_hi:[1,1]
    v_mfma_f32_16x16x32_bf16 v[104:107], v[228:231], v[52:55], v[104:107]
    v_pk_mul_f16 v63, v63, v36 op_sel:[0,1] op_sel_hi:[1,1]
    v_pk_mul_f16 v142, v142, v36 op_sel:[0,1] op_sel_hi:[1,1]
    v_mfma_f32_16x16x32_f16 v[100:103], v[68:71], v[24:27], v[208:211]
    s_add_u32 m0, s67, 3072
    v_exp_f32 v48, v48
    v_mfma_f32_16x16x32_f16 v[100:103], v[72:75], v[8:11], v[100:103]
    buffer_store_dwordx4 v[96:99], v128, s[28:31], s60 offen sc1
    v_pk_mul_f16 v143, v143, v36 op_sel:[0,1] op_sel_hi:[1,1]
    v_exp_f32 v49, v49
    v_mfma_f32_16x16x32_f16 v[100:103], v[80:83], v[152:155], v[100:103]
    v_exp_f32 v50, v50
    v_mfma_f32_16x16x32_f16 v[36:39], v[68:71], v[28:31], v[208:211]
    v_exp_f32 v51, v51
    v_mfma_f32_16x16x32_f16 v[36:39], v[72:75], v[12:15], v[36:39]
    v_cvt_pk_bf16_f32 v48, v48, v49
    v_cvt_pk_bf16_f32 v49, v50, v51
    v_mfma_f32_16x16x32_f16 v[36:39], v[80:83], v[146:149], v[36:39]
    s_waitcnt lgkmcnt(0)
    buffer_load_dwordx4 v127, s[24:27], s56 offen nt lds
    v_mfma_f32_16x16x32_f16 v[116:119], v[8:11], v[28:31], v[192:195]
    s_nop 0
    v_exp_f32 v100, v100
    v_mfma_f32_16x16x32_f16 v[116:119], v[152:155], v[144:147], v[116:119]
    s_nop 0
    v_cvt_pk_bf16_f32 v170, v100, 0
    v_mov_b32_dpp v103, v39 quad_perm:[0,1,2,3] row_mask:0x2 bank_mask:0xf
    v_mfma_f32_16x16x32_f16 v[96:99], v[60:63], v[28:31], v[184:187]
    s_add_u32 m0, s67, 4096
    v_exp_f32 v37, v37
    v_mfma_f32_16x16x32_f16 v[96:99], v[140:143], v[144:147], v[96:99]
    buffer_store_dwordx4 v[56:59], v127, s[28:31], s60 offen sc1
    buffer_load_dwordx4 v126, s[24:27], s56 offen nt lds
    v_exp_f32 v116, v116
    v_mfma_f32_16x16x32_f16 v[56:59], v[60:63], v[24:27], v[196:199]
    v_exp_f32 v117, v117
    v_mfma_f32_16x16x32_f16 v[56:59], v[140:143], v[150:153], v[56:59]
    v_exp_f32 v118, v118
    v_mfma_f32_16x16x32_f16 v[24:27], v[60:63], v[40:43], v[172:175]
    v_exp_f32 v119, v119
    v_mfma_f32_16x16x32_f16 v[24:27], v[140:143], v[138:141], v[24:27]
    s_nop 0
    buffer_store_dwordx4 v[32:35], v126, s[28:31], s60 offen sc1
    v_cvt_pk_bf16_f32 v44, v116, v117
    v_cvt_pk_bf16_f32 v45, v118, v119
    v_exp_f32 v56, v56
    v_mfma_f32_16x16x32_bf16 v[116:119], v[232:235], v[84:87], 0
    s_mov_b32 s53, s47
    v_exp_f32 v57, v57
    v_mfma_f32_16x16x32_bf16 v[116:119], v[236:239], v[64:67], v[116:119]
    s_mov_b32 s47, s46
    v_exp_f32 v58, v58
    v_mfma_f32_16x16x32_bf16 v[116:119], v[240:243], v[20:23], v[116:119]
    s_mov_b32 s46, s45
    ds_read_b128 v[20:23], v136 offset:1664
    v_cvt_pk_bf16_f32 v168, v56, v57
    v_mfma_f32_16x16x32_bf16 v[116:119], v[244:247], v[88:91], v[116:119]
    s_mov_b32 s45, s44
    v_exp_f32 v59, v59
    v_mfma_f32_16x16x32_bf16 v[116:119], v[248:251], v[92:95], v[116:119]
    s_mov_b32 s44, s53
    v_exp_f32 v96, v96
    v_mfma_f32_16x16x32_bf16 v[116:119], v[252:255], v[52:55], v[116:119]
    s_sub_u32 s48, s44, s46
    ds_read_b128 v[32:35], v136 offset:1792
    v_cvt_pk_bf16_f32 v169, v58, v59
    v_mfma_f32_16x16x32_f16 v[52:55], v[68:71], v[40:43], v[208:211]
    s_sub_u32 s49, s46, s45
    v_exp_f32 v97, v97
    v_mfma_f32_16x16x32_f16 v[52:55], v[72:75], v[60:63], v[52:55]
    s_cmp_lg_u32 s5, -1
    ds_read_b128 v[56:59], v136 offset:1536
    v_fma_f32 v51, v76, v76, s42
    v_mfma_f32_16x16x32_f16 v[52:55], v[80:83], v[140:143], v[52:55]
    ds_read_b128 v[68:71], v137 offset:1664
    v_fmac_f32 v51, v77, v77
    v_mfma_f32_16x16x32_bf16 v[64:67], v[220:223], v[46:49], 0
    ds_read_b128 v[72:75], v137 offset:1536
    v_fmac_f32 v51, v78, v78
    v_mfma_f32_16x16x32_bf16 v[64:67], v[220:223], v[168:171], v[64:67]
    v_exp_f32 v98, v98
    v_mfma_f32_16x16x32_bf16 v[84:87], v[0:3], v[46:49], 0
    ds_read_b128 v[80:83], v137 offset:1792
    v_mov_b32_dpp v103, v55 quad_perm:[0,1,2,3] row_mask:0x4 bank_mask:0xf
    v_mfma_f32_16x16x32_bf16 v[84:87], v[164:167], v[168:171], v[84:87]
    v_exp_f32 v99, v99
    v_mfma_f32_16x16x32_bf16 v[108:111], v[16:19], v[46:49], 0
    v_exp_f32 v103, v103
    v_mfma_f32_16x16x32_bf16 v[108:111], v[160:163], v[168:171], v[108:111]
    v_cvt_pk_bf16_f32 v103, v103, v103
    v_fmac_f32 v51, v79, v79
    v_mfma_f32_16x16x32_bf16 v[88:91], v[4:7], v[46:49], 0
    ds_write_b16 v131, v103 offset:64
    v_mfma_f32_16x16x32_bf16 v[88:91], v[156:159], v[168:171], v[88:91]
    v_rcp_f32 v65, v64
    v_mfma_f32_16x16x32_f16 v[100:103], v[8:11], v[40:43], v[180:183]
    v_max3_u32 v124, v124, v64, v65
    v_mul_f32 v84, v84, v65
    v_mfma_f32_16x16x32_f16 v[100:103], v[152:155], v[138:141], v[100:103]
    s_waitcnt lgkmcnt(2)
    ds_read_b128 v[46:49], v132 offset:48
    v_mul_f32 v85, v85, v65
    v_mfma_f32_16x16x32_bf16 v[92:95], a[216:219], v[72:75], 0
    ds_read_b128 v[152:155], v132 offset:64
    v_cvt_pk_bf16_f32 v8, v84, v85
    v_mfma_f32_16x16x32_bf16 v[92:95], a[220:223], v[56:59], v[92:95]
    v_mul_f32 v86, v86, v65
    v_mul_f32 v87, v87, v65
    v_mfma_f32_16x16x32_bf16 v[92:95], a[224:227], v[68:71], v[92:95]
    v_cvt_pk_bf16_f32 v9, v86, v87
    v_mul_f32 v108, v108, v65
    v_mfma_f32_16x16x32_bf16 v[92:95], a[228:231], v[20:23], v[92:95]
    s_waitcnt lgkmcnt(3)
    v_mul_f32 v109, v109, v65
    v_cvt_pk_bf16_f32 v10, v108, v109
    v_mfma_f32_16x16x32_bf16 v[92:95], a[232:235], v[80:83], v[92:95]
    ds_write_b32 v135, v8 offset:0
    v_mfma_f32_16x16x32_bf16 v[92:95], a[236:239], v[32:35], v[92:95]
    v_mul_f32 v110, v110, v65
    v_mul_f32 v111, v111, v65
    v_mfma_f32_16x16x32_bf16 v[84:87], a[240:243], v[72:75], 0
    v_cvt_pk_bf16_f32 v11, v110, v111
    v_mul_f32 v88, v88, v65
    v_mfma_f32_16x16x32_bf16 v[84:87], a[244:247], v[56:59], v[84:87]
    v_mul_f32 v89, v89, v65
    v_cvt_pk_bf16_f32 v8, v88, v89
    v_mfma_f32_16x16x32_bf16 v[84:87], a[248:251], v[68:71], v[84:87]
    ds_write_b32 v135, v9 offset:4
    v_mfma_f32_16x16x32_bf16 v[84:87], a[252:255], v[20:23], v[84:87]
    v_mul_f32 v90, v90, v65
    v_mul_f32 v91, v91, v65
    v_mfma_f32_16x16x32_bf16 v[84:87], v[224:227], v[80:83], v[84:87]
    v_cvt_pk_bf16_f32 v9, v90, v91
    v_cvt_pk_bf16_f32 v168, v96, v97
    v_mfma_f32_16x16x32_bf16 v[84:87], v[228:231], v[32:35], v[84:87]
    s_waitcnt lgkmcnt(2)
    ds_read_b128 v[64:67], v137 offset:3200
    v_cvt_pk_bf16_f32 v169, v98, v99
    v_mfma_f32_16x16x32_bf16 v[96:99], v[46:49], v[0:3], 0
    v_cvt_pk_bf16_f32 v170, v37, 0
    v_fmac_f32 v51, v104, v104
    v_mfma_f32_16x16x32_bf16 v[96:99], v[152:155], v[164:167], v[96:99]
    v_exp_f32 v24, v24
    v_mfma_f32_16x16x32_bf16 v[36:39], v[46:49], v[16:19], 0
    v_exp_f32 v25, v25
    v_mfma_f32_16x16x32_bf16 v[36:39], v[152:155], v[160:163], v[36:39]
    ds_write_b64 v135, v[10:11] offset:8
    v_mfma_f32_16x16x32_bf16 v[108:111], v[46:49], v[4:7], 0
    v_exp_f32 v26, v26
    v_mfma_f32_16x16x32_bf16 v[108:111], v[152:155], v[156:159], v[108:111]
    v_exp_f32 v27, v27
    v_mfma_f32_16x16x32_f16 v[46:49], v[12:15], v[28:31], v[188:191]
    s_nop 0
    ds_read_b128 v[152:155], v137 offset:3072
    v_mov_b32_dpp v99, v39 quad_perm:[0,1,2,3] row_mask:0x2 bank_mask:0xf
    v_mfma_f32_16x16x32_f16 v[46:49], v[146:149], v[144:147], v[46:49]
    s_nop 0
    ds_read_b128 v[36:39], v136 offset:3072
    v_mov_b32_dpp v99, v111 quad_perm:[0,1,2,3] row_mask:0x4 bank_mask:0xf
    v_mfma_f32_16x16x32_bf16 v[28:31], v[232:235], v[72:75], 0
    ds_read_b128 v[72:75], v136 offset:3200
    v_cvt_pk_bf16_f32 v99, v99, v99
    v_mfma_f32_16x16x32_bf16 v[28:31], v[236:239], v[56:59], v[28:31]
    ds_read_b128 v[56:59], v137 offset:3328
    v_add_u32 v137, s48, v137
    v_mfma_f32_16x16x32_bf16 v[28:31], v[240:243], v[68:71], v[28:31]
    ds_read_b128 v[68:71], v136 offset:3328
    v_add_u32 v136, s48, v136
    v_mfma_f32_16x16x32_bf16 v[28:31], v[244:247], v[20:23], v[28:31]
    v_exp_f32 v46, v46
    v_mfma_f32_16x16x32_bf16 v[28:31], v[248:251], v[80:83], v[28:31]
    v_exp_f32 v47, v47
    v_mfma_f32_16x16x32_bf16 v[28:31], v[252:255], v[32:35], v[28:31]
    v_exp_f32 v48, v48
    v_mfma_f32_16x16x32_f16 v[20:23], v[12:15], v[40:43], v[176:179]
    ds_write_b16 v131, v99
    v_mfma_f32_16x16x32_f16 v[20:23], v[146:149], v[138:141], v[20:23]
    s_waitcnt lgkmcnt(5)
    v_exp_f32 v49, v49
    v_mfma_f32_16x16x32_bf16 v[140:143], a[240:243], v[152:155], 0
    s_waitcnt lgkmcnt(4)
    v_cvt_pk_bf16_f32 v46, v46, v47
    v_cvt_pk_bf16_f32 v47, v48, v49
    v_mfma_f32_16x16x32_bf16 v[140:143], a[244:247], v[36:39], v[140:143]
    v_exp_f32 v54, v54
    v_mfma_f32_16x16x32_bf16 v[140:143], a[248:251], v[64:67], v[140:143]
    s_waitcnt lgkmcnt(2)
    ds_write_b32 v134, v8 offset:0
    v_mfma_f32_16x16x32_bf16 v[140:143], a[252:255], v[72:75], v[140:143]
    v_exp_f32 v20, v20
    v_mfma_f32_16x16x32_bf16 v[140:143], v[224:227], v[56:59], v[140:143]
    s_waitcnt lgkmcnt(2)
    v_exp_f32 v21, v21
    v_mfma_f32_16x16x32_bf16 v[140:143], v[228:231], v[68:71], v[140:143]
    v_exp_f32 v22, v22
    v_mfma_f32_16x16x32_bf16 v[10:13], v[220:223], v[44:47], 0
    ds_write_b32 v134, v9 offset:4
    v_mfma_f32_16x16x32_bf16 v[10:13], v[220:223], v[168:171], v[10:13]
    v_exp_f32 v23, v23
    v_mfma_f32_16x16x32_bf16 v[32:35], v[0:3], v[44:47], 0
    v_cvt_pk_bf16_f32 v48, v20, v21
    v_cvt_pk_bf16_f32 v49, v22, v23
    v_mfma_f32_16x16x32_bf16 v[32:35], v[164:167], v[168:171], v[32:35]
    ds_read_b128 v[146:149], v137 offset:0
    v_fmac_f32 v51, v105, v105
    v_mfma_f32_16x16x32_bf16 v[20:23], v[16:19], v[44:47], 0
    ds_read_b128 v[12:15], v136 offset:0
    v_fmac_f32 v51, v106, v106
    v_mfma_f32_16x16x32_bf16 v[20:23], v[160:163], v[168:171], v[20:23]
    ds_read_b128 v[40:43], v137 offset:256
    v_fmac_f32 v51, v107, v107
    v_mfma_f32_16x16x32_bf16 v[80:83], v[4:7], v[44:47], 0
    v_exp_f32 v100, v100
    v_mfma_f32_16x16x32_bf16 v[80:83], v[156:159], v[168:171], v[80:83]
    ds_read_b128 v[96:99], v136 offset:128
    v_cvt_pk_bf16_f32 v168, v24, v25
    v_mfma_f32_16x16x32_bf16 v[108:111], a[216:219], v[152:155], 0
    v_cvt_pk_bf16_f32 v169, v26, v27
    v_cvt_pk_bf16_f32 v170, v54, 0
    v_mfma_f32_16x16x32_bf16 v[108:111], a[220:223], v[36:39], v[108:111]
    ds_read_b128 v[52:55], v136 offset:256
    v_fmac_f32 v51, v116, v116
    v_mfma_f32_16x16x32_bf16 v[108:111], a[224:227], v[64:67], v[108:111]
    v_exp_f32 v101, v101
    v_mfma_f32_16x16x32_bf16 v[108:111], a[228:231], v[72:75], v[108:111]
    v_exp_f32 v102, v102
    v_mfma_f32_16x16x32_bf16 v[108:111], a[232:235], v[56:59], v[108:111]
    v_exp_f32 v103, v103
    v_mfma_f32_16x16x32_bf16 v[108:111], a[236:239], v[68:71], v[108:111]
    v_cvt_pk_bf16_f32 v46, v100, v101
    v_cvt_pk_bf16_f32 v47, v102, v103
    v_mfma_f32_16x16x32_bf16 v[88:91], v[232:235], v[152:155], 0
    v_rcp_f32 v11, v10
    v_mfma_f32_16x16x32_bf16 v[88:91], v[236:239], v[36:39], v[88:91]
    v_max3_u32 v124, v124, v10, v11
    v_mul_f32 v32, v32, v11
    v_mfma_f32_16x16x32_bf16 v[88:91], v[240:243], v[64:67], v[88:91]
    ds_read_b128 v[36:39], v137 offset:128
    v_mul_f32 v33, v33, v11
    v_mfma_f32_16x16x32_bf16 v[88:91], v[244:247], v[72:75], v[88:91]
    ds_read_b128 v[72:75], v136 offset:1792
    v_cvt_pk_bf16_f32 v24, v32, v33
    v_mfma_f32_16x16x32_bf16 v[88:91], v[248:251], v[56:59], v[88:91]
    v_mul_f32 v34, v34, v11
    v_mul_f32 v35, v35, v11
    v_mfma_f32_16x16x32_bf16 v[88:91], v[252:255], v[68:71], v[88:91]
    ds_read_b128 v[100:103], v137 offset:1664
    v_cvt_pk_bf16_f32 v25, v34, v35
    v_mfma_f32_16x16x32_bf16 v[68:71], v[220:223], v[46:49], 0
    v_mul_f32 v20, v20, v11
    v_mul_f32 v21, v21, v11
    v_mfma_f32_16x16x32_bf16 v[68:71], v[220:223], v[168:171], v[68:71]
    v_cvt_pk_bf16_f32 v26, v20, v21
    v_mul_f32 v22, v22, v11
    v_mfma_f32_16x16x32_bf16 v[152:155], v[0:3], v[46:49], 0
    v_mul_f32 v23, v23, v11
    v_cvt_pk_bf16_f32 v27, v22, v23
    v_mfma_f32_16x16x32_bf16 v[152:155], v[164:167], v[168:171], v[152:155]
    s_nop 0
    ds_write_b32 v135, v24 offset:1536
    v_mfma_f32_16x16x32_bf16 v[20:23], v[16:19], v[46:49], 0
    s_nop 0
    v_rcp_f32 v69, v68
    v_mfma_f32_16x16x32_bf16 v[20:23], v[160:163], v[168:171], v[20:23]
    s_nop 0
    v_max3_u32 v124, v124, v68, v69
    v_mul_f32 v152, v152, v69
    v_mfma_f32_16x16x32_bf16 v[0:3], v[4:7], v[46:49], 0
    ds_read_b128 v[112:115], v136 offset:1536
    v_mul_f32 v153, v153, v69
    v_mfma_f32_16x16x32_bf16 v[0:3], v[156:159], v[168:171], v[0:3]
    s_waitcnt lgkmcnt(3)
    ds_read_b128 v[60:63], v137 offset:1536
    v_cvt_pk_bf16_f32 v152, v152, v153
    v_mfma_f32_16x16x32_bf16 v[46:49], a[0:3], v[146:149], 0
    s_cbranch_scc1 L_loopF0
L_tailF:
    ds_write_b32 v135, v25 offset:1540
    v_mul_f32 v80, v80, v11
    v_mul_f32 v81, v81, v11
    v_cvt_pk_bf16_f32 v24, v80, v81
    v_mul_f32 v82, v82, v11
    v_mul_f32 v83, v83, v11
    v_cvt_pk_bf16_f32 v25, v82, v83
    s_mov_b32 s30, 100270464
    s_mul_i32 s89, s68, 7168
    ds_write_b64 v135, v[26:27] offset:1544
    v_mul_f32 v154, v154, v69
    s_add_u32 s89, s89, 135168
    s_movk_i32 s90, 112
    ds_write_b64 v134, v[24:25] offset:1536
    v_mul_f32 v155, v155, v69
    v_cvt_pk_bf16_f32 v153, v154, v155
    v_mul_f32 v20, v20, v69
    v_mul_f32 v21, v21, v69
    v_cvt_pk_bf16_f32 v154, v20, v21
    v_mul_f32 v22, v22, v69
    v_mul_f32 v23, v23, v69
    v_cvt_pk_bf16_f32 v155, v22, v23
    v_mul_f32 v0, v0, v69
    v_mul_f32 v1, v1, v69
    v_cvt_pk_bf16_f32 v0, v0, v1
    v_mul_f32 v2, v2, v69
    v_mul_f32 v3, v3, v69
    v_cvt_pk_bf16_f32 v1, v2, v3
    s_lshr_b32 s91, s64, 16
    s_lshl_b32 s92, s68, 10
    ds_write_b64 v135, v[152:153] offset:3072
    v_fmac_f32 v51, v117, v117
    s_sub_u32 s84, s45, s44
    s_sub_u32 s85, s46, s45
    ds_write_b64 v135, v[154:155] offset:3080
    v_fmac_f32 v51, v118, v118
    v_fmac_f32 v51, v119, v119
    v_fma_f32 v132, v92, v92, s42
    s_sub_u32 s86, s44, s45
    s_sub_u32 s93, s44, s47
    ds_write_b32 v134, v0 offset:3072
    ds_write_b32 v134, v1 offset:3076
    v_fmac_f32 v132, v93, v93
    v_fmac_f32 v132, v94, v94
    v_fmac_f32 v132, v95, v95
    v_fmac_f32 v132, v84, v84
    v_fmac_f32 v132, v85, v85
    v_fmac_f32 v132, v86, v86
    v_fmac_f32 v132, v87, v87
    v_fmac_f32 v132, v28, v28
    v_fmac_f32 v132, v29, v29
    v_fmac_f32 v132, v30, v30
    v_fmac_f32 v132, v31, v31
    v_fma_f32 v131, v108, v108, s42
    v_fmac_f32 v131, v109, v109
    v_fmac_f32 v131, v110, v110
    v_fmac_f32 v131, v111, v111
    v_fmac_f32 v131, v140, v140
    v_fmac_f32 v131, v141, v141
    v_fmac_f32 v131, v142, v142
    v_fmac_f32 v131, v143, v143
    v_fmac_f32 v131, v88, v88
    v_fmac_f32 v131, v89, v89
    v_fmac_f32 v131, v90, v90
    v_fmac_f32 v131, v91, v91
    v_cvt_pk_bf16_f32 v138, v51, v132
    v_cvt_pk_bf16_f32 v139, v131, v167
    s_sub_u32 s94, s45, s47
    s_sub_u32 s95, s46, s47
    ds_write_b64 v159, v[138:139]
    v_mbcnt_lo_u32_b32 v131, -1, 0
    v_mbcnt_hi_u32_b32 v131, -1, v131
    v_and_b32 v132, 15, v131
    v_lshrrev_b32 v131, 4, v131
    v_mul_u32_u24 v138, 1792, v131
    v_add_u32 v138, s89, v138
    v_mad_u32_u24 v131, v132, s90, v138
    v_lshrrev_b32 v139, v132, s64
    v_and_b32 v139, 1, v139
    v_cmp_eq_u32 vcc, 1, v139
    s_waitcnt lgkmcnt(1)
    v_mad_u32_u24 v60, v132, s90, v138
    v_lshrrev_b32 v132, v132, s91
    v_cndmask_b32 v131, v138, v131, vcc
    v_and_b32 v132, 1, v132
    v_subrev_u32 v60, 28672, v60
    v_cmp_eq_u32 vcc, 1, v132
    ds_read_b128 v[32:35], v131 offset:64
    ds_read_b128 v[24:27], v131 offset:80
    v_cndmask_b32 v60, v138, v60, vcc
    v_add_u32 v132, s92, v163
    s_waitcnt lgkmcnt(2)
    s_barrier
    ds_read_b128 v[4:7], v131
    v_add_u32 v62, s84, v137
    ds_read_b64 v[8:9], v131 offset:16
    ds_read_b128 v[0:3], v132 offset:6144
    v_add_u32 v61, s84, v136
    v_add_u32 v156, s85, v135
    ds_read_b128 v[20:23], v163 offset:0
    v_add_u32 v63, s85, v134
    ds_read_b128 v[12:15], v163 offset:1024
    v_add_u32 v138, s86, v135
    v_add_u32 v132, s86, v134
    v_add_u32 v131, s93, v133
    v_add_u32 v139, s94, v133
    s_waitcnt lgkmcnt(6)
    v_mfma_f32_16x16x32_bf16 v[16:19], v[220:223], v[32:35], 0
    s_waitcnt lgkmcnt(5)
    ds_read_b128 a[24:27], v62 offset:1536
    ds_read_b128 a[28:31], v61 offset:1536
    v_mfma_f32_16x16x32_bf16 v[16:19], v[220:223], v[24:27], v[16:19]
    s_waitcnt lgkmcnt(3)
    ds_read_b128 a[32:35], v62 offset:1664
    v_lshlrev_b32 v158, 16, v4
    v_and_b32 v4, 0xffff0000, v4
    v_lshlrev_b32 v157, 16, v5
    v_and_b32 v5, 0xffff0000, v5
    v_lshlrev_b32 v11, 16, v6
    v_and_b32 v6, 0xffff0000, v6
    v_rcp_f32 v17, v16
    v_lshlrev_b32 v10, 16, v7
    v_mfma_f32_16x16x32_bf16 v[36:39], v[216:219], v[20:23], 0
    s_waitcnt lgkmcnt(3)
    ds_read_b128 a[36:39], v61 offset:1664
    ds_read_b128 a[40:43], v62 offset:1792
    v_mfma_f32_16x16x32_bf16 v[36:39], v[216:219], v[12:15], v[36:39]
    s_waitcnt lgkmcnt(4)
    ds_read_b128 a[44:47], v61 offset:1792
    v_max3_u32 v124, v124, v16, v17
    v_mul_f32 v158, v158, v17
    v_mul_f32 v4, v4, v17
    v_cvt_pk_bf16_f32 v4, v158, v4
    v_mfma_f32_16x16x32_bf16 v[12:15], a[216:219], a[24:27], 0
    s_waitcnt lgkmcnt(4)
    v_mul_f32 v157, v157, v17
    v_mul_f32 v5, v5, v17
    v_mfma_f32_16x16x32_bf16 v[12:15], a[220:223], a[28:31], v[12:15]
    s_waitcnt lgkmcnt(3)
    ds_read_b128 a[0:3], v62 offset:0
    ds_read_b128 a[4:7], v61 offset:0
    v_mfma_f32_16x16x32_bf16 v[12:15], a[224:227], a[32:35], v[12:15]
    s_waitcnt lgkmcnt(4)
    ds_read_b128 a[8:11], v62 offset:128
    v_cvt_pk_bf16_f32 v5, v157, v5
    v_mul_f32 v11, v11, v17
    v_mul_f32 v6, v6, v17
    v_cvt_pk_bf16_f32 v6, v11, v6
    v_and_b32 v7, 0xffff0000, v7
    v_mfma_f32_16x16x32_bf16 v[12:15], a[228:231], a[36:39], v[12:15]
    s_waitcnt lgkmcnt(4)
    ds_read_b128 a[12:15], v61 offset:128
    ds_read_b128 a[16:19], v62 offset:256
    v_mfma_f32_16x16x32_bf16 v[12:15], a[232:235], a[40:43], v[12:15]
    s_waitcnt lgkmcnt(5)
    ds_read_b128 a[20:23], v61 offset:256
    v_mul_f32 v10, v10, v17
    v_mfma_f32_16x16x32_bf16 v[12:15], a[236:239], a[44:47], v[12:15]
    v_mul_f32 v7, v7, v17
    v_cvt_pk_bf16_f32 v7, v10, v7
    v_mfma_f32_16x16x32_bf16 v[40:43], a[240:243], a[24:27], 0
    ds_write_b128 v138, v[4:7] offset:0
    v_mfma_f32_16x16x32_bf16 v[40:43], a[244:247], a[28:31], v[40:43]
    v_lshlrev_b32 v39, 16, v8
    v_and_b32 v8, 0xffff0000, v8
    v_mfma_f32_16x16x32_bf16 v[40:43], a[248:251], a[32:35], v[40:43]
    v_mul_f32 v39, v39, v17
    v_mul_f32 v8, v8, v17
    v_mfma_f32_16x16x32_bf16 v[40:43], a[252:255], a[36:39], v[40:43]
    v_cvt_pk_bf16_f32 v160, v39, v8
    v_lshlrev_b32 v39, 16, v9
    v_mfma_f32_16x16x32_bf16 v[40:43], v[224:227], a[40:43], v[40:43]
    v_and_b32 v9, 0xffff0000, v9
    v_mul_f32 v39, v39, v17
    v_mfma_f32_16x16x32_bf16 v[40:43], v[228:231], a[44:47], v[40:43]
    v_mul_f32 v9, v9, v17
    v_cvt_pk_bf16_f32 v161, v39, v9
    v_mfma_f32_16x16x32_bf16 v[32:35], v[232:235], a[24:27], 0
    ds_write_b64 v132, v[160:161] offset:0
    v_mfma_f32_16x16x32_bf16 v[32:35], v[236:239], a[28:31], v[32:35]
    v_lshrrev_b32 v39, 0, v3
    v_lshrrev_b32 v39, v39, s64
    v_mfma_f32_16x16x32_bf16 v[32:35], v[240:243], a[32:35], v[32:35]
    v_and_b32 v39, 1, v39
    v_cmp_eq_u32 vcc, 1, v39
    v_mfma_f32_16x16x32_bf16 v[32:35], v[244:247], a[36:39], v[32:35]
    s_nop 0
    v_cndmask_b32 v0, 2.0, v0, vcc
    v_lshrrev_b32 v39, 8, v3
    v_mfma_f32_16x16x32_bf16 v[32:35], v[248:251], a[40:43], v[32:35]
    v_lshrrev_b32 v39, v39, s64
    v_and_b32 v39, 1, v39
    v_mfma_f32_16x16x32_bf16 v[32:35], v[252:255], a[44:47], v[32:35]
    s_waitcnt lgkmcnt(1)
    v_cmp_eq_u32 vcc, 1, v39
    v_lshrrev_b32 v3, 16, v3
    v_mfma_f32_16x16x32_bf16 v[44:47], a[216:219], a[0:3], 0
    v_cndmask_b32 v1, 2.0, v1, vcc
    v_lshrrev_b32 v3, v3, s64
    v_mfma_f32_16x16x32_bf16 v[44:47], a[220:223], a[4:7], v[44:47]
    ds_read_b128 a[48:51], v62 offset:3072
    ds_read_b128 a[52:55], v61 offset:3072
    v_mfma_f32_16x16x32_bf16 v[44:47], a[224:227], a[8:11], v[44:47]
    ds_read_b128 a[56:59], v62 offset:3200
    v_and_b32 v3, 1, v3
    v_mfma_f32_16x16x32_bf16 v[44:47], a[228:231], a[12:15], v[44:47]
    ds_read_b128 a[60:63], v61 offset:3200
    v_cmp_eq_u32 vcc, 1, v3
    v_mfma_f32_16x16x32_bf16 v[44:47], a[232:235], a[16:19], v[44:47]
    ds_read_b128 a[64:67], v62 offset:3328
    v_cndmask_b32 v2, 2.0, v2, vcc
    v_mfma_f32_16x16x32_bf16 v[44:47], a[236:239], a[20:23], v[44:47]
    ds_read_b128 a[68:71], v61 offset:3328
    v_add_u32 v3, s95, v133
    v_mfma_f32_16x16x32_bf16 v[48:51], a[240:243], a[0:3], 0
    v_rsq_f32 v36, v36
    v_mfma_f32_16x16x32_bf16 v[48:51], a[244:247], a[4:7], v[48:51]
    v_mul_f32 v36, s43, v36
    v_mul_f32 v76, v76, v36
    v_mfma_f32_16x16x32_bf16 v[48:51], a[248:251], a[8:11], v[48:51]
    v_mul_f32 v77, v77, v36
    v_cvt_pk_bf16_f32 v4, v76, v77
    v_mfma_f32_16x16x32_bf16 v[48:51], a[252:255], a[12:15], v[48:51]
    v_mul_f32 v78, v78, v36
    v_mul_f32 v79, v79, v36
    v_mfma_f32_16x16x32_bf16 v[48:51], v[224:227], a[16:19], v[48:51]
    v_cvt_pk_bf16_f32 v5, v78, v79
    v_mul_f32 v104, v104, v36
    v_mfma_f32_16x16x32_bf16 v[48:51], v[228:231], a[20:23], v[48:51]
    v_mul_f32 v105, v105, v36
    v_cvt_pk_bf16_f32 v6, v104, v105
    v_mfma_f32_16x16x32_bf16 v[24:27], v[232:235], a[0:3], 0
    v_mul_f32 v106, v106, v36
    v_mul_f32 v107, v107, v36
    v_mfma_f32_16x16x32_bf16 v[24:27], v[236:239], a[4:7], v[24:27]
    v_cvt_pk_bf16_f32 v7, v106, v107
    v_mul_f32 v116, v116, v36
    v_mfma_f32_16x16x32_bf16 v[24:27], v[240:243], a[8:11], v[24:27]
    ds_write_b128 v156, v[4:7] offset:0
    v_mfma_f32_16x16x32_bf16 v[24:27], v[244:247], a[12:15], v[24:27]
    v_mul_f32 v117, v117, v36
    v_cvt_pk_bf16_f32 v116, v116, v117
    v_mfma_f32_16x16x32_bf16 v[24:27], v[248:251], a[16:19], v[24:27]
    v_mul_f32 v118, v118, v36
    v_mul_f32 v119, v119, v36
    v_mfma_f32_16x16x32_bf16 v[24:27], v[252:255], a[20:23], v[24:27]
    s_waitcnt lgkmcnt(1)
    v_cvt_pk_bf16_f32 v117, v118, v119
    v_fma_f32 v62, v44, v44, s42
    v_mfma_f32_16x16x32_bf16 v[8:11], a[216:219], a[48:51], 0
    ds_write_b64 v63, v[116:117] offset:0
    v_mfma_f32_16x16x32_bf16 v[8:11], a[220:223], a[52:55], v[8:11]
    ds_read_b128 v[64:67], v60 offset:64
    v_fmac_f32 v62, v45, v45
    v_mfma_f32_16x16x32_bf16 v[8:11], a[224:227], a[56:59], v[8:11]
    ds_read_b128 v[4:7], v60 offset:80
    v_fmac_f32 v62, v46, v46
    v_mfma_f32_16x16x32_bf16 v[8:11], a[228:231], a[60:63], v[8:11]
    ds_read_b128 v[56:59], v60
    v_fmac_f32 v62, v47, v47
    v_mfma_f32_16x16x32_bf16 v[8:11], a[232:235], a[64:67], v[8:11]
L_pg2:
    s_cbranch_execz L_main
    ds_read_b64 v[60:61], v60 offset:16
    v_fmac_f32 v62, v48, v48
    v_mfma_f32_16x16x32_bf16 v[8:11], a[236:239], a[68:71], v[8:11]
    v_rsq_f32 v37, v37
    v_mfma_f32_16x16x32_bf16 v[52:55], a[240:243], a[48:51], 0
    v_mul_f32 v37, s43, v37
    v_mul_f32 v92, v92, v37
    v_mfma_f32_16x16x32_bf16 v[52:55], a[244:247], a[52:55], v[52:55]
    v_mul_f32 v93, v93, v37
    v_cvt_pk_bf16_f32 v16, v92, v93
    v_mfma_f32_16x16x32_bf16 v[52:55], a[248:251], a[56:59], v[52:55]
    v_mul_f32 v94, v94, v37
    v_mul_f32 v95, v95, v37
    v_mfma_f32_16x16x32_bf16 v[52:55], a[252:255], a[60:63], v[52:55]
    v_cvt_pk_bf16_f32 v17, v94, v95
    v_mul_f32 v84, v84, v37
    v_mfma_f32_16x16x32_bf16 v[52:55], v[224:227], a[64:67], v[52:55]
    v_mul_f32 v85, v85, v37
    v_cvt_pk_bf16_f32 v18, v84, v85
    v_mfma_f32_16x16x32_bf16 v[52:55], v[228:231], a[68:71], v[52:55]
    v_mul_f32 v86, v86, v37
    v_mul_f32 v87, v87, v37
    v_mfma_f32_16x16x32_bf16 v[20:23], v[232:235], a[48:51], 0
    v_cvt_pk_bf16_f32 v19, v86, v87
    v_mul_f32 v28, v28, v37
    v_mfma_f32_16x16x32_bf16 v[20:23], v[236:239], a[52:55], v[20:23]
    ds_write_b128 v156, v[16:19] offset:1536
    v_mfma_f32_16x16x32_bf16 v[20:23], v[240:243], a[56:59], v[20:23]
    v_mul_f32 v29, v29, v37
    v_cvt_pk_bf16_f32 v28, v28, v29
    v_mfma_f32_16x16x32_bf16 v[20:23], v[244:247], a[60:63], v[20:23]
    v_mul_f32 v30, v30, v37
    v_mul_f32 v31, v31, v37
    v_mfma_f32_16x16x32_bf16 v[20:23], v[248:251], a[64:67], v[20:23]
    v_cvt_pk_bf16_f32 v29, v30, v31
    v_fmac_f32 v62, v49, v49
    v_mfma_f32_16x16x32_bf16 v[20:23], v[252:255], a[68:71], v[20:23]
    s_waitcnt lgkmcnt(1)
    ds_write_b64 v63, v[28:29] offset:1536
    v_mfma_f32_16x16x32_bf16 v[16:19], v[220:223], v[64:67], 0
    v_rsq_f32 v38, v38
    v_mfma_f32_16x16x32_bf16 v[16:19], v[220:223], v[4:7], v[16:19]
    v_mul_f32 v38, s43, v38
    v_mul_f32 v108, v108, v38
    v_mul_f32 v109, v109, v38
    v_cvt_pk_bf16_f32 v4, v108, v109
    v_mul_f32 v110, v110, v38
    v_mul_f32 v111, v111, v38
    v_cvt_pk_bf16_f32 v5, v110, v111
    v_mul_f32 v140, v140, v38
    v_mul_f32 v141, v141, v38
    v_cvt_pk_bf16_f32 v6, v140, v141
    v_mul_f32 v142, v142, v38
    v_mul_f32 v143, v143, v38
    v_cvt_pk_bf16_f32 v7, v142, v143
    v_mul_f32 v88, v88, v38
    v_mul_f32 v89, v89, v38
    v_cvt_pk_bf16_f32 v88, v88, v89
    v_mul_f32 v90, v90, v38
    v_mul_f32 v91, v91, v38
    v_cvt_pk_bf16_f32 v89, v90, v91
    ds_write_b128 v156, v[4:7] offset:3072
    v_fmac_f32 v62, v50, v50
    v_fmac_f32 v62, v51, v51
    v_fmac_f32 v62, v24, v24
    v_fmac_f32 v62, v25, v25
    ds_write_b64 v63, v[88:89] offset:3072
    v_fmac_f32 v62, v26, v26
    v_fmac_f32 v62, v27, v27
    v_fma_f32 v133, v12, v12, s42
    v_fmac_f32 v133, v13, v13
    v_fmac_f32 v133, v14, v14
    v_fmac_f32 v133, v15, v15
    v_fmac_f32 v133, v40, v40
    v_fmac_f32 v133, v41, v41
    v_fmac_f32 v133, v42, v42
    v_fmac_f32 v133, v43, v43
    v_fmac_f32 v133, v32, v32
    v_fmac_f32 v133, v33, v33
    v_fmac_f32 v133, v34, v34
    v_fmac_f32 v133, v35, v35
    v_cvt_pk_bf16_f32 v62, v62, v133
    v_fma_f32 v133, v8, v8, s42
    v_fmac_f32 v133, v9, v9
    v_fmac_f32 v133, v10, v10
    v_fmac_f32 v133, v11, v11
    v_fmac_f32 v133, v52, v52
    v_fmac_f32 v133, v53, v53
    v_fmac_f32 v133, v54, v54
    v_fmac_f32 v133, v55, v55
    v_fmac_f32 v133, v20, v20
    v_fmac_f32 v133, v21, v21
    v_fmac_f32 v133, v22, v22
    v_fmac_f32 v133, v23, v23
    v_cvt_pk_bf16_f32 v63, v133, v133
    ds_write_b64 v159, v[62:63] offset:2048
    v_rcp_f32 v17, v16
    v_lshlrev_b32 v133, 16, v56
    v_max3_u32 v124, v124, v16, v17
    v_and_b32 v56, 0xffff0000, v56
    v_mul_f32 v133, v133, v17
    v_mul_f32 v56, v56, v17
    v_cvt_pk_bf16_f32 v4, v133, v56
    v_lshlrev_b32 v56, 16, v57
    v_and_b32 v57, 0xffff0000, v57
    v_mul_f32 v56, v56, v17
    v_mul_f32 v57, v57, v17
    v_cvt_pk_bf16_f32 v5, v56, v57
    v_lshlrev_b32 v133, 16, v58
    v_and_b32 v58, 0xffff0000, v58
    v_mul_f32 v133, v133, v17
    v_mul_f32 v58, v58, v17
    v_cvt_pk_bf16_f32 v6, v133, v58
    v_lshlrev_b32 v7, 16, v59
    v_and_b32 v59, 0xffff0000, v59
    v_mul_f32 v7, v7, v17
    v_mul_f32 v59, v59, v17
    v_cvt_pk_bf16_f32 v7, v7, v59
    v_lshlrev_b32 v133, 16, v60
    v_and_b32 v60, 0xffff0000, v60
    v_mul_f32 v133, v133, v17
    v_mul_f32 v60, v60, v17
    v_cvt_pk_bf16_f32 v160, v133, v60
    v_lshlrev_b32 v133, 16, v61
    v_and_b32 v61, 0xffff0000, v61
    v_mul_f32 v133, v133, v17
    v_mul_f32 v61, v61, v17
    v_cvt_pk_bf16_f32 v161, v133, v61
    s_waitcnt lgkmcnt(0)
    s_barrier
    ds_write_b128 v138, v[4:7] offset:1536
    v_cmp_gt_u32 vcc, 1820327936, v124
    v_mov_b32 v157, 0x3f803f80
    s_nop 0
    v_cndmask_b32 v125, -1, v125, vcc
    ds_write_b64 v132, v[160:161] offset:1536
    v_and_b32 v125, 0xb0000000, v125
    v_cmp_ne_u32 vcc, 0, v125
    s_nop 0
    ds_read_b128 a[144:147], v3 offset:0
    v_cndmask_b32 v157, 0, v157, vcc
    ds_read_b128 a[148:151], v3 offset:1024
    ds_read_b128 a[152:155], v3 offset:2048
    ds_read_b128 a[156:159], v3 offset:3072
    ds_read_b128 a[160:163], v3 offset:4096
    s_waitcnt lgkmcnt(5)
    s_barrier
    s_waitcnt lgkmcnt(4)
    buffer_store_dwordx4 a[144:147], v130, s[28:31], s59 offen sc1
    ds_read_b128 v[16:19], v163 offset:2048
    ds_read_b128 v[4:7], v163 offset:3072
    ds_read_b128 a[96:99], v137 offset:1536
    ds_read_b128 a[100:103], v136 offset:1536
    ds_read_b128 a[104:107], v137 offset:1664
    ds_read_b128 a[108:111], v136 offset:1664
    ds_read_b128 a[112:115], v137 offset:1792
    s_waitcnt lgkmcnt(8)
    buffer_store_dwordx4 a[148:151], v129, s[28:31], s59 offen sc1
    ds_read_b128 a[116:119], v136 offset:1792
    s_waitcnt lgkmcnt(7)
    v_mfma_f32_16x16x32_bf16 v[36:39], v[216:219], v[16:19], 0
    s_waitcnt lgkmcnt(6)
    v_mfma_f32_16x16x32_bf16 v[36:39], v[216:219], v[4:7], v[36:39]
    s_waitcnt lgkmcnt(5)
    v_mfma_f32_16x16x32_bf16 v[4:7], a[216:219], a[96:99], 0
    s_waitcnt lgkmcnt(4)
    v_mfma_f32_16x16x32_bf16 v[4:7], a[220:223], a[100:103], v[4:7]
    s_waitcnt lgkmcnt(3)
    ds_read_b128 a[72:75], v137 offset:0
    ds_read_b128 a[76:79], v136 offset:0
    v_mfma_f32_16x16x32_bf16 v[4:7], a[224:227], a[104:107], v[4:7]
    s_waitcnt lgkmcnt(4)
    ds_read_b128 a[80:83], v137 offset:128
    v_mfma_f32_16x16x32_bf16 v[4:7], a[228:231], a[108:111], v[4:7]
    s_waitcnt lgkmcnt(4)
    buffer_store_dwordx4 a[152:155], v128, s[28:31], s59 offen sc1
    ds_read_b128 a[84:87], v136 offset:128
    v_rsq_f32 v36, v36
    v_mfma_f32_16x16x32_bf16 v[4:7], a[232:235], a[112:115], v[4:7]
    s_waitcnt lgkmcnt(4)
    ds_read_b128 a[88:91], v137 offset:256
    ds_read_b128 a[92:95], v136 offset:256
    v_mfma_f32_16x16x32_bf16 v[4:7], a[236:239], a[116:119], v[4:7]
    v_rsq_f32 v37, v37
    v_mfma_f32_16x16x32_bf16 v[16:19], a[240:243], a[96:99], 0
    v_mul_f32 v36, s43, v36
    v_mul_f32 v37, s43, v37
    v_mfma_f32_16x16x32_bf16 v[16:19], a[244:247], a[100:103], v[16:19]
    v_rsq_f32 v38, v38
    v_mfma_f32_16x16x32_bf16 v[16:19], a[248:251], a[104:107], v[16:19]
    v_mul_f32 v38, s43, v38
    v_mul_f32 v8, v8, v38
    v_mfma_f32_16x16x32_bf16 v[16:19], a[252:255], a[108:111], v[16:19]
    buffer_store_dwordx4 a[156:159], v127, s[28:31], s59 offen sc1
    v_mul_f32 v9, v9, v38
    v_cvt_pk_bf16_f32 v28, v8, v9
    v_mul_f32 v10, v10, v38
    v_mul_f32 v11, v11, v38
    v_mfma_f32_16x16x32_bf16 v[16:19], v[224:227], a[112:115], v[16:19]
    v_cvt_pk_bf16_f32 v29, v10, v11
    v_mul_f32 v52, v52, v38
    v_mfma_f32_16x16x32_bf16 v[16:19], v[228:231], a[116:119], v[16:19]
    v_mul_f32 v53, v53, v38
    v_cvt_pk_bf16_f32 v30, v52, v53
    v_mfma_f32_16x16x32_bf16 v[8:11], v[232:235], a[96:99], 0
    v_mul_f32 v54, v54, v38
    v_mul_f32 v55, v55, v38
    v_mfma_f32_16x16x32_bf16 v[8:11], v[236:239], a[100:103], v[8:11]
    v_cvt_pk_bf16_f32 v31, v54, v55
    v_mul_f32 v20, v20, v38
    v_mfma_f32_16x16x32_bf16 v[8:11], v[240:243], a[104:107], v[8:11]
    ds_write_b128 v135, v[28:31] offset:3072
    v_mfma_f32_16x16x32_bf16 v[8:11], v[244:247], a[108:111], v[8:11]
    buffer_store_dwordx4 a[160:163], v126, s[28:31], s59 offen sc1
    v_mul_f32 v21, v21, v38
    v_cvt_pk_bf16_f32 v124, v20, v21
    v_mul_f32 v22, v22, v38
    v_mul_f32 v23, v23, v38
    v_mfma_f32_16x16x32_bf16 v[8:11], v[248:251], a[112:115], v[8:11]
    v_cvt_pk_bf16_f32 v125, v22, v23
    v_mul_f32 v44, v44, v36
    v_mfma_f32_16x16x32_bf16 v[8:11], v[252:255], a[116:119], v[8:11]
    s_waitcnt lgkmcnt(1)
    ds_write_b64 v134, v[124:125] offset:3072
    v_mfma_f32_16x16x32_bf16 v[20:23], a[216:219], a[72:75], 0
    v_mul_f32 v45, v45, v36
    v_cvt_pk_bf16_f32 v44, v44, v45
    v_mfma_f32_16x16x32_bf16 v[20:23], a[220:223], a[76:79], v[20:23]
    v_mul_f32 v46, v46, v36
    v_mul_f32 v47, v47, v36
    v_mfma_f32_16x16x32_bf16 v[20:23], a[224:227], a[80:83], v[20:23]
    v_cvt_pk_bf16_f32 v45, v46, v47
    v_mul_f32 v48, v48, v36
    v_mfma_f32_16x16x32_bf16 v[20:23], a[228:231], a[84:87], v[20:23]
    v_mul_f32 v49, v49, v36
    v_cvt_pk_bf16_f32 v46, v48, v49
    v_mfma_f32_16x16x32_bf16 v[20:23], a[232:235], a[88:91], v[20:23]
    v_mul_f32 v50, v50, v36
    v_mul_f32 v51, v51, v36
    v_mfma_f32_16x16x32_bf16 v[20:23], a[236:239], a[92:95], v[20:23]
    v_cvt_pk_bf16_f32 v47, v50, v51
    v_mul_f32 v24, v24, v36
    v_mfma_f32_16x16x32_bf16 v[28:31], a[240:243], a[72:75], 0
    ds_write_b128 v135, v[44:47] offset:0
    v_mfma_f32_16x16x32_bf16 v[28:31], a[244:247], a[76:79], v[28:31]
    v_mul_f32 v25, v25, v36
    v_cvt_pk_bf16_f32 v38, v24, v25
    v_mfma_f32_16x16x32_bf16 v[28:31], a[248:251], a[80:83], v[28:31]
    v_mul_f32 v26, v26, v36
    v_mul_f32 v27, v27, v36
    v_mfma_f32_16x16x32_bf16 v[28:31], a[252:255], a[84:87], v[28:31]
    v_cvt_pk_bf16_f32 v39, v26, v27
    v_fma_f32 v133, v4, v4, s42
    v_mfma_f32_16x16x32_bf16 v[28:31], v[224:227], a[88:91], v[28:31]
    ds_write_b64 v134, v[38:39] offset:0
    v_mfma_f32_16x16x32_bf16 v[28:31], v[228:231], a[92:95], v[28:31]
    v_fmac_f32 v133, v5, v5
    v_fmac_f32 v133, v6, v6
    v_mfma_f32_16x16x32_bf16 v[24:27], v[232:235], a[72:75], 0
    v_fmac_f32 v133, v7, v7
    v_fmac_f32 v133, v16, v16
    v_mfma_f32_16x16x32_bf16 v[24:27], v[236:239], a[76:79], v[24:27]
    v_fmac_f32 v133, v17, v17
    v_fmac_f32 v133, v18, v18
    v_mfma_f32_16x16x32_bf16 v[24:27], v[240:243], a[80:83], v[24:27]
    v_fmac_f32 v133, v19, v19
    v_fmac_f32 v133, v8, v8
    v_mfma_f32_16x16x32_bf16 v[24:27], v[244:247], a[84:87], v[24:27]
    v_fmac_f32 v133, v9, v9
    v_fmac_f32 v133, v10, v10
    v_mfma_f32_16x16x32_bf16 v[24:27], v[248:251], a[88:91], v[24:27]
    v_fmac_f32 v133, v11, v11
    v_fma_f32 v3, v20, v20, s42
    v_mfma_f32_16x16x32_bf16 v[24:27], v[252:255], a[92:95], v[24:27]
    s_nop 0
    v_fmac_f32 v3, v21, v21
    v_fmac_f32 v3, v22, v22
    v_fmac_f32 v3, v23, v23
    v_fmac_f32 v3, v28, v28
    v_fmac_f32 v3, v29, v29
    v_fmac_f32 v3, v30, v30
    v_fmac_f32 v3, v31, v31
    v_fmac_f32 v3, v24, v24
    v_fmac_f32 v3, v25, v25
    v_fmac_f32 v3, v26, v26
    v_fmac_f32 v3, v27, v27
    v_cvt_pk_bf16_f32 v156, v3, v133
    ds_write_b64 v159, v[156:157] offset:4096
    v_mul_f32 v12, v12, v37
    v_mul_f32 v13, v13, v37
    v_cvt_pk_bf16_f32 v12, v12, v13
    v_mul_f32 v14, v14, v37
    v_mul_f32 v15, v15, v37
    v_cvt_pk_bf16_f32 v13, v14, v15
    v_mul_f32 v40, v40, v37
    v_mul_f32 v41, v41, v37
    v_cvt_pk_bf16_f32 v14, v40, v41
    v_mul_f32 v42, v42, v37
    v_mul_f32 v43, v43, v37
    v_cvt_pk_bf16_f32 v15, v42, v43
    v_mul_f32 v32, v32, v37
    v_mul_f32 v33, v33, v37
    v_cvt_pk_bf16_f32 v124, v32, v33
    v_mul_f32 v34, v34, v37
    v_mul_f32 v35, v35, v37
    v_cvt_pk_bf16_f32 v125, v34, v35
    ds_write_b128 v135, v[12:15] offset:1536
    s_waitcnt lgkmcnt(1)
    s_barrier
    ds_write_b64 v134, v[124:125] offset:1536
    ds_read_b128 v[36:39], v163 offset:4096
    ds_read_b128 v[32:35], v163 offset:5120
    s_waitcnt lgkmcnt(2)
    s_barrier
    s_waitcnt lgkmcnt(1)
    v_mfma_f32_16x16x32_bf16 v[12:15], v[216:219], v[36:39], 0
    s_waitcnt lgkmcnt(0)
    ds_read_b128 a[164:167], v139 offset:0
    ds_read_b128 a[168:171], v139 offset:1024
    v_mfma_f32_16x16x32_bf16 v[12:15], v[216:219], v[32:35], v[12:15]
    s_nop 0
    ds_read_b128 a[172:175], v139 offset:2048
    s_nop 2
    ds_read_b128 a[176:179], v139 offset:3072
    s_nop 1
    v_rsq_f32 v12, v12
    ds_read_b128 a[180:183], v139 offset:4096
    v_mul_f32 v12, s43, v12
    v_mul_f32 v20, v20, v12
    v_mul_f32 v21, v21, v12
    v_cvt_pk_bf16_f32 v20, v20, v21
    v_mul_f32 v22, v22, v12
    v_mul_f32 v23, v23, v12
    v_cvt_pk_bf16_f32 v21, v22, v23
    v_mul_f32 v28, v28, v12
    v_mul_f32 v29, v29, v12
    s_waitcnt lgkmcnt(4)
    buffer_store_dwordx4 a[164:167], v130, s[28:31], s58 offen sc1
    v_cvt_pk_bf16_f32 v22, v28, v29
    v_mul_f32 v30, v30, v12
    v_mul_f32 v31, v31, v12
    v_cvt_pk_bf16_f32 v23, v30, v31
    v_mul_f32 v24, v24, v12
    v_mul_f32 v25, v25, v12
    v_cvt_pk_bf16_f32 v124, v24, v25
    v_mul_f32 v26, v26, v12
    v_mul_f32 v27, v27, v12
    v_cvt_pk_bf16_f32 v125, v26, v27
    ds_write_b128 v138, v[20:23] offset:0
    v_rsq_f32 v13, v13
    v_cmp_neq_f32 vcc, 0, v14
    v_mul_f32 v13, s43, v13
    s_waitcnt lgkmcnt(1)
    buffer_store_dwordx4 a[168:171], v129, s[28:31], s58 offen sc1
    ds_write_b64 v132, v[124:125] offset:0
    v_mul_f32 v4, v4, v13
    v_mul_f32 v5, v5, v13
    v_cvt_pk_bf16_f32 v4, v4, v5
    v_mul_f32 v6, v6, v13
    v_mul_f32 v7, v7, v13
    v_cvt_pk_bf16_f32 v5, v6, v7
    v_mul_f32 v16, v16, v13
    v_mul_f32 v17, v17, v13
    v_cvt_pk_bf16_f32 v6, v16, v17
    v_mul_f32 v18, v18, v13
    v_mul_f32 v19, v19, v13
    v_cvt_pk_bf16_f32 v7, v18, v19
    v_mul_f32 v8, v8, v13
    v_mul_f32 v9, v9, v13
    v_cvt_pk_bf16_f32 v124, v8, v9
    v_mul_f32 v10, v10, v13
    v_mul_f32 v11, v11, v13
    v_cvt_pk_bf16_f32 v125, v10, v11
    buffer_store_dwordx4 a[172:175], v128, s[28:31], s58 offen sc1
    ds_write_b128 v138, v[4:7] offset:1536
    ds_write_b64 v132, v[124:125] offset:1536
    buffer_store_dwordx4 a[176:179], v127, s[28:31], s58 offen sc1
    s_waitcnt lgkmcnt(0)
    s_barrier
    buffer_store_dwordx4 a[180:183], v126, s[28:31], s58 offen sc1
    ds_read_b128 a[184:187], v131 offset:0
    ds_read_b128 a[188:191], v131 offset:1024
    ds_read_b128 a[192:195], v131 offset:2048
    s_waitcnt lgkmcnt(2)
    buffer_store_dwordx4 a[184:187], v0, s[28:31], 0 offen sc1
    s_waitcnt lgkmcnt(0)
    buffer_store_dwordx4 a[188:191], v1, s[28:31], 0 offen sc1
    buffer_store_dwordx4 a[192:195], v2, s[28:31], 0 offen sc1
    s_nop 4
    s_cbranch_vccnz L_slow
L_fin:
    s_cmp_eq_u32 s2, 255
    s_cbranch_scc1 L_again
L_end:
    s_endpgm
L_slow:
    s_waitcnt vmcnt(0) lgkmcnt(0)
    s_nop 15
    s_barrier
    s_lshr_b32 s66, s64, 20
    v_mbcnt_lo_u32_b32 v4, -1, 0
    v_mbcnt_hi_u32_b32 v4, -1, v4
    s_load_dwordx16 s[4:19], s[0:1], 0
    s_load_dwordx4 s[20:23], s[0:1], 64
    s_load_dwordx2 s[38:39], s[0:1], 80
    s_bfe_u32 s88, s2, 0x50003
    s_lshl2_add_u32 s88, s88, s68
    v_lshlrev_b32 v5, 7, v4
    s_mul_i32 s89, s88, 576
    s_mul_i32 s88, s88, 1728
    v_min_u32 v17, 1664, v5
    v_min_u32 v7, 512, v5
    s_mov_b32 s34, 221184
    s_mov_b32 s35, 0x20000
    s_mov_b32 s78, 73728
    s_mov_b32 s79, 0x20000
    v_and_b32 v161, 15, v4
    v_lshrrev_b32 v44, 4, v4
    v_lshrrev_b32 v148, 2, v161
    v_and_b32 v5, 3, v161
    s_mul_i32 s87, s68, 192
    v_mad_u32_u24 v23, v161, 12, s87
    v_lshlrev_b32 v6, 1, v161
    v_lshlrev_b32 v16, 1, v148
    v_lshl_add_u32 v16, v44, 5, v16
    s_movk_i32 s86, 384
    s_mov_b32 s26, 100270464
    s_mov_b32 s27, 0x20000
    s_mov_b32 s30, 0
    s_mov_b32 s31, 0x20000
    s_mul_i32 s96, s68, 288
    s_and_b32 s97, s68, 1
    s_lshl_b32 s97, s97, 2
    s_mov_b32 s98, 193536
    s_waitcnt lgkmcnt(0)
    s_mov_b32 s24, s4
    s_mov_b32 s25, s5
    s_mov_b32 s32, s6
    s_mov_b32 s33, s7
    s_mov_b32 s76, s8
    s_mov_b32 s77, s9
    buffer_load_dword a254, v17, s[32:35], s88 offen
    buffer_load_dword a253, v7, s[76:79], s89 offen
    s_load_dwordx2 s[82:83], s[10:11], 0
    s_movk_i32 s18, 676
    s_mov_b32 s19, 0x20000
    buffer_load_dwordx3 v[32:34], v23, s[16:19], 0 offen
    s_mov_b32 s99, 589824
    v_add_u32 v7, s96, v4
    v_mul_u32_u24 v131, 2731, v7
    v_mul_u32_u24 v35, 6242, v7
    v_lshrrev_b32 v131, 16, v131
    s_lshr_b32 s94, s2, 3
    s_mul_i32 s70, s94, 167
    global_load_ushort v20, v6, s[12:13]
    v_lshrrev_b32 v35, 20, v35
    v_and_or_b32 v8, v131, 3, s97
    v_xor_b32 v8, v7, v8
    v_lshl_add_u32 v130, v8, 4, s99
    v_mad_u32_u24 v130, v35, s98, v130
    s_min_u32 s95, s94, 7
    s_add_u32 s70, s70, s95
    global_load_ushort v21, v6, s[12:13] offset:32
    v_add_u32 v22, 64, v7
    v_mul_u32_u24 v6, 2731, v22
    v_mul_u32_u24 v25, 6242, v22
    v_lshrrev_b32 v6, 16, v6
    v_lshrrev_b32 v25, 20, v25
    s_and_b32 s95, s2, 7
    s_mul_i32 s95, s95, 20
    global_load_ushort v18, v16, s[14:15] offset:0
    v_and_or_b32 v9, v6, 3, s97
    v_xor_b32 v9, v22, v9
    v_lshl_add_u32 v129, v9, 4, s99
    v_mad_u32_u24 v129, v25, s98, v129
    v_add_u32 v17, 128, v7
    s_add_u32 s69, s70, s95
    s_add_u32 s70, s70, 140
    global_load_ushort v133, v16, s[14:15] offset:8
    v_mul_u32_u24 v22, 2731, v17
    v_mul_u32_u24 v11, 6242, v17
    v_lshrrev_b32 v22, 16, v22
    v_lshrrev_b32 v11, 20, v11
    v_and_or_b32 v10, v22, 3, s97
    s_movk_i32 s62, 2688
    s_movk_i32 s71, 20
    global_load_ushort v19, v16, s[14:15] offset:16
    v_xor_b32 v10, v17, v10
    v_lshl_add_u32 v128, v10, 4, s99
    v_mad_u32_u24 v128, v11, s98, v128
    v_add_u32 v17, 192, v7
    v_mul_u32_u24 v124, 2731, v17
    s_cmp_lt_u32 s94, 7
    s_cselect_b32 s73, 28, 27
    global_load_ushort v24, v16, s[14:15] offset:24
    v_mul_u32_u24 v125, 6242, v17
    v_lshrrev_b32 v124, 16, v124
    v_lshrrev_b32 v125, 20, v125
    v_and_or_b32 v16, v124, 3, s97
    v_xor_b32 v16, v17, v16
    v_lshl_add_u32 v127, v16, 4, s99
    v_mad_u32_u24 v127, v125, s98, v127
    v_add_u32 v126, 256, v7
    v_mul_u32_u24 v26, 2731, v126
    v_mul_u32_u24 v7, 6242, v126
    v_lshrrev_b32 v26, 16, v26
    v_lshrrev_b32 v7, 20, v7
    v_and_or_b32 v27, v26, 3, s97
    v_xor_b32 v27, v126, v27
    v_lshl_add_u32 v126, v27, 4, s99
    v_mad_u32_u24 v126, v7, s98, v126
    s_mov_b32 s93, 1769472
    s_mul_i32 s54, s68, 5120
    s_cmp_ge_u32 s2, 248
    s_cbranch_scc1 L_bndS
L_bndrS:
    s_mov_b32 s63, 1180032
    s_mul_i32 s94, s69, 58255
    s_lshr_b32 s94, s94, 22
    s_mul_i32 s94, s94, s63
    s_mul_i32 s72, s69, s62
    s_add_u32 s72, s72, s94
    v_lshl_or_b32 v149, v4, 4, 2.0
    s_sub_u32 s94, s73, 1
    s_max_u32 s94, s94, 20
    s_mul_i32 s95, s68, -44
    s_movk_i32 s99, -24
    s_add_u32 m0, s54, 0
    v_and_b32 v11, -4, v22
    s_mul_i32 s85, s68, 96
    s_sub_u32 s100, s85, 1024
    buffer_load_dwordx4 v130, s[24:27], s72 offen nt lds
    s_add_u32 m0, s54, 1024
    v_mad_u32_u24 v7, v11, 3, v22
    v_add_u32 v7, s95, v7
    v_mad_i32_i24 v10, v22, s99, v10
    v_med3_u32 v11, v7, 20, s94
    v_add_u32 v11, s70, v11
    v_add_u32 v22, s69, v7
    s_sub_u32 s87, s85, 2048
    s_movk_i32 s91, 1152
    buffer_load_dwordx4 v129, s[24:27], s72 offen nt lds
    v_cmp_gt_u32 vcc, s71, v7
    v_lshl_add_u32 v10, v10, 4, s93
    s_add_u32 m0, s54, 43008
    v_cndmask_b32 v22, v11, v22, vcc
    v_mul_u32_u24 v11, 58255, v22
    v_mad_u32_u24 v10, v22, s62, v10
    v_lshrrev_b32 v11, 22, v11
    v_mad_u32_u24 v10, v11, s63, v10
    s_mul_i32 s90, s68, 3072
    s_add_u32 s90, s90, 61440
    buffer_load_dwordx4 v10, s[24:27], 0 offen  lds
    v_lshlrev_b32 v11, 16, v7
    s_add_u32 m0, s54, 2048
    v_and_b32 v35, -4, v6
    v_mad_u32_u24 v22, v35, 3, v6
    v_add_u32 v22, s95, v22
    v_mad_i32_i24 v9, v6, s99, v9
    v_med3_u32 v35, v22, 20, s94
    s_mov_b32 s28, s22
    s_mov_b32 s29, s23
    buffer_load_dwordx4 v128, s[24:27], s72 offen nt lds
    v_add_u32 v35, s70, v35
    v_add_u32 v6, s69, v22
    v_cmp_gt_u32 vcc, s71, v22
    v_lshl_add_u32 v9, v9, 4, s93
    s_add_u32 m0, s54, 41984
    v_cndmask_b32 v6, v35, v6, vcc
    v_mul_u32_u24 v35, 58255, v6
    v_mad_u32_u24 v9, v6, s62, v9
    v_lshrrev_b32 v35, 22, v35
    v_mad_u32_u24 v9, v35, s63, v9
    s_mov_b32 s41, 0x2a8cbccc
    s_mov_b32 s42, 0x38fba882
    buffer_load_dwordx4 v9, s[24:27], 0 offen  lds
    v_lshl_or_b32 v11, v22, 8, v11
    s_add_u32 m0, s54, 3072
    v_cmp_gt_u32 vcc, 32, v4
    v_and_b32 v35, -4, v131
    v_mad_u32_u24 v22, v35, 3, v131
    v_cndmask_b32 v126, v149, v126, vcc
    v_add_u32 v22, s95, v22
    s_mov_b32 s43, 0x415db3d7
    s_mov_b32 s57, s72
    buffer_load_dwordx4 v127, s[24:27], s72 offen nt lds
    s_add_u32 m0, s54, 4096
    v_mad_i32_i24 v8, v131, s99, v8
    v_med3_u32 v35, v22, 20, s94
    v_add_u32 v35, s70, v35
    v_add_u32 v131, s69, v22
    v_cmp_gt_u32 vcc, s71, v22
    v_lshl_add_u32 v8, v8, 4, s93
    s_mul_i32 s93, s68, 6
    s_lshl_b32 s94, s97, 1
    buffer_load_dwordx4 v126, s[24:27], s72 offen nt lds
    v_cndmask_b32 v131, v35, v131, vcc
    v_mul_u32_u24 v35, 58255, v131
    v_mad_u32_u24 v8, v131, s62, v8
    v_lshrrev_b32 v35, 22, v35
    v_mad_u32_u24 v8, v35, s63, v8
    s_add_u32 m0, s54, 40960
    v_lshl_or_b32 v11, v22, 0, v11
    s_mov_b32 s58, 0
    s_mov_b32 s59, 0
    buffer_load_dwordx4 v8, s[24:27], 0 offen nt lds
    v_mul_u32_u24 v131, 10923, v4
    v_lshrrev_b32 v168, 17, v131
    v_lshrrev_b32 v131, 16, v131
    v_mad_i32_i24 v6, v131, -6, v4
    v_bitop3_b32 v168, v168, v131, 4 bitop3:0x28
    v_lshl_add_u32 v6, v6, 4, s85
    v_mul_u32_u24 v168, 3, v168
    v_xor_b32 v131, v131, v168
    v_mad_u32_u24 v168, v131, s91, v6
    v_add_u32 v7, 64, v4
    v_mul_u32_u24 v17, 10923, v7
    v_lshrrev_b32 v157, 17, v17
    v_lshrrev_b32 v17, 16, v17
    v_mad_i32_i24 v22, v17, -6, v7
    v_bitop3_b32 v157, v157, v17, 4 bitop3:0x28
    v_lshl_add_u32 v22, v22, 4, s100
    v_mul_u32_u24 v157, 3, v157
    v_xor_b32 v17, v17, v157
    v_mad_u32_u24 v157, v17, s91, v22
    v_add_u32 v7, 128, v4
    v_mul_u32_u24 v35, 10923, v7
    v_lshrrev_b32 v47, 17, v35
    v_lshrrev_b32 v35, 16, v35
    v_mad_i32_i24 v16, v35, -6, v7
    v_bitop3_b32 v47, v47, v35, 4 bitop3:0x28
    v_lshl_add_u32 v16, v16, 4, s87
    v_mul_u32_u24 v47, 3, v47
    v_xor_b32 v35, v35, v47
    v_mad_u32_u24 v47, v35, s91, v16
    v_mad_u32_u24 v158, v131, s86, v6
    v_mad_u32_u24 v17, v17, s86, v22
    v_mad_u32_u24 v16, v35, s86, v16
    s_add_u32 m0, s90, 0
    s_mov_b32 s92, 0
    buffer_load_dwordx4 v168, s[32:35], s92 offen offset:0 lds
    v_mov_b32 v35, 0x3f803f80
    v_cmp_eq_u32 vcc, 0, v5
    v_and_b32 v22, 1, v4
    v_lshlrev_b32 v22, 4, v22
    v_cndmask_b32 v220, 0, v35, vcc
    v_cndmask_b32 v221, 0, v35, vcc
    v_cndmask_b32 v222, 0, v35, vcc
    v_cndmask_b32 v223, 0, v35, vcc
    v_mov_b32 v35, 0x3f80
    v_lshlrev_b32 v22, v22, v35
    v_cmp_gt_u32 vcc, 2, v5
    v_mov_b32 v171, 0
    v_mov_b32 v150, 0
    v_cndmask_b32 v216, 0, v22, vcc
    v_cndmask_b32 v218, 0, v22, vcc
    v_cmp_le_u32 vcc, 2, v5
    v_mov_b32 v151, 0
    v_mov_b32 v144, 0
    v_cndmask_b32 v217, 0, v22, vcc
    v_cndmask_b32 v219, 0, v22, vcc
    v_cmp_eq_u32 vcc, v44, v148
    v_mov_b32 v145, 0
    v_mov_b32 v138, 0
    v_cndmask_b32 v26, 0, v216, vcc
    v_cndmask_b32 v27, 0, v217, vcc
    v_mov_b32 v139, 0
    v_lshrrev_b32 v6, 1, v44
    v_lshl_add_u32 v7, v44, 2, v148
    v_lshl_add_u32 v7, v6, 3, v7
    v_mul_u32_u24 v7, 96, v7
    v_add_u32 v7, s90, v7
    v_lshl_add_u32 v6, v5, 4, v7
    v_lshl_add_u32 v7, v5, 3, v7
    s_waitcnt lgkmcnt(0)
    s_lshl_b32 s85, s68, 4
    v_lshlrev_b32 v25, 4, v44
    v_lshrrev_b64 v[124:125], v25, s[82:83]
    v_lshlrev_b32 v25, 16, v124
    v_min_f32 v25, 0x40930000, v25
    v_max_f32 v25, 0xc2c80000, v25
    v_mul_f32 v25, 0x3fb8aa3b, v25
    v_exp_f32 v25, v25
    v_mov_b32 v132, 0xc138aa3b
    v_cvt_pk_bf16_f32 v25, v25, v25
    v_lshlrev_b32 v25, 16, v25
    v_mul_f32 v25, 0x4038aa3b, v25
    v_fmac_f32 v132, 0xbe333333, v25
    v_readlane_b32 s55, v25, s85
    v_mul_f32 v25, 0x43000000, v25
    v_mov_b32 v22, 0
    v_readlane_b32 s52, v25, s85
    v_mov_b32 v35, 0
    v_mul_u32_u24 v124, 5120, v44
    v_add_u32 v124, v23, v124
    s_mov_b32 s84, 0x41b8aa3b
    v_mul_u32_u24 v131, 5120, v148
    v_mad_u32_u24 v131, v5, s86, v131
    v_and_b32 v23, 7, v161
    v_xor_b32 v125, v23, v44
    v_lshl_add_u32 v147, v125, 4, v131
    s_mov_b32 s44, 61440
    s_mov_b32 s45, 40960
    buffer_load_dwordx4 v157, s[32:35], s92 offen offset:1024 lds
    v_xor_b32 v146, 64, v147
    v_add_u32 v137, 40960, v147
    v_xor_b32 v136, 64, v137
    v_add_u32 v131, 61440, v131
    v_add_u32 v125, s93, v44
    v_xor_b32 v125, v23, v125
    v_lshl_add_u32 v135, v125, 4, v131
    s_mov_b32 s46, 20480
    s_mov_b32 s47, 0
    buffer_load_dwordx4 v47, s[32:35], s92 offen offset:2048 lds
    s_add_u32 m0, s90, 12288
    s_mov_b32 s92, 36864
    v_lshrrev_b32 v125, 1, v44
    v_add3_u32 v125, v125, s93, 4
    v_xor_b32 v125, v23, v125
    v_lshl_add_u32 v125, v125, 4, v131
    v_and_b32 v131, 1, v44
    s_add_u32 s93, s54, 20480
    s_mov_b32 s60, 0
    buffer_load_dwordx4 v168, s[32:35], s92 offen offset:0 lds
    s_waitcnt vmcnt(16)
    v_lshl_or_b32 v20, v21, 16, v20
    v_cmp_gt_u32 vcc, 16, v4
    v_mov_b32 v21, 0
    v_lshl_add_u32 v134, v131, 3, v125
    v_cndmask_b32 v23, 0, v20, vcc
    v_cndmask_b32 v20, 0, v20, vcc
    v_lshlrev_b32 v25, 4, v4
    v_mfma_f32_16x16x16_bf16 v[0:3], v[22:23], v[32:33], 0
    s_waitcnt vmcnt(14)
    s_mov_b32 s65, -1
    v_lshl_or_b32 v18, v133, 16, v18
    v_add_u32 v133, s93, v25
    v_mfma_f32_16x16x16_bf16 v[12:15], v[20:21], v[32:33], 0
    s_lshr_b32 s93, s68, 1
    v_add_u32 v163, 81920, v25
    v_mul_u32_u24 v131, 1792, v44
    v_mfma_f32_16x16x16_bf16 v[28:31], v[20:21], v[34:35], 0
    s_waitcnt vmcnt(12)
    s_lshl_b32 s93, s93, 10
    buffer_load_dwordx4 v157, s[32:35], s92 offen offset:1024 lds
    v_lshl_or_b32 v19, v24, 16, v19
    v_max_f32 v0, 0, v0
    v_max_f32 v12, 0, v12
    v_max_f32 v13, 0, v13
    v_max_f32 v14, 0, v14
    v_max_f32 v15, 0, v15
    v_cvt_pk_bf16_f32 v12, v12, v13
    v_cvt_pk_bf16_f32 v13, v14, v15
    v_max_f32 v1, 0, v1
    v_max_f32 v2, 0, v2
    v_mfma_f32_16x16x16_bf16 v[20:23], v[18:19], v[12:13], 0
    s_add_u32 s93, s93, s94
    v_max_f32 v3, 0, v3
    v_cvt_pk_bf16_f32 v0, v0, v1
    v_cvt_pk_bf16_f32 v1, v2, v3
    v_max_f32 v28, 0, v28
    v_max_f32 v29, 0, v29
    v_mfma_f32_16x16x16_bf16 v[12:15], v[18:19], v[0:1], 0
    s_mov_b32 s61, 1
    v_max_f32 v30, 0, v30
    v_max_f32 v31, 0, v31
    v_cvt_pk_bf16_f32 v28, v28, v29
    v_cvt_pk_bf16_f32 v29, v30, v31
    v_cvt_pk_bf16_f32 v20, v20, v20
    v_lshlrev_b32 v20, 16, v20
    v_mfma_f32_16x16x16_bf16 v[0:3], v[18:19], v[28:29], 0
    s_movk_i32 s4, 112
    v_mul_f32 v20, 0xbfb8aa3b, v20
    v_cvt_pk_bf16_f32 v12, v12, v12
    v_exp_f32 v20, v20
    v_lshlrev_b32 v12, 16, v12
    v_add_f32 v20, 1.0, v20
    v_rcp_f32 v20, v20
    v_mul_f32 v12, 0xbfb8aa3b, v12
    v_cvt_pk_bf16_f32 v20, v20, v20
    v_lshlrev_b32 v20, 16, v20
    v_fma_f32 v20, v20, s84, v132
    s_mov_b32 s5, 0
    s_mov_b32 s6, 0
    ds_write_b32 v124, v20 offset:44032
    v_exp_f32 v12, v12
    v_cvt_pk_bf16_f32 v0, v0, v0
    v_add_f32 v12, 1.0, v12
    v_rcp_f32 v12, v12
    v_lshlrev_b32 v0, 16, v0
    v_cvt_pk_bf16_f32 v12, v12, v12
    v_lshlrev_b32 v12, 16, v12
    v_fma_f32 v12, v12, s84, v132
    s_mov_b32 s12, 0
    s_mov_b32 s64, 3
    ds_write_b32 v124, v12 offset:44036
    v_mul_f32 v0, 0xbfb8aa3b, v0
    v_exp_f32 v0, v0
    v_add_u32 v159, s93, v163
    v_add_f32 v0, 1.0, v0
    v_rcp_f32 v0, v0
    s_mul_i32 s93, s68, 7168
    v_cvt_pk_bf16_f32 v0, v0, v0
    v_lshlrev_b32 v0, 16, v0
    v_fma_f32 v0, v0, s84, v132
    s_add_u32 s93, s93, 135168
    s_mov_b32 s10, 81924
    ds_write_b32 v124, v0 offset:44040
    v_add_u32 v125, s93, v131
    v_mul_u32_u24 v131, 112, v161
    v_add_u32 v124, v131, v125
    v_subrev_u32 v124, 28672, v124
    v_cmp_eq_u32 vcc, 0, v148
    v_add_u32 v131, 16, v125
    v_mov_b32 v167, 0
    v_cndmask_b32 v132, v149, v125, vcc
    v_cmp_eq_u32 vcc, 3, v5
    s_mov_b32 s11, 0x20000
    s_mov_b32 s3, 0x00010001
    v_cndmask_b32 v132, v132, v131, vcc
    v_mul_u32_u24 v131, 1792, v148
    v_lshl_add_u32 v131, v44, 3, v131
    v_lshl_add_u32 v131, v5, 1, v131
    v_add_u32 v131, s93, v131
    v_cmp_gt_u32 vcc, 3, v44
    v_mov_b32 v125, v131
    s_add_u32 s93, s69, 1
    v_cndmask_b32 v131, v149, v131, vcc
    s_mul_i32 s94, s93, 58255
    s_lshr_b32 s94, s94, 22
    s_mul_i32 s94, s94, s63
    s_mul_i32 s56, s93, s62
    s_add_u32 s56, s56, s94
    s_sub_u32 s93, s71, 1
    s_cmp_eq_u32 s68, 0
    s_cselect_b32 s13, s93, -1
    s_cmp_gt_u32 s73, 20
    s_cselect_b32 s13, s13, -1
    s_and_b32 s93, s2, -8
    s_sub_u32 s93, 81920, s93
    s_sub_u32 s8, s38, s93
    s_waitcnt lgkmcnt(0)
    s_barrier
    s_subb_u32 s9, s39, 0
    s_add_u32 s101, s54, 44032
    v_mul_u32_u24 v45, 48, v148
    v_lshl_add_u32 v45, v5, 2, v45
    v_mul_u32_u24 v46, 48, v44
    v_add_u32 v199, 0, v45
    v_mul_u32_u24 v5, 37, v199
    v_lshrrev_b32 v5, 10, v5
    v_mad_u32_u24 v199, v5, 24, v199
    v_add_u32 v199, s101, v199
    v_add_u32 v148, 16, v45
    v_mul_u32_u24 v5, 37, v148
    v_lshrrev_b32 v5, 10, v5
    v_mad_u32_u24 v148, v5, 24, v148
    v_add_u32 v148, s101, v148
    v_add_u32 v5, 32, v45
    v_mul_u32_u24 v156, 37, v5
    v_lshrrev_b32 v156, 10, v156
    v_mad_u32_u24 v5, v156, 24, v5
    v_add_u32 v5, s101, v5
    v_add_u32 v164, 0, v46
    v_mul_u32_u24 v156, 37, v164
    v_lshrrev_b32 v156, 10, v156
    v_mad_u32_u24 v164, v156, 24, v164
    v_add_u32 v169, 4, v46
    v_mul_u32_u24 v156, 37, v169
    v_lshrrev_b32 v156, 10, v156
    v_mad_u32_u24 v169, v156, 24, v169
    v_add_u32 v182, 8, v46
    v_mul_u32_u24 v156, 37, v182
    v_lshrrev_b32 v156, 10, v156
    v_mad_u32_u24 v182, v156, 24, v182
    v_add_u32 v25, 12, v46
    v_mul_u32_u24 v24, 37, v25
    v_lshrrev_b32 v24, 10, v24
    v_mad_u32_u24 v25, v24, 24, v25
    v_add_u32 v170, 16, v46
    v_mul_u32_u24 v24, 37, v170
    v_lshrrev_b32 v24, 10, v24
    v_mad_u32_u24 v170, v24, 24, v170
    v_add_u32 v24, 20, v46
    v_mul_u32_u24 v156, 37, v24
    v_lshrrev_b32 v156, 10, v156
    v_mad_u32_u24 v24, v156, 24, v24
    v_add_u32 v19, 24, v46
    v_mul_u32_u24 v18, 37, v19
    v_lshrrev_b32 v18, 10, v18
    v_mad_u32_u24 v19, v18, 24, v19
    v_add_u32 v179, 28, v46
    v_mul_u32_u24 v18, 37, v179
    v_lshrrev_b32 v18, 10, v18
    v_mad_u32_u24 v179, v18, 24, v179
    v_add_u32 v18, 32, v46
    v_mul_u32_u24 v156, 37, v18
    v_lshrrev_b32 v156, 10, v156
    v_mad_u32_u24 v18, v156, 24, v18
    v_add_u32 v162, 36, v46
    v_mul_u32_u24 v156, 37, v162
    v_lshrrev_b32 v156, 10, v156
    v_mad_u32_u24 v162, v156, 24, v162
    v_add_u32 v156, 40, v46
    v_mul_u32_u24 v160, 37, v156
    v_lshrrev_b32 v160, 10, v160
    v_mad_u32_u24 v156, v160, 24, v156
    v_add_u32 v46, 44, v46
    s_lshr_b32 s93, s68, 1
    s_mul_i32 s93, s93, 30720
    buffer_load_dwordx4 v47, s[32:35], s92 offen offset:2048 lds
    s_add_u32 m0, s90, 24576
    s_mov_b32 s92, 73728
    ds_read_b32 v208, v199
    v_mul_u32_u24 v160, 37, v46
    v_lshrrev_b32 v160, 10, v160
    v_mad_u32_u24 v46, v160, 24, v46
    v_lshl_add_u32 v160, v44, 4, v45
    v_mul_u32_u24 v165, 37, v160
    v_lshrrev_b32 v165, 10, v165
    v_mad_u32_u24 v160, v165, 24, v160
    v_mov_b32 v165, 336
    v_cmp_gt_u32 vcc, 3, v44
    v_sub_u32 v204, v199, v164
    s_and_b32 s94, s68, 1
    v_cndmask_b32 v160, v165, v160, vcc
    v_sub_u32 v160, s101, v160
    s_mul_i32 s94, s94, -2304
    s_add_u32 s93, s93, s94
    ds_read_b32 v204, v204 offset:336
    v_sub_u32 v205, v199, v169
    v_sub_u32 v206, v199, v182
    s_lshl_b32 s94, s97, 4
    buffer_load_dwordx4 v168, s[32:35], s92 offen offset:0 lds
    ds_read_b32 v205, v205 offset:336
    v_sub_u32 v207, v199, v25
    v_sub_u32 v200, v199, v170
    v_sub_u32 v201, v199, v24
    v_sub_u32 v202, v199, v19
    v_sub_u32 v203, v199, v179
    ds_read_b32 v206, v206 offset:336
    buffer_load_dwordx4 v157, s[32:35], s92 offen offset:1024 lds
    v_sub_u32 v196, v199, v18
    v_sub_u32 v197, v199, v162
    v_sub_u32 v198, v199, v156
    v_sub_u32 v199, v199, v46
    ds_read_b32 v207, v207 offset:336
    v_sub_u32 v192, v148, v164
    v_sub_u32 v193, v148, v169
    v_sub_u32 v194, v148, v182
    v_sub_u32 v195, v148, v25
    v_sub_u32 v188, v148, v170
    ds_read_b32 v200, v200 offset:336
    v_sub_u32 v189, v148, v24
    v_sub_u32 v190, v148, v19
    v_sub_u32 v191, v148, v179
    v_sub_u32 v184, v148, v18
    v_sub_u32 v185, v148, v162
    ds_read_b32 v201, v201 offset:336
    buffer_load_dwordx4 v47, s[32:35], s92 offen offset:2048 lds
    s_add_u32 m0, s90, 36864
    s_mov_b32 s92, 110592
    v_sub_u32 v186, v148, v156
    v_sub_u32 v187, v148, v46
    ds_read_b32 v202, v202 offset:336
    v_sub_u32 v180, v5, v164
    v_sub_u32 v181, v5, v169
    v_sub_u32 v182, v5, v182
    v_sub_u32 v183, v5, v25
    v_sub_u32 v176, v5, v170
    s_waitcnt vmcnt(9)
    s_barrier
    ds_read_b32 v203, v203 offset:336
    v_sub_u32 v177, v5, v24
    v_sub_u32 v178, v5, v19
    v_sub_u32 v179, v5, v179
    v_sub_u32 v172, v5, v18
    v_sub_u32 v173, v5, v162
    ds_read_b32 v196, v196 offset:336
    v_sub_u32 v174, v5, v156
    v_sub_u32 v175, v5, v46
    v_mov_b32 v156, 0xf149f2ca
    v_and_b32 v24, 8, v161
    v_add_u32 v24, v24, v161
    ds_read_b32 v197, v197 offset:336
    buffer_load_dwordx4 v168, s[32:35], s92 offen offset:0 lds
    v_mul_u32_u24 v24, 96, v24
    v_add_u32 v24, s90, v24
    v_lshl_add_u32 v25, v44, 4, v24
    v_lshl_add_u32 v24, v44, 3, v24
    ds_read_b32 v198, v198 offset:336
    v_add_u32 v19, s93, v25
    v_add_u32 v18, s93, v24
    v_lshlrev_b32 v162, 4, v44
    v_add_u32 v162, 4608, v162
    s_lshr_b32 s93, s68, 1
    s_mul_i32 s93, s93, 5120
    ds_read_b32 v199, v199 offset:336
    s_add_u32 s93, s93, s94
    v_add_u32 v46, s93, v162
    v_cmp_eq_u32 vcc, 0, v161
    buffer_load_dwordx4 v157, s[32:35], s92 offen offset:1024 lds
    ds_read_b32 v211, v160 offset:672
    v_cndmask_b32 v46, v149, v46, vcc
    ds_read_b32 v192, v192 offset:336
    ds_read_b32 v193, v193 offset:336
    ds_read_b32 v194, v194 offset:336
    buffer_load_dwordx4 v47, s[32:35], s92 offen offset:2048 lds
    s_add_u32 m0, s90, 49152
    s_mov_b32 s92, 147456
    ds_read_b32 v195, v195 offset:336
    ds_read_b32 v188, v188 offset:336
    ds_read_b32 v189, v189 offset:336
    buffer_load_dwordx4 v168, s[32:35], s92 offen offset:0 lds
    ds_read_b32 v190, v190 offset:336
    ds_read_b32 v191, v191 offset:336
    ds_read_b32 v184, v184 offset:336
    buffer_load_dwordx4 v157, s[32:35], s92 offen offset:1024 lds
    ds_read_b32 v185, v185 offset:336
    ds_read_b32 v186, v186 offset:336
    ds_read_b32 v187, v187 offset:336
    ds_read_b32 v209, v148
    buffer_load_dwordx4 v47, s[32:35], s92 offen offset:2048 lds
    s_add_u32 m0, s90, 61440
    s_mov_b32 s92, 184320
    ds_read_b32 v180, v180 offset:336
    ds_read_b32 v181, v181 offset:336
    ds_read_b32 v182, v182 offset:336
    buffer_load_dwordx4 v168, s[32:35], s92 offen offset:0 lds
    ds_read_b32 v183, v183 offset:336
    ds_read_b32 v176, v176 offset:336
    ds_read_b32 v177, v177 offset:336
    buffer_load_dwordx4 v157, s[32:35], s92 offen offset:1024 lds
    ds_read_b32 v178, v178 offset:336
    ds_read_b32 v179, v179 offset:336
    ds_read_b32 v172, v172 offset:336
    ds_read_b32 v173, v173 offset:336
    buffer_load_dwordx4 v47, s[32:35], s92 offen offset:2048 lds
    ds_read_b32 v174, v174 offset:336
    ds_read_b32 v175, v175 offset:336
    ds_read_b32 v210, v5
    s_waitcnt vmcnt(15)
    ds_read_b64_tr_b16 a[0:1], v7 offset:0
    ds_read_b64_tr_b16 a[2:3], v7 offset:768
    ds_read_b64_tr_b16 a[24:25], v7 offset:32
    ds_read_b64_tr_b16 a[26:27], v7 offset:800
    ds_read_b64_tr_b16 a[48:49], v7 offset:64
    ds_read_b64_tr_b16 a[50:51], v7 offset:832
    s_add_u32 m0, s90, 0
    s_mov_b32 s92, 384
    s_waitcnt vmcnt(12)
    ds_read_b64_tr_b16 a[4:5], v7 offset:12288
    ds_read_b64_tr_b16 a[6:7], v7 offset:13056
    ds_read_b64_tr_b16 a[28:29], v7 offset:12320
    ds_read_b64_tr_b16 a[30:31], v7 offset:13088
    ds_read_b64_tr_b16 a[52:53], v7 offset:12352
    ds_read_b64_tr_b16 a[54:55], v7 offset:13120
    s_waitcnt vmcnt(9)
    ds_read_b64_tr_b16 a[8:9], v7 offset:24576
    ds_read_b64_tr_b16 a[10:11], v7 offset:25344
    ds_read_b64_tr_b16 a[32:33], v7 offset:24608
    s_waitcnt lgkmcnt(15)
    s_cmp_ge_u32 s2, 248
    s_cbranch_scc1 L_maskS
L_nomaskS:
    v_cmp_gt_u32 vcc, 16, v4
    v_readlane_b32 s84, v211, 48
    ds_read_b64_tr_b16 a[34:35], v7 offset:25376
    v_cndmask_b32 v208, v156, v208, vcc
    v_cndmask_b32 v209, v156, v209, vcc
    v_cndmask_b32 v210, v156, v210, vcc
    v_cmp_gt_u32 vcc, 49, v4
    ds_read_b64_tr_b16 a[56:57], v7 offset:24640
    s_waitcnt lgkmcnt(10)
    buffer_load_dwordx4 v168, s[32:35], s92 offen offset:0 lds
    ds_read_b64_tr_b16 a[58:59], v7 offset:25408
    v_cndmask_b32 v211, v156, v211, vcc
    s_waitcnt vmcnt(7)
    ds_read_b64_tr_b16 a[12:13], v7 offset:36864
    ds_read_b64_tr_b16 a[14:15], v7 offset:37632
    buffer_load_dwordx4 v157, s[32:35], s92 offen offset:1024 lds
    ds_read_b64_tr_b16 a[36:37], v7 offset:36896
    ds_read_b64_tr_b16 a[38:39], v7 offset:37664
    ds_read_b64_tr_b16 a[60:61], v7 offset:36928
    ds_read_b64_tr_b16 a[62:63], v7 offset:37696
    buffer_load_dwordx4 v47, s[32:35], s92 offen offset:2048 lds
    s_add_u32 m0, s90, 12288
    s_mov_b32 s92, 37248
    ds_read_b128 v[64:67], v147 offset:40960
    ds_read_b128 v[60:63], v146 offset:40960
    s_waitcnt lgkmcnt(10)
    buffer_load_dwordx4 v168, s[32:35], s92 offen offset:0 lds
    ds_read_b128 v[56:59], v147 offset:41088
    ds_read_b128 v[52:55], v146 offset:41088
    buffer_load_dwordx4 v157, s[32:35], s92 offen offset:1024 lds
    ds_read_b128 v[40:43], v147 offset:41216
    ds_read_b128 v[0:3], v146 offset:41216
    buffer_load_dwordx4 v47, s[32:35], s92 offen offset:2048 lds
    s_add_u32 m0, s90, 24576
    s_mov_b32 s92, 74112
    s_waitcnt vmcnt(9)
    ds_read_b64_tr_b16 a[16:17], v7 offset:49152
    ds_read_b64_tr_b16 a[18:19], v7 offset:49920
    ds_read_b64_tr_b16 a[40:41], v7 offset:49184
    ds_read_b64_tr_b16 a[42:43], v7 offset:49952
    ds_read_b64_tr_b16 a[64:65], v7 offset:49216
    ds_read_b64_tr_b16 a[66:67], v7 offset:49984
    s_waitcnt lgkmcnt(6)
    buffer_load_dwordx4 v168, s[32:35], s92 offen offset:0 lds
    buffer_load_dwordx4 v157, s[32:35], s92 offen offset:1024 lds
    buffer_load_dwordx4 v47, s[32:35], s92 offen offset:2048 lds
    s_add_u32 m0, s90, 36864
    s_mov_b32 s92, 110976
    s_waitcnt vmcnt(9)
    ds_read_b64_tr_b16 a[20:21], v7 offset:61440
    ds_read_b64_tr_b16 a[22:23], v7 offset:62208
    v_mfma_f32_16x16x32_bf16 v[72:75], a[0:3], v[64:67], 0
    ds_read_b64_tr_b16 a[44:45], v7 offset:61472
    v_mfma_f32_16x16x32_bf16 v[72:75], a[4:7], v[60:63], v[72:75]
    ds_read_b64_tr_b16 a[46:47], v7 offset:62240
    v_mfma_f32_16x16x32_bf16 v[72:75], a[8:11], v[56:59], v[72:75]
    ds_read_b64_tr_b16 a[68:69], v7 offset:61504
    v_mfma_f32_16x16x32_bf16 v[72:75], a[12:15], v[52:55], v[72:75]
    s_waitcnt lgkmcnt(5)
    ds_read_b64_tr_b16 a[70:71], v7 offset:62272
    v_mfma_f32_16x16x32_bf16 v[72:75], a[16:19], v[40:43], v[72:75]
    ds_read_b128 v[48:51], v147 offset:42496
    ds_read_b128 v[36:39], v146 offset:42496
    ds_read_b128 v[32:35], v147 offset:42624
    ds_read_b128 v[28:31], v146 offset:42624
    s_waitcnt lgkmcnt(7)
    v_mfma_f32_16x16x32_bf16 v[72:75], a[20:23], v[0:3], v[72:75]
    ds_read_b128 v[20:23], v147 offset:42752
    s_nop 0
    v_mfma_f32_16x16x32_bf16 v[92:95], a[24:27], v[64:67], 0
    s_nop 0
    ds_read_b128 v[12:15], v146 offset:42752
    s_nop 0
    v_mfma_f32_16x16x32_bf16 v[92:95], a[28:31], v[60:63], v[92:95]
    s_nop 0
    v_fma_f32 v170, v72, v72, s41
    v_fmac_f32 v170, v73, v73
    v_mfma_f32_16x16x32_bf16 v[92:95], a[32:35], v[56:59], v[92:95]
    v_fmac_f32 v170, v74, v74
    v_fmac_f32 v170, v75, v75
    v_mfma_f32_16x16x32_bf16 v[92:95], a[36:39], v[52:55], v[92:95]
    v_mfma_f32_16x16x32_bf16 v[92:95], a[40:43], v[40:43], v[92:95]
    s_waitcnt lgkmcnt(4)
    buffer_load_dwordx4 v168, s[32:35], s92 offen offset:0 lds
    v_mfma_f32_16x16x32_bf16 v[92:95], a[44:47], v[0:3], v[92:95]
    s_nop 1
    v_mfma_f32_16x16x32_bf16 v[88:91], a[48:51], v[64:67], 0
    s_nop 2
    v_mfma_f32_16x16x32_bf16 v[88:91], a[52:55], v[60:63], v[88:91]
    s_nop 0
    v_fmac_f32 v170, v92, v92
    v_fmac_f32 v170, v93, v93
    v_mfma_f32_16x16x32_bf16 v[88:91], a[56:59], v[56:59], v[88:91]
    v_fmac_f32 v170, v94, v94
    v_fmac_f32 v170, v95, v95
    v_mfma_f32_16x16x32_bf16 v[88:91], a[60:63], v[52:55], v[88:91]
    buffer_load_dwordx4 v157, s[32:35], s92 offen offset:1024 lds
    v_mfma_f32_16x16x32_bf16 v[88:91], a[64:67], v[40:43], v[88:91]
    v_mfma_f32_16x16x32_bf16 v[88:91], a[68:71], v[0:3], v[88:91]
    s_nop 0
    v_mfma_f32_16x16x32_bf16 v[0:3], a[0:3], v[48:51], 0
    s_nop 2
    v_mfma_f32_16x16x32_bf16 v[0:3], a[4:7], v[36:39], v[0:3]
    s_waitcnt lgkmcnt(0)
    s_nop 0
    v_fmac_f32 v170, v88, v88
    v_fmac_f32 v170, v89, v89
    v_mfma_f32_16x16x32_bf16 v[0:3], a[8:11], v[32:35], v[0:3]
    v_fmac_f32 v170, v90, v90
    v_fmac_f32 v170, v91, v91
    v_mfma_f32_16x16x32_bf16 v[0:3], a[12:15], v[28:31], v[0:3]
    s_waitcnt vmcnt(8)
    buffer_load_dwordx4 v47, s[32:35], s92 offen offset:2048 lds
    ds_read_b64_tr_b16 a[72:73], v7 offset:0
    v_mfma_f32_16x16x32_bf16 v[0:3], a[16:19], v[20:23], v[0:3]
    s_add_u32 m0, s90, 49152
    ds_read_b64_tr_b16 a[74:75], v7 offset:768
    v_mfma_f32_16x16x32_bf16 v[0:3], a[20:23], v[12:15], v[0:3]
    s_mov_b32 s92, 147840
    ds_read_b64_tr_b16 a[96:97], v7 offset:32
    v_mfma_f32_16x16x32_bf16 v[60:63], a[24:27], v[48:51], 0
    ds_read_b64_tr_b16 a[98:99], v7 offset:800
    v_mfma_f32_16x16x32_bf16 v[60:63], a[28:31], v[36:39], v[60:63]
    ds_read_b64_tr_b16 a[120:121], v7 offset:64
    buffer_load_dwordx4 v168, s[32:35], s92 offen offset:0 lds
    v_mfma_f32_16x16x32_bf16 v[60:63], a[32:35], v[32:35], v[60:63]
    ds_read_b64_tr_b16 a[122:123], v7 offset:832
    v_fma_f32 v169, v0, v0, s41
    v_mfma_f32_16x16x32_bf16 v[60:63], a[36:39], v[28:31], v[60:63]
    ds_read_b128 v[100:103], v147 offset:40960
    v_fmac_f32 v169, v1, v1
    v_mfma_f32_16x16x32_bf16 v[60:63], a[40:43], v[20:23], v[60:63]
    ds_read_b128 v[68:71], v146 offset:40960
    v_fmac_f32 v169, v2, v2
    v_mfma_f32_16x16x32_bf16 v[60:63], a[44:47], v[12:15], v[60:63]
    ds_read_b128 v[56:59], v147 offset:41088
    v_fmac_f32 v169, v3, v3
    v_mfma_f32_16x16x32_bf16 v[40:43], a[48:51], v[48:51], 0
    ds_read_b128 v[52:55], v146 offset:41088
    buffer_load_dwordx4 v157, s[32:35], s92 offen offset:1024 lds
    v_mfma_f32_16x16x32_bf16 v[40:43], a[52:55], v[36:39], v[40:43]
    s_nop 0
    ds_read_b128 v[48:51], v147 offset:41216
    v_fmac_f32 v169, v60, v60
    v_mfma_f32_16x16x32_bf16 v[40:43], a[56:59], v[32:35], v[40:43]
    ds_read_b128 v[32:35], v146 offset:41216
    v_fmac_f32 v169, v61, v61
    v_mfma_f32_16x16x32_bf16 v[40:43], a[60:63], v[28:31], v[40:43]
    v_fmac_f32 v169, v62, v62
    v_fmac_f32 v169, v63, v63
    v_mfma_f32_16x16x32_bf16 v[40:43], a[64:67], v[20:23], v[40:43]
    v_mfma_f32_16x16x32_bf16 v[40:43], a[68:71], v[12:15], v[40:43]
    s_waitcnt vmcnt(8)
    buffer_load_dwordx4 v47, s[32:35], s92 offen offset:2048 lds
    ds_read_b64_tr_b16 a[76:77], v7 offset:12288
    s_add_u32 m0, s90, 61440
    s_mov_b32 s92, 184704
    ds_read_b64_tr_b16 a[78:79], v7 offset:13056
    s_nop 0
    ds_read_b64_tr_b16 a[100:101], v7 offset:12320
    v_fmac_f32 v169, v40, v40
    ds_read_b64_tr_b16 a[102:103], v7 offset:13088
    v_fmac_f32 v169, v41, v41
    ds_read_b64_tr_b16 a[124:125], v7 offset:12352
    v_fmac_f32 v169, v42, v42
    ds_read_b64_tr_b16 a[126:127], v7 offset:13120
    v_fmac_f32 v169, v43, v43
    buffer_load_dwordx4 v168, s[32:35], s92 offen offset:0 lds
    buffer_load_dwordx4 v157, s[32:35], s92 offen offset:1024 lds
    buffer_load_dwordx4 v47, s[32:35], s92 offen offset:2048 lds
    s_add_u32 m0, s90, 0
    s_mov_b32 s92, 768
    s_waitcnt vmcnt(9)
    ds_read_b64_tr_b16 a[80:81], v7 offset:24576
    ds_read_b64_tr_b16 a[82:83], v7 offset:25344
    ds_read_b64_tr_b16 a[104:105], v7 offset:24608
    ds_read_b64_tr_b16 a[106:107], v7 offset:25376
    ds_read_b64_tr_b16 a[128:129], v7 offset:24640
    ds_read_b64_tr_b16 a[130:131], v7 offset:25408
    s_waitcnt lgkmcnt(6)
    buffer_load_dwordx4 v168, s[32:35], s92 offen offset:0 lds
    buffer_load_dwordx4 v157, s[32:35], s92 offen offset:1024 lds
    buffer_load_dwordx4 v47, s[32:35], s92 offen offset:2048 lds
    s_add_u32 m0, s90, 12288
    s_mov_b32 s92, 37632
    s_waitcnt vmcnt(9)
    ds_read_b64_tr_b16 a[84:85], v7 offset:36864
    ds_read_b64_tr_b16 a[86:87], v7 offset:37632
    ds_read_b64_tr_b16 a[108:109], v7 offset:36896
    ds_read_b64_tr_b16 a[110:111], v7 offset:37664
    ds_read_b64_tr_b16 a[132:133], v7 offset:36928
    ds_read_b64_tr_b16 a[134:135], v7 offset:37696
    buffer_load_dwordx4 v168, s[32:35], s92 offen offset:0 lds
    buffer_load_dwordx4 v157, s[32:35], s92 offen offset:1024 lds
    buffer_load_dwordx4 v47, s[32:35], s92 offen offset:2048 lds
    s_add_u32 m0, s90, 24576
    s_mov_b32 s92, 74496
    s_waitcnt vmcnt(9)
    ds_read_b64_tr_b16 a[88:89], v7 offset:49152
    ds_read_b64_tr_b16 a[90:91], v7 offset:49920
    ds_read_b64_tr_b16 a[112:113], v7 offset:49184
    ds_read_b64_tr_b16 a[114:115], v7 offset:49952
    ds_read_b64_tr_b16 a[136:137], v7 offset:49216
    ds_read_b64_tr_b16 a[138:139], v7 offset:49984
    s_waitcnt lgkmcnt(6)
    buffer_load_dwordx4 v168, s[32:35], s92 offen offset:0 lds
    buffer_load_dwordx4 v157, s[32:35], s92 offen offset:1024 lds
    buffer_load_dwordx4 v47, s[32:35], s92 offen offset:2048 lds
    s_add_u32 m0, s90, 36864
    s_mov_b32 s92, 111360
    s_waitcnt vmcnt(9)
    ds_read_b64_tr_b16 a[92:93], v7 offset:61440
    ds_read_b64_tr_b16 a[94:95], v7 offset:62208
    v_mfma_f32_16x16x32_bf16 v[36:39], a[72:75], v[100:103], 0
    ds_read_b64_tr_b16 a[116:117], v7 offset:61472
    v_mfma_f32_16x16x32_bf16 v[36:39], a[76:79], v[68:71], v[36:39]
    ds_read_b64_tr_b16 a[118:119], v7 offset:62240
    v_mfma_f32_16x16x32_bf16 v[36:39], a[80:83], v[56:59], v[36:39]
    ds_read_b64_tr_b16 a[140:141], v7 offset:61504
    v_mfma_f32_16x16x32_bf16 v[36:39], a[84:87], v[52:55], v[36:39]
    s_waitcnt lgkmcnt(5)
    buffer_load_dwordx4 v168, s[32:35], s92 offen offset:0 lds
    ds_read_b64_tr_b16 a[142:143], v7 offset:62272
    v_mfma_f32_16x16x32_bf16 v[36:39], a[88:91], v[48:51], v[36:39]
    ds_read_b128 v[96:99], v147 offset:42496
    ds_read_b128 v[80:83], v146 offset:42496
    ds_read_b128 v[28:31], v147 offset:42624
    ds_read_b128 v[20:23], v146 offset:42624
    s_waitcnt lgkmcnt(7)
    v_mfma_f32_16x16x32_bf16 v[36:39], a[92:95], v[32:35], v[36:39]
    buffer_load_dwordx4 v157, s[32:35], s92 offen offset:1024 lds
    ds_read_b128 v[64:67], v147 offset:42752
    v_mfma_f32_16x16x32_bf16 v[84:87], a[96:99], v[100:103], 0
    s_nop 1
    ds_read_b128 v[12:15], v146 offset:42752
    v_mfma_f32_16x16x32_bf16 v[84:87], a[100:103], v[68:71], v[84:87]
    s_nop 0
    v_fma_f32 v156, v36, v36, s41
    v_fmac_f32 v156, v37, v37
    v_mfma_f32_16x16x32_bf16 v[84:87], a[104:107], v[56:59], v[84:87]
    v_fmac_f32 v156, v38, v38
    v_fmac_f32 v156, v39, v39
    v_mfma_f32_16x16x32_bf16 v[84:87], a[108:111], v[52:55], v[84:87]
    v_mfma_f32_16x16x32_bf16 v[84:87], a[112:115], v[48:51], v[84:87]
    s_waitcnt vmcnt(8) lgkmcnt(4)
    buffer_load_dwordx4 v47, s[32:35], s92 offen offset:2048 lds
    ds_read_b64_tr_b16 a[144:145], v6 offset:0
    v_mfma_f32_16x16x32_bf16 v[84:87], a[116:119], v[32:35], v[84:87]
    s_add_u32 m0, s90, 49152
    ds_read_b64_tr_b16 a[146:147], v6 offset:768
    v_mfma_f32_16x16x32_bf16 v[76:79], a[120:123], v[100:103], 0
    s_mov_b32 s92, 148224
    s_nop 0
    ds_read_b64_tr_b16 a[168:169], v6 offset:8
    v_mfma_f32_16x16x32_bf16 v[76:79], a[124:127], v[68:71], v[76:79]
    s_nop 0
    v_fmac_f32 v156, v84, v84
    v_fmac_f32 v156, v85, v85
    v_mfma_f32_16x16x32_bf16 v[76:79], a[128:131], v[56:59], v[76:79]
    ds_read_b64_tr_b16 a[170:171], v6 offset:776
    v_fmac_f32 v156, v86, v86
    v_mfma_f32_16x16x32_bf16 v[76:79], a[132:135], v[52:55], v[76:79]
    buffer_load_dwordx4 v168, s[32:35], s92 offen offset:0 lds
    ds_read_b64_tr_b16 a[192:193], v7 offset:64
    v_mfma_f32_16x16x32_bf16 v[76:79], a[136:139], v[48:51], v[76:79]
    ds_read_b64_tr_b16 a[194:195], v7 offset:832
    v_fmac_f32 v156, v87, v87
    v_mfma_f32_16x16x32_bf16 v[76:79], a[140:143], v[32:35], v[76:79]
    s_nop 0
    v_mfma_f32_16x16x32_bf16 v[56:59], a[72:75], v[96:99], 0
    s_nop 2
    v_mfma_f32_16x16x32_bf16 v[56:59], a[76:79], v[80:83], v[56:59]
    s_waitcnt lgkmcnt(5)
    s_nop 0
    v_fmac_f32 v156, v76, v76
    v_fmac_f32 v156, v77, v77
    v_mfma_f32_16x16x32_bf16 v[56:59], a[80:83], v[28:31], v[56:59]
    buffer_load_dwordx4 v157, s[32:35], s92 offen offset:1024 lds
    v_fmac_f32 v156, v78, v78
    v_mfma_f32_16x16x32_bf16 v[56:59], a[84:87], v[20:23], v[56:59]
    v_fmac_f32 v156, v79, v79
    v_cvt_pk_bf16_f32 v170, v170, v156
    v_mfma_f32_16x16x32_bf16 v[56:59], a[88:91], v[64:67], v[56:59]
    v_mfma_f32_16x16x32_bf16 v[56:59], a[92:95], v[12:15], v[56:59]
    ds_read_b128 v[68:71], v147 offset:40960
    v_mfma_f32_16x16x32_bf16 v[52:55], a[96:99], v[96:99], 0
    ds_read_b128 v[32:35], v146 offset:40960
    v_mfma_f32_16x16x32_bf16 v[52:55], a[100:103], v[80:83], v[52:55]
    s_waitcnt vmcnt(8)
    buffer_load_dwordx4 v47, s[32:35], s92 offen offset:2048 lds
    ds_read_b64_tr_b16 a[148:149], v6 offset:12288
    v_mfma_f32_16x16x32_bf16 v[52:55], a[104:107], v[28:31], v[52:55]
    s_add_u32 m0, s90, 61440
    v_fma_f32 v156, v56, v56, s41
    v_fmac_f32 v156, v57, v57
    v_mfma_f32_16x16x32_bf16 v[52:55], a[108:111], v[20:23], v[52:55]
    s_mov_b32 s92, 185088
    ds_read_b64_tr_b16 a[150:151], v6 offset:13056
    v_fmac_f32 v156, v58, v58
    v_mfma_f32_16x16x32_bf16 v[52:55], a[112:115], v[64:67], v[52:55]
    ds_read_b64_tr_b16 a[172:173], v6 offset:12296
    v_fmac_f32 v156, v59, v59
    v_mfma_f32_16x16x32_bf16 v[52:55], a[116:119], v[12:15], v[52:55]
    ds_read_b64_tr_b16 a[174:175], v6 offset:13064
    v_mfma_f32_16x16x32_bf16 v[48:51], a[120:123], v[96:99], 0
    s_nop 0
    buffer_load_dwordx4 v168, s[32:35], s92 offen offset:0 lds
    ds_read_b64_tr_b16 a[196:197], v7 offset:12352
    v_mfma_f32_16x16x32_bf16 v[48:51], a[124:127], v[80:83], v[48:51]
    s_nop 0
    ds_read_b64_tr_b16 a[198:199], v7 offset:13120
    v_fmac_f32 v156, v52, v52
    v_mfma_f32_16x16x32_bf16 v[48:51], a[128:131], v[28:31], v[48:51]
    ds_read_b128 v[28:31], v147 offset:41088
    v_fmac_f32 v156, v53, v53
    v_mfma_f32_16x16x32_bf16 v[48:51], a[132:135], v[20:23], v[48:51]
    ds_read_b128 v[20:23], v146 offset:41088
    v_fmac_f32 v156, v54, v54
    v_mfma_f32_16x16x32_bf16 v[48:51], a[136:139], v[64:67], v[48:51]
    ds_read_b128 v[64:67], v147 offset:41216
    v_fmac_f32 v156, v55, v55
    v_mfma_f32_16x16x32_bf16 v[48:51], a[140:143], v[12:15], v[48:51]
    s_nop 0
    buffer_load_dwordx4 v157, s[32:35], s92 offen offset:1024 lds
    ds_read_b128 v[12:15], v146 offset:41216
    v_mfma_f32_16x16x16_bf16 v[80:83], v[216:217], v[170:171], 0
    s_nop 0
    v_mov_b32 v44, 0
    v_mov_b32 v45, 0
    v_mov_b32 v149, 0
    v_fmac_f32 v156, v48, v48
    v_fmac_f32 v156, v49, v49
    v_fmac_f32 v156, v50, v50
    v_fmac_f32 v156, v51, v51
    v_rsq_f32 v80, v80
    v_rsq_f32 v81, v81
    v_mul_f32 v80, s55, v80
    v_mul_f32 v81, 0.5, v81
    v_mul_f32 v72, v72, v80
    buffer_load_dwordx4 v47, s[32:35], s92 offen offset:2048 lds
    s_add_u32 m0, s90, 0
    s_mov_b32 s92, 0
    s_waitcnt vmcnt(9)
    ds_read_b64_tr_b16 a[152:153], v6 offset:24576
    v_mul_f32 v73, v73, v80
    v_cvt_pk_f16_f32 v72, v72, v73
    v_mul_f32 v74, v74, v80
    ds_read_b64_tr_b16 a[154:155], v6 offset:25344
    v_mul_f32 v75, v75, v80
    v_cvt_pk_f16_f32 v73, v74, v75
    v_mul_f32 v92, v92, v80
    ds_read_b64_tr_b16 a[176:177], v6 offset:24584
    v_mul_f32 v93, v93, v80
    v_cvt_pk_f16_f32 v74, v92, v93
    s_waitcnt lgkmcnt(3)
    buffer_load_dwordx4 v158, s[76:79], s92 offen offset:0 lds
    ds_read_b64_tr_b16 a[178:179], v6 offset:25352
    v_mul_f32 v94, v94, v80
    v_mul_f32 v95, v95, v80
    v_cvt_pk_f16_f32 v75, v94, v95
    ds_read_b64_tr_b16 a[200:201], v7 offset:24640
    v_mul_f32 v88, v88, v80
    ds_read_b64_tr_b16 a[202:203], v7 offset:25408
    v_mul_f32 v89, v89, v80
    v_cvt_pk_f16_f32 v160, v88, v89
    v_mul_f32 v90, v90, v80
    v_mul_f32 v91, v91, v80
    v_cvt_pk_f16_f32 v161, v90, v91
    v_mul_f32 v36, v36, v81
    buffer_load_dwordx4 v17, s[76:79], s92 offen offset:1024 lds
    v_mul_f32 v37, v37, v81
    v_cvt_pk_f16_f32 v36, v36, v37
    v_mul_f32 v38, v38, v81
    v_mul_f32 v39, v39, v81
    v_cvt_pk_f16_f32 v37, v38, v39
    v_mul_f32 v84, v84, v81
    v_mul_f32 v85, v85, v81
    v_cvt_pk_f16_f32 v38, v84, v85
    v_mul_f32 v86, v86, v81
    v_mul_f32 v87, v87, v81
    v_cvt_pk_f16_f32 v39, v86, v87
    v_mul_f32 v76, v76, v81
    v_mul_f32 v77, v77, v81
    v_cvt_pk_f16_f32 v4, v76, v77
    v_mul_f32 v78, v78, v81
    v_mul_f32 v79, v79, v81
    v_cvt_pk_f16_f32 v5, v78, v79
    buffer_load_dwordx4 v16, s[76:79], s92 offen offset:2048 lds
    s_add_u32 m0, s90, 12288
    s_mov_b32 s92, 12288
    s_waitcnt vmcnt(9)
    ds_read_b64_tr_b16 a[156:157], v6 offset:36864
    v_fma_mix_f32 v148, v72, v36, 0 op_sel:[0,0,0] op_sel_hi:[1,1,0]
    v_fma_mix_f32 v148, v72, v36, v148 op_sel:[1,1,0] op_sel_hi:[1,1,0]
    v_fma_mix_f32 v148, v73, v37, v148 op_sel:[0,0,0] op_sel_hi:[1,1,0]
    ds_read_b64_tr_b16 a[158:159], v6 offset:37632
    v_fma_mix_f32 v148, v73, v37, v148 op_sel:[1,1,0] op_sel_hi:[1,1,0]
    v_fma_mix_f32 v148, v74, v38, v148 op_sel:[0,0,0] op_sel_hi:[1,1,0]
    v_fma_mix_f32 v148, v74, v38, v148 op_sel:[1,1,0] op_sel_hi:[1,1,0]
    ds_read_b64_tr_b16 a[180:181], v6 offset:36872
    v_fma_mix_f32 v148, v75, v39, v148 op_sel:[0,0,0] op_sel_hi:[1,1,0]
    v_fma_mix_f32 v148, v75, v39, v148 op_sel:[1,1,0] op_sel_hi:[1,1,0]
    buffer_load_dwordx4 v158, s[76:79], s92 offen offset:0 lds
    ds_read_b64_tr_b16 a[182:183], v6 offset:37640
    v_fma_mix_f32 v148, v160, v4, v148 op_sel:[0,0,0] op_sel_hi:[1,1,0]
    v_fma_mix_f32 v148, v160, v4, v148 op_sel:[1,1,0] op_sel_hi:[1,1,0]
    v_fma_mix_f32 v148, v161, v5, v148 op_sel:[0,0,0] op_sel_hi:[1,1,0]
    ds_read_b64_tr_b16 a[204:205], v7 offset:36928
    v_fma_mix_f32 v148, v161, v5, v148 op_sel:[1,1,0] op_sel_hi:[1,1,0]
    ds_read_b64_tr_b16 a[206:207], v7 offset:37696
    v_mov_b32 v47, v148
    v_add_u32 v168, 28672, v124
    ds_write_b128 v168, v[36:39]
    buffer_load_dwordx4 v17, s[76:79], s92 offen offset:1024 lds
    v_permlane32_swap_b32 v47, v148
    v_add_f32 v148, v47, v148
    v_mov_b32 v47, v148
    v_cvt_pk_bf16_f32 v170, v169, v156
    s_nop 0
    v_permlane16_swap_b32 v47, v148
    v_mfma_f32_16x16x16_bf16 v[36:39], v[216:217], v[170:171], 0
    s_waitcnt vmcnt(8)
    ds_write2_b64 v168, v[44:45], v[44:45] offset0:2 offset1:3
    v_add_f32 v148, v47, v148
    buffer_load_dwordx4 v16, s[76:79], s92 offen offset:2048 lds
    s_add_u32 m0, s90, 24576
    s_mov_b32 s92, 24576
    v_and_b32 v47, 0xffff0000, v148
    v_sub_f32 v148, v148, v47
    ds_read_b64_tr_b16 a[160:161], v6 offset:49152
    v_cvt_pk_bf16_f32 v148, v148, v47
    v_rsq_f32 v36, v36
    ds_read_b64_tr_b16 a[162:163], v6 offset:49920
    v_rsq_f32 v37, v37
    v_mul_f32 v36, s55, v36
    s_waitcnt lgkmcnt(3)
    buffer_load_dwordx4 v158, s[76:79], s92 offen offset:0 lds
    ds_read_b64_tr_b16 a[184:185], v6 offset:49160
    v_mul_f32 v37, 0.5, v37
    v_mul_f32 v0, v0, v36
    v_mul_f32 v1, v1, v36
    ds_read_b64_tr_b16 a[186:187], v6 offset:49928
    v_cvt_pk_f16_f32 v0, v0, v1
    v_mul_f32 v2, v2, v36
    v_mul_f32 v3, v3, v36
    ds_read_b64_tr_b16 a[208:209], v7 offset:49216
    v_cvt_pk_f16_f32 v1, v2, v3
    ds_read_b64_tr_b16 a[210:211], v7 offset:49984
    v_mul_f32 v60, v60, v36
    buffer_load_dwordx4 v17, s[76:79], s92 offen offset:1024 lds
    ds_write_b128 v168, v[72:75] offset:32
    v_mul_f32 v61, v61, v36
    v_cvt_pk_f16_f32 v2, v60, v61
    v_mul_f32 v62, v62, v36
    v_mul_f32 v63, v63, v36
    v_cvt_pk_f16_f32 v3, v62, v63
    v_mul_f32 v40, v40, v36
    v_mul_f32 v41, v41, v36
    v_cvt_pk_f16_f32 v156, v40, v41
    ds_write2_b64 v168, v[4:5], v[44:45] offset0:6 offset1:7
    buffer_load_dwordx4 v16, s[76:79], s92 offen offset:2048 lds
    s_add_u32 m0, s90, 36864
    s_mov_b32 s92, 36864
    v_mul_f32 v42, v42, v36
    v_mul_f32 v43, v43, v36
    v_cvt_pk_f16_f32 v157, v42, v43
    v_mul_f32 v56, v56, v37
    v_mul_f32 v57, v57, v37
    s_waitcnt vmcnt(9)
    ds_read_b64_tr_b16 a[164:165], v6 offset:61440
    v_cvt_pk_f16_f32 v4, v56, v57
    v_mul_f32 v58, v58, v37
    v_mul_f32 v59, v59, v37
    ds_read_b64_tr_b16 a[166:167], v6 offset:62208
    v_mfma_f32_16x16x32_bf16 v[40:43], a[144:147], v[68:71], 0
    buffer_load_dwordx4 v158, s[76:79], s92 offen offset:0 lds
    ds_read_b64_tr_b16 a[188:189], v6 offset:61448
    v_mfma_f32_16x16x32_bf16 v[40:43], a[148:151], v[32:35], v[40:43]
    v_cvt_pk_f16_f32 v5, v58, v59
    v_mul_f32 v52, v52, v37
    v_mfma_f32_16x16x32_bf16 v[40:43], a[152:155], v[28:31], v[40:43]
    ds_read_b64_tr_b16 a[190:191], v6 offset:62216
    v_mul_f32 v53, v53, v37
    v_mfma_f32_16x16x32_bf16 v[40:43], a[156:159], v[20:23], v[40:43]
    s_waitcnt lgkmcnt(4)
    ds_read_b64_tr_b16 a[212:213], v7 offset:61504
    v_cvt_pk_f16_f32 v6, v52, v53
    v_mfma_f32_16x16x32_bf16 v[40:43], a[160:163], v[64:67], v[40:43]
    ds_read_b64_tr_b16 a[214:215], v7 offset:62272
    v_mul_f32 v54, v54, v37
    v_mul_f32 v55, v55, v37
    v_cvt_pk_f16_f32 v7, v54, v55
    buffer_load_dwordx4 v17, s[76:79], s92 offen offset:1024 lds
    ds_write2_b64 v168, v[44:45], v[160:161] offset0:8 offset1:9
    v_mul_f32 v48, v48, v37
    v_mul_f32 v49, v49, v37
    v_cvt_pk_f16_f32 v160, v48, v49
    v_mul_f32 v50, v50, v37
    s_waitcnt lgkmcnt(5)
    v_mfma_f32_16x16x32_bf16 v[40:43], a[164:167], v[12:15], v[40:43]
    v_mul_f32 v51, v51, v37
    v_cvt_pk_f16_f32 v161, v50, v51
    v_mfma_f32_16x16x32_bf16 v[56:59], a[168:171], v[68:71], 0
    buffer_load_dwordx4 v16, s[76:79], s92 offen offset:2048 lds
    ds_read_b128 v[52:55], v147 offset:42496
    v_mfma_f32_16x16x32_bf16 v[56:59], a[172:175], v[32:35], v[56:59]
    s_add_u32 m0, s90, 49152
    v_fma_mix_f32 v230, v0, v4, 0 op_sel:[0,0,0] op_sel_hi:[1,1,0]
    v_fma_mix_f32 v230, v0, v4, v230 op_sel:[1,1,0] op_sel_hi:[1,1,0]
    v_mfma_f32_16x16x32_bf16 v[56:59], a[176:179], v[28:31], v[56:59]
    s_mov_b32 s92, 49152
    ds_write_b64 v168, v[148:149] offset:88
    v_mfma_f32_16x16x32_bf16 v[56:59], a[180:183], v[20:23], v[56:59]
    s_lshl_b32 s93, s68, 10
    v_fma_mix_f32 v230, v1, v5, v230 op_sel:[0,0,0] op_sel_hi:[1,1,0]
    v_fma_mix_f32 v230, v1, v5, v230 op_sel:[1,1,0] op_sel_hi:[1,1,0]
    v_mfma_f32_16x16x32_bf16 v[56:59], a[184:187], v[64:67], v[56:59]
    s_waitcnt lgkmcnt(3)
    s_mov_b32 s53, s47
    ds_read_b128 v[48:51], v146 offset:42496
    v_fma_mix_f32 v230, v2, v6, v230 op_sel:[0,0,0] op_sel_hi:[1,1,0]
    v_mfma_f32_16x16x32_bf16 v[56:59], a[188:191], v[12:15], v[56:59]
    s_mov_b32 s47, s46
    buffer_load_dwordx4 v158, s[76:79], s92 offen offset:0 lds
    ds_read_b128 v[36:39], v147 offset:42624
    v_mfma_f32_16x16x32_bf16 v[60:63], a[192:195], v[68:71], 0
    s_mov_b32 s46, s45
    v_fma_mix_f32 v230, v2, v6, v230 op_sel:[1,1,0] op_sel_hi:[1,1,0]
    v_fma_mix_f32 v230, v3, v7, v230 op_sel:[0,0,0] op_sel_hi:[1,1,0]
    v_mfma_f32_16x16x32_bf16 v[60:63], a[196:199], v[32:35], v[60:63]
    s_mov_b32 s45, s44
    ds_read_b128 v[32:35], v146 offset:42624
    v_fma_mix_f32 v230, v3, v7, v230 op_sel:[1,1,0] op_sel_hi:[1,1,0]
    v_mfma_f32_16x16x32_bf16 v[60:63], a[200:203], v[28:31], v[60:63]
    s_mov_b32 s44, s53
    ds_read_b128 v[28:31], v147 offset:42752
    v_fma_mix_f32 v230, v156, v160, v230 op_sel:[0,0,0] op_sel_hi:[1,1,0]
    v_mfma_f32_16x16x32_bf16 v[60:63], a[204:207], v[20:23], v[60:63]
    s_sub_u32 s48, s44, s46
    ds_read_b128 v[20:23], v146 offset:42752
    v_fma_mix_f32 v230, v156, v160, v230 op_sel:[1,1,0] op_sel_hi:[1,1,0]
    v_mfma_f32_16x16x32_bf16 v[60:63], a[208:211], v[64:67], v[60:63]
    s_sub_u32 s49, s46, s45
    buffer_load_dwordx4 v17, s[76:79], s92 offen offset:1024 lds
    v_fma_mix_f32 v230, v157, v161, v230 op_sel:[0,0,0] op_sel_hi:[1,1,0]
    v_mfma_f32_16x16x32_bf16 v[60:63], a[212:215], v[12:15], v[60:63]
    s_waitcnt lgkmcnt(5)
    v_fma_mix_f32 v230, v157, v161, v230 op_sel:[1,1,0] op_sel_hi:[1,1,0]
    v_mov_b32 v146, v230
    v_mfma_f32_16x16x32_bf16 v[12:15], a[144:147], v[52:55], 0
    s_waitcnt lgkmcnt(4)
    v_permlane32_swap_b32 v146, v230
    v_add_f32 v230, v146, v230
    v_mfma_f32_16x16x32_bf16 v[12:15], a[148:151], v[48:51], v[12:15]
    s_waitcnt lgkmcnt(3)
    v_mov_b32 v146, v230
    v_cvt_pk_bf16_f32 v148, v40, v41
    v_cvt_pk_bf16_f32 v149, v42, v43
    v_mfma_f32_16x16x32_bf16 v[12:15], a[152:155], v[36:39], v[12:15]
    s_waitcnt lgkmcnt(2)
    ds_write_b64 v124, v[148:149] offset:28752
    buffer_load_dwordx4 v16, s[76:79], s92 offen offset:2048 lds
    s_add_u32 m0, s90, 61440
    v_mfma_f32_16x16x32_bf16 v[12:15], a[156:159], v[32:35], v[12:15]
    s_waitcnt lgkmcnt(2)
    s_mov_b32 s92, 61440
    v_permlane16_swap_b32 v146, v230
    v_mfma_f32_16x16x32_bf16 v[12:15], a[160:163], v[28:31], v[12:15]
    s_waitcnt lgkmcnt(1)
    v_add_f32 v230, v146, v230
    v_and_b32 v146, 0xffff0000, v230
    v_mfma_f32_16x16x32_bf16 v[12:15], a[164:167], v[20:23], v[12:15]
    v_sub_f32 v230, v230, v146
    v_cvt_pk_bf16_f32 v230, v230, v146
    v_mfma_f32_16x16x32_bf16 v[40:43], a[168:171], v[52:55], 0
    v_cvt_pk_bf16_f32 v56, v56, v57
    v_cvt_pk_bf16_f32 v57, v58, v59
    v_mfma_f32_16x16x32_bf16 v[40:43], a[172:175], v[48:51], v[40:43]
    buffer_load_dwordx4 v158, s[76:79], s92 offen offset:0 lds
    v_cvt_pk_bf16_f32 v58, v60, v61
    v_mfma_f32_16x16x32_bf16 v[40:43], a[176:179], v[36:39], v[40:43]
    v_cvt_pk_bf16_f32 v59, v62, v63
    v_cvt_pk_bf16_f32 v246, v12, v13
    v_mfma_f32_16x16x32_bf16 v[40:43], a[180:183], v[32:35], v[40:43]
    ds_write_b128 v124, v[56:59] offset:28768
    v_mfma_f32_16x16x32_bf16 v[40:43], a[184:187], v[28:31], v[40:43]
    v_cvt_pk_bf16_f32 v247, v14, v15
    v_add_u32 v158, s93, v163
    v_mfma_f32_16x16x32_bf16 v[40:43], a[188:191], v[20:23], v[40:43]
    buffer_load_dwordx4 v17, s[76:79], s92 offen offset:1024 lds
    v_add_u32 v137, s48, v137
    v_mfma_f32_16x16x32_bf16 v[12:15], a[192:195], v[52:55], 0
    s_nop 0
    v_add_u32 v136, s48, v136
    s_nop 0
    v_mfma_f32_16x16x32_bf16 v[12:15], a[196:199], v[48:51], v[12:15]
    s_nop 0
    v_cvt_pk_bf16_f32 v76, v40, v41
    v_cvt_pk_bf16_f32 v77, v42, v43
    v_mfma_f32_16x16x32_bf16 v[12:15], a[200:203], v[36:39], v[12:15]
    v_mfma_f32_16x16x32_bf16 v[12:15], a[204:207], v[32:35], v[12:15]
    v_mfma_f32_16x16x32_bf16 v[12:15], a[208:211], v[28:31], v[12:15]
    buffer_load_dwordx4 v16, s[76:79], s92 offen offset:2048 lds
    v_mfma_f32_16x16x32_bf16 v[12:15], a[212:215], v[20:23], v[12:15]
    s_add_u32 m0, s54, 20480
    s_nop 6
    v_cvt_pk_bf16_f32 v78, v12, v13
    v_cvt_pk_bf16_f32 v79, v14, v15
    buffer_load_dwordx4 v130, s[24:27], s56 offen nt lds
    s_add_u32 m0, s54, 21504
    s_nop 0
    buffer_load_dwordx4 v129, s[24:27], s56 offen nt lds
    s_add_u32 m0, s54, 22528
    s_nop 0
    buffer_load_dwordx4 v128, s[24:27], s56 offen nt lds
    s_add_u32 m0, s54, 23552
    s_nop 0
    buffer_load_dwordx4 v127, s[24:27], s56 offen nt lds
    s_add_u32 m0, s54, 24576
    s_nop 0
    buffer_load_dwordx4 v126, s[24:27], s56 offen nt lds
    s_waitcnt vmcnt(5)
    s_barrier
    ds_read_b128 v[32:35], v19 offset:0
    ds_read_b64 v[40:41], v18 offset:64
    ds_read_b128 v[12:15], v19 offset:3072
    ds_read_b64 v[42:43], v18 offset:3136
    ds_read_b128 v[48:51], v19 offset:6144
    ds_read_b64 v[28:29], v18 offset:6208
    ds_read_b128 v[20:23], v19 offset:9216
    ds_read_b64 v[30:31], v18 offset:9280
    ds_read_b128 v[36:39], v19 offset:12288
    ds_read_b64 v[52:53], v18 offset:12352
    ds_read_b128 v[64:67], v19 offset:15360
    ds_read_b64 v[54:55], v18 offset:15424
    s_waitcnt lgkmcnt(11)
    v_mfma_f32_16x16x32_bf16 v[60:63], v[32:35], v[220:223], 0
    s_waitcnt lgkmcnt(9)
    ds_read_b128 v[32:35], v19 offset:18432
    v_mfma_f32_16x16x32_bf16 v[60:63], v[12:15], v[220:223], v[60:63]
    s_waitcnt lgkmcnt(8)
    ds_read_b64 v[12:13], v18 offset:18496
    ds_read_b128 v[56:59], v19 offset:21504
    v_mfma_f32_16x16x32_bf16 v[60:63], v[48:51], v[220:223], v[60:63]
    s_waitcnt lgkmcnt(8)
    ds_read_b64 v[14:15], v18 offset:21568
    ds_read_b128 v[48:51], v19 offset:24576
    v_mfma_f32_16x16x32_bf16 v[60:63], v[20:23], v[220:223], v[60:63]
    ds_read_b64 v[20:21], v18 offset:24640
    v_mfma_f32_16x16x32_bf16 v[60:63], v[40:43], v[220:223], v[60:63]
    s_waitcnt lgkmcnt(9)
    ds_read_b128 v[40:43], v19 offset:27648
    v_mfma_f32_16x16x32_bf16 v[60:63], v[28:31], v[220:223], v[60:63]
    ds_read_b64 v[22:23], v18 offset:27712
    v_mfma_f32_16x16x32_bf16 v[28:31], v[36:39], v[220:223], 0
    s_waitcnt lgkmcnt(8)
    ds_read_b128 v[36:39], v19 offset:30720
    v_mfma_f32_16x16x32_bf16 v[28:31], v[64:67], v[220:223], v[28:31]
    s_waitcnt lgkmcnt(8)
    s_nop 0
    ds_read_b64 v[16:17], v18 offset:30784
    v_mul_f32 v60, 0xbbaaaaab, v60
    v_mfma_f32_16x16x32_bf16 v[28:31], v[32:35], v[220:223], v[28:31]
    s_waitcnt lgkmcnt(7)
    ds_read_b128 v[32:35], v19 offset:33792
    v_mul_f32 v61, 0xbbaaaaab, v61
    v_mul_f32 v62, 0xbbaaaaab, v62
    v_mul_f32 v63, 0xbbaaaaab, v63
    v_mfma_f32_16x16x32_bf16 v[28:31], v[56:59], v[220:223], v[28:31]
    ds_write_b128 v46, v[60:63] offset:0
    v_mfma_f32_16x16x32_bf16 v[28:31], v[52:55], v[220:223], v[28:31]
    s_waitcnt lgkmcnt(6)
    v_mfma_f32_16x16x32_bf16 v[28:31], v[12:15], v[220:223], v[28:31]
    v_mfma_f32_16x16x32_bf16 v[12:15], v[48:51], v[220:223], 0
    s_waitcnt lgkmcnt(4)
    ds_read_b64 v[18:19], v18 offset:33856
    s_nop 0
    v_mfma_f32_16x16x32_bf16 v[12:15], v[40:43], v[220:223], v[12:15]
    s_waitcnt lgkmcnt(4)
    s_nop 0
    ds_read_b128 v[40:43], v25 offset:0
    v_mul_f32 v28, 0xbbaaaaab, v28
    v_mfma_f32_16x16x32_bf16 v[12:15], v[36:39], v[220:223], v[12:15]
    s_waitcnt lgkmcnt(3)
    ds_read_b64 v[44:45], v24 offset:64
    v_mul_f32 v29, 0xbbaaaaab, v29
    v_mul_f32 v30, 0xbbaaaaab, v30
    v_mul_f32 v31, 0xbbaaaaab, v31
    v_mfma_f32_16x16x32_bf16 v[12:15], v[32:35], v[220:223], v[12:15]
    ds_write_b128 v46, v[28:31] offset:128
    v_mfma_f32_16x16x32_bf16 v[12:15], v[20:23], v[220:223], v[12:15]
    ds_read_b128 v[62:65], v25 offset:768
    ds_read_b64 v[66:67], v24 offset:832
    ds_read_b128 v[56:59], v25 offset:12288
    s_waitcnt lgkmcnt(6)
    v_mfma_f32_16x16x32_bf16 v[12:15], v[16:19], v[220:223], v[12:15]
    s_nop 0
    ds_read_b64 v[60:61], v24 offset:12352
    s_nop 0
    ds_read_b128 v[102:105], v25 offset:13056
    s_nop 2
    ds_read_b64 v[106:107], v24 offset:13120
    v_mul_f32 v12, 0xbbaaaaab, v12
    v_mul_f32 v13, 0xbbaaaaab, v13
    v_mul_f32 v14, 0xbbaaaaab, v14
    v_mul_f32 v15, 0xbbaaaaab, v15
    ds_write_b128 v46, v[12:15] offset:256
    s_waitcnt lgkmcnt(0)
    s_barrier
    ds_read_b128 v[12:15], v162 offset:0
    ds_read_b128 v[28:31], v162 offset:64
    ds_read_b128 v[36:39], v162 offset:128
    ds_read_b128 v[16:19], v162 offset:192
    s_waitcnt lgkmcnt(3)
    v_mfma_f32_16x16x16_bf16 v[32:35], v[40:41], v[26:27], v[12:15]
    v_mfma_f32_16x16x16_bf16 v[20:23], v[42:43], v[26:27], v[12:15]
    s_nop 2
    v_mfma_f32_16x16x16_bf16 v[52:55], v[44:45], v[26:27], v[12:15]
    s_waitcnt lgkmcnt(0)
    s_nop 0
    ds_read_b128 v[96:99], v25 offset:24576
    v_cvt_pk_bf16_f32 v32, v32, v33
    v_mfma_f32_16x16x16_bf16 v[12:15], v[62:63], v[26:27], v[28:31]
    ds_read_b64 v[100:101], v24 offset:24640
    v_accvgpr_write_b32 a216, v32
    v_mfma_f32_16x16x16_bf16 v[48:51], v[64:65], v[26:27], v[28:31]
    ds_read_b128 v[40:43], v162 offset:256
    v_cvt_pk_bf16_f32 v34, v34, v35
    v_mfma_f32_16x16x16_bf16 v[44:47], v[66:67], v[26:27], v[28:31]
    ds_read_b128 v[90:93], v25 offset:25344
    v_accvgpr_write_b32 a217, v34
    v_mfma_f32_16x16x16_bf16 v[80:83], v[56:57], v[26:27], v[36:39]
    ds_read_b64 v[94:95], v24 offset:25408
    v_cvt_pk_bf16_f32 v20, v20, v21
    v_mfma_f32_16x16x16_bf16 v[32:35], v[58:59], v[26:27], v[36:39]
    ds_read_b128 v[68:71], v162 offset:320
    v_accvgpr_write_b32 a240, v20
    v_mfma_f32_16x16x16_bf16 v[28:31], v[60:61], v[26:27], v[36:39]
    ds_read_b128 v[84:87], v25 offset:36864
    v_cvt_pk_bf16_f32 v22, v22, v23
    v_mfma_f32_16x16x16_bf16 v[60:63], v[102:103], v[26:27], v[16:19]
    ds_read_b64 v[88:89], v24 offset:36928
    v_accvgpr_write_b32 a241, v22
    v_mfma_f32_16x16x16_bf16 v[36:39], v[104:105], v[26:27], v[16:19]
    ds_read_b128 v[64:67], v162 offset:5120
    v_cvt_pk_bf16_f32 v232, v52, v53
    v_mfma_f32_16x16x16_bf16 v[20:23], v[106:107], v[26:27], v[16:19]
    s_waitcnt lgkmcnt(6)
    ds_read_b128 v[116:119], v25 offset:37632
    v_cvt_pk_bf16_f32 v233, v54, v55
    v_cvt_pk_bf16_f32 v12, v12, v13
    v_accvgpr_write_b32 a218, v12
    v_cvt_pk_bf16_f32 v14, v14, v15
    v_accvgpr_write_b32 a219, v14
    v_cvt_pk_bf16_f32 v48, v48, v49
    v_mfma_f32_16x16x16_bf16 v[56:59], v[96:97], v[26:27], v[40:43]
    ds_read_b64 v[120:121], v24 offset:37696
    v_accvgpr_write_b32 a242, v48
    v_mfma_f32_16x16x16_bf16 v[16:19], v[98:99], v[26:27], v[40:43]
    ds_read_b128 v[52:55], v162 offset:5184
    v_cvt_pk_bf16_f32 v50, v50, v51
    v_mfma_f32_16x16x16_bf16 v[12:15], v[100:101], v[26:27], v[40:43]
    s_waitcnt lgkmcnt(6)
    ds_read_b128 v[110:113], v25 offset:49152
    v_accvgpr_write_b32 a243, v50
    v_cvt_pk_bf16_f32 v234, v44, v45
    v_cvt_pk_bf16_f32 v235, v46, v47
    v_mfma_f32_16x16x16_bf16 v[72:75], v[90:91], v[26:27], v[68:71]
    ds_read_b64 v[114:115], v24 offset:49216
    v_cvt_pk_bf16_f32 v80, v80, v81
    v_mfma_f32_16x16x16_bf16 v[44:47], v[92:93], v[26:27], v[68:71]
    ds_read_b128 v[48:51], v162 offset:5248
    v_accvgpr_write_b32 a220, v80
    v_mfma_f32_16x16x16_bf16 v[40:43], v[94:95], v[26:27], v[68:71]
    s_waitcnt lgkmcnt(6)
    ds_read_b128 v[104:107], v25 offset:49920
    v_cvt_pk_bf16_f32 v82, v82, v83
    v_accvgpr_write_b32 a221, v82
    v_cvt_pk_bf16_f32 v32, v32, v33
    v_accvgpr_write_b32 a244, v32
    v_cvt_pk_bf16_f32 v34, v34, v35
    v_accvgpr_write_b32 a245, v34
    v_cvt_pk_bf16_f32 v236, v28, v29
    v_cvt_pk_bf16_f32 v237, v30, v31
    v_mfma_f32_16x16x16_bf16 v[100:103], v[84:85], v[26:27], v[64:67]
    ds_read_b64 v[108:109], v24 offset:49984
    v_cvt_pk_bf16_f32 v60, v60, v61
    v_mfma_f32_16x16x16_bf16 v[32:35], v[86:87], v[26:27], v[64:67]
    ds_read_b128 v[84:87], v162 offset:5312
    v_accvgpr_write_b32 a222, v60
    v_mfma_f32_16x16x16_bf16 v[28:31], v[88:89], v[26:27], v[64:67]
    s_waitcnt lgkmcnt(5)
    ds_read_b128 v[92:95], v25 offset:61440
    v_cvt_pk_bf16_f32 v62, v62, v63
    v_accvgpr_write_b32 a223, v62
    v_cvt_pk_bf16_f32 v36, v36, v37
    v_accvgpr_write_b32 a246, v36
    v_cvt_pk_bf16_f32 v38, v38, v39
    v_accvgpr_write_b32 a247, v38
    v_cvt_pk_bf16_f32 v238, v20, v21
    v_cvt_pk_bf16_f32 v239, v22, v23
    v_mfma_f32_16x16x16_bf16 v[36:39], v[116:117], v[26:27], v[52:55]
    ds_read_b64 v[96:97], v24 offset:61504
    v_cvt_pk_bf16_f32 v56, v56, v57
    v_mfma_f32_16x16x16_bf16 v[68:71], v[118:119], v[26:27], v[52:55]
    ds_read_b128 v[80:83], v162 offset:5376
    v_accvgpr_write_b32 a224, v56
    v_mfma_f32_16x16x16_bf16 v[64:67], v[120:121], v[26:27], v[52:55]
    s_waitcnt lgkmcnt(5)
    ds_read_b128 v[20:23], v25 offset:62208
    v_cvt_pk_bf16_f32 v58, v58, v59
    v_accvgpr_write_b32 a225, v58
    v_cvt_pk_bf16_f32 v16, v16, v17
    v_accvgpr_write_b32 a248, v16
    v_cvt_pk_bf16_f32 v18, v18, v19
    v_accvgpr_write_b32 a249, v18
    v_cvt_pk_bf16_f32 v240, v12, v13
    v_cvt_pk_bf16_f32 v241, v14, v15
    v_mfma_f32_16x16x16_bf16 v[60:63], v[110:111], v[26:27], v[48:51]
    ds_read_b64 v[24:25], v24 offset:62272
    v_cvt_pk_bf16_f32 v72, v72, v73
    v_mfma_f32_16x16x16_bf16 v[52:55], v[112:113], v[26:27], v[48:51]
    ds_read_b128 v[16:19], v162 offset:5440
    v_accvgpr_write_b32 a226, v72
    v_mfma_f32_16x16x16_bf16 v[56:59], v[114:115], v[26:27], v[48:51]
    s_waitcnt lgkmcnt(5)
    ds_read_b128 v[12:15], v137 offset:0
    v_cvt_pk_bf16_f32 v74, v74, v75
    v_accvgpr_write_b32 a227, v74
    v_cvt_pk_bf16_f32 v44, v44, v45
    v_accvgpr_write_b32 a250, v44
    v_cvt_pk_bf16_f32 v46, v46, v47
    v_accvgpr_write_b32 a251, v46
    v_cvt_pk_bf16_f32 v242, v40, v41
    v_cvt_pk_bf16_f32 v243, v42, v43
    v_mfma_f32_16x16x16_bf16 v[48:51], v[104:105], v[26:27], v[84:87]
    ds_read_b128 v[146:149], v136 offset:0
    v_cvt_pk_bf16_f32 v100, v100, v101
    v_mfma_f32_16x16x16_bf16 v[44:47], v[106:107], v[26:27], v[84:87]
    ds_read_b128 v[72:75], v137 offset:128
    v_accvgpr_write_b32 a228, v100
    v_mfma_f32_16x16x16_bf16 v[40:43], v[108:109], v[26:27], v[84:87]
    s_waitcnt lgkmcnt(5)
    ds_read_b128 v[88:91], v136 offset:128
    v_cvt_pk_bf16_f32 v102, v102, v103
    v_accvgpr_write_b32 a229, v102
    v_cvt_pk_bf16_f32 v32, v32, v33
    v_accvgpr_write_b32 a252, v32
    v_cvt_pk_bf16_f32 v34, v34, v35
    v_accvgpr_write_b32 a253, v34
    v_cvt_pk_bf16_f32 v244, v28, v29
    v_cvt_pk_bf16_f32 v245, v30, v31
    v_mfma_f32_16x16x16_bf16 v[32:35], v[92:93], v[26:27], v[80:83]
    s_waitcnt vmcnt(0) lgkmcnt(4)
    s_barrier
    ds_write_b128 v158, v[8:11] offset:6144
    v_mfma_f32_16x16x16_bf16 v[28:31], v[94:95], v[26:27], v[80:83]
    v_cvt_pk_bf16_f32 v36, v36, v37
    v_accvgpr_write_b32 a230, v36
    v_mfma_f32_16x16x16_bf16 v[8:11], v[96:97], v[26:27], v[80:83]
    s_waitcnt lgkmcnt(4)
    v_cvt_pk_bf16_f32 v38, v38, v39
    v_accvgpr_write_b32 a231, v38
    v_cvt_pk_bf16_f32 v68, v68, v69
    v_mfma_f32_16x16x32_bf16 v[36:39], a[0:3], v[12:15], 0
    s_waitcnt lgkmcnt(3)
    ds_write_b64 v124, v[246:247] offset:80
    v_mfma_f32_16x16x32_bf16 v[36:39], a[4:7], v[146:149], v[36:39]
    s_waitcnt lgkmcnt(3)
    v_accvgpr_write_b32 a254, v68
    v_cvt_pk_bf16_f32 v70, v70, v71
    v_mfma_f32_16x16x32_bf16 v[36:39], a[8:11], v[72:75], v[36:39]
    s_waitcnt lgkmcnt(2)
    ds_write_b128 v124, v[76:79] offset:96
    v_mfma_f32_16x16x32_bf16 v[36:39], a[12:15], v[88:91], v[36:39]
    v_accvgpr_write_b32 a255, v70
    v_cvt_pk_bf16_f32 v246, v64, v65
    v_cvt_pk_bf16_f32 v247, v66, v67
    v_cvt_pk_bf16_f32 v60, v60, v61
    v_accvgpr_write_b32 a232, v60
    v_cvt_pk_bf16_f32 v62, v62, v63
    v_accvgpr_write_b32 a233, v62
    v_cvt_pk_bf16_f32 v224, v52, v53
    v_cvt_pk_bf16_f32 v225, v54, v55
    v_cvt_pk_bf16_f32 v248, v56, v57
    v_cvt_pk_bf16_f32 v249, v58, v59
    v_cvt_pk_bf16_f32 v48, v48, v49
    v_accvgpr_write_b32 a234, v48
    v_cvt_pk_bf16_f32 v50, v50, v51
    v_accvgpr_write_b32 a235, v50
    v_cvt_pk_bf16_f32 v226, v44, v45
    v_cvt_pk_bf16_f32 v227, v46, v47
    v_cvt_pk_bf16_f32 v250, v40, v41
    v_cvt_pk_bf16_f32 v251, v42, v43
    v_cvt_pk_bf16_f32 v32, v32, v33
    v_accvgpr_write_b32 a236, v32
    v_cvt_pk_bf16_f32 v34, v34, v35
    v_accvgpr_write_b32 a237, v34
    v_cvt_pk_bf16_f32 v228, v28, v29
    v_cvt_pk_bf16_f32 v229, v30, v31
    v_cvt_pk_bf16_f32 v252, v8, v9
    v_cvt_pk_bf16_f32 v253, v10, v11
    v_mov_b32 v254, 0
    v_mov_b32 v255, 0
    v_mov_b32 v231, 0
    v_add_u32 v124, 0, v124
    ds_write_b128 v124, v[4:7]
    v_add_u32 v135, s49, v135
    v_add_u32 v134, s49, v134
    ds_write2_b64 v124, v[254:255], v[254:255] offset0:2 offset1:3
    ds_write_b128 v124, v[0:3] offset:32
    ds_write2_b64 v124, v[160:161], v[254:255] offset0:6 offset1:7
    ds_write2_b64 v124, v[254:255], v[156:157] offset0:8 offset1:9
    ds_write_b64 v124, v[230:231] offset:88
    ds_read_b128 v[76:79], v137 offset:256
    ds_read_b128 v[56:59], v136 offset:256
    s_waitcnt lgkmcnt(1)
    v_mfma_f32_16x16x32_bf16 v[36:39], a[16:19], v[76:79], v[36:39]
    s_waitcnt lgkmcnt(0)
    v_mfma_f32_16x16x32_bf16 v[36:39], a[20:23], v[56:59], v[36:39]
    s_nop 0
    v_mfma_f32_16x16x16_bf16 v[8:11], v[20:21], v[26:27], v[16:19]
    s_nop 3
    v_mfma_f32_16x16x16_bf16 v[4:7], v[22:23], v[26:27], v[16:19]
    s_nop 0
    v_fma_f32 v124, v36, v36, s41
    v_fmac_f32 v124, v37, v37
    v_mfma_f32_16x16x16_bf16 v[0:3], v[24:25], v[26:27], v[16:19]
    v_cvt_pk_bf16_f32 v8, v8, v9
    v_accvgpr_write_b32 a238, v8
    v_cvt_pk_bf16_f32 v10, v10, v11
    v_mfma_f32_16x16x32_bf16 v[48:51], a[24:27], v[12:15], 0
    v_accvgpr_write_b32 a239, v10
    v_cvt_pk_bf16_f32 v230, v4, v5
    v_mfma_f32_16x16x32_bf16 v[48:51], a[28:31], v[146:149], v[48:51]
    v_cvt_pk_bf16_f32 v231, v6, v7
    v_cvt_pk_bf16_f32 v254, v0, v1
    v_mfma_f32_16x16x32_bf16 v[48:51], a[32:35], v[72:75], v[48:51]
    v_cvt_pk_bf16_f32 v255, v2, v3
    v_fmac_f32 v124, v38, v38
    v_mfma_f32_16x16x32_bf16 v[48:51], a[36:39], v[88:91], v[48:51]
    v_fmac_f32 v124, v39, v39
    v_mfma_f32_16x16x32_bf16 v[48:51], a[40:43], v[76:79], v[48:51]
    v_mfma_f32_16x16x32_bf16 v[48:51], a[44:47], v[56:59], v[48:51]
    s_nop 1
    v_mfma_f32_16x16x32_bf16 v[40:43], a[48:51], v[12:15], 0
    s_nop 2
    v_mfma_f32_16x16x32_bf16 v[40:43], a[52:55], v[146:149], v[40:43]
    s_nop 0
    v_fmac_f32 v124, v48, v48
    v_fmac_f32 v124, v49, v49
    v_mfma_f32_16x16x32_bf16 v[40:43], a[56:59], v[72:75], v[40:43]
    v_fmac_f32 v124, v50, v50
    v_fmac_f32 v124, v51, v51
    v_mfma_f32_16x16x32_bf16 v[40:43], a[60:63], v[88:91], v[40:43]
    v_mfma_f32_16x16x32_bf16 v[40:43], a[64:67], v[76:79], v[40:43]
    v_mfma_f32_16x16x32_bf16 v[40:43], a[68:71], v[56:59], v[40:43]
    s_nop 1
    v_mfma_f32_16x16x32_bf16 v[28:31], a[72:75], v[12:15], 0
    s_nop 2
    v_mfma_f32_16x16x32_bf16 v[28:31], a[76:79], v[146:149], v[28:31]
    s_nop 0
    v_fmac_f32 v124, v40, v40
    v_fmac_f32 v124, v41, v41
    v_mfma_f32_16x16x32_bf16 v[28:31], a[80:83], v[72:75], v[28:31]
    v_fmac_f32 v124, v42, v42
    v_fmac_f32 v124, v43, v43
    v_mfma_f32_16x16x32_bf16 v[28:31], a[84:87], v[88:91], v[28:31]
    v_mfma_f32_16x16x32_bf16 v[28:31], a[88:91], v[76:79], v[28:31]
    v_mfma_f32_16x16x32_bf16 v[28:31], a[92:95], v[56:59], v[28:31]
    s_nop 1
    v_mfma_f32_16x16x32_bf16 v[32:35], a[96:99], v[12:15], 0
    s_nop 2
    v_mfma_f32_16x16x32_bf16 v[32:35], a[100:103], v[146:149], v[32:35]
    s_nop 0
    v_fma_f32 v156, v28, v28, s41
    v_fmac_f32 v156, v29, v29
    v_mfma_f32_16x16x32_bf16 v[32:35], a[104:107], v[72:75], v[32:35]
    v_fmac_f32 v156, v30, v30
    v_fmac_f32 v156, v31, v31
    v_mfma_f32_16x16x32_bf16 v[32:35], a[108:111], v[88:91], v[32:35]
    v_mfma_f32_16x16x32_bf16 v[32:35], a[112:115], v[76:79], v[32:35]
    v_mfma_f32_16x16x32_bf16 v[32:35], a[116:119], v[56:59], v[32:35]
    s_nop 1
    v_mfma_f32_16x16x32_bf16 v[20:23], a[120:123], v[12:15], 0
    s_nop 2
    v_mfma_f32_16x16x32_bf16 v[20:23], a[124:127], v[146:149], v[20:23]
    s_nop 0
    v_fmac_f32 v156, v32, v32
    v_fmac_f32 v156, v33, v33
    v_mfma_f32_16x16x32_bf16 v[20:23], a[128:131], v[72:75], v[20:23]
    v_fmac_f32 v156, v34, v34
    v_fmac_f32 v156, v35, v35
    v_mfma_f32_16x16x32_bf16 v[20:23], a[132:135], v[88:91], v[20:23]
    v_mfma_f32_16x16x32_bf16 v[20:23], a[136:139], v[76:79], v[20:23]
    v_mfma_f32_16x16x32_bf16 v[20:23], a[140:143], v[56:59], v[20:23]
    s_nop 1
    v_mfma_f32_16x16x32_bf16 v[4:7], v[12:15], a[144:147], 0
    s_nop 2
    v_mfma_f32_16x16x32_bf16 v[4:7], v[146:149], a[148:151], v[4:7]
    s_nop 0
    v_fmac_f32 v156, v20, v20
    v_fmac_f32 v156, v21, v21
    v_mfma_f32_16x16x32_bf16 v[4:7], v[72:75], a[152:155], v[4:7]
    v_fmac_f32 v156, v22, v22
    v_fmac_f32 v156, v23, v23
    v_mfma_f32_16x16x32_bf16 v[4:7], v[88:91], a[156:159], v[4:7]
    v_cvt_pk_bf16_f32 v170, v124, v156
    v_mfma_f32_16x16x32_bf16 v[4:7], v[76:79], a[160:163], v[4:7]
    ds_read_b128 v[108:111], v137 offset:1536
    v_mfma_f32_16x16x32_bf16 v[4:7], v[56:59], a[164:167], v[4:7]
    s_nop 0
    ds_read_b128 v[104:107], v136 offset:1536
    s_nop 0
    v_mfma_f32_16x16x16_bf16 v[24:27], v[216:217], v[170:171], 0
    s_nop 0
    ds_read_b128 v[44:47], v137 offset:1664
    s_nop 1
    v_cvt_pk_bf16_f32 v16, v4, v5
    v_mfma_f32_16x16x32_bf16 v[0:3], v[12:15], a[168:171], 0
    ds_read_b128 v[100:103], v136 offset:1664
    v_cvt_pk_bf16_f32 v17, v6, v7
    v_mfma_f32_16x16x32_bf16 v[0:3], v[146:149], a[172:175], v[0:3]
    ds_read_b128 v[68:71], v137 offset:1792
    v_mfma_f32_16x16x32_bf16 v[0:3], v[72:75], a[176:179], v[0:3]
    ds_read_b128 v[64:67], v136 offset:1792
    v_mfma_f32_16x16x32_bf16 v[0:3], v[88:91], a[180:183], v[0:3]
    v_rsq_f32 v24, v24
    v_mfma_f32_16x16x32_bf16 v[0:3], v[76:79], a[184:187], v[0:3]
    v_rsq_f32 v25, v25
    v_mfma_f32_16x16x32_bf16 v[0:3], v[56:59], a[188:191], v[0:3]
    v_mul_f32 v24, s55, v24
    v_mul_f32 v25, 0.5, v25
    v_mfma_f32_16x16x32_bf16 v[8:11], v[12:15], a[192:195], 0
    s_nop 0
    v_mul_f32 v36, v36, v24
    v_mul_f32 v37, v37, v24
    v_mfma_f32_16x16x32_bf16 v[8:11], v[146:149], a[196:199], v[8:11]
    s_nop 0
    v_cvt_pk_bf16_f32 v0, v0, v1
    v_cvt_pk_bf16_f32 v1, v2, v3
    v_mfma_f32_16x16x32_bf16 v[8:11], v[72:75], a[200:203], v[8:11]
    v_cvt_pk_f16_f32 v4, v36, v37
    v_mul_f32 v38, v38, v24
    v_mfma_f32_16x16x32_bf16 v[8:11], v[88:91], a[204:207], v[8:11]
    v_mul_f32 v39, v39, v24
    v_cvt_pk_f16_f32 v5, v38, v39
    v_mfma_f32_16x16x32_bf16 v[8:11], v[76:79], a[208:211], v[8:11]
    v_mul_f32 v48, v48, v24
    v_mul_f32 v49, v49, v24
    v_mfma_f32_16x16x32_bf16 v[8:11], v[56:59], a[212:215], v[8:11]
    s_waitcnt lgkmcnt(0)
    v_cvt_pk_f16_f32 v6, v48, v49
    v_mul_f32 v50, v50, v24
    v_mfma_f32_16x16x32_bf16 v[12:15], a[0:3], v[108:111], 0
    v_mul_f32 v51, v51, v24
    v_cvt_pk_f16_f32 v7, v50, v51
    v_mfma_f32_16x16x32_bf16 v[12:15], a[4:7], v[104:107], v[12:15]
    v_mul_f32 v40, v40, v24
    v_mul_f32 v41, v41, v24
    v_mfma_f32_16x16x32_bf16 v[12:15], a[8:11], v[44:47], v[12:15]
    v_cvt_pk_f16_f32 v152, v40, v41
    v_mul_f32 v42, v42, v24
    v_mfma_f32_16x16x32_bf16 v[12:15], a[12:15], v[100:103], v[12:15]
    v_mul_f32 v43, v43, v24
    v_cvt_pk_f16_f32 v153, v42, v43
    v_mfma_f32_16x16x32_bf16 v[12:15], a[16:19], v[68:71], v[12:15]
    v_mul_f32 v28, v28, v25
    v_mul_f32 v29, v29, v25
    v_mfma_f32_16x16x32_bf16 v[12:15], a[20:23], v[64:67], v[12:15]
    v_cvt_pk_f16_f32 v28, v28, v29
    v_mul_f32 v30, v30, v25
    v_mfma_f32_16x16x32_bf16 v[60:63], a[24:27], v[108:111], 0
    v_mul_f32 v31, v31, v25
    v_cvt_pk_f16_f32 v29, v30, v31
    v_mfma_f32_16x16x32_bf16 v[60:63], a[28:31], v[104:107], v[60:63]
    v_mul_f32 v32, v32, v25
    v_mul_f32 v33, v33, v25
    v_mfma_f32_16x16x32_bf16 v[60:63], a[32:35], v[44:47], v[60:63]
    v_cvt_pk_f16_f32 v30, v32, v33
    v_mul_f32 v34, v34, v25
    v_mfma_f32_16x16x32_bf16 v[60:63], a[36:39], v[100:103], v[60:63]
    v_mul_f32 v35, v35, v25
    v_cvt_pk_f16_f32 v31, v34, v35
    v_mfma_f32_16x16x32_bf16 v[60:63], a[40:43], v[68:71], v[60:63]
    v_mul_f32 v20, v20, v25
    v_mul_f32 v21, v21, v25
    v_mfma_f32_16x16x32_bf16 v[60:63], a[44:47], v[64:67], v[60:63]
    v_cvt_pk_f16_f32 v154, v20, v21
    v_mul_f32 v22, v22, v25
    v_mfma_f32_16x16x32_bf16 v[36:39], a[48:51], v[108:111], 0
    v_mul_f32 v23, v23, v25
    v_cvt_pk_f16_f32 v155, v22, v23
    v_mfma_f32_16x16x32_bf16 v[36:39], a[52:55], v[104:107], v[36:39]
    v_cvt_pk_bf16_f32 v20, v8, v9
    v_cvt_pk_bf16_f32 v21, v10, v11
    v_mfma_f32_16x16x32_bf16 v[36:39], a[56:59], v[44:47], v[36:39]
    v_fma_f32 v124, v12, v12, s41
    v_fmac_f32 v124, v13, v13
    v_mfma_f32_16x16x32_bf16 v[36:39], a[60:63], v[100:103], v[36:39]
    v_fmac_f32 v124, v14, v14
    v_fmac_f32 v124, v15, v15
    v_mfma_f32_16x16x32_bf16 v[36:39], a[64:67], v[68:71], v[36:39]
    v_fmac_f32 v124, v60, v60
    v_fmac_f32 v124, v61, v61
    v_mfma_f32_16x16x32_bf16 v[36:39], a[68:71], v[64:67], v[36:39]
    v_fmac_f32 v124, v62, v62
    v_fmac_f32 v124, v63, v63
    v_mfma_f32_16x16x32_bf16 v[52:55], a[72:75], v[108:111], 0
    s_nop 2
    v_mfma_f32_16x16x32_bf16 v[52:55], a[76:79], v[104:107], v[52:55]
    s_nop 0
    v_fmac_f32 v124, v36, v36
    v_fmac_f32 v124, v37, v37
    v_mfma_f32_16x16x32_bf16 v[52:55], a[80:83], v[44:47], v[52:55]
    v_fmac_f32 v124, v38, v38
    v_fmac_f32 v124, v39, v39
    v_mfma_f32_16x16x32_bf16 v[52:55], a[84:87], v[100:103], v[52:55]
    v_mfma_f32_16x16x32_bf16 v[52:55], a[88:91], v[68:71], v[52:55]
    v_mfma_f32_16x16x32_bf16 v[52:55], a[92:95], v[64:67], v[52:55]
    s_nop 1
    v_mfma_f32_16x16x32_bf16 v[8:11], a[96:99], v[108:111], 0
    s_nop 2
    v_mfma_f32_16x16x32_bf16 v[8:11], a[100:103], v[104:107], v[8:11]
    s_nop 0
    v_fma_f32 v2, v52, v52, s41
    v_fmac_f32 v2, v53, v53
    v_mfma_f32_16x16x32_bf16 v[8:11], a[104:107], v[44:47], v[8:11]
    v_fmac_f32 v2, v54, v54
    v_fmac_f32 v2, v55, v55
    v_mfma_f32_16x16x32_bf16 v[8:11], a[108:111], v[100:103], v[8:11]
    v_mfma_f32_16x16x32_bf16 v[8:11], a[112:115], v[68:71], v[8:11]
    v_mfma_f32_16x16x32_bf16 v[8:11], a[116:119], v[64:67], v[8:11]
    s_sub_u32 s50, s45, s44
    v_add_u32 v135, s48, v135
    v_add_u32 v134, s48, v134
    v_mfma_f32_16x16x32_bf16 v[48:51], a[120:123], v[108:111], 0
    s_sub_u32 s51, s46, s47
    v_add_u32 v133, s51, v133
    v_mfma_f32_16x16x32_bf16 v[48:51], a[124:127], v[104:107], v[48:51]
    s_mov_b32 s60, s59
    v_fmac_f32 v2, v8, v8
    v_fmac_f32 v2, v9, v9
    v_mfma_f32_16x16x32_bf16 v[48:51], a[128:131], v[44:47], v[48:51]
    s_mov_b32 s59, s58
    v_fmac_f32 v2, v10, v10
    v_fmac_f32 v2, v11, v11
    v_mfma_f32_16x16x32_bf16 v[48:51], a[132:135], v[100:103], v[48:51]
    s_mov_b32 s58, s57
    v_mfma_f32_16x16x32_bf16 v[48:51], a[136:139], v[68:71], v[48:51]
    s_mov_b32 s57, s56
    v_mfma_f32_16x16x32_bf16 v[48:51], a[140:143], v[64:67], v[48:51]
    s_mov_b32 s7, s6
    s_nop 0
    v_mfma_f32_16x16x32_bf16 v[24:27], v[108:111], a[144:147], 0
    s_mov_b32 s6, s5
    s_nop 1
    v_mfma_f32_16x16x32_bf16 v[24:27], v[104:107], a[148:151], v[24:27]
    s_mov_b32 s5, s4
    v_fmac_f32 v2, v48, v48
    v_fmac_f32 v2, v49, v49
    v_mfma_f32_16x16x32_bf16 v[24:27], v[44:47], a[152:155], v[24:27]
    s_sub_u32 s14, s6, s7
    v_fmac_f32 v2, v50, v50
    v_fmac_f32 v2, v51, v51
    v_mfma_f32_16x16x32_bf16 v[24:27], v[100:103], a[156:159], v[24:27]
    s_add_u32 s61, s61, 1
    v_cvt_pk_bf16_f32 v170, v124, v2
    v_add_u32 v132, s14, v132
    v_mfma_f32_16x16x32_bf16 v[24:27], v[68:71], a[160:163], v[24:27]
    s_ff1_i32_b32 s15, s66
    ds_read_b128 v[96:99], v137 offset:3072
    v_add_u32 v131, s14, v131
    v_mfma_f32_16x16x32_bf16 v[24:27], v[64:67], a[164:167], v[24:27]
    s_cmp_lg_u32 s66, 0
    ds_read_b128 v[92:95], v136 offset:3072
    v_add_u32 v125, s14, v125
    v_mfma_f32_16x16x16_bf16 v[40:43], v[216:217], v[170:171], 0
    s_cselect_b32 s12, s15, s12
    ds_read_b128 v[84:87], v137 offset:3200
    s_nop 1
    v_cvt_pk_bf16_f32 v18, v24, v25
    v_mfma_f32_16x16x32_bf16 v[72:75], v[108:111], a[168:171], 0
    s_cmp_lt_u32 s61, s71
    ds_read_b128 v[80:83], v136 offset:3200
    v_cvt_pk_bf16_f32 v19, v26, v27
    v_mfma_f32_16x16x32_bf16 v[72:75], v[104:107], a[172:175], v[72:75]
    s_cselect_b32 s15, 31, s15
    ds_read_b128 v[56:59], v137 offset:3328
    v_add_u32 v137, s50, v137
    v_mfma_f32_16x16x32_bf16 v[72:75], v[44:47], a[176:179], v[72:75]
    s_bitset0_b32 s66, s15
    ds_read_b128 v[24:27], v136 offset:3328
    v_add_u32 v136, s50, v136
    v_mfma_f32_16x16x32_bf16 v[72:75], v[100:103], a[180:183], v[72:75]
    s_add_u32 s12, s12, 20
    v_rsq_f32 v40, v40
    v_mfma_f32_16x16x32_bf16 v[72:75], v[68:71], a[184:187], v[72:75]
    s_max_u32 s12, s12, s61
    v_rsq_f32 v41, v41
    v_mfma_f32_16x16x32_bf16 v[72:75], v[64:67], a[188:191], v[72:75]
    s_cmp_lt_u32 s61, s71
    v_mul_f32 v40, s55, v40
    v_mul_f32 v41, 0.5, v41
    v_mfma_f32_16x16x32_bf16 v[32:35], v[108:111], a[192:195], 0
    s_cselect_b32 s15, s61, s12
    v_mul_f32 v12, v12, v40
    v_mul_f32 v13, v13, v40
    v_mfma_f32_16x16x32_bf16 v[32:35], v[104:107], a[196:199], v[32:35]
    s_cselect_b32 s56, s69, s70
    v_cvt_pk_bf16_f32 v2, v72, v73
    v_cvt_pk_bf16_f32 v3, v74, v75
    v_mfma_f32_16x16x32_bf16 v[32:35], v[44:47], a[200:203], v[32:35]
    s_add_u32 s56, s56, s15
    v_cvt_pk_f16_f32 v44, v12, v13
    v_mul_f32 v14, v14, v40
    v_mfma_f32_16x16x32_bf16 v[32:35], v[100:103], a[204:207], v[32:35]
    s_mul_i32 s53, s56, 58255
    v_mul_f32 v15, v15, v40
    v_cvt_pk_f16_f32 v45, v14, v15
    v_mfma_f32_16x16x32_bf16 v[32:35], v[68:71], a[208:211], v[32:35]
    s_waitcnt lgkmcnt(0)
    s_lshr_b32 s53, s53, 22
    v_mul_f32 v60, v60, v40
    v_mul_f32 v61, v61, v40
    v_mfma_f32_16x16x32_bf16 v[32:35], v[64:67], a[212:215], v[32:35]
    s_barrier
    v_cvt_pk_f16_f32 v46, v60, v61
    v_mul_f32 v62, v62, v40
    v_mfma_f32_16x16x32_bf16 v[12:15], a[0:3], v[96:99], 0
    s_mul_i32 s53, s53, s63
    v_mul_f32 v63, v63, v40
    v_cvt_pk_f16_f32 v47, v62, v63
    v_mfma_f32_16x16x32_bf16 v[12:15], a[4:7], v[92:95], v[12:15]
    s_mul_i32 s56, s56, s62
    v_mul_f32 v36, v36, v40
    v_mul_f32 v37, v37, v40
    v_mfma_f32_16x16x32_bf16 v[12:15], a[8:11], v[84:87], v[12:15]
    s_add_u32 s56, s56, s53
    v_cvt_pk_f16_f32 v146, v36, v37
    v_mul_f32 v38, v38, v40
    v_mfma_f32_16x16x32_bf16 v[12:15], a[12:15], v[80:83], v[12:15]
    s_mul_i32 s4, s15, 112
    v_mul_f32 v39, v39, v40
    v_cvt_pk_f16_f32 v147, v38, v39
    v_mfma_f32_16x16x32_bf16 v[12:15], a[16:19], v[56:59], v[12:15]
    s_cmp_ge_u32 s15, 16
    v_mul_f32 v52, v52, v41
    v_mul_f32 v53, v53, v41
    v_mfma_f32_16x16x32_bf16 v[12:15], a[20:23], v[24:27], v[12:15]
    s_cselect_b32 s53, -30464, 0
    v_cvt_pk_f16_f32 v72, v52, v53
    v_mul_f32 v54, v54, v41
    v_mfma_f32_16x16x32_bf16 v[36:39], a[24:27], v[96:99], 0
    s_add_u32 s4, s4, s53
    v_mul_f32 v55, v55, v41
    v_cvt_pk_f16_f32 v73, v54, v55
    v_mfma_f32_16x16x32_bf16 v[36:39], a[28:31], v[92:95], v[36:39]
    s_cmp_lt_u32 s15, s73
    v_mul_f32 v8, v8, v41
    v_mul_f32 v9, v9, v41
    v_mfma_f32_16x16x32_bf16 v[36:39], a[32:35], v[84:87], v[36:39]
    s_cselect_b32 s26, 100270464, 0
    v_cvt_pk_f16_f32 v74, v8, v9
    v_mul_f32 v10, v10, v41
    v_mfma_f32_16x16x32_bf16 v[36:39], a[36:39], v[80:83], v[36:39]
    s_cselect_b32 s56, s56, 0
    v_mul_f32 v11, v11, v41
    v_cvt_pk_f16_f32 v75, v10, v11
    v_mfma_f32_16x16x32_bf16 v[36:39], a[40:43], v[56:59], v[36:39]
    s_cselect_b32 s4, s4, -1
    v_mul_f32 v48, v48, v41
    v_mul_f32 v49, v49, v41
    v_mfma_f32_16x16x32_bf16 v[36:39], a[44:47], v[24:27], v[36:39]
    s_cselect_b32 s15, s15, 0
    v_cvt_pk_f16_f32 v148, v48, v49
    v_mul_f32 v50, v50, v41
    v_mfma_f32_16x16x32_bf16 v[8:11], a[48:51], v[96:99], 0
    s_cselect_b32 s13, s13, -1
    v_mul_f32 v51, v51, v41
    v_cvt_pk_f16_f32 v149, v50, v51
    v_mfma_f32_16x16x32_bf16 v[8:11], a[52:55], v[92:95], v[8:11]
    s_bitset1_b32 s64, s15
    v_cvt_pk_bf16_f32 v22, v32, v33
    v_cvt_pk_bf16_f32 v23, v34, v35
    v_mfma_f32_16x16x32_bf16 v[8:11], a[56:59], v[84:87], v[8:11]
    s_add_u32 s65, s65, 1
    v_fma_f32 v156, v12, v12, s41
    v_fmac_f32 v156, v13, v13
    v_mfma_f32_16x16x32_bf16 v[8:11], a[60:63], v[80:83], v[8:11]
    s_cmp_ge_i32 s65, 2
    v_fmac_f32 v156, v14, v14
    v_fmac_f32 v156, v15, v15
    v_mfma_f32_16x16x32_bf16 v[8:11], a[64:67], v[56:59], v[8:11]
    s_cselect_b32 s30, 100270464, 0
    v_fmac_f32 v156, v36, v36
    v_fmac_f32 v156, v37, v37
    v_mfma_f32_16x16x32_bf16 v[8:11], a[68:71], v[24:27], v[8:11]
    s_add_u32 s67, s46, s54
    v_fmac_f32 v156, v38, v38
    v_fmac_f32 v156, v39, v39
    v_mfma_f32_16x16x32_bf16 v[64:67], a[72:75], v[96:99], 0
    s_add_u32 m0, s67, 0
    v_and_b32 v124, -8, v125
    v_mfma_f32_16x16x32_bf16 v[64:67], a[76:79], v[92:95], v[64:67]
    buffer_load_dwordx4 v130, s[24:27], s56 offen nt lds
    v_fmac_f32 v156, v8, v8
    v_mfma_f32_16x16x32_bf16 v[64:67], a[80:83], v[84:87], v[64:67]
    s_add_u32 m0, s67, 1024
    v_fmac_f32 v156, v9, v9
    v_fmac_f32 v156, v10, v10
    v_mfma_f32_16x16x32_bf16 v[64:67], a[84:87], v[80:83], v[64:67]
    v_fmac_f32 v156, v11, v11
    v_mfma_f32_16x16x32_bf16 v[64:67], a[88:91], v[56:59], v[64:67]
    v_mfma_f32_16x16x32_bf16 v[64:67], a[92:95], v[24:27], v[64:67]
    s_nop 1
    v_mfma_f32_16x16x32_bf16 v[32:35], a[96:99], v[96:99], 0
    s_nop 0
    buffer_load_dwordx4 v129, s[24:27], s56 offen nt lds
    s_nop 0
    v_mfma_f32_16x16x32_bf16 v[32:35], a[100:103], v[92:95], v[32:35]
    s_add_u32 m0, s67, 2048
    v_fma_f32 v157, v64, v64, s41
    v_fmac_f32 v157, v65, v65
    v_mfma_f32_16x16x32_bf16 v[32:35], a[104:107], v[84:87], v[32:35]
    v_fmac_f32 v157, v66, v66
    v_fmac_f32 v157, v67, v67
    v_mfma_f32_16x16x32_bf16 v[32:35], a[108:111], v[80:83], v[32:35]
    v_mfma_f32_16x16x32_bf16 v[32:35], a[112:115], v[56:59], v[32:35]
    v_mfma_f32_16x16x32_bf16 v[32:35], a[116:119], v[24:27], v[32:35]
    buffer_load_dwordx4 v128, s[24:27], s56 offen nt lds
    s_nop 0
    v_mfma_f32_16x16x32_bf16 v[40:43], a[120:123], v[96:99], 0
    s_add_u32 m0, s67, 3072
    s_nop 1
    v_mfma_f32_16x16x32_bf16 v[40:43], a[124:127], v[92:95], v[40:43]
    s_mov_b32 s53, s47
    v_fmac_f32 v157, v32, v32
    v_fmac_f32 v157, v33, v33
    v_mfma_f32_16x16x32_bf16 v[40:43], a[128:131], v[84:87], v[40:43]
    s_mov_b32 s47, s46
    v_fmac_f32 v157, v34, v34
    v_fmac_f32 v157, v35, v35
    v_mfma_f32_16x16x32_bf16 v[40:43], a[132:135], v[80:83], v[40:43]
    s_mov_b32 s46, s45
    v_mfma_f32_16x16x32_bf16 v[40:43], a[136:139], v[56:59], v[40:43]
    s_mov_b32 s45, s44
    buffer_load_dwordx4 v127, s[24:27], s56 offen nt lds
    v_mfma_f32_16x16x32_bf16 v[40:43], a[140:143], v[24:27], v[40:43]
    s_add_u32 m0, s67, 4096
    s_nop 0
    v_mfma_f32_16x16x32_bf16 v[68:71], v[96:99], a[144:147], 0
    s_mov_b32 s44, s53
    s_nop 1
    v_mfma_f32_16x16x32_bf16 v[68:71], v[92:95], a[148:151], v[68:71]
    s_sub_u32 s48, s44, s46
    v_fmac_f32 v157, v40, v40
    v_fmac_f32 v157, v41, v41
    v_mfma_f32_16x16x32_bf16 v[68:71], v[84:87], a[152:155], v[68:71]
    s_sub_u32 s49, s46, s45
    v_fmac_f32 v157, v42, v42
    v_fmac_f32 v157, v43, v43
    v_mfma_f32_16x16x32_bf16 v[68:71], v[80:83], a[156:159], v[68:71]
    buffer_load_dwordx4 v126, s[24:27], s56 offen nt lds
    v_cvt_pk_bf16_f32 v170, v156, v157
    v_mfma_f32_16x16x32_bf16 v[68:71], v[56:59], a[160:163], v[68:71]
    ds_read_b128 v[60:63], v132 offset:0
    v_add_u32 v137, s48, v137
    v_mfma_f32_16x16x32_bf16 v[68:71], v[24:27], a[164:167], v[68:71]
    s_nop 0
    ds_read_b128 v[52:55], v132 offset:16
    v_add_u32 v136, s48, v136
    v_mfma_f32_16x16x16_bf16 v[76:79], v[216:217], v[170:171], 0
    s_nop 0
    ds_read_b128 v[48:51], v132 offset:48
    s_nop 1
    v_cvt_pk_bf16_f32 v164, v68, v69
    v_mfma_f32_16x16x32_bf16 v[88:91], v[96:99], a[168:171], 0
    v_cvt_pk_bf16_f32 v165, v70, v71
    v_mfma_f32_16x16x32_bf16 v[88:91], v[92:95], a[172:175], v[88:91]
    v_rsq_f32 v76, v76
    v_mfma_f32_16x16x32_bf16 v[88:91], v[84:87], a[176:179], v[88:91]
    v_rsq_f32 v77, v77
    v_mfma_f32_16x16x32_bf16 v[88:91], v[80:83], a[180:183], v[88:91]
    v_mul_f32 v76, s55, v76
    v_mul_f32 v77, 0.5, v77
    v_mfma_f32_16x16x32_bf16 v[88:91], v[56:59], a[184:187], v[88:91]
    v_mul_f32 v64, v64, v77
    v_mul_f32 v65, v65, v77
    v_mfma_f32_16x16x32_bf16 v[88:91], v[24:27], a[188:191], v[88:91]
    v_cvt_pk_f16_f32 v64, v64, v65
    v_mul_f32 v66, v66, v77
    v_mfma_f32_16x16x32_bf16 v[68:71], v[96:99], a[192:195], 0
    s_nop 0
    v_mul_f32 v67, v67, v77
    v_cvt_pk_f16_f32 v65, v66, v67
    v_mfma_f32_16x16x32_bf16 v[68:71], v[92:95], a[196:199], v[68:71]
    s_nop 0
    v_cvt_pk_bf16_f32 v160, v88, v89
    v_cvt_pk_bf16_f32 v161, v90, v91
    v_mfma_f32_16x16x32_bf16 v[68:71], v[84:87], a[200:203], v[68:71]
    v_mul_f32 v32, v32, v77
    v_mul_f32 v33, v33, v77
    v_mfma_f32_16x16x32_bf16 v[68:71], v[80:83], a[204:207], v[68:71]
    v_cvt_pk_f16_f32 v66, v32, v33
    v_mul_f32 v34, v34, v77
    v_mfma_f32_16x16x32_bf16 v[68:71], v[56:59], a[208:211], v[68:71]
    v_mul_f32 v35, v35, v77
    v_cvt_pk_f16_f32 v67, v34, v35
    v_mfma_f32_16x16x32_bf16 v[68:71], v[24:27], a[212:215], v[68:71]
    v_mul_f32 v40, v40, v77
    v_mul_f32 v41, v41, v77
    v_mfma_f32_16x16x32_f16 v[32:35], v[28:31], v[4:7], v[204:207]
    ds_read_u16 v166, v131 offset:80
    v_cvt_pk_f16_f32 v142, v40, v41
    v_mfma_f32_16x16x32_f16 v[32:35], v[152:155], v[150:153], v[32:35]
    ds_read_u16 v162, v131 offset:96
    v_mul_f32 v42, v42, v77
    v_mfma_f32_16x16x32_f16 v[24:27], v[72:75], v[4:7], v[200:203]
    ds_read_u16 v158, v131 offset:104
    v_mul_f32 v43, v43, v77
    v_mfma_f32_16x16x32_f16 v[24:27], v[146:149], v[150:153], v[24:27]
    s_waitcnt lgkmcnt(3)
    ds_read_b32 v124, v124 offset:64
    v_cvt_pk_f16_f32 v143, v42, v43
    v_mfma_f32_16x16x32_f16 v[56:59], v[60:63], v[4:7], v[208:211]
    v_mul_f32 v12, v12, v76
    v_mul_f32 v13, v13, v76
    v_mfma_f32_16x16x32_f16 v[56:59], v[52:55], v[28:31], v[56:59]
    v_cvt_pk_f16_f32 v12, v12, v13
    v_mul_f32 v14, v14, v76
    v_mfma_f32_16x16x32_f16 v[56:59], v[48:51], v[152:155], v[56:59]
    v_mul_f32 v15, v15, v76
    v_cvt_pk_f16_f32 v13, v14, v15
    v_mfma_f32_16x16x32_f16 v[40:43], v[60:63], v[44:47], v[208:211]
    v_mul_f32 v36, v36, v76
    v_mul_f32 v37, v37, v76
    v_mfma_f32_16x16x32_f16 v[40:43], v[52:55], v[72:75], v[40:43]
    v_cvt_pk_f16_f32 v14, v36, v37
    v_mul_f32 v38, v38, v76
    v_mfma_f32_16x16x32_f16 v[40:43], v[48:51], v[146:149], v[40:43]
    v_mul_f32 v39, v39, v76
    v_cvt_pk_f16_f32 v15, v38, v39
    v_mfma_f32_16x16x32_f16 v[36:39], v[28:31], v[44:47], v[192:195]
    v_mul_f32 v8, v8, v76
    v_mul_f32 v9, v9, v76
    v_mfma_f32_16x16x32_f16 v[36:39], v[152:155], v[144:147], v[36:39]
    v_cvt_pk_f16_f32 v140, v8, v9
    v_mul_f32 v10, v10, v76
    v_mul_f32 v11, v11, v76
    v_cvt_pk_f16_f32 v141, v10, v11
    v_mfma_f32_16x16x32_f16 v[8:11], v[64:67], v[4:7], v[196:199]
    v_cvt_pk_bf16_f32 v156, v68, v69
    v_cvt_pk_bf16_f32 v157, v70, v71
    v_mfma_f32_16x16x32_f16 v[8:11], v[140:143], v[150:153], v[8:11]
    v_max3_f32 v40, v32, v33, v34
    v_max3_f32 v40, v40, v35, v24
    v_mfma_f32_16x16x32_f16 v[4:7], v[60:63], v[12:15], v[208:211]
    s_nop 0
    v_max3_f32 v40, v40, v25, v26
    v_mov_b32_dpp v59, v43 quad_perm:[0,1,2,3] row_mask:0x2 bank_mask:0xf
    v_mfma_f32_16x16x32_f16 v[4:7], v[52:55], v[64:67], v[4:7]
    s_nop 0
    v_max3_f32 v40, v40, v27, v8
    v_max3_f32 v40, v40, v9, v10
    v_mfma_f32_16x16x32_f16 v[4:7], v[48:51], v[140:143], v[4:7]
    v_max3_f32 v40, v40, v11, v56
    v_mov_b32 v42, v40
    v_mfma_f32_16x16x32_f16 v[52:55], v[72:75], v[44:47], v[188:191]
    s_nop 0
    v_permlane32_swap_b32 v42, v40
    v_mfma_f32_16x16x32_f16 v[52:55], v[146:149], v[144:147], v[52:55]
    v_max_f32 v40, v42, v40
    v_mov_b32 v42, v40
    v_mfma_f32_16x16x32_f16 v[48:51], v[64:67], v[44:47], v[184:187]
    s_nop 0
    v_permlane16_swap_b32 v42, v40
    v_mfma_f32_16x16x32_f16 v[48:51], v[140:143], v[144:147], v[48:51]
    v_max_f32 v40, v42, v40
    v_sub_f32 v32, v32, v40
    v_sub_f32 v33, v33, v40
    v_sub_f32 v34, v34, v40
    v_sub_f32 v35, v35, v40
    v_sub_f32 v24, v24, v40
    v_sub_f32 v25, v25, v40
    v_sub_f32 v26, v26, v40
    v_sub_f32 v27, v27, v40
    v_sub_f32 v8, v8, v40
    v_sub_f32 v9, v9, v40
    v_sub_f32 v10, v10, v40
    v_sub_f32 v11, v11, v40
    v_sub_f32 v56, v56, v40
    v_exp_f32 v32, v32
    v_exp_f32 v33, v33
    v_exp_f32 v34, v34
    v_exp_f32 v35, v35
    v_cvt_pk_bf16_f32 v60, v32, v33
    v_cvt_pk_bf16_f32 v61, v34, v35
    v_exp_f32 v24, v24
    v_exp_f32 v25, v25
    v_exp_f32 v26, v26
    v_exp_f32 v27, v27
    v_cvt_pk_bf16_f32 v62, v24, v25
    v_cvt_pk_bf16_f32 v63, v26, v27
    v_exp_f32 v8, v8
    v_exp_f32 v9, v9
    v_exp_f32 v10, v10
    v_exp_f32 v11, v11
    v_cvt_pk_bf16_f32 v168, v8, v9
    v_cvt_pk_bf16_f32 v169, v10, v11
    v_exp_f32 v56, v56
    v_mov_b32_dpp v59, v7 quad_perm:[0,1,2,3] row_mask:0x4 bank_mask:0xf
    v_cvt_pk_bf16_f32 v170, v56, 0
    v_mfma_f32_16x16x32_bf16 v[44:47], v[220:223], v[60:63], 0
    s_waitcnt lgkmcnt(0)
    v_and_b32 v4, 0xffff0000, v124
    v_lshlrev_b32 v124, 16, v124
    v_mfma_f32_16x16x32_bf16 v[44:47], v[220:223], v[168:171], v[44:47]
    v_add_f32 v124, v124, v4
    v_add_f32 v124, v124, v211
    v_mfma_f32_16x16x32_bf16 v[8:11], v[16:19], v[60:63], 0
    s_nop 0
    v_mov_b32_dpp v59, v124 quad_perm:[0,1,2,3] row_mask:0x8 bank_mask:0xf
    v_mov_b32 v124, v59
    v_mfma_f32_16x16x32_bf16 v[8:11], v[164:167], v[168:171], v[8:11]
    s_nop 0
    v_max_f32_dpp v124, v124, v124 row_ror:8 row_mask:0xf bank_mask:0xf
    v_max3_f32 v4, v36, v37, v38
    v_mfma_f32_16x16x32_bf16 v[24:27], v[0:3], v[60:63], 0
    v_max_f32_dpp v124, v124, v124 row_ror:4 row_mask:0xf bank_mask:0xf
    v_max3_f32 v4, v4, v39, v52
    v_mfma_f32_16x16x32_bf16 v[24:27], v[160:163], v[168:171], v[24:27]
    v_max_f32_dpp v124, v124, v124 row_ror:2 row_mask:0xf bank_mask:0xf
    v_max3_f32 v4, v4, v53, v54
    v_mfma_f32_16x16x32_bf16 v[32:35], v[20:23], v[60:63], 0
    v_max_f32_dpp v124, v124, v124 row_ror:1 row_mask:0xf bank_mask:0xf
    v_mov_b32 v5, v124
    v_mfma_f32_16x16x32_bf16 v[32:35], v[156:159], v[168:171], v[32:35]
    s_nop 0
    v_permlane32_swap_b32 v5, v124
    v_max_f32 v124, v5, v124
    v_mov_b32 v5, v124
    v_rcp_f32 v45, v44
    v_max3_f32 v4, v4, v55, v48
    v_permlane16_swap_b32 v5, v124
    v_max_f32 v124, v5, v124
    v_sub_f32 v59, v59, v124
    v_exp_f32 v59, v59
    v_mul_f32 v8, v8, v45
    v_cvt_pk_bf16_f32 v59, v59, v59
    ds_write_b16 v125, v59 offset:64
    v_mul_f32 v9, v9, v45
    v_cvt_pk_bf16_f32 v68, v8, v9
    ds_read_b128 v[60:63], v132 offset:48
    v_mul_f32 v10, v10, v45
    v_mul_f32 v11, v11, v45
    v_cvt_pk_bf16_f32 v69, v10, v11
    ds_read_b128 v[56:59], v132 offset:64
    v_mfma_f32_16x16x32_f16 v[8:11], v[28:31], v[12:15], v[180:183]
    v_mul_f32 v24, v24, v45
    v_mul_f32 v25, v25, v45
    v_mfma_f32_16x16x32_f16 v[8:11], v[152:155], v[138:141], v[8:11]
    ds_write_b64 v135, v[68:69] offset:0
    v_mfma_f32_16x16x32_f16 v[28:31], v[72:75], v[12:15], v[176:179]
    v_cvt_pk_bf16_f32 v70, v24, v25
    v_mul_f32 v26, v26, v45
    v_mfma_f32_16x16x32_f16 v[28:31], v[146:149], v[138:141], v[28:31]
    v_mul_f32 v27, v27, v45
    v_cvt_pk_bf16_f32 v71, v26, v27
    v_mfma_f32_16x16x32_f16 v[24:27], v[64:67], v[12:15], v[172:175]
    ds_write_b64 v135, v[70:71] offset:8
    v_mfma_f32_16x16x32_f16 v[24:27], v[140:143], v[138:141], v[24:27]
    s_waitcnt lgkmcnt(3)
    v_mul_f32 v32, v32, v45
    v_mul_f32 v33, v33, v45
    v_cvt_pk_bf16_f32 v146, v32, v33
    v_mul_f32 v34, v34, v45
    v_mfma_f32_16x16x32_bf16 v[12:15], v[60:63], v[16:19], 0
    s_waitcnt lgkmcnt(2)
    v_mul_f32 v35, v35, v45
    v_cvt_pk_bf16_f32 v147, v34, v35
    v_max3_f32 v4, v4, v49, v50
    v_max3_f32 v4, v4, v51, v41
    v_mfma_f32_16x16x32_bf16 v[12:15], v[56:59], v[164:167], v[12:15]
    ds_write_b64 v134, v[146:147] offset:0
    v_mfma_f32_16x16x32_bf16 v[44:47], v[60:63], v[0:3], 0
    v_mov_b32 v5, v4
    v_max3_f32 v124, v8, v9, v10
    v_mfma_f32_16x16x32_bf16 v[44:47], v[56:59], v[160:163], v[44:47]
    v_permlane32_swap_b32 v5, v4
    v_mfma_f32_16x16x32_bf16 v[32:35], v[60:63], v[20:23], 0
    v_max_f32 v4, v5, v4
    v_mov_b32 v5, v4
    v_mfma_f32_16x16x32_bf16 v[32:35], v[56:59], v[156:159], v[32:35]
    s_nop 0
    v_permlane16_swap_b32 v5, v4
    v_max_f32 v4, v5, v4
    v_sub_f32 v36, v36, v4
    v_sub_f32 v37, v37, v4
    v_sub_f32 v38, v38, v4
    v_sub_f32 v39, v39, v4
    v_sub_f32 v52, v52, v4
    v_sub_f32 v53, v53, v4
    v_sub_f32 v54, v54, v4
    v_sub_f32 v55, v55, v4
    v_sub_f32 v48, v48, v4
    v_sub_f32 v49, v49, v4
    v_sub_f32 v50, v50, v4
    v_sub_f32 v51, v51, v4
    v_sub_f32 v41, v41, v4
    v_exp_f32 v36, v36
    v_exp_f32 v37, v37
    v_exp_f32 v38, v38
    v_exp_f32 v39, v39
    v_cvt_pk_bf16_f32 v36, v36, v37
    v_cvt_pk_bf16_f32 v37, v38, v39
    v_exp_f32 v52, v52
    v_exp_f32 v53, v53
    v_exp_f32 v54, v54
    v_exp_f32 v55, v55
    v_cvt_pk_bf16_f32 v38, v52, v53
    v_cvt_pk_bf16_f32 v39, v54, v55
    v_exp_f32 v48, v48
    v_exp_f32 v49, v49
    v_exp_f32 v50, v50
    v_exp_f32 v51, v51
    v_cvt_pk_bf16_f32 v168, v48, v49
    v_cvt_pk_bf16_f32 v169, v50, v51
    v_exp_f32 v41, v41
    v_mov_b32_dpp v15, v47 quad_perm:[0,1,2,3] row_mask:0x2 bank_mask:0xf
    v_cvt_pk_bf16_f32 v170, v41, 0
    v_mfma_f32_16x16x32_bf16 v[44:47], v[220:223], v[36:39], 0
    v_mov_b32_dpp v15, v35 quad_perm:[0,1,2,3] row_mask:0x4 bank_mask:0xf
    v_cvt_pk_bf16_f32 v15, v15, v15
    v_mfma_f32_16x16x32_bf16 v[44:47], v[220:223], v[168:171], v[44:47]
    ds_write_b16 v131, v15
    v_mfma_f32_16x16x32_bf16 v[32:35], v[16:19], v[36:39], 0
    ds_read_b128 v[12:15], v137 offset:0
    v_max3_f32 v124, v124, v11, v28
    v_mfma_f32_16x16x32_bf16 v[32:35], v[164:167], v[168:171], v[32:35]
    ds_read_b128 v[146:149], v136 offset:0
    v_max3_f32 v124, v124, v29, v30
    v_mfma_f32_16x16x32_bf16 v[48:51], v[0:3], v[36:39], 0
    ds_read_b128 v[72:75], v137 offset:128
    v_max3_f32 v124, v124, v31, v24
    v_mfma_f32_16x16x32_bf16 v[48:51], v[160:163], v[168:171], v[48:51]
    ds_read_b128 v[88:91], v136 offset:128
    v_max3_f32 v124, v124, v25, v26
    v_mfma_f32_16x16x32_bf16 v[40:43], v[20:23], v[36:39], 0
    ds_read_b128 v[76:79], v137 offset:256
    v_max3_f32 v124, v124, v27, v6
    v_mfma_f32_16x16x32_bf16 v[40:43], v[156:159], v[168:171], v[40:43]
    ds_read_b128 v[56:59], v136 offset:256
    v_mov_b32 v4, v124
    v_rcp_f32 v45, v44
    s_nop 0
    v_mul_f32 v32, v32, v45
    v_mul_f32 v33, v33, v45
    v_cvt_pk_bf16_f32 v32, v32, v33
    v_mul_f32 v34, v34, v45
    v_mul_f32 v35, v35, v45
    v_cvt_pk_bf16_f32 v33, v34, v35
    v_mul_f32 v48, v48, v45
    v_mul_f32 v49, v49, v45
    v_cvt_pk_bf16_f32 v34, v48, v49
    v_mul_f32 v50, v50, v45
    s_waitcnt lgkmcnt(5)
    v_mfma_f32_16x16x32_bf16 v[36:39], a[0:3], v[12:15], 0
    ds_write_b64 v135, v[32:33] offset:1536
    v_mul_f32 v51, v51, v45
    v_cvt_pk_bf16_f32 v35, v50, v51
    v_mul_f32 v40, v40, v45
    v_mul_f32 v41, v41, v45
    v_cvt_pk_bf16_f32 v168, v40, v41
    v_mul_f32 v42, v42, v45
    v_mul_f32 v43, v43, v45
    v_cvt_pk_bf16_f32 v169, v42, v43
    ds_write_b64 v135, v[34:35] offset:1544
    v_permlane32_swap_b32 v4, v124
    v_max_f32 v124, v4, v124
    v_mov_b32 v4, v124
    s_nop 0
    ds_write_b64 v134, v[168:169] offset:1536
    v_permlane16_swap_b32 v4, v124
    v_max_f32 v124, v4, v124
    v_sub_f32 v8, v8, v124
    v_sub_f32 v9, v9, v124
    v_sub_f32 v10, v10, v124
    v_sub_f32 v11, v11, v124
    v_sub_f32 v28, v28, v124
    v_sub_f32 v29, v29, v124
    v_sub_f32 v30, v30, v124
    v_sub_f32 v31, v31, v124
    v_sub_f32 v24, v24, v124
    v_sub_f32 v25, v25, v124
    v_sub_f32 v26, v26, v124
    v_sub_f32 v27, v27, v124
    v_sub_f32 v6, v6, v124
    v_exp_f32 v8, v8
    v_exp_f32 v9, v9
    v_exp_f32 v10, v10
    v_exp_f32 v11, v11
    v_cvt_pk_bf16_f32 v8, v8, v9
    v_cvt_pk_bf16_f32 v9, v10, v11
    v_exp_f32 v28, v28
    v_exp_f32 v29, v29
    v_exp_f32 v30, v30
    v_exp_f32 v31, v31
    v_cvt_pk_bf16_f32 v10, v28, v29
    v_cvt_pk_bf16_f32 v11, v30, v31
    v_exp_f32 v24, v24
    v_exp_f32 v25, v25
    v_exp_f32 v26, v26
    v_exp_f32 v27, v27
    v_cvt_pk_bf16_f32 v168, v24, v25
    v_cvt_pk_bf16_f32 v169, v26, v27
    v_exp_f32 v6, v6
    s_nop 0
    v_cvt_pk_bf16_f32 v170, v6, 0
    v_mfma_f32_16x16x32_bf16 v[152:155], v[220:223], v[8:11], 0
    s_nop 0
    v_mfma_f32_16x16x32_bf16 v[152:155], v[220:223], v[168:171], v[152:155]
    s_nop 1
    v_mfma_f32_16x16x32_bf16 v[4:7], v[16:19], v[8:11], 0
    s_nop 2
    v_mfma_f32_16x16x32_bf16 v[4:7], v[164:167], v[168:171], v[4:7]
    s_nop 0
    v_rcp_f32 v153, v152
    v_mfma_f32_16x16x32_bf16 v[16:19], v[0:3], v[8:11], 0
    s_nop 2
    v_mfma_f32_16x16x32_bf16 v[16:19], v[160:163], v[168:171], v[16:19]
    s_nop 0
    v_mul_f32 v4, v4, v153
    v_mul_f32 v5, v5, v153
    v_mfma_f32_16x16x32_bf16 v[0:3], v[20:23], v[8:11], 0
    v_cvt_pk_bf16_f32 v8, v4, v5
    v_mul_f32 v6, v6, v153
    v_mfma_f32_16x16x32_bf16 v[0:3], v[156:159], v[168:171], v[0:3]
    v_mul_f32 v7, v7, v153
    v_cvt_pk_bf16_f32 v9, v6, v7
    s_waitcnt lgkmcnt(0)
.p2align 6
L_loopS0:
    v_mfma_f32_16x16x32_bf16 v[36:39], a[4:7], v[146:149], v[36:39]
    ds_write_b64 v135, v[8:9] offset:3072
    v_mfma_f32_16x16x32_bf16 v[36:39], a[8:11], v[72:75], v[36:39]
    v_mul_f32 v16, v16, v153
    v_mul_f32 v17, v17, v153
    v_mfma_f32_16x16x32_bf16 v[36:39], a[12:15], v[88:91], v[36:39]
    v_cvt_pk_bf16_f32 v10, v16, v17
    v_mul_f32 v18, v18, v153
    v_mfma_f32_16x16x32_bf16 v[36:39], a[16:19], v[76:79], v[36:39]
    v_mul_f32 v19, v19, v153
    v_cvt_pk_bf16_f32 v11, v18, v19
    v_mfma_f32_16x16x32_bf16 v[36:39], a[20:23], v[56:59], v[36:39]
    ds_write_b64 v135, v[10:11] offset:3080
    v_mfma_f32_16x16x32_bf16 v[8:11], a[24:27], v[12:15], 0
    v_mul_f32 v0, v0, v153
    v_mul_f32 v1, v1, v153
    v_mfma_f32_16x16x32_bf16 v[8:11], a[28:31], v[146:149], v[8:11]
    v_cvt_pk_bf16_f32 v0, v0, v1
    v_mul_f32 v2, v2, v153
    v_mfma_f32_16x16x32_bf16 v[8:11], a[32:35], v[72:75], v[8:11]
    v_mul_f32 v3, v3, v153
    v_cvt_pk_bf16_f32 v1, v2, v3
    v_mfma_f32_16x16x32_bf16 v[8:11], a[36:39], v[88:91], v[8:11]
    ds_write_b64 v134, v[0:1] offset:3072
    v_mfma_f32_16x16x32_bf16 v[8:11], a[40:43], v[76:79], v[8:11]
    v_fma_f32 v170, v40, v40, s42
    v_fmac_f32 v170, v41, v41
    v_mfma_f32_16x16x32_bf16 v[8:11], a[44:47], v[56:59], v[8:11]
    v_fmac_f32 v170, v42, v42
    v_fmac_f32 v170, v43, v43
    v_mfma_f32_16x16x32_bf16 v[152:155], a[48:51], v[12:15], 0
    v_fmac_f32 v170, v140, v140
    v_fmac_f32 v170, v141, v141
    v_mfma_f32_16x16x32_bf16 v[152:155], a[52:55], v[146:149], v[152:155]
    v_fmac_f32 v170, v142, v142
    v_fmac_f32 v170, v143, v143
    v_mfma_f32_16x16x32_bf16 v[152:155], a[56:59], v[72:75], v[152:155]
    s_waitcnt vmcnt(10)
    v_fmac_f32 v170, v44, v44
    v_fmac_f32 v170, v45, v45
    v_mfma_f32_16x16x32_bf16 v[152:155], a[60:63], v[88:91], v[152:155]
    v_fmac_f32 v170, v46, v46
    v_fmac_f32 v170, v47, v47
    v_mfma_f32_16x16x32_bf16 v[152:155], a[64:67], v[76:79], v[152:155]
    v_cvt_pk_bf16_f32 v16, v92, v93
    v_cvt_pk_bf16_f32 v17, v170, v167
    v_mfma_f32_16x16x32_bf16 v[152:155], a[68:71], v[56:59], v[152:155]
    ds_write_b64 v159, v[16:17]
    v_mfma_f32_16x16x32_bf16 v[60:63], a[72:75], v[12:15], 0
    v_add_u32 v135, s49, v135
    v_add_u32 v134, s49, v134
    v_mfma_f32_16x16x32_bf16 v[60:63], a[76:79], v[146:149], v[60:63]
    v_fma_f32 v170, v36, v36, s41
    v_fmac_f32 v170, v37, v37
    v_mfma_f32_16x16x32_bf16 v[60:63], a[80:83], v[72:75], v[60:63]
    v_fmac_f32 v170, v38, v38
    v_fmac_f32 v170, v39, v39
    v_mfma_f32_16x16x32_bf16 v[60:63], a[84:87], v[88:91], v[60:63]
    v_fmac_f32 v170, v8, v8
    v_fmac_f32 v170, v9, v9
    v_mfma_f32_16x16x32_bf16 v[60:63], a[88:91], v[76:79], v[60:63]
    v_fmac_f32 v170, v10, v10
    v_fmac_f32 v170, v11, v11
    v_mfma_f32_16x16x32_bf16 v[60:63], a[92:95], v[56:59], v[60:63]
    v_fmac_f32 v170, v152, v152
    v_fmac_f32 v170, v153, v153
    v_mfma_f32_16x16x32_bf16 v[92:95], a[96:99], v[12:15], 0
    v_fmac_f32 v170, v154, v154
    v_fmac_f32 v170, v155, v155
    v_mfma_f32_16x16x32_bf16 v[92:95], a[100:103], v[146:149], v[92:95]
    s_waitcnt lgkmcnt(0)
    s_nop 0
    v_fma_f32 v124, v60, v60, s41
    v_fmac_f32 v124, v61, v61
    v_mfma_f32_16x16x32_bf16 v[92:95], a[104:107], v[72:75], v[92:95]
    s_barrier
    ds_read_b128 v[16:19], v163 offset:0
    v_fmac_f32 v124, v62, v62
    v_mfma_f32_16x16x32_bf16 v[92:95], a[108:111], v[88:91], v[92:95]
    ds_read_b128 v[0:3], v163 offset:1024
    v_fmac_f32 v124, v63, v63
    v_mfma_f32_16x16x32_bf16 v[92:95], a[112:115], v[76:79], v[92:95]
    v_mfma_f32_16x16x32_bf16 v[92:95], a[116:119], v[56:59], v[92:95]
    s_nop 1
    v_mfma_f32_16x16x32_bf16 v[64:67], a[120:123], v[12:15], 0
    s_nop 2
    v_mfma_f32_16x16x32_bf16 v[64:67], a[124:127], v[146:149], v[64:67]
    s_nop 0
    v_fmac_f32 v124, v92, v92
    v_fmac_f32 v124, v93, v93
    v_mfma_f32_16x16x32_bf16 v[64:67], a[128:131], v[72:75], v[64:67]
    v_fmac_f32 v124, v94, v94
    v_fmac_f32 v124, v95, v95
    v_mfma_f32_16x16x32_bf16 v[64:67], a[132:135], v[88:91], v[64:67]
    v_mfma_f32_16x16x32_bf16 v[64:67], a[136:139], v[76:79], v[64:67]
    v_mfma_f32_16x16x32_bf16 v[64:67], a[140:143], v[56:59], v[64:67]
    s_waitcnt lgkmcnt(1)
    v_readfirstlane_b32 s12, v17
    v_mfma_f32_16x16x32_bf16 v[80:83], v[216:219], v[16:19], 0
    s_waitcnt lgkmcnt(0)
    s_nop 1
    v_mfma_f32_16x16x32_bf16 v[80:83], v[216:219], v[0:3], v[80:83]
    s_lshr_b32 s12, s12, 23
    v_fmac_f32 v124, v64, v64
    v_fmac_f32 v124, v65, v65
    v_mfma_f32_16x16x32_bf16 v[16:19], v[12:15], a[144:147], 0
    v_fmac_f32 v124, v66, v66
    v_fmac_f32 v124, v67, v67
    v_mfma_f32_16x16x32_bf16 v[16:19], v[146:149], a[148:151], v[16:19]
    s_nop 0
    v_rsq_f32 v80, v80
    v_mfma_f32_16x16x32_bf16 v[16:19], v[72:75], a[152:155], v[16:19]
    v_rsq_f32 v81, v81
    v_mfma_f32_16x16x32_bf16 v[16:19], v[88:91], a[156:159], v[16:19]
    v_rsq_f32 v82, v82
    v_mfma_f32_16x16x32_bf16 v[16:19], v[76:79], a[160:163], v[16:19]
    ds_read_b128 v[84:87], v137 offset:1536
    v_mul_f32 v80, s43, v80
    v_mfma_f32_16x16x32_bf16 v[16:19], v[56:59], a[164:167], v[16:19]
    ds_read_b128 v[48:51], v136 offset:1536
    v_mul_f32 v81, s43, v81
    v_mfma_f32_16x16x32_bf16 v[68:71], v[12:15], a[168:171], 0
    ds_read_b128 v[52:55], v137 offset:1664
    v_mul_f32 v82, s43, v82
    v_mfma_f32_16x16x32_bf16 v[68:71], v[146:149], a[172:175], v[68:71]
    ds_read_b128 v[96:99], v136 offset:1664
    v_cvt_pk_bf16_f32 v170, v170, v124
    v_mfma_f32_16x16x32_bf16 v[68:71], v[72:75], a[176:179], v[68:71]
    ds_read_b128 v[112:115], v137 offset:1792
    v_cvt_pk_bf16_f32 v16, v16, v17
    v_mfma_f32_16x16x32_bf16 v[68:71], v[88:91], a[180:183], v[68:71]
    ds_read_b128 v[104:107], v136 offset:1792
    v_cvt_pk_bf16_f32 v17, v18, v19
    v_mfma_f32_16x16x32_bf16 v[68:71], v[76:79], a[184:187], v[68:71]
    v_mul_f32 v32, v32, v80
    v_mul_f32 v33, v33, v80
    v_mfma_f32_16x16x32_bf16 v[68:71], v[56:59], a[188:191], v[68:71]
    s_nop 0
    v_cvt_pk_bf16_f32 v18, v32, v33
    v_mul_f32 v34, v34, v80
    v_mfma_f32_16x16x16_bf16 v[100:103], v[216:217], v[170:171], 0
    s_nop 0
    v_mul_f32 v35, v35, v80
    v_cvt_pk_bf16_f32 v19, v34, v35
    v_mul_f32 v20, v20, v80
    v_cvt_pk_bf16_f32 v0, v68, v69
    v_mfma_f32_16x16x32_bf16 v[32:35], v[12:15], a[192:195], 0
    ds_write_b64 v135, v[18:19] offset:0
    v_mfma_f32_16x16x32_bf16 v[32:35], v[146:149], a[196:199], v[32:35]
    v_rsq_f32 v100, v100
    v_mfma_f32_16x16x32_bf16 v[32:35], v[72:75], a[200:203], v[32:35]
    v_rsq_f32 v101, v101
    v_mfma_f32_16x16x32_bf16 v[32:35], v[88:91], a[204:207], v[32:35]
    v_mul_f32 v100, s55, v100
    v_mul_f32 v101, 0.5, v101
    v_mfma_f32_16x16x32_bf16 v[32:35], v[76:79], a[208:211], v[32:35]
    v_cvt_pk_bf16_f32 v1, v70, v71
    v_mul_f32 v36, v36, v100
    v_mfma_f32_16x16x32_bf16 v[32:35], v[56:59], a[212:215], v[32:35]
    s_waitcnt lgkmcnt(1)
    v_mul_f32 v37, v37, v100
    v_cvt_pk_f16_f32 v76, v36, v37
    v_mfma_f32_16x16x32_bf16 v[146:149], a[0:3], v[84:87], 0
    v_mul_f32 v38, v38, v100
    v_mul_f32 v39, v39, v100
    v_mfma_f32_16x16x32_bf16 v[146:149], a[4:7], v[48:51], v[146:149]
    v_cvt_pk_f16_f32 v77, v38, v39
    v_mul_f32 v8, v8, v100
    v_mfma_f32_16x16x32_bf16 v[146:149], a[8:11], v[52:55], v[146:149]
    v_mul_f32 v9, v9, v100
    v_cvt_pk_f16_f32 v78, v8, v9
    v_mfma_f32_16x16x32_bf16 v[146:149], a[12:15], v[96:99], v[146:149]
    v_mul_f32 v10, v10, v100
    v_mul_f32 v11, v11, v100
    v_mfma_f32_16x16x32_bf16 v[146:149], a[16:19], v[112:115], v[146:149]
    v_cvt_pk_f16_f32 v79, v10, v11
    v_mul_f32 v152, v152, v100
    v_mfma_f32_16x16x32_bf16 v[146:149], a[20:23], v[104:107], v[146:149]
    v_mul_f32 v153, v153, v100
    v_cvt_pk_f16_f32 v152, v152, v153
    v_mfma_f32_16x16x32_bf16 v[36:39], a[24:27], v[84:87], 0
    v_mul_f32 v154, v154, v100
    v_mul_f32 v155, v155, v100
    v_mfma_f32_16x16x32_bf16 v[36:39], a[28:31], v[48:51], v[36:39]
    v_cvt_pk_f16_f32 v153, v154, v155
    v_mul_f32 v60, v60, v101
    v_mfma_f32_16x16x32_bf16 v[36:39], a[32:35], v[52:55], v[36:39]
    v_mul_f32 v61, v61, v101
    v_cvt_pk_f16_f32 v12, v60, v61
    v_mfma_f32_16x16x32_bf16 v[36:39], a[36:39], v[96:99], v[36:39]
    v_mul_f32 v62, v62, v101
    v_mul_f32 v63, v63, v101
    v_mfma_f32_16x16x32_bf16 v[36:39], a[40:43], v[112:115], v[36:39]
    v_cvt_pk_f16_f32 v13, v62, v63
    v_mul_f32 v92, v92, v101
    v_mfma_f32_16x16x32_bf16 v[36:39], a[44:47], v[104:107], v[36:39]
    v_mul_f32 v93, v93, v101
    v_cvt_pk_f16_f32 v14, v92, v93
    v_mfma_f32_16x16x32_bf16 v[72:75], a[48:51], v[84:87], 0
    v_mul_f32 v94, v94, v101
    v_mul_f32 v95, v95, v101
    v_mfma_f32_16x16x32_bf16 v[72:75], a[52:55], v[48:51], v[72:75]
    v_cvt_pk_f16_f32 v15, v94, v95
    v_mul_f32 v64, v64, v101
    v_mfma_f32_16x16x32_bf16 v[72:75], a[56:59], v[52:55], v[72:75]
    v_mul_f32 v65, v65, v101
    v_cvt_pk_f16_f32 v154, v64, v65
    v_mfma_f32_16x16x32_bf16 v[72:75], a[60:63], v[96:99], v[72:75]
    v_mul_f32 v66, v66, v101
    v_mul_f32 v67, v67, v101
    v_mfma_f32_16x16x32_bf16 v[72:75], a[64:67], v[112:115], v[72:75]
    v_cvt_pk_f16_f32 v155, v66, v67
    v_cvt_pk_bf16_f32 v8, v32, v33
    v_mfma_f32_16x16x32_bf16 v[72:75], a[68:71], v[104:107], v[72:75]
    v_cvt_pk_bf16_f32 v9, v34, v35
    v_mul_f32 v21, v21, v80
    v_mfma_f32_16x16x32_bf16 v[32:35], a[72:75], v[84:87], 0
    v_cvt_pk_bf16_f32 v20, v20, v21
    v_mul_f32 v22, v22, v80
    v_mfma_f32_16x16x32_bf16 v[32:35], a[76:79], v[48:51], v[32:35]
    v_mul_f32 v23, v23, v80
    v_cvt_pk_bf16_f32 v21, v22, v23
    v_mfma_f32_16x16x32_bf16 v[32:35], a[80:83], v[52:55], v[32:35]
    ds_write_b64 v135, v[20:21] offset:8
    v_mfma_f32_16x16x32_bf16 v[32:35], a[84:87], v[96:99], v[32:35]
    v_mul_f32 v4, v4, v80
    v_mul_f32 v5, v5, v80
    v_mfma_f32_16x16x32_bf16 v[32:35], a[88:91], v[112:115], v[32:35]
    v_cvt_pk_bf16_f32 v18, v4, v5
    v_mul_f32 v6, v6, v80
    v_mfma_f32_16x16x32_bf16 v[32:35], a[92:95], v[104:107], v[32:35]
    v_mul_f32 v7, v7, v80
    v_cvt_pk_bf16_f32 v19, v6, v7
    v_mfma_f32_16x16x32_bf16 v[20:23], a[96:99], v[84:87], 0
    ds_write_b64 v134, v[18:19] offset:0
    v_mfma_f32_16x16x32_bf16 v[20:23], a[100:103], v[48:51], v[20:23]
    v_fma_f32 v18, v146, v146, s41
    v_fmac_f32 v18, v147, v147
    v_mfma_f32_16x16x32_bf16 v[20:23], a[104:107], v[52:55], v[20:23]
    v_fmac_f32 v18, v148, v148
    v_fmac_f32 v18, v149, v149
    v_mfma_f32_16x16x32_bf16 v[20:23], a[108:111], v[96:99], v[20:23]
    v_fmac_f32 v18, v36, v36
    v_fmac_f32 v18, v37, v37
    v_mfma_f32_16x16x32_bf16 v[20:23], a[112:115], v[112:115], v[20:23]
    v_fmac_f32 v18, v38, v38
    v_fmac_f32 v18, v39, v39
    v_mfma_f32_16x16x32_bf16 v[20:23], a[116:119], v[104:107], v[20:23]
    v_fmac_f32 v18, v72, v72
    v_fmac_f32 v18, v73, v73
    v_mfma_f32_16x16x32_bf16 v[4:7], a[120:123], v[84:87], 0
    v_fmac_f32 v18, v74, v74
    v_fmac_f32 v18, v75, v75
    v_mfma_f32_16x16x32_bf16 v[4:7], a[124:127], v[48:51], v[4:7]
    v_mul_f32 v24, v24, v81
    v_mul_f32 v25, v25, v81
    v_mfma_f32_16x16x32_bf16 v[4:7], a[128:131], v[52:55], v[4:7]
    v_cvt_pk_bf16_f32 v88, v24, v25
    v_mul_f32 v26, v26, v81
    v_mfma_f32_16x16x32_bf16 v[4:7], a[132:135], v[96:99], v[4:7]
    v_mul_f32 v27, v27, v81
    v_cvt_pk_bf16_f32 v89, v26, v27
    v_mfma_f32_16x16x32_bf16 v[4:7], a[136:139], v[112:115], v[4:7]
    ds_write_b64 v135, v[88:89] offset:1536
    v_mfma_f32_16x16x32_bf16 v[4:7], a[140:143], v[104:107], v[4:7]
    v_mul_f32 v28, v28, v81
    v_mul_f32 v29, v29, v81
    v_mfma_f32_16x16x32_bf16 v[60:63], v[84:87], a[144:147], 0
    v_cvt_pk_bf16_f32 v90, v28, v29
    v_mul_f32 v30, v30, v81
    v_mfma_f32_16x16x32_bf16 v[60:63], v[48:51], a[148:151], v[60:63]
    v_mul_f32 v31, v31, v81
    v_cvt_pk_bf16_f32 v91, v30, v31
    v_mfma_f32_16x16x32_bf16 v[60:63], v[52:55], a[152:155], v[60:63]
    ds_write_b64 v135, v[90:91] offset:1544
    v_mfma_f32_16x16x32_bf16 v[60:63], v[96:99], a[156:159], v[60:63]
    v_mul_f32 v108, v108, v81
    v_mul_f32 v109, v109, v81
    v_mfma_f32_16x16x32_bf16 v[60:63], v[112:115], a[160:163], v[60:63]
    ds_read_b128 v[88:91], v137 offset:3072
    v_cvt_pk_bf16_f32 v2, v108, v109
    v_mfma_f32_16x16x32_bf16 v[60:63], v[104:107], a[164:167], v[60:63]
    ds_read_b128 v[56:59], v136 offset:3072
    v_mul_f32 v110, v110, v81
    v_mfma_f32_16x16x32_bf16 v[92:95], v[84:87], a[168:171], 0
    ds_read_b128 v[64:67], v137 offset:3200
    v_mul_f32 v111, v111, v81
    v_mfma_f32_16x16x32_bf16 v[92:95], v[48:51], a[172:175], v[92:95]
    ds_read_b128 v[24:27], v136 offset:3200
    v_cvt_pk_bf16_f32 v3, v110, v111
    v_mfma_f32_16x16x32_bf16 v[92:95], v[52:55], a[176:179], v[92:95]
    ds_write_b64 v134, v[2:3] offset:1536
    v_mfma_f32_16x16x32_bf16 v[92:95], v[96:99], a[180:183], v[92:95]
    v_fma_f32 v19, v32, v32, s41
    v_fmac_f32 v19, v33, v33
    v_mfma_f32_16x16x32_bf16 v[92:95], v[112:115], a[184:187], v[92:95]
    ds_read_b128 v[68:71], v137 offset:3328
    v_fmac_f32 v19, v34, v34
    v_mfma_f32_16x16x32_bf16 v[92:95], v[104:107], a[188:191], v[92:95]
    ds_read_b128 v[28:31], v136 offset:3328
    v_fmac_f32 v19, v35, v35
    v_mfma_f32_16x16x32_bf16 v[108:111], v[84:87], a[192:195], 0
    v_fmac_f32 v19, v20, v20
    v_fmac_f32 v19, v21, v21
    v_mfma_f32_16x16x32_bf16 v[108:111], v[48:51], a[196:199], v[108:111]
    s_sub_u32 s50, s45, s44
    v_fmac_f32 v19, v22, v22
    v_fmac_f32 v19, v23, v23
    v_mfma_f32_16x16x32_bf16 v[108:111], v[52:55], a[200:203], v[108:111]
    s_sub_u32 s51, s46, s47
    v_fmac_f32 v19, v4, v4
    v_fmac_f32 v19, v5, v5
    v_mfma_f32_16x16x32_bf16 v[108:111], v[96:99], a[204:207], v[108:111]
    s_mov_b32 s60, s59
    v_fmac_f32 v19, v6, v6
    v_fmac_f32 v19, v7, v7
    v_mfma_f32_16x16x32_bf16 v[108:111], v[112:115], a[208:211], v[108:111]
    s_mov_b32 s59, s58
    v_cvt_pk_bf16_f32 v170, v18, v19
    v_cvt_pk_bf16_f32 v18, v60, v61
    v_mfma_f32_16x16x32_bf16 v[108:111], v[104:107], a[212:215], v[108:111]
    s_mov_b32 s58, s57
    v_cvt_pk_bf16_f32 v19, v62, v63
    v_cvt_pk_bf16_f32 v2, v92, v93
    v_mfma_f32_16x16x16_bf16 v[60:63], v[216:217], v[170:171], 0
    s_waitcnt lgkmcnt(2)
    s_mov_b32 s57, s56
    v_cvt_pk_bf16_f32 v3, v94, v95
    v_mul_f32 v40, v40, v82
    v_mul_f32 v41, v41, v82
    v_cvt_pk_bf16_f32 v10, v108, v109
    v_mfma_f32_16x16x32_bf16 v[92:95], a[0:3], v[88:91], 0
    s_mov_b32 s7, s6
    v_cvt_pk_bf16_f32 v11, v110, v111
    v_cvt_pk_bf16_f32 v40, v40, v41
    v_mfma_f32_16x16x32_bf16 v[92:95], a[4:7], v[56:59], v[92:95]
    s_mov_b32 s6, s5
    v_rsq_f32 v60, v60
    v_mfma_f32_16x16x32_bf16 v[92:95], a[8:11], v[64:67], v[92:95]
    s_mov_b32 s5, s4
    v_rsq_f32 v61, v61
    v_mfma_f32_16x16x32_bf16 v[92:95], a[12:15], v[24:27], v[92:95]
    s_waitcnt lgkmcnt(0)
    s_sub_u32 s14, s6, s7
    v_mul_f32 v60, s55, v60
    v_mul_f32 v61, 0.5, v61
    v_mfma_f32_16x16x32_bf16 v[92:95], a[16:19], v[68:71], v[92:95]
    s_add_u32 s61, s61, 1
    v_mul_f32 v146, v146, v60
    v_mul_f32 v147, v147, v60
    v_mfma_f32_16x16x32_bf16 v[92:95], a[20:23], v[28:31], v[92:95]
    s_ff1_i32_b32 s15, s66
    v_cvt_pk_f16_f32 v96, v146, v147
    v_mul_f32 v148, v148, v60
    v_mfma_f32_16x16x32_bf16 v[84:87], a[24:27], v[88:91], 0
    s_cmp_lg_u32 s66, 0
    v_mul_f32 v149, v149, v60
    v_cvt_pk_f16_f32 v97, v148, v149
    v_mfma_f32_16x16x32_bf16 v[84:87], a[28:31], v[56:59], v[84:87]
    s_cselect_b32 s12, s15, s12
    v_mul_f32 v36, v36, v60
    v_mul_f32 v37, v37, v60
    v_mfma_f32_16x16x32_bf16 v[84:87], a[32:35], v[64:67], v[84:87]
    s_cmp_lt_u32 s61, s71
    v_cvt_pk_f16_f32 v98, v36, v37
    v_mul_f32 v38, v38, v60
    v_mfma_f32_16x16x32_bf16 v[84:87], a[36:39], v[24:27], v[84:87]
    s_cselect_b32 s15, 31, s15
    v_mul_f32 v39, v39, v60
    v_cvt_pk_f16_f32 v99, v38, v39
    v_mfma_f32_16x16x32_bf16 v[84:87], a[40:43], v[68:71], v[84:87]
    s_bitset0_b32 s66, s15
    v_mul_f32 v72, v72, v60
    v_mul_f32 v73, v73, v60
    v_mfma_f32_16x16x32_bf16 v[84:87], a[44:47], v[28:31], v[84:87]
    s_add_u32 s12, s12, 20
    v_cvt_pk_f16_f32 v146, v72, v73
    v_mul_f32 v74, v74, v60
    v_mfma_f32_16x16x32_bf16 v[48:51], a[48:51], v[88:91], 0
    s_max_u32 s12, s12, s61
    v_mul_f32 v75, v75, v60
    v_cvt_pk_f16_f32 v147, v74, v75
    v_mfma_f32_16x16x32_bf16 v[48:51], a[52:55], v[56:59], v[48:51]
    s_cmp_lt_u32 s61, s71
    v_mul_f32 v32, v32, v61
    v_mul_f32 v33, v33, v61
    v_mfma_f32_16x16x32_bf16 v[48:51], a[56:59], v[64:67], v[48:51]
    s_cselect_b32 s15, s61, s12
    v_cvt_pk_f16_f32 v36, v32, v33
    v_mul_f32 v34, v34, v61
    v_mfma_f32_16x16x32_bf16 v[48:51], a[60:63], v[24:27], v[48:51]
    s_cselect_b32 s56, s69, s70
    v_mul_f32 v35, v35, v61
    v_cvt_pk_f16_f32 v37, v34, v35
    v_mfma_f32_16x16x32_bf16 v[48:51], a[64:67], v[68:71], v[48:51]
    s_add_u32 s56, s56, s15
    v_mul_f32 v20, v20, v61
    v_mul_f32 v21, v21, v61
    v_mfma_f32_16x16x32_bf16 v[48:51], a[68:71], v[28:31], v[48:51]
    s_mul_i32 s53, s56, 58255
    v_cvt_pk_f16_f32 v38, v20, v21
    v_mul_f32 v22, v22, v61
    v_mfma_f32_16x16x32_bf16 v[72:75], a[72:75], v[88:91], 0
    s_lshr_b32 s53, s53, 22
    v_mul_f32 v23, v23, v61
    v_cvt_pk_f16_f32 v39, v22, v23
    v_mfma_f32_16x16x32_bf16 v[72:75], a[76:79], v[56:59], v[72:75]
    s_mul_i32 s53, s53, s63
    v_mul_f32 v4, v4, v61
    v_mul_f32 v5, v5, v61
    v_mfma_f32_16x16x32_bf16 v[72:75], a[80:83], v[64:67], v[72:75]
    s_mul_i32 s56, s56, s62
    v_cvt_pk_f16_f32 v148, v4, v5
    v_mul_f32 v6, v6, v61
    v_mfma_f32_16x16x32_bf16 v[72:75], a[84:87], v[24:27], v[72:75]
    s_add_u32 s56, s56, s53
    v_mul_f32 v7, v7, v61
    v_cvt_pk_f16_f32 v149, v6, v7
    v_mfma_f32_16x16x32_bf16 v[72:75], a[88:91], v[68:71], v[72:75]
    s_mul_i32 s4, s15, 112
    v_mul_f32 v42, v42, v82
    v_mul_f32 v43, v43, v82
    v_mfma_f32_16x16x32_bf16 v[72:75], a[92:95], v[28:31], v[72:75]
    s_cmp_ge_u32 s15, 16
    v_cvt_pk_bf16_f32 v41, v42, v43
    v_mul_f32 v140, v140, v82
    v_mfma_f32_16x16x32_bf16 v[20:23], a[96:99], v[88:91], 0
    s_cselect_b32 s53, -30464, 0
    ds_write_b64 v135, v[40:41] offset:3072
    v_mfma_f32_16x16x32_bf16 v[20:23], a[100:103], v[56:59], v[20:23]
    s_add_u32 s4, s4, s53
    v_mul_f32 v141, v141, v82
    v_cvt_pk_bf16_f32 v42, v140, v141
    v_mfma_f32_16x16x32_bf16 v[20:23], a[104:107], v[64:67], v[20:23]
    s_cmp_lt_u32 s15, s73
    v_mul_f32 v142, v142, v82
    v_mul_f32 v143, v143, v82
    v_mfma_f32_16x16x32_bf16 v[20:23], a[108:111], v[24:27], v[20:23]
    s_cselect_b32 s26, 100270464, 0
    v_cvt_pk_bf16_f32 v43, v142, v143
    v_mul_f32 v44, v44, v82
    v_mfma_f32_16x16x32_bf16 v[20:23], a[112:115], v[68:71], v[20:23]
    s_cselect_b32 s56, s56, 0
    ds_write_b64 v135, v[42:43] offset:3080
    v_mfma_f32_16x16x32_bf16 v[20:23], a[116:119], v[28:31], v[20:23]
    s_cselect_b32 s4, s4, -1
    v_mul_f32 v45, v45, v82
    v_cvt_pk_bf16_f32 v44, v44, v45
    v_mul_f32 v46, v46, v82
    v_mul_f32 v47, v47, v82
    v_cvt_pk_bf16_f32 v45, v46, v47
    s_cselect_b32 s15, s15, 0
    s_cselect_b32 s13, s13, -1
    ds_write_b64 v134, v[44:45] offset:3072
    v_fma_f32 v124, v92, v92, s41
    v_fmac_f32 v124, v93, v93
    v_fmac_f32 v124, v94, v94
    v_fmac_f32 v124, v95, v95
    v_mfma_f32_16x16x32_bf16 v[4:7], a[120:123], v[88:91], 0
    s_waitcnt vmcnt(0)
    v_fmac_f32 v124, v84, v84
    v_fmac_f32 v124, v85, v85
    v_mfma_f32_16x16x32_bf16 v[4:7], a[124:127], v[56:59], v[4:7]
    s_bitset1_b32 s64, s15
    v_fmac_f32 v124, v86, v86
    v_fmac_f32 v124, v87, v87
    v_mfma_f32_16x16x32_bf16 v[4:7], a[128:131], v[64:67], v[4:7]
    s_add_u32 s65, s65, 1
    v_fmac_f32 v124, v48, v48
    v_fmac_f32 v124, v49, v49
    v_mfma_f32_16x16x32_bf16 v[4:7], a[132:135], v[24:27], v[4:7]
    s_cmp_ge_i32 s65, 2
    v_fmac_f32 v124, v50, v50
    v_fmac_f32 v124, v51, v51
    v_mfma_f32_16x16x32_bf16 v[4:7], a[136:139], v[68:71], v[4:7]
    s_cselect_b32 s30, 100270464, 0
    v_fma_f32 v170, v72, v72, s41
    v_fmac_f32 v170, v73, v73
    v_mfma_f32_16x16x32_bf16 v[4:7], a[140:143], v[28:31], v[4:7]
    s_add_u32 s67, s46, s54
    v_fmac_f32 v170, v74, v74
    v_fmac_f32 v170, v75, v75
    v_mfma_f32_16x16x32_bf16 v[32:35], v[88:91], a[144:147], 0
    s_waitcnt lgkmcnt(0)
    s_add_u32 m0, s67, 0
    v_fmac_f32 v170, v20, v20
    v_fmac_f32 v170, v21, v21
    v_mfma_f32_16x16x32_bf16 v[32:35], v[56:59], a[148:151], v[32:35]
    s_barrier
    v_fmac_f32 v170, v22, v22
    v_fmac_f32 v170, v23, v23
    v_mfma_f32_16x16x32_bf16 v[32:35], v[64:67], a[152:155], v[32:35]
    s_cmp_ge_u32 s61, s13
    v_fmac_f32 v170, v4, v4
    v_fmac_f32 v170, v5, v5
    v_mfma_f32_16x16x32_bf16 v[32:35], v[24:27], a[156:159], v[32:35]
    s_cbranch_scc1 L_atomS0
L_atomS0r:
    v_mfma_f32_16x16x32_bf16 v[32:35], v[68:71], a[160:163], v[32:35]
    v_fmac_f32 v170, v6, v6
    v_fmac_f32 v170, v7, v7
    v_mfma_f32_16x16x32_bf16 v[32:35], v[28:31], a[164:167], v[32:35]
    v_cvt_pk_bf16_f32 v170, v124, v170
    v_add_u32 v137, s50, v137
    v_mfma_f32_16x16x32_bf16 v[40:43], v[88:91], a[168:171], 0
    ds_read_b128 v[60:63], v137 offset:0
    v_add_u32 v136, s50, v136
    v_mfma_f32_16x16x32_bf16 v[40:43], v[56:59], a[172:175], v[40:43]
    s_nop 0
    ds_read_b128 v[80:83], v136 offset:0
    v_cvt_pk_bf16_f32 v164, v32, v33
    v_mfma_f32_16x16x32_bf16 v[40:43], v[64:67], a[176:179], v[40:43]
    ds_read_b128 v[52:55], v137 offset:128
    v_cvt_pk_bf16_f32 v165, v34, v35
    v_mfma_f32_16x16x32_bf16 v[40:43], v[24:27], a[180:183], v[40:43]
    ds_read_b128 v[112:115], v136 offset:128
    v_add_u32 v135, s48, v135
    v_mfma_f32_16x16x32_bf16 v[40:43], v[68:71], a[184:187], v[40:43]
    ds_read_b128 v[108:111], v137 offset:256
    v_add_u32 v134, s48, v134
    v_mfma_f32_16x16x32_bf16 v[40:43], v[28:31], a[188:191], v[40:43]
    s_nop 0
    ds_read_b128 v[104:107], v136 offset:256
    v_add_u32 v133, s51, v133
    v_mfma_f32_16x16x16_bf16 v[100:103], v[216:217], v[170:171], 0
    s_nop 0
    v_add_u32 v132, s14, v132
    v_add_u32 v131, s14, v131
    v_add_u32 v125, s14, v125
    v_cvt_pk_bf16_f32 v160, v40, v41
    v_mfma_f32_16x16x32_bf16 v[116:119], v[88:91], a[192:195], 0
    v_cvt_pk_bf16_f32 v161, v42, v43
    v_and_b32 v120, -8, v125
    v_mfma_f32_16x16x32_bf16 v[116:119], v[56:59], a[196:199], v[116:119]
    v_rsq_f32 v100, v100
    v_mfma_f32_16x16x32_bf16 v[116:119], v[64:67], a[200:203], v[116:119]
    v_rsq_f32 v101, v101
    v_mfma_f32_16x16x32_bf16 v[116:119], v[24:27], a[204:207], v[116:119]
    ds_read_b128 v[24:27], v132 offset:0
    v_mul_f32 v100, s55, v100
    v_mfma_f32_16x16x32_bf16 v[116:119], v[68:71], a[208:211], v[116:119]
    ds_read_b128 v[68:71], v132 offset:16
    v_mul_f32 v101, 0.5, v101
    v_mfma_f32_16x16x32_bf16 v[116:119], v[28:31], a[212:215], v[116:119]
    s_waitcnt lgkmcnt(3)
    ds_read_b128 v[28:31], v132 offset:48
    v_mul_f32 v72, v72, v101
    v_mfma_f32_16x16x32_bf16 v[32:35], a[216:219], v[60:63], 0
    ds_read_b128 v[88:91], v133 offset:0
    v_mul_f32 v73, v73, v101
    v_mfma_f32_16x16x32_bf16 v[32:35], a[220:223], v[80:83], v[32:35]
    v_cvt_pk_f16_f32 v40, v72, v73
    v_mul_f32 v74, v74, v101
    v_mfma_f32_16x16x32_bf16 v[32:35], a[224:227], v[52:55], v[32:35]
    v_mul_f32 v75, v75, v101
    v_cvt_pk_f16_f32 v41, v74, v75
    v_mfma_f32_16x16x32_bf16 v[32:35], a[228:231], v[112:115], v[32:35]
    v_mul_f32 v20, v20, v101
    v_mul_f32 v21, v21, v101
    v_mfma_f32_16x16x32_bf16 v[32:35], a[232:235], v[108:111], v[32:35]
    s_waitcnt lgkmcnt(4)
    v_cvt_pk_f16_f32 v42, v20, v21
    v_mul_f32 v22, v22, v101
    v_mfma_f32_16x16x32_bf16 v[32:35], a[236:239], v[104:107], v[32:35]
    v_mul_f32 v23, v23, v101
    v_cvt_pk_f16_f32 v43, v22, v23
    v_mfma_f32_16x16x32_bf16 v[20:23], a[240:243], v[60:63], 0
    v_mul_f32 v4, v4, v101
    v_mul_f32 v5, v5, v101
    v_mfma_f32_16x16x32_bf16 v[20:23], a[244:247], v[80:83], v[20:23]
    v_cvt_pk_f16_f32 v142, v4, v5
    v_mul_f32 v6, v6, v101
    v_mfma_f32_16x16x32_bf16 v[20:23], a[248:251], v[52:55], v[20:23]
    v_mul_f32 v7, v7, v101
    v_cvt_pk_f16_f32 v143, v6, v7
    v_mfma_f32_16x16x32_bf16 v[20:23], a[252:255], v[112:115], v[20:23]
    s_waitcnt lgkmcnt(0)
    buffer_load_dwordx4 v130, s[24:27], s56 offen nt lds
    v_mul_f32 v92, v92, v100
    v_mfma_f32_16x16x32_bf16 v[20:23], v[224:227], v[108:111], v[20:23]
    v_mul_f32 v93, v93, v100
    v_cvt_pk_f16_f32 v44, v92, v93
    v_mfma_f32_16x16x32_bf16 v[20:23], v[228:231], v[104:107], v[20:23]
    v_mul_f32 v94, v94, v100
    v_mul_f32 v95, v95, v100
    v_mfma_f32_16x16x32_bf16 v[4:7], v[232:235], v[60:63], 0
    v_cvt_pk_f16_f32 v45, v94, v95
    v_mul_f32 v84, v84, v100
    v_mfma_f32_16x16x32_bf16 v[4:7], v[236:239], v[80:83], v[4:7]
    v_mul_f32 v85, v85, v100
    v_cvt_pk_f16_f32 v46, v84, v85
    v_mfma_f32_16x16x32_bf16 v[4:7], v[240:243], v[52:55], v[4:7]
    v_mul_f32 v86, v86, v100
    v_mul_f32 v87, v87, v100
    v_mfma_f32_16x16x32_bf16 v[4:7], v[244:247], v[112:115], v[4:7]
    v_cvt_pk_f16_f32 v47, v86, v87
    v_mul_f32 v48, v48, v100
    v_mfma_f32_16x16x32_bf16 v[4:7], v[248:251], v[108:111], v[4:7]
    buffer_store_dwordx4 v[88:91], v130, s[28:31], s60 offen sc1
    v_mul_f32 v49, v49, v100
    v_cvt_pk_f16_f32 v140, v48, v49
    v_mul_f32 v50, v50, v100
    v_mul_f32 v51, v51, v100
    v_mfma_f32_16x16x32_bf16 v[4:7], v[252:255], v[104:107], v[4:7]
    s_add_u32 m0, s67, 1024
    v_cvt_pk_f16_f32 v141, v50, v51
    v_cvt_pk_bf16_f32 v156, v116, v117
    v_mfma_f32_16x16x32_f16 v[112:115], v[12:15], v[76:79], v[204:207]
    ds_read_u16 v166, v131 offset:80
    v_cvt_pk_bf16_f32 v157, v118, v119
    v_mfma_f32_16x16x32_f16 v[112:115], v[152:155], v[150:153], v[112:115]
    ds_read_u16 v162, v131 offset:96
    v_mfma_f32_16x16x32_f16 v[108:111], v[36:39], v[76:79], v[200:203]
    s_nop 0
    ds_read_u16 v158, v131 offset:104
    s_nop 0
    v_mfma_f32_16x16x32_f16 v[108:111], v[146:149], v[150:153], v[108:111]
    s_nop 0
    ds_read_b32 v120, v120 offset:64
    v_max3_f32 v124, v112, v113, v114
    v_mfma_f32_16x16x32_f16 v[104:107], v[40:43], v[76:79], v[196:199]
    ds_read_b128 v[48:51], v133 offset:1024
    v_mfma_f32_16x16x32_f16 v[104:107], v[140:143], v[150:153], v[104:107]
    s_nop 0
    ds_read_b128 v[72:75], v137 offset:1536
    v_max3_f32 v124, v124, v115, v108
    v_mfma_f32_16x16x32_f16 v[88:91], v[24:27], v[76:79], v[208:211]
    ds_read_b128 v[76:79], v136 offset:1536
    v_max3_f32 v124, v124, v109, v110
    v_mfma_f32_16x16x32_f16 v[88:91], v[68:71], v[12:15], v[88:91]
    ds_read_b128 v[60:63], v137 offset:1664
    v_max3_f32 v124, v124, v111, v104
    v_mfma_f32_16x16x32_f16 v[88:91], v[28:31], v[152:155], v[88:91]
    ds_read_b128 v[56:59], v136 offset:1664
    v_max3_f32 v124, v124, v105, v106
    v_mfma_f32_16x16x32_f16 v[92:95], v[24:27], v[96:99], v[208:211]
    ds_read_b128 v[64:67], v137 offset:1792
    s_nop 0
    v_mfma_f32_16x16x32_f16 v[92:95], v[68:71], v[36:39], v[92:95]
    s_nop 0
    ds_read_b128 v[80:83], v136 offset:1792
    v_max3_f32 v124, v124, v107, v88
    v_mfma_f32_16x16x32_f16 v[92:95], v[28:31], v[146:149], v[92:95]
    v_mov_b32 v168, v124
    v_mfma_f32_16x16x32_f16 v[84:87], v[24:27], v[44:47], v[208:211]
    s_nop 0
    v_permlane32_swap_b32 v168, v124
    v_mfma_f32_16x16x32_f16 v[84:87], v[68:71], v[40:43], v[84:87]
    s_waitcnt lgkmcnt(6)
    buffer_load_dwordx4 v129, s[24:27], s56 offen nt lds
    v_max_f32 v124, v168, v124
    v_mfma_f32_16x16x32_f16 v[84:87], v[28:31], v[140:143], v[84:87]
    s_waitcnt lgkmcnt(5)
    v_mov_b32 v168, v124
    v_mov_b32_dpp v91, v95 quad_perm:[0,1,2,3] row_mask:0x2 bank_mask:0xf
    v_mfma_f32_16x16x32_bf16 v[24:27], a[216:219], v[72:75], 0
    s_waitcnt lgkmcnt(4)
    v_permlane16_swap_b32 v168, v124
    v_mfma_f32_16x16x32_bf16 v[24:27], a[220:223], v[76:79], v[24:27]
    s_waitcnt lgkmcnt(3)
    v_max_f32 v124, v168, v124
    v_sub_f32 v112, v112, v124
    v_mfma_f32_16x16x32_bf16 v[24:27], a[224:227], v[60:63], v[24:27]
    s_waitcnt lgkmcnt(2)
    v_sub_f32 v113, v113, v124
    v_sub_f32 v114, v114, v124
    v_mfma_f32_16x16x32_bf16 v[24:27], a[228:231], v[56:59], v[24:27]
    s_waitcnt lgkmcnt(1)
    v_sub_f32 v115, v115, v124
    v_sub_f32 v108, v108, v124
    v_mfma_f32_16x16x32_bf16 v[24:27], a[232:235], v[64:67], v[24:27]
    s_waitcnt lgkmcnt(0)
    v_sub_f32 v109, v109, v124
    v_sub_f32 v110, v110, v124
    v_mfma_f32_16x16x32_bf16 v[24:27], a[236:239], v[80:83], v[24:27]
    buffer_store_dwordx4 v[48:51], v129, s[28:31], s60 offen sc1
    ds_read_b128 v[100:103], v133 offset:2048
    v_sub_f32 v111, v111, v124
    v_sub_f32 v104, v104, v124
    v_sub_f32 v105, v105, v124
    v_mfma_f32_16x16x32_f16 v[48:51], v[12:15], v[96:99], v[192:195]
    s_add_u32 m0, s67, 2048
    v_sub_f32 v106, v106, v124
    v_sub_f32 v107, v107, v124
    v_mfma_f32_16x16x32_f16 v[48:51], v[152:155], v[144:147], v[48:51]
    v_sub_f32 v88, v88, v124
    v_mov_b32_dpp v91, v87 quad_perm:[0,1,2,3] row_mask:0x4 bank_mask:0xf
    v_mfma_f32_16x16x32_f16 v[68:71], v[36:39], v[96:99], v[188:191]
    v_exp_f32 v112, v112
    v_mfma_f32_16x16x32_f16 v[68:71], v[146:149], v[144:147], v[68:71]
    v_exp_f32 v113, v113
    v_mfma_f32_16x16x32_f16 v[52:55], v[40:43], v[96:99], v[184:187]
    v_exp_f32 v114, v114
    v_mfma_f32_16x16x32_f16 v[52:55], v[140:143], v[144:147], v[52:55]
    v_exp_f32 v115, v115
    v_mfma_f32_16x16x32_bf16 v[28:31], a[240:243], v[72:75], 0
    v_cvt_pk_bf16_f32 v96, v112, v113
    v_cvt_pk_bf16_f32 v97, v114, v115
    v_mfma_f32_16x16x32_bf16 v[28:31], a[244:247], v[76:79], v[28:31]
    v_exp_f32 v108, v108
    v_mfma_f32_16x16x32_bf16 v[28:31], a[248:251], v[60:63], v[28:31]
    s_waitcnt lgkmcnt(0)
    buffer_load_dwordx4 v128, s[24:27], s56 offen nt lds
    v_and_b32 v124, 0xffff0000, v120
    v_mfma_f32_16x16x32_bf16 v[28:31], a[252:255], v[56:59], v[28:31]
    v_exp_f32 v109, v109
    v_mfma_f32_16x16x32_bf16 v[28:31], v[224:227], v[64:67], v[28:31]
    v_exp_f32 v110, v110
    v_mfma_f32_16x16x32_bf16 v[28:31], v[228:231], v[80:83], v[28:31]
    s_mov_b32 s53, s47
    v_exp_f32 v111, v111
    v_cvt_pk_bf16_f32 v98, v108, v109
    v_cvt_pk_bf16_f32 v99, v110, v111
    v_exp_f32 v104, v104
    v_exp_f32 v105, v105
    v_exp_f32 v106, v106
    v_exp_f32 v107, v107
    v_cvt_pk_bf16_f32 v168, v104, v105
    v_cvt_pk_bf16_f32 v169, v106, v107
    v_exp_f32 v88, v88
    v_lshlrev_b32 v120, 16, v120
    v_cvt_pk_bf16_f32 v170, v88, 0
    v_mfma_f32_16x16x32_bf16 v[112:115], v[220:223], v[96:99], 0
    s_add_u32 m0, s67, 3072
    buffer_store_dwordx4 v[100:103], v128, s[28:31], s60 offen sc1
    v_add_f32 v120, v120, v124
    v_add_f32 v120, v120, v211
    v_max3_f32 v124, v48, v49, v50
    v_max3_f32 v124, v124, v51, v68
    v_mfma_f32_16x16x32_bf16 v[112:115], v[220:223], v[168:171], v[112:115]
    s_mov_b32 s47, s46
    v_mov_b32_dpp v91, v120 quad_perm:[0,1,2,3] row_mask:0x8 bank_mask:0xf
    v_mov_b32 v84, v91
    v_mfma_f32_16x16x32_bf16 v[108:111], v[16:19], v[96:99], 0
    s_mov_b32 s46, s45
    v_max_f32_dpp v84, v84, v84 row_ror:8 row_mask:0xf bank_mask:0xf
    v_max3_f32 v124, v124, v69, v70
    v_mfma_f32_16x16x32_bf16 v[108:111], v[164:167], v[168:171], v[108:111]
    s_mov_b32 s45, s44
    v_max_f32_dpp v84, v84, v84 row_ror:4 row_mask:0xf bank_mask:0xf
    v_max3_f32 v124, v124, v71, v52
    v_mfma_f32_16x16x32_bf16 v[104:107], v[0:3], v[96:99], 0
    s_mov_b32 s44, s53
    v_max_f32_dpp v84, v84, v84 row_ror:2 row_mask:0xf bank_mask:0xf
    v_max3_f32 v124, v124, v53, v54
    v_mfma_f32_16x16x32_bf16 v[104:107], v[160:163], v[168:171], v[104:107]
    s_sub_u32 s48, s44, s46
    v_max_f32_dpp v84, v84, v84 row_ror:1 row_mask:0xf bank_mask:0xf
    v_mov_b32 v85, v84
    v_mfma_f32_16x16x32_bf16 v[100:103], v[8:11], v[96:99], 0
    s_sub_u32 s49, s46, s45
    v_permlane32_swap_b32 v85, v84
    v_mfma_f32_16x16x32_bf16 v[100:103], v[156:159], v[168:171], v[100:103]
    v_max_f32 v84, v85, v84
    v_mov_b32 v85, v84
    v_rcp_f32 v113, v112
    v_max3_f32 v124, v124, v55, v93
    v_permlane16_swap_b32 v85, v84
    v_max_f32 v84, v85, v84
    v_sub_f32 v91, v91, v84
    v_exp_f32 v91, v91
    v_mul_f32 v108, v108, v113
    v_cvt_pk_bf16_f32 v91, v91, v91
    ds_write_b16 v125, v91 offset:64
    v_mul_f32 v109, v109, v113
    v_cvt_pk_bf16_f32 v88, v108, v109
    ds_read_b128 v[94:97], v132 offset:48
    v_mul_f32 v110, v110, v113
    v_mul_f32 v111, v111, v113
    v_cvt_pk_bf16_f32 v89, v110, v111
    ds_read_b128 v[114:117], v132 offset:64
    v_mfma_f32_16x16x32_bf16 v[108:111], v[232:235], v[72:75], 0
    v_mul_f32 v104, v104, v113
    v_mul_f32 v105, v105, v113
    v_mfma_f32_16x16x32_bf16 v[108:111], v[236:239], v[76:79], v[108:111]
    ds_write_b64 v135, v[88:89] offset:0
    v_mfma_f32_16x16x32_bf16 v[108:111], v[240:243], v[60:63], v[108:111]
    v_cvt_pk_bf16_f32 v90, v104, v105
    v_mul_f32 v106, v106, v113
    v_mfma_f32_16x16x32_bf16 v[108:111], v[244:247], v[56:59], v[108:111]
    v_mul_f32 v107, v107, v113
    v_cvt_pk_bf16_f32 v91, v106, v107
    v_mfma_f32_16x16x32_bf16 v[108:111], v[248:251], v[64:67], v[108:111]
    ds_write_b64 v135, v[90:91] offset:8
    v_mfma_f32_16x16x32_bf16 v[108:111], v[252:255], v[80:83], v[108:111]
    s_waitcnt lgkmcnt(3)
    v_mul_f32 v100, v100, v113
    v_mul_f32 v101, v101, v113
    v_cvt_pk_bf16_f32 v168, v100, v101
    v_mul_f32 v102, v102, v113
    v_mfma_f32_16x16x32_bf16 v[72:75], v[94:97], v[16:19], 0
    s_waitcnt lgkmcnt(2)
    v_mul_f32 v103, v103, v113
    v_cvt_pk_bf16_f32 v169, v102, v103
    v_mov_b32 v170, v124
    v_fma_f32 v92, v32, v32, s42
    v_mfma_f32_16x16x32_bf16 v[72:75], v[114:117], v[164:167], v[72:75]
    ds_write_b64 v134, v[168:169] offset:0
    v_mfma_f32_16x16x32_bf16 v[88:91], v[94:97], v[0:3], 0
    v_permlane32_swap_b32 v170, v124
    v_mfma_f32_16x16x32_bf16 v[88:91], v[114:117], v[160:163], v[88:91]
    v_max_f32 v124, v170, v124
    v_mov_b32 v170, v124
    v_mfma_f32_16x16x32_bf16 v[76:79], v[94:97], v[8:11], 0
    s_nop 0
    v_permlane16_swap_b32 v170, v124
    v_mfma_f32_16x16x32_bf16 v[76:79], v[114:117], v[156:159], v[76:79]
    ds_read_b128 v[60:63], v133 offset:3072
    v_max_f32 v124, v170, v124
    v_sub_f32 v48, v48, v124
    v_sub_f32 v49, v49, v124
    v_sub_f32 v50, v50, v124
    v_sub_f32 v51, v51, v124
    v_sub_f32 v68, v68, v124
    v_sub_f32 v69, v69, v124
    v_sub_f32 v70, v70, v124
    v_sub_f32 v71, v71, v124
    v_sub_f32 v52, v52, v124
    v_sub_f32 v53, v53, v124
    v_sub_f32 v54, v54, v124
    v_sub_f32 v55, v55, v124
    v_sub_f32 v93, v93, v124
    v_exp_f32 v48, v48
    v_exp_f32 v49, v49
    v_exp_f32 v50, v50
    v_exp_f32 v51, v51
    v_cvt_pk_bf16_f32 v56, v48, v49
    v_cvt_pk_bf16_f32 v57, v50, v51
    v_exp_f32 v68, v68
    v_exp_f32 v69, v69
    v_exp_f32 v70, v70
    v_exp_f32 v71, v71
    v_cvt_pk_bf16_f32 v58, v68, v69
    v_cvt_pk_bf16_f32 v59, v70, v71
    v_exp_f32 v52, v52
    v_exp_f32 v53, v53
    v_exp_f32 v54, v54
    v_exp_f32 v55, v55
    v_cvt_pk_bf16_f32 v168, v52, v53
    v_cvt_pk_bf16_f32 v169, v54, v55
    v_exp_f32 v93, v93
    v_mov_b32_dpp v75, v91 quad_perm:[0,1,2,3] row_mask:0x2 bank_mask:0xf
    v_cvt_pk_bf16_f32 v170, v93, 0
    v_mfma_f32_16x16x32_bf16 v[88:91], v[220:223], v[56:59], 0
    s_waitcnt lgkmcnt(0)
    buffer_load_dwordx4 v127, s[24:27], s56 offen nt lds
    ds_read_b128 v[64:67], v137 offset:3072
    v_mfma_f32_16x16x32_bf16 v[88:91], v[220:223], v[168:171], v[88:91]
    v_mov_b32_dpp v75, v79 quad_perm:[0,1,2,3] row_mask:0x4 bank_mask:0xf
    v_cvt_pk_bf16_f32 v75, v75, v75
    v_mfma_f32_16x16x32_bf16 v[76:79], v[16:19], v[56:59], 0
    ds_write_b16 v131, v75
    v_mfma_f32_16x16x32_bf16 v[76:79], v[164:167], v[168:171], v[76:79]
    ds_read_b128 v[72:75], v136 offset:3072
    v_fmac_f32 v92, v33, v33
    v_mfma_f32_16x16x32_bf16 v[80:83], v[0:3], v[56:59], 0
    ds_read_b128 v[48:51], v137 offset:3200
    v_fmac_f32 v92, v34, v34
    v_mfma_f32_16x16x32_bf16 v[80:83], v[160:163], v[168:171], v[80:83]
    ds_read_b128 v[68:71], v136 offset:3200
    v_fmac_f32 v92, v35, v35
    v_mfma_f32_16x16x32_bf16 v[52:55], v[8:11], v[56:59], 0
    ds_read_b128 v[56:59], v137 offset:3328
    v_add_u32 v137, s48, v137
    v_mfma_f32_16x16x32_bf16 v[52:55], v[156:159], v[168:171], v[52:55]
    buffer_store_dwordx4 v[60:63], v127, s[28:31], s60 offen sc1
    ds_read_b128 v[94:97], v136 offset:3328
    v_rcp_f32 v89, v88
    v_add_u32 v136, s48, v136
    v_mfma_f32_16x16x32_f16 v[60:63], v[12:15], v[44:47], v[180:183]
    s_add_u32 m0, s67, 4096
    ds_read_b128 v[12:15], v133 offset:4096
    v_mul_f32 v76, v76, v89
    v_mfma_f32_16x16x32_f16 v[60:63], v[152:155], v[138:141], v[60:63]
    s_cmp_lg_u32 s5, -1
    v_mul_f32 v77, v77, v89
    v_cvt_pk_bf16_f32 v76, v76, v77
    v_mfma_f32_16x16x32_f16 v[152:155], v[36:39], v[44:47], v[176:179]
    v_mul_f32 v78, v78, v89
    v_mul_f32 v79, v79, v89
    v_mfma_f32_16x16x32_f16 v[152:155], v[146:149], v[138:141], v[152:155]
    v_cvt_pk_bf16_f32 v77, v78, v79
    v_mul_f32 v80, v80, v89
    v_mfma_f32_16x16x32_f16 v[36:39], v[40:43], v[44:47], v[172:175]
    ds_write_b64 v135, v[76:77] offset:1536
    v_mfma_f32_16x16x32_f16 v[36:39], v[140:143], v[138:141], v[36:39]
    s_waitcnt lgkmcnt(4)
    v_mul_f32 v81, v81, v89
    v_cvt_pk_bf16_f32 v78, v80, v81
    v_mfma_f32_16x16x32_bf16 v[40:43], a[216:219], v[64:67], 0
    v_mul_f32 v82, v82, v89
    v_mul_f32 v83, v83, v89
    v_mfma_f32_16x16x32_bf16 v[40:43], a[220:223], v[72:75], v[40:43]
    v_cvt_pk_bf16_f32 v79, v82, v83
    v_mul_f32 v52, v52, v89
    v_mfma_f32_16x16x32_bf16 v[40:43], a[224:227], v[48:51], v[40:43]
    ds_write_b64 v135, v[78:79] offset:1544
    v_mfma_f32_16x16x32_bf16 v[40:43], a[228:231], v[68:71], v[40:43]
    s_waitcnt lgkmcnt(2)
    buffer_load_dwordx4 v126, s[24:27], s56 offen nt lds
    v_mul_f32 v53, v53, v89
    v_mfma_f32_16x16x32_bf16 v[40:43], a[232:235], v[56:59], v[40:43]
    v_cvt_pk_bf16_f32 v168, v52, v53
    v_mul_f32 v54, v54, v89
    v_mfma_f32_16x16x32_bf16 v[40:43], a[236:239], v[94:97], v[40:43]
    v_mul_f32 v55, v55, v89
    v_cvt_pk_bf16_f32 v169, v54, v55
    v_mfma_f32_16x16x32_bf16 v[140:143], a[240:243], v[64:67], 0
    ds_write_b64 v134, v[168:169] offset:1536
    v_mfma_f32_16x16x32_bf16 v[140:143], a[244:247], v[72:75], v[140:143]
    v_max3_f32 v168, v60, v61, v62
    v_max3_f32 v168, v168, v63, v152
    v_mfma_f32_16x16x32_bf16 v[140:143], a[248:251], v[48:51], v[140:143]
    v_max3_f32 v168, v168, v153, v154
    v_max3_f32 v168, v168, v155, v36
    v_mfma_f32_16x16x32_bf16 v[140:143], a[252:255], v[68:71], v[140:143]
    v_max3_f32 v168, v168, v37, v38
    v_max3_f32 v168, v168, v39, v86
    v_mfma_f32_16x16x32_bf16 v[140:143], v[224:227], v[56:59], v[140:143]
    buffer_store_dwordx4 v[12:15], v126, s[28:31], s60 offen sc1
    v_mov_b32 v169, v168
    v_fmac_f32 v92, v20, v20
    v_fmac_f32 v92, v21, v21
    v_fmac_f32 v92, v22, v22
    v_mfma_f32_16x16x32_bf16 v[140:143], v[228:231], v[94:97], v[140:143]
    ds_read_b128 v[12:15], v137 offset:0
    v_fmac_f32 v92, v23, v23
    v_mfma_f32_16x16x32_bf16 v[44:47], v[232:235], v[64:67], 0
    ds_read_b128 v[146:149], v136 offset:0
    v_fmac_f32 v92, v4, v4
    v_mfma_f32_16x16x32_bf16 v[44:47], v[236:239], v[72:75], v[44:47]
    ds_read_b128 v[72:75], v137 offset:128
    v_fmac_f32 v92, v5, v5
    v_mfma_f32_16x16x32_bf16 v[44:47], v[240:243], v[48:51], v[44:47]
    ds_read_b128 v[88:91], v136 offset:128
    v_fmac_f32 v92, v6, v6
    v_mfma_f32_16x16x32_bf16 v[44:47], v[244:247], v[68:71], v[44:47]
    ds_read_b128 v[76:79], v137 offset:256
    v_fmac_f32 v92, v7, v7
    v_mfma_f32_16x16x32_bf16 v[44:47], v[248:251], v[56:59], v[44:47]
    ds_read_b128 v[56:59], v136 offset:256
    v_fma_f32 v93, v24, v24, s42
    v_mfma_f32_16x16x32_bf16 v[44:47], v[252:255], v[94:97], v[44:47]
    v_permlane32_swap_b32 v169, v168
    v_max_f32 v168, v169, v168
    v_mov_b32 v169, v168
    v_fmac_f32 v93, v25, v25
    v_fmac_f32 v93, v26, v26
    v_permlane16_swap_b32 v169, v168
    v_max_f32 v168, v169, v168
    v_sub_f32 v60, v60, v168
    v_sub_f32 v61, v61, v168
    v_sub_f32 v62, v62, v168
    v_sub_f32 v63, v63, v168
    v_sub_f32 v152, v152, v168
    v_sub_f32 v153, v153, v168
    v_sub_f32 v154, v154, v168
    v_sub_f32 v155, v155, v168
    v_sub_f32 v36, v36, v168
    v_sub_f32 v37, v37, v168
    v_sub_f32 v38, v38, v168
    v_sub_f32 v39, v39, v168
    v_sub_f32 v86, v86, v168
    v_exp_f32 v60, v60
    v_exp_f32 v61, v61
    v_exp_f32 v62, v62
    v_exp_f32 v63, v63
    v_cvt_pk_bf16_f32 v60, v60, v61
    v_cvt_pk_bf16_f32 v61, v62, v63
    v_exp_f32 v152, v152
    v_exp_f32 v153, v153
    v_exp_f32 v154, v154
    v_exp_f32 v155, v155
    v_cvt_pk_bf16_f32 v62, v152, v153
    v_cvt_pk_bf16_f32 v63, v154, v155
    v_exp_f32 v36, v36
    v_exp_f32 v37, v37
    v_exp_f32 v38, v38
    v_exp_f32 v39, v39
    v_cvt_pk_bf16_f32 v168, v36, v37
    v_cvt_pk_bf16_f32 v169, v38, v39
    v_exp_f32 v86, v86
    v_fmac_f32 v93, v27, v27
    v_cvt_pk_bf16_f32 v170, v86, 0
    v_mfma_f32_16x16x32_bf16 v[152:155], v[220:223], v[60:63], 0
    v_fmac_f32 v93, v28, v28
    v_fmac_f32 v93, v29, v29
    v_mfma_f32_16x16x32_bf16 v[152:155], v[220:223], v[168:171], v[152:155]
    v_fmac_f32 v93, v30, v30
    v_fmac_f32 v93, v31, v31
    v_mfma_f32_16x16x32_bf16 v[36:39], v[16:19], v[60:63], 0
    s_nop 0
    v_fmac_f32 v93, v108, v108
    v_fmac_f32 v93, v109, v109
    v_mfma_f32_16x16x32_bf16 v[36:39], v[164:167], v[168:171], v[36:39]
    s_nop 0
    v_rcp_f32 v153, v152
    v_mfma_f32_16x16x32_bf16 v[16:19], v[0:3], v[60:63], 0
    s_nop 0
    v_fmac_f32 v93, v110, v110
    v_fmac_f32 v93, v111, v111
    v_mfma_f32_16x16x32_bf16 v[16:19], v[160:163], v[168:171], v[16:19]
    s_nop 0
    v_mul_f32 v36, v36, v153
    v_mul_f32 v37, v37, v153
    v_mfma_f32_16x16x32_bf16 v[0:3], v[8:11], v[60:63], 0
    v_cvt_pk_bf16_f32 v8, v36, v37
    v_mul_f32 v38, v38, v153
    v_mfma_f32_16x16x32_bf16 v[0:3], v[156:159], v[168:171], v[0:3]
    s_waitcnt lgkmcnt(0)
    v_mul_f32 v39, v39, v153
    v_cvt_pk_bf16_f32 v9, v38, v39
    v_mfma_f32_16x16x32_bf16 v[36:39], a[0:3], v[12:15], 0
    s_cbranch_scc1 L_loopS0
    ds_write_b64 v135, v[8:9] offset:3072
    v_mul_f32 v16, v16, v153
    v_mul_f32 v17, v17, v153
    v_cvt_pk_bf16_f32 v10, v16, v17
    v_mul_f32 v18, v18, v153
    v_mul_f32 v19, v19, v153
    v_cvt_pk_bf16_f32 v11, v18, v19
    v_mul_f32 v0, v0, v153
    v_mul_f32 v1, v1, v153
    v_cvt_pk_bf16_f32 v0, v0, v1
    v_mul_f32 v2, v2, v153
    v_mul_f32 v3, v3, v153
    v_cvt_pk_bf16_f32 v1, v2, v3
    s_mov_b32 s30, 100270464
    s_mul_i32 s89, s68, 7168
    ds_write_b64 v135, v[10:11] offset:3080
    v_fma_f32 v125, v40, v40, s42
    s_add_u32 s89, s89, 135168
    s_movk_i32 s90, 112
    ds_write_b64 v134, v[0:1] offset:3072
    v_fmac_f32 v125, v41, v41
    v_fmac_f32 v125, v42, v42
    v_fmac_f32 v125, v43, v43
    v_fmac_f32 v125, v140, v140
    v_fmac_f32 v125, v141, v141
    v_fmac_f32 v125, v142, v142
    v_fmac_f32 v125, v143, v143
    v_fmac_f32 v125, v44, v44
    v_fmac_f32 v125, v45, v45
    v_fmac_f32 v125, v46, v46
    v_fmac_f32 v125, v47, v47
    v_cvt_pk_bf16_f32 v124, v92, v93
    v_cvt_pk_bf16_f32 v125, v125, v167
    s_lshr_b32 s91, s64, 16
    s_sub_u32 s84, s45, s44
    ds_write_b64 v159, v[124:125]
    v_mbcnt_lo_u32_b32 v131, -1, 0
    v_mbcnt_hi_u32_b32 v131, -1, v131
    v_and_b32 v132, 15, v131
    v_lshrrev_b32 v131, 4, v131
    v_mul_u32_u24 v18, 1792, v131
    v_add_u32 v18, s89, v18
    v_mad_u32_u24 v131, v132, s90, v18
    v_lshrrev_b32 v124, v132, s64
    v_and_b32 v124, 1, v124
    v_cmp_eq_u32 vcc, 1, v124
    v_mad_u32_u24 v60, v132, s90, v18
    v_lshrrev_b32 v19, v132, s91
    v_cndmask_b32 v131, v18, v131, vcc
    s_sub_u32 s85, s46, s45
    s_sub_u32 s86, s44, s45
    ds_read_b128 v[52:55], v131 offset:64
    ds_read_b128 v[0:3], v131 offset:80
    v_and_b32 v19, 1, v19
    v_subrev_u32 v60, 28672, v60
    s_sub_u32 s93, s44, s47
    s_sub_u32 s94, s45, s47
    ds_read_b128 v[12:15], v131
    s_waitcnt lgkmcnt(3)
    s_barrier
    ds_read_b64 v[16:17], v131 offset:16
    ds_read_b128 v[48:51], v163 offset:0
    ds_read_b128 v[36:39], v163 offset:1024
    v_cmp_eq_u32 vcc, 1, v19
    v_add_u32 v131, s84, v137
    v_add_u32 v132, s84, v136
    v_cndmask_b32 v60, v18, v60, vcc
    s_sub_u32 s95, s46, s47
    s_waitcnt lgkmcnt(5)
    v_mfma_f32_16x16x32_bf16 v[8:11], v[220:223], v[52:55], 0
    s_waitcnt lgkmcnt(4)
    s_lshl_b32 s92, s68, 10
    ds_read_b128 a[24:27], v131 offset:1536
    ds_read_b128 a[32:35], v131 offset:1664
    v_mfma_f32_16x16x32_bf16 v[8:11], v[220:223], v[0:3], v[8:11]
    s_waitcnt lgkmcnt(5)
    ds_read_b128 a[40:43], v131 offset:1792
    v_lshlrev_b32 v125, 16, v12
    v_and_b32 v12, 0xffff0000, v12
    v_lshlrev_b32 v124, 16, v13
    v_and_b32 v13, 0xffff0000, v13
    v_lshlrev_b32 v19, 16, v14
    v_and_b32 v14, 0xffff0000, v14
    v_rcp_f32 v9, v8
    v_lshlrev_b32 v18, 16, v15
    v_mul_f32 v125, v125, v9
    s_waitcnt lgkmcnt(4)
    v_mfma_f32_16x16x32_bf16 v[0:3], v[216:219], v[48:51], 0
    s_waitcnt lgkmcnt(3)
    ds_read_b128 a[28:31], v132 offset:1536
    ds_read_b128 a[36:39], v132 offset:1664
    v_mfma_f32_16x16x32_bf16 v[0:3], v[216:219], v[36:39], v[0:3]
    s_waitcnt lgkmcnt(4)
    ds_read_b128 a[44:47], v132 offset:1792
    v_mul_f32 v12, v12, v9
    v_cvt_pk_bf16_f32 v12, v125, v12
    v_mul_f32 v124, v124, v9
    v_mfma_f32_16x16x32_bf16 v[48:51], a[216:219], a[24:27], 0
    v_mul_f32 v13, v13, v9
    v_cvt_pk_bf16_f32 v13, v124, v13
    v_mul_f32 v19, v19, v9
    v_mul_f32 v14, v14, v9
    v_cvt_pk_bf16_f32 v14, v19, v14
    v_and_b32 v15, 0xffff0000, v15
    v_mul_f32 v18, v18, v9
    v_mul_f32 v15, v15, v9
    v_cvt_pk_bf16_f32 v15, v18, v15
    v_lshlrev_b32 v3, 16, v16
    v_and_b32 v16, 0xffff0000, v16
    v_mul_f32 v3, v3, v9
    v_mul_f32 v16, v16, v9
    v_cvt_pk_bf16_f32 v124, v3, v16
    v_lshlrev_b32 v3, 16, v17
    s_waitcnt lgkmcnt(2)
    v_mfma_f32_16x16x32_bf16 v[48:51], a[220:223], a[28:31], v[48:51]
    ds_read_b128 a[0:3], v131 offset:0
    ds_read_b128 a[4:7], v132 offset:0
    v_mfma_f32_16x16x32_bf16 v[48:51], a[224:227], a[32:35], v[48:51]
    s_waitcnt lgkmcnt(3)
    ds_read_b128 a[8:11], v131 offset:128
    v_and_b32 v17, 0xffff0000, v17
    v_mfma_f32_16x16x32_bf16 v[48:51], a[228:231], a[36:39], v[48:51]
    ds_read_b128 a[12:15], v132 offset:128
    v_mul_f32 v3, v3, v9
    v_mfma_f32_16x16x32_bf16 v[48:51], a[232:235], a[40:43], v[48:51]
    s_waitcnt lgkmcnt(4)
    ds_read_b128 a[16:19], v131 offset:256
    v_mul_f32 v17, v17, v9
    v_mfma_f32_16x16x32_bf16 v[48:51], a[236:239], a[44:47], v[48:51]
    ds_read_b128 a[20:23], v132 offset:256
    v_cvt_pk_bf16_f32 v125, v3, v17
    v_mfma_f32_16x16x32_bf16 v[16:19], a[240:243], a[24:27], 0
    v_rsq_f32 v0, v0
    v_mfma_f32_16x16x32_bf16 v[16:19], a[244:247], a[28:31], v[16:19]
    v_mul_f32 v0, s43, v0
    v_mul_f32 v32, v32, v0
    v_mfma_f32_16x16x32_bf16 v[16:19], a[248:251], a[32:35], v[16:19]
    v_mul_f32 v33, v33, v0
    v_cvt_pk_bf16_f32 v32, v32, v33
    v_mfma_f32_16x16x32_bf16 v[16:19], a[252:255], a[36:39], v[16:19]
    v_mul_f32 v34, v34, v0
    v_mul_f32 v35, v35, v0
    v_mfma_f32_16x16x32_bf16 v[16:19], v[224:227], a[40:43], v[16:19]
    v_cvt_pk_bf16_f32 v33, v34, v35
    v_mul_f32 v20, v20, v0
    v_mfma_f32_16x16x32_bf16 v[16:19], v[228:231], a[44:47], v[16:19]
    v_mul_f32 v21, v21, v0
    v_cvt_pk_bf16_f32 v34, v20, v21
    v_mfma_f32_16x16x32_bf16 v[8:11], v[232:235], a[24:27], 0
    v_mul_f32 v22, v22, v0
    v_mul_f32 v23, v23, v0
    v_mfma_f32_16x16x32_bf16 v[8:11], v[236:239], a[28:31], v[8:11]
    v_cvt_pk_bf16_f32 v35, v22, v23
    v_mul_f32 v4, v4, v0
    v_mfma_f32_16x16x32_bf16 v[8:11], v[240:243], a[32:35], v[8:11]
    v_mul_f32 v5, v5, v0
    v_cvt_pk_bf16_f32 v4, v4, v5
    v_mfma_f32_16x16x32_bf16 v[8:11], v[244:247], a[36:39], v[8:11]
    v_mul_f32 v6, v6, v0
    v_mul_f32 v7, v7, v0
    v_mfma_f32_16x16x32_bf16 v[8:11], v[248:251], a[40:43], v[8:11]
    v_cvt_pk_bf16_f32 v5, v6, v7
    v_add_u32 v0, s85, v135
    v_mfma_f32_16x16x32_bf16 v[8:11], v[252:255], a[44:47], v[8:11]
    s_waitcnt lgkmcnt(0)
    ds_write_b128 v0, v[32:35] offset:0
    v_mfma_f32_16x16x32_bf16 v[52:55], a[216:219], a[0:3], 0
    v_rsq_f32 v1, v1
    v_mfma_f32_16x16x32_bf16 v[52:55], a[220:223], a[4:7], v[52:55]
    ds_read_b128 a[48:51], v131 offset:3072
    v_mul_f32 v1, s43, v1
    v_mfma_f32_16x16x32_bf16 v[52:55], a[224:227], a[8:11], v[52:55]
    ds_read_b128 a[52:55], v132 offset:3072
    v_add_u32 v63, s85, v134
    v_mfma_f32_16x16x32_bf16 v[52:55], a[228:231], a[12:15], v[52:55]
    ds_write_b64 v63, v[4:5] offset:0
    v_mfma_f32_16x16x32_bf16 v[52:55], a[232:235], a[16:19], v[52:55]
    v_rsq_f32 v2, v2
    v_mfma_f32_16x16x32_bf16 v[52:55], a[236:239], a[20:23], v[52:55]
    ds_read_b128 a[56:59], v131 offset:3200
    ds_read_b128 a[60:63], v132 offset:3200
    v_mfma_f32_16x16x32_bf16 v[20:23], a[240:243], a[0:3], 0
    v_mul_f32 v2, s43, v2
    v_mul_f32 v40, v40, v2
    v_mfma_f32_16x16x32_bf16 v[20:23], a[244:247], a[4:7], v[20:23]
    ds_read_b128 a[64:67], v131 offset:3328
    ds_read_b128 a[68:71], v132 offset:3328
    v_mfma_f32_16x16x32_bf16 v[20:23], a[248:251], a[8:11], v[20:23]
    v_mul_f32 v41, v41, v2
    v_cvt_pk_bf16_f32 v32, v40, v41
    v_mfma_f32_16x16x32_bf16 v[20:23], a[252:255], a[12:15], v[20:23]
    v_mul_f32 v42, v42, v2
    v_mul_f32 v43, v43, v2
    v_mfma_f32_16x16x32_bf16 v[20:23], v[224:227], a[16:19], v[20:23]
    v_cvt_pk_bf16_f32 v33, v42, v43
    v_mul_f32 v140, v140, v2
    v_mfma_f32_16x16x32_bf16 v[20:23], v[228:231], a[20:23], v[20:23]
    v_mul_f32 v141, v141, v2
    v_cvt_pk_bf16_f32 v34, v140, v141
    v_mfma_f32_16x16x32_bf16 v[4:7], v[232:235], a[0:3], 0
    v_mul_f32 v142, v142, v2
    v_mul_f32 v143, v143, v2
    v_mfma_f32_16x16x32_bf16 v[4:7], v[236:239], a[4:7], v[4:7]
    v_cvt_pk_bf16_f32 v35, v142, v143
    v_mul_f32 v44, v44, v2
    v_mfma_f32_16x16x32_bf16 v[4:7], v[240:243], a[8:11], v[4:7]
    ds_write_b128 v0, v[32:35] offset:3072
    v_mfma_f32_16x16x32_bf16 v[4:7], v[244:247], a[12:15], v[4:7]
    v_mul_f32 v45, v45, v2
    v_cvt_pk_bf16_f32 v44, v44, v45
    v_mfma_f32_16x16x32_bf16 v[4:7], v[248:251], a[16:19], v[4:7]
    v_mul_f32 v46, v46, v2
    v_mul_f32 v47, v47, v2
    v_mfma_f32_16x16x32_bf16 v[4:7], v[252:255], a[20:23], v[4:7]
    s_waitcnt lgkmcnt(1)
    v_cvt_pk_bf16_f32 v45, v46, v47
    v_add_u32 v138, s86, v135
    v_mfma_f32_16x16x32_bf16 v[32:35], a[216:219], a[48:51], 0
    ds_write_b64 v63, v[44:45] offset:3072
    v_mfma_f32_16x16x32_bf16 v[32:35], a[220:223], a[52:55], v[32:35]
    ds_write_b128 v138, v[12:15] offset:0
    v_mfma_f32_16x16x32_bf16 v[32:35], a[224:227], a[56:59], v[32:35]
    v_add_u32 v132, s86, v134
    v_add_u32 v131, s93, v133
    v_mfma_f32_16x16x32_bf16 v[32:35], a[228:231], a[60:63], v[32:35]
    v_add_u32 v139, s94, v133
    v_add_u32 v3, s95, v133
    v_mfma_f32_16x16x32_bf16 v[32:35], a[232:235], a[64:67], v[32:35]
    ds_write_b64 v132, v[124:125] offset:0
    v_mfma_f32_16x16x32_bf16 v[32:35], a[236:239], a[68:71], v[32:35]
    ds_read_b128 v[64:67], v60 offset:64
    v_fma_f32 v62, v52, v52, s42
    v_mfma_f32_16x16x32_bf16 v[40:43], a[240:243], a[48:51], 0
    ds_read_b128 v[44:47], v60 offset:80
    v_fmac_f32 v62, v53, v53
    v_mfma_f32_16x16x32_bf16 v[40:43], a[244:247], a[52:55], v[40:43]
    ds_read_b128 v[56:59], v60
    v_fmac_f32 v62, v54, v54
    v_mfma_f32_16x16x32_bf16 v[40:43], a[248:251], a[56:59], v[40:43]
    ds_read_b64 v[60:61], v60 offset:16
    v_fmac_f32 v62, v55, v55
    v_mfma_f32_16x16x32_bf16 v[40:43], a[252:255], a[60:63], v[40:43]
    v_fmac_f32 v62, v20, v20
    v_fmac_f32 v62, v21, v21
    v_mfma_f32_16x16x32_bf16 v[40:43], v[224:227], a[64:67], v[40:43]
    v_fmac_f32 v62, v22, v22
    v_fmac_f32 v62, v23, v23
    v_mfma_f32_16x16x32_bf16 v[40:43], v[228:231], a[68:71], v[40:43]
    v_fmac_f32 v62, v4, v4
    v_fmac_f32 v62, v5, v5
    v_mfma_f32_16x16x32_bf16 v[12:15], v[232:235], a[48:51], 0
    v_fmac_f32 v62, v6, v6
    v_fmac_f32 v62, v7, v7
    v_mfma_f32_16x16x32_bf16 v[12:15], v[236:239], a[52:55], v[12:15]
    v_mul_f32 v24, v24, v1
    v_mul_f32 v25, v25, v1
    v_mfma_f32_16x16x32_bf16 v[12:15], v[240:243], a[56:59], v[12:15]
    v_cvt_pk_bf16_f32 v24, v24, v25
    v_mul_f32 v26, v26, v1
    v_mfma_f32_16x16x32_bf16 v[12:15], v[244:247], a[60:63], v[12:15]
    v_mul_f32 v27, v27, v1
    v_cvt_pk_bf16_f32 v25, v26, v27
    v_mfma_f32_16x16x32_bf16 v[12:15], v[248:251], a[64:67], v[12:15]
    v_mul_f32 v28, v28, v1
    v_mul_f32 v29, v29, v1
    v_mfma_f32_16x16x32_bf16 v[12:15], v[252:255], a[68:71], v[12:15]
    s_waitcnt lgkmcnt(0)
    v_cvt_pk_bf16_f32 v26, v28, v29
    v_mul_f32 v30, v30, v1
    v_mfma_f32_16x16x32_bf16 v[36:39], v[220:223], v[64:67], 0
    v_mul_f32 v31, v31, v1
    v_cvt_pk_bf16_f32 v27, v30, v31
    v_mfma_f32_16x16x32_bf16 v[36:39], v[220:223], v[44:47], v[36:39]
    ds_write_b128 v0, v[24:27] offset:1536
    v_mul_f32 v108, v108, v1
    v_mul_f32 v109, v109, v1
    v_cvt_pk_bf16_f32 v108, v108, v109
    v_mul_f32 v110, v110, v1
    v_mul_f32 v111, v111, v1
    v_cvt_pk_bf16_f32 v109, v110, v111
    ds_write_b64 v63, v[108:109] offset:1536
    v_fma_f32 v63, v32, v32, s42
    v_fmac_f32 v63, v33, v33
    v_fmac_f32 v63, v34, v34
    v_fmac_f32 v63, v35, v35
    v_fmac_f32 v63, v40, v40
    v_fmac_f32 v63, v41, v41
    v_fmac_f32 v63, v42, v42
    v_fmac_f32 v63, v43, v43
    v_fmac_f32 v63, v12, v12
    v_fmac_f32 v63, v13, v13
    v_fmac_f32 v63, v14, v14
    v_fmac_f32 v63, v15, v15
    v_cvt_pk_bf16_f32 v63, v63, v63
    v_fma_f32 v133, v48, v48, s42
    v_fmac_f32 v133, v49, v49
    v_fmac_f32 v133, v50, v50
    v_fmac_f32 v133, v51, v51
    v_fmac_f32 v133, v16, v16
    v_fmac_f32 v133, v17, v17
    v_fmac_f32 v133, v18, v18
    v_fmac_f32 v133, v19, v19
    v_fmac_f32 v133, v8, v8
    v_fmac_f32 v133, v9, v9
    v_fmac_f32 v133, v10, v10
    v_fmac_f32 v133, v11, v11
    v_cvt_pk_bf16_f32 v62, v62, v133
    ds_write_b64 v159, v[62:63] offset:2048
    v_rcp_f32 v37, v36
    v_lshlrev_b32 v133, 16, v56
    v_and_b32 v56, 0xffff0000, v56
    v_mul_f32 v133, v133, v37
    v_mul_f32 v56, v56, v37
    v_cvt_pk_bf16_f32 v24, v133, v56
    v_lshlrev_b32 v56, 16, v57
    v_and_b32 v57, 0xffff0000, v57
    v_mul_f32 v56, v56, v37
    v_mul_f32 v57, v57, v37
    v_cvt_pk_bf16_f32 v25, v56, v57
    v_lshlrev_b32 v133, 16, v58
    v_and_b32 v58, 0xffff0000, v58
    v_mul_f32 v133, v133, v37
    v_mul_f32 v58, v58, v37
    v_cvt_pk_bf16_f32 v26, v133, v58
    v_lshlrev_b32 v27, 16, v59
    v_and_b32 v59, 0xffff0000, v59
    v_mul_f32 v27, v27, v37
    v_mul_f32 v59, v59, v37
    v_cvt_pk_bf16_f32 v27, v27, v59
    v_lshlrev_b32 v133, 16, v60
    v_and_b32 v60, 0xffff0000, v60
    v_mul_f32 v133, v133, v37
    v_mul_f32 v60, v60, v37
    v_cvt_pk_bf16_f32 v0, v133, v60
    v_lshlrev_b32 v133, 16, v61
    v_and_b32 v61, 0xffff0000, v61
    v_mul_f32 v133, v133, v37
    v_mul_f32 v61, v61, v37
    v_cvt_pk_bf16_f32 v1, v133, v61
    s_waitcnt lgkmcnt(0)
    s_barrier
    ds_write_b128 v138, v[24:27] offset:1536
    v_mov_b32 v125, 0
    v_add_u32 v47, s92, v163
    ds_write_b64 v132, v[0:1] offset:1536
    ds_read_b128 v[28:31], v163 offset:2048
    ds_read_b128 v[24:27], v163 offset:3072
    ds_read_b128 a[144:147], v3 offset:0
    ds_read_b128 a[148:151], v3 offset:1024
    ds_read_b128 a[152:155], v3 offset:2048
    s_waitcnt lgkmcnt(5)
    s_barrier
    s_waitcnt lgkmcnt(4)
    v_mfma_f32_16x16x32_bf16 v[36:39], v[216:219], v[28:31], 0
    s_waitcnt lgkmcnt(3)
    ds_read_b128 a[72:75], v137 offset:0
    ds_read_b128 a[76:79], v136 offset:0
    v_mfma_f32_16x16x32_bf16 v[36:39], v[216:219], v[24:27], v[36:39]
    s_waitcnt lgkmcnt(4)
    ds_read_b128 a[80:83], v137 offset:128
    s_nop 0
    buffer_store_dwordx4 a[144:147], v130, s[28:31], s59 offen sc1
    s_nop 0
    ds_read_b128 a[84:87], v136 offset:128
    s_nop 1
    v_rsq_f32 v36, v36
    ds_read_b128 a[88:91], v137 offset:256
    ds_read_b128 a[92:95], v136 offset:256
    v_mul_f32 v36, s43, v36
    v_mul_f32 v52, v52, v36
    v_mul_f32 v53, v53, v36
    ds_read_b128 a[96:99], v137 offset:1536
    v_cvt_pk_bf16_f32 v0, v52, v53
    s_waitcnt lgkmcnt(6)
    v_mfma_f32_16x16x32_bf16 v[24:27], a[216:219], a[72:75], 0
    s_waitcnt lgkmcnt(5)
    ds_read_b128 a[100:103], v136 offset:1536
    ds_read_b128 a[104:107], v137 offset:1664
    v_mfma_f32_16x16x32_bf16 v[24:27], a[220:223], a[76:79], v[24:27]
    s_waitcnt lgkmcnt(6)
    buffer_store_dwordx4 a[148:151], v129, s[28:31], s59 offen sc1
    ds_read_b128 a[108:111], v136 offset:1664
    v_mul_f32 v54, v54, v36
    v_mul_f32 v55, v55, v36
    v_cvt_pk_bf16_f32 v1, v54, v55
    v_mfma_f32_16x16x32_bf16 v[24:27], a[224:227], a[80:83], v[24:27]
    s_waitcnt lgkmcnt(6)
    ds_read_b128 a[112:115], v137 offset:1792
    v_mul_f32 v20, v20, v36
    v_mfma_f32_16x16x32_bf16 v[24:27], a[228:231], a[84:87], v[24:27]
    s_waitcnt lgkmcnt(6)
    ds_read_b128 a[116:119], v136 offset:1792
    v_mul_f32 v21, v21, v36
    v_mfma_f32_16x16x32_bf16 v[24:27], a[232:235], a[88:91], v[24:27]
    s_waitcnt lgkmcnt(6)
    ds_read_b128 a[156:159], v3 offset:3072
    v_cvt_pk_bf16_f32 v2, v20, v21
    v_mfma_f32_16x16x32_bf16 v[24:27], a[236:239], a[92:95], v[24:27]
    ds_read_b128 a[160:163], v3 offset:4096
    v_mul_f32 v22, v22, v36
    v_mfma_f32_16x16x32_bf16 v[28:31], a[240:243], a[72:75], 0
    v_mul_f32 v23, v23, v36
    v_cvt_pk_bf16_f32 v3, v22, v23
    v_mfma_f32_16x16x32_bf16 v[28:31], a[244:247], a[76:79], v[28:31]
    s_nop 0
    buffer_store_dwordx4 a[152:155], v128, s[28:31], s59 offen sc1
    v_fma_f32 v133, v24, v24, s42
    v_fmac_f32 v133, v25, v25
    v_fmac_f32 v133, v26, v26
    v_fmac_f32 v133, v27, v27
    v_mfma_f32_16x16x32_bf16 v[28:31], a[248:251], a[80:83], v[28:31]
    v_mul_f32 v4, v4, v36
    v_mul_f32 v5, v5, v36
    v_mfma_f32_16x16x32_bf16 v[28:31], a[252:255], a[84:87], v[28:31]
    v_cvt_pk_bf16_f32 v136, v4, v5
    v_mul_f32 v6, v6, v36
    v_mfma_f32_16x16x32_bf16 v[28:31], v[224:227], a[88:91], v[28:31]
    v_rsq_f32 v37, v37
    v_mfma_f32_16x16x32_bf16 v[28:31], v[228:231], a[92:95], v[28:31]
    v_mul_f32 v7, v7, v36
    v_cvt_pk_bf16_f32 v137, v6, v7
    v_mfma_f32_16x16x32_bf16 v[20:23], v[232:235], a[72:75], 0
    v_rsq_f32 v38, v38
    v_mfma_f32_16x16x32_bf16 v[20:23], v[236:239], a[76:79], v[20:23]
    s_waitcnt lgkmcnt(0)
    s_nop 0
    buffer_store_dwordx4 a[156:159], v127, s[28:31], s59 offen sc1
    v_fmac_f32 v133, v28, v28
    v_fmac_f32 v133, v29, v29
    v_fmac_f32 v133, v30, v30
    v_fmac_f32 v133, v31, v31
    v_mfma_f32_16x16x32_bf16 v[20:23], v[240:243], a[80:83], v[20:23]
    v_mul_f32 v37, s43, v37
    v_mul_f32 v48, v48, v37
    v_mfma_f32_16x16x32_bf16 v[20:23], v[244:247], a[84:87], v[20:23]
    v_mul_f32 v49, v49, v37
    v_cvt_pk_bf16_f32 v44, v48, v49
    v_mfma_f32_16x16x32_bf16 v[20:23], v[248:251], a[88:91], v[20:23]
    v_mul_f32 v50, v50, v37
    v_mul_f32 v51, v51, v37
    v_mfma_f32_16x16x32_bf16 v[20:23], v[252:255], a[92:95], v[20:23]
    v_cvt_pk_bf16_f32 v45, v50, v51
    v_mul_f32 v16, v16, v37
    v_mfma_f32_16x16x32_bf16 v[4:7], a[216:219], a[96:99], 0
    v_mul_f32 v17, v17, v37
    v_cvt_pk_bf16_f32 v46, v16, v17
    v_mfma_f32_16x16x32_bf16 v[4:7], a[220:223], a[100:103], v[4:7]
    ds_write_b128 v135, v[0:3] offset:0
    v_mfma_f32_16x16x32_bf16 v[4:7], a[224:227], a[104:107], v[4:7]
    buffer_store_dwordx4 a[160:163], v126, s[28:31], s59 offen sc1
    v_fmac_f32 v133, v20, v20
    v_fmac_f32 v133, v21, v21
    v_fmac_f32 v133, v22, v22
    v_fmac_f32 v133, v23, v23
    v_mfma_f32_16x16x32_bf16 v[4:7], a[228:231], a[108:111], v[4:7]
    ds_write_b64 v134, v[136:137] offset:0
    v_mfma_f32_16x16x32_bf16 v[4:7], a[232:235], a[112:115], v[4:7]
    ds_read_b128 v[0:3], v47 offset:6144
    v_mul_f32 v18, v18, v37
    v_mfma_f32_16x16x32_bf16 v[4:7], a[236:239], a[116:119], v[4:7]
    v_mul_f32 v19, v19, v37
    v_cvt_pk_bf16_f32 v47, v18, v19
    v_mfma_f32_16x16x32_bf16 v[16:19], a[240:243], a[96:99], 0
    ds_write_b128 v135, v[44:47] offset:1536
    v_mfma_f32_16x16x32_bf16 v[16:19], a[244:247], a[100:103], v[16:19]
    v_mul_f32 v8, v8, v37
    v_mul_f32 v9, v9, v37
    v_mfma_f32_16x16x32_bf16 v[16:19], a[248:251], a[104:107], v[16:19]
    v_cvt_pk_bf16_f32 v136, v8, v9
    v_mul_f32 v10, v10, v37
    v_mfma_f32_16x16x32_bf16 v[16:19], a[252:255], a[108:111], v[16:19]
    v_mul_f32 v11, v11, v37
    v_cvt_pk_bf16_f32 v137, v10, v11
    v_mfma_f32_16x16x32_bf16 v[16:19], v[224:227], a[112:115], v[16:19]
    ds_write_b64 v134, v[136:137] offset:1536
    v_mfma_f32_16x16x32_bf16 v[16:19], v[228:231], a[116:119], v[16:19]
    v_mul_f32 v38, s43, v38
    v_mul_f32 v32, v32, v38
    v_mfma_f32_16x16x32_bf16 v[8:11], v[232:235], a[96:99], 0
    v_mul_f32 v33, v33, v38
    v_cvt_pk_bf16_f32 v32, v32, v33
    v_mfma_f32_16x16x32_bf16 v[8:11], v[236:239], a[100:103], v[8:11]
    v_mul_f32 v34, v34, v38
    v_mul_f32 v35, v35, v38
    v_mfma_f32_16x16x32_bf16 v[8:11], v[240:243], a[104:107], v[8:11]
    v_cvt_pk_bf16_f32 v33, v34, v35
    v_mul_f32 v40, v40, v38
    v_mfma_f32_16x16x32_bf16 v[8:11], v[244:247], a[108:111], v[8:11]
    v_mul_f32 v41, v41, v38
    v_cvt_pk_bf16_f32 v34, v40, v41
    v_mfma_f32_16x16x32_bf16 v[8:11], v[248:251], a[112:115], v[8:11]
    v_mul_f32 v42, v42, v38
    v_mul_f32 v43, v43, v38
    v_mfma_f32_16x16x32_bf16 v[8:11], v[252:255], a[116:119], v[8:11]
    v_cvt_pk_bf16_f32 v35, v42, v43
    v_mul_f32 v12, v12, v38
    v_mul_f32 v13, v13, v38
    v_cvt_pk_bf16_f32 v136, v12, v13
    v_mul_f32 v14, v14, v38
    v_mul_f32 v15, v15, v38
    v_cvt_pk_bf16_f32 v137, v14, v15
    ds_write_b128 v135, v[32:35] offset:3072
    v_fma_f32 v124, v4, v4, s42
    v_fmac_f32 v124, v5, v5
    v_fmac_f32 v124, v6, v6
    v_fmac_f32 v124, v7, v7
    ds_write_b64 v134, v[136:137] offset:3072
    v_fmac_f32 v124, v16, v16
    v_fmac_f32 v124, v17, v17
    v_fmac_f32 v124, v18, v18
    v_fmac_f32 v124, v19, v19
    v_fmac_f32 v124, v8, v8
    v_fmac_f32 v124, v9, v9
    v_fmac_f32 v124, v10, v10
    v_fmac_f32 v124, v11, v11
    v_cvt_pk_bf16_f32 v124, v133, v124
    ds_write_b64 v159, v[124:125] offset:4096
    s_waitcnt lgkmcnt(3)
    v_lshrrev_b32 v124, 0, v3
    v_lshrrev_b32 v124, v124, s64
    v_and_b32 v124, 1, v124
    v_cmp_eq_u32 vcc, 1, v124
    v_lshrrev_b32 v124, 8, v3
    v_lshrrev_b32 v124, v124, s64
    v_cndmask_b32 v0, 2.0, v0, vcc
    v_and_b32 v124, 1, v124
    s_waitcnt lgkmcnt(1)
    s_barrier
    ds_read_b128 a[164:167], v139 offset:0
    ds_read_b128 a[168:171], v139 offset:1024
    v_cmp_eq_u32 vcc, 1, v124
    v_lshrrev_b32 v3, 16, v3
    s_waitcnt lgkmcnt(2)
    s_barrier
    ds_read_b128 a[172:175], v139 offset:2048
    v_cndmask_b32 v1, 2.0, v1, vcc
    ds_read_b128 a[176:179], v139 offset:3072
    v_lshrrev_b32 v3, v3, s64
    ds_read_b128 a[180:183], v139 offset:4096
    v_and_b32 v3, 1, v3
    ds_read_b128 v[36:39], v163 offset:4096
    v_cmp_eq_u32 vcc, 1, v3
    ds_read_b128 v[32:35], v163 offset:5120
    s_nop 0
    v_cndmask_b32 v2, 2.0, v2, vcc
    s_waitcnt lgkmcnt(6)
    buffer_store_dwordx4 a[164:167], v130, s[28:31], s58 offen sc1
    s_waitcnt lgkmcnt(1)
    v_mfma_f32_16x16x32_bf16 v[12:15], v[216:219], v[36:39], 0
    s_waitcnt lgkmcnt(0)
    v_mfma_f32_16x16x32_bf16 v[12:15], v[216:219], v[32:35], v[12:15]
    s_nop 2
    buffer_store_dwordx4 a[168:171], v129, s[28:31], s58 offen sc1
    s_nop 3
    v_rsq_f32 v12, v12
    v_rsq_f32 v13, v13
    v_mul_f32 v12, s43, v12
    v_mul_f32 v24, v24, v12
    v_mul_f32 v25, v25, v12
    v_cvt_pk_bf16_f32 v24, v24, v25
    v_mul_f32 v26, v26, v12
    v_mul_f32 v27, v27, v12
    v_cvt_pk_bf16_f32 v25, v26, v27
    v_mul_f32 v28, v28, v12
    v_mul_f32 v29, v29, v12
    v_cvt_pk_bf16_f32 v26, v28, v29
    v_mul_f32 v30, v30, v12
    v_mul_f32 v31, v31, v12
    v_cvt_pk_bf16_f32 v27, v30, v31
    v_mul_f32 v20, v20, v12
    v_mul_f32 v21, v21, v12
    buffer_store_dwordx4 a[172:175], v128, s[28:31], s58 offen sc1
    ds_write_b128 v138, v[24:27] offset:0
    v_cvt_pk_bf16_f32 v14, v20, v21
    v_mul_f32 v22, v22, v12
    v_mul_f32 v23, v23, v12
    v_cvt_pk_bf16_f32 v15, v22, v23
    ds_write_b64 v132, v[14:15] offset:0
    v_mul_f32 v13, s43, v13
    v_mul_f32 v4, v4, v13
    v_mul_f32 v5, v5, v13
    v_cvt_pk_bf16_f32 v4, v4, v5
    v_mul_f32 v6, v6, v13
    v_mul_f32 v7, v7, v13
    v_cvt_pk_bf16_f32 v5, v6, v7
    v_mul_f32 v16, v16, v13
    v_mul_f32 v17, v17, v13
    buffer_store_dwordx4 a[176:179], v127, s[28:31], s58 offen sc1
    v_cvt_pk_bf16_f32 v6, v16, v17
    v_mul_f32 v18, v18, v13
    v_mul_f32 v19, v19, v13
    v_cvt_pk_bf16_f32 v7, v18, v19
    v_mul_f32 v8, v8, v13
    v_mul_f32 v9, v9, v13
    v_cvt_pk_bf16_f32 v124, v8, v9
    v_mul_f32 v10, v10, v13
    v_mul_f32 v11, v11, v13
    v_cvt_pk_bf16_f32 v125, v10, v11
    ds_write_b128 v138, v[4:7] offset:1536
    ds_write_b64 v132, v[124:125] offset:1536
    buffer_store_dwordx4 a[180:183], v126, s[28:31], s58 offen sc1
    s_waitcnt lgkmcnt(0)
    s_barrier
    ds_read_b128 a[184:187], v131 offset:0
    ds_read_b128 a[188:191], v131 offset:1024
    ds_read_b128 a[192:195], v131 offset:2048
    s_waitcnt lgkmcnt(2)
    buffer_store_dwordx4 a[184:187], v0, s[28:31], 0 offen sc1
    s_waitcnt lgkmcnt(0)
    buffer_store_dwordx4 a[188:191], v1, s[28:31], 0 offen sc1
    buffer_store_dwordx4 a[192:195], v2, s[28:31], 0 offen sc1
    s_branch L_fin
L_again:
    s_waitcnt vmcnt(0) lgkmcnt(0)
    s_nop 15
    s_barrier
    s_movk_i32 s2, 256
    s_branch L_top
L_bndS:
    s_movk_i32 s73, 20
    s_movk_i32 s71, 18
    s_movk_i32 s70, -20
    s_mov_b32 s74, 0
    s_bitcmp1_b32 s2, 2
    s_cbranch_scc1 L_bndcS
    s_sub_u32 s94, s2, 248
    s_mul_i32 s69, s94, 18
    s_mov_b32 s74, 2
    s_sub_u32 s93, s93, 1373568
    v_cmp_le_u32 vcc, 4, v35
    v_add_u32 v16, 98896896, v130
    v_subrev_u32 v17, 1373568, v130
    v_cndmask_b32 v130, v16, v17, vcc
    v_cmp_le_u32 vcc, 4, v25
    v_add_u32 v16, 98896896, v129
    v_subrev_u32 v17, 1373568, v129
    v_cndmask_b32 v129, v16, v17, vcc
    v_cmp_le_u32 vcc, 4, v11
    v_add_u32 v16, 98896896, v128
    v_subrev_u32 v17, 1373568, v128
    v_cndmask_b32 v128, v16, v17, vcc
    v_cmp_le_u32 vcc, 4, v125
    v_add_u32 v16, 98896896, v127
    v_subrev_u32 v17, 1373568, v127
    v_cndmask_b32 v127, v16, v17, vcc
    v_cmp_le_u32 vcc, 4, v7
    v_add_u32 v16, 98896896, v126
    v_subrev_u32 v17, 1373568, v126
    v_cndmask_b32 v126, v16, v17, vcc
    s_cmp_lt_u32 s2, 256
    s_cbranch_scc1 L_bndrS
L_bndcS:
    s_sub_u32 s94, s2, 252
    s_mul_i32 s69, s94, 20
    s_lshr_b32 s71, s94, 1
    s_sub_u32 s69, s69, s71
    s_and_b32 s94, s94, 1
    s_sub_u32 s71, 20, s94
    s_cmp_eq_u32 s2, 255
    s_cselect_b32 s71, 13, s71
    s_mov_b32 s62, 1373568
    s_add_u32 s74, s74, 1
    s_sub_u32 s93, s93, 2688
    v_mad_i32_i24 v16, v35, -7, v131
    v_cmp_le_u32 vcc, 4, v16
    v_add_u32 v16, 193536, v130
    v_subrev_u32 v17, 2688, v130
    v_cndmask_b32 v130, v16, v17, vcc
    v_mad_i32_i24 v16, v25, -7, v6
    v_cmp_le_u32 vcc, 4, v16
    v_add_u32 v16, 193536, v129
    v_subrev_u32 v17, 2688, v129
    v_cndmask_b32 v129, v16, v17, vcc
    v_mad_i32_i24 v16, v11, -7, v22
    v_cmp_le_u32 vcc, 4, v16
    v_add_u32 v16, 193536, v128
    v_subrev_u32 v17, 2688, v128
    v_cndmask_b32 v128, v16, v17, vcc
    v_mad_i32_i24 v16, v125, -7, v124
    v_cmp_le_u32 vcc, 4, v16
    v_add_u32 v16, 193536, v127
    v_subrev_u32 v17, 2688, v127
    v_cndmask_b32 v127, v16, v17, vcc
    v_mad_i32_i24 v16, v7, -7, v26
    v_cmp_le_u32 vcc, 4, v16
    v_add_u32 v16, 193536, v126
    v_subrev_u32 v17, 2688, v126
    v_cndmask_b32 v126, v16, v17, vcc
    s_cmp_eq_u32 s2, 256
    s_cselect_b32 s62, 0, s62
    s_cselect_b32 s69, 0, s69
    s_cselect_b32 s71, 2, s71
    s_branch L_bndrS
L_maskS:
    s_and_b32 s20, s74, 2
    s_and_b32 s21, s74, 1
    s_mov_b32 s22, 0xc31044fe
    v_lshrrev_b32 v5, 2, v45
    v_add_u32 v5, 0, v5
    v_mul_u32_u24 v161, 37, v5
    v_lshrrev_b32 v160, 8, v161
    v_mad_i32_i24 v160, v160, -7, v5
    v_lshrrev_b32 v161, 10, v161
    v_lshrrev_b32 v160, 2, v160
    v_mul_u32_u24 v161, s20, v161
    v_mad_u32_u24 v5, v160, s21, v161
    v_cvt_f32_u32 v5, v5
    v_lshrrev_b32 v149, 2, v45
    v_add_u32 v149, 4, v149
    v_mul_u32_u24 v161, 37, v149
    v_lshrrev_b32 v160, 8, v161
    v_mad_i32_i24 v160, v160, -7, v149
    v_lshrrev_b32 v161, 10, v161
    v_lshrrev_b32 v160, 2, v160
    v_mul_u32_u24 v161, s20, v161
    v_mad_u32_u24 v149, v160, s21, v161
    v_cvt_f32_u32 v149, v149
    v_lshrrev_b32 v148, 2, v45
    v_add_u32 v148, 8, v148
    v_mul_u32_u24 v161, 37, v148
    v_lshrrev_b32 v160, 8, v161
    v_mad_i32_i24 v160, v160, -7, v148
    v_lshrrev_b32 v161, 10, v161
    v_lshrrev_b32 v160, 2, v160
    v_mul_u32_u24 v161, s20, v161
    v_mad_u32_u24 v148, v160, s21, v161
    v_cvt_f32_u32 v148, v148
    v_mad_u32_u24 v169, v44, 12, 0
    v_mul_u32_u24 v161, 37, v169
    v_lshrrev_b32 v160, 8, v161
    v_mad_i32_i24 v160, v160, -7, v169
    v_lshrrev_b32 v161, 10, v161
    v_lshrrev_b32 v160, 2, v160
    v_mul_u32_u24 v161, s20, v161
    v_mad_u32_u24 v169, v160, s21, v161
    v_cvt_f32_u32 v169, v169
    v_sub_f32 v161, v5, v169
    v_mul_f32 v161, v161, v161 clamp
    v_fmac_f32 v204, s22, v161
    v_sub_f32 v161, v149, v169
    v_mul_f32 v161, v161, v161 clamp
    v_fmac_f32 v192, s22, v161
    v_sub_f32 v161, v148, v169
    v_mul_f32 v161, v161, v161 clamp
    v_fmac_f32 v180, s22, v161
    v_mad_u32_u24 v169, v44, 12, 1
    v_mul_u32_u24 v161, 37, v169
    v_lshrrev_b32 v160, 8, v161
    v_mad_i32_i24 v160, v160, -7, v169
    v_lshrrev_b32 v161, 10, v161
    v_lshrrev_b32 v160, 2, v160
    v_mul_u32_u24 v161, s20, v161
    v_mad_u32_u24 v169, v160, s21, v161
    v_cvt_f32_u32 v169, v169
    v_sub_f32 v161, v5, v169
    v_mul_f32 v161, v161, v161 clamp
    v_fmac_f32 v205, s22, v161
    v_sub_f32 v161, v149, v169
    v_mul_f32 v161, v161, v161 clamp
    v_fmac_f32 v193, s22, v161
    v_sub_f32 v161, v148, v169
    v_mul_f32 v161, v161, v161 clamp
    v_fmac_f32 v181, s22, v161
    v_mad_u32_u24 v169, v44, 12, 2
    v_mul_u32_u24 v161, 37, v169
    v_lshrrev_b32 v160, 8, v161
    v_mad_i32_i24 v160, v160, -7, v169
    v_lshrrev_b32 v161, 10, v161
    v_lshrrev_b32 v160, 2, v160
    v_mul_u32_u24 v161, s20, v161
    v_mad_u32_u24 v169, v160, s21, v161
    v_cvt_f32_u32 v169, v169
    v_sub_f32 v161, v5, v169
    v_mul_f32 v161, v161, v161 clamp
    v_fmac_f32 v206, s22, v161
    v_sub_f32 v161, v149, v169
    v_mul_f32 v161, v161, v161 clamp
    v_fmac_f32 v194, s22, v161
    v_sub_f32 v161, v148, v169
    v_mul_f32 v161, v161, v161 clamp
    v_fmac_f32 v182, s22, v161
    v_mad_u32_u24 v169, v44, 12, 3
    v_mul_u32_u24 v161, 37, v169
    v_lshrrev_b32 v160, 8, v161
    v_mad_i32_i24 v160, v160, -7, v169
    v_lshrrev_b32 v161, 10, v161
    v_lshrrev_b32 v160, 2, v160
    v_mul_u32_u24 v161, s20, v161
    v_mad_u32_u24 v169, v160, s21, v161
    v_cvt_f32_u32 v169, v169
    v_sub_f32 v161, v5, v169
    v_mul_f32 v161, v161, v161 clamp
    v_fmac_f32 v207, s22, v161
    v_sub_f32 v161, v149, v169
    v_mul_f32 v161, v161, v161 clamp
    v_fmac_f32 v195, s22, v161
    v_sub_f32 v161, v148, v169
    v_mul_f32 v161, v161, v161 clamp
    v_fmac_f32 v183, s22, v161
    v_mad_u32_u24 v169, v44, 12, 4
    v_mul_u32_u24 v161, 37, v169
    v_lshrrev_b32 v160, 8, v161
    v_mad_i32_i24 v160, v160, -7, v169
    v_lshrrev_b32 v161, 10, v161
    v_lshrrev_b32 v160, 2, v160
    v_mul_u32_u24 v161, s20, v161
    v_mad_u32_u24 v169, v160, s21, v161
    v_cvt_f32_u32 v169, v169
    v_sub_f32 v161, v5, v169
    v_mul_f32 v161, v161, v161 clamp
    v_fmac_f32 v200, s22, v161
    v_sub_f32 v161, v149, v169
    v_mul_f32 v161, v161, v161 clamp
    v_fmac_f32 v188, s22, v161
    v_sub_f32 v161, v148, v169
    v_mul_f32 v161, v161, v161 clamp
    v_fmac_f32 v176, s22, v161
    v_mad_u32_u24 v169, v44, 12, 5
    v_mul_u32_u24 v161, 37, v169
    v_lshrrev_b32 v160, 8, v161
    v_mad_i32_i24 v160, v160, -7, v169
    v_lshrrev_b32 v161, 10, v161
    v_lshrrev_b32 v160, 2, v160
    v_mul_u32_u24 v161, s20, v161
    v_mad_u32_u24 v169, v160, s21, v161
    v_cvt_f32_u32 v169, v169
    v_sub_f32 v161, v5, v169
    v_mul_f32 v161, v161, v161 clamp
    v_fmac_f32 v201, s22, v161
    v_sub_f32 v161, v149, v169
    v_mul_f32 v161, v161, v161 clamp
    v_fmac_f32 v189, s22, v161
    v_sub_f32 v161, v148, v169
    v_mul_f32 v161, v161, v161 clamp
    v_fmac_f32 v177, s22, v161
    v_mad_u32_u24 v169, v44, 12, 6
    v_mul_u32_u24 v161, 37, v169
    v_lshrrev_b32 v160, 8, v161
    v_mad_i32_i24 v160, v160, -7, v169
    v_lshrrev_b32 v161, 10, v161
    v_lshrrev_b32 v160, 2, v160
    v_mul_u32_u24 v161, s20, v161
    v_mad_u32_u24 v169, v160, s21, v161
    v_cvt_f32_u32 v169, v169
    v_sub_f32 v161, v5, v169
    v_mul_f32 v161, v161, v161 clamp
    v_fmac_f32 v202, s22, v161
    v_sub_f32 v161, v149, v169
    v_mul_f32 v161, v161, v161 clamp
    v_fmac_f32 v190, s22, v161
    v_sub_f32 v161, v148, v169
    v_mul_f32 v161, v161, v161 clamp
    v_fmac_f32 v178, s22, v161
    v_mad_u32_u24 v169, v44, 12, 7
    v_mul_u32_u24 v161, 37, v169
    v_lshrrev_b32 v160, 8, v161
    v_mad_i32_i24 v160, v160, -7, v169
    v_lshrrev_b32 v161, 10, v161
    v_lshrrev_b32 v160, 2, v160
    v_mul_u32_u24 v161, s20, v161
    v_mad_u32_u24 v169, v160, s21, v161
    v_cvt_f32_u32 v169, v169
    v_sub_f32 v161, v5, v169
    v_mul_f32 v161, v161, v161 clamp
    v_fmac_f32 v203, s22, v161
    v_sub_f32 v161, v149, v169
    v_mul_f32 v161, v161, v161 clamp
    v_fmac_f32 v191, s22, v161
    v_sub_f32 v161, v148, v169
    v_mul_f32 v161, v161, v161 clamp
    v_fmac_f32 v179, s22, v161
    v_mad_u32_u24 v169, v44, 12, 8
    v_mul_u32_u24 v161, 37, v169
    v_lshrrev_b32 v160, 8, v161
    v_mad_i32_i24 v160, v160, -7, v169
    v_lshrrev_b32 v161, 10, v161
    v_lshrrev_b32 v160, 2, v160
    v_mul_u32_u24 v161, s20, v161
    v_mad_u32_u24 v169, v160, s21, v161
    v_cvt_f32_u32 v169, v169
    v_sub_f32 v161, v5, v169
    v_mul_f32 v161, v161, v161 clamp
    v_fmac_f32 v196, s22, v161
    v_sub_f32 v161, v149, v169
    v_mul_f32 v161, v161, v161 clamp
    v_fmac_f32 v184, s22, v161
    v_sub_f32 v161, v148, v169
    v_mul_f32 v161, v161, v161 clamp
    v_fmac_f32 v172, s22, v161
    v_mad_u32_u24 v169, v44, 12, 9
    v_mul_u32_u24 v161, 37, v169
    v_lshrrev_b32 v160, 8, v161
    v_mad_i32_i24 v160, v160, -7, v169
    v_lshrrev_b32 v161, 10, v161
    v_lshrrev_b32 v160, 2, v160
    v_mul_u32_u24 v161, s20, v161
    v_mad_u32_u24 v169, v160, s21, v161
    v_cvt_f32_u32 v169, v169
    v_sub_f32 v161, v5, v169
    v_mul_f32 v161, v161, v161 clamp
    v_fmac_f32 v197, s22, v161
    v_sub_f32 v161, v149, v169
    v_mul_f32 v161, v161, v161 clamp
    v_fmac_f32 v185, s22, v161
    v_sub_f32 v161, v148, v169
    v_mul_f32 v161, v161, v161 clamp
    v_fmac_f32 v173, s22, v161
    v_mad_u32_u24 v169, v44, 12, 10
    v_mul_u32_u24 v161, 37, v169
    v_lshrrev_b32 v160, 8, v161
    v_mad_i32_i24 v160, v160, -7, v169
    v_lshrrev_b32 v161, 10, v161
    v_lshrrev_b32 v160, 2, v160
    v_mul_u32_u24 v161, s20, v161
    v_mad_u32_u24 v169, v160, s21, v161
    v_cvt_f32_u32 v169, v169
    v_sub_f32 v161, v5, v169
    v_mul_f32 v161, v161, v161 clamp
    v_fmac_f32 v198, s22, v161
    v_sub_f32 v161, v149, v169
    v_mul_f32 v161, v161, v161 clamp
    v_fmac_f32 v186, s22, v161
    v_sub_f32 v161, v148, v169
    v_mul_f32 v161, v161, v161 clamp
    v_fmac_f32 v174, s22, v161
    v_mad_u32_u24 v169, v44, 12, 11
    v_mul_u32_u24 v161, 37, v169
    v_lshrrev_b32 v160, 8, v161
    v_mad_i32_i24 v160, v160, -7, v169
    v_lshrrev_b32 v161, 10, v161
    v_lshrrev_b32 v160, 2, v160
    v_mul_u32_u24 v161, s20, v161
    v_mad_u32_u24 v169, v160, s21, v161
    v_cvt_f32_u32 v169, v169
    v_sub_f32 v161, v5, v169
    v_mul_f32 v161, v161, v161 clamp
    v_fmac_f32 v199, s22, v161
    v_sub_f32 v161, v149, v169
    v_mul_f32 v161, v161, v161 clamp
    v_fmac_f32 v187, s22, v161
    v_sub_f32 v161, v148, v169
    v_mul_f32 v161, v161, v161 clamp
    v_fmac_f32 v175, s22, v161
    v_cvt_f32_u32 v169, s74
    v_sub_f32 v161, v5, v169
    v_mul_f32 v161, v161, v161 clamp
    v_fmac_f32 v208, s22, v161
    v_sub_f32 v161, v149, v169
    v_mul_f32 v161, v161, v161 clamp
    v_fmac_f32 v209, s22, v161
    v_sub_f32 v161, v148, v169
    v_mul_f32 v161, v161, v161 clamp
    v_fmac_f32 v210, s22, v161
    v_lshrrev_b32 v5, 2, v45
    v_lshl_add_u32 v5, v44, 2, v5
    v_add_u32 v161, 1, v44
    v_lshrrev_b32 v161, 2, v161
    v_mad_u32_u24 v5, v161, 36, v5
    v_min_u32 v5, 48, v5
    v_mul_u32_u24 v161, 37, v5
    v_lshrrev_b32 v160, 8, v161
    v_mad_i32_i24 v160, v160, -7, v5
    v_lshrrev_b32 v161, 10, v161
    v_lshrrev_b32 v160, 2, v160
    v_mul_u32_u24 v161, s20, v161
    v_mad_u32_u24 v5, v160, s21, v161
    v_cvt_f32_u32 v5, v5
    v_sub_f32 v161, v5, v169
    v_mul_f32 v161, v161, v161 clamp
    v_fmac_f32 v211, s22, v161
    s_branch L_nomaskS
L_atomS0:
    v_mov_b32 v167, 0x800000
    buffer_atomic_add v167, v163, s[8:11], 0 offen sc0 sc1
    s_branch L_atomS0r

.section .rodata,"a"
.p2align 6
.amdhsa_kernel standalone__window_attn_swin_v2__vision_kernel
  .amdhsa_next_free_vgpr 512
  .amdhsa_next_free_sgpr 102
  .amdhsa_accum_offset 256
  .amdhsa_group_segment_fixed_size 0
  .amdhsa_kernarg_size 96
  .amdhsa_user_sgpr_count 2
  .amdhsa_user_sgpr_kernarg_segment_ptr 1
  .amdhsa_system_sgpr_workgroup_id_x 1
.end_amdhsa_kernel
```
